```python
import torch

def _softmax(x, axis=-1):
    return torch.softmax(x, dim=axis)
def _gelu(x):
    return torch.nn.functional.gelu(x, approximate="tanh")
def _silu(x):
    return torch.nn.functional.silu(x)
def _sigmoid(x):
    return torch.sigmoid(x)
def _layernorm(x, axis=-1, eps=1e-5):
    m = x.mean(dim=axis, keepdim=True)
    v = x.var(dim=axis, keepdim=True, unbiased=False)
    return (x - m) / torch.sqrt(v + eps)
def _scatter_add(tgt, idx, src, axis=0):
    return tgt.clone().index_add_(axis, idx, src)
def _segment_sum(src, seg, n):
    out = torch.zeros((n,) + src.shape[1:], dtype=src.dtype)
    return out.index_add_(0, seg, src)
def _pad(x, pw):
    flat = tuple(v for pair in reversed(pw) for v in pair)
    return torch.nn.functional.pad(x, flat)

kernel_name = 'standalone__kv_cache_quant_int4_int2_kv_with_per_channel_or_per_token_scales__prompt'

def setup_inputs():

    _w = (lambda a: (lambda t: t.to(torch.bfloat16) if t.is_floating_point() else t)(torch.as_tensor(a)))
    B = 1
    Sq = 2048
    Skv = 2048
    Hq = 32
    Hkv = 32
    Dh = 192
    bits = 8
    G = 64
    if G <= 0 or G >= Skv:
        G = max(1, Skv // 2)
    Skv = (Skv // G) * G
    ngk = Skv // G
    qmax = (1 << bits) - 1
    return {
        "q": _w((lambda *s: torch.randn(*s, dtype=torch.bfloat16) * 0.2)(B, Hq, Sq, Dh)),
        "qk": _w(torch.randint(0, qmax + 1, (B, Hkv, Skv, Dh)).to(torch.int32)),
        "qv": _w(torch.randint(0, qmax + 1, (B, Hkv, Skv, Dh)).to(torch.int32)),
        "k_scales": _w(torch.abs((lambda *s: torch.randn(*s, dtype=torch.bfloat16) * 0.2)(B, Hkv, ngk, Dh)) * 0.05 + 0.02),
        "k_zeros": _w((lambda *s: torch.randn(*s, dtype=torch.bfloat16) * 0.2)(B, Hkv, ngk, Dh) + float(qmax) / 2.0),
        "v_scales": _w(torch.abs((lambda *s: torch.randn(*s, dtype=torch.bfloat16) * 0.05)(B, Hkv, Skv, 1)) * 0.05 + 0.02),
        "v_zeros": _w((lambda *s: torch.randn(*s, dtype=torch.bfloat16) * 0.05)(B, Hkv, Skv, 1) + float(qmax) / 2.0),
    }

def reference(q, qk, qv, k_scales, k_zeros, v_scales, v_zeros):
    B, Hq, Sq, Dh = q.shape
    Hkv, Skv = qk.shape[1], qk.shape[2]
    ngk = k_scales.shape[2]
    G = Skv // ngk
    ks = (lambda x, n, axis: torch.repeat_interleave(x, n, dim=axis))(k_scales, G, axis=2)
    kz = (lambda x, n, axis: torch.repeat_interleave(x, n, dim=axis))(k_zeros, G, axis=2)
    k = ((lambda x, dt: x.to(dt))(qk, q.dtype) - kz) * ks
    v = ((lambda x, dt: x.to(dt))(qv, q.dtype) - v_zeros) * v_scales
    rep = Hq // Hkv
    if rep > 1:
        k = (lambda x, n, axis: torch.repeat_interleave(x, n, dim=axis))(k, rep, axis=1)
        v = (lambda x, n, axis: torch.repeat_interleave(x, n, dim=axis))(v, rep, axis=1)
    scale = float(Dh) ** -0.5
    logits = torch.einsum("bhqd,bhkd->bhqk", q, k) * scale
    p = _softmax(logits, axis=-1)
    o = torch.einsum("bhqk,bhkd->bhqd", p, v)
    return o
```

```asm
; @launch grid=(256,1,1) block=(256,1,1) lds=147584
.amdgcn_target "amdgcn-amd-amdhsa--gfx950"
.text
.globl standalone__kv_cache_quant_int4_int2_kv_with_per_channel_or_per_token_scales__prompt_kernel
.p2align 8
.type standalone__kv_cache_quant_int4_int2_kv_with_per_channel_or_per_token_scales__prompt_kernel,@function
standalone__kv_cache_quant_int4_int2_kv_with_per_channel_or_per_token_scales__prompt_kernel:
    s_cmp_ge_u32 s2, 256
    s_cbranch_scc1 L_done
    s_load_dwordx16 s[40:55], s[0:1], 0
    s_load_dwordx4 s[16:19], s[0:1], 64
    s_and_b32 s94, s2, 7
    s_lshr_b32 s95, s2, 3
    s_lshr_b32 s24, s95, 3
    s_lshl_b32 s94, s94, 2
    s_add_u32 s94, s94, s24
    s_and_b32 s95, s95, 7
    s_getpc_b64 s[60:61]
L_pc:
    s_sub_u32 s60, s60, L_pc-standalone__kv_cache_quant_int4_int2_kv_with_per_channel_or_per_token_scales__prompt_kernel
    s_subb_u32 s61, s61, 0
    s_mov_b32 s62, L_slow-standalone__kv_cache_quant_int4_int2_kv_with_per_channel_or_per_token_scales__prompt_kernel
    s_mov_b32 s63, 0x20000
    s_lshr_b32 s22, s2, 3
    s_lshl_b32 s22, s22, 12
    v_lshlrev_b32 v30, 4, v0
    buffer_load_dwordx4 v[128:131], v30, s[60:63], s22 offen
    v_lshrrev_b32 v24, 6, v0
    v_and_b32 v25, 63, v0
    v_readfirstlane_b32 s25, v24
    v_lshlrev_b32 v1, 4, v25
    v_mul_u32_u24 v26, 43, v25
    v_lshrrev_b32 v26, 10, v26
    v_mul_u32_u24 v27, 24, v26
    v_sub_u32 v27, v25, v27
    v_lshrrev_b32 v28, 1, v24
    v_and_b32 v29, 1, v24
    v_lshlrev_b32 v30, 4, v29
    v_lshl_add_u32 v30, v28, 2, v30
    v_add_u32 v30, v30, v26
    v_mul_u32_u24 v30, 768, v30
    v_lshrrev_b32 v48, 1, v26
    v_lshlrev_b32 v48, 30, v48
    v_lshl_add_u32 v30, v27, 4, v30
    v_or_b32 v9, v30, v48
    v_lshl_or_b32 v10, v27, 3, v48
    v_mul_u32_u24 v30, 6144, v24
    v_add3_u32 v12, v30, v1, v48
    s_mov_b32 s66, 1572864
    s_mov_b32 s67, 0x20000
    s_mov_b32 s70, 1572864
    s_mov_b32 s71, 0x20000
    s_mov_b32 s74, 12288
    s_mov_b32 s75, 0x20000
    s_mov_b32 s78, 12288
    s_mov_b32 s79, 0x20000
    s_mov_b32 s82, 4096
    s_mov_b32 s83, 0x20000
    s_mov_b32 s86, 4096
    s_mov_b32 s87, 0x20000
    s_mov_b32 s22, 64
    s_mov_b32 s23, 0x20000
    s_mul_i32 s33, s95, 24576
    s_add_u32 s34, s33, 6144
    s_mov_b32 s35, s33
    s_lshr_b32 s36, s95, 1
    s_mul_i32 s36, s36, 384
    s_lshl_b32 s37, s95, 6
    s_lshl_b32 s24, s25, 4
    s_add_u32 s37, s37, s24
    s_mul_i32 s24, s94, 1572864
    s_mul_i32 s56, s94, 12288
    s_lshl_b32 s57, s94, 12
    s_lshl_b32 s58, s94, 10
    s_add_u32 s58, s58, 51380320
    s_or_b32 s39, s95, s25
    s_waitcnt lgkmcnt(0)
    s_add_u32 s64, s42, s24
    s_addc_u32 s65, s43, 0
    s_add_u32 s72, s46, s56
    s_addc_u32 s73, s47, 0
    s_add_u32 s76, s48, s56
    s_addc_u32 s77, s49, 0
    buffer_load_dwordx4 v[224:227], v9, s[64:67], s33 offen offset:0 nt
    buffer_load_dwordx4 v[228:231], v9, s[64:67], s33 offen offset:1536 nt
    buffer_load_dwordx4 v[232:235], v9, s[64:67], s34 offen offset:0 nt
    buffer_load_dwordx4 v[236:239], v9, s[64:67], s34 offen offset:1536 nt
    buffer_load_dwordx2 v[32:33], v10, s[72:75], s36 offen offset:0
    buffer_load_dwordx2 v[34:35], v10, s[76:79], s36 offen offset:0
    buffer_load_dwordx2 v[36:37], v10, s[72:75], s36 offen offset:192
    buffer_load_dwordx2 v[38:39], v10, s[76:79], s36 offen offset:192
    s_add_u32 s20, s18, s58
    s_addc_u32 s21, s19, 0
    s_add_u32 s80, s50, s57
    s_addc_u32 s81, s51, 0
    s_add_u32 s84, s52, s57
    s_addc_u32 s85, s53, 0
    s_add_u32 s68, s44, s24
    s_addc_u32 s69, s45, 0
    s_mul_i32 s59, s94, 786432
    s_add_u32 s12, s54, s59
    s_addc_u32 s13, s55, 0
    s_add_u32 s8, s40, s59
    s_addc_u32 s9, s41, 0
    s_cmp_lg_u32 s39, 0
    s_cbranch_scc1 L_notleader0
    s_buffer_load_dwordx16 s[40:55], s[20:23], 0 glc
L_notleader0:
    buffer_load_dwordx4 v[240:243], v9, s[64:67], s33 offen offset:384 nt
    buffer_load_dwordx4 v[244:247], v9, s[64:67], s33 offen offset:1920 nt
    buffer_load_dwordx4 v[248:251], v9, s[64:67], s34 offen offset:384 nt
    buffer_load_dwordx4 v[252:255], v9, s[64:67], s34 offen offset:1920 nt
    s_add_u32 s4, s18, s24
    s_addc_u32 s5, s19, 0
    s_mov_b32 s6, 1572864
    s_mov_b32 s7, 0x20000
    s_mov_b32 s10, 786432
    s_mov_b32 s11, 0x20000
    s_mov_b32 s88, s16
    s_mov_b32 s89, s17
    s_add_u32 s16, s33, 3072
    s_add_u32 s17, s33, 6144
    s_mov_b32 s90, 256
    s_mov_b32 s91, 0x20000
    s_lshl_b32 s93, s94, 3
    s_cmp_lg_u32 s39, 0
    s_cbranch_scc1 L_notleader
    s_waitcnt lgkmcnt(0)
    s_mov_b32 s59, 1
    s_lshr_b32 s40, s40, 10
    s_min_u32 s40, s40, 31
    s_bitset1_b32 s59, s40
    s_lshr_b32 s41, s41, 10
    s_min_u32 s41, s41, 31
    s_bitset1_b32 s59, s41
    s_lshr_b32 s42, s42, 10
    s_min_u32 s42, s42, 31
    s_bitset1_b32 s59, s42
    s_lshr_b32 s43, s43, 10
    s_min_u32 s43, s43, 31
    s_bitset1_b32 s59, s43
    s_lshr_b32 s44, s44, 10
    s_min_u32 s44, s44, 31
    s_bitset1_b32 s59, s44
    s_lshr_b32 s45, s45, 10
    s_min_u32 s45, s45, 31
    s_bitset1_b32 s59, s45
    s_lshr_b32 s46, s46, 10
    s_min_u32 s46, s46, 31
    s_bitset1_b32 s59, s46
    s_lshr_b32 s47, s47, 10
    s_min_u32 s47, s47, 31
    s_bitset1_b32 s59, s47
    s_lshr_b32 s48, s48, 10
    s_min_u32 s48, s48, 31
    s_bitset1_b32 s59, s48
    s_lshr_b32 s49, s49, 10
    s_min_u32 s49, s49, 31
    s_bitset1_b32 s59, s49
    s_lshr_b32 s50, s50, 10
    s_min_u32 s50, s50, 31
    s_bitset1_b32 s59, s50
    s_lshr_b32 s51, s51, 10
    s_min_u32 s51, s51, 31
    s_bitset1_b32 s59, s51
    s_lshr_b32 s52, s52, 10
    s_min_u32 s52, s52, 31
    s_bitset1_b32 s59, s52
    s_lshr_b32 s53, s53, 10
    s_min_u32 s53, s53, 31
    s_bitset1_b32 s59, s53
    s_lshr_b32 s54, s54, 10
    s_min_u32 s54, s54, 31
    s_bitset1_b32 s59, s54
    s_lshr_b32 s55, s55, 10
    s_min_u32 s55, s55, 31
    s_bitset1_b32 s59, s55
    s_ff0_i32_b32 s59, s59
    s_lshl_b32 s59, s59, 10
    v_mov_b32 v52, s59
    s_mov_b64 exec, 1
    buffer_store_dword v52, off, s[88:91], s93 sc1
    s_mov_b64 exec, -1
L_notleader:
    s_lshl_b32 s24, s95, 2
    s_add_u32 s24, s24, 32
    s_buffer_load_dword s46, s[20:23], s24 glc
    s_mov_b32 s45, 0
    s_mov_b32 s44, 32
    buffer_load_dwordx4 v[112:115], v12, s[68:71], s35 offen offset:0 nt
    buffer_load_dwordx4 v[116:119], v12, s[68:71], s35 offen offset:768 nt
    buffer_load_dwordx4 v[120:123], v12, s[68:71], s35 offen offset:1536 nt
    buffer_load_dwordx4 v[124:127], v12, s[68:71], s35 offen offset:2304 nt
    buffer_load_dwordx2 v[40:41], off, s[80:83], s37 offset:0
    buffer_load_dwordx2 v[42:43], off, s[84:87], s37 offset:0
    buffer_load_dwordx2 v[44:45], off, s[80:83], s37 offset:8
    buffer_load_dwordx2 v[46:47], off, s[84:87], s37 offset:8
    s_mov_b32 s14, 786432
    s_mov_b32 s15, 0x20000
    s_lshl_b32 s24, s25, 8
    s_add_u32 s93, s93, s24
    v_mul_u32_u24 v30, 3072, v24
    v_add_u32 v4, v30, v1
    v_lshl_add_u32 v30, v24, 3, v26
    v_mul_u32_u24 v30, 384, v30
    v_lshlrev_b32 v31, 2, v29
    v_xor_b32 v31, v27, v31
    v_lshl_add_u32 v30, v31, 4, v30
    v_or_b32 v11, v30, v48
    v_lshlrev_b32 v30, 8, v24
    v_add_u32 v30, 12288, v30
    v_lshrrev_b32 v31, 4, v25
    v_lshl_add_u32 v30, v31, 10, v30
    v_and_b32 v31, 15, v25
    v_lshl_add_u32 v30, v31, 4, v30
    v_or_b32 v20, v30, v48
    s_lshl_b32 s24, s95, 2
    v_lshl_add_u32 v13, v0, 2, s24
    v_cmp_lt_u32 vcc, 0, v0
    v_mov_b32 v30, 0x40000000
    s_nop 0
    v_cndmask_b32 v13, v13, v30, vcc
    s_mul_i32 s26, s25, 3072
    s_add_u32 s26, s26, 12288
    s_add_u32 s56, s26, 24576
    s_add_u32 s24, s95, 1
    s_and_b32 s24, s24, 7
    s_mul_i32 s32, s24, 24576
    s_add_u32 s27, s32, 12288
    s_mov_b32 s28, 98304
    s_mov_b32 s30, 73728
    v_add_u32 v1, 24576, v1
    s_mov_b32 s38, 0x3dd53b95
    s_mov_b32 s97, 0xffff0000
    s_mov_b32 s96, 100000
    v_and_b32 v26, 15, v25
    v_lshrrev_b32 v27, 4, v25
    v_bfe_u32 v28, v25, 1, 3
    v_xor_b32 v29, v27, v28
    v_mul_u32_u24 v30, 384, v26
    v_lshl_add_u32 v2, v29, 4, v30
    v_xor_b32 v3, 64, v2
    s_mul_i32 s40, s25, 6144
    s_add_u32 s40, s40, 73728
    v_lshrrev_b32 v29, 1, v27
    v_xor_b32 v29, v29, v28
    v_lshl_add_u32 v31, v29, 4, v30
    v_and_b32 v29, 1, v27
    v_lshl_add_u32 v31, v29, 3, v31
    v_xor_b32 v22, 0, v31
    v_add_u32 v22, s40, v22
    v_xor_b32 v23, 32, v31
    v_add_u32 v23, s40, v23
    v_xor_b32 v142, 64, v31
    v_add_u32 v142, s40, v142
    v_xor_b32 v143, 96, v31
    v_add_u32 v143, s40, v143
    s_lshl_b32 s24, s95, 2
    s_add_u32 s24, s24, s25
    s_mul_i32 s24, s24, 24576
    v_add_u32 v26, 0, v25
    v_mul_u32_u24 v27, 2731, v26
    v_lshrrev_b32 v27, 17, v27
    v_and_b32 v27, 7, v27
    v_xor_b32 v26, v26, v27
    v_lshlrev_b32 v136, 4, v26
    v_add_u32 v136, s24, v136
    v_add_u32 v26, 64, v25
    v_mul_u32_u24 v27, 2731, v26
    v_lshrrev_b32 v27, 17, v27
    v_and_b32 v27, 7, v27
    v_xor_b32 v26, v26, v27
    v_lshlrev_b32 v137, 4, v26
    v_add_u32 v137, s24, v137
    v_add_u32 v26, 128, v25
    v_mul_u32_u24 v27, 2731, v26
    v_lshrrev_b32 v27, 17, v27
    v_and_b32 v27, 7, v27
    v_xor_b32 v26, v26, v27
    v_lshlrev_b32 v138, 4, v26
    v_add_u32 v138, s24, v138
    v_add_u32 v26, 192, v25
    v_mul_u32_u24 v27, 2731, v26
    v_lshrrev_b32 v27, 17, v27
    v_and_b32 v27, 7, v27
    v_xor_b32 v26, v26, v27
    v_lshlrev_b32 v139, 4, v26
    v_add_u32 v139, s24, v139
    v_add_u32 v26, 256, v25
    v_mul_u32_u24 v27, 2731, v26
    v_lshrrev_b32 v27, 17, v27
    v_and_b32 v27, 7, v27
    v_xor_b32 v26, v26, v27
    v_lshlrev_b32 v140, 4, v26
    v_add_u32 v140, s24, v140
    v_add_u32 v26, 320, v25
    v_mul_u32_u24 v27, 2731, v26
    v_lshrrev_b32 v27, 17, v27
    v_and_b32 v27, 7, v27
    v_xor_b32 v26, v26, v27
    v_lshlrev_b32 v141, 4, v26
    v_add_u32 v141, s24, v141
    v_mov_b32 v5, 0
    v_mov_b32 v6, 0
    v_mov_b32 v7, 0
    v_mov_b32 v8, 0
    s_mov_b32 s62, -1
    s_mov_b32 s63, 0xffff
    s_waitcnt vmcnt(12)
    buffer_load_dwordx4 v[80:83], v12, s[68:71], s16 offen offset:0 nt
    buffer_load_dwordx4 v[84:87], v12, s[68:71], s16 offen offset:768 nt
    buffer_load_dwordx4 v[88:91], v12, s[68:71], s16 offen offset:1536 nt
    buffer_load_dwordx4 v[92:95], v12, s[68:71], s16 offen offset:2304 nt
    v_lshlrev_b32 v48, 16, v32
    v_and_b32 v49, s97, v32
    v_lshlrev_b32 v50, 16, v34
    v_and_b32 v51, s97, v34
    v_mul_f32 v48, s38, v48
    v_mul_f32 v49, s38, v49
    v_mul_f32_e64 v50, -v50, v48
    v_mul_f32_e64 v51, -v51, v49
    v_cvt_f32_i32 v224, v224
    v_cvt_f32_i32 v225, v225
    v_fma_f32 v224, v224, v48, v50
    v_fma_f32 v225, v225, v49, v51
    v_cvt_pk_bf16_f32 v224, v224, v225
    v_cvt_f32_i32 v228, v228
    v_cvt_f32_i32 v229, v229
    v_fma_f32 v228, v228, v48, v50
    v_fma_f32 v229, v229, v49, v51
    v_cvt_pk_bf16_f32 v228, v228, v229
    v_cvt_f32_i32 v232, v232
    v_cvt_f32_i32 v233, v233
    v_fma_f32 v232, v232, v48, v50
    v_fma_f32 v233, v233, v49, v51
    v_cvt_pk_bf16_f32 v232, v232, v233
    v_cvt_f32_i32 v236, v236
    v_cvt_f32_i32 v237, v237
    v_fma_f32 v236, v236, v48, v50
    v_fma_f32 v237, v237, v49, v51
    v_cvt_pk_bf16_f32 v236, v236, v237
    v_lshlrev_b32 v48, 16, v33
    v_and_b32 v49, s97, v33
    v_lshlrev_b32 v50, 16, v35
    v_and_b32 v51, s97, v35
    v_mul_f32 v48, s38, v48
    v_mul_f32 v49, s38, v49
    v_mul_f32_e64 v50, -v50, v48
    v_mul_f32_e64 v51, -v51, v49
    v_cvt_f32_i32 v226, v226
    v_cvt_f32_i32 v227, v227
    v_fma_f32 v226, v226, v48, v50
    v_fma_f32 v227, v227, v49, v51
    v_cvt_pk_bf16_f32 v225, v226, v227
    v_cvt_f32_i32 v230, v230
    v_cvt_f32_i32 v231, v231
    v_fma_f32 v230, v230, v48, v50
    v_fma_f32 v231, v231, v49, v51
    v_cvt_pk_bf16_f32 v229, v230, v231
    v_cvt_f32_i32 v234, v234
    v_cvt_f32_i32 v235, v235
    v_fma_f32 v234, v234, v48, v50
    v_fma_f32 v235, v235, v49, v51
    v_cvt_pk_bf16_f32 v233, v234, v235
    v_cvt_f32_i32 v238, v238
    v_cvt_f32_i32 v239, v239
    v_fma_f32 v238, v238, v48, v50
    v_fma_f32 v239, v239, v49, v51
    v_cvt_pk_bf16_f32 v237, v238, v239
    s_waitcnt vmcnt(12)
    v_lshlrev_b32 v48, 16, v36
    v_and_b32 v49, s97, v36
    v_lshlrev_b32 v50, 16, v38
    v_and_b32 v51, s97, v38
    v_mul_f32 v48, s38, v48
    v_mul_f32 v49, s38, v49
    v_mul_f32_e64 v50, -v50, v48
    v_mul_f32_e64 v51, -v51, v49
    v_cvt_f32_i32 v240, v240
    v_cvt_f32_i32 v241, v241
    v_fma_f32 v240, v240, v48, v50
    v_fma_f32 v241, v241, v49, v51
    v_cvt_pk_bf16_f32 v226, v240, v241
    v_cvt_f32_i32 v244, v244
    v_cvt_f32_i32 v245, v245
    v_fma_f32 v244, v244, v48, v50
    v_fma_f32 v245, v245, v49, v51
    v_cvt_pk_bf16_f32 v230, v244, v245
    v_cvt_f32_i32 v248, v248
    v_cvt_f32_i32 v249, v249
    v_fma_f32 v248, v248, v48, v50
    v_fma_f32 v249, v249, v49, v51
    v_cvt_pk_bf16_f32 v234, v248, v249
    v_cvt_f32_i32 v252, v252
    v_cvt_f32_i32 v253, v253
    v_fma_f32 v252, v252, v48, v50
    v_fma_f32 v253, v253, v49, v51
    v_cvt_pk_bf16_f32 v238, v252, v253
    v_lshlrev_b32 v48, 16, v37
    v_and_b32 v49, s97, v37
    v_lshlrev_b32 v50, 16, v39
    v_and_b32 v51, s97, v39
    v_mul_f32 v48, s38, v48
    v_mul_f32 v49, s38, v49
    v_mul_f32_e64 v50, -v50, v48
    v_mul_f32_e64 v51, -v51, v49
    v_cvt_f32_i32 v242, v242
    v_cvt_f32_i32 v243, v243
    v_fma_f32 v242, v242, v48, v50
    v_fma_f32 v243, v243, v49, v51
    v_cvt_pk_bf16_f32 v227, v242, v243
    v_cvt_f32_i32 v246, v246
    v_cvt_f32_i32 v247, v247
    v_fma_f32 v246, v246, v48, v50
    v_fma_f32 v247, v247, v49, v51
    v_cvt_pk_bf16_f32 v231, v246, v247
    v_cvt_f32_i32 v250, v250
    v_cvt_f32_i32 v251, v251
    v_fma_f32 v250, v250, v48, v50
    v_fma_f32 v251, v251, v49, v51
    v_cvt_pk_bf16_f32 v235, v250, v251
    v_cvt_f32_i32 v254, v254
    v_cvt_f32_i32 v255, v255
    v_fma_f32 v254, v254, v48, v50
    v_fma_f32 v255, v255, v49, v51
    v_cvt_pk_bf16_f32 v239, v254, v255
    buffer_store_dwordx4 v[224:227], v11, s[4:7], s33 offen offset:0 sc1
    s_mov_b64 exec, s[62:63]
    ds_write_b128 v11, v[224:227] offset:0
    s_mov_b64 exec, -1
    v_xor_b32 v55, 16, v11
    buffer_store_dwordx4 v[228:231], v55, s[4:7], s33 offen offset:768 sc1
    s_mov_b64 exec, s[62:63]
    ds_write_b128 v55, v[228:231] offset:768
    s_mov_b64 exec, -1
    v_xor_b32 v54, 32, v11
    buffer_store_dwordx4 v[232:235], v54, s[4:7], s33 offen offset:1536 sc1
    s_mov_b64 exec, s[62:63]
    ds_write_b128 v54, v[232:235] offset:1536
    s_mov_b64 exec, -1
    v_xor_b32 v55, 48, v11
    buffer_store_dwordx4 v[236:239], v55, s[4:7], s33 offen offset:2304 sc1
    s_mov_b64 exec, s[62:63]
    ds_write_b128 v55, v[236:239] offset:2304
    s_mov_b64 exec, -1
    s_mov_b32 s41, 0
    s_add_u32 m0, s40, 24576
    s_nop 0
    buffer_load_dwordx4 v136, s[8:11], s41 offen nt lds
    s_add_u32 m0, s40, 25600
    s_nop 0
    buffer_load_dwordx4 v137, s[8:11], s41 offen nt lds
    s_add_u32 m0, s40, 26624
    s_nop 0
    buffer_load_dwordx4 v138, s[8:11], s41 offen nt lds
    s_add_u32 m0, s40, 27648
    s_nop 0
    buffer_load_dwordx4 v139, s[8:11], s41 offen nt lds
    s_add_u32 m0, s40, 28672
    s_nop 0
    buffer_load_dwordx4 v140, s[8:11], s41 offen nt lds
    s_add_u32 m0, s40, 29696
    s_waitcnt vmcnt(20)
    buffer_load_dwordx4 v141, s[8:11], s41 offen nt lds
    s_waitcnt vmcnt(14)
    v_lshlrev_b32 v48, 16, v40
    v_and_b32 v49, s97, v40
    v_lshlrev_b32 v50, 16, v42
    v_and_b32 v51, s97, v42
    v_mul_f32_e64 v50, -v50, v48
    v_mul_f32_e64 v51, -v51, v49
    v_cvt_f32_i32 v112, v112
    v_cvt_f32_i32 v116, v116
    v_fma_f32 v112, v112, v48, v50
    v_fma_f32 v116, v116, v49, v51
    v_cvt_f32_i32 v113, v113
    v_cvt_f32_i32 v117, v117
    v_fma_f32 v113, v113, v48, v50
    v_fma_f32 v117, v117, v49, v51
    v_cvt_f32_i32 v114, v114
    v_cvt_f32_i32 v118, v118
    v_fma_f32 v114, v114, v48, v50
    v_fma_f32 v118, v118, v49, v51
    v_cvt_f32_i32 v115, v115
    v_cvt_f32_i32 v119, v119
    v_fma_f32 v115, v115, v48, v50
    v_fma_f32 v119, v119, v49, v51
    v_lshlrev_b32 v48, 16, v41
    v_and_b32 v49, s97, v41
    v_lshlrev_b32 v50, 16, v43
    v_and_b32 v51, s97, v43
    v_mul_f32_e64 v50, -v50, v48
    v_mul_f32_e64 v51, -v51, v49
    v_cvt_f32_i32 v120, v120
    v_cvt_f32_i32 v124, v124
    v_fma_f32 v120, v120, v48, v50
    v_fma_f32 v124, v124, v49, v51
    v_cvt_f32_i32 v121, v121
    v_cvt_f32_i32 v125, v125
    v_fma_f32 v121, v121, v48, v50
    v_fma_f32 v125, v125, v49, v51
    v_cvt_f32_i32 v122, v122
    v_cvt_f32_i32 v126, v126
    v_fma_f32 v122, v122, v48, v50
    v_fma_f32 v126, v126, v49, v51
    v_cvt_f32_i32 v123, v123
    v_cvt_f32_i32 v127, v127
    v_fma_f32 v123, v123, v48, v50
    v_fma_f32 v127, v127, v49, v51
    v_cvt_pk_bf16_f32 v112, v112, v116
    v_cvt_pk_bf16_f32 v116, v113, v117
    v_cvt_pk_bf16_f32 v113, v120, v124
    v_cvt_pk_bf16_f32 v117, v121, v125
    v_cvt_pk_bf16_f32 v120, v114, v118
    v_cvt_pk_bf16_f32 v121, v122, v126
    v_cvt_pk_bf16_f32 v124, v115, v119
    v_cvt_pk_bf16_f32 v125, v123, v127
    s_waitcnt vmcnt(10)
    v_lshlrev_b32 v48, 16, v44
    v_and_b32 v49, s97, v44
    v_lshlrev_b32 v50, 16, v46
    v_and_b32 v51, s97, v46
    v_mul_f32_e64 v50, -v50, v48
    v_mul_f32_e64 v51, -v51, v49
    v_cvt_f32_i32 v80, v80
    v_cvt_f32_i32 v84, v84
    v_fma_f32 v80, v80, v48, v50
    v_fma_f32 v84, v84, v49, v51
    v_cvt_f32_i32 v81, v81
    v_cvt_f32_i32 v85, v85
    v_fma_f32 v81, v81, v48, v50
    v_fma_f32 v85, v85, v49, v51
    v_cvt_f32_i32 v82, v82
    v_cvt_f32_i32 v86, v86
    v_fma_f32 v82, v82, v48, v50
    v_fma_f32 v86, v86, v49, v51
    v_cvt_f32_i32 v83, v83
    v_cvt_f32_i32 v87, v87
    v_fma_f32 v83, v83, v48, v50
    v_fma_f32 v87, v87, v49, v51
    v_lshlrev_b32 v48, 16, v45
    v_and_b32 v49, s97, v45
    v_lshlrev_b32 v50, 16, v47
    v_and_b32 v51, s97, v47
    v_mul_f32_e64 v50, -v50, v48
    v_mul_f32_e64 v51, -v51, v49
    v_cvt_f32_i32 v88, v88
    v_cvt_f32_i32 v92, v92
    v_fma_f32 v88, v88, v48, v50
    v_fma_f32 v92, v92, v49, v51
    v_cvt_f32_i32 v89, v89
    v_cvt_f32_i32 v93, v93
    v_fma_f32 v89, v89, v48, v50
    v_fma_f32 v93, v93, v49, v51
    v_cvt_f32_i32 v90, v90
    v_cvt_f32_i32 v94, v94
    v_fma_f32 v90, v90, v48, v50
    v_fma_f32 v94, v94, v49, v51
    v_cvt_f32_i32 v91, v91
    v_cvt_f32_i32 v95, v95
    v_fma_f32 v91, v91, v48, v50
    v_fma_f32 v95, v95, v49, v51
    v_cvt_pk_bf16_f32 v114, v80, v84
    v_cvt_pk_bf16_f32 v118, v81, v85
    v_cvt_pk_bf16_f32 v115, v88, v92
    v_cvt_pk_bf16_f32 v119, v89, v93
    v_cvt_pk_bf16_f32 v122, v82, v86
    v_cvt_pk_bf16_f32 v123, v90, v94
    v_cvt_pk_bf16_f32 v126, v83, v87
    v_cvt_pk_bf16_f32 v127, v91, v95
    buffer_store_dwordx4 v[112:115], v20, s[4:7], s35 offen offset:0 sc1
    buffer_store_dwordx4 v[116:119], v20, s[4:7], s35 offen offset:3072 sc1
    buffer_store_dwordx4 v[120:123], v20, s[4:7], s17 offen offset:0 sc1
    buffer_store_dwordx4 v[124:127], v20, s[4:7], s17 offen offset:3072 sc1
    s_mov_b64 exec, s[62:63]
    ds_write_b128 v20, v[112:115] offset:12288
    ds_write_b128 v20, v[116:119] offset:15360
    ds_write_b128 v20, v[120:123] offset:18432
    ds_write_b128 v20, v[124:127] offset:21504
    s_mov_b64 exec, -1
    buffer_load_dword v0, off, s[88:91], s93 sc1
    s_mov_b32 s41, 6144
    s_add_u32 m0, s40, 0
    s_nop 0
    buffer_load_dwordx4 v136, s[8:11], s41 offen nt lds
    s_add_u32 m0, s40, 1024
    s_nop 0
    buffer_load_dwordx4 v137, s[8:11], s41 offen nt lds
    s_add_u32 m0, s40, 2048
    s_nop 0
    buffer_load_dwordx4 v138, s[8:11], s41 offen nt lds
    s_add_u32 m0, s40, 3072
    s_nop 0
    buffer_load_dwordx4 v139, s[8:11], s41 offen nt lds
    s_add_u32 m0, s40, 4096
    s_nop 0
    buffer_load_dwordx4 v140, s[8:11], s41 offen nt lds
    s_add_u32 m0, s40, 5120
    s_waitcnt vmcnt(15)
    buffer_load_dwordx4 v141, s[8:11], s41 offen nt lds
    s_waitcnt vmcnt(6)
    s_cmp_lg_u32 s25, 0
    s_cbranch_scc1 L_tagdone
    v_readfirstlane_b32 s42, v0
    s_mov_b32 s39, 100
    s_waitcnt lgkmcnt(0)
    s_and_b32 s46, s46, 0xfffffc00
L_tagretry:
    s_cmp_eq_u32 s42, s46
    s_cselect_b32 s42, 0, s42
    s_cmp_lg_u32 s42, 0
    s_cbranch_scc1 L_tagok
    s_sub_u32 s39, s39, 1
    s_cbranch_scc1 L_tagslow
    s_sleep 4
    s_buffer_load_dword s42, s[88:91], s93 glc
    s_waitcnt lgkmcnt(0)
    s_branch L_tagretry
L_tagok:
    s_add_u32 s42, s42, s45
    v_mov_b32 v0, s42
    v_mov_b32 v16, 147456
    ds_write_b32 v16, v0
L_tagdone:
    s_waitcnt lgkmcnt(0)
    s_barrier
    v_add_u32 v0, 1, v0
    buffer_store_dword v0, v13, s[20:23], 0 offen offset:32 sc1
    v_mov_b32 v16, 147456
    ds_read_b32 v17, v16
    s_mov_b32 s88, s60
    s_mov_b32 s89, s61
    s_mov_b32 s90, L_slow-standalone__kv_cache_quant_int4_int2_kv_with_per_channel_or_per_token_scales__prompt_kernel
    s_lshr_b32 s24, s2, 3
    s_mul_i32 s93, s24, 43
    s_lshr_b32 s93, s93, 7
    s_mul_i32 s39, s93, 3
    s_sub_u32 s24, s24, s39
    s_lshl_b32 s24, s24, 10
    s_mul_i32 s93, s93, 12288
    s_add_u32 s93, s93, s24
    ds_read_b128 v[144:147], v2 offset:0
    ds_read_b128 v[148:151], v3 offset:0
    ds_read_b128 v[152:155], v2 offset:6144
    ds_read_b128 v[156:159], v3 offset:6144
    ds_read_b128 v[160:163], v2 offset:128
    ds_read_b128 v[164:167], v3 offset:128
    ds_read_b128 v[168:171], v2 offset:6272
    ds_read_b128 v[172:175], v3 offset:6272
    ds_read_b128 v[176:179], v2 offset:256
    ds_read_b128 v[180:183], v3 offset:256
    ds_read_b128 v[184:187], v2 offset:6400
    ds_read_b128 v[188:191], v3 offset:6400
    s_waitcnt vmcnt(12)
    ds_read_b64 a[192:193], v22 offset:24576
    ds_read_b64 a[194:195], v142 offset:24704
    ds_read_b64 a[196:197], v23 offset:24576
    ds_read_b64 a[198:199], v143 offset:24704
    ds_read_b64 a[200:201], v142 offset:24576
    ds_read_b64 a[202:203], v22 offset:24832
    ds_read_b64 a[204:205], v143 offset:24576
    ds_read_b64 a[206:207], v23 offset:24832
    ds_read_b64 a[208:209], v22 offset:24704
    ds_read_b64 a[210:211], v142 offset:24832
    ds_read_b64 a[212:213], v23 offset:24704
    ds_read_b64 a[214:215], v143 offset:24832
    s_waitcnt lgkmcnt(15)
    v_readfirstlane_b32 s92, v17
    s_add_u32 s92, s92, 1
    s_mov_b32 s41, 12288
    s_add_u32 m0, s40, 49152
    s_nop 0
    buffer_load_dwordx4 v136, s[8:11], s41 offen nt lds
    s_add_u32 m0, s40, 50176
    s_nop 0
    buffer_load_dwordx4 v137, s[8:11], s41 offen nt lds
    s_add_u32 m0, s40, 51200
    s_nop 0
    buffer_load_dwordx4 v138, s[8:11], s41 offen nt lds
    s_waitcnt lgkmcnt(0)
    v_mfma_f32_16x16x32_bf16 v[64:67], v[144:147], a[192:195], 0
    v_mfma_f32_16x16x32_bf16 v[64:67], v[148:151], a[196:199], v[64:67]
    v_mfma_f32_16x16x32_bf16 v[64:67], v[160:163], a[200:203], v[64:67]
    v_mfma_f32_16x16x32_bf16 v[64:67], v[164:167], a[204:207], v[64:67]
    v_mfma_f32_16x16x32_bf16 v[64:67], v[176:179], a[208:211], v[64:67]
    v_mfma_f32_16x16x32_bf16 v[64:67], v[180:183], a[212:215], v[64:67]
    v_mfma_f32_16x16x32_bf16 v[96:99], v[152:155], a[192:195], 0
    v_mfma_f32_16x16x32_bf16 v[96:99], v[156:159], a[196:199], v[96:99]
    v_mfma_f32_16x16x32_bf16 v[96:99], v[168:171], a[200:203], v[96:99]
    v_mfma_f32_16x16x32_bf16 v[96:99], v[172:175], a[204:207], v[96:99]
    v_mfma_f32_16x16x32_bf16 v[96:99], v[184:187], a[208:211], v[96:99]
    v_mfma_f32_16x16x32_bf16 v[96:99], v[188:191], a[212:215], v[96:99]
    s_waitcnt vmcnt(4)
    ds_read_b64 a[216:217], v22 offset:0
    ds_read_b64 a[218:219], v142 offset:128
    ds_read_b64 a[220:221], v23 offset:0
    ds_read_b64 a[222:223], v143 offset:128
    ds_read_b64 a[224:225], v142 offset:0
    ds_read_b64 a[226:227], v22 offset:256
    ds_read_b64 a[228:229], v143 offset:0
    ds_read_b64 a[230:231], v23 offset:256
    ds_read_b64 a[232:233], v22 offset:128
    ds_read_b64 a[234:235], v142 offset:256
    ds_read_b64 a[236:237], v23 offset:128
    ds_read_b64 a[238:239], v143 offset:256
    s_mov_b32 s41, 12288
    s_add_u32 m0, s40, 52224
    s_nop 0
    buffer_load_dwordx4 v139, s[8:11], s41 offen nt lds
    s_add_u32 m0, s40, 53248
    s_nop 0
    buffer_load_dwordx4 v140, s[8:11], s41 offen nt lds
    s_add_u32 m0, s40, 54272
    s_nop 0
    buffer_load_dwordx4 v141, s[8:11], s41 offen nt lds
    s_waitcnt lgkmcnt(0)
    v_mfma_f32_16x16x32_bf16 v[68:71], v[144:147], a[216:219], 0
    v_mfma_f32_16x16x32_bf16 v[68:71], v[148:151], a[220:223], v[68:71]
    v_mfma_f32_16x16x32_bf16 v[68:71], v[160:163], a[224:227], v[68:71]
    v_mfma_f32_16x16x32_bf16 v[68:71], v[164:167], a[228:231], v[68:71]
    v_mfma_f32_16x16x32_bf16 v[68:71], v[176:179], a[232:235], v[68:71]
    v_mfma_f32_16x16x32_bf16 v[68:71], v[180:183], a[236:239], v[68:71]
    v_mfma_f32_16x16x32_bf16 v[100:103], v[152:155], a[216:219], 0
    v_mfma_f32_16x16x32_bf16 v[100:103], v[156:159], a[220:223], v[100:103]
    v_mfma_f32_16x16x32_bf16 v[100:103], v[168:171], a[224:227], v[100:103]
    v_mfma_f32_16x16x32_bf16 v[100:103], v[172:175], a[228:231], v[100:103]
    v_mfma_f32_16x16x32_bf16 v[100:103], v[184:187], a[232:235], v[100:103]
    v_mfma_f32_16x16x32_bf16 v[100:103], v[188:191], a[236:239], v[100:103]
    s_nop 7
    ds_read_b128 v[24:27], v1 offset:0
    ds_read_b128 v[28:31], v1 offset:1024
    ds_read_b128 v[32:35], v1 offset:2048
    ds_read_b128 v[36:39], v1 offset:3072
    s_mov_b32 s41, 18432
    s_add_u32 m0, s40, 24576
    s_nop 0
    buffer_load_dwordx4 v136, s[8:11], s41 offen nt lds
    v_max3_f32 v48, v64, v65, v66
    v_max3_f32 v50, v68, v69, v70
    v_max3_f32 v48, v48, v67, v96
    v_max3_f32 v50, v50, v71, v100
    v_max3_f32 v48, v48, v97, v98
    v_max3_f32 v50, v50, v101, v102
    v_max_f32 v48, v48, v99
    v_max_f32 v50, v50, v103
    v_mov_b32 v49, v48
    v_mov_b32 v51, v50
    s_nop 0
    v_permlane16_swap_b32 v48, v49
    v_permlane16_swap_b32 v50, v51
    s_nop 0
    v_max_f32 v48, v48, v49
    v_max_f32 v50, v50, v51
    v_mov_b32 v49, v48
    v_mov_b32 v51, v50
    s_nop 0
    v_permlane32_swap_b32 v48, v49
    v_permlane32_swap_b32 v50, v51
    s_nop 0
    v_max_f32 v48, v48, v49
    v_max_f32 v50, v50, v51
    v_sub_f32 v128, 0, v48
    v_sub_f32 v129, 0, v48
    v_sub_f32 v130, 0, v48
    v_sub_f32 v131, 0, v48
    v_sub_f32 v132, 0, v50
    v_sub_f32 v133, 0, v50
    s_add_u32 m0, s40, 25600
    s_nop 0
    buffer_load_dwordx4 v137, s[8:11], s41 offen nt lds
    v_sub_f32 v134, 0, v50
    v_sub_f32 v135, 0, v50
    v_add_f32 v64, v64, v128
    v_add_f32 v65, v65, v128
    v_add_f32 v66, v66, v128
    v_add_f32 v67, v67, v128
    v_add_f32 v96, v96, v128
    v_add_f32 v97, v97, v128
    v_add_f32 v98, v98, v128
    v_add_f32 v99, v99, v128
    v_add_f32 v68, v68, v132
    v_add_f32 v69, v69, v132
    v_add_f32 v70, v70, v132
    v_add_f32 v71, v71, v132
    v_add_f32 v100, v100, v132
    v_add_f32 v101, v101, v132
    v_add_f32 v102, v102, v132
    v_add_f32 v103, v103, v132
    v_exp_f32 v16, v64
    v_exp_f32 v17, v65
    v_exp_f32 v18, v66
    v_add_f32 v5, v5, v16
    v_add_f32 v5, v5, v17
    v_exp_f32 v19, v67
    v_cvt_pk_bf16_f32 v64, v16, v17
    v_exp_f32 v16, v96
    v_add_f32 v5, v5, v18
    v_add_f32 v5, v5, v19
    v_exp_f32 v17, v97
    s_add_u32 m0, s40, 26624
    s_nop 0
    buffer_load_dwordx4 v138, s[8:11], s41 offen nt lds
    v_cvt_pk_bf16_f32 v65, v18, v19
    v_exp_f32 v18, v98
    v_add_f32 v5, v5, v16
    v_add_f32 v5, v5, v17
    v_exp_f32 v19, v99
    v_cvt_pk_bf16_f32 v66, v16, v17
    v_exp_f32 v16, v68
    v_add_f32 v5, v5, v18
    v_add_f32 v5, v5, v19
    v_exp_f32 v17, v69
    v_cvt_pk_bf16_f32 v67, v18, v19
    v_exp_f32 v18, v70
    v_add_f32 v6, v6, v16
    v_add_f32 v6, v6, v17
    v_exp_f32 v19, v71
    v_cvt_pk_bf16_f32 v68, v16, v17
    v_exp_f32 v16, v100
    v_add_f32 v6, v6, v18
    v_add_f32 v6, v6, v19
    v_exp_f32 v17, v101
    v_cvt_pk_bf16_f32 v69, v18, v19
    v_exp_f32 v18, v102
    v_add_f32 v6, v6, v16
    v_add_f32 v6, v6, v17
    v_exp_f32 v19, v103
    v_cvt_pk_bf16_f32 v70, v16, v17
    v_add_f32 v6, v6, v18
    v_add_f32 v6, v6, v19
    v_cvt_pk_bf16_f32 v71, v18, v19
    s_buffer_load_dwordx8 s[48:55], s[20:23], s44 glc
    s_waitcnt lgkmcnt(2)
    v_mfma_f32_16x16x32_bf16 a[0:3], v[24:27], v[64:67], 0
    ds_read_b128 v[40:43], v1 offset:4096
    v_mfma_f32_16x16x32_bf16 a[4:7], v[28:31], v[64:67], 0
    v_mfma_f32_16x16x32_bf16 a[48:51], v[24:27], v[68:71], 0
    ds_read_b128 v[44:47], v1 offset:5120
    v_mfma_f32_16x16x32_bf16 a[52:55], v[28:31], v[68:71], 0
    s_waitcnt lgkmcnt(2)
    v_mfma_f32_16x16x32_bf16 a[8:11], v[32:35], v[64:67], 0
    ds_read_b128 v[24:27], v1 offset:6144
    v_mfma_f32_16x16x32_bf16 a[12:15], v[36:39], v[64:67], 0
    v_mfma_f32_16x16x32_bf16 a[56:59], v[32:35], v[68:71], 0
    ds_read_b128 v[28:31], v1 offset:7168
    v_mfma_f32_16x16x32_bf16 a[60:63], v[36:39], v[68:71], 0
    s_waitcnt lgkmcnt(2)
    v_mfma_f32_16x16x32_bf16 a[16:19], v[40:43], v[64:67], 0
    ds_read_b128 v[32:35], v1 offset:8192
    v_mfma_f32_16x16x32_bf16 a[20:23], v[44:47], v[64:67], 0
    v_mfma_f32_16x16x32_bf16 a[64:67], v[40:43], v[68:71], 0
    ds_read_b128 v[36:39], v1 offset:9216
    v_mfma_f32_16x16x32_bf16 a[68:71], v[44:47], v[68:71], 0
    s_waitcnt lgkmcnt(2)
    v_mfma_f32_16x16x32_bf16 a[24:27], v[24:27], v[64:67], 0
    ds_read_b128 v[40:43], v1 offset:10240
    v_mfma_f32_16x16x32_bf16 a[28:31], v[28:31], v[64:67], 0
    v_mfma_f32_16x16x32_bf16 a[72:75], v[24:27], v[68:71], 0
    ds_read_b128 v[44:47], v1 offset:11264
    v_mfma_f32_16x16x32_bf16 a[76:79], v[28:31], v[68:71], 0
    s_waitcnt lgkmcnt(2)
    v_mfma_f32_16x16x32_bf16 a[32:35], v[32:35], v[64:67], 0
    v_mfma_f32_16x16x32_bf16 a[36:39], v[36:39], v[64:67], 0
    v_mfma_f32_16x16x32_bf16 a[80:83], v[32:35], v[68:71], 0
    v_mfma_f32_16x16x32_bf16 a[84:87], v[36:39], v[68:71], 0
    s_waitcnt lgkmcnt(0)
    v_mfma_f32_16x16x32_bf16 a[40:43], v[40:43], v[64:67], 0
    v_mfma_f32_16x16x32_bf16 a[44:47], v[44:47], v[64:67], 0
    v_mfma_f32_16x16x32_bf16 a[88:91], v[40:43], v[68:71], 0
    v_mfma_f32_16x16x32_bf16 a[92:95], v[44:47], v[68:71], 0
    s_waitcnt lgkmcnt(0)
    s_sub_u32 s48, s48, s92
    s_sub_u32 s49, s49, s92
    s_sub_u32 s50, s50, s92
    s_sub_u32 s51, s51, s92
    s_sub_u32 s52, s52, s92
    s_sub_u32 s53, s53, s92
    s_sub_u32 s54, s54, s92
    s_sub_u32 s55, s55, s92
    s_max_u32 s48, s48, s49
    s_max_u32 s48, s48, s50
    s_max_u32 s48, s48, s51
    s_max_u32 s48, s48, s52
    s_max_u32 s48, s48, s53
    s_max_u32 s48, s48, s54
    s_max_u32 s48, s48, s55
    s_cmp_ge_u32 s48, 16
    s_cbranch_scc1 L_pollslow0
L_pollok0:
    s_add_u32 s92, s92, 1
    s_mov_b32 m0, s26
    s_nop 0
    buffer_load_dwordx4 v4, s[4:7], s32 offen offset:0 sc1 lds
    buffer_load_dwordx4 v4, s[4:7], s32 offen offset:1024 sc1 lds
    buffer_load_dwordx4 v4, s[4:7], s32 offen offset:2048 sc1 lds
    s_add_u32 s32, s32, 24576
    s_sub_u32 s57, s32, 196608
    s_min_u32 s32, s32, s57
    s_add_u32 s26, s26, 36864
    s_sub_u32 s57, s26, 147456
    s_min_u32 s26, s26, s57
    s_mov_b32 m0, s26
    s_waitcnt vmcnt(11)
    buffer_load_dwordx4 v4, s[4:7], s32 offen offset:0 sc1 lds
    s_waitcnt vmcnt(11)
    buffer_load_dwordx4 v4, s[4:7], s32 offen offset:1024 sc1 lds
    s_waitcnt vmcnt(11)
    buffer_load_dwordx4 v4, s[4:7], s32 offen offset:2048 sc1 lds
    s_add_u32 s32, s32, 24576
    s_sub_u32 s57, s32, 196608
    s_min_u32 s32, s32, s57
    s_add_u32 s26, s26, 12288
    s_mov_b32 m0, s26
    s_waitcnt vmcnt(11)
    buffer_load_dwordx4 v4, s[4:7], s32 offen offset:0 sc1 lds
    s_waitcnt vmcnt(11)
    buffer_load_dwordx4 v4, s[4:7], s32 offen offset:1024 sc1 lds
    s_waitcnt vmcnt(11)
    buffer_load_dwordx4 v4, s[4:7], s32 offen offset:2048 sc1 lds
    s_add_u32 s32, s32, 24576
    s_sub_u32 s57, s32, 196608
    s_min_u32 s32, s32, s57
    s_add_u32 s26, s26, 36864
    s_sub_u32 s57, s26, 147456
    s_min_u32 s26, s26, s57
    s_mov_b32 m0, s56
    s_waitcnt vmcnt(11)
    buffer_load_dwordx4 v4, s[4:7], s27 offen offset:0 sc1 lds
    s_waitcnt vmcnt(11)
    buffer_load_dwordx4 v4, s[4:7], s27 offen offset:1024 sc1 lds
    s_waitcnt vmcnt(11)
    buffer_load_dwordx4 v4, s[4:7], s27 offen offset:2048 sc1 lds
    s_add_u32 s27, s27, 24576
    s_sub_u32 s58, s27, 196608
    s_min_u32 s27, s27, s58
    s_add_u32 s56, s56, 36864
    s_sub_u32 s58, s56, 147456
    s_min_u32 s56, s56, s58
    s_add_u32 s33, s33, 196608
    s_add_u32 s34, s34, 196608
    s_add_u32 s36, s36, 1536
    s_add_u32 s35, s35, 196608
    s_add_u32 s16, s16, 196608
    s_add_u32 s17, s17, 196608
    s_add_u32 s37, s37, 512
    s_waitcnt vmcnt(9)
    s_barrier
    ds_read_b128 v[24:27], v2 offset:12288
    ds_read_b128 v[28:31], v3 offset:12288
    ds_read_b128 v[32:35], v2 offset:18432
    ds_read_b128 v[36:39], v3 offset:18432
    s_waitcnt lgkmcnt(2)
    v_mfma_f32_16x16x32_bf16 v[72:75], v[24:27], a[192:195], v[128:131]
    s_mov_b32 m0, s56
    ds_read_b128 v[40:43], v2 offset:12416
    v_mfma_f32_16x16x32_bf16 v[72:75], v[28:31], a[196:199], v[72:75]
    buffer_load_dwordx4 v4, s[4:7], s27 offen offset:0 sc1 lds
    v_mfma_f32_16x16x32_bf16 v[76:79], v[24:27], a[216:219], v[132:135]
    ds_read_b128 v[44:47], v3 offset:12416
    v_mfma_f32_16x16x32_bf16 v[76:79], v[28:31], a[220:223], v[76:79]
    s_waitcnt lgkmcnt(2)
    buffer_load_dwordx4 v4, s[4:7], s27 offen offset:1024 sc1 lds
    v_mfma_f32_16x16x32_bf16 v[104:107], v[32:35], a[192:195], v[128:131]
    ds_read_b128 v[24:27], v2 offset:18560
    v_mfma_f32_16x16x32_bf16 v[104:107], v[36:39], a[196:199], v[104:107]
    v_mfma_f32_16x16x32_bf16 v[108:111], v[32:35], a[216:219], v[132:135]
    ds_read_b128 v[28:31], v3 offset:18560
    v_mfma_f32_16x16x32_bf16 v[108:111], v[36:39], a[220:223], v[108:111]
    s_waitcnt lgkmcnt(2)
    buffer_load_dwordx4 v4, s[4:7], s27 offen offset:2048 sc1 lds
    v_mfma_f32_16x16x32_bf16 v[72:75], v[40:43], a[200:203], v[72:75]
    s_add_u32 s27, s27, 24576
    ds_read_b128 v[32:35], v2 offset:12544
    v_mfma_f32_16x16x32_bf16 v[72:75], v[44:47], a[204:207], v[72:75]
    s_sub_u32 s58, s27, 196608
    v_mfma_f32_16x16x32_bf16 v[76:79], v[40:43], a[224:227], v[76:79]
    s_min_u32 s27, s27, s58
    ds_read_b128 v[36:39], v3 offset:12544
    v_mfma_f32_16x16x32_bf16 v[76:79], v[44:47], a[228:231], v[76:79]
    s_waitcnt lgkmcnt(2)
    s_add_u32 s56, s56, 12288
    v_mfma_f32_16x16x32_bf16 v[104:107], v[24:27], a[200:203], v[104:107]
    s_mov_b32 m0, s56
    ds_read_b128 v[40:43], v2 offset:18688
    v_mfma_f32_16x16x32_bf16 v[104:107], v[28:31], a[204:207], v[104:107]
    s_waitcnt vmcnt(6)
    v_mfma_f32_16x16x32_bf16 v[108:111], v[24:27], a[224:227], v[108:111]
    ds_read_b128 v[44:47], v3 offset:18688
    v_mfma_f32_16x16x32_bf16 v[108:111], v[28:31], a[228:231], v[108:111]
    s_waitcnt lgkmcnt(2)
    s_barrier
    v_add_u32 v2, 49152, v2
    v_add_u32 v3, 49152, v3
    v_mfma_f32_16x16x32_bf16 v[72:75], v[32:35], a[208:211], v[72:75]
    ds_read_b128 v[24:27], v2 offset:0
    v_mfma_f32_16x16x32_bf16 v[72:75], v[36:39], a[212:215], v[72:75]
    buffer_load_dwordx4 v4, s[4:7], s27 offen offset:0 sc1 lds
    v_mfma_f32_16x16x32_bf16 v[76:79], v[32:35], a[232:235], v[76:79]
    ds_read_b128 v[28:31], v3 offset:0
    v_mfma_f32_16x16x32_bf16 v[76:79], v[36:39], a[236:239], v[76:79]
    s_waitcnt lgkmcnt(2)
    buffer_load_dwordx4 v4, s[4:7], s27 offen offset:1024 sc1 lds
    v_mfma_f32_16x16x32_bf16 v[104:107], v[40:43], a[208:211], v[104:107]
    ds_read_b128 v[32:35], v2 offset:6144
    v_mfma_f32_16x16x32_bf16 v[104:107], v[44:47], a[212:215], v[104:107]
    buffer_load_dwordx4 v4, s[4:7], s27 offen offset:2048 sc1 lds
    v_mfma_f32_16x16x32_bf16 v[108:111], v[40:43], a[232:235], v[108:111]
    s_add_u32 s27, s27, 24576
    ds_read_b128 v[36:39], v3 offset:6144
    s_sub_u32 s58, s27, 196608
    v_mfma_f32_16x16x32_bf16 v[108:111], v[44:47], a[236:239], v[108:111]
    s_waitcnt lgkmcnt(2)
    s_min_u32 s27, s27, s58
    s_add_u32 s56, s56, 36864
    s_sub_u32 s58, s56, 147456
    s_min_u32 s56, s56, s58
    v_mfma_f32_16x16x32_bf16 v[80:83], v[24:27], a[192:195], v[128:131]
    s_mov_b32 s41, 18432
    ds_read_b128 v[40:43], v2 offset:128
    v_mfma_f32_16x16x32_bf16 v[80:83], v[28:31], a[196:199], v[80:83]
    s_add_u32 m0, s40, 27648
    v_mfma_f32_16x16x32_bf16 v[84:87], v[24:27], a[216:219], v[132:135]
    ds_read_b128 v[44:47], v3 offset:128
    v_mfma_f32_16x16x32_bf16 v[84:87], v[28:31], a[220:223], v[84:87]
    s_waitcnt lgkmcnt(2)
    v_exp_f32 v16, v72
    v_mfma_f32_16x16x32_bf16 v[112:115], v[32:35], a[192:195], v[128:131]
    ds_read_b128 v[24:27], v2 offset:6272
    v_mfma_f32_16x16x32_bf16 v[112:115], v[36:39], a[196:199], v[112:115]
    buffer_load_dwordx4 v139, s[8:11], s41 offen nt lds
    v_mfma_f32_16x16x32_bf16 v[116:119], v[32:35], a[216:219], v[132:135]
    ds_read_b128 v[28:31], v3 offset:6272
    v_mfma_f32_16x16x32_bf16 v[116:119], v[36:39], a[220:223], v[116:119]
    s_waitcnt lgkmcnt(2)
    v_exp_f32 v17, v73
    v_mfma_f32_16x16x32_bf16 v[80:83], v[40:43], a[200:203], v[80:83]
    s_add_u32 m0, s40, 28672
    ds_read_b128 v[32:35], v2 offset:256
    v_mfma_f32_16x16x32_bf16 v[80:83], v[44:47], a[204:207], v[80:83]
    v_exp_f32 v18, v74
    v_mfma_f32_16x16x32_bf16 v[84:87], v[40:43], a[224:227], v[84:87]
    ds_read_b128 v[36:39], v3 offset:256
    v_add_f32 v5, v5, v16
    v_mfma_f32_16x16x32_bf16 v[84:87], v[44:47], a[228:231], v[84:87]
    s_waitcnt lgkmcnt(2)
    v_add_f32 v5, v5, v17
    v_mfma_f32_16x16x32_bf16 v[112:115], v[24:27], a[200:203], v[112:115]
    ds_read_b128 v[40:43], v2 offset:6400
    v_mfma_f32_16x16x32_bf16 v[112:115], v[28:31], a[204:207], v[112:115]
    buffer_load_dwordx4 v140, s[8:11], s41 offen nt lds
    v_mfma_f32_16x16x32_bf16 v[116:119], v[24:27], a[224:227], v[116:119]
    ds_read_b128 v[44:47], v3 offset:6400
    v_mfma_f32_16x16x32_bf16 v[116:119], v[28:31], a[228:231], v[116:119]
    s_waitcnt lgkmcnt(2)
    v_exp_f32 v19, v75
    v_cvt_pk_bf16_f32 v72, v16, v17
    v_mfma_f32_16x16x32_bf16 v[80:83], v[32:35], a[208:211], v[80:83]
    s_add_u32 m0, s40, 29696
    ds_read_b128 v[24:27], v2 offset:12288
    v_mfma_f32_16x16x32_bf16 v[80:83], v[36:39], a[212:215], v[80:83]
    v_exp_f32 v16, v104
    v_mfma_f32_16x16x32_bf16 v[84:87], v[32:35], a[232:235], v[84:87]
    ds_read_b128 v[28:31], v3 offset:12288
    v_add_f32 v5, v5, v18
    v_mfma_f32_16x16x32_bf16 v[84:87], v[36:39], a[236:239], v[84:87]
    s_waitcnt lgkmcnt(2)
    buffer_load_dwordx4 v141, s[8:11], s41 offen nt lds
    v_add_f32 v5, v5, v19
    v_mfma_f32_16x16x32_bf16 v[112:115], v[40:43], a[208:211], v[112:115]
    ds_read_b128 v[32:35], v2 offset:18432
    v_mfma_f32_16x16x32_bf16 v[112:115], v[44:47], a[212:215], v[112:115]
    v_exp_f32 v17, v105
    v_cvt_pk_bf16_f32 v73, v18, v19
    v_mfma_f32_16x16x32_bf16 v[116:119], v[40:43], a[232:235], v[116:119]
    ds_read_b128 v[36:39], v3 offset:18432
    v_mfma_f32_16x16x32_bf16 v[116:119], v[44:47], a[236:239], v[116:119]
    s_waitcnt lgkmcnt(2)
    v_exp_f32 v18, v106
    v_add_f32 v5, v5, v16
    v_mfma_f32_16x16x32_bf16 v[88:91], v[24:27], a[192:195], v[128:131]
    ds_read_b128 v[40:43], v2 offset:12416
    v_add_f32 v5, v5, v17
    v_mfma_f32_16x16x32_bf16 v[88:91], v[28:31], a[196:199], v[88:91]
    s_waitcnt vmcnt(11)
    buffer_load_dwordx2 v[56:57], v10, s[72:75], s36 offen offset:0
    v_mfma_f32_16x16x32_bf16 v[92:95], v[24:27], a[216:219], v[132:135]
    ds_read_b128 v[44:47], v3 offset:12416
    v_mfma_f32_16x16x32_bf16 v[92:95], v[28:31], a[220:223], v[92:95]
    s_waitcnt lgkmcnt(2)
    v_exp_f32 v19, v107
    v_cvt_pk_bf16_f32 v74, v16, v17
    v_mfma_f32_16x16x32_bf16 v[120:123], v[32:35], a[192:195], v[128:131]
    ds_read_b128 v[24:27], v2 offset:18560
    v_mfma_f32_16x16x32_bf16 v[120:123], v[36:39], a[196:199], v[120:123]
    buffer_load_dwordx2 v[58:59], v10, s[76:79], s36 offen offset:0
    v_mfma_f32_16x16x32_bf16 v[124:127], v[32:35], a[216:219], v[132:135]
    ds_read_b128 v[28:31], v3 offset:18560
    v_mfma_f32_16x16x32_bf16 v[124:127], v[36:39], a[220:223], v[124:127]
    s_waitcnt lgkmcnt(2)
    v_exp_f32 v16, v76
    v_add_f32 v5, v5, v18
    v_mfma_f32_16x16x32_bf16 v[88:91], v[40:43], a[200:203], v[88:91]
    ds_read_b128 v[32:35], v2 offset:12544
    v_add_f32 v5, v5, v19
    v_mfma_f32_16x16x32_bf16 v[88:91], v[44:47], a[204:207], v[88:91]
    s_waitcnt vmcnt(12)
    buffer_load_dwordx4 v[224:227], v9, s[64:67], s33 offen offset:0 nt
    v_mfma_f32_16x16x32_bf16 v[92:95], v[40:43], a[224:227], v[92:95]
    ds_read_b128 v[36:39], v3 offset:12544
    v_mfma_f32_16x16x32_bf16 v[92:95], v[44:47], a[228:231], v[92:95]
    s_waitcnt lgkmcnt(2)
    v_exp_f32 v17, v77
    v_cvt_pk_bf16_f32 v75, v18, v19
    v_mfma_f32_16x16x32_bf16 v[120:123], v[24:27], a[200:203], v[120:123]
    ds_read_b128 v[40:43], v2 offset:18688
    v_mfma_f32_16x16x32_bf16 v[120:123], v[28:31], a[204:207], v[120:123]
    s_waitcnt vmcnt(6)
    buffer_load_dwordx4 v[228:231], v9, s[64:67], s33 offen offset:1536 nt
    v_mfma_f32_16x16x32_bf16 v[124:127], v[24:27], a[224:227], v[124:127]
    ds_read_b128 v[44:47], v3 offset:18688
    v_mfma_f32_16x16x32_bf16 v[124:127], v[28:31], a[228:231], v[124:127]
    s_waitcnt lgkmcnt(2)
    s_barrier
    v_mfma_f32_16x16x32_bf16 v[88:91], v[32:35], a[208:211], v[88:91]
    ds_read_b128 v[24:27], v1 offset:12288
    v_mfma_f32_16x16x32_bf16 v[88:91], v[36:39], a[212:215], v[88:91]
    buffer_load_dwordx4 v[232:235], v9, s[64:67], s34 offen offset:0 nt
    v_mfma_f32_16x16x32_bf16 v[92:95], v[32:35], a[232:235], v[92:95]
    ds_read_b128 v[28:31], v1 offset:13312
    v_mfma_f32_16x16x32_bf16 v[92:95], v[36:39], a[236:239], v[92:95]
    s_waitcnt lgkmcnt(2)
    v_exp_f32 v18, v78
    v_add_f32 v6, v6, v16
    v_mfma_f32_16x16x32_bf16 v[120:123], v[40:43], a[208:211], v[120:123]
    ds_read_b128 v[32:35], v1 offset:14336
    v_add_f32 v6, v6, v17
    v_mfma_f32_16x16x32_bf16 v[120:123], v[44:47], a[212:215], v[120:123]
    buffer_load_dwordx4 v[236:239], v9, s[64:67], s34 offen offset:1536 nt
    v_mfma_f32_16x16x32_bf16 v[124:127], v[40:43], a[232:235], v[124:127]
    ds_read_b128 v[36:39], v1 offset:15360
    v_mfma_f32_16x16x32_bf16 v[124:127], v[44:47], a[236:239], v[124:127]
    s_waitcnt lgkmcnt(2)
    v_exp_f32 v19, v79
    v_cvt_pk_bf16_f32 v76, v16, v17
    v_exp_f32 v16, v108
    v_add_f32 v6, v6, v18
    v_add_f32 v6, v6, v19
    v_exp_f32 v17, v109
    v_cvt_pk_bf16_f32 v77, v18, v19
    v_exp_f32 v18, v110
    v_add_f32 v6, v6, v16
    v_add_f32 v6, v6, v17
    v_exp_f32 v19, v111
    v_cvt_pk_bf16_f32 v78, v16, v17
    v_add_f32 v6, v6, v18
    v_add_f32 v6, v6, v19
    v_cvt_pk_bf16_f32 v79, v18, v19
    v_mfma_f32_16x16x32_bf16 a[0:3], v[24:27], v[72:75], a[0:3]
    ds_read_b128 v[40:43], v1 offset:16384
    v_mfma_f32_16x16x32_bf16 a[4:7], v[28:31], v[72:75], a[4:7]
    buffer_load_dwordx2 v[60:61], v10, s[72:75], s36 offen offset:192
    v_mfma_f32_16x16x32_bf16 a[48:51], v[24:27], v[76:79], a[48:51]
    ds_read_b128 v[44:47], v1 offset:17408
    v_mfma_f32_16x16x32_bf16 a[52:55], v[28:31], v[76:79], a[52:55]
    s_waitcnt lgkmcnt(2)
    v_exp_f32 v16, v80
    v_mfma_f32_16x16x32_bf16 a[8:11], v[32:35], v[72:75], a[8:11]
    ds_read_b128 v[24:27], v1 offset:18432
    v_mfma_f32_16x16x32_bf16 a[12:15], v[36:39], v[72:75], a[12:15]
    buffer_load_dwordx2 v[62:63], v10, s[76:79], s36 offen offset:192
    v_mfma_f32_16x16x32_bf16 a[56:59], v[32:35], v[76:79], a[56:59]
    ds_read_b128 v[28:31], v1 offset:19456
    v_mfma_f32_16x16x32_bf16 a[60:63], v[36:39], v[76:79], a[60:63]
    s_waitcnt lgkmcnt(2)
    v_exp_f32 v17, v81
    v_mfma_f32_16x16x32_bf16 a[16:19], v[40:43], v[72:75], a[16:19]
    ds_read_b128 v[32:35], v1 offset:20480
    v_mfma_f32_16x16x32_bf16 a[20:23], v[44:47], v[72:75], a[20:23]
    buffer_load_dwordx4 v[240:243], v9, s[64:67], s33 offen offset:384 nt
    v_mfma_f32_16x16x32_bf16 a[64:67], v[40:43], v[76:79], a[64:67]
    ds_read_b128 v[36:39], v1 offset:21504
    v_mfma_f32_16x16x32_bf16 a[68:71], v[44:47], v[76:79], a[68:71]
    s_waitcnt lgkmcnt(2)
    v_exp_f32 v18, v82
    v_add_f32 v5, v5, v16
    v_mfma_f32_16x16x32_bf16 a[24:27], v[24:27], v[72:75], a[24:27]
    ds_read_b128 v[40:43], v1 offset:22528
    v_add_f32 v5, v5, v17
    v_mfma_f32_16x16x32_bf16 a[28:31], v[28:31], v[72:75], a[28:31]
    buffer_load_dwordx4 v[244:247], v9, s[64:67], s33 offen offset:1920 nt
    v_mfma_f32_16x16x32_bf16 a[72:75], v[24:27], v[76:79], a[72:75]
    ds_read_b128 v[44:47], v1 offset:23552
    v_mfma_f32_16x16x32_bf16 a[76:79], v[28:31], v[76:79], a[76:79]
    s_waitcnt lgkmcnt(2)
    v_add_u32 v1, 49152, v1
    v_exp_f32 v19, v83
    v_mfma_f32_16x16x32_bf16 a[32:35], v[32:35], v[72:75], a[32:35]
    ds_read_b128 v[24:27], v1 offset:0
    v_cvt_pk_bf16_f32 v80, v16, v17
    v_mfma_f32_16x16x32_bf16 a[36:39], v[36:39], v[72:75], a[36:39]
    buffer_load_dwordx4 v[248:251], v9, s[64:67], s34 offen offset:384 nt
    v_mfma_f32_16x16x32_bf16 a[80:83], v[32:35], v[76:79], a[80:83]
    ds_read_b128 v[28:31], v1 offset:1024
    v_mfma_f32_16x16x32_bf16 a[84:87], v[36:39], v[76:79], a[84:87]
    s_waitcnt lgkmcnt(2)
    v_exp_f32 v16, v112
    v_add_f32 v5, v5, v18
    v_mfma_f32_16x16x32_bf16 a[40:43], v[40:43], v[72:75], a[40:43]
    ds_read_b128 v[32:35], v1 offset:2048
    v_add_f32 v5, v5, v19
    v_mfma_f32_16x16x32_bf16 a[44:47], v[44:47], v[72:75], a[44:47]
    buffer_load_dwordx4 v[252:255], v9, s[64:67], s34 offen offset:1920 nt
    v_mfma_f32_16x16x32_bf16 a[88:91], v[40:43], v[76:79], a[88:91]
    ds_read_b128 v[36:39], v1 offset:3072
    v_mfma_f32_16x16x32_bf16 a[92:95], v[44:47], v[76:79], a[92:95]
    s_waitcnt lgkmcnt(2)
    v_exp_f32 v17, v113
    v_cvt_pk_bf16_f32 v81, v18, v19
    v_exp_f32 v18, v114
    v_add_f32 v5, v5, v16
    v_add_f32 v5, v5, v17
    v_exp_f32 v19, v115
    v_cvt_pk_bf16_f32 v82, v16, v17
    v_exp_f32 v16, v84
    v_add_f32 v5, v5, v18
    v_add_f32 v5, v5, v19
    v_exp_f32 v17, v85
    v_cvt_pk_bf16_f32 v83, v18, v19
    v_exp_f32 v18, v86
    v_add_f32 v6, v6, v16
    v_add_f32 v6, v6, v17
    v_exp_f32 v19, v87
    v_cvt_pk_bf16_f32 v84, v16, v17
    v_exp_f32 v16, v116
    v_add_f32 v6, v6, v18
    v_add_f32 v6, v6, v19
    v_exp_f32 v17, v117
    v_cvt_pk_bf16_f32 v85, v18, v19
    v_exp_f32 v18, v118
    v_add_f32 v6, v6, v16
    v_add_f32 v6, v6, v17
    v_exp_f32 v19, v119
    v_cvt_pk_bf16_f32 v86, v16, v17
    v_add_f32 v6, v6, v18
    v_add_f32 v6, v6, v19
    v_cvt_pk_bf16_f32 v87, v18, v19
    v_mfma_f32_16x16x32_bf16 a[0:3], v[24:27], v[80:83], a[0:3]
    ds_read_b128 v[40:43], v1 offset:4096
    v_mfma_f32_16x16x32_bf16 a[4:7], v[28:31], v[80:83], a[4:7]
    buffer_load_dwordx4 v[144:147], v12, s[68:71], s35 offen offset:0 nt
    v_mfma_f32_16x16x32_bf16 a[48:51], v[24:27], v[84:87], a[48:51]
    ds_read_b128 v[44:47], v1 offset:5120
    v_mfma_f32_16x16x32_bf16 a[52:55], v[28:31], v[84:87], a[52:55]
    s_waitcnt lgkmcnt(2)
    v_exp_f32 v16, v88
    v_mfma_f32_16x16x32_bf16 a[8:11], v[32:35], v[80:83], a[8:11]
    ds_read_b128 v[24:27], v1 offset:6144
    v_mfma_f32_16x16x32_bf16 a[12:15], v[36:39], v[80:83], a[12:15]
    v_exp_f32 v17, v89
    v_mfma_f32_16x16x32_bf16 a[56:59], v[32:35], v[84:87], a[56:59]
    ds_read_b128 v[28:31], v1 offset:7168
    v_mfma_f32_16x16x32_bf16 a[60:63], v[36:39], v[84:87], a[60:63]
    s_waitcnt lgkmcnt(2)
    buffer_load_dwordx4 v[148:151], v12, s[68:71], s35 offen offset:768 nt
    v_mfma_f32_16x16x32_bf16 a[16:19], v[40:43], v[80:83], a[16:19]
    ds_read_b128 v[32:35], v1 offset:8192
    v_mfma_f32_16x16x32_bf16 a[20:23], v[44:47], v[80:83], a[20:23]
    v_exp_f32 v18, v90
    v_add_f32 v5, v5, v16
    v_mfma_f32_16x16x32_bf16 a[64:67], v[40:43], v[84:87], a[64:67]
    ds_read_b128 v[36:39], v1 offset:9216
    v_add_f32 v5, v5, v17
    v_mfma_f32_16x16x32_bf16 a[68:71], v[44:47], v[84:87], a[68:71]
    s_waitcnt lgkmcnt(2)
    v_exp_f32 v19, v91
    v_cvt_pk_bf16_f32 v88, v16, v17
    v_mfma_f32_16x16x32_bf16 a[24:27], v[24:27], v[80:83], a[24:27]
    ds_read_b128 v[40:43], v1 offset:10240
    v_mfma_f32_16x16x32_bf16 a[28:31], v[28:31], v[80:83], a[28:31]
    v_exp_f32 v16, v120
    v_add_f32 v5, v5, v18
    v_mfma_f32_16x16x32_bf16 a[72:75], v[24:27], v[84:87], a[72:75]
    ds_read_b128 v[44:47], v1 offset:11264
    v_add_f32 v5, v5, v19
    v_mfma_f32_16x16x32_bf16 a[76:79], v[28:31], v[84:87], a[76:79]
    s_waitcnt lgkmcnt(2)
    s_waitcnt vmcnt(16)
    buffer_load_dwordx4 v[152:155], v12, s[68:71], s35 offen offset:1536 nt
    v_mfma_f32_16x16x32_bf16 a[32:35], v[32:35], v[80:83], a[32:35]
    s_waitcnt vmcnt(39)
    ds_read_b128 v[24:27], v1 offset:12288
    ds_read_b64 a[240:241], v22 offset:49152
    v_mfma_f32_16x16x32_bf16 a[36:39], v[36:39], v[80:83], a[36:39]
    v_exp_f32 v17, v121
    v_cvt_pk_bf16_f32 v89, v18, v19
    v_mfma_f32_16x16x32_bf16 a[80:83], v[32:35], v[84:87], a[80:83]
    ds_read_b128 v[28:31], v1 offset:13312
    ds_read_b64 a[242:243], v142 offset:49280
    v_mfma_f32_16x16x32_bf16 a[84:87], v[36:39], v[84:87], a[84:87]
    s_waitcnt lgkmcnt(4)
    v_exp_f32 v18, v122
    v_add_f32 v5, v5, v16
    v_mfma_f32_16x16x32_bf16 a[40:43], v[40:43], v[80:83], a[40:43]
    ds_read_b128 v[32:35], v1 offset:14336
    v_add_f32 v5, v5, v17
    v_mfma_f32_16x16x32_bf16 a[44:47], v[44:47], v[80:83], a[44:47]
    v_exp_f32 v19, v123
    v_cvt_pk_bf16_f32 v90, v16, v17
    v_exp_f32 v16, v92
    v_add_f32 v5, v5, v18
    v_add_f32 v5, v5, v19
    v_exp_f32 v17, v93
    v_cvt_pk_bf16_f32 v91, v18, v19
    v_exp_f32 v18, v94
    v_add_f32 v6, v6, v16
    v_add_f32 v6, v6, v17
    v_exp_f32 v19, v95
    v_cvt_pk_bf16_f32 v92, v16, v17
    v_exp_f32 v16, v124
    v_add_f32 v6, v6, v18
    v_add_f32 v6, v6, v19
    v_exp_f32 v17, v125
    v_cvt_pk_bf16_f32 v93, v18, v19
    v_exp_f32 v18, v126
    v_add_f32 v6, v6, v16
    v_add_f32 v6, v6, v17
    v_exp_f32 v19, v127
    v_cvt_pk_bf16_f32 v94, v16, v17
    v_add_f32 v6, v6, v18
    v_add_f32 v6, v6, v19
    v_cvt_pk_bf16_f32 v95, v18, v19
    v_mfma_f32_16x16x32_bf16 a[88:91], v[40:43], v[84:87], a[88:91]
    ds_read_b128 v[36:39], v1 offset:15360
    ds_read_b64 a[244:245], v23 offset:49152
    v_mfma_f32_16x16x32_bf16 a[92:95], v[44:47], v[84:87], a[92:95]
    s_waitcnt lgkmcnt(4)
    s_waitcnt vmcnt(16)
    buffer_load_dwordx4 v[156:159], v12, s[68:71], s35 offen offset:2304 nt
    v_mfma_f32_16x16x32_bf16 a[0:3], v[24:27], v[88:91], a[0:3]
    ds_read_b128 v[40:43], v1 offset:16384
    ds_read_b64 a[246:247], v143 offset:49280
    v_mfma_f32_16x16x32_bf16 a[4:7], v[28:31], v[88:91], a[4:7]
    ds_read_b64 a[248:249], v142 offset:49152
    ds_read_b64 a[250:251], v22 offset:49408
    v_mfma_f32_16x16x32_bf16 a[48:51], v[24:27], v[92:95], a[48:51]
    ds_read_b128 v[44:47], v1 offset:17408
    ds_read_b64 a[252:253], v143 offset:49152
    v_mfma_f32_16x16x32_bf16 a[52:55], v[28:31], v[92:95], a[52:55]
    s_waitcnt lgkmcnt(7)
    ds_read_b64 a[254:255], v23 offset:49408
    ds_read_b64 v[192:193], v22 offset:49280
    v_mfma_f32_16x16x32_bf16 a[8:11], v[32:35], v[88:91], a[8:11]
    ds_read_b128 v[24:27], v1 offset:18432
    ds_read_b64 v[194:195], v142 offset:49408
    v_mfma_f32_16x16x32_bf16 a[12:15], v[36:39], v[88:91], a[12:15]
    ds_read_b64 v[196:197], v23 offset:49280
    ds_read_b64 v[198:199], v143 offset:49408
    v_mfma_f32_16x16x32_bf16 a[56:59], v[32:35], v[92:95], a[56:59]
    s_waitcnt vmcnt(16)
    ds_read_b128 v[28:31], v1 offset:19456
    v_mfma_f32_16x16x32_bf16 a[60:63], v[36:39], v[92:95], a[60:63]
    s_waitcnt lgkmcnt(8)
    v_mfma_f32_16x16x32_bf16 a[16:19], v[40:43], v[88:91], a[16:19]
    ds_read_b128 v[32:35], v1 offset:20480
    ds_read_b64 v[200:201], v22 offset:24576
    v_mfma_f32_16x16x32_bf16 a[20:23], v[44:47], v[88:91], a[20:23]
    ds_read_b64 v[202:203], v142 offset:24704
    v_mfma_f32_16x16x32_bf16 a[64:67], v[40:43], v[92:95], a[64:67]
    ds_read_b128 v[36:39], v1 offset:21504
    ds_read_b64 v[204:205], v23 offset:24576
    v_mfma_f32_16x16x32_bf16 a[68:71], v[44:47], v[92:95], a[68:71]
    s_waitcnt lgkmcnt(5)
    ds_read_b64 v[206:207], v143 offset:24704
    v_mfma_f32_16x16x32_bf16 a[24:27], v[24:27], v[88:91], a[24:27]
    ds_read_b128 v[40:43], v1 offset:22528
    ds_read_b64 v[208:209], v142 offset:24576
    v_mfma_f32_16x16x32_bf16 a[28:31], v[28:31], v[88:91], a[28:31]
    v_mfma_f32_16x16x32_bf16 a[72:75], v[24:27], v[92:95], a[72:75]
    ds_read_b128 v[44:47], v1 offset:23552
    ds_read_b64 v[210:211], v22 offset:24832
    v_mfma_f32_16x16x32_bf16 a[76:79], v[28:31], v[92:95], a[76:79]
    s_waitcnt lgkmcnt(6)
    v_subrev_u32 v2, 49152, v2
    v_subrev_u32 v3, 49152, v3
    v_mfma_f32_16x16x32_bf16 a[32:35], v[32:35], v[88:91], a[32:35]
    ds_read_b128 v[24:27], v2 offset:0
    ds_read_b64 v[212:213], v143 offset:24576
    v_mfma_f32_16x16x32_bf16 a[36:39], v[36:39], v[88:91], a[36:39]
    ds_read_b64 v[214:215], v23 offset:24832
    ds_read_b64 v[216:217], v22 offset:24704
    v_mfma_f32_16x16x32_bf16 a[80:83], v[32:35], v[92:95], a[80:83]
    ds_read_b128 v[28:31], v3 offset:0
    ds_read_b64 v[218:219], v142 offset:24832
    v_mfma_f32_16x16x32_bf16 a[84:87], v[36:39], v[92:95], a[84:87]
    s_waitcnt lgkmcnt(7)
    v_mfma_f32_16x16x32_bf16 a[40:43], v[40:43], v[88:91], a[40:43]
    ds_read_b128 v[32:35], v2 offset:6144
    ds_read_b64 v[220:221], v23 offset:24704
    v_mfma_f32_16x16x32_bf16 a[44:47], v[44:47], v[88:91], a[44:47]
    ds_read_b64 v[222:223], v143 offset:24832
    v_mfma_f32_16x16x32_bf16 a[88:91], v[40:43], v[92:95], a[88:91]
    ds_read_b128 v[36:39], v3 offset:6144
    v_mfma_f32_16x16x32_bf16 a[92:95], v[44:47], v[92:95], a[92:95]
    s_waitcnt lgkmcnt(5)
    s_waitcnt lgkmcnt(0)
    s_barrier
    v_mfma_f32_16x16x32_bf16 v[160:163], v[24:27], a[240:243], 0
    s_waitcnt vmcnt(10)
    ds_read_b128 v[40:43], v2 offset:128
    v_lshlrev_b32 v48, 16, v56
    v_mfma_f32_16x16x32_bf16 v[160:163], v[28:31], a[244:247], v[160:163]
    s_mov_b32 m0, s26
    v_and_b32 v49, s97, v56
    v_lshlrev_b32 v50, 16, v58
    v_mfma_f32_16x16x32_bf16 v[164:167], v[24:27], v[200:203], 0
    ds_read_b128 v[44:47], v3 offset:128
    v_and_b32 v51, s97, v58
    v_mfma_f32_16x16x32_bf16 v[164:167], v[28:31], v[204:207], v[164:167]
    s_waitcnt lgkmcnt(2)
    buffer_load_dwordx4 v4, s[4:7], s32 offen offset:0 sc1 lds
    v_mfma_f32_16x16x32_bf16 v[96:99], v[32:35], a[240:243], 0
    ds_read_b128 v[24:27], v2 offset:6272
    v_mul_f32 v48, s38, v48
    v_mfma_f32_16x16x32_bf16 v[96:99], v[36:39], a[244:247], v[96:99]
    v_mul_f32 v49, s38, v49
    v_mul_f32_e64 v50, -v50, v48
    v_mfma_f32_16x16x32_bf16 v[100:103], v[32:35], v[200:203], 0
    ds_read_b128 v[28:31], v3 offset:6272
    v_mul_f32_e64 v51, -v51, v49
    v_mfma_f32_16x16x32_bf16 v[100:103], v[36:39], v[204:207], v[100:103]
    s_waitcnt lgkmcnt(2)
    buffer_load_dwordx4 v4, s[4:7], s32 offen offset:1024 sc1 lds
    v_mfma_f32_16x16x32_bf16 v[160:163], v[40:43], a[248:251], v[160:163]
    ds_read_b128 v[32:35], v2 offset:256
    v_cvt_f32_i32 v224, v224
    v_mfma_f32_16x16x32_bf16 v[160:163], v[44:47], a[252:255], v[160:163]
    v_cvt_f32_i32 v225, v225
    v_fma_f32 v224, v224, v48, v50
    v_mfma_f32_16x16x32_bf16 v[164:167], v[40:43], v[208:211], v[164:167]
    ds_read_b128 v[36:39], v3 offset:256
    v_fma_f32 v225, v225, v49, v51
    v_mfma_f32_16x16x32_bf16 v[164:167], v[44:47], v[212:215], v[164:167]
    s_waitcnt lgkmcnt(2)
    buffer_load_dwordx4 v4, s[4:7], s32 offen offset:2048 sc1 lds
    v_cvt_pk_bf16_f32 v224, v224, v225
    v_mfma_f32_16x16x32_bf16 v[96:99], v[24:27], a[248:251], v[96:99]
    s_add_u32 s32, s32, 24576
    ds_read_b128 v[40:43], v2 offset:6400
    v_cvt_f32_i32 v228, v228
    v_mfma_f32_16x16x32_bf16 v[96:99], v[28:31], a[252:255], v[96:99]
    s_sub_u32 s57, s32, 196608
    v_cvt_f32_i32 v229, v229
    v_fma_f32 v228, v228, v48, v50
    v_mfma_f32_16x16x32_bf16 v[100:103], v[24:27], v[208:211], v[100:103]
    s_min_u32 s32, s32, s57
    ds_read_b128 v[44:47], v3 offset:6400
    v_fma_f32 v229, v229, v49, v51
    v_mfma_f32_16x16x32_bf16 v[100:103], v[28:31], v[212:215], v[100:103]
    s_waitcnt lgkmcnt(2)
    v_cvt_pk_bf16_f32 v228, v228, v229
    v_cvt_f32_i32 v232, v232
    v_cvt_f32_i32 v233, v233
    v_mfma_f32_16x16x32_bf16 v[160:163], v[32:35], v[192:195], v[160:163]
    s_add_u32 s26, s26, 12288
    ds_read_b128 v[24:27], v2 offset:12288
    v_fma_f32 v232, v232, v48, v50
    v_mfma_f32_16x16x32_bf16 v[160:163], v[36:39], v[196:199], v[160:163]
    s_mov_b32 m0, s26
    v_fma_f32 v233, v233, v49, v51
    v_cvt_pk_bf16_f32 v232, v232, v233
    v_mfma_f32_16x16x32_bf16 v[164:167], v[32:35], v[216:219], v[164:167]
    ds_read_b128 v[28:31], v3 offset:12288
    v_cvt_f32_i32 v236, v236
    v_mfma_f32_16x16x32_bf16 v[164:167], v[36:39], v[220:223], v[164:167]
    s_waitcnt lgkmcnt(2)
    buffer_load_dwordx4 v4, s[4:7], s32 offen offset:0 sc1 lds
    v_cvt_f32_i32 v237, v237
    v_mfma_f32_16x16x32_bf16 v[96:99], v[40:43], v[192:195], v[96:99]
    ds_read_b128 v[32:35], v2 offset:18432
    v_fma_f32 v236, v236, v48, v50
    v_mfma_f32_16x16x32_bf16 v[96:99], v[44:47], v[196:199], v[96:99]
    v_fma_f32 v237, v237, v49, v51
    v_cvt_pk_bf16_f32 v236, v236, v237
    v_lshlrev_b32 v48, 16, v57
    v_mfma_f32_16x16x32_bf16 v[100:103], v[40:43], v[216:219], v[100:103]
    ds_read_b128 v[36:39], v3 offset:18432
    v_and_b32 v49, s97, v57
    v_mfma_f32_16x16x32_bf16 v[100:103], v[44:47], v[220:223], v[100:103]
    s_waitcnt lgkmcnt(2)
    buffer_load_dwordx4 v4, s[4:7], s32 offen offset:1024 sc1 lds
    v_lshlrev_b32 v50, 16, v59
    v_mfma_f32_16x16x32_bf16 v[168:171], v[24:27], a[240:243], 0
    ds_read_b128 v[40:43], v2 offset:12416
    s_waitcnt vmcnt(13)
    buffer_load_dwordx4 v4, s[4:7], s32 offen offset:2048 sc1 lds
    v_mfma_f32_16x16x32_bf16 v[168:171], v[28:31], a[244:247], v[168:171]
    v_and_b32 v51, s97, v59
    v_mul_f32 v48, s38, v48
    v_mul_f32 v49, s38, v49
    v_mfma_f32_16x16x32_bf16 v[172:175], v[24:27], v[200:203], 0
    s_add_u32 s32, s32, 24576
    ds_read_b128 v[44:47], v3 offset:12416
    v_mul_f32_e64 v50, -v50, v48
    v_mfma_f32_16x16x32_bf16 v[172:175], v[28:31], v[204:207], v[172:175]
    s_waitcnt lgkmcnt(2)
    v_mul_f32_e64 v51, -v51, v49
    v_cvt_f32_i32 v226, v226
    v_cvt_f32_i32 v227, v227
    v_mfma_f32_16x16x32_bf16 v[104:107], v[32:35], a[240:243], 0
    s_sub_u32 s57, s32, 196608
    ds_read_b128 v[24:27], v2 offset:18560
    v_fma_f32 v226, v226, v48, v50
    v_mfma_f32_16x16x32_bf16 v[104:107], v[36:39], a[244:247], v[104:107]
    v_fma_f32 v227, v227, v49, v51
    v_cvt_pk_bf16_f32 v225, v226, v227
    v_cvt_f32_i32 v230, v230
    v_mfma_f32_16x16x32_bf16 v[108:111], v[32:35], v[200:203], 0
    s_min_u32 s32, s32, s57
    ds_read_b128 v[28:31], v3 offset:18560
    v_cvt_f32_i32 v231, v231
    v_mfma_f32_16x16x32_bf16 v[108:111], v[36:39], v[204:207], v[108:111]
    s_waitcnt lgkmcnt(2)
    v_fma_f32 v230, v230, v48, v50
    v_fma_f32 v231, v231, v49, v51
    v_cvt_pk_bf16_f32 v229, v230, v231
    v_mfma_f32_16x16x32_bf16 v[168:171], v[40:43], a[248:251], v[168:171]
    s_add_u32 s26, s26, 36864
    ds_read_b128 v[32:35], v2 offset:12544
    v_cvt_f32_i32 v234, v234
    v_mfma_f32_16x16x32_bf16 v[168:171], v[44:47], a[252:255], v[168:171]
    v_cvt_f32_i32 v235, v235
    v_fma_f32 v234, v234, v48, v50
    v_max3_f32 v16, v160, v161, v162
    v_mfma_f32_16x16x32_bf16 v[172:175], v[40:43], v[208:211], v[172:175]
    ds_read_b128 v[36:39], v3 offset:12544
    v_fma_f32 v235, v235, v49, v51
    v_cvt_pk_bf16_f32 v233, v234, v235
    v_cvt_f32_i32 v238, v238
    v_cvt_f32_i32 v239, v239
    v_fma_f32 v238, v238, v48, v50
    v_fma_f32 v239, v239, v49, v51
    v_cvt_pk_bf16_f32 v237, v238, v239
    v_mfma_f32_16x16x32_bf16 v[172:175], v[44:47], v[212:215], v[172:175]
    s_waitcnt lgkmcnt(2)
    v_max3_f32 v18, v164, v165, v166
    v_max3_f32 v16, v16, v163, v96
    v_max3_f32 v18, v18, v167, v100
    v_mfma_f32_16x16x32_bf16 v[104:107], v[24:27], a[248:251], v[104:107]
    s_sub_u32 s57, s26, 147456
    ds_read_b128 v[40:43], v2 offset:18688
    s_min_u32 s26, s26, s57
    v_mfma_f32_16x16x32_bf16 v[104:107], v[28:31], a[252:255], v[104:107]
    s_waitcnt vmcnt(13)
    buffer_load_dwordx2 v[56:57], off, s[80:83], s37 offset:0
    v_max3_f32 v16, v16, v97, v98
    v_mfma_f32_16x16x32_bf16 v[108:111], v[24:27], v[208:211], v[108:111]
    s_waitcnt vmcnt(11)
    ds_read_b128 v[44:47], v3 offset:18688
    v_max3_f32 v18, v18, v101, v102
    v_mfma_f32_16x16x32_bf16 v[108:111], v[28:31], v[212:215], v[108:111]
    s_waitcnt lgkmcnt(2)
    v_add_u32 v2, 49152, v2
    v_add_u32 v3, 49152, v3
    v_max_f32 v16, v16, v99
    v_mfma_f32_16x16x32_bf16 v[168:171], v[32:35], v[192:195], v[168:171]
    ds_read_b128 v[24:27], v2 offset:0
    v_max_f32 v18, v18, v103
    v_mfma_f32_16x16x32_bf16 v[168:171], v[36:39], v[196:199], v[168:171]
    v_mov_b32 v17, v16
    v_mov_b32 v19, v18
    s_nop 0
    v_mfma_f32_16x16x32_bf16 v[172:175], v[32:35], v[216:219], v[172:175]
    ds_read_b128 v[28:31], v3 offset:0
    v_permlane16_swap_b32 v16, v17
    v_mfma_f32_16x16x32_bf16 v[172:175], v[36:39], v[220:223], v[172:175]
    s_waitcnt lgkmcnt(2)
    v_permlane16_swap_b32 v18, v19
    s_nop 0
    v_max_f32 v16, v16, v17
    v_mfma_f32_16x16x32_bf16 v[104:107], v[40:43], v[192:195], v[104:107]
    ds_read_b128 v[32:35], v2 offset:6144
    v_max_f32 v18, v18, v19
    v_mfma_f32_16x16x32_bf16 v[104:107], v[44:47], v[196:199], v[104:107]
    v_mov_b32 v17, v16
    v_mov_b32 v19, v18
    s_nop 0
    v_permlane32_swap_b32 v16, v17
    v_permlane32_swap_b32 v18, v19
    s_nop 0
    v_max_f32 v16, v16, v17
    v_max_f32 v18, v18, v19
    v_sub_f32 v136, 0, v16
    v_sub_f32 v137, 0, v16
    v_sub_f32 v138, 0, v16
    v_sub_f32 v139, 0, v16
    v_sub_f32 v140, 0, v18
    v_sub_f32 v141, 0, v18
    v_sub_f32 v142, 0, v18
    v_sub_f32 v143, 0, v18
    v_mfma_f32_16x16x32_bf16 v[108:111], v[40:43], v[216:219], v[108:111]
    ds_read_b128 v[36:39], v3 offset:6144
    v_lshlrev_b32 v48, 16, v60
    v_mfma_f32_16x16x32_bf16 v[108:111], v[44:47], v[220:223], v[108:111]
    s_waitcnt lgkmcnt(2)
    v_and_b32 v49, s97, v60
    v_lshlrev_b32 v50, 16, v62
    v_and_b32 v51, s97, v62
    v_mfma_f32_16x16x32_bf16 v[176:179], v[24:27], a[240:243], v[136:139]
    ds_read_b128 v[40:43], v2 offset:128
    v_mul_f32 v48, s38, v48
    v_mfma_f32_16x16x32_bf16 v[176:179], v[28:31], a[244:247], v[176:179]
    buffer_load_dwordx2 v[58:59], off, s[84:87], s37 offset:0
    v_mul_f32 v49, s38, v49
    v_mfma_f32_16x16x32_bf16 v[180:183], v[24:27], v[200:203], v[140:143]
    ds_read_b128 v[44:47], v3 offset:128
    v_mul_f32_e64 v50, -v50, v48
    v_mfma_f32_16x16x32_bf16 v[180:183], v[28:31], v[204:207], v[180:183]
    s_waitcnt lgkmcnt(2)
    v_mul_f32_e64 v51, -v51, v49
    v_cvt_f32_i32 v240, v240
    v_cvt_f32_i32 v241, v241
    v_mfma_f32_16x16x32_bf16 v[112:115], v[32:35], a[240:243], v[136:139]
    ds_read_b128 v[24:27], v2 offset:6272
    v_fma_f32 v240, v240, v48, v50
    v_mfma_f32_16x16x32_bf16 v[112:115], v[36:39], a[244:247], v[112:115]
    v_fma_f32 v241, v241, v49, v51
    v_add_f32 v160, v160, v136
    v_cvt_pk_bf16_f32 v226, v240, v241
    v_mfma_f32_16x16x32_bf16 v[116:119], v[32:35], v[200:203], v[140:143]
    ds_read_b128 v[28:31], v3 offset:6272
    v_add_f32 v161, v161, v136
    v_mfma_f32_16x16x32_bf16 v[116:119], v[36:39], v[204:207], v[116:119]
    s_waitcnt lgkmcnt(2)
    v_add_f32 v162, v162, v136
    v_cvt_f32_i32 v244, v244
    v_add_f32 v163, v163, v136
    v_mfma_f32_16x16x32_bf16 v[176:179], v[40:43], a[248:251], v[176:179]
    ds_read_b128 v[32:35], v2 offset:256
    v_add_f32 v96, v96, v136
    v_mfma_f32_16x16x32_bf16 v[176:179], v[44:47], a[252:255], v[176:179]
    v_cvt_f32_i32 v245, v245
    v_add_f32 v97, v97, v136
    v_fma_f32 v244, v244, v48, v50
    v_mfma_f32_16x16x32_bf16 v[180:183], v[40:43], v[208:211], v[180:183]
    ds_read_b128 v[36:39], v3 offset:256
    v_add_f32 v98, v98, v136
    v_mfma_f32_16x16x32_bf16 v[180:183], v[44:47], v[212:215], v[180:183]
    s_waitcnt lgkmcnt(2)
    v_fma_f32 v245, v245, v49, v51
    v_add_f32 v99, v99, v136
    v_add_f32 v164, v164, v140
    v_mfma_f32_16x16x32_bf16 v[112:115], v[24:27], a[248:251], v[112:115]
    ds_read_b128 v[40:43], v2 offset:6400
    v_cvt_pk_bf16_f32 v230, v244, v245
    v_mfma_f32_16x16x32_bf16 v[112:115], v[28:31], a[252:255], v[112:115]
    v_add_f32 v165, v165, v140
    v_cvt_f32_i32 v248, v248
    v_add_f32 v166, v166, v140
    v_mfma_f32_16x16x32_bf16 v[116:119], v[24:27], v[208:211], v[116:119]
    ds_read_b128 v[44:47], v3 offset:6400
    v_cvt_f32_i32 v249, v249
    v_mfma_f32_16x16x32_bf16 v[116:119], v[28:31], v[212:215], v[116:119]
    s_waitcnt lgkmcnt(2)
    v_fma_f32 v248, v248, v48, v50
    v_add_f32 v167, v167, v140
    v_add_f32 v100, v100, v140
    v_mfma_f32_16x16x32_bf16 v[176:179], v[32:35], v[192:195], v[176:179]
    ds_read_b128 v[24:27], v2 offset:12288
    v_fma_f32 v249, v249, v49, v51
    v_mfma_f32_16x16x32_bf16 v[176:179], v[36:39], v[196:199], v[176:179]
    v_cvt_pk_bf16_f32 v234, v248, v249
    v_add_f32 v101, v101, v140
    v_cvt_f32_i32 v252, v252
    v_mfma_f32_16x16x32_bf16 v[180:183], v[32:35], v[216:219], v[180:183]
    ds_read_b128 v[28:31], v3 offset:12288
    v_cvt_f32_i32 v253, v253
    v_mfma_f32_16x16x32_bf16 v[180:183], v[36:39], v[220:223], v[180:183]
    s_waitcnt lgkmcnt(2)
    v_fma_f32 v252, v252, v48, v50
    v_fma_f32 v253, v253, v49, v51
    v_add_f32 v102, v102, v140
    v_mfma_f32_16x16x32_bf16 v[112:115], v[40:43], v[192:195], v[112:115]
    ds_read_b128 v[32:35], v2 offset:18432
    v_cvt_pk_bf16_f32 v238, v252, v253
    v_mfma_f32_16x16x32_bf16 v[112:115], v[44:47], v[196:199], v[112:115]
    v_lshlrev_b32 v48, 16, v61
    v_and_b32 v49, s97, v61
    v_lshlrev_b32 v50, 16, v63
    v_mfma_f32_16x16x32_bf16 v[116:119], v[40:43], v[216:219], v[116:119]
    ds_read_b128 v[36:39], v3 offset:18432
    v_and_b32 v51, s97, v63
    v_mfma_f32_16x16x32_bf16 v[116:119], v[44:47], v[220:223], v[116:119]
    s_waitcnt lgkmcnt(2)
    v_mul_f32 v48, s38, v48
    v_mul_f32 v49, s38, v49
    v_mul_f32_e64 v50, -v50, v48
    v_mfma_f32_16x16x32_bf16 v[184:187], v[24:27], a[240:243], v[136:139]
    ds_read_b128 v[40:43], v2 offset:12416
    v_mul_f32_e64 v51, -v51, v49
    v_cvt_f32_i32 v242, v242
    v_cvt_f32_i32 v243, v243
    v_fma_f32 v242, v242, v48, v50
    v_fma_f32 v243, v243, v49, v51
    v_cvt_pk_bf16_f32 v227, v242, v243
    v_cvt_f32_i32 v246, v246
    v_cvt_f32_i32 v247, v247
    v_fma_f32 v246, v246, v48, v50
    v_fma_f32 v247, v247, v49, v51
    v_cvt_pk_bf16_f32 v231, v246, v247
    v_cvt_f32_i32 v250, v250
    v_cvt_f32_i32 v251, v251
    v_fma_f32 v250, v250, v48, v50
    v_fma_f32 v251, v251, v49, v51
    v_cvt_pk_bf16_f32 v235, v250, v251
    v_cvt_f32_i32 v254, v254
    v_cvt_f32_i32 v255, v255
    v_fma_f32 v254, v254, v48, v50
    v_fma_f32 v255, v255, v49, v51
    v_cvt_pk_bf16_f32 v239, v254, v255
    v_mfma_f32_16x16x32_bf16 v[184:187], v[28:31], a[244:247], v[184:187]
    buffer_store_dwordx4 v[224:227], v11, s[4:7], s33 offen offset:0 sc1
    v_mfma_f32_16x16x32_bf16 v[188:191], v[24:27], v[200:203], v[140:143]
    ds_read_b128 v[44:47], v3 offset:12416
    v_add_f32 v103, v103, v140
    v_mfma_f32_16x16x32_bf16 v[188:191], v[28:31], v[204:207], v[188:191]
    s_waitcnt lgkmcnt(2)
    v_exp_f32 v16, v160
    v_mfma_f32_16x16x32_bf16 v[120:123], v[32:35], a[240:243], v[136:139]
    ds_read_b128 v[24:27], v2 offset:18560
    v_xor_b32 v55, 16, v11
    v_mfma_f32_16x16x32_bf16 v[120:123], v[36:39], a[244:247], v[120:123]
    buffer_store_dwordx4 v[228:231], v55, s[4:7], s33 offen offset:768 sc1
    v_mfma_f32_16x16x32_bf16 v[124:127], v[32:35], v[200:203], v[140:143]
    ds_read_b128 v[28:31], v3 offset:18560
    v_mfma_f32_16x16x32_bf16 v[124:127], v[36:39], v[204:207], v[124:127]
    s_waitcnt lgkmcnt(2)
    v_exp_f32 v17, v161
    v_mfma_f32_16x16x32_bf16 v[184:187], v[40:43], a[248:251], v[184:187]
    ds_read_b128 v[32:35], v2 offset:12544
    v_mfma_f32_16x16x32_bf16 v[184:187], v[44:47], a[252:255], v[184:187]
    v_exp_f32 v18, v162
    v_add_f32 v7, v7, v16
    v_mfma_f32_16x16x32_bf16 v[188:191], v[40:43], v[208:211], v[188:191]
    ds_read_b128 v[36:39], v3 offset:12544
    v_add_f32 v7, v7, v17
    v_mfma_f32_16x16x32_bf16 v[188:191], v[44:47], v[212:215], v[188:191]
    s_waitcnt lgkmcnt(2)
    v_exp_f32 v19, v163
    v_cvt_pk_bf16_f32 v160, v16, v17
    v_mfma_f32_16x16x32_bf16 v[120:123], v[24:27], a[248:251], v[120:123]
    ds_read_b128 v[40:43], v2 offset:18688
    v_xor_b32 v54, 32, v11
    v_mfma_f32_16x16x32_bf16 v[120:123], v[28:31], a[252:255], v[120:123]
    s_waitcnt vmcnt(4)
    v_exp_f32 v16, v96
    v_add_f32 v7, v7, v18
    v_mfma_f32_16x16x32_bf16 v[124:127], v[24:27], v[208:211], v[124:127]
    ds_read_b128 v[44:47], v3 offset:18688
    v_add_f32 v7, v7, v19
    v_mfma_f32_16x16x32_bf16 v[124:127], v[28:31], v[212:215], v[124:127]
    s_waitcnt lgkmcnt(2)
    s_barrier
    v_add_u32 v2, 49152, v2
    v_add_u32 v3, 49152, v3
    v_mfma_f32_16x16x32_bf16 v[184:187], v[32:35], v[192:195], v[184:187]
    ds_read_b128 v[24:27], v2 offset:0
    v_xor_b32 v55, 48, v11
    v_mfma_f32_16x16x32_bf16 v[184:187], v[36:39], v[196:199], v[184:187]
    buffer_store_dwordx4 v[232:235], v54, s[4:7], s33 offen offset:1536 sc1
    v_mfma_f32_16x16x32_bf16 v[188:191], v[32:35], v[216:219], v[188:191]
    ds_read_b128 v[28:31], v3 offset:0
    v_mfma_f32_16x16x32_bf16 v[188:191], v[36:39], v[220:223], v[188:191]
    s_waitcnt lgkmcnt(2)
    v_exp_f32 v17, v97
    v_cvt_pk_bf16_f32 v161, v18, v19
    v_mfma_f32_16x16x32_bf16 v[120:123], v[40:43], v[192:195], v[120:123]
    ds_read_b128 v[32:35], v2 offset:6144
    v_mfma_f32_16x16x32_bf16 v[120:123], v[44:47], v[196:199], v[120:123]
    buffer_store_dwordx4 v[236:239], v55, s[4:7], s33 offen offset:2304 sc1
    v_mfma_f32_16x16x32_bf16 v[124:127], v[40:43], v[216:219], v[124:127]
    ds_read_b128 v[36:39], v3 offset:6144
    v_mfma_f32_16x16x32_bf16 v[124:127], v[44:47], v[220:223], v[124:127]
    s_waitcnt lgkmcnt(2)
    v_exp_f32 v18, v98
    v_add_f32 v7, v7, v16
    v_add_f32 v7, v7, v17
    v_exp_f32 v19, v99
    v_cvt_pk_bf16_f32 v162, v16, v17
    v_exp_f32 v16, v164
    v_add_f32 v7, v7, v18
    v_add_f32 v7, v7, v19
    v_exp_f32 v17, v165
    v_cvt_pk_bf16_f32 v163, v18, v19
    v_exp_f32 v18, v166
    v_add_f32 v8, v8, v16
    v_add_f32 v8, v8, v17
    v_exp_f32 v19, v167
    v_cvt_pk_bf16_f32 v164, v16, v17
    v_exp_f32 v16, v100
    v_add_f32 v8, v8, v18
    v_add_f32 v8, v8, v19
    v_exp_f32 v17, v101
    v_cvt_pk_bf16_f32 v165, v18, v19
    v_exp_f32 v18, v102
    v_add_f32 v8, v8, v16
    v_add_f32 v8, v8, v17
    v_exp_f32 v19, v103
    v_cvt_pk_bf16_f32 v166, v16, v17
    v_add_f32 v8, v8, v18
    v_add_f32 v8, v8, v19
    v_cvt_pk_bf16_f32 v167, v18, v19
    v_add_f32 v168, v168, v136
    v_add_f32 v169, v169, v136
    v_add_f32 v170, v170, v136
    v_add_f32 v171, v171, v136
    v_add_f32 v104, v104, v136
    v_add_f32 v105, v105, v136
    v_add_f32 v106, v106, v136
    v_add_f32 v107, v107, v136
    v_add_f32 v172, v172, v140
    v_add_f32 v173, v173, v140
    v_add_f32 v174, v174, v140
    v_add_f32 v175, v175, v140
    v_add_f32 v108, v108, v140
    v_add_f32 v109, v109, v140
    v_add_f32 v110, v110, v140
    v_add_f32 v111, v111, v140
    v_exp_f32 v16, v168
    v_exp_f32 v17, v169
    v_exp_f32 v18, v170
    v_add_f32 v7, v7, v16
    v_add_f32 v7, v7, v17
    v_exp_f32 v19, v171
    v_cvt_pk_bf16_f32 v168, v16, v17
    v_exp_f32 v16, v104
    v_add_f32 v7, v7, v18
    v_add_f32 v7, v7, v19
    v_exp_f32 v17, v105
    v_cvt_pk_bf16_f32 v169, v18, v19
    v_exp_f32 v18, v106
    v_add_f32 v7, v7, v16
    v_add_f32 v7, v7, v17
    v_exp_f32 v19, v107
    v_cvt_pk_bf16_f32 v170, v16, v17
    v_exp_f32 v16, v172
    v_add_f32 v7, v7, v18
    v_add_f32 v7, v7, v19
    v_exp_f32 v17, v173
    v_cvt_pk_bf16_f32 v171, v18, v19
    v_exp_f32 v18, v174
    v_add_f32 v8, v8, v16
    v_add_f32 v8, v8, v17
    v_exp_f32 v19, v175
    v_cvt_pk_bf16_f32 v172, v16, v17
    v_exp_f32 v16, v108
    v_add_f32 v8, v8, v18
    v_add_f32 v8, v8, v19
    v_exp_f32 v17, v109
    v_cvt_pk_bf16_f32 v173, v18, v19
    v_exp_f32 v18, v110
    v_add_f32 v8, v8, v16
    v_add_f32 v8, v8, v17
    v_exp_f32 v19, v111
    v_cvt_pk_bf16_f32 v174, v16, v17
    v_add_f32 v8, v8, v18
    v_add_f32 v8, v8, v19
    v_cvt_pk_bf16_f32 v175, v18, v19
    v_mfma_f32_16x16x32_bf16 v[64:67], v[24:27], a[192:195], v[128:131]
    ds_read_b128 v[40:43], v2 offset:128
    v_mfma_f32_16x16x32_bf16 v[64:67], v[28:31], a[196:199], v[64:67]
    buffer_load_dwordx2 v[60:61], off, s[80:83], s37 offset:8
    v_mfma_f32_16x16x32_bf16 v[68:71], v[24:27], a[216:219], v[132:135]
    v_exp_f32 v16, v176
    v_mfma_f32_16x16x32_bf16 v[68:71], v[28:31], a[220:223], v[68:71]
    v_exp_f32 v17, v177
    v_mfma_f32_16x16x32_bf16 v[72:75], v[24:27], a[240:243], v[136:139]
    ds_read_b128 v[44:47], v3 offset:128
    v_mfma_f32_16x16x32_bf16 v[72:75], v[28:31], a[244:247], v[72:75]
    buffer_load_dwordx2 v[62:63], off, s[84:87], s37 offset:8
    v_mfma_f32_16x16x32_bf16 v[76:79], v[24:27], v[200:203], v[140:143]
    v_exp_f32 v18, v178
    v_mfma_f32_16x16x32_bf16 v[76:79], v[28:31], v[204:207], v[76:79]
    s_waitcnt lgkmcnt(2)
    v_add_f32 v7, v7, v16
    v_add_f32 v7, v7, v17
    v_mfma_f32_16x16x32_bf16 v[96:99], v[32:35], a[192:195], v[128:131]
    ds_read_b128 v[24:27], v2 offset:6272
    v_mfma_f32_16x16x32_bf16 v[96:99], v[36:39], a[196:199], v[96:99]
    buffer_load_dwordx4 v[240:243], v12, s[68:71], s16 offen offset:0 nt
    v_mfma_f32_16x16x32_bf16 v[100:103], v[32:35], a[216:219], v[132:135]
    s_waitcnt vmcnt(7)
    v_exp_f32 v19, v179
    v_mfma_f32_16x16x32_bf16 v[100:103], v[36:39], a[220:223], v[100:103]
    v_cvt_pk_bf16_f32 v176, v16, v17
    v_exp_f32 v16, v112
    v_mfma_f32_16x16x32_bf16 v[104:107], v[32:35], a[240:243], v[136:139]
    ds_read_b128 v[28:31], v3 offset:6272
    v_add_f32 v7, v7, v18
    v_mfma_f32_16x16x32_bf16 v[104:107], v[36:39], a[244:247], v[104:107]
    buffer_load_dwordx4 v[244:247], v12, s[68:71], s16 offen offset:768 nt
    v_add_f32 v7, v7, v19
    v_mfma_f32_16x16x32_bf16 v[108:111], v[32:35], v[200:203], v[140:143]
    v_exp_f32 v17, v113
    v_mfma_f32_16x16x32_bf16 v[108:111], v[36:39], v[204:207], v[108:111]
    s_waitcnt lgkmcnt(2)
    v_cvt_pk_bf16_f32 v177, v18, v19
    v_exp_f32 v18, v114
    v_mfma_f32_16x16x32_bf16 v[64:67], v[40:43], a[200:203], v[64:67]
    ds_read_b128 v[32:35], v2 offset:256
    v_add_f32 v7, v7, v16
    v_mfma_f32_16x16x32_bf16 v[64:67], v[44:47], a[204:207], v[64:67]
    buffer_load_dwordx4 v[248:251], v12, s[68:71], s16 offen offset:1536 nt
    v_add_f32 v7, v7, v17
    v_mfma_f32_16x16x32_bf16 v[68:71], v[40:43], a[224:227], v[68:71]
    v_exp_f32 v19, v115
    v_mfma_f32_16x16x32_bf16 v[68:71], v[44:47], a[228:231], v[68:71]
    v_cvt_pk_bf16_f32 v178, v16, v17
    v_exp_f32 v16, v180
    v_mfma_f32_16x16x32_bf16 v[72:75], v[40:43], a[248:251], v[72:75]
    ds_read_b128 v[36:39], v3 offset:256
    v_add_f32 v7, v7, v18
    v_mfma_f32_16x16x32_bf16 v[72:75], v[44:47], a[252:255], v[72:75]
    buffer_load_dwordx4 v[252:255], v12, s[68:71], s16 offen offset:2304 nt
    v_add_f32 v7, v7, v19
    v_mfma_f32_16x16x32_bf16 v[76:79], v[40:43], v[208:211], v[76:79]
    v_exp_f32 v17, v181
    v_mfma_f32_16x16x32_bf16 v[76:79], v[44:47], v[212:215], v[76:79]
    s_waitcnt lgkmcnt(2)
    v_cvt_pk_bf16_f32 v179, v18, v19
    v_exp_f32 v18, v182
    v_mfma_f32_16x16x32_bf16 v[96:99], v[24:27], a[200:203], v[96:99]
    s_mov_b32 m0, s26
    ds_read_b128 v[40:43], v2 offset:6400
    v_add_f32 v8, v8, v16
    v_mfma_f32_16x16x32_bf16 v[96:99], v[28:31], a[204:207], v[96:99]
    buffer_load_dwordx4 v4, s[4:7], s32 offen offset:0 sc1 lds
    v_add_f32 v8, v8, v17
    v_mfma_f32_16x16x32_bf16 v[100:103], v[24:27], a[224:227], v[100:103]
    v_exp_f32 v19, v183
    v_mfma_f32_16x16x32_bf16 v[100:103], v[28:31], a[228:231], v[100:103]
    v_cvt_pk_bf16_f32 v180, v16, v17
    v_exp_f32 v16, v116
    v_mfma_f32_16x16x32_bf16 v[104:107], v[24:27], a[248:251], v[104:107]
    ds_read_b128 v[44:47], v3 offset:6400
    v_add_f32 v8, v8, v18
    v_mfma_f32_16x16x32_bf16 v[104:107], v[28:31], a[252:255], v[104:107]
    buffer_load_dwordx4 v4, s[4:7], s32 offen offset:1024 sc1 lds
    v_add_f32 v8, v8, v19
    v_mfma_f32_16x16x32_bf16 v[108:111], v[24:27], v[208:211], v[108:111]
    v_exp_f32 v17, v117
    v_mfma_f32_16x16x32_bf16 v[108:111], v[28:31], v[212:215], v[108:111]
    s_waitcnt lgkmcnt(2)
    v_cvt_pk_bf16_f32 v181, v18, v19
    v_exp_f32 v18, v118
    v_mfma_f32_16x16x32_bf16 v[64:67], v[32:35], a[208:211], v[64:67]
    ds_read_b128 v[24:27], v2 offset:12288
    v_add_f32 v8, v8, v16
    v_mfma_f32_16x16x32_bf16 v[64:67], v[36:39], a[212:215], v[64:67]
    buffer_load_dwordx4 v4, s[4:7], s32 offen offset:2048 sc1 lds
    v_add_f32 v8, v8, v17
    v_mfma_f32_16x16x32_bf16 v[68:71], v[32:35], a[232:235], v[68:71]
    s_add_u32 s32, s32, 24576
    v_exp_f32 v19, v119
    v_mfma_f32_16x16x32_bf16 v[68:71], v[36:39], a[236:239], v[68:71]
    v_cvt_pk_bf16_f32 v182, v16, v17
    v_add_f32 v8, v8, v18
    v_add_f32 v8, v8, v19
    v_mfma_f32_16x16x32_bf16 v[72:75], v[32:35], v[192:195], v[72:75]
    s_sub_u32 s57, s32, 196608
    ds_read_b128 v[28:31], v3 offset:12288
    v_cvt_pk_bf16_f32 v183, v18, v19
    v_mfma_f32_16x16x32_bf16 v[72:75], v[36:39], v[196:199], v[72:75]
    s_waitcnt lgkmcnt(2)
    v_exp_f32 v16, v184
    v_lshlrev_b32 v48, 16, v56
    v_mfma_f32_16x16x32_bf16 v[76:79], v[32:35], v[216:219], v[76:79]
    s_waitcnt vmcnt(9)
    v_exp_f32 v17, v185
    v_mfma_f32_16x16x32_bf16 v[76:79], v[36:39], v[220:223], v[76:79]
    s_barrier
    v_exp_f32 v18, v186
    v_mfma_f32_16x16x32_bf16 v[96:99], v[40:43], a[208:211], v[96:99]
    s_min_u32 s32, s32, s57
    ds_read_b128 v[32:35], v2 offset:18432
    v_add_f32 v7, v7, v16
    v_mfma_f32_16x16x32_bf16 v[96:99], v[44:47], a[212:215], v[96:99]
    v_add_f32 v7, v7, v17
    v_exp_f32 v19, v187
    v_mfma_f32_16x16x32_bf16 v[100:103], v[40:43], a[232:235], v[100:103]
    s_add_u32 s26, s26, 12288
    v_cvt_pk_bf16_f32 v184, v16, v17
    v_and_b32 v49, s97, v56
    v_mfma_f32_16x16x32_bf16 v[100:103], v[44:47], a[236:239], v[100:103]
    v_exp_f32 v16, v120
    v_add_f32 v7, v7, v18
    v_mfma_f32_16x16x32_bf16 v[104:107], v[40:43], v[192:195], v[104:107]
    s_mov_b32 m0, s26
    ds_read_b128 v[36:39], v3 offset:18432
    v_add_f32 v7, v7, v19
    v_mfma_f32_16x16x32_bf16 v[104:107], v[44:47], v[196:199], v[104:107]
    buffer_load_dwordx4 v4, s[4:7], s32 offen offset:0 sc1 lds
    v_lshlrev_b32 v50, 16, v58
    v_mfma_f32_16x16x32_bf16 v[108:111], v[40:43], v[216:219], v[108:111]
    v_exp_f32 v17, v121
    v_mfma_f32_16x16x32_bf16 v[108:111], v[44:47], v[220:223], v[108:111]
    s_waitcnt lgkmcnt(2)
    v_cvt_pk_bf16_f32 v185, v18, v19
    v_exp_f32 v18, v122
    v_mfma_f32_16x16x32_bf16 v[80:83], v[24:27], a[192:195], v[128:131]
    ds_read_b128 v[40:43], v2 offset:12416
    v_add_f32 v7, v7, v16
    v_mfma_f32_16x16x32_bf16 v[80:83], v[28:31], a[196:199], v[80:83]
    buffer_load_dwordx4 v4, s[4:7], s32 offen offset:1024 sc1 lds
    v_add_f32 v7, v7, v17
    v_mfma_f32_16x16x32_bf16 v[84:87], v[24:27], a[216:219], v[132:135]
    v_exp_f32 v19, v123
    v_mfma_f32_16x16x32_bf16 v[84:87], v[28:31], a[220:223], v[84:87]
    v_cvt_pk_bf16_f32 v186, v16, v17
    v_exp_f32 v16, v188
    v_mfma_f32_16x16x32_bf16 v[88:91], v[24:27], a[240:243], v[136:139]
    ds_read_b128 v[44:47], v3 offset:12416
    v_add_f32 v7, v7, v18
    v_mfma_f32_16x16x32_bf16 v[88:91], v[28:31], a[244:247], v[88:91]
    v_add_u32 v0, 1, v0
    buffer_store_dword v0, v13, s[20:23], 0 offen offset:32 sc1
    v_mfma_f32_16x16x32_bf16 v[92:95], v[24:27], v[200:203], v[140:143]
    v_add_f32 v7, v7, v19
    v_exp_f32 v17, v189
    v_cvt_pk_bf16_f32 v187, v18, v19
    v_exp_f32 v18, v190
    v_add_f32 v8, v8, v16
    v_add_f32 v8, v8, v17
    v_exp_f32 v19, v191
    v_cvt_pk_bf16_f32 v188, v16, v17
    v_exp_f32 v16, v124
    v_add_f32 v8, v8, v18
    v_add_f32 v8, v8, v19
    v_exp_f32 v17, v125
    v_cvt_pk_bf16_f32 v189, v18, v19
    v_exp_f32 v18, v126
    v_add_f32 v8, v8, v16
    v_add_f32 v8, v8, v17
    v_exp_f32 v19, v127
    v_cvt_pk_bf16_f32 v190, v16, v17
    v_add_f32 v8, v8, v18
    v_add_f32 v8, v8, v19
    v_cvt_pk_bf16_f32 v191, v18, v19
    v_mfma_f32_16x16x32_bf16 v[92:95], v[28:31], v[204:207], v[92:95]
    s_waitcnt lgkmcnt(2)
    v_and_b32 v51, s97, v58
    v_mul_f32_e64 v50, -v50, v48
    v_mul_f32_e64 v51, -v51, v49
    v_mfma_f32_16x16x32_bf16 v[112:115], v[32:35], a[192:195], v[128:131]
    ds_read_b128 v[24:27], v2 offset:18560
    v_cvt_f32_i32 v144, v144
    v_mfma_f32_16x16x32_bf16 v[112:115], v[36:39], a[196:199], v[112:115]
    buffer_load_dwordx4 v4, s[4:7], s32 offen offset:2048 sc1 lds
    v_cvt_f32_i32 v148, v148
    v_mfma_f32_16x16x32_bf16 v[116:119], v[32:35], a[216:219], v[132:135]
    s_mov_b32 s32, 196608
    v_fma_f32 v144, v144, v48, v50
    v_fma_f32 v148, v148, v49, v51
    v_mfma_f32_16x16x32_bf16 v[116:119], v[36:39], a[220:223], v[116:119]
    v_cvt_f32_i32 v145, v145
    v_cvt_f32_i32 v149, v149
    v_fma_f32 v145, v145, v48, v50
    v_mfma_f32_16x16x32_bf16 v[120:123], v[32:35], a[240:243], v[136:139]
    s_add_u32 s26, s26, 36864
    ds_read_b128 v[28:31], v3 offset:18560
    v_fma_f32 v149, v149, v49, v51
    v_mfma_f32_16x16x32_bf16 v[120:123], v[36:39], a[244:247], v[120:123]
    v_cvt_f32_i32 v146, v146
    v_cvt_f32_i32 v150, v150
    v_fma_f32 v146, v146, v48, v50
    v_mfma_f32_16x16x32_bf16 v[124:127], v[32:35], v[200:203], v[140:143]
    s_sub_u32 s57, s26, 147456
    v_fma_f32 v150, v150, v49, v51
    v_cvt_f32_i32 v147, v147
    v_mfma_f32_16x16x32_bf16 v[124:127], v[36:39], v[204:207], v[124:127]
    s_waitcnt lgkmcnt(2)
    v_cvt_f32_i32 v151, v151
    v_exp_f32 v16, v64
    v_mfma_f32_16x16x32_bf16 v[80:83], v[40:43], a[200:203], v[80:83]
    s_min_u32 s26, s26, s57
    ds_read_b128 v[32:35], v2 offset:12544
    v_fma_f32 v147, v147, v48, v50
    v_mfma_f32_16x16x32_bf16 v[80:83], v[44:47], a[204:207], v[80:83]
    v_exp_f32 v17, v65
    v_fma_f32 v151, v151, v49, v51
    v_mfma_f32_16x16x32_bf16 v[84:87], v[40:43], a[224:227], v[84:87]
    s_mov_b32 m0, s56
    v_exp_f32 v18, v66
    v_mfma_f32_16x16x32_bf16 v[84:87], v[44:47], a[228:231], v[84:87]
    buffer_load_dwordx4 v4, s[4:7], s27 offen offset:0 sc1 lds
    v_lshlrev_b32 v48, 16, v57
    v_mfma_f32_16x16x32_bf16 v[88:91], v[40:43], a[248:251], v[88:91]
    ds_read_b128 v[36:39], v3 offset:12544
    v_add_f32 v5, v5, v16
    v_mfma_f32_16x16x32_bf16 v[88:91], v[44:47], a[252:255], v[88:91]
    v_add_f32 v5, v5, v17
    v_and_b32 v49, s97, v57
    v_lshlrev_b32 v50, 16, v59
    v_mfma_f32_16x16x32_bf16 v[92:95], v[40:43], v[208:211], v[92:95]
    v_exp_f32 v19, v67
    v_mfma_f32_16x16x32_bf16 v[92:95], v[44:47], v[212:215], v[92:95]
    s_waitcnt lgkmcnt(2)
    buffer_load_dwordx4 v4, s[4:7], s27 offen offset:1024 sc1 lds
    v_cvt_pk_bf16_f32 v64, v16, v17
    v_mfma_f32_16x16x32_bf16 v[112:115], v[24:27], a[200:203], v[112:115]
    ds_read_b128 v[40:43], v2 offset:18688
    v_and_b32 v51, s97, v59
    v_mfma_f32_16x16x32_bf16 v[112:115], v[28:31], a[204:207], v[112:115]
    v_exp_f32 v16, v96
    v_add_f32 v5, v5, v18
    v_mfma_f32_16x16x32_bf16 v[116:119], v[24:27], a[224:227], v[116:119]
    v_add_f32 v5, v5, v19
    v_mul_f32_e64 v50, -v50, v48
    v_mfma_f32_16x16x32_bf16 v[116:119], v[28:31], a[228:231], v[116:119]
    s_waitcnt vmcnt(13)
    buffer_load_dwordx4 v4, s[4:7], s27 offen offset:2048 sc1 lds
    v_mul_f32_e64 v51, -v51, v49
    v_mfma_f32_16x16x32_bf16 v[120:123], v[24:27], a[248:251], v[120:123]
    s_add_u32 s27, s27, 24576
    ds_read_b128 v[44:47], v3 offset:18688
    v_cvt_f32_i32 v152, v152
    v_mfma_f32_16x16x32_bf16 v[120:123], v[28:31], a[252:255], v[120:123]
    s_waitcnt lgkmcnt(2)
    v_exp_f32 v17, v97
    v_cvt_pk_bf16_f32 v65, v18, v19
    v_mfma_f32_16x16x32_bf16 v[124:127], v[24:27], v[208:211], v[124:127]
    s_sub_u32 s58, s27, 196608
    v_exp_f32 v18, v98
    v_mfma_f32_16x16x32_bf16 v[124:127], v[28:31], v[212:215], v[124:127]
    s_barrier
    v_subrev_u32 v1, 49152, v1
    v_add_f32 v5, v5, v16
    v_mfma_f32_16x16x32_bf16 v[80:83], v[32:35], a[208:211], v[80:83]
    s_min_u32 s27, s27, s58
    ds_read_b128 v[24:27], v1 offset:0
    v_add_f32 v5, v5, v17
    v_mfma_f32_16x16x32_bf16 v[80:83], v[36:39], a[212:215], v[80:83]
    v_exp_f32 v19, v99
    v_cvt_f32_i32 v156, v156
    v_mfma_f32_16x16x32_bf16 v[84:87], v[32:35], a[232:235], v[84:87]
    s_add_u32 s56, s56, 12288
    v_cvt_pk_bf16_f32 v66, v16, v17
    v_fma_f32 v152, v152, v48, v50
    v_mfma_f32_16x16x32_bf16 v[84:87], v[36:39], a[236:239], v[84:87]
    v_exp_f32 v16, v68
    v_fma_f32 v156, v156, v49, v51
    v_mfma_f32_16x16x32_bf16 v[88:91], v[32:35], v[192:195], v[88:91]
    s_mov_b32 m0, s56
    ds_read_b128 v[28:31], v1 offset:12288
    v_add_f32 v5, v5, v18
    v_mfma_f32_16x16x32_bf16 v[88:91], v[36:39], v[196:199], v[88:91]
    s_waitcnt vmcnt(12)
    buffer_load_dwordx4 v4, s[4:7], s27 offen offset:0 sc1 lds
    v_add_f32 v5, v5, v19
    v_mfma_f32_16x16x32_bf16 v[92:95], v[32:35], v[216:219], v[92:95]
    v_exp_f32 v17, v69
    v_mfma_f32_16x16x32_bf16 v[92:95], v[36:39], v[220:223], v[92:95]
    s_waitcnt lgkmcnt(2)
    v_cvt_f32_i32 v153, v153
    v_cvt_pk_bf16_f32 v67, v18, v19
    v_cvt_f32_i32 v157, v157
    v_mfma_f32_16x16x32_bf16 v[112:115], v[40:43], a[208:211], v[112:115]
    ds_read_b128 v[32:35], v1 offset:1024
    v_fma_f32 v153, v153, v48, v50
    v_mfma_f32_16x16x32_bf16 v[112:115], v[44:47], a[212:215], v[112:115]
    s_waitcnt vmcnt(12)
    buffer_load_dwordx4 v4, s[4:7], s27 offen offset:1024 sc1 lds
    v_fma_f32 v157, v157, v49, v51
    v_mfma_f32_16x16x32_bf16 v[116:119], v[40:43], a[232:235], v[116:119]
    s_waitcnt vmcnt(12)
    buffer_load_dwordx4 v4, s[4:7], s27 offen offset:2048 sc1 lds
    v_mfma_f32_16x16x32_bf16 v[116:119], v[44:47], a[236:239], v[116:119]
    v_exp_f32 v18, v70
    v_add_f32 v6, v6, v16
    v_mfma_f32_16x16x32_bf16 v[120:123], v[40:43], v[192:195], v[120:123]
    s_add_u32 s27, s27, 24576
    ds_read_b128 v[36:39], v1 offset:13312
    v_add_f32 v6, v6, v17
    v_mfma_f32_16x16x32_bf16 v[120:123], v[44:47], v[196:199], v[120:123]
    v_exp_f32 v19, v71
    v_cvt_pk_bf16_f32 v68, v16, v17
    v_mfma_f32_16x16x32_bf16 v[124:127], v[40:43], v[216:219], v[124:127]
    s_sub_u32 s58, s27, 196608
    v_exp_f32 v16, v100
    v_mfma_f32_16x16x32_bf16 v[124:127], v[44:47], v[220:223], v[124:127]
    s_waitcnt lgkmcnt(2)
    v_cvt_f32_i32 v154, v154
    v_add_f32 v6, v6, v18
    v_cvt_f32_i32 v158, v158
    v_add_f32 v6, v6, v19
    v_fma_f32 v154, v154, v48, v50
    v_exp_f32 v17, v101
    v_fma_f32 v158, v158, v49, v51
    v_cvt_f32_i32 v155, v155
    v_cvt_pk_bf16_f32 v69, v18, v19
    v_cvt_f32_i32 v159, v159
    v_exp_f32 v18, v102
    v_fma_f32 v155, v155, v48, v50
    v_fma_f32 v159, v159, v49, v51
    v_add_f32 v6, v6, v16
    v_cvt_pk_bf16_f32 v144, v144, v148
    v_add_f32 v6, v6, v17
    v_cvt_pk_bf16_f32 v148, v145, v149
    v_exp_f32 v19, v103
    v_cvt_pk_bf16_f32 v145, v152, v156
    v_cvt_pk_bf16_f32 v149, v153, v157
    v_cvt_pk_bf16_f32 v70, v16, v17
    s_min_u32 s27, s27, s58
    v_cvt_pk_bf16_f32 v152, v146, v150
    v_add_f32 v6, v6, v18
    s_add_u32 s56, s56, 36864
    v_cvt_pk_bf16_f32 v153, v154, v158
    v_add_f32 v6, v6, v19
    s_sub_u32 s58, s56, 147456
    v_cvt_pk_bf16_f32 v156, v147, v151
    v_cvt_pk_bf16_f32 v71, v18, v19
    s_min_u32 s56, s56, s58
    v_cvt_pk_bf16_f32 v157, v155, v159
    s_mov_b32 s31, 7
    v_mfma_f32_16x16x32_bf16 a[96:99], v[24:27], v[160:163], 0
    s_add_u32 s33, s33, 196608
    ds_read_b128 v[40:43], v1 offset:2048
    v_mfma_f32_16x16x32_bf16 a[96:99], v[28:31], v[168:171], a[96:99]
    s_add_u32 s34, s34, 196608
    v_exp_f32 v16, v72
    v_mfma_f32_16x16x32_bf16 a[144:147], v[24:27], v[164:167], 0
    ds_read_b128 v[44:47], v1 offset:14336
    v_mfma_f32_16x16x32_bf16 a[144:147], v[28:31], v[172:175], a[144:147]
    s_waitcnt lgkmcnt(2)
    v_exp_f32 v17, v73
    v_mfma_f32_16x16x32_bf16 a[100:103], v[32:35], v[160:163], 0
    s_add_u32 s36, s36, 1536
    ds_read_b128 v[24:27], v1 offset:3072
    v_mfma_f32_16x16x32_bf16 a[100:103], v[36:39], v[168:171], a[100:103]
    v_exp_f32 v18, v74
    v_mfma_f32_16x16x32_bf16 a[148:151], v[32:35], v[164:167], 0
    ds_read_b128 v[28:31], v1 offset:15360
    v_add_f32 v7, v7, v16
    v_mfma_f32_16x16x32_bf16 a[148:151], v[36:39], v[172:175], a[148:151]
    s_waitcnt lgkmcnt(2)
    s_waitcnt vmcnt(12)
    buffer_load_dwordx2 v[56:57], v10, s[72:75], s36 offen offset:0
    v_mfma_f32_16x16x32_bf16 a[104:107], v[40:43], v[160:163], 0
    ds_read_b128 v[32:35], v1 offset:4096
    v_add_f32 v7, v7, v17
    v_mfma_f32_16x16x32_bf16 a[104:107], v[44:47], v[168:171], a[104:107]
    v_exp_f32 v19, v75
    v_mfma_f32_16x16x32_bf16 a[152:155], v[40:43], v[164:167], 0
    ds_read_b128 v[36:39], v1 offset:16384
    v_cvt_pk_bf16_f32 v72, v16, v17
    v_mfma_f32_16x16x32_bf16 a[152:155], v[44:47], v[172:175], a[152:155]
    s_waitcnt lgkmcnt(2)
    buffer_load_dwordx2 v[58:59], v10, s[76:79], s36 offen offset:0
    v_mfma_f32_16x16x32_bf16 a[108:111], v[24:27], v[160:163], 0
    ds_read_b128 v[40:43], v1 offset:5120
    v_mfma_f32_16x16x32_bf16 a[108:111], v[28:31], v[168:171], a[108:111]
    v_exp_f32 v16, v104
    v_mfma_f32_16x16x32_bf16 a[156:159], v[24:27], v[164:167], 0
    ds_read_b128 v[44:47], v1 offset:17408
    v_add_f32 v7, v7, v18
    v_mfma_f32_16x16x32_bf16 a[156:159], v[28:31], v[172:175], a[156:159]
    s_waitcnt lgkmcnt(2)
    s_waitcnt vmcnt(13)
    buffer_load_dwordx4 v[224:227], v9, s[64:67], s33 offen offset:0 nt
    v_mfma_f32_16x16x32_bf16 a[112:115], v[32:35], v[160:163], 0
    ds_read_b128 v[24:27], v1 offset:6144
    v_add_f32 v7, v7, v19
    v_mfma_f32_16x16x32_bf16 a[112:115], v[36:39], v[168:171], a[112:115]
    v_exp_f32 v17, v105
    v_mfma_f32_16x16x32_bf16 a[160:163], v[32:35], v[164:167], 0
    ds_read_b128 v[28:31], v1 offset:18432
    v_cvt_pk_bf16_f32 v73, v18, v19
    v_mfma_f32_16x16x32_bf16 a[160:163], v[36:39], v[172:175], a[160:163]
    s_waitcnt lgkmcnt(2)
    s_waitcnt vmcnt(13)
    buffer_load_dwordx4 v[228:231], v9, s[64:67], s33 offen offset:1536 nt
    v_mfma_f32_16x16x32_bf16 a[116:119], v[40:43], v[160:163], 0
    ds_read_b128 v[32:35], v1 offset:7168
    v_mfma_f32_16x16x32_bf16 a[116:119], v[44:47], v[168:171], a[116:119]
    v_exp_f32 v18, v106
    v_mfma_f32_16x16x32_bf16 a[164:167], v[40:43], v[164:167], 0
    ds_read_b128 v[36:39], v1 offset:19456
    v_add_f32 v7, v7, v16
    v_mfma_f32_16x16x32_bf16 a[164:167], v[44:47], v[172:175], a[164:167]
    s_waitcnt lgkmcnt(2)
    buffer_load_dwordx4 v[232:235], v9, s[64:67], s34 offen offset:0 nt
    v_add_f32 v7, v7, v17
    v_mfma_f32_16x16x32_bf16 a[120:123], v[24:27], v[160:163], 0
    ds_read_b128 v[40:43], v1 offset:8192
    v_mfma_f32_16x16x32_bf16 a[120:123], v[28:31], v[168:171], a[120:123]
    v_exp_f32 v19, v107
    v_cvt_pk_bf16_f32 v74, v16, v17
    v_mfma_f32_16x16x32_bf16 a[168:171], v[24:27], v[164:167], 0
    ds_read_b128 v[44:47], v1 offset:20480
    v_mfma_f32_16x16x32_bf16 a[168:171], v[28:31], v[172:175], a[168:171]
    s_waitcnt lgkmcnt(2)
    s_waitcnt vmcnt(14)
    buffer_load_dwordx4 v[236:239], v9, s[64:67], s34 offen offset:1536 nt
    v_mfma_f32_16x16x32_bf16 a[124:127], v[32:35], v[160:163], 0
    ds_read_b128 v[24:27], v1 offset:9216
    v_mfma_f32_16x16x32_bf16 a[124:127], v[36:39], v[168:171], a[124:127]
    v_exp_f32 v16, v76
    v_add_f32 v7, v7, v18
    v_mfma_f32_16x16x32_bf16 a[172:175], v[32:35], v[164:167], 0
    s_waitcnt vmcnt(19)
    ds_read_b128 v[28:31], v1 offset:21504
    v_add_f32 v7, v7, v19
    v_mfma_f32_16x16x32_bf16 a[172:175], v[36:39], v[172:175], a[172:175]
    s_waitcnt lgkmcnt(2)
    v_exp_f32 v17, v77
    v_cvt_pk_bf16_f32 v75, v18, v19
    v_mfma_f32_16x16x32_bf16 a[128:131], v[40:43], v[160:163], 0
    s_add_u32 s29, s28, 49152
    ds_read_b128 v[32:35], v1 offset:10240
    v_lshlrev_b32 v48, 16, v60
    v_mfma_f32_16x16x32_bf16 a[128:131], v[44:47], v[168:171], a[128:131]
    v_exp_f32 v18, v78
    v_add_f32 v8, v8, v16
    v_mfma_f32_16x16x32_bf16 a[176:179], v[40:43], v[164:167], 0
    s_sub_u32 s3, s29, 147456
    ds_read_b128 v[36:39], v1 offset:22528
    v_add_f32 v8, v8, v17
    v_mfma_f32_16x16x32_bf16 a[176:179], v[44:47], v[172:175], a[176:179]
    s_waitcnt lgkmcnt(2)
    v_exp_f32 v19, v79
    v_mfma_f32_16x16x32_bf16 a[132:135], v[24:27], v[160:163], 0
    ds_read_b128 v[40:43], v1 offset:11264
    v_cvt_pk_bf16_f32 v76, v16, v17
    v_mfma_f32_16x16x32_bf16 a[132:135], v[28:31], v[168:171], a[132:135]
    v_exp_f32 v16, v108
    v_mfma_f32_16x16x32_bf16 a[180:183], v[24:27], v[164:167], 0
    s_min_u32 s29, s29, s3
    ds_read_b128 v[44:47], v1 offset:23552
    v_and_b32 v49, s97, v60
    v_mfma_f32_16x16x32_bf16 a[180:183], v[28:31], v[172:175], a[180:183]
    s_waitcnt lgkmcnt(2)
    v_add_u32 v1, 49152, v1
    v_add_f32 v8, v8, v18
    v_mfma_f32_16x16x32_bf16 a[136:139], v[32:35], v[160:163], 0
    ds_read_b128 v[24:27], v1 offset:0
    v_add_f32 v8, v8, v19
    v_mfma_f32_16x16x32_bf16 a[136:139], v[36:39], v[168:171], a[136:139]
    v_lshlrev_b32 v50, 16, v62
    v_exp_f32 v17, v109
    v_mfma_f32_16x16x32_bf16 a[184:187], v[32:35], v[164:167], 0
    ds_read_b128 v[28:31], v1 offset:12288
    v_and_b32 v51, s97, v62
    v_mfma_f32_16x16x32_bf16 a[184:187], v[36:39], v[172:175], a[184:187]
    s_waitcnt lgkmcnt(2)
    v_cvt_pk_bf16_f32 v77, v18, v19
    v_mul_f32_e64 v50, -v50, v48
    v_mfma_f32_16x16x32_bf16 a[140:143], v[40:43], v[160:163], 0
    s_sub_u32 s3, s29, s28
    ds_read_b128 v[32:35], v1 offset:1024
    v_bfe_u32 v53, v4, 4, 6
    v_mfma_f32_16x16x32_bf16 a[140:143], v[44:47], v[168:171], a[140:143]
    v_exp_f32 v18, v110
    v_mul_f32_e64 v51, -v51, v49
    v_mfma_f32_16x16x32_bf16 a[188:191], v[40:43], v[164:167], 0
    ds_read_b128 v[36:39], v1 offset:13312
    v_lshlrev_b32 v53, 2, v53
    v_mfma_f32_16x16x32_bf16 a[188:191], v[44:47], v[172:175], a[188:191]
    s_waitcnt lgkmcnt(2)
    s_barrier
    v_add_f32 v8, v8, v16
    v_mfma_f32_16x16x32_bf16 a[96:99], v[24:27], v[176:179], a[96:99]
    ds_read_b128 v[40:43], v1 offset:2048
    buffer_load_dword v52, v53, s[20:23], s44 offen sc1
    v_mfma_f32_16x16x32_bf16 a[96:99], v[28:31], v[184:187], a[96:99]
    v_add_f32 v8, v8, v17
    v_cvt_f32_i32 v240, v240
    v_cvt_f32_i32 v244, v244
    v_mfma_f32_16x16x32_bf16 a[144:147], v[24:27], v[180:183], a[144:147]
    s_mov_b32 s28, s29
    ds_read_b128 v[44:47], v1 offset:14336
    v_fma_f32 v240, v240, v48, v50
    v_mfma_f32_16x16x32_bf16 a[144:147], v[28:31], v[188:191], a[144:147]
    s_waitcnt lgkmcnt(2)
    v_exp_f32 v19, v111
    v_cvt_pk_bf16_f32 v78, v16, v17
    v_mfma_f32_16x16x32_bf16 a[100:103], v[32:35], v[176:179], a[100:103]
    s_mov_b32 m0, s56
    ds_read_b128 v[24:27], v1 offset:3072
    v_add_f32 v8, v8, v18
    v_mfma_f32_16x16x32_bf16 a[100:103], v[36:39], v[184:187], a[100:103]
    s_waitcnt vmcnt(15)
    buffer_load_dwordx4 v4, s[4:7], s27 offen offset:0 sc1 lds
    v_add_f32 v8, v8, v19
    v_mfma_f32_16x16x32_bf16 a[148:151], v[32:35], v[180:183], a[148:151]
    ds_read_b128 v[28:31], v1 offset:15360
    v_fma_f32 v244, v244, v49, v51
    v_mfma_f32_16x16x32_bf16 a[148:151], v[36:39], v[188:191], a[148:151]
    s_waitcnt lgkmcnt(2)
    v_cvt_pk_bf16_f32 v79, v18, v19
    v_cvt_f32_i32 v241, v241
    v_cvt_f32_i32 v245, v245
    v_mfma_f32_16x16x32_bf16 a[104:107], v[40:43], v[176:179], a[104:107]
    ds_read_b128 v[32:35], v1 offset:4096
    v_fma_f32 v241, v241, v48, v50
    v_mfma_f32_16x16x32_bf16 a[104:107], v[44:47], v[184:187], a[104:107]
    s_waitcnt vmcnt(14)
    buffer_load_dwordx4 v4, s[4:7], s27 offen offset:1024 sc1 lds
    v_fma_f32 v245, v245, v49, v51
    v_mfma_f32_16x16x32_bf16 a[152:155], v[40:43], v[180:183], a[152:155]
    ds_read_b128 v[36:39], v1 offset:16384
    v_cvt_f32_i32 v242, v242
    v_mfma_f32_16x16x32_bf16 a[152:155], v[44:47], v[188:191], a[152:155]
    s_waitcnt lgkmcnt(2)
    v_exp_f32 v16, v80
    v_cvt_f32_i32 v246, v246
    v_mfma_f32_16x16x32_bf16 a[108:111], v[24:27], v[176:179], a[108:111]
    ds_read_b128 v[40:43], v1 offset:5120
    v_fma_f32 v242, v242, v48, v50
    v_mfma_f32_16x16x32_bf16 a[108:111], v[28:31], v[184:187], a[108:111]
    s_waitcnt vmcnt(14)
    buffer_load_dwordx4 v4, s[4:7], s27 offen offset:2048 sc1 lds
    v_fma_f32 v246, v246, v49, v51
    v_mfma_f32_16x16x32_bf16 a[156:159], v[24:27], v[180:183], a[156:159]
    ds_read_b128 v[44:47], v1 offset:17408
    v_cvt_f32_i32 v243, v243
    v_mfma_f32_16x16x32_bf16 a[156:159], v[28:31], v[188:191], a[156:159]
    s_waitcnt lgkmcnt(2)
    v_exp_f32 v17, v81
    v_cvt_f32_i32 v247, v247
    v_mfma_f32_16x16x32_bf16 a[112:115], v[32:35], v[176:179], a[112:115]
    s_add_u32 s27, s27, 24576
    ds_read_b128 v[24:27], v1 offset:6144
    v_fma_f32 v243, v243, v48, v50
    v_mfma_f32_16x16x32_bf16 a[112:115], v[36:39], v[184:187], a[112:115]
    v_exp_f32 v18, v82
    v_add_f32 v5, v5, v16
    v_mfma_f32_16x16x32_bf16 a[160:163], v[32:35], v[180:183], a[160:163]
    s_sub_u32 s58, s27, 196608
    ds_read_b128 v[28:31], v1 offset:18432
    v_add_f32 v5, v5, v17
    v_mfma_f32_16x16x32_bf16 a[160:163], v[36:39], v[188:191], a[160:163]
    s_waitcnt lgkmcnt(2)
    v_exp_f32 v19, v83
    v_cvt_pk_bf16_f32 v80, v16, v17
    v_mfma_f32_16x16x32_bf16 a[116:119], v[40:43], v[176:179], a[116:119]
    s_min_u32 s27, s27, s58
    ds_read_b128 v[32:35], v1 offset:7168
    v_fma_f32 v247, v247, v49, v51
    v_mfma_f32_16x16x32_bf16 a[116:119], v[44:47], v[184:187], a[116:119]
    v_exp_f32 v16, v112
    v_add_f32 v5, v5, v18
    v_mfma_f32_16x16x32_bf16 a[164:167], v[40:43], v[180:183], a[164:167]
    ds_read_b128 v[36:39], v1 offset:19456
    v_add_u32 v2, s3, v2
    v_add_u32 v3, s3, v3
    v_mfma_f32_16x16x32_bf16 a[164:167], v[44:47], v[188:191], a[164:167]
    s_waitcnt lgkmcnt(2)
    v_add_f32 v5, v5, v19
    v_exp_f32 v17, v113
    v_mfma_f32_16x16x32_bf16 a[120:123], v[24:27], v[176:179], a[120:123]
    s_add_u32 s56, s56, 12288
    ds_read_b128 v[40:43], v1 offset:8192
    v_cvt_pk_bf16_f32 v81, v18, v19
    v_mfma_f32_16x16x32_bf16 a[120:123], v[28:31], v[184:187], a[120:123]
    v_exp_f32 v18, v114
    v_lshlrev_b32 v48, 16, v61
    v_mfma_f32_16x16x32_bf16 a[168:171], v[24:27], v[180:183], a[168:171]
    s_mov_b32 m0, s56
    ds_read_b128 v[44:47], v1 offset:20480
    v_and_b32 v49, s97, v61
    v_mfma_f32_16x16x32_bf16 a[168:171], v[28:31], v[188:191], a[168:171]
    s_waitcnt lgkmcnt(2)
    s_waitcnt vmcnt(14)
    buffer_load_dwordx4 v4, s[4:7], s27 offen offset:0 sc1 lds
    v_add_f32 v5, v5, v16
    v_mfma_f32_16x16x32_bf16 a[124:127], v[32:35], v[176:179], a[124:127]
    ds_read_b128 v[24:27], v1 offset:9216
    v_add_f32 v5, v5, v17
    v_mfma_f32_16x16x32_bf16 a[124:127], v[36:39], v[184:187], a[124:127]
    v_lshlrev_b32 v50, 16, v63
    v_exp_f32 v19, v115
    v_mfma_f32_16x16x32_bf16 a[172:175], v[32:35], v[180:183], a[172:175]
    ds_read_b128 v[28:31], v1 offset:21504
    v_and_b32 v51, s97, v63
    v_mfma_f32_16x16x32_bf16 a[172:175], v[36:39], v[188:191], a[172:175]
    s_waitcnt lgkmcnt(2)
    s_waitcnt vmcnt(14)
    buffer_load_dwordx4 v4, s[4:7], s27 offen offset:1024 sc1 lds
    v_cvt_pk_bf16_f32 v82, v16, v17
    v_mfma_f32_16x16x32_bf16 a[128:131], v[40:43], v[176:179], a[128:131]
    ds_read_b128 v[32:35], v1 offset:10240
    v_mul_f32_e64 v50, -v50, v48
    v_mfma_f32_16x16x32_bf16 a[128:131], v[44:47], v[184:187], a[128:131]
    v_exp_f32 v16, v84
    v_mul_f32_e64 v51, -v51, v49
    v_mfma_f32_16x16x32_bf16 a[176:179], v[40:43], v[180:183], a[176:179]
    ds_read_b128 v[36:39], v1 offset:22528
    v_add_f32 v5, v5, v18
    v_mfma_f32_16x16x32_bf16 a[176:179], v[44:47], v[188:191], a[176:179]
    s_waitcnt lgkmcnt(2)
    s_waitcnt vmcnt(14)
    buffer_load_dwordx4 v4, s[4:7], s27 offen offset:2048 sc1 lds
    v_add_f32 v5, v5, v19
    v_mfma_f32_16x16x32_bf16 a[132:135], v[24:27], v[176:179], a[132:135]
    ds_read_b128 v[40:43], v1 offset:11264
    v_cvt_f32_i32 v248, v248
    v_mfma_f32_16x16x32_bf16 a[132:135], v[28:31], v[184:187], a[132:135]
    s_waitcnt vmcnt(19)
    v_exp_f32 v17, v85
    v_cvt_f32_i32 v252, v252
    v_mfma_f32_16x16x32_bf16 a[180:183], v[24:27], v[180:183], a[180:183]
    s_mov_b32 s27, 208896
    ds_read_b128 v[44:47], v1 offset:23552
    v_cvt_pk_bf16_f32 v83, v18, v19
    v_mfma_f32_16x16x32_bf16 a[180:183], v[28:31], v[188:191], a[180:183]
    s_waitcnt lgkmcnt(2)
    s_barrier
    v_fma_f32 v248, v248, v48, v50
    v_mfma_f32_16x16x32_bf16 a[136:139], v[32:35], v[176:179], a[136:139]
    s_add_u32 s56, s56, 36864
    ds_read_b128 v[24:27], v2 offset:0
    v_fma_f32 v252, v252, v49, v51
    v_mfma_f32_16x16x32_bf16 a[136:139], v[36:39], v[184:187], a[136:139]
    v_exp_f32 v18, v86
    v_add_f32 v6, v6, v16
    v_mfma_f32_16x16x32_bf16 a[184:187], v[32:35], v[180:183], a[184:187]
    s_sub_u32 s58, s56, 147456
    ds_read_b128 v[28:31], v3 offset:0
    v_cvt_f32_i32 v249, v249
    v_mfma_f32_16x16x32_bf16 a[184:187], v[36:39], v[188:191], a[184:187]
    s_waitcnt lgkmcnt(2)
    v_add_f32 v6, v6, v17
    v_cvt_f32_i32 v253, v253
    v_fma_f32 v249, v249, v48, v50
    v_mfma_f32_16x16x32_bf16 a[140:143], v[40:43], v[176:179], a[140:143]
    s_nop 0
    ds_read_b128 v[32:35], v2 offset:6144
    v_fma_f32 v253, v253, v49, v51
    v_mfma_f32_16x16x32_bf16 a[140:143], v[44:47], v[184:187], a[140:143]
    s_min_u32 s56, s56, s58
    v_exp_f32 v19, v87
    v_cvt_pk_bf16_f32 v84, v16, v17
    v_mfma_f32_16x16x32_bf16 a[188:191], v[40:43], v[180:183], a[188:191]
    s_waitcnt lgkmcnt(1)
    ds_read_b128 v[36:39], v3 offset:6144
    v_exp_f32 v16, v116
    v_cvt_f32_i32 v250, v250
    v_add_f32 v6, v6, v18
    v_cvt_f32_i32 v254, v254
    v_add_f32 v6, v6, v19
    v_fma_f32 v250, v250, v48, v50
    v_exp_f32 v17, v117
    v_fma_f32 v254, v254, v49, v51
    v_cvt_f32_i32 v251, v251
    v_cvt_pk_bf16_f32 v85, v18, v19
    v_cvt_f32_i32 v255, v255
    v_exp_f32 v18, v118
    v_fma_f32 v251, v251, v48, v50
    v_fma_f32 v255, v255, v49, v51
    v_add_f32 v6, v6, v16
    v_cvt_pk_bf16_f32 v146, v240, v244
    v_add_f32 v6, v6, v17
    v_cvt_pk_bf16_f32 v150, v241, v245
    v_exp_f32 v19, v119
    v_cvt_pk_bf16_f32 v147, v248, v252
    v_cvt_pk_bf16_f32 v151, v249, v253
    v_cvt_pk_bf16_f32 v86, v16, v17
    v_cvt_pk_bf16_f32 v154, v242, v246
    v_add_f32 v6, v6, v18
    v_cvt_pk_bf16_f32 v155, v250, v254
    v_add_f32 v6, v6, v19
    v_cvt_pk_bf16_f32 v158, v243, v247
    v_cvt_pk_bf16_f32 v87, v18, v19
    v_cvt_pk_bf16_f32 v159, v251, v255
    v_mfma_f32_16x16x32_bf16 a[188:191], v[44:47], v[188:191], a[188:191]
    s_branch L_join
.p2align 6
L_loop:
    v_mfma_f32_16x16x32_bf16 v[160:163], v[24:27], a[192:195], v[128:131]
    s_mov_b32 m0, s56
    ds_read_b128 v[40:43], v2 offset:128
    s_waitcnt vmcnt(12)
    v_mfma_f32_16x16x32_bf16 v[160:163], v[28:31], a[196:199], v[160:163]
    buffer_load_dwordx2 v[60:61], off, s[80:83], s37 offset:8
    v_mfma_f32_16x16x32_bf16 v[164:167], v[24:27], a[216:219], v[132:135]
    v_exp_f32 v16, v88
    v_mfma_f32_16x16x32_bf16 v[164:167], v[28:31], a[220:223], v[164:167]
    v_exp_f32 v17, v89
    v_mfma_f32_16x16x32_bf16 v[168:171], v[24:27], a[240:243], v[136:139]
    ds_read_b128 v[44:47], v3 offset:128
    v_lshlrev_b32 v48, 16, v56
    v_mfma_f32_16x16x32_bf16 v[168:171], v[28:31], a[244:247], v[168:171]
    buffer_load_dwordx4 v4, s[4:7], s27 offen offset:0 sc1 lds
    v_mfma_f32_16x16x32_bf16 v[172:175], v[24:27], v[200:203], v[140:143]
    v_exp_f32 v18, v90
    v_mfma_f32_16x16x32_bf16 v[172:175], v[28:31], v[204:207], v[172:175]
    s_waitcnt lgkmcnt(2)
    v_add_f32 v7, v7, v16
    v_add_f32 v7, v7, v17
    v_mfma_f32_16x16x32_bf16 v[96:99], v[32:35], a[192:195], v[128:131]
    ds_read_b128 v[24:27], v2 offset:6272
    v_and_b32 v49, s97, v56
    v_mfma_f32_16x16x32_bf16 v[96:99], v[36:39], a[196:199], v[96:99]
    buffer_load_dwordx2 v[62:63], off, s[84:87], s37 offset:8
    v_mfma_f32_16x16x32_bf16 v[100:103], v[32:35], a[216:219], v[132:135]
    v_exp_f32 v19, v91
    v_mfma_f32_16x16x32_bf16 v[100:103], v[36:39], a[220:223], v[100:103]
    v_cvt_pk_bf16_f32 v88, v16, v17
    v_lshlrev_b32 v50, 16, v58
    v_mfma_f32_16x16x32_bf16 v[104:107], v[32:35], a[240:243], v[136:139]
    ds_read_b128 v[28:31], v3 offset:6272
    v_mfma_f32_16x16x32_bf16 v[104:107], v[36:39], a[244:247], v[104:107]
    v_exp_f32 v16, v120
    v_mfma_f32_16x16x32_bf16 v[108:111], v[32:35], v[200:203], v[140:143]
    v_add_f32 v7, v7, v18
    v_add_f32 v7, v7, v19
    v_mfma_f32_16x16x32_bf16 v[108:111], v[36:39], v[204:207], v[108:111]
    s_waitcnt lgkmcnt(2)
    buffer_load_dwordx4 v4, s[4:7], s27 offen offset:1024 sc1 lds
    v_mfma_f32_16x16x32_bf16 v[160:163], v[40:43], a[200:203], v[160:163]
    ds_read_b128 v[32:35], v2 offset:256
    v_and_b32 v51, s97, v58
    v_mfma_f32_16x16x32_bf16 v[160:163], v[44:47], a[204:207], v[160:163]
    v_exp_f32 v17, v121
    v_mfma_f32_16x16x32_bf16 v[164:167], v[40:43], a[224:227], v[164:167]
    v_cvt_pk_bf16_f32 v89, v18, v19
    v_mul_f32_e64 v50, -v50, v48
    v_mfma_f32_16x16x32_bf16 v[164:167], v[44:47], a[228:231], v[164:167]
    buffer_load_dwordx4 v[240:243], v12, s[68:71], s16 offen offset:0 nt
    v_mfma_f32_16x16x32_bf16 v[168:171], v[40:43], a[248:251], v[168:171]
    ds_read_b128 v[36:39], v3 offset:256
    v_mfma_f32_16x16x32_bf16 v[168:171], v[44:47], a[252:255], v[168:171]
    v_exp_f32 v18, v122
    v_mfma_f32_16x16x32_bf16 v[172:175], v[40:43], v[208:211], v[172:175]
    v_add_f32 v7, v7, v16
    v_add_f32 v7, v7, v17
    v_mfma_f32_16x16x32_bf16 v[172:175], v[44:47], v[212:215], v[172:175]
    s_waitcnt lgkmcnt(2)
    buffer_load_dwordx4 v[244:247], v12, s[68:71], s16 offen offset:768 nt
    v_mfma_f32_16x16x32_bf16 v[96:99], v[24:27], a[200:203], v[96:99]
    ds_read_b128 v[40:43], v2 offset:6400
    v_mul_f32_e64 v51, -v51, v49
    v_mfma_f32_16x16x32_bf16 v[96:99], v[28:31], a[204:207], v[96:99]
    v_exp_f32 v19, v123
    v_mfma_f32_16x16x32_bf16 v[100:103], v[24:27], a[224:227], v[100:103]
    v_cvt_pk_bf16_f32 v90, v16, v17
    v_mfma_f32_16x16x32_bf16 v[100:103], v[28:31], a[228:231], v[100:103]
    buffer_load_dwordx4 v4, s[4:7], s27 offen offset:2048 sc1 lds
    v_mfma_f32_16x16x32_bf16 v[104:107], v[24:27], a[248:251], v[104:107]
    ds_read_b128 v[44:47], v3 offset:6400
    v_cvt_f32_i32 v144, v144
    v_mfma_f32_16x16x32_bf16 v[104:107], v[28:31], a[252:255], v[104:107]
    v_exp_f32 v16, v92
    v_mfma_f32_16x16x32_bf16 v[108:111], v[24:27], v[208:211], v[108:111]
    s_add_u32 s29, s30, 49152
    v_add_f32 v7, v7, v18
    v_add_f32 v7, v7, v19
    v_mfma_f32_16x16x32_bf16 v[108:111], v[28:31], v[212:215], v[108:111]
    s_waitcnt lgkmcnt(2)
    buffer_load_dwordx4 v[248:251], v12, s[68:71], s16 offen offset:1536 nt
    v_mfma_f32_16x16x32_bf16 v[160:163], v[32:35], a[208:211], v[160:163]
    s_add_u32 s27, s27, 24576
    ds_read_b128 v[24:27], v2 offset:12288
    v_cvt_f32_i32 v148, v148
    v_mfma_f32_16x16x32_bf16 v[160:163], v[36:39], a[212:215], v[160:163]
    v_exp_f32 v17, v93
    v_cvt_pk_bf16_f32 v91, v18, v19
    v_mfma_f32_16x16x32_bf16 v[164:167], v[32:35], a[232:235], v[164:167]
    s_sub_u32 s3, s29, 147456
    v_exp_f32 v18, v94
    v_mfma_f32_16x16x32_bf16 v[164:167], v[36:39], a[236:239], v[164:167]
    s_add_u32 s56, s56, 12288
    v_add_f32 v8, v8, v16
    v_add_f32 v8, v8, v17
    v_mfma_f32_16x16x32_bf16 v[168:171], v[32:35], v[192:195], v[168:171]
    ds_read_b128 v[28:31], v3 offset:12288
    v_fma_f32 v144, v144, v48, v50
    v_mfma_f32_16x16x32_bf16 v[168:171], v[36:39], v[196:199], v[168:171]
    buffer_load_dwordx4 v[252:255], v12, s[68:71], s16 offen offset:2304 nt
    v_mfma_f32_16x16x32_bf16 v[172:175], v[32:35], v[216:219], v[172:175]
    v_exp_f32 v19, v95
    v_mfma_f32_16x16x32_bf16 v[172:175], v[36:39], v[220:223], v[172:175]
    s_waitcnt lgkmcnt(2)
    v_cvt_pk_bf16_f32 v92, v16, v17
    v_fma_f32 v148, v148, v49, v51
    v_mfma_f32_16x16x32_bf16 v[96:99], v[40:43], a[208:211], v[96:99]
    s_mov_b32 m0, s56
    ds_read_b128 v[32:35], v2 offset:18432
    v_mfma_f32_16x16x32_bf16 v[96:99], v[44:47], a[212:215], v[96:99]
    s_min_u32 s29, s29, s3
    v_exp_f32 v16, v124
    v_mfma_f32_16x16x32_bf16 v[100:103], v[40:43], a[232:235], v[100:103]
    v_add_f32 v8, v8, v18
    v_add_f32 v8, v8, v19
    v_mfma_f32_16x16x32_bf16 v[100:103], v[44:47], a[236:239], v[100:103]
    v_exp_f32 v17, v125
    v_mfma_f32_16x16x32_bf16 v[104:107], v[40:43], v[192:195], v[104:107]
    ds_read_b128 v[36:39], v3 offset:18432
    v_cvt_pk_bf16_f32 v93, v18, v19
    v_mfma_f32_16x16x32_bf16 v[104:107], v[44:47], v[196:199], v[104:107]
    v_exp_f32 v18, v126
    v_mfma_f32_16x16x32_bf16 v[108:111], v[40:43], v[216:219], v[108:111]
    v_add_f32 v8, v8, v16
    v_add_f32 v8, v8, v17
    v_mfma_f32_16x16x32_bf16 v[108:111], v[44:47], v[220:223], v[108:111]
    s_waitcnt lgkmcnt(2)
    buffer_load_dwordx4 v4, s[4:7], s27 offen offset:0 sc1 lds
    v_mfma_f32_16x16x32_bf16 v[176:179], v[24:27], a[192:195], v[128:131]
    ds_read_b128 v[40:43], v2 offset:12416
    v_cvt_f32_i32 v145, v145
    v_mfma_f32_16x16x32_bf16 v[176:179], v[28:31], a[196:199], v[176:179]
    s_sub_u32 s3, s29, s30
    v_exp_f32 v19, v127
    v_mfma_f32_16x16x32_bf16 v[180:183], v[24:27], a[216:219], v[132:135]
    v_cvt_pk_bf16_f32 v94, v16, v17
    v_add_f32 v8, v8, v18
    v_add_f32 v8, v8, v19
    v_cvt_pk_bf16_f32 v95, v18, v19
    v_mfma_f32_16x16x32_bf16 v[180:183], v[28:31], a[220:223], v[180:183]
    v_cvt_f32_i32 v149, v149
    v_mfma_f32_16x16x32_bf16 v[184:187], v[24:27], a[240:243], v[136:139]
    ds_read_b128 v[44:47], v3 offset:12416
    v_fma_f32 v145, v145, v48, v50
    v_mfma_f32_16x16x32_bf16 v[184:187], v[28:31], a[244:247], v[184:187]
    v_exp_f32 v16, v160
    v_mfma_f32_16x16x32_bf16 v[188:191], v[24:27], v[200:203], v[140:143]
    v_exp_f32 v17, v161
    v_mfma_f32_16x16x32_bf16 v[188:191], v[28:31], v[204:207], v[188:191]
    s_waitcnt lgkmcnt(2)
    v_exp_f32 v18, v162
    v_mfma_f32_16x16x32_bf16 v[112:115], v[32:35], a[192:195], v[128:131]
    ds_read_b128 v[24:27], v2 offset:18560
    v_add_f32 v5, v5, v16
    v_mfma_f32_16x16x32_bf16 v[112:115], v[36:39], a[196:199], v[112:115]
    s_mov_b32 s30, s29
    buffer_load_dwordx4 v4, s[4:7], s27 offen offset:1024 sc1 lds
    v_mfma_f32_16x16x32_bf16 v[116:119], v[32:35], a[216:219], v[132:135]
    v_add_f32 v5, v5, v17
    v_fma_f32 v149, v149, v49, v51
    v_mfma_f32_16x16x32_bf16 v[116:119], v[36:39], a[220:223], v[116:119]
    v_exp_f32 v19, v163
    v_mfma_f32_16x16x32_bf16 v[120:123], v[32:35], a[240:243], v[136:139]
    ds_read_b128 v[28:31], v3 offset:18560
    v_cvt_pk_bf16_f32 v160, v16, v17
    v_mfma_f32_16x16x32_bf16 v[120:123], v[36:39], a[244:247], v[120:123]
    v_exp_f32 v16, v96
    v_mfma_f32_16x16x32_bf16 v[124:127], v[32:35], v[200:203], v[140:143]
    v_add_f32 v5, v5, v18
    v_cvt_f32_i32 v146, v146
    v_mfma_f32_16x16x32_bf16 v[124:127], v[36:39], v[204:207], v[124:127]
    s_waitcnt lgkmcnt(2)
    v_add_f32 v5, v5, v19
    v_mfma_f32_16x16x32_bf16 v[176:179], v[40:43], a[200:203], v[176:179]
    ds_read_b128 v[32:35], v2 offset:12544
    v_cvt_f32_i32 v150, v150
    v_mfma_f32_16x16x32_bf16 v[176:179], v[44:47], a[204:207], v[176:179]
    buffer_load_dwordx4 v4, s[4:7], s27 offen offset:2048 sc1 lds
    v_mfma_f32_16x16x32_bf16 v[180:183], v[40:43], a[224:227], v[180:183]
    v_exp_f32 v17, v97
    v_mfma_f32_16x16x32_bf16 v[180:183], v[44:47], a[228:231], v[180:183]
    v_cvt_pk_bf16_f32 v161, v18, v19
    v_add_u32 v1, s3, v1
    v_mfma_f32_16x16x32_bf16 v[184:187], v[40:43], a[248:251], v[184:187]
    ds_read_b128 v[36:39], v3 offset:12544
    v_fma_f32 v146, v146, v48, v50
    v_mfma_f32_16x16x32_bf16 v[184:187], v[44:47], a[252:255], v[184:187]
    v_exp_f32 v18, v98
    v_mfma_f32_16x16x32_bf16 v[188:191], v[40:43], v[208:211], v[188:191]
    v_add_f32 v5, v5, v16
    v_add_f32 v5, v5, v17
    v_mfma_f32_16x16x32_bf16 v[188:191], v[44:47], v[212:215], v[188:191]
    s_waitcnt lgkmcnt(2)
    v_exp_f32 v19, v99
    v_mfma_f32_16x16x32_bf16 v[112:115], v[24:27], a[200:203], v[112:115]
    ds_read_b128 v[40:43], v2 offset:18688
    v_cvt_pk_bf16_f32 v162, v16, v17
    v_mfma_f32_16x16x32_bf16 v[112:115], v[28:31], a[204:207], v[112:115]
    v_exp_f32 v16, v164
    v_mfma_f32_16x16x32_bf16 v[116:119], v[24:27], a[224:227], v[116:119]
    v_add_f32 v5, v5, v18
    v_add_f32 v5, v5, v19
    v_mfma_f32_16x16x32_bf16 v[116:119], v[28:31], a[228:231], v[116:119]
    s_add_u32 s27, s27, 24576
    v_exp_f32 v17, v165
    v_mfma_f32_16x16x32_bf16 v[120:123], v[24:27], a[248:251], v[120:123]
    s_add_u32 s56, s56, 36864
    ds_read_b128 v[44:47], v3 offset:18688
    v_cvt_pk_bf16_f32 v163, v18, v19
    v_mfma_f32_16x16x32_bf16 v[120:123], v[28:31], a[252:255], v[120:123]
    s_waitcnt lgkmcnt(2)
    v_exp_f32 v18, v166
    v_mfma_f32_16x16x32_bf16 v[124:127], v[24:27], v[208:211], v[124:127]
    s_waitcnt vmcnt(12)
    v_fma_f32 v150, v150, v49, v51
    v_add_f32 v6, v6, v16
    v_mfma_f32_16x16x32_bf16 v[124:127], v[28:31], v[212:215], v[124:127]
    s_barrier
    v_add_f32 v6, v6, v17
    v_mfma_f32_16x16x32_bf16 v[176:179], v[32:35], a[208:211], v[176:179]
    s_sub_u32 s58, s56, 147456
    ds_read_b128 v[24:27], v1 offset:0
    v_cvt_f32_i32 v147, v147
    v_mfma_f32_16x16x32_bf16 v[176:179], v[36:39], a[212:215], v[176:179]
    v_exp_f32 v19, v167
    v_mfma_f32_16x16x32_bf16 v[180:183], v[32:35], a[232:235], v[180:183]
    s_min_u32 s56, s56, s58
    v_cvt_pk_bf16_f32 v164, v16, v17
    v_cvt_f32_i32 v151, v151
    v_mfma_f32_16x16x32_bf16 v[180:183], v[36:39], a[236:239], v[180:183]
    v_exp_f32 v16, v100
    v_mfma_f32_16x16x32_bf16 v[184:187], v[32:35], v[192:195], v[184:187]
    ds_read_b128 v[28:31], v1 offset:12288
    v_add_f32 v6, v6, v18
    v_mfma_f32_16x16x32_bf16 v[184:187], v[36:39], v[196:199], v[184:187]
    v_add_f32 v6, v6, v19
    v_fma_f32 v147, v147, v48, v50
    v_mfma_f32_16x16x32_bf16 v[188:191], v[32:35], v[216:219], v[188:191]
    v_exp_f32 v17, v101
    v_mfma_f32_16x16x32_bf16 v[188:191], v[36:39], v[220:223], v[188:191]
    s_waitcnt lgkmcnt(2)
    v_cvt_pk_bf16_f32 v165, v18, v19
    v_mfma_f32_16x16x32_bf16 v[112:115], v[40:43], a[208:211], v[112:115]
    ds_read_b128 v[32:35], v1 offset:1024
    v_mfma_f32_16x16x32_bf16 v[112:115], v[44:47], a[212:215], v[112:115]
    v_exp_f32 v18, v102
    v_mfma_f32_16x16x32_bf16 v[116:119], v[40:43], a[232:235], v[116:119]
    v_add_f32 v6, v6, v16
    v_add_f32 v6, v6, v17
    v_mfma_f32_16x16x32_bf16 v[116:119], v[44:47], a[236:239], v[116:119]
    v_exp_f32 v19, v103
    v_mfma_f32_16x16x32_bf16 v[120:123], v[40:43], v[192:195], v[120:123]
    ds_read_b128 v[36:39], v1 offset:13312
    v_fma_f32 v151, v151, v49, v51
    v_mfma_f32_16x16x32_bf16 v[120:123], v[44:47], v[196:199], v[120:123]
    v_cvt_pk_bf16_f32 v166, v16, v17
    v_add_f32 v6, v6, v18
    v_mfma_f32_16x16x32_bf16 v[124:127], v[40:43], v[216:219], v[124:127]
    v_add_f32 v6, v6, v19
    v_cvt_pk_bf16_f32 v167, v18, v19
    v_mfma_f32_16x16x32_bf16 v[124:127], v[44:47], v[220:223], v[124:127]
    s_waitcnt lgkmcnt(2)
    v_mfma_f32_16x16x32_bf16 a[0:3], v[24:27], v[64:67], a[0:3]
    ds_read_b128 v[40:43], v1 offset:2048
    v_lshlrev_b32 v48, 16, v57
    v_mfma_f32_16x16x32_bf16 a[0:3], v[28:31], v[80:83], a[0:3]
    buffer_store_dwordx4 v[224:227], v11, s[4:7], s33 offen offset:0 sc1
    v_mfma_f32_16x16x32_bf16 a[48:51], v[24:27], v[68:71], a[48:51]
    v_exp_f32 v16, v168
    v_mfma_f32_16x16x32_bf16 a[48:51], v[28:31], v[84:87], a[48:51]
    v_exp_f32 v17, v169
    v_mfma_f32_16x16x32_bf16 a[96:99], v[24:27], v[72:75], a[96:99]
    ds_read_b128 v[44:47], v1 offset:14336
    v_xor_b32 v55, 16, v11
    v_mfma_f32_16x16x32_bf16 a[96:99], v[28:31], v[88:91], a[96:99]
    v_exp_f32 v18, v170
    v_mfma_f32_16x16x32_bf16 a[144:147], v[24:27], v[76:79], a[144:147]
    v_add_f32 v7, v7, v16
    v_and_b32 v49, s97, v57
    v_mfma_f32_16x16x32_bf16 a[144:147], v[28:31], v[92:95], a[144:147]
    s_waitcnt lgkmcnt(2)
    v_add_f32 v7, v7, v17
    v_lshlrev_b32 v50, 16, v59
    v_mfma_f32_16x16x32_bf16 a[4:7], v[32:35], v[64:67], a[4:7]
    ds_read_b128 v[24:27], v1 offset:3072
    v_and_b32 v51, s97, v59
    v_mfma_f32_16x16x32_bf16 a[4:7], v[36:39], v[80:83], a[4:7]
    buffer_store_dwordx4 v[228:231], v55, s[4:7], s33 offen offset:768 sc1
    v_mfma_f32_16x16x32_bf16 a[52:55], v[32:35], v[68:71], a[52:55]
    v_exp_f32 v19, v171
    v_mfma_f32_16x16x32_bf16 a[52:55], v[36:39], v[84:87], a[52:55]
    v_cvt_pk_bf16_f32 v168, v16, v17
    v_mul_f32_e64 v50, -v50, v48
    v_mfma_f32_16x16x32_bf16 a[100:103], v[32:35], v[72:75], a[100:103]
    ds_read_b128 v[28:31], v1 offset:15360
    v_xor_b32 v54, 32, v11
    v_mfma_f32_16x16x32_bf16 a[100:103], v[36:39], v[88:91], a[100:103]
    v_exp_f32 v16, v104
    v_mfma_f32_16x16x32_bf16 a[148:151], v[32:35], v[76:79], a[148:151]
    v_add_f32 v7, v7, v18
    v_add_f32 v7, v7, v19
    v_mfma_f32_16x16x32_bf16 a[148:151], v[36:39], v[92:95], a[148:151]
    s_waitcnt lgkmcnt(2)
    v_exp_f32 v17, v105
    v_mfma_f32_16x16x32_bf16 a[8:11], v[40:43], v[64:67], a[8:11]
    ds_read_b128 v[32:35], v1 offset:4096
    v_cvt_pk_bf16_f32 v169, v18, v19
    v_mfma_f32_16x16x32_bf16 a[8:11], v[44:47], v[80:83], a[8:11]
    buffer_store_dwordx4 v[232:235], v54, s[4:7], s33 offen offset:1536 sc1
    v_mfma_f32_16x16x32_bf16 a[56:59], v[40:43], v[68:71], a[56:59]
    v_exp_f32 v18, v106
    v_mfma_f32_16x16x32_bf16 a[56:59], v[44:47], v[84:87], a[56:59]
    v_add_f32 v7, v7, v16
    v_add_f32 v7, v7, v17
    v_mfma_f32_16x16x32_bf16 a[104:107], v[40:43], v[72:75], a[104:107]
    ds_read_b128 v[36:39], v1 offset:16384
    v_mul_f32_e64 v51, -v51, v49
    v_mfma_f32_16x16x32_bf16 a[104:107], v[44:47], v[88:91], a[104:107]
    v_exp_f32 v19, v107
    v_mfma_f32_16x16x32_bf16 a[152:155], v[40:43], v[76:79], a[152:155]
    v_xor_b32 v55, 48, v11
    v_cvt_pk_bf16_f32 v170, v16, v17
    v_mfma_f32_16x16x32_bf16 a[152:155], v[44:47], v[92:95], a[152:155]
    s_waitcnt lgkmcnt(2)
    v_exp_f32 v16, v172
    v_mfma_f32_16x16x32_bf16 a[12:15], v[24:27], v[64:67], a[12:15]
    ds_read_b128 v[40:43], v1 offset:5120
    v_add_f32 v7, v7, v18
    v_mfma_f32_16x16x32_bf16 a[12:15], v[28:31], v[80:83], a[12:15]
    buffer_store_dwordx4 v[236:239], v55, s[4:7], s33 offen offset:2304 sc1
    v_mfma_f32_16x16x32_bf16 a[60:63], v[24:27], v[68:71], a[60:63]
    v_add_f32 v7, v7, v19
    v_cvt_f32_i32 v152, v152
    v_mfma_f32_16x16x32_bf16 a[60:63], v[28:31], v[84:87], a[60:63]
    v_exp_f32 v17, v173
    v_mfma_f32_16x16x32_bf16 a[108:111], v[24:27], v[72:75], a[108:111]
    ds_read_b128 v[44:47], v1 offset:17408
    v_cvt_pk_bf16_f32 v171, v18, v19
    v_mfma_f32_16x16x32_bf16 a[108:111], v[28:31], v[88:91], a[108:111]
    v_exp_f32 v18, v174
    v_mfma_f32_16x16x32_bf16 a[156:159], v[24:27], v[76:79], a[156:159]
    s_add_u32 s29, s28, 49152
    v_cvt_f32_i32 v156, v156
    v_add_f32 v8, v8, v16
    v_mfma_f32_16x16x32_bf16 a[156:159], v[28:31], v[92:95], a[156:159]
    s_waitcnt lgkmcnt(2)
    v_add_f32 v8, v8, v17
    v_fma_f32 v152, v152, v48, v50
    v_mfma_f32_16x16x32_bf16 a[16:19], v[32:35], v[64:67], a[16:19]
    ds_read_b128 v[24:27], v1 offset:6144
    v_fma_f32 v156, v156, v49, v51
    v_mfma_f32_16x16x32_bf16 a[16:19], v[36:39], v[80:83], a[16:19]
    s_mov_b32 m0, s26
    v_exp_f32 v19, v175
    v_mfma_f32_16x16x32_bf16 a[64:67], v[32:35], v[68:71], a[64:67]
    s_sub_u32 s3, s29, 147456
    v_cvt_pk_bf16_f32 v172, v16, v17
    v_cvt_f32_i32 v153, v153
    v_mfma_f32_16x16x32_bf16 a[64:67], v[36:39], v[84:87], a[64:67]
    buffer_load_dwordx4 v4, s[4:7], s32 offen offset:0 sc1 lds
    v_mfma_f32_16x16x32_bf16 a[112:115], v[32:35], v[72:75], a[112:115]
    ds_read_b128 v[28:31], v1 offset:18432
    v_cvt_f32_i32 v157, v157
    v_mfma_f32_16x16x32_bf16 a[112:115], v[36:39], v[88:91], a[112:115]
    v_exp_f32 v16, v108
    v_mfma_f32_16x16x32_bf16 a[160:163], v[32:35], v[76:79], a[160:163]
    v_add_f32 v8, v8, v18
    v_add_f32 v8, v8, v19
    v_mfma_f32_16x16x32_bf16 a[160:163], v[36:39], v[92:95], a[160:163]
    s_waitcnt lgkmcnt(2)
    v_exp_f32 v17, v109
    v_mfma_f32_16x16x32_bf16 a[20:23], v[40:43], v[64:67], a[20:23]
    s_min_u32 s29, s29, s3
    ds_read_b128 v[32:35], v1 offset:7168
    v_cvt_pk_bf16_f32 v173, v18, v19
    v_mfma_f32_16x16x32_bf16 a[20:23], v[44:47], v[80:83], a[20:23]
    buffer_load_dwordx4 v4, s[4:7], s32 offen offset:1024 sc1 lds
    v_mfma_f32_16x16x32_bf16 a[68:71], v[40:43], v[68:71], a[68:71]
    v_exp_f32 v18, v110
    v_mfma_f32_16x16x32_bf16 a[68:71], v[44:47], v[84:87], a[68:71]
    v_add_f32 v8, v8, v16
    v_add_f32 v8, v8, v17
    v_mfma_f32_16x16x32_bf16 a[116:119], v[40:43], v[72:75], a[116:119]
    ds_read_b128 v[36:39], v1 offset:19456
    v_fma_f32 v153, v153, v48, v50
    v_mfma_f32_16x16x32_bf16 a[116:119], v[44:47], v[88:91], a[116:119]
    v_exp_f32 v19, v111
    v_mfma_f32_16x16x32_bf16 a[164:167], v[40:43], v[76:79], a[164:167]
    s_sub_u32 s3, s29, s28
    v_cvt_pk_bf16_f32 v174, v16, v17
    v_add_f32 v8, v8, v18
    v_mfma_f32_16x16x32_bf16 a[164:167], v[44:47], v[92:95], a[164:167]
    s_waitcnt lgkmcnt(2)
    buffer_load_dwordx4 v4, s[4:7], s32 offen offset:2048 sc1 lds
    v_mfma_f32_16x16x32_bf16 a[24:27], v[24:27], v[64:67], a[24:27]
    ds_read_b128 v[40:43], v1 offset:8192
    v_add_f32 v8, v8, v19
    v_mfma_f32_16x16x32_bf16 a[24:27], v[28:31], v[80:83], a[24:27]
    v_cvt_pk_bf16_f32 v175, v18, v19
    v_fma_f32 v157, v157, v49, v51
    v_mfma_f32_16x16x32_bf16 a[72:75], v[24:27], v[68:71], a[72:75]
    s_add_u32 s32, s32, 24576
    v_exp_f32 v16, v176
    v_mfma_f32_16x16x32_bf16 a[72:75], v[28:31], v[84:87], a[72:75]
    v_exp_f32 v17, v177
    v_mfma_f32_16x16x32_bf16 a[120:123], v[24:27], v[72:75], a[120:123]
    s_add_u32 s26, s26, 12288
    ds_read_b128 v[44:47], v1 offset:20480
    v_cvt_f32_i32 v154, v154
    v_mfma_f32_16x16x32_bf16 a[120:123], v[28:31], v[88:91], a[120:123]
    s_mov_b32 s28, s29
    v_exp_f32 v18, v178
    v_mfma_f32_16x16x32_bf16 a[168:171], v[24:27], v[76:79], a[168:171]
    v_cvt_f32_i32 v158, v158
    v_add_f32 v5, v5, v16
    v_mfma_f32_16x16x32_bf16 a[168:171], v[28:31], v[92:95], a[168:171]
    s_waitcnt lgkmcnt(2)
    v_add_f32 v5, v5, v17
    v_fma_f32 v154, v154, v48, v50
    v_mfma_f32_16x16x32_bf16 a[28:31], v[32:35], v[64:67], a[28:31]
    s_mov_b32 m0, s26
    ds_read_b128 v[24:27], v1 offset:9216
    v_fma_f32 v158, v158, v49, v51
    v_mfma_f32_16x16x32_bf16 a[28:31], v[36:39], v[80:83], a[28:31]
    v_exp_f32 v19, v179
    v_mfma_f32_16x16x32_bf16 a[76:79], v[32:35], v[68:71], a[76:79]
    v_cvt_pk_bf16_f32 v176, v16, v17
    v_cvt_f32_i32 v155, v155
    v_mfma_f32_16x16x32_bf16 a[76:79], v[36:39], v[84:87], a[76:79]
    buffer_load_dwordx4 v4, s[4:7], s32 offen offset:0 sc1 lds
    v_mfma_f32_16x16x32_bf16 a[124:127], v[32:35], v[72:75], a[124:127]
    ds_read_b128 v[28:31], v1 offset:21504
    v_cvt_f32_i32 v159, v159
    v_mfma_f32_16x16x32_bf16 a[124:127], v[36:39], v[88:91], a[124:127]
    v_exp_f32 v16, v112
    v_mfma_f32_16x16x32_bf16 a[172:175], v[32:35], v[76:79], a[172:175]
    v_add_f32 v5, v5, v18
    v_add_f32 v5, v5, v19
    v_mfma_f32_16x16x32_bf16 a[172:175], v[36:39], v[92:95], a[172:175]
    s_waitcnt lgkmcnt(2)
    v_exp_f32 v17, v113
    v_mfma_f32_16x16x32_bf16 a[32:35], v[40:43], v[64:67], a[32:35]
    ds_read_b128 v[32:35], v1 offset:10240
    v_cvt_pk_bf16_f32 v177, v18, v19
    v_mfma_f32_16x16x32_bf16 a[32:35], v[44:47], v[80:83], a[32:35]
    buffer_load_dwordx4 v4, s[4:7], s32 offen offset:1024 sc1 lds
    v_mfma_f32_16x16x32_bf16 a[80:83], v[40:43], v[68:71], a[80:83]
    v_exp_f32 v18, v114
    v_mfma_f32_16x16x32_bf16 a[80:83], v[44:47], v[84:87], a[80:83]
    v_add_f32 v5, v5, v16
    v_add_f32 v5, v5, v17
    v_mfma_f32_16x16x32_bf16 a[128:131], v[40:43], v[72:75], a[128:131]
    ds_read_b128 v[36:39], v1 offset:22528
    v_fma_f32 v155, v155, v48, v50
    v_mfma_f32_16x16x32_bf16 a[128:131], v[44:47], v[88:91], a[128:131]
    buffer_load_dwordx4 v4, s[4:7], s32 offen offset:2048 sc1 lds
    v_mfma_f32_16x16x32_bf16 a[176:179], v[40:43], v[76:79], a[176:179]
    v_exp_f32 v19, v115
    v_mfma_f32_16x16x32_bf16 a[176:179], v[44:47], v[92:95], a[176:179]
    s_waitcnt lgkmcnt(2)
    v_cvt_pk_bf16_f32 v178, v16, v17
    v_add_u32 v2, s3, v2
    v_mfma_f32_16x16x32_bf16 a[36:39], v[24:27], v[64:67], a[36:39]
    ds_read_b128 v[40:43], v1 offset:11264
    v_fma_f32 v159, v159, v49, v51
    v_mfma_f32_16x16x32_bf16 a[36:39], v[28:31], v[80:83], a[36:39]
    v_exp_f32 v16, v180
    v_mfma_f32_16x16x32_bf16 a[84:87], v[24:27], v[68:71], a[84:87]
    v_add_f32 v5, v5, v18
    v_add_f32 v5, v5, v19
    v_mfma_f32_16x16x32_bf16 a[84:87], v[28:31], v[84:87], a[84:87]
    s_add_u32 s32, s32, 24576
    v_exp_f32 v17, v181
    v_mfma_f32_16x16x32_bf16 a[132:135], v[24:27], v[72:75], a[132:135]
    s_add_u32 s26, s26, 36864
    ds_read_b128 v[44:47], v1 offset:23552
    v_add_u32 v3, s3, v3
    v_mfma_f32_16x16x32_bf16 a[132:135], v[28:31], v[88:91], a[132:135]
    s_waitcnt lgkmcnt(2)
    v_cvt_pk_bf16_f32 v179, v18, v19
    v_cvt_pk_bf16_f32 v144, v144, v148
    v_mfma_f32_16x16x32_bf16 a[180:183], v[24:27], v[76:79], a[180:183]
    s_waitcnt vmcnt(6)
    v_exp_f32 v18, v182
    v_mfma_f32_16x16x32_bf16 a[180:183], v[28:31], v[92:95], a[180:183]
    s_barrier
    v_add_f32 v6, v6, v16
    v_mfma_f32_16x16x32_bf16 a[40:43], v[32:35], v[64:67], a[40:43]
    s_sub_u32 s57, s26, 147456
    ds_read_b128 v[24:27], v2 offset:0
    v_add_f32 v6, v6, v17
    v_mfma_f32_16x16x32_bf16 a[40:43], v[36:39], v[80:83], a[40:43]
    v_exp_f32 v19, v183
    v_mfma_f32_16x16x32_bf16 a[88:91], v[32:35], v[68:71], a[88:91]
    s_min_u32 s26, s26, s57
    v_cvt_pk_bf16_f32 v148, v145, v149
    v_cvt_pk_bf16_f32 v180, v16, v17
    v_mfma_f32_16x16x32_bf16 a[88:91], v[36:39], v[84:87], a[88:91]
    v_exp_f32 v16, v116
    v_mfma_f32_16x16x32_bf16 a[136:139], v[32:35], v[72:75], a[136:139]
    ds_read_b128 v[28:31], v3 offset:0
    v_cvt_pk_bf16_f32 v145, v152, v156
    v_mfma_f32_16x16x32_bf16 a[136:139], v[36:39], v[88:91], a[136:139]
    v_add_f32 v6, v6, v18
    v_add_f32 v6, v6, v19
    v_mfma_f32_16x16x32_bf16 a[184:187], v[32:35], v[76:79], a[184:187]
    v_exp_f32 v17, v117
    v_mfma_f32_16x16x32_bf16 a[184:187], v[36:39], v[92:95], a[184:187]
    s_waitcnt lgkmcnt(2)
    v_cvt_pk_bf16_f32 v149, v153, v157
    v_add_u32 v0, 1, v0
    v_mfma_f32_16x16x32_bf16 a[44:47], v[40:43], v[64:67], a[44:47]
    ds_read_b128 v[32:35], v2 offset:6144
    v_cvt_pk_bf16_f32 v181, v18, v19
    v_mfma_f32_16x16x32_bf16 a[44:47], v[44:47], v[80:83], a[44:47]
    buffer_store_dword v0, v13, s[20:23], 0 offen offset:32 sc1
    v_mfma_f32_16x16x32_bf16 a[92:95], v[40:43], v[68:71], a[92:95]
    v_exp_f32 v18, v118
    v_mfma_f32_16x16x32_bf16 a[92:95], v[44:47], v[84:87], a[92:95]
    v_add_f32 v6, v6, v16
    v_cvt_pk_bf16_f32 v152, v146, v150
    v_mfma_f32_16x16x32_bf16 a[140:143], v[40:43], v[72:75], a[140:143]
    ds_read_b128 v[36:39], v3 offset:6144
    v_add_f32 v6, v6, v17
    v_mfma_f32_16x16x32_bf16 a[140:143], v[44:47], v[88:91], a[140:143]
    v_exp_f32 v19, v119
    v_mfma_f32_16x16x32_bf16 a[188:191], v[40:43], v[76:79], a[188:191]
    v_cvt_pk_bf16_f32 v182, v16, v17
    v_cvt_pk_bf16_f32 v153, v154, v158
    v_mfma_f32_16x16x32_bf16 a[188:191], v[44:47], v[92:95], a[188:191]
    s_waitcnt lgkmcnt(2)
    v_add_f32 v6, v6, v18
    v_add_f32 v6, v6, v19
    v_cvt_pk_bf16_f32 v156, v147, v151
    v_cvt_pk_bf16_f32 v183, v18, v19
    v_cvt_pk_bf16_f32 v157, v155, v159
    v_mfma_f32_16x16x32_bf16 v[64:67], v[24:27], a[192:195], v[128:131]
    s_add_u32 s33, s33, 196608
    ds_read_b128 v[40:43], v2 offset:128
    s_mov_b32 m0, s56
    v_mfma_f32_16x16x32_bf16 v[64:67], v[28:31], a[196:199], v[64:67]
    s_waitcnt vmcnt(14)
    v_exp_f32 v16, v184
    v_mfma_f32_16x16x32_bf16 v[68:71], v[24:27], a[216:219], v[132:135]
    s_add_u32 s34, s34, 196608
    v_exp_f32 v17, v185
    v_mfma_f32_16x16x32_bf16 v[68:71], v[28:31], a[220:223], v[68:71]
    v_exp_f32 v18, v186
    v_mfma_f32_16x16x32_bf16 v[72:75], v[24:27], a[240:243], v[136:139]
    s_add_u32 s36, s36, 1536
    ds_read_b128 v[44:47], v3 offset:128
    v_lshlrev_b32 v48, 16, v60
    v_mfma_f32_16x16x32_bf16 v[72:75], v[28:31], a[244:247], v[72:75]
    buffer_load_dwordx4 v4, s[4:7], s27 offen offset:0 sc1 lds
    v_mfma_f32_16x16x32_bf16 v[76:79], v[24:27], v[200:203], v[140:143]
    v_add_f32 v7, v7, v16
    v_add_f32 v7, v7, v17
    v_mfma_f32_16x16x32_bf16 v[76:79], v[28:31], v[204:207], v[76:79]
    s_waitcnt lgkmcnt(2)
    v_exp_f32 v19, v187
    v_mfma_f32_16x16x32_bf16 v[96:99], v[32:35], a[192:195], v[128:131]
    ds_read_b128 v[24:27], v2 offset:6272
    v_and_b32 v49, s97, v60
    v_mfma_f32_16x16x32_bf16 v[96:99], v[36:39], a[196:199], v[96:99]
    buffer_load_dwordx2 v[56:57], v10, s[72:75], s36 offen offset:0
    v_mfma_f32_16x16x32_bf16 v[100:103], v[32:35], a[216:219], v[132:135]
    v_cvt_pk_bf16_f32 v184, v16, v17
    v_lshlrev_b32 v50, 16, v62
    v_mfma_f32_16x16x32_bf16 v[100:103], v[36:39], a[220:223], v[100:103]
    v_exp_f32 v16, v120
    v_mfma_f32_16x16x32_bf16 v[104:107], v[32:35], a[240:243], v[136:139]
    ds_read_b128 v[28:31], v3 offset:6272
    v_add_f32 v7, v7, v18
    v_mfma_f32_16x16x32_bf16 v[104:107], v[36:39], a[244:247], v[104:107]
    v_add_f32 v7, v7, v19
    v_mfma_f32_16x16x32_bf16 v[108:111], v[32:35], v[200:203], v[140:143]
    v_exp_f32 v17, v121
    v_mfma_f32_16x16x32_bf16 v[108:111], v[36:39], v[204:207], v[108:111]
    s_waitcnt lgkmcnt(2)
    buffer_load_dwordx2 v[58:59], v10, s[76:79], s36 offen offset:0
    v_mfma_f32_16x16x32_bf16 v[64:67], v[40:43], a[200:203], v[64:67]
    ds_read_b128 v[32:35], v2 offset:256
    v_cvt_pk_bf16_f32 v185, v18, v19
    v_mfma_f32_16x16x32_bf16 v[64:67], v[44:47], a[204:207], v[64:67]
    v_exp_f32 v18, v122
    v_mfma_f32_16x16x32_bf16 v[68:71], v[40:43], a[224:227], v[68:71]
    v_add_f32 v7, v7, v16
    v_and_b32 v51, s97, v62
    v_mfma_f32_16x16x32_bf16 v[68:71], v[44:47], a[228:231], v[68:71]
    buffer_load_dwordx4 v4, s[4:7], s27 offen offset:1024 sc1 lds
    v_mfma_f32_16x16x32_bf16 v[72:75], v[40:43], a[248:251], v[72:75]
    ds_read_b128 v[36:39], v3 offset:256
    v_add_f32 v7, v7, v17
    v_mfma_f32_16x16x32_bf16 v[72:75], v[44:47], a[252:255], v[72:75]
    v_exp_f32 v19, v123
    v_mfma_f32_16x16x32_bf16 v[76:79], v[40:43], v[208:211], v[76:79]
    v_cvt_pk_bf16_f32 v186, v16, v17
    v_mul_f32_e64 v50, -v50, v48
    v_mfma_f32_16x16x32_bf16 v[76:79], v[44:47], v[212:215], v[76:79]
    s_waitcnt lgkmcnt(2)
    buffer_load_dwordx4 v[224:227], v9, s[64:67], s33 offen offset:0 nt
    v_mfma_f32_16x16x32_bf16 v[96:99], v[24:27], a[200:203], v[96:99]
    ds_read_b128 v[40:43], v2 offset:6400
    v_mul_f32_e64 v51, -v51, v49
    v_mfma_f32_16x16x32_bf16 v[96:99], v[28:31], a[204:207], v[96:99]
    v_exp_f32 v16, v188
    v_mfma_f32_16x16x32_bf16 v[100:103], v[24:27], a[224:227], v[100:103]
    v_add_f32 v7, v7, v18
    v_add_f32 v7, v7, v19
    v_mfma_f32_16x16x32_bf16 v[100:103], v[28:31], a[228:231], v[100:103]
    buffer_load_dwordx4 v4, s[4:7], s27 offen offset:2048 sc1 lds
    v_mfma_f32_16x16x32_bf16 v[104:107], v[24:27], a[248:251], v[104:107]
    ds_read_b128 v[44:47], v3 offset:6400
    v_cvt_f32_i32 v240, v240
    v_mfma_f32_16x16x32_bf16 v[104:107], v[28:31], a[252:255], v[104:107]
    v_exp_f32 v17, v189
    v_mfma_f32_16x16x32_bf16 v[108:111], v[24:27], v[208:211], v[108:111]
    s_add_u32 s29, s30, 49152
    v_cvt_pk_bf16_f32 v187, v18, v19
    s_add_u32 s27, s27, 24576
    v_mfma_f32_16x16x32_bf16 v[108:111], v[28:31], v[212:215], v[108:111]
    s_waitcnt lgkmcnt(2)
    buffer_load_dwordx4 v[228:231], v9, s[64:67], s33 offen offset:1536 nt
    v_mfma_f32_16x16x32_bf16 v[64:67], v[32:35], a[208:211], v[64:67]
    ds_read_b128 v[24:27], v2 offset:12288
    v_cvt_f32_i32 v244, v244
    v_mfma_f32_16x16x32_bf16 v[64:67], v[36:39], a[212:215], v[64:67]
    s_sub_u32 s3, s29, 147456
    v_exp_f32 v18, v190
    v_mfma_f32_16x16x32_bf16 v[68:71], v[32:35], a[232:235], v[68:71]
    v_add_f32 v8, v8, v16
    v_add_f32 v8, v8, v17
    v_mfma_f32_16x16x32_bf16 v[68:71], v[36:39], a[236:239], v[68:71]
    s_add_u32 s56, s56, 12288
    buffer_load_dwordx4 v[232:235], v9, s[64:67], s34 offen offset:0 nt
    v_mfma_f32_16x16x32_bf16 v[72:75], v[32:35], v[192:195], v[72:75]
    ds_read_b128 v[28:31], v3 offset:12288
    v_fma_f32 v240, v240, v48, v50
    v_mfma_f32_16x16x32_bf16 v[72:75], v[36:39], v[196:199], v[72:75]
    v_exp_f32 v19, v191
    v_mfma_f32_16x16x32_bf16 v[76:79], v[32:35], v[216:219], v[76:79]
    v_cvt_pk_bf16_f32 v188, v16, v17
    v_mfma_f32_16x16x32_bf16 v[76:79], v[36:39], v[220:223], v[76:79]
    s_waitcnt lgkmcnt(2)
    buffer_load_dwordx4 v[236:239], v9, s[64:67], s34 offen offset:1536 nt
    v_mfma_f32_16x16x32_bf16 v[96:99], v[40:43], a[208:211], v[96:99]
    s_mov_b32 m0, s56
    ds_read_b128 v[32:35], v2 offset:18432
    v_fma_f32 v244, v244, v49, v51
    v_mfma_f32_16x16x32_bf16 v[96:99], v[44:47], a[212:215], v[96:99]
    s_min_u32 s29, s29, s3
    v_exp_f32 v16, v124
    v_mfma_f32_16x16x32_bf16 v[100:103], v[40:43], a[232:235], v[100:103]
    v_add_f32 v8, v8, v18
    v_add_f32 v8, v8, v19
    v_mfma_f32_16x16x32_bf16 v[100:103], v[44:47], a[236:239], v[100:103]
    v_exp_f32 v17, v125
    v_mfma_f32_16x16x32_bf16 v[104:107], v[40:43], v[192:195], v[104:107]
    ds_read_b128 v[36:39], v3 offset:18432
    v_cvt_pk_bf16_f32 v189, v18, v19
    v_mfma_f32_16x16x32_bf16 v[104:107], v[44:47], v[196:199], v[104:107]
    v_exp_f32 v18, v126
    v_mfma_f32_16x16x32_bf16 v[108:111], v[40:43], v[216:219], v[108:111]
    v_add_f32 v8, v8, v16
    v_add_f32 v8, v8, v17
    v_mfma_f32_16x16x32_bf16 v[108:111], v[44:47], v[220:223], v[108:111]
    s_waitcnt lgkmcnt(2)
    buffer_load_dwordx4 v4, s[4:7], s27 offen offset:0 sc1 lds
    v_mfma_f32_16x16x32_bf16 v[80:83], v[24:27], a[192:195], v[128:131]
    ds_read_b128 v[40:43], v2 offset:12416
    v_cvt_f32_i32 v241, v241
    v_mfma_f32_16x16x32_bf16 v[80:83], v[28:31], a[196:199], v[80:83]
    s_sub_u32 s3, s29, s30
    v_exp_f32 v19, v127
    v_mfma_f32_16x16x32_bf16 v[84:87], v[24:27], a[216:219], v[132:135]
    v_cvt_pk_bf16_f32 v190, v16, v17
    v_add_f32 v8, v8, v18
    v_add_f32 v8, v8, v19
    v_cvt_pk_bf16_f32 v191, v18, v19
    v_mfma_f32_16x16x32_bf16 v[84:87], v[28:31], a[220:223], v[84:87]
    v_cvt_f32_i32 v245, v245
    v_mfma_f32_16x16x32_bf16 v[88:91], v[24:27], a[240:243], v[136:139]
    ds_read_b128 v[44:47], v3 offset:12416
    v_fma_f32 v241, v241, v48, v50
    v_mfma_f32_16x16x32_bf16 v[88:91], v[28:31], a[244:247], v[88:91]
    v_exp_f32 v16, v64
    v_mfma_f32_16x16x32_bf16 v[92:95], v[24:27], v[200:203], v[140:143]
    v_exp_f32 v17, v65
    v_mfma_f32_16x16x32_bf16 v[92:95], v[28:31], v[204:207], v[92:95]
    s_waitcnt lgkmcnt(2)
    v_exp_f32 v18, v66
    v_mfma_f32_16x16x32_bf16 v[112:115], v[32:35], a[192:195], v[128:131]
    ds_read_b128 v[24:27], v2 offset:18560
    v_add_f32 v5, v5, v16
    v_mfma_f32_16x16x32_bf16 v[112:115], v[36:39], a[196:199], v[112:115]
    s_mov_b32 s30, s29
    buffer_load_dwordx4 v4, s[4:7], s27 offen offset:1024 sc1 lds
    v_mfma_f32_16x16x32_bf16 v[116:119], v[32:35], a[216:219], v[132:135]
    v_add_f32 v5, v5, v17
    v_fma_f32 v245, v245, v49, v51
    v_mfma_f32_16x16x32_bf16 v[116:119], v[36:39], a[220:223], v[116:119]
    v_exp_f32 v19, v67
    v_mfma_f32_16x16x32_bf16 v[120:123], v[32:35], a[240:243], v[136:139]
    ds_read_b128 v[28:31], v3 offset:18560
    v_cvt_pk_bf16_f32 v64, v16, v17
    v_mfma_f32_16x16x32_bf16 v[120:123], v[36:39], a[244:247], v[120:123]
    v_exp_f32 v16, v96
    v_mfma_f32_16x16x32_bf16 v[124:127], v[32:35], v[200:203], v[140:143]
    v_add_f32 v5, v5, v18
    v_cvt_f32_i32 v242, v242
    v_mfma_f32_16x16x32_bf16 v[124:127], v[36:39], v[204:207], v[124:127]
    s_waitcnt lgkmcnt(2)
    v_add_f32 v5, v5, v19
    v_mfma_f32_16x16x32_bf16 v[80:83], v[40:43], a[200:203], v[80:83]
    ds_read_b128 v[32:35], v2 offset:12544
    v_cvt_f32_i32 v246, v246
    v_mfma_f32_16x16x32_bf16 v[80:83], v[44:47], a[204:207], v[80:83]
    buffer_load_dwordx4 v4, s[4:7], s27 offen offset:2048 sc1 lds
    v_mfma_f32_16x16x32_bf16 v[84:87], v[40:43], a[224:227], v[84:87]
    v_exp_f32 v17, v97
    v_mfma_f32_16x16x32_bf16 v[84:87], v[44:47], a[228:231], v[84:87]
    v_cvt_pk_bf16_f32 v65, v18, v19
    v_add_u32 v1, s3, v1
    v_mfma_f32_16x16x32_bf16 v[88:91], v[40:43], a[248:251], v[88:91]
    ds_read_b128 v[36:39], v3 offset:12544
    v_fma_f32 v242, v242, v48, v50
    v_mfma_f32_16x16x32_bf16 v[88:91], v[44:47], a[252:255], v[88:91]
    v_exp_f32 v18, v98
    v_mfma_f32_16x16x32_bf16 v[92:95], v[40:43], v[208:211], v[92:95]
    v_add_f32 v5, v5, v16
    v_add_f32 v5, v5, v17
    v_mfma_f32_16x16x32_bf16 v[92:95], v[44:47], v[212:215], v[92:95]
    s_waitcnt lgkmcnt(2)
    v_exp_f32 v19, v99
    v_mfma_f32_16x16x32_bf16 v[112:115], v[24:27], a[200:203], v[112:115]
    ds_read_b128 v[40:43], v2 offset:18688
    v_cvt_pk_bf16_f32 v66, v16, v17
    v_mfma_f32_16x16x32_bf16 v[112:115], v[28:31], a[204:207], v[112:115]
    v_exp_f32 v16, v68
    v_mfma_f32_16x16x32_bf16 v[116:119], v[24:27], a[224:227], v[116:119]
    v_add_f32 v5, v5, v18
    v_add_f32 v5, v5, v19
    v_mfma_f32_16x16x32_bf16 v[116:119], v[28:31], a[228:231], v[116:119]
    s_add_u32 s27, s27, 24576
    v_exp_f32 v17, v69
    v_mfma_f32_16x16x32_bf16 v[120:123], v[24:27], a[248:251], v[120:123]
    s_add_u32 s56, s56, 36864
    ds_read_b128 v[44:47], v3 offset:18688
    v_cvt_pk_bf16_f32 v67, v18, v19
    v_mfma_f32_16x16x32_bf16 v[120:123], v[28:31], a[252:255], v[120:123]
    s_waitcnt lgkmcnt(2)
    v_exp_f32 v18, v70
    v_mfma_f32_16x16x32_bf16 v[124:127], v[24:27], v[208:211], v[124:127]
    s_waitcnt vmcnt(23)
    v_fma_f32 v246, v246, v49, v51
    v_add_f32 v6, v6, v16
    v_mfma_f32_16x16x32_bf16 v[124:127], v[28:31], v[212:215], v[124:127]
    s_barrier
    v_add_f32 v6, v6, v17
    v_mfma_f32_16x16x32_bf16 v[80:83], v[32:35], a[208:211], v[80:83]
    s_sub_u32 s58, s56, 147456
    ds_read_b128 v[24:27], v1 offset:0
    v_cvt_f32_i32 v243, v243
    v_mfma_f32_16x16x32_bf16 v[80:83], v[36:39], a[212:215], v[80:83]
    v_exp_f32 v19, v71
    v_mfma_f32_16x16x32_bf16 v[84:87], v[32:35], a[232:235], v[84:87]
    s_min_u32 s56, s56, s58
    v_cvt_pk_bf16_f32 v68, v16, v17
    v_cvt_f32_i32 v247, v247
    v_mfma_f32_16x16x32_bf16 v[84:87], v[36:39], a[236:239], v[84:87]
    v_exp_f32 v16, v100
    v_mfma_f32_16x16x32_bf16 v[88:91], v[32:35], v[192:195], v[88:91]
    ds_read_b128 v[28:31], v1 offset:12288
    v_add_f32 v6, v6, v18
    v_mfma_f32_16x16x32_bf16 v[88:91], v[36:39], v[196:199], v[88:91]
    v_add_f32 v6, v6, v19
    v_fma_f32 v243, v243, v48, v50
    v_mfma_f32_16x16x32_bf16 v[92:95], v[32:35], v[216:219], v[92:95]
    v_exp_f32 v17, v101
    v_mfma_f32_16x16x32_bf16 v[92:95], v[36:39], v[220:223], v[92:95]
    s_waitcnt lgkmcnt(2)
    v_cvt_pk_bf16_f32 v69, v18, v19
    v_mfma_f32_16x16x32_bf16 v[112:115], v[40:43], a[208:211], v[112:115]
    ds_read_b128 v[32:35], v1 offset:1024
    v_mfma_f32_16x16x32_bf16 v[112:115], v[44:47], a[212:215], v[112:115]
    v_exp_f32 v18, v102
    v_mfma_f32_16x16x32_bf16 v[116:119], v[40:43], a[232:235], v[116:119]
    v_add_f32 v6, v6, v16
    v_add_f32 v6, v6, v17
    v_mfma_f32_16x16x32_bf16 v[116:119], v[44:47], a[236:239], v[116:119]
    v_exp_f32 v19, v103
    v_mfma_f32_16x16x32_bf16 v[120:123], v[40:43], v[192:195], v[120:123]
    ds_read_b128 v[36:39], v1 offset:13312
    v_fma_f32 v247, v247, v49, v51
    v_mfma_f32_16x16x32_bf16 v[120:123], v[44:47], v[196:199], v[120:123]
    v_cvt_pk_bf16_f32 v70, v16, v17
    v_add_f32 v6, v6, v18
    v_mfma_f32_16x16x32_bf16 v[124:127], v[40:43], v[216:219], v[124:127]
    v_add_f32 v6, v6, v19
    v_cvt_pk_bf16_f32 v71, v18, v19
    v_mfma_f32_16x16x32_bf16 v[124:127], v[44:47], v[220:223], v[124:127]
    s_waitcnt lgkmcnt(2)
    v_mfma_f32_16x16x32_bf16 a[0:3], v[24:27], v[160:163], a[0:3]
    s_mov_b32 m0, s56
    ds_read_b128 v[40:43], v1 offset:2048
    v_lshlrev_b32 v48, 16, v61
    v_mfma_f32_16x16x32_bf16 a[0:3], v[28:31], v[176:179], a[0:3]
    v_exp_f32 v16, v72
    v_mfma_f32_16x16x32_bf16 a[48:51], v[24:27], v[164:167], a[48:51]
    v_exp_f32 v17, v73
    v_mfma_f32_16x16x32_bf16 a[48:51], v[28:31], v[180:183], a[48:51]
    v_exp_f32 v18, v74
    v_mfma_f32_16x16x32_bf16 a[96:99], v[24:27], v[168:171], a[96:99]
    ds_read_b128 v[44:47], v1 offset:14336
    v_and_b32 v49, s97, v61
    v_mfma_f32_16x16x32_bf16 a[96:99], v[28:31], v[184:187], a[96:99]
    buffer_load_dwordx4 v4, s[4:7], s27 offen offset:0 sc1 lds
    v_mfma_f32_16x16x32_bf16 a[144:147], v[24:27], v[172:175], a[144:147]
    v_add_f32 v7, v7, v16
    v_add_f32 v7, v7, v17
    v_mfma_f32_16x16x32_bf16 a[144:147], v[28:31], v[188:191], a[144:147]
    s_waitcnt lgkmcnt(2)
    v_exp_f32 v19, v75
    v_mfma_f32_16x16x32_bf16 a[4:7], v[32:35], v[160:163], a[4:7]
    ds_read_b128 v[24:27], v1 offset:3072
    v_lshlrev_b32 v50, 16, v63
    v_mfma_f32_16x16x32_bf16 a[4:7], v[36:39], v[176:179], a[4:7]
    v_cvt_pk_bf16_f32 v72, v16, v17
    v_and_b32 v51, s97, v63
    v_mfma_f32_16x16x32_bf16 a[52:55], v[32:35], v[164:167], a[52:55]
    v_exp_f32 v16, v104
    v_mfma_f32_16x16x32_bf16 a[52:55], v[36:39], v[180:183], a[52:55]
    v_bfe_u32 v53, v4, 4, 6
    v_add_f32 v7, v7, v18
    v_mfma_f32_16x16x32_bf16 a[100:103], v[32:35], v[168:171], a[100:103]
    ds_read_b128 v[28:31], v1 offset:15360
    v_add_f32 v7, v7, v19
    v_mfma_f32_16x16x32_bf16 a[100:103], v[36:39], v[184:187], a[100:103]
    v_exp_f32 v17, v105
    v_mfma_f32_16x16x32_bf16 a[148:151], v[32:35], v[172:175], a[148:151]
    v_mul_f32_e64 v50, -v50, v48
    v_cvt_pk_bf16_f32 v73, v18, v19
    v_mfma_f32_16x16x32_bf16 a[148:151], v[36:39], v[188:191], a[148:151]
    s_waitcnt lgkmcnt(2)
    buffer_load_dwordx4 v4, s[4:7], s27 offen offset:1024 sc1 lds
    v_mfma_f32_16x16x32_bf16 a[8:11], v[40:43], v[160:163], a[8:11]
    ds_read_b128 v[32:35], v1 offset:4096
    v_lshlrev_b32 v53, 2, v53
    v_mfma_f32_16x16x32_bf16 a[8:11], v[44:47], v[176:179], a[8:11]
    v_exp_f32 v18, v106
    v_mfma_f32_16x16x32_bf16 a[56:59], v[40:43], v[164:167], a[56:59]
    v_add_f32 v7, v7, v16
    v_add_f32 v7, v7, v17
    v_mfma_f32_16x16x32_bf16 a[56:59], v[44:47], v[180:183], a[56:59]
    buffer_load_dword v52, v53, s[20:23], s44 offen sc1
    v_mfma_f32_16x16x32_bf16 a[104:107], v[40:43], v[168:171], a[104:107]
    ds_read_b128 v[36:39], v1 offset:16384
    v_mul_f32_e64 v51, -v51, v49
    v_mfma_f32_16x16x32_bf16 a[104:107], v[44:47], v[184:187], a[104:107]
    v_exp_f32 v19, v107
    v_mfma_f32_16x16x32_bf16 a[152:155], v[40:43], v[172:175], a[152:155]
    v_cvt_pk_bf16_f32 v74, v16, v17
    v_cvt_f32_i32 v248, v248
    v_mfma_f32_16x16x32_bf16 a[152:155], v[44:47], v[188:191], a[152:155]
    s_waitcnt lgkmcnt(2)
    buffer_load_dwordx4 v4, s[4:7], s27 offen offset:2048 sc1 lds
    v_mfma_f32_16x16x32_bf16 a[12:15], v[24:27], v[160:163], a[12:15]
    ds_read_b128 v[40:43], v1 offset:5120
    v_cvt_f32_i32 v252, v252
    v_mfma_f32_16x16x32_bf16 a[12:15], v[28:31], v[176:179], a[12:15]
    v_exp_f32 v16, v76
    v_mfma_f32_16x16x32_bf16 a[60:63], v[24:27], v[164:167], a[60:63]
    v_add_f32 v7, v7, v18
    v_add_f32 v7, v7, v19
    v_mfma_f32_16x16x32_bf16 a[60:63], v[28:31], v[180:183], a[60:63]
    v_exp_f32 v17, v77
    v_mfma_f32_16x16x32_bf16 a[108:111], v[24:27], v[168:171], a[108:111]
    ds_read_b128 v[44:47], v1 offset:17408
    v_cvt_pk_bf16_f32 v75, v18, v19
    v_mfma_f32_16x16x32_bf16 a[108:111], v[28:31], v[184:187], a[108:111]
    v_exp_f32 v18, v78
    v_mfma_f32_16x16x32_bf16 a[156:159], v[24:27], v[172:175], a[156:159]
    s_add_u32 s29, s28, 49152
    v_add_f32 v8, v8, v16
    v_fma_f32 v248, v248, v48, v50
    v_mfma_f32_16x16x32_bf16 a[156:159], v[28:31], v[188:191], a[156:159]
    s_waitcnt lgkmcnt(2)
    v_add_f32 v8, v8, v17
    v_fma_f32 v252, v252, v49, v51
    v_mfma_f32_16x16x32_bf16 a[16:19], v[32:35], v[160:163], a[16:19]
    s_add_u32 s27, s27, 24576
    ds_read_b128 v[24:27], v1 offset:6144
    v_cvt_f32_i32 v249, v249
    v_mfma_f32_16x16x32_bf16 a[16:19], v[36:39], v[176:179], a[16:19]
    s_sub_u32 s3, s29, 147456
    v_exp_f32 v19, v79
    v_mfma_f32_16x16x32_bf16 a[64:67], v[32:35], v[164:167], a[64:67]
    v_cvt_pk_bf16_f32 v76, v16, v17
    v_cvt_f32_i32 v253, v253
    v_mfma_f32_16x16x32_bf16 a[64:67], v[36:39], v[180:183], a[64:67]
    s_add_u32 s56, s56, 12288
    v_exp_f32 v16, v108
    v_mfma_f32_16x16x32_bf16 a[112:115], v[32:35], v[168:171], a[112:115]
    ds_read_b128 v[28:31], v1 offset:18432
    v_add_f32 v8, v8, v18
    v_mfma_f32_16x16x32_bf16 a[112:115], v[36:39], v[184:187], a[112:115]
    v_add_f32 v8, v8, v19
    v_fma_f32 v249, v249, v48, v50
    v_mfma_f32_16x16x32_bf16 a[160:163], v[32:35], v[172:175], a[160:163]
    v_exp_f32 v17, v109
    v_mfma_f32_16x16x32_bf16 a[160:163], v[36:39], v[188:191], a[160:163]
    s_waitcnt lgkmcnt(2)
    v_cvt_pk_bf16_f32 v77, v18, v19
    v_fma_f32 v253, v253, v49, v51
    v_mfma_f32_16x16x32_bf16 a[20:23], v[40:43], v[160:163], a[20:23]
    s_mov_b32 m0, s56
    ds_read_b128 v[32:35], v1 offset:7168
    s_min_u32 s29, s29, s3
    v_mfma_f32_16x16x32_bf16 a[20:23], v[44:47], v[176:179], a[20:23]
    v_exp_f32 v18, v110
    v_mfma_f32_16x16x32_bf16 a[68:71], v[40:43], v[164:167], a[68:71]
    v_add_f32 v8, v8, v16
    v_add_f32 v8, v8, v17
    v_mfma_f32_16x16x32_bf16 a[68:71], v[44:47], v[180:183], a[68:71]
    v_exp_f32 v19, v111
    v_mfma_f32_16x16x32_bf16 a[116:119], v[40:43], v[168:171], a[116:119]
    ds_read_b128 v[36:39], v1 offset:19456
    v_cvt_pk_bf16_f32 v78, v16, v17
    v_mfma_f32_16x16x32_bf16 a[116:119], v[44:47], v[184:187], a[116:119]
    v_add_f32 v8, v8, v18
    v_cvt_f32_i32 v250, v250
    v_mfma_f32_16x16x32_bf16 a[164:167], v[40:43], v[172:175], a[164:167]
    s_sub_u32 s3, s29, s28
    v_add_f32 v8, v8, v19
    v_cvt_pk_bf16_f32 v79, v18, v19
    v_mfma_f32_16x16x32_bf16 a[164:167], v[44:47], v[188:191], a[164:167]
    s_waitcnt lgkmcnt(2)
    buffer_load_dwordx4 v4, s[4:7], s27 offen offset:0 sc1 lds
    v_mfma_f32_16x16x32_bf16 a[24:27], v[24:27], v[160:163], a[24:27]
    ds_read_b128 v[40:43], v1 offset:8192
    v_cvt_f32_i32 v254, v254
    v_mfma_f32_16x16x32_bf16 a[24:27], v[28:31], v[176:179], a[24:27]
    v_exp_f32 v16, v80
    v_mfma_f32_16x16x32_bf16 a[72:75], v[24:27], v[164:167], a[72:75]
    v_exp_f32 v17, v81
    v_mfma_f32_16x16x32_bf16 a[72:75], v[28:31], v[180:183], a[72:75]
    v_exp_f32 v18, v82
    v_mfma_f32_16x16x32_bf16 a[120:123], v[24:27], v[168:171], a[120:123]
    ds_read_b128 v[44:47], v1 offset:20480
    v_fma_f32 v250, v250, v48, v50
    v_mfma_f32_16x16x32_bf16 a[120:123], v[28:31], v[184:187], a[120:123]
    s_mov_b32 s28, s29
    v_add_f32 v5, v5, v16
    v_add_f32 v5, v5, v17
    v_mfma_f32_16x16x32_bf16 a[168:171], v[24:27], v[172:175], a[168:171]
    v_fma_f32 v254, v254, v49, v51
    v_mfma_f32_16x16x32_bf16 a[168:171], v[28:31], v[188:191], a[168:171]
    s_waitcnt lgkmcnt(2)
    v_exp_f32 v19, v83
    v_mfma_f32_16x16x32_bf16 a[28:31], v[32:35], v[160:163], a[28:31]
    ds_read_b128 v[24:27], v1 offset:9216
    v_cvt_pk_bf16_f32 v80, v16, v17
    v_mfma_f32_16x16x32_bf16 a[28:31], v[36:39], v[176:179], a[28:31]
    buffer_load_dwordx4 v4, s[4:7], s27 offen offset:1024 sc1 lds
    v_mfma_f32_16x16x32_bf16 a[76:79], v[32:35], v[164:167], a[76:79]
    v_exp_f32 v16, v112
    v_mfma_f32_16x16x32_bf16 a[76:79], v[36:39], v[180:183], a[76:79]
    v_add_f32 v5, v5, v18
    v_cvt_f32_i32 v251, v251
    v_mfma_f32_16x16x32_bf16 a[124:127], v[32:35], v[168:171], a[124:127]
    ds_read_b128 v[28:31], v1 offset:21504
    v_add_f32 v5, v5, v19
    v_mfma_f32_16x16x32_bf16 a[124:127], v[36:39], v[184:187], a[124:127]
    v_exp_f32 v17, v113
    v_mfma_f32_16x16x32_bf16 a[172:175], v[32:35], v[172:175], a[172:175]
    v_cvt_f32_i32 v255, v255
    v_cvt_pk_bf16_f32 v81, v18, v19
    v_mfma_f32_16x16x32_bf16 a[172:175], v[36:39], v[188:191], a[172:175]
    s_waitcnt lgkmcnt(2)
    v_exp_f32 v18, v114
    v_mfma_f32_16x16x32_bf16 a[32:35], v[40:43], v[160:163], a[32:35]
    ds_read_b128 v[32:35], v1 offset:10240
    v_add_u32 v2, s3, v2
    v_mfma_f32_16x16x32_bf16 a[32:35], v[44:47], v[176:179], a[32:35]
    buffer_load_dwordx4 v4, s[4:7], s27 offen offset:2048 sc1 lds
    v_mfma_f32_16x16x32_bf16 a[80:83], v[40:43], v[164:167], a[80:83]
    v_add_f32 v5, v5, v16
    v_add_f32 v5, v5, v17
    v_mfma_f32_16x16x32_bf16 a[80:83], v[44:47], v[180:183], a[80:83]
    v_exp_f32 v19, v115
    v_mfma_f32_16x16x32_bf16 a[128:131], v[40:43], v[168:171], a[128:131]
    ds_read_b128 v[36:39], v1 offset:22528
    v_fma_f32 v251, v251, v48, v50
    v_mfma_f32_16x16x32_bf16 a[128:131], v[44:47], v[184:187], a[128:131]
    v_cvt_pk_bf16_f32 v82, v16, v17
    v_fma_f32 v255, v255, v49, v51
    v_mfma_f32_16x16x32_bf16 a[176:179], v[40:43], v[172:175], a[176:179]
    v_exp_f32 v16, v84
    v_mfma_f32_16x16x32_bf16 a[176:179], v[44:47], v[188:191], a[176:179]
    s_waitcnt lgkmcnt(2)
    v_add_f32 v5, v5, v18
    v_add_u32 v3, s3, v3
    v_mfma_f32_16x16x32_bf16 a[36:39], v[24:27], v[160:163], a[36:39]
    ds_read_b128 v[40:43], v1 offset:11264
    v_add_f32 v5, v5, v19
    v_mfma_f32_16x16x32_bf16 a[36:39], v[28:31], v[176:179], a[36:39]
    v_exp_f32 v17, v85
    v_mfma_f32_16x16x32_bf16 a[84:87], v[24:27], v[164:167], a[84:87]
    v_cvt_pk_bf16_f32 v146, v240, v244
    v_cvt_pk_bf16_f32 v83, v18, v19
    v_mfma_f32_16x16x32_bf16 a[84:87], v[28:31], v[180:183], a[84:87]
    s_add_u32 s27, s27, 24576
    v_cvt_pk_bf16_f32 v150, v241, v245
    v_cvt_pk_bf16_f32 v147, v248, v252
    v_mfma_f32_16x16x32_bf16 a[132:135], v[24:27], v[168:171], a[132:135]
    s_add_u32 s56, s56, 36864
    ds_read_b128 v[44:47], v1 offset:23552
    v_mfma_f32_16x16x32_bf16 a[132:135], v[28:31], v[184:187], a[132:135]
    s_waitcnt lgkmcnt(2)
    v_exp_f32 v18, v86
    v_mfma_f32_16x16x32_bf16 a[180:183], v[24:27], v[172:175], a[180:183]
    s_waitcnt vmcnt(20)
    v_add_f32 v6, v6, v16
    v_add_f32 v6, v6, v17
    v_mfma_f32_16x16x32_bf16 a[180:183], v[28:31], v[188:191], a[180:183]
    s_barrier
    v_cvt_pk_bf16_f32 v151, v249, v253
    v_mfma_f32_16x16x32_bf16 a[40:43], v[32:35], v[160:163], a[40:43]
    s_sub_u32 s58, s56, 147456
    ds_read_b128 v[24:27], v2 offset:0
    v_mfma_f32_16x16x32_bf16 a[40:43], v[36:39], v[176:179], a[40:43]
    buffer_load_dword v15, v4, s[88:91], s93 offen
    v_mfma_f32_16x16x32_bf16 a[88:91], v[32:35], v[164:167], a[88:91]
    s_min_u32 s56, s56, s58
    v_exp_f32 v19, v87
    v_mfma_f32_16x16x32_bf16 a[88:91], v[36:39], v[180:183], a[88:91]
    v_cvt_pk_bf16_f32 v84, v16, v17
    v_cvt_pk_bf16_f32 v154, v242, v246
    v_mfma_f32_16x16x32_bf16 a[136:139], v[32:35], v[168:171], a[136:139]
    ds_read_b128 v[28:31], v3 offset:0
    v_cvt_pk_bf16_f32 v155, v250, v254
    v_mfma_f32_16x16x32_bf16 a[136:139], v[36:39], v[184:187], a[136:139]
    v_exp_f32 v16, v116
    v_mfma_f32_16x16x32_bf16 a[184:187], v[32:35], v[172:175], a[184:187]
    v_add_f32 v6, v6, v18
    v_add_f32 v6, v6, v19
    v_mfma_f32_16x16x32_bf16 a[184:187], v[36:39], v[188:191], a[184:187]
    s_waitcnt lgkmcnt(2)
    v_exp_f32 v17, v117
    v_mfma_f32_16x16x32_bf16 a[44:47], v[40:43], v[160:163], a[44:47]
    ds_read_b128 v[32:35], v2 offset:6144
    v_cvt_pk_bf16_f32 v85, v18, v19
    v_mfma_f32_16x16x32_bf16 a[44:47], v[44:47], v[176:179], a[44:47]
    v_exp_f32 v18, v118
    v_mfma_f32_16x16x32_bf16 a[92:95], v[40:43], v[164:167], a[92:95]
    v_add_f32 v6, v6, v16
    v_add_f32 v6, v6, v17
    v_mfma_f32_16x16x32_bf16 a[92:95], v[44:47], v[180:183], a[92:95]
    v_exp_f32 v19, v119
    v_mfma_f32_16x16x32_bf16 a[140:143], v[40:43], v[168:171], a[140:143]
    ds_read_b128 v[36:39], v3 offset:6144
    v_cvt_pk_bf16_f32 v158, v243, v247
    v_mfma_f32_16x16x32_bf16 a[140:143], v[44:47], v[184:187], a[140:143]
    v_cvt_pk_bf16_f32 v86, v16, v17
    v_add_f32 v6, v6, v18
    v_mfma_f32_16x16x32_bf16 a[188:191], v[40:43], v[172:175], a[188:191]
    v_add_f32 v6, v6, v19
    v_cvt_pk_bf16_f32 v159, v251, v255
    v_mfma_f32_16x16x32_bf16 a[188:191], v[44:47], v[188:191], a[188:191]
    s_waitcnt lgkmcnt(2)
    v_cvt_pk_bf16_f32 v87, v18, v19
L_join:
    v_mfma_f32_16x16x32_bf16 v[160:163], v[24:27], a[192:195], v[128:131]
    s_waitcnt vmcnt(7)
    ds_read_b128 v[40:43], v2 offset:128
    v_mfma_f32_16x16x32_bf16 v[160:163], v[28:31], a[196:199], v[160:163]
    s_waitcnt vmcnt(5)
    v_subrev_u32 v52, s92, v52
    v_cmp_lt_u32 vcc, 15, v52
    v_mfma_f32_16x16x32_bf16 v[164:167], v[24:27], a[216:219], v[132:135]
    v_exp_f32 v16, v88
    v_mfma_f32_16x16x32_bf16 v[164:167], v[28:31], a[220:223], v[164:167]
    v_exp_f32 v17, v89
    v_mfma_f32_16x16x32_bf16 v[168:171], v[24:27], a[240:243], v[136:139]
    s_and_b32 s59, vcc_lo, 0xff
    ds_read_b128 v[44:47], v3 offset:128
    v_lshlrev_b32 v48, 16, v56
    v_mfma_f32_16x16x32_bf16 v[168:171], v[28:31], a[244:247], v[168:171]
    s_cbranch_scc1 L_pollslow1
L_pollok1:
    v_mfma_f32_16x16x32_bf16 v[172:175], v[24:27], v[200:203], v[140:143]
    s_add_u32 s92, s92, 1
    v_exp_f32 v18, v90
    v_mfma_f32_16x16x32_bf16 v[172:175], v[28:31], v[204:207], v[172:175]
    s_waitcnt lgkmcnt(2)
    v_add_f32 v7, v7, v16
    v_add_f32 v7, v7, v17
    v_mfma_f32_16x16x32_bf16 v[96:99], v[32:35], a[192:195], v[128:131]
    ds_read_b128 v[24:27], v2 offset:6272
    v_and_b32 v49, s97, v56
    v_mfma_f32_16x16x32_bf16 v[96:99], v[36:39], a[196:199], v[96:99]
    buffer_store_dwordx4 v[144:147], v20, s[4:7], s35 offen offset:0 sc1
    v_mfma_f32_16x16x32_bf16 v[100:103], v[32:35], a[216:219], v[132:135]
    v_exp_f32 v19, v91
    v_mfma_f32_16x16x32_bf16 v[100:103], v[36:39], a[220:223], v[100:103]
    v_cvt_pk_bf16_f32 v88, v16, v17
    v_mfma_f32_16x16x32_bf16 v[104:107], v[32:35], a[240:243], v[136:139]
    ds_read_b128 v[28:31], v3 offset:6272
    v_mfma_f32_16x16x32_bf16 v[104:107], v[36:39], a[244:247], v[104:107]
    v_exp_f32 v16, v120
    v_mfma_f32_16x16x32_bf16 v[108:111], v[32:35], v[200:203], v[140:143]
    v_add_f32 v7, v7, v18
    v_add_f32 v7, v7, v19
    v_mfma_f32_16x16x32_bf16 v[108:111], v[36:39], v[204:207], v[108:111]
    s_waitcnt lgkmcnt(2)
    v_exp_f32 v17, v121
    v_mfma_f32_16x16x32_bf16 v[160:163], v[40:43], a[200:203], v[160:163]
    ds_read_b128 v[32:35], v2 offset:256
    v_cvt_pk_bf16_f32 v89, v18, v19
    v_mfma_f32_16x16x32_bf16 v[160:163], v[44:47], a[204:207], v[160:163]
    buffer_store_dwordx4 v[148:151], v20, s[4:7], s35 offen offset:3072 sc1
    v_mfma_f32_16x16x32_bf16 v[164:167], v[40:43], a[224:227], v[164:167]
    v_exp_f32 v18, v122
    v_mfma_f32_16x16x32_bf16 v[164:167], v[44:47], a[228:231], v[164:167]
    v_add_f32 v7, v7, v16
    v_add_f32 v7, v7, v17
    v_mfma_f32_16x16x32_bf16 v[168:171], v[40:43], a[248:251], v[168:171]
    ds_read_b128 v[36:39], v3 offset:256
    v_lshlrev_b32 v50, 16, v58
    v_mfma_f32_16x16x32_bf16 v[168:171], v[44:47], a[252:255], v[168:171]
    v_exp_f32 v19, v123
    v_mfma_f32_16x16x32_bf16 v[172:175], v[40:43], v[208:211], v[172:175]
    v_cvt_pk_bf16_f32 v90, v16, v17
    v_and_b32 v51, s97, v58
    v_mfma_f32_16x16x32_bf16 v[172:175], v[44:47], v[212:215], v[172:175]
    s_waitcnt lgkmcnt(2)
    v_exp_f32 v16, v92
    v_mfma_f32_16x16x32_bf16 v[96:99], v[24:27], a[200:203], v[96:99]
    ds_read_b128 v[40:43], v2 offset:6400
    v_add_f32 v7, v7, v18
    v_mfma_f32_16x16x32_bf16 v[96:99], v[28:31], a[204:207], v[96:99]
    buffer_store_dwordx4 v[152:155], v20, s[4:7], s17 offen offset:0 sc1
    v_mfma_f32_16x16x32_bf16 v[100:103], v[24:27], a[224:227], v[100:103]
    v_add_f32 v7, v7, v19
    v_mul_f32 v48, s38, v48
    v_mfma_f32_16x16x32_bf16 v[100:103], v[28:31], a[228:231], v[100:103]
    v_exp_f32 v17, v93
    v_mfma_f32_16x16x32_bf16 v[104:107], v[24:27], a[248:251], v[104:107]
    ds_read_b128 v[44:47], v3 offset:6400
    v_cvt_pk_bf16_f32 v91, v18, v19
    v_mfma_f32_16x16x32_bf16 v[104:107], v[28:31], a[252:255], v[104:107]
    v_exp_f32 v18, v94
    v_mfma_f32_16x16x32_bf16 v[108:111], v[24:27], v[208:211], v[108:111]
    s_add_u32 s29, s30, 49152
    v_add_f32 v8, v8, v16
    v_mfma_f32_16x16x32_bf16 v[108:111], v[28:31], v[212:215], v[108:111]
    s_waitcnt lgkmcnt(2)
    v_add_f32 v8, v8, v17
    v_mul_f32 v49, s38, v49
    v_mfma_f32_16x16x32_bf16 v[160:163], v[32:35], a[208:211], v[160:163]
    ds_read_b128 v[24:27], v2 offset:12288
    v_mfma_f32_16x16x32_bf16 v[160:163], v[36:39], a[212:215], v[160:163]
    buffer_store_dwordx4 v[156:159], v20, s[4:7], s17 offen offset:3072 sc1
    v_mfma_f32_16x16x32_bf16 v[164:167], v[32:35], a[232:235], v[164:167]
    s_sub_u32 s3, s29, 147456
    v_exp_f32 v19, v95
    v_mfma_f32_16x16x32_bf16 v[164:167], v[36:39], a[236:239], v[164:167]
    v_cvt_pk_bf16_f32 v92, v16, v17
    v_mfma_f32_16x16x32_bf16 v[168:171], v[32:35], v[192:195], v[168:171]
    ds_read_b128 v[28:31], v3 offset:12288
    v_mul_f32_e64 v50, -v50, v48
    v_mfma_f32_16x16x32_bf16 v[168:171], v[36:39], v[196:199], v[168:171]
    v_exp_f32 v16, v124
    v_mfma_f32_16x16x32_bf16 v[172:175], v[32:35], v[216:219], v[172:175]
    v_add_f32 v8, v8, v18
    v_add_f32 v8, v8, v19
    v_mfma_f32_16x16x32_bf16 v[172:175], v[36:39], v[220:223], v[172:175]
    s_waitcnt lgkmcnt(2)
    v_exp_f32 v17, v125
    v_mfma_f32_16x16x32_bf16 v[96:99], v[40:43], a[208:211], v[96:99]
    ds_read_b128 v[32:35], v2 offset:18432
    v_cvt_pk_bf16_f32 v93, v18, v19
    v_mfma_f32_16x16x32_bf16 v[96:99], v[44:47], a[212:215], v[96:99]
    s_mov_b32 m0, s26
    v_exp_f32 v18, v126
    v_mfma_f32_16x16x32_bf16 v[100:103], v[40:43], a[232:235], v[100:103]
    s_min_u32 s29, s29, s3
    v_mul_f32_e64 v51, -v51, v49
    v_mfma_f32_16x16x32_bf16 v[100:103], v[44:47], a[236:239], v[100:103]
    buffer_load_dwordx4 v4, s[4:7], s32 offen offset:0 sc1 lds
    v_mfma_f32_16x16x32_bf16 v[104:107], v[40:43], v[192:195], v[104:107]
    ds_read_b128 v[36:39], v3 offset:18432
    v_add_f32 v8, v8, v16
    v_mfma_f32_16x16x32_bf16 v[104:107], v[44:47], v[196:199], v[104:107]
    v_add_f32 v8, v8, v17
    v_mfma_f32_16x16x32_bf16 v[108:111], v[40:43], v[216:219], v[108:111]
    v_exp_f32 v19, v127
    v_mfma_f32_16x16x32_bf16 v[108:111], v[44:47], v[220:223], v[108:111]
    s_waitcnt lgkmcnt(2)
    buffer_load_dwordx4 v4, s[4:7], s32 offen offset:1024 sc1 lds
    v_mfma_f32_16x16x32_bf16 v[176:179], v[24:27], a[192:195], v[128:131]
    ds_read_b128 v[40:43], v2 offset:12416
    v_cvt_pk_bf16_f32 v94, v16, v17
    v_mfma_f32_16x16x32_bf16 v[176:179], v[28:31], a[196:199], v[176:179]
    s_sub_u32 s3, s29, s30
    v_add_f32 v8, v8, v18
    v_add_f32 v8, v8, v19
    v_mfma_f32_16x16x32_bf16 v[180:183], v[24:27], a[216:219], v[132:135]
    v_cvt_pk_bf16_f32 v95, v18, v19
    v_cvt_f32_i32 v224, v224
    v_mfma_f32_16x16x32_bf16 v[180:183], v[28:31], a[220:223], v[180:183]
    buffer_load_dwordx4 v4, s[4:7], s32 offen offset:2048 sc1 lds
    v_mfma_f32_16x16x32_bf16 v[184:187], v[24:27], a[240:243], v[136:139]
    ds_read_b128 v[44:47], v3 offset:12416
    v_mfma_f32_16x16x32_bf16 v[184:187], v[28:31], a[244:247], v[184:187]
    v_exp_f32 v16, v160
    v_mfma_f32_16x16x32_bf16 v[188:191], v[24:27], v[200:203], v[140:143]
    s_add_u32 s32, s32, 24576
    v_exp_f32 v17, v161
    v_mfma_f32_16x16x32_bf16 v[188:191], v[28:31], v[204:207], v[188:191]
    s_waitcnt lgkmcnt(2)
    v_exp_f32 v18, v162
    v_mfma_f32_16x16x32_bf16 v[112:115], v[32:35], a[192:195], v[128:131]
    s_add_u32 s26, s26, 12288
    ds_read_b128 v[24:27], v2 offset:18560
    v_add_f32 v5, v5, v16
    v_mfma_f32_16x16x32_bf16 v[112:115], v[36:39], a[196:199], v[112:115]
    s_mov_b32 s30, s29
    v_add_f32 v5, v5, v17
    v_cvt_f32_i32 v225, v225
    v_mfma_f32_16x16x32_bf16 v[116:119], v[32:35], a[216:219], v[132:135]
    v_exp_f32 v19, v163
    v_mfma_f32_16x16x32_bf16 v[116:119], v[36:39], a[220:223], v[116:119]
    s_mov_b32 m0, s26
    v_cvt_pk_bf16_f32 v160, v16, v17
    v_fma_f32 v224, v224, v48, v50
    v_mfma_f32_16x16x32_bf16 v[120:123], v[32:35], a[240:243], v[136:139]
    ds_read_b128 v[28:31], v3 offset:18560
    v_mfma_f32_16x16x32_bf16 v[120:123], v[36:39], a[244:247], v[120:123]
    v_exp_f32 v16, v96
    v_mfma_f32_16x16x32_bf16 v[124:127], v[32:35], v[200:203], v[140:143]
    v_add_f32 v5, v5, v18
    v_add_f32 v5, v5, v19
    v_mfma_f32_16x16x32_bf16 v[124:127], v[36:39], v[204:207], v[124:127]
    s_waitcnt lgkmcnt(2)
    buffer_load_dwordx4 v4, s[4:7], s32 offen offset:0 sc1 lds
    v_mfma_f32_16x16x32_bf16 v[176:179], v[40:43], a[200:203], v[176:179]
    ds_read_b128 v[32:35], v2 offset:12544
    v_fma_f32 v225, v225, v49, v51
    v_mfma_f32_16x16x32_bf16 v[176:179], v[44:47], a[204:207], v[176:179]
    v_exp_f32 v17, v97
    v_mfma_f32_16x16x32_bf16 v[180:183], v[40:43], a[224:227], v[180:183]
    v_cvt_pk_bf16_f32 v161, v18, v19
    v_add_u32 v1, s3, v1
    v_mfma_f32_16x16x32_bf16 v[180:183], v[44:47], a[228:231], v[180:183]
    buffer_load_dwordx4 v4, s[4:7], s32 offen offset:1024 sc1 lds
    v_mfma_f32_16x16x32_bf16 v[184:187], v[40:43], a[248:251], v[184:187]
    ds_read_b128 v[36:39], v3 offset:12544
    v_mfma_f32_16x16x32_bf16 v[184:187], v[44:47], a[252:255], v[184:187]
    v_exp_f32 v18, v98
    v_mfma_f32_16x16x32_bf16 v[188:191], v[40:43], v[208:211], v[188:191]
    v_add_f32 v5, v5, v16
    v_add_f32 v5, v5, v17
    v_mfma_f32_16x16x32_bf16 v[188:191], v[44:47], v[212:215], v[188:191]
    s_waitcnt lgkmcnt(2)
    buffer_load_dwordx4 v4, s[4:7], s32 offen offset:2048 sc1 lds
    v_mfma_f32_16x16x32_bf16 v[112:115], v[24:27], a[200:203], v[112:115]
    ds_read_b128 v[40:43], v2 offset:18688
    v_cvt_pk_bf16_f32 v224, v224, v225
    v_mfma_f32_16x16x32_bf16 v[112:115], v[28:31], a[204:207], v[112:115]
    v_exp_f32 v19, v99
    v_mfma_f32_16x16x32_bf16 v[116:119], v[24:27], a[224:227], v[116:119]
    v_cvt_pk_bf16_f32 v162, v16, v17
    v_mfma_f32_16x16x32_bf16 v[116:119], v[28:31], a[228:231], v[116:119]
    s_add_u32 s32, s32, 24576
    v_exp_f32 v16, v164
    v_mfma_f32_16x16x32_bf16 v[120:123], v[24:27], a[248:251], v[120:123]
    s_add_u32 s26, s26, 36864
    ds_read_b128 v[44:47], v3 offset:18688
    v_add_f32 v5, v5, v18
    v_mfma_f32_16x16x32_bf16 v[120:123], v[28:31], a[252:255], v[120:123]
    s_waitcnt lgkmcnt(2)
    v_add_f32 v5, v5, v19
    v_cvt_f32_i32 v228, v228
    v_mfma_f32_16x16x32_bf16 v[124:127], v[24:27], v[208:211], v[124:127]
    s_waitcnt vmcnt(6)
    v_exp_f32 v17, v165
    v_mfma_f32_16x16x32_bf16 v[124:127], v[28:31], v[212:215], v[124:127]
    s_barrier
    v_cvt_pk_bf16_f32 v163, v18, v19
    v_mfma_f32_16x16x32_bf16 v[176:179], v[32:35], a[208:211], v[176:179]
    s_sub_u32 s57, s26, 147456
    ds_read_b128 v[24:27], v1 offset:0
    v_add_u32 v0, 1, v0
    v_mfma_f32_16x16x32_bf16 v[176:179], v[36:39], a[212:215], v[176:179]
    v_exp_f32 v18, v166
    v_mfma_f32_16x16x32_bf16 v[180:183], v[32:35], a[232:235], v[180:183]
    s_min_u32 s26, s26, s57
    v_add_f32 v6, v6, v16
    v_add_f32 v6, v6, v17
    v_mfma_f32_16x16x32_bf16 v[180:183], v[36:39], a[236:239], v[180:183]
    v_exp_f32 v19, v167
    v_mfma_f32_16x16x32_bf16 v[184:187], v[32:35], v[192:195], v[184:187]
    ds_read_b128 v[28:31], v1 offset:12288
    v_cvt_pk_bf16_f32 v164, v16, v17
    v_mfma_f32_16x16x32_bf16 v[184:187], v[36:39], v[196:199], v[184:187]
    buffer_store_dword v0, v13, s[20:23], 0 offen offset:32 sc1
    v_mfma_f32_16x16x32_bf16 v[188:191], v[32:35], v[216:219], v[188:191]
    v_exp_f32 v16, v100
    v_mfma_f32_16x16x32_bf16 v[188:191], v[36:39], v[220:223], v[188:191]
    s_waitcnt lgkmcnt(2)
    v_add_f32 v6, v6, v18
    v_add_f32 v6, v6, v19
    v_mfma_f32_16x16x32_bf16 v[112:115], v[40:43], a[208:211], v[112:115]
    ds_read_b128 v[32:35], v1 offset:1024
    v_cvt_f32_i32 v229, v229
    v_mfma_f32_16x16x32_bf16 v[112:115], v[44:47], a[212:215], v[112:115]
    v_exp_f32 v17, v101
    v_mfma_f32_16x16x32_bf16 v[116:119], v[40:43], a[232:235], v[116:119]
    v_cvt_pk_bf16_f32 v165, v18, v19
    v_fma_f32 v228, v228, v48, v50
    v_mfma_f32_16x16x32_bf16 v[116:119], v[44:47], a[236:239], v[116:119]
    v_exp_f32 v18, v102
    v_mfma_f32_16x16x32_bf16 v[120:123], v[40:43], v[192:195], v[120:123]
    ds_read_b128 v[36:39], v1 offset:13312
    v_add_f32 v6, v6, v16
    v_mfma_f32_16x16x32_bf16 v[120:123], v[44:47], v[196:199], v[120:123]
    v_add_f32 v6, v6, v17
    v_mfma_f32_16x16x32_bf16 v[124:127], v[40:43], v[216:219], v[124:127]
    v_exp_f32 v19, v103
    v_mfma_f32_16x16x32_bf16 v[124:127], v[44:47], v[220:223], v[124:127]
    s_waitcnt lgkmcnt(2)
    v_cvt_pk_bf16_f32 v166, v16, v17
    v_add_f32 v6, v6, v18
    v_add_f32 v6, v6, v19
    v_cvt_pk_bf16_f32 v167, v18, v19
    v_mfma_f32_16x16x32_bf16 a[0:3], v[24:27], v[64:67], a[0:3]
    ds_read_b128 v[40:43], v1 offset:2048
    v_fma_f32 v229, v229, v49, v51
    v_mfma_f32_16x16x32_bf16 a[0:3], v[28:31], v[80:83], a[0:3]
    buffer_load_dwordx2 v[60:61], v10, s[72:75], s36 offen offset:192
    v_mfma_f32_16x16x32_bf16 a[48:51], v[24:27], v[68:71], a[48:51]
    v_exp_f32 v16, v168
    v_mfma_f32_16x16x32_bf16 a[48:51], v[28:31], v[84:87], a[48:51]
    v_exp_f32 v17, v169
    v_mfma_f32_16x16x32_bf16 a[96:99], v[24:27], v[72:75], a[96:99]
    ds_read_b128 v[44:47], v1 offset:14336
    v_cvt_pk_bf16_f32 v228, v228, v229
    v_mfma_f32_16x16x32_bf16 a[96:99], v[28:31], v[88:91], a[96:99]
    buffer_load_dwordx2 v[62:63], v10, s[76:79], s36 offen offset:192
    v_mfma_f32_16x16x32_bf16 a[144:147], v[24:27], v[76:79], a[144:147]
    v_exp_f32 v18, v170
    v_mfma_f32_16x16x32_bf16 a[144:147], v[28:31], v[92:95], a[144:147]
    s_waitcnt lgkmcnt(2)
    v_add_f32 v7, v7, v16
    v_add_f32 v7, v7, v17
    v_mfma_f32_16x16x32_bf16 a[4:7], v[32:35], v[64:67], a[4:7]
    ds_read_b128 v[24:27], v1 offset:3072
    v_cvt_f32_i32 v232, v232
    v_mfma_f32_16x16x32_bf16 a[4:7], v[36:39], v[80:83], a[4:7]
    v_exp_f32 v19, v171
    v_mfma_f32_16x16x32_bf16 a[52:55], v[32:35], v[68:71], a[52:55]
    v_cvt_pk_bf16_f32 v168, v16, v17
    v_cvt_f32_i32 v233, v233
    v_mfma_f32_16x16x32_bf16 a[52:55], v[36:39], v[84:87], a[52:55]
    buffer_load_dwordx4 v[240:243], v9, s[64:67], s33 offen offset:384 nt
    v_mfma_f32_16x16x32_bf16 a[100:103], v[32:35], v[72:75], a[100:103]
    ds_read_b128 v[28:31], v1 offset:15360
    v_fma_f32 v232, v232, v48, v50
    v_mfma_f32_16x16x32_bf16 a[100:103], v[36:39], v[88:91], a[100:103]
    v_exp_f32 v16, v104
    v_mfma_f32_16x16x32_bf16 a[148:151], v[32:35], v[76:79], a[148:151]
    v_add_f32 v7, v7, v18
    v_add_f32 v7, v7, v19
    v_mfma_f32_16x16x32_bf16 a[148:151], v[36:39], v[92:95], a[148:151]
    s_waitcnt lgkmcnt(2)
    buffer_load_dwordx4 v[244:247], v9, s[64:67], s33 offen offset:1920 nt
    v_mfma_f32_16x16x32_bf16 a[8:11], v[40:43], v[64:67], a[8:11]
    ds_read_b128 v[32:35], v1 offset:4096
    v_fma_f32 v233, v233, v49, v51
    v_mfma_f32_16x16x32_bf16 a[8:11], v[44:47], v[80:83], a[8:11]
    v_exp_f32 v17, v105
    v_mfma_f32_16x16x32_bf16 a[56:59], v[40:43], v[68:71], a[56:59]
    v_cvt_pk_bf16_f32 v169, v18, v19
    v_cvt_pk_bf16_f32 v232, v232, v233
    v_mfma_f32_16x16x32_bf16 a[56:59], v[44:47], v[84:87], a[56:59]
    v_exp_f32 v18, v106
    v_mfma_f32_16x16x32_bf16 a[104:107], v[40:43], v[72:75], a[104:107]
    ds_read_b128 v[36:39], v1 offset:16384
    v_add_f32 v7, v7, v16
    v_mfma_f32_16x16x32_bf16 a[104:107], v[44:47], v[88:91], a[104:107]
    buffer_load_dwordx4 v[248:251], v9, s[64:67], s34 offen offset:384 nt
    v_mfma_f32_16x16x32_bf16 a[152:155], v[40:43], v[76:79], a[152:155]
    v_add_f32 v7, v7, v17
    v_cvt_f32_i32 v236, v236
    v_mfma_f32_16x16x32_bf16 a[152:155], v[44:47], v[92:95], a[152:155]
    s_waitcnt lgkmcnt(2)
    v_exp_f32 v19, v107
    v_mfma_f32_16x16x32_bf16 a[12:15], v[24:27], v[64:67], a[12:15]
    ds_read_b128 v[40:43], v1 offset:5120
    v_cvt_pk_bf16_f32 v170, v16, v17
    v_mfma_f32_16x16x32_bf16 a[12:15], v[28:31], v[80:83], a[12:15]
    buffer_load_dwordx4 v[252:255], v9, s[64:67], s34 offen offset:1920 nt
    v_mfma_f32_16x16x32_bf16 a[60:63], v[24:27], v[68:71], a[60:63]
    v_exp_f32 v16, v172
    v_mfma_f32_16x16x32_bf16 a[60:63], v[28:31], v[84:87], a[60:63]
    v_add_f32 v7, v7, v18
    v_add_f32 v7, v7, v19
    v_mfma_f32_16x16x32_bf16 a[108:111], v[24:27], v[72:75], a[108:111]
    ds_read_b128 v[44:47], v1 offset:17408
    v_cvt_f32_i32 v237, v237
    v_mfma_f32_16x16x32_bf16 a[108:111], v[28:31], v[88:91], a[108:111]
    v_exp_f32 v17, v173
    v_mfma_f32_16x16x32_bf16 a[156:159], v[24:27], v[76:79], a[156:159]
    s_add_u32 s29, s28, 49152
    v_cvt_pk_bf16_f32 v171, v18, v19
    v_fma_f32 v236, v236, v48, v50
    v_mfma_f32_16x16x32_bf16 a[156:159], v[28:31], v[92:95], a[156:159]
    s_waitcnt lgkmcnt(2)
    v_exp_f32 v18, v174
    v_mfma_f32_16x16x32_bf16 a[16:19], v[32:35], v[64:67], a[16:19]
    s_mov_b32 m0, s26
    ds_read_b128 v[24:27], v1 offset:6144
    v_add_f32 v8, v8, v16
    v_mfma_f32_16x16x32_bf16 a[16:19], v[36:39], v[80:83], a[16:19]
    s_sub_u32 s3, s29, 147456
    buffer_load_dwordx4 v4, s[4:7], s32 offen offset:0 sc1 lds
    v_mfma_f32_16x16x32_bf16 a[64:67], v[32:35], v[68:71], a[64:67]
    v_add_f32 v8, v8, v17
    v_fma_f32 v237, v237, v49, v51
    v_mfma_f32_16x16x32_bf16 a[64:67], v[36:39], v[84:87], a[64:67]
    v_exp_f32 v19, v175
    v_mfma_f32_16x16x32_bf16 a[112:115], v[32:35], v[72:75], a[112:115]
    ds_read_b128 v[28:31], v1 offset:18432
    v_cvt_pk_bf16_f32 v172, v16, v17
    v_mfma_f32_16x16x32_bf16 a[112:115], v[36:39], v[88:91], a[112:115]
    v_exp_f32 v16, v108
    v_mfma_f32_16x16x32_bf16 a[160:163], v[32:35], v[76:79], a[160:163]
    v_cvt_pk_bf16_f32 v236, v236, v237
    v_add_f32 v8, v8, v18
    v_mfma_f32_16x16x32_bf16 a[160:163], v[36:39], v[92:95], a[160:163]
    s_waitcnt lgkmcnt(2)
    buffer_load_dwordx4 v4, s[4:7], s32 offen offset:1024 sc1 lds
    v_mfma_f32_16x16x32_bf16 a[20:23], v[40:43], v[64:67], a[20:23]
    s_min_u32 s29, s29, s3
    ds_read_b128 v[32:35], v1 offset:7168
    v_add_f32 v8, v8, v19
    v_mfma_f32_16x16x32_bf16 a[20:23], v[44:47], v[80:83], a[20:23]
    v_exp_f32 v17, v109
    v_mfma_f32_16x16x32_bf16 a[68:71], v[40:43], v[68:71], a[68:71]
    v_lshlrev_b32 v48, 16, v57
    v_cvt_pk_bf16_f32 v173, v18, v19
    v_mfma_f32_16x16x32_bf16 a[68:71], v[44:47], v[84:87], a[68:71]
    v_exp_f32 v18, v110
    v_mfma_f32_16x16x32_bf16 a[116:119], v[40:43], v[72:75], a[116:119]
    ds_read_b128 v[36:39], v1 offset:19456
    v_and_b32 v49, s97, v57
    v_mfma_f32_16x16x32_bf16 a[116:119], v[44:47], v[88:91], a[116:119]
    buffer_load_dwordx4 v4, s[4:7], s32 offen offset:2048 sc1 lds
    v_mfma_f32_16x16x32_bf16 a[164:167], v[40:43], v[76:79], a[164:167]
    s_sub_u32 s3, s29, s28
    v_add_f32 v8, v8, v16
    v_add_f32 v8, v8, v17
    v_mfma_f32_16x16x32_bf16 a[164:167], v[44:47], v[92:95], a[164:167]
    s_waitcnt lgkmcnt(2)
    v_exp_f32 v19, v111
    v_mfma_f32_16x16x32_bf16 a[24:27], v[24:27], v[64:67], a[24:27]
    s_add_u32 s32, s32, 24576
    ds_read_b128 v[40:43], v1 offset:8192
    v_lshlrev_b32 v50, 16, v59
    v_mfma_f32_16x16x32_bf16 a[24:27], v[28:31], v[80:83], a[24:27]
    v_cvt_pk_bf16_f32 v174, v16, v17
    v_and_b32 v51, s97, v59
    v_mfma_f32_16x16x32_bf16 a[72:75], v[24:27], v[68:71], a[72:75]
    v_add_f32 v8, v8, v18
    v_add_f32 v8, v8, v19
    v_mfma_f32_16x16x32_bf16 a[72:75], v[28:31], v[84:87], a[72:75]
    s_add_u32 s26, s26, 12288
    v_mul_f32 v48, s38, v48
    v_cvt_pk_bf16_f32 v175, v18, v19
    v_mfma_f32_16x16x32_bf16 a[120:123], v[24:27], v[72:75], a[120:123]
    ds_read_b128 v[44:47], v1 offset:20480
    v_mul_f32 v49, s38, v49
    v_mfma_f32_16x16x32_bf16 a[120:123], v[28:31], v[88:91], a[120:123]
    s_mov_b32 s28, s29
    v_exp_f32 v16, v176
    v_mfma_f32_16x16x32_bf16 a[168:171], v[24:27], v[76:79], a[168:171]
    s_mov_b32 m0, s26
    v_exp_f32 v17, v177
    v_mfma_f32_16x16x32_bf16 a[168:171], v[28:31], v[92:95], a[168:171]
    s_waitcnt lgkmcnt(2)
    v_mul_f32_e64 v50, -v50, v48
    v_mul_f32_e64 v51, -v51, v49
    v_mfma_f32_16x16x32_bf16 a[28:31], v[32:35], v[64:67], a[28:31]
    ds_read_b128 v[24:27], v1 offset:9216
    v_cvt_f32_i32 v226, v226
    v_mfma_f32_16x16x32_bf16 a[28:31], v[36:39], v[80:83], a[28:31]
    v_exp_f32 v18, v178
    v_mfma_f32_16x16x32_bf16 a[76:79], v[32:35], v[68:71], a[76:79]
    v_add_f32 v5, v5, v16
    v_add_f32 v5, v5, v17
    v_mfma_f32_16x16x32_bf16 a[76:79], v[36:39], v[84:87], a[76:79]
    buffer_load_dwordx4 v4, s[4:7], s32 offen offset:0 sc1 lds
    v_mfma_f32_16x16x32_bf16 a[124:127], v[32:35], v[72:75], a[124:127]
    ds_read_b128 v[28:31], v1 offset:21504
    v_cvt_f32_i32 v227, v227
    v_mfma_f32_16x16x32_bf16 a[124:127], v[36:39], v[88:91], a[124:127]
    v_exp_f32 v19, v179
    v_cvt_pk_bf16_f32 v176, v16, v17
    v_mfma_f32_16x16x32_bf16 a[172:175], v[32:35], v[76:79], a[172:175]
    v_exp_f32 v16, v112
    v_mfma_f32_16x16x32_bf16 a[172:175], v[36:39], v[92:95], a[172:175]
    s_waitcnt lgkmcnt(2)
    buffer_load_dwordx4 v4, s[4:7], s32 offen offset:1024 sc1 lds
    v_mfma_f32_16x16x32_bf16 a[32:35], v[40:43], v[64:67], a[32:35]
    ds_read_b128 v[32:35], v1 offset:10240
    v_add_f32 v5, v5, v18
    v_mfma_f32_16x16x32_bf16 a[32:35], v[44:47], v[80:83], a[32:35]
    v_add_f32 v5, v5, v19
    v_fma_f32 v226, v226, v48, v50
    v_mfma_f32_16x16x32_bf16 a[80:83], v[40:43], v[68:71], a[80:83]
    v_exp_f32 v17, v113
    v_mfma_f32_16x16x32_bf16 a[80:83], v[44:47], v[84:87], a[80:83]
    v_cvt_pk_bf16_f32 v177, v18, v19
    v_fma_f32 v227, v227, v49, v51
    v_mfma_f32_16x16x32_bf16 a[128:131], v[40:43], v[72:75], a[128:131]
    ds_read_b128 v[36:39], v1 offset:22528
    v_cvt_pk_bf16_f32 v225, v226, v227
    v_mfma_f32_16x16x32_bf16 a[128:131], v[44:47], v[88:91], a[128:131]
    buffer_load_dwordx4 v4, s[4:7], s32 offen offset:2048 sc1 lds
    v_mfma_f32_16x16x32_bf16 a[176:179], v[40:43], v[76:79], a[176:179]
    v_exp_f32 v18, v114
    v_mfma_f32_16x16x32_bf16 a[176:179], v[44:47], v[92:95], a[176:179]
    s_waitcnt lgkmcnt(2)
    v_add_f32 v5, v5, v16
    v_add_f32 v5, v5, v17
    v_mfma_f32_16x16x32_bf16 a[36:39], v[24:27], v[64:67], a[36:39]
    ds_read_b128 v[40:43], v1 offset:11264
    v_cvt_f32_i32 v230, v230
    v_mfma_f32_16x16x32_bf16 a[36:39], v[28:31], v[80:83], a[36:39]
    v_exp_f32 v19, v115
    v_cvt_pk_bf16_f32 v178, v16, v17
    v_mfma_f32_16x16x32_bf16 a[84:87], v[24:27], v[68:71], a[84:87]
    v_exp_f32 v16, v180
    v_mfma_f32_16x16x32_bf16 a[84:87], v[28:31], v[84:87], a[84:87]
    s_add_u32 s32, s32, 24576
    v_add_u32 v2, s3, v2
    v_add_f32 v5, v5, v18
    v_mfma_f32_16x16x32_bf16 a[132:135], v[24:27], v[72:75], a[132:135]
    s_add_u32 s26, s26, 36864
    ds_read_b128 v[44:47], v1 offset:23552
    v_add_u32 v3, s3, v3
    v_mfma_f32_16x16x32_bf16 a[132:135], v[28:31], v[88:91], a[132:135]
    s_waitcnt lgkmcnt(2)
    v_add_f32 v5, v5, v19
    v_cvt_f32_i32 v231, v231
    v_mfma_f32_16x16x32_bf16 a[180:183], v[24:27], v[76:79], a[180:183]
    s_waitcnt vmcnt(13)
    v_exp_f32 v17, v181
    v_mfma_f32_16x16x32_bf16 a[180:183], v[28:31], v[92:95], a[180:183]
    s_barrier
    v_fma_f32 v230, v230, v48, v50
    v_cvt_pk_bf16_f32 v179, v18, v19
    v_mfma_f32_16x16x32_bf16 a[40:43], v[32:35], v[64:67], a[40:43]
    s_sub_u32 s57, s26, 147456
    ds_read_b128 v[24:27], v2 offset:0
    v_fma_f32 v231, v231, v49, v51
    v_mfma_f32_16x16x32_bf16 a[40:43], v[36:39], v[80:83], a[40:43]
    v_exp_f32 v18, v182
    v_mfma_f32_16x16x32_bf16 a[88:91], v[32:35], v[68:71], a[88:91]
    s_min_u32 s26, s26, s57
    v_add_f32 v6, v6, v16
    v_add_f32 v6, v6, v17
    v_mfma_f32_16x16x32_bf16 a[88:91], v[36:39], v[84:87], a[88:91]
    v_exp_f32 v19, v183
    v_mfma_f32_16x16x32_bf16 a[136:139], v[32:35], v[72:75], a[136:139]
    ds_read_b128 v[28:31], v3 offset:0
    v_cvt_pk_bf16_f32 v229, v230, v231
    v_mfma_f32_16x16x32_bf16 a[136:139], v[36:39], v[88:91], a[136:139]
    v_cvt_pk_bf16_f32 v180, v16, v17
    v_cvt_f32_i32 v234, v234
    v_mfma_f32_16x16x32_bf16 a[184:187], v[32:35], v[76:79], a[184:187]
    v_exp_f32 v16, v116
    v_mfma_f32_16x16x32_bf16 a[184:187], v[36:39], v[92:95], a[184:187]
    s_waitcnt lgkmcnt(2)
    v_add_f32 v6, v6, v18
    v_cvt_f32_i32 v235, v235
    v_mfma_f32_16x16x32_bf16 a[44:47], v[40:43], v[64:67], a[44:47]
    ds_read_b128 v[32:35], v2 offset:6144
    v_add_f32 v6, v6, v19
    v_mfma_f32_16x16x32_bf16 a[44:47], v[44:47], v[80:83], a[44:47]
    v_exp_f32 v17, v117
    v_mfma_f32_16x16x32_bf16 a[92:95], v[40:43], v[68:71], a[92:95]
    v_fma_f32 v234, v234, v48, v50
    v_cvt_pk_bf16_f32 v181, v18, v19
    v_mfma_f32_16x16x32_bf16 a[92:95], v[44:47], v[84:87], a[92:95]
    v_fma_f32 v235, v235, v49, v51
    v_cvt_pk_bf16_f32 v233, v234, v235
    v_mfma_f32_16x16x32_bf16 a[140:143], v[40:43], v[72:75], a[140:143]
    ds_read_b128 v[36:39], v3 offset:6144
    v_cvt_f32_i32 v238, v238
    v_mfma_f32_16x16x32_bf16 a[140:143], v[44:47], v[88:91], a[140:143]
    v_exp_f32 v18, v118
    v_mfma_f32_16x16x32_bf16 a[188:191], v[40:43], v[76:79], a[188:191]
    v_add_f32 v6, v6, v16
    v_add_f32 v6, v6, v17
    v_mfma_f32_16x16x32_bf16 a[188:191], v[44:47], v[92:95], a[188:191]
    s_waitcnt lgkmcnt(2)
    v_exp_f32 v19, v119
    v_cvt_pk_bf16_f32 v182, v16, v17
    v_cvt_f32_i32 v239, v239
    v_add_f32 v6, v6, v18
    v_fma_f32 v238, v238, v48, v50
    v_add_f32 v6, v6, v19
    v_fma_f32 v239, v239, v49, v51
    v_cvt_pk_bf16_f32 v183, v18, v19
    v_cvt_pk_bf16_f32 v237, v238, v239
    v_mfma_f32_16x16x32_bf16 v[64:67], v[24:27], a[192:195], v[128:131]
    ds_read_b128 v[40:43], v2 offset:128
    v_mfma_f32_16x16x32_bf16 v[64:67], v[28:31], a[196:199], v[64:67]
    v_exp_f32 v16, v184
    v_mfma_f32_16x16x32_bf16 v[68:71], v[24:27], a[216:219], v[132:135]
    v_exp_f32 v17, v185
    v_mfma_f32_16x16x32_bf16 v[68:71], v[28:31], a[220:223], v[68:71]
    v_bfe_u32 v53, v4, 4, 6
    v_mfma_f32_16x16x32_bf16 v[72:75], v[24:27], a[240:243], v[136:139]
    ds_read_b128 v[44:47], v3 offset:128
    v_lshlrev_b32 v53, 2, v53
    v_mfma_f32_16x16x32_bf16 v[72:75], v[28:31], a[244:247], v[72:75]
    v_exp_f32 v18, v186
    v_mfma_f32_16x16x32_bf16 v[76:79], v[24:27], v[200:203], v[140:143]
    v_add_f32 v7, v7, v16
    v_add_f32 v7, v7, v17
    v_mfma_f32_16x16x32_bf16 v[76:79], v[28:31], v[204:207], v[76:79]
    s_waitcnt lgkmcnt(2)
    buffer_load_dword v52, v53, s[20:23], s44 offen sc1
    v_mfma_f32_16x16x32_bf16 v[96:99], v[32:35], a[192:195], v[128:131]
    ds_read_b128 v[24:27], v2 offset:6272
    v_mfma_f32_16x16x32_bf16 v[96:99], v[36:39], a[196:199], v[96:99]
    v_exp_f32 v19, v187
    v_mfma_f32_16x16x32_bf16 v[100:103], v[32:35], a[216:219], v[132:135]
    v_cvt_pk_bf16_f32 v184, v16, v17
    v_mfma_f32_16x16x32_bf16 v[100:103], v[36:39], a[220:223], v[100:103]
    s_add_u32 s35, s35, 196608
    v_exp_f32 v16, v120
    v_mfma_f32_16x16x32_bf16 v[104:107], v[32:35], a[240:243], v[136:139]
    s_add_u32 s16, s16, 196608
    ds_read_b128 v[28:31], v3 offset:6272
    v_add_f32 v7, v7, v18
    v_mfma_f32_16x16x32_bf16 v[104:107], v[36:39], a[244:247], v[104:107]
    s_add_u32 s17, s17, 196608
    v_add_f32 v7, v7, v19
    v_mfma_f32_16x16x32_bf16 v[108:111], v[32:35], v[200:203], v[140:143]
    v_exp_f32 v17, v121
    v_mfma_f32_16x16x32_bf16 v[108:111], v[36:39], v[204:207], v[108:111]
    s_waitcnt lgkmcnt(2)
    v_cvt_pk_bf16_f32 v185, v18, v19
    s_add_u32 s37, s37, 512
    v_mfma_f32_16x16x32_bf16 v[64:67], v[40:43], a[200:203], v[64:67]
    ds_read_b128 v[32:35], v2 offset:256
    v_mfma_f32_16x16x32_bf16 v[64:67], v[44:47], a[204:207], v[64:67]
    v_exp_f32 v18, v122
    v_mfma_f32_16x16x32_bf16 v[68:71], v[40:43], a[224:227], v[68:71]
    v_add_f32 v7, v7, v16
    v_add_f32 v7, v7, v17
    v_mfma_f32_16x16x32_bf16 v[68:71], v[44:47], a[228:231], v[68:71]
    buffer_load_dwordx2 v[56:57], off, s[80:83], s37 offset:0
    v_mfma_f32_16x16x32_bf16 v[72:75], v[40:43], a[248:251], v[72:75]
    ds_read_b128 v[36:39], v3 offset:256
    v_mfma_f32_16x16x32_bf16 v[72:75], v[44:47], a[252:255], v[72:75]
    v_exp_f32 v19, v123
    v_mfma_f32_16x16x32_bf16 v[76:79], v[40:43], v[208:211], v[76:79]
    v_cvt_pk_bf16_f32 v186, v16, v17
    v_mfma_f32_16x16x32_bf16 v[76:79], v[44:47], v[212:215], v[76:79]
    s_waitcnt lgkmcnt(2)
    buffer_load_dwordx2 v[58:59], off, s[84:87], s37 offset:0
    v_mfma_f32_16x16x32_bf16 v[96:99], v[24:27], a[200:203], v[96:99]
    ds_read_b128 v[40:43], v2 offset:6400
    v_mfma_f32_16x16x32_bf16 v[96:99], v[28:31], a[204:207], v[96:99]
    v_exp_f32 v16, v188
    v_mfma_f32_16x16x32_bf16 v[100:103], v[24:27], a[224:227], v[100:103]
    v_add_f32 v7, v7, v18
    v_add_f32 v7, v7, v19
    v_mfma_f32_16x16x32_bf16 v[100:103], v[28:31], a[228:231], v[100:103]
    buffer_load_dwordx4 v[144:147], v12, s[68:71], s35 offen offset:0 nt
    v_mfma_f32_16x16x32_bf16 v[104:107], v[24:27], a[248:251], v[104:107]
    ds_read_b128 v[44:47], v3 offset:6400
    v_mfma_f32_16x16x32_bf16 v[104:107], v[28:31], a[252:255], v[104:107]
    v_exp_f32 v17, v189
    v_mfma_f32_16x16x32_bf16 v[108:111], v[24:27], v[208:211], v[108:111]
    s_add_u32 s29, s30, 49152
    v_cvt_pk_bf16_f32 v187, v18, v19
    v_mfma_f32_16x16x32_bf16 v[108:111], v[28:31], v[212:215], v[108:111]
    s_waitcnt lgkmcnt(2)
    buffer_load_dwordx4 v[148:151], v12, s[68:71], s35 offen offset:768 nt
    v_mfma_f32_16x16x32_bf16 v[64:67], v[32:35], a[208:211], v[64:67]
    ds_read_b128 v[24:27], v2 offset:12288
    v_mfma_f32_16x16x32_bf16 v[64:67], v[36:39], a[212:215], v[64:67]
    s_sub_u32 s3, s29, 147456
    v_exp_f32 v18, v190
    v_mfma_f32_16x16x32_bf16 v[68:71], v[32:35], a[232:235], v[68:71]
    v_add_f32 v8, v8, v16
    v_add_f32 v8, v8, v17
    v_mfma_f32_16x16x32_bf16 v[68:71], v[36:39], a[236:239], v[68:71]
    buffer_load_dwordx4 v[152:155], v12, s[68:71], s35 offen offset:1536 nt
    v_mfma_f32_16x16x32_bf16 v[72:75], v[32:35], v[192:195], v[72:75]
    ds_read_b128 v[28:31], v3 offset:12288
    v_mfma_f32_16x16x32_bf16 v[72:75], v[36:39], v[196:199], v[72:75]
    v_exp_f32 v19, v191
    v_mfma_f32_16x16x32_bf16 v[76:79], v[32:35], v[216:219], v[76:79]
    v_cvt_pk_bf16_f32 v188, v16, v17
    v_mfma_f32_16x16x32_bf16 v[76:79], v[36:39], v[220:223], v[76:79]
    s_waitcnt lgkmcnt(2)
    buffer_load_dwordx4 v[156:159], v12, s[68:71], s35 offen offset:2304 nt
    v_mfma_f32_16x16x32_bf16 v[96:99], v[40:43], a[208:211], v[96:99]
    s_waitcnt vmcnt(13)
    ds_read_b128 v[32:35], v2 offset:18432
    v_mfma_f32_16x16x32_bf16 v[96:99], v[44:47], a[212:215], v[96:99]
    s_mov_b32 m0, s26
    v_exp_f32 v16, v124
    v_mfma_f32_16x16x32_bf16 v[100:103], v[40:43], a[232:235], v[100:103]
    s_min_u32 s29, s29, s3
    v_add_f32 v8, v8, v18
    v_add_f32 v8, v8, v19
    v_mfma_f32_16x16x32_bf16 v[100:103], v[44:47], a[236:239], v[100:103]
    v_exp_f32 v17, v125
    v_mfma_f32_16x16x32_bf16 v[104:107], v[40:43], v[192:195], v[104:107]
    ds_read_b128 v[36:39], v3 offset:18432
    v_cvt_pk_bf16_f32 v189, v18, v19
    v_mfma_f32_16x16x32_bf16 v[104:107], v[44:47], v[196:199], v[104:107]
    buffer_load_dwordx4 v4, s[4:7], s32 offen offset:0 sc1 lds
    v_mfma_f32_16x16x32_bf16 v[108:111], v[40:43], v[216:219], v[108:111]
    v_exp_f32 v18, v126
    v_mfma_f32_16x16x32_bf16 v[108:111], v[44:47], v[220:223], v[108:111]
    s_waitcnt lgkmcnt(2)
    v_add_f32 v8, v8, v16
    v_add_f32 v8, v8, v17
    v_mfma_f32_16x16x32_bf16 v[80:83], v[24:27], a[192:195], v[128:131]
    ds_read_b128 v[40:43], v2 offset:12416
    v_lshlrev_b32 v48, 16, v60
    v_mfma_f32_16x16x32_bf16 v[80:83], v[28:31], a[196:199], v[80:83]
    s_sub_u32 s3, s29, s30
    v_exp_f32 v19, v127
    v_mfma_f32_16x16x32_bf16 v[84:87], v[24:27], a[216:219], v[132:135]
    v_cvt_pk_bf16_f32 v190, v16, v17
    v_add_f32 v8, v8, v18
    v_add_f32 v8, v8, v19
    v_cvt_pk_bf16_f32 v191, v18, v19
    v_mfma_f32_16x16x32_bf16 v[84:87], v[28:31], a[220:223], v[84:87]
    buffer_load_dwordx4 v4, s[4:7], s32 offen offset:1024 sc1 lds
    v_mfma_f32_16x16x32_bf16 v[88:91], v[24:27], a[240:243], v[136:139]
    ds_read_b128 v[44:47], v3 offset:12416
    v_and_b32 v49, s97, v60
    v_mfma_f32_16x16x32_bf16 v[88:91], v[28:31], a[244:247], v[88:91]
    v_lshlrev_b32 v50, 16, v62
    v_and_b32 v51, s97, v62
    v_mfma_f32_16x16x32_bf16 v[92:95], v[24:27], v[200:203], v[140:143]
    v_exp_f32 v16, v64
    v_mfma_f32_16x16x32_bf16 v[92:95], v[28:31], v[204:207], v[92:95]
    s_waitcnt lgkmcnt(2)
    v_exp_f32 v17, v65
    v_mfma_f32_16x16x32_bf16 v[112:115], v[32:35], a[192:195], v[128:131]
    ds_read_b128 v[24:27], v2 offset:18560
    v_mul_f32 v48, s38, v48
    v_mfma_f32_16x16x32_bf16 v[112:115], v[36:39], a[196:199], v[112:115]
    s_mov_b32 s30, s29
    buffer_load_dwordx4 v4, s[4:7], s32 offen offset:2048 sc1 lds
    v_mfma_f32_16x16x32_bf16 v[116:119], v[32:35], a[216:219], v[132:135]
    v_exp_f32 v18, v66
    v_mfma_f32_16x16x32_bf16 v[116:119], v[36:39], a[220:223], v[116:119]
    v_add_f32 v5, v5, v16
    v_add_f32 v5, v5, v17
    v_mfma_f32_16x16x32_bf16 v[120:123], v[32:35], a[240:243], v[136:139]
    ds_read_b128 v[28:31], v3 offset:18560
    v_mul_f32 v49, s38, v49
    v_mfma_f32_16x16x32_bf16 v[120:123], v[36:39], a[244:247], v[120:123]
    s_add_u32 s32, s32, 24576
    v_exp_f32 v19, v67
    v_mfma_f32_16x16x32_bf16 v[124:127], v[32:35], v[200:203], v[140:143]
    v_cvt_pk_bf16_f32 v64, v16, v17
    v_mul_f32_e64 v50, -v50, v48
    v_mfma_f32_16x16x32_bf16 v[124:127], v[36:39], v[204:207], v[124:127]
    s_waitcnt lgkmcnt(2)
    v_exp_f32 v16, v96
    v_mfma_f32_16x16x32_bf16 v[80:83], v[40:43], a[200:203], v[80:83]
    s_add_u32 s26, s26, 12288
    ds_read_b128 v[32:35], v2 offset:12544
    v_add_f32 v5, v5, v18
    v_mfma_f32_16x16x32_bf16 v[80:83], v[44:47], a[204:207], v[80:83]
    v_add_f32 v5, v5, v19
    v_mul_f32_e64 v51, -v51, v49
    v_mfma_f32_16x16x32_bf16 v[84:87], v[40:43], a[224:227], v[84:87]
    v_exp_f32 v17, v97
    v_mfma_f32_16x16x32_bf16 v[84:87], v[44:47], a[228:231], v[84:87]
    s_mov_b32 m0, s26
    v_cvt_f32_i32 v240, v240
    v_cvt_pk_bf16_f32 v65, v18, v19
    v_mfma_f32_16x16x32_bf16 v[88:91], v[40:43], a[248:251], v[88:91]
    ds_read_b128 v[36:39], v3 offset:12544
    v_cvt_f32_i32 v241, v241
    v_mfma_f32_16x16x32_bf16 v[88:91], v[44:47], a[252:255], v[88:91]
    v_exp_f32 v18, v98
    v_mfma_f32_16x16x32_bf16 v[92:95], v[40:43], v[208:211], v[92:95]
    v_add_f32 v5, v5, v16
    v_add_f32 v5, v5, v17
    v_mfma_f32_16x16x32_bf16 v[92:95], v[44:47], v[212:215], v[92:95]
    s_waitcnt lgkmcnt(2)
    v_exp_f32 v19, v99
    v_mfma_f32_16x16x32_bf16 v[112:115], v[24:27], a[200:203], v[112:115]
    ds_read_b128 v[40:43], v2 offset:18688
    v_fma_f32 v240, v240, v48, v50
    v_mfma_f32_16x16x32_bf16 v[112:115], v[28:31], a[204:207], v[112:115]
    buffer_load_dwordx4 v4, s[4:7], s32 offen offset:0 sc1 lds
    v_mfma_f32_16x16x32_bf16 v[116:119], v[24:27], a[224:227], v[116:119]
    v_cvt_pk_bf16_f32 v66, v16, v17
    v_fma_f32 v241, v241, v49, v51
    v_mfma_f32_16x16x32_bf16 v[116:119], v[28:31], a[228:231], v[116:119]
    v_exp_f32 v16, v68
    v_mfma_f32_16x16x32_bf16 v[120:123], v[24:27], a[248:251], v[120:123]
    ds_read_b128 v[44:47], v3 offset:18688
    v_add_u32 v1, s3, v1
    v_mfma_f32_16x16x32_bf16 v[120:123], v[28:31], a[252:255], v[120:123]
    s_waitcnt lgkmcnt(2)
    v_add_f32 v5, v5, v18
    v_add_f32 v5, v5, v19
    v_mfma_f32_16x16x32_bf16 v[124:127], v[24:27], v[208:211], v[124:127]
    s_waitcnt vmcnt(34)
    v_exp_f32 v17, v69
    v_mfma_f32_16x16x32_bf16 v[124:127], v[28:31], v[212:215], v[124:127]
    s_barrier
    v_cvt_pk_bf16_f32 v226, v240, v241
    v_mfma_f32_16x16x32_bf16 v[80:83], v[32:35], a[208:211], v[80:83]
    ds_read_b128 v[24:27], v1 offset:0
    v_cvt_pk_bf16_f32 v67, v18, v19
    v_mfma_f32_16x16x32_bf16 v[80:83], v[36:39], a[212:215], v[80:83]
    buffer_load_dwordx4 v4, s[4:7], s32 offen offset:1024 sc1 lds
    v_mfma_f32_16x16x32_bf16 v[84:87], v[32:35], a[232:235], v[84:87]
    v_exp_f32 v18, v70
    v_mfma_f32_16x16x32_bf16 v[84:87], v[36:39], a[236:239], v[84:87]
    v_add_f32 v6, v6, v16
    v_add_f32 v6, v6, v17
    v_mfma_f32_16x16x32_bf16 v[88:91], v[32:35], v[192:195], v[88:91]
    ds_read_b128 v[28:31], v1 offset:12288
    v_cvt_f32_i32 v244, v244
    v_mfma_f32_16x16x32_bf16 v[88:91], v[36:39], v[196:199], v[88:91]
    buffer_load_dwordx4 v4, s[4:7], s32 offen offset:2048 sc1 lds
    v_mfma_f32_16x16x32_bf16 v[92:95], v[32:35], v[216:219], v[92:95]
    v_exp_f32 v19, v71
    v_mfma_f32_16x16x32_bf16 v[92:95], v[36:39], v[220:223], v[92:95]
    s_waitcnt lgkmcnt(2)
    v_cvt_pk_bf16_f32 v68, v16, v17
    v_exp_f32 v16, v100
    v_mfma_f32_16x16x32_bf16 v[112:115], v[40:43], a[208:211], v[112:115]
    ds_read_b128 v[32:35], v1 offset:1024
    v_cvt_f32_i32 v245, v245
    v_mfma_f32_16x16x32_bf16 v[112:115], v[44:47], a[212:215], v[112:115]
    v_add_f32 v6, v6, v18
    v_add_f32 v6, v6, v19
    v_fma_f32 v244, v244, v48, v50
    v_mfma_f32_16x16x32_bf16 v[116:119], v[40:43], a[232:235], v[116:119]
    v_exp_f32 v17, v101
    v_mfma_f32_16x16x32_bf16 v[116:119], v[44:47], a[236:239], v[116:119]
    s_add_u32 s32, s32, 24576
    v_fma_f32 v245, v245, v49, v51
    v_cvt_pk_bf16_f32 v69, v18, v19
    v_mfma_f32_16x16x32_bf16 v[120:123], v[40:43], v[192:195], v[120:123]
    s_add_u32 s26, s26, 36864
    ds_read_b128 v[36:39], v1 offset:13312
    v_cvt_pk_bf16_f32 v230, v244, v245
    v_mfma_f32_16x16x32_bf16 v[120:123], v[44:47], v[196:199], v[120:123]
    s_sub_u32 s57, s26, 147456
    v_exp_f32 v18, v102
    v_mfma_f32_16x16x32_bf16 v[124:127], v[40:43], v[216:219], v[124:127]
    s_min_u32 s26, s26, s57
    v_add_f32 v6, v6, v16
    v_add_f32 v6, v6, v17
    v_mfma_f32_16x16x32_bf16 v[124:127], v[44:47], v[220:223], v[124:127]
    s_waitcnt lgkmcnt(2)
    v_exp_f32 v19, v103
    v_cvt_f32_i32 v248, v248
    v_cvt_f32_i32 v249, v249
    v_cvt_pk_bf16_f32 v70, v16, v17
    v_fma_f32 v248, v248, v48, v50
    v_add_f32 v6, v6, v18
    v_fma_f32 v249, v249, v49, v51
    v_add_f32 v6, v6, v19
    v_cvt_pk_bf16_f32 v234, v248, v249
    v_cvt_pk_bf16_f32 v71, v18, v19
    v_cvt_f32_i32 v252, v252
    v_mfma_f32_16x16x32_bf16 a[0:3], v[24:27], v[160:163], a[0:3]
    ds_read_b128 v[40:43], v1 offset:2048
    v_cvt_f32_i32 v253, v253
    v_mfma_f32_16x16x32_bf16 a[0:3], v[28:31], v[176:179], a[0:3]
    s_waitcnt vmcnt(12)
    v_subrev_u32 v52, s92, v52
    v_cmp_lt_u32 vcc, 15, v52
    v_mfma_f32_16x16x32_bf16 a[48:51], v[24:27], v[164:167], a[48:51]
    v_exp_f32 v16, v72
    v_mfma_f32_16x16x32_bf16 a[48:51], v[28:31], v[180:183], a[48:51]
    v_exp_f32 v17, v73
    v_mfma_f32_16x16x32_bf16 a[96:99], v[24:27], v[168:171], a[96:99]
    s_and_b32 s59, vcc_lo, 0xff
    ds_read_b128 v[44:47], v1 offset:14336
    v_fma_f32 v252, v252, v48, v50
    v_mfma_f32_16x16x32_bf16 a[96:99], v[28:31], v[184:187], a[96:99]
    s_cbranch_scc1 L_pollslow2
L_pollok2:
    v_mfma_f32_16x16x32_bf16 a[144:147], v[24:27], v[172:175], a[144:147]
    s_add_u32 s92, s92, 1
    v_exp_f32 v18, v74
    v_mfma_f32_16x16x32_bf16 a[144:147], v[28:31], v[188:191], a[144:147]
    s_waitcnt lgkmcnt(2)
    v_add_f32 v7, v7, v16
    v_add_f32 v7, v7, v17
    v_mfma_f32_16x16x32_bf16 a[4:7], v[32:35], v[160:163], a[4:7]
    s_mov_b32 m0, s56
    ds_read_b128 v[24:27], v1 offset:3072
    v_fma_f32 v253, v253, v49, v51
    v_mfma_f32_16x16x32_bf16 a[4:7], v[36:39], v[176:179], a[4:7]
    v_exp_f32 v19, v75
    v_mfma_f32_16x16x32_bf16 a[52:55], v[32:35], v[164:167], a[52:55]
    v_cvt_pk_bf16_f32 v72, v16, v17
    v_cvt_pk_bf16_f32 v238, v252, v253
    v_mfma_f32_16x16x32_bf16 a[52:55], v[36:39], v[180:183], a[52:55]
    buffer_load_dwordx4 v4, s[4:7], s27 offen offset:0 sc1 lds
    v_mfma_f32_16x16x32_bf16 a[100:103], v[32:35], v[168:171], a[100:103]
    ds_read_b128 v[28:31], v1 offset:15360
    v_lshlrev_b32 v48, 16, v61
    v_mfma_f32_16x16x32_bf16 a[100:103], v[36:39], v[184:187], a[100:103]
    v_exp_f32 v16, v104
    v_mfma_f32_16x16x32_bf16 a[148:151], v[32:35], v[172:175], a[148:151]
    v_add_f32 v7, v7, v18
    v_add_f32 v7, v7, v19
    v_mfma_f32_16x16x32_bf16 a[148:151], v[36:39], v[188:191], a[148:151]
    s_waitcnt lgkmcnt(2)
    buffer_load_dwordx4 v4, s[4:7], s27 offen offset:1024 sc1 lds
    v_mfma_f32_16x16x32_bf16 a[8:11], v[40:43], v[160:163], a[8:11]
    ds_read_b128 v[32:35], v1 offset:4096
    v_and_b32 v49, s97, v61
    v_mfma_f32_16x16x32_bf16 a[8:11], v[44:47], v[176:179], a[8:11]
    v_exp_f32 v17, v105
    v_mfma_f32_16x16x32_bf16 a[56:59], v[40:43], v[164:167], a[56:59]
    v_cvt_pk_bf16_f32 v73, v18, v19
    v_lshlrev_b32 v50, 16, v63
    v_mfma_f32_16x16x32_bf16 a[56:59], v[44:47], v[180:183], a[56:59]
    buffer_load_dwordx4 v4, s[4:7], s27 offen offset:2048 sc1 lds
    v_mfma_f32_16x16x32_bf16 a[104:107], v[40:43], v[168:171], a[104:107]
    ds_read_b128 v[36:39], v1 offset:16384
    v_and_b32 v51, s97, v63
    v_mfma_f32_16x16x32_bf16 a[104:107], v[44:47], v[184:187], a[104:107]
    v_exp_f32 v18, v106
    v_mfma_f32_16x16x32_bf16 a[152:155], v[40:43], v[172:175], a[152:155]
    v_add_f32 v7, v7, v16
    v_add_f32 v7, v7, v17
    v_mfma_f32_16x16x32_bf16 a[152:155], v[44:47], v[188:191], a[152:155]
    s_waitcnt lgkmcnt(2)
    v_exp_f32 v19, v107
    v_mfma_f32_16x16x32_bf16 a[12:15], v[24:27], v[160:163], a[12:15]
    s_add_u32 s27, s27, 24576
    ds_read_b128 v[40:43], v1 offset:5120
    v_cvt_pk_bf16_f32 v74, v16, v17
    v_mfma_f32_16x16x32_bf16 a[12:15], v[28:31], v[176:179], a[12:15]
    s_add_u32 s56, s56, 12288
    v_exp_f32 v16, v76
    v_mfma_f32_16x16x32_bf16 a[60:63], v[24:27], v[164:167], a[60:63]
    v_add_f32 v7, v7, v18
    v_add_f32 v7, v7, v19
    v_mfma_f32_16x16x32_bf16 a[60:63], v[28:31], v[180:183], a[60:63]
    v_exp_f32 v17, v77
    v_mfma_f32_16x16x32_bf16 a[108:111], v[24:27], v[168:171], a[108:111]
    s_mov_b32 m0, s56
    ds_read_b128 v[44:47], v1 offset:17408
    v_cvt_pk_bf16_f32 v75, v18, v19
    v_mfma_f32_16x16x32_bf16 a[108:111], v[28:31], v[184:187], a[108:111]
    v_exp_f32 v18, v78
    v_mfma_f32_16x16x32_bf16 a[156:159], v[24:27], v[172:175], a[156:159]
    s_add_u32 s29, s28, 49152
    v_add_f32 v8, v8, v16
    v_mul_f32 v48, s38, v48
    v_mfma_f32_16x16x32_bf16 a[156:159], v[28:31], v[188:191], a[156:159]
    s_waitcnt lgkmcnt(2)
    buffer_load_dwordx4 v4, s[4:7], s27 offen offset:0 sc1 lds
    v_mfma_f32_16x16x32_bf16 a[16:19], v[32:35], v[160:163], a[16:19]
    ds_read_b128 v[24:27], v1 offset:6144
    v_add_f32 v8, v8, v17
    v_mfma_f32_16x16x32_bf16 a[16:19], v[36:39], v[176:179], a[16:19]
    s_sub_u32 s3, s29, 147456
    v_exp_f32 v19, v79
    v_mfma_f32_16x16x32_bf16 a[64:67], v[32:35], v[164:167], a[64:67]
    v_cvt_pk_bf16_f32 v76, v16, v17
    v_mul_f32 v49, s38, v49
    v_mfma_f32_16x16x32_bf16 a[64:67], v[36:39], v[180:183], a[64:67]
    v_exp_f32 v16, v108
    v_mfma_f32_16x16x32_bf16 a[112:115], v[32:35], v[168:171], a[112:115]
    ds_read_b128 v[28:31], v1 offset:18432
    v_add_f32 v8, v8, v18
    v_mfma_f32_16x16x32_bf16 a[112:115], v[36:39], v[184:187], a[112:115]
    buffer_load_dwordx4 v4, s[4:7], s27 offen offset:1024 sc1 lds
    v_mfma_f32_16x16x32_bf16 a[160:163], v[32:35], v[172:175], a[160:163]
    v_add_f32 v8, v8, v19
    v_mul_f32_e64 v50, -v50, v48
    v_mfma_f32_16x16x32_bf16 a[160:163], v[36:39], v[188:191], a[160:163]
    s_waitcnt lgkmcnt(2)
    v_exp_f32 v17, v109
    v_mfma_f32_16x16x32_bf16 a[20:23], v[40:43], v[160:163], a[20:23]
    s_min_u32 s29, s29, s3
    ds_read_b128 v[32:35], v1 offset:7168
    v_cvt_pk_bf16_f32 v77, v18, v19
    v_mfma_f32_16x16x32_bf16 a[20:23], v[44:47], v[176:179], a[20:23]
    buffer_load_dwordx4 v4, s[4:7], s27 offen offset:2048 sc1 lds
    v_mfma_f32_16x16x32_bf16 a[68:71], v[40:43], v[164:167], a[68:71]
    v_exp_f32 v18, v110
    v_mfma_f32_16x16x32_bf16 a[68:71], v[44:47], v[180:183], a[68:71]
    v_add_f32 v8, v8, v16
    v_mul_f32_e64 v51, -v51, v49
    v_mfma_f32_16x16x32_bf16 a[116:119], v[40:43], v[168:171], a[116:119]
    ds_read_b128 v[36:39], v1 offset:19456
    v_add_f32 v8, v8, v17
    v_mfma_f32_16x16x32_bf16 a[116:119], v[44:47], v[184:187], a[116:119]
    v_exp_f32 v19, v111
    v_mfma_f32_16x16x32_bf16 a[164:167], v[40:43], v[172:175], a[164:167]
    s_add_u32 s27, s27, 24576
    v_cvt_f32_i32 v242, v242
    v_cvt_pk_bf16_f32 v78, v16, v17
    v_mfma_f32_16x16x32_bf16 a[164:167], v[44:47], v[188:191], a[164:167]
    s_waitcnt lgkmcnt(2)
    v_add_f32 v8, v8, v18
    v_cvt_f32_i32 v243, v243
    v_mfma_f32_16x16x32_bf16 a[24:27], v[24:27], v[160:163], a[24:27]
    s_add_u32 s56, s56, 36864
    ds_read_b128 v[40:43], v1 offset:8192
    v_add_f32 v8, v8, v19
    v_mfma_f32_16x16x32_bf16 a[24:27], v[28:31], v[176:179], a[24:27]
    s_sub_u32 s3, s29, s28
    v_cvt_pk_bf16_f32 v79, v18, v19
    v_fma_f32 v242, v242, v48, v50
    v_mfma_f32_16x16x32_bf16 a[72:75], v[24:27], v[164:167], a[72:75]
    s_sub_u32 s58, s56, 147456
    v_exp_f32 v16, v80
    v_mfma_f32_16x16x32_bf16 a[72:75], v[28:31], v[180:183], a[72:75]
    v_exp_f32 v17, v81
    v_mfma_f32_16x16x32_bf16 a[120:123], v[24:27], v[168:171], a[120:123]
    ds_read_b128 v[44:47], v1 offset:20480
    v_fma_f32 v243, v243, v49, v51
    v_mfma_f32_16x16x32_bf16 a[120:123], v[28:31], v[184:187], a[120:123]
    s_mov_b32 s28, s29
    v_exp_f32 v18, v82
    v_mfma_f32_16x16x32_bf16 a[168:171], v[24:27], v[172:175], a[168:171]
    s_min_u32 s56, s56, s58
    v_add_f32 v5, v5, v16
    v_cvt_pk_bf16_f32 v227, v242, v243
    v_mfma_f32_16x16x32_bf16 a[168:171], v[28:31], v[188:191], a[168:171]
    s_waitcnt lgkmcnt(2)
    v_add_f32 v5, v5, v17
    v_cvt_f32_i32 v246, v246
    v_mfma_f32_16x16x32_bf16 a[28:31], v[32:35], v[160:163], a[28:31]
    ds_read_b128 v[24:27], v1 offset:9216
    v_cvt_f32_i32 v247, v247
    v_mfma_f32_16x16x32_bf16 a[28:31], v[36:39], v[176:179], a[28:31]
    v_exp_f32 v19, v83
    v_mfma_f32_16x16x32_bf16 a[76:79], v[32:35], v[164:167], a[76:79]
    v_cvt_pk_bf16_f32 v80, v16, v17
    v_fma_f32 v246, v246, v48, v50
    v_mfma_f32_16x16x32_bf16 a[76:79], v[36:39], v[180:183], a[76:79]
    v_exp_f32 v16, v112
    v_mfma_f32_16x16x32_bf16 a[124:127], v[32:35], v[168:171], a[124:127]
    ds_read_b128 v[28:31], v1 offset:21504
    v_add_f32 v5, v5, v18
    v_mfma_f32_16x16x32_bf16 a[124:127], v[36:39], v[184:187], a[124:127]
    v_add_f32 v5, v5, v19
    v_fma_f32 v247, v247, v49, v51
    v_mfma_f32_16x16x32_bf16 a[172:175], v[32:35], v[172:175], a[172:175]
    v_exp_f32 v17, v113
    v_mfma_f32_16x16x32_bf16 a[172:175], v[36:39], v[188:191], a[172:175]
    s_waitcnt lgkmcnt(2)
    v_cvt_pk_bf16_f32 v81, v18, v19
    v_cvt_pk_bf16_f32 v231, v246, v247
    v_mfma_f32_16x16x32_bf16 a[32:35], v[40:43], v[160:163], a[32:35]
    ds_read_b128 v[32:35], v1 offset:10240
    v_add_u32 v2, s3, v2
    v_mfma_f32_16x16x32_bf16 a[32:35], v[44:47], v[176:179], a[32:35]
    v_exp_f32 v18, v114
    v_mfma_f32_16x16x32_bf16 a[80:83], v[40:43], v[164:167], a[80:83]
    v_add_f32 v5, v5, v16
    v_add_f32 v5, v5, v17
    v_mfma_f32_16x16x32_bf16 a[80:83], v[44:47], v[180:183], a[80:83]
    v_exp_f32 v19, v115
    v_mfma_f32_16x16x32_bf16 a[128:131], v[40:43], v[168:171], a[128:131]
    ds_read_b128 v[36:39], v1 offset:22528
    v_cvt_pk_bf16_f32 v82, v16, v17
    v_mfma_f32_16x16x32_bf16 a[128:131], v[44:47], v[184:187], a[128:131]
    v_cvt_f32_i32 v250, v250
    v_cvt_f32_i32 v251, v251
    v_mfma_f32_16x16x32_bf16 a[176:179], v[40:43], v[172:175], a[176:179]
    v_exp_f32 v16, v84
    v_mfma_f32_16x16x32_bf16 a[176:179], v[44:47], v[188:191], a[176:179]
    s_waitcnt lgkmcnt(2)
    v_add_f32 v5, v5, v18
    v_add_f32 v5, v5, v19
    v_mfma_f32_16x16x32_bf16 a[36:39], v[24:27], v[160:163], a[36:39]
    ds_read_b128 v[40:43], v1 offset:11264
    v_add_u32 v3, s3, v3
    v_mfma_f32_16x16x32_bf16 a[36:39], v[28:31], v[176:179], a[36:39]
    v_exp_f32 v17, v85
    v_mfma_f32_16x16x32_bf16 a[84:87], v[24:27], v[164:167], a[84:87]
    v_cvt_pk_bf16_f32 v83, v18, v19
    v_fma_f32 v250, v250, v48, v50
    v_mfma_f32_16x16x32_bf16 a[84:87], v[28:31], v[180:183], a[84:87]
    v_exp_f32 v18, v86
    v_mfma_f32_16x16x32_bf16 a[132:135], v[24:27], v[168:171], a[132:135]
    ds_read_b128 v[44:47], v1 offset:23552
    v_fma_f32 v251, v251, v49, v51
    v_mfma_f32_16x16x32_bf16 a[132:135], v[28:31], v[184:187], a[132:135]
    s_waitcnt lgkmcnt(2)
    v_add_f32 v6, v6, v16
    v_add_f32 v6, v6, v17
    v_mfma_f32_16x16x32_bf16 a[180:183], v[24:27], v[172:175], a[180:183]
    s_waitcnt vmcnt(19)
    v_exp_f32 v19, v87
    v_mfma_f32_16x16x32_bf16 a[180:183], v[28:31], v[188:191], a[180:183]
    s_barrier
    v_cvt_pk_bf16_f32 v235, v250, v251
    v_mfma_f32_16x16x32_bf16 a[40:43], v[32:35], v[160:163], a[40:43]
    ds_read_b128 v[24:27], v2 offset:0
    v_cvt_pk_bf16_f32 v84, v16, v17
    v_mfma_f32_16x16x32_bf16 a[40:43], v[36:39], v[176:179], a[40:43]
    v_exp_f32 v16, v116
    v_mfma_f32_16x16x32_bf16 a[88:91], v[32:35], v[164:167], a[88:91]
    v_cvt_f32_i32 v254, v254
    v_add_f32 v6, v6, v18
    v_mfma_f32_16x16x32_bf16 a[88:91], v[36:39], v[180:183], a[88:91]
    v_add_f32 v6, v6, v19
    v_cvt_f32_i32 v255, v255
    v_mfma_f32_16x16x32_bf16 a[136:139], v[32:35], v[168:171], a[136:139]
    ds_read_b128 v[28:31], v3 offset:0
    v_fma_f32 v254, v254, v48, v50
    v_mfma_f32_16x16x32_bf16 a[136:139], v[36:39], v[184:187], a[136:139]
    v_exp_f32 v17, v117
    v_mfma_f32_16x16x32_bf16 a[184:187], v[32:35], v[172:175], a[184:187]
    v_cvt_pk_bf16_f32 v85, v18, v19
    v_mfma_f32_16x16x32_bf16 a[184:187], v[36:39], v[188:191], a[184:187]
    s_waitcnt lgkmcnt(2)
    v_exp_f32 v18, v118
    v_mfma_f32_16x16x32_bf16 a[44:47], v[40:43], v[160:163], a[44:47]
    ds_read_b128 v[32:35], v2 offset:6144
    v_add_f32 v6, v6, v16
    v_mfma_f32_16x16x32_bf16 a[44:47], v[44:47], v[176:179], a[44:47]
    v_add_f32 v6, v6, v17
    v_fma_f32 v255, v255, v49, v51
    v_mfma_f32_16x16x32_bf16 a[92:95], v[40:43], v[164:167], a[92:95]
    v_exp_f32 v19, v119
    v_mfma_f32_16x16x32_bf16 a[92:95], v[44:47], v[180:183], a[92:95]
    v_cvt_pk_bf16_f32 v86, v16, v17
    v_cvt_pk_bf16_f32 v239, v254, v255
    v_mfma_f32_16x16x32_bf16 a[140:143], v[40:43], v[168:171], a[140:143]
    s_sub_u32 s31, s31, 1
    ds_read_b128 v[36:39], v3 offset:6144
    v_add_f32 v6, v6, v18
    v_mfma_f32_16x16x32_bf16 a[140:143], v[44:47], v[184:187], a[140:143]
    v_add_f32 v6, v6, v19
    v_cvt_pk_bf16_f32 v87, v18, v19
    v_mfma_f32_16x16x32_bf16 a[188:191], v[40:43], v[172:175], a[188:191]
    s_waitcnt lgkmcnt(2)
    s_cmp_lg_u32 s31, 0
    v_mfma_f32_16x16x32_bf16 a[188:191], v[44:47], v[188:191], a[188:191]
    s_cbranch_scc1 L_loop
    v_mfma_f32_16x16x32_bf16 v[160:163], v[24:27], a[192:195], v[128:131]
    s_mov_b32 m0, s26
    ds_read_b128 v[40:43], v2 offset:128
    v_mfma_f32_16x16x32_bf16 v[160:163], v[28:31], a[196:199], v[160:163]
    v_exp_f32 v16, v88
    v_mfma_f32_16x16x32_bf16 v[164:167], v[24:27], a[216:219], v[132:135]
    ds_read_b128 v[44:47], v3 offset:128
    v_mfma_f32_16x16x32_bf16 v[164:167], v[28:31], a[220:223], v[164:167]
    s_waitcnt lgkmcnt(2)
    buffer_load_dwordx4 v4, s[4:7], s32 offen offset:0 sc1 lds
    v_mfma_f32_16x16x32_bf16 v[96:99], v[32:35], a[192:195], v[128:131]
    ds_read_b128 v[24:27], v2 offset:6272
    v_mfma_f32_16x16x32_bf16 v[96:99], v[36:39], a[196:199], v[96:99]
    v_exp_f32 v17, v89
    v_mfma_f32_16x16x32_bf16 v[100:103], v[32:35], a[216:219], v[132:135]
    ds_read_b128 v[28:31], v3 offset:6272
    v_mfma_f32_16x16x32_bf16 v[100:103], v[36:39], a[220:223], v[100:103]
    s_waitcnt lgkmcnt(2)
    buffer_load_dwordx4 v4, s[4:7], s32 offen offset:1024 sc1 lds
    v_mfma_f32_16x16x32_bf16 v[160:163], v[40:43], a[200:203], v[160:163]
    ds_read_b128 v[32:35], v2 offset:256
    v_mfma_f32_16x16x32_bf16 v[160:163], v[44:47], a[204:207], v[160:163]
    v_exp_f32 v18, v90
    v_add_f32 v7, v7, v16
    v_mfma_f32_16x16x32_bf16 v[164:167], v[40:43], a[224:227], v[164:167]
    ds_read_b128 v[36:39], v3 offset:256
    v_add_f32 v7, v7, v17
    v_mfma_f32_16x16x32_bf16 v[164:167], v[44:47], a[228:231], v[164:167]
    s_waitcnt lgkmcnt(2)
    buffer_load_dwordx4 v4, s[4:7], s32 offen offset:2048 sc1 lds
    v_mfma_f32_16x16x32_bf16 v[96:99], v[24:27], a[200:203], v[96:99]
    ds_read_b128 v[40:43], v2 offset:6400
    v_mfma_f32_16x16x32_bf16 v[96:99], v[28:31], a[204:207], v[96:99]
    v_exp_f32 v19, v91
    v_cvt_pk_bf16_f32 v88, v16, v17
    v_mfma_f32_16x16x32_bf16 v[100:103], v[24:27], a[224:227], v[100:103]
    s_add_u32 s32, s32, 24576
    ds_read_b128 v[44:47], v3 offset:6400
    v_mfma_f32_16x16x32_bf16 v[100:103], v[28:31], a[228:231], v[100:103]
    s_waitcnt lgkmcnt(2)
    v_exp_f32 v16, v120
    v_add_f32 v7, v7, v18
    v_mfma_f32_16x16x32_bf16 v[160:163], v[32:35], a[208:211], v[160:163]
    s_add_u32 s26, s26, 12288
    ds_read_b128 v[24:27], v2 offset:12288
    v_add_f32 v7, v7, v19
    v_mfma_f32_16x16x32_bf16 v[160:163], v[36:39], a[212:215], v[160:163]
    v_exp_f32 v17, v121
    v_cvt_pk_bf16_f32 v89, v18, v19
    v_mfma_f32_16x16x32_bf16 v[164:167], v[32:35], a[232:235], v[164:167]
    s_mov_b32 m0, s26
    ds_read_b128 v[28:31], v3 offset:12288
    v_mfma_f32_16x16x32_bf16 v[164:167], v[36:39], a[236:239], v[164:167]
    s_waitcnt lgkmcnt(2)
    v_exp_f32 v18, v122
    v_add_f32 v7, v7, v16
    v_mfma_f32_16x16x32_bf16 v[96:99], v[40:43], a[208:211], v[96:99]
    ds_read_b128 v[32:35], v2 offset:18432
    v_add_f32 v7, v7, v17
    v_mfma_f32_16x16x32_bf16 v[96:99], v[44:47], a[212:215], v[96:99]
    buffer_load_dwordx4 v4, s[4:7], s32 offen offset:0 sc1 lds
    v_mfma_f32_16x16x32_bf16 v[100:103], v[40:43], a[232:235], v[100:103]
    ds_read_b128 v[36:39], v3 offset:18432
    v_mfma_f32_16x16x32_bf16 v[100:103], v[44:47], a[236:239], v[100:103]
    s_waitcnt lgkmcnt(2)
    v_exp_f32 v19, v123
    v_cvt_pk_bf16_f32 v90, v16, v17
    v_mfma_f32_16x16x32_bf16 v[168:171], v[24:27], a[192:195], v[128:131]
    ds_read_b128 v[40:43], v2 offset:12416
    v_mfma_f32_16x16x32_bf16 v[168:171], v[28:31], a[196:199], v[168:171]
    buffer_load_dwordx4 v4, s[4:7], s32 offen offset:1024 sc1 lds
    v_mfma_f32_16x16x32_bf16 v[172:175], v[24:27], a[216:219], v[132:135]
    ds_read_b128 v[44:47], v3 offset:12416
    v_mfma_f32_16x16x32_bf16 v[172:175], v[28:31], a[220:223], v[172:175]
    s_waitcnt lgkmcnt(2)
    v_exp_f32 v16, v92
    v_add_f32 v7, v7, v18
    v_mfma_f32_16x16x32_bf16 v[104:107], v[32:35], a[192:195], v[128:131]
    ds_read_b128 v[24:27], v2 offset:18560
    v_add_f32 v7, v7, v19
    v_mfma_f32_16x16x32_bf16 v[104:107], v[36:39], a[196:199], v[104:107]
    buffer_load_dwordx4 v4, s[4:7], s32 offen offset:2048 sc1 lds
    v_mfma_f32_16x16x32_bf16 v[108:111], v[32:35], a[216:219], v[132:135]
    s_add_u32 s29, s30, 49152
    ds_read_b128 v[28:31], v3 offset:18560
    v_mfma_f32_16x16x32_bf16 v[108:111], v[36:39], a[220:223], v[108:111]
    s_waitcnt lgkmcnt(2)
    v_exp_f32 v17, v93
    v_cvt_pk_bf16_f32 v91, v18, v19
    v_mfma_f32_16x16x32_bf16 v[168:171], v[40:43], a[200:203], v[168:171]
    s_add_u32 s32, s32, 24576
    ds_read_b128 v[32:35], v2 offset:12544
    v_mfma_f32_16x16x32_bf16 v[168:171], v[44:47], a[204:207], v[168:171]
    v_exp_f32 v18, v94
    v_add_f32 v8, v8, v16
    v_mfma_f32_16x16x32_bf16 v[172:175], v[40:43], a[224:227], v[172:175]
    s_add_u32 s26, s26, 36864
    ds_read_b128 v[36:39], v3 offset:12544
    v_add_f32 v8, v8, v17
    v_mfma_f32_16x16x32_bf16 v[172:175], v[44:47], a[228:231], v[172:175]
    s_waitcnt lgkmcnt(2)
    v_exp_f32 v19, v95
    v_cvt_pk_bf16_f32 v92, v16, v17
    v_mfma_f32_16x16x32_bf16 v[104:107], v[24:27], a[200:203], v[104:107]
    s_sub_u32 s3, s29, 147456
    ds_read_b128 v[40:43], v2 offset:18688
    s_sub_u32 s57, s26, 147456
    v_mfma_f32_16x16x32_bf16 v[104:107], v[28:31], a[204:207], v[104:107]
    v_exp_f32 v16, v124
    v_add_f32 v8, v8, v18
    v_mfma_f32_16x16x32_bf16 v[108:111], v[24:27], a[224:227], v[108:111]
    s_min_u32 s26, s26, s57
    ds_read_b128 v[44:47], v3 offset:18688
    v_add_f32 v8, v8, v19
    v_mfma_f32_16x16x32_bf16 v[108:111], v[28:31], a[228:231], v[108:111]
    s_waitcnt lgkmcnt(2)
    v_subrev_u32 v2, 98304, v2
    v_subrev_u32 v3, 98304, v3
    v_mfma_f32_16x16x32_bf16 v[168:171], v[32:35], a[208:211], v[168:171]
    ds_read_b128 v[24:27], v2 offset:0
    v_exp_f32 v17, v125
    v_cvt_pk_bf16_f32 v93, v18, v19
    v_exp_f32 v18, v126
    v_add_f32 v8, v8, v16
    v_add_f32 v8, v8, v17
    v_exp_f32 v19, v127
    v_cvt_pk_bf16_f32 v94, v16, v17
    v_add_f32 v8, v8, v18
    v_add_f32 v8, v8, v19
    v_cvt_pk_bf16_f32 v95, v18, v19
    v_mfma_f32_16x16x32_bf16 v[168:171], v[36:39], a[212:215], v[168:171]
    s_mov_b32 m0, s56
    v_exp_f32 v16, v160
    v_mfma_f32_16x16x32_bf16 v[172:175], v[32:35], a[232:235], v[172:175]
    s_min_u32 s29, s29, s3
    ds_read_b128 v[28:31], v3 offset:0
    v_mfma_f32_16x16x32_bf16 v[172:175], v[36:39], a[236:239], v[172:175]
    s_waitcnt lgkmcnt(2)
    buffer_load_dwordx4 v4, s[4:7], s27 offen offset:0 sc1 lds
    v_mfma_f32_16x16x32_bf16 v[104:107], v[40:43], a[208:211], v[104:107]
    ds_read_b128 v[32:35], v2 offset:6144
    v_mfma_f32_16x16x32_bf16 v[104:107], v[44:47], a[212:215], v[104:107]
    v_exp_f32 v17, v161
    v_mfma_f32_16x16x32_bf16 v[108:111], v[40:43], a[232:235], v[108:111]
    ds_read_b128 v[36:39], v3 offset:6144
    v_mfma_f32_16x16x32_bf16 v[108:111], v[44:47], a[236:239], v[108:111]
    s_waitcnt lgkmcnt(2)
    buffer_load_dwordx4 v4, s[4:7], s27 offen offset:1024 sc1 lds
    v_mfma_f32_16x16x32_bf16 v[176:179], v[24:27], a[192:195], v[128:131]
    ds_read_b128 v[40:43], v2 offset:128
    v_mfma_f32_16x16x32_bf16 v[176:179], v[28:31], a[196:199], v[176:179]
    s_sub_u32 s3, s29, s30
    v_exp_f32 v18, v162
    v_mfma_f32_16x16x32_bf16 v[180:183], v[24:27], a[216:219], v[132:135]
    ds_read_b128 v[44:47], v3 offset:128
    v_add_f32 v5, v5, v16
    v_mfma_f32_16x16x32_bf16 v[180:183], v[28:31], a[220:223], v[180:183]
    s_waitcnt lgkmcnt(2)
    v_add_f32 v5, v5, v17
    v_mfma_f32_16x16x32_bf16 v[112:115], v[32:35], a[192:195], v[128:131]
    ds_read_b128 v[24:27], v2 offset:6272
    v_mfma_f32_16x16x32_bf16 v[112:115], v[36:39], a[196:199], v[112:115]
    buffer_load_dwordx4 v4, s[4:7], s27 offen offset:2048 sc1 lds
    v_mfma_f32_16x16x32_bf16 v[116:119], v[32:35], a[216:219], v[132:135]
    ds_read_b128 v[28:31], v3 offset:6272
    v_mfma_f32_16x16x32_bf16 v[116:119], v[36:39], a[220:223], v[116:119]
    s_waitcnt lgkmcnt(2)
    v_exp_f32 v19, v163
    v_mfma_f32_16x16x32_bf16 v[176:179], v[40:43], a[200:203], v[176:179]
    s_add_u32 s27, s27, 24576
    ds_read_b128 v[32:35], v2 offset:256
    v_cvt_pk_bf16_f32 v160, v16, v17
    v_mfma_f32_16x16x32_bf16 v[176:179], v[44:47], a[204:207], v[176:179]
    s_add_u32 s56, s56, 12288
    v_exp_f32 v16, v96
    v_mfma_f32_16x16x32_bf16 v[180:183], v[40:43], a[224:227], v[180:183]
    s_mov_b32 s30, s29
    ds_read_b128 v[36:39], v3 offset:256
    v_add_f32 v5, v5, v18
    v_mfma_f32_16x16x32_bf16 v[180:183], v[44:47], a[228:231], v[180:183]
    s_waitcnt lgkmcnt(2)
    v_add_f32 v5, v5, v19
    s_mov_b32 m0, s56
    v_mfma_f32_16x16x32_bf16 v[112:115], v[24:27], a[200:203], v[112:115]
    ds_read_b128 v[40:43], v2 offset:6400
    v_mfma_f32_16x16x32_bf16 v[112:115], v[28:31], a[204:207], v[112:115]
    v_exp_f32 v17, v97
    v_mfma_f32_16x16x32_bf16 v[116:119], v[24:27], a[224:227], v[116:119]
    ds_read_b128 v[44:47], v3 offset:6400
    v_cvt_pk_bf16_f32 v161, v18, v19
    v_mfma_f32_16x16x32_bf16 v[116:119], v[28:31], a[228:231], v[116:119]
    s_waitcnt lgkmcnt(2)
    buffer_load_dwordx4 v4, s[4:7], s27 offen offset:0 sc1 lds
    v_mfma_f32_16x16x32_bf16 v[176:179], v[32:35], a[208:211], v[176:179]
    ds_read_b128 v[24:27], v2 offset:12288
    v_mfma_f32_16x16x32_bf16 v[176:179], v[36:39], a[212:215], v[176:179]
    v_exp_f32 v18, v98
    v_mfma_f32_16x16x32_bf16 v[180:183], v[32:35], a[232:235], v[180:183]
    ds_read_b128 v[28:31], v3 offset:12288
    v_add_f32 v5, v5, v16
    v_mfma_f32_16x16x32_bf16 v[180:183], v[36:39], a[236:239], v[180:183]
    s_waitcnt lgkmcnt(2)
    buffer_load_dwordx4 v4, s[4:7], s27 offen offset:1024 sc1 lds
    v_add_f32 v5, v5, v17
    v_mfma_f32_16x16x32_bf16 v[112:115], v[40:43], a[208:211], v[112:115]
    ds_read_b128 v[32:35], v2 offset:18432
    v_add_u32 v1, s3, v1
    v_mfma_f32_16x16x32_bf16 v[112:115], v[44:47], a[212:215], v[112:115]
    v_exp_f32 v19, v99
    v_mfma_f32_16x16x32_bf16 v[116:119], v[40:43], a[232:235], v[116:119]
    ds_read_b128 v[36:39], v3 offset:18432
    v_cvt_pk_bf16_f32 v162, v16, v17
    v_mfma_f32_16x16x32_bf16 v[116:119], v[44:47], a[236:239], v[116:119]
    s_waitcnt lgkmcnt(2)
    buffer_load_dwordx4 v4, s[4:7], s27 offen offset:2048 sc1 lds
    v_mfma_f32_16x16x32_bf16 v[184:187], v[24:27], a[192:195], v[128:131]
    ds_read_b128 v[40:43], v2 offset:12416
    v_mfma_f32_16x16x32_bf16 v[184:187], v[28:31], a[196:199], v[184:187]
    v_exp_f32 v16, v164
    v_add_f32 v5, v5, v18
    v_mfma_f32_16x16x32_bf16 v[188:191], v[24:27], a[216:219], v[132:135]
    ds_read_b128 v[44:47], v3 offset:12416
    v_add_f32 v5, v5, v19
    v_mfma_f32_16x16x32_bf16 v[188:191], v[28:31], a[220:223], v[188:191]
    s_waitcnt lgkmcnt(2)
    v_exp_f32 v17, v165
    v_mfma_f32_16x16x32_bf16 v[120:123], v[32:35], a[192:195], v[128:131]
    s_add_u32 s27, s27, 24576
    ds_read_b128 v[24:27], v2 offset:18560
    v_cvt_pk_bf16_f32 v163, v18, v19
    v_mfma_f32_16x16x32_bf16 v[120:123], v[36:39], a[196:199], v[120:123]
    s_waitcnt vmcnt(12)
    v_exp_f32 v18, v166
    v_mfma_f32_16x16x32_bf16 v[124:127], v[32:35], a[216:219], v[132:135]
    s_add_u32 s56, s56, 36864
    ds_read_b128 v[28:31], v3 offset:18560
    v_add_f32 v6, v6, v16
    v_mfma_f32_16x16x32_bf16 v[124:127], v[36:39], a[220:223], v[124:127]
    s_waitcnt lgkmcnt(2)
    s_barrier
    v_mfma_f32_16x16x32_bf16 v[184:187], v[40:43], a[200:203], v[184:187]
    s_sub_u32 s58, s56, 147456
    ds_read_b128 v[32:35], v2 offset:12544
    v_add_f32 v6, v6, v17
    v_mfma_f32_16x16x32_bf16 v[184:187], v[44:47], a[204:207], v[184:187]
    v_exp_f32 v19, v167
    v_mfma_f32_16x16x32_bf16 v[188:191], v[40:43], a[224:227], v[188:191]
    s_min_u32 s56, s56, s58
    ds_read_b128 v[36:39], v3 offset:12544
    v_cvt_pk_bf16_f32 v164, v16, v17
    v_mfma_f32_16x16x32_bf16 v[188:191], v[44:47], a[228:231], v[188:191]
    s_waitcnt lgkmcnt(2)
    v_exp_f32 v16, v100
    v_mfma_f32_16x16x32_bf16 v[120:123], v[24:27], a[200:203], v[120:123]
    ds_read_b128 v[40:43], v2 offset:18688
    v_add_f32 v6, v6, v18
    v_mfma_f32_16x16x32_bf16 v[120:123], v[28:31], a[204:207], v[120:123]
    v_add_f32 v6, v6, v19
    v_mfma_f32_16x16x32_bf16 v[124:127], v[24:27], a[224:227], v[124:127]
    ds_read_b128 v[44:47], v3 offset:18688
    v_mfma_f32_16x16x32_bf16 v[124:127], v[28:31], a[228:231], v[124:127]
    s_waitcnt lgkmcnt(2)
    v_exp_f32 v17, v101
    v_mfma_f32_16x16x32_bf16 v[184:187], v[32:35], a[208:211], v[184:187]
    ds_read_b128 v[24:27], v1 offset:0
    v_cvt_pk_bf16_f32 v165, v18, v19
    v_mfma_f32_16x16x32_bf16 v[184:187], v[36:39], a[212:215], v[184:187]
    v_exp_f32 v18, v102
    v_mfma_f32_16x16x32_bf16 v[188:191], v[32:35], a[232:235], v[188:191]
    ds_read_b128 v[28:31], v1 offset:12288
    v_add_f32 v6, v6, v16
    v_mfma_f32_16x16x32_bf16 v[188:191], v[36:39], a[236:239], v[188:191]
    s_waitcnt lgkmcnt(2)
    v_add_f32 v6, v6, v17
    v_mfma_f32_16x16x32_bf16 v[120:123], v[40:43], a[208:211], v[120:123]
    ds_read_b128 v[32:35], v1 offset:1024
    v_mfma_f32_16x16x32_bf16 v[120:123], v[44:47], a[212:215], v[120:123]
    v_exp_f32 v19, v103
    v_mfma_f32_16x16x32_bf16 v[124:127], v[40:43], a[232:235], v[124:127]
    ds_read_b128 v[36:39], v1 offset:13312
    v_cvt_pk_bf16_f32 v166, v16, v17
    v_mfma_f32_16x16x32_bf16 v[124:127], v[44:47], a[236:239], v[124:127]
    s_waitcnt lgkmcnt(2)
    v_add_f32 v6, v6, v18
    v_add_f32 v6, v6, v19
    v_cvt_pk_bf16_f32 v167, v18, v19
    v_mfma_f32_16x16x32_bf16 a[0:3], v[24:27], v[64:67], a[0:3]
    s_mov_b32 m0, s56
    ds_read_b128 v[40:43], v1 offset:2048
    v_mfma_f32_16x16x32_bf16 a[0:3], v[28:31], v[80:83], a[0:3]
    v_exp_f32 v16, v168
    v_mfma_f32_16x16x32_bf16 a[48:51], v[24:27], v[68:71], a[48:51]
    v_exp_f32 v17, v169
    v_mfma_f32_16x16x32_bf16 a[48:51], v[28:31], v[84:87], a[48:51]
    buffer_load_dwordx4 v4, s[4:7], s27 offen offset:0 sc1 lds
    v_mfma_f32_16x16x32_bf16 a[96:99], v[24:27], v[72:75], a[96:99]
    ds_read_b128 v[44:47], v1 offset:14336
    v_mfma_f32_16x16x32_bf16 a[96:99], v[28:31], v[88:91], a[96:99]
    v_exp_f32 v18, v170
    v_mfma_f32_16x16x32_bf16 a[144:147], v[24:27], v[76:79], a[144:147]
    v_add_f32 v5, v5, v16
    v_add_f32 v5, v5, v17
    v_mfma_f32_16x16x32_bf16 a[144:147], v[28:31], v[92:95], a[144:147]
    s_waitcnt lgkmcnt(2)
    buffer_load_dwordx4 v4, s[4:7], s27 offen offset:1024 sc1 lds
    v_mfma_f32_16x16x32_bf16 a[4:7], v[32:35], v[64:67], a[4:7]
    ds_read_b128 v[24:27], v1 offset:3072
    v_mfma_f32_16x16x32_bf16 a[4:7], v[36:39], v[80:83], a[4:7]
    v_exp_f32 v19, v171
    v_cvt_pk_bf16_f32 v168, v16, v17
    v_mfma_f32_16x16x32_bf16 a[52:55], v[32:35], v[68:71], a[52:55]
    v_exp_f32 v16, v104
    v_mfma_f32_16x16x32_bf16 a[52:55], v[36:39], v[84:87], a[52:55]
    v_add_f32 v5, v5, v18
    v_add_f32 v5, v5, v19
    v_mfma_f32_16x16x32_bf16 a[100:103], v[32:35], v[72:75], a[100:103]
    ds_read_b128 v[28:31], v1 offset:15360
    v_mfma_f32_16x16x32_bf16 a[100:103], v[36:39], v[88:91], a[100:103]
    buffer_load_dwordx4 v4, s[4:7], s27 offen offset:2048 sc1 lds
    v_mfma_f32_16x16x32_bf16 a[148:151], v[32:35], v[76:79], a[148:151]
    v_exp_f32 v17, v105
    v_mfma_f32_16x16x32_bf16 a[148:151], v[36:39], v[92:95], a[148:151]
    s_waitcnt lgkmcnt(2)
    v_cvt_pk_bf16_f32 v169, v18, v19
    v_exp_f32 v18, v106
    v_mfma_f32_16x16x32_bf16 a[8:11], v[40:43], v[64:67], a[8:11]
    s_add_u32 s27, s27, 24576
    ds_read_b128 v[32:35], v1 offset:4096
    v_add_f32 v5, v5, v16
    v_mfma_f32_16x16x32_bf16 a[8:11], v[44:47], v[80:83], a[8:11]
    v_add_f32 v5, v5, v17
    v_exp_f32 v19, v107
    v_mfma_f32_16x16x32_bf16 a[56:59], v[40:43], v[68:71], a[56:59]
    v_cvt_pk_bf16_f32 v170, v16, v17
    v_mfma_f32_16x16x32_bf16 a[56:59], v[44:47], v[84:87], a[56:59]
    v_exp_f32 v16, v172
    v_add_f32 v5, v5, v18
    v_mfma_f32_16x16x32_bf16 a[104:107], v[40:43], v[72:75], a[104:107]
    s_add_u32 s56, s56, 12288
    ds_read_b128 v[36:39], v1 offset:16384
    v_add_f32 v5, v5, v19
    v_mfma_f32_16x16x32_bf16 a[104:107], v[44:47], v[88:91], a[104:107]
    v_exp_f32 v17, v173
    v_cvt_pk_bf16_f32 v171, v18, v19
    v_mfma_f32_16x16x32_bf16 a[152:155], v[40:43], v[76:79], a[152:155]
    s_mov_b32 m0, s56
    v_exp_f32 v18, v174
    v_mfma_f32_16x16x32_bf16 a[152:155], v[44:47], v[92:95], a[152:155]
    s_waitcnt lgkmcnt(2)
    v_add_f32 v6, v6, v16
    v_add_f32 v6, v6, v17
    v_mfma_f32_16x16x32_bf16 a[12:15], v[24:27], v[64:67], a[12:15]
    ds_read_b128 v[40:43], v1 offset:5120
    v_mfma_f32_16x16x32_bf16 a[12:15], v[28:31], v[80:83], a[12:15]
    buffer_load_dwordx4 v4, s[4:7], s27 offen offset:0 sc1 lds
    v_mfma_f32_16x16x32_bf16 a[60:63], v[24:27], v[68:71], a[60:63]
    v_exp_f32 v19, v175
    v_mfma_f32_16x16x32_bf16 a[60:63], v[28:31], v[84:87], a[60:63]
    v_cvt_pk_bf16_f32 v172, v16, v17
    v_exp_f32 v16, v108
    v_mfma_f32_16x16x32_bf16 a[108:111], v[24:27], v[72:75], a[108:111]
    ds_read_b128 v[44:47], v1 offset:17408
    v_add_f32 v6, v6, v18
    v_mfma_f32_16x16x32_bf16 a[108:111], v[28:31], v[88:91], a[108:111]
    v_add_f32 v6, v6, v19
    v_exp_f32 v17, v109
    v_mfma_f32_16x16x32_bf16 a[156:159], v[24:27], v[76:79], a[156:159]
    v_cvt_pk_bf16_f32 v173, v18, v19
    v_mfma_f32_16x16x32_bf16 a[156:159], v[28:31], v[92:95], a[156:159]
    s_waitcnt lgkmcnt(2)
    buffer_load_dwordx4 v4, s[4:7], s27 offen offset:1024 sc1 lds
    v_mfma_f32_16x16x32_bf16 a[16:19], v[32:35], v[64:67], a[16:19]
    ds_read_b128 v[24:27], v1 offset:6144
    v_mfma_f32_16x16x32_bf16 a[16:19], v[36:39], v[80:83], a[16:19]
    v_exp_f32 v18, v110
    v_add_f32 v6, v6, v16
    v_mfma_f32_16x16x32_bf16 a[64:67], v[32:35], v[68:71], a[64:67]
    v_add_f32 v6, v6, v17
    v_mfma_f32_16x16x32_bf16 a[64:67], v[36:39], v[84:87], a[64:67]
    buffer_load_dwordx4 v4, s[4:7], s27 offen offset:2048 sc1 lds
    v_mfma_f32_16x16x32_bf16 a[112:115], v[32:35], v[72:75], a[112:115]
    ds_read_b128 v[28:31], v1 offset:18432
    v_mfma_f32_16x16x32_bf16 a[112:115], v[36:39], v[88:91], a[112:115]
    v_exp_f32 v19, v111
    v_cvt_pk_bf16_f32 v174, v16, v17
    v_mfma_f32_16x16x32_bf16 a[160:163], v[32:35], v[76:79], a[160:163]
    v_add_f32 v6, v6, v18
    v_add_f32 v6, v6, v19
    v_mfma_f32_16x16x32_bf16 a[160:163], v[36:39], v[92:95], a[160:163]
    s_waitcnt lgkmcnt(2)
    v_cvt_pk_bf16_f32 v175, v18, v19
    v_exp_f32 v16, v176
    v_mfma_f32_16x16x32_bf16 a[20:23], v[40:43], v[64:67], a[20:23]
    ds_read_b128 v[32:35], v1 offset:7168
    v_mfma_f32_16x16x32_bf16 a[20:23], v[44:47], v[80:83], a[20:23]
    s_add_u32 s27, s27, 24576
    v_exp_f32 v17, v177
    v_mfma_f32_16x16x32_bf16 a[68:71], v[40:43], v[68:71], a[68:71]
    s_add_u32 s56, s56, 36864
    v_exp_f32 v18, v178
    v_mfma_f32_16x16x32_bf16 a[68:71], v[44:47], v[84:87], a[68:71]
    v_add_f32 v5, v5, v16
    v_add_f32 v5, v5, v17
    v_mfma_f32_16x16x32_bf16 a[116:119], v[40:43], v[72:75], a[116:119]
    ds_read_b128 v[36:39], v1 offset:19456
    v_mfma_f32_16x16x32_bf16 a[116:119], v[44:47], v[88:91], a[116:119]
    v_exp_f32 v19, v179
    v_cvt_pk_bf16_f32 v176, v16, v17
    v_mfma_f32_16x16x32_bf16 a[164:167], v[40:43], v[76:79], a[164:167]
    s_sub_u32 s58, s56, 147456
    v_exp_f32 v16, v112
    v_mfma_f32_16x16x32_bf16 a[164:167], v[44:47], v[92:95], a[164:167]
    s_waitcnt lgkmcnt(2)
    v_add_f32 v5, v5, v18
    v_add_f32 v5, v5, v19
    v_mfma_f32_16x16x32_bf16 a[24:27], v[24:27], v[64:67], a[24:27]
    s_min_u32 s56, s56, s58
    ds_read_b128 v[40:43], v1 offset:8192
    v_mfma_f32_16x16x32_bf16 a[24:27], v[28:31], v[80:83], a[24:27]
    v_exp_f32 v17, v113
    v_cvt_pk_bf16_f32 v177, v18, v19
    v_mfma_f32_16x16x32_bf16 a[72:75], v[24:27], v[68:71], a[72:75]
    v_exp_f32 v18, v114
    v_mfma_f32_16x16x32_bf16 a[72:75], v[28:31], v[84:87], a[72:75]
    v_add_f32 v5, v5, v16
    v_add_f32 v5, v5, v17
    v_mfma_f32_16x16x32_bf16 a[120:123], v[24:27], v[72:75], a[120:123]
    ds_read_b128 v[44:47], v1 offset:20480
    v_mfma_f32_16x16x32_bf16 a[120:123], v[28:31], v[88:91], a[120:123]
    v_exp_f32 v19, v115
    v_cvt_pk_bf16_f32 v178, v16, v17
    v_mfma_f32_16x16x32_bf16 a[168:171], v[24:27], v[76:79], a[168:171]
    v_exp_f32 v16, v180
    v_mfma_f32_16x16x32_bf16 a[168:171], v[28:31], v[92:95], a[168:171]
    s_waitcnt lgkmcnt(2)
    v_add_f32 v5, v5, v18
    v_add_f32 v5, v5, v19
    v_mfma_f32_16x16x32_bf16 a[28:31], v[32:35], v[64:67], a[28:31]
    ds_read_b128 v[24:27], v1 offset:9216
    v_mfma_f32_16x16x32_bf16 a[28:31], v[36:39], v[80:83], a[28:31]
    v_exp_f32 v17, v181
    v_cvt_pk_bf16_f32 v179, v18, v19
    v_mfma_f32_16x16x32_bf16 a[76:79], v[32:35], v[68:71], a[76:79]
    v_exp_f32 v18, v182
    v_mfma_f32_16x16x32_bf16 a[76:79], v[36:39], v[84:87], a[76:79]
    v_add_f32 v6, v6, v16
    v_add_f32 v6, v6, v17
    v_mfma_f32_16x16x32_bf16 a[124:127], v[32:35], v[72:75], a[124:127]
    ds_read_b128 v[28:31], v1 offset:21504
    v_mfma_f32_16x16x32_bf16 a[124:127], v[36:39], v[88:91], a[124:127]
    v_exp_f32 v19, v183
    v_cvt_pk_bf16_f32 v180, v16, v17
    v_mfma_f32_16x16x32_bf16 a[172:175], v[32:35], v[76:79], a[172:175]
    v_exp_f32 v16, v116
    v_mfma_f32_16x16x32_bf16 a[172:175], v[36:39], v[92:95], a[172:175]
    s_waitcnt lgkmcnt(2)
    v_add_f32 v6, v6, v18
    v_add_f32 v6, v6, v19
    v_mfma_f32_16x16x32_bf16 a[32:35], v[40:43], v[64:67], a[32:35]
    ds_read_b128 v[32:35], v1 offset:10240
    v_mfma_f32_16x16x32_bf16 a[32:35], v[44:47], v[80:83], a[32:35]
    v_exp_f32 v17, v117
    v_cvt_pk_bf16_f32 v181, v18, v19
    v_mfma_f32_16x16x32_bf16 a[80:83], v[40:43], v[68:71], a[80:83]
    v_exp_f32 v18, v118
    v_mfma_f32_16x16x32_bf16 a[80:83], v[44:47], v[84:87], a[80:83]
    v_add_f32 v6, v6, v16
    v_add_f32 v6, v6, v17
    v_mfma_f32_16x16x32_bf16 a[128:131], v[40:43], v[72:75], a[128:131]
    ds_read_b128 v[36:39], v1 offset:22528
    v_mfma_f32_16x16x32_bf16 a[128:131], v[44:47], v[88:91], a[128:131]
    v_exp_f32 v19, v119
    v_cvt_pk_bf16_f32 v182, v16, v17
    v_mfma_f32_16x16x32_bf16 a[176:179], v[40:43], v[76:79], a[176:179]
    v_add_f32 v6, v6, v18
    v_add_f32 v6, v6, v19
    v_mfma_f32_16x16x32_bf16 a[176:179], v[44:47], v[92:95], a[176:179]
    s_waitcnt lgkmcnt(2)
    v_cvt_pk_bf16_f32 v183, v18, v19
    v_exp_f32 v16, v184
    v_mfma_f32_16x16x32_bf16 a[36:39], v[24:27], v[64:67], a[36:39]
    ds_read_b128 v[40:43], v1 offset:11264
    v_mfma_f32_16x16x32_bf16 a[36:39], v[28:31], v[80:83], a[36:39]
    v_exp_f32 v17, v185
    v_mfma_f32_16x16x32_bf16 a[84:87], v[24:27], v[68:71], a[84:87]
    v_exp_f32 v18, v186
    v_mfma_f32_16x16x32_bf16 a[84:87], v[28:31], v[84:87], a[84:87]
    v_add_f32 v5, v5, v16
    v_add_f32 v5, v5, v17
    v_mfma_f32_16x16x32_bf16 a[132:135], v[24:27], v[72:75], a[132:135]
    ds_read_b128 v[44:47], v1 offset:23552
    v_mfma_f32_16x16x32_bf16 a[132:135], v[28:31], v[88:91], a[132:135]
    s_waitcnt lgkmcnt(2)
    v_exp_f32 v19, v187
    v_cvt_pk_bf16_f32 v184, v16, v17
    v_mfma_f32_16x16x32_bf16 a[180:183], v[24:27], v[76:79], a[180:183]
    s_waitcnt vmcnt(6)
    v_exp_f32 v16, v120
    v_mfma_f32_16x16x32_bf16 a[180:183], v[28:31], v[92:95], a[180:183]
    s_barrier
    v_add_u32 v2, 49152, v2
    v_add_u32 v3, 49152, v3
    v_mfma_f32_16x16x32_bf16 a[40:43], v[32:35], v[64:67], a[40:43]
    ds_read_b128 v[24:27], v2 offset:0
    v_add_f32 v5, v5, v18
    v_mfma_f32_16x16x32_bf16 a[40:43], v[36:39], v[80:83], a[40:43]
    v_add_f32 v5, v5, v19
    v_exp_f32 v17, v121
    v_mfma_f32_16x16x32_bf16 a[88:91], v[32:35], v[68:71], a[88:91]
    v_cvt_pk_bf16_f32 v185, v18, v19
    v_mfma_f32_16x16x32_bf16 a[88:91], v[36:39], v[84:87], a[88:91]
    v_exp_f32 v18, v122
    v_add_f32 v5, v5, v16
    v_mfma_f32_16x16x32_bf16 a[136:139], v[32:35], v[72:75], a[136:139]
    ds_read_b128 v[28:31], v3 offset:0
    v_add_f32 v5, v5, v17
    v_mfma_f32_16x16x32_bf16 a[136:139], v[36:39], v[88:91], a[136:139]
    v_exp_f32 v19, v123
    v_cvt_pk_bf16_f32 v186, v16, v17
    v_mfma_f32_16x16x32_bf16 a[184:187], v[32:35], v[76:79], a[184:187]
    v_exp_f32 v16, v188
    v_mfma_f32_16x16x32_bf16 a[184:187], v[36:39], v[92:95], a[184:187]
    s_waitcnt lgkmcnt(2)
    v_add_f32 v5, v5, v18
    v_add_f32 v5, v5, v19
    v_mfma_f32_16x16x32_bf16 a[44:47], v[40:43], v[64:67], a[44:47]
    ds_read_b128 v[32:35], v2 offset:6144
    v_mfma_f32_16x16x32_bf16 a[44:47], v[44:47], v[80:83], a[44:47]
    v_exp_f32 v17, v189
    v_cvt_pk_bf16_f32 v187, v18, v19
    v_mfma_f32_16x16x32_bf16 a[92:95], v[40:43], v[68:71], a[92:95]
    v_exp_f32 v18, v190
    v_mfma_f32_16x16x32_bf16 a[92:95], v[44:47], v[84:87], a[92:95]
    v_add_f32 v6, v6, v16
    v_add_f32 v6, v6, v17
    v_mfma_f32_16x16x32_bf16 a[140:143], v[40:43], v[72:75], a[140:143]
    ds_read_b128 v[36:39], v3 offset:6144
    v_mfma_f32_16x16x32_bf16 a[140:143], v[44:47], v[88:91], a[140:143]
    v_exp_f32 v19, v191
    v_cvt_pk_bf16_f32 v188, v16, v17
    v_mfma_f32_16x16x32_bf16 a[188:191], v[40:43], v[76:79], a[188:191]
    v_exp_f32 v16, v124
    v_mfma_f32_16x16x32_bf16 a[188:191], v[44:47], v[92:95], a[188:191]
    s_waitcnt lgkmcnt(2)
    v_add_f32 v6, v6, v18
    v_add_f32 v6, v6, v19
    v_exp_f32 v17, v125
    v_cvt_pk_bf16_f32 v189, v18, v19
    v_exp_f32 v18, v126
    v_add_f32 v6, v6, v16
    v_add_f32 v6, v6, v17
    v_exp_f32 v19, v127
    v_cvt_pk_bf16_f32 v190, v16, v17
    v_add_f32 v6, v6, v18
    v_add_f32 v6, v6, v19
    v_cvt_pk_bf16_f32 v191, v18, v19
    v_mfma_f32_16x16x32_bf16 v[64:67], v[24:27], a[192:195], v[128:131]
    ds_read_b128 v[40:43], v2 offset:128
    v_bfe_u32 v60, v4, 4, 6
    v_mfma_f32_16x16x32_bf16 v[64:67], v[28:31], a[196:199], v[64:67]
    s_mul_i32 s24, s25, 6144
    s_add_u32 s24, s24, 98304
    v_mfma_f32_16x16x32_bf16 v[68:71], v[24:27], a[216:219], v[132:135]
    ds_read_b128 v[44:47], v3 offset:128
    v_mfma_f32_16x16x32_bf16 v[68:71], v[28:31], a[220:223], v[68:71]
    s_waitcnt lgkmcnt(2)
    v_and_b32 v56, 15, v60
    v_mfma_f32_16x16x32_bf16 v[96:99], v[32:35], a[192:195], v[128:131]
    ds_read_b128 v[24:27], v2 offset:6272
    v_lshrrev_b32 v57, 4, v60
    v_mfma_f32_16x16x32_bf16 v[96:99], v[36:39], a[196:199], v[96:99]
    v_lshlrev_b32 v57, 1, v57
    v_mfma_f32_16x16x32_bf16 v[100:103], v[32:35], a[216:219], v[132:135]
    ds_read_b128 v[28:31], v3 offset:6272
    v_mfma_f32_16x16x32_bf16 v[100:103], v[36:39], a[220:223], v[100:103]
    s_waitcnt lgkmcnt(2)
    v_and_b32 v61, 7, v60
    v_mfma_f32_16x16x32_bf16 v[64:67], v[40:43], a[200:203], v[64:67]
    ds_read_b128 v[32:35], v2 offset:256
    v_xor_b32 v57, v57, v61
    v_mfma_f32_16x16x32_bf16 v[64:67], v[44:47], a[204:207], v[64:67]
    v_lshlrev_b32 v56, 7, v56
    v_mfma_f32_16x16x32_bf16 v[68:71], v[40:43], a[224:227], v[68:71]
    ds_read_b128 v[36:39], v3 offset:256
    v_lshl_add_u32 v56, v57, 4, v56
    v_mfma_f32_16x16x32_bf16 v[68:71], v[44:47], a[228:231], v[68:71]
    s_waitcnt lgkmcnt(2)
    v_mfma_f32_16x16x32_bf16 v[96:99], v[24:27], a[200:203], v[96:99]
    ds_read_b128 v[40:43], v2 offset:6400
    v_add_u32 v56, s24, v56
    v_mfma_f32_16x16x32_bf16 v[96:99], v[28:31], a[204:207], v[96:99]
    s_waitcnt vmcnt(0)
    v_xor_b32 v57, 16, v56
    v_mfma_f32_16x16x32_bf16 v[100:103], v[24:27], a[224:227], v[100:103]
    ds_read_b128 v[44:47], v3 offset:6400
    v_lshrrev_b32 v58, 3, v60
    v_mfma_f32_16x16x32_bf16 v[100:103], v[28:31], a[228:231], v[100:103]
    s_waitcnt lgkmcnt(2)
    s_barrier
    v_mfma_f32_16x16x32_bf16 v[64:67], v[32:35], a[208:211], v[64:67]
    s_mov_b32 m0, s56
    ds_read_b128 v[24:27], v2 offset:12288
    v_mul_u32_u24 v59, 384, v58
    v_mfma_f32_16x16x32_bf16 v[64:67], v[36:39], a[212:215], v[64:67]
    v_lshl_add_u32 v59, v61, 4, v59
    v_mfma_f32_16x16x32_bf16 v[68:71], v[32:35], a[232:235], v[68:71]
    ds_read_b128 v[28:31], v3 offset:12288
    v_xor_b32 v58, v58, v60
    v_mfma_f32_16x16x32_bf16 v[68:71], v[36:39], a[236:239], v[68:71]
    s_waitcnt lgkmcnt(2)
    buffer_load_dwordx4 v4, s[4:7], s27 offen offset:0 sc1 lds
    v_mfma_f32_16x16x32_bf16 v[96:99], v[40:43], a[208:211], v[96:99]
    ds_read_b128 v[32:35], v2 offset:18432
    v_lshlrev_b32 v58, 4, v58
    v_mfma_f32_16x16x32_bf16 v[96:99], v[44:47], a[212:215], v[96:99]
    v_add_u32 v58, s24, v58
    v_mfma_f32_16x16x32_bf16 v[100:103], v[40:43], a[232:235], v[100:103]
    s_lshl_b32 s24, s95, 2
    ds_read_b128 v[36:39], v3 offset:18432
    v_mfma_f32_16x16x32_bf16 v[100:103], v[44:47], a[236:239], v[100:103]
    s_waitcnt lgkmcnt(2)
    buffer_load_dwordx4 v4, s[4:7], s27 offen offset:1024 sc1 lds
    v_mfma_f32_16x16x32_bf16 v[72:75], v[24:27], a[192:195], v[128:131]
    s_add_u32 s24, s24, s25
    ds_read_b128 v[40:43], v2 offset:12416
    v_mfma_f32_16x16x32_bf16 v[72:75], v[28:31], a[196:199], v[72:75]
    s_mul_i32 s24, s24, 24576
    v_mfma_f32_16x16x32_bf16 v[76:79], v[24:27], a[216:219], v[132:135]
    s_add_u32 s40, s24, 6144
    ds_read_b128 v[44:47], v3 offset:12416
    v_mfma_f32_16x16x32_bf16 v[76:79], v[28:31], a[220:223], v[76:79]
    s_waitcnt lgkmcnt(2)
    buffer_load_dwordx4 v4, s[4:7], s27 offen offset:2048 sc1 lds
    v_mfma_f32_16x16x32_bf16 v[104:107], v[32:35], a[192:195], v[128:131]
    s_add_u32 s41, s24, 12288
    ds_read_b128 v[24:27], v2 offset:18560
    v_mfma_f32_16x16x32_bf16 v[104:107], v[36:39], a[196:199], v[104:107]
    s_add_u32 s42, s24, 18432
    v_mfma_f32_16x16x32_bf16 v[108:111], v[32:35], a[216:219], v[132:135]
    s_add_u32 s27, s27, 24576
    ds_read_b128 v[28:31], v3 offset:18560
    v_mfma_f32_16x16x32_bf16 v[108:111], v[36:39], a[220:223], v[108:111]
    s_waitcnt lgkmcnt(2)
    v_exp_f32 v16, v64
    v_mfma_f32_16x16x32_bf16 v[72:75], v[40:43], a[200:203], v[72:75]
    s_add_u32 s56, s56, 12288
    ds_read_b128 v[32:35], v2 offset:12544
    v_mfma_f32_16x16x32_bf16 v[72:75], v[44:47], a[204:207], v[72:75]
    v_exp_f32 v17, v65
    v_mfma_f32_16x16x32_bf16 v[76:79], v[40:43], a[224:227], v[76:79]
    s_mov_b32 m0, s56
    ds_read_b128 v[36:39], v3 offset:12544
    v_mfma_f32_16x16x32_bf16 v[76:79], v[44:47], a[228:231], v[76:79]
    s_waitcnt lgkmcnt(2)
    v_exp_f32 v18, v66
    v_mfma_f32_16x16x32_bf16 v[104:107], v[24:27], a[200:203], v[104:107]
    ds_read_b128 v[40:43], v2 offset:18688
    v_add_f32 v5, v5, v16
    v_mfma_f32_16x16x32_bf16 v[104:107], v[28:31], a[204:207], v[104:107]
    buffer_load_dwordx4 v4, s[4:7], s27 offen offset:0 sc1 lds
    v_add_f32 v5, v5, v17
    v_mfma_f32_16x16x32_bf16 v[108:111], v[24:27], a[224:227], v[108:111]
    ds_read_b128 v[44:47], v3 offset:18688
    v_mfma_f32_16x16x32_bf16 v[108:111], v[28:31], a[228:231], v[108:111]
    s_waitcnt lgkmcnt(2)
    v_add_u32 v2, 49152, v2
    v_add_u32 v3, 49152, v3
    v_mfma_f32_16x16x32_bf16 v[72:75], v[32:35], a[208:211], v[72:75]
    ds_read_b128 v[24:27], v2 offset:0
    v_mfma_f32_16x16x32_bf16 v[72:75], v[36:39], a[212:215], v[72:75]
    v_exp_f32 v19, v67
    v_cvt_pk_bf16_f32 v64, v16, v17
    v_mfma_f32_16x16x32_bf16 v[76:79], v[32:35], a[232:235], v[76:79]
    ds_read_b128 v[28:31], v3 offset:0
    v_mfma_f32_16x16x32_bf16 v[76:79], v[36:39], a[236:239], v[76:79]
    s_waitcnt lgkmcnt(2)
    buffer_load_dwordx4 v4, s[4:7], s27 offen offset:1024 sc1 lds
    v_mfma_f32_16x16x32_bf16 v[104:107], v[40:43], a[208:211], v[104:107]
    ds_read_b128 v[32:35], v2 offset:6144
    v_mfma_f32_16x16x32_bf16 v[104:107], v[44:47], a[212:215], v[104:107]
    v_exp_f32 v16, v96
    v_add_f32 v5, v5, v18
    v_mfma_f32_16x16x32_bf16 v[108:111], v[40:43], a[232:235], v[108:111]
    ds_read_b128 v[36:39], v3 offset:6144
    v_add_f32 v5, v5, v19
    v_mfma_f32_16x16x32_bf16 v[108:111], v[44:47], a[236:239], v[108:111]
    s_waitcnt lgkmcnt(2)
    buffer_load_dwordx4 v4, s[4:7], s27 offen offset:2048 sc1 lds
    v_mfma_f32_16x16x32_bf16 v[80:83], v[24:27], a[240:243], v[136:139]
    ds_read_b128 v[40:43], v2 offset:128
    v_mfma_f32_16x16x32_bf16 v[80:83], v[28:31], a[244:247], v[80:83]
    v_exp_f32 v17, v97
    v_cvt_pk_bf16_f32 v65, v18, v19
    v_mfma_f32_16x16x32_bf16 v[84:87], v[24:27], v[200:203], v[140:143]
    ds_read_b128 v[44:47], v3 offset:128
    v_mfma_f32_16x16x32_bf16 v[84:87], v[28:31], v[204:207], v[84:87]
    s_waitcnt lgkmcnt(2)
    v_exp_f32 v18, v98
    v_add_f32 v5, v5, v16
    v_mfma_f32_16x16x32_bf16 v[112:115], v[32:35], a[240:243], v[136:139]
    s_add_u32 s27, s27, 24576
    ds_read_b128 v[24:27], v2 offset:6272
    v_add_f32 v5, v5, v17
    v_mfma_f32_16x16x32_bf16 v[112:115], v[36:39], a[244:247], v[112:115]
    v_exp_f32 v19, v99
    v_cvt_pk_bf16_f32 v66, v16, v17
    v_mfma_f32_16x16x32_bf16 v[116:119], v[32:35], v[200:203], v[140:143]
    s_add_u32 s56, s56, 36864
    ds_read_b128 v[28:31], v3 offset:6272
    v_mfma_f32_16x16x32_bf16 v[116:119], v[36:39], v[204:207], v[116:119]
    s_waitcnt lgkmcnt(2)
    v_exp_f32 v16, v68
    v_add_f32 v5, v5, v18
    v_mfma_f32_16x16x32_bf16 v[80:83], v[40:43], a[248:251], v[80:83]
    s_sub_u32 s58, s56, 147456
    ds_read_b128 v[32:35], v2 offset:256
    v_add_f32 v5, v5, v19
    v_mfma_f32_16x16x32_bf16 v[80:83], v[44:47], a[252:255], v[80:83]
    v_exp_f32 v17, v69
    v_cvt_pk_bf16_f32 v67, v18, v19
    v_mfma_f32_16x16x32_bf16 v[84:87], v[40:43], v[208:211], v[84:87]
    s_min_u32 s56, s56, s58
    ds_read_b128 v[36:39], v3 offset:256
    v_mfma_f32_16x16x32_bf16 v[84:87], v[44:47], v[212:215], v[84:87]
    s_waitcnt lgkmcnt(2)
    v_exp_f32 v18, v70
    v_add_f32 v6, v6, v16
    v_mfma_f32_16x16x32_bf16 v[112:115], v[24:27], a[248:251], v[112:115]
    ds_read_b128 v[40:43], v2 offset:6400
    v_add_f32 v6, v6, v17
    v_exp_f32 v19, v71
    v_cvt_pk_bf16_f32 v68, v16, v17
    v_exp_f32 v16, v100
    v_add_f32 v6, v6, v18
    v_add_f32 v6, v6, v19
    v_exp_f32 v17, v101
    v_cvt_pk_bf16_f32 v69, v18, v19
    v_exp_f32 v18, v102
    v_add_f32 v6, v6, v16
    v_add_f32 v6, v6, v17
    v_exp_f32 v19, v103
    v_cvt_pk_bf16_f32 v70, v16, v17
    v_add_f32 v6, v6, v18
    v_add_f32 v6, v6, v19
    v_cvt_pk_bf16_f32 v71, v18, v19
    v_mfma_f32_16x16x32_bf16 v[112:115], v[28:31], a[252:255], v[112:115]
    v_exp_f32 v16, v72
    v_mfma_f32_16x16x32_bf16 v[116:119], v[24:27], v[208:211], v[116:119]
    ds_read_b128 v[44:47], v3 offset:6400
    v_mfma_f32_16x16x32_bf16 v[116:119], v[28:31], v[212:215], v[116:119]
    s_waitcnt lgkmcnt(2)
    v_exp_f32 v17, v73
    v_mfma_f32_16x16x32_bf16 v[80:83], v[32:35], v[192:195], v[80:83]
    ds_read_b128 v[24:27], v2 offset:12288
    v_mfma_f32_16x16x32_bf16 v[80:83], v[36:39], v[196:199], v[80:83]
    v_exp_f32 v18, v74
    v_mfma_f32_16x16x32_bf16 v[84:87], v[32:35], v[216:219], v[84:87]
    ds_read_b128 v[28:31], v3 offset:12288
    v_add_f32 v5, v5, v16
    v_mfma_f32_16x16x32_bf16 v[84:87], v[36:39], v[220:223], v[84:87]
    s_waitcnt lgkmcnt(2)
    v_add_f32 v5, v5, v17
    v_mfma_f32_16x16x32_bf16 v[112:115], v[40:43], v[192:195], v[112:115]
    ds_read_b128 v[32:35], v2 offset:18432
    v_mfma_f32_16x16x32_bf16 v[112:115], v[44:47], v[196:199], v[112:115]
    v_exp_f32 v19, v75
    v_mfma_f32_16x16x32_bf16 v[116:119], v[40:43], v[216:219], v[116:119]
    ds_read_b128 v[36:39], v3 offset:18432
    v_cvt_pk_bf16_f32 v72, v16, v17
    v_mfma_f32_16x16x32_bf16 v[116:119], v[44:47], v[220:223], v[116:119]
    s_waitcnt lgkmcnt(2)
    v_exp_f32 v16, v104
    v_mfma_f32_16x16x32_bf16 v[88:91], v[24:27], a[240:243], v[136:139]
    ds_read_b128 v[40:43], v2 offset:12416
    v_add_f32 v5, v5, v18
    v_mfma_f32_16x16x32_bf16 v[88:91], v[28:31], a[244:247], v[88:91]
    v_add_f32 v5, v5, v19
    v_mfma_f32_16x16x32_bf16 v[92:95], v[24:27], v[200:203], v[140:143]
    ds_read_b128 v[44:47], v3 offset:12416
    v_mfma_f32_16x16x32_bf16 v[92:95], v[28:31], v[204:207], v[92:95]
    s_waitcnt lgkmcnt(2)
    v_exp_f32 v17, v105
    v_cvt_pk_bf16_f32 v73, v18, v19
    v_mfma_f32_16x16x32_bf16 v[120:123], v[32:35], a[240:243], v[136:139]
    ds_read_b128 v[24:27], v2 offset:18560
    v_mfma_f32_16x16x32_bf16 v[120:123], v[36:39], a[244:247], v[120:123]
    v_exp_f32 v18, v106
    v_add_f32 v5, v5, v16
    v_mfma_f32_16x16x32_bf16 v[124:127], v[32:35], v[200:203], v[140:143]
    ds_read_b128 v[28:31], v3 offset:18560
    v_add_f32 v5, v5, v17
    v_mfma_f32_16x16x32_bf16 v[124:127], v[36:39], v[204:207], v[124:127]
    s_waitcnt lgkmcnt(2)
    v_exp_f32 v19, v107
    v_cvt_pk_bf16_f32 v74, v16, v17
    v_mfma_f32_16x16x32_bf16 v[88:91], v[40:43], a[248:251], v[88:91]
    ds_read_b128 v[32:35], v2 offset:12544
    v_mfma_f32_16x16x32_bf16 v[88:91], v[44:47], a[252:255], v[88:91]
    v_exp_f32 v16, v76
    v_add_f32 v5, v5, v18
    v_mfma_f32_16x16x32_bf16 v[92:95], v[40:43], v[208:211], v[92:95]
    ds_read_b128 v[36:39], v3 offset:12544
    v_add_f32 v5, v5, v19
    v_mfma_f32_16x16x32_bf16 v[92:95], v[44:47], v[212:215], v[92:95]
    s_waitcnt lgkmcnt(2)
    v_exp_f32 v17, v77
    v_mfma_f32_16x16x32_bf16 v[120:123], v[24:27], a[248:251], v[120:123]
    ds_read_b128 v[40:43], v2 offset:18688
    v_cvt_pk_bf16_f32 v75, v18, v19
    v_mfma_f32_16x16x32_bf16 v[120:123], v[28:31], a[252:255], v[120:123]
    v_exp_f32 v18, v78
    v_mfma_f32_16x16x32_bf16 v[124:127], v[24:27], v[208:211], v[124:127]
    ds_read_b128 v[44:47], v3 offset:18688
    v_add_f32 v6, v6, v16
    v_mfma_f32_16x16x32_bf16 v[124:127], v[28:31], v[212:215], v[124:127]
    s_waitcnt lgkmcnt(2)
    v_add_u32 v1, 49152, v1
    v_add_f32 v6, v6, v17
    v_mfma_f32_16x16x32_bf16 v[88:91], v[32:35], v[192:195], v[88:91]
    ds_read_b128 v[24:27], v1 offset:0
    v_mfma_f32_16x16x32_bf16 v[88:91], v[36:39], v[196:199], v[88:91]
    v_exp_f32 v19, v79
    v_cvt_pk_bf16_f32 v76, v16, v17
    v_mfma_f32_16x16x32_bf16 v[92:95], v[32:35], v[216:219], v[92:95]
    ds_read_b128 v[28:31], v1 offset:12288
    v_mfma_f32_16x16x32_bf16 v[92:95], v[36:39], v[220:223], v[92:95]
    s_waitcnt lgkmcnt(2)
    v_exp_f32 v16, v108
    v_add_f32 v6, v6, v18
    v_mfma_f32_16x16x32_bf16 v[120:123], v[40:43], v[192:195], v[120:123]
    ds_read_b128 v[32:35], v1 offset:1024
    v_add_f32 v6, v6, v19
    v_mfma_f32_16x16x32_bf16 v[120:123], v[44:47], v[196:199], v[120:123]
    v_exp_f32 v17, v109
    v_cvt_pk_bf16_f32 v77, v18, v19
    v_mfma_f32_16x16x32_bf16 v[124:127], v[40:43], v[216:219], v[124:127]
    ds_read_b128 v[36:39], v1 offset:13312
    v_mfma_f32_16x16x32_bf16 v[124:127], v[44:47], v[220:223], v[124:127]
    s_waitcnt lgkmcnt(2)
    v_exp_f32 v18, v110
    v_add_f32 v6, v6, v16
    v_add_f32 v6, v6, v17
    v_exp_f32 v19, v111
    v_cvt_pk_bf16_f32 v78, v16, v17
    v_add_f32 v6, v6, v18
    v_add_f32 v6, v6, v19
    v_cvt_pk_bf16_f32 v79, v18, v19
    v_mfma_f32_16x16x32_bf16 a[0:3], v[24:27], v[160:163], a[0:3]
    ds_read_b128 v[40:43], v1 offset:2048
    v_mfma_f32_16x16x32_bf16 a[0:3], v[28:31], v[168:171], a[0:3]
    v_exp_f32 v16, v80
    v_mfma_f32_16x16x32_bf16 a[48:51], v[24:27], v[164:167], a[48:51]
    ds_read_b128 v[44:47], v1 offset:14336
    v_mfma_f32_16x16x32_bf16 a[48:51], v[28:31], v[172:175], a[48:51]
    s_waitcnt lgkmcnt(2)
    v_exp_f32 v17, v81
    v_mfma_f32_16x16x32_bf16 a[4:7], v[32:35], v[160:163], a[4:7]
    ds_read_b128 v[24:27], v1 offset:3072
    v_mfma_f32_16x16x32_bf16 a[4:7], v[36:39], v[168:171], a[4:7]
    v_exp_f32 v18, v82
    v_mfma_f32_16x16x32_bf16 a[52:55], v[32:35], v[164:167], a[52:55]
    ds_read_b128 v[28:31], v1 offset:15360
    v_add_f32 v7, v7, v16
    v_mfma_f32_16x16x32_bf16 a[52:55], v[36:39], v[172:175], a[52:55]
    s_waitcnt lgkmcnt(2)
    v_add_f32 v7, v7, v17
    v_mfma_f32_16x16x32_bf16 a[8:11], v[40:43], v[160:163], a[8:11]
    ds_read_b128 v[32:35], v1 offset:4096
    v_mfma_f32_16x16x32_bf16 a[8:11], v[44:47], v[168:171], a[8:11]
    v_exp_f32 v19, v83
    v_mfma_f32_16x16x32_bf16 a[56:59], v[40:43], v[164:167], a[56:59]
    ds_read_b128 v[36:39], v1 offset:16384
    v_cvt_pk_bf16_f32 v80, v16, v17
    v_mfma_f32_16x16x32_bf16 a[56:59], v[44:47], v[172:175], a[56:59]
    s_waitcnt lgkmcnt(2)
    v_exp_f32 v16, v112
    v_mfma_f32_16x16x32_bf16 a[12:15], v[24:27], v[160:163], a[12:15]
    ds_read_b128 v[40:43], v1 offset:5120
    v_add_f32 v7, v7, v18
    v_mfma_f32_16x16x32_bf16 a[12:15], v[28:31], v[168:171], a[12:15]
    v_add_f32 v7, v7, v19
    v_mfma_f32_16x16x32_bf16 a[60:63], v[24:27], v[164:167], a[60:63]
    ds_read_b128 v[44:47], v1 offset:17408
    v_mfma_f32_16x16x32_bf16 a[60:63], v[28:31], v[172:175], a[60:63]
    s_waitcnt lgkmcnt(2)
    v_exp_f32 v17, v113
    v_mfma_f32_16x16x32_bf16 a[16:19], v[32:35], v[160:163], a[16:19]
    ds_read_b128 v[24:27], v1 offset:6144
    v_cvt_pk_bf16_f32 v81, v18, v19
    v_mfma_f32_16x16x32_bf16 a[16:19], v[36:39], v[168:171], a[16:19]
    v_exp_f32 v18, v114
    v_mfma_f32_16x16x32_bf16 a[64:67], v[32:35], v[164:167], a[64:67]
    ds_read_b128 v[28:31], v1 offset:18432
    v_add_f32 v7, v7, v16
    v_mfma_f32_16x16x32_bf16 a[64:67], v[36:39], v[172:175], a[64:67]
    s_waitcnt lgkmcnt(2)
    v_add_f32 v7, v7, v17
    v_mfma_f32_16x16x32_bf16 a[20:23], v[40:43], v[160:163], a[20:23]
    ds_read_b128 v[32:35], v1 offset:7168
    v_mfma_f32_16x16x32_bf16 a[20:23], v[44:47], v[168:171], a[20:23]
    v_exp_f32 v19, v115
    v_cvt_pk_bf16_f32 v82, v16, v17
    v_mfma_f32_16x16x32_bf16 a[68:71], v[40:43], v[164:167], a[68:71]
    ds_read_b128 v[36:39], v1 offset:19456
    v_mfma_f32_16x16x32_bf16 a[68:71], v[44:47], v[172:175], a[68:71]
    s_waitcnt lgkmcnt(2)
    v_exp_f32 v16, v84
    v_add_f32 v7, v7, v18
    v_mfma_f32_16x16x32_bf16 a[24:27], v[24:27], v[160:163], a[24:27]
    ds_read_b128 v[40:43], v1 offset:8192
    v_add_f32 v7, v7, v19
    v_mfma_f32_16x16x32_bf16 a[24:27], v[28:31], v[168:171], a[24:27]
    v_exp_f32 v17, v85
    v_mfma_f32_16x16x32_bf16 a[72:75], v[24:27], v[164:167], a[72:75]
    ds_read_b128 v[44:47], v1 offset:20480
    v_cvt_pk_bf16_f32 v83, v18, v19
    v_mfma_f32_16x16x32_bf16 a[72:75], v[28:31], v[172:175], a[72:75]
    s_waitcnt lgkmcnt(2)
    v_exp_f32 v18, v86
    v_mfma_f32_16x16x32_bf16 a[28:31], v[32:35], v[160:163], a[28:31]
    ds_read_b128 v[24:27], v1 offset:9216
    v_add_f32 v8, v8, v16
    v_mfma_f32_16x16x32_bf16 a[28:31], v[36:39], v[168:171], a[28:31]
    v_add_f32 v8, v8, v17
    v_mfma_f32_16x16x32_bf16 a[76:79], v[32:35], v[164:167], a[76:79]
    ds_read_b128 v[28:31], v1 offset:21504
    v_mfma_f32_16x16x32_bf16 a[76:79], v[36:39], v[172:175], a[76:79]
    s_waitcnt lgkmcnt(2)
    v_exp_f32 v19, v87
    v_cvt_pk_bf16_f32 v84, v16, v17
    v_mfma_f32_16x16x32_bf16 a[32:35], v[40:43], v[160:163], a[32:35]
    ds_read_b128 v[32:35], v1 offset:10240
    v_mfma_f32_16x16x32_bf16 a[32:35], v[44:47], v[168:171], a[32:35]
    v_exp_f32 v16, v116
    v_add_f32 v8, v8, v18
    v_mfma_f32_16x16x32_bf16 a[80:83], v[40:43], v[164:167], a[80:83]
    ds_read_b128 v[36:39], v1 offset:22528
    v_add_f32 v8, v8, v19
    v_mfma_f32_16x16x32_bf16 a[80:83], v[44:47], v[172:175], a[80:83]
    s_waitcnt lgkmcnt(2)
    v_exp_f32 v17, v117
    v_mfma_f32_16x16x32_bf16 a[36:39], v[24:27], v[160:163], a[36:39]
    ds_read_b128 v[40:43], v1 offset:11264
    v_cvt_pk_bf16_f32 v85, v18, v19
    v_mfma_f32_16x16x32_bf16 a[36:39], v[28:31], v[168:171], a[36:39]
    v_exp_f32 v18, v118
    v_mfma_f32_16x16x32_bf16 a[84:87], v[24:27], v[164:167], a[84:87]
    ds_read_b128 v[44:47], v1 offset:23552
    v_add_f32 v8, v8, v16
    v_mfma_f32_16x16x32_bf16 a[84:87], v[28:31], v[172:175], a[84:87]
    s_waitcnt lgkmcnt(2)
    v_subrev_u32 v1, 98304, v1
    v_add_f32 v8, v8, v17
    v_mfma_f32_16x16x32_bf16 a[40:43], v[32:35], v[160:163], a[40:43]
    ds_read_b128 v[24:27], v1 offset:0
    v_mfma_f32_16x16x32_bf16 a[40:43], v[36:39], v[168:171], a[40:43]
    v_exp_f32 v19, v119
    v_cvt_pk_bf16_f32 v86, v16, v17
    v_mfma_f32_16x16x32_bf16 a[88:91], v[32:35], v[164:167], a[88:91]
    ds_read_b128 v[28:31], v1 offset:12288
    v_add_f32 v8, v8, v18
    v_mfma_f32_16x16x32_bf16 a[88:91], v[36:39], v[172:175], a[88:91]
    s_waitcnt lgkmcnt(2)
    v_add_f32 v8, v8, v19
    v_cvt_pk_bf16_f32 v87, v18, v19
    v_mfma_f32_16x16x32_bf16 a[44:47], v[40:43], v[160:163], a[44:47]
    ds_read_b128 v[32:35], v1 offset:1024
    v_mfma_f32_16x16x32_bf16 a[44:47], v[44:47], v[168:171], a[44:47]
    v_exp_f32 v16, v88
    v_mfma_f32_16x16x32_bf16 a[92:95], v[40:43], v[164:167], a[92:95]
    ds_read_b128 v[36:39], v1 offset:13312
    v_mfma_f32_16x16x32_bf16 a[92:95], v[44:47], v[172:175], a[92:95]
    s_waitcnt lgkmcnt(2)
    v_exp_f32 v17, v89
    v_mfma_f32_16x16x32_bf16 a[0:3], v[24:27], v[176:179], a[0:3]
    ds_read_b128 v[40:43], v1 offset:2048
    v_mfma_f32_16x16x32_bf16 a[0:3], v[28:31], v[184:187], a[0:3]
    v_exp_f32 v18, v90
    v_add_f32 v7, v7, v16
    v_mfma_f32_16x16x32_bf16 a[48:51], v[24:27], v[180:183], a[48:51]
    ds_read_b128 v[44:47], v1 offset:14336
    v_add_f32 v7, v7, v17
    v_mfma_f32_16x16x32_bf16 a[48:51], v[28:31], v[188:191], a[48:51]
    s_waitcnt lgkmcnt(2)
    v_exp_f32 v19, v91
    v_cvt_pk_bf16_f32 v88, v16, v17
    v_mfma_f32_16x16x32_bf16 a[4:7], v[32:35], v[176:179], a[4:7]
    ds_read_b128 v[24:27], v1 offset:3072
    v_mfma_f32_16x16x32_bf16 a[4:7], v[36:39], v[184:187], a[4:7]
    v_exp_f32 v16, v120
    v_mfma_f32_16x16x32_bf16 a[52:55], v[32:35], v[180:183], a[52:55]
    ds_read_b128 v[28:31], v1 offset:15360
    v_add_f32 v7, v7, v18
    v_mfma_f32_16x16x32_bf16 a[52:55], v[36:39], v[188:191], a[52:55]
    s_waitcnt lgkmcnt(2)
    v_add_f32 v7, v7, v19
    v_exp_f32 v17, v121
    v_mfma_f32_16x16x32_bf16 a[8:11], v[40:43], v[176:179], a[8:11]
    ds_read_b128 v[32:35], v1 offset:4096
    v_cvt_pk_bf16_f32 v89, v18, v19
    v_mfma_f32_16x16x32_bf16 a[8:11], v[44:47], v[184:187], a[8:11]
    v_exp_f32 v18, v122
    v_mfma_f32_16x16x32_bf16 a[56:59], v[40:43], v[180:183], a[56:59]
    ds_read_b128 v[36:39], v1 offset:16384
    v_add_f32 v7, v7, v16
    v_mfma_f32_16x16x32_bf16 a[56:59], v[44:47], v[188:191], a[56:59]
    s_waitcnt lgkmcnt(2)
    v_add_f32 v7, v7, v17
    v_mfma_f32_16x16x32_bf16 a[12:15], v[24:27], v[176:179], a[12:15]
    ds_read_b128 v[40:43], v1 offset:5120
    v_mfma_f32_16x16x32_bf16 a[12:15], v[28:31], v[184:187], a[12:15]
    v_exp_f32 v19, v123
    v_mfma_f32_16x16x32_bf16 a[60:63], v[24:27], v[180:183], a[60:63]
    ds_read_b128 v[44:47], v1 offset:17408
    v_cvt_pk_bf16_f32 v90, v16, v17
    v_mfma_f32_16x16x32_bf16 a[60:63], v[28:31], v[188:191], a[60:63]
    s_waitcnt lgkmcnt(2)
    v_exp_f32 v16, v92
    v_mfma_f32_16x16x32_bf16 a[16:19], v[32:35], v[176:179], a[16:19]
    ds_read_b128 v[24:27], v1 offset:6144
    v_add_f32 v7, v7, v18
    v_mfma_f32_16x16x32_bf16 a[16:19], v[36:39], v[184:187], a[16:19]
    v_add_f32 v7, v7, v19
    v_exp_f32 v17, v93
    v_mfma_f32_16x16x32_bf16 a[64:67], v[32:35], v[180:183], a[64:67]
    ds_read_b128 v[28:31], v1 offset:18432
    v_cvt_pk_bf16_f32 v91, v18, v19
    v_mfma_f32_16x16x32_bf16 a[64:67], v[36:39], v[188:191], a[64:67]
    s_waitcnt lgkmcnt(2)
    v_exp_f32 v18, v94
    v_mfma_f32_16x16x32_bf16 a[20:23], v[40:43], v[176:179], a[20:23]
    ds_read_b128 v[32:35], v1 offset:7168
    v_add_f32 v8, v8, v16
    v_mfma_f32_16x16x32_bf16 a[20:23], v[44:47], v[184:187], a[20:23]
    v_add_f32 v8, v8, v17
    v_mfma_f32_16x16x32_bf16 a[68:71], v[40:43], v[180:183], a[68:71]
    ds_read_b128 v[36:39], v1 offset:19456
    v_mfma_f32_16x16x32_bf16 a[68:71], v[44:47], v[188:191], a[68:71]
    s_waitcnt lgkmcnt(2)
    v_exp_f32 v19, v95
    v_mfma_f32_16x16x32_bf16 a[24:27], v[24:27], v[176:179], a[24:27]
    ds_read_b128 v[40:43], v1 offset:8192
    v_cvt_pk_bf16_f32 v92, v16, v17
    v_mfma_f32_16x16x32_bf16 a[24:27], v[28:31], v[184:187], a[24:27]
    v_exp_f32 v16, v124
    v_mfma_f32_16x16x32_bf16 a[72:75], v[24:27], v[180:183], a[72:75]
    ds_read_b128 v[44:47], v1 offset:20480
    v_add_f32 v8, v8, v18
    v_mfma_f32_16x16x32_bf16 a[72:75], v[28:31], v[188:191], a[72:75]
    s_waitcnt lgkmcnt(2)
    v_add_f32 v8, v8, v19
    v_exp_f32 v17, v125
    v_mfma_f32_16x16x32_bf16 a[28:31], v[32:35], v[176:179], a[28:31]
    ds_read_b128 v[24:27], v1 offset:9216
    v_cvt_pk_bf16_f32 v93, v18, v19
    v_mfma_f32_16x16x32_bf16 a[28:31], v[36:39], v[184:187], a[28:31]
    s_waitcnt vmcnt(0)
    v_exp_f32 v18, v126
    v_mfma_f32_16x16x32_bf16 a[76:79], v[32:35], v[180:183], a[76:79]
    ds_read_b128 v[28:31], v1 offset:21504
    v_add_f32 v8, v8, v16
    v_mfma_f32_16x16x32_bf16 a[76:79], v[36:39], v[188:191], a[76:79]
    s_waitcnt lgkmcnt(2)
    s_barrier
    v_mfma_f32_16x16x32_bf16 a[32:35], v[40:43], v[176:179], a[32:35]
    ds_read_b128 v[32:35], v1 offset:10240
    v_add_f32 v8, v8, v17
    v_mfma_f32_16x16x32_bf16 a[32:35], v[44:47], v[184:187], a[32:35]
    v_exp_f32 v19, v127
    v_mfma_f32_16x16x32_bf16 a[80:83], v[40:43], v[180:183], a[80:83]
    ds_read_b128 v[36:39], v1 offset:22528
    v_cvt_pk_bf16_f32 v94, v16, v17
    v_mfma_f32_16x16x32_bf16 a[80:83], v[44:47], v[188:191], a[80:83]
    s_waitcnt lgkmcnt(2)
    v_add_f32 v8, v8, v18
    v_add_f32 v8, v8, v19
    v_mfma_f32_16x16x32_bf16 a[36:39], v[24:27], v[176:179], a[36:39]
    ds_read_b128 v[40:43], v1 offset:11264
    v_cvt_pk_bf16_f32 v95, v18, v19
    v_mfma_f32_16x16x32_bf16 a[36:39], v[28:31], v[184:187], a[36:39]
    v_mov_b32 v48, v5
    v_mov_b32 v50, v6
    v_mfma_f32_16x16x32_bf16 a[84:87], v[24:27], v[180:183], a[84:87]
    s_nop 0
    ds_read_b128 v[44:47], v1 offset:23552
    v_permlane16_swap_b32 v5, v48
    v_mfma_f32_16x16x32_bf16 a[84:87], v[28:31], v[188:191], a[84:87]
    s_waitcnt lgkmcnt(2)
    v_add_u32 v1, 49152, v1
    v_permlane16_swap_b32 v6, v50
    v_mfma_f32_16x16x32_bf16 a[40:43], v[32:35], v[176:179], a[40:43]
    s_nop 0
    ds_read_b128 v[24:27], v1 offset:0
    v_add_f32 v5, v5, v48
    v_mfma_f32_16x16x32_bf16 a[40:43], v[36:39], v[184:187], a[40:43]
    v_add_f32 v6, v6, v50
    v_mov_b32 v48, v5
    v_mfma_f32_16x16x32_bf16 a[88:91], v[32:35], v[180:183], a[88:91]
    ds_read_b128 v[28:31], v1 offset:12288
    v_mov_b32 v50, v6
    v_mfma_f32_16x16x32_bf16 a[88:91], v[36:39], v[188:191], a[88:91]
    s_waitcnt lgkmcnt(2)
    s_nop 0
    v_permlane32_swap_b32 v5, v48
    v_mfma_f32_16x16x32_bf16 a[44:47], v[40:43], v[176:179], a[44:47]
    ds_read_b128 v[32:35], v1 offset:1024
    v_permlane32_swap_b32 v6, v50
    v_mfma_f32_16x16x32_bf16 a[44:47], v[44:47], v[184:187], a[44:47]
    s_nop 0
    v_add_f32 v5, v5, v48
    v_add_f32 v6, v6, v50
    v_mfma_f32_16x16x32_bf16 a[92:95], v[40:43], v[180:183], a[92:95]
    ds_read_b128 v[36:39], v1 offset:13312
    v_mfma_f32_16x16x32_bf16 a[92:95], v[44:47], v[188:191], a[92:95]
    s_waitcnt lgkmcnt(2)
    v_rcp_f32 v48, v5
    v_rcp_f32 v50, v6
    s_nop 0
    v_mfma_f32_16x16x32_bf16 a[0:3], v[24:27], v[64:67], a[0:3]
    ds_read_b128 v[40:43], v1 offset:2048
    v_mfma_f32_16x16x32_bf16 a[0:3], v[28:31], v[72:75], a[0:3]
    v_mfma_f32_16x16x32_bf16 a[48:51], v[24:27], v[68:71], a[48:51]
    ds_read_b128 v[44:47], v1 offset:14336
    v_mfma_f32_16x16x32_bf16 a[48:51], v[28:31], v[76:79], a[48:51]
    s_waitcnt lgkmcnt(2)
    v_mfma_f32_16x16x32_bf16 a[4:7], v[32:35], v[64:67], a[4:7]
    ds_read_b128 v[24:27], v1 offset:3072
    v_mfma_f32_16x16x32_bf16 a[4:7], v[36:39], v[72:75], a[4:7]
    v_mfma_f32_16x16x32_bf16 a[52:55], v[32:35], v[68:71], a[52:55]
    ds_read_b128 v[28:31], v1 offset:15360
    v_mfma_f32_16x16x32_bf16 a[52:55], v[36:39], v[76:79], a[52:55]
    s_waitcnt lgkmcnt(2)
    v_mfma_f32_16x16x32_bf16 a[8:11], v[40:43], v[64:67], a[8:11]
    ds_read_b128 v[32:35], v1 offset:4096
    v_mfma_f32_16x16x32_bf16 a[8:11], v[44:47], v[72:75], a[8:11]
    v_mfma_f32_16x16x32_bf16 a[56:59], v[40:43], v[68:71], a[56:59]
    ds_read_b128 v[36:39], v1 offset:16384
    v_mfma_f32_16x16x32_bf16 a[56:59], v[44:47], v[76:79], a[56:59]
    s_waitcnt lgkmcnt(2)
    v_mfma_f32_16x16x32_bf16 a[12:15], v[24:27], v[64:67], a[12:15]
    ds_read_b128 v[40:43], v1 offset:5120
    v_mfma_f32_16x16x32_bf16 a[12:15], v[28:31], v[72:75], a[12:15]
    v_mfma_f32_16x16x32_bf16 a[60:63], v[24:27], v[68:71], a[60:63]
    ds_read_b128 v[44:47], v1 offset:17408
    v_mfma_f32_16x16x32_bf16 a[60:63], v[28:31], v[76:79], a[60:63]
    s_waitcnt lgkmcnt(2)
    v_mfma_f32_16x16x32_bf16 a[16:19], v[32:35], v[64:67], a[16:19]
    ds_read_b128 v[24:27], v1 offset:6144
    v_mfma_f32_16x16x32_bf16 a[16:19], v[36:39], v[72:75], a[16:19]
    v_mfma_f32_16x16x32_bf16 a[64:67], v[32:35], v[68:71], a[64:67]
    ds_read_b128 v[28:31], v1 offset:18432
    v_mfma_f32_16x16x32_bf16 a[64:67], v[36:39], v[76:79], a[64:67]
    s_waitcnt lgkmcnt(2)
    v_mfma_f32_16x16x32_bf16 a[20:23], v[40:43], v[64:67], a[20:23]
    ds_read_b128 v[32:35], v1 offset:7168
    v_mfma_f32_16x16x32_bf16 a[20:23], v[44:47], v[72:75], a[20:23]
    v_mfma_f32_16x16x32_bf16 a[68:71], v[40:43], v[68:71], a[68:71]
    ds_read_b128 v[36:39], v1 offset:19456
    v_mfma_f32_16x16x32_bf16 a[68:71], v[44:47], v[76:79], a[68:71]
    s_waitcnt lgkmcnt(2)
    v_mfma_f32_16x16x32_bf16 a[24:27], v[24:27], v[64:67], a[24:27]
    ds_read_b128 v[40:43], v1 offset:8192
    v_mfma_f32_16x16x32_bf16 a[24:27], v[28:31], v[72:75], a[24:27]
    v_mfma_f32_16x16x32_bf16 a[72:75], v[24:27], v[68:71], a[72:75]
    ds_read_b128 v[44:47], v1 offset:20480
    v_mfma_f32_16x16x32_bf16 a[72:75], v[28:31], v[76:79], a[72:75]
    s_waitcnt lgkmcnt(2)
    v_mfma_f32_16x16x32_bf16 a[28:31], v[32:35], v[64:67], a[28:31]
    ds_read_b128 v[24:27], v1 offset:9216
    v_mfma_f32_16x16x32_bf16 a[28:31], v[36:39], v[72:75], a[28:31]
    v_mfma_f32_16x16x32_bf16 a[76:79], v[32:35], v[68:71], a[76:79]
    ds_read_b128 v[28:31], v1 offset:21504
    v_mfma_f32_16x16x32_bf16 a[76:79], v[36:39], v[76:79], a[76:79]
    s_waitcnt lgkmcnt(2)
    v_mfma_f32_16x16x32_bf16 a[32:35], v[40:43], v[64:67], a[32:35]
    ds_read_b128 v[32:35], v1 offset:10240
    v_mfma_f32_16x16x32_bf16 a[32:35], v[44:47], v[72:75], a[32:35]
    v_mfma_f32_16x16x32_bf16 a[80:83], v[40:43], v[68:71], a[80:83]
    ds_read_b128 v[36:39], v1 offset:22528
    v_mfma_f32_16x16x32_bf16 a[80:83], v[44:47], v[76:79], a[80:83]
    s_waitcnt lgkmcnt(2)
    v_mfma_f32_16x16x32_bf16 a[36:39], v[24:27], v[64:67], a[36:39]
    ds_read_b128 v[40:43], v1 offset:11264
    v_mfma_f32_16x16x32_bf16 a[36:39], v[28:31], v[72:75], a[36:39]
    v_mfma_f32_16x16x32_bf16 a[84:87], v[24:27], v[68:71], a[84:87]
    ds_read_b128 v[44:47], v1 offset:23552
    v_mfma_f32_16x16x32_bf16 a[84:87], v[28:31], v[76:79], a[84:87]
    s_waitcnt lgkmcnt(2)
    v_subrev_u32 v2, 98304, v2
    v_subrev_u32 v3, 98304, v3
    v_mfma_f32_16x16x32_bf16 a[40:43], v[32:35], v[64:67], a[40:43]
    ds_read_b128 v[24:27], v2 offset:0
    v_mfma_f32_16x16x32_bf16 a[40:43], v[36:39], v[72:75], a[40:43]
    v_mfma_f32_16x16x32_bf16 a[88:91], v[32:35], v[68:71], a[88:91]
    ds_read_b128 v[28:31], v3 offset:0
    v_mfma_f32_16x16x32_bf16 a[88:91], v[36:39], v[76:79], a[88:91]
    s_waitcnt lgkmcnt(2)
    v_mfma_f32_16x16x32_bf16 a[44:47], v[40:43], v[64:67], a[44:47]
    ds_read_b128 v[32:35], v2 offset:6144
    v_mfma_f32_16x16x32_bf16 a[44:47], v[44:47], v[72:75], a[44:47]
    v_mfma_f32_16x16x32_bf16 a[92:95], v[40:43], v[68:71], a[92:95]
    ds_read_b128 v[36:39], v3 offset:6144
    v_mfma_f32_16x16x32_bf16 a[92:95], v[44:47], v[76:79], a[92:95]
    s_waitcnt lgkmcnt(2)
    v_mfma_f32_16x16x32_bf16 v[160:163], v[24:27], a[240:243], v[136:139]
    ds_read_b128 v[40:43], v2 offset:128
    v_mfma_f32_16x16x32_bf16 v[160:163], v[28:31], a[244:247], v[160:163]
    v_mfma_f32_16x16x32_bf16 v[164:167], v[24:27], v[200:203], v[140:143]
    ds_read_b128 v[44:47], v3 offset:128
    v_mfma_f32_16x16x32_bf16 v[164:167], v[28:31], v[204:207], v[164:167]
    s_waitcnt lgkmcnt(2)
    v_mfma_f32_16x16x32_bf16 v[96:99], v[32:35], a[240:243], v[136:139]
    ds_read_b128 v[24:27], v2 offset:6272
    v_accvgpr_read_b32 v224, a0
    v_mfma_f32_16x16x32_bf16 v[96:99], v[36:39], a[244:247], v[96:99]
    v_accvgpr_read_b32 v225, a12
    v_accvgpr_read_b32 v226, a24
    v_mfma_f32_16x16x32_bf16 v[100:103], v[32:35], v[200:203], v[140:143]
    ds_read_b128 v[28:31], v3 offset:6272
    v_accvgpr_read_b32 v227, a36
    v_mfma_f32_16x16x32_bf16 v[100:103], v[36:39], v[204:207], v[100:103]
    s_waitcnt lgkmcnt(2)
    v_accvgpr_read_b32 v228, a1
    v_accvgpr_read_b32 v229, a13
    v_mfma_f32_16x16x32_bf16 v[160:163], v[40:43], a[248:251], v[160:163]
    ds_read_b128 v[32:35], v2 offset:256
    v_accvgpr_read_b32 v230, a25
    v_mfma_f32_16x16x32_bf16 v[160:163], v[44:47], a[252:255], v[160:163]
    v_accvgpr_read_b32 v231, a37
    v_mul_f32 v224, v224, v48
    v_mul_f32 v225, v225, v48
    v_mul_f32 v226, v226, v48
    v_mfma_f32_16x16x32_bf16 v[164:167], v[40:43], v[208:211], v[164:167]
    ds_read_b128 v[36:39], v3 offset:256
    v_mul_f32 v227, v227, v48
    v_mfma_f32_16x16x32_bf16 v[164:167], v[44:47], v[212:215], v[164:167]
    s_waitcnt lgkmcnt(2)
    v_mul_f32 v228, v228, v48
    v_mul_f32 v229, v229, v48
    v_mul_f32 v230, v230, v48
    v_mul_f32 v231, v231, v48
    v_mfma_f32_16x16x32_bf16 v[96:99], v[24:27], a[248:251], v[96:99]
    ds_read_b128 v[40:43], v2 offset:6400
    v_cvt_pk_bf16_f32 v224, v224, v225
    v_mfma_f32_16x16x32_bf16 v[96:99], v[28:31], a[252:255], v[96:99]
    v_cvt_pk_bf16_f32 v225, v226, v227
    v_cvt_pk_bf16_f32 v226, v228, v229
    v_cvt_pk_bf16_f32 v227, v230, v231
    v_mfma_f32_16x16x32_bf16 v[100:103], v[24:27], v[208:211], v[100:103]
    ds_read_b128 v[44:47], v3 offset:6400
    v_mfma_f32_16x16x32_bf16 v[100:103], v[28:31], v[212:215], v[100:103]
    s_waitcnt lgkmcnt(2)
    ds_write_b128 v56, v[224:227] offset:0
    v_mfma_f32_16x16x32_bf16 v[160:163], v[32:35], v[192:195], v[160:163]
    ds_read_b128 v[24:27], v2 offset:12288
    v_accvgpr_read_b32 v232, a2
    v_mfma_f32_16x16x32_bf16 v[160:163], v[36:39], v[196:199], v[160:163]
    v_accvgpr_read_b32 v233, a14
    v_accvgpr_read_b32 v234, a26
    v_accvgpr_read_b32 v235, a38
    v_accvgpr_read_b32 v236, a3
    v_mfma_f32_16x16x32_bf16 v[164:167], v[32:35], v[216:219], v[164:167]
    ds_read_b128 v[28:31], v3 offset:12288
    v_accvgpr_read_b32 v237, a15
    v_mfma_f32_16x16x32_bf16 v[164:167], v[36:39], v[220:223], v[164:167]
    s_waitcnt lgkmcnt(3)
    v_accvgpr_read_b32 v238, a27
    v_accvgpr_read_b32 v239, a39
    v_mul_f32 v232, v232, v48
    v_mul_f32 v233, v233, v48
    v_mfma_f32_16x16x32_bf16 v[96:99], v[40:43], v[192:195], v[96:99]
    ds_read_b128 v[32:35], v2 offset:18432
    v_mul_f32 v234, v234, v48
    v_mfma_f32_16x16x32_bf16 v[96:99], v[44:47], v[196:199], v[96:99]
    v_mul_f32 v235, v235, v48
    v_mul_f32 v236, v236, v48
    v_mul_f32 v237, v237, v48
    v_mul_f32 v238, v238, v48
    v_mfma_f32_16x16x32_bf16 v[100:103], v[40:43], v[216:219], v[100:103]
    ds_read_b128 v[36:39], v3 offset:18432
    v_mul_f32 v239, v239, v48
    v_mfma_f32_16x16x32_bf16 v[100:103], v[44:47], v[220:223], v[100:103]
    s_waitcnt lgkmcnt(2)
    v_cvt_pk_bf16_f32 v232, v232, v233
    v_cvt_pk_bf16_f32 v233, v234, v235
    v_cvt_pk_bf16_f32 v234, v236, v237
    v_cvt_pk_bf16_f32 v235, v238, v239
    v_mfma_f32_16x16x32_bf16 v[168:171], v[24:27], a[240:243], v[136:139]
    ds_read_b128 v[40:43], v2 offset:12416
    v_mfma_f32_16x16x32_bf16 v[168:171], v[28:31], a[244:247], v[168:171]
    ds_write_b128 v57, v[232:235] offset:0
    v_mfma_f32_16x16x32_bf16 v[172:175], v[24:27], v[200:203], v[140:143]
    ds_read_b128 v[44:47], v3 offset:12416
    ds_read_b128 v[144:147], v58 offset:0
    v_mfma_f32_16x16x32_bf16 v[172:175], v[28:31], v[204:207], v[172:175]
    s_waitcnt lgkmcnt(4)
    ds_read_b128 v[148:151], v58 offset:1024
    v_accvgpr_read_b32 v240, a4
    v_accvgpr_read_b32 v241, a16
    v_accvgpr_read_b32 v242, a28
    v_mfma_f32_16x16x32_bf16 v[104:107], v[32:35], a[240:243], v[136:139]
    ds_read_b128 v[24:27], v2 offset:18560
    v_accvgpr_read_b32 v243, a40
    v_mfma_f32_16x16x32_bf16 v[104:107], v[36:39], a[244:247], v[104:107]
    v_accvgpr_read_b32 v244, a5
    v_accvgpr_read_b32 v245, a17
    v_accvgpr_read_b32 v246, a29
    v_accvgpr_read_b32 v247, a41
    v_mfma_f32_16x16x32_bf16 v[108:111], v[32:35], v[200:203], v[140:143]
    ds_read_b128 v[28:31], v3 offset:18560
    v_mul_f32 v240, v240, v48
    v_mfma_f32_16x16x32_bf16 v[108:111], v[36:39], v[204:207], v[108:111]
    s_waitcnt lgkmcnt(4)
    v_mul_f32 v241, v241, v48
    v_mul_f32 v242, v242, v48
    v_mul_f32 v243, v243, v48
    v_mul_f32 v244, v244, v48
    v_mfma_f32_16x16x32_bf16 v[168:171], v[40:43], a[248:251], v[168:171]
    ds_read_b128 v[32:35], v2 offset:12544
    v_mul_f32 v245, v245, v48
    v_mfma_f32_16x16x32_bf16 v[168:171], v[44:47], a[252:255], v[168:171]
    v_mul_f32 v246, v246, v48
    v_mul_f32 v247, v247, v48
    v_cvt_pk_bf16_f32 v240, v240, v241
    v_cvt_pk_bf16_f32 v241, v242, v243
    v_mfma_f32_16x16x32_bf16 v[172:175], v[40:43], v[208:211], v[172:175]
    ds_read_b128 v[36:39], v3 offset:12544
    v_cvt_pk_bf16_f32 v242, v244, v245
    v_mfma_f32_16x16x32_bf16 v[172:175], v[44:47], v[212:215], v[172:175]
    s_waitcnt lgkmcnt(2)
    v_exp_f32 v16, v160
    v_cvt_pk_bf16_f32 v243, v246, v247
    s_waitcnt lgkmcnt(5)
    v_mfma_f32_16x16x32_bf16 v[104:107], v[24:27], a[248:251], v[104:107]
    ds_read_b128 v[40:43], v2 offset:18688
    v_mfma_f32_16x16x32_bf16 v[104:107], v[28:31], a[252:255], v[104:107]
    buffer_store_dwordx4 v[144:147], v59, s[12:15], s24 offen offset:0 sc0 sc1
    v_mfma_f32_16x16x32_bf16 v[108:111], v[24:27], v[208:211], v[108:111]
    ds_read_b128 v[44:47], v3 offset:18688
    v_mfma_f32_16x16x32_bf16 v[108:111], v[28:31], v[212:215], v[108:111]
    s_waitcnt lgkmcnt(2)
    v_add_u32 v2, 49152, v2
    v_add_u32 v3, 49152, v3
    v_mfma_f32_16x16x32_bf16 v[168:171], v[32:35], v[192:195], v[168:171]
    ds_read_b128 v[24:27], v2 offset:0
    v_mfma_f32_16x16x32_bf16 v[168:171], v[36:39], v[196:199], v[168:171]
    v_exp_f32 v17, v161
    v_mfma_f32_16x16x32_bf16 v[172:175], v[32:35], v[216:219], v[172:175]
    ds_read_b128 v[28:31], v3 offset:0
    v_mfma_f32_16x16x32_bf16 v[172:175], v[36:39], v[220:223], v[172:175]
    s_waitcnt lgkmcnt(2)
    v_exp_f32 v18, v162
    v_add_f32 v7, v7, v16
    v_mfma_f32_16x16x32_bf16 v[104:107], v[40:43], v[192:195], v[104:107]
    ds_read_b128 v[32:35], v2 offset:6144
    v_add_f32 v7, v7, v17
    v_mfma_f32_16x16x32_bf16 v[104:107], v[44:47], v[196:199], v[104:107]
    v_exp_f32 v19, v163
    v_cvt_pk_bf16_f32 v160, v16, v17
    v_mfma_f32_16x16x32_bf16 v[108:111], v[40:43], v[216:219], v[108:111]
    ds_read_b128 v[36:39], v3 offset:6144
    v_mfma_f32_16x16x32_bf16 v[108:111], v[44:47], v[220:223], v[108:111]
    s_waitcnt lgkmcnt(2)
    ds_write_b128 v56, v[240:243] offset:2048
    v_exp_f32 v16, v96
    v_add_f32 v7, v7, v18
    v_add_f32 v7, v7, v19
    v_exp_f32 v17, v97
    v_accvgpr_read_b32 v248, a6
    v_cvt_pk_bf16_f32 v161, v18, v19
    v_accvgpr_read_b32 v249, a18
    v_exp_f32 v18, v98
    v_accvgpr_read_b32 v250, a30
    v_accvgpr_read_b32 v251, a42
    v_add_f32 v7, v7, v16
    v_accvgpr_read_b32 v252, a7
    v_add_f32 v7, v7, v17
    v_accvgpr_read_b32 v253, a19
    v_exp_f32 v19, v99
    v_accvgpr_read_b32 v254, a31
    v_accvgpr_read_b32 v255, a43
    v_cvt_pk_bf16_f32 v162, v16, v17
    v_mul_f32 v248, v248, v48
    v_exp_f32 v16, v164
    v_mul_f32 v249, v249, v48
    v_mul_f32 v250, v250, v48
    v_add_f32 v7, v7, v18
    v_mul_f32 v251, v251, v48
    v_add_f32 v7, v7, v19
    v_mul_f32 v252, v252, v48
    v_exp_f32 v17, v165
    v_mul_f32 v253, v253, v48
    v_mul_f32 v254, v254, v48
    v_cvt_pk_bf16_f32 v163, v18, v19
    v_mul_f32 v255, v255, v48
    v_exp_f32 v18, v166
    v_cvt_pk_bf16_f32 v248, v248, v249
    v_cvt_pk_bf16_f32 v249, v250, v251
    v_add_f32 v8, v8, v16
    v_cvt_pk_bf16_f32 v250, v252, v253
    v_add_f32 v8, v8, v17
    v_cvt_pk_bf16_f32 v251, v254, v255
    v_exp_f32 v19, v167
    s_waitcnt lgkmcnt(11)
    buffer_store_dwordx4 v[148:151], v59, s[12:15], s24 offen offset:3072 sc0 sc1
    v_cvt_pk_bf16_f32 v164, v16, v17
    v_exp_f32 v16, v100
    v_add_f32 v8, v8, v18
    v_add_f32 v8, v8, v19
    ds_write_b128 v57, v[248:251] offset:2048
    v_exp_f32 v17, v101
    v_cvt_pk_bf16_f32 v165, v18, v19
    v_exp_f32 v18, v102
    ds_read_b128 v[152:155], v58 offset:2048
    ds_read_b128 v[156:159], v58 offset:3072
    v_add_f32 v8, v8, v16
    v_accvgpr_read_b32 v224, a8
    v_add_f32 v8, v8, v17
    v_accvgpr_read_b32 v225, a20
    v_exp_f32 v19, v103
    v_accvgpr_read_b32 v226, a32
    v_accvgpr_read_b32 v227, a44
    v_cvt_pk_bf16_f32 v166, v16, v17
    v_accvgpr_read_b32 v228, a9
    v_add_f32 v8, v8, v18
    v_accvgpr_read_b32 v229, a21
    v_add_f32 v8, v8, v19
    v_accvgpr_read_b32 v230, a33
    v_cvt_pk_bf16_f32 v167, v18, v19
    v_accvgpr_read_b32 v231, a45
    v_mfma_f32_16x16x32_bf16 v[176:179], v[24:27], a[240:243], v[136:139]
    ds_read_b128 v[40:43], v2 offset:128
    v_mul_f32 v224, v224, v48
    v_mfma_f32_16x16x32_bf16 v[176:179], v[28:31], a[244:247], v[176:179]
    v_mul_f32 v225, v225, v48
    v_mul_f32 v226, v226, v48
    v_mfma_f32_16x16x32_bf16 v[180:183], v[24:27], v[200:203], v[140:143]
    ds_read_b128 v[44:47], v3 offset:128
    v_mul_f32 v227, v227, v48
    v_mfma_f32_16x16x32_bf16 v[180:183], v[28:31], v[204:207], v[180:183]
    s_waitcnt lgkmcnt(6)
    v_exp_f32 v16, v168
    v_mul_f32 v228, v228, v48
    v_mfma_f32_16x16x32_bf16 v[112:115], v[32:35], a[240:243], v[136:139]
    ds_read_b128 v[24:27], v2 offset:6272
    v_mul_f32 v229, v229, v48
    v_mfma_f32_16x16x32_bf16 v[112:115], v[36:39], a[244:247], v[112:115]
    v_exp_f32 v17, v169
    v_mul_f32 v230, v230, v48
    v_mul_f32 v231, v231, v48
    v_mfma_f32_16x16x32_bf16 v[116:119], v[32:35], v[200:203], v[140:143]
    ds_read_b128 v[28:31], v3 offset:6272
    v_cvt_pk_bf16_f32 v224, v224, v225
    v_mfma_f32_16x16x32_bf16 v[116:119], v[36:39], v[204:207], v[116:119]
    s_waitcnt lgkmcnt(2)
    v_exp_f32 v18, v170
    v_cvt_pk_bf16_f32 v225, v226, v227
    v_cvt_pk_bf16_f32 v226, v228, v229
    v_mfma_f32_16x16x32_bf16 v[176:179], v[40:43], a[248:251], v[176:179]
    ds_read_b128 v[32:35], v2 offset:256
    v_add_f32 v7, v7, v16
    v_mfma_f32_16x16x32_bf16 v[176:179], v[44:47], a[252:255], v[176:179]
    v_add_f32 v7, v7, v17
    v_cvt_pk_bf16_f32 v227, v230, v231
    s_waitcnt lgkmcnt(6)
    v_mfma_f32_16x16x32_bf16 v[180:183], v[40:43], v[208:211], v[180:183]
    ds_read_b128 v[36:39], v3 offset:256
    v_mfma_f32_16x16x32_bf16 v[180:183], v[44:47], v[212:215], v[180:183]
    s_waitcnt lgkmcnt(2)
    v_exp_f32 v19, v171
    v_cvt_pk_bf16_f32 v168, v16, v17
    v_mfma_f32_16x16x32_bf16 v[112:115], v[24:27], a[248:251], v[112:115]
    ds_read_b128 v[40:43], v2 offset:6400
    v_mfma_f32_16x16x32_bf16 v[112:115], v[28:31], a[252:255], v[112:115]
    buffer_store_dwordx4 v[152:155], v59, s[12:15], s24 offen offset:128 sc0 sc1
    v_mfma_f32_16x16x32_bf16 v[116:119], v[24:27], v[208:211], v[116:119]
    ds_read_b128 v[44:47], v3 offset:6400
    v_mfma_f32_16x16x32_bf16 v[116:119], v[28:31], v[212:215], v[116:119]
    s_waitcnt lgkmcnt(2)
    v_exp_f32 v16, v104
    v_add_f32 v7, v7, v18
    v_mfma_f32_16x16x32_bf16 v[176:179], v[32:35], v[192:195], v[176:179]
    ds_read_b128 v[24:27], v2 offset:12288
    v_add_f32 v7, v7, v19
    v_mfma_f32_16x16x32_bf16 v[176:179], v[36:39], v[196:199], v[176:179]
    v_exp_f32 v17, v105
    v_cvt_pk_bf16_f32 v169, v18, v19
    v_mfma_f32_16x16x32_bf16 v[180:183], v[32:35], v[216:219], v[180:183]
    ds_read_b128 v[28:31], v3 offset:12288
    v_mfma_f32_16x16x32_bf16 v[180:183], v[36:39], v[220:223], v[180:183]
    s_waitcnt lgkmcnt(2)
    v_exp_f32 v18, v106
    v_add_f32 v7, v7, v16
    v_mfma_f32_16x16x32_bf16 v[112:115], v[40:43], v[192:195], v[112:115]
    ds_read_b128 v[32:35], v2 offset:18432
    v_add_f32 v7, v7, v17
    v_mfma_f32_16x16x32_bf16 v[112:115], v[44:47], v[196:199], v[112:115]
    v_exp_f32 v19, v107
    v_cvt_pk_bf16_f32 v170, v16, v17
    v_mfma_f32_16x16x32_bf16 v[116:119], v[40:43], v[216:219], v[116:119]
    ds_read_b128 v[36:39], v3 offset:18432
    v_mfma_f32_16x16x32_bf16 v[116:119], v[44:47], v[220:223], v[116:119]
    s_waitcnt lgkmcnt(2)
    v_exp_f32 v16, v172
    v_add_f32 v7, v7, v18
    v_mfma_f32_16x16x32_bf16 v[184:187], v[24:27], a[240:243], v[136:139]
    ds_read_b128 v[40:43], v2 offset:12416
    v_add_f32 v7, v7, v19
    v_mfma_f32_16x16x32_bf16 v[184:187], v[28:31], a[244:247], v[184:187]
    v_exp_f32 v17, v173
    v_cvt_pk_bf16_f32 v171, v18, v19
    v_mfma_f32_16x16x32_bf16 v[188:191], v[24:27], v[200:203], v[140:143]
    ds_read_b128 v[44:47], v3 offset:12416
    v_mfma_f32_16x16x32_bf16 v[188:191], v[28:31], v[204:207], v[188:191]
    s_waitcnt lgkmcnt(2)
    v_exp_f32 v18, v174
    v_add_f32 v8, v8, v16
    v_mfma_f32_16x16x32_bf16 v[120:123], v[32:35], a[240:243], v[136:139]
    ds_read_b128 v[24:27], v2 offset:18560
    v_add_f32 v8, v8, v17
    v_mfma_f32_16x16x32_bf16 v[120:123], v[36:39], a[244:247], v[120:123]
    v_exp_f32 v19, v175
    v_cvt_pk_bf16_f32 v172, v16, v17
    v_mfma_f32_16x16x32_bf16 v[124:127], v[32:35], v[200:203], v[140:143]
    ds_read_b128 v[28:31], v3 offset:18560
    v_exp_f32 v16, v108
    v_add_f32 v8, v8, v18
    v_add_f32 v8, v8, v19
    v_exp_f32 v17, v109
    v_cvt_pk_bf16_f32 v173, v18, v19
    v_exp_f32 v18, v110
    v_add_f32 v8, v8, v16
    v_add_f32 v8, v8, v17
    v_exp_f32 v19, v111
    v_cvt_pk_bf16_f32 v174, v16, v17
    v_add_f32 v8, v8, v18
    v_add_f32 v8, v8, v19
    v_cvt_pk_bf16_f32 v175, v18, v19
    v_mfma_f32_16x16x32_bf16 v[124:127], v[36:39], v[204:207], v[124:127]
    s_waitcnt lgkmcnt(2)
    ds_write_b128 v56, v[224:227] offset:4096
    v_mfma_f32_16x16x32_bf16 v[184:187], v[40:43], a[248:251], v[184:187]
    ds_read_b128 v[32:35], v2 offset:12544
    v_accvgpr_read_b32 v232, a10
    v_mfma_f32_16x16x32_bf16 v[184:187], v[44:47], a[252:255], v[184:187]
    v_accvgpr_read_b32 v233, a22
    v_accvgpr_read_b32 v234, a34
    v_accvgpr_read_b32 v235, a46
    v_accvgpr_read_b32 v236, a11
    v_mfma_f32_16x16x32_bf16 v[188:191], v[40:43], v[208:211], v[188:191]
    ds_read_b128 v[36:39], v3 offset:12544
    v_accvgpr_read_b32 v237, a23
    v_mfma_f32_16x16x32_bf16 v[188:191], v[44:47], v[212:215], v[188:191]
    s_waitcnt lgkmcnt(3)
    v_accvgpr_read_b32 v238, a35
    v_accvgpr_read_b32 v239, a47
    v_mul_f32 v232, v232, v48
    v_mul_f32 v233, v233, v48
    v_mfma_f32_16x16x32_bf16 v[120:123], v[24:27], a[248:251], v[120:123]
    ds_read_b128 v[40:43], v2 offset:18688
    v_mul_f32 v234, v234, v48
    v_mfma_f32_16x16x32_bf16 v[120:123], v[28:31], a[252:255], v[120:123]
    v_mul_f32 v235, v235, v48
    v_mul_f32 v236, v236, v48
    v_mul_f32 v237, v237, v48
    v_mul_f32 v238, v238, v48
    v_mfma_f32_16x16x32_bf16 v[124:127], v[24:27], v[208:211], v[124:127]
    ds_read_b128 v[44:47], v3 offset:18688
    v_mul_f32 v239, v239, v48
    v_mfma_f32_16x16x32_bf16 v[124:127], v[28:31], v[212:215], v[124:127]
    s_waitcnt lgkmcnt(2)
    v_add_u32 v1, 49152, v1
    v_cvt_pk_bf16_f32 v232, v232, v233
    v_cvt_pk_bf16_f32 v233, v234, v235
    v_cvt_pk_bf16_f32 v234, v236, v237
    v_mfma_f32_16x16x32_bf16 v[184:187], v[32:35], v[192:195], v[184:187]
    ds_read_b128 v[24:27], v1 offset:0
    v_cvt_pk_bf16_f32 v235, v238, v239
    v_mfma_f32_16x16x32_bf16 v[184:187], v[36:39], v[196:199], v[184:187]
    s_waitcnt lgkmcnt(15)
    v_exp_f32 v16, v176
    v_mfma_f32_16x16x32_bf16 v[188:191], v[32:35], v[216:219], v[188:191]
    ds_read_b128 v[28:31], v1 offset:12288
    v_mfma_f32_16x16x32_bf16 v[188:191], v[36:39], v[220:223], v[188:191]
    s_waitcnt lgkmcnt(2)
    v_exp_f32 v17, v177
    v_mfma_f32_16x16x32_bf16 v[120:123], v[40:43], v[192:195], v[120:123]
    ds_read_b128 v[32:35], v1 offset:1024
    v_mfma_f32_16x16x32_bf16 v[120:123], v[44:47], v[196:199], v[120:123]
    buffer_store_dwordx4 v[156:159], v59, s[12:15], s24 offen offset:3200 sc0 sc1
    v_mfma_f32_16x16x32_bf16 v[124:127], v[40:43], v[216:219], v[124:127]
    ds_read_b128 v[36:39], v1 offset:13312
    v_mfma_f32_16x16x32_bf16 v[124:127], v[44:47], v[220:223], v[124:127]
    s_waitcnt lgkmcnt(2)
    ds_write_b128 v57, v[232:235] offset:4096
    v_mfma_f32_16x16x32_bf16 a[96:99], v[24:27], v[80:83], a[96:99]
    ds_read_b128 v[40:43], v1 offset:2048
    ds_read_b128 v[128:131], v58 offset:4096
    v_mfma_f32_16x16x32_bf16 a[96:99], v[28:31], v[88:91], a[96:99]
    ds_read_b128 v[132:135], v58 offset:5120
    v_accvgpr_read_b32 v240, a48
    v_accvgpr_read_b32 v241, a60
    v_accvgpr_read_b32 v242, a72
    v_mfma_f32_16x16x32_bf16 a[144:147], v[24:27], v[84:87], a[144:147]
    ds_read_b128 v[44:47], v1 offset:14336
    v_accvgpr_read_b32 v243, a84
    v_mfma_f32_16x16x32_bf16 a[144:147], v[28:31], v[92:95], a[144:147]
    s_waitcnt lgkmcnt(5)
    v_accvgpr_read_b32 v244, a49
    v_accvgpr_read_b32 v245, a61
    v_accvgpr_read_b32 v246, a73
    v_accvgpr_read_b32 v247, a85
    v_mfma_f32_16x16x32_bf16 a[100:103], v[32:35], v[80:83], a[100:103]
    ds_read_b128 v[24:27], v1 offset:3072
    v_mul_f32 v240, v240, v50
    v_mfma_f32_16x16x32_bf16 a[100:103], v[36:39], v[88:91], a[100:103]
    v_exp_f32 v18, v178
    v_add_f32 v7, v7, v16
    v_mul_f32 v241, v241, v50
    v_mfma_f32_16x16x32_bf16 a[148:151], v[32:35], v[84:87], a[148:151]
    ds_read_b128 v[28:31], v1 offset:15360
    v_add_f32 v7, v7, v17
    v_mfma_f32_16x16x32_bf16 a[148:151], v[36:39], v[92:95], a[148:151]
    s_waitcnt lgkmcnt(2)
    v_exp_f32 v19, v179
    v_cvt_pk_bf16_f32 v176, v16, v17
    v_mul_f32 v242, v242, v50
    v_mfma_f32_16x16x32_bf16 a[104:107], v[40:43], v[80:83], a[104:107]
    ds_read_b128 v[32:35], v1 offset:4096
    v_mul_f32 v243, v243, v50
    v_mfma_f32_16x16x32_bf16 a[104:107], v[44:47], v[88:91], a[104:107]
    v_exp_f32 v16, v112
    v_add_f32 v7, v7, v18
    v_mul_f32 v244, v244, v50
    v_mfma_f32_16x16x32_bf16 a[152:155], v[40:43], v[84:87], a[152:155]
    ds_read_b128 v[36:39], v1 offset:16384
    v_add_f32 v7, v7, v19
    v_mfma_f32_16x16x32_bf16 a[152:155], v[44:47], v[92:95], a[152:155]
    s_waitcnt lgkmcnt(2)
    v_exp_f32 v17, v113
    v_cvt_pk_bf16_f32 v177, v18, v19
    v_mul_f32 v245, v245, v50
    v_mfma_f32_16x16x32_bf16 a[108:111], v[24:27], v[80:83], a[108:111]
    ds_read_b128 v[40:43], v1 offset:5120
    v_exp_f32 v18, v114
    v_add_f32 v7, v7, v16
    v_add_f32 v7, v7, v17
    v_exp_f32 v19, v115
    v_cvt_pk_bf16_f32 v178, v16, v17
    v_exp_f32 v16, v180
    v_add_f32 v7, v7, v18
    v_add_f32 v7, v7, v19
    v_exp_f32 v17, v181
    v_cvt_pk_bf16_f32 v179, v18, v19
    v_exp_f32 v18, v182
    v_add_f32 v8, v8, v16
    v_add_f32 v8, v8, v17
    v_exp_f32 v19, v183
    v_cvt_pk_bf16_f32 v180, v16, v17
    v_exp_f32 v16, v116
    v_add_f32 v8, v8, v18
    v_add_f32 v8, v8, v19
    v_exp_f32 v17, v117
    v_cvt_pk_bf16_f32 v181, v18, v19
    v_exp_f32 v18, v118
    v_add_f32 v8, v8, v16
    v_add_f32 v8, v8, v17
    v_exp_f32 v19, v119
    v_cvt_pk_bf16_f32 v182, v16, v17
    v_add_f32 v8, v8, v18
    v_add_f32 v8, v8, v19
    v_cvt_pk_bf16_f32 v183, v18, v19
    v_mfma_f32_16x16x32_bf16 a[108:111], v[28:31], v[88:91], a[108:111]
    v_mul_f32 v246, v246, v50
    v_mul_f32 v247, v247, v50
    v_cvt_pk_bf16_f32 v240, v240, v241
    v_cvt_pk_bf16_f32 v241, v242, v243
    v_mfma_f32_16x16x32_bf16 a[156:159], v[24:27], v[84:87], a[156:159]
    ds_read_b128 v[44:47], v1 offset:17408
    v_cvt_pk_bf16_f32 v242, v244, v245
    v_mfma_f32_16x16x32_bf16 a[156:159], v[28:31], v[92:95], a[156:159]
    s_waitcnt lgkmcnt(2)
    v_cvt_pk_bf16_f32 v243, v246, v247
    s_waitcnt lgkmcnt(8)
    v_mfma_f32_16x16x32_bf16 a[112:115], v[32:35], v[80:83], a[112:115]
    ds_read_b128 v[24:27], v1 offset:6144
    v_mfma_f32_16x16x32_bf16 a[112:115], v[36:39], v[88:91], a[112:115]
    buffer_store_dwordx4 v[128:131], v59, s[12:15], s24 offen offset:256 sc0 sc1
    v_mfma_f32_16x16x32_bf16 a[160:163], v[32:35], v[84:87], a[160:163]
    ds_read_b128 v[28:31], v1 offset:18432
    v_mfma_f32_16x16x32_bf16 a[160:163], v[36:39], v[92:95], a[160:163]
    s_waitcnt lgkmcnt(2)
    ds_write_b128 v56, v[240:243] offset:0
    v_mfma_f32_16x16x32_bf16 a[116:119], v[40:43], v[80:83], a[116:119]
    ds_read_b128 v[32:35], v1 offset:7168
    v_accvgpr_read_b32 v248, a50
    v_mfma_f32_16x16x32_bf16 a[116:119], v[44:47], v[88:91], a[116:119]
    v_accvgpr_read_b32 v249, a62
    v_accvgpr_read_b32 v250, a74
    v_accvgpr_read_b32 v251, a86
    v_accvgpr_read_b32 v252, a51
    v_mfma_f32_16x16x32_bf16 a[164:167], v[40:43], v[84:87], a[164:167]
    ds_read_b128 v[36:39], v1 offset:19456
    v_accvgpr_read_b32 v253, a63
    v_mfma_f32_16x16x32_bf16 a[164:167], v[44:47], v[92:95], a[164:167]
    s_waitcnt lgkmcnt(3)
    v_accvgpr_read_b32 v254, a75
    v_accvgpr_read_b32 v255, a87
    v_mul_f32 v248, v248, v50
    v_mul_f32 v249, v249, v50
    v_mfma_f32_16x16x32_bf16 a[120:123], v[24:27], v[80:83], a[120:123]
    ds_read_b128 v[40:43], v1 offset:8192
    v_mul_f32 v250, v250, v50
    v_mfma_f32_16x16x32_bf16 a[120:123], v[28:31], v[88:91], a[120:123]
    v_mul_f32 v251, v251, v50
    v_mul_f32 v252, v252, v50
    v_mul_f32 v253, v253, v50
    v_mul_f32 v254, v254, v50
    v_mfma_f32_16x16x32_bf16 a[168:171], v[24:27], v[84:87], a[168:171]
    ds_read_b128 v[44:47], v1 offset:20480
    v_mul_f32 v255, v255, v50
    v_mfma_f32_16x16x32_bf16 a[168:171], v[28:31], v[92:95], a[168:171]
    s_waitcnt lgkmcnt(2)
    v_cvt_pk_bf16_f32 v248, v248, v249
    v_cvt_pk_bf16_f32 v249, v250, v251
    v_cvt_pk_bf16_f32 v250, v252, v253
    v_cvt_pk_bf16_f32 v251, v254, v255
    v_mfma_f32_16x16x32_bf16 a[124:127], v[32:35], v[80:83], a[124:127]
    s_waitcnt lgkmcnt(14)
    ds_read_b128 v[24:27], v1 offset:9216
    v_mfma_f32_16x16x32_bf16 a[124:127], v[36:39], v[88:91], a[124:127]
    buffer_store_dwordx4 v[132:135], v59, s[12:15], s24 offen offset:3328 sc0 sc1
    v_mfma_f32_16x16x32_bf16 a[172:175], v[32:35], v[84:87], a[172:175]
    ds_read_b128 v[28:31], v1 offset:21504
    v_mfma_f32_16x16x32_bf16 a[172:175], v[36:39], v[92:95], a[172:175]
    s_waitcnt lgkmcnt(2)
    ds_write_b128 v57, v[248:251] offset:0
    v_mfma_f32_16x16x32_bf16 a[128:131], v[40:43], v[80:83], a[128:131]
    ds_read_b128 v[32:35], v1 offset:10240
    ds_read_b128 v[144:147], v58 offset:0
    v_mfma_f32_16x16x32_bf16 a[128:131], v[44:47], v[88:91], a[128:131]
    ds_read_b128 v[148:151], v58 offset:1024
    v_accvgpr_read_b32 v224, a52
    v_accvgpr_read_b32 v225, a64
    v_accvgpr_read_b32 v226, a76
    v_mfma_f32_16x16x32_bf16 a[176:179], v[40:43], v[84:87], a[176:179]
    ds_read_b128 v[36:39], v1 offset:22528
    v_accvgpr_read_b32 v227, a88
    v_mfma_f32_16x16x32_bf16 a[176:179], v[44:47], v[92:95], a[176:179]
    s_waitcnt lgkmcnt(5)
    v_accvgpr_read_b32 v228, a53
    v_accvgpr_read_b32 v229, a65
    v_accvgpr_read_b32 v230, a77
    v_accvgpr_read_b32 v231, a89
    v_mfma_f32_16x16x32_bf16 a[132:135], v[24:27], v[80:83], a[132:135]
    ds_read_b128 v[40:43], v1 offset:11264
    v_mul_f32 v224, v224, v50
    v_mfma_f32_16x16x32_bf16 a[132:135], v[28:31], v[88:91], a[132:135]
    v_mul_f32 v225, v225, v50
    v_mul_f32 v226, v226, v50
    v_mul_f32 v227, v227, v50
    v_mul_f32 v228, v228, v50
    v_mfma_f32_16x16x32_bf16 a[180:183], v[24:27], v[84:87], a[180:183]
    ds_read_b128 v[44:47], v1 offset:23552
    v_mul_f32 v229, v229, v50
    v_mfma_f32_16x16x32_bf16 a[180:183], v[28:31], v[92:95], a[180:183]
    s_waitcnt lgkmcnt(2)
    v_subrev_u32 v14, 49152, v1
    v_subrev_u32 v1, 98304, v1
    v_mul_f32 v230, v230, v50
    v_mul_f32 v231, v231, v50
    v_mfma_f32_16x16x32_bf16 a[136:139], v[32:35], v[80:83], a[136:139]
    ds_read_b128 v[24:27], v1 offset:0
    v_cvt_pk_bf16_f32 v224, v224, v225
    v_mfma_f32_16x16x32_bf16 a[136:139], v[36:39], v[88:91], a[136:139]
    v_cvt_pk_bf16_f32 v225, v226, v227
    v_cvt_pk_bf16_f32 v226, v228, v229
    v_cvt_pk_bf16_f32 v227, v230, v231
    s_waitcnt lgkmcnt(5)
    v_mfma_f32_16x16x32_bf16 a[184:187], v[32:35], v[84:87], a[184:187]
    ds_read_b128 v[28:31], v1 offset:12288
    v_mfma_f32_16x16x32_bf16 a[184:187], v[36:39], v[92:95], a[184:187]
    s_waitcnt lgkmcnt(2)
    v_exp_f32 v16, v184
    v_mfma_f32_16x16x32_bf16 a[140:143], v[40:43], v[80:83], a[140:143]
    ds_read_b128 v[32:35], v14 offset:0
    v_mfma_f32_16x16x32_bf16 a[140:143], v[44:47], v[88:91], a[140:143]
    buffer_store_dwordx4 v[144:147], v59, s[12:15], s40 offen offset:0 sc0 sc1
    v_mfma_f32_16x16x32_bf16 a[188:191], v[40:43], v[84:87], a[188:191]
    ds_read_b128 v[36:39], v14 offset:12288
    v_mfma_f32_16x16x32_bf16 a[188:191], v[44:47], v[92:95], a[188:191]
    s_waitcnt lgkmcnt(2)
    ds_write_b128 v56, v[224:227] offset:2048
    v_accvgpr_read_b32 v232, a54
    v_accvgpr_read_b32 v233, a66
    v_accvgpr_read_b32 v234, a78
    v_accvgpr_read_b32 v235, a90
    v_accvgpr_read_b32 v236, a55
    v_accvgpr_read_b32 v237, a67
    v_accvgpr_read_b32 v238, a79
    v_accvgpr_read_b32 v239, a91
    v_mul_f32 v232, v232, v50
    v_mul_f32 v233, v233, v50
    v_mul_f32 v234, v234, v50
    v_mul_f32 v235, v235, v50
    v_mul_f32 v236, v236, v50
    v_mul_f32 v237, v237, v50
    v_mul_f32 v238, v238, v50
    v_mul_f32 v239, v239, v50
    v_cvt_pk_bf16_f32 v232, v232, v233
    v_cvt_pk_bf16_f32 v233, v234, v235
    v_cvt_pk_bf16_f32 v234, v236, v237
    v_cvt_pk_bf16_f32 v235, v238, v239
    s_waitcnt lgkmcnt(8)
    buffer_store_dwordx4 v[148:151], v59, s[12:15], s40 offen offset:3072 sc0 sc1
    ds_write_b128 v57, v[232:235] offset:2048
    ds_read_b128 v[152:155], v58 offset:2048
    ds_read_b128 v[156:159], v58 offset:3072
    v_accvgpr_read_b32 v240, a56
    v_accvgpr_read_b32 v241, a68
    v_accvgpr_read_b32 v242, a80
    v_accvgpr_read_b32 v243, a92
    v_accvgpr_read_b32 v244, a57
    v_accvgpr_read_b32 v245, a69
    v_accvgpr_read_b32 v246, a81
    v_accvgpr_read_b32 v247, a93
    v_mul_f32 v240, v240, v50
    v_mul_f32 v241, v241, v50
    v_mul_f32 v242, v242, v50
    v_mul_f32 v243, v243, v50
    v_mul_f32 v244, v244, v50
    v_mul_f32 v245, v245, v50
    v_mul_f32 v246, v246, v50
    v_mul_f32 v247, v247, v50
    v_cvt_pk_bf16_f32 v240, v240, v241
    v_cvt_pk_bf16_f32 v241, v242, v243
    v_cvt_pk_bf16_f32 v242, v244, v245
    v_cvt_pk_bf16_f32 v243, v246, v247
    v_exp_f32 v17, v185
    s_waitcnt lgkmcnt(1)
    buffer_store_dwordx4 v[152:155], v59, s[12:15], s40 offen offset:128 sc0 sc1
    v_exp_f32 v18, v186
    v_add_f32 v7, v7, v16
    v_add_f32 v7, v7, v17
    v_exp_f32 v19, v187
    ds_write_b128 v56, v[240:243] offset:4096
    v_cvt_pk_bf16_f32 v184, v16, v17
    v_exp_f32 v16, v120
    v_accvgpr_read_b32 v248, a58
    v_add_f32 v7, v7, v18
    v_accvgpr_read_b32 v249, a70
    v_add_f32 v7, v7, v19
    v_accvgpr_read_b32 v250, a82
    v_exp_f32 v17, v121
    v_accvgpr_read_b32 v251, a94
    v_accvgpr_read_b32 v252, a59
    v_cvt_pk_bf16_f32 v185, v18, v19
    v_accvgpr_read_b32 v253, a71
    v_exp_f32 v18, v122
    v_accvgpr_read_b32 v254, a83
    v_accvgpr_read_b32 v255, a95
    v_add_f32 v7, v7, v16
    v_mul_f32 v248, v248, v50
    v_add_f32 v7, v7, v17
    v_mul_f32 v249, v249, v50
    v_exp_f32 v19, v123
    v_mul_f32 v250, v250, v50
    v_mul_f32 v251, v251, v50
    v_cvt_pk_bf16_f32 v186, v16, v17
    v_mul_f32 v252, v252, v50
    v_exp_f32 v16, v188
    v_mul_f32 v253, v253, v50
    v_mul_f32 v254, v254, v50
    v_add_f32 v7, v7, v18
    v_mul_f32 v255, v255, v50
    v_add_f32 v7, v7, v19
    v_cvt_pk_bf16_f32 v248, v248, v249
    v_exp_f32 v17, v189
    v_cvt_pk_bf16_f32 v249, v250, v251
    v_cvt_pk_bf16_f32 v250, v252, v253
    v_cvt_pk_bf16_f32 v187, v18, v19
    v_cvt_pk_bf16_f32 v251, v254, v255
    v_exp_f32 v18, v190
    s_waitcnt lgkmcnt(1)
    buffer_store_dwordx4 v[156:159], v59, s[12:15], s40 offen offset:3200 sc0 sc1
    v_add_f32 v8, v8, v16
    v_add_f32 v8, v8, v17
    v_exp_f32 v19, v191
    v_cvt_pk_bf16_f32 v188, v16, v17
    ds_write_b128 v57, v[248:251] offset:4096
    v_exp_f32 v16, v124
    v_add_f32 v8, v8, v18
    v_add_f32 v8, v8, v19
    ds_read_b128 v[128:131], v58 offset:4096
    v_exp_f32 v17, v125
    ds_read_b128 v[132:135], v58 offset:5120
    s_waitcnt lgkmcnt(1)
    buffer_store_dwordx4 v[128:131], v59, s[12:15], s40 offen offset:256 sc0 sc1
    v_cvt_pk_bf16_f32 v189, v18, v19
    v_exp_f32 v18, v126
    v_add_f32 v8, v8, v16
    v_add_f32 v8, v8, v17
    v_exp_f32 v19, v127
    s_waitcnt lgkmcnt(0)
    buffer_store_dwordx4 v[132:135], v59, s[12:15], s40 offen offset:3328 sc0 sc1
    v_cvt_pk_bf16_f32 v190, v16, v17
    v_add_f32 v8, v8, v18
    v_add_f32 v8, v8, v19
    v_cvt_pk_bf16_f32 v191, v18, v19
    v_mfma_f32_16x16x32_bf16 a[96:99], v[24:27], v[160:163], a[96:99]
    ds_read_b128 v[40:43], v1 offset:3072
    v_mov_b32 v52, v7
    v_mfma_f32_16x16x32_bf16 a[96:99], v[28:31], v[168:171], a[96:99]
    v_mov_b32 v54, v8
    s_nop 0
    v_mfma_f32_16x16x32_bf16 a[144:147], v[24:27], v[164:167], a[144:147]
    ds_read_b128 v[44:47], v1 offset:15360
    v_permlane16_swap_b32 v7, v52
    v_mfma_f32_16x16x32_bf16 a[144:147], v[28:31], v[172:175], a[144:147]
    s_waitcnt lgkmcnt(10)
    v_permlane16_swap_b32 v8, v54
    v_mfma_f32_16x16x32_bf16 a[96:99], v[32:35], v[176:179], a[96:99]
    s_nop 0
    ds_read_b128 v[24:27], v14 offset:3072
    v_mfma_f32_16x16x32_bf16 a[96:99], v[36:39], v[184:187], a[96:99]
    v_add_f32 v7, v7, v52
    v_mfma_f32_16x16x32_bf16 a[144:147], v[32:35], v[180:183], a[144:147]
    ds_read_b128 v[28:31], v14 offset:15360
    v_add_f32 v8, v8, v54
    v_mfma_f32_16x16x32_bf16 a[144:147], v[36:39], v[188:191], a[144:147]
    s_waitcnt lgkmcnt(2)
    v_mov_b32 v52, v7
    v_mfma_f32_16x16x32_bf16 a[108:111], v[40:43], v[160:163], a[108:111]
    ds_read_b128 v[32:35], v1 offset:6144
    v_mov_b32 v54, v8
    v_mfma_f32_16x16x32_bf16 a[108:111], v[44:47], v[168:171], a[108:111]
    s_nop 0
    v_mfma_f32_16x16x32_bf16 a[156:159], v[40:43], v[164:167], a[156:159]
    ds_read_b128 v[36:39], v1 offset:18432
    v_permlane32_swap_b32 v7, v52
    v_mfma_f32_16x16x32_bf16 a[156:159], v[44:47], v[172:175], a[156:159]
    s_waitcnt lgkmcnt(2)
    v_permlane32_swap_b32 v8, v54
    v_mfma_f32_16x16x32_bf16 a[108:111], v[24:27], v[176:179], a[108:111]
    s_nop 0
    ds_read_b128 v[40:43], v14 offset:6144
    v_mfma_f32_16x16x32_bf16 a[108:111], v[28:31], v[184:187], a[108:111]
    v_add_f32 v7, v7, v52
    v_mfma_f32_16x16x32_bf16 a[156:159], v[24:27], v[180:183], a[156:159]
    ds_read_b128 v[44:47], v14 offset:18432
    v_add_f32 v8, v8, v54
    v_mfma_f32_16x16x32_bf16 a[156:159], v[28:31], v[188:191], a[156:159]
    s_waitcnt lgkmcnt(2)
    v_rcp_f32 v52, v7
    v_mfma_f32_16x16x32_bf16 a[120:123], v[32:35], v[160:163], a[120:123]
    ds_read_b128 v[24:27], v1 offset:9216
    v_mfma_f32_16x16x32_bf16 a[120:123], v[36:39], v[168:171], a[120:123]
    v_rcp_f32 v54, v8
    v_mfma_f32_16x16x32_bf16 a[168:171], v[32:35], v[164:167], a[168:171]
    ds_read_b128 v[28:31], v1 offset:21504
    v_mfma_f32_16x16x32_bf16 a[168:171], v[36:39], v[172:175], a[168:171]
    s_waitcnt lgkmcnt(2)
    s_nop 0
    v_mfma_f32_16x16x32_bf16 a[120:123], v[40:43], v[176:179], a[120:123]
    ds_read_b128 v[32:35], v14 offset:9216
    v_max3_f32 v16, v5, v6, v7
    v_mfma_f32_16x16x32_bf16 a[120:123], v[44:47], v[184:187], a[120:123]
    v_max_f32 v16, v16, v8
    v_mfma_f32_16x16x32_bf16 a[168:171], v[40:43], v[180:183], a[168:171]
    s_mov_b32 s29, 0x5f800000
    ds_read_b128 v[36:39], v14 offset:21504
    v_mfma_f32_16x16x32_bf16 a[168:171], v[44:47], v[188:191], a[168:171]
    s_waitcnt lgkmcnt(2)
    v_cmp_lt_f32 vcc, s29, v16
    v_mfma_f32_16x16x32_bf16 a[132:135], v[24:27], v[160:163], a[132:135]
    ds_read_b128 v[40:43], v1 offset:1024
    v_mfma_f32_16x16x32_bf16 a[132:135], v[28:31], v[168:171], a[132:135]
    v_mfma_f32_16x16x32_bf16 a[180:183], v[24:27], v[164:167], a[180:183]
    ds_read_b128 v[44:47], v1 offset:13312
    v_mfma_f32_16x16x32_bf16 a[180:183], v[28:31], v[172:175], a[180:183]
    s_waitcnt lgkmcnt(2)
    v_mfma_f32_16x16x32_bf16 a[132:135], v[32:35], v[176:179], a[132:135]
    ds_read_b128 v[24:27], v14 offset:1024
    v_mfma_f32_16x16x32_bf16 a[132:135], v[36:39], v[184:187], a[132:135]
    s_cbranch_vccnz L_slow
    v_mfma_f32_16x16x32_bf16 a[180:183], v[32:35], v[180:183], a[180:183]
    ds_read_b128 v[28:31], v14 offset:13312
    v_mfma_f32_16x16x32_bf16 a[180:183], v[36:39], v[188:191], a[180:183]
    s_waitcnt lgkmcnt(2)
    v_mfma_f32_16x16x32_bf16 a[100:103], v[40:43], v[160:163], a[100:103]
    ds_read_b128 v[32:35], v1 offset:4096
    v_mfma_f32_16x16x32_bf16 a[100:103], v[44:47], v[168:171], a[100:103]
    v_mfma_f32_16x16x32_bf16 a[148:151], v[40:43], v[164:167], a[148:151]
    ds_read_b128 v[36:39], v1 offset:16384
    v_mfma_f32_16x16x32_bf16 a[148:151], v[44:47], v[172:175], a[148:151]
    s_waitcnt lgkmcnt(2)
    v_mfma_f32_16x16x32_bf16 a[100:103], v[24:27], v[176:179], a[100:103]
    ds_read_b128 v[40:43], v14 offset:4096
    v_accvgpr_read_b32 v224, a96
    v_mfma_f32_16x16x32_bf16 a[100:103], v[28:31], v[184:187], a[100:103]
    v_accvgpr_read_b32 v225, a108
    v_accvgpr_read_b32 v226, a120
    v_mfma_f32_16x16x32_bf16 a[148:151], v[24:27], v[180:183], a[148:151]
    ds_read_b128 v[44:47], v14 offset:16384
    v_accvgpr_read_b32 v227, a132
    v_mfma_f32_16x16x32_bf16 a[148:151], v[28:31], v[188:191], a[148:151]
    s_waitcnt lgkmcnt(2)
    v_accvgpr_read_b32 v228, a97
    v_accvgpr_read_b32 v229, a109
    v_accvgpr_read_b32 v230, a121
    v_accvgpr_read_b32 v231, a133
    v_mfma_f32_16x16x32_bf16 a[112:115], v[32:35], v[160:163], a[112:115]
    ds_read_b128 v[24:27], v1 offset:7168
    v_mul_f32 v224, v224, v52
    v_mfma_f32_16x16x32_bf16 a[112:115], v[36:39], v[168:171], a[112:115]
    v_mul_f32 v225, v225, v52
    v_mul_f32 v226, v226, v52
    v_mul_f32 v227, v227, v52
    v_mul_f32 v228, v228, v52
    v_mfma_f32_16x16x32_bf16 a[160:163], v[32:35], v[164:167], a[160:163]
    ds_read_b128 v[28:31], v1 offset:19456
    v_mul_f32 v229, v229, v52
    v_mfma_f32_16x16x32_bf16 a[160:163], v[36:39], v[172:175], a[160:163]
    s_waitcnt lgkmcnt(2)
    v_mul_f32 v230, v230, v52
    v_mul_f32 v231, v231, v52
    v_cvt_pk_bf16_f32 v224, v224, v225
    v_cvt_pk_bf16_f32 v225, v226, v227
    v_mfma_f32_16x16x32_bf16 a[112:115], v[40:43], v[176:179], a[112:115]
    ds_read_b128 v[32:35], v14 offset:7168
    v_cvt_pk_bf16_f32 v226, v228, v229
    v_mfma_f32_16x16x32_bf16 a[112:115], v[44:47], v[184:187], a[112:115]
    v_cvt_pk_bf16_f32 v227, v230, v231
    v_mfma_f32_16x16x32_bf16 a[160:163], v[40:43], v[180:183], a[160:163]
    ds_read_b128 v[36:39], v14 offset:19456
    v_mfma_f32_16x16x32_bf16 a[160:163], v[44:47], v[188:191], a[160:163]
    s_waitcnt lgkmcnt(2)
    ds_write_b128 v56, v[224:227] offset:0
    v_mfma_f32_16x16x32_bf16 a[124:127], v[24:27], v[160:163], a[124:127]
    ds_read_b128 v[40:43], v1 offset:10240
    v_accvgpr_read_b32 v232, a98
    v_mfma_f32_16x16x32_bf16 a[124:127], v[28:31], v[168:171], a[124:127]
    v_accvgpr_read_b32 v233, a110
    v_accvgpr_read_b32 v234, a122
    v_accvgpr_read_b32 v235, a134
    v_accvgpr_read_b32 v236, a99
    v_mfma_f32_16x16x32_bf16 a[172:175], v[24:27], v[164:167], a[172:175]
    ds_read_b128 v[44:47], v1 offset:22528
    v_accvgpr_read_b32 v237, a111
    v_mfma_f32_16x16x32_bf16 a[172:175], v[28:31], v[172:175], a[172:175]
    s_waitcnt lgkmcnt(3)
    v_accvgpr_read_b32 v238, a123
    v_accvgpr_read_b32 v239, a135
    v_mul_f32 v232, v232, v52
    v_mul_f32 v233, v233, v52
    v_mfma_f32_16x16x32_bf16 a[124:127], v[32:35], v[176:179], a[124:127]
    ds_read_b128 v[24:27], v14 offset:10240
    v_mul_f32 v234, v234, v52
    v_mfma_f32_16x16x32_bf16 a[124:127], v[36:39], v[184:187], a[124:127]
    v_mul_f32 v235, v235, v52
    v_mul_f32 v236, v236, v52
    v_mul_f32 v237, v237, v52
    v_mul_f32 v238, v238, v52
    v_mfma_f32_16x16x32_bf16 a[172:175], v[32:35], v[180:183], a[172:175]
    ds_read_b128 v[28:31], v14 offset:22528
    v_mul_f32 v239, v239, v52
    v_mfma_f32_16x16x32_bf16 a[172:175], v[36:39], v[188:191], a[172:175]
    s_waitcnt lgkmcnt(2)
    v_cvt_pk_bf16_f32 v232, v232, v233
    v_cvt_pk_bf16_f32 v233, v234, v235
    v_cvt_pk_bf16_f32 v234, v236, v237
    v_cvt_pk_bf16_f32 v235, v238, v239
    v_mfma_f32_16x16x32_bf16 a[136:139], v[40:43], v[160:163], a[136:139]
    ds_read_b128 v[32:35], v1 offset:2048
    v_mfma_f32_16x16x32_bf16 a[136:139], v[44:47], v[168:171], a[136:139]
    ds_write_b128 v57, v[232:235] offset:0
    v_mfma_f32_16x16x32_bf16 a[184:187], v[40:43], v[164:167], a[184:187]
    ds_read_b128 v[36:39], v1 offset:14336
    ds_read_b128 v[144:147], v58 offset:0
    v_mfma_f32_16x16x32_bf16 a[184:187], v[44:47], v[172:175], a[184:187]
    s_waitcnt lgkmcnt(4)
    ds_read_b128 v[148:151], v58 offset:1024
    v_accvgpr_read_b32 v240, a144
    v_accvgpr_read_b32 v241, a156
    v_accvgpr_read_b32 v242, a168
    v_mfma_f32_16x16x32_bf16 a[136:139], v[24:27], v[176:179], a[136:139]
    ds_read_b128 v[40:43], v14 offset:2048
    v_accvgpr_read_b32 v243, a180
    v_mfma_f32_16x16x32_bf16 a[136:139], v[28:31], v[184:187], a[136:139]
    v_accvgpr_read_b32 v244, a145
    v_accvgpr_read_b32 v245, a157
    v_accvgpr_read_b32 v246, a169
    v_accvgpr_read_b32 v247, a181
    v_mfma_f32_16x16x32_bf16 a[184:187], v[24:27], v[180:183], a[184:187]
    ds_read_b128 v[44:47], v14 offset:14336
    v_mul_f32 v240, v240, v54
    v_mfma_f32_16x16x32_bf16 a[184:187], v[28:31], v[188:191], a[184:187]
    s_waitcnt lgkmcnt(4)
    v_mul_f32 v241, v241, v54
    v_mul_f32 v242, v242, v54
    v_mul_f32 v243, v243, v54
    v_mul_f32 v244, v244, v54
    v_mfma_f32_16x16x32_bf16 a[104:107], v[32:35], v[160:163], a[104:107]
    ds_read_b128 v[24:27], v1 offset:5120
    v_mul_f32 v245, v245, v54
    v_mfma_f32_16x16x32_bf16 a[104:107], v[36:39], v[168:171], a[104:107]
    v_mul_f32 v246, v246, v54
    v_mul_f32 v247, v247, v54
    v_cvt_pk_bf16_f32 v240, v240, v241
    v_cvt_pk_bf16_f32 v241, v242, v243
    v_mfma_f32_16x16x32_bf16 a[152:155], v[32:35], v[164:167], a[152:155]
    ds_read_b128 v[28:31], v1 offset:17408
    v_cvt_pk_bf16_f32 v242, v244, v245
    v_mfma_f32_16x16x32_bf16 a[152:155], v[36:39], v[172:175], a[152:155]
    s_waitcnt lgkmcnt(2)
    v_cvt_pk_bf16_f32 v243, v246, v247
    s_waitcnt lgkmcnt(5)
    buffer_store_dwordx4 v[144:147], v59, s[12:15], s41 offen offset:0 sc0 sc1
    ds_write_b128 v56, v[240:243] offset:2048
    v_accvgpr_read_b32 v248, a146
    v_accvgpr_read_b32 v249, a158
    v_accvgpr_read_b32 v250, a170
    v_accvgpr_read_b32 v251, a182
    v_accvgpr_read_b32 v252, a147
    v_accvgpr_read_b32 v253, a159
    v_accvgpr_read_b32 v254, a171
    v_accvgpr_read_b32 v255, a183
    v_mul_f32 v248, v248, v54
    v_mul_f32 v249, v249, v54
    v_mul_f32 v250, v250, v54
    v_mul_f32 v251, v251, v54
    v_mul_f32 v252, v252, v54
    v_mul_f32 v253, v253, v54
    v_mul_f32 v254, v254, v54
    v_mul_f32 v255, v255, v54
    v_cvt_pk_bf16_f32 v248, v248, v249
    v_cvt_pk_bf16_f32 v249, v250, v251
    v_cvt_pk_bf16_f32 v250, v252, v253
    v_cvt_pk_bf16_f32 v251, v254, v255
    s_waitcnt lgkmcnt(5)
    buffer_store_dwordx4 v[148:151], v59, s[12:15], s41 offen offset:3072 sc0 sc1
    ds_write_b128 v57, v[248:251] offset:2048
    ds_read_b128 v[152:155], v58 offset:2048
    ds_read_b128 v[156:159], v58 offset:3072
    v_mfma_f32_16x16x32_bf16 a[104:107], v[40:43], v[176:179], a[104:107]
    ds_read_b128 v[32:35], v14 offset:5120
    v_accvgpr_read_b32 v224, a100
    v_mfma_f32_16x16x32_bf16 a[104:107], v[44:47], v[184:187], a[104:107]
    v_accvgpr_read_b32 v225, a112
    v_accvgpr_read_b32 v226, a124
    v_mfma_f32_16x16x32_bf16 a[152:155], v[40:43], v[180:183], a[152:155]
    ds_read_b128 v[36:39], v14 offset:17408
    v_accvgpr_read_b32 v227, a136
    v_mfma_f32_16x16x32_bf16 a[152:155], v[44:47], v[188:191], a[152:155]
    s_waitcnt lgkmcnt(6)
    v_accvgpr_read_b32 v228, a101
    v_accvgpr_read_b32 v229, a113
    v_accvgpr_read_b32 v230, a125
    v_accvgpr_read_b32 v231, a137
    v_mfma_f32_16x16x32_bf16 a[116:119], v[24:27], v[160:163], a[116:119]
    ds_read_b128 v[40:43], v1 offset:8192
    v_mul_f32 v224, v224, v52
    v_mfma_f32_16x16x32_bf16 a[116:119], v[28:31], v[168:171], a[116:119]
    v_mul_f32 v225, v225, v52
    v_mul_f32 v226, v226, v52
    v_mul_f32 v227, v227, v52
    v_mul_f32 v228, v228, v52
    v_mfma_f32_16x16x32_bf16 a[164:167], v[24:27], v[164:167], a[164:167]
    ds_read_b128 v[44:47], v1 offset:20480
    v_mul_f32 v229, v229, v52
    v_mfma_f32_16x16x32_bf16 a[164:167], v[28:31], v[172:175], a[164:167]
    s_waitcnt lgkmcnt(2)
    v_mul_f32 v230, v230, v52
    v_mul_f32 v231, v231, v52
    v_cvt_pk_bf16_f32 v224, v224, v225
    v_cvt_pk_bf16_f32 v225, v226, v227
    v_mfma_f32_16x16x32_bf16 a[116:119], v[32:35], v[176:179], a[116:119]
    ds_read_b128 v[24:27], v14 offset:8192
    v_cvt_pk_bf16_f32 v226, v228, v229
    v_mfma_f32_16x16x32_bf16 a[116:119], v[36:39], v[184:187], a[116:119]
    v_cvt_pk_bf16_f32 v227, v230, v231
    s_waitcnt lgkmcnt(6)
    v_mfma_f32_16x16x32_bf16 a[164:167], v[32:35], v[180:183], a[164:167]
    ds_read_b128 v[28:31], v14 offset:20480
    v_mfma_f32_16x16x32_bf16 a[164:167], v[36:39], v[188:191], a[164:167]
    s_waitcnt lgkmcnt(2)
    v_mfma_f32_16x16x32_bf16 a[128:131], v[40:43], v[160:163], a[128:131]
    ds_read_b128 v[32:35], v1 offset:11264
    v_mfma_f32_16x16x32_bf16 a[128:131], v[44:47], v[168:171], a[128:131]
    buffer_store_dwordx4 v[152:155], v59, s[12:15], s42 offen offset:0 sc0 sc1
    v_mfma_f32_16x16x32_bf16 a[176:179], v[40:43], v[164:167], a[176:179]
    ds_read_b128 v[36:39], v1 offset:23552
    v_mfma_f32_16x16x32_bf16 a[176:179], v[44:47], v[172:175], a[176:179]
    s_waitcnt lgkmcnt(2)
    ds_write_b128 v56, v[224:227] offset:4096
    v_mfma_f32_16x16x32_bf16 a[128:131], v[24:27], v[176:179], a[128:131]
    ds_read_b128 v[40:43], v14 offset:11264
    v_accvgpr_read_b32 v232, a102
    v_mfma_f32_16x16x32_bf16 a[128:131], v[28:31], v[184:187], a[128:131]
    v_accvgpr_read_b32 v233, a114
    v_accvgpr_read_b32 v234, a126
    v_accvgpr_read_b32 v235, a138
    v_accvgpr_read_b32 v236, a103
    v_mfma_f32_16x16x32_bf16 a[176:179], v[24:27], v[180:183], a[176:179]
    ds_read_b128 v[44:47], v14 offset:23552
    v_accvgpr_read_b32 v237, a115
    v_mfma_f32_16x16x32_bf16 a[176:179], v[28:31], v[188:191], a[176:179]
    s_waitcnt lgkmcnt(3)
    v_accvgpr_read_b32 v238, a127
    v_accvgpr_read_b32 v239, a139
    v_mul_f32 v232, v232, v52
    v_mul_f32 v233, v233, v52
    v_mfma_f32_16x16x32_bf16 a[140:143], v[32:35], v[160:163], a[140:143]
    v_mul_f32 v234, v234, v52
    v_mul_f32 v235, v235, v52
    v_mfma_f32_16x16x32_bf16 a[140:143], v[36:39], v[168:171], a[140:143]
    v_mul_f32 v236, v236, v52
    v_mul_f32 v237, v237, v52
    v_mul_f32 v238, v238, v52
    v_mul_f32 v239, v239, v52
    v_mfma_f32_16x16x32_bf16 a[188:191], v[32:35], v[164:167], a[188:191]
    v_cvt_pk_bf16_f32 v232, v232, v233
    v_cvt_pk_bf16_f32 v233, v234, v235
    v_mfma_f32_16x16x32_bf16 a[188:191], v[36:39], v[172:175], a[188:191]
    s_waitcnt lgkmcnt(0)
    v_cvt_pk_bf16_f32 v234, v236, v237
    v_cvt_pk_bf16_f32 v235, v238, v239
    s_waitcnt lgkmcnt(11)
    v_mfma_f32_16x16x32_bf16 a[140:143], v[40:43], v[176:179], a[140:143]
    v_mfma_f32_16x16x32_bf16 a[140:143], v[44:47], v[184:187], a[140:143]
    buffer_store_dwordx4 v[156:159], v59, s[12:15], s42 offen offset:3072 sc0 sc1
    v_mfma_f32_16x16x32_bf16 a[188:191], v[40:43], v[180:183], a[188:191]
    v_mfma_f32_16x16x32_bf16 a[188:191], v[44:47], v[188:191], a[188:191]
    ds_write_b128 v57, v[232:235] offset:4096
    ds_read_b128 v[128:131], v58 offset:4096
    ds_read_b128 v[132:135], v58 offset:5120
    v_accvgpr_read_b32 v240, a148
    v_accvgpr_read_b32 v241, a160
    v_accvgpr_read_b32 v242, a172
    v_accvgpr_read_b32 v243, a184
    v_accvgpr_read_b32 v244, a149
    v_accvgpr_read_b32 v245, a161
    v_accvgpr_read_b32 v246, a173
    v_accvgpr_read_b32 v247, a185
    v_mul_f32 v240, v240, v54
    v_mul_f32 v241, v241, v54
    v_mul_f32 v242, v242, v54
    v_mul_f32 v243, v243, v54
    v_mul_f32 v244, v244, v54
    v_mul_f32 v245, v245, v54
    v_mul_f32 v246, v246, v54
    v_mul_f32 v247, v247, v54
    v_cvt_pk_bf16_f32 v240, v240, v241
    v_cvt_pk_bf16_f32 v241, v242, v243
    v_cvt_pk_bf16_f32 v242, v244, v245
    v_cvt_pk_bf16_f32 v243, v246, v247
    s_waitcnt lgkmcnt(1)
    buffer_store_dwordx4 v[128:131], v59, s[12:15], s41 offen offset:128 sc0 sc1
    ds_write_b128 v56, v[240:243] offset:0
    v_accvgpr_read_b32 v248, a150
    v_accvgpr_read_b32 v249, a162
    v_accvgpr_read_b32 v250, a174
    v_accvgpr_read_b32 v251, a186
    v_accvgpr_read_b32 v252, a151
    v_accvgpr_read_b32 v253, a163
    v_accvgpr_read_b32 v254, a175
    v_accvgpr_read_b32 v255, a187
    v_mul_f32 v248, v248, v54
    v_mul_f32 v249, v249, v54
    v_mul_f32 v250, v250, v54
    v_mul_f32 v251, v251, v54
    v_mul_f32 v252, v252, v54
    v_mul_f32 v253, v253, v54
    v_mul_f32 v254, v254, v54
    v_mul_f32 v255, v255, v54
    v_cvt_pk_bf16_f32 v248, v248, v249
    v_cvt_pk_bf16_f32 v249, v250, v251
    v_cvt_pk_bf16_f32 v250, v252, v253
    v_cvt_pk_bf16_f32 v251, v254, v255
    s_waitcnt lgkmcnt(1)
    buffer_store_dwordx4 v[132:135], v59, s[12:15], s41 offen offset:3200 sc0 sc1
    ds_write_b128 v57, v[248:251] offset:0
    ds_read_b128 v[144:147], v58 offset:0
    ds_read_b128 v[148:151], v58 offset:1024
    s_nop 7
    v_accvgpr_read_b32 v224, a104
    v_accvgpr_read_b32 v225, a116
    v_accvgpr_read_b32 v226, a128
    v_accvgpr_read_b32 v227, a140
    v_accvgpr_read_b32 v228, a105
    v_accvgpr_read_b32 v229, a117
    v_accvgpr_read_b32 v230, a129
    v_accvgpr_read_b32 v231, a141
    v_pk_mul_f32 v[224:225], v[224:225], v[52:53] op_sel_hi:[1,0]
    v_pk_mul_f32 v[226:227], v[226:227], v[52:53] op_sel_hi:[1,0]
    v_pk_mul_f32 v[228:229], v[228:229], v[52:53] op_sel_hi:[1,0]
    v_pk_mul_f32 v[230:231], v[230:231], v[52:53] op_sel_hi:[1,0]
    v_cvt_pk_bf16_f32 v224, v224, v225
    v_cvt_pk_bf16_f32 v225, v226, v227
    v_cvt_pk_bf16_f32 v226, v228, v229
    v_cvt_pk_bf16_f32 v227, v230, v231
    s_waitcnt lgkmcnt(1)
    buffer_store_dwordx4 v[144:147], v59, s[12:15], s42 offen offset:128 sc0 sc1
    ds_write_b128 v56, v[224:227] offset:2048
    v_accvgpr_read_b32 v232, a106
    v_accvgpr_read_b32 v233, a118
    v_accvgpr_read_b32 v234, a130
    v_accvgpr_read_b32 v235, a142
    v_accvgpr_read_b32 v236, a107
    v_accvgpr_read_b32 v237, a119
    v_accvgpr_read_b32 v238, a131
    v_accvgpr_read_b32 v239, a143
    v_pk_mul_f32 v[232:233], v[232:233], v[52:53] op_sel_hi:[1,0]
    v_pk_mul_f32 v[234:235], v[234:235], v[52:53] op_sel_hi:[1,0]
    v_pk_mul_f32 v[236:237], v[236:237], v[52:53] op_sel_hi:[1,0]
    v_pk_mul_f32 v[238:239], v[238:239], v[52:53] op_sel_hi:[1,0]
    v_cvt_pk_bf16_f32 v232, v232, v233
    v_cvt_pk_bf16_f32 v233, v234, v235
    v_cvt_pk_bf16_f32 v234, v236, v237
    v_cvt_pk_bf16_f32 v235, v238, v239
    s_waitcnt lgkmcnt(1)
    buffer_store_dwordx4 v[148:151], v59, s[12:15], s42 offen offset:3200 sc0 sc1
    ds_write_b128 v57, v[232:235] offset:2048
    ds_read_b128 v[152:155], v58 offset:2048
    ds_read_b128 v[156:159], v58 offset:3072
    v_accvgpr_read_b32 v240, a152
    v_accvgpr_read_b32 v241, a164
    v_accvgpr_read_b32 v242, a176
    v_accvgpr_read_b32 v243, a188
    v_accvgpr_read_b32 v244, a153
    v_accvgpr_read_b32 v245, a165
    v_accvgpr_read_b32 v246, a177
    v_accvgpr_read_b32 v247, a189
    v_pk_mul_f32 v[240:241], v[240:241], v[54:55] op_sel_hi:[1,0]
    v_pk_mul_f32 v[242:243], v[242:243], v[54:55] op_sel_hi:[1,0]
    v_pk_mul_f32 v[244:245], v[244:245], v[54:55] op_sel_hi:[1,0]
    v_pk_mul_f32 v[246:247], v[246:247], v[54:55] op_sel_hi:[1,0]
    v_cvt_pk_bf16_f32 v240, v240, v241
    v_cvt_pk_bf16_f32 v241, v242, v243
    v_cvt_pk_bf16_f32 v242, v244, v245
    v_cvt_pk_bf16_f32 v243, v246, v247
    s_waitcnt lgkmcnt(1)
    buffer_store_dwordx4 v[152:155], v59, s[12:15], s41 offen offset:256 sc0 sc1
    ds_write_b128 v56, v[240:243] offset:4096
    v_accvgpr_read_b32 v248, a154
    v_accvgpr_read_b32 v249, a166
    v_accvgpr_read_b32 v250, a178
    v_accvgpr_read_b32 v251, a190
    v_accvgpr_read_b32 v252, a155
    v_accvgpr_read_b32 v253, a167
    v_accvgpr_read_b32 v254, a179
    v_accvgpr_read_b32 v255, a191
    v_pk_mul_f32 v[248:249], v[248:249], v[54:55] op_sel_hi:[1,0]
    v_pk_mul_f32 v[250:251], v[250:251], v[54:55] op_sel_hi:[1,0]
    v_pk_mul_f32 v[252:253], v[252:253], v[54:55] op_sel_hi:[1,0]
    v_pk_mul_f32 v[254:255], v[254:255], v[54:55] op_sel_hi:[1,0]
    v_cvt_pk_bf16_f32 v248, v248, v249
    v_cvt_pk_bf16_f32 v249, v250, v251
    v_cvt_pk_bf16_f32 v250, v252, v253
    v_cvt_pk_bf16_f32 v251, v254, v255
    s_waitcnt lgkmcnt(1)
    buffer_store_dwordx4 v[156:159], v59, s[12:15], s41 offen offset:3328 sc0 sc1
    ds_write_b128 v57, v[248:251] offset:4096
    ds_read_b128 v[128:131], v58 offset:4096
    ds_read_b128 v[132:135], v58 offset:5120
    s_waitcnt lgkmcnt(1)
    buffer_store_dwordx4 v[128:131], v59, s[12:15], s42 offen offset:256 sc0 sc1
    s_waitcnt lgkmcnt(0)
    buffer_store_dwordx4 v[132:135], v59, s[12:15], s42 offen offset:3328 sc0 sc1
L_fin:
L_done:
    s_endpgm
L_pollslow0:
    s_mov_b32 s59, 60
L_pollsm0:
    s_buffer_load_dwordx8 s[48:55], s[20:23], s44 glc
    s_waitcnt lgkmcnt(0)
    s_sub_u32 s48, s48, s92
    s_sub_u32 s49, s49, s92
    s_sub_u32 s50, s50, s92
    s_sub_u32 s51, s51, s92
    s_sub_u32 s52, s52, s92
    s_sub_u32 s53, s53, s92
    s_sub_u32 s54, s54, s92
    s_sub_u32 s55, s55, s92
    s_max_u32 s48, s48, s49
    s_max_u32 s48, s48, s50
    s_max_u32 s48, s48, s51
    s_max_u32 s48, s48, s52
    s_max_u32 s48, s48, s53
    s_max_u32 s48, s48, s54
    s_max_u32 s48, s48, s55
    s_cmp_lt_u32 s48, 16
    s_cbranch_scc1 L_pollok0
    s_sub_u32 s59, s59, 1
    s_cbranch_scc1 L_pollvec0
    s_sleep 1
    s_branch L_pollsm0
L_pollvec0:
    v_bfe_u32 v53, v4, 4, 6
    v_lshlrev_b32 v53, 2, v53
    s_sub_u32 s96, s96, 1
    s_cbranch_scc1 L_pollgiveup0
    s_sleep 2
    buffer_load_dword v52, v53, s[20:23], s44 offen sc1
    s_waitcnt vmcnt(0)
    v_subrev_u32 v52, s92, v52
    v_cmp_lt_u32 vcc, 15, v52
    s_nop 0
    s_and_b32 s59, vcc_lo, 0xff
    s_cbranch_scc1 L_pollvec0
    s_branch L_pollok0
L_pollgiveup0:
    s_mov_b32 s96, 0
    s_branch L_pollok0
L_pollslow1:
    s_mov_b32 s59, 200
L_pollsm1:
    s_buffer_load_dwordx8 s[48:55], s[20:23], s44 glc
    s_waitcnt lgkmcnt(0)
    s_sub_u32 s48, s48, s92
    s_sub_u32 s49, s49, s92
    s_sub_u32 s50, s50, s92
    s_sub_u32 s51, s51, s92
    s_sub_u32 s52, s52, s92
    s_sub_u32 s53, s53, s92
    s_sub_u32 s54, s54, s92
    s_sub_u32 s55, s55, s92
    s_max_u32 s48, s48, s49
    s_max_u32 s48, s48, s50
    s_max_u32 s48, s48, s51
    s_max_u32 s48, s48, s52
    s_max_u32 s48, s48, s53
    s_max_u32 s48, s48, s54
    s_max_u32 s48, s48, s55
    s_cmp_lt_u32 s48, 16
    s_cbranch_scc1 L_pollok1
    s_sub_u32 s59, s59, 1
    s_cbranch_scc1 L_pollvec1
    s_sleep 1
    s_branch L_pollsm1
L_pollvec1:
    v_bfe_u32 v53, v4, 4, 6
    v_lshlrev_b32 v53, 2, v53
    s_sub_u32 s96, s96, 1
    s_cbranch_scc1 L_pollgiveup1
    s_sleep 2
    buffer_load_dword v52, v53, s[20:23], s44 offen sc1
    s_waitcnt vmcnt(0)
    v_subrev_u32 v52, s92, v52
    v_cmp_lt_u32 vcc, 15, v52
    s_nop 0
    s_and_b32 s59, vcc_lo, 0xff
    s_cbranch_scc1 L_pollvec1
    s_branch L_pollok1
L_pollgiveup1:
    s_mov_b32 s96, 0
    s_branch L_pollok1
L_pollslow2:
    s_mov_b32 s59, 200
L_pollsm2:
    s_buffer_load_dwordx8 s[48:55], s[20:23], s44 glc
    s_waitcnt lgkmcnt(0)
    s_sub_u32 s48, s48, s92
    s_sub_u32 s49, s49, s92
    s_sub_u32 s50, s50, s92
    s_sub_u32 s51, s51, s92
    s_sub_u32 s52, s52, s92
    s_sub_u32 s53, s53, s92
    s_sub_u32 s54, s54, s92
    s_sub_u32 s55, s55, s92
    s_max_u32 s48, s48, s49
    s_max_u32 s48, s48, s50
    s_max_u32 s48, s48, s51
    s_max_u32 s48, s48, s52
    s_max_u32 s48, s48, s53
    s_max_u32 s48, s48, s54
    s_max_u32 s48, s48, s55
    s_cmp_lt_u32 s48, 16
    s_cbranch_scc1 L_pollok2
    s_sub_u32 s59, s59, 1
    s_cbranch_scc1 L_pollvec2
    s_sleep 1
    s_branch L_pollsm2
L_pollvec2:
    v_bfe_u32 v53, v4, 4, 6
    v_lshlrev_b32 v53, 2, v53
    s_sub_u32 s96, s96, 1
    s_cbranch_scc1 L_pollgiveup2
    s_sleep 2
    buffer_load_dword v52, v53, s[20:23], s44 offen sc1
    s_waitcnt vmcnt(0)
    v_subrev_u32 v52, s92, v52
    v_cmp_lt_u32 vcc, 15, v52
    s_nop 0
    s_and_b32 s59, vcc_lo, 0xff
    s_cbranch_scc1 L_pollvec2
    s_branch L_pollok2
L_pollgiveup2:
    s_mov_b32 s96, 0
    s_branch L_pollok2
L_tagslow:
    s_sub_u32 s96, s96, 1
    s_cbranch_scc1 L_taggiveup
    s_sleep 2
    buffer_load_dword v0, off, s[88:91], s93 sc1
    s_waitcnt vmcnt(0)
    v_readfirstlane_b32 s42, v0
    s_nop 0
    s_cmp_eq_u32 s42, s46
    s_cbranch_scc1 L_tagslow
    s_cmp_eq_u32 s42, 0
    s_cbranch_scc1 L_tagslow
    s_branch L_tagok
L_taggiveup:
    s_mov_b32 s96, 0
    s_branch L_tagok
L_slow:
    s_waitcnt vmcnt(0) lgkmcnt(0)
    s_nop 15
    v_accvgpr_write_b32 a0, 0
    v_accvgpr_write_b32 a1, 0
    v_accvgpr_write_b32 a2, 0
    v_accvgpr_write_b32 a3, 0
    v_accvgpr_write_b32 a4, 0
    v_accvgpr_write_b32 a5, 0
    v_accvgpr_write_b32 a6, 0
    v_accvgpr_write_b32 a7, 0
    v_accvgpr_write_b32 a8, 0
    v_accvgpr_write_b32 a9, 0
    v_accvgpr_write_b32 a10, 0
    v_accvgpr_write_b32 a11, 0
    v_accvgpr_write_b32 a12, 0
    v_accvgpr_write_b32 a13, 0
    v_accvgpr_write_b32 a14, 0
    v_accvgpr_write_b32 a15, 0
    v_accvgpr_write_b32 a16, 0
    v_accvgpr_write_b32 a17, 0
    v_accvgpr_write_b32 a18, 0
    v_accvgpr_write_b32 a19, 0
    v_accvgpr_write_b32 a20, 0
    v_accvgpr_write_b32 a21, 0
    v_accvgpr_write_b32 a22, 0
    v_accvgpr_write_b32 a23, 0
    v_accvgpr_write_b32 a24, 0
    v_accvgpr_write_b32 a25, 0
    v_accvgpr_write_b32 a26, 0
    v_accvgpr_write_b32 a27, 0
    v_accvgpr_write_b32 a28, 0
    v_accvgpr_write_b32 a29, 0
    v_accvgpr_write_b32 a30, 0
    v_accvgpr_write_b32 a31, 0
    v_accvgpr_write_b32 a32, 0
    v_accvgpr_write_b32 a33, 0
    v_accvgpr_write_b32 a34, 0
    v_accvgpr_write_b32 a35, 0
    v_accvgpr_write_b32 a36, 0
    v_accvgpr_write_b32 a37, 0
    v_accvgpr_write_b32 a38, 0
    v_accvgpr_write_b32 a39, 0
    v_accvgpr_write_b32 a40, 0
    v_accvgpr_write_b32 a41, 0
    v_accvgpr_write_b32 a42, 0
    v_accvgpr_write_b32 a43, 0
    v_accvgpr_write_b32 a44, 0
    v_accvgpr_write_b32 a45, 0
    v_accvgpr_write_b32 a46, 0
    v_accvgpr_write_b32 a47, 0
    v_accvgpr_write_b32 a48, 0
    v_accvgpr_write_b32 a49, 0
    v_accvgpr_write_b32 a50, 0
    v_accvgpr_write_b32 a51, 0
    v_accvgpr_write_b32 a52, 0
    v_accvgpr_write_b32 a53, 0
    v_accvgpr_write_b32 a54, 0
    v_accvgpr_write_b32 a55, 0
    v_accvgpr_write_b32 a56, 0
    v_accvgpr_write_b32 a57, 0
    v_accvgpr_write_b32 a58, 0
    v_accvgpr_write_b32 a59, 0
    v_accvgpr_write_b32 a60, 0
    v_accvgpr_write_b32 a61, 0
    v_accvgpr_write_b32 a62, 0
    v_accvgpr_write_b32 a63, 0
    v_accvgpr_write_b32 a64, 0
    v_accvgpr_write_b32 a65, 0
    v_accvgpr_write_b32 a66, 0
    v_accvgpr_write_b32 a67, 0
    v_accvgpr_write_b32 a68, 0
    v_accvgpr_write_b32 a69, 0
    v_accvgpr_write_b32 a70, 0
    v_accvgpr_write_b32 a71, 0
    v_accvgpr_write_b32 a72, 0
    v_accvgpr_write_b32 a73, 0
    v_accvgpr_write_b32 a74, 0
    v_accvgpr_write_b32 a75, 0
    v_accvgpr_write_b32 a76, 0
    v_accvgpr_write_b32 a77, 0
    v_accvgpr_write_b32 a78, 0
    v_accvgpr_write_b32 a79, 0
    v_accvgpr_write_b32 a80, 0
    v_accvgpr_write_b32 a81, 0
    v_accvgpr_write_b32 a82, 0
    v_accvgpr_write_b32 a83, 0
    v_accvgpr_write_b32 a84, 0
    v_accvgpr_write_b32 a85, 0
    v_accvgpr_write_b32 a86, 0
    v_accvgpr_write_b32 a87, 0
    v_accvgpr_write_b32 a88, 0
    v_accvgpr_write_b32 a89, 0
    v_accvgpr_write_b32 a90, 0
    v_accvgpr_write_b32 a91, 0
    v_accvgpr_write_b32 a92, 0
    v_accvgpr_write_b32 a93, 0
    v_accvgpr_write_b32 a94, 0
    v_accvgpr_write_b32 a95, 0
    v_accvgpr_write_b32 a96, 0
    v_accvgpr_write_b32 a97, 0
    v_accvgpr_write_b32 a98, 0
    v_accvgpr_write_b32 a99, 0
    v_accvgpr_write_b32 a100, 0
    v_accvgpr_write_b32 a101, 0
    v_accvgpr_write_b32 a102, 0
    v_accvgpr_write_b32 a103, 0
    v_accvgpr_write_b32 a104, 0
    v_accvgpr_write_b32 a105, 0
    v_accvgpr_write_b32 a106, 0
    v_accvgpr_write_b32 a107, 0
    v_accvgpr_write_b32 a108, 0
    v_accvgpr_write_b32 a109, 0
    v_accvgpr_write_b32 a110, 0
    v_accvgpr_write_b32 a111, 0
    v_accvgpr_write_b32 a112, 0
    v_accvgpr_write_b32 a113, 0
    v_accvgpr_write_b32 a114, 0
    v_accvgpr_write_b32 a115, 0
    v_accvgpr_write_b32 a116, 0
    v_accvgpr_write_b32 a117, 0
    v_accvgpr_write_b32 a118, 0
    v_accvgpr_write_b32 a119, 0
    v_accvgpr_write_b32 a120, 0
    v_accvgpr_write_b32 a121, 0
    v_accvgpr_write_b32 a122, 0
    v_accvgpr_write_b32 a123, 0
    v_accvgpr_write_b32 a124, 0
    v_accvgpr_write_b32 a125, 0
    v_accvgpr_write_b32 a126, 0
    v_accvgpr_write_b32 a127, 0
    v_accvgpr_write_b32 a128, 0
    v_accvgpr_write_b32 a129, 0
    v_accvgpr_write_b32 a130, 0
    v_accvgpr_write_b32 a131, 0
    v_accvgpr_write_b32 a132, 0
    v_accvgpr_write_b32 a133, 0
    v_accvgpr_write_b32 a134, 0
    v_accvgpr_write_b32 a135, 0
    v_accvgpr_write_b32 a136, 0
    v_accvgpr_write_b32 a137, 0
    v_accvgpr_write_b32 a138, 0
    v_accvgpr_write_b32 a139, 0
    v_accvgpr_write_b32 a140, 0
    v_accvgpr_write_b32 a141, 0
    v_accvgpr_write_b32 a142, 0
    v_accvgpr_write_b32 a143, 0
    v_accvgpr_write_b32 a144, 0
    v_accvgpr_write_b32 a145, 0
    v_accvgpr_write_b32 a146, 0
    v_accvgpr_write_b32 a147, 0
    v_accvgpr_write_b32 a148, 0
    v_accvgpr_write_b32 a149, 0
    v_accvgpr_write_b32 a150, 0
    v_accvgpr_write_b32 a151, 0
    v_accvgpr_write_b32 a152, 0
    v_accvgpr_write_b32 a153, 0
    v_accvgpr_write_b32 a154, 0
    v_accvgpr_write_b32 a155, 0
    v_accvgpr_write_b32 a156, 0
    v_accvgpr_write_b32 a157, 0
    v_accvgpr_write_b32 a158, 0
    v_accvgpr_write_b32 a159, 0
    v_accvgpr_write_b32 a160, 0
    v_accvgpr_write_b32 a161, 0
    v_accvgpr_write_b32 a162, 0
    v_accvgpr_write_b32 a163, 0
    v_accvgpr_write_b32 a164, 0
    v_accvgpr_write_b32 a165, 0
    v_accvgpr_write_b32 a166, 0
    v_accvgpr_write_b32 a167, 0
    v_accvgpr_write_b32 a168, 0
    v_accvgpr_write_b32 a169, 0
    v_accvgpr_write_b32 a170, 0
    v_accvgpr_write_b32 a171, 0
    v_accvgpr_write_b32 a172, 0
    v_accvgpr_write_b32 a173, 0
    v_accvgpr_write_b32 a174, 0
    v_accvgpr_write_b32 a175, 0
    v_accvgpr_write_b32 a176, 0
    v_accvgpr_write_b32 a177, 0
    v_accvgpr_write_b32 a178, 0
    v_accvgpr_write_b32 a179, 0
    v_accvgpr_write_b32 a180, 0
    v_accvgpr_write_b32 a181, 0
    v_accvgpr_write_b32 a182, 0
    v_accvgpr_write_b32 a183, 0
    v_accvgpr_write_b32 a184, 0
    v_accvgpr_write_b32 a185, 0
    v_accvgpr_write_b32 a186, 0
    v_accvgpr_write_b32 a187, 0
    v_accvgpr_write_b32 a188, 0
    v_accvgpr_write_b32 a189, 0
    v_accvgpr_write_b32 a190, 0
    v_accvgpr_write_b32 a191, 0
    v_mov_b32 v5, 0
    v_mov_b32 v240, 0xff7fffff
    v_mov_b32 v6, 0
    v_mov_b32 v241, 0xff7fffff
    v_mov_b32 v7, 0
    v_mov_b32 v242, 0xff7fffff
    v_mov_b32 v8, 0
    v_mov_b32 v243, 0xff7fffff
    v_subrev_u32 v244, 49152, v2
    v_subrev_u32 v245, 49152, v3
    v_subrev_u32 v246, 24576, v1
    s_mov_b32 s48, 0
L_slowloop:
    s_add_u32 s49, s48, 6144
    s_add_u32 s50, s48, 12288
    s_add_u32 s51, s48, 16384
    s_add_u32 s52, s48, 20480
    buffer_load_dwordx4 v[64:67], v244, s[4:7], s48 offen offset:0 sc1
    buffer_load_dwordx4 v[68:71], v245, s[4:7], s48 offen offset:0 sc1
    buffer_load_dwordx4 v[72:75], v244, s[4:7], s49 offen offset:0 sc1
    buffer_load_dwordx4 v[76:79], v245, s[4:7], s49 offen offset:0 sc1
    buffer_load_dwordx4 v[80:83], v244, s[4:7], s48 offen offset:128 sc1
    buffer_load_dwordx4 v[84:87], v245, s[4:7], s48 offen offset:128 sc1
    buffer_load_dwordx4 v[88:91], v244, s[4:7], s49 offen offset:128 sc1
    buffer_load_dwordx4 v[92:95], v245, s[4:7], s49 offen offset:128 sc1
    buffer_load_dwordx4 v[96:99], v244, s[4:7], s48 offen offset:256 sc1
    buffer_load_dwordx4 v[100:103], v245, s[4:7], s48 offen offset:256 sc1
    buffer_load_dwordx4 v[104:107], v244, s[4:7], s49 offen offset:256 sc1
    buffer_load_dwordx4 v[108:111], v245, s[4:7], s49 offen offset:256 sc1
    buffer_load_dwordx4 v[112:115], v246, s[4:7], s50 offen offset:0 sc1
    buffer_load_dwordx4 v[116:119], v246, s[4:7], s50 offen offset:1024 sc1
    buffer_load_dwordx4 v[120:123], v246, s[4:7], s50 offen offset:2048 sc1
    buffer_load_dwordx4 v[124:127], v246, s[4:7], s50 offen offset:3072 sc1
    buffer_load_dwordx4 v[128:131], v246, s[4:7], s51 offen offset:0 sc1
    buffer_load_dwordx4 v[132:135], v246, s[4:7], s51 offen offset:1024 sc1
    buffer_load_dwordx4 v[136:139], v246, s[4:7], s51 offen offset:2048 sc1
    buffer_load_dwordx4 v[140:143], v246, s[4:7], s51 offen offset:3072 sc1
    buffer_load_dwordx4 v[144:147], v246, s[4:7], s52 offen offset:0 sc1
    buffer_load_dwordx4 v[148:151], v246, s[4:7], s52 offen offset:1024 sc1
    buffer_load_dwordx4 v[152:155], v246, s[4:7], s52 offen offset:2048 sc1
    buffer_load_dwordx4 v[156:159], v246, s[4:7], s52 offen offset:3072 sc1
    s_waitcnt vmcnt(12)
    v_mfma_f32_16x16x32_bf16 v[160:163], v[64:67], a[192:195], 0
    v_mfma_f32_16x16x32_bf16 v[168:171], v[64:67], a[216:219], 0
    v_mfma_f32_16x16x32_bf16 v[176:179], v[64:67], a[240:243], 0
    v_mfma_f32_16x16x32_bf16 v[184:187], v[64:67], v[200:203], 0
    v_mfma_f32_16x16x32_bf16 v[160:163], v[68:71], a[196:199], v[160:163]
    v_mfma_f32_16x16x32_bf16 v[168:171], v[68:71], a[220:223], v[168:171]
    v_mfma_f32_16x16x32_bf16 v[176:179], v[68:71], a[244:247], v[176:179]
    v_mfma_f32_16x16x32_bf16 v[184:187], v[68:71], v[204:207], v[184:187]
    v_mfma_f32_16x16x32_bf16 v[164:167], v[72:75], a[192:195], 0
    v_mfma_f32_16x16x32_bf16 v[172:175], v[72:75], a[216:219], 0
    v_mfma_f32_16x16x32_bf16 v[180:183], v[72:75], a[240:243], 0
    v_mfma_f32_16x16x32_bf16 v[188:191], v[72:75], v[200:203], 0
    v_mfma_f32_16x16x32_bf16 v[164:167], v[76:79], a[196:199], v[164:167]
    v_mfma_f32_16x16x32_bf16 v[172:175], v[76:79], a[220:223], v[172:175]
    v_mfma_f32_16x16x32_bf16 v[180:183], v[76:79], a[244:247], v[180:183]
    v_mfma_f32_16x16x32_bf16 v[188:191], v[76:79], v[204:207], v[188:191]
    v_mfma_f32_16x16x32_bf16 v[160:163], v[80:83], a[200:203], v[160:163]
    v_mfma_f32_16x16x32_bf16 v[168:171], v[80:83], a[224:227], v[168:171]
    v_mfma_f32_16x16x32_bf16 v[176:179], v[80:83], a[248:251], v[176:179]
    v_mfma_f32_16x16x32_bf16 v[184:187], v[80:83], v[208:211], v[184:187]
    v_mfma_f32_16x16x32_bf16 v[160:163], v[84:87], a[204:207], v[160:163]
    v_mfma_f32_16x16x32_bf16 v[168:171], v[84:87], a[228:231], v[168:171]
    v_mfma_f32_16x16x32_bf16 v[176:179], v[84:87], a[252:255], v[176:179]
    v_mfma_f32_16x16x32_bf16 v[184:187], v[84:87], v[212:215], v[184:187]
    v_mfma_f32_16x16x32_bf16 v[164:167], v[88:91], a[200:203], v[164:167]
    v_mfma_f32_16x16x32_bf16 v[172:175], v[88:91], a[224:227], v[172:175]
    v_mfma_f32_16x16x32_bf16 v[180:183], v[88:91], a[248:251], v[180:183]
    v_mfma_f32_16x16x32_bf16 v[188:191], v[88:91], v[208:211], v[188:191]
    v_mfma_f32_16x16x32_bf16 v[164:167], v[92:95], a[204:207], v[164:167]
    v_mfma_f32_16x16x32_bf16 v[172:175], v[92:95], a[228:231], v[172:175]
    v_mfma_f32_16x16x32_bf16 v[180:183], v[92:95], a[252:255], v[180:183]
    v_mfma_f32_16x16x32_bf16 v[188:191], v[92:95], v[212:215], v[188:191]
    v_mfma_f32_16x16x32_bf16 v[160:163], v[96:99], a[208:211], v[160:163]
    v_mfma_f32_16x16x32_bf16 v[168:171], v[96:99], a[232:235], v[168:171]
    v_mfma_f32_16x16x32_bf16 v[176:179], v[96:99], v[192:195], v[176:179]
    v_mfma_f32_16x16x32_bf16 v[184:187], v[96:99], v[216:219], v[184:187]
    v_mfma_f32_16x16x32_bf16 v[160:163], v[100:103], a[212:215], v[160:163]
    v_mfma_f32_16x16x32_bf16 v[168:171], v[100:103], a[236:239], v[168:171]
    v_mfma_f32_16x16x32_bf16 v[176:179], v[100:103], v[196:199], v[176:179]
    v_mfma_f32_16x16x32_bf16 v[184:187], v[100:103], v[220:223], v[184:187]
    v_mfma_f32_16x16x32_bf16 v[164:167], v[104:107], a[208:211], v[164:167]
    v_mfma_f32_16x16x32_bf16 v[172:175], v[104:107], a[232:235], v[172:175]
    v_mfma_f32_16x16x32_bf16 v[180:183], v[104:107], v[192:195], v[180:183]
    v_mfma_f32_16x16x32_bf16 v[188:191], v[104:107], v[216:219], v[188:191]
    v_mfma_f32_16x16x32_bf16 v[164:167], v[108:111], a[212:215], v[164:167]
    v_mfma_f32_16x16x32_bf16 v[172:175], v[108:111], a[236:239], v[172:175]
    v_mfma_f32_16x16x32_bf16 v[180:183], v[108:111], v[196:199], v[180:183]
    v_mfma_f32_16x16x32_bf16 v[188:191], v[108:111], v[220:223], v[188:191]
    s_nop 9
    v_max3_f32 v16, v160, v161, v162
    v_max3_f32 v16, v16, v163, v164
    v_max3_f32 v16, v16, v165, v166
    v_max3_f32 v16, v16, v167, v240
    v_mov_b32 v17, v16
    s_nop 1
    v_permlane16_swap_b32 v16, v17
    s_nop 1
    v_max_f32 v16, v16, v17
    v_mov_b32 v17, v16
    s_nop 1
    v_permlane32_swap_b32 v16, v17
    s_nop 1
    v_max_f32 v16, v16, v17
    v_sub_f32 v17, v240, v16
    v_exp_f32 v17, v17
    v_mov_b32 v240, v16
    v_sub_f32 v160, v160, v16
    v_sub_f32 v161, v161, v16
    v_sub_f32 v162, v162, v16
    v_sub_f32 v163, v163, v16
    v_sub_f32 v164, v164, v16
    v_sub_f32 v165, v165, v16
    v_sub_f32 v166, v166, v16
    v_sub_f32 v167, v167, v16
    v_exp_f32 v160, v160
    v_exp_f32 v161, v161
    v_exp_f32 v162, v162
    v_exp_f32 v163, v163
    v_exp_f32 v164, v164
    v_exp_f32 v165, v165
    v_exp_f32 v166, v166
    v_exp_f32 v167, v167
    v_mul_f32 v5, v5, v17
    v_add_f32 v5, v5, v160
    v_add_f32 v5, v5, v161
    v_add_f32 v5, v5, v162
    v_add_f32 v5, v5, v163
    v_add_f32 v5, v5, v164
    v_add_f32 v5, v5, v165
    v_add_f32 v5, v5, v166
    v_add_f32 v5, v5, v167
    v_cvt_pk_bf16_f32 v224, v160, v161
    v_cvt_pk_bf16_f32 v225, v162, v163
    v_cvt_pk_bf16_f32 v226, v164, v165
    v_cvt_pk_bf16_f32 v227, v166, v167
    v_accvgpr_read_b32 v18, a0
    v_mul_f32 v18, v18, v17
    v_accvgpr_write_b32 a0, v18
    v_accvgpr_read_b32 v19, a1
    v_mul_f32 v19, v19, v17
    v_accvgpr_write_b32 a1, v19
    v_accvgpr_read_b32 v18, a2
    v_mul_f32 v18, v18, v17
    v_accvgpr_write_b32 a2, v18
    v_accvgpr_read_b32 v19, a3
    v_mul_f32 v19, v19, v17
    v_accvgpr_write_b32 a3, v19
    v_accvgpr_read_b32 v18, a4
    v_mul_f32 v18, v18, v17
    v_accvgpr_write_b32 a4, v18
    v_accvgpr_read_b32 v19, a5
    v_mul_f32 v19, v19, v17
    v_accvgpr_write_b32 a5, v19
    v_accvgpr_read_b32 v18, a6
    v_mul_f32 v18, v18, v17
    v_accvgpr_write_b32 a6, v18
    v_accvgpr_read_b32 v19, a7
    v_mul_f32 v19, v19, v17
    v_accvgpr_write_b32 a7, v19
    v_accvgpr_read_b32 v18, a8
    v_mul_f32 v18, v18, v17
    v_accvgpr_write_b32 a8, v18
    v_accvgpr_read_b32 v19, a9
    v_mul_f32 v19, v19, v17
    v_accvgpr_write_b32 a9, v19
    v_accvgpr_read_b32 v18, a10
    v_mul_f32 v18, v18, v17
    v_accvgpr_write_b32 a10, v18
    v_accvgpr_read_b32 v19, a11
    v_mul_f32 v19, v19, v17
    v_accvgpr_write_b32 a11, v19
    v_accvgpr_read_b32 v18, a12
    v_mul_f32 v18, v18, v17
    v_accvgpr_write_b32 a12, v18
    v_accvgpr_read_b32 v19, a13
    v_mul_f32 v19, v19, v17
    v_accvgpr_write_b32 a13, v19
    v_accvgpr_read_b32 v18, a14
    v_mul_f32 v18, v18, v17
    v_accvgpr_write_b32 a14, v18
    v_accvgpr_read_b32 v19, a15
    v_mul_f32 v19, v19, v17
    v_accvgpr_write_b32 a15, v19
    v_accvgpr_read_b32 v18, a16
    v_mul_f32 v18, v18, v17
    v_accvgpr_write_b32 a16, v18
    v_accvgpr_read_b32 v19, a17
    v_mul_f32 v19, v19, v17
    v_accvgpr_write_b32 a17, v19
    v_accvgpr_read_b32 v18, a18
    v_mul_f32 v18, v18, v17
    v_accvgpr_write_b32 a18, v18
    v_accvgpr_read_b32 v19, a19
    v_mul_f32 v19, v19, v17
    v_accvgpr_write_b32 a19, v19
    v_accvgpr_read_b32 v18, a20
    v_mul_f32 v18, v18, v17
    v_accvgpr_write_b32 a20, v18
    v_accvgpr_read_b32 v19, a21
    v_mul_f32 v19, v19, v17
    v_accvgpr_write_b32 a21, v19
    v_accvgpr_read_b32 v18, a22
    v_mul_f32 v18, v18, v17
    v_accvgpr_write_b32 a22, v18
    v_accvgpr_read_b32 v19, a23
    v_mul_f32 v19, v19, v17
    v_accvgpr_write_b32 a23, v19
    v_accvgpr_read_b32 v18, a24
    v_mul_f32 v18, v18, v17
    v_accvgpr_write_b32 a24, v18
    v_accvgpr_read_b32 v19, a25
    v_mul_f32 v19, v19, v17
    v_accvgpr_write_b32 a25, v19
    v_accvgpr_read_b32 v18, a26
    v_mul_f32 v18, v18, v17
    v_accvgpr_write_b32 a26, v18
    v_accvgpr_read_b32 v19, a27
    v_mul_f32 v19, v19, v17
    v_accvgpr_write_b32 a27, v19
    v_accvgpr_read_b32 v18, a28
    v_mul_f32 v18, v18, v17
    v_accvgpr_write_b32 a28, v18
    v_accvgpr_read_b32 v19, a29
    v_mul_f32 v19, v19, v17
    v_accvgpr_write_b32 a29, v19
    v_accvgpr_read_b32 v18, a30
    v_mul_f32 v18, v18, v17
    v_accvgpr_write_b32 a30, v18
    v_accvgpr_read_b32 v19, a31
    v_mul_f32 v19, v19, v17
    v_accvgpr_write_b32 a31, v19
    v_accvgpr_read_b32 v18, a32
    v_mul_f32 v18, v18, v17
    v_accvgpr_write_b32 a32, v18
    v_accvgpr_read_b32 v19, a33
    v_mul_f32 v19, v19, v17
    v_accvgpr_write_b32 a33, v19
    v_accvgpr_read_b32 v18, a34
    v_mul_f32 v18, v18, v17
    v_accvgpr_write_b32 a34, v18
    v_accvgpr_read_b32 v19, a35
    v_mul_f32 v19, v19, v17
    v_accvgpr_write_b32 a35, v19
    v_accvgpr_read_b32 v18, a36
    v_mul_f32 v18, v18, v17
    v_accvgpr_write_b32 a36, v18
    v_accvgpr_read_b32 v19, a37
    v_mul_f32 v19, v19, v17
    v_accvgpr_write_b32 a37, v19
    v_accvgpr_read_b32 v18, a38
    v_mul_f32 v18, v18, v17
    v_accvgpr_write_b32 a38, v18
    v_accvgpr_read_b32 v19, a39
    v_mul_f32 v19, v19, v17
    v_accvgpr_write_b32 a39, v19
    v_accvgpr_read_b32 v18, a40
    v_mul_f32 v18, v18, v17
    v_accvgpr_write_b32 a40, v18
    v_accvgpr_read_b32 v19, a41
    v_mul_f32 v19, v19, v17
    v_accvgpr_write_b32 a41, v19
    v_accvgpr_read_b32 v18, a42
    v_mul_f32 v18, v18, v17
    v_accvgpr_write_b32 a42, v18
    v_accvgpr_read_b32 v19, a43
    v_mul_f32 v19, v19, v17
    v_accvgpr_write_b32 a43, v19
    v_accvgpr_read_b32 v18, a44
    v_mul_f32 v18, v18, v17
    v_accvgpr_write_b32 a44, v18
    v_accvgpr_read_b32 v19, a45
    v_mul_f32 v19, v19, v17
    v_accvgpr_write_b32 a45, v19
    v_accvgpr_read_b32 v18, a46
    v_mul_f32 v18, v18, v17
    v_accvgpr_write_b32 a46, v18
    v_accvgpr_read_b32 v19, a47
    v_mul_f32 v19, v19, v17
    v_accvgpr_write_b32 a47, v19
    v_max3_f32 v16, v168, v169, v170
    v_max3_f32 v16, v16, v171, v172
    v_max3_f32 v16, v16, v173, v174
    v_max3_f32 v16, v16, v175, v241
    v_mov_b32 v17, v16
    s_nop 1
    v_permlane16_swap_b32 v16, v17
    s_nop 1
    v_max_f32 v16, v16, v17
    v_mov_b32 v17, v16
    s_nop 1
    v_permlane32_swap_b32 v16, v17
    s_nop 1
    v_max_f32 v16, v16, v17
    v_sub_f32 v17, v241, v16
    v_exp_f32 v17, v17
    v_mov_b32 v241, v16
    v_sub_f32 v168, v168, v16
    v_sub_f32 v169, v169, v16
    v_sub_f32 v170, v170, v16
    v_sub_f32 v171, v171, v16
    v_sub_f32 v172, v172, v16
    v_sub_f32 v173, v173, v16
    v_sub_f32 v174, v174, v16
    v_sub_f32 v175, v175, v16
    v_exp_f32 v168, v168
    v_exp_f32 v169, v169
    v_exp_f32 v170, v170
    v_exp_f32 v171, v171
    v_exp_f32 v172, v172
    v_exp_f32 v173, v173
    v_exp_f32 v174, v174
    v_exp_f32 v175, v175
    v_mul_f32 v6, v6, v17
    v_add_f32 v6, v6, v168
    v_add_f32 v6, v6, v169
    v_add_f32 v6, v6, v170
    v_add_f32 v6, v6, v171
    v_add_f32 v6, v6, v172
    v_add_f32 v6, v6, v173
    v_add_f32 v6, v6, v174
    v_add_f32 v6, v6, v175
    v_cvt_pk_bf16_f32 v228, v168, v169
    v_cvt_pk_bf16_f32 v229, v170, v171
    v_cvt_pk_bf16_f32 v230, v172, v173
    v_cvt_pk_bf16_f32 v231, v174, v175
    v_accvgpr_read_b32 v18, a48
    v_mul_f32 v18, v18, v17
    v_accvgpr_write_b32 a48, v18
    v_accvgpr_read_b32 v19, a49
    v_mul_f32 v19, v19, v17
    v_accvgpr_write_b32 a49, v19
    v_accvgpr_read_b32 v18, a50
    v_mul_f32 v18, v18, v17
    v_accvgpr_write_b32 a50, v18
    v_accvgpr_read_b32 v19, a51
    v_mul_f32 v19, v19, v17
    v_accvgpr_write_b32 a51, v19
    v_accvgpr_read_b32 v18, a52
    v_mul_f32 v18, v18, v17
    v_accvgpr_write_b32 a52, v18
    v_accvgpr_read_b32 v19, a53
    v_mul_f32 v19, v19, v17
    v_accvgpr_write_b32 a53, v19
    v_accvgpr_read_b32 v18, a54
    v_mul_f32 v18, v18, v17
    v_accvgpr_write_b32 a54, v18
    v_accvgpr_read_b32 v19, a55
    v_mul_f32 v19, v19, v17
    v_accvgpr_write_b32 a55, v19
    v_accvgpr_read_b32 v18, a56
    v_mul_f32 v18, v18, v17
    v_accvgpr_write_b32 a56, v18
    v_accvgpr_read_b32 v19, a57
    v_mul_f32 v19, v19, v17
    v_accvgpr_write_b32 a57, v19
    v_accvgpr_read_b32 v18, a58
    v_mul_f32 v18, v18, v17
    v_accvgpr_write_b32 a58, v18
    v_accvgpr_read_b32 v19, a59
    v_mul_f32 v19, v19, v17
    v_accvgpr_write_b32 a59, v19
    v_accvgpr_read_b32 v18, a60
    v_mul_f32 v18, v18, v17
    v_accvgpr_write_b32 a60, v18
    v_accvgpr_read_b32 v19, a61
    v_mul_f32 v19, v19, v17
    v_accvgpr_write_b32 a61, v19
    v_accvgpr_read_b32 v18, a62
    v_mul_f32 v18, v18, v17
    v_accvgpr_write_b32 a62, v18
    v_accvgpr_read_b32 v19, a63
    v_mul_f32 v19, v19, v17
    v_accvgpr_write_b32 a63, v19
    v_accvgpr_read_b32 v18, a64
    v_mul_f32 v18, v18, v17
    v_accvgpr_write_b32 a64, v18
    v_accvgpr_read_b32 v19, a65
    v_mul_f32 v19, v19, v17
    v_accvgpr_write_b32 a65, v19
    v_accvgpr_read_b32 v18, a66
    v_mul_f32 v18, v18, v17
    v_accvgpr_write_b32 a66, v18
    v_accvgpr_read_b32 v19, a67
    v_mul_f32 v19, v19, v17
    v_accvgpr_write_b32 a67, v19
    v_accvgpr_read_b32 v18, a68
    v_mul_f32 v18, v18, v17
    v_accvgpr_write_b32 a68, v18
    v_accvgpr_read_b32 v19, a69
    v_mul_f32 v19, v19, v17
    v_accvgpr_write_b32 a69, v19
    v_accvgpr_read_b32 v18, a70
    v_mul_f32 v18, v18, v17
    v_accvgpr_write_b32 a70, v18
    v_accvgpr_read_b32 v19, a71
    v_mul_f32 v19, v19, v17
    v_accvgpr_write_b32 a71, v19
    v_accvgpr_read_b32 v18, a72
    v_mul_f32 v18, v18, v17
    v_accvgpr_write_b32 a72, v18
    v_accvgpr_read_b32 v19, a73
    v_mul_f32 v19, v19, v17
    v_accvgpr_write_b32 a73, v19
    v_accvgpr_read_b32 v18, a74
    v_mul_f32 v18, v18, v17
    v_accvgpr_write_b32 a74, v18
    v_accvgpr_read_b32 v19, a75
    v_mul_f32 v19, v19, v17
    v_accvgpr_write_b32 a75, v19
    v_accvgpr_read_b32 v18, a76
    v_mul_f32 v18, v18, v17
    v_accvgpr_write_b32 a76, v18
    v_accvgpr_read_b32 v19, a77
    v_mul_f32 v19, v19, v17
    v_accvgpr_write_b32 a77, v19
    v_accvgpr_read_b32 v18, a78
    v_mul_f32 v18, v18, v17
    v_accvgpr_write_b32 a78, v18
    v_accvgpr_read_b32 v19, a79
    v_mul_f32 v19, v19, v17
    v_accvgpr_write_b32 a79, v19
    v_accvgpr_read_b32 v18, a80
    v_mul_f32 v18, v18, v17
    v_accvgpr_write_b32 a80, v18
    v_accvgpr_read_b32 v19, a81
    v_mul_f32 v19, v19, v17
    v_accvgpr_write_b32 a81, v19
    v_accvgpr_read_b32 v18, a82
    v_mul_f32 v18, v18, v17
    v_accvgpr_write_b32 a82, v18
    v_accvgpr_read_b32 v19, a83
    v_mul_f32 v19, v19, v17
    v_accvgpr_write_b32 a83, v19
    v_accvgpr_read_b32 v18, a84
    v_mul_f32 v18, v18, v17
    v_accvgpr_write_b32 a84, v18
    v_accvgpr_read_b32 v19, a85
    v_mul_f32 v19, v19, v17
    v_accvgpr_write_b32 a85, v19
    v_accvgpr_read_b32 v18, a86
    v_mul_f32 v18, v18, v17
    v_accvgpr_write_b32 a86, v18
    v_accvgpr_read_b32 v19, a87
    v_mul_f32 v19, v19, v17
    v_accvgpr_write_b32 a87, v19
    v_accvgpr_read_b32 v18, a88
    v_mul_f32 v18, v18, v17
    v_accvgpr_write_b32 a88, v18
    v_accvgpr_read_b32 v19, a89
    v_mul_f32 v19, v19, v17
    v_accvgpr_write_b32 a89, v19
    v_accvgpr_read_b32 v18, a90
    v_mul_f32 v18, v18, v17
    v_accvgpr_write_b32 a90, v18
    v_accvgpr_read_b32 v19, a91
    v_mul_f32 v19, v19, v17
    v_accvgpr_write_b32 a91, v19
    v_accvgpr_read_b32 v18, a92
    v_mul_f32 v18, v18, v17
    v_accvgpr_write_b32 a92, v18
    v_accvgpr_read_b32 v19, a93
    v_mul_f32 v19, v19, v17
    v_accvgpr_write_b32 a93, v19
    v_accvgpr_read_b32 v18, a94
    v_mul_f32 v18, v18, v17
    v_accvgpr_write_b32 a94, v18
    v_accvgpr_read_b32 v19, a95
    v_mul_f32 v19, v19, v17
    v_accvgpr_write_b32 a95, v19
    v_max3_f32 v16, v176, v177, v178
    v_max3_f32 v16, v16, v179, v180
    v_max3_f32 v16, v16, v181, v182
    v_max3_f32 v16, v16, v183, v242
    v_mov_b32 v17, v16
    s_nop 1
    v_permlane16_swap_b32 v16, v17
    s_nop 1
    v_max_f32 v16, v16, v17
    v_mov_b32 v17, v16
    s_nop 1
    v_permlane32_swap_b32 v16, v17
    s_nop 1
    v_max_f32 v16, v16, v17
    v_sub_f32 v17, v242, v16
    v_exp_f32 v17, v17
    v_mov_b32 v242, v16
    v_sub_f32 v176, v176, v16
    v_sub_f32 v177, v177, v16
    v_sub_f32 v178, v178, v16
    v_sub_f32 v179, v179, v16
    v_sub_f32 v180, v180, v16
    v_sub_f32 v181, v181, v16
    v_sub_f32 v182, v182, v16
    v_sub_f32 v183, v183, v16
    v_exp_f32 v176, v176
    v_exp_f32 v177, v177
    v_exp_f32 v178, v178
    v_exp_f32 v179, v179
    v_exp_f32 v180, v180
    v_exp_f32 v181, v181
    v_exp_f32 v182, v182
    v_exp_f32 v183, v183
    v_mul_f32 v7, v7, v17
    v_add_f32 v7, v7, v176
    v_add_f32 v7, v7, v177
    v_add_f32 v7, v7, v178
    v_add_f32 v7, v7, v179
    v_add_f32 v7, v7, v180
    v_add_f32 v7, v7, v181
    v_add_f32 v7, v7, v182
    v_add_f32 v7, v7, v183
    v_cvt_pk_bf16_f32 v232, v176, v177
    v_cvt_pk_bf16_f32 v233, v178, v179
    v_cvt_pk_bf16_f32 v234, v180, v181
    v_cvt_pk_bf16_f32 v235, v182, v183
    v_accvgpr_read_b32 v18, a96
    v_mul_f32 v18, v18, v17
    v_accvgpr_write_b32 a96, v18
    v_accvgpr_read_b32 v19, a97
    v_mul_f32 v19, v19, v17
    v_accvgpr_write_b32 a97, v19
    v_accvgpr_read_b32 v18, a98
    v_mul_f32 v18, v18, v17
    v_accvgpr_write_b32 a98, v18
    v_accvgpr_read_b32 v19, a99
    v_mul_f32 v19, v19, v17
    v_accvgpr_write_b32 a99, v19
    v_accvgpr_read_b32 v18, a100
    v_mul_f32 v18, v18, v17
    v_accvgpr_write_b32 a100, v18
    v_accvgpr_read_b32 v19, a101
    v_mul_f32 v19, v19, v17
    v_accvgpr_write_b32 a101, v19
    v_accvgpr_read_b32 v18, a102
    v_mul_f32 v18, v18, v17
    v_accvgpr_write_b32 a102, v18
    v_accvgpr_read_b32 v19, a103
    v_mul_f32 v19, v19, v17
    v_accvgpr_write_b32 a103, v19
    v_accvgpr_read_b32 v18, a104
    v_mul_f32 v18, v18, v17
    v_accvgpr_write_b32 a104, v18
    v_accvgpr_read_b32 v19, a105
    v_mul_f32 v19, v19, v17
    v_accvgpr_write_b32 a105, v19
    v_accvgpr_read_b32 v18, a106
    v_mul_f32 v18, v18, v17
    v_accvgpr_write_b32 a106, v18
    v_accvgpr_read_b32 v19, a107
    v_mul_f32 v19, v19, v17
    v_accvgpr_write_b32 a107, v19
    v_accvgpr_read_b32 v18, a108
    v_mul_f32 v18, v18, v17
    v_accvgpr_write_b32 a108, v18
    v_accvgpr_read_b32 v19, a109
    v_mul_f32 v19, v19, v17
    v_accvgpr_write_b32 a109, v19
    v_accvgpr_read_b32 v18, a110
    v_mul_f32 v18, v18, v17
    v_accvgpr_write_b32 a110, v18
    v_accvgpr_read_b32 v19, a111
    v_mul_f32 v19, v19, v17
    v_accvgpr_write_b32 a111, v19
    v_accvgpr_read_b32 v18, a112
    v_mul_f32 v18, v18, v17
    v_accvgpr_write_b32 a112, v18
    v_accvgpr_read_b32 v19, a113
    v_mul_f32 v19, v19, v17
    v_accvgpr_write_b32 a113, v19
    v_accvgpr_read_b32 v18, a114
    v_mul_f32 v18, v18, v17
    v_accvgpr_write_b32 a114, v18
    v_accvgpr_read_b32 v19, a115
    v_mul_f32 v19, v19, v17
    v_accvgpr_write_b32 a115, v19
    v_accvgpr_read_b32 v18, a116
    v_mul_f32 v18, v18, v17
    v_accvgpr_write_b32 a116, v18
    v_accvgpr_read_b32 v19, a117
    v_mul_f32 v19, v19, v17
    v_accvgpr_write_b32 a117, v19
    v_accvgpr_read_b32 v18, a118
    v_mul_f32 v18, v18, v17
    v_accvgpr_write_b32 a118, v18
    v_accvgpr_read_b32 v19, a119
    v_mul_f32 v19, v19, v17
    v_accvgpr_write_b32 a119, v19
    v_accvgpr_read_b32 v18, a120
    v_mul_f32 v18, v18, v17
    v_accvgpr_write_b32 a120, v18
    v_accvgpr_read_b32 v19, a121
    v_mul_f32 v19, v19, v17
    v_accvgpr_write_b32 a121, v19
    v_accvgpr_read_b32 v18, a122
    v_mul_f32 v18, v18, v17
    v_accvgpr_write_b32 a122, v18
    v_accvgpr_read_b32 v19, a123
    v_mul_f32 v19, v19, v17
    v_accvgpr_write_b32 a123, v19
    v_accvgpr_read_b32 v18, a124
    v_mul_f32 v18, v18, v17
    v_accvgpr_write_b32 a124, v18
    v_accvgpr_read_b32 v19, a125
    v_mul_f32 v19, v19, v17
    v_accvgpr_write_b32 a125, v19
    v_accvgpr_read_b32 v18, a126
    v_mul_f32 v18, v18, v17
    v_accvgpr_write_b32 a126, v18
    v_accvgpr_read_b32 v19, a127
    v_mul_f32 v19, v19, v17
    v_accvgpr_write_b32 a127, v19
    v_accvgpr_read_b32 v18, a128
    v_mul_f32 v18, v18, v17
    v_accvgpr_write_b32 a128, v18
    v_accvgpr_read_b32 v19, a129
    v_mul_f32 v19, v19, v17
    v_accvgpr_write_b32 a129, v19
    v_accvgpr_read_b32 v18, a130
    v_mul_f32 v18, v18, v17
    v_accvgpr_write_b32 a130, v18
    v_accvgpr_read_b32 v19, a131
    v_mul_f32 v19, v19, v17
    v_accvgpr_write_b32 a131, v19
    v_accvgpr_read_b32 v18, a132
    v_mul_f32 v18, v18, v17
    v_accvgpr_write_b32 a132, v18
    v_accvgpr_read_b32 v19, a133
    v_mul_f32 v19, v19, v17
    v_accvgpr_write_b32 a133, v19
    v_accvgpr_read_b32 v18, a134
    v_mul_f32 v18, v18, v17
    v_accvgpr_write_b32 a134, v18
    v_accvgpr_read_b32 v19, a135
    v_mul_f32 v19, v19, v17
    v_accvgpr_write_b32 a135, v19
    v_accvgpr_read_b32 v18, a136
    v_mul_f32 v18, v18, v17
    v_accvgpr_write_b32 a136, v18
    v_accvgpr_read_b32 v19, a137
    v_mul_f32 v19, v19, v17
    v_accvgpr_write_b32 a137, v19
    v_accvgpr_read_b32 v18, a138
    v_mul_f32 v18, v18, v17
    v_accvgpr_write_b32 a138, v18
    v_accvgpr_read_b32 v19, a139
    v_mul_f32 v19, v19, v17
    v_accvgpr_write_b32 a139, v19
    v_accvgpr_read_b32 v18, a140
    v_mul_f32 v18, v18, v17
    v_accvgpr_write_b32 a140, v18
    v_accvgpr_read_b32 v19, a141
    v_mul_f32 v19, v19, v17
    v_accvgpr_write_b32 a141, v19
    v_accvgpr_read_b32 v18, a142
    v_mul_f32 v18, v18, v17
    v_accvgpr_write_b32 a142, v18
    v_accvgpr_read_b32 v19, a143
    v_mul_f32 v19, v19, v17
    v_accvgpr_write_b32 a143, v19
    v_max3_f32 v16, v184, v185, v186
    v_max3_f32 v16, v16, v187, v188
    v_max3_f32 v16, v16, v189, v190
    v_max3_f32 v16, v16, v191, v243
    v_mov_b32 v17, v16
    s_nop 1
    v_permlane16_swap_b32 v16, v17
    s_nop 1
    v_max_f32 v16, v16, v17
    v_mov_b32 v17, v16
    s_nop 1
    v_permlane32_swap_b32 v16, v17
    s_nop 1
    v_max_f32 v16, v16, v17
    v_sub_f32 v17, v243, v16
    v_exp_f32 v17, v17
    v_mov_b32 v243, v16
    v_sub_f32 v184, v184, v16
    v_sub_f32 v185, v185, v16
    v_sub_f32 v186, v186, v16
    v_sub_f32 v187, v187, v16
    v_sub_f32 v188, v188, v16
    v_sub_f32 v189, v189, v16
    v_sub_f32 v190, v190, v16
    v_sub_f32 v191, v191, v16
    v_exp_f32 v184, v184
    v_exp_f32 v185, v185
    v_exp_f32 v186, v186
    v_exp_f32 v187, v187
    v_exp_f32 v188, v188
    v_exp_f32 v189, v189
    v_exp_f32 v190, v190
    v_exp_f32 v191, v191
    v_mul_f32 v8, v8, v17
    v_add_f32 v8, v8, v184
    v_add_f32 v8, v8, v185
    v_add_f32 v8, v8, v186
    v_add_f32 v8, v8, v187
    v_add_f32 v8, v8, v188
    v_add_f32 v8, v8, v189
    v_add_f32 v8, v8, v190
    v_add_f32 v8, v8, v191
    v_cvt_pk_bf16_f32 v236, v184, v185
    v_cvt_pk_bf16_f32 v237, v186, v187
    v_cvt_pk_bf16_f32 v238, v188, v189
    v_cvt_pk_bf16_f32 v239, v190, v191
    v_accvgpr_read_b32 v18, a144
    v_mul_f32 v18, v18, v17
    v_accvgpr_write_b32 a144, v18
    v_accvgpr_read_b32 v19, a145
    v_mul_f32 v19, v19, v17
    v_accvgpr_write_b32 a145, v19
    v_accvgpr_read_b32 v18, a146
    v_mul_f32 v18, v18, v17
    v_accvgpr_write_b32 a146, v18
    v_accvgpr_read_b32 v19, a147
    v_mul_f32 v19, v19, v17
    v_accvgpr_write_b32 a147, v19
    v_accvgpr_read_b32 v18, a148
    v_mul_f32 v18, v18, v17
    v_accvgpr_write_b32 a148, v18
    v_accvgpr_read_b32 v19, a149
    v_mul_f32 v19, v19, v17
    v_accvgpr_write_b32 a149, v19
    v_accvgpr_read_b32 v18, a150
    v_mul_f32 v18, v18, v17
    v_accvgpr_write_b32 a150, v18
    v_accvgpr_read_b32 v19, a151
    v_mul_f32 v19, v19, v17
    v_accvgpr_write_b32 a151, v19
    v_accvgpr_read_b32 v18, a152
    v_mul_f32 v18, v18, v17
    v_accvgpr_write_b32 a152, v18
    v_accvgpr_read_b32 v19, a153
    v_mul_f32 v19, v19, v17
    v_accvgpr_write_b32 a153, v19
    v_accvgpr_read_b32 v18, a154
    v_mul_f32 v18, v18, v17
    v_accvgpr_write_b32 a154, v18
    v_accvgpr_read_b32 v19, a155
    v_mul_f32 v19, v19, v17
    v_accvgpr_write_b32 a155, v19
    v_accvgpr_read_b32 v18, a156
    v_mul_f32 v18, v18, v17
    v_accvgpr_write_b32 a156, v18
    v_accvgpr_read_b32 v19, a157
    v_mul_f32 v19, v19, v17
    v_accvgpr_write_b32 a157, v19
    v_accvgpr_read_b32 v18, a158
    v_mul_f32 v18, v18, v17
    v_accvgpr_write_b32 a158, v18
    v_accvgpr_read_b32 v19, a159
    v_mul_f32 v19, v19, v17
    v_accvgpr_write_b32 a159, v19
    v_accvgpr_read_b32 v18, a160
    v_mul_f32 v18, v18, v17
    v_accvgpr_write_b32 a160, v18
    v_accvgpr_read_b32 v19, a161
    v_mul_f32 v19, v19, v17
    v_accvgpr_write_b32 a161, v19
    v_accvgpr_read_b32 v18, a162
    v_mul_f32 v18, v18, v17
    v_accvgpr_write_b32 a162, v18
    v_accvgpr_read_b32 v19, a163
    v_mul_f32 v19, v19, v17
    v_accvgpr_write_b32 a163, v19
    v_accvgpr_read_b32 v18, a164
    v_mul_f32 v18, v18, v17
    v_accvgpr_write_b32 a164, v18
    v_accvgpr_read_b32 v19, a165
    v_mul_f32 v19, v19, v17
    v_accvgpr_write_b32 a165, v19
    v_accvgpr_read_b32 v18, a166
    v_mul_f32 v18, v18, v17
    v_accvgpr_write_b32 a166, v18
    v_accvgpr_read_b32 v19, a167
    v_mul_f32 v19, v19, v17
    v_accvgpr_write_b32 a167, v19
    v_accvgpr_read_b32 v18, a168
    v_mul_f32 v18, v18, v17
    v_accvgpr_write_b32 a168, v18
    v_accvgpr_read_b32 v19, a169
    v_mul_f32 v19, v19, v17
    v_accvgpr_write_b32 a169, v19
    v_accvgpr_read_b32 v18, a170
    v_mul_f32 v18, v18, v17
    v_accvgpr_write_b32 a170, v18
    v_accvgpr_read_b32 v19, a171
    v_mul_f32 v19, v19, v17
    v_accvgpr_write_b32 a171, v19
    v_accvgpr_read_b32 v18, a172
    v_mul_f32 v18, v18, v17
    v_accvgpr_write_b32 a172, v18
    v_accvgpr_read_b32 v19, a173
    v_mul_f32 v19, v19, v17
    v_accvgpr_write_b32 a173, v19
    v_accvgpr_read_b32 v18, a174
    v_mul_f32 v18, v18, v17
    v_accvgpr_write_b32 a174, v18
    v_accvgpr_read_b32 v19, a175
    v_mul_f32 v19, v19, v17
    v_accvgpr_write_b32 a175, v19
    v_accvgpr_read_b32 v18, a176
    v_mul_f32 v18, v18, v17
    v_accvgpr_write_b32 a176, v18
    v_accvgpr_read_b32 v19, a177
    v_mul_f32 v19, v19, v17
    v_accvgpr_write_b32 a177, v19
    v_accvgpr_read_b32 v18, a178
    v_mul_f32 v18, v18, v17
    v_accvgpr_write_b32 a178, v18
    v_accvgpr_read_b32 v19, a179
    v_mul_f32 v19, v19, v17
    v_accvgpr_write_b32 a179, v19
    v_accvgpr_read_b32 v18, a180
    v_mul_f32 v18, v18, v17
    v_accvgpr_write_b32 a180, v18
    v_accvgpr_read_b32 v19, a181
    v_mul_f32 v19, v19, v17
    v_accvgpr_write_b32 a181, v19
    v_accvgpr_read_b32 v18, a182
    v_mul_f32 v18, v18, v17
    v_accvgpr_write_b32 a182, v18
    v_accvgpr_read_b32 v19, a183
    v_mul_f32 v19, v19, v17
    v_accvgpr_write_b32 a183, v19
    v_accvgpr_read_b32 v18, a184
    v_mul_f32 v18, v18, v17
    v_accvgpr_write_b32 a184, v18
    v_accvgpr_read_b32 v19, a185
    v_mul_f32 v19, v19, v17
    v_accvgpr_write_b32 a185, v19
    v_accvgpr_read_b32 v18, a186
    v_mul_f32 v18, v18, v17
    v_accvgpr_write_b32 a186, v18
    v_accvgpr_read_b32 v19, a187
    v_mul_f32 v19, v19, v17
    v_accvgpr_write_b32 a187, v19
    v_accvgpr_read_b32 v18, a188
    v_mul_f32 v18, v18, v17
    v_accvgpr_write_b32 a188, v18
    v_accvgpr_read_b32 v19, a189
    v_mul_f32 v19, v19, v17
    v_accvgpr_write_b32 a189, v19
    v_accvgpr_read_b32 v18, a190
    v_mul_f32 v18, v18, v17
    v_accvgpr_write_b32 a190, v18
    v_accvgpr_read_b32 v19, a191
    v_mul_f32 v19, v19, v17
    v_accvgpr_write_b32 a191, v19
    s_waitcnt vmcnt(0)
    s_nop 1
    v_mfma_f32_16x16x32_bf16 a[0:3], v[112:115], v[224:227], a[0:3]
    v_mfma_f32_16x16x32_bf16 a[48:51], v[112:115], v[228:231], a[48:51]
    v_mfma_f32_16x16x32_bf16 a[96:99], v[112:115], v[232:235], a[96:99]
    v_mfma_f32_16x16x32_bf16 a[144:147], v[112:115], v[236:239], a[144:147]
    v_mfma_f32_16x16x32_bf16 a[4:7], v[116:119], v[224:227], a[4:7]
    v_mfma_f32_16x16x32_bf16 a[52:55], v[116:119], v[228:231], a[52:55]
    v_mfma_f32_16x16x32_bf16 a[100:103], v[116:119], v[232:235], a[100:103]
    v_mfma_f32_16x16x32_bf16 a[148:151], v[116:119], v[236:239], a[148:151]
    v_mfma_f32_16x16x32_bf16 a[8:11], v[120:123], v[224:227], a[8:11]
    v_mfma_f32_16x16x32_bf16 a[56:59], v[120:123], v[228:231], a[56:59]
    v_mfma_f32_16x16x32_bf16 a[104:107], v[120:123], v[232:235], a[104:107]
    v_mfma_f32_16x16x32_bf16 a[152:155], v[120:123], v[236:239], a[152:155]
    v_mfma_f32_16x16x32_bf16 a[12:15], v[124:127], v[224:227], a[12:15]
    v_mfma_f32_16x16x32_bf16 a[60:63], v[124:127], v[228:231], a[60:63]
    v_mfma_f32_16x16x32_bf16 a[108:111], v[124:127], v[232:235], a[108:111]
    v_mfma_f32_16x16x32_bf16 a[156:159], v[124:127], v[236:239], a[156:159]
    v_mfma_f32_16x16x32_bf16 a[16:19], v[128:131], v[224:227], a[16:19]
    v_mfma_f32_16x16x32_bf16 a[64:67], v[128:131], v[228:231], a[64:67]
    v_mfma_f32_16x16x32_bf16 a[112:115], v[128:131], v[232:235], a[112:115]
    v_mfma_f32_16x16x32_bf16 a[160:163], v[128:131], v[236:239], a[160:163]
    v_mfma_f32_16x16x32_bf16 a[20:23], v[132:135], v[224:227], a[20:23]
    v_mfma_f32_16x16x32_bf16 a[68:71], v[132:135], v[228:231], a[68:71]
    v_mfma_f32_16x16x32_bf16 a[116:119], v[132:135], v[232:235], a[116:119]
    v_mfma_f32_16x16x32_bf16 a[164:167], v[132:135], v[236:239], a[164:167]
    v_mfma_f32_16x16x32_bf16 a[24:27], v[136:139], v[224:227], a[24:27]
    v_mfma_f32_16x16x32_bf16 a[72:75], v[136:139], v[228:231], a[72:75]
    v_mfma_f32_16x16x32_bf16 a[120:123], v[136:139], v[232:235], a[120:123]
    v_mfma_f32_16x16x32_bf16 a[168:171], v[136:139], v[236:239], a[168:171]
    v_mfma_f32_16x16x32_bf16 a[28:31], v[140:143], v[224:227], a[28:31]
    v_mfma_f32_16x16x32_bf16 a[76:79], v[140:143], v[228:231], a[76:79]
    v_mfma_f32_16x16x32_bf16 a[124:127], v[140:143], v[232:235], a[124:127]
    v_mfma_f32_16x16x32_bf16 a[172:175], v[140:143], v[236:239], a[172:175]
    v_mfma_f32_16x16x32_bf16 a[32:35], v[144:147], v[224:227], a[32:35]
    v_mfma_f32_16x16x32_bf16 a[80:83], v[144:147], v[228:231], a[80:83]
    v_mfma_f32_16x16x32_bf16 a[128:131], v[144:147], v[232:235], a[128:131]
    v_mfma_f32_16x16x32_bf16 a[176:179], v[144:147], v[236:239], a[176:179]
    v_mfma_f32_16x16x32_bf16 a[36:39], v[148:151], v[224:227], a[36:39]
    v_mfma_f32_16x16x32_bf16 a[84:87], v[148:151], v[228:231], a[84:87]
    v_mfma_f32_16x16x32_bf16 a[132:135], v[148:151], v[232:235], a[132:135]
    v_mfma_f32_16x16x32_bf16 a[180:183], v[148:151], v[236:239], a[180:183]
    v_mfma_f32_16x16x32_bf16 a[40:43], v[152:155], v[224:227], a[40:43]
    v_mfma_f32_16x16x32_bf16 a[88:91], v[152:155], v[228:231], a[88:91]
    v_mfma_f32_16x16x32_bf16 a[136:139], v[152:155], v[232:235], a[136:139]
    v_mfma_f32_16x16x32_bf16 a[184:187], v[152:155], v[236:239], a[184:187]
    v_mfma_f32_16x16x32_bf16 a[44:47], v[156:159], v[224:227], a[44:47]
    v_mfma_f32_16x16x32_bf16 a[92:95], v[156:159], v[228:231], a[92:95]
    v_mfma_f32_16x16x32_bf16 a[140:143], v[156:159], v[232:235], a[140:143]
    v_mfma_f32_16x16x32_bf16 a[188:191], v[156:159], v[236:239], a[188:191]
    s_add_u32 s48, s48, 24576
    s_cmp_lt_u32 s48, 1572864
    s_nop 7
    s_cbranch_scc1 L_slowloop
    v_mov_b32 v48, v5
    v_mov_b32 v50, v6
    s_nop 0
    v_permlane16_swap_b32 v5, v48
    v_permlane16_swap_b32 v6, v50
    s_nop 0
    v_add_f32 v5, v5, v48
    v_add_f32 v6, v6, v50
    v_mov_b32 v48, v5
    v_mov_b32 v50, v6
    s_nop 0
    v_permlane32_swap_b32 v5, v48
    v_permlane32_swap_b32 v6, v50
    s_nop 0
    v_add_f32 v5, v5, v48
    v_add_f32 v6, v6, v50
    v_rcp_f32 v48, v5
    v_rcp_f32 v50, v6
    s_nop 0
    v_mov_b32 v52, v7
    v_mov_b32 v54, v8
    s_nop 0
    v_permlane16_swap_b32 v7, v52
    v_permlane16_swap_b32 v8, v54
    s_nop 0
    v_add_f32 v7, v7, v52
    v_add_f32 v8, v8, v54
    v_mov_b32 v52, v7
    v_mov_b32 v54, v8
    s_nop 0
    v_permlane32_swap_b32 v7, v52
    v_permlane32_swap_b32 v8, v54
    s_nop 0
    v_add_f32 v7, v7, v52
    v_add_f32 v8, v8, v54
    v_rcp_f32 v52, v7
    v_rcp_f32 v54, v8
    s_nop 0
    v_accvgpr_read_b32 v64, a0
    v_accvgpr_read_b32 v65, a12
    v_accvgpr_read_b32 v66, a24
    v_accvgpr_read_b32 v67, a36
    v_accvgpr_read_b32 v68, a1
    v_accvgpr_read_b32 v69, a13
    v_accvgpr_read_b32 v70, a25
    v_accvgpr_read_b32 v71, a37
    v_pk_mul_f32 v[64:65], v[64:65], v[48:49] op_sel_hi:[1,0]
    v_pk_mul_f32 v[66:67], v[66:67], v[48:49] op_sel_hi:[1,0]
    v_pk_mul_f32 v[68:69], v[68:69], v[48:49] op_sel_hi:[1,0]
    v_pk_mul_f32 v[70:71], v[70:71], v[48:49] op_sel_hi:[1,0]
    v_cvt_pk_bf16_f32 v64, v64, v65
    v_cvt_pk_bf16_f32 v65, v66, v67
    v_cvt_pk_bf16_f32 v66, v68, v69
    v_cvt_pk_bf16_f32 v67, v70, v71
    ds_write_b128 v56, v[64:67] offset:0
    v_accvgpr_read_b32 v72, a2
    v_accvgpr_read_b32 v73, a14
    v_accvgpr_read_b32 v74, a26
    v_accvgpr_read_b32 v75, a38
    v_accvgpr_read_b32 v76, a3
    v_accvgpr_read_b32 v77, a15
    v_accvgpr_read_b32 v78, a27
    v_accvgpr_read_b32 v79, a39
    v_pk_mul_f32 v[72:73], v[72:73], v[48:49] op_sel_hi:[1,0]
    v_pk_mul_f32 v[74:75], v[74:75], v[48:49] op_sel_hi:[1,0]
    v_pk_mul_f32 v[76:77], v[76:77], v[48:49] op_sel_hi:[1,0]
    v_pk_mul_f32 v[78:79], v[78:79], v[48:49] op_sel_hi:[1,0]
    v_cvt_pk_bf16_f32 v72, v72, v73
    v_cvt_pk_bf16_f32 v73, v74, v75
    v_cvt_pk_bf16_f32 v74, v76, v77
    v_cvt_pk_bf16_f32 v75, v78, v79
    ds_write_b128 v57, v[72:75] offset:0
    ds_read_b128 v[128:131], v58 offset:0
    ds_read_b128 v[132:135], v58 offset:1024
    v_accvgpr_read_b32 v80, a4
    v_accvgpr_read_b32 v81, a16
    v_accvgpr_read_b32 v82, a28
    v_accvgpr_read_b32 v83, a40
    v_accvgpr_read_b32 v84, a5
    v_accvgpr_read_b32 v85, a17
    v_accvgpr_read_b32 v86, a29
    v_accvgpr_read_b32 v87, a41
    v_pk_mul_f32 v[80:81], v[80:81], v[48:49] op_sel_hi:[1,0]
    v_pk_mul_f32 v[82:83], v[82:83], v[48:49] op_sel_hi:[1,0]
    v_pk_mul_f32 v[84:85], v[84:85], v[48:49] op_sel_hi:[1,0]
    v_pk_mul_f32 v[86:87], v[86:87], v[48:49] op_sel_hi:[1,0]
    v_cvt_pk_bf16_f32 v80, v80, v81
    v_cvt_pk_bf16_f32 v81, v82, v83
    v_cvt_pk_bf16_f32 v82, v84, v85
    v_cvt_pk_bf16_f32 v83, v86, v87
    s_waitcnt lgkmcnt(1)
    buffer_store_dwordx4 v[128:131], v59, s[12:15], s24 offen offset:0 sc0 sc1
    ds_write_b128 v56, v[80:83] offset:2048
    v_accvgpr_read_b32 v88, a6
    v_accvgpr_read_b32 v89, a18
    v_accvgpr_read_b32 v90, a30
    v_accvgpr_read_b32 v91, a42
    v_accvgpr_read_b32 v92, a7
    v_accvgpr_read_b32 v93, a19
    v_accvgpr_read_b32 v94, a31
    v_accvgpr_read_b32 v95, a43
    v_pk_mul_f32 v[88:89], v[88:89], v[48:49] op_sel_hi:[1,0]
    v_pk_mul_f32 v[90:91], v[90:91], v[48:49] op_sel_hi:[1,0]
    v_pk_mul_f32 v[92:93], v[92:93], v[48:49] op_sel_hi:[1,0]
    v_pk_mul_f32 v[94:95], v[94:95], v[48:49] op_sel_hi:[1,0]
    v_cvt_pk_bf16_f32 v88, v88, v89
    v_cvt_pk_bf16_f32 v89, v90, v91
    v_cvt_pk_bf16_f32 v90, v92, v93
    v_cvt_pk_bf16_f32 v91, v94, v95
    s_waitcnt lgkmcnt(1)
    buffer_store_dwordx4 v[132:135], v59, s[12:15], s24 offen offset:3072 sc0 sc1
    ds_write_b128 v57, v[88:91] offset:2048
    ds_read_b128 v[136:139], v58 offset:2048
    ds_read_b128 v[140:143], v58 offset:3072
    v_accvgpr_read_b32 v96, a8
    v_accvgpr_read_b32 v97, a20
    v_accvgpr_read_b32 v98, a32
    v_accvgpr_read_b32 v99, a44
    v_accvgpr_read_b32 v100, a9
    v_accvgpr_read_b32 v101, a21
    v_accvgpr_read_b32 v102, a33
    v_accvgpr_read_b32 v103, a45
    v_pk_mul_f32 v[96:97], v[96:97], v[48:49] op_sel_hi:[1,0]
    v_pk_mul_f32 v[98:99], v[98:99], v[48:49] op_sel_hi:[1,0]
    v_pk_mul_f32 v[100:101], v[100:101], v[48:49] op_sel_hi:[1,0]
    v_pk_mul_f32 v[102:103], v[102:103], v[48:49] op_sel_hi:[1,0]
    v_cvt_pk_bf16_f32 v96, v96, v97
    v_cvt_pk_bf16_f32 v97, v98, v99
    v_cvt_pk_bf16_f32 v98, v100, v101
    v_cvt_pk_bf16_f32 v99, v102, v103
    s_waitcnt lgkmcnt(1)
    buffer_store_dwordx4 v[136:139], v59, s[12:15], s24 offen offset:128 sc0 sc1
    ds_write_b128 v56, v[96:99] offset:4096
    v_accvgpr_read_b32 v104, a10
    v_accvgpr_read_b32 v105, a22
    v_accvgpr_read_b32 v106, a34
    v_accvgpr_read_b32 v107, a46
    v_accvgpr_read_b32 v108, a11
    v_accvgpr_read_b32 v109, a23
    v_accvgpr_read_b32 v110, a35
    v_accvgpr_read_b32 v111, a47
    v_pk_mul_f32 v[104:105], v[104:105], v[48:49] op_sel_hi:[1,0]
    v_pk_mul_f32 v[106:107], v[106:107], v[48:49] op_sel_hi:[1,0]
    v_pk_mul_f32 v[108:109], v[108:109], v[48:49] op_sel_hi:[1,0]
    v_pk_mul_f32 v[110:111], v[110:111], v[48:49] op_sel_hi:[1,0]
    v_cvt_pk_bf16_f32 v104, v104, v105
    v_cvt_pk_bf16_f32 v105, v106, v107
    v_cvt_pk_bf16_f32 v106, v108, v109
    v_cvt_pk_bf16_f32 v107, v110, v111
    s_waitcnt lgkmcnt(1)
    buffer_store_dwordx4 v[140:143], v59, s[12:15], s24 offen offset:3200 sc0 sc1
    ds_write_b128 v57, v[104:107] offset:4096
    ds_read_b128 v[144:147], v58 offset:4096
    ds_read_b128 v[148:151], v58 offset:5120
    v_accvgpr_read_b32 v112, a48
    v_accvgpr_read_b32 v113, a60
    v_accvgpr_read_b32 v114, a72
    v_accvgpr_read_b32 v115, a84
    v_accvgpr_read_b32 v116, a49
    v_accvgpr_read_b32 v117, a61
    v_accvgpr_read_b32 v118, a73
    v_accvgpr_read_b32 v119, a85
    v_pk_mul_f32 v[112:113], v[112:113], v[50:51] op_sel_hi:[1,0]
    v_pk_mul_f32 v[114:115], v[114:115], v[50:51] op_sel_hi:[1,0]
    v_pk_mul_f32 v[116:117], v[116:117], v[50:51] op_sel_hi:[1,0]
    v_pk_mul_f32 v[118:119], v[118:119], v[50:51] op_sel_hi:[1,0]
    v_cvt_pk_bf16_f32 v112, v112, v113
    v_cvt_pk_bf16_f32 v113, v114, v115
    v_cvt_pk_bf16_f32 v114, v116, v117
    v_cvt_pk_bf16_f32 v115, v118, v119
    s_waitcnt lgkmcnt(1)
    buffer_store_dwordx4 v[144:147], v59, s[12:15], s24 offen offset:256 sc0 sc1
    ds_write_b128 v56, v[112:115] offset:0
    v_accvgpr_read_b32 v120, a50
    v_accvgpr_read_b32 v121, a62
    v_accvgpr_read_b32 v122, a74
    v_accvgpr_read_b32 v123, a86
    v_accvgpr_read_b32 v124, a51
    v_accvgpr_read_b32 v125, a63
    v_accvgpr_read_b32 v126, a75
    v_accvgpr_read_b32 v127, a87
    v_pk_mul_f32 v[120:121], v[120:121], v[50:51] op_sel_hi:[1,0]
    v_pk_mul_f32 v[122:123], v[122:123], v[50:51] op_sel_hi:[1,0]
    v_pk_mul_f32 v[124:125], v[124:125], v[50:51] op_sel_hi:[1,0]
    v_pk_mul_f32 v[126:127], v[126:127], v[50:51] op_sel_hi:[1,0]
    v_cvt_pk_bf16_f32 v120, v120, v121
    v_cvt_pk_bf16_f32 v121, v122, v123
    v_cvt_pk_bf16_f32 v122, v124, v125
    v_cvt_pk_bf16_f32 v123, v126, v127
    s_waitcnt lgkmcnt(1)
    buffer_store_dwordx4 v[148:151], v59, s[12:15], s24 offen offset:3328 sc0 sc1
    ds_write_b128 v57, v[120:123] offset:0
    ds_read_b128 v[152:155], v58 offset:0
    ds_read_b128 v[156:159], v58 offset:1024
    v_accvgpr_read_b32 v64, a52
    v_accvgpr_read_b32 v65, a64
    v_accvgpr_read_b32 v66, a76
    v_accvgpr_read_b32 v67, a88
    v_accvgpr_read_b32 v68, a53
    v_accvgpr_read_b32 v69, a65
    v_accvgpr_read_b32 v70, a77
    v_accvgpr_read_b32 v71, a89
    v_pk_mul_f32 v[64:65], v[64:65], v[50:51] op_sel_hi:[1,0]
    v_pk_mul_f32 v[66:67], v[66:67], v[50:51] op_sel_hi:[1,0]
    v_pk_mul_f32 v[68:69], v[68:69], v[50:51] op_sel_hi:[1,0]
    v_pk_mul_f32 v[70:71], v[70:71], v[50:51] op_sel_hi:[1,0]
    v_cvt_pk_bf16_f32 v64, v64, v65
    v_cvt_pk_bf16_f32 v65, v66, v67
    v_cvt_pk_bf16_f32 v66, v68, v69
    v_cvt_pk_bf16_f32 v67, v70, v71
    s_waitcnt lgkmcnt(1)
    buffer_store_dwordx4 v[152:155], v59, s[12:15], s40 offen offset:0 sc0 sc1
    ds_write_b128 v56, v[64:67] offset:2048
    v_accvgpr_read_b32 v72, a54
    v_accvgpr_read_b32 v73, a66
    v_accvgpr_read_b32 v74, a78
    v_accvgpr_read_b32 v75, a90
    v_accvgpr_read_b32 v76, a55
    v_accvgpr_read_b32 v77, a67
    v_accvgpr_read_b32 v78, a79
    v_accvgpr_read_b32 v79, a91
    v_pk_mul_f32 v[72:73], v[72:73], v[50:51] op_sel_hi:[1,0]
    v_pk_mul_f32 v[74:75], v[74:75], v[50:51] op_sel_hi:[1,0]
    v_pk_mul_f32 v[76:77], v[76:77], v[50:51] op_sel_hi:[1,0]
    v_pk_mul_f32 v[78:79], v[78:79], v[50:51] op_sel_hi:[1,0]
    v_cvt_pk_bf16_f32 v72, v72, v73
    v_cvt_pk_bf16_f32 v73, v74, v75
    v_cvt_pk_bf16_f32 v74, v76, v77
    v_cvt_pk_bf16_f32 v75, v78, v79
    s_waitcnt lgkmcnt(1)
    buffer_store_dwordx4 v[156:159], v59, s[12:15], s40 offen offset:3072 sc0 sc1
    ds_write_b128 v57, v[72:75] offset:2048
    ds_read_b128 v[128:131], v58 offset:2048
    ds_read_b128 v[132:135], v58 offset:3072
    v_accvgpr_read_b32 v80, a56
    v_accvgpr_read_b32 v81, a68
    v_accvgpr_read_b32 v82, a80
    v_accvgpr_read_b32 v83, a92
    v_accvgpr_read_b32 v84, a57
    v_accvgpr_read_b32 v85, a69
    v_accvgpr_read_b32 v86, a81
    v_accvgpr_read_b32 v87, a93
    v_pk_mul_f32 v[80:81], v[80:81], v[50:51] op_sel_hi:[1,0]
    v_pk_mul_f32 v[82:83], v[82:83], v[50:51] op_sel_hi:[1,0]
    v_pk_mul_f32 v[84:85], v[84:85], v[50:51] op_sel_hi:[1,0]
    v_pk_mul_f32 v[86:87], v[86:87], v[50:51] op_sel_hi:[1,0]
    v_cvt_pk_bf16_f32 v80, v80, v81
    v_cvt_pk_bf16_f32 v81, v82, v83
    v_cvt_pk_bf16_f32 v82, v84, v85
    v_cvt_pk_bf16_f32 v83, v86, v87
    s_waitcnt lgkmcnt(1)
    buffer_store_dwordx4 v[128:131], v59, s[12:15], s40 offen offset:128 sc0 sc1
    ds_write_b128 v56, v[80:83] offset:4096
    v_accvgpr_read_b32 v88, a58
    v_accvgpr_read_b32 v89, a70
    v_accvgpr_read_b32 v90, a82
    v_accvgpr_read_b32 v91, a94
    v_accvgpr_read_b32 v92, a59
    v_accvgpr_read_b32 v93, a71
    v_accvgpr_read_b32 v94, a83
    v_accvgpr_read_b32 v95, a95
    v_pk_mul_f32 v[88:89], v[88:89], v[50:51] op_sel_hi:[1,0]
    v_pk_mul_f32 v[90:91], v[90:91], v[50:51] op_sel_hi:[1,0]
    v_pk_mul_f32 v[92:93], v[92:93], v[50:51] op_sel_hi:[1,0]
    v_pk_mul_f32 v[94:95], v[94:95], v[50:51] op_sel_hi:[1,0]
    v_cvt_pk_bf16_f32 v88, v88, v89
    v_cvt_pk_bf16_f32 v89, v90, v91
    v_cvt_pk_bf16_f32 v90, v92, v93
    v_cvt_pk_bf16_f32 v91, v94, v95
    s_waitcnt lgkmcnt(1)
    buffer_store_dwordx4 v[132:135], v59, s[12:15], s40 offen offset:3200 sc0 sc1
    ds_write_b128 v57, v[88:91] offset:4096
    ds_read_b128 v[136:139], v58 offset:4096
    ds_read_b128 v[140:143], v58 offset:5120
    v_accvgpr_read_b32 v96, a96
    v_accvgpr_read_b32 v97, a108
    v_accvgpr_read_b32 v98, a120
    v_accvgpr_read_b32 v99, a132
    v_accvgpr_read_b32 v100, a97
    v_accvgpr_read_b32 v101, a109
    v_accvgpr_read_b32 v102, a121
    v_accvgpr_read_b32 v103, a133
    v_pk_mul_f32 v[96:97], v[96:97], v[52:53] op_sel_hi:[1,0]
    v_pk_mul_f32 v[98:99], v[98:99], v[52:53] op_sel_hi:[1,0]
    v_pk_mul_f32 v[100:101], v[100:101], v[52:53] op_sel_hi:[1,0]
    v_pk_mul_f32 v[102:103], v[102:103], v[52:53] op_sel_hi:[1,0]
    v_cvt_pk_bf16_f32 v96, v96, v97
    v_cvt_pk_bf16_f32 v97, v98, v99
    v_cvt_pk_bf16_f32 v98, v100, v101
    v_cvt_pk_bf16_f32 v99, v102, v103
    s_waitcnt lgkmcnt(1)
    buffer_store_dwordx4 v[136:139], v59, s[12:15], s40 offen offset:256 sc0 sc1
    ds_write_b128 v56, v[96:99] offset:0
    v_accvgpr_read_b32 v104, a98
    v_accvgpr_read_b32 v105, a110
    v_accvgpr_read_b32 v106, a122
    v_accvgpr_read_b32 v107, a134
    v_accvgpr_read_b32 v108, a99
    v_accvgpr_read_b32 v109, a111
    v_accvgpr_read_b32 v110, a123
    v_accvgpr_read_b32 v111, a135
    v_pk_mul_f32 v[104:105], v[104:105], v[52:53] op_sel_hi:[1,0]
    v_pk_mul_f32 v[106:107], v[106:107], v[52:53] op_sel_hi:[1,0]
    v_pk_mul_f32 v[108:109], v[108:109], v[52:53] op_sel_hi:[1,0]
    v_pk_mul_f32 v[110:111], v[110:111], v[52:53] op_sel_hi:[1,0]
    v_cvt_pk_bf16_f32 v104, v104, v105
    v_cvt_pk_bf16_f32 v105, v106, v107
    v_cvt_pk_bf16_f32 v106, v108, v109
    v_cvt_pk_bf16_f32 v107, v110, v111
    s_waitcnt lgkmcnt(1)
    buffer_store_dwordx4 v[140:143], v59, s[12:15], s40 offen offset:3328 sc0 sc1
    ds_write_b128 v57, v[104:107] offset:0
    ds_read_b128 v[144:147], v58 offset:0
    ds_read_b128 v[148:151], v58 offset:1024
    v_accvgpr_read_b32 v112, a100
    v_accvgpr_read_b32 v113, a112
    v_accvgpr_read_b32 v114, a124
    v_accvgpr_read_b32 v115, a136
    v_accvgpr_read_b32 v116, a101
    v_accvgpr_read_b32 v117, a113
    v_accvgpr_read_b32 v118, a125
    v_accvgpr_read_b32 v119, a137
    v_pk_mul_f32 v[112:113], v[112:113], v[52:53] op_sel_hi:[1,0]
    v_pk_mul_f32 v[114:115], v[114:115], v[52:53] op_sel_hi:[1,0]
    v_pk_mul_f32 v[116:117], v[116:117], v[52:53] op_sel_hi:[1,0]
    v_pk_mul_f32 v[118:119], v[118:119], v[52:53] op_sel_hi:[1,0]
    v_cvt_pk_bf16_f32 v112, v112, v113
    v_cvt_pk_bf16_f32 v113, v114, v115
    v_cvt_pk_bf16_f32 v114, v116, v117
    v_cvt_pk_bf16_f32 v115, v118, v119
    s_waitcnt lgkmcnt(1)
    buffer_store_dwordx4 v[144:147], v59, s[12:15], s41 offen offset:0 sc0 sc1
    ds_write_b128 v56, v[112:115] offset:2048
    v_accvgpr_read_b32 v120, a102
    v_accvgpr_read_b32 v121, a114
    v_accvgpr_read_b32 v122, a126
    v_accvgpr_read_b32 v123, a138
    v_accvgpr_read_b32 v124, a103
    v_accvgpr_read_b32 v125, a115
    v_accvgpr_read_b32 v126, a127
    v_accvgpr_read_b32 v127, a139
    v_pk_mul_f32 v[120:121], v[120:121], v[52:53] op_sel_hi:[1,0]
    v_pk_mul_f32 v[122:123], v[122:123], v[52:53] op_sel_hi:[1,0]
    v_pk_mul_f32 v[124:125], v[124:125], v[52:53] op_sel_hi:[1,0]
    v_pk_mul_f32 v[126:127], v[126:127], v[52:53] op_sel_hi:[1,0]
    v_cvt_pk_bf16_f32 v120, v120, v121
    v_cvt_pk_bf16_f32 v121, v122, v123
    v_cvt_pk_bf16_f32 v122, v124, v125
    v_cvt_pk_bf16_f32 v123, v126, v127
    s_waitcnt lgkmcnt(1)
    buffer_store_dwordx4 v[148:151], v59, s[12:15], s41 offen offset:3072 sc0 sc1
    ds_write_b128 v57, v[120:123] offset:2048
    ds_read_b128 v[152:155], v58 offset:2048
    ds_read_b128 v[156:159], v58 offset:3072
    v_accvgpr_read_b32 v64, a104
    v_accvgpr_read_b32 v65, a116
    v_accvgpr_read_b32 v66, a128
    v_accvgpr_read_b32 v67, a140
    v_accvgpr_read_b32 v68, a105
    v_accvgpr_read_b32 v69, a117
    v_accvgpr_read_b32 v70, a129
    v_accvgpr_read_b32 v71, a141
    v_pk_mul_f32 v[64:65], v[64:65], v[52:53] op_sel_hi:[1,0]
    v_pk_mul_f32 v[66:67], v[66:67], v[52:53] op_sel_hi:[1,0]
    v_pk_mul_f32 v[68:69], v[68:69], v[52:53] op_sel_hi:[1,0]
    v_pk_mul_f32 v[70:71], v[70:71], v[52:53] op_sel_hi:[1,0]
    v_cvt_pk_bf16_f32 v64, v64, v65
    v_cvt_pk_bf16_f32 v65, v66, v67
    v_cvt_pk_bf16_f32 v66, v68, v69
    v_cvt_pk_bf16_f32 v67, v70, v71
    s_waitcnt lgkmcnt(1)
    buffer_store_dwordx4 v[152:155], v59, s[12:15], s41 offen offset:128 sc0 sc1
    ds_write_b128 v56, v[64:67] offset:4096
    v_accvgpr_read_b32 v72, a106
    v_accvgpr_read_b32 v73, a118
    v_accvgpr_read_b32 v74, a130
    v_accvgpr_read_b32 v75, a142
    v_accvgpr_read_b32 v76, a107
    v_accvgpr_read_b32 v77, a119
    v_accvgpr_read_b32 v78, a131
    v_accvgpr_read_b32 v79, a143
    v_pk_mul_f32 v[72:73], v[72:73], v[52:53] op_sel_hi:[1,0]
    v_pk_mul_f32 v[74:75], v[74:75], v[52:53] op_sel_hi:[1,0]
    v_pk_mul_f32 v[76:77], v[76:77], v[52:53] op_sel_hi:[1,0]
    v_pk_mul_f32 v[78:79], v[78:79], v[52:53] op_sel_hi:[1,0]
    v_cvt_pk_bf16_f32 v72, v72, v73
    v_cvt_pk_bf16_f32 v73, v74, v75
    v_cvt_pk_bf16_f32 v74, v76, v77
    v_cvt_pk_bf16_f32 v75, v78, v79
    s_waitcnt lgkmcnt(1)
    buffer_store_dwordx4 v[156:159], v59, s[12:15], s41 offen offset:3200 sc0 sc1
    ds_write_b128 v57, v[72:75] offset:4096
    ds_read_b128 v[128:131], v58 offset:4096
    ds_read_b128 v[132:135], v58 offset:5120
    v_accvgpr_read_b32 v80, a144
    v_accvgpr_read_b32 v81, a156
    v_accvgpr_read_b32 v82, a168
    v_accvgpr_read_b32 v83, a180
    v_accvgpr_read_b32 v84, a145
    v_accvgpr_read_b32 v85, a157
    v_accvgpr_read_b32 v86, a169
    v_accvgpr_read_b32 v87, a181
    v_pk_mul_f32 v[80:81], v[80:81], v[54:55] op_sel_hi:[1,0]
    v_pk_mul_f32 v[82:83], v[82:83], v[54:55] op_sel_hi:[1,0]
    v_pk_mul_f32 v[84:85], v[84:85], v[54:55] op_sel_hi:[1,0]
    v_pk_mul_f32 v[86:87], v[86:87], v[54:55] op_sel_hi:[1,0]
    v_cvt_pk_bf16_f32 v80, v80, v81
    v_cvt_pk_bf16_f32 v81, v82, v83
    v_cvt_pk_bf16_f32 v82, v84, v85
    v_cvt_pk_bf16_f32 v83, v86, v87
    s_waitcnt lgkmcnt(1)
    buffer_store_dwordx4 v[128:131], v59, s[12:15], s41 offen offset:256 sc0 sc1
    ds_write_b128 v56, v[80:83] offset:0
    v_accvgpr_read_b32 v88, a146
    v_accvgpr_read_b32 v89, a158
    v_accvgpr_read_b32 v90, a170
    v_accvgpr_read_b32 v91, a182
    v_accvgpr_read_b32 v92, a147
    v_accvgpr_read_b32 v93, a159
    v_accvgpr_read_b32 v94, a171
    v_accvgpr_read_b32 v95, a183
    v_pk_mul_f32 v[88:89], v[88:89], v[54:55] op_sel_hi:[1,0]
    v_pk_mul_f32 v[90:91], v[90:91], v[54:55] op_sel_hi:[1,0]
    v_pk_mul_f32 v[92:93], v[92:93], v[54:55] op_sel_hi:[1,0]
    v_pk_mul_f32 v[94:95], v[94:95], v[54:55] op_sel_hi:[1,0]
    v_cvt_pk_bf16_f32 v88, v88, v89
    v_cvt_pk_bf16_f32 v89, v90, v91
    v_cvt_pk_bf16_f32 v90, v92, v93
    v_cvt_pk_bf16_f32 v91, v94, v95
    s_waitcnt lgkmcnt(1)
    buffer_store_dwordx4 v[132:135], v59, s[12:15], s41 offen offset:3328 sc0 sc1
    ds_write_b128 v57, v[88:91] offset:0
    ds_read_b128 v[136:139], v58 offset:0
    ds_read_b128 v[140:143], v58 offset:1024
    v_accvgpr_read_b32 v96, a148
    v_accvgpr_read_b32 v97, a160
    v_accvgpr_read_b32 v98, a172
    v_accvgpr_read_b32 v99, a184
    v_accvgpr_read_b32 v100, a149
    v_accvgpr_read_b32 v101, a161
    v_accvgpr_read_b32 v102, a173
    v_accvgpr_read_b32 v103, a185
    v_pk_mul_f32 v[96:97], v[96:97], v[54:55] op_sel_hi:[1,0]
    v_pk_mul_f32 v[98:99], v[98:99], v[54:55] op_sel_hi:[1,0]
    v_pk_mul_f32 v[100:101], v[100:101], v[54:55] op_sel_hi:[1,0]
    v_pk_mul_f32 v[102:103], v[102:103], v[54:55] op_sel_hi:[1,0]
    v_cvt_pk_bf16_f32 v96, v96, v97
    v_cvt_pk_bf16_f32 v97, v98, v99
    v_cvt_pk_bf16_f32 v98, v100, v101
    v_cvt_pk_bf16_f32 v99, v102, v103
    s_waitcnt lgkmcnt(1)
    buffer_store_dwordx4 v[136:139], v59, s[12:15], s42 offen offset:0 sc0 sc1
    ds_write_b128 v56, v[96:99] offset:2048
    v_accvgpr_read_b32 v104, a150
    v_accvgpr_read_b32 v105, a162
    v_accvgpr_read_b32 v106, a174
    v_accvgpr_read_b32 v107, a186
    v_accvgpr_read_b32 v108, a151
    v_accvgpr_read_b32 v109, a163
    v_accvgpr_read_b32 v110, a175
    v_accvgpr_read_b32 v111, a187
    v_pk_mul_f32 v[104:105], v[104:105], v[54:55] op_sel_hi:[1,0]
    v_pk_mul_f32 v[106:107], v[106:107], v[54:55] op_sel_hi:[1,0]
    v_pk_mul_f32 v[108:109], v[108:109], v[54:55] op_sel_hi:[1,0]
    v_pk_mul_f32 v[110:111], v[110:111], v[54:55] op_sel_hi:[1,0]
    v_cvt_pk_bf16_f32 v104, v104, v105
    v_cvt_pk_bf16_f32 v105, v106, v107
    v_cvt_pk_bf16_f32 v106, v108, v109
    v_cvt_pk_bf16_f32 v107, v110, v111
    s_waitcnt lgkmcnt(1)
    buffer_store_dwordx4 v[140:143], v59, s[12:15], s42 offen offset:3072 sc0 sc1
    ds_write_b128 v57, v[104:107] offset:2048
    ds_read_b128 v[144:147], v58 offset:2048
    ds_read_b128 v[148:151], v58 offset:3072
    v_accvgpr_read_b32 v112, a152
    v_accvgpr_read_b32 v113, a164
    v_accvgpr_read_b32 v114, a176
    v_accvgpr_read_b32 v115, a188
    v_accvgpr_read_b32 v116, a153
    v_accvgpr_read_b32 v117, a165
    v_accvgpr_read_b32 v118, a177
    v_accvgpr_read_b32 v119, a189
    v_pk_mul_f32 v[112:113], v[112:113], v[54:55] op_sel_hi:[1,0]
    v_pk_mul_f32 v[114:115], v[114:115], v[54:55] op_sel_hi:[1,0]
    v_pk_mul_f32 v[116:117], v[116:117], v[54:55] op_sel_hi:[1,0]
    v_pk_mul_f32 v[118:119], v[118:119], v[54:55] op_sel_hi:[1,0]
    v_cvt_pk_bf16_f32 v112, v112, v113
    v_cvt_pk_bf16_f32 v113, v114, v115
    v_cvt_pk_bf16_f32 v114, v116, v117
    v_cvt_pk_bf16_f32 v115, v118, v119
    s_waitcnt lgkmcnt(1)
    buffer_store_dwordx4 v[144:147], v59, s[12:15], s42 offen offset:128 sc0 sc1
    ds_write_b128 v56, v[112:115] offset:4096
    v_accvgpr_read_b32 v120, a154
    v_accvgpr_read_b32 v121, a166
    v_accvgpr_read_b32 v122, a178
    v_accvgpr_read_b32 v123, a190
    v_accvgpr_read_b32 v124, a155
    v_accvgpr_read_b32 v125, a167
    v_accvgpr_read_b32 v126, a179
    v_accvgpr_read_b32 v127, a191
    v_pk_mul_f32 v[120:121], v[120:121], v[54:55] op_sel_hi:[1,0]
    v_pk_mul_f32 v[122:123], v[122:123], v[54:55] op_sel_hi:[1,0]
    v_pk_mul_f32 v[124:125], v[124:125], v[54:55] op_sel_hi:[1,0]
    v_pk_mul_f32 v[126:127], v[126:127], v[54:55] op_sel_hi:[1,0]
    v_cvt_pk_bf16_f32 v120, v120, v121
    v_cvt_pk_bf16_f32 v121, v122, v123
    v_cvt_pk_bf16_f32 v122, v124, v125
    v_cvt_pk_bf16_f32 v123, v126, v127
    s_waitcnt lgkmcnt(1)
    buffer_store_dwordx4 v[148:151], v59, s[12:15], s42 offen offset:3200 sc0 sc1
    ds_write_b128 v57, v[120:123] offset:4096
    ds_read_b128 v[152:155], v58 offset:4096
    ds_read_b128 v[156:159], v58 offset:5120
    s_waitcnt lgkmcnt(1)
    buffer_store_dwordx4 v[152:155], v59, s[12:15], s42 offen offset:256 sc0 sc1
    s_waitcnt lgkmcnt(0)
    buffer_store_dwordx4 v[156:159], v59, s[12:15], s42 offen offset:3328 sc0 sc1
    s_branch L_fin
.section .rodata,"a"
.p2align 6
.amdhsa_kernel standalone__kv_cache_quant_int4_int2_kv_with_per_channel_or_per_token_scales__prompt_kernel
  .amdhsa_next_free_vgpr 512
  .amdhsa_next_free_sgpr 102
  .amdhsa_accum_offset 256
  .amdhsa_group_segment_fixed_size 0
  .amdhsa_kernarg_size 80
  .amdhsa_user_sgpr_count 2
  .amdhsa_user_sgpr_kernarg_segment_ptr 1
  .amdhsa_system_sgpr_workgroup_id_x 1
.end_amdhsa_kernel
```

```asm
; @launch grid=(256,1,1) block=(256,1,1) lds=147584
.amdgcn_target "amdgcn-amd-amdhsa--gfx950"
.text
.globl standalone__kv_cache_quant_int4_int2_kv_with_per_channel_or_per_token_scales__prompt_kernel
.p2align 8
.type standalone__kv_cache_quant_int4_int2_kv_with_per_channel_or_per_token_scales__prompt_kernel,@function
standalone__kv_cache_quant_int4_int2_kv_with_per_channel_or_per_token_scales__prompt_kernel:
    s_cmp_ge_u32 s2, 256
    s_cbranch_scc1 L_done
    s_load_dwordx16 s[40:55], s[0:1], 0
    s_load_dwordx4 s[16:19], s[0:1], 64
    s_and_b32 s94, s2, 7
    s_lshr_b32 s95, s2, 3
    s_lshr_b32 s24, s95, 3
    s_lshl_b32 s94, s94, 2
    s_add_u32 s94, s94, s24
    s_and_b32 s95, s95, 7
    s_getpc_b64 s[60:61]
L_pc:
    s_sub_u32 s60, s60, L_pc-standalone__kv_cache_quant_int4_int2_kv_with_per_channel_or_per_token_scales__prompt_kernel
    s_subb_u32 s61, s61, 0
    s_mov_b32 s62, L_slow-standalone__kv_cache_quant_int4_int2_kv_with_per_channel_or_per_token_scales__prompt_kernel
    s_mov_b32 s63, 0x20000
    s_lshr_b32 s22, s2, 3
    s_lshl_b32 s22, s22, 12
    v_lshlrev_b32 v30, 4, v0
    buffer_load_dwordx4 v[128:131], v30, s[60:63], s22 offen
    v_lshrrev_b32 v24, 6, v0
    v_and_b32 v25, 63, v0
    v_readfirstlane_b32 s25, v24
    v_lshlrev_b32 v1, 4, v25
    v_mul_u32_u24 v26, 43, v25
    v_lshrrev_b32 v26, 10, v26
    v_mul_u32_u24 v27, 24, v26
    v_sub_u32 v27, v25, v27
    v_lshrrev_b32 v28, 1, v24
    v_and_b32 v29, 1, v24
    v_lshlrev_b32 v30, 4, v29
    v_lshl_add_u32 v30, v28, 2, v30
    v_add_u32 v30, v30, v26
    v_mul_u32_u24 v30, 768, v30
    v_lshrrev_b32 v48, 1, v26
    v_lshlrev_b32 v48, 30, v48
    v_lshl_add_u32 v30, v27, 4, v30
    v_or_b32 v9, v30, v48
    v_lshl_or_b32 v10, v27, 3, v48
    v_mul_u32_u24 v30, 6144, v24
    v_add3_u32 v12, v30, v1, v48
    s_mov_b32 s66, 1572864
    s_mov_b32 s67, 0x20000
    s_mov_b32 s70, 1572864
    s_mov_b32 s71, 0x20000
    s_mov_b32 s74, 12288
    s_mov_b32 s75, 0x20000
    s_mov_b32 s78, 12288
    s_mov_b32 s79, 0x20000
    s_mov_b32 s82, 4096
    s_mov_b32 s83, 0x20000
    s_mov_b32 s86, 4096
    s_mov_b32 s87, 0x20000
    s_mov_b32 s22, 64
    s_mov_b32 s23, 0x20000
    s_mul_i32 s33, s95, 24576
    s_add_u32 s34, s33, 6144
    s_mov_b32 s35, s33
    s_lshr_b32 s36, s95, 1
    s_mul_i32 s36, s36, 384
    s_lshl_b32 s37, s95, 6
    s_lshl_b32 s24, s25, 4
    s_add_u32 s37, s37, s24
    s_mul_i32 s24, s94, 1572864
    s_mul_i32 s56, s94, 12288
    s_lshl_b32 s57, s94, 12
    s_lshl_b32 s58, s94, 10
    s_add_u32 s58, s58, 51380320
    s_or_b32 s39, s95, s25
    s_waitcnt lgkmcnt(0)
    s_add_u32 s64, s42, s24
    s_addc_u32 s65, s43, 0
    s_add_u32 s72, s46, s56
    s_addc_u32 s73, s47, 0
    s_add_u32 s76, s48, s56
    s_addc_u32 s77, s49, 0
    buffer_load_dwordx4 v[224:227], v9, s[64:67], s33 offen offset:0 nt
    buffer_load_dwordx4 v[228:231], v9, s[64:67], s33 offen offset:1536 nt
    buffer_load_dwordx4 v[232:235], v9, s[64:67], s34 offen offset:0 nt
    buffer_load_dwordx4 v[236:239], v9, s[64:67], s34 offen offset:1536 nt
    buffer_load_dwordx2 v[32:33], v10, s[72:75], s36 offen offset:0
    buffer_load_dwordx2 v[34:35], v10, s[76:79], s36 offen offset:0
    buffer_load_dwordx2 v[36:37], v10, s[72:75], s36 offen offset:192
    buffer_load_dwordx2 v[38:39], v10, s[76:79], s36 offen offset:192
    s_add_u32 s20, s18, s58
    s_addc_u32 s21, s19, 0
    s_add_u32 s80, s50, s57
    s_addc_u32 s81, s51, 0
    s_add_u32 s84, s52, s57
    s_addc_u32 s85, s53, 0
    s_add_u32 s68, s44, s24
    s_addc_u32 s69, s45, 0
    s_mul_i32 s59, s94, 786432
    s_add_u32 s12, s54, s59
    s_addc_u32 s13, s55, 0
    s_add_u32 s8, s40, s59
    s_addc_u32 s9, s41, 0
    s_cmp_lg_u32 s39, 0
    s_cbranch_scc1 L_notleader0
    s_buffer_load_dwordx16 s[40:55], s[20:23], 0 glc
L_notleader0:
    buffer_load_dwordx4 v[240:243], v9, s[64:67], s33 offen offset:384 nt
    buffer_load_dwordx4 v[244:247], v9, s[64:67], s33 offen offset:1920 nt
    buffer_load_dwordx4 v[248:251], v9, s[64:67], s34 offen offset:384 nt
    buffer_load_dwordx4 v[252:255], v9, s[64:67], s34 offen offset:1920 nt
    s_add_u32 s4, s18, s24
    s_addc_u32 s5, s19, 0
    s_mov_b32 s6, 1572864
    s_mov_b32 s7, 0x20000
    s_mov_b32 s10, 786432
    s_mov_b32 s11, 0x20000
    s_mov_b32 s88, s16
    s_mov_b32 s89, s17
    s_add_u32 s16, s33, 3072
    s_add_u32 s17, s33, 6144
    s_mov_b32 s90, 256
    s_mov_b32 s91, 0x20000
    s_lshl_b32 s93, s94, 3
    s_cmp_lg_u32 s39, 0
    s_cbranch_scc1 L_notleader
    s_waitcnt lgkmcnt(0)
    s_mov_b32 s59, 1
    s_lshr_b32 s40, s40, 10
    s_min_u32 s40, s40, 31
    s_bitset1_b32 s59, s40
    s_lshr_b32 s41, s41, 10
    s_min_u32 s41, s41, 31
    s_bitset1_b32 s59, s41
    s_lshr_b32 s42, s42, 10
    s_min_u32 s42, s42, 31
    s_bitset1_b32 s59, s42
    s_lshr_b32 s43, s43, 10
    s_min_u32 s43, s43, 31
    s_bitset1_b32 s59, s43
    s_lshr_b32 s44, s44, 10
    s_min_u32 s44, s44, 31
    s_bitset1_b32 s59, s44
    s_lshr_b32 s45, s45, 10
    s_min_u32 s45, s45, 31
    s_bitset1_b32 s59, s45
    s_lshr_b32 s46, s46, 10
    s_min_u32 s46, s46, 31
    s_bitset1_b32 s59, s46
    s_lshr_b32 s47, s47, 10
    s_min_u32 s47, s47, 31
    s_bitset1_b32 s59, s47
    s_lshr_b32 s48, s48, 10
    s_min_u32 s48, s48, 31
    s_bitset1_b32 s59, s48
    s_lshr_b32 s49, s49, 10
    s_min_u32 s49, s49, 31
    s_bitset1_b32 s59, s49
    s_lshr_b32 s50, s50, 10
    s_min_u32 s50, s50, 31
    s_bitset1_b32 s59, s50
    s_lshr_b32 s51, s51, 10
    s_min_u32 s51, s51, 31
    s_bitset1_b32 s59, s51
    s_lshr_b32 s52, s52, 10
    s_min_u32 s52, s52, 31
    s_bitset1_b32 s59, s52
    s_lshr_b32 s53, s53, 10
    s_min_u32 s53, s53, 31
    s_bitset1_b32 s59, s53
    s_lshr_b32 s54, s54, 10
    s_min_u32 s54, s54, 31
    s_bitset1_b32 s59, s54
    s_lshr_b32 s55, s55, 10
    s_min_u32 s55, s55, 31
    s_bitset1_b32 s59, s55
    s_ff0_i32_b32 s59, s59
    s_lshl_b32 s59, s59, 10
    v_mov_b32 v52, s59
    s_mov_b64 exec, 1
    buffer_store_dword v52, off, s[88:91], s93 sc1
    s_mov_b64 exec, -1
L_notleader:
    s_lshl_b32 s24, s95, 2
    s_add_u32 s24, s24, 32
    s_buffer_load_dword s46, s[20:23], s24 glc
    s_getreg_b32 s45, hwreg(HW_REG_XCC_ID, 0, 4)
    s_lshl_b32 s45, s45, 5
    s_mov_b32 s44, 0
    buffer_load_dwordx4 v[112:115], v12, s[68:71], s35 offen offset:0 nt
    buffer_load_dwordx4 v[116:119], v12, s[68:71], s35 offen offset:768 nt
    buffer_load_dwordx4 v[120:123], v12, s[68:71], s35 offen offset:1536 nt
    buffer_load_dwordx4 v[124:127], v12, s[68:71], s35 offen offset:2304 nt
    buffer_load_dwordx2 v[40:41], off, s[80:83], s37 offset:0
    buffer_load_dwordx2 v[42:43], off, s[84:87], s37 offset:0
    buffer_load_dwordx2 v[44:45], off, s[80:83], s37 offset:8
    buffer_load_dwordx2 v[46:47], off, s[84:87], s37 offset:8
    s_mov_b32 s14, 786432
    s_mov_b32 s15, 0x20000
    s_lshl_b32 s24, s25, 8
    s_add_u32 s93, s93, s24
    v_mul_u32_u24 v30, 3072, v24
    v_add_u32 v4, v30, v1
    v_lshl_add_u32 v30, v24, 3, v26
    v_mul_u32_u24 v30, 384, v30
    v_lshlrev_b32 v31, 2, v29
    v_xor_b32 v31, v27, v31
    v_lshl_add_u32 v30, v31, 4, v30
    v_or_b32 v11, v30, v48
    v_lshlrev_b32 v30, 8, v24
    v_add_u32 v30, 12288, v30
    v_lshrrev_b32 v31, 4, v25
    v_lshl_add_u32 v30, v31, 10, v30
    v_and_b32 v31, 15, v25
    v_lshl_add_u32 v30, v31, 4, v30
    v_or_b32 v20, v30, v48
    s_lshl_b32 s24, s95, 2
    v_lshl_add_u32 v13, v0, 2, s24
    v_cmp_lt_u32 vcc, 0, v0
    v_mov_b32 v30, 0x40000000
    s_nop 0
    v_cndmask_b32 v13, v13, v30, vcc
    s_mul_i32 s26, s25, 3072
    s_add_u32 s26, s26, 12288
    s_add_u32 s56, s26, 24576
    s_add_u32 s24, s95, 1
    s_and_b32 s24, s24, 7
    s_mul_i32 s32, s24, 24576
    s_add_u32 s27, s32, 12288
    s_mov_b32 s28, 98304
    s_mov_b32 s30, 73728
    v_add_u32 v1, 24576, v1
    s_mov_b32 s38, 0x3dd53b95
    s_mov_b32 s97, 0xffff0000
    s_mov_b32 s96, 100000
    v_and_b32 v26, 15, v25
    v_lshrrev_b32 v27, 4, v25
    v_bfe_u32 v28, v25, 1, 3
    v_xor_b32 v29, v27, v28
    v_mul_u32_u24 v30, 384, v26
    v_lshl_add_u32 v2, v29, 4, v30
    v_xor_b32 v3, 64, v2
    s_mul_i32 s40, s25, 6144
    s_add_u32 s40, s40, 73728
    v_lshrrev_b32 v29, 1, v27
    v_xor_b32 v29, v29, v28
    v_lshl_add_u32 v31, v29, 4, v30
    v_and_b32 v29, 1, v27
    v_lshl_add_u32 v31, v29, 3, v31
    v_xor_b32 v22, 0, v31
    v_add_u32 v22, s40, v22
    v_xor_b32 v23, 32, v31
    v_add_u32 v23, s40, v23
    v_xor_b32 v142, 64, v31
    v_add_u32 v142, s40, v142
    v_xor_b32 v143, 96, v31
    v_add_u32 v143, s40, v143
    s_lshl_b32 s24, s95, 2
    s_add_u32 s24, s24, s25
    s_mul_i32 s24, s24, 24576
    v_add_u32 v26, 0, v25
    v_mul_u32_u24 v27, 2731, v26
    v_lshrrev_b32 v27, 17, v27
    v_and_b32 v27, 7, v27
    v_xor_b32 v26, v26, v27
    v_lshlrev_b32 v136, 4, v26
    v_add_u32 v136, s24, v136
    v_add_u32 v26, 64, v25
    v_mul_u32_u24 v27, 2731, v26
    v_lshrrev_b32 v27, 17, v27
    v_and_b32 v27, 7, v27
    v_xor_b32 v26, v26, v27
    v_lshlrev_b32 v137, 4, v26
    v_add_u32 v137, s24, v137
    v_add_u32 v26, 128, v25
    v_mul_u32_u24 v27, 2731, v26
    v_lshrrev_b32 v27, 17, v27
    v_and_b32 v27, 7, v27
    v_xor_b32 v26, v26, v27
    v_lshlrev_b32 v138, 4, v26
    v_add_u32 v138, s24, v138
    v_add_u32 v26, 192, v25
    v_mul_u32_u24 v27, 2731, v26
    v_lshrrev_b32 v27, 17, v27
    v_and_b32 v27, 7, v27
    v_xor_b32 v26, v26, v27
    v_lshlrev_b32 v139, 4, v26
    v_add_u32 v139, s24, v139
    v_add_u32 v26, 256, v25
    v_mul_u32_u24 v27, 2731, v26
    v_lshrrev_b32 v27, 17, v27
    v_and_b32 v27, 7, v27
    v_xor_b32 v26, v26, v27
    v_lshlrev_b32 v140, 4, v26
    v_add_u32 v140, s24, v140
    v_add_u32 v26, 320, v25
    v_mul_u32_u24 v27, 2731, v26
    v_lshrrev_b32 v27, 17, v27
    v_and_b32 v27, 7, v27
    v_xor_b32 v26, v26, v27
    v_lshlrev_b32 v141, 4, v26
    v_add_u32 v141, s24, v141
    v_mov_b32 v5, 0
    v_mov_b32 v6, 0
    v_mov_b32 v7, 0
    v_mov_b32 v8, 0
    s_mov_b32 s62, -1
    s_mov_b32 s63, 0xffff
    s_waitcnt vmcnt(12)
    buffer_load_dwordx4 v[80:83], v12, s[68:71], s16 offen offset:0 nt
    buffer_load_dwordx4 v[84:87], v12, s[68:71], s16 offen offset:768 nt
    buffer_load_dwordx4 v[88:91], v12, s[68:71], s16 offen offset:1536 nt
    buffer_load_dwordx4 v[92:95], v12, s[68:71], s16 offen offset:2304 nt
    v_lshlrev_b32 v48, 16, v32
    v_and_b32 v49, s97, v32
    v_lshlrev_b32 v50, 16, v34
    v_and_b32 v51, s97, v34
    v_mul_f32 v48, s38, v48
    v_mul_f32 v49, s38, v49
    v_mul_f32_e64 v50, -v50, v48
    v_mul_f32_e64 v51, -v51, v49
    v_cvt_f32_i32 v224, v224
    v_cvt_f32_i32 v225, v225
    v_fma_f32 v224, v224, v48, v50
    v_fma_f32 v225, v225, v49, v51
    v_cvt_pk_bf16_f32 v224, v224, v225
    v_cvt_f32_i32 v228, v228
    v_cvt_f32_i32 v229, v229
    v_fma_f32 v228, v228, v48, v50
    v_fma_f32 v229, v229, v49, v51
    v_cvt_pk_bf16_f32 v228, v228, v229
    v_cvt_f32_i32 v232, v232
    v_cvt_f32_i32 v233, v233
    v_fma_f32 v232, v232, v48, v50
    v_fma_f32 v233, v233, v49, v51
    v_cvt_pk_bf16_f32 v232, v232, v233
    v_cvt_f32_i32 v236, v236
    v_cvt_f32_i32 v237, v237
    v_fma_f32 v236, v236, v48, v50
    v_fma_f32 v237, v237, v49, v51
    v_cvt_pk_bf16_f32 v236, v236, v237
    v_lshlrev_b32 v48, 16, v33
    v_and_b32 v49, s97, v33
    v_lshlrev_b32 v50, 16, v35
    v_and_b32 v51, s97, v35
    v_mul_f32 v48, s38, v48
    v_mul_f32 v49, s38, v49
    v_mul_f32_e64 v50, -v50, v48
    v_mul_f32_e64 v51, -v51, v49
    v_cvt_f32_i32 v226, v226
    v_cvt_f32_i32 v227, v227
    v_fma_f32 v226, v226, v48, v50
    v_fma_f32 v227, v227, v49, v51
    v_cvt_pk_bf16_f32 v225, v226, v227
    v_cvt_f32_i32 v230, v230
    v_cvt_f32_i32 v231, v231
    v_fma_f32 v230, v230, v48, v50
    v_fma_f32 v231, v231, v49, v51
    v_cvt_pk_bf16_f32 v229, v230, v231
    v_cvt_f32_i32 v234, v234
    v_cvt_f32_i32 v235, v235
    v_fma_f32 v234, v234, v48, v50
    v_fma_f32 v235, v235, v49, v51
    v_cvt_pk_bf16_f32 v233, v234, v235
    v_cvt_f32_i32 v238, v238
    v_cvt_f32_i32 v239, v239
    v_fma_f32 v238, v238, v48, v50
    v_fma_f32 v239, v239, v49, v51
    v_cvt_pk_bf16_f32 v237, v238, v239
    s_waitcnt vmcnt(12)
    v_lshlrev_b32 v48, 16, v36
    v_and_b32 v49, s97, v36
    v_lshlrev_b32 v50, 16, v38
    v_and_b32 v51, s97, v38
    v_mul_f32 v48, s38, v48
    v_mul_f32 v49, s38, v49
    v_mul_f32_e64 v50, -v50, v48
    v_mul_f32_e64 v51, -v51, v49
    v_cvt_f32_i32 v240, v240
    v_cvt_f32_i32 v241, v241
    v_fma_f32 v240, v240, v48, v50
    v_fma_f32 v241, v241, v49, v51
    v_cvt_pk_bf16_f32 v226, v240, v241
    v_cvt_f32_i32 v244, v244
    v_cvt_f32_i32 v245, v245
    v_fma_f32 v244, v244, v48, v50
    v_fma_f32 v245, v245, v49, v51
    v_cvt_pk_bf16_f32 v230, v244, v245
    v_cvt_f32_i32 v248, v248
    v_cvt_f32_i32 v249, v249
    v_fma_f32 v248, v248, v48, v50
    v_fma_f32 v249, v249, v49, v51
    v_cvt_pk_bf16_f32 v234, v248, v249
    v_cvt_f32_i32 v252, v252
    v_cvt_f32_i32 v253, v253
    v_fma_f32 v252, v252, v48, v50
    v_fma_f32 v253, v253, v49, v51
    v_cvt_pk_bf16_f32 v238, v252, v253
    v_lshlrev_b32 v48, 16, v37
    v_and_b32 v49, s97, v37
    v_lshlrev_b32 v50, 16, v39
    v_and_b32 v51, s97, v39
    v_mul_f32 v48, s38, v48
    v_mul_f32 v49, s38, v49
    v_mul_f32_e64 v50, -v50, v48
    v_mul_f32_e64 v51, -v51, v49
    v_cvt_f32_i32 v242, v242
    v_cvt_f32_i32 v243, v243
    v_fma_f32 v242, v242, v48, v50
    v_fma_f32 v243, v243, v49, v51
    v_cvt_pk_bf16_f32 v227, v242, v243
    v_cvt_f32_i32 v246, v246
    v_cvt_f32_i32 v247, v247
    v_fma_f32 v246, v246, v48, v50
    v_fma_f32 v247, v247, v49, v51
    v_cvt_pk_bf16_f32 v231, v246, v247
    v_cvt_f32_i32 v250, v250
    v_cvt_f32_i32 v251, v251
    v_fma_f32 v250, v250, v48, v50
    v_fma_f32 v251, v251, v49, v51
    v_cvt_pk_bf16_f32 v235, v250, v251
    v_cvt_f32_i32 v254, v254
    v_cvt_f32_i32 v255, v255
    v_fma_f32 v254, v254, v48, v50
    v_fma_f32 v255, v255, v49, v51
    v_cvt_pk_bf16_f32 v239, v254, v255
    buffer_store_dwordx4 v[224:227], v11, s[4:7], s33 offen offset:0
    s_mov_b64 exec, s[62:63]
    ds_write_b128 v11, v[224:227] offset:0
    s_mov_b64 exec, -1
    v_xor_b32 v55, 16, v11
    buffer_store_dwordx4 v[228:231], v55, s[4:7], s33 offen offset:768
    s_mov_b64 exec, s[62:63]
    ds_write_b128 v55, v[228:231] offset:768
    s_mov_b64 exec, -1
    v_xor_b32 v54, 32, v11
    buffer_store_dwordx4 v[232:235], v54, s[4:7], s33 offen offset:1536
    s_mov_b64 exec, s[62:63]
    ds_write_b128 v54, v[232:235] offset:1536
    s_mov_b64 exec, -1
    v_xor_b32 v55, 48, v11
    buffer_store_dwordx4 v[236:239], v55, s[4:7], s33 offen offset:2304
    s_mov_b64 exec, s[62:63]
    ds_write_b128 v55, v[236:239] offset:2304
    s_mov_b64 exec, -1
    s_mov_b32 s41, 0
    s_add_u32 m0, s40, 24576
    s_nop 0
    buffer_load_dwordx4 v136, s[8:11], s41 offen nt lds
    s_add_u32 m0, s40, 25600
    s_nop 0
    buffer_load_dwordx4 v137, s[8:11], s41 offen nt lds
    s_add_u32 m0, s40, 26624
    s_nop 0
    buffer_load_dwordx4 v138, s[8:11], s41 offen nt lds
    s_add_u32 m0, s40, 27648
    s_nop 0
    buffer_load_dwordx4 v139, s[8:11], s41 offen nt lds
    s_add_u32 m0, s40, 28672
    s_nop 0
    buffer_load_dwordx4 v140, s[8:11], s41 offen nt lds
    s_add_u32 m0, s40, 29696
    s_waitcnt vmcnt(20)
    buffer_load_dwordx4 v141, s[8:11], s41 offen nt lds
    s_waitcnt vmcnt(14)
    v_lshlrev_b32 v48, 16, v40
    v_and_b32 v49, s97, v40
    v_lshlrev_b32 v50, 16, v42
    v_and_b32 v51, s97, v42
    v_mul_f32_e64 v50, -v50, v48
    v_mul_f32_e64 v51, -v51, v49
    v_cvt_f32_i32 v112, v112
    v_cvt_f32_i32 v116, v116
    v_fma_f32 v112, v112, v48, v50
    v_fma_f32 v116, v116, v49, v51
    v_cvt_f32_i32 v113, v113
    v_cvt_f32_i32 v117, v117
    v_fma_f32 v113, v113, v48, v50
    v_fma_f32 v117, v117, v49, v51
    v_cvt_f32_i32 v114, v114
    v_cvt_f32_i32 v118, v118
    v_fma_f32 v114, v114, v48, v50
    v_fma_f32 v118, v118, v49, v51
    v_cvt_f32_i32 v115, v115
    v_cvt_f32_i32 v119, v119
    v_fma_f32 v115, v115, v48, v50
    v_fma_f32 v119, v119, v49, v51
    v_lshlrev_b32 v48, 16, v41
    v_and_b32 v49, s97, v41
    v_lshlrev_b32 v50, 16, v43
    v_and_b32 v51, s97, v43
    v_mul_f32_e64 v50, -v50, v48
    v_mul_f32_e64 v51, -v51, v49
    v_cvt_f32_i32 v120, v120
    v_cvt_f32_i32 v124, v124
    v_fma_f32 v120, v120, v48, v50
    v_fma_f32 v124, v124, v49, v51
    v_cvt_f32_i32 v121, v121
    v_cvt_f32_i32 v125, v125
    v_fma_f32 v121, v121, v48, v50
    v_fma_f32 v125, v125, v49, v51
    v_cvt_f32_i32 v122, v122
    v_cvt_f32_i32 v126, v126
    v_fma_f32 v122, v122, v48, v50
    v_fma_f32 v126, v126, v49, v51
    v_cvt_f32_i32 v123, v123
    v_cvt_f32_i32 v127, v127
    v_fma_f32 v123, v123, v48, v50
    v_fma_f32 v127, v127, v49, v51
    v_cvt_pk_bf16_f32 v112, v112, v116
    v_cvt_pk_bf16_f32 v116, v113, v117
    v_cvt_pk_bf16_f32 v113, v120, v124
    v_cvt_pk_bf16_f32 v117, v121, v125
    v_cvt_pk_bf16_f32 v120, v114, v118
    v_cvt_pk_bf16_f32 v121, v122, v126
    v_cvt_pk_bf16_f32 v124, v115, v119
    v_cvt_pk_bf16_f32 v125, v123, v127
    s_waitcnt vmcnt(10)
    v_lshlrev_b32 v48, 16, v44
    v_and_b32 v49, s97, v44
    v_lshlrev_b32 v50, 16, v46
    v_and_b32 v51, s97, v46
    v_mul_f32_e64 v50, -v50, v48
    v_mul_f32_e64 v51, -v51, v49
    v_cvt_f32_i32 v80, v80
    v_cvt_f32_i32 v84, v84
    v_fma_f32 v80, v80, v48, v50
    v_fma_f32 v84, v84, v49, v51
    v_cvt_f32_i32 v81, v81
    v_cvt_f32_i32 v85, v85
    v_fma_f32 v81, v81, v48, v50
    v_fma_f32 v85, v85, v49, v51
    v_cvt_f32_i32 v82, v82
    v_cvt_f32_i32 v86, v86
    v_fma_f32 v82, v82, v48, v50
    v_fma_f32 v86, v86, v49, v51
    v_cvt_f32_i32 v83, v83
    v_cvt_f32_i32 v87, v87
    v_fma_f32 v83, v83, v48, v50
    v_fma_f32 v87, v87, v49, v51
    v_lshlrev_b32 v48, 16, v45
    v_and_b32 v49, s97, v45
    v_lshlrev_b32 v50, 16, v47
    v_and_b32 v51, s97, v47
    v_mul_f32_e64 v50, -v50, v48
    v_mul_f32_e64 v51, -v51, v49
    v_cvt_f32_i32 v88, v88
    v_cvt_f32_i32 v92, v92
    v_fma_f32 v88, v88, v48, v50
    v_fma_f32 v92, v92, v49, v51
    v_cvt_f32_i32 v89, v89
    v_cvt_f32_i32 v93, v93
    v_fma_f32 v89, v89, v48, v50
    v_fma_f32 v93, v93, v49, v51
    v_cvt_f32_i32 v90, v90
    v_cvt_f32_i32 v94, v94
    v_fma_f32 v90, v90, v48, v50
    v_fma_f32 v94, v94, v49, v51
    v_cvt_f32_i32 v91, v91
    v_cvt_f32_i32 v95, v95
    v_fma_f32 v91, v91, v48, v50
    v_fma_f32 v95, v95, v49, v51
    v_cvt_pk_bf16_f32 v114, v80, v84
    v_cvt_pk_bf16_f32 v118, v81, v85
    v_cvt_pk_bf16_f32 v115, v88, v92
    v_cvt_pk_bf16_f32 v119, v89, v93
    v_cvt_pk_bf16_f32 v122, v82, v86
    v_cvt_pk_bf16_f32 v123, v90, v94
    v_cvt_pk_bf16_f32 v126, v83, v87
    v_cvt_pk_bf16_f32 v127, v91, v95
    buffer_store_dwordx4 v[112:115], v20, s[4:7], s35 offen offset:0
    buffer_store_dwordx4 v[116:119], v20, s[4:7], s35 offen offset:3072
    buffer_store_dwordx4 v[120:123], v20, s[4:7], s17 offen offset:0
    buffer_store_dwordx4 v[124:127], v20, s[4:7], s17 offen offset:3072
    s_mov_b64 exec, s[62:63]
    ds_write_b128 v20, v[112:115] offset:12288
    ds_write_b128 v20, v[116:119] offset:15360
    ds_write_b128 v20, v[120:123] offset:18432
    ds_write_b128 v20, v[124:127] offset:21504
    s_mov_b64 exec, -1
    buffer_load_dword v0, off, s[88:91], s93 sc1
    s_mov_b32 s41, 6144
    s_add_u32 m0, s40, 0
    s_nop 0
    buffer_load_dwordx4 v136, s[8:11], s41 offen nt lds
    s_add_u32 m0, s40, 1024
    s_nop 0
    buffer_load_dwordx4 v137, s[8:11], s41 offen nt lds
    s_add_u32 m0, s40, 2048
    s_nop 0
    buffer_load_dwordx4 v138, s[8:11], s41 offen nt lds
    s_add_u32 m0, s40, 3072
    s_nop 0
    buffer_load_dwordx4 v139, s[8:11], s41 offen nt lds
    s_add_u32 m0, s40, 4096
    s_nop 0
    buffer_load_dwordx4 v140, s[8:11], s41 offen nt lds
    s_add_u32 m0, s40, 5120
    s_waitcnt vmcnt(15)
    buffer_load_dwordx4 v141, s[8:11], s41 offen nt lds
    s_waitcnt vmcnt(6)
    s_cmp_lg_u32 s25, 0
    s_cbranch_scc1 L_tagdone
    v_readfirstlane_b32 s42, v0
    s_mov_b32 s39, 100
    s_waitcnt lgkmcnt(0)
    s_and_b32 s46, s46, 0xfffffc00
L_tagretry:
    s_cmp_eq_u32 s42, s46
    s_cselect_b32 s42, 0, s42
    s_cmp_lg_u32 s42, 0
    s_cbranch_scc1 L_tagok
    s_sub_u32 s39, s39, 1
    s_cbranch_scc1 L_tagslow
    s_sleep 4
    s_buffer_load_dword s42, s[88:91], s93 glc
    s_waitcnt lgkmcnt(0)
    s_branch L_tagretry
L_tagok:
    s_add_u32 s42, s42, s45
    v_mov_b32 v0, s42
    v_mov_b32 v16, 147456
    ds_write_b32 v16, v0
L_tagdone:
    s_waitcnt lgkmcnt(0)
    s_barrier
    v_add_u32 v0, 1, v0
    buffer_store_dword v0, v13, s[20:23], 0 offen
    buffer_store_dword v0, v13, s[20:23], 0 offen offset:32 sc1
    v_mov_b32 v16, 147456
    ds_read_b32 v17, v16
    s_mov_b32 s88, s60
    s_mov_b32 s89, s61
    s_mov_b32 s90, L_slow-standalone__kv_cache_quant_int4_int2_kv_with_per_channel_or_per_token_scales__prompt_kernel
    s_lshr_b32 s24, s2, 3
    s_mul_i32 s93, s24, 43
    s_lshr_b32 s93, s93, 7
    s_mul_i32 s39, s93, 3
    s_sub_u32 s24, s24, s39
    s_lshl_b32 s24, s24, 10
    s_mul_i32 s93, s93, 12288
    s_add_u32 s93, s93, s24
    ds_read_b128 v[144:147], v2 offset:0
    ds_read_b128 v[148:151], v3 offset:0
    ds_read_b128 v[152:155], v2 offset:6144
    ds_read_b128 v[156:159], v3 offset:6144
    ds_read_b128 v[160:163], v2 offset:128
    ds_read_b128 v[164:167], v3 offset:128
    ds_read_b128 v[168:171], v2 offset:6272
    ds_read_b128 v[172:175], v3 offset:6272
    ds_read_b128 v[176:179], v2 offset:256
    ds_read_b128 v[180:183], v3 offset:256
    ds_read_b128 v[184:187], v2 offset:6400
    ds_read_b128 v[188:191], v3 offset:6400
    s_waitcnt vmcnt(13)
    ds_read_b64 a[192:193], v22 offset:24576
    ds_read_b64 a[194:195], v142 offset:24704
    ds_read_b64 a[196:197], v23 offset:24576
    ds_read_b64 a[198:199], v143 offset:24704
    ds_read_b64 a[200:201], v142 offset:24576
    ds_read_b64 a[202:203], v22 offset:24832
    ds_read_b64 a[204:205], v143 offset:24576
    ds_read_b64 a[206:207], v23 offset:24832
    ds_read_b64 a[208:209], v22 offset:24704
    ds_read_b64 a[210:211], v142 offset:24832
    ds_read_b64 a[212:213], v23 offset:24704
    ds_read_b64 a[214:215], v143 offset:24832
    s_waitcnt lgkmcnt(15)
    v_readfirstlane_b32 s92, v17
    s_add_u32 s92, s92, 1
    s_mov_b32 s41, 12288
    s_add_u32 m0, s40, 49152
    s_nop 0
    buffer_load_dwordx4 v136, s[8:11], s41 offen nt lds
    s_add_u32 m0, s40, 50176
    s_nop 0
    buffer_load_dwordx4 v137, s[8:11], s41 offen nt lds
    s_add_u32 m0, s40, 51200
    s_nop 0
    buffer_load_dwordx4 v138, s[8:11], s41 offen nt lds
    s_waitcnt lgkmcnt(0)
    v_mfma_f32_16x16x32_bf16 v[64:67], v[144:147], a[192:195], 0
    v_mfma_f32_16x16x32_bf16 v[64:67], v[148:151], a[196:199], v[64:67]
    v_mfma_f32_16x16x32_bf16 v[64:67], v[160:163], a[200:203], v[64:67]
    v_mfma_f32_16x16x32_bf16 v[64:67], v[164:167], a[204:207], v[64:67]
    v_mfma_f32_16x16x32_bf16 v[64:67], v[176:179], a[208:211], v[64:67]
    v_mfma_f32_16x16x32_bf16 v[64:67], v[180:183], a[212:215], v[64:67]
    v_mfma_f32_16x16x32_bf16 v[96:99], v[152:155], a[192:195], 0
    v_mfma_f32_16x16x32_bf16 v[96:99], v[156:159], a[196:199], v[96:99]
    v_mfma_f32_16x16x32_bf16 v[96:99], v[168:171], a[200:203], v[96:99]
    v_mfma_f32_16x16x32_bf16 v[96:99], v[172:175], a[204:207], v[96:99]
    v_mfma_f32_16x16x32_bf16 v[96:99], v[184:187], a[208:211], v[96:99]
    v_mfma_f32_16x16x32_bf16 v[96:99], v[188:191], a[212:215], v[96:99]
    s_waitcnt vmcnt(5)
    ds_read_b64 a[216:217], v22 offset:0
    ds_read_b64 a[218:219], v142 offset:128
    ds_read_b64 a[220:221], v23 offset:0
    ds_read_b64 a[222:223], v143 offset:128
    ds_read_b64 a[224:225], v142 offset:0
    ds_read_b64 a[226:227], v22 offset:256
    ds_read_b64 a[228:229], v143 offset:0
    ds_read_b64 a[230:231], v23 offset:256
    ds_read_b64 a[232:233], v22 offset:128
    ds_read_b64 a[234:235], v142 offset:256
    ds_read_b64 a[236:237], v23 offset:128
    ds_read_b64 a[238:239], v143 offset:256
    s_mov_b32 s41, 12288
    s_add_u32 m0, s40, 52224
    s_nop 0
    buffer_load_dwordx4 v139, s[8:11], s41 offen nt lds
    s_add_u32 m0, s40, 53248
    s_nop 0
    buffer_load_dwordx4 v140, s[8:11], s41 offen nt lds
    s_add_u32 m0, s40, 54272
    s_nop 0
    buffer_load_dwordx4 v141, s[8:11], s41 offen nt lds
    s_waitcnt lgkmcnt(0)
    v_mfma_f32_16x16x32_bf16 v[68:71], v[144:147], a[216:219], 0
    v_mfma_f32_16x16x32_bf16 v[68:71], v[148:151], a[220:223], v[68:71]
    v_mfma_f32_16x16x32_bf16 v[68:71], v[160:163], a[224:227], v[68:71]
    v_mfma_f32_16x16x32_bf16 v[68:71], v[164:167], a[228:231], v[68:71]
    v_mfma_f32_16x16x32_bf16 v[68:71], v[176:179], a[232:235], v[68:71]
    v_mfma_f32_16x16x32_bf16 v[68:71], v[180:183], a[236:239], v[68:71]
    v_mfma_f32_16x16x32_bf16 v[100:103], v[152:155], a[216:219], 0
    v_mfma_f32_16x16x32_bf16 v[100:103], v[156:159], a[220:223], v[100:103]
    v_mfma_f32_16x16x32_bf16 v[100:103], v[168:171], a[224:227], v[100:103]
    v_mfma_f32_16x16x32_bf16 v[100:103], v[172:175], a[228:231], v[100:103]
    v_mfma_f32_16x16x32_bf16 v[100:103], v[184:187], a[232:235], v[100:103]
    v_mfma_f32_16x16x32_bf16 v[100:103], v[188:191], a[236:239], v[100:103]
    s_nop 7
    ds_read_b128 v[24:27], v1 offset:0
    ds_read_b128 v[28:31], v1 offset:1024
    ds_read_b128 v[32:35], v1 offset:2048
    ds_read_b128 v[36:39], v1 offset:3072
    s_mov_b32 s41, 18432
    s_add_u32 m0, s40, 24576
    s_nop 0
    buffer_load_dwordx4 v136, s[8:11], s41 offen nt lds
    v_max3_f32 v48, v64, v65, v66
    v_max3_f32 v50, v68, v69, v70
    v_max3_f32 v48, v48, v67, v96
    v_max3_f32 v50, v50, v71, v100
    v_max3_f32 v48, v48, v97, v98
    v_max3_f32 v50, v50, v101, v102
    v_max_f32 v48, v48, v99
    v_max_f32 v50, v50, v103
    v_mov_b32 v49, v48
    v_mov_b32 v51, v50
    s_nop 0
    v_permlane16_swap_b32 v48, v49
    v_permlane16_swap_b32 v50, v51
    s_nop 0
    v_max_f32 v48, v48, v49
    v_max_f32 v50, v50, v51
    v_mov_b32 v49, v48
    v_mov_b32 v51, v50
    s_nop 0
    v_permlane32_swap_b32 v48, v49
    v_permlane32_swap_b32 v50, v51
    s_nop 0
    v_max_f32 v48, v48, v49
    v_max_f32 v50, v50, v51
    v_sub_f32 v128, 0, v48
    v_sub_f32 v129, 0, v48
    v_sub_f32 v130, 0, v48
    v_sub_f32 v131, 0, v48
    v_sub_f32 v132, 0, v50
    v_sub_f32 v133, 0, v50
    s_add_u32 m0, s40, 25600
    s_nop 0
    buffer_load_dwordx4 v137, s[8:11], s41 offen nt lds
    v_sub_f32 v134, 0, v50
    v_sub_f32 v135, 0, v50
    v_add_f32 v64, v64, v128
    v_add_f32 v65, v65, v128
    v_add_f32 v66, v66, v128
    v_add_f32 v67, v67, v128
    v_add_f32 v96, v96, v128
    v_add_f32 v97, v97, v128
    v_add_f32 v98, v98, v128
    v_add_f32 v99, v99, v128
    v_add_f32 v68, v68, v132
    v_add_f32 v69, v69, v132
    v_add_f32 v70, v70, v132
    v_add_f32 v71, v71, v132
    v_add_f32 v100, v100, v132
    v_add_f32 v101, v101, v132
    v_add_f32 v102, v102, v132
    v_add_f32 v103, v103, v132
    v_exp_f32 v16, v64
    v_exp_f32 v17, v65
    v_exp_f32 v18, v66
    v_add_f32 v5, v5, v16
    v_add_f32 v5, v5, v17
    v_exp_f32 v19, v67
    v_cvt_pk_bf16_f32 v64, v16, v17
    v_exp_f32 v16, v96
    v_add_f32 v5, v5, v18
    v_add_f32 v5, v5, v19
    v_exp_f32 v17, v97
    s_add_u32 m0, s40, 26624
    s_nop 0
    buffer_load_dwordx4 v138, s[8:11], s41 offen nt lds
    v_cvt_pk_bf16_f32 v65, v18, v19
    v_exp_f32 v18, v98
    v_add_f32 v5, v5, v16
    v_add_f32 v5, v5, v17
    v_exp_f32 v19, v99
    v_cvt_pk_bf16_f32 v66, v16, v17
    v_exp_f32 v16, v68
    v_add_f32 v5, v5, v18
    v_add_f32 v5, v5, v19
    v_exp_f32 v17, v69
    v_cvt_pk_bf16_f32 v67, v18, v19
    v_exp_f32 v18, v70
    v_add_f32 v6, v6, v16
    v_add_f32 v6, v6, v17
    v_exp_f32 v19, v71
    v_cvt_pk_bf16_f32 v68, v16, v17
    v_exp_f32 v16, v100
    v_add_f32 v6, v6, v18
    v_add_f32 v6, v6, v19
    v_exp_f32 v17, v101
    v_cvt_pk_bf16_f32 v69, v18, v19
    v_exp_f32 v18, v102
    v_add_f32 v6, v6, v16
    v_add_f32 v6, v6, v17
    v_exp_f32 v19, v103
    v_cvt_pk_bf16_f32 v70, v16, v17
    v_add_f32 v6, v6, v18
    v_add_f32 v6, v6, v19
    v_cvt_pk_bf16_f32 v71, v18, v19
    s_buffer_load_dwordx8 s[48:55], s[20:23], s44 glc
    s_waitcnt lgkmcnt(2)
    v_mfma_f32_16x16x32_bf16 a[0:3], v[24:27], v[64:67], 0
    ds_read_b128 v[40:43], v1 offset:4096
    v_mfma_f32_16x16x32_bf16 a[4:7], v[28:31], v[64:67], 0
    v_mfma_f32_16x16x32_bf16 a[48:51], v[24:27], v[68:71], 0
    ds_read_b128 v[44:47], v1 offset:5120
    v_mfma_f32_16x16x32_bf16 a[52:55], v[28:31], v[68:71], 0
    s_waitcnt lgkmcnt(2)
    v_mfma_f32_16x16x32_bf16 a[8:11], v[32:35], v[64:67], 0
    ds_read_b128 v[24:27], v1 offset:6144
    v_mfma_f32_16x16x32_bf16 a[12:15], v[36:39], v[64:67], 0
    v_mfma_f32_16x16x32_bf16 a[56:59], v[32:35], v[68:71], 0
    ds_read_b128 v[28:31], v1 offset:7168
    v_mfma_f32_16x16x32_bf16 a[60:63], v[36:39], v[68:71], 0
    s_waitcnt lgkmcnt(2)
    v_mfma_f32_16x16x32_bf16 a[16:19], v[40:43], v[64:67], 0
    ds_read_b128 v[32:35], v1 offset:8192
    v_mfma_f32_16x16x32_bf16 a[20:23], v[44:47], v[64:67], 0
    v_mfma_f32_16x16x32_bf16 a[64:67], v[40:43], v[68:71], 0
    ds_read_b128 v[36:39], v1 offset:9216
    v_mfma_f32_16x16x32_bf16 a[68:71], v[44:47], v[68:71], 0
    s_waitcnt lgkmcnt(2)
    v_mfma_f32_16x16x32_bf16 a[24:27], v[24:27], v[64:67], 0
    ds_read_b128 v[40:43], v1 offset:10240
    v_mfma_f32_16x16x32_bf16 a[28:31], v[28:31], v[64:67], 0
    v_mfma_f32_16x16x32_bf16 a[72:75], v[24:27], v[68:71], 0
    ds_read_b128 v[44:47], v1 offset:11264
    v_mfma_f32_16x16x32_bf16 a[76:79], v[28:31], v[68:71], 0
    s_waitcnt lgkmcnt(2)
    v_mfma_f32_16x16x32_bf16 a[32:35], v[32:35], v[64:67], 0
    v_mfma_f32_16x16x32_bf16 a[36:39], v[36:39], v[64:67], 0
    v_mfma_f32_16x16x32_bf16 a[80:83], v[32:35], v[68:71], 0
    v_mfma_f32_16x16x32_bf16 a[84:87], v[36:39], v[68:71], 0
    s_waitcnt lgkmcnt(0)
    v_mfma_f32_16x16x32_bf16 a[40:43], v[40:43], v[64:67], 0
    v_mfma_f32_16x16x32_bf16 a[44:47], v[44:47], v[64:67], 0
    v_mfma_f32_16x16x32_bf16 a[88:91], v[40:43], v[68:71], 0
    v_mfma_f32_16x16x32_bf16 a[92:95], v[44:47], v[68:71], 0
    s_waitcnt lgkmcnt(0)
    s_sub_u32 s48, s48, s92
    s_sub_u32 s49, s49, s92
    s_sub_u32 s50, s50, s92
    s_sub_u32 s51, s51, s92
    s_sub_u32 s52, s52, s92
    s_sub_u32 s53, s53, s92
    s_sub_u32 s54, s54, s92
    s_sub_u32 s55, s55, s92
    s_max_u32 s48, s48, s49
    s_max_u32 s48, s48, s50
    s_max_u32 s48, s48, s51
    s_max_u32 s48, s48, s52
    s_max_u32 s48, s48, s53
    s_max_u32 s48, s48, s54
    s_max_u32 s48, s48, s55
    s_cmp_ge_u32 s48, 16
    s_cbranch_scc1 L_pollslow0
L_pollok0:
    s_add_u32 s92, s92, 1
    s_mov_b32 s44, 32
    s_mov_b32 m0, s26
    s_nop 0
    buffer_load_dwordx4 v4, s[4:7], s32 offen offset:0 sc1 lds
    buffer_load_dwordx4 v4, s[4:7], s32 offen offset:1024 sc1 lds
    buffer_load_dwordx4 v4, s[4:7], s32 offen offset:2048 sc1 lds
    s_add_u32 s32, s32, 24576
    s_sub_u32 s57, s32, 196608
    s_min_u32 s32, s32, s57
    s_add_u32 s26, s26, 36864
    s_sub_u32 s57, s26, 147456
    s_min_u32 s26, s26, s57
    s_mov_b32 m0, s26
    s_waitcnt vmcnt(11)
    buffer_load_dwordx4 v4, s[4:7], s32 offen offset:0 sc1 lds
    s_waitcnt vmcnt(11)
    buffer_load_dwordx4 v4, s[4:7], s32 offen offset:1024 sc1 lds
    s_waitcnt vmcnt(11)
    buffer_load_dwordx4 v4, s[4:7], s32 offen offset:2048 sc1 lds
    s_add_u32 s32, s32, 24576
    s_sub_u32 s57, s32, 196608
    s_min_u32 s32, s32, s57
    s_add_u32 s26, s26, 12288
    s_mov_b32 m0, s26
    s_waitcnt vmcnt(11)
    buffer_load_dwordx4 v4, s[4:7], s32 offen offset:0 sc1 lds
    s_waitcnt vmcnt(11)
    buffer_load_dwordx4 v4, s[4:7], s32 offen offset:1024 sc1 lds
    s_waitcnt vmcnt(11)
    buffer_load_dwordx4 v4, s[4:7], s32 offen offset:2048 sc1 lds
    s_add_u32 s32, s32, 24576
    s_sub_u32 s57, s32, 196608
    s_min_u32 s32, s32, s57
    s_add_u32 s26, s26, 36864
    s_sub_u32 s57, s26, 147456
    s_min_u32 s26, s26, s57
    s_mov_b32 m0, s56
    s_waitcnt vmcnt(11)
    buffer_load_dwordx4 v4, s[4:7], s27 offen offset:0 sc1 lds
    s_waitcnt vmcnt(11)
    buffer_load_dwordx4 v4, s[4:7], s27 offen offset:1024 sc1 lds
    s_waitcnt vmcnt(11)
    buffer_load_dwordx4 v4, s[4:7], s27 offen offset:2048 sc1 lds
    s_add_u32 s27, s27, 24576
    s_sub_u32 s58, s27, 196608
    s_min_u32 s27, s27, s58
    s_add_u32 s56, s56, 36864
    s_sub_u32 s58, s56, 147456
    s_min_u32 s56, s56, s58
    s_add_u32 s33, s33, 196608
    s_add_u32 s34, s34, 196608
    s_add_u32 s36, s36, 1536
    s_add_u32 s35, s35, 196608
    s_add_u32 s16, s16, 196608
    s_add_u32 s17, s17, 196608
    s_add_u32 s37, s37, 512
    s_waitcnt vmcnt(9)
    s_barrier
    ds_read_b128 v[24:27], v2 offset:12288
    ds_read_b128 v[28:31], v3 offset:12288
    ds_read_b128 v[32:35], v2 offset:18432
    ds_read_b128 v[36:39], v3 offset:18432
    s_waitcnt lgkmcnt(2)
    v_mfma_f32_16x16x32_bf16 v[72:75], v[24:27], a[192:195], v[128:131]
    s_mov_b32 m0, s56
    ds_read_b128 v[40:43], v2 offset:12416
    v_mfma_f32_16x16x32_bf16 v[72:75], v[28:31], a[196:199], v[72:75]
    buffer_load_dwordx4 v4, s[4:7], s27 offen offset:0 sc1 lds
    v_mfma_f32_16x16x32_bf16 v[76:79], v[24:27], a[216:219], v[132:135]
    ds_read_b128 v[44:47], v3 offset:12416
    v_mfma_f32_16x16x32_bf16 v[76:79], v[28:31], a[220:223], v[76:79]
    s_waitcnt lgkmcnt(2)
    buffer_load_dwordx4 v4, s[4:7], s27 offen offset:1024 sc1 lds
    v_mfma_f32_16x16x32_bf16 v[104:107], v[32:35], a[192:195], v[128:131]
    ds_read_b128 v[24:27], v2 offset:18560
    v_mfma_f32_16x16x32_bf16 v[104:107], v[36:39], a[196:199], v[104:107]
    buffer_load_dwordx4 v4, s[4:7], s27 offen offset:2048 sc1 lds
    v_mfma_f32_16x16x32_bf16 v[108:111], v[32:35], a[216:219], v[132:135]
    s_add_u32 s27, s27, 24576
    ds_read_b128 v[28:31], v3 offset:18560
    v_mfma_f32_16x16x32_bf16 v[108:111], v[36:39], a[220:223], v[108:111]
    s_waitcnt lgkmcnt(2)
    s_sub_u32 s58, s27, 196608
    v_mfma_f32_16x16x32_bf16 v[72:75], v[40:43], a[200:203], v[72:75]
    ds_read_b128 v[32:35], v2 offset:12544
    v_mfma_f32_16x16x32_bf16 v[72:75], v[44:47], a[204:207], v[72:75]
    s_min_u32 s27, s27, s58
    v_mfma_f32_16x16x32_bf16 v[76:79], v[40:43], a[224:227], v[76:79]
    s_add_u32 s56, s56, 12288
    ds_read_b128 v[36:39], v3 offset:12544
    v_mfma_f32_16x16x32_bf16 v[76:79], v[44:47], a[228:231], v[76:79]
    s_waitcnt lgkmcnt(2)
    s_mov_b32 m0, s56
    v_mfma_f32_16x16x32_bf16 v[104:107], v[24:27], a[200:203], v[104:107]
    ds_read_b128 v[40:43], v2 offset:18688
    v_mfma_f32_16x16x32_bf16 v[104:107], v[28:31], a[204:207], v[104:107]
    s_waitcnt vmcnt(6)
    buffer_load_dwordx4 v4, s[4:7], s27 offen offset:0 sc1 lds
    v_mfma_f32_16x16x32_bf16 v[108:111], v[24:27], a[224:227], v[108:111]
    ds_read_b128 v[44:47], v3 offset:18688
    v_mfma_f32_16x16x32_bf16 v[108:111], v[28:31], a[228:231], v[108:111]
    s_waitcnt lgkmcnt(2)
    s_barrier
    v_add_u32 v2, 49152, v2
    v_add_u32 v3, 49152, v3
    v_mfma_f32_16x16x32_bf16 v[72:75], v[32:35], a[208:211], v[72:75]
    ds_read_b128 v[24:27], v2 offset:0
    v_mfma_f32_16x16x32_bf16 v[72:75], v[36:39], a[212:215], v[72:75]
    buffer_load_dwordx4 v4, s[4:7], s27 offen offset:1024 sc1 lds
    v_mfma_f32_16x16x32_bf16 v[76:79], v[32:35], a[232:235], v[76:79]
    ds_read_b128 v[28:31], v3 offset:0
    v_mfma_f32_16x16x32_bf16 v[76:79], v[36:39], a[236:239], v[76:79]
    s_waitcnt lgkmcnt(2)
    buffer_load_dwordx4 v4, s[4:7], s27 offen offset:2048 sc1 lds
    v_mfma_f32_16x16x32_bf16 v[104:107], v[40:43], a[208:211], v[104:107]
    ds_read_b128 v[32:35], v2 offset:6144
    v_mfma_f32_16x16x32_bf16 v[104:107], v[44:47], a[212:215], v[104:107]
    v_mfma_f32_16x16x32_bf16 v[108:111], v[40:43], a[232:235], v[108:111]
    s_add_u32 s27, s27, 24576
    ds_read_b128 v[36:39], v3 offset:6144
    s_sub_u32 s58, s27, 196608
    v_mfma_f32_16x16x32_bf16 v[108:111], v[44:47], a[236:239], v[108:111]
    s_waitcnt lgkmcnt(2)
    s_min_u32 s27, s27, s58
    s_add_u32 s56, s56, 36864
    s_sub_u32 s58, s56, 147456
    s_min_u32 s56, s56, s58
    v_mfma_f32_16x16x32_bf16 v[80:83], v[24:27], a[192:195], v[128:131]
    s_mov_b32 s41, 18432
    ds_read_b128 v[40:43], v2 offset:128
    s_add_u32 m0, s40, 27648
    v_mfma_f32_16x16x32_bf16 v[80:83], v[28:31], a[196:199], v[80:83]
    v_mfma_f32_16x16x32_bf16 v[84:87], v[24:27], a[216:219], v[132:135]
    ds_read_b128 v[44:47], v3 offset:128
    v_mfma_f32_16x16x32_bf16 v[84:87], v[28:31], a[220:223], v[84:87]
    s_waitcnt lgkmcnt(2)
    buffer_load_dwordx4 v139, s[8:11], s41 offen nt lds
    v_mfma_f32_16x16x32_bf16 v[112:115], v[32:35], a[192:195], v[128:131]
    ds_read_b128 v[24:27], v2 offset:6272
    v_mfma_f32_16x16x32_bf16 v[112:115], v[36:39], a[196:199], v[112:115]
    v_exp_f32 v16, v72
    v_mfma_f32_16x16x32_bf16 v[116:119], v[32:35], a[216:219], v[132:135]
    s_add_u32 m0, s40, 28672
    ds_read_b128 v[28:31], v3 offset:6272
    v_mfma_f32_16x16x32_bf16 v[116:119], v[36:39], a[220:223], v[116:119]
    s_waitcnt lgkmcnt(2)
    v_exp_f32 v17, v73
    v_mfma_f32_16x16x32_bf16 v[80:83], v[40:43], a[200:203], v[80:83]
    ds_read_b128 v[32:35], v2 offset:256
    v_mfma_f32_16x16x32_bf16 v[80:83], v[44:47], a[204:207], v[80:83]
    buffer_load_dwordx4 v140, s[8:11], s41 offen nt lds
    v_mfma_f32_16x16x32_bf16 v[84:87], v[40:43], a[224:227], v[84:87]
    ds_read_b128 v[36:39], v3 offset:256
    v_mfma_f32_16x16x32_bf16 v[84:87], v[44:47], a[228:231], v[84:87]
    s_waitcnt lgkmcnt(2)
    v_exp_f32 v18, v74
    v_mfma_f32_16x16x32_bf16 v[112:115], v[24:27], a[200:203], v[112:115]
    ds_read_b128 v[40:43], v2 offset:6400
    v_add_f32 v5, v5, v16
    v_mfma_f32_16x16x32_bf16 v[112:115], v[28:31], a[204:207], v[112:115]
    s_add_u32 m0, s40, 29696
    v_add_f32 v5, v5, v17
    v_mfma_f32_16x16x32_bf16 v[116:119], v[24:27], a[224:227], v[116:119]
    ds_read_b128 v[44:47], v3 offset:6400
    v_mfma_f32_16x16x32_bf16 v[116:119], v[28:31], a[228:231], v[116:119]
    s_waitcnt lgkmcnt(2)
    v_exp_f32 v19, v75
    v_cvt_pk_bf16_f32 v72, v16, v17
    v_mfma_f32_16x16x32_bf16 v[80:83], v[32:35], a[208:211], v[80:83]
    ds_read_b128 v[24:27], v2 offset:12288
    v_mfma_f32_16x16x32_bf16 v[80:83], v[36:39], a[212:215], v[80:83]
    buffer_load_dwordx4 v141, s[8:11], s41 offen nt lds
    v_mfma_f32_16x16x32_bf16 v[84:87], v[32:35], a[232:235], v[84:87]
    ds_read_b128 v[28:31], v3 offset:12288
    v_mfma_f32_16x16x32_bf16 v[84:87], v[36:39], a[236:239], v[84:87]
    s_waitcnt lgkmcnt(2)
    v_exp_f32 v16, v104
    v_add_f32 v5, v5, v18
    v_mfma_f32_16x16x32_bf16 v[112:115], v[40:43], a[208:211], v[112:115]
    ds_read_b128 v[32:35], v2 offset:18432
    v_add_f32 v5, v5, v19
    v_mfma_f32_16x16x32_bf16 v[112:115], v[44:47], a[212:215], v[112:115]
    v_exp_f32 v17, v105
    v_cvt_pk_bf16_f32 v73, v18, v19
    v_mfma_f32_16x16x32_bf16 v[116:119], v[40:43], a[232:235], v[116:119]
    ds_read_b128 v[36:39], v3 offset:18432
    v_mfma_f32_16x16x32_bf16 v[116:119], v[44:47], a[236:239], v[116:119]
    s_waitcnt lgkmcnt(2)
    v_exp_f32 v18, v106
    v_add_f32 v5, v5, v16
    v_mfma_f32_16x16x32_bf16 v[88:91], v[24:27], a[192:195], v[128:131]
    ds_read_b128 v[40:43], v2 offset:12416
    v_add_f32 v5, v5, v17
    v_mfma_f32_16x16x32_bf16 v[88:91], v[28:31], a[196:199], v[88:91]
    s_waitcnt vmcnt(11)
    buffer_load_dwordx2 v[56:57], v10, s[72:75], s36 offen offset:0
    v_mfma_f32_16x16x32_bf16 v[92:95], v[24:27], a[216:219], v[132:135]
    ds_read_b128 v[44:47], v3 offset:12416
    v_mfma_f32_16x16x32_bf16 v[92:95], v[28:31], a[220:223], v[92:95]
    s_waitcnt lgkmcnt(2)
    v_exp_f32 v19, v107
    v_cvt_pk_bf16_f32 v74, v16, v17
    v_mfma_f32_16x16x32_bf16 v[120:123], v[32:35], a[192:195], v[128:131]
    ds_read_b128 v[24:27], v2 offset:18560
    v_mfma_f32_16x16x32_bf16 v[120:123], v[36:39], a[196:199], v[120:123]
    buffer_load_dwordx2 v[58:59], v10, s[76:79], s36 offen offset:0
    v_mfma_f32_16x16x32_bf16 v[124:127], v[32:35], a[216:219], v[132:135]
    ds_read_b128 v[28:31], v3 offset:18560
    v_mfma_f32_16x16x32_bf16 v[124:127], v[36:39], a[220:223], v[124:127]
    s_waitcnt lgkmcnt(2)
    v_exp_f32 v16, v76
    v_add_f32 v5, v5, v18
    v_mfma_f32_16x16x32_bf16 v[88:91], v[40:43], a[200:203], v[88:91]
    ds_read_b128 v[32:35], v2 offset:12544
    v_add_f32 v5, v5, v19
    v_mfma_f32_16x16x32_bf16 v[88:91], v[44:47], a[204:207], v[88:91]
    s_waitcnt vmcnt(12)
    buffer_load_dwordx4 v[224:227], v9, s[64:67], s33 offen offset:0 nt
    v_mfma_f32_16x16x32_bf16 v[92:95], v[40:43], a[224:227], v[92:95]
    ds_read_b128 v[36:39], v3 offset:12544
    v_mfma_f32_16x16x32_bf16 v[92:95], v[44:47], a[228:231], v[92:95]
    s_waitcnt lgkmcnt(2)
    v_exp_f32 v17, v77
    v_cvt_pk_bf16_f32 v75, v18, v19
    v_mfma_f32_16x16x32_bf16 v[120:123], v[24:27], a[200:203], v[120:123]
    ds_read_b128 v[40:43], v2 offset:18688
    v_mfma_f32_16x16x32_bf16 v[120:123], v[28:31], a[204:207], v[120:123]
    s_waitcnt vmcnt(6)
    buffer_load_dwordx4 v[228:231], v9, s[64:67], s33 offen offset:1536 nt
    v_mfma_f32_16x16x32_bf16 v[124:127], v[24:27], a[224:227], v[124:127]
    ds_read_b128 v[44:47], v3 offset:18688
    v_mfma_f32_16x16x32_bf16 v[124:127], v[28:31], a[228:231], v[124:127]
    s_waitcnt lgkmcnt(2)
    s_barrier
    v_mfma_f32_16x16x32_bf16 v[88:91], v[32:35], a[208:211], v[88:91]
    ds_read_b128 v[24:27], v1 offset:12288
    v_mfma_f32_16x16x32_bf16 v[88:91], v[36:39], a[212:215], v[88:91]
    buffer_load_dwordx4 v[232:235], v9, s[64:67], s34 offen offset:0 nt
    v_mfma_f32_16x16x32_bf16 v[92:95], v[32:35], a[232:235], v[92:95]
    ds_read_b128 v[28:31], v1 offset:13312
    v_mfma_f32_16x16x32_bf16 v[92:95], v[36:39], a[236:239], v[92:95]
    s_waitcnt lgkmcnt(2)
    v_exp_f32 v18, v78
    v_add_f32 v6, v6, v16
    v_mfma_f32_16x16x32_bf16 v[120:123], v[40:43], a[208:211], v[120:123]
    ds_read_b128 v[32:35], v1 offset:14336
    v_add_f32 v6, v6, v17
    v_mfma_f32_16x16x32_bf16 v[120:123], v[44:47], a[212:215], v[120:123]
    buffer_load_dwordx4 v[236:239], v9, s[64:67], s34 offen offset:1536 nt
    v_mfma_f32_16x16x32_bf16 v[124:127], v[40:43], a[232:235], v[124:127]
    ds_read_b128 v[36:39], v1 offset:15360
    v_mfma_f32_16x16x32_bf16 v[124:127], v[44:47], a[236:239], v[124:127]
    s_waitcnt lgkmcnt(2)
    v_exp_f32 v19, v79
    v_cvt_pk_bf16_f32 v76, v16, v17
    v_exp_f32 v16, v108
    v_add_f32 v6, v6, v18
    v_add_f32 v6, v6, v19
    v_exp_f32 v17, v109
    v_cvt_pk_bf16_f32 v77, v18, v19
    v_exp_f32 v18, v110
    v_add_f32 v6, v6, v16
    v_add_f32 v6, v6, v17
    v_exp_f32 v19, v111
    v_cvt_pk_bf16_f32 v78, v16, v17
    v_add_f32 v6, v6, v18
    v_add_f32 v6, v6, v19
    v_cvt_pk_bf16_f32 v79, v18, v19
    v_mfma_f32_16x16x32_bf16 a[0:3], v[24:27], v[72:75], a[0:3]
    ds_read_b128 v[40:43], v1 offset:16384
    v_mfma_f32_16x16x32_bf16 a[4:7], v[28:31], v[72:75], a[4:7]
    buffer_load_dwordx2 v[60:61], v10, s[72:75], s36 offen offset:192
    v_mfma_f32_16x16x32_bf16 a[48:51], v[24:27], v[76:79], a[48:51]
    ds_read_b128 v[44:47], v1 offset:17408
    v_mfma_f32_16x16x32_bf16 a[52:55], v[28:31], v[76:79], a[52:55]
    s_waitcnt lgkmcnt(2)
    v_exp_f32 v16, v80
    v_mfma_f32_16x16x32_bf16 a[8:11], v[32:35], v[72:75], a[8:11]
    ds_read_b128 v[24:27], v1 offset:18432
    v_mfma_f32_16x16x32_bf16 a[12:15], v[36:39], v[72:75], a[12:15]
    buffer_load_dwordx2 v[62:63], v10, s[76:79], s36 offen offset:192
    v_mfma_f32_16x16x32_bf16 a[56:59], v[32:35], v[76:79], a[56:59]
    ds_read_b128 v[28:31], v1 offset:19456
    v_mfma_f32_16x16x32_bf16 a[60:63], v[36:39], v[76:79], a[60:63]
    s_waitcnt lgkmcnt(2)
    v_exp_f32 v17, v81
    v_mfma_f32_16x16x32_bf16 a[16:19], v[40:43], v[72:75], a[16:19]
    ds_read_b128 v[32:35], v1 offset:20480
    v_mfma_f32_16x16x32_bf16 a[20:23], v[44:47], v[72:75], a[20:23]
    buffer_load_dwordx4 v[240:243], v9, s[64:67], s33 offen offset:384 nt
    v_mfma_f32_16x16x32_bf16 a[64:67], v[40:43], v[76:79], a[64:67]
    ds_read_b128 v[36:39], v1 offset:21504
    v_mfma_f32_16x16x32_bf16 a[68:71], v[44:47], v[76:79], a[68:71]
    s_waitcnt lgkmcnt(2)
    v_exp_f32 v18, v82
    v_add_f32 v5, v5, v16
    v_mfma_f32_16x16x32_bf16 a[24:27], v[24:27], v[72:75], a[24:27]
    ds_read_b128 v[40:43], v1 offset:22528
    v_add_f32 v5, v5, v17
    v_mfma_f32_16x16x32_bf16 a[28:31], v[28:31], v[72:75], a[28:31]
    buffer_load_dwordx4 v[244:247], v9, s[64:67], s33 offen offset:1920 nt
    v_mfma_f32_16x16x32_bf16 a[72:75], v[24:27], v[76:79], a[72:75]
    ds_read_b128 v[44:47], v1 offset:23552
    v_mfma_f32_16x16x32_bf16 a[76:79], v[28:31], v[76:79], a[76:79]
    s_waitcnt lgkmcnt(2)
    v_add_u32 v1, 49152, v1
    v_exp_f32 v19, v83
    v_mfma_f32_16x16x32_bf16 a[32:35], v[32:35], v[72:75], a[32:35]
    ds_read_b128 v[24:27], v1 offset:0
    v_cvt_pk_bf16_f32 v80, v16, v17
    v_mfma_f32_16x16x32_bf16 a[36:39], v[36:39], v[72:75], a[36:39]
    buffer_load_dwordx4 v[248:251], v9, s[64:67], s34 offen offset:384 nt
    v_mfma_f32_16x16x32_bf16 a[80:83], v[32:35], v[76:79], a[80:83]
    ds_read_b128 v[28:31], v1 offset:1024
    v_mfma_f32_16x16x32_bf16 a[84:87], v[36:39], v[76:79], a[84:87]
    s_waitcnt lgkmcnt(2)
    v_exp_f32 v16, v112
    v_add_f32 v5, v5, v18
    v_mfma_f32_16x16x32_bf16 a[40:43], v[40:43], v[72:75], a[40:43]
    ds_read_b128 v[32:35], v1 offset:2048
    v_add_f32 v5, v5, v19
    v_mfma_f32_16x16x32_bf16 a[44:47], v[44:47], v[72:75], a[44:47]
    buffer_load_dwordx4 v[252:255], v9, s[64:67], s34 offen offset:1920 nt
    v_mfma_f32_16x16x32_bf16 a[88:91], v[40:43], v[76:79], a[88:91]
    ds_read_b128 v[36:39], v1 offset:3072
    v_mfma_f32_16x16x32_bf16 a[92:95], v[44:47], v[76:79], a[92:95]
    s_waitcnt lgkmcnt(2)
    v_exp_f32 v17, v113
    v_cvt_pk_bf16_f32 v81, v18, v19
    v_exp_f32 v18, v114
    v_add_f32 v5, v5, v16
    v_add_f32 v5, v5, v17
    v_exp_f32 v19, v115
    v_cvt_pk_bf16_f32 v82, v16, v17
    v_exp_f32 v16, v84
    v_add_f32 v5, v5, v18
    v_add_f32 v5, v5, v19
    v_exp_f32 v17, v85
    v_cvt_pk_bf16_f32 v83, v18, v19
    v_exp_f32 v18, v86
    v_add_f32 v6, v6, v16
    v_add_f32 v6, v6, v17
    v_exp_f32 v19, v87
    v_cvt_pk_bf16_f32 v84, v16, v17
    v_exp_f32 v16, v116
    v_add_f32 v6, v6, v18
    v_add_f32 v6, v6, v19
    v_exp_f32 v17, v117
    v_cvt_pk_bf16_f32 v85, v18, v19
    v_exp_f32 v18, v118
    v_add_f32 v6, v6, v16
    v_add_f32 v6, v6, v17
    v_exp_f32 v19, v119
    v_cvt_pk_bf16_f32 v86, v16, v17
    v_add_f32 v6, v6, v18
    v_add_f32 v6, v6, v19
    v_cvt_pk_bf16_f32 v87, v18, v19
    v_mfma_f32_16x16x32_bf16 a[0:3], v[24:27], v[80:83], a[0:3]
    ds_read_b128 v[40:43], v1 offset:4096
    v_mfma_f32_16x16x32_bf16 a[4:7], v[28:31], v[80:83], a[4:7]
    buffer_load_dwordx4 v[144:147], v12, s[68:71], s35 offen offset:0 nt
    v_mfma_f32_16x16x32_bf16 a[48:51], v[24:27], v[84:87], a[48:51]
    ds_read_b128 v[44:47], v1 offset:5120
    v_mfma_f32_16x16x32_bf16 a[52:55], v[28:31], v[84:87], a[52:55]
    s_waitcnt lgkmcnt(2)
    v_exp_f32 v16, v88
    v_mfma_f32_16x16x32_bf16 a[8:11], v[32:35], v[80:83], a[8:11]
    ds_read_b128 v[24:27], v1 offset:6144
    v_mfma_f32_16x16x32_bf16 a[12:15], v[36:39], v[80:83], a[12:15]
    buffer_load_dwordx4 v[148:151], v12, s[68:71], s35 offen offset:768 nt
    v_mfma_f32_16x16x32_bf16 a[56:59], v[32:35], v[84:87], a[56:59]
    ds_read_b128 v[28:31], v1 offset:7168
    v_mfma_f32_16x16x32_bf16 a[60:63], v[36:39], v[84:87], a[60:63]
    s_waitcnt lgkmcnt(2)
    v_exp_f32 v17, v89
    v_mfma_f32_16x16x32_bf16 a[16:19], v[40:43], v[80:83], a[16:19]
    ds_read_b128 v[32:35], v1 offset:8192
    v_mfma_f32_16x16x32_bf16 a[20:23], v[44:47], v[80:83], a[20:23]
    v_exp_f32 v18, v90
    v_add_f32 v5, v5, v16
    v_mfma_f32_16x16x32_bf16 a[64:67], v[40:43], v[84:87], a[64:67]
    ds_read_b128 v[36:39], v1 offset:9216
    v_add_f32 v5, v5, v17
    v_mfma_f32_16x16x32_bf16 a[68:71], v[44:47], v[84:87], a[68:71]
    s_waitcnt lgkmcnt(2)
    s_waitcnt vmcnt(16)
    buffer_load_dwordx4 v[152:155], v12, s[68:71], s35 offen offset:1536 nt
    v_mfma_f32_16x16x32_bf16 a[24:27], v[24:27], v[80:83], a[24:27]
    ds_read_b128 v[40:43], v1 offset:10240
    v_mfma_f32_16x16x32_bf16 a[28:31], v[28:31], v[80:83], a[28:31]
    v_exp_f32 v19, v91
    v_cvt_pk_bf16_f32 v88, v16, v17
    v_mfma_f32_16x16x32_bf16 a[72:75], v[24:27], v[84:87], a[72:75]
    ds_read_b128 v[44:47], v1 offset:11264
    v_mfma_f32_16x16x32_bf16 a[76:79], v[28:31], v[84:87], a[76:79]
    s_waitcnt lgkmcnt(2)
    v_exp_f32 v16, v120
    v_add_f32 v5, v5, v18
    v_mfma_f32_16x16x32_bf16 a[32:35], v[32:35], v[80:83], a[32:35]
    s_waitcnt vmcnt(39)
    ds_read_b128 v[24:27], v1 offset:12288
    v_add_f32 v5, v5, v19
    v_mfma_f32_16x16x32_bf16 a[36:39], v[36:39], v[80:83], a[36:39]
    v_exp_f32 v17, v121
    v_cvt_pk_bf16_f32 v89, v18, v19
    v_mfma_f32_16x16x32_bf16 a[80:83], v[32:35], v[84:87], a[80:83]
    ds_read_b128 v[28:31], v1 offset:13312
    ds_read_b64 a[240:241], v22 offset:49152
    v_mfma_f32_16x16x32_bf16 a[84:87], v[36:39], v[84:87], a[84:87]
    s_waitcnt lgkmcnt(3)
    s_waitcnt vmcnt(16)
    buffer_load_dwordx4 v[156:159], v12, s[68:71], s35 offen offset:2304 nt
    v_mfma_f32_16x16x32_bf16 a[40:43], v[40:43], v[80:83], a[40:43]
    ds_read_b128 v[32:35], v1 offset:14336
    ds_read_b64 a[242:243], v142 offset:49280
    v_mfma_f32_16x16x32_bf16 a[44:47], v[44:47], v[80:83], a[44:47]
    v_exp_f32 v18, v122
    v_add_f32 v5, v5, v16
    v_add_f32 v5, v5, v17
    v_exp_f32 v19, v123
    v_cvt_pk_bf16_f32 v90, v16, v17
    v_exp_f32 v16, v92
    v_add_f32 v5, v5, v18
    v_add_f32 v5, v5, v19
    v_exp_f32 v17, v93
    v_cvt_pk_bf16_f32 v91, v18, v19
    v_exp_f32 v18, v94
    v_add_f32 v6, v6, v16
    v_add_f32 v6, v6, v17
    v_exp_f32 v19, v95
    v_cvt_pk_bf16_f32 v92, v16, v17
    v_exp_f32 v16, v124
    v_add_f32 v6, v6, v18
    v_add_f32 v6, v6, v19
    v_exp_f32 v17, v125
    v_cvt_pk_bf16_f32 v93, v18, v19
    v_exp_f32 v18, v126
    v_add_f32 v6, v6, v16
    v_add_f32 v6, v6, v17
    v_exp_f32 v19, v127
    v_cvt_pk_bf16_f32 v94, v16, v17
    v_add_f32 v6, v6, v18
    v_add_f32 v6, v6, v19
    v_cvt_pk_bf16_f32 v95, v18, v19
    v_mfma_f32_16x16x32_bf16 a[88:91], v[40:43], v[84:87], a[88:91]
    ds_read_b128 v[36:39], v1 offset:15360
    ds_read_b64 a[244:245], v23 offset:49152
    v_mfma_f32_16x16x32_bf16 a[92:95], v[44:47], v[84:87], a[92:95]
    s_waitcnt lgkmcnt(5)
    ds_read_b64 a[246:247], v143 offset:49280
    ds_read_b64 a[248:249], v142 offset:49152
    v_mfma_f32_16x16x32_bf16 a[0:3], v[24:27], v[88:91], a[0:3]
    ds_read_b128 v[40:43], v1 offset:16384
    ds_read_b64 a[250:251], v22 offset:49408
    v_mfma_f32_16x16x32_bf16 a[4:7], v[28:31], v[88:91], a[4:7]
    ds_read_b64 a[252:253], v143 offset:49152
    ds_read_b64 a[254:255], v23 offset:49408
    v_mfma_f32_16x16x32_bf16 a[48:51], v[24:27], v[92:95], a[48:51]
    ds_read_b128 v[44:47], v1 offset:17408
    ds_read_b64 v[192:193], v22 offset:49280
    v_mfma_f32_16x16x32_bf16 a[52:55], v[28:31], v[92:95], a[52:55]
    s_waitcnt lgkmcnt(9)
    ds_read_b64 v[194:195], v142 offset:49408
    ds_read_b64 v[196:197], v23 offset:49280
    v_mfma_f32_16x16x32_bf16 a[8:11], v[32:35], v[88:91], a[8:11]
    ds_read_b128 v[24:27], v1 offset:18432
    ds_read_b64 v[198:199], v143 offset:49408
    v_mfma_f32_16x16x32_bf16 a[12:15], v[36:39], v[88:91], a[12:15]
    s_waitcnt vmcnt(16)
    v_mfma_f32_16x16x32_bf16 a[56:59], v[32:35], v[92:95], a[56:59]
    ds_read_b128 v[28:31], v1 offset:19456
    ds_read_b64 v[200:201], v22 offset:24576
    v_mfma_f32_16x16x32_bf16 a[60:63], v[36:39], v[92:95], a[60:63]
    s_waitcnt lgkmcnt(7)
    v_mfma_f32_16x16x32_bf16 a[16:19], v[40:43], v[88:91], a[16:19]
    ds_read_b128 v[32:35], v1 offset:20480
    ds_read_b64 v[202:203], v142 offset:24704
    v_mfma_f32_16x16x32_bf16 a[20:23], v[44:47], v[88:91], a[20:23]
    ds_read_b64 v[204:205], v23 offset:24576
    v_mfma_f32_16x16x32_bf16 a[64:67], v[40:43], v[92:95], a[64:67]
    ds_read_b128 v[36:39], v1 offset:21504
    ds_read_b64 v[206:207], v143 offset:24704
    v_mfma_f32_16x16x32_bf16 a[68:71], v[44:47], v[92:95], a[68:71]
    s_waitcnt lgkmcnt(6)
    ds_read_b64 v[208:209], v142 offset:24576
    v_mfma_f32_16x16x32_bf16 a[24:27], v[24:27], v[88:91], a[24:27]
    ds_read_b128 v[40:43], v1 offset:22528
    ds_read_b64 v[210:211], v22 offset:24832
    v_mfma_f32_16x16x32_bf16 a[28:31], v[28:31], v[88:91], a[28:31]
    v_mfma_f32_16x16x32_bf16 a[72:75], v[24:27], v[92:95], a[72:75]
    ds_read_b128 v[44:47], v1 offset:23552
    ds_read_b64 v[212:213], v143 offset:24576
    v_mfma_f32_16x16x32_bf16 a[76:79], v[28:31], v[92:95], a[76:79]
    s_waitcnt lgkmcnt(6)
    v_subrev_u32 v2, 49152, v2
    v_subrev_u32 v3, 49152, v3
    v_mfma_f32_16x16x32_bf16 a[32:35], v[32:35], v[88:91], a[32:35]
    ds_read_b128 v[24:27], v2 offset:0
    ds_read_b64 v[214:215], v23 offset:24832
    v_mfma_f32_16x16x32_bf16 a[36:39], v[36:39], v[88:91], a[36:39]
    ds_read_b64 v[216:217], v22 offset:24704
    ds_read_b64 v[218:219], v142 offset:24832
    v_mfma_f32_16x16x32_bf16 a[80:83], v[32:35], v[92:95], a[80:83]
    ds_read_b128 v[28:31], v3 offset:0
    ds_read_b64 v[220:221], v23 offset:24704
    v_mfma_f32_16x16x32_bf16 a[84:87], v[36:39], v[92:95], a[84:87]
    s_waitcnt lgkmcnt(7)
    v_mfma_f32_16x16x32_bf16 a[40:43], v[40:43], v[88:91], a[40:43]
    ds_read_b128 v[32:35], v2 offset:6144
    ds_read_b64 v[222:223], v143 offset:24832
    v_mfma_f32_16x16x32_bf16 a[44:47], v[44:47], v[88:91], a[44:47]
    v_mfma_f32_16x16x32_bf16 a[88:91], v[40:43], v[92:95], a[88:91]
    ds_read_b128 v[36:39], v3 offset:6144
    v_mfma_f32_16x16x32_bf16 a[92:95], v[44:47], v[92:95], a[92:95]
    s_waitcnt lgkmcnt(4)
    s_waitcnt lgkmcnt(0)
    s_barrier
    v_mfma_f32_16x16x32_bf16 v[160:163], v[24:27], a[240:243], 0
    s_waitcnt vmcnt(10)
    ds_read_b128 v[40:43], v2 offset:128
    v_lshlrev_b32 v48, 16, v56
    v_mfma_f32_16x16x32_bf16 v[160:163], v[28:31], a[244:247], v[160:163]
    s_mov_b32 m0, s26
    v_and_b32 v49, s97, v56
    v_lshlrev_b32 v50, 16, v58
    v_mfma_f32_16x16x32_bf16 v[164:167], v[24:27], v[200:203], 0
    ds_read_b128 v[44:47], v3 offset:128
    v_and_b32 v51, s97, v58
    v_mfma_f32_16x16x32_bf16 v[164:167], v[28:31], v[204:207], v[164:167]
    s_waitcnt lgkmcnt(2)
    buffer_load_dwordx4 v4, s[4:7], s32 offen offset:0 sc1 lds
    v_mfma_f32_16x16x32_bf16 v[96:99], v[32:35], a[240:243], 0
    ds_read_b128 v[24:27], v2 offset:6272
    v_mul_f32 v48, s38, v48
    v_mfma_f32_16x16x32_bf16 v[96:99], v[36:39], a[244:247], v[96:99]
    v_mul_f32 v49, s38, v49
    v_mul_f32_e64 v50, -v50, v48
    v_mfma_f32_16x16x32_bf16 v[100:103], v[32:35], v[200:203], 0
    ds_read_b128 v[28:31], v3 offset:6272
    v_mul_f32_e64 v51, -v51, v49
    v_mfma_f32_16x16x32_bf16 v[100:103], v[36:39], v[204:207], v[100:103]
    s_waitcnt lgkmcnt(2)
    buffer_load_dwordx4 v4, s[4:7], s32 offen offset:1024 sc1 lds
    v_mfma_f32_16x16x32_bf16 v[160:163], v[40:43], a[248:251], v[160:163]
    ds_read_b128 v[32:35], v2 offset:256
    v_cvt_f32_i32 v224, v224
    v_mfma_f32_16x16x32_bf16 v[160:163], v[44:47], a[252:255], v[160:163]
    v_cvt_f32_i32 v225, v225
    v_fma_f32 v224, v224, v48, v50
    v_mfma_f32_16x16x32_bf16 v[164:167], v[40:43], v[208:211], v[164:167]
    ds_read_b128 v[36:39], v3 offset:256
    v_fma_f32 v225, v225, v49, v51
    v_mfma_f32_16x16x32_bf16 v[164:167], v[44:47], v[212:215], v[164:167]
    s_waitcnt lgkmcnt(2)
    buffer_load_dwordx4 v4, s[4:7], s32 offen offset:2048 sc1 lds
    v_cvt_pk_bf16_f32 v224, v224, v225
    v_mfma_f32_16x16x32_bf16 v[96:99], v[24:27], a[248:251], v[96:99]
    s_add_u32 s32, s32, 24576
    ds_read_b128 v[40:43], v2 offset:6400
    v_cvt_f32_i32 v228, v228
    v_mfma_f32_16x16x32_bf16 v[96:99], v[28:31], a[252:255], v[96:99]
    s_sub_u32 s57, s32, 196608
    v_cvt_f32_i32 v229, v229
    v_fma_f32 v228, v228, v48, v50
    v_mfma_f32_16x16x32_bf16 v[100:103], v[24:27], v[208:211], v[100:103]
    s_min_u32 s32, s32, s57
    ds_read_b128 v[44:47], v3 offset:6400
    v_fma_f32 v229, v229, v49, v51
    v_mfma_f32_16x16x32_bf16 v[100:103], v[28:31], v[212:215], v[100:103]
    s_waitcnt lgkmcnt(2)
    v_cvt_pk_bf16_f32 v228, v228, v229
    v_cvt_f32_i32 v232, v232
    v_cvt_f32_i32 v233, v233
    v_mfma_f32_16x16x32_bf16 v[160:163], v[32:35], v[192:195], v[160:163]
    s_add_u32 s26, s26, 12288
    ds_read_b128 v[24:27], v2 offset:12288
    v_fma_f32 v232, v232, v48, v50
    v_mfma_f32_16x16x32_bf16 v[160:163], v[36:39], v[196:199], v[160:163]
    s_mov_b32 m0, s26
    v_fma_f32 v233, v233, v49, v51
    v_cvt_pk_bf16_f32 v232, v232, v233
    v_mfma_f32_16x16x32_bf16 v[164:167], v[32:35], v[216:219], v[164:167]
    ds_read_b128 v[28:31], v3 offset:12288
    v_cvt_f32_i32 v236, v236
    v_mfma_f32_16x16x32_bf16 v[164:167], v[36:39], v[220:223], v[164:167]
    s_waitcnt lgkmcnt(2)
    buffer_load_dwordx4 v4, s[4:7], s32 offen offset:0 sc1 lds
    v_cvt_f32_i32 v237, v237
    v_mfma_f32_16x16x32_bf16 v[96:99], v[40:43], v[192:195], v[96:99]
    ds_read_b128 v[32:35], v2 offset:18432
    v_fma_f32 v236, v236, v48, v50
    v_mfma_f32_16x16x32_bf16 v[96:99], v[44:47], v[196:199], v[96:99]
    v_fma_f32 v237, v237, v49, v51
    v_cvt_pk_bf16_f32 v236, v236, v237
    v_lshlrev_b32 v48, 16, v57
    v_mfma_f32_16x16x32_bf16 v[100:103], v[40:43], v[216:219], v[100:103]
    ds_read_b128 v[36:39], v3 offset:18432
    v_and_b32 v49, s97, v57
    v_mfma_f32_16x16x32_bf16 v[100:103], v[44:47], v[220:223], v[100:103]
    s_waitcnt lgkmcnt(2)
    buffer_load_dwordx4 v4, s[4:7], s32 offen offset:1024 sc1 lds
    v_lshlrev_b32 v50, 16, v59
    v_mfma_f32_16x16x32_bf16 v[168:171], v[24:27], a[240:243], 0
    ds_read_b128 v[40:43], v2 offset:12416
    s_waitcnt vmcnt(13)
    buffer_load_dwordx4 v4, s[4:7], s32 offen offset:2048 sc1 lds
    v_mfma_f32_16x16x32_bf16 v[168:171], v[28:31], a[244:247], v[168:171]
    v_and_b32 v51, s97, v59
    v_mul_f32 v48, s38, v48
    v_mul_f32 v49, s38, v49
    v_mfma_f32_16x16x32_bf16 v[172:175], v[24:27], v[200:203], 0
    s_add_u32 s32, s32, 24576
    ds_read_b128 v[44:47], v3 offset:12416
    v_mul_f32_e64 v50, -v50, v48
    v_mfma_f32_16x16x32_bf16 v[172:175], v[28:31], v[204:207], v[172:175]
    s_waitcnt lgkmcnt(2)
    v_mul_f32_e64 v51, -v51, v49
    v_cvt_f32_i32 v226, v226
    v_cvt_f32_i32 v227, v227
    v_mfma_f32_16x16x32_bf16 v[104:107], v[32:35], a[240:243], 0
    s_sub_u32 s57, s32, 196608
    ds_read_b128 v[24:27], v2 offset:18560
    v_fma_f32 v226, v226, v48, v50
    v_mfma_f32_16x16x32_bf16 v[104:107], v[36:39], a[244:247], v[104:107]
    v_fma_f32 v227, v227, v49, v51
    v_cvt_pk_bf16_f32 v225, v226, v227
    v_cvt_f32_i32 v230, v230
    v_mfma_f32_16x16x32_bf16 v[108:111], v[32:35], v[200:203], 0
    s_min_u32 s32, s32, s57
    ds_read_b128 v[28:31], v3 offset:18560
    v_cvt_f32_i32 v231, v231
    v_mfma_f32_16x16x32_bf16 v[108:111], v[36:39], v[204:207], v[108:111]
    s_waitcnt lgkmcnt(2)
    v_fma_f32 v230, v230, v48, v50
    v_fma_f32 v231, v231, v49, v51
    v_cvt_pk_bf16_f32 v229, v230, v231
    v_mfma_f32_16x16x32_bf16 v[168:171], v[40:43], a[248:251], v[168:171]
    s_add_u32 s26, s26, 36864
    ds_read_b128 v[32:35], v2 offset:12544
    v_cvt_f32_i32 v234, v234
    v_mfma_f32_16x16x32_bf16 v[168:171], v[44:47], a[252:255], v[168:171]
    v_cvt_f32_i32 v235, v235
    v_fma_f32 v234, v234, v48, v50
    v_max3_f32 v16, v160, v161, v162
    v_mfma_f32_16x16x32_bf16 v[172:175], v[40:43], v[208:211], v[172:175]
    ds_read_b128 v[36:39], v3 offset:12544
    v_fma_f32 v235, v235, v49, v51
    v_cvt_pk_bf16_f32 v233, v234, v235
    v_cvt_f32_i32 v238, v238
    v_cvt_f32_i32 v239, v239
    v_fma_f32 v238, v238, v48, v50
    v_fma_f32 v239, v239, v49, v51
    v_cvt_pk_bf16_f32 v237, v238, v239
    v_mfma_f32_16x16x32_bf16 v[172:175], v[44:47], v[212:215], v[172:175]
    s_waitcnt lgkmcnt(2)
    v_max3_f32 v18, v164, v165, v166
    v_max3_f32 v16, v16, v163, v96
    v_max3_f32 v18, v18, v167, v100
    v_mfma_f32_16x16x32_bf16 v[104:107], v[24:27], a[248:251], v[104:107]
    s_sub_u32 s57, s26, 147456
    ds_read_b128 v[40:43], v2 offset:18688
    s_min_u32 s26, s26, s57
    v_mfma_f32_16x16x32_bf16 v[104:107], v[28:31], a[252:255], v[104:107]
    s_waitcnt vmcnt(13)
    buffer_load_dwordx2 v[56:57], off, s[80:83], s37 offset:0
    v_max3_f32 v16, v16, v97, v98
    v_mfma_f32_16x16x32_bf16 v[108:111], v[24:27], v[208:211], v[108:111]
    s_waitcnt vmcnt(11)
    ds_read_b128 v[44:47], v3 offset:18688
    v_max3_f32 v18, v18, v101, v102
    v_mfma_f32_16x16x32_bf16 v[108:111], v[28:31], v[212:215], v[108:111]
    s_waitcnt lgkmcnt(2)
    v_add_u32 v2, 49152, v2
    v_add_u32 v3, 49152, v3
    v_max_f32 v16, v16, v99
    v_mfma_f32_16x16x32_bf16 v[168:171], v[32:35], v[192:195], v[168:171]
    ds_read_b128 v[24:27], v2 offset:0
    v_max_f32 v18, v18, v103
    v_mfma_f32_16x16x32_bf16 v[168:171], v[36:39], v[196:199], v[168:171]
    v_mov_b32 v17, v16
    v_mov_b32 v19, v18
    s_nop 0
    v_mfma_f32_16x16x32_bf16 v[172:175], v[32:35], v[216:219], v[172:175]
    ds_read_b128 v[28:31], v3 offset:0
    v_permlane16_swap_b32 v16, v17
    v_mfma_f32_16x16x32_bf16 v[172:175], v[36:39], v[220:223], v[172:175]
    s_waitcnt lgkmcnt(2)
    buffer_load_dwordx2 v[58:59], off, s[84:87], s37 offset:0
    v_permlane16_swap_b32 v18, v19
    v_mfma_f32_16x16x32_bf16 v[104:107], v[40:43], v[192:195], v[104:107]
    s_nop 0
    ds_read_b128 v[32:35], v2 offset:6144
    v_max_f32 v16, v16, v17
    v_mfma_f32_16x16x32_bf16 v[104:107], v[44:47], v[196:199], v[104:107]
    v_max_f32 v18, v18, v19
    v_mov_b32 v17, v16
    v_mov_b32 v19, v18
    s_nop 0
    v_permlane32_swap_b32 v16, v17
    v_permlane32_swap_b32 v18, v19
    s_nop 0
    v_max_f32 v16, v16, v17
    v_max_f32 v18, v18, v19
    v_sub_f32 v136, 0, v16
    v_sub_f32 v137, 0, v16
    v_sub_f32 v138, 0, v16
    v_sub_f32 v139, 0, v16
    v_sub_f32 v140, 0, v18
    v_sub_f32 v141, 0, v18
    v_sub_f32 v142, 0, v18
    v_sub_f32 v143, 0, v18
    v_mfma_f32_16x16x32_bf16 v[108:111], v[40:43], v[216:219], v[108:111]
    ds_read_b128 v[36:39], v3 offset:6144
    v_lshlrev_b32 v48, 16, v60
    v_mfma_f32_16x16x32_bf16 v[108:111], v[44:47], v[220:223], v[108:111]
    s_waitcnt lgkmcnt(2)
    v_and_b32 v49, s97, v60
    v_lshlrev_b32 v50, 16, v62
    v_and_b32 v51, s97, v62
    v_mfma_f32_16x16x32_bf16 v[176:179], v[24:27], a[240:243], v[136:139]
    ds_read_b128 v[40:43], v2 offset:128
    v_mul_f32 v48, s38, v48
    v_mfma_f32_16x16x32_bf16 v[176:179], v[28:31], a[244:247], v[176:179]
    v_mul_f32 v49, s38, v49
    v_mul_f32_e64 v50, -v50, v48
    v_mul_f32_e64 v51, -v51, v49
    v_mfma_f32_16x16x32_bf16 v[180:183], v[24:27], v[200:203], v[140:143]
    ds_read_b128 v[44:47], v3 offset:128
    v_cvt_f32_i32 v240, v240
    v_mfma_f32_16x16x32_bf16 v[180:183], v[28:31], v[204:207], v[180:183]
    s_waitcnt lgkmcnt(2)
    v_cvt_f32_i32 v241, v241
    v_fma_f32 v240, v240, v48, v50
    v_fma_f32 v241, v241, v49, v51
    v_mfma_f32_16x16x32_bf16 v[112:115], v[32:35], a[240:243], v[136:139]
    ds_read_b128 v[24:27], v2 offset:6272
    v_cvt_pk_bf16_f32 v226, v240, v241
    v_mfma_f32_16x16x32_bf16 v[112:115], v[36:39], a[244:247], v[112:115]
    v_add_f32 v160, v160, v136
    v_add_f32 v161, v161, v136
    v_cvt_f32_i32 v244, v244
    v_mfma_f32_16x16x32_bf16 v[116:119], v[32:35], v[200:203], v[140:143]
    ds_read_b128 v[28:31], v3 offset:6272
    v_add_f32 v162, v162, v136
    v_mfma_f32_16x16x32_bf16 v[116:119], v[36:39], v[204:207], v[116:119]
    s_waitcnt lgkmcnt(2)
    v_add_f32 v163, v163, v136
    v_cvt_f32_i32 v245, v245
    v_add_f32 v96, v96, v136
    v_mfma_f32_16x16x32_bf16 v[176:179], v[40:43], a[248:251], v[176:179]
    ds_read_b128 v[32:35], v2 offset:256
    v_add_f32 v97, v97, v136
    v_mfma_f32_16x16x32_bf16 v[176:179], v[44:47], a[252:255], v[176:179]
    v_fma_f32 v244, v244, v48, v50
    v_add_f32 v98, v98, v136
    v_add_f32 v99, v99, v136
    v_mfma_f32_16x16x32_bf16 v[180:183], v[40:43], v[208:211], v[180:183]
    ds_read_b128 v[36:39], v3 offset:256
    v_fma_f32 v245, v245, v49, v51
    v_mfma_f32_16x16x32_bf16 v[180:183], v[44:47], v[212:215], v[180:183]
    s_waitcnt lgkmcnt(2)
    v_add_f32 v164, v164, v140
    v_cvt_pk_bf16_f32 v230, v244, v245
    v_add_f32 v165, v165, v140
    v_mfma_f32_16x16x32_bf16 v[112:115], v[24:27], a[248:251], v[112:115]
    ds_read_b128 v[40:43], v2 offset:6400
    v_cvt_f32_i32 v248, v248
    v_mfma_f32_16x16x32_bf16 v[112:115], v[28:31], a[252:255], v[112:115]
    v_add_f32 v166, v166, v140
    v_add_f32 v167, v167, v140
    v_cvt_f32_i32 v249, v249
    v_mfma_f32_16x16x32_bf16 v[116:119], v[24:27], v[208:211], v[116:119]
    ds_read_b128 v[44:47], v3 offset:6400
    v_add_f32 v100, v100, v140
    v_mfma_f32_16x16x32_bf16 v[116:119], v[28:31], v[212:215], v[116:119]
    s_waitcnt lgkmcnt(2)
    v_fma_f32 v248, v248, v48, v50
    v_fma_f32 v249, v249, v49, v51
    v_add_f32 v101, v101, v140
    v_mfma_f32_16x16x32_bf16 v[176:179], v[32:35], v[192:195], v[176:179]
    ds_read_b128 v[24:27], v2 offset:12288
    v_cvt_pk_bf16_f32 v234, v248, v249
    v_mfma_f32_16x16x32_bf16 v[176:179], v[36:39], v[196:199], v[176:179]
    v_cvt_f32_i32 v252, v252
    v_add_f32 v102, v102, v140
    v_add_f32 v103, v103, v140
    v_mfma_f32_16x16x32_bf16 v[180:183], v[32:35], v[216:219], v[180:183]
    ds_read_b128 v[28:31], v3 offset:12288
    v_cvt_f32_i32 v253, v253
    v_mfma_f32_16x16x32_bf16 v[180:183], v[36:39], v[220:223], v[180:183]
    s_waitcnt lgkmcnt(2)
    v_fma_f32 v252, v252, v48, v50
    v_fma_f32 v253, v253, v49, v51
    v_cvt_pk_bf16_f32 v238, v252, v253
    v_mfma_f32_16x16x32_bf16 v[112:115], v[40:43], v[192:195], v[112:115]
    ds_read_b128 v[32:35], v2 offset:18432
    v_lshlrev_b32 v48, 16, v61
    v_mfma_f32_16x16x32_bf16 v[112:115], v[44:47], v[196:199], v[112:115]
    v_and_b32 v49, s97, v61
    v_lshlrev_b32 v50, 16, v63
    v_and_b32 v51, s97, v63
    v_mfma_f32_16x16x32_bf16 v[116:119], v[40:43], v[216:219], v[116:119]
    ds_read_b128 v[36:39], v3 offset:18432
    v_mul_f32 v48, s38, v48
    v_mfma_f32_16x16x32_bf16 v[116:119], v[44:47], v[220:223], v[116:119]
    s_waitcnt lgkmcnt(2)
    v_mul_f32 v49, s38, v49
    v_mul_f32_e64 v50, -v50, v48
    v_mul_f32_e64 v51, -v51, v49
    v_mfma_f32_16x16x32_bf16 v[184:187], v[24:27], a[240:243], v[136:139]
    ds_read_b128 v[40:43], v2 offset:12416
    v_cvt_f32_i32 v242, v242
    v_cvt_f32_i32 v243, v243
    v_fma_f32 v242, v242, v48, v50
    v_fma_f32 v243, v243, v49, v51
    v_cvt_pk_bf16_f32 v227, v242, v243
    v_cvt_f32_i32 v246, v246
    v_cvt_f32_i32 v247, v247
    v_fma_f32 v246, v246, v48, v50
    v_fma_f32 v247, v247, v49, v51
    v_cvt_pk_bf16_f32 v231, v246, v247
    v_cvt_f32_i32 v250, v250
    v_cvt_f32_i32 v251, v251
    v_fma_f32 v250, v250, v48, v50
    v_fma_f32 v251, v251, v49, v51
    v_cvt_pk_bf16_f32 v235, v250, v251
    v_cvt_f32_i32 v254, v254
    v_cvt_f32_i32 v255, v255
    v_fma_f32 v254, v254, v48, v50
    v_fma_f32 v255, v255, v49, v51
    v_cvt_pk_bf16_f32 v239, v254, v255
    v_mfma_f32_16x16x32_bf16 v[184:187], v[28:31], a[244:247], v[184:187]
    buffer_store_dwordx4 v[224:227], v11, s[4:7], s33 offen offset:0 sc1
    v_mfma_f32_16x16x32_bf16 v[188:191], v[24:27], v[200:203], v[140:143]
    ds_read_b128 v[44:47], v3 offset:12416
    v_xor_b32 v55, 16, v11
    v_mfma_f32_16x16x32_bf16 v[188:191], v[28:31], v[204:207], v[188:191]
    s_waitcnt lgkmcnt(2)
    v_exp_f32 v16, v160
    v_mfma_f32_16x16x32_bf16 v[120:123], v[32:35], a[240:243], v[136:139]
    ds_read_b128 v[24:27], v2 offset:18560
    v_mfma_f32_16x16x32_bf16 v[120:123], v[36:39], a[244:247], v[120:123]
    buffer_store_dwordx4 v[228:231], v55, s[4:7], s33 offen offset:768 sc1
    v_mfma_f32_16x16x32_bf16 v[124:127], v[32:35], v[200:203], v[140:143]
    ds_read_b128 v[28:31], v3 offset:18560
    v_mfma_f32_16x16x32_bf16 v[124:127], v[36:39], v[204:207], v[124:127]
    s_waitcnt lgkmcnt(2)
    v_exp_f32 v17, v161
    v_mfma_f32_16x16x32_bf16 v[184:187], v[40:43], a[248:251], v[184:187]
    ds_read_b128 v[32:35], v2 offset:12544
    v_mfma_f32_16x16x32_bf16 v[184:187], v[44:47], a[252:255], v[184:187]
    v_exp_f32 v18, v162
    v_add_f32 v7, v7, v16
    v_mfma_f32_16x16x32_bf16 v[188:191], v[40:43], v[208:211], v[188:191]
    ds_read_b128 v[36:39], v3 offset:12544
    v_add_f32 v7, v7, v17
    v_mfma_f32_16x16x32_bf16 v[188:191], v[44:47], v[212:215], v[188:191]
    s_waitcnt lgkmcnt(2)
    v_exp_f32 v19, v163
    v_cvt_pk_bf16_f32 v160, v16, v17
    v_mfma_f32_16x16x32_bf16 v[120:123], v[24:27], a[248:251], v[120:123]
    ds_read_b128 v[40:43], v2 offset:18688
    v_xor_b32 v54, 32, v11
    v_mfma_f32_16x16x32_bf16 v[120:123], v[28:31], a[252:255], v[120:123]
    s_waitcnt vmcnt(4)
    v_exp_f32 v16, v96
    v_add_f32 v7, v7, v18
    v_mfma_f32_16x16x32_bf16 v[124:127], v[24:27], v[208:211], v[124:127]
    ds_read_b128 v[44:47], v3 offset:18688
    v_add_f32 v7, v7, v19
    v_mfma_f32_16x16x32_bf16 v[124:127], v[28:31], v[212:215], v[124:127]
    s_waitcnt lgkmcnt(2)
    s_barrier
    v_add_u32 v2, 49152, v2
    v_add_u32 v3, 49152, v3
    v_mfma_f32_16x16x32_bf16 v[184:187], v[32:35], v[192:195], v[184:187]
    ds_read_b128 v[24:27], v2 offset:0
    v_xor_b32 v55, 48, v11
    v_mfma_f32_16x16x32_bf16 v[184:187], v[36:39], v[196:199], v[184:187]
    buffer_store_dwordx4 v[232:235], v54, s[4:7], s33 offen offset:1536 sc1
    v_mfma_f32_16x16x32_bf16 v[188:191], v[32:35], v[216:219], v[188:191]
    ds_read_b128 v[28:31], v3 offset:0
    v_mfma_f32_16x16x32_bf16 v[188:191], v[36:39], v[220:223], v[188:191]
    s_waitcnt lgkmcnt(2)
    v_exp_f32 v17, v97
    v_cvt_pk_bf16_f32 v161, v18, v19
    v_mfma_f32_16x16x32_bf16 v[120:123], v[40:43], v[192:195], v[120:123]
    ds_read_b128 v[32:35], v2 offset:6144
    v_mfma_f32_16x16x32_bf16 v[120:123], v[44:47], v[196:199], v[120:123]
    buffer_store_dwordx4 v[236:239], v55, s[4:7], s33 offen offset:2304 sc1
    v_mfma_f32_16x16x32_bf16 v[124:127], v[40:43], v[216:219], v[124:127]
    ds_read_b128 v[36:39], v3 offset:6144
    v_mfma_f32_16x16x32_bf16 v[124:127], v[44:47], v[220:223], v[124:127]
    s_waitcnt lgkmcnt(2)
    v_exp_f32 v18, v98
    v_add_f32 v7, v7, v16
    v_add_f32 v7, v7, v17
    v_exp_f32 v19, v99
    v_cvt_pk_bf16_f32 v162, v16, v17
    v_exp_f32 v16, v164
    v_add_f32 v7, v7, v18
    v_add_f32 v7, v7, v19
    v_exp_f32 v17, v165
    v_cvt_pk_bf16_f32 v163, v18, v19
    v_exp_f32 v18, v166
    v_add_f32 v8, v8, v16
    v_add_f32 v8, v8, v17
    v_exp_f32 v19, v167
    v_cvt_pk_bf16_f32 v164, v16, v17
    v_exp_f32 v16, v100
    v_add_f32 v8, v8, v18
    v_add_f32 v8, v8, v19
    v_exp_f32 v17, v101
    v_cvt_pk_bf16_f32 v165, v18, v19
    v_exp_f32 v18, v102
    v_add_f32 v8, v8, v16
    v_add_f32 v8, v8, v17
    v_exp_f32 v19, v103
    v_cvt_pk_bf16_f32 v166, v16, v17
    v_add_f32 v8, v8, v18
    v_add_f32 v8, v8, v19
    v_cvt_pk_bf16_f32 v167, v18, v19
    v_add_f32 v168, v168, v136
    v_add_f32 v169, v169, v136
    v_add_f32 v170, v170, v136
    v_add_f32 v171, v171, v136
    v_add_f32 v104, v104, v136
    v_add_f32 v105, v105, v136
    v_add_f32 v106, v106, v136
    v_add_f32 v107, v107, v136
    v_add_f32 v172, v172, v140
    v_add_f32 v173, v173, v140
    v_add_f32 v174, v174, v140
    v_add_f32 v175, v175, v140
    v_add_f32 v108, v108, v140
    v_add_f32 v109, v109, v140
    v_add_f32 v110, v110, v140
    v_add_f32 v111, v111, v140
    v_exp_f32 v16, v168
    v_exp_f32 v17, v169
    v_exp_f32 v18, v170
    v_add_f32 v7, v7, v16
    v_add_f32 v7, v7, v17
    v_exp_f32 v19, v171
    v_cvt_pk_bf16_f32 v168, v16, v17
    v_exp_f32 v16, v104
    v_add_f32 v7, v7, v18
    v_add_f32 v7, v7, v19
    v_exp_f32 v17, v105
    v_cvt_pk_bf16_f32 v169, v18, v19
    v_exp_f32 v18, v106
    v_add_f32 v7, v7, v16
    v_add_f32 v7, v7, v17
    v_exp_f32 v19, v107
    v_cvt_pk_bf16_f32 v170, v16, v17
    v_exp_f32 v16, v172
    v_add_f32 v7, v7, v18
    v_add_f32 v7, v7, v19
    v_exp_f32 v17, v173
    v_cvt_pk_bf16_f32 v171, v18, v19
    v_exp_f32 v18, v174
    v_add_f32 v8, v8, v16
    v_add_f32 v8, v8, v17
    v_exp_f32 v19, v175
    v_cvt_pk_bf16_f32 v172, v16, v17
    v_exp_f32 v16, v108
    v_add_f32 v8, v8, v18
    v_add_f32 v8, v8, v19
    v_exp_f32 v17, v109
    v_cvt_pk_bf16_f32 v173, v18, v19
    v_exp_f32 v18, v110
    v_add_f32 v8, v8, v16
    v_add_f32 v8, v8, v17
    v_exp_f32 v19, v111
    v_cvt_pk_bf16_f32 v174, v16, v17
    v_add_f32 v8, v8, v18
    v_add_f32 v8, v8, v19
    v_cvt_pk_bf16_f32 v175, v18, v19
    v_mfma_f32_16x16x32_bf16 v[64:67], v[24:27], a[192:195], v[128:131]
    ds_read_b128 v[40:43], v2 offset:128
    v_mfma_f32_16x16x32_bf16 v[64:67], v[28:31], a[196:199], v[64:67]
    buffer_load_dwordx2 v[60:61], off, s[80:83], s37 offset:8
    v_mfma_f32_16x16x32_bf16 v[68:71], v[24:27], a[216:219], v[132:135]
    v_exp_f32 v16, v176
    v_mfma_f32_16x16x32_bf16 v[68:71], v[28:31], a[220:223], v[68:71]
    v_exp_f32 v17, v177
    v_mfma_f32_16x16x32_bf16 v[72:75], v[24:27], a[240:243], v[136:139]
    ds_read_b128 v[44:47], v3 offset:128
    v_mfma_f32_16x16x32_bf16 v[72:75], v[28:31], a[244:247], v[72:75]
    buffer_load_dwordx2 v[62:63], off, s[84:87], s37 offset:8
    v_mfma_f32_16x16x32_bf16 v[76:79], v[24:27], v[200:203], v[140:143]
    v_exp_f32 v18, v178
    v_mfma_f32_16x16x32_bf16 v[76:79], v[28:31], v[204:207], v[76:79]
    s_waitcnt lgkmcnt(2)
    v_add_f32 v7, v7, v16
    v_add_f32 v7, v7, v17
    v_mfma_f32_16x16x32_bf16 v[96:99], v[32:35], a[192:195], v[128:131]
    ds_read_b128 v[24:27], v2 offset:6272
    v_mfma_f32_16x16x32_bf16 v[96:99], v[36:39], a[196:199], v[96:99]
    buffer_load_dwordx4 v[240:243], v12, s[68:71], s16 offen offset:0 nt
    v_mfma_f32_16x16x32_bf16 v[100:103], v[32:35], a[216:219], v[132:135]
    s_waitcnt vmcnt(7)
    v_exp_f32 v19, v179
    v_mfma_f32_16x16x32_bf16 v[100:103], v[36:39], a[220:223], v[100:103]
    v_cvt_pk_bf16_f32 v176, v16, v17
    v_exp_f32 v16, v112
    v_mfma_f32_16x16x32_bf16 v[104:107], v[32:35], a[240:243], v[136:139]
    ds_read_b128 v[28:31], v3 offset:6272
    v_add_f32 v7, v7, v18
    v_mfma_f32_16x16x32_bf16 v[104:107], v[36:39], a[244:247], v[104:107]
    buffer_load_dwordx4 v[244:247], v12, s[68:71], s16 offen offset:768 nt
    v_add_f32 v7, v7, v19
    v_mfma_f32_16x16x32_bf16 v[108:111], v[32:35], v[200:203], v[140:143]
    v_exp_f32 v17, v113
    v_mfma_f32_16x16x32_bf16 v[108:111], v[36:39], v[204:207], v[108:111]
    s_waitcnt lgkmcnt(2)
    v_cvt_pk_bf16_f32 v177, v18, v19
    v_exp_f32 v18, v114
    v_mfma_f32_16x16x32_bf16 v[64:67], v[40:43], a[200:203], v[64:67]
    ds_read_b128 v[32:35], v2 offset:256
    v_add_f32 v7, v7, v16
    v_mfma_f32_16x16x32_bf16 v[64:67], v[44:47], a[204:207], v[64:67]
    buffer_load_dwordx4 v[248:251], v12, s[68:71], s16 offen offset:1536 nt
    v_add_f32 v7, v7, v17
    v_mfma_f32_16x16x32_bf16 v[68:71], v[40:43], a[224:227], v[68:71]
    v_exp_f32 v19, v115
    v_mfma_f32_16x16x32_bf16 v[68:71], v[44:47], a[228:231], v[68:71]
    v_cvt_pk_bf16_f32 v178, v16, v17
    v_exp_f32 v16, v180
    v_mfma_f32_16x16x32_bf16 v[72:75], v[40:43], a[248:251], v[72:75]
    ds_read_b128 v[36:39], v3 offset:256
    v_add_f32 v7, v7, v18
    v_mfma_f32_16x16x32_bf16 v[72:75], v[44:47], a[252:255], v[72:75]
    buffer_load_dwordx4 v[252:255], v12, s[68:71], s16 offen offset:2304 nt
    v_add_f32 v7, v7, v19
    v_mfma_f32_16x16x32_bf16 v[76:79], v[40:43], v[208:211], v[76:79]
    v_exp_f32 v17, v181
    v_mfma_f32_16x16x32_bf16 v[76:79], v[44:47], v[212:215], v[76:79]
    s_waitcnt lgkmcnt(2)
    v_cvt_pk_bf16_f32 v179, v18, v19
    v_exp_f32 v18, v182
    v_mfma_f32_16x16x32_bf16 v[96:99], v[24:27], a[200:203], v[96:99]
    s_mov_b32 m0, s26
    ds_read_b128 v[40:43], v2 offset:6400
    v_add_f32 v8, v8, v16
    v_mfma_f32_16x16x32_bf16 v[96:99], v[28:31], a[204:207], v[96:99]
    buffer_load_dwordx4 v4, s[4:7], s32 offen offset:0 sc1 lds
    v_add_f32 v8, v8, v17
    v_mfma_f32_16x16x32_bf16 v[100:103], v[24:27], a[224:227], v[100:103]
    v_exp_f32 v19, v183
    v_mfma_f32_16x16x32_bf16 v[100:103], v[28:31], a[228:231], v[100:103]
    v_cvt_pk_bf16_f32 v180, v16, v17
    v_exp_f32 v16, v116
    v_mfma_f32_16x16x32_bf16 v[104:107], v[24:27], a[248:251], v[104:107]
    ds_read_b128 v[44:47], v3 offset:6400
    v_add_f32 v8, v8, v18
    v_mfma_f32_16x16x32_bf16 v[104:107], v[28:31], a[252:255], v[104:107]
    buffer_load_dwordx4 v4, s[4:7], s32 offen offset:1024 sc1 lds
    v_add_f32 v8, v8, v19
    v_mfma_f32_16x16x32_bf16 v[108:111], v[24:27], v[208:211], v[108:111]
    v_exp_f32 v17, v117
    v_mfma_f32_16x16x32_bf16 v[108:111], v[28:31], v[212:215], v[108:111]
    s_waitcnt lgkmcnt(2)
    v_cvt_pk_bf16_f32 v181, v18, v19
    v_exp_f32 v18, v118
    v_mfma_f32_16x16x32_bf16 v[64:67], v[32:35], a[208:211], v[64:67]
    ds_read_b128 v[24:27], v2 offset:12288
    v_add_f32 v8, v8, v16
    v_mfma_f32_16x16x32_bf16 v[64:67], v[36:39], a[212:215], v[64:67]
    buffer_load_dwordx4 v4, s[4:7], s32 offen offset:2048 sc1 lds
    v_add_f32 v8, v8, v17
    v_mfma_f32_16x16x32_bf16 v[68:71], v[32:35], a[232:235], v[68:71]
    s_add_u32 s32, s32, 24576
    v_exp_f32 v19, v119
    v_mfma_f32_16x16x32_bf16 v[68:71], v[36:39], a[236:239], v[68:71]
    v_cvt_pk_bf16_f32 v182, v16, v17
    v_add_f32 v8, v8, v18
    v_add_f32 v8, v8, v19
    v_mfma_f32_16x16x32_bf16 v[72:75], v[32:35], v[192:195], v[72:75]
    s_sub_u32 s57, s32, 196608
    ds_read_b128 v[28:31], v3 offset:12288
    v_cvt_pk_bf16_f32 v183, v18, v19
    v_mfma_f32_16x16x32_bf16 v[72:75], v[36:39], v[196:199], v[72:75]
    s_waitcnt lgkmcnt(2)
    v_exp_f32 v16, v184
    v_lshlrev_b32 v48, 16, v56
    v_mfma_f32_16x16x32_bf16 v[76:79], v[32:35], v[216:219], v[76:79]
    s_waitcnt vmcnt(9)
    v_exp_f32 v17, v185
    v_mfma_f32_16x16x32_bf16 v[76:79], v[36:39], v[220:223], v[76:79]
    s_barrier
    v_exp_f32 v18, v186
    v_mfma_f32_16x16x32_bf16 v[96:99], v[40:43], a[208:211], v[96:99]
    s_min_u32 s32, s32, s57
    ds_read_b128 v[32:35], v2 offset:18432
    v_add_f32 v7, v7, v16
    v_mfma_f32_16x16x32_bf16 v[96:99], v[44:47], a[212:215], v[96:99]
    v_add_f32 v7, v7, v17
    v_exp_f32 v19, v187
    v_mfma_f32_16x16x32_bf16 v[100:103], v[40:43], a[232:235], v[100:103]
    s_add_u32 s26, s26, 12288
    v_cvt_pk_bf16_f32 v184, v16, v17
    v_and_b32 v49, s97, v56
    v_mfma_f32_16x16x32_bf16 v[100:103], v[44:47], a[236:239], v[100:103]
    v_exp_f32 v16, v120
    v_add_f32 v7, v7, v18
    v_mfma_f32_16x16x32_bf16 v[104:107], v[40:43], v[192:195], v[104:107]
    s_mov_b32 m0, s26
    ds_read_b128 v[36:39], v3 offset:18432
    v_add_f32 v7, v7, v19
    v_mfma_f32_16x16x32_bf16 v[104:107], v[44:47], v[196:199], v[104:107]
    buffer_load_dwordx4 v4, s[4:7], s32 offen offset:0 sc1 lds
    v_lshlrev_b32 v50, 16, v58
    v_mfma_f32_16x16x32_bf16 v[108:111], v[40:43], v[216:219], v[108:111]
    v_exp_f32 v17, v121
    v_mfma_f32_16x16x32_bf16 v[108:111], v[44:47], v[220:223], v[108:111]
    s_waitcnt lgkmcnt(2)
    v_cvt_pk_bf16_f32 v185, v18, v19
    v_exp_f32 v18, v122
    v_mfma_f32_16x16x32_bf16 v[80:83], v[24:27], a[192:195], v[128:131]
    ds_read_b128 v[40:43], v2 offset:12416
    v_add_f32 v7, v7, v16
    v_mfma_f32_16x16x32_bf16 v[80:83], v[28:31], a[196:199], v[80:83]
    buffer_load_dwordx4 v4, s[4:7], s32 offen offset:1024 sc1 lds
    v_add_f32 v7, v7, v17
    v_mfma_f32_16x16x32_bf16 v[84:87], v[24:27], a[216:219], v[132:135]
    v_exp_f32 v19, v123
    v_mfma_f32_16x16x32_bf16 v[84:87], v[28:31], a[220:223], v[84:87]
    v_cvt_pk_bf16_f32 v186, v16, v17
    v_exp_f32 v16, v188
    v_mfma_f32_16x16x32_bf16 v[88:91], v[24:27], a[240:243], v[136:139]
    ds_read_b128 v[44:47], v3 offset:12416
    v_add_f32 v7, v7, v18
    v_mfma_f32_16x16x32_bf16 v[88:91], v[28:31], a[244:247], v[88:91]
    v_add_u32 v0, 1, v0
    buffer_store_dword v0, v13, s[20:23], 0 offen offset:32 sc1
    v_mfma_f32_16x16x32_bf16 v[92:95], v[24:27], v[200:203], v[140:143]
    v_add_f32 v7, v7, v19
    v_exp_f32 v17, v189
    v_cvt_pk_bf16_f32 v187, v18, v19
    v_exp_f32 v18, v190
    v_add_f32 v8, v8, v16
    v_add_f32 v8, v8, v17
    v_exp_f32 v19, v191
    v_cvt_pk_bf16_f32 v188, v16, v17
    v_exp_f32 v16, v124
    v_add_f32 v8, v8, v18
    v_add_f32 v8, v8, v19
    v_exp_f32 v17, v125
    v_cvt_pk_bf16_f32 v189, v18, v19
    v_exp_f32 v18, v126
    v_add_f32 v8, v8, v16
    v_add_f32 v8, v8, v17
    v_exp_f32 v19, v127
    v_cvt_pk_bf16_f32 v190, v16, v17
    v_add_f32 v8, v8, v18
    v_add_f32 v8, v8, v19
    v_cvt_pk_bf16_f32 v191, v18, v19
    v_mfma_f32_16x16x32_bf16 v[92:95], v[28:31], v[204:207], v[92:95]
    s_waitcnt lgkmcnt(2)
    v_and_b32 v51, s97, v58
    v_mul_f32_e64 v50, -v50, v48
    v_mul_f32_e64 v51, -v51, v49
    v_mfma_f32_16x16x32_bf16 v[112:115], v[32:35], a[192:195], v[128:131]
    ds_read_b128 v[24:27], v2 offset:18560
    v_cvt_f32_i32 v144, v144
    v_mfma_f32_16x16x32_bf16 v[112:115], v[36:39], a[196:199], v[112:115]
    buffer_load_dwordx4 v4, s[4:7], s32 offen offset:2048 sc1 lds
    v_cvt_f32_i32 v148, v148
    v_mfma_f32_16x16x32_bf16 v[116:119], v[32:35], a[216:219], v[132:135]
    s_mov_b32 s32, 196608
    v_fma_f32 v144, v144, v48, v50
    v_fma_f32 v148, v148, v49, v51
    v_mfma_f32_16x16x32_bf16 v[116:119], v[36:39], a[220:223], v[116:119]
    v_cvt_f32_i32 v145, v145
    v_cvt_f32_i32 v149, v149
    v_fma_f32 v145, v145, v48, v50
    v_mfma_f32_16x16x32_bf16 v[120:123], v[32:35], a[240:243], v[136:139]
    s_add_u32 s26, s26, 36864
    ds_read_b128 v[28:31], v3 offset:18560
    v_fma_f32 v149, v149, v49, v51
    v_mfma_f32_16x16x32_bf16 v[120:123], v[36:39], a[244:247], v[120:123]
    v_cvt_f32_i32 v146, v146
    v_cvt_f32_i32 v150, v150
    v_fma_f32 v146, v146, v48, v50
    v_mfma_f32_16x16x32_bf16 v[124:127], v[32:35], v[200:203], v[140:143]
    s_sub_u32 s57, s26, 147456
    v_fma_f32 v150, v150, v49, v51
    v_cvt_f32_i32 v147, v147
    v_mfma_f32_16x16x32_bf16 v[124:127], v[36:39], v[204:207], v[124:127]
    s_waitcnt lgkmcnt(2)
    v_cvt_f32_i32 v151, v151
    v_exp_f32 v16, v64
    v_mfma_f32_16x16x32_bf16 v[80:83], v[40:43], a[200:203], v[80:83]
    s_min_u32 s26, s26, s57
    ds_read_b128 v[32:35], v2 offset:12544
    v_fma_f32 v147, v147, v48, v50
    v_mfma_f32_16x16x32_bf16 v[80:83], v[44:47], a[204:207], v[80:83]
    v_exp_f32 v17, v65
    v_fma_f32 v151, v151, v49, v51
    v_mfma_f32_16x16x32_bf16 v[84:87], v[40:43], a[224:227], v[84:87]
    s_mov_b32 m0, s56
    v_exp_f32 v18, v66
    v_mfma_f32_16x16x32_bf16 v[84:87], v[44:47], a[228:231], v[84:87]
    buffer_load_dwordx4 v4, s[4:7], s27 offen offset:0 sc1 lds
    v_lshlrev_b32 v48, 16, v57
    v_mfma_f32_16x16x32_bf16 v[88:91], v[40:43], a[248:251], v[88:91]
    ds_read_b128 v[36:39], v3 offset:12544
    v_add_f32 v5, v5, v16
    v_mfma_f32_16x16x32_bf16 v[88:91], v[44:47], a[252:255], v[88:91]
    v_add_f32 v5, v5, v17
    v_and_b32 v49, s97, v57
    v_lshlrev_b32 v50, 16, v59
    v_mfma_f32_16x16x32_bf16 v[92:95], v[40:43], v[208:211], v[92:95]
    v_exp_f32 v19, v67
    v_mfma_f32_16x16x32_bf16 v[92:95], v[44:47], v[212:215], v[92:95]
    s_waitcnt lgkmcnt(2)
    buffer_load_dwordx4 v4, s[4:7], s27 offen offset:1024 sc1 lds
    v_cvt_pk_bf16_f32 v64, v16, v17
    v_mfma_f32_16x16x32_bf16 v[112:115], v[24:27], a[200:203], v[112:115]
    ds_read_b128 v[40:43], v2 offset:18688
    v_and_b32 v51, s97, v59
    v_mfma_f32_16x16x32_bf16 v[112:115], v[28:31], a[204:207], v[112:115]
    v_exp_f32 v16, v96
    v_add_f32 v5, v5, v18
    v_mfma_f32_16x16x32_bf16 v[116:119], v[24:27], a[224:227], v[116:119]
    v_add_f32 v5, v5, v19
    v_mul_f32_e64 v50, -v50, v48
    v_mfma_f32_16x16x32_bf16 v[116:119], v[28:31], a[228:231], v[116:119]
    s_waitcnt vmcnt(13)
    buffer_load_dwordx4 v4, s[4:7], s27 offen offset:2048 sc1 lds
    v_mul_f32_e64 v51, -v51, v49
    v_mfma_f32_16x16x32_bf16 v[120:123], v[24:27], a[248:251], v[120:123]
    s_add_u32 s27, s27, 24576
    ds_read_b128 v[44:47], v3 offset:18688
    v_cvt_f32_i32 v152, v152
    v_mfma_f32_16x16x32_bf16 v[120:123], v[28:31], a[252:255], v[120:123]
    s_waitcnt lgkmcnt(2)
    v_exp_f32 v17, v97
    v_cvt_pk_bf16_f32 v65, v18, v19
    v_mfma_f32_16x16x32_bf16 v[124:127], v[24:27], v[208:211], v[124:127]
    s_sub_u32 s58, s27, 196608
    v_exp_f32 v18, v98
    v_mfma_f32_16x16x32_bf16 v[124:127], v[28:31], v[212:215], v[124:127]
    s_barrier
    v_subrev_u32 v1, 49152, v1
    v_add_f32 v5, v5, v16
    v_mfma_f32_16x16x32_bf16 v[80:83], v[32:35], a[208:211], v[80:83]
    s_min_u32 s27, s27, s58
    ds_read_b128 v[24:27], v1 offset:0
    v_add_f32 v5, v5, v17
    v_mfma_f32_16x16x32_bf16 v[80:83], v[36:39], a[212:215], v[80:83]
    v_exp_f32 v19, v99
    v_cvt_f32_i32 v156, v156
    v_mfma_f32_16x16x32_bf16 v[84:87], v[32:35], a[232:235], v[84:87]
    s_add_u32 s56, s56, 12288
    v_cvt_pk_bf16_f32 v66, v16, v17
    v_fma_f32 v152, v152, v48, v50
    v_mfma_f32_16x16x32_bf16 v[84:87], v[36:39], a[236:239], v[84:87]
    v_exp_f32 v16, v68
    v_fma_f32 v156, v156, v49, v51
    v_mfma_f32_16x16x32_bf16 v[88:91], v[32:35], v[192:195], v[88:91]
    s_mov_b32 m0, s56
    ds_read_b128 v[28:31], v1 offset:12288
    v_add_f32 v5, v5, v18
    v_mfma_f32_16x16x32_bf16 v[88:91], v[36:39], v[196:199], v[88:91]
    s_waitcnt vmcnt(12)
    buffer_load_dwordx4 v4, s[4:7], s27 offen offset:0 sc1 lds
    v_add_f32 v5, v5, v19
    v_mfma_f32_16x16x32_bf16 v[92:95], v[32:35], v[216:219], v[92:95]
    v_exp_f32 v17, v69
    v_mfma_f32_16x16x32_bf16 v[92:95], v[36:39], v[220:223], v[92:95]
    s_waitcnt lgkmcnt(2)
    v_cvt_f32_i32 v153, v153
    v_cvt_pk_bf16_f32 v67, v18, v19
    v_cvt_f32_i32 v157, v157
    v_mfma_f32_16x16x32_bf16 v[112:115], v[40:43], a[208:211], v[112:115]
    ds_read_b128 v[32:35], v1 offset:1024
    v_fma_f32 v153, v153, v48, v50
    v_mfma_f32_16x16x32_bf16 v[112:115], v[44:47], a[212:215], v[112:115]
    s_waitcnt vmcnt(12)
    buffer_load_dwordx4 v4, s[4:7], s27 offen offset:1024 sc1 lds
    v_fma_f32 v157, v157, v49, v51
    v_mfma_f32_16x16x32_bf16 v[116:119], v[40:43], a[232:235], v[116:119]
    s_waitcnt vmcnt(12)
    buffer_load_dwordx4 v4, s[4:7], s27 offen offset:2048 sc1 lds
    v_mfma_f32_16x16x32_bf16 v[116:119], v[44:47], a[236:239], v[116:119]
    v_exp_f32 v18, v70
    v_add_f32 v6, v6, v16
    v_mfma_f32_16x16x32_bf16 v[120:123], v[40:43], v[192:195], v[120:123]
    s_add_u32 s27, s27, 24576
    ds_read_b128 v[36:39], v1 offset:13312
    v_add_f32 v6, v6, v17
    v_mfma_f32_16x16x32_bf16 v[120:123], v[44:47], v[196:199], v[120:123]
    v_exp_f32 v19, v71
    v_cvt_pk_bf16_f32 v68, v16, v17
    v_mfma_f32_16x16x32_bf16 v[124:127], v[40:43], v[216:219], v[124:127]
    s_sub_u32 s58, s27, 196608
    v_exp_f32 v16, v100
    v_mfma_f32_16x16x32_bf16 v[124:127], v[44:47], v[220:223], v[124:127]
    s_waitcnt lgkmcnt(2)
    v_cvt_f32_i32 v154, v154
    v_add_f32 v6, v6, v18
    v_cvt_f32_i32 v158, v158
    v_add_f32 v6, v6, v19
    v_fma_f32 v154, v154, v48, v50
    v_exp_f32 v17, v101
    v_fma_f32 v158, v158, v49, v51
    v_cvt_f32_i32 v155, v155
    v_cvt_pk_bf16_f32 v69, v18, v19
    v_cvt_f32_i32 v159, v159
    v_exp_f32 v18, v102
    v_fma_f32 v155, v155, v48, v50
    v_fma_f32 v159, v159, v49, v51
    v_add_f32 v6, v6, v16
    v_cvt_pk_bf16_f32 v144, v144, v148
    v_add_f32 v6, v6, v17
    v_cvt_pk_bf16_f32 v148, v145, v149
    v_exp_f32 v19, v103
    v_cvt_pk_bf16_f32 v145, v152, v156
    v_cvt_pk_bf16_f32 v149, v153, v157
    v_cvt_pk_bf16_f32 v70, v16, v17
    s_min_u32 s27, s27, s58
    v_cvt_pk_bf16_f32 v152, v146, v150
    v_add_f32 v6, v6, v18
    s_add_u32 s56, s56, 36864
    v_cvt_pk_bf16_f32 v153, v154, v158
    v_add_f32 v6, v6, v19
    s_sub_u32 s58, s56, 147456
    v_cvt_pk_bf16_f32 v156, v147, v151
    v_cvt_pk_bf16_f32 v71, v18, v19
    s_min_u32 s56, s56, s58
    v_cvt_pk_bf16_f32 v157, v155, v159
    s_mov_b32 s31, 7
    v_mfma_f32_16x16x32_bf16 a[96:99], v[24:27], v[160:163], 0
    s_add_u32 s33, s33, 196608
    ds_read_b128 v[40:43], v1 offset:2048
    v_mfma_f32_16x16x32_bf16 a[96:99], v[28:31], v[168:171], a[96:99]
    s_add_u32 s34, s34, 196608
    v_exp_f32 v16, v72
    v_mfma_f32_16x16x32_bf16 a[144:147], v[24:27], v[164:167], 0
    s_add_u32 s36, s36, 1536
    ds_read_b128 v[44:47], v1 offset:14336
    v_mfma_f32_16x16x32_bf16 a[144:147], v[28:31], v[172:175], a[144:147]
    s_waitcnt lgkmcnt(2)
    v_exp_f32 v17, v73
    v_mfma_f32_16x16x32_bf16 a[100:103], v[32:35], v[160:163], 0
    ds_read_b128 v[24:27], v1 offset:3072
    v_mfma_f32_16x16x32_bf16 a[100:103], v[36:39], v[168:171], a[100:103]
    s_waitcnt vmcnt(12)
    buffer_load_dwordx2 v[56:57], v10, s[72:75], s36 offen offset:0
    v_mfma_f32_16x16x32_bf16 a[148:151], v[32:35], v[164:167], 0
    ds_read_b128 v[28:31], v1 offset:15360
    v_mfma_f32_16x16x32_bf16 a[148:151], v[36:39], v[172:175], a[148:151]
    s_waitcnt lgkmcnt(2)
    v_exp_f32 v18, v74
    v_mfma_f32_16x16x32_bf16 a[104:107], v[40:43], v[160:163], 0
    ds_read_b128 v[32:35], v1 offset:4096
    v_add_f32 v7, v7, v16
    v_mfma_f32_16x16x32_bf16 a[104:107], v[44:47], v[168:171], a[104:107]
    buffer_load_dwordx2 v[58:59], v10, s[76:79], s36 offen offset:0
    v_mfma_f32_16x16x32_bf16 a[152:155], v[40:43], v[164:167], 0
    ds_read_b128 v[36:39], v1 offset:16384
    v_add_f32 v7, v7, v17
    v_mfma_f32_16x16x32_bf16 a[152:155], v[44:47], v[172:175], a[152:155]
    s_waitcnt lgkmcnt(2)
    v_exp_f32 v19, v75
    v_mfma_f32_16x16x32_bf16 a[108:111], v[24:27], v[160:163], 0
    ds_read_b128 v[40:43], v1 offset:5120
    v_cvt_pk_bf16_f32 v72, v16, v17
    v_mfma_f32_16x16x32_bf16 a[108:111], v[28:31], v[168:171], a[108:111]
    s_waitcnt vmcnt(13)
    buffer_load_dwordx4 v[224:227], v9, s[64:67], s33 offen offset:0 nt
    v_mfma_f32_16x16x32_bf16 a[156:159], v[24:27], v[164:167], 0
    ds_read_b128 v[44:47], v1 offset:17408
    v_mfma_f32_16x16x32_bf16 a[156:159], v[28:31], v[172:175], a[156:159]
    s_waitcnt lgkmcnt(2)
    v_exp_f32 v16, v104
    v_mfma_f32_16x16x32_bf16 a[112:115], v[32:35], v[160:163], 0
    ds_read_b128 v[24:27], v1 offset:6144
    v_add_f32 v7, v7, v18
    v_mfma_f32_16x16x32_bf16 a[112:115], v[36:39], v[168:171], a[112:115]
    s_waitcnt vmcnt(13)
    buffer_load_dwordx4 v[228:231], v9, s[64:67], s33 offen offset:1536 nt
    v_add_f32 v7, v7, v19
    v_mfma_f32_16x16x32_bf16 a[160:163], v[32:35], v[164:167], 0
    ds_read_b128 v[28:31], v1 offset:18432
    v_mfma_f32_16x16x32_bf16 a[160:163], v[36:39], v[172:175], a[160:163]
    s_waitcnt lgkmcnt(2)
    v_exp_f32 v17, v105
    v_cvt_pk_bf16_f32 v73, v18, v19
    v_mfma_f32_16x16x32_bf16 a[116:119], v[40:43], v[160:163], 0
    ds_read_b128 v[32:35], v1 offset:7168
    v_mfma_f32_16x16x32_bf16 a[116:119], v[44:47], v[168:171], a[116:119]
    buffer_load_dwordx4 v[232:235], v9, s[64:67], s34 offen offset:0 nt
    v_mfma_f32_16x16x32_bf16 a[164:167], v[40:43], v[164:167], 0
    ds_read_b128 v[36:39], v1 offset:19456
    v_mfma_f32_16x16x32_bf16 a[164:167], v[44:47], v[172:175], a[164:167]
    s_waitcnt lgkmcnt(2)
    v_exp_f32 v18, v106
    v_add_f32 v7, v7, v16
    v_mfma_f32_16x16x32_bf16 a[120:123], v[24:27], v[160:163], 0
    ds_read_b128 v[40:43], v1 offset:8192
    v_add_f32 v7, v7, v17
    v_mfma_f32_16x16x32_bf16 a[120:123], v[28:31], v[168:171], a[120:123]
    s_waitcnt vmcnt(14)
    buffer_load_dwordx4 v[236:239], v9, s[64:67], s34 offen offset:1536 nt
    v_mfma_f32_16x16x32_bf16 a[168:171], v[24:27], v[164:167], 0
    ds_read_b128 v[44:47], v1 offset:20480
    v_mfma_f32_16x16x32_bf16 a[168:171], v[28:31], v[172:175], a[168:171]
    s_waitcnt lgkmcnt(2)
    v_exp_f32 v19, v107
    v_cvt_pk_bf16_f32 v74, v16, v17
    v_mfma_f32_16x16x32_bf16 a[124:127], v[32:35], v[160:163], 0
    ds_read_b128 v[24:27], v1 offset:9216
    v_mfma_f32_16x16x32_bf16 a[124:127], v[36:39], v[168:171], a[124:127]
    v_exp_f32 v16, v76
    v_add_f32 v7, v7, v18
    v_mfma_f32_16x16x32_bf16 a[172:175], v[32:35], v[164:167], 0
    s_waitcnt vmcnt(19)
    ds_read_b128 v[28:31], v1 offset:21504
    v_add_f32 v7, v7, v19
    v_mfma_f32_16x16x32_bf16 a[172:175], v[36:39], v[172:175], a[172:175]
    s_waitcnt lgkmcnt(2)
    v_exp_f32 v17, v77
    v_cvt_pk_bf16_f32 v75, v18, v19
    v_mfma_f32_16x16x32_bf16 a[128:131], v[40:43], v[160:163], 0
    s_add_u32 s29, s28, 49152
    ds_read_b128 v[32:35], v1 offset:10240
    v_lshlrev_b32 v48, 16, v60
    v_mfma_f32_16x16x32_bf16 a[128:131], v[44:47], v[168:171], a[128:131]
    v_exp_f32 v18, v78
    v_add_f32 v8, v8, v16
    v_mfma_f32_16x16x32_bf16 a[176:179], v[40:43], v[164:167], 0
    s_sub_u32 s3, s29, 147456
    ds_read_b128 v[36:39], v1 offset:22528
    v_add_f32 v8, v8, v17
    v_mfma_f32_16x16x32_bf16 a[176:179], v[44:47], v[172:175], a[176:179]
    s_waitcnt lgkmcnt(2)
    v_exp_f32 v19, v79
    v_mfma_f32_16x16x32_bf16 a[132:135], v[24:27], v[160:163], 0
    s_min_u32 s29, s29, s3
    ds_read_b128 v[40:43], v1 offset:11264
    v_cvt_pk_bf16_f32 v76, v16, v17
    v_mfma_f32_16x16x32_bf16 a[132:135], v[28:31], v[168:171], a[132:135]
    v_exp_f32 v16, v108
    v_mfma_f32_16x16x32_bf16 a[180:183], v[24:27], v[164:167], 0
    s_sub_u32 s3, s29, s28
    ds_read_b128 v[44:47], v1 offset:23552
    v_and_b32 v49, s97, v60
    v_mfma_f32_16x16x32_bf16 a[180:183], v[28:31], v[172:175], a[180:183]
    s_waitcnt lgkmcnt(2)
    v_add_u32 v1, 49152, v1
    v_add_f32 v8, v8, v18
    v_mfma_f32_16x16x32_bf16 a[136:139], v[32:35], v[160:163], 0
    ds_read_b128 v[24:27], v1 offset:0
    v_add_f32 v8, v8, v19
    v_mfma_f32_16x16x32_bf16 a[136:139], v[36:39], v[168:171], a[136:139]
    v_lshlrev_b32 v50, 16, v62
    v_exp_f32 v17, v109
    v_mfma_f32_16x16x32_bf16 a[184:187], v[32:35], v[164:167], 0
    ds_read_b128 v[28:31], v1 offset:12288
    v_and_b32 v51, s97, v62
    v_mfma_f32_16x16x32_bf16 a[184:187], v[36:39], v[172:175], a[184:187]
    s_waitcnt lgkmcnt(2)
    v_cvt_pk_bf16_f32 v77, v18, v19
    v_mul_f32_e64 v50, -v50, v48
    v_mfma_f32_16x16x32_bf16 a[140:143], v[40:43], v[160:163], 0
    s_mov_b32 s28, s29
    ds_read_b128 v[32:35], v1 offset:1024
    v_bfe_u32 v53, v4, 4, 6
    v_mfma_f32_16x16x32_bf16 a[140:143], v[44:47], v[168:171], a[140:143]
    v_exp_f32 v18, v110
    v_mul_f32_e64 v51, -v51, v49
    v_mfma_f32_16x16x32_bf16 a[188:191], v[40:43], v[164:167], 0
    ds_read_b128 v[36:39], v1 offset:13312
    v_lshlrev_b32 v53, 2, v53
    v_mfma_f32_16x16x32_bf16 a[188:191], v[44:47], v[172:175], a[188:191]
    s_waitcnt lgkmcnt(2)
    s_barrier
    v_add_f32 v8, v8, v16
    v_mfma_f32_16x16x32_bf16 a[96:99], v[24:27], v[176:179], a[96:99]
    ds_read_b128 v[40:43], v1 offset:2048
    buffer_load_dword v52, v53, s[20:23], s44 offen sc1
    v_mfma_f32_16x16x32_bf16 a[96:99], v[28:31], v[184:187], a[96:99]
    v_add_f32 v8, v8, v17
    v_cvt_f32_i32 v240, v240
    v_cvt_f32_i32 v244, v244
    v_mfma_f32_16x16x32_bf16 a[144:147], v[24:27], v[180:183], a[144:147]
    ds_read_b128 v[44:47], v1 offset:14336
    v_fma_f32 v240, v240, v48, v50
    v_mfma_f32_16x16x32_bf16 a[144:147], v[28:31], v[188:191], a[144:147]
    s_waitcnt lgkmcnt(2)
    v_exp_f32 v19, v111
    v_cvt_pk_bf16_f32 v78, v16, v17
    v_mfma_f32_16x16x32_bf16 a[100:103], v[32:35], v[176:179], a[100:103]
    s_mov_b32 m0, s56
    ds_read_b128 v[24:27], v1 offset:3072
    v_add_f32 v8, v8, v18
    v_mfma_f32_16x16x32_bf16 a[100:103], v[36:39], v[184:187], a[100:103]
    s_waitcnt vmcnt(15)
    buffer_load_dwordx4 v4, s[4:7], s27 offen offset:0 sc1 lds
    v_add_f32 v8, v8, v19
    v_mfma_f32_16x16x32_bf16 a[148:151], v[32:35], v[180:183], a[148:151]
    ds_read_b128 v[28:31], v1 offset:15360
    v_fma_f32 v244, v244, v49, v51
    v_mfma_f32_16x16x32_bf16 a[148:151], v[36:39], v[188:191], a[148:151]
    s_waitcnt lgkmcnt(2)
    v_cvt_pk_bf16_f32 v79, v18, v19
    v_cvt_f32_i32 v241, v241
    v_cvt_f32_i32 v245, v245
    v_mfma_f32_16x16x32_bf16 a[104:107], v[40:43], v[176:179], a[104:107]
    ds_read_b128 v[32:35], v1 offset:4096
    v_fma_f32 v241, v241, v48, v50
    v_mfma_f32_16x16x32_bf16 a[104:107], v[44:47], v[184:187], a[104:107]
    s_waitcnt vmcnt(14)
    buffer_load_dwordx4 v4, s[4:7], s27 offen offset:1024 sc1 lds
    v_fma_f32 v245, v245, v49, v51
    v_mfma_f32_16x16x32_bf16 a[152:155], v[40:43], v[180:183], a[152:155]
    ds_read_b128 v[36:39], v1 offset:16384
    v_cvt_f32_i32 v242, v242
    v_mfma_f32_16x16x32_bf16 a[152:155], v[44:47], v[188:191], a[152:155]
    s_waitcnt lgkmcnt(2)
    v_exp_f32 v16, v80
    v_cvt_f32_i32 v246, v246
    v_mfma_f32_16x16x32_bf16 a[108:111], v[24:27], v[176:179], a[108:111]
    ds_read_b128 v[40:43], v1 offset:5120
    v_fma_f32 v242, v242, v48, v50
    v_mfma_f32_16x16x32_bf16 a[108:111], v[28:31], v[184:187], a[108:111]
    s_waitcnt vmcnt(14)
    buffer_load_dwordx4 v4, s[4:7], s27 offen offset:2048 sc1 lds
    v_fma_f32 v246, v246, v49, v51
    v_mfma_f32_16x16x32_bf16 a[156:159], v[24:27], v[180:183], a[156:159]
    s_add_u32 s27, s27, 24576
    ds_read_b128 v[44:47], v1 offset:17408
    v_cvt_f32_i32 v243, v243
    v_mfma_f32_16x16x32_bf16 a[156:159], v[28:31], v[188:191], a[156:159]
    s_waitcnt lgkmcnt(2)
    v_exp_f32 v17, v81
    v_cvt_f32_i32 v247, v247
    v_mfma_f32_16x16x32_bf16 a[112:115], v[32:35], v[176:179], a[112:115]
    s_sub_u32 s58, s27, 196608
    ds_read_b128 v[24:27], v1 offset:6144
    v_fma_f32 v243, v243, v48, v50
    v_mfma_f32_16x16x32_bf16 a[112:115], v[36:39], v[184:187], a[112:115]
    v_exp_f32 v18, v82
    v_add_f32 v5, v5, v16
    v_mfma_f32_16x16x32_bf16 a[160:163], v[32:35], v[180:183], a[160:163]
    s_min_u32 s27, s27, s58
    ds_read_b128 v[28:31], v1 offset:18432
    v_add_f32 v5, v5, v17
    v_mfma_f32_16x16x32_bf16 a[160:163], v[36:39], v[188:191], a[160:163]
    s_waitcnt lgkmcnt(2)
    v_exp_f32 v19, v83
    v_cvt_pk_bf16_f32 v80, v16, v17
    v_mfma_f32_16x16x32_bf16 a[116:119], v[40:43], v[176:179], a[116:119]
    s_add_u32 s56, s56, 12288
    ds_read_b128 v[32:35], v1 offset:7168
    v_fma_f32 v247, v247, v49, v51
    v_mfma_f32_16x16x32_bf16 a[116:119], v[44:47], v[184:187], a[116:119]
    v_exp_f32 v16, v112
    v_add_f32 v5, v5, v18
    v_mfma_f32_16x16x32_bf16 a[164:167], v[40:43], v[180:183], a[164:167]
    ds_read_b128 v[36:39], v1 offset:19456
    v_add_u32 v2, s3, v2
    v_add_u32 v3, s3, v3
    v_mfma_f32_16x16x32_bf16 a[164:167], v[44:47], v[188:191], a[164:167]
    s_waitcnt lgkmcnt(2)
    v_add_f32 v5, v5, v19
    v_exp_f32 v17, v113
    v_mfma_f32_16x16x32_bf16 a[120:123], v[24:27], v[176:179], a[120:123]
    s_mov_b32 m0, s56
    ds_read_b128 v[40:43], v1 offset:8192
    v_cvt_pk_bf16_f32 v81, v18, v19
    v_mfma_f32_16x16x32_bf16 a[120:123], v[28:31], v[184:187], a[120:123]
    s_waitcnt vmcnt(14)
    buffer_load_dwordx4 v4, s[4:7], s27 offen offset:0 sc1 lds
    v_lshlrev_b32 v48, 16, v61
    v_mfma_f32_16x16x32_bf16 a[168:171], v[24:27], v[180:183], a[168:171]
    ds_read_b128 v[44:47], v1 offset:20480
    v_and_b32 v49, s97, v61
    v_mfma_f32_16x16x32_bf16 a[168:171], v[28:31], v[188:191], a[168:171]
    s_waitcnt lgkmcnt(2)
    v_exp_f32 v18, v114
    v_add_f32 v5, v5, v16
    v_mfma_f32_16x16x32_bf16 a[124:127], v[32:35], v[176:179], a[124:127]
    ds_read_b128 v[24:27], v1 offset:9216
    v_add_f32 v5, v5, v17
    v_mfma_f32_16x16x32_bf16 a[124:127], v[36:39], v[184:187], a[124:127]
    s_waitcnt vmcnt(14)
    buffer_load_dwordx4 v4, s[4:7], s27 offen offset:1024 sc1 lds
    v_lshlrev_b32 v50, 16, v63
    v_mfma_f32_16x16x32_bf16 a[172:175], v[32:35], v[180:183], a[172:175]
    ds_read_b128 v[28:31], v1 offset:21504
    v_and_b32 v51, s97, v63
    v_mfma_f32_16x16x32_bf16 a[172:175], v[36:39], v[188:191], a[172:175]
    s_waitcnt lgkmcnt(2)
    v_exp_f32 v19, v115
    v_cvt_pk_bf16_f32 v82, v16, v17
    v_mfma_f32_16x16x32_bf16 a[128:131], v[40:43], v[176:179], a[128:131]
    ds_read_b128 v[32:35], v1 offset:10240
    v_mul_f32_e64 v50, -v50, v48
    v_mfma_f32_16x16x32_bf16 a[128:131], v[44:47], v[184:187], a[128:131]
    s_waitcnt vmcnt(14)
    buffer_load_dwordx4 v4, s[4:7], s27 offen offset:2048 sc1 lds
    v_mul_f32_e64 v51, -v51, v49
    v_mfma_f32_16x16x32_bf16 a[176:179], v[40:43], v[180:183], a[176:179]
    ds_read_b128 v[36:39], v1 offset:22528
    v_cvt_f32_i32 v248, v248
    v_mfma_f32_16x16x32_bf16 a[176:179], v[44:47], v[188:191], a[176:179]
    s_waitcnt lgkmcnt(2)
    v_exp_f32 v16, v84
    v_add_f32 v5, v5, v18
    v_mfma_f32_16x16x32_bf16 a[132:135], v[24:27], v[176:179], a[132:135]
    ds_read_b128 v[40:43], v1 offset:11264
    v_add_f32 v5, v5, v19
    v_mfma_f32_16x16x32_bf16 a[132:135], v[28:31], v[184:187], a[132:135]
    s_waitcnt vmcnt(19)
    v_exp_f32 v17, v85
    v_cvt_f32_i32 v252, v252
    v_mfma_f32_16x16x32_bf16 a[180:183], v[24:27], v[180:183], a[180:183]
    s_mov_b32 s27, 208896
    ds_read_b128 v[44:47], v1 offset:23552
    v_cvt_pk_bf16_f32 v83, v18, v19
    v_mfma_f32_16x16x32_bf16 a[180:183], v[28:31], v[188:191], a[180:183]
    s_waitcnt lgkmcnt(2)
    s_barrier
    v_fma_f32 v248, v248, v48, v50
    v_mfma_f32_16x16x32_bf16 a[136:139], v[32:35], v[176:179], a[136:139]
    s_add_u32 s56, s56, 36864
    ds_read_b128 v[24:27], v2 offset:0
    v_fma_f32 v252, v252, v49, v51
    v_mfma_f32_16x16x32_bf16 a[136:139], v[36:39], v[184:187], a[136:139]
    v_exp_f32 v18, v86
    v_add_f32 v6, v6, v16
    v_mfma_f32_16x16x32_bf16 a[184:187], v[32:35], v[180:183], a[184:187]
    s_sub_u32 s58, s56, 147456
    ds_read_b128 v[28:31], v3 offset:0
    v_cvt_f32_i32 v249, v249
    v_mfma_f32_16x16x32_bf16 a[184:187], v[36:39], v[188:191], a[184:187]
    s_waitcnt lgkmcnt(2)
    v_add_f32 v6, v6, v17
    v_cvt_f32_i32 v253, v253
    v_fma_f32 v249, v249, v48, v50
    v_mfma_f32_16x16x32_bf16 a[140:143], v[40:43], v[176:179], a[140:143]
    s_nop 0
    ds_read_b128 v[32:35], v2 offset:6144
    v_fma_f32 v253, v253, v49, v51
    v_mfma_f32_16x16x32_bf16 a[140:143], v[44:47], v[184:187], a[140:143]
    s_min_u32 s56, s56, s58
    v_exp_f32 v19, v87
    v_cvt_pk_bf16_f32 v84, v16, v17
    v_mfma_f32_16x16x32_bf16 a[188:191], v[40:43], v[180:183], a[188:191]
    s_waitcnt lgkmcnt(1)
    ds_read_b128 v[36:39], v3 offset:6144
    v_exp_f32 v16, v116
    v_cvt_f32_i32 v250, v250
    v_add_f32 v6, v6, v18
    v_cvt_f32_i32 v254, v254
    v_add_f32 v6, v6, v19
    v_fma_f32 v250, v250, v48, v50
    v_exp_f32 v17, v117
    v_fma_f32 v254, v254, v49, v51
    v_cvt_f32_i32 v251, v251
    v_cvt_pk_bf16_f32 v85, v18, v19
    v_cvt_f32_i32 v255, v255
    v_exp_f32 v18, v118
    v_fma_f32 v251, v251, v48, v50
    v_fma_f32 v255, v255, v49, v51
    v_add_f32 v6, v6, v16
    v_cvt_pk_bf16_f32 v146, v240, v244
    v_add_f32 v6, v6, v17
    v_cvt_pk_bf16_f32 v150, v241, v245
    v_exp_f32 v19, v119
    v_cvt_pk_bf16_f32 v147, v248, v252
    v_cvt_pk_bf16_f32 v151, v249, v253
    v_cvt_pk_bf16_f32 v86, v16, v17
    v_cvt_pk_bf16_f32 v154, v242, v246
    v_add_f32 v6, v6, v18
    v_cvt_pk_bf16_f32 v155, v250, v254
    v_add_f32 v6, v6, v19
    v_cvt_pk_bf16_f32 v158, v243, v247
    v_cvt_pk_bf16_f32 v87, v18, v19
    v_cvt_pk_bf16_f32 v159, v251, v255
    v_mfma_f32_16x16x32_bf16 a[188:191], v[44:47], v[188:191], a[188:191]
    s_branch L_join
.p2align 6
L_loop:
    v_mfma_f32_16x16x32_bf16 v[160:163], v[24:27], a[192:195], v[128:131]
    s_mov_b32 m0, s56
    ds_read_b128 v[40:43], v2 offset:128
    v_fma_f32 v250, v250, v48, v50
    v_mfma_f32_16x16x32_bf16 v[160:163], v[28:31], a[196:199], v[160:163]
    buffer_load_dwordx4 v4, s[4:7], s27 offen offset:0 sc1 lds
    v_mfma_f32_16x16x32_bf16 v[164:167], v[24:27], a[216:219], v[132:135]
    v_exp_f32 v16, v88
    v_mfma_f32_16x16x32_bf16 v[164:167], v[28:31], a[220:223], v[164:167]
    v_exp_f32 v17, v89
    v_mfma_f32_16x16x32_bf16 v[168:171], v[24:27], a[240:243], v[136:139]
    ds_read_b128 v[44:47], v3 offset:128
    v_fma_f32 v251, v251, v49, v51
    v_mfma_f32_16x16x32_bf16 v[168:171], v[28:31], a[244:247], v[168:171]
    v_exp_f32 v18, v90
    v_mfma_f32_16x16x32_bf16 v[172:175], v[24:27], v[200:203], v[140:143]
    v_add_f32 v7, v7, v16
    v_add_f32 v7, v7, v17
    v_mfma_f32_16x16x32_bf16 v[172:175], v[28:31], v[204:207], v[172:175]
    s_waitcnt lgkmcnt(2)
    v_exp_f32 v19, v91
    v_mfma_f32_16x16x32_bf16 v[96:99], v[32:35], a[192:195], v[128:131]
    ds_read_b128 v[24:27], v2 offset:6272
    v_cvt_pk_bf16_f32 v235, v250, v251
    v_mfma_f32_16x16x32_bf16 v[96:99], v[36:39], a[196:199], v[96:99]
    buffer_load_dwordx4 v4, s[4:7], s27 offen offset:1024 sc1 lds
    v_mfma_f32_16x16x32_bf16 v[100:103], v[32:35], a[216:219], v[132:135]
    v_cvt_pk_bf16_f32 v88, v16, v17
    v_cvt_f32_i32 v254, v254
    v_mfma_f32_16x16x32_bf16 v[100:103], v[36:39], a[220:223], v[100:103]
    v_exp_f32 v16, v120
    v_mfma_f32_16x16x32_bf16 v[104:107], v[32:35], a[240:243], v[136:139]
    ds_read_b128 v[28:31], v3 offset:6272
    v_add_f32 v7, v7, v18
    v_mfma_f32_16x16x32_bf16 v[104:107], v[36:39], a[244:247], v[104:107]
    v_add_f32 v7, v7, v19
    v_cvt_f32_i32 v255, v255
    v_mfma_f32_16x16x32_bf16 v[108:111], v[32:35], v[200:203], v[140:143]
    v_exp_f32 v17, v121
    v_mfma_f32_16x16x32_bf16 v[108:111], v[36:39], v[204:207], v[108:111]
    s_waitcnt lgkmcnt(2)
    v_cvt_pk_bf16_f32 v89, v18, v19
    v_fma_f32 v254, v254, v48, v50
    v_mfma_f32_16x16x32_bf16 v[160:163], v[40:43], a[200:203], v[160:163]
    ds_read_b128 v[32:35], v2 offset:256
    v_mfma_f32_16x16x32_bf16 v[160:163], v[44:47], a[204:207], v[160:163]
    v_exp_f32 v18, v122
    v_mfma_f32_16x16x32_bf16 v[164:167], v[40:43], a[224:227], v[164:167]
    v_add_f32 v7, v7, v16
    v_add_f32 v7, v7, v17
    v_mfma_f32_16x16x32_bf16 v[164:167], v[44:47], a[228:231], v[164:167]
    buffer_load_dwordx4 v4, s[4:7], s27 offen offset:2048 sc1 lds
    v_mfma_f32_16x16x32_bf16 v[168:171], v[40:43], a[248:251], v[168:171]
    ds_read_b128 v[36:39], v3 offset:256
    v_fma_f32 v255, v255, v49, v51
    v_mfma_f32_16x16x32_bf16 v[168:171], v[44:47], a[252:255], v[168:171]
    v_exp_f32 v19, v123
    v_mfma_f32_16x16x32_bf16 v[172:175], v[40:43], v[208:211], v[172:175]
    v_cvt_pk_bf16_f32 v90, v16, v17
    v_cvt_pk_bf16_f32 v239, v254, v255
    v_mfma_f32_16x16x32_bf16 v[172:175], v[44:47], v[212:215], v[172:175]
    s_waitcnt lgkmcnt(2)
    v_exp_f32 v16, v92
    v_mfma_f32_16x16x32_bf16 v[96:99], v[24:27], a[200:203], v[96:99]
    ds_read_b128 v[40:43], v2 offset:6400
    v_add_f32 v7, v7, v18
    v_mfma_f32_16x16x32_bf16 v[96:99], v[28:31], a[204:207], v[96:99]
    s_add_u32 s27, s27, 24576
    v_add_f32 v7, v7, v19
    v_mfma_f32_16x16x32_bf16 v[100:103], v[24:27], a[224:227], v[100:103]
    v_exp_f32 v17, v93
    v_mfma_f32_16x16x32_bf16 v[100:103], v[28:31], a[228:231], v[100:103]
    v_cvt_pk_bf16_f32 v91, v18, v19
    v_mfma_f32_16x16x32_bf16 v[104:107], v[24:27], a[248:251], v[104:107]
    ds_read_b128 v[44:47], v3 offset:6400
    v_mfma_f32_16x16x32_bf16 v[104:107], v[28:31], a[252:255], v[104:107]
    v_exp_f32 v18, v94
    v_mfma_f32_16x16x32_bf16 v[108:111], v[24:27], v[208:211], v[108:111]
    s_add_u32 s29, s30, 49152
    v_add_f32 v8, v8, v16
    v_add_f32 v8, v8, v17
    v_mfma_f32_16x16x32_bf16 v[108:111], v[28:31], v[212:215], v[108:111]
    s_waitcnt lgkmcnt(2)
    v_exp_f32 v19, v95
    v_mfma_f32_16x16x32_bf16 v[160:163], v[32:35], a[208:211], v[160:163]
    s_waitcnt vmcnt(11)
    ds_read_b128 v[24:27], v2 offset:12288
    v_cvt_pk_bf16_f32 v92, v16, v17
    v_mfma_f32_16x16x32_bf16 v[160:163], v[36:39], a[212:215], v[160:163]
    s_sub_u32 s3, s29, 147456
    buffer_load_dwordx2 v[60:61], off, s[80:83], s37 offset:8
    v_mfma_f32_16x16x32_bf16 v[164:167], v[32:35], a[232:235], v[164:167]
    s_add_u32 s56, s56, 12288
    v_exp_f32 v16, v124
    v_mfma_f32_16x16x32_bf16 v[164:167], v[36:39], a[236:239], v[164:167]
    s_min_u32 s29, s29, s3
    v_add_f32 v8, v8, v18
    v_lshlrev_b32 v48, 16, v56
    v_mfma_f32_16x16x32_bf16 v[168:171], v[32:35], v[192:195], v[168:171]
    s_mov_b32 m0, s56
    ds_read_b128 v[28:31], v3 offset:12288
    v_add_f32 v8, v8, v19
    v_mfma_f32_16x16x32_bf16 v[168:171], v[36:39], v[196:199], v[168:171]
    buffer_load_dwordx2 v[62:63], off, s[84:87], s37 offset:8
    v_mfma_f32_16x16x32_bf16 v[172:175], v[32:35], v[216:219], v[172:175]
    v_exp_f32 v17, v125
    v_mfma_f32_16x16x32_bf16 v[172:175], v[36:39], v[220:223], v[172:175]
    s_waitcnt lgkmcnt(2)
    v_cvt_pk_bf16_f32 v93, v18, v19
    v_and_b32 v49, s97, v56
    v_mfma_f32_16x16x32_bf16 v[96:99], v[40:43], a[208:211], v[96:99]
    ds_read_b128 v[32:35], v2 offset:18432
    v_lshlrev_b32 v50, 16, v58
    v_mfma_f32_16x16x32_bf16 v[96:99], v[44:47], a[212:215], v[96:99]
    s_sub_u32 s3, s29, s30
    v_exp_f32 v18, v126
    v_mfma_f32_16x16x32_bf16 v[100:103], v[40:43], a[232:235], v[100:103]
    v_add_f32 v8, v8, v16
    v_add_f32 v8, v8, v17
    v_mfma_f32_16x16x32_bf16 v[100:103], v[44:47], a[236:239], v[100:103]
    buffer_load_dwordx4 v4, s[4:7], s27 offen offset:0 sc1 lds
    v_mfma_f32_16x16x32_bf16 v[104:107], v[40:43], v[192:195], v[104:107]
    ds_read_b128 v[36:39], v3 offset:18432
    v_and_b32 v51, s97, v58
    v_mfma_f32_16x16x32_bf16 v[104:107], v[44:47], v[196:199], v[104:107]
    v_exp_f32 v19, v127
    v_mfma_f32_16x16x32_bf16 v[108:111], v[40:43], v[216:219], v[108:111]
    v_cvt_pk_bf16_f32 v94, v16, v17
    v_add_f32 v8, v8, v18
    v_mfma_f32_16x16x32_bf16 v[108:111], v[44:47], v[220:223], v[108:111]
    s_waitcnt lgkmcnt(2)
    buffer_load_dwordx4 v[240:243], v12, s[68:71], s16 offen offset:0 nt
    v_mfma_f32_16x16x32_bf16 v[176:179], v[24:27], a[192:195], v[128:131]
    ds_read_b128 v[40:43], v2 offset:12416
    v_add_f32 v8, v8, v19
    v_mfma_f32_16x16x32_bf16 v[176:179], v[28:31], a[196:199], v[176:179]
    s_mov_b32 s30, s29
    v_cvt_pk_bf16_f32 v95, v18, v19
    v_mul_f32_e64 v50, -v50, v48
    v_mfma_f32_16x16x32_bf16 v[180:183], v[24:27], a[216:219], v[132:135]
    v_exp_f32 v16, v160
    v_mfma_f32_16x16x32_bf16 v[180:183], v[28:31], a[220:223], v[180:183]
    buffer_load_dwordx4 v4, s[4:7], s27 offen offset:1024 sc1 lds
    v_mfma_f32_16x16x32_bf16 v[184:187], v[24:27], a[240:243], v[136:139]
    ds_read_b128 v[44:47], v3 offset:12416
    v_mul_f32_e64 v51, -v51, v49
    v_mfma_f32_16x16x32_bf16 v[184:187], v[28:31], a[244:247], v[184:187]
    v_exp_f32 v17, v161
    v_mfma_f32_16x16x32_bf16 v[188:191], v[24:27], v[200:203], v[140:143]
    v_exp_f32 v18, v162
    v_mfma_f32_16x16x32_bf16 v[188:191], v[28:31], v[204:207], v[188:191]
    s_waitcnt lgkmcnt(2)
    buffer_load_dwordx4 v[244:247], v12, s[68:71], s16 offen offset:768 nt
    v_mfma_f32_16x16x32_bf16 v[112:115], v[32:35], a[192:195], v[128:131]
    ds_read_b128 v[24:27], v2 offset:18560
    v_add_f32 v5, v5, v16
    v_mfma_f32_16x16x32_bf16 v[112:115], v[36:39], a[196:199], v[112:115]
    v_add_f32 v5, v5, v17
    v_cvt_f32_i32 v144, v144
    v_mfma_f32_16x16x32_bf16 v[116:119], v[32:35], a[216:219], v[132:135]
    v_exp_f32 v19, v163
    v_mfma_f32_16x16x32_bf16 v[116:119], v[36:39], a[220:223], v[116:119]
    v_cvt_pk_bf16_f32 v160, v16, v17
    v_cvt_f32_i32 v148, v148
    v_mfma_f32_16x16x32_bf16 v[120:123], v[32:35], a[240:243], v[136:139]
    ds_read_b128 v[28:31], v3 offset:18560
    v_fma_f32 v144, v144, v48, v50
    v_mfma_f32_16x16x32_bf16 v[120:123], v[36:39], a[244:247], v[120:123]
    buffer_load_dwordx4 v[248:251], v12, s[68:71], s16 offen offset:1536 nt
    v_mfma_f32_16x16x32_bf16 v[124:127], v[32:35], v[200:203], v[140:143]
    v_exp_f32 v16, v96
    v_mfma_f32_16x16x32_bf16 v[124:127], v[36:39], v[204:207], v[124:127]
    s_waitcnt lgkmcnt(2)
    v_add_f32 v5, v5, v18
    v_add_f32 v5, v5, v19
    v_mfma_f32_16x16x32_bf16 v[176:179], v[40:43], a[200:203], v[176:179]
    ds_read_b128 v[32:35], v2 offset:12544
    v_fma_f32 v148, v148, v49, v51
    v_mfma_f32_16x16x32_bf16 v[176:179], v[44:47], a[204:207], v[176:179]
    buffer_load_dwordx4 v4, s[4:7], s27 offen offset:2048 sc1 lds
    v_mfma_f32_16x16x32_bf16 v[180:183], v[40:43], a[224:227], v[180:183]
    v_exp_f32 v17, v97
    v_mfma_f32_16x16x32_bf16 v[180:183], v[44:47], a[228:231], v[180:183]
    v_cvt_pk_bf16_f32 v161, v18, v19
    v_cvt_f32_i32 v145, v145
    v_mfma_f32_16x16x32_bf16 v[184:187], v[40:43], a[248:251], v[184:187]
    ds_read_b128 v[36:39], v3 offset:12544
    v_add_u32 v1, s3, v1
    v_mfma_f32_16x16x32_bf16 v[184:187], v[44:47], a[252:255], v[184:187]
    buffer_load_dwordx4 v[252:255], v12, s[68:71], s16 offen offset:2304 nt
    v_mfma_f32_16x16x32_bf16 v[188:191], v[40:43], v[208:211], v[188:191]
    v_exp_f32 v18, v98
    v_mfma_f32_16x16x32_bf16 v[188:191], v[44:47], v[212:215], v[188:191]
    s_waitcnt lgkmcnt(2)
    v_add_f32 v5, v5, v16
    v_add_f32 v5, v5, v17
    v_mfma_f32_16x16x32_bf16 v[112:115], v[24:27], a[200:203], v[112:115]
    ds_read_b128 v[40:43], v2 offset:18688
    v_cvt_f32_i32 v149, v149
    v_mfma_f32_16x16x32_bf16 v[112:115], v[28:31], a[204:207], v[112:115]
    v_exp_f32 v19, v99
    v_cvt_pk_bf16_f32 v162, v16, v17
    v_mfma_f32_16x16x32_bf16 v[116:119], v[24:27], a[224:227], v[116:119]
    v_exp_f32 v16, v164
    v_mfma_f32_16x16x32_bf16 v[116:119], v[28:31], a[228:231], v[116:119]
    s_add_u32 s27, s27, 24576
    v_add_f32 v5, v5, v18
    v_add_f32 v5, v5, v19
    v_mfma_f32_16x16x32_bf16 v[120:123], v[24:27], a[248:251], v[120:123]
    s_add_u32 s56, s56, 36864
    ds_read_b128 v[44:47], v3 offset:18688
    v_fma_f32 v145, v145, v48, v50
    v_mfma_f32_16x16x32_bf16 v[120:123], v[28:31], a[252:255], v[120:123]
    s_waitcnt lgkmcnt(2)
    v_exp_f32 v17, v165
    v_mfma_f32_16x16x32_bf16 v[124:127], v[24:27], v[208:211], v[124:127]
    s_waitcnt vmcnt(12)
    v_cvt_pk_bf16_f32 v163, v18, v19
    v_fma_f32 v149, v149, v49, v51
    v_mfma_f32_16x16x32_bf16 v[124:127], v[28:31], v[212:215], v[124:127]
    s_barrier
    s_sub_u32 s58, s56, 147456
    v_mfma_f32_16x16x32_bf16 v[176:179], v[32:35], a[208:211], v[176:179]
    s_min_u32 s56, s56, s58
    ds_read_b128 v[24:27], v1 offset:0
    v_cvt_f32_i32 v146, v146
    v_mfma_f32_16x16x32_bf16 v[176:179], v[36:39], a[212:215], v[176:179]
    v_exp_f32 v18, v166
    v_mfma_f32_16x16x32_bf16 v[180:183], v[32:35], a[232:235], v[180:183]
    v_add_f32 v6, v6, v16
    v_add_f32 v6, v6, v17
    v_mfma_f32_16x16x32_bf16 v[180:183], v[36:39], a[236:239], v[180:183]
    v_exp_f32 v19, v167
    v_mfma_f32_16x16x32_bf16 v[184:187], v[32:35], v[192:195], v[184:187]
    ds_read_b128 v[28:31], v1 offset:12288
    v_cvt_pk_bf16_f32 v164, v16, v17
    v_mfma_f32_16x16x32_bf16 v[184:187], v[36:39], v[196:199], v[184:187]
    v_exp_f32 v16, v100
    v_mfma_f32_16x16x32_bf16 v[188:191], v[32:35], v[216:219], v[188:191]
    v_add_f32 v6, v6, v18
    v_add_f32 v6, v6, v19
    v_mfma_f32_16x16x32_bf16 v[188:191], v[36:39], v[220:223], v[188:191]
    s_waitcnt lgkmcnt(2)
    v_exp_f32 v17, v101
    v_mfma_f32_16x16x32_bf16 v[112:115], v[40:43], a[208:211], v[112:115]
    ds_read_b128 v[32:35], v1 offset:1024
    v_cvt_pk_bf16_f32 v165, v18, v19
    v_mfma_f32_16x16x32_bf16 v[112:115], v[44:47], a[212:215], v[112:115]
    v_exp_f32 v18, v102
    v_mfma_f32_16x16x32_bf16 v[116:119], v[40:43], a[232:235], v[116:119]
    v_add_f32 v6, v6, v16
    v_cvt_f32_i32 v150, v150
    v_mfma_f32_16x16x32_bf16 v[116:119], v[44:47], a[236:239], v[116:119]
    v_add_f32 v6, v6, v17
    v_fma_f32 v146, v146, v48, v50
    v_mfma_f32_16x16x32_bf16 v[120:123], v[40:43], v[192:195], v[120:123]
    ds_read_b128 v[36:39], v1 offset:13312
    v_fma_f32 v150, v150, v49, v51
    v_mfma_f32_16x16x32_bf16 v[120:123], v[44:47], v[196:199], v[120:123]
    v_exp_f32 v19, v103
    v_mfma_f32_16x16x32_bf16 v[124:127], v[40:43], v[216:219], v[124:127]
    v_cvt_pk_bf16_f32 v166, v16, v17
    v_add_f32 v6, v6, v18
    v_mfma_f32_16x16x32_bf16 v[124:127], v[44:47], v[220:223], v[124:127]
    s_waitcnt lgkmcnt(2)
    v_add_f32 v6, v6, v19
    v_cvt_pk_bf16_f32 v167, v18, v19
    v_mfma_f32_16x16x32_bf16 a[0:3], v[24:27], v[64:67], a[0:3]
    ds_read_b128 v[40:43], v1 offset:2048
    v_cvt_f32_i32 v147, v147
    v_mfma_f32_16x16x32_bf16 a[0:3], v[28:31], v[80:83], a[0:3]
    buffer_store_dwordx4 v[224:227], v11, s[4:7], s33 offen offset:0 sc1
    v_mfma_f32_16x16x32_bf16 a[48:51], v[24:27], v[68:71], a[48:51]
    v_exp_f32 v16, v168
    v_mfma_f32_16x16x32_bf16 a[48:51], v[28:31], v[84:87], a[48:51]
    v_exp_f32 v17, v169
    v_mfma_f32_16x16x32_bf16 a[96:99], v[24:27], v[72:75], a[96:99]
    ds_read_b128 v[44:47], v1 offset:14336
    v_xor_b32 v55, 16, v11
    v_mfma_f32_16x16x32_bf16 a[96:99], v[28:31], v[88:91], a[96:99]
    v_exp_f32 v18, v170
    v_mfma_f32_16x16x32_bf16 a[144:147], v[24:27], v[76:79], a[144:147]
    v_add_f32 v7, v7, v16
    v_add_f32 v7, v7, v17
    v_mfma_f32_16x16x32_bf16 a[144:147], v[28:31], v[92:95], a[144:147]
    s_waitcnt lgkmcnt(2)
    v_exp_f32 v19, v171
    v_mfma_f32_16x16x32_bf16 a[4:7], v[32:35], v[64:67], a[4:7]
    ds_read_b128 v[24:27], v1 offset:3072
    v_cvt_f32_i32 v151, v151
    v_mfma_f32_16x16x32_bf16 a[4:7], v[36:39], v[80:83], a[4:7]
    buffer_store_dwordx4 v[228:231], v55, s[4:7], s33 offen offset:768 sc1
    v_mfma_f32_16x16x32_bf16 a[52:55], v[32:35], v[68:71], a[52:55]
    v_cvt_pk_bf16_f32 v168, v16, v17
    v_fma_f32 v147, v147, v48, v50
    v_mfma_f32_16x16x32_bf16 a[52:55], v[36:39], v[84:87], a[52:55]
    v_exp_f32 v16, v104
    v_mfma_f32_16x16x32_bf16 a[100:103], v[32:35], v[72:75], a[100:103]
    ds_read_b128 v[28:31], v1 offset:15360
    v_add_f32 v7, v7, v18
    v_mfma_f32_16x16x32_bf16 a[100:103], v[36:39], v[88:91], a[100:103]
    v_add_f32 v7, v7, v19
    v_xor_b32 v54, 32, v11
    v_mfma_f32_16x16x32_bf16 a[148:151], v[32:35], v[76:79], a[148:151]
    v_exp_f32 v17, v105
    v_mfma_f32_16x16x32_bf16 a[148:151], v[36:39], v[92:95], a[148:151]
    s_waitcnt lgkmcnt(2)
    v_cvt_pk_bf16_f32 v169, v18, v19
    v_fma_f32 v151, v151, v49, v51
    v_mfma_f32_16x16x32_bf16 a[8:11], v[40:43], v[64:67], a[8:11]
    ds_read_b128 v[32:35], v1 offset:4096
    v_lshlrev_b32 v48, 16, v57
    v_mfma_f32_16x16x32_bf16 a[8:11], v[44:47], v[80:83], a[8:11]
    buffer_store_dwordx4 v[232:235], v54, s[4:7], s33 offen offset:1536 sc1
    v_mfma_f32_16x16x32_bf16 a[56:59], v[40:43], v[68:71], a[56:59]
    v_exp_f32 v18, v106
    v_mfma_f32_16x16x32_bf16 a[56:59], v[44:47], v[84:87], a[56:59]
    v_add_f32 v7, v7, v16
    v_add_f32 v7, v7, v17
    v_mfma_f32_16x16x32_bf16 a[104:107], v[40:43], v[72:75], a[104:107]
    ds_read_b128 v[36:39], v1 offset:16384
    v_xor_b32 v55, 48, v11
    v_mfma_f32_16x16x32_bf16 a[104:107], v[44:47], v[88:91], a[104:107]
    v_exp_f32 v19, v107
    v_mfma_f32_16x16x32_bf16 a[152:155], v[40:43], v[76:79], a[152:155]
    v_cvt_pk_bf16_f32 v170, v16, v17
    v_and_b32 v49, s97, v57
    v_mfma_f32_16x16x32_bf16 a[152:155], v[44:47], v[92:95], a[152:155]
    s_waitcnt lgkmcnt(2)
    v_exp_f32 v16, v172
    v_mfma_f32_16x16x32_bf16 a[12:15], v[24:27], v[64:67], a[12:15]
    ds_read_b128 v[40:43], v1 offset:5120
    v_add_f32 v7, v7, v18
    v_mfma_f32_16x16x32_bf16 a[12:15], v[28:31], v[80:83], a[12:15]
    buffer_store_dwordx4 v[236:239], v55, s[4:7], s33 offen offset:2304 sc1
    v_mfma_f32_16x16x32_bf16 a[60:63], v[24:27], v[68:71], a[60:63]
    v_add_f32 v7, v7, v19
    v_lshlrev_b32 v50, 16, v59
    v_mfma_f32_16x16x32_bf16 a[60:63], v[28:31], v[84:87], a[60:63]
    v_exp_f32 v17, v173
    v_mfma_f32_16x16x32_bf16 a[108:111], v[24:27], v[72:75], a[108:111]
    ds_read_b128 v[44:47], v1 offset:17408
    v_cvt_pk_bf16_f32 v171, v18, v19
    v_mfma_f32_16x16x32_bf16 a[108:111], v[28:31], v[88:91], a[108:111]
    v_exp_f32 v18, v174
    v_mfma_f32_16x16x32_bf16 a[156:159], v[24:27], v[76:79], a[156:159]
    s_add_u32 s29, s28, 49152
    v_add_f32 v8, v8, v16
    v_add_f32 v8, v8, v17
    v_mfma_f32_16x16x32_bf16 a[156:159], v[28:31], v[92:95], a[156:159]
    s_waitcnt lgkmcnt(2)
    v_exp_f32 v19, v175
    v_mfma_f32_16x16x32_bf16 a[16:19], v[32:35], v[64:67], a[16:19]
    s_sub_u32 s3, s29, 147456
    ds_read_b128 v[24:27], v1 offset:6144
    v_cvt_pk_bf16_f32 v172, v16, v17
    v_mfma_f32_16x16x32_bf16 a[16:19], v[36:39], v[80:83], a[16:19]
    s_mov_b32 m0, s26
    v_exp_f32 v16, v108
    v_mfma_f32_16x16x32_bf16 a[64:67], v[32:35], v[68:71], a[64:67]
    s_min_u32 s29, s29, s3
    v_and_b32 v51, s97, v59
    v_add_f32 v8, v8, v18
    v_mfma_f32_16x16x32_bf16 a[64:67], v[36:39], v[84:87], a[64:67]
    buffer_load_dwordx4 v4, s[4:7], s32 offen offset:0 sc1 lds
    v_mfma_f32_16x16x32_bf16 a[112:115], v[32:35], v[72:75], a[112:115]
    ds_read_b128 v[28:31], v1 offset:18432
    v_add_f32 v8, v8, v19
    v_mfma_f32_16x16x32_bf16 a[112:115], v[36:39], v[88:91], a[112:115]
    v_exp_f32 v17, v109
    v_mfma_f32_16x16x32_bf16 a[160:163], v[32:35], v[76:79], a[160:163]
    v_cvt_pk_bf16_f32 v173, v18, v19
    v_mul_f32_e64 v50, -v50, v48
    v_mfma_f32_16x16x32_bf16 a[160:163], v[36:39], v[92:95], a[160:163]
    s_waitcnt lgkmcnt(2)
    buffer_load_dwordx4 v4, s[4:7], s32 offen offset:1024 sc1 lds
    v_mfma_f32_16x16x32_bf16 a[20:23], v[40:43], v[64:67], a[20:23]
    s_sub_u32 s3, s29, s28
    ds_read_b128 v[32:35], v1 offset:7168
    v_mul_f32_e64 v51, -v51, v49
    v_mfma_f32_16x16x32_bf16 a[20:23], v[44:47], v[80:83], a[20:23]
    v_exp_f32 v18, v110
    v_mfma_f32_16x16x32_bf16 a[68:71], v[40:43], v[68:71], a[68:71]
    v_add_f32 v8, v8, v16
    v_add_f32 v8, v8, v17
    v_mfma_f32_16x16x32_bf16 a[68:71], v[44:47], v[84:87], a[68:71]
    buffer_load_dwordx4 v4, s[4:7], s32 offen offset:2048 sc1 lds
    v_mfma_f32_16x16x32_bf16 a[116:119], v[40:43], v[72:75], a[116:119]
    ds_read_b128 v[36:39], v1 offset:19456
    v_cvt_f32_i32 v152, v152
    v_mfma_f32_16x16x32_bf16 a[116:119], v[44:47], v[88:91], a[116:119]
    v_exp_f32 v19, v111
    v_mfma_f32_16x16x32_bf16 a[164:167], v[40:43], v[76:79], a[164:167]
    s_mov_b32 s28, s29
    v_cvt_pk_bf16_f32 v174, v16, v17
    v_add_f32 v8, v8, v18
    v_mfma_f32_16x16x32_bf16 a[164:167], v[44:47], v[92:95], a[164:167]
    s_waitcnt lgkmcnt(2)
    v_add_f32 v8, v8, v19
    v_cvt_pk_bf16_f32 v175, v18, v19
    v_mfma_f32_16x16x32_bf16 a[24:27], v[24:27], v[64:67], a[24:27]
    s_add_u32 s32, s32, 24576
    ds_read_b128 v[40:43], v1 offset:8192
    v_cvt_f32_i32 v156, v156
    v_mfma_f32_16x16x32_bf16 a[24:27], v[28:31], v[80:83], a[24:27]
    v_exp_f32 v16, v176
    v_mfma_f32_16x16x32_bf16 a[72:75], v[24:27], v[68:71], a[72:75]
    s_add_u32 s26, s26, 12288
    v_exp_f32 v17, v177
    v_mfma_f32_16x16x32_bf16 a[72:75], v[28:31], v[84:87], a[72:75]
    v_exp_f32 v18, v178
    v_mfma_f32_16x16x32_bf16 a[120:123], v[24:27], v[72:75], a[120:123]
    s_mov_b32 m0, s26
    ds_read_b128 v[44:47], v1 offset:20480
    v_add_f32 v5, v5, v16
    v_mfma_f32_16x16x32_bf16 a[120:123], v[28:31], v[88:91], a[120:123]
    v_add_f32 v5, v5, v17
    v_fma_f32 v152, v152, v48, v50
    v_mfma_f32_16x16x32_bf16 a[168:171], v[24:27], v[76:79], a[168:171]
    v_exp_f32 v19, v179
    v_mfma_f32_16x16x32_bf16 a[168:171], v[28:31], v[92:95], a[168:171]
    s_waitcnt lgkmcnt(2)
    v_cvt_pk_bf16_f32 v176, v16, v17
    v_fma_f32 v156, v156, v49, v51
    v_mfma_f32_16x16x32_bf16 a[28:31], v[32:35], v[64:67], a[28:31]
    ds_read_b128 v[24:27], v1 offset:9216
    v_add_u32 v2, s3, v2
    v_mfma_f32_16x16x32_bf16 a[28:31], v[36:39], v[80:83], a[28:31]
    buffer_load_dwordx4 v4, s[4:7], s32 offen offset:0 sc1 lds
    v_mfma_f32_16x16x32_bf16 a[76:79], v[32:35], v[68:71], a[76:79]
    v_exp_f32 v16, v112
    v_mfma_f32_16x16x32_bf16 a[76:79], v[36:39], v[84:87], a[76:79]
    v_add_f32 v5, v5, v18
    v_add_f32 v5, v5, v19
    v_mfma_f32_16x16x32_bf16 a[124:127], v[32:35], v[72:75], a[124:127]
    ds_read_b128 v[28:31], v1 offset:21504
    v_cvt_f32_i32 v153, v153
    v_mfma_f32_16x16x32_bf16 a[124:127], v[36:39], v[88:91], a[124:127]
    buffer_load_dwordx4 v4, s[4:7], s32 offen offset:1024 sc1 lds
    v_mfma_f32_16x16x32_bf16 a[172:175], v[32:35], v[76:79], a[172:175]
    v_exp_f32 v17, v113
    v_mfma_f32_16x16x32_bf16 a[172:175], v[36:39], v[92:95], a[172:175]
    s_waitcnt lgkmcnt(2)
    v_cvt_pk_bf16_f32 v177, v18, v19
    v_add_u32 v3, s3, v3
    v_mfma_f32_16x16x32_bf16 a[32:35], v[40:43], v[64:67], a[32:35]
    ds_read_b128 v[32:35], v1 offset:10240
    v_cvt_f32_i32 v157, v157
    v_mfma_f32_16x16x32_bf16 a[32:35], v[44:47], v[80:83], a[32:35]
    v_exp_f32 v18, v114
    v_mfma_f32_16x16x32_bf16 a[80:83], v[40:43], v[68:71], a[80:83]
    v_add_f32 v5, v5, v16
    v_add_f32 v5, v5, v17
    v_mfma_f32_16x16x32_bf16 a[80:83], v[44:47], v[84:87], a[80:83]
    buffer_load_dwordx4 v4, s[4:7], s32 offen offset:2048 sc1 lds
    v_mfma_f32_16x16x32_bf16 a[128:131], v[40:43], v[72:75], a[128:131]
    ds_read_b128 v[36:39], v1 offset:22528
    v_mfma_f32_16x16x32_bf16 a[128:131], v[44:47], v[88:91], a[128:131]
    v_exp_f32 v19, v115
    v_mfma_f32_16x16x32_bf16 a[176:179], v[40:43], v[76:79], a[176:179]
    v_cvt_pk_bf16_f32 v178, v16, v17
    v_fma_f32 v153, v153, v48, v50
    v_mfma_f32_16x16x32_bf16 a[176:179], v[44:47], v[92:95], a[176:179]
    s_waitcnt lgkmcnt(2)
    v_exp_f32 v16, v180
    v_mfma_f32_16x16x32_bf16 a[36:39], v[24:27], v[64:67], a[36:39]
    ds_read_b128 v[40:43], v1 offset:11264
    v_add_f32 v5, v5, v18
    v_mfma_f32_16x16x32_bf16 a[36:39], v[28:31], v[80:83], a[36:39]
    v_add_f32 v5, v5, v19
    v_mfma_f32_16x16x32_bf16 a[84:87], v[24:27], v[68:71], a[84:87]
    v_exp_f32 v17, v181
    v_mfma_f32_16x16x32_bf16 a[84:87], v[28:31], v[84:87], a[84:87]
    s_add_u32 s32, s32, 24576
    v_cvt_pk_bf16_f32 v179, v18, v19
    s_add_u32 s26, s26, 36864
    v_mfma_f32_16x16x32_bf16 a[132:135], v[24:27], v[72:75], a[132:135]
    s_sub_u32 s57, s26, 147456
    ds_read_b128 v[44:47], v1 offset:23552
    v_fma_f32 v157, v157, v49, v51
    v_mfma_f32_16x16x32_bf16 a[132:135], v[28:31], v[88:91], a[132:135]
    s_waitcnt lgkmcnt(2)
    v_exp_f32 v18, v182
    v_mfma_f32_16x16x32_bf16 a[180:183], v[24:27], v[76:79], a[180:183]
    s_waitcnt vmcnt(6)
    v_add_f32 v6, v6, v16
    v_add_f32 v6, v6, v17
    v_mfma_f32_16x16x32_bf16 a[180:183], v[28:31], v[92:95], a[180:183]
    s_barrier
    v_cvt_f32_i32 v154, v154
    v_mfma_f32_16x16x32_bf16 a[40:43], v[32:35], v[64:67], a[40:43]
    s_min_u32 s26, s26, s57
    ds_read_b128 v[24:27], v2 offset:0
    v_add_u32 v0, 1, v0
    v_mfma_f32_16x16x32_bf16 a[40:43], v[36:39], v[80:83], a[40:43]
    buffer_store_dword v0, v13, s[20:23], 0 offen offset:32 sc1
    v_mfma_f32_16x16x32_bf16 a[88:91], v[32:35], v[68:71], a[88:91]
    v_exp_f32 v19, v183
    v_mfma_f32_16x16x32_bf16 a[88:91], v[36:39], v[84:87], a[88:91]
    v_cvt_pk_bf16_f32 v180, v16, v17
    v_cvt_f32_i32 v158, v158
    v_mfma_f32_16x16x32_bf16 a[136:139], v[32:35], v[72:75], a[136:139]
    ds_read_b128 v[28:31], v3 offset:0
    v_mfma_f32_16x16x32_bf16 a[136:139], v[36:39], v[88:91], a[136:139]
    v_exp_f32 v16, v116
    v_mfma_f32_16x16x32_bf16 a[184:187], v[32:35], v[76:79], a[184:187]
    v_add_f32 v6, v6, v18
    v_add_f32 v6, v6, v19
    v_mfma_f32_16x16x32_bf16 a[184:187], v[36:39], v[92:95], a[184:187]
    s_waitcnt lgkmcnt(2)
    v_exp_f32 v17, v117
    v_mfma_f32_16x16x32_bf16 a[44:47], v[40:43], v[64:67], a[44:47]
    ds_read_b128 v[32:35], v2 offset:6144
    v_cvt_pk_bf16_f32 v181, v18, v19
    v_mfma_f32_16x16x32_bf16 a[44:47], v[44:47], v[80:83], a[44:47]
    v_exp_f32 v18, v118
    v_mfma_f32_16x16x32_bf16 a[92:95], v[40:43], v[68:71], a[92:95]
    v_add_f32 v6, v6, v16
    v_add_f32 v6, v6, v17
    v_mfma_f32_16x16x32_bf16 a[92:95], v[44:47], v[84:87], a[92:95]
    v_exp_f32 v19, v119
    v_mfma_f32_16x16x32_bf16 a[140:143], v[40:43], v[72:75], a[140:143]
    ds_read_b128 v[36:39], v3 offset:6144
    v_cvt_pk_bf16_f32 v182, v16, v17
    v_mfma_f32_16x16x32_bf16 a[140:143], v[44:47], v[88:91], a[140:143]
    v_add_f32 v6, v6, v18
    v_add_f32 v6, v6, v19
    v_mfma_f32_16x16x32_bf16 a[188:191], v[40:43], v[76:79], a[188:191]
    v_cvt_pk_bf16_f32 v183, v18, v19
    v_mfma_f32_16x16x32_bf16 a[188:191], v[44:47], v[92:95], a[188:191]
    s_waitcnt lgkmcnt(2)
    v_mfma_f32_16x16x32_bf16 v[64:67], v[24:27], a[192:195], v[128:131]
    s_add_u32 s33, s33, 196608
    ds_read_b128 v[40:43], v2 offset:128
    v_fma_f32 v154, v154, v48, v50
    v_mfma_f32_16x16x32_bf16 v[64:67], v[28:31], a[196:199], v[64:67]
    s_mov_b32 m0, s56
    v_exp_f32 v16, v184
    v_mfma_f32_16x16x32_bf16 v[68:71], v[24:27], a[216:219], v[132:135]
    s_add_u32 s34, s34, 196608
    v_exp_f32 v17, v185
    v_mfma_f32_16x16x32_bf16 v[68:71], v[28:31], a[220:223], v[68:71]
    s_add_u32 s36, s36, 1536
    buffer_load_dwordx4 v4, s[4:7], s27 offen offset:0 sc1 lds
    v_mfma_f32_16x16x32_bf16 v[72:75], v[24:27], a[240:243], v[136:139]
    ds_read_b128 v[44:47], v3 offset:128
    v_fma_f32 v158, v158, v49, v51
    v_mfma_f32_16x16x32_bf16 v[72:75], v[28:31], a[244:247], v[72:75]
    v_exp_f32 v18, v186
    v_mfma_f32_16x16x32_bf16 v[76:79], v[24:27], v[200:203], v[140:143]
    v_add_f32 v7, v7, v16
    v_add_f32 v7, v7, v17
    v_mfma_f32_16x16x32_bf16 v[76:79], v[28:31], v[204:207], v[76:79]
    s_waitcnt lgkmcnt(2)
    buffer_load_dwordx2 v[56:57], v10, s[72:75], s36 offen offset:0
    v_mfma_f32_16x16x32_bf16 v[96:99], v[32:35], a[192:195], v[128:131]
    ds_read_b128 v[24:27], v2 offset:6272
    v_cvt_f32_i32 v155, v155
    v_mfma_f32_16x16x32_bf16 v[96:99], v[36:39], a[196:199], v[96:99]
    v_exp_f32 v19, v187
    v_mfma_f32_16x16x32_bf16 v[100:103], v[32:35], a[216:219], v[132:135]
    v_cvt_pk_bf16_f32 v184, v16, v17
    v_cvt_f32_i32 v159, v159
    v_mfma_f32_16x16x32_bf16 v[100:103], v[36:39], a[220:223], v[100:103]
    buffer_load_dwordx4 v4, s[4:7], s27 offen offset:1024 sc1 lds
    v_mfma_f32_16x16x32_bf16 v[104:107], v[32:35], a[240:243], v[136:139]
    ds_read_b128 v[28:31], v3 offset:6272
    v_fma_f32 v155, v155, v48, v50
    v_mfma_f32_16x16x32_bf16 v[104:107], v[36:39], a[244:247], v[104:107]
    v_exp_f32 v16, v120
    v_mfma_f32_16x16x32_bf16 v[108:111], v[32:35], v[200:203], v[140:143]
    v_add_f32 v7, v7, v18
    v_add_f32 v7, v7, v19
    v_mfma_f32_16x16x32_bf16 v[108:111], v[36:39], v[204:207], v[108:111]
    s_waitcnt lgkmcnt(2)
    buffer_load_dwordx2 v[58:59], v10, s[76:79], s36 offen offset:0
    v_mfma_f32_16x16x32_bf16 v[64:67], v[40:43], a[200:203], v[64:67]
    ds_read_b128 v[32:35], v2 offset:256
    v_fma_f32 v159, v159, v49, v51
    v_mfma_f32_16x16x32_bf16 v[64:67], v[44:47], a[204:207], v[64:67]
    v_exp_f32 v17, v121
    v_mfma_f32_16x16x32_bf16 v[68:71], v[40:43], a[224:227], v[68:71]
    v_cvt_pk_bf16_f32 v185, v18, v19
    v_cvt_pk_bf16_f32 v144, v144, v148
    v_mfma_f32_16x16x32_bf16 v[68:71], v[44:47], a[228:231], v[68:71]
    buffer_load_dwordx4 v[224:227], v9, s[64:67], s33 offen offset:0 nt
    v_mfma_f32_16x16x32_bf16 v[72:75], v[40:43], a[248:251], v[72:75]
    ds_read_b128 v[36:39], v3 offset:256
    v_cvt_pk_bf16_f32 v148, v145, v149
    v_mfma_f32_16x16x32_bf16 v[72:75], v[44:47], a[252:255], v[72:75]
    v_exp_f32 v18, v122
    v_mfma_f32_16x16x32_bf16 v[76:79], v[40:43], v[208:211], v[76:79]
    v_add_f32 v7, v7, v16
    v_add_f32 v7, v7, v17
    v_mfma_f32_16x16x32_bf16 v[76:79], v[44:47], v[212:215], v[76:79]
    s_waitcnt lgkmcnt(2)
    buffer_load_dwordx4 v4, s[4:7], s27 offen offset:2048 sc1 lds
    v_mfma_f32_16x16x32_bf16 v[96:99], v[24:27], a[200:203], v[96:99]
    ds_read_b128 v[40:43], v2 offset:6400
    v_cvt_pk_bf16_f32 v145, v152, v156
    v_mfma_f32_16x16x32_bf16 v[96:99], v[28:31], a[204:207], v[96:99]
    v_exp_f32 v19, v123
    v_cvt_pk_bf16_f32 v186, v16, v17
    v_mfma_f32_16x16x32_bf16 v[100:103], v[24:27], a[224:227], v[100:103]
    v_exp_f32 v16, v188
    v_mfma_f32_16x16x32_bf16 v[100:103], v[28:31], a[228:231], v[100:103]
    buffer_load_dwordx4 v[228:231], v9, s[64:67], s33 offen offset:1536 nt
    v_mfma_f32_16x16x32_bf16 v[104:107], v[24:27], a[248:251], v[104:107]
    ds_read_b128 v[44:47], v3 offset:6400
    v_add_f32 v7, v7, v18
    v_mfma_f32_16x16x32_bf16 v[104:107], v[28:31], a[252:255], v[104:107]
    v_add_f32 v7, v7, v19
    v_cvt_pk_bf16_f32 v149, v153, v157
    v_mfma_f32_16x16x32_bf16 v[108:111], v[24:27], v[208:211], v[108:111]
    s_add_u32 s29, s30, 49152
    v_exp_f32 v17, v189
    v_mfma_f32_16x16x32_bf16 v[108:111], v[28:31], v[212:215], v[108:111]
    s_waitcnt lgkmcnt(2)
    buffer_load_dwordx4 v[232:235], v9, s[64:67], s34 offen offset:0 nt
    v_cvt_pk_bf16_f32 v187, v18, v19
    v_mfma_f32_16x16x32_bf16 v[64:67], v[32:35], a[208:211], v[64:67]
    s_sub_u32 s3, s29, 147456
    ds_read_b128 v[24:27], v2 offset:12288
    s_add_u32 s27, s27, 24576
    v_mfma_f32_16x16x32_bf16 v[64:67], v[36:39], a[212:215], v[64:67]
    s_min_u32 s29, s29, s3
    v_exp_f32 v18, v190
    v_mfma_f32_16x16x32_bf16 v[68:71], v[32:35], a[232:235], v[68:71]
    v_add_f32 v8, v8, v16
    v_add_f32 v8, v8, v17
    v_mfma_f32_16x16x32_bf16 v[68:71], v[36:39], a[236:239], v[68:71]
    buffer_load_dwordx4 v[236:239], v9, s[64:67], s34 offen offset:1536 nt
    v_mfma_f32_16x16x32_bf16 v[72:75], v[32:35], v[192:195], v[72:75]
    s_add_u32 s56, s56, 12288
    ds_read_b128 v[28:31], v3 offset:12288
    v_cvt_pk_bf16_f32 v152, v146, v150
    v_mfma_f32_16x16x32_bf16 v[72:75], v[36:39], v[196:199], v[72:75]
    v_exp_f32 v19, v191
    v_cvt_pk_bf16_f32 v188, v16, v17
    v_mfma_f32_16x16x32_bf16 v[76:79], v[32:35], v[216:219], v[76:79]
    v_exp_f32 v16, v124
    v_mfma_f32_16x16x32_bf16 v[76:79], v[36:39], v[220:223], v[76:79]
    s_waitcnt lgkmcnt(2)
    v_add_f32 v8, v8, v18
    v_add_f32 v8, v8, v19
    v_mfma_f32_16x16x32_bf16 v[96:99], v[40:43], a[208:211], v[96:99]
    ds_read_b128 v[32:35], v2 offset:18432
    v_cvt_pk_bf16_f32 v153, v154, v158
    v_mfma_f32_16x16x32_bf16 v[96:99], v[44:47], a[212:215], v[96:99]
    s_sub_u32 s3, s29, s30
    v_exp_f32 v17, v125
    v_mfma_f32_16x16x32_bf16 v[100:103], v[40:43], a[232:235], v[100:103]
    s_mov_b32 m0, s56
    v_cvt_pk_bf16_f32 v189, v18, v19
    v_cvt_pk_bf16_f32 v156, v147, v151
    v_mfma_f32_16x16x32_bf16 v[100:103], v[44:47], a[236:239], v[100:103]
    v_exp_f32 v18, v126
    v_mfma_f32_16x16x32_bf16 v[104:107], v[40:43], v[192:195], v[104:107]
    ds_read_b128 v[36:39], v3 offset:18432
    v_add_f32 v8, v8, v16
    v_mfma_f32_16x16x32_bf16 v[104:107], v[44:47], v[196:199], v[104:107]
    v_add_f32 v8, v8, v17
    v_cvt_pk_bf16_f32 v157, v155, v159
    v_mfma_f32_16x16x32_bf16 v[108:111], v[40:43], v[216:219], v[108:111]
    v_exp_f32 v19, v127
    v_mfma_f32_16x16x32_bf16 v[108:111], v[44:47], v[220:223], v[108:111]
    s_waitcnt lgkmcnt(2)
    v_cvt_pk_bf16_f32 v190, v16, v17
    v_add_f32 v8, v8, v18
    v_mfma_f32_16x16x32_bf16 v[80:83], v[24:27], a[192:195], v[128:131]
    ds_read_b128 v[40:43], v2 offset:12416
    v_add_f32 v8, v8, v19
    v_mfma_f32_16x16x32_bf16 v[80:83], v[28:31], a[196:199], v[80:83]
    s_mov_b32 s30, s29
    v_cvt_pk_bf16_f32 v191, v18, v19
    v_mfma_f32_16x16x32_bf16 v[84:87], v[24:27], a[216:219], v[132:135]
    v_exp_f32 v16, v64
    v_mfma_f32_16x16x32_bf16 v[84:87], v[28:31], a[220:223], v[84:87]
    s_waitcnt vmcnt(20)
    buffer_load_dwordx4 v4, s[4:7], s27 offen offset:0 sc1 lds
    v_mfma_f32_16x16x32_bf16 v[88:91], v[24:27], a[240:243], v[136:139]
    ds_read_b128 v[44:47], v3 offset:12416
    v_lshlrev_b32 v48, 16, v60
    v_mfma_f32_16x16x32_bf16 v[88:91], v[28:31], a[244:247], v[88:91]
    v_exp_f32 v17, v65
    v_mfma_f32_16x16x32_bf16 v[92:95], v[24:27], v[200:203], v[140:143]
    v_exp_f32 v18, v66
    v_mfma_f32_16x16x32_bf16 v[92:95], v[28:31], v[204:207], v[92:95]
    s_waitcnt lgkmcnt(2)
    v_add_f32 v5, v5, v16
    v_add_f32 v5, v5, v17
    v_mfma_f32_16x16x32_bf16 v[112:115], v[32:35], a[192:195], v[128:131]
    ds_read_b128 v[24:27], v2 offset:18560
    v_and_b32 v49, s97, v60
    v_mfma_f32_16x16x32_bf16 v[112:115], v[36:39], a[196:199], v[112:115]
    v_exp_f32 v19, v67
    v_mfma_f32_16x16x32_bf16 v[116:119], v[32:35], a[216:219], v[132:135]
    v_cvt_pk_bf16_f32 v64, v16, v17
    v_lshlrev_b32 v50, 16, v62
    v_mfma_f32_16x16x32_bf16 v[116:119], v[36:39], a[220:223], v[116:119]
    v_exp_f32 v16, v96
    v_mfma_f32_16x16x32_bf16 v[120:123], v[32:35], a[240:243], v[136:139]
    ds_read_b128 v[28:31], v3 offset:18560
    v_add_f32 v5, v5, v18
    v_mfma_f32_16x16x32_bf16 v[120:123], v[36:39], a[244:247], v[120:123]
    v_add_f32 v5, v5, v19
    v_and_b32 v51, s97, v62
    v_mfma_f32_16x16x32_bf16 v[124:127], v[32:35], v[200:203], v[140:143]
    v_exp_f32 v17, v97
    v_mfma_f32_16x16x32_bf16 v[124:127], v[36:39], v[204:207], v[124:127]
    s_waitcnt lgkmcnt(2)
    buffer_load_dwordx4 v4, s[4:7], s27 offen offset:1024 sc1 lds
    v_mfma_f32_16x16x32_bf16 v[80:83], v[40:43], a[200:203], v[80:83]
    ds_read_b128 v[32:35], v2 offset:12544
    v_cvt_pk_bf16_f32 v65, v18, v19
    v_mfma_f32_16x16x32_bf16 v[80:83], v[44:47], a[204:207], v[80:83]
    v_exp_f32 v18, v98
    v_mfma_f32_16x16x32_bf16 v[84:87], v[40:43], a[224:227], v[84:87]
    v_add_f32 v5, v5, v16
    v_add_f32 v5, v5, v17
    v_mfma_f32_16x16x32_bf16 v[84:87], v[44:47], a[228:231], v[84:87]
    v_exp_f32 v19, v99
    v_mfma_f32_16x16x32_bf16 v[88:91], v[40:43], a[248:251], v[88:91]
    ds_read_b128 v[36:39], v3 offset:12544
    v_cvt_pk_bf16_f32 v66, v16, v17
    v_mfma_f32_16x16x32_bf16 v[88:91], v[44:47], a[252:255], v[88:91]
    v_exp_f32 v16, v68
    v_mfma_f32_16x16x32_bf16 v[92:95], v[40:43], v[208:211], v[92:95]
    v_mul_f32_e64 v50, -v50, v48
    v_add_u32 v1, s3, v1
    v_mfma_f32_16x16x32_bf16 v[92:95], v[44:47], v[212:215], v[92:95]
    s_waitcnt lgkmcnt(2)
    v_add_f32 v5, v5, v18
    v_mul_f32_e64 v51, -v51, v49
    v_mfma_f32_16x16x32_bf16 v[112:115], v[24:27], a[200:203], v[112:115]
    ds_read_b128 v[40:43], v2 offset:18688
    v_add_f32 v5, v5, v19
    v_mfma_f32_16x16x32_bf16 v[112:115], v[28:31], a[204:207], v[112:115]
    buffer_load_dwordx4 v4, s[4:7], s27 offen offset:2048 sc1 lds
    v_mfma_f32_16x16x32_bf16 v[116:119], v[24:27], a[224:227], v[116:119]
    v_exp_f32 v17, v69
    v_mfma_f32_16x16x32_bf16 v[116:119], v[28:31], a[228:231], v[116:119]
    v_cvt_pk_bf16_f32 v67, v18, v19
    v_cvt_f32_i32 v240, v240
    v_mfma_f32_16x16x32_bf16 v[120:123], v[24:27], a[248:251], v[120:123]
    ds_read_b128 v[44:47], v3 offset:18688
    v_cvt_f32_i32 v244, v244
    v_mfma_f32_16x16x32_bf16 v[120:123], v[28:31], a[252:255], v[120:123]
    s_waitcnt lgkmcnt(2)
    v_exp_f32 v18, v70
    v_mfma_f32_16x16x32_bf16 v[124:127], v[24:27], v[208:211], v[124:127]
    s_waitcnt vmcnt(24)
    v_add_f32 v6, v6, v16
    v_add_f32 v6, v6, v17
    v_mfma_f32_16x16x32_bf16 v[124:127], v[28:31], v[212:215], v[124:127]
    s_barrier
    v_fma_f32 v240, v240, v48, v50
    v_mfma_f32_16x16x32_bf16 v[80:83], v[32:35], a[208:211], v[80:83]
    ds_read_b128 v[24:27], v1 offset:0
    v_fma_f32 v244, v244, v49, v51
    v_mfma_f32_16x16x32_bf16 v[80:83], v[36:39], a[212:215], v[80:83]
    v_exp_f32 v19, v71
    v_mfma_f32_16x16x32_bf16 v[84:87], v[32:35], a[232:235], v[84:87]
    v_cvt_pk_bf16_f32 v68, v16, v17
    v_mfma_f32_16x16x32_bf16 v[84:87], v[36:39], a[236:239], v[84:87]
    v_exp_f32 v16, v100
    v_mfma_f32_16x16x32_bf16 v[88:91], v[32:35], v[192:195], v[88:91]
    ds_read_b128 v[28:31], v1 offset:12288
    v_add_f32 v6, v6, v18
    v_mfma_f32_16x16x32_bf16 v[88:91], v[36:39], v[196:199], v[88:91]
    v_add_f32 v6, v6, v19
    v_cvt_f32_i32 v241, v241
    v_mfma_f32_16x16x32_bf16 v[92:95], v[32:35], v[216:219], v[92:95]
    v_exp_f32 v17, v101
    v_mfma_f32_16x16x32_bf16 v[92:95], v[36:39], v[220:223], v[92:95]
    s_waitcnt lgkmcnt(2)
    v_cvt_pk_bf16_f32 v69, v18, v19
    v_cvt_f32_i32 v245, v245
    v_mfma_f32_16x16x32_bf16 v[112:115], v[40:43], a[208:211], v[112:115]
    ds_read_b128 v[32:35], v1 offset:1024
    v_mfma_f32_16x16x32_bf16 v[112:115], v[44:47], a[212:215], v[112:115]
    v_exp_f32 v18, v102
    v_mfma_f32_16x16x32_bf16 v[116:119], v[40:43], a[232:235], v[116:119]
    v_add_f32 v6, v6, v16
    v_add_f32 v6, v6, v17
    v_mfma_f32_16x16x32_bf16 v[116:119], v[44:47], a[236:239], v[116:119]
    s_add_u32 s27, s27, 24576
    v_exp_f32 v19, v103
    v_mfma_f32_16x16x32_bf16 v[120:123], v[40:43], v[192:195], v[120:123]
    s_add_u32 s56, s56, 36864
    ds_read_b128 v[36:39], v1 offset:13312
    v_cvt_pk_bf16_f32 v70, v16, v17
    v_mfma_f32_16x16x32_bf16 v[120:123], v[44:47], v[196:199], v[120:123]
    s_sub_u32 s58, s56, 147456
    v_add_f32 v6, v6, v18
    v_add_f32 v6, v6, v19
    v_mfma_f32_16x16x32_bf16 v[124:127], v[40:43], v[216:219], v[124:127]
    s_min_u32 s56, s56, s58
    v_cvt_pk_bf16_f32 v71, v18, v19
    v_mfma_f32_16x16x32_bf16 v[124:127], v[44:47], v[220:223], v[124:127]
    s_waitcnt lgkmcnt(2)
    v_mfma_f32_16x16x32_bf16 a[0:3], v[24:27], v[160:163], a[0:3]
    s_mov_b32 m0, s56
    ds_read_b128 v[40:43], v1 offset:2048
    v_fma_f32 v241, v241, v48, v50
    v_mfma_f32_16x16x32_bf16 a[0:3], v[28:31], v[176:179], a[0:3]
    buffer_load_dwordx4 v4, s[4:7], s27 offen offset:0 sc1 lds
    v_mfma_f32_16x16x32_bf16 a[48:51], v[24:27], v[164:167], a[48:51]
    v_exp_f32 v16, v72
    v_mfma_f32_16x16x32_bf16 a[48:51], v[28:31], v[180:183], a[48:51]
    v_exp_f32 v17, v73
    v_mfma_f32_16x16x32_bf16 a[96:99], v[24:27], v[168:171], a[96:99]
    ds_read_b128 v[44:47], v1 offset:14336
    v_fma_f32 v245, v245, v49, v51
    v_mfma_f32_16x16x32_bf16 a[96:99], v[28:31], v[184:187], a[96:99]
    v_exp_f32 v18, v74
    v_mfma_f32_16x16x32_bf16 a[144:147], v[24:27], v[172:175], a[144:147]
    v_add_f32 v7, v7, v16
    v_add_f32 v7, v7, v17
    v_mfma_f32_16x16x32_bf16 a[144:147], v[28:31], v[188:191], a[144:147]
    s_waitcnt lgkmcnt(2)
    v_exp_f32 v19, v75
    v_mfma_f32_16x16x32_bf16 a[4:7], v[32:35], v[160:163], a[4:7]
    ds_read_b128 v[24:27], v1 offset:3072
    v_cvt_f32_i32 v242, v242
    v_mfma_f32_16x16x32_bf16 a[4:7], v[36:39], v[176:179], a[4:7]
    buffer_load_dwordx4 v4, s[4:7], s27 offen offset:1024 sc1 lds
    v_mfma_f32_16x16x32_bf16 a[52:55], v[32:35], v[164:167], a[52:55]
    v_cvt_pk_bf16_f32 v72, v16, v17
    v_cvt_f32_i32 v246, v246
    v_mfma_f32_16x16x32_bf16 a[52:55], v[36:39], v[180:183], a[52:55]
    v_exp_f32 v16, v104
    v_mfma_f32_16x16x32_bf16 a[100:103], v[32:35], v[168:171], a[100:103]
    ds_read_b128 v[28:31], v1 offset:15360
    v_add_f32 v7, v7, v18
    v_mfma_f32_16x16x32_bf16 a[100:103], v[36:39], v[184:187], a[100:103]
    v_add_f32 v7, v7, v19
    v_bfe_u32 v53, v4, 4, 6
    v_mfma_f32_16x16x32_bf16 a[148:151], v[32:35], v[172:175], a[148:151]
    v_exp_f32 v17, v105
    v_mfma_f32_16x16x32_bf16 a[148:151], v[36:39], v[188:191], a[148:151]
    s_waitcnt lgkmcnt(2)
    v_fma_f32 v242, v242, v48, v50
    v_cvt_pk_bf16_f32 v73, v18, v19
    v_mfma_f32_16x16x32_bf16 a[8:11], v[40:43], v[160:163], a[8:11]
    ds_read_b128 v[32:35], v1 offset:4096
    v_fma_f32 v246, v246, v49, v51
    v_mfma_f32_16x16x32_bf16 a[8:11], v[44:47], v[176:179], a[8:11]
    v_exp_f32 v18, v106
    v_mfma_f32_16x16x32_bf16 a[56:59], v[40:43], v[164:167], a[56:59]
    v_lshlrev_b32 v53, 2, v53
    v_add_f32 v7, v7, v16
    v_mfma_f32_16x16x32_bf16 a[56:59], v[44:47], v[180:183], a[56:59]
    buffer_load_dword v52, v53, s[20:23], s44 offen sc1
    v_mfma_f32_16x16x32_bf16 a[104:107], v[40:43], v[168:171], a[104:107]
    ds_read_b128 v[36:39], v1 offset:16384
    v_add_f32 v7, v7, v17
    v_mfma_f32_16x16x32_bf16 a[104:107], v[44:47], v[184:187], a[104:107]
    v_exp_f32 v19, v107
    v_mfma_f32_16x16x32_bf16 a[152:155], v[40:43], v[172:175], a[152:155]
    v_cvt_f32_i32 v243, v243
    v_cvt_pk_bf16_f32 v74, v16, v17
    v_mfma_f32_16x16x32_bf16 a[152:155], v[44:47], v[188:191], a[152:155]
    s_waitcnt lgkmcnt(2)
    buffer_load_dwordx4 v4, s[4:7], s27 offen offset:2048 sc1 lds
    v_mfma_f32_16x16x32_bf16 a[12:15], v[24:27], v[160:163], a[12:15]
    ds_read_b128 v[40:43], v1 offset:5120
    v_cvt_f32_i32 v247, v247
    v_mfma_f32_16x16x32_bf16 a[12:15], v[28:31], v[176:179], a[12:15]
    s_add_u32 s27, s27, 24576
    v_exp_f32 v16, v76
    v_mfma_f32_16x16x32_bf16 a[60:63], v[24:27], v[164:167], a[60:63]
    v_add_f32 v7, v7, v18
    v_add_f32 v7, v7, v19
    v_mfma_f32_16x16x32_bf16 a[60:63], v[28:31], v[180:183], a[60:63]
    v_fma_f32 v243, v243, v48, v50
    v_fma_f32 v247, v247, v49, v51
    v_mfma_f32_16x16x32_bf16 a[108:111], v[24:27], v[168:171], a[108:111]
    ds_read_b128 v[44:47], v1 offset:17408
    v_lshlrev_b32 v48, 16, v61
    v_mfma_f32_16x16x32_bf16 a[108:111], v[28:31], v[184:187], a[108:111]
    v_exp_f32 v17, v77
    v_mfma_f32_16x16x32_bf16 a[156:159], v[24:27], v[172:175], a[156:159]
    s_add_u32 s29, s28, 49152
    v_cvt_pk_bf16_f32 v75, v18, v19
    v_and_b32 v49, s97, v61
    v_mfma_f32_16x16x32_bf16 a[156:159], v[28:31], v[188:191], a[156:159]
    s_waitcnt lgkmcnt(2)
    v_exp_f32 v18, v78
    v_mfma_f32_16x16x32_bf16 a[16:19], v[32:35], v[160:163], a[16:19]
    s_sub_u32 s3, s29, 147456
    ds_read_b128 v[24:27], v1 offset:6144
    v_add_f32 v8, v8, v16
    v_mfma_f32_16x16x32_bf16 a[16:19], v[36:39], v[176:179], a[16:19]
    s_add_u32 s56, s56, 12288
    v_add_f32 v8, v8, v17
    v_lshlrev_b32 v50, 16, v63
    v_mfma_f32_16x16x32_bf16 a[64:67], v[32:35], v[164:167], a[64:67]
    s_min_u32 s29, s29, s3
    v_exp_f32 v19, v79
    v_mfma_f32_16x16x32_bf16 a[64:67], v[36:39], v[180:183], a[64:67]
    s_mov_b32 m0, s56
    v_cvt_pk_bf16_f32 v76, v16, v17
    v_and_b32 v51, s97, v63
    v_mfma_f32_16x16x32_bf16 a[112:115], v[32:35], v[168:171], a[112:115]
    ds_read_b128 v[28:31], v1 offset:18432
    v_mul_f32_e64 v50, -v50, v48
    v_mfma_f32_16x16x32_bf16 a[112:115], v[36:39], v[184:187], a[112:115]
    v_exp_f32 v16, v108
    v_mfma_f32_16x16x32_bf16 a[160:163], v[32:35], v[172:175], a[160:163]
    v_add_f32 v8, v8, v18
    v_add_f32 v8, v8, v19
    v_mfma_f32_16x16x32_bf16 a[160:163], v[36:39], v[188:191], a[160:163]
    s_waitcnt lgkmcnt(2)
    v_exp_f32 v17, v109
    v_mfma_f32_16x16x32_bf16 a[20:23], v[40:43], v[160:163], a[20:23]
    s_sub_u32 s3, s29, s28
    ds_read_b128 v[32:35], v1 offset:7168
    v_cvt_pk_bf16_f32 v77, v18, v19
    v_mfma_f32_16x16x32_bf16 a[20:23], v[44:47], v[176:179], a[20:23]
    v_exp_f32 v18, v110
    v_mfma_f32_16x16x32_bf16 a[68:71], v[40:43], v[164:167], a[68:71]
    v_mul_f32_e64 v51, -v51, v49
    v_add_f32 v8, v8, v16
    v_mfma_f32_16x16x32_bf16 a[68:71], v[44:47], v[180:183], a[68:71]
    buffer_load_dwordx4 v4, s[4:7], s27 offen offset:0 sc1 lds
    v_mfma_f32_16x16x32_bf16 a[116:119], v[40:43], v[168:171], a[116:119]
    ds_read_b128 v[36:39], v1 offset:19456
    v_add_f32 v8, v8, v17
    v_mfma_f32_16x16x32_bf16 a[116:119], v[44:47], v[184:187], a[116:119]
    v_exp_f32 v19, v111
    v_mfma_f32_16x16x32_bf16 a[164:167], v[40:43], v[172:175], a[164:167]
    s_mov_b32 s28, s29
    v_cvt_f32_i32 v248, v248
    v_cvt_pk_bf16_f32 v78, v16, v17
    v_mfma_f32_16x16x32_bf16 a[164:167], v[44:47], v[188:191], a[164:167]
    s_waitcnt lgkmcnt(2)
    v_add_f32 v8, v8, v18
    v_cvt_f32_i32 v252, v252
    v_mfma_f32_16x16x32_bf16 a[24:27], v[24:27], v[160:163], a[24:27]
    ds_read_b128 v[40:43], v1 offset:8192
    v_add_f32 v8, v8, v19
    v_mfma_f32_16x16x32_bf16 a[24:27], v[28:31], v[176:179], a[24:27]
    v_cvt_pk_bf16_f32 v79, v18, v19
    v_fma_f32 v248, v248, v48, v50
    v_mfma_f32_16x16x32_bf16 a[72:75], v[24:27], v[164:167], a[72:75]
    v_exp_f32 v16, v80
    v_mfma_f32_16x16x32_bf16 a[72:75], v[28:31], v[180:183], a[72:75]
    buffer_load_dwordx4 v4, s[4:7], s27 offen offset:1024 sc1 lds
    v_mfma_f32_16x16x32_bf16 a[120:123], v[24:27], v[168:171], a[120:123]
    ds_read_b128 v[44:47], v1 offset:20480
    v_fma_f32 v252, v252, v49, v51
    v_mfma_f32_16x16x32_bf16 a[120:123], v[28:31], v[184:187], a[120:123]
    v_exp_f32 v17, v81
    v_mfma_f32_16x16x32_bf16 a[168:171], v[24:27], v[172:175], a[168:171]
    v_exp_f32 v18, v82
    v_mfma_f32_16x16x32_bf16 a[168:171], v[28:31], v[188:191], a[168:171]
    s_waitcnt lgkmcnt(2)
    v_cvt_f32_i32 v249, v249
    v_add_f32 v5, v5, v16
    v_mfma_f32_16x16x32_bf16 a[28:31], v[32:35], v[160:163], a[28:31]
    ds_read_b128 v[24:27], v1 offset:9216
    v_add_f32 v5, v5, v17
    v_mfma_f32_16x16x32_bf16 a[28:31], v[36:39], v[176:179], a[28:31]
    v_exp_f32 v19, v83
    v_mfma_f32_16x16x32_bf16 a[76:79], v[32:35], v[164:167], a[76:79]
    v_cvt_f32_i32 v253, v253
    v_cvt_pk_bf16_f32 v80, v16, v17
    v_mfma_f32_16x16x32_bf16 a[76:79], v[36:39], v[180:183], a[76:79]
    v_exp_f32 v16, v112
    v_mfma_f32_16x16x32_bf16 a[124:127], v[32:35], v[168:171], a[124:127]
    ds_read_b128 v[28:31], v1 offset:21504
    v_fma_f32 v249, v249, v48, v50
    v_mfma_f32_16x16x32_bf16 a[124:127], v[36:39], v[184:187], a[124:127]
    buffer_load_dwordx4 v4, s[4:7], s27 offen offset:2048 sc1 lds
    v_mfma_f32_16x16x32_bf16 a[172:175], v[32:35], v[172:175], a[172:175]
    v_add_f32 v5, v5, v18
    v_add_f32 v5, v5, v19
    v_mfma_f32_16x16x32_bf16 a[172:175], v[36:39], v[188:191], a[172:175]
    s_waitcnt lgkmcnt(2)
    v_exp_f32 v17, v113
    v_mfma_f32_16x16x32_bf16 a[32:35], v[40:43], v[160:163], a[32:35]
    ds_read_b128 v[32:35], v1 offset:10240
    v_fma_f32 v253, v253, v49, v51
    v_mfma_f32_16x16x32_bf16 a[32:35], v[44:47], v[176:179], a[32:35]
    v_cvt_pk_bf16_f32 v81, v18, v19
    v_cvt_f32_i32 v250, v250
    v_mfma_f32_16x16x32_bf16 a[80:83], v[40:43], v[164:167], a[80:83]
    v_exp_f32 v18, v114
    v_mfma_f32_16x16x32_bf16 a[80:83], v[44:47], v[180:183], a[80:83]
    v_cvt_f32_i32 v254, v254
    v_add_f32 v5, v5, v16
    v_mfma_f32_16x16x32_bf16 a[128:131], v[40:43], v[168:171], a[128:131]
    ds_read_b128 v[36:39], v1 offset:22528
    v_add_f32 v5, v5, v17
    v_mfma_f32_16x16x32_bf16 a[128:131], v[44:47], v[184:187], a[128:131]
    v_exp_f32 v19, v115
    v_mfma_f32_16x16x32_bf16 a[176:179], v[40:43], v[172:175], a[176:179]
    v_fma_f32 v250, v250, v48, v50
    v_cvt_pk_bf16_f32 v82, v16, v17
    v_mfma_f32_16x16x32_bf16 a[176:179], v[44:47], v[188:191], a[176:179]
    s_waitcnt lgkmcnt(2)
    v_exp_f32 v16, v84
    v_mfma_f32_16x16x32_bf16 a[36:39], v[24:27], v[160:163], a[36:39]
    ds_read_b128 v[40:43], v1 offset:11264
    v_fma_f32 v254, v254, v49, v51
    v_mfma_f32_16x16x32_bf16 a[36:39], v[28:31], v[176:179], a[36:39]
    v_add_u32 v2, s3, v2
    v_add_f32 v5, v5, v18
    v_mfma_f32_16x16x32_bf16 a[84:87], v[24:27], v[164:167], a[84:87]
    v_add_f32 v5, v5, v19
    v_cvt_f32_i32 v251, v251
    v_mfma_f32_16x16x32_bf16 a[84:87], v[28:31], v[180:183], a[84:87]
    s_add_u32 s27, s27, 24576
    v_exp_f32 v17, v85
    v_mfma_f32_16x16x32_bf16 a[132:135], v[24:27], v[168:171], a[132:135]
    s_add_u32 s56, s56, 36864
    ds_read_b128 v[44:47], v1 offset:23552
    v_add_u32 v3, s3, v3
    v_mfma_f32_16x16x32_bf16 a[132:135], v[28:31], v[184:187], a[132:135]
    s_waitcnt lgkmcnt(2)
    v_cvt_pk_bf16_f32 v83, v18, v19
    v_cvt_f32_i32 v255, v255
    v_mfma_f32_16x16x32_bf16 a[180:183], v[24:27], v[172:175], a[180:183]
    s_waitcnt vmcnt(20)
    v_exp_f32 v18, v86
    v_mfma_f32_16x16x32_bf16 a[180:183], v[28:31], v[188:191], a[180:183]
    s_barrier
    v_fma_f32 v251, v251, v48, v50
    v_mfma_f32_16x16x32_bf16 a[40:43], v[32:35], v[160:163], a[40:43]
    s_sub_u32 s58, s56, 147456
    ds_read_b128 v[24:27], v2 offset:0
    v_add_f32 v6, v6, v16
    v_mfma_f32_16x16x32_bf16 a[40:43], v[36:39], v[176:179], a[40:43]
    s_min_u32 s56, s56, s58
    buffer_load_dword v15, v4, s[88:91], s93 offen
    v_mfma_f32_16x16x32_bf16 a[88:91], v[32:35], v[164:167], a[88:91]
    v_add_f32 v6, v6, v17
    v_fma_f32 v255, v255, v49, v51
    v_mfma_f32_16x16x32_bf16 a[88:91], v[36:39], v[180:183], a[88:91]
    v_exp_f32 v19, v87
    v_mfma_f32_16x16x32_bf16 a[136:139], v[32:35], v[168:171], a[136:139]
    ds_read_b128 v[28:31], v3 offset:0
    v_cvt_pk_bf16_f32 v84, v16, v17
    v_mfma_f32_16x16x32_bf16 a[136:139], v[36:39], v[184:187], a[136:139]
    v_exp_f32 v16, v116
    v_mfma_f32_16x16x32_bf16 a[184:187], v[32:35], v[172:175], a[184:187]
    v_add_f32 v6, v6, v18
    v_cvt_pk_bf16_f32 v146, v240, v244
    v_mfma_f32_16x16x32_bf16 a[184:187], v[36:39], v[188:191], a[184:187]
    s_waitcnt lgkmcnt(2)
    v_add_f32 v6, v6, v19
    v_cvt_pk_bf16_f32 v150, v241, v245
    v_mfma_f32_16x16x32_bf16 a[44:47], v[40:43], v[160:163], a[44:47]
    ds_read_b128 v[32:35], v2 offset:6144
    v_cvt_pk_bf16_f32 v147, v248, v252
    v_mfma_f32_16x16x32_bf16 a[44:47], v[44:47], v[176:179], a[44:47]
    v_exp_f32 v17, v117
    v_mfma_f32_16x16x32_bf16 a[92:95], v[40:43], v[164:167], a[92:95]
    v_cvt_pk_bf16_f32 v85, v18, v19
    v_cvt_pk_bf16_f32 v151, v249, v253
    v_mfma_f32_16x16x32_bf16 a[92:95], v[44:47], v[180:183], a[92:95]
    v_exp_f32 v18, v118
    v_mfma_f32_16x16x32_bf16 a[140:143], v[40:43], v[168:171], a[140:143]
    ds_read_b128 v[36:39], v3 offset:6144
    v_add_f32 v6, v6, v16
    v_mfma_f32_16x16x32_bf16 a[140:143], v[44:47], v[184:187], a[140:143]
    v_add_f32 v6, v6, v17
    v_cvt_pk_bf16_f32 v154, v242, v246
    v_mfma_f32_16x16x32_bf16 a[188:191], v[40:43], v[172:175], a[188:191]
    v_exp_f32 v19, v119
    v_mfma_f32_16x16x32_bf16 a[188:191], v[44:47], v[188:191], a[188:191]
    s_waitcnt lgkmcnt(2)
    v_cvt_pk_bf16_f32 v86, v16, v17
    v_add_f32 v6, v6, v18
    v_cvt_pk_bf16_f32 v155, v250, v254
    v_add_f32 v6, v6, v19
    v_cvt_pk_bf16_f32 v158, v243, v247
    v_cvt_pk_bf16_f32 v87, v18, v19
    v_cvt_pk_bf16_f32 v159, v251, v255
L_join:
    v_mfma_f32_16x16x32_bf16 v[160:163], v[24:27], a[192:195], v[128:131]
    s_waitcnt vmcnt(7)
    ds_read_b128 v[40:43], v2 offset:128
    v_lshlrev_b32 v48, 16, v56
    v_mfma_f32_16x16x32_bf16 v[160:163], v[28:31], a[196:199], v[160:163]
    s_waitcnt vmcnt(5)
    v_subrev_u32 v52, s92, v52
    v_cmp_lt_u32 vcc, 15, v52
    v_mfma_f32_16x16x32_bf16 v[164:167], v[24:27], a[216:219], v[132:135]
    v_exp_f32 v16, v88
    v_mfma_f32_16x16x32_bf16 v[164:167], v[28:31], a[220:223], v[164:167]
    v_exp_f32 v17, v89
    v_mfma_f32_16x16x32_bf16 v[168:171], v[24:27], a[240:243], v[136:139]
    s_and_b32 s59, vcc_lo, 0xff
    ds_read_b128 v[44:47], v3 offset:128
    v_and_b32 v49, s97, v56
    v_mfma_f32_16x16x32_bf16 v[168:171], v[28:31], a[244:247], v[168:171]
    s_cbranch_scc1 L_pollslow1
L_pollok1:
    v_mfma_f32_16x16x32_bf16 v[172:175], v[24:27], v[200:203], v[140:143]
    s_add_u32 s92, s92, 1
    v_exp_f32 v18, v90
    v_mfma_f32_16x16x32_bf16 v[172:175], v[28:31], v[204:207], v[172:175]
    s_waitcnt lgkmcnt(2)
    v_add_f32 v7, v7, v16
    v_add_f32 v7, v7, v17
    v_mfma_f32_16x16x32_bf16 v[96:99], v[32:35], a[192:195], v[128:131]
    ds_read_b128 v[24:27], v2 offset:6272
    v_lshlrev_b32 v50, 16, v58
    v_mfma_f32_16x16x32_bf16 v[96:99], v[36:39], a[196:199], v[96:99]
    buffer_store_dwordx4 v[144:147], v20, s[4:7], s35 offen offset:0 sc1
    v_mfma_f32_16x16x32_bf16 v[100:103], v[32:35], a[216:219], v[132:135]
    v_exp_f32 v19, v91
    v_mfma_f32_16x16x32_bf16 v[100:103], v[36:39], a[220:223], v[100:103]
    v_cvt_pk_bf16_f32 v88, v16, v17
    v_mfma_f32_16x16x32_bf16 v[104:107], v[32:35], a[240:243], v[136:139]
    ds_read_b128 v[28:31], v3 offset:6272
    v_mfma_f32_16x16x32_bf16 v[104:107], v[36:39], a[244:247], v[104:107]
    v_exp_f32 v16, v120
    v_mfma_f32_16x16x32_bf16 v[108:111], v[32:35], v[200:203], v[140:143]
    v_add_f32 v7, v7, v18
    v_add_f32 v7, v7, v19
    v_mfma_f32_16x16x32_bf16 v[108:111], v[36:39], v[204:207], v[108:111]
    s_waitcnt lgkmcnt(2)
    v_exp_f32 v17, v121
    v_mfma_f32_16x16x32_bf16 v[160:163], v[40:43], a[200:203], v[160:163]
    ds_read_b128 v[32:35], v2 offset:256
    v_cvt_pk_bf16_f32 v89, v18, v19
    v_mfma_f32_16x16x32_bf16 v[160:163], v[44:47], a[204:207], v[160:163]
    buffer_store_dwordx4 v[148:151], v20, s[4:7], s35 offen offset:3072 sc1
    v_mfma_f32_16x16x32_bf16 v[164:167], v[40:43], a[224:227], v[164:167]
    v_exp_f32 v18, v122
    v_mfma_f32_16x16x32_bf16 v[164:167], v[44:47], a[228:231], v[164:167]
    v_add_f32 v7, v7, v16
    v_add_f32 v7, v7, v17
    v_mfma_f32_16x16x32_bf16 v[168:171], v[40:43], a[248:251], v[168:171]
    ds_read_b128 v[36:39], v3 offset:256
    v_and_b32 v51, s97, v58
    v_mfma_f32_16x16x32_bf16 v[168:171], v[44:47], a[252:255], v[168:171]
    v_exp_f32 v19, v123
    v_mfma_f32_16x16x32_bf16 v[172:175], v[40:43], v[208:211], v[172:175]
    v_cvt_pk_bf16_f32 v90, v16, v17
    v_mul_f32 v48, s38, v48
    v_mfma_f32_16x16x32_bf16 v[172:175], v[44:47], v[212:215], v[172:175]
    s_waitcnt lgkmcnt(2)
    v_exp_f32 v16, v92
    v_mfma_f32_16x16x32_bf16 v[96:99], v[24:27], a[200:203], v[96:99]
    ds_read_b128 v[40:43], v2 offset:6400
    v_add_f32 v7, v7, v18
    v_mfma_f32_16x16x32_bf16 v[96:99], v[28:31], a[204:207], v[96:99]
    buffer_store_dwordx4 v[152:155], v20, s[4:7], s17 offen offset:0 sc1
    v_mfma_f32_16x16x32_bf16 v[100:103], v[24:27], a[224:227], v[100:103]
    v_add_f32 v7, v7, v19
    v_mul_f32 v49, s38, v49
    v_mfma_f32_16x16x32_bf16 v[100:103], v[28:31], a[228:231], v[100:103]
    v_exp_f32 v17, v93
    v_mfma_f32_16x16x32_bf16 v[104:107], v[24:27], a[248:251], v[104:107]
    ds_read_b128 v[44:47], v3 offset:6400
    v_cvt_pk_bf16_f32 v91, v18, v19
    v_mfma_f32_16x16x32_bf16 v[104:107], v[28:31], a[252:255], v[104:107]
    v_exp_f32 v18, v94
    v_mfma_f32_16x16x32_bf16 v[108:111], v[24:27], v[208:211], v[108:111]
    s_add_u32 s29, s30, 49152
    v_add_f32 v8, v8, v16
    v_add_f32 v8, v8, v17
    v_mfma_f32_16x16x32_bf16 v[108:111], v[28:31], v[212:215], v[108:111]
    s_waitcnt lgkmcnt(2)
    v_exp_f32 v19, v95
    v_mfma_f32_16x16x32_bf16 v[160:163], v[32:35], a[208:211], v[160:163]
    s_sub_u32 s3, s29, 147456
    ds_read_b128 v[24:27], v2 offset:12288
    v_cvt_pk_bf16_f32 v92, v16, v17
    v_mfma_f32_16x16x32_bf16 v[160:163], v[36:39], a[212:215], v[160:163]
    buffer_store_dwordx4 v[156:159], v20, s[4:7], s17 offen offset:3072 sc1
    v_mfma_f32_16x16x32_bf16 v[164:167], v[32:35], a[232:235], v[164:167]
    s_min_u32 s29, s29, s3
    v_exp_f32 v16, v124
    v_mfma_f32_16x16x32_bf16 v[164:167], v[36:39], a[236:239], v[164:167]
    v_add_f32 v8, v8, v18
    v_add_f32 v8, v8, v19
    v_mfma_f32_16x16x32_bf16 v[168:171], v[32:35], v[192:195], v[168:171]
    ds_read_b128 v[28:31], v3 offset:12288
    v_mul_f32_e64 v50, -v50, v48
    v_mfma_f32_16x16x32_bf16 v[168:171], v[36:39], v[196:199], v[168:171]
    v_exp_f32 v17, v125
    v_mfma_f32_16x16x32_bf16 v[172:175], v[32:35], v[216:219], v[172:175]
    v_cvt_pk_bf16_f32 v93, v18, v19
    v_mul_f32_e64 v51, -v51, v49
    v_mfma_f32_16x16x32_bf16 v[172:175], v[36:39], v[220:223], v[172:175]
    s_waitcnt lgkmcnt(2)
    v_exp_f32 v18, v126
    v_mfma_f32_16x16x32_bf16 v[96:99], v[40:43], a[208:211], v[96:99]
    ds_read_b128 v[32:35], v2 offset:18432
    v_add_f32 v8, v8, v16
    v_mfma_f32_16x16x32_bf16 v[96:99], v[44:47], a[212:215], v[96:99]
    s_mov_b32 m0, s26
    v_add_f32 v8, v8, v17
    s_sub_u32 s3, s29, s30
    v_mfma_f32_16x16x32_bf16 v[100:103], v[40:43], a[232:235], v[100:103]
    v_exp_f32 v19, v127
    v_mfma_f32_16x16x32_bf16 v[100:103], v[44:47], a[236:239], v[100:103]
    buffer_load_dwordx4 v4, s[4:7], s32 offen offset:0 sc1 lds
    v_mfma_f32_16x16x32_bf16 v[104:107], v[40:43], v[192:195], v[104:107]
    ds_read_b128 v[36:39], v3 offset:18432
    v_cvt_pk_bf16_f32 v94, v16, v17
    v_mfma_f32_16x16x32_bf16 v[104:107], v[44:47], v[196:199], v[104:107]
    v_add_f32 v8, v8, v18
    v_add_f32 v8, v8, v19
    v_mfma_f32_16x16x32_bf16 v[108:111], v[40:43], v[216:219], v[108:111]
    v_cvt_pk_bf16_f32 v95, v18, v19
    v_cvt_f32_i32 v224, v224
    v_mfma_f32_16x16x32_bf16 v[108:111], v[44:47], v[220:223], v[108:111]
    s_waitcnt lgkmcnt(2)
    buffer_load_dwordx4 v4, s[4:7], s32 offen offset:1024 sc1 lds
    v_mfma_f32_16x16x32_bf16 v[176:179], v[24:27], a[192:195], v[128:131]
    ds_read_b128 v[40:43], v2 offset:12416
    v_cvt_f32_i32 v225, v225
    v_mfma_f32_16x16x32_bf16 v[176:179], v[28:31], a[196:199], v[176:179]
    s_mov_b32 s30, s29
    v_exp_f32 v16, v160
    v_mfma_f32_16x16x32_bf16 v[180:183], v[24:27], a[216:219], v[132:135]
    v_exp_f32 v17, v161
    v_mfma_f32_16x16x32_bf16 v[180:183], v[28:31], a[220:223], v[180:183]
    buffer_load_dwordx4 v4, s[4:7], s32 offen offset:2048 sc1 lds
    v_mfma_f32_16x16x32_bf16 v[184:187], v[24:27], a[240:243], v[136:139]
    s_add_u32 s32, s32, 24576
    ds_read_b128 v[44:47], v3 offset:12416
    v_mfma_f32_16x16x32_bf16 v[184:187], v[28:31], a[244:247], v[184:187]
    v_exp_f32 v18, v162
    v_mfma_f32_16x16x32_bf16 v[188:191], v[24:27], v[200:203], v[140:143]
    s_add_u32 s26, s26, 12288
    v_add_f32 v5, v5, v16
    v_add_f32 v5, v5, v17
    v_mfma_f32_16x16x32_bf16 v[188:191], v[28:31], v[204:207], v[188:191]
    s_waitcnt lgkmcnt(2)
    v_exp_f32 v19, v163
    v_mfma_f32_16x16x32_bf16 v[112:115], v[32:35], a[192:195], v[128:131]
    s_mov_b32 m0, s26
    ds_read_b128 v[24:27], v2 offset:18560
    v_cvt_pk_bf16_f32 v160, v16, v17
    v_mfma_f32_16x16x32_bf16 v[112:115], v[36:39], a[196:199], v[112:115]
    v_exp_f32 v16, v96
    v_mfma_f32_16x16x32_bf16 v[116:119], v[32:35], a[216:219], v[132:135]
    v_add_f32 v5, v5, v18
    v_fma_f32 v224, v224, v48, v50
    v_mfma_f32_16x16x32_bf16 v[116:119], v[36:39], a[220:223], v[116:119]
    v_add_f32 v5, v5, v19
    v_fma_f32 v225, v225, v49, v51
    v_mfma_f32_16x16x32_bf16 v[120:123], v[32:35], a[240:243], v[136:139]
    ds_read_b128 v[28:31], v3 offset:18560
    v_add_u32 v1, s3, v1
    v_mfma_f32_16x16x32_bf16 v[120:123], v[36:39], a[244:247], v[120:123]
    buffer_load_dwordx4 v4, s[4:7], s32 offen offset:0 sc1 lds
    v_mfma_f32_16x16x32_bf16 v[124:127], v[32:35], v[200:203], v[140:143]
    v_exp_f32 v17, v97
    v_mfma_f32_16x16x32_bf16 v[124:127], v[36:39], v[204:207], v[124:127]
    s_waitcnt lgkmcnt(2)
    v_cvt_pk_bf16_f32 v161, v18, v19
    v_mfma_f32_16x16x32_bf16 v[176:179], v[40:43], a[200:203], v[176:179]
    ds_read_b128 v[32:35], v2 offset:12544
    v_cvt_pk_bf16_f32 v224, v224, v225
    v_mfma_f32_16x16x32_bf16 v[176:179], v[44:47], a[204:207], v[176:179]
    buffer_load_dwordx4 v4, s[4:7], s32 offen offset:1024 sc1 lds
    v_mfma_f32_16x16x32_bf16 v[180:183], v[40:43], a[224:227], v[180:183]
    v_exp_f32 v18, v98
    v_mfma_f32_16x16x32_bf16 v[180:183], v[44:47], a[228:231], v[180:183]
    v_add_f32 v5, v5, v16
    v_add_f32 v5, v5, v17
    v_mfma_f32_16x16x32_bf16 v[184:187], v[40:43], a[248:251], v[184:187]
    ds_read_b128 v[36:39], v3 offset:12544
    v_mfma_f32_16x16x32_bf16 v[184:187], v[44:47], a[252:255], v[184:187]
    buffer_load_dwordx4 v4, s[4:7], s32 offen offset:2048 sc1 lds
    v_mfma_f32_16x16x32_bf16 v[188:191], v[40:43], v[208:211], v[188:191]
    v_exp_f32 v19, v99
    v_mfma_f32_16x16x32_bf16 v[188:191], v[44:47], v[212:215], v[188:191]
    s_waitcnt lgkmcnt(2)
    v_cvt_pk_bf16_f32 v162, v16, v17
    v_cvt_f32_i32 v228, v228
    v_mfma_f32_16x16x32_bf16 v[112:115], v[24:27], a[200:203], v[112:115]
    ds_read_b128 v[40:43], v2 offset:18688
    v_mfma_f32_16x16x32_bf16 v[112:115], v[28:31], a[204:207], v[112:115]
    v_exp_f32 v16, v164
    v_mfma_f32_16x16x32_bf16 v[116:119], v[24:27], a[224:227], v[116:119]
    v_add_f32 v5, v5, v18
    v_add_f32 v5, v5, v19
    v_mfma_f32_16x16x32_bf16 v[116:119], v[28:31], a[228:231], v[116:119]
    s_add_u32 s32, s32, 24576
    v_exp_f32 v17, v165
    v_mfma_f32_16x16x32_bf16 v[120:123], v[24:27], a[248:251], v[120:123]
    s_add_u32 s26, s26, 36864
    ds_read_b128 v[44:47], v3 offset:18688
    v_cvt_pk_bf16_f32 v163, v18, v19
    v_mfma_f32_16x16x32_bf16 v[120:123], v[28:31], a[252:255], v[120:123]
    s_waitcnt lgkmcnt(2)
    v_exp_f32 v18, v166
    v_mfma_f32_16x16x32_bf16 v[124:127], v[24:27], v[208:211], v[124:127]
    s_waitcnt vmcnt(6)
    v_add_f32 v6, v6, v16
    v_add_f32 v6, v6, v17
    v_mfma_f32_16x16x32_bf16 v[124:127], v[28:31], v[212:215], v[124:127]
    s_barrier
    s_sub_u32 s57, s26, 147456
    v_mfma_f32_16x16x32_bf16 v[176:179], v[32:35], a[208:211], v[176:179]
    s_min_u32 s26, s26, s57
    ds_read_b128 v[24:27], v1 offset:0
    v_add_u32 v0, 1, v0
    v_mfma_f32_16x16x32_bf16 v[176:179], v[36:39], a[212:215], v[176:179]
    buffer_store_dword v0, v13, s[20:23], 0 offen offset:32 sc1
    v_mfma_f32_16x16x32_bf16 v[180:183], v[32:35], a[232:235], v[180:183]
    v_exp_f32 v19, v167
    v_mfma_f32_16x16x32_bf16 v[180:183], v[36:39], a[236:239], v[180:183]
    v_cvt_pk_bf16_f32 v164, v16, v17
    v_cvt_f32_i32 v229, v229
    v_mfma_f32_16x16x32_bf16 v[184:187], v[32:35], v[192:195], v[184:187]
    ds_read_b128 v[28:31], v1 offset:12288
    v_fma_f32 v228, v228, v48, v50
    v_mfma_f32_16x16x32_bf16 v[184:187], v[36:39], v[196:199], v[184:187]
    v_exp_f32 v16, v100
    v_mfma_f32_16x16x32_bf16 v[188:191], v[32:35], v[216:219], v[188:191]
    v_add_f32 v6, v6, v18
    v_add_f32 v6, v6, v19
    v_mfma_f32_16x16x32_bf16 v[188:191], v[36:39], v[220:223], v[188:191]
    s_waitcnt lgkmcnt(2)
    v_exp_f32 v17, v101
    v_mfma_f32_16x16x32_bf16 v[112:115], v[40:43], a[208:211], v[112:115]
    ds_read_b128 v[32:35], v1 offset:1024
    v_cvt_pk_bf16_f32 v165, v18, v19
    v_mfma_f32_16x16x32_bf16 v[112:115], v[44:47], a[212:215], v[112:115]
    v_exp_f32 v18, v102
    v_mfma_f32_16x16x32_bf16 v[116:119], v[40:43], a[232:235], v[116:119]
    v_add_f32 v6, v6, v16
    v_add_f32 v6, v6, v17
    v_mfma_f32_16x16x32_bf16 v[116:119], v[44:47], a[236:239], v[116:119]
    v_exp_f32 v19, v103
    v_mfma_f32_16x16x32_bf16 v[120:123], v[40:43], v[192:195], v[120:123]
    ds_read_b128 v[36:39], v1 offset:13312
    v_cvt_pk_bf16_f32 v166, v16, v17
    v_mfma_f32_16x16x32_bf16 v[120:123], v[44:47], v[196:199], v[120:123]
    v_add_f32 v6, v6, v18
    v_add_f32 v6, v6, v19
    v_mfma_f32_16x16x32_bf16 v[124:127], v[40:43], v[216:219], v[124:127]
    v_cvt_pk_bf16_f32 v167, v18, v19
    v_mfma_f32_16x16x32_bf16 v[124:127], v[44:47], v[220:223], v[124:127]
    s_waitcnt lgkmcnt(2)
    v_mfma_f32_16x16x32_bf16 a[0:3], v[24:27], v[64:67], a[0:3]
    s_mov_b32 m0, s26
    ds_read_b128 v[40:43], v1 offset:2048
    v_fma_f32 v229, v229, v49, v51
    v_mfma_f32_16x16x32_bf16 a[0:3], v[28:31], v[80:83], a[0:3]
    buffer_load_dwordx2 v[60:61], v10, s[72:75], s36 offen offset:192
    v_mfma_f32_16x16x32_bf16 a[48:51], v[24:27], v[68:71], a[48:51]
    v_exp_f32 v16, v168
    v_mfma_f32_16x16x32_bf16 a[48:51], v[28:31], v[84:87], a[48:51]
    v_exp_f32 v17, v169
    v_mfma_f32_16x16x32_bf16 a[96:99], v[24:27], v[72:75], a[96:99]
    ds_read_b128 v[44:47], v1 offset:14336
    v_cvt_pk_bf16_f32 v228, v228, v229
    v_mfma_f32_16x16x32_bf16 a[96:99], v[28:31], v[88:91], a[96:99]
    buffer_load_dwordx4 v4, s[4:7], s32 offen offset:0 sc1 lds
    v_mfma_f32_16x16x32_bf16 a[144:147], v[24:27], v[76:79], a[144:147]
    v_exp_f32 v18, v170
    v_mfma_f32_16x16x32_bf16 a[144:147], v[28:31], v[92:95], a[144:147]
    s_waitcnt lgkmcnt(2)
    v_add_f32 v7, v7, v16
    v_add_f32 v7, v7, v17
    v_mfma_f32_16x16x32_bf16 a[4:7], v[32:35], v[64:67], a[4:7]
    ds_read_b128 v[24:27], v1 offset:3072
    v_cvt_f32_i32 v232, v232
    v_mfma_f32_16x16x32_bf16 a[4:7], v[36:39], v[80:83], a[4:7]
    buffer_load_dwordx2 v[62:63], v10, s[76:79], s36 offen offset:192
    v_mfma_f32_16x16x32_bf16 a[52:55], v[32:35], v[68:71], a[52:55]
    v_exp_f32 v19, v171
    v_mfma_f32_16x16x32_bf16 a[52:55], v[36:39], v[84:87], a[52:55]
    v_cvt_pk_bf16_f32 v168, v16, v17
    v_cvt_f32_i32 v233, v233
    v_mfma_f32_16x16x32_bf16 a[100:103], v[32:35], v[72:75], a[100:103]
    ds_read_b128 v[28:31], v1 offset:15360
    v_fma_f32 v232, v232, v48, v50
    v_mfma_f32_16x16x32_bf16 a[100:103], v[36:39], v[88:91], a[100:103]
    buffer_load_dwordx4 v[240:243], v9, s[64:67], s33 offen offset:384 nt
    v_mfma_f32_16x16x32_bf16 a[148:151], v[32:35], v[76:79], a[148:151]
    v_exp_f32 v16, v104
    v_mfma_f32_16x16x32_bf16 a[148:151], v[36:39], v[92:95], a[148:151]
    s_waitcnt lgkmcnt(2)
    v_add_f32 v7, v7, v18
    v_add_f32 v7, v7, v19
    v_mfma_f32_16x16x32_bf16 a[8:11], v[40:43], v[64:67], a[8:11]
    ds_read_b128 v[32:35], v1 offset:4096
    v_fma_f32 v233, v233, v49, v51
    v_mfma_f32_16x16x32_bf16 a[8:11], v[44:47], v[80:83], a[8:11]
    buffer_load_dwordx4 v4, s[4:7], s32 offen offset:1024 sc1 lds
    v_mfma_f32_16x16x32_bf16 a[56:59], v[40:43], v[68:71], a[56:59]
    v_exp_f32 v17, v105
    v_mfma_f32_16x16x32_bf16 a[56:59], v[44:47], v[84:87], a[56:59]
    v_cvt_pk_bf16_f32 v169, v18, v19
    v_cvt_pk_bf16_f32 v232, v232, v233
    v_mfma_f32_16x16x32_bf16 a[104:107], v[40:43], v[72:75], a[104:107]
    ds_read_b128 v[36:39], v1 offset:16384
    v_cvt_f32_i32 v236, v236
    v_mfma_f32_16x16x32_bf16 a[104:107], v[44:47], v[88:91], a[104:107]
    buffer_load_dwordx4 v[244:247], v9, s[64:67], s33 offen offset:1920 nt
    v_mfma_f32_16x16x32_bf16 a[152:155], v[40:43], v[76:79], a[152:155]
    v_exp_f32 v18, v106
    v_mfma_f32_16x16x32_bf16 a[152:155], v[44:47], v[92:95], a[152:155]
    s_waitcnt lgkmcnt(2)
    v_add_f32 v7, v7, v16
    v_add_f32 v7, v7, v17
    v_mfma_f32_16x16x32_bf16 a[12:15], v[24:27], v[64:67], a[12:15]
    ds_read_b128 v[40:43], v1 offset:5120
    v_cvt_f32_i32 v237, v237
    v_mfma_f32_16x16x32_bf16 a[12:15], v[28:31], v[80:83], a[12:15]
    buffer_load_dwordx4 v4, s[4:7], s32 offen offset:2048 sc1 lds
    v_mfma_f32_16x16x32_bf16 a[60:63], v[24:27], v[68:71], a[60:63]
    v_exp_f32 v19, v107
    v_mfma_f32_16x16x32_bf16 a[60:63], v[28:31], v[84:87], a[60:63]
    v_cvt_pk_bf16_f32 v170, v16, v17
    v_exp_f32 v16, v172
    v_mfma_f32_16x16x32_bf16 a[108:111], v[24:27], v[72:75], a[108:111]
    ds_read_b128 v[44:47], v1 offset:17408
    v_add_f32 v7, v7, v18
    v_mfma_f32_16x16x32_bf16 a[108:111], v[28:31], v[88:91], a[108:111]
    buffer_load_dwordx4 v[248:251], v9, s[64:67], s34 offen offset:384 nt
    v_add_f32 v7, v7, v19
    v_mfma_f32_16x16x32_bf16 a[156:159], v[24:27], v[76:79], a[156:159]
    s_add_u32 s29, s28, 49152
    v_exp_f32 v17, v173
    v_mfma_f32_16x16x32_bf16 a[156:159], v[28:31], v[92:95], a[156:159]
    s_waitcnt lgkmcnt(2)
    v_cvt_pk_bf16_f32 v171, v18, v19
    v_fma_f32 v236, v236, v48, v50
    v_mfma_f32_16x16x32_bf16 a[16:19], v[32:35], v[64:67], a[16:19]
    s_sub_u32 s3, s29, 147456
    ds_read_b128 v[24:27], v1 offset:6144
    v_fma_f32 v237, v237, v49, v51
    v_mfma_f32_16x16x32_bf16 a[16:19], v[36:39], v[80:83], a[16:19]
    s_add_u32 s32, s32, 24576
    buffer_load_dwordx4 v[252:255], v9, s[64:67], s34 offen offset:1920 nt
    v_mfma_f32_16x16x32_bf16 a[64:67], v[32:35], v[68:71], a[64:67]
    s_min_u32 s29, s29, s3
    v_exp_f32 v18, v174
    v_mfma_f32_16x16x32_bf16 a[64:67], v[36:39], v[84:87], a[64:67]
    v_add_f32 v8, v8, v16
    v_add_f32 v8, v8, v17
    v_mfma_f32_16x16x32_bf16 a[112:115], v[32:35], v[72:75], a[112:115]
    s_add_u32 s26, s26, 12288
    ds_read_b128 v[28:31], v1 offset:18432
    v_cvt_pk_bf16_f32 v236, v236, v237
    v_mfma_f32_16x16x32_bf16 a[112:115], v[36:39], v[88:91], a[112:115]
    v_exp_f32 v19, v175
    v_cvt_pk_bf16_f32 v172, v16, v17
    v_mfma_f32_16x16x32_bf16 a[160:163], v[32:35], v[76:79], a[160:163]
    v_exp_f32 v16, v108
    v_mfma_f32_16x16x32_bf16 a[160:163], v[36:39], v[92:95], a[160:163]
    s_waitcnt lgkmcnt(2)
    v_add_f32 v8, v8, v18
    v_add_f32 v8, v8, v19
    v_mfma_f32_16x16x32_bf16 a[20:23], v[40:43], v[64:67], a[20:23]
    s_sub_u32 s3, s29, s28
    ds_read_b128 v[32:35], v1 offset:7168
    v_lshlrev_b32 v48, 16, v57
    v_mfma_f32_16x16x32_bf16 a[20:23], v[44:47], v[80:83], a[20:23]
    v_exp_f32 v17, v109
    v_mfma_f32_16x16x32_bf16 a[68:71], v[40:43], v[68:71], a[68:71]
    s_mov_b32 m0, s26
    v_cvt_pk_bf16_f32 v173, v18, v19
    v_and_b32 v49, s97, v57
    v_mfma_f32_16x16x32_bf16 a[68:71], v[44:47], v[84:87], a[68:71]
    v_exp_f32 v18, v110
    v_mfma_f32_16x16x32_bf16 a[116:119], v[40:43], v[72:75], a[116:119]
    ds_read_b128 v[36:39], v1 offset:19456
    v_add_f32 v8, v8, v16
    v_mfma_f32_16x16x32_bf16 a[116:119], v[44:47], v[88:91], a[116:119]
    v_add_f32 v8, v8, v17
    v_mfma_f32_16x16x32_bf16 a[164:167], v[40:43], v[76:79], a[164:167]
    s_mov_b32 s28, s29
    v_exp_f32 v19, v111
    v_mfma_f32_16x16x32_bf16 a[164:167], v[44:47], v[92:95], a[164:167]
    s_waitcnt lgkmcnt(2)
    v_cvt_pk_bf16_f32 v174, v16, v17
    v_add_f32 v8, v8, v18
    v_mfma_f32_16x16x32_bf16 a[24:27], v[24:27], v[64:67], a[24:27]
    ds_read_b128 v[40:43], v1 offset:8192
    v_add_f32 v8, v8, v19
    v_mfma_f32_16x16x32_bf16 a[24:27], v[28:31], v[80:83], a[24:27]
    v_cvt_pk_bf16_f32 v175, v18, v19
    v_lshlrev_b32 v50, 16, v59
    v_mfma_f32_16x16x32_bf16 a[72:75], v[24:27], v[68:71], a[72:75]
    v_exp_f32 v16, v176
    v_mfma_f32_16x16x32_bf16 a[72:75], v[28:31], v[84:87], a[72:75]
    buffer_load_dwordx4 v4, s[4:7], s32 offen offset:0 sc1 lds
    v_mfma_f32_16x16x32_bf16 a[120:123], v[24:27], v[72:75], a[120:123]
    ds_read_b128 v[44:47], v1 offset:20480
    v_and_b32 v51, s97, v59
    v_mfma_f32_16x16x32_bf16 a[120:123], v[28:31], v[88:91], a[120:123]
    v_exp_f32 v17, v177
    v_mfma_f32_16x16x32_bf16 a[168:171], v[24:27], v[76:79], a[168:171]
    v_exp_f32 v18, v178
    v_mfma_f32_16x16x32_bf16 a[168:171], v[28:31], v[92:95], a[168:171]
    s_waitcnt lgkmcnt(2)
    v_add_f32 v5, v5, v16
    v_add_f32 v5, v5, v17
    v_mfma_f32_16x16x32_bf16 a[28:31], v[32:35], v[64:67], a[28:31]
    ds_read_b128 v[24:27], v1 offset:9216
    v_mul_f32 v48, s38, v48
    v_mfma_f32_16x16x32_bf16 a[28:31], v[36:39], v[80:83], a[28:31]
    v_exp_f32 v19, v179
    v_mfma_f32_16x16x32_bf16 a[76:79], v[32:35], v[68:71], a[76:79]
    v_cvt_pk_bf16_f32 v176, v16, v17
    v_add_u32 v2, s3, v2
    v_mfma_f32_16x16x32_bf16 a[76:79], v[36:39], v[84:87], a[76:79]
    v_exp_f32 v16, v112
    v_mfma_f32_16x16x32_bf16 a[124:127], v[32:35], v[72:75], a[124:127]
    ds_read_b128 v[28:31], v1 offset:21504
    v_add_f32 v5, v5, v18
    v_mfma_f32_16x16x32_bf16 a[124:127], v[36:39], v[88:91], a[124:127]
    v_add_f32 v5, v5, v19
    v_mul_f32 v49, s38, v49
    v_mfma_f32_16x16x32_bf16 a[172:175], v[32:35], v[76:79], a[172:175]
    v_exp_f32 v17, v113
    v_mfma_f32_16x16x32_bf16 a[172:175], v[36:39], v[92:95], a[172:175]
    s_waitcnt lgkmcnt(2)
    buffer_load_dwordx4 v4, s[4:7], s32 offen offset:1024 sc1 lds
    v_mfma_f32_16x16x32_bf16 a[32:35], v[40:43], v[64:67], a[32:35]
    ds_read_b128 v[32:35], v1 offset:10240
    v_cvt_pk_bf16_f32 v177, v18, v19
    v_mfma_f32_16x16x32_bf16 a[32:35], v[44:47], v[80:83], a[32:35]
    v_exp_f32 v18, v114
    v_mfma_f32_16x16x32_bf16 a[80:83], v[40:43], v[68:71], a[80:83]
    v_add_f32 v5, v5, v16
    v_add_f32 v5, v5, v17
    v_mfma_f32_16x16x32_bf16 a[80:83], v[44:47], v[84:87], a[80:83]
    v_exp_f32 v19, v115
    v_mfma_f32_16x16x32_bf16 a[128:131], v[40:43], v[72:75], a[128:131]
    ds_read_b128 v[36:39], v1 offset:22528
    v_mul_f32_e64 v50, -v50, v48
    v_mfma_f32_16x16x32_bf16 a[128:131], v[44:47], v[88:91], a[128:131]
    v_cvt_pk_bf16_f32 v178, v16, v17
    v_mul_f32_e64 v51, -v51, v49
    v_mfma_f32_16x16x32_bf16 a[176:179], v[40:43], v[76:79], a[176:179]
    v_exp_f32 v16, v180
    v_mfma_f32_16x16x32_bf16 a[176:179], v[44:47], v[92:95], a[176:179]
    s_waitcnt lgkmcnt(2)
    v_add_f32 v5, v5, v18
    v_add_u32 v3, s3, v3
    v_mfma_f32_16x16x32_bf16 a[36:39], v[24:27], v[64:67], a[36:39]
    ds_read_b128 v[40:43], v1 offset:11264
    v_add_f32 v5, v5, v19
    v_mfma_f32_16x16x32_bf16 a[36:39], v[28:31], v[80:83], a[36:39]
    buffer_load_dwordx4 v4, s[4:7], s32 offen offset:2048 sc1 lds
    v_mfma_f32_16x16x32_bf16 a[84:87], v[24:27], v[68:71], a[84:87]
    v_exp_f32 v17, v181
    v_mfma_f32_16x16x32_bf16 a[84:87], v[28:31], v[84:87], a[84:87]
    v_cvt_pk_bf16_f32 v179, v18, v19
    v_cvt_f32_i32 v226, v226
    v_mfma_f32_16x16x32_bf16 a[132:135], v[24:27], v[72:75], a[132:135]
    ds_read_b128 v[44:47], v1 offset:23552
    v_cvt_f32_i32 v227, v227
    v_mfma_f32_16x16x32_bf16 a[132:135], v[28:31], v[88:91], a[132:135]
    s_waitcnt lgkmcnt(2)
    v_exp_f32 v18, v182
    v_mfma_f32_16x16x32_bf16 a[180:183], v[24:27], v[76:79], a[180:183]
    s_waitcnt vmcnt(13)
    v_add_f32 v6, v6, v16
    v_add_f32 v6, v6, v17
    v_mfma_f32_16x16x32_bf16 a[180:183], v[28:31], v[92:95], a[180:183]
    s_barrier
    v_fma_f32 v226, v226, v48, v50
    v_mfma_f32_16x16x32_bf16 a[40:43], v[32:35], v[64:67], a[40:43]
    ds_read_b128 v[24:27], v2 offset:0
    v_fma_f32 v227, v227, v49, v51
    v_mfma_f32_16x16x32_bf16 a[40:43], v[36:39], v[80:83], a[40:43]
    v_exp_f32 v19, v183
    v_mfma_f32_16x16x32_bf16 a[88:91], v[32:35], v[68:71], a[88:91]
    v_cvt_pk_bf16_f32 v180, v16, v17
    v_mfma_f32_16x16x32_bf16 a[88:91], v[36:39], v[84:87], a[88:91]
    v_exp_f32 v16, v116
    v_mfma_f32_16x16x32_bf16 a[136:139], v[32:35], v[72:75], a[136:139]
    ds_read_b128 v[28:31], v3 offset:0
    v_add_f32 v6, v6, v18
    v_mfma_f32_16x16x32_bf16 a[136:139], v[36:39], v[88:91], a[136:139]
    v_add_f32 v6, v6, v19
    v_cvt_pk_bf16_f32 v225, v226, v227
    v_mfma_f32_16x16x32_bf16 a[184:187], v[32:35], v[76:79], a[184:187]
    v_exp_f32 v17, v117
    v_mfma_f32_16x16x32_bf16 a[184:187], v[36:39], v[92:95], a[184:187]
    s_waitcnt lgkmcnt(2)
    v_cvt_pk_bf16_f32 v181, v18, v19
    v_cvt_f32_i32 v230, v230
    v_mfma_f32_16x16x32_bf16 a[44:47], v[40:43], v[64:67], a[44:47]
    ds_read_b128 v[32:35], v2 offset:6144
    v_mfma_f32_16x16x32_bf16 a[44:47], v[44:47], v[80:83], a[44:47]
    v_exp_f32 v18, v118
    v_mfma_f32_16x16x32_bf16 a[92:95], v[40:43], v[68:71], a[92:95]
    v_add_f32 v6, v6, v16
    v_add_f32 v6, v6, v17
    v_mfma_f32_16x16x32_bf16 a[92:95], v[44:47], v[84:87], a[92:95]
    s_add_u32 s32, s32, 24576
    v_exp_f32 v19, v119
    v_mfma_f32_16x16x32_bf16 a[140:143], v[40:43], v[72:75], a[140:143]
    s_add_u32 s26, s26, 36864
    ds_read_b128 v[36:39], v3 offset:6144
    v_cvt_pk_bf16_f32 v182, v16, v17
    v_mfma_f32_16x16x32_bf16 a[140:143], v[44:47], v[88:91], a[140:143]
    s_sub_u32 s57, s26, 147456
    v_add_f32 v6, v6, v18
    v_add_f32 v6, v6, v19
    v_mfma_f32_16x16x32_bf16 a[188:191], v[40:43], v[76:79], a[188:191]
    s_min_u32 s26, s26, s57
    v_cvt_pk_bf16_f32 v183, v18, v19
    v_mfma_f32_16x16x32_bf16 a[188:191], v[44:47], v[92:95], a[188:191]
    s_waitcnt lgkmcnt(2)
    v_mfma_f32_16x16x32_bf16 v[64:67], v[24:27], a[192:195], v[128:131]
    ds_read_b128 v[40:43], v2 offset:128
    v_cvt_f32_i32 v231, v231
    v_mfma_f32_16x16x32_bf16 v[64:67], v[28:31], a[196:199], v[64:67]
    v_exp_f32 v16, v184
    v_mfma_f32_16x16x32_bf16 v[68:71], v[24:27], a[216:219], v[132:135]
    v_exp_f32 v17, v185
    v_mfma_f32_16x16x32_bf16 v[68:71], v[28:31], a[220:223], v[68:71]
    v_bfe_u32 v53, v4, 4, 6
    v_fma_f32 v230, v230, v48, v50
    v_mfma_f32_16x16x32_bf16 v[72:75], v[24:27], a[240:243], v[136:139]
    ds_read_b128 v[44:47], v3 offset:128
    v_lshlrev_b32 v53, 2, v53
    v_mfma_f32_16x16x32_bf16 v[72:75], v[28:31], a[244:247], v[72:75]
    buffer_load_dword v52, v53, s[20:23], s44 offen sc1
    v_mfma_f32_16x16x32_bf16 v[76:79], v[24:27], v[200:203], v[140:143]
    v_exp_f32 v18, v186
    v_mfma_f32_16x16x32_bf16 v[76:79], v[28:31], v[204:207], v[76:79]
    s_waitcnt lgkmcnt(2)
    v_add_f32 v7, v7, v16
    v_add_f32 v7, v7, v17
    v_mfma_f32_16x16x32_bf16 v[96:99], v[32:35], a[192:195], v[128:131]
    ds_read_b128 v[24:27], v2 offset:6272
    v_fma_f32 v231, v231, v49, v51
    v_mfma_f32_16x16x32_bf16 v[96:99], v[36:39], a[196:199], v[96:99]
    v_exp_f32 v19, v187
    v_mfma_f32_16x16x32_bf16 v[100:103], v[32:35], a[216:219], v[132:135]
    v_cvt_pk_bf16_f32 v184, v16, v17
    v_cvt_pk_bf16_f32 v229, v230, v231
    v_mfma_f32_16x16x32_bf16 v[100:103], v[36:39], a[220:223], v[100:103]
    s_add_u32 s35, s35, 196608
    v_exp_f32 v16, v120
    v_mfma_f32_16x16x32_bf16 v[104:107], v[32:35], a[240:243], v[136:139]
    s_mov_b32 m0, s26
    ds_read_b128 v[28:31], v3 offset:6272
    v_add_f32 v7, v7, v18
    v_mfma_f32_16x16x32_bf16 v[104:107], v[36:39], a[244:247], v[104:107]
    s_add_u32 s16, s16, 196608
    buffer_load_dwordx4 v4, s[4:7], s32 offen offset:0 sc1 lds
    v_mfma_f32_16x16x32_bf16 v[108:111], v[32:35], v[200:203], v[140:143]
    s_add_u32 s17, s17, 196608
    v_add_f32 v7, v7, v19
    v_cvt_f32_i32 v234, v234
    v_mfma_f32_16x16x32_bf16 v[108:111], v[36:39], v[204:207], v[108:111]
    s_waitcnt lgkmcnt(2)
    v_exp_f32 v17, v121
    v_mfma_f32_16x16x32_bf16 v[64:67], v[40:43], a[200:203], v[64:67]
    s_add_u32 s37, s37, 512
    ds_read_b128 v[32:35], v2 offset:256
    v_cvt_pk_bf16_f32 v185, v18, v19
    v_mfma_f32_16x16x32_bf16 v[64:67], v[44:47], a[204:207], v[64:67]
    v_exp_f32 v18, v122
    v_mfma_f32_16x16x32_bf16 v[68:71], v[40:43], a[224:227], v[68:71]
    v_add_f32 v7, v7, v16
    v_add_f32 v7, v7, v17
    v_mfma_f32_16x16x32_bf16 v[68:71], v[44:47], a[228:231], v[68:71]
    v_exp_f32 v19, v123
    v_mfma_f32_16x16x32_bf16 v[72:75], v[40:43], a[248:251], v[72:75]
    ds_read_b128 v[36:39], v3 offset:256
    v_cvt_pk_bf16_f32 v186, v16, v17
    v_mfma_f32_16x16x32_bf16 v[72:75], v[44:47], a[252:255], v[72:75]
    buffer_load_dwordx4 v4, s[4:7], s32 offen offset:1024 sc1 lds
    v_mfma_f32_16x16x32_bf16 v[76:79], v[40:43], v[208:211], v[76:79]
    v_exp_f32 v16, v188
    v_mfma_f32_16x16x32_bf16 v[76:79], v[44:47], v[212:215], v[76:79]
    s_waitcnt lgkmcnt(2)
    v_add_f32 v7, v7, v18
    v_cvt_f32_i32 v235, v235
    v_mfma_f32_16x16x32_bf16 v[96:99], v[24:27], a[200:203], v[96:99]
    ds_read_b128 v[40:43], v2 offset:6400
    v_add_f32 v7, v7, v19
    v_mfma_f32_16x16x32_bf16 v[96:99], v[28:31], a[204:207], v[96:99]
    buffer_load_dwordx2 v[56:57], off, s[80:83], s37 offset:0
    v_mfma_f32_16x16x32_bf16 v[100:103], v[24:27], a[224:227], v[100:103]
    v_exp_f32 v17, v189
    v_mfma_f32_16x16x32_bf16 v[100:103], v[28:31], a[228:231], v[100:103]
    v_cvt_pk_bf16_f32 v187, v18, v19
    v_fma_f32 v234, v234, v48, v50
    v_mfma_f32_16x16x32_bf16 v[104:107], v[24:27], a[248:251], v[104:107]
    ds_read_b128 v[44:47], v3 offset:6400
    v_fma_f32 v235, v235, v49, v51
    v_mfma_f32_16x16x32_bf16 v[104:107], v[28:31], a[252:255], v[104:107]
    buffer_load_dwordx2 v[58:59], off, s[84:87], s37 offset:0
    v_mfma_f32_16x16x32_bf16 v[108:111], v[24:27], v[208:211], v[108:111]
    s_add_u32 s29, s30, 49152
    v_exp_f32 v18, v190
    v_mfma_f32_16x16x32_bf16 v[108:111], v[28:31], v[212:215], v[108:111]
    s_waitcnt lgkmcnt(2)
    v_add_f32 v8, v8, v16
    v_add_f32 v8, v8, v17
    v_mfma_f32_16x16x32_bf16 v[64:67], v[32:35], a[208:211], v[64:67]
    s_sub_u32 s3, s29, 147456
    ds_read_b128 v[24:27], v2 offset:12288
    v_cvt_pk_bf16_f32 v233, v234, v235
    v_mfma_f32_16x16x32_bf16 v[64:67], v[36:39], a[212:215], v[64:67]
    s_min_u32 s29, s29, s3
    buffer_load_dwordx4 v4, s[4:7], s32 offen offset:2048 sc1 lds
    v_mfma_f32_16x16x32_bf16 v[68:71], v[32:35], a[232:235], v[68:71]
    v_exp_f32 v19, v191
    v_mfma_f32_16x16x32_bf16 v[68:71], v[36:39], a[236:239], v[68:71]
    v_cvt_pk_bf16_f32 v188, v16, v17
    v_cvt_f32_i32 v238, v238
    v_mfma_f32_16x16x32_bf16 v[72:75], v[32:35], v[192:195], v[72:75]
    ds_read_b128 v[28:31], v3 offset:12288
    v_mfma_f32_16x16x32_bf16 v[72:75], v[36:39], v[196:199], v[72:75]
    buffer_load_dwordx4 v[144:147], v12, s[68:71], s35 offen offset:0 nt
    v_mfma_f32_16x16x32_bf16 v[76:79], v[32:35], v[216:219], v[76:79]
    v_exp_f32 v16, v124
    v_mfma_f32_16x16x32_bf16 v[76:79], v[36:39], v[220:223], v[76:79]
    s_waitcnt lgkmcnt(2)
    v_add_f32 v8, v8, v18
    v_add_f32 v8, v8, v19
    v_mfma_f32_16x16x32_bf16 v[96:99], v[40:43], a[208:211], v[96:99]
    s_add_u32 s32, s32, 24576
    ds_read_b128 v[32:35], v2 offset:18432
    v_cvt_f32_i32 v239, v239
    v_mfma_f32_16x16x32_bf16 v[96:99], v[44:47], a[212:215], v[96:99]
    s_sub_u32 s3, s29, s30
    v_exp_f32 v17, v125
    v_mfma_f32_16x16x32_bf16 v[100:103], v[40:43], a[232:235], v[100:103]
    v_cvt_pk_bf16_f32 v189, v18, v19
    v_fma_f32 v238, v238, v48, v50
    v_mfma_f32_16x16x32_bf16 v[100:103], v[44:47], a[236:239], v[100:103]
    v_exp_f32 v18, v126
    v_mfma_f32_16x16x32_bf16 v[104:107], v[40:43], v[192:195], v[104:107]
    s_add_u32 s26, s26, 12288
    ds_read_b128 v[36:39], v3 offset:18432
    v_add_f32 v8, v8, v16
    v_mfma_f32_16x16x32_bf16 v[104:107], v[44:47], v[196:199], v[104:107]
    buffer_load_dwordx4 v[148:151], v12, s[68:71], s35 offen offset:768 nt
    v_mfma_f32_16x16x32_bf16 v[108:111], v[40:43], v[216:219], v[108:111]
    v_add_f32 v8, v8, v17
    v_fma_f32 v239, v239, v49, v51
    v_mfma_f32_16x16x32_bf16 v[108:111], v[44:47], v[220:223], v[108:111]
    s_waitcnt lgkmcnt(2)
    v_exp_f32 v19, v127
    v_mfma_f32_16x16x32_bf16 v[80:83], v[24:27], a[192:195], v[128:131]
    ds_read_b128 v[40:43], v2 offset:12416
    v_cvt_pk_bf16_f32 v190, v16, v17
    v_mfma_f32_16x16x32_bf16 v[80:83], v[28:31], a[196:199], v[80:83]
    s_mov_b32 m0, s26
    v_add_f32 v8, v8, v18
    v_add_f32 v8, v8, v19
    v_mfma_f32_16x16x32_bf16 v[84:87], v[24:27], a[216:219], v[132:135]
    s_mov_b32 s30, s29
    v_cvt_pk_bf16_f32 v191, v18, v19
    v_cvt_pk_bf16_f32 v237, v238, v239
    v_mfma_f32_16x16x32_bf16 v[84:87], v[28:31], a[220:223], v[84:87]
    v_exp_f32 v16, v64
    v_mfma_f32_16x16x32_bf16 v[88:91], v[24:27], a[240:243], v[136:139]
    ds_read_b128 v[44:47], v3 offset:12416
    v_mfma_f32_16x16x32_bf16 v[88:91], v[28:31], a[244:247], v[88:91]
    buffer_load_dwordx4 v[152:155], v12, s[68:71], s35 offen offset:1536 nt
    v_mfma_f32_16x16x32_bf16 v[92:95], v[24:27], v[200:203], v[140:143]
    v_exp_f32 v17, v65
    v_mfma_f32_16x16x32_bf16 v[92:95], v[28:31], v[204:207], v[92:95]
    s_waitcnt lgkmcnt(2)
    v_exp_f32 v18, v66
    v_mfma_f32_16x16x32_bf16 v[112:115], v[32:35], a[192:195], v[128:131]
    ds_read_b128 v[24:27], v2 offset:18560
    v_add_f32 v5, v5, v16
    v_mfma_f32_16x16x32_bf16 v[112:115], v[36:39], a[196:199], v[112:115]
    buffer_load_dwordx4 v4, s[4:7], s32 offen offset:0 sc1 lds
    v_mfma_f32_16x16x32_bf16 v[116:119], v[32:35], a[216:219], v[132:135]
    v_add_f32 v5, v5, v17
    v_add_u32 v1, s3, v1
    v_mfma_f32_16x16x32_bf16 v[116:119], v[36:39], a[220:223], v[116:119]
    v_exp_f32 v19, v67
    v_mfma_f32_16x16x32_bf16 v[120:123], v[32:35], a[240:243], v[136:139]
    ds_read_b128 v[28:31], v3 offset:18560
    v_cvt_pk_bf16_f32 v64, v16, v17
    v_mfma_f32_16x16x32_bf16 v[120:123], v[36:39], a[244:247], v[120:123]
    s_waitcnt vmcnt(13)
    buffer_load_dwordx4 v[156:159], v12, s[68:71], s35 offen offset:2304 nt
    v_mfma_f32_16x16x32_bf16 v[124:127], v[32:35], v[200:203], v[140:143]
    v_exp_f32 v16, v96
    v_mfma_f32_16x16x32_bf16 v[124:127], v[36:39], v[204:207], v[124:127]
    s_waitcnt lgkmcnt(2)
    v_add_f32 v5, v5, v18
    v_add_f32 v5, v5, v19
    v_mfma_f32_16x16x32_bf16 v[80:83], v[40:43], a[200:203], v[80:83]
    ds_read_b128 v[32:35], v2 offset:12544
    v_lshlrev_b32 v48, 16, v60
    v_mfma_f32_16x16x32_bf16 v[80:83], v[44:47], a[204:207], v[80:83]
    v_exp_f32 v17, v97
    v_mfma_f32_16x16x32_bf16 v[84:87], v[40:43], a[224:227], v[84:87]
    v_cvt_pk_bf16_f32 v65, v18, v19
    v_and_b32 v49, s97, v60
    v_mfma_f32_16x16x32_bf16 v[84:87], v[44:47], a[228:231], v[84:87]
    buffer_load_dwordx4 v4, s[4:7], s32 offen offset:1024 sc1 lds
    v_mfma_f32_16x16x32_bf16 v[88:91], v[40:43], a[248:251], v[88:91]
    ds_read_b128 v[36:39], v3 offset:12544
    v_lshlrev_b32 v50, 16, v62
    v_mfma_f32_16x16x32_bf16 v[88:91], v[44:47], a[252:255], v[88:91]
    v_exp_f32 v18, v98
    v_mfma_f32_16x16x32_bf16 v[92:95], v[40:43], v[208:211], v[92:95]
    v_add_f32 v5, v5, v16
    v_add_f32 v5, v5, v17
    v_mfma_f32_16x16x32_bf16 v[92:95], v[44:47], v[212:215], v[92:95]
    s_waitcnt lgkmcnt(2)
    v_exp_f32 v19, v99
    v_mfma_f32_16x16x32_bf16 v[112:115], v[24:27], a[200:203], v[112:115]
    ds_read_b128 v[40:43], v2 offset:18688
    v_cvt_pk_bf16_f32 v66, v16, v17
    v_mfma_f32_16x16x32_bf16 v[112:115], v[28:31], a[204:207], v[112:115]
    v_exp_f32 v16, v68
    v_mfma_f32_16x16x32_bf16 v[116:119], v[24:27], a[224:227], v[116:119]
    v_add_f32 v5, v5, v18
    v_add_f32 v5, v5, v19
    v_mfma_f32_16x16x32_bf16 v[116:119], v[28:31], a[228:231], v[116:119]
    v_exp_f32 v17, v69
    v_mfma_f32_16x16x32_bf16 v[120:123], v[24:27], a[248:251], v[120:123]
    ds_read_b128 v[44:47], v3 offset:18688
    v_cvt_pk_bf16_f32 v67, v18, v19
    v_mfma_f32_16x16x32_bf16 v[120:123], v[28:31], a[252:255], v[120:123]
    s_waitcnt lgkmcnt(2)
    buffer_load_dwordx4 v4, s[4:7], s32 offen offset:2048 sc1 lds
    v_mfma_f32_16x16x32_bf16 v[124:127], v[24:27], v[208:211], v[124:127]
    s_waitcnt vmcnt(36)
    v_exp_f32 v18, v70
    v_mfma_f32_16x16x32_bf16 v[124:127], v[28:31], v[212:215], v[124:127]
    s_barrier
    v_add_f32 v6, v6, v16
    v_mfma_f32_16x16x32_bf16 v[80:83], v[32:35], a[208:211], v[80:83]
    ds_read_b128 v[24:27], v1 offset:0
    v_add_f32 v6, v6, v17
    v_mfma_f32_16x16x32_bf16 v[80:83], v[36:39], a[212:215], v[80:83]
    v_exp_f32 v19, v71
    v_mfma_f32_16x16x32_bf16 v[84:87], v[32:35], a[232:235], v[84:87]
    v_cvt_pk_bf16_f32 v68, v16, v17
    v_and_b32 v51, s97, v62
    v_mfma_f32_16x16x32_bf16 v[84:87], v[36:39], a[236:239], v[84:87]
    v_exp_f32 v16, v100
    v_mfma_f32_16x16x32_bf16 v[88:91], v[32:35], v[192:195], v[88:91]
    ds_read_b128 v[28:31], v1 offset:12288
    v_add_f32 v6, v6, v18
    v_mfma_f32_16x16x32_bf16 v[88:91], v[36:39], v[196:199], v[88:91]
    v_add_f32 v6, v6, v19
    v_mul_f32 v48, s38, v48
    v_mfma_f32_16x16x32_bf16 v[92:95], v[32:35], v[216:219], v[92:95]
    v_exp_f32 v17, v101
    v_mfma_f32_16x16x32_bf16 v[92:95], v[36:39], v[220:223], v[92:95]
    s_waitcnt lgkmcnt(2)
    v_cvt_pk_bf16_f32 v69, v18, v19
    v_mul_f32 v49, s38, v49
    v_mfma_f32_16x16x32_bf16 v[112:115], v[40:43], a[208:211], v[112:115]
    ds_read_b128 v[32:35], v1 offset:1024
    v_mul_f32_e64 v50, -v50, v48
    v_mfma_f32_16x16x32_bf16 v[112:115], v[44:47], a[212:215], v[112:115]
    v_exp_f32 v18, v102
    v_mfma_f32_16x16x32_bf16 v[116:119], v[40:43], a[232:235], v[116:119]
    v_add_f32 v6, v6, v16
    v_add_f32 v6, v6, v17
    v_mfma_f32_16x16x32_bf16 v[116:119], v[44:47], a[236:239], v[116:119]
    v_exp_f32 v19, v103
    v_mfma_f32_16x16x32_bf16 v[120:123], v[40:43], v[192:195], v[120:123]
    ds_read_b128 v[36:39], v1 offset:13312
    v_cvt_pk_bf16_f32 v70, v16, v17
    v_mfma_f32_16x16x32_bf16 v[120:123], v[44:47], v[196:199], v[120:123]
    s_add_u32 s32, s32, 24576
    v_add_f32 v6, v6, v18
    v_mul_f32_e64 v51, -v51, v49
    v_mfma_f32_16x16x32_bf16 v[124:127], v[40:43], v[216:219], v[124:127]
    s_add_u32 s26, s26, 36864
    v_add_f32 v6, v6, v19
    s_sub_u32 s57, s26, 147456
    v_mfma_f32_16x16x32_bf16 v[124:127], v[44:47], v[220:223], v[124:127]
    s_waitcnt lgkmcnt(2)
    v_cvt_pk_bf16_f32 v71, v18, v19
    s_min_u32 s26, s26, s57
    v_mfma_f32_16x16x32_bf16 a[0:3], v[24:27], v[160:163], a[0:3]
    ds_read_b128 v[40:43], v1 offset:2048
    v_cvt_f32_i32 v240, v240
    v_mfma_f32_16x16x32_bf16 a[0:3], v[28:31], v[176:179], a[0:3]
    s_waitcnt vmcnt(12)
    v_subrev_u32 v52, s92, v52
    v_cmp_lt_u32 vcc, 15, v52
    v_mfma_f32_16x16x32_bf16 a[48:51], v[24:27], v[164:167], a[48:51]
    v_exp_f32 v16, v72
    v_mfma_f32_16x16x32_bf16 a[48:51], v[28:31], v[180:183], a[48:51]
    v_exp_f32 v17, v73
    v_mfma_f32_16x16x32_bf16 a[96:99], v[24:27], v[168:171], a[96:99]
    s_and_b32 s59, vcc_lo, 0xff
    ds_read_b128 v[44:47], v1 offset:14336
    v_cvt_f32_i32 v241, v241
    v_mfma_f32_16x16x32_bf16 a[96:99], v[28:31], v[184:187], a[96:99]
    s_cbranch_scc1 L_pollslow2
L_pollok2:
    v_mfma_f32_16x16x32_bf16 a[144:147], v[24:27], v[172:175], a[144:147]
    s_add_u32 s92, s92, 1
    v_exp_f32 v18, v74
    v_mfma_f32_16x16x32_bf16 a[144:147], v[28:31], v[188:191], a[144:147]
    s_waitcnt lgkmcnt(2)
    v_add_f32 v7, v7, v16
    v_add_f32 v7, v7, v17
    v_mfma_f32_16x16x32_bf16 a[4:7], v[32:35], v[160:163], a[4:7]
    s_mov_b32 m0, s56
    ds_read_b128 v[24:27], v1 offset:3072
    v_fma_f32 v240, v240, v48, v50
    v_mfma_f32_16x16x32_bf16 a[4:7], v[36:39], v[176:179], a[4:7]
    buffer_load_dwordx4 v4, s[4:7], s27 offen offset:0 sc1 lds
    v_mfma_f32_16x16x32_bf16 a[52:55], v[32:35], v[164:167], a[52:55]
    v_exp_f32 v19, v75
    v_mfma_f32_16x16x32_bf16 a[52:55], v[36:39], v[180:183], a[52:55]
    v_cvt_pk_bf16_f32 v72, v16, v17
    v_fma_f32 v241, v241, v49, v51
    v_mfma_f32_16x16x32_bf16 a[100:103], v[32:35], v[168:171], a[100:103]
    ds_read_b128 v[28:31], v1 offset:15360
    v_cvt_pk_bf16_f32 v226, v240, v241
    v_mfma_f32_16x16x32_bf16 a[100:103], v[36:39], v[184:187], a[100:103]
    v_exp_f32 v16, v104
    v_mfma_f32_16x16x32_bf16 a[148:151], v[32:35], v[172:175], a[148:151]
    v_add_f32 v7, v7, v18
    v_add_f32 v7, v7, v19
    v_mfma_f32_16x16x32_bf16 a[148:151], v[36:39], v[188:191], a[148:151]
    s_waitcnt lgkmcnt(2)
    v_exp_f32 v17, v105
    v_mfma_f32_16x16x32_bf16 a[8:11], v[40:43], v[160:163], a[8:11]
    ds_read_b128 v[32:35], v1 offset:4096
    v_cvt_pk_bf16_f32 v73, v18, v19
    v_mfma_f32_16x16x32_bf16 a[8:11], v[44:47], v[176:179], a[8:11]
    buffer_load_dwordx4 v4, s[4:7], s27 offen offset:1024 sc1 lds
    v_mfma_f32_16x16x32_bf16 a[56:59], v[40:43], v[164:167], a[56:59]
    v_exp_f32 v18, v106
    v_mfma_f32_16x16x32_bf16 a[56:59], v[44:47], v[180:183], a[56:59]
    v_add_f32 v7, v7, v16
    v_cvt_f32_i32 v244, v244
    v_mfma_f32_16x16x32_bf16 a[104:107], v[40:43], v[168:171], a[104:107]
    ds_read_b128 v[36:39], v1 offset:16384
    v_add_f32 v7, v7, v17
    v_mfma_f32_16x16x32_bf16 a[104:107], v[44:47], v[184:187], a[104:107]
    v_exp_f32 v19, v107
    v_mfma_f32_16x16x32_bf16 a[152:155], v[40:43], v[172:175], a[152:155]
    v_cvt_f32_i32 v245, v245
    v_cvt_pk_bf16_f32 v74, v16, v17
    v_mfma_f32_16x16x32_bf16 a[152:155], v[44:47], v[188:191], a[152:155]
    s_waitcnt lgkmcnt(2)
    v_exp_f32 v16, v76
    v_mfma_f32_16x16x32_bf16 a[12:15], v[24:27], v[160:163], a[12:15]
    ds_read_b128 v[40:43], v1 offset:5120
    v_fma_f32 v244, v244, v48, v50
    v_mfma_f32_16x16x32_bf16 a[12:15], v[28:31], v[176:179], a[12:15]
    buffer_load_dwordx4 v4, s[4:7], s27 offen offset:2048 sc1 lds
    v_mfma_f32_16x16x32_bf16 a[60:63], v[24:27], v[164:167], a[60:63]
    v_add_f32 v7, v7, v18
    v_add_f32 v7, v7, v19
    v_mfma_f32_16x16x32_bf16 a[60:63], v[28:31], v[180:183], a[60:63]
    v_exp_f32 v17, v77
    v_mfma_f32_16x16x32_bf16 a[108:111], v[24:27], v[168:171], a[108:111]
    ds_read_b128 v[44:47], v1 offset:17408
    v_fma_f32 v245, v245, v49, v51
    v_mfma_f32_16x16x32_bf16 a[108:111], v[28:31], v[184:187], a[108:111]
    v_cvt_pk_bf16_f32 v75, v18, v19
    v_cvt_pk_bf16_f32 v230, v244, v245
    v_mfma_f32_16x16x32_bf16 a[156:159], v[24:27], v[172:175], a[156:159]
    s_add_u32 s29, s28, 49152
    v_exp_f32 v18, v78
    v_mfma_f32_16x16x32_bf16 a[156:159], v[28:31], v[188:191], a[156:159]
    s_waitcnt lgkmcnt(2)
    v_add_f32 v8, v8, v16
    v_cvt_f32_i32 v248, v248
    v_mfma_f32_16x16x32_bf16 a[16:19], v[32:35], v[160:163], a[16:19]
    s_sub_u32 s3, s29, 147456
    ds_read_b128 v[24:27], v1 offset:6144
    v_add_f32 v8, v8, v17
    v_mfma_f32_16x16x32_bf16 a[16:19], v[36:39], v[176:179], a[16:19]
    s_add_u32 s27, s27, 24576
    v_exp_f32 v19, v79
    v_mfma_f32_16x16x32_bf16 a[64:67], v[32:35], v[164:167], a[64:67]
    s_min_u32 s29, s29, s3
    v_cvt_f32_i32 v249, v249
    v_cvt_pk_bf16_f32 v76, v16, v17
    v_mfma_f32_16x16x32_bf16 a[64:67], v[36:39], v[180:183], a[64:67]
    s_add_u32 s56, s56, 12288
    v_exp_f32 v16, v108
    v_mfma_f32_16x16x32_bf16 a[112:115], v[32:35], v[168:171], a[112:115]
    ds_read_b128 v[28:31], v1 offset:18432
    v_fma_f32 v248, v248, v48, v50
    v_mfma_f32_16x16x32_bf16 a[112:115], v[36:39], v[184:187], a[112:115]
    v_add_f32 v8, v8, v18
    v_fma_f32 v249, v249, v49, v51
    v_mfma_f32_16x16x32_bf16 a[160:163], v[32:35], v[172:175], a[160:163]
    v_add_f32 v8, v8, v19
    v_cvt_pk_bf16_f32 v234, v248, v249
    v_mfma_f32_16x16x32_bf16 a[160:163], v[36:39], v[188:191], a[160:163]
    s_waitcnt lgkmcnt(2)
    v_exp_f32 v17, v109
    v_mfma_f32_16x16x32_bf16 a[20:23], v[40:43], v[160:163], a[20:23]
    s_mov_b32 m0, s56
    ds_read_b128 v[32:35], v1 offset:7168
    v_cvt_pk_bf16_f32 v77, v18, v19
    v_mfma_f32_16x16x32_bf16 a[20:23], v[44:47], v[176:179], a[20:23]
    s_sub_u32 s3, s29, s28
    v_exp_f32 v18, v110
    v_mfma_f32_16x16x32_bf16 a[68:71], v[40:43], v[164:167], a[68:71]
    v_cvt_f32_i32 v252, v252
    v_add_f32 v8, v8, v16
    v_mfma_f32_16x16x32_bf16 a[68:71], v[44:47], v[180:183], a[68:71]
    v_add_f32 v8, v8, v17
    v_cvt_f32_i32 v253, v253
    v_mfma_f32_16x16x32_bf16 a[116:119], v[40:43], v[168:171], a[116:119]
    ds_read_b128 v[36:39], v1 offset:19456
    v_fma_f32 v252, v252, v48, v50
    v_mfma_f32_16x16x32_bf16 a[116:119], v[44:47], v[184:187], a[116:119]
    buffer_load_dwordx4 v4, s[4:7], s27 offen offset:0 sc1 lds
    v_mfma_f32_16x16x32_bf16 a[164:167], v[40:43], v[172:175], a[164:167]
    s_mov_b32 s28, s29
    v_exp_f32 v19, v111
    v_mfma_f32_16x16x32_bf16 a[164:167], v[44:47], v[188:191], a[164:167]
    s_waitcnt lgkmcnt(2)
    v_cvt_pk_bf16_f32 v78, v16, v17
    v_add_f32 v8, v8, v18
    v_mfma_f32_16x16x32_bf16 a[24:27], v[24:27], v[160:163], a[24:27]
    ds_read_b128 v[40:43], v1 offset:8192
    v_add_f32 v8, v8, v19
    v_mfma_f32_16x16x32_bf16 a[24:27], v[28:31], v[176:179], a[24:27]
    v_cvt_pk_bf16_f32 v79, v18, v19
    v_fma_f32 v253, v253, v49, v51
    v_mfma_f32_16x16x32_bf16 a[72:75], v[24:27], v[164:167], a[72:75]
    v_exp_f32 v16, v80
    v_mfma_f32_16x16x32_bf16 a[72:75], v[28:31], v[180:183], a[72:75]
    v_exp_f32 v17, v81
    v_mfma_f32_16x16x32_bf16 a[120:123], v[24:27], v[168:171], a[120:123]
    ds_read_b128 v[44:47], v1 offset:20480
    v_cvt_pk_bf16_f32 v238, v252, v253
    v_mfma_f32_16x16x32_bf16 a[120:123], v[28:31], v[184:187], a[120:123]
    v_exp_f32 v18, v82
    v_mfma_f32_16x16x32_bf16 a[168:171], v[24:27], v[172:175], a[168:171]
    v_lshlrev_b32 v48, 16, v61
    v_add_f32 v5, v5, v16
    v_mfma_f32_16x16x32_bf16 a[168:171], v[28:31], v[188:191], a[168:171]
    s_waitcnt lgkmcnt(2)
    buffer_load_dwordx4 v4, s[4:7], s27 offen offset:1024 sc1 lds
    v_mfma_f32_16x16x32_bf16 a[28:31], v[32:35], v[160:163], a[28:31]
    ds_read_b128 v[24:27], v1 offset:9216
    v_add_f32 v5, v5, v17
    v_mfma_f32_16x16x32_bf16 a[28:31], v[36:39], v[176:179], a[28:31]
    v_exp_f32 v19, v83
    v_mfma_f32_16x16x32_bf16 a[76:79], v[32:35], v[164:167], a[76:79]
    v_and_b32 v49, s97, v61
    v_cvt_pk_bf16_f32 v80, v16, v17
    v_mfma_f32_16x16x32_bf16 a[76:79], v[36:39], v[180:183], a[76:79]
    v_exp_f32 v16, v112
    v_mfma_f32_16x16x32_bf16 a[124:127], v[32:35], v[168:171], a[124:127]
    ds_read_b128 v[28:31], v1 offset:21504
    v_lshlrev_b32 v50, 16, v63
    v_mfma_f32_16x16x32_bf16 a[124:127], v[36:39], v[184:187], a[124:127]
    v_add_f32 v5, v5, v18
    v_and_b32 v51, s97, v63
    v_mfma_f32_16x16x32_bf16 a[172:175], v[32:35], v[172:175], a[172:175]
    v_add_f32 v5, v5, v19
    v_mul_f32 v48, s38, v48
    v_mfma_f32_16x16x32_bf16 a[172:175], v[36:39], v[188:191], a[172:175]
    s_waitcnt lgkmcnt(2)
    buffer_load_dwordx4 v4, s[4:7], s27 offen offset:2048 sc1 lds
    v_mfma_f32_16x16x32_bf16 a[32:35], v[40:43], v[160:163], a[32:35]
    ds_read_b128 v[32:35], v1 offset:10240
    v_mul_f32 v49, s38, v49
    v_mfma_f32_16x16x32_bf16 a[32:35], v[44:47], v[176:179], a[32:35]
    v_exp_f32 v17, v113
    v_mfma_f32_16x16x32_bf16 a[80:83], v[40:43], v[164:167], a[80:83]
    v_cvt_pk_bf16_f32 v81, v18, v19
    v_mul_f32_e64 v50, -v50, v48
    v_mfma_f32_16x16x32_bf16 a[80:83], v[44:47], v[180:183], a[80:83]
    v_exp_f32 v18, v114
    v_mfma_f32_16x16x32_bf16 a[128:131], v[40:43], v[168:171], a[128:131]
    ds_read_b128 v[36:39], v1 offset:22528
    v_add_f32 v5, v5, v16
    v_mfma_f32_16x16x32_bf16 a[128:131], v[44:47], v[184:187], a[128:131]
    v_add_f32 v5, v5, v17
    v_mul_f32_e64 v51, -v51, v49
    v_mfma_f32_16x16x32_bf16 a[176:179], v[40:43], v[172:175], a[176:179]
    v_exp_f32 v19, v115
    v_mfma_f32_16x16x32_bf16 a[176:179], v[44:47], v[188:191], a[176:179]
    s_waitcnt lgkmcnt(2)
    v_cvt_pk_bf16_f32 v82, v16, v17
    v_add_u32 v2, s3, v2
    v_mfma_f32_16x16x32_bf16 a[36:39], v[24:27], v[160:163], a[36:39]
    ds_read_b128 v[40:43], v1 offset:11264
    v_cvt_f32_i32 v242, v242
    v_mfma_f32_16x16x32_bf16 a[36:39], v[28:31], v[176:179], a[36:39]
    v_exp_f32 v16, v84
    v_mfma_f32_16x16x32_bf16 a[84:87], v[24:27], v[164:167], a[84:87]
    v_add_f32 v5, v5, v18
    v_add_f32 v5, v5, v19
    v_mfma_f32_16x16x32_bf16 a[84:87], v[28:31], v[180:183], a[84:87]
    s_add_u32 s27, s27, 24576
    v_exp_f32 v17, v85
    v_mfma_f32_16x16x32_bf16 a[132:135], v[24:27], v[168:171], a[132:135]
    s_add_u32 s56, s56, 36864
    ds_read_b128 v[44:47], v1 offset:23552
    v_add_u32 v3, s3, v3
    v_mfma_f32_16x16x32_bf16 a[132:135], v[28:31], v[184:187], a[132:135]
    s_waitcnt lgkmcnt(2)
    v_cvt_pk_bf16_f32 v83, v18, v19
    v_cvt_f32_i32 v243, v243
    v_mfma_f32_16x16x32_bf16 a[180:183], v[24:27], v[172:175], a[180:183]
    s_waitcnt vmcnt(19)
    v_exp_f32 v18, v86
    v_mfma_f32_16x16x32_bf16 a[180:183], v[28:31], v[188:191], a[180:183]
    s_barrier
    v_add_f32 v6, v6, v16
    v_mfma_f32_16x16x32_bf16 a[40:43], v[32:35], v[160:163], a[40:43]
    s_sub_u32 s58, s56, 147456
    ds_read_b128 v[24:27], v2 offset:0
    v_add_f32 v6, v6, v17
    v_mfma_f32_16x16x32_bf16 a[40:43], v[36:39], v[176:179], a[40:43]
    s_min_u32 s56, s56, s58
    v_exp_f32 v19, v87
    v_mfma_f32_16x16x32_bf16 a[88:91], v[32:35], v[164:167], a[88:91]
    v_fma_f32 v242, v242, v48, v50
    v_fma_f32 v243, v243, v49, v51
    v_mfma_f32_16x16x32_bf16 a[88:91], v[36:39], v[180:183], a[88:91]
    v_cvt_pk_bf16_f32 v84, v16, v17
    v_cvt_pk_bf16_f32 v227, v242, v243
    v_mfma_f32_16x16x32_bf16 a[136:139], v[32:35], v[168:171], a[136:139]
    ds_read_b128 v[28:31], v3 offset:0
    v_cvt_f32_i32 v246, v246
    v_mfma_f32_16x16x32_bf16 a[136:139], v[36:39], v[184:187], a[136:139]
    v_exp_f32 v16, v116
    v_mfma_f32_16x16x32_bf16 a[184:187], v[32:35], v[172:175], a[184:187]
    v_add_f32 v6, v6, v18
    v_add_f32 v6, v6, v19
    v_mfma_f32_16x16x32_bf16 a[184:187], v[36:39], v[188:191], a[184:187]
    s_waitcnt lgkmcnt(2)
    v_exp_f32 v17, v117
    v_mfma_f32_16x16x32_bf16 a[44:47], v[40:43], v[160:163], a[44:47]
    ds_read_b128 v[32:35], v2 offset:6144
    v_cvt_pk_bf16_f32 v85, v18, v19
    v_mfma_f32_16x16x32_bf16 a[44:47], v[44:47], v[176:179], a[44:47]
    v_exp_f32 v18, v118
    v_mfma_f32_16x16x32_bf16 a[92:95], v[40:43], v[164:167], a[92:95]
    v_cvt_f32_i32 v247, v247
    v_fma_f32 v246, v246, v48, v50
    v_mfma_f32_16x16x32_bf16 a[92:95], v[44:47], v[180:183], a[92:95]
    v_add_f32 v6, v6, v16
    v_add_f32 v6, v6, v17
    v_mfma_f32_16x16x32_bf16 a[140:143], v[40:43], v[168:171], a[140:143]
    s_sub_u32 s31, s31, 1
    ds_read_b128 v[36:39], v3 offset:6144
    v_fma_f32 v247, v247, v49, v51
    v_mfma_f32_16x16x32_bf16 a[140:143], v[44:47], v[184:187], a[140:143]
    v_exp_f32 v19, v119
    v_mfma_f32_16x16x32_bf16 a[188:191], v[40:43], v[172:175], a[188:191]
    s_waitcnt lgkmcnt(2)
    s_cmp_lg_u32 s31, 0
    v_cvt_pk_bf16_f32 v86, v16, v17
    v_add_f32 v6, v6, v18
    v_cvt_pk_bf16_f32 v231, v246, v247
    v_add_f32 v6, v6, v19
    v_cvt_f32_i32 v250, v250
    v_cvt_pk_bf16_f32 v87, v18, v19
    v_cvt_f32_i32 v251, v251
    v_mfma_f32_16x16x32_bf16 a[188:191], v[44:47], v[188:191], a[188:191]
    s_cbranch_scc1 L_loop
    v_mfma_f32_16x16x32_bf16 v[160:163], v[24:27], a[192:195], v[128:131]
    s_mov_b32 m0, s26
    ds_read_b128 v[40:43], v2 offset:128
    v_mfma_f32_16x16x32_bf16 v[160:163], v[28:31], a[196:199], v[160:163]
    buffer_load_dwordx4 v4, s[4:7], s32 offen offset:0 sc1 lds
    v_mfma_f32_16x16x32_bf16 v[164:167], v[24:27], a[216:219], v[132:135]
    ds_read_b128 v[44:47], v3 offset:128
    v_mfma_f32_16x16x32_bf16 v[164:167], v[28:31], a[220:223], v[164:167]
    s_waitcnt lgkmcnt(2)
    v_exp_f32 v16, v88
    v_mfma_f32_16x16x32_bf16 v[96:99], v[32:35], a[192:195], v[128:131]
    ds_read_b128 v[24:27], v2 offset:6272
    v_mfma_f32_16x16x32_bf16 v[96:99], v[36:39], a[196:199], v[96:99]
    buffer_load_dwordx4 v4, s[4:7], s32 offen offset:1024 sc1 lds
    v_mfma_f32_16x16x32_bf16 v[100:103], v[32:35], a[216:219], v[132:135]
    ds_read_b128 v[28:31], v3 offset:6272
    v_mfma_f32_16x16x32_bf16 v[100:103], v[36:39], a[220:223], v[100:103]
    s_waitcnt lgkmcnt(2)
    v_exp_f32 v17, v89
    v_mfma_f32_16x16x32_bf16 v[160:163], v[40:43], a[200:203], v[160:163]
    ds_read_b128 v[32:35], v2 offset:256
    v_mfma_f32_16x16x32_bf16 v[160:163], v[44:47], a[204:207], v[160:163]
    v_exp_f32 v18, v90
    v_mfma_f32_16x16x32_bf16 v[164:167], v[40:43], a[224:227], v[164:167]
    ds_read_b128 v[36:39], v3 offset:256
    v_add_f32 v7, v7, v16
    v_mfma_f32_16x16x32_bf16 v[164:167], v[44:47], a[228:231], v[164:167]
    s_waitcnt lgkmcnt(2)
    buffer_load_dwordx4 v4, s[4:7], s32 offen offset:2048 sc1 lds
    v_add_f32 v7, v7, v17
    v_mfma_f32_16x16x32_bf16 v[96:99], v[24:27], a[200:203], v[96:99]
    ds_read_b128 v[40:43], v2 offset:6400
    v_mfma_f32_16x16x32_bf16 v[96:99], v[28:31], a[204:207], v[96:99]
    v_exp_f32 v19, v91
    v_cvt_pk_bf16_f32 v88, v16, v17
    v_mfma_f32_16x16x32_bf16 v[100:103], v[24:27], a[224:227], v[100:103]
    s_add_u32 s32, s32, 24576
    ds_read_b128 v[44:47], v3 offset:6400
    v_mfma_f32_16x16x32_bf16 v[100:103], v[28:31], a[228:231], v[100:103]
    s_waitcnt lgkmcnt(2)
    v_exp_f32 v16, v120
    v_mfma_f32_16x16x32_bf16 v[160:163], v[32:35], a[208:211], v[160:163]
    s_add_u32 s26, s26, 12288
    ds_read_b128 v[24:27], v2 offset:12288
    v_add_f32 v7, v7, v18
    v_mfma_f32_16x16x32_bf16 v[160:163], v[36:39], a[212:215], v[160:163]
    v_add_f32 v7, v7, v19
    v_mfma_f32_16x16x32_bf16 v[164:167], v[32:35], a[232:235], v[164:167]
    s_mov_b32 m0, s26
    ds_read_b128 v[28:31], v3 offset:12288
    v_mfma_f32_16x16x32_bf16 v[164:167], v[36:39], a[236:239], v[164:167]
    s_waitcnt lgkmcnt(2)
    v_exp_f32 v17, v121
    v_cvt_pk_bf16_f32 v89, v18, v19
    v_mfma_f32_16x16x32_bf16 v[96:99], v[40:43], a[208:211], v[96:99]
    ds_read_b128 v[32:35], v2 offset:18432
    v_mfma_f32_16x16x32_bf16 v[96:99], v[44:47], a[212:215], v[96:99]
    v_exp_f32 v18, v122
    v_mfma_f32_16x16x32_bf16 v[100:103], v[40:43], a[232:235], v[100:103]
    ds_read_b128 v[36:39], v3 offset:18432
    v_add_f32 v7, v7, v16
    v_mfma_f32_16x16x32_bf16 v[100:103], v[44:47], a[236:239], v[100:103]
    s_waitcnt lgkmcnt(2)
    buffer_load_dwordx4 v4, s[4:7], s32 offen offset:0 sc1 lds
    v_add_f32 v7, v7, v17
    v_mfma_f32_16x16x32_bf16 v[168:171], v[24:27], a[192:195], v[128:131]
    ds_read_b128 v[40:43], v2 offset:12416
    v_mfma_f32_16x16x32_bf16 v[168:171], v[28:31], a[196:199], v[168:171]
    v_exp_f32 v19, v123
    v_cvt_pk_bf16_f32 v90, v16, v17
    v_mfma_f32_16x16x32_bf16 v[172:175], v[24:27], a[216:219], v[132:135]
    ds_read_b128 v[44:47], v3 offset:12416
    v_mfma_f32_16x16x32_bf16 v[172:175], v[28:31], a[220:223], v[172:175]
    s_waitcnt lgkmcnt(2)
    buffer_load_dwordx4 v4, s[4:7], s32 offen offset:1024 sc1 lds
    v_mfma_f32_16x16x32_bf16 v[104:107], v[32:35], a[192:195], v[128:131]
    ds_read_b128 v[24:27], v2 offset:18560
    v_mfma_f32_16x16x32_bf16 v[104:107], v[36:39], a[196:199], v[104:107]
    v_exp_f32 v16, v92
    v_add_f32 v7, v7, v18
    v_mfma_f32_16x16x32_bf16 v[108:111], v[32:35], a[216:219], v[132:135]
    s_add_u32 s29, s30, 49152
    ds_read_b128 v[28:31], v3 offset:18560
    v_add_f32 v7, v7, v19
    v_mfma_f32_16x16x32_bf16 v[108:111], v[36:39], a[220:223], v[108:111]
    s_waitcnt lgkmcnt(2)
    v_exp_f32 v17, v93
    v_cvt_pk_bf16_f32 v91, v18, v19
    v_mfma_f32_16x16x32_bf16 v[168:171], v[40:43], a[200:203], v[168:171]
    s_sub_u32 s3, s29, 147456
    ds_read_b128 v[32:35], v2 offset:12544
    v_mfma_f32_16x16x32_bf16 v[168:171], v[44:47], a[204:207], v[168:171]
    s_min_u32 s29, s29, s3
    buffer_load_dwordx4 v4, s[4:7], s32 offen offset:2048 sc1 lds
    v_mfma_f32_16x16x32_bf16 v[172:175], v[40:43], a[224:227], v[172:175]
    ds_read_b128 v[36:39], v3 offset:12544
    v_mfma_f32_16x16x32_bf16 v[172:175], v[44:47], a[228:231], v[172:175]
    s_waitcnt lgkmcnt(2)
    v_exp_f32 v18, v94
    v_add_f32 v8, v8, v16
    v_mfma_f32_16x16x32_bf16 v[104:107], v[24:27], a[200:203], v[104:107]
    s_add_u32 s32, s32, 24576
    ds_read_b128 v[40:43], v2 offset:18688
    v_add_f32 v8, v8, v17
    v_mfma_f32_16x16x32_bf16 v[104:107], v[28:31], a[204:207], v[104:107]
    v_exp_f32 v19, v95
    v_cvt_pk_bf16_f32 v92, v16, v17
    v_mfma_f32_16x16x32_bf16 v[108:111], v[24:27], a[224:227], v[108:111]
    ds_read_b128 v[44:47], v3 offset:18688
    v_mfma_f32_16x16x32_bf16 v[108:111], v[28:31], a[228:231], v[108:111]
    s_waitcnt lgkmcnt(2)
    v_subrev_u32 v2, 98304, v2
    v_subrev_u32 v3, 98304, v3
    v_mfma_f32_16x16x32_bf16 v[168:171], v[32:35], a[208:211], v[168:171]
    s_add_u32 s26, s26, 36864
    ds_read_b128 v[24:27], v2 offset:0
    v_mfma_f32_16x16x32_bf16 v[168:171], v[36:39], a[212:215], v[168:171]
    v_exp_f32 v16, v124
    v_add_f32 v8, v8, v18
    v_mfma_f32_16x16x32_bf16 v[172:175], v[32:35], a[232:235], v[172:175]
    s_sub_u32 s57, s26, 147456
    ds_read_b128 v[28:31], v3 offset:0
    v_add_f32 v8, v8, v19
    v_mfma_f32_16x16x32_bf16 v[172:175], v[36:39], a[236:239], v[172:175]
    s_waitcnt lgkmcnt(2)
    v_exp_f32 v17, v125
    v_cvt_pk_bf16_f32 v93, v18, v19
    v_mfma_f32_16x16x32_bf16 v[104:107], v[40:43], a[208:211], v[104:107]
    s_min_u32 s26, s26, s57
    ds_read_b128 v[32:35], v2 offset:6144
    s_sub_u32 s3, s29, s30
    v_mfma_f32_16x16x32_bf16 v[104:107], v[44:47], a[212:215], v[104:107]
    v_exp_f32 v18, v126
    v_mfma_f32_16x16x32_bf16 v[108:111], v[40:43], a[232:235], v[108:111]
    s_mov_b32 m0, s56
    ds_read_b128 v[36:39], v3 offset:6144
    v_add_f32 v8, v8, v16
    v_mfma_f32_16x16x32_bf16 v[108:111], v[44:47], a[236:239], v[108:111]
    s_waitcnt lgkmcnt(2)
    v_add_f32 v8, v8, v17
    v_mfma_f32_16x16x32_bf16 v[176:179], v[24:27], a[192:195], v[128:131]
    ds_read_b128 v[40:43], v2 offset:128
    v_mfma_f32_16x16x32_bf16 v[176:179], v[28:31], a[196:199], v[176:179]
    v_exp_f32 v19, v127
    v_cvt_pk_bf16_f32 v94, v16, v17
    v_mfma_f32_16x16x32_bf16 v[180:183], v[24:27], a[216:219], v[132:135]
    ds_read_b128 v[44:47], v3 offset:128
    v_add_f32 v8, v8, v18
    v_add_f32 v8, v8, v19
    v_cvt_pk_bf16_f32 v95, v18, v19
    v_mfma_f32_16x16x32_bf16 v[180:183], v[28:31], a[220:223], v[180:183]
    s_waitcnt lgkmcnt(2)
    buffer_load_dwordx4 v4, s[4:7], s27 offen offset:0 sc1 lds
    v_mfma_f32_16x16x32_bf16 v[112:115], v[32:35], a[192:195], v[128:131]
    s_mov_b32 s30, s29
    ds_read_b128 v[24:27], v2 offset:6272
    v_mfma_f32_16x16x32_bf16 v[112:115], v[36:39], a[196:199], v[112:115]
    v_exp_f32 v16, v160
    v_mfma_f32_16x16x32_bf16 v[116:119], v[32:35], a[216:219], v[132:135]
    ds_read_b128 v[28:31], v3 offset:6272
    v_mfma_f32_16x16x32_bf16 v[116:119], v[36:39], a[220:223], v[116:119]
    s_waitcnt lgkmcnt(2)
    buffer_load_dwordx4 v4, s[4:7], s27 offen offset:1024 sc1 lds
    v_mfma_f32_16x16x32_bf16 v[176:179], v[40:43], a[200:203], v[176:179]
    ds_read_b128 v[32:35], v2 offset:256
    v_mfma_f32_16x16x32_bf16 v[176:179], v[44:47], a[204:207], v[176:179]
    v_exp_f32 v17, v161
    v_mfma_f32_16x16x32_bf16 v[180:183], v[40:43], a[224:227], v[180:183]
    ds_read_b128 v[36:39], v3 offset:256
    v_add_u32 v1, s3, v1
    v_mfma_f32_16x16x32_bf16 v[180:183], v[44:47], a[228:231], v[180:183]
    s_waitcnt lgkmcnt(2)
    v_exp_f32 v18, v162
    v_add_f32 v5, v5, v16
    v_mfma_f32_16x16x32_bf16 v[112:115], v[24:27], a[200:203], v[112:115]
    ds_read_b128 v[40:43], v2 offset:6400
    v_add_f32 v5, v5, v17
    v_mfma_f32_16x16x32_bf16 v[112:115], v[28:31], a[204:207], v[112:115]
    buffer_load_dwordx4 v4, s[4:7], s27 offen offset:2048 sc1 lds
    v_mfma_f32_16x16x32_bf16 v[116:119], v[24:27], a[224:227], v[116:119]
    ds_read_b128 v[44:47], v3 offset:6400
    v_mfma_f32_16x16x32_bf16 v[116:119], v[28:31], a[228:231], v[116:119]
    s_waitcnt lgkmcnt(2)
    v_exp_f32 v19, v163
    v_cvt_pk_bf16_f32 v160, v16, v17
    v_mfma_f32_16x16x32_bf16 v[176:179], v[32:35], a[208:211], v[176:179]
    s_add_u32 s27, s27, 24576
    ds_read_b128 v[24:27], v2 offset:12288
    v_mfma_f32_16x16x32_bf16 v[176:179], v[36:39], a[212:215], v[176:179]
    v_exp_f32 v16, v96
    v_add_f32 v5, v5, v18
    v_mfma_f32_16x16x32_bf16 v[180:183], v[32:35], a[232:235], v[180:183]
    s_add_u32 s56, s56, 12288
    ds_read_b128 v[28:31], v3 offset:12288
    v_add_f32 v5, v5, v19
    v_mfma_f32_16x16x32_bf16 v[180:183], v[36:39], a[236:239], v[180:183]
    s_waitcnt lgkmcnt(2)
    v_exp_f32 v17, v97
    v_cvt_pk_bf16_f32 v161, v18, v19
    v_mfma_f32_16x16x32_bf16 v[112:115], v[40:43], a[208:211], v[112:115]
    ds_read_b128 v[32:35], v2 offset:18432
    v_mfma_f32_16x16x32_bf16 v[112:115], v[44:47], a[212:215], v[112:115]
    s_mov_b32 m0, s56
    v_exp_f32 v18, v98
    v_mfma_f32_16x16x32_bf16 v[116:119], v[40:43], a[232:235], v[116:119]
    ds_read_b128 v[36:39], v3 offset:18432
    v_add_f32 v5, v5, v16
    v_mfma_f32_16x16x32_bf16 v[116:119], v[44:47], a[236:239], v[116:119]
    s_waitcnt lgkmcnt(2)
    v_add_f32 v5, v5, v17
    v_mfma_f32_16x16x32_bf16 v[184:187], v[24:27], a[192:195], v[128:131]
    ds_read_b128 v[40:43], v2 offset:12416
    v_mfma_f32_16x16x32_bf16 v[184:187], v[28:31], a[196:199], v[184:187]
    buffer_load_dwordx4 v4, s[4:7], s27 offen offset:0 sc1 lds
    v_mfma_f32_16x16x32_bf16 v[188:191], v[24:27], a[216:219], v[132:135]
    ds_read_b128 v[44:47], v3 offset:12416
    v_mfma_f32_16x16x32_bf16 v[188:191], v[28:31], a[220:223], v[188:191]
    s_waitcnt lgkmcnt(2)
    v_exp_f32 v19, v99
    v_cvt_pk_bf16_f32 v162, v16, v17
    v_mfma_f32_16x16x32_bf16 v[120:123], v[32:35], a[192:195], v[128:131]
    ds_read_b128 v[24:27], v2 offset:18560
    v_mfma_f32_16x16x32_bf16 v[120:123], v[36:39], a[196:199], v[120:123]
    s_waitcnt vmcnt(10)
    v_exp_f32 v16, v164
    v_add_f32 v5, v5, v18
    v_mfma_f32_16x16x32_bf16 v[124:127], v[32:35], a[216:219], v[132:135]
    ds_read_b128 v[28:31], v3 offset:18560
    v_add_f32 v5, v5, v19
    v_mfma_f32_16x16x32_bf16 v[124:127], v[36:39], a[220:223], v[124:127]
    s_waitcnt lgkmcnt(2)
    s_barrier
    v_mfma_f32_16x16x32_bf16 v[184:187], v[40:43], a[200:203], v[184:187]
    ds_read_b128 v[32:35], v2 offset:12544
    v_mfma_f32_16x16x32_bf16 v[184:187], v[44:47], a[204:207], v[184:187]
    buffer_load_dwordx4 v4, s[4:7], s27 offen offset:1024 sc1 lds
    v_mfma_f32_16x16x32_bf16 v[188:191], v[40:43], a[224:227], v[188:191]
    ds_read_b128 v[36:39], v3 offset:12544
    v_mfma_f32_16x16x32_bf16 v[188:191], v[44:47], a[228:231], v[188:191]
    s_waitcnt lgkmcnt(2)
    v_exp_f32 v17, v165
    v_cvt_pk_bf16_f32 v163, v18, v19
    v_mfma_f32_16x16x32_bf16 v[120:123], v[24:27], a[200:203], v[120:123]
    ds_read_b128 v[40:43], v2 offset:18688
    v_mfma_f32_16x16x32_bf16 v[120:123], v[28:31], a[204:207], v[120:123]
    buffer_load_dwordx4 v4, s[4:7], s27 offen offset:2048 sc1 lds
    v_mfma_f32_16x16x32_bf16 v[124:127], v[24:27], a[224:227], v[124:127]
    ds_read_b128 v[44:47], v3 offset:18688
    v_mfma_f32_16x16x32_bf16 v[124:127], v[28:31], a[228:231], v[124:127]
    s_waitcnt lgkmcnt(2)
    v_exp_f32 v18, v166
    v_add_f32 v6, v6, v16
    v_mfma_f32_16x16x32_bf16 v[184:187], v[32:35], a[208:211], v[184:187]
    ds_read_b128 v[24:27], v1 offset:0
    v_add_f32 v6, v6, v17
    v_mfma_f32_16x16x32_bf16 v[184:187], v[36:39], a[212:215], v[184:187]
    v_exp_f32 v19, v167
    v_cvt_pk_bf16_f32 v164, v16, v17
    v_mfma_f32_16x16x32_bf16 v[188:191], v[32:35], a[232:235], v[188:191]
    ds_read_b128 v[28:31], v1 offset:12288
    v_mfma_f32_16x16x32_bf16 v[188:191], v[36:39], a[236:239], v[188:191]
    s_waitcnt lgkmcnt(2)
    v_exp_f32 v16, v100
    v_add_f32 v6, v6, v18
    v_mfma_f32_16x16x32_bf16 v[120:123], v[40:43], a[208:211], v[120:123]
    s_add_u32 s27, s27, 24576
    ds_read_b128 v[32:35], v1 offset:1024
    v_add_f32 v6, v6, v19
    v_mfma_f32_16x16x32_bf16 v[120:123], v[44:47], a[212:215], v[120:123]
    v_exp_f32 v17, v101
    v_cvt_pk_bf16_f32 v165, v18, v19
    v_mfma_f32_16x16x32_bf16 v[124:127], v[40:43], a[232:235], v[124:127]
    s_add_u32 s56, s56, 36864
    ds_read_b128 v[36:39], v1 offset:13312
    s_sub_u32 s58, s56, 147456
    v_mfma_f32_16x16x32_bf16 v[124:127], v[44:47], a[236:239], v[124:127]
    s_waitcnt lgkmcnt(2)
    v_exp_f32 v18, v102
    v_add_f32 v6, v6, v16
    v_add_f32 v6, v6, v17
    v_exp_f32 v19, v103
    v_cvt_pk_bf16_f32 v166, v16, v17
    v_add_f32 v6, v6, v18
    v_add_f32 v6, v6, v19
    v_cvt_pk_bf16_f32 v167, v18, v19
    s_min_u32 s56, s56, s58
    v_mfma_f32_16x16x32_bf16 a[0:3], v[24:27], v[64:67], a[0:3]
    s_mov_b32 m0, s56
    ds_read_b128 v[40:43], v1 offset:2048
    v_bfe_u32 v57, v4, 4, 3
    v_mfma_f32_16x16x32_bf16 a[0:3], v[28:31], v[80:83], a[0:3]
    buffer_load_dwordx4 v4, s[4:7], s27 offen offset:0 sc1 lds
    v_mfma_f32_16x16x32_bf16 a[48:51], v[24:27], v[68:71], a[48:51]
    v_exp_f32 v16, v168
    v_mfma_f32_16x16x32_bf16 a[48:51], v[28:31], v[84:87], a[48:51]
    v_exp_f32 v17, v169
    v_mfma_f32_16x16x32_bf16 a[96:99], v[24:27], v[72:75], a[96:99]
    ds_read_b128 v[44:47], v1 offset:14336
    v_mul_u32_u24 v56, 384, v57
    v_mfma_f32_16x16x32_bf16 a[96:99], v[28:31], v[88:91], a[96:99]
    v_exp_f32 v18, v170
    v_mfma_f32_16x16x32_bf16 a[144:147], v[24:27], v[76:79], a[144:147]
    v_add_f32 v5, v5, v16
    v_add_f32 v5, v5, v17
    v_mfma_f32_16x16x32_bf16 a[144:147], v[28:31], v[92:95], a[144:147]
    s_waitcnt lgkmcnt(2)
    buffer_load_dwordx4 v4, s[4:7], s27 offen offset:1024 sc1 lds
    v_mfma_f32_16x16x32_bf16 a[4:7], v[32:35], v[64:67], a[4:7]
    ds_read_b128 v[24:27], v1 offset:3072
    v_bfe_u32 v57, v4, 8, 2
    v_mfma_f32_16x16x32_bf16 a[4:7], v[36:39], v[80:83], a[4:7]
    v_exp_f32 v19, v171
    v_mfma_f32_16x16x32_bf16 a[52:55], v[32:35], v[68:71], a[52:55]
    v_cvt_pk_bf16_f32 v168, v16, v17
    v_lshl_add_u32 v56, v57, 5, v56
    v_mfma_f32_16x16x32_bf16 a[52:55], v[36:39], v[84:87], a[52:55]
    v_exp_f32 v16, v104
    v_mfma_f32_16x16x32_bf16 a[100:103], v[32:35], v[72:75], a[100:103]
    ds_read_b128 v[28:31], v1 offset:15360
    v_add_f32 v5, v5, v18
    v_mfma_f32_16x16x32_bf16 a[100:103], v[36:39], v[88:91], a[100:103]
    v_add_f32 v5, v5, v19
    v_mfma_f32_16x16x32_bf16 a[148:151], v[32:35], v[76:79], a[148:151]
    v_exp_f32 v17, v105
    v_mfma_f32_16x16x32_bf16 a[148:151], v[36:39], v[92:95], a[148:151]
    s_waitcnt lgkmcnt(2)
    buffer_load_dwordx4 v4, s[4:7], s27 offen offset:2048 sc1 lds
    v_mfma_f32_16x16x32_bf16 a[8:11], v[40:43], v[64:67], a[8:11]
    ds_read_b128 v[32:35], v1 offset:4096
    v_cvt_pk_bf16_f32 v169, v18, v19
    v_mfma_f32_16x16x32_bf16 a[8:11], v[44:47], v[80:83], a[8:11]
    v_exp_f32 v18, v106
    v_mfma_f32_16x16x32_bf16 a[56:59], v[40:43], v[68:71], a[56:59]
    v_add_f32 v5, v5, v16
    v_add_f32 v5, v5, v17
    v_mfma_f32_16x16x32_bf16 a[56:59], v[44:47], v[84:87], a[56:59]
    v_exp_f32 v19, v107
    v_mfma_f32_16x16x32_bf16 a[104:107], v[40:43], v[72:75], a[104:107]
    s_add_u32 s27, s27, 24576
    ds_read_b128 v[36:39], v1 offset:16384
    v_cvt_pk_bf16_f32 v170, v16, v17
    v_mfma_f32_16x16x32_bf16 a[104:107], v[44:47], v[88:91], a[104:107]
    v_exp_f32 v16, v172
    v_mfma_f32_16x16x32_bf16 a[152:155], v[40:43], v[76:79], a[152:155]
    v_add_f32 v5, v5, v18
    v_bfe_u32 v57, v4, 7, 1
    v_mfma_f32_16x16x32_bf16 a[152:155], v[44:47], v[92:95], a[152:155]
    s_waitcnt lgkmcnt(2)
    v_add_f32 v5, v5, v19
    v_lshl_add_u32 v56, v57, 4, v56
    v_mfma_f32_16x16x32_bf16 a[12:15], v[24:27], v[64:67], a[12:15]
    s_add_u32 s56, s56, 12288
    ds_read_b128 v[40:43], v1 offset:5120
    v_mfma_f32_16x16x32_bf16 a[12:15], v[28:31], v[80:83], a[12:15]
    v_exp_f32 v17, v173
    v_mfma_f32_16x16x32_bf16 a[60:63], v[24:27], v[68:71], a[60:63]
    v_cvt_pk_bf16_f32 v171, v18, v19
    v_mfma_f32_16x16x32_bf16 a[60:63], v[28:31], v[84:87], a[60:63]
    v_exp_f32 v18, v174
    v_mfma_f32_16x16x32_bf16 a[108:111], v[24:27], v[72:75], a[108:111]
    s_mov_b32 m0, s56
    ds_read_b128 v[44:47], v1 offset:17408
    v_add_f32 v6, v6, v16
    v_mfma_f32_16x16x32_bf16 a[108:111], v[28:31], v[88:91], a[108:111]
    v_add_f32 v6, v6, v17
    v_mfma_f32_16x16x32_bf16 a[156:159], v[24:27], v[76:79], a[156:159]
    s_mov_b32 s62, 0x00ff00ff
    v_exp_f32 v19, v175
    v_mfma_f32_16x16x32_bf16 a[156:159], v[28:31], v[92:95], a[156:159]
    s_waitcnt lgkmcnt(2)
    v_cvt_pk_bf16_f32 v172, v16, v17
    v_mfma_f32_16x16x32_bf16 a[16:19], v[32:35], v[64:67], a[16:19]
    ds_read_b128 v[24:27], v1 offset:6144
    v_mfma_f32_16x16x32_bf16 a[16:19], v[36:39], v[80:83], a[16:19]
    v_exp_f32 v16, v108
    v_mfma_f32_16x16x32_bf16 a[64:67], v[32:35], v[68:71], a[64:67]
    v_add_f32 v6, v6, v18
    v_add_f32 v6, v6, v19
    v_mfma_f32_16x16x32_bf16 a[64:67], v[36:39], v[84:87], a[64:67]
    buffer_load_dwordx4 v4, s[4:7], s27 offen offset:0 sc1 lds
    v_mfma_f32_16x16x32_bf16 a[112:115], v[32:35], v[72:75], a[112:115]
    ds_read_b128 v[28:31], v1 offset:18432
    v_mfma_f32_16x16x32_bf16 a[112:115], v[36:39], v[88:91], a[112:115]
    s_mov_b32 s63, 0x00ff00ff
    v_exp_f32 v17, v109
    v_mfma_f32_16x16x32_bf16 a[160:163], v[32:35], v[76:79], a[160:163]
    v_cvt_pk_bf16_f32 v173, v18, v19
    v_mfma_f32_16x16x32_bf16 a[160:163], v[36:39], v[92:95], a[160:163]
    s_waitcnt lgkmcnt(2)
    v_exp_f32 v18, v110
    v_mfma_f32_16x16x32_bf16 a[20:23], v[40:43], v[64:67], a[20:23]
    ds_read_b128 v[32:35], v1 offset:7168
    v_add_f32 v6, v6, v16
    v_mfma_f32_16x16x32_bf16 a[20:23], v[44:47], v[80:83], a[20:23]
    buffer_load_dwordx4 v4, s[4:7], s27 offen offset:1024 sc1 lds
    v_mfma_f32_16x16x32_bf16 a[68:71], v[40:43], v[68:71], a[68:71]
    v_add_f32 v6, v6, v17
    v_mfma_f32_16x16x32_bf16 a[68:71], v[44:47], v[84:87], a[68:71]
    v_exp_f32 v19, v111
    v_mfma_f32_16x16x32_bf16 a[116:119], v[40:43], v[72:75], a[116:119]
    s_lshl_b32 s24, s95, 2
    ds_read_b128 v[36:39], v1 offset:19456
    v_cvt_pk_bf16_f32 v174, v16, v17
    v_mfma_f32_16x16x32_bf16 a[116:119], v[44:47], v[88:91], a[116:119]
    v_add_f32 v6, v6, v18
    v_add_f32 v6, v6, v19
    v_mfma_f32_16x16x32_bf16 a[164:167], v[40:43], v[76:79], a[164:167]
    v_cvt_pk_bf16_f32 v175, v18, v19
    v_mfma_f32_16x16x32_bf16 a[164:167], v[44:47], v[92:95], a[164:167]
    s_waitcnt lgkmcnt(2)
    v_exp_f32 v16, v176
    v_mfma_f32_16x16x32_bf16 a[24:27], v[24:27], v[64:67], a[24:27]
    ds_read_b128 v[40:43], v1 offset:8192
    v_mfma_f32_16x16x32_bf16 a[24:27], v[28:31], v[80:83], a[24:27]
    buffer_load_dwordx4 v4, s[4:7], s27 offen offset:2048 sc1 lds
    v_mfma_f32_16x16x32_bf16 a[72:75], v[24:27], v[68:71], a[72:75]
    v_exp_f32 v17, v177
    v_mfma_f32_16x16x32_bf16 a[72:75], v[28:31], v[84:87], a[72:75]
    s_add_u32 s24, s24, s25
    v_exp_f32 v18, v178
    v_mfma_f32_16x16x32_bf16 a[120:123], v[24:27], v[72:75], a[120:123]
    ds_read_b128 v[44:47], v1 offset:20480
    v_add_f32 v5, v5, v16
    v_mfma_f32_16x16x32_bf16 a[120:123], v[28:31], v[88:91], a[120:123]
    v_add_f32 v5, v5, v17
    v_mfma_f32_16x16x32_bf16 a[168:171], v[24:27], v[76:79], a[168:171]
    v_exp_f32 v19, v179
    v_mfma_f32_16x16x32_bf16 a[168:171], v[28:31], v[92:95], a[168:171]
    s_waitcnt lgkmcnt(2)
    v_cvt_pk_bf16_f32 v176, v16, v17
    v_mfma_f32_16x16x32_bf16 a[28:31], v[32:35], v[64:67], a[28:31]
    ds_read_b128 v[24:27], v1 offset:9216
    v_mfma_f32_16x16x32_bf16 a[28:31], v[36:39], v[80:83], a[28:31]
    v_exp_f32 v16, v112
    v_mfma_f32_16x16x32_bf16 a[76:79], v[32:35], v[68:71], a[76:79]
    s_mul_i32 s24, s24, 24576
    v_add_f32 v5, v5, v18
    v_add_f32 v5, v5, v19
    v_mfma_f32_16x16x32_bf16 a[76:79], v[36:39], v[84:87], a[76:79]
    v_exp_f32 v17, v113
    v_mfma_f32_16x16x32_bf16 a[124:127], v[32:35], v[72:75], a[124:127]
    ds_read_b128 v[28:31], v1 offset:21504
    v_mfma_f32_16x16x32_bf16 a[124:127], v[36:39], v[88:91], a[124:127]
    s_add_u32 s27, s27, 24576
    v_cvt_pk_bf16_f32 v177, v18, v19
    s_add_u32 s56, s56, 36864
    v_mfma_f32_16x16x32_bf16 a[172:175], v[32:35], v[76:79], a[172:175]
    s_sub_u32 s58, s56, 147456
    v_exp_f32 v18, v114
    v_mfma_f32_16x16x32_bf16 a[172:175], v[36:39], v[92:95], a[172:175]
    s_waitcnt lgkmcnt(2)
    v_add_f32 v5, v5, v16
    v_mfma_f32_16x16x32_bf16 a[32:35], v[40:43], v[64:67], a[32:35]
    ds_read_b128 v[32:35], v1 offset:10240
    v_add_f32 v5, v5, v17
    v_mfma_f32_16x16x32_bf16 a[32:35], v[44:47], v[80:83], a[32:35]
    s_add_u32 s40, s24, 6144
    v_exp_f32 v19, v115
    v_mfma_f32_16x16x32_bf16 a[80:83], v[40:43], v[68:71], a[80:83]
    s_min_u32 s56, s56, s58
    v_mfma_f32_16x16x32_bf16 a[80:83], v[44:47], v[84:87], a[80:83]
    v_cvt_pk_bf16_f32 v178, v16, v17
    v_mfma_f32_16x16x32_bf16 a[128:131], v[40:43], v[72:75], a[128:131]
    ds_read_b128 v[36:39], v1 offset:22528
    v_mfma_f32_16x16x32_bf16 a[128:131], v[44:47], v[88:91], a[128:131]
    v_exp_f32 v16, v180
    v_mfma_f32_16x16x32_bf16 a[176:179], v[40:43], v[76:79], a[176:179]
    v_add_f32 v5, v5, v18
    v_add_f32 v5, v5, v19
    v_mfma_f32_16x16x32_bf16 a[176:179], v[44:47], v[92:95], a[176:179]
    s_waitcnt lgkmcnt(2)
    v_exp_f32 v17, v181
    v_mfma_f32_16x16x32_bf16 a[36:39], v[24:27], v[64:67], a[36:39]
    s_add_u32 s41, s24, 12288
    ds_read_b128 v[40:43], v1 offset:11264
    v_mfma_f32_16x16x32_bf16 a[36:39], v[28:31], v[80:83], a[36:39]
    v_cvt_pk_bf16_f32 v179, v18, v19
    v_mfma_f32_16x16x32_bf16 a[84:87], v[24:27], v[68:71], a[84:87]
    v_exp_f32 v18, v182
    v_mfma_f32_16x16x32_bf16 a[84:87], v[28:31], v[84:87], a[84:87]
    v_add_f32 v6, v6, v16
    v_mfma_f32_16x16x32_bf16 a[132:135], v[24:27], v[72:75], a[132:135]
    ds_read_b128 v[44:47], v1 offset:23552
    v_add_f32 v6, v6, v17
    v_mfma_f32_16x16x32_bf16 a[132:135], v[28:31], v[88:91], a[132:135]
    s_waitcnt lgkmcnt(2)
    v_exp_f32 v19, v183
    v_mfma_f32_16x16x32_bf16 a[180:183], v[24:27], v[76:79], a[180:183]
    s_waitcnt vmcnt(6)
    s_add_u32 s42, s24, 18432
    v_mfma_f32_16x16x32_bf16 a[180:183], v[28:31], v[92:95], a[180:183]
    s_barrier
    v_add_u32 v2, 49152, v2
    v_add_u32 v3, 49152, v3
    v_mfma_f32_16x16x32_bf16 a[40:43], v[32:35], v[64:67], a[40:43]
    ds_read_b128 v[24:27], v2 offset:0
    v_cvt_pk_bf16_f32 v180, v16, v17
    v_mfma_f32_16x16x32_bf16 a[40:43], v[36:39], v[80:83], a[40:43]
    v_exp_f32 v16, v116
    v_mfma_f32_16x16x32_bf16 a[88:91], v[32:35], v[68:71], a[88:91]
    v_add_f32 v6, v6, v18
    v_add_f32 v6, v6, v19
    v_mfma_f32_16x16x32_bf16 a[88:91], v[36:39], v[84:87], a[88:91]
    v_exp_f32 v17, v117
    v_mfma_f32_16x16x32_bf16 a[136:139], v[32:35], v[72:75], a[136:139]
    ds_read_b128 v[28:31], v3 offset:0
    v_mfma_f32_16x16x32_bf16 a[136:139], v[36:39], v[88:91], a[136:139]
    v_cvt_pk_bf16_f32 v181, v18, v19
    v_mfma_f32_16x16x32_bf16 a[184:187], v[32:35], v[76:79], a[184:187]
    v_exp_f32 v18, v118
    v_mfma_f32_16x16x32_bf16 a[184:187], v[36:39], v[92:95], a[184:187]
    s_waitcnt lgkmcnt(2)
    v_add_f32 v6, v6, v16
    v_mfma_f32_16x16x32_bf16 a[44:47], v[40:43], v[64:67], a[44:47]
    ds_read_b128 v[32:35], v2 offset:6144
    v_add_f32 v6, v6, v17
    v_mfma_f32_16x16x32_bf16 a[44:47], v[44:47], v[80:83], a[44:47]
    v_exp_f32 v19, v119
    v_mfma_f32_16x16x32_bf16 a[92:95], v[40:43], v[68:71], a[92:95]
    v_mfma_f32_16x16x32_bf16 a[92:95], v[44:47], v[84:87], a[92:95]
    v_cvt_pk_bf16_f32 v182, v16, v17
    v_mfma_f32_16x16x32_bf16 a[140:143], v[40:43], v[72:75], a[140:143]
    ds_read_b128 v[36:39], v3 offset:6144
    v_add_f32 v6, v6, v18
    v_mfma_f32_16x16x32_bf16 a[140:143], v[44:47], v[88:91], a[140:143]
    v_add_f32 v6, v6, v19
    v_cvt_pk_bf16_f32 v183, v18, v19
    v_mfma_f32_16x16x32_bf16 a[188:191], v[40:43], v[76:79], a[188:191]
    v_mfma_f32_16x16x32_bf16 a[188:191], v[44:47], v[92:95], a[188:191]
    s_waitcnt lgkmcnt(2)
    v_mfma_f32_16x16x32_bf16 v[64:67], v[24:27], a[192:195], v[128:131]
    ds_read_b128 v[40:43], v2 offset:128
    v_mfma_f32_16x16x32_bf16 v[64:67], v[28:31], a[196:199], v[64:67]
    v_exp_f32 v16, v184
    v_mfma_f32_16x16x32_bf16 v[68:71], v[24:27], a[216:219], v[132:135]
    ds_read_b128 v[44:47], v3 offset:128
    v_mfma_f32_16x16x32_bf16 v[68:71], v[28:31], a[220:223], v[68:71]
    s_waitcnt lgkmcnt(2)
    v_exp_f32 v17, v185
    v_mfma_f32_16x16x32_bf16 v[96:99], v[32:35], a[192:195], v[128:131]
    ds_read_b128 v[24:27], v2 offset:6272
    v_mfma_f32_16x16x32_bf16 v[96:99], v[36:39], a[196:199], v[96:99]
    v_exp_f32 v18, v186
    v_mfma_f32_16x16x32_bf16 v[100:103], v[32:35], a[216:219], v[132:135]
    ds_read_b128 v[28:31], v3 offset:6272
    v_add_f32 v5, v5, v16
    v_mfma_f32_16x16x32_bf16 v[100:103], v[36:39], a[220:223], v[100:103]
    s_waitcnt lgkmcnt(2)
    v_add_f32 v5, v5, v17
    v_mfma_f32_16x16x32_bf16 v[64:67], v[40:43], a[200:203], v[64:67]
    ds_read_b128 v[32:35], v2 offset:256
    v_mfma_f32_16x16x32_bf16 v[64:67], v[44:47], a[204:207], v[64:67]
    v_exp_f32 v19, v187
    v_mfma_f32_16x16x32_bf16 v[68:71], v[40:43], a[224:227], v[68:71]
    ds_read_b128 v[36:39], v3 offset:256
    v_cvt_pk_bf16_f32 v184, v16, v17
    v_mfma_f32_16x16x32_bf16 v[68:71], v[44:47], a[228:231], v[68:71]
    s_waitcnt lgkmcnt(2)
    v_exp_f32 v16, v120
    v_mfma_f32_16x16x32_bf16 v[96:99], v[24:27], a[200:203], v[96:99]
    ds_read_b128 v[40:43], v2 offset:6400
    v_add_f32 v5, v5, v18
    v_mfma_f32_16x16x32_bf16 v[96:99], v[28:31], a[204:207], v[96:99]
    s_waitcnt vmcnt(0)
    v_add_f32 v5, v5, v19
    v_mfma_f32_16x16x32_bf16 v[100:103], v[24:27], a[224:227], v[100:103]
    ds_read_b128 v[44:47], v3 offset:6400
    v_mfma_f32_16x16x32_bf16 v[100:103], v[28:31], a[228:231], v[100:103]
    s_waitcnt lgkmcnt(2)
    s_barrier
    v_mfma_f32_16x16x32_bf16 v[64:67], v[32:35], a[208:211], v[64:67]
    s_mov_b32 m0, s56
    ds_read_b128 v[24:27], v2 offset:12288
    v_mfma_f32_16x16x32_bf16 v[64:67], v[36:39], a[212:215], v[64:67]
    buffer_load_dwordx4 v4, s[4:7], s27 offen offset:0 sc1 lds
    v_mfma_f32_16x16x32_bf16 v[68:71], v[32:35], a[232:235], v[68:71]
    ds_read_b128 v[28:31], v3 offset:12288
    v_mfma_f32_16x16x32_bf16 v[68:71], v[36:39], a[236:239], v[68:71]
    s_waitcnt lgkmcnt(2)
    v_exp_f32 v17, v121
    v_cvt_pk_bf16_f32 v185, v18, v19
    v_mfma_f32_16x16x32_bf16 v[96:99], v[40:43], a[208:211], v[96:99]
    ds_read_b128 v[32:35], v2 offset:18432
    v_mfma_f32_16x16x32_bf16 v[96:99], v[44:47], a[212:215], v[96:99]
    buffer_load_dwordx4 v4, s[4:7], s27 offen offset:1024 sc1 lds
    v_mfma_f32_16x16x32_bf16 v[100:103], v[40:43], a[232:235], v[100:103]
    ds_read_b128 v[36:39], v3 offset:18432
    v_mfma_f32_16x16x32_bf16 v[100:103], v[44:47], a[236:239], v[100:103]
    s_waitcnt lgkmcnt(2)
    v_exp_f32 v18, v122
    v_add_f32 v5, v5, v16
    v_mfma_f32_16x16x32_bf16 v[72:75], v[24:27], a[192:195], v[128:131]
    ds_read_b128 v[40:43], v2 offset:12416
    v_add_f32 v5, v5, v17
    v_mfma_f32_16x16x32_bf16 v[72:75], v[28:31], a[196:199], v[72:75]
    v_exp_f32 v19, v123
    v_cvt_pk_bf16_f32 v186, v16, v17
    v_mfma_f32_16x16x32_bf16 v[76:79], v[24:27], a[216:219], v[132:135]
    ds_read_b128 v[44:47], v3 offset:12416
    v_mfma_f32_16x16x32_bf16 v[76:79], v[28:31], a[220:223], v[76:79]
    s_waitcnt lgkmcnt(2)
    buffer_load_dwordx4 v4, s[4:7], s27 offen offset:2048 sc1 lds
    v_mfma_f32_16x16x32_bf16 v[104:107], v[32:35], a[192:195], v[128:131]
    ds_read_b128 v[24:27], v2 offset:18560
    v_mfma_f32_16x16x32_bf16 v[104:107], v[36:39], a[196:199], v[104:107]
    v_exp_f32 v16, v188
    v_add_f32 v5, v5, v18
    v_mfma_f32_16x16x32_bf16 v[108:111], v[32:35], a[216:219], v[132:135]
    ds_read_b128 v[28:31], v3 offset:18560
    v_add_f32 v5, v5, v19
    v_mfma_f32_16x16x32_bf16 v[108:111], v[36:39], a[220:223], v[108:111]
    s_waitcnt lgkmcnt(2)
    v_exp_f32 v17, v189
    v_cvt_pk_bf16_f32 v187, v18, v19
    v_mfma_f32_16x16x32_bf16 v[72:75], v[40:43], a[200:203], v[72:75]
    s_add_u32 s27, s27, 24576
    ds_read_b128 v[32:35], v2 offset:12544
    v_mfma_f32_16x16x32_bf16 v[72:75], v[44:47], a[204:207], v[72:75]
    v_exp_f32 v18, v190
    v_mfma_f32_16x16x32_bf16 v[76:79], v[40:43], a[224:227], v[76:79]
    s_add_u32 s56, s56, 12288
    ds_read_b128 v[36:39], v3 offset:12544
    v_add_f32 v6, v6, v16
    v_mfma_f32_16x16x32_bf16 v[76:79], v[44:47], a[228:231], v[76:79]
    s_waitcnt lgkmcnt(2)
    v_add_f32 v6, v6, v17
    v_mfma_f32_16x16x32_bf16 v[104:107], v[24:27], a[200:203], v[104:107]
    ds_read_b128 v[40:43], v2 offset:18688
    v_mfma_f32_16x16x32_bf16 v[104:107], v[28:31], a[204:207], v[104:107]
    v_exp_f32 v19, v191
    v_cvt_pk_bf16_f32 v188, v16, v17
    v_mfma_f32_16x16x32_bf16 v[108:111], v[24:27], a[224:227], v[108:111]
    s_mov_b32 m0, s56
    ds_read_b128 v[44:47], v3 offset:18688
    v_mfma_f32_16x16x32_bf16 v[108:111], v[28:31], a[228:231], v[108:111]
    s_waitcnt lgkmcnt(2)
    v_add_u32 v2, 49152, v2
    v_add_u32 v3, 49152, v3
    v_mfma_f32_16x16x32_bf16 v[72:75], v[32:35], a[208:211], v[72:75]
    ds_read_b128 v[24:27], v2 offset:0
    v_mfma_f32_16x16x32_bf16 v[72:75], v[36:39], a[212:215], v[72:75]
    buffer_load_dwordx4 v4, s[4:7], s27 offen offset:0 sc1 lds
    v_mfma_f32_16x16x32_bf16 v[76:79], v[32:35], a[232:235], v[76:79]
    ds_read_b128 v[28:31], v3 offset:0
    v_mfma_f32_16x16x32_bf16 v[76:79], v[36:39], a[236:239], v[76:79]
    s_waitcnt lgkmcnt(2)
    v_exp_f32 v16, v124
    v_add_f32 v6, v6, v18
    v_mfma_f32_16x16x32_bf16 v[104:107], v[40:43], a[208:211], v[104:107]
    ds_read_b128 v[32:35], v2 offset:6144
    v_add_f32 v6, v6, v19
    v_mfma_f32_16x16x32_bf16 v[104:107], v[44:47], a[212:215], v[104:107]
    v_exp_f32 v17, v125
    v_cvt_pk_bf16_f32 v189, v18, v19
    v_mfma_f32_16x16x32_bf16 v[108:111], v[40:43], a[232:235], v[108:111]
    ds_read_b128 v[36:39], v3 offset:6144
    v_mfma_f32_16x16x32_bf16 v[108:111], v[44:47], a[236:239], v[108:111]
    s_waitcnt lgkmcnt(2)
    buffer_load_dwordx4 v4, s[4:7], s27 offen offset:1024 sc1 lds
    v_mfma_f32_16x16x32_bf16 v[80:83], v[24:27], a[240:243], v[136:139]
    ds_read_b128 v[40:43], v2 offset:128
    v_mfma_f32_16x16x32_bf16 v[80:83], v[28:31], a[244:247], v[80:83]
    v_exp_f32 v18, v126
    v_add_f32 v6, v6, v16
    v_mfma_f32_16x16x32_bf16 v[84:87], v[24:27], v[200:203], v[140:143]
    ds_read_b128 v[44:47], v3 offset:128
    v_add_f32 v6, v6, v17
    v_exp_f32 v19, v127
    v_cvt_pk_bf16_f32 v190, v16, v17
    v_add_f32 v6, v6, v18
    v_add_f32 v6, v6, v19
    v_cvt_pk_bf16_f32 v191, v18, v19
    v_mfma_f32_16x16x32_bf16 v[84:87], v[28:31], v[204:207], v[84:87]
    s_waitcnt lgkmcnt(2)
    v_exp_f32 v16, v64
    v_mfma_f32_16x16x32_bf16 v[112:115], v[32:35], a[240:243], v[136:139]
    ds_read_b128 v[24:27], v2 offset:6272
    v_mfma_f32_16x16x32_bf16 v[112:115], v[36:39], a[244:247], v[112:115]
    buffer_load_dwordx4 v4, s[4:7], s27 offen offset:2048 sc1 lds
    v_mfma_f32_16x16x32_bf16 v[116:119], v[32:35], v[200:203], v[140:143]
    ds_read_b128 v[28:31], v3 offset:6272
    v_mfma_f32_16x16x32_bf16 v[116:119], v[36:39], v[204:207], v[116:119]
    s_waitcnt lgkmcnt(2)
    v_exp_f32 v17, v65
    v_mfma_f32_16x16x32_bf16 v[80:83], v[40:43], a[248:251], v[80:83]
    ds_read_b128 v[32:35], v2 offset:256
    v_mfma_f32_16x16x32_bf16 v[80:83], v[44:47], a[252:255], v[80:83]
    v_exp_f32 v18, v66
    v_mfma_f32_16x16x32_bf16 v[84:87], v[40:43], v[208:211], v[84:87]
    ds_read_b128 v[36:39], v3 offset:256
    v_add_f32 v5, v5, v16
    v_mfma_f32_16x16x32_bf16 v[84:87], v[44:47], v[212:215], v[84:87]
    s_waitcnt lgkmcnt(2)
    v_add_f32 v5, v5, v17
    v_mfma_f32_16x16x32_bf16 v[112:115], v[24:27], a[248:251], v[112:115]
    ds_read_b128 v[40:43], v2 offset:6400
    v_mfma_f32_16x16x32_bf16 v[112:115], v[28:31], a[252:255], v[112:115]
    v_exp_f32 v19, v67
    v_cvt_pk_bf16_f32 v64, v16, v17
    v_mfma_f32_16x16x32_bf16 v[116:119], v[24:27], v[208:211], v[116:119]
    s_add_u32 s27, s27, 24576
    ds_read_b128 v[44:47], v3 offset:6400
    s_add_u32 s56, s56, 36864
    v_mfma_f32_16x16x32_bf16 v[116:119], v[28:31], v[212:215], v[116:119]
    s_waitcnt lgkmcnt(2)
    v_exp_f32 v16, v96
    v_mfma_f32_16x16x32_bf16 v[80:83], v[32:35], v[192:195], v[80:83]
    s_sub_u32 s58, s56, 147456
    ds_read_b128 v[24:27], v2 offset:12288
    v_add_f32 v5, v5, v18
    v_mfma_f32_16x16x32_bf16 v[80:83], v[36:39], v[196:199], v[80:83]
    s_min_u32 s56, s56, s58
    v_add_f32 v5, v5, v19
    v_mfma_f32_16x16x32_bf16 v[84:87], v[32:35], v[216:219], v[84:87]
    ds_read_b128 v[28:31], v3 offset:12288
    v_mfma_f32_16x16x32_bf16 v[84:87], v[36:39], v[220:223], v[84:87]
    s_waitcnt lgkmcnt(2)
    v_exp_f32 v17, v97
    v_cvt_pk_bf16_f32 v65, v18, v19
    v_mfma_f32_16x16x32_bf16 v[112:115], v[40:43], v[192:195], v[112:115]
    ds_read_b128 v[32:35], v2 offset:18432
    v_mfma_f32_16x16x32_bf16 v[112:115], v[44:47], v[196:199], v[112:115]
    v_exp_f32 v18, v98
    v_mfma_f32_16x16x32_bf16 v[116:119], v[40:43], v[216:219], v[116:119]
    ds_read_b128 v[36:39], v3 offset:18432
    v_add_f32 v5, v5, v16
    v_mfma_f32_16x16x32_bf16 v[116:119], v[44:47], v[220:223], v[116:119]
    s_waitcnt lgkmcnt(2)
    v_add_f32 v5, v5, v17
    v_mfma_f32_16x16x32_bf16 v[88:91], v[24:27], a[240:243], v[136:139]
    ds_read_b128 v[40:43], v2 offset:12416
    v_mfma_f32_16x16x32_bf16 v[88:91], v[28:31], a[244:247], v[88:91]
    v_exp_f32 v19, v99
    v_cvt_pk_bf16_f32 v66, v16, v17
    v_mfma_f32_16x16x32_bf16 v[92:95], v[24:27], v[200:203], v[140:143]
    ds_read_b128 v[44:47], v3 offset:12416
    v_mfma_f32_16x16x32_bf16 v[92:95], v[28:31], v[204:207], v[92:95]
    s_waitcnt lgkmcnt(2)
    v_exp_f32 v16, v68
    v_mfma_f32_16x16x32_bf16 v[120:123], v[32:35], a[240:243], v[136:139]
    ds_read_b128 v[24:27], v2 offset:18560
    v_add_f32 v5, v5, v18
    v_mfma_f32_16x16x32_bf16 v[120:123], v[36:39], a[244:247], v[120:123]
    v_add_f32 v5, v5, v19
    v_mfma_f32_16x16x32_bf16 v[124:127], v[32:35], v[200:203], v[140:143]
    ds_read_b128 v[28:31], v3 offset:18560
    v_mfma_f32_16x16x32_bf16 v[124:127], v[36:39], v[204:207], v[124:127]
    s_waitcnt lgkmcnt(2)
    v_exp_f32 v17, v69
    v_cvt_pk_bf16_f32 v67, v18, v19
    v_mfma_f32_16x16x32_bf16 v[88:91], v[40:43], a[248:251], v[88:91]
    ds_read_b128 v[32:35], v2 offset:12544
    v_mfma_f32_16x16x32_bf16 v[88:91], v[44:47], a[252:255], v[88:91]
    v_exp_f32 v18, v70
    v_mfma_f32_16x16x32_bf16 v[92:95], v[40:43], v[208:211], v[92:95]
    ds_read_b128 v[36:39], v3 offset:12544
    v_add_f32 v6, v6, v16
    v_mfma_f32_16x16x32_bf16 v[92:95], v[44:47], v[212:215], v[92:95]
    s_waitcnt lgkmcnt(2)
    v_add_f32 v6, v6, v17
    v_mfma_f32_16x16x32_bf16 v[120:123], v[24:27], a[248:251], v[120:123]
    ds_read_b128 v[40:43], v2 offset:18688
    v_mfma_f32_16x16x32_bf16 v[120:123], v[28:31], a[252:255], v[120:123]
    v_exp_f32 v19, v71
    v_cvt_pk_bf16_f32 v68, v16, v17
    v_mfma_f32_16x16x32_bf16 v[124:127], v[24:27], v[208:211], v[124:127]
    ds_read_b128 v[44:47], v3 offset:18688
    v_mfma_f32_16x16x32_bf16 v[124:127], v[28:31], v[212:215], v[124:127]
    s_waitcnt lgkmcnt(2)
    v_add_u32 v1, 49152, v1
    v_exp_f32 v16, v100
    v_mfma_f32_16x16x32_bf16 v[88:91], v[32:35], v[192:195], v[88:91]
    ds_read_b128 v[24:27], v1 offset:0
    v_add_f32 v6, v6, v18
    v_mfma_f32_16x16x32_bf16 v[88:91], v[36:39], v[196:199], v[88:91]
    v_add_f32 v6, v6, v19
    v_mfma_f32_16x16x32_bf16 v[92:95], v[32:35], v[216:219], v[92:95]
    ds_read_b128 v[28:31], v1 offset:12288
    v_mfma_f32_16x16x32_bf16 v[92:95], v[36:39], v[220:223], v[92:95]
    s_waitcnt lgkmcnt(2)
    v_exp_f32 v17, v101
    v_cvt_pk_bf16_f32 v69, v18, v19
    v_mfma_f32_16x16x32_bf16 v[120:123], v[40:43], v[192:195], v[120:123]
    ds_read_b128 v[32:35], v1 offset:1024
    v_mfma_f32_16x16x32_bf16 v[120:123], v[44:47], v[196:199], v[120:123]
    v_exp_f32 v18, v102
    v_mfma_f32_16x16x32_bf16 v[124:127], v[40:43], v[216:219], v[124:127]
    ds_read_b128 v[36:39], v1 offset:13312
    v_add_f32 v6, v6, v16
    v_mfma_f32_16x16x32_bf16 v[124:127], v[44:47], v[220:223], v[124:127]
    s_waitcnt lgkmcnt(2)
    v_add_f32 v6, v6, v17
    v_exp_f32 v19, v103
    v_cvt_pk_bf16_f32 v70, v16, v17
    v_add_f32 v6, v6, v18
    v_add_f32 v6, v6, v19
    v_cvt_pk_bf16_f32 v71, v18, v19
    v_mfma_f32_16x16x32_bf16 a[0:3], v[24:27], v[160:163], a[0:3]
    ds_read_b128 v[40:43], v1 offset:2048
    v_mfma_f32_16x16x32_bf16 a[0:3], v[28:31], v[168:171], a[0:3]
    v_exp_f32 v16, v72
    v_mfma_f32_16x16x32_bf16 a[48:51], v[24:27], v[164:167], a[48:51]
    ds_read_b128 v[44:47], v1 offset:14336
    v_mfma_f32_16x16x32_bf16 a[48:51], v[28:31], v[172:175], a[48:51]
    s_waitcnt lgkmcnt(2)
    v_exp_f32 v17, v73
    v_mfma_f32_16x16x32_bf16 a[4:7], v[32:35], v[160:163], a[4:7]
    ds_read_b128 v[24:27], v1 offset:3072
    v_mfma_f32_16x16x32_bf16 a[4:7], v[36:39], v[168:171], a[4:7]
    v_exp_f32 v18, v74
    v_mfma_f32_16x16x32_bf16 a[52:55], v[32:35], v[164:167], a[52:55]
    ds_read_b128 v[28:31], v1 offset:15360
    v_add_f32 v5, v5, v16
    v_mfma_f32_16x16x32_bf16 a[52:55], v[36:39], v[172:175], a[52:55]
    s_waitcnt lgkmcnt(2)
    v_add_f32 v5, v5, v17
    v_mfma_f32_16x16x32_bf16 a[8:11], v[40:43], v[160:163], a[8:11]
    ds_read_b128 v[32:35], v1 offset:4096
    v_mfma_f32_16x16x32_bf16 a[8:11], v[44:47], v[168:171], a[8:11]
    v_exp_f32 v19, v75
    v_mfma_f32_16x16x32_bf16 a[56:59], v[40:43], v[164:167], a[56:59]
    ds_read_b128 v[36:39], v1 offset:16384
    v_cvt_pk_bf16_f32 v72, v16, v17
    v_mfma_f32_16x16x32_bf16 a[56:59], v[44:47], v[172:175], a[56:59]
    s_waitcnt lgkmcnt(2)
    v_exp_f32 v16, v104
    v_mfma_f32_16x16x32_bf16 a[12:15], v[24:27], v[160:163], a[12:15]
    ds_read_b128 v[40:43], v1 offset:5120
    v_add_f32 v5, v5, v18
    v_mfma_f32_16x16x32_bf16 a[12:15], v[28:31], v[168:171], a[12:15]
    v_add_f32 v5, v5, v19
    v_mfma_f32_16x16x32_bf16 a[60:63], v[24:27], v[164:167], a[60:63]
    ds_read_b128 v[44:47], v1 offset:17408
    v_mfma_f32_16x16x32_bf16 a[60:63], v[28:31], v[172:175], a[60:63]
    s_waitcnt lgkmcnt(2)
    v_exp_f32 v17, v105
    v_mfma_f32_16x16x32_bf16 a[16:19], v[32:35], v[160:163], a[16:19]
    ds_read_b128 v[24:27], v1 offset:6144
    v_cvt_pk_bf16_f32 v73, v18, v19
    v_mfma_f32_16x16x32_bf16 a[16:19], v[36:39], v[168:171], a[16:19]
    v_exp_f32 v18, v106
    v_mfma_f32_16x16x32_bf16 a[64:67], v[32:35], v[164:167], a[64:67]
    ds_read_b128 v[28:31], v1 offset:18432
    v_add_f32 v5, v5, v16
    v_mfma_f32_16x16x32_bf16 a[64:67], v[36:39], v[172:175], a[64:67]
    s_waitcnt lgkmcnt(2)
    v_add_f32 v5, v5, v17
    v_mfma_f32_16x16x32_bf16 a[20:23], v[40:43], v[160:163], a[20:23]
    ds_read_b128 v[32:35], v1 offset:7168
    v_mfma_f32_16x16x32_bf16 a[20:23], v[44:47], v[168:171], a[20:23]
    v_exp_f32 v19, v107
    v_cvt_pk_bf16_f32 v74, v16, v17
    v_mfma_f32_16x16x32_bf16 a[68:71], v[40:43], v[164:167], a[68:71]
    ds_read_b128 v[36:39], v1 offset:19456
    v_mfma_f32_16x16x32_bf16 a[68:71], v[44:47], v[172:175], a[68:71]
    s_waitcnt lgkmcnt(2)
    v_exp_f32 v16, v76
    v_add_f32 v5, v5, v18
    v_mfma_f32_16x16x32_bf16 a[24:27], v[24:27], v[160:163], a[24:27]
    ds_read_b128 v[40:43], v1 offset:8192
    v_add_f32 v5, v5, v19
    v_mfma_f32_16x16x32_bf16 a[24:27], v[28:31], v[168:171], a[24:27]
    v_exp_f32 v17, v77
    v_mfma_f32_16x16x32_bf16 a[72:75], v[24:27], v[164:167], a[72:75]
    ds_read_b128 v[44:47], v1 offset:20480
    v_cvt_pk_bf16_f32 v75, v18, v19
    v_mfma_f32_16x16x32_bf16 a[72:75], v[28:31], v[172:175], a[72:75]
    s_waitcnt lgkmcnt(2)
    v_exp_f32 v18, v78
    v_mfma_f32_16x16x32_bf16 a[28:31], v[32:35], v[160:163], a[28:31]
    ds_read_b128 v[24:27], v1 offset:9216
    v_add_f32 v6, v6, v16
    v_mfma_f32_16x16x32_bf16 a[28:31], v[36:39], v[168:171], a[28:31]
    v_add_f32 v6, v6, v17
    v_mfma_f32_16x16x32_bf16 a[76:79], v[32:35], v[164:167], a[76:79]
    ds_read_b128 v[28:31], v1 offset:21504
    v_mfma_f32_16x16x32_bf16 a[76:79], v[36:39], v[172:175], a[76:79]
    s_waitcnt lgkmcnt(2)
    v_exp_f32 v19, v79
    v_cvt_pk_bf16_f32 v76, v16, v17
    v_mfma_f32_16x16x32_bf16 a[32:35], v[40:43], v[160:163], a[32:35]
    ds_read_b128 v[32:35], v1 offset:10240
    v_mfma_f32_16x16x32_bf16 a[32:35], v[44:47], v[168:171], a[32:35]
    v_exp_f32 v16, v108
    v_add_f32 v6, v6, v18
    v_mfma_f32_16x16x32_bf16 a[80:83], v[40:43], v[164:167], a[80:83]
    ds_read_b128 v[36:39], v1 offset:22528
    v_add_f32 v6, v6, v19
    v_mfma_f32_16x16x32_bf16 a[80:83], v[44:47], v[172:175], a[80:83]
    s_waitcnt lgkmcnt(2)
    v_exp_f32 v17, v109
    v_mfma_f32_16x16x32_bf16 a[36:39], v[24:27], v[160:163], a[36:39]
    ds_read_b128 v[40:43], v1 offset:11264
    v_cvt_pk_bf16_f32 v77, v18, v19
    v_mfma_f32_16x16x32_bf16 a[36:39], v[28:31], v[168:171], a[36:39]
    v_exp_f32 v18, v110
    v_mfma_f32_16x16x32_bf16 a[84:87], v[24:27], v[164:167], a[84:87]
    ds_read_b128 v[44:47], v1 offset:23552
    v_add_f32 v6, v6, v16
    v_mfma_f32_16x16x32_bf16 a[84:87], v[28:31], v[172:175], a[84:87]
    s_waitcnt lgkmcnt(2)
    v_subrev_u32 v1, 98304, v1
    v_add_f32 v6, v6, v17
    v_mfma_f32_16x16x32_bf16 a[40:43], v[32:35], v[160:163], a[40:43]
    ds_read_b128 v[24:27], v1 offset:0
    v_mfma_f32_16x16x32_bf16 a[40:43], v[36:39], v[168:171], a[40:43]
    v_exp_f32 v19, v111
    v_cvt_pk_bf16_f32 v78, v16, v17
    v_mfma_f32_16x16x32_bf16 a[88:91], v[32:35], v[164:167], a[88:91]
    ds_read_b128 v[28:31], v1 offset:12288
    v_add_f32 v6, v6, v18
    v_mfma_f32_16x16x32_bf16 a[88:91], v[36:39], v[172:175], a[88:91]
    s_waitcnt lgkmcnt(2)
    v_add_f32 v6, v6, v19
    v_cvt_pk_bf16_f32 v79, v18, v19
    v_mfma_f32_16x16x32_bf16 a[44:47], v[40:43], v[160:163], a[44:47]
    ds_read_b128 v[32:35], v1 offset:1024
    v_mov_b32 v48, v5
    v_mfma_f32_16x16x32_bf16 a[44:47], v[44:47], v[168:171], a[44:47]
    v_mov_b32 v50, v6
    s_nop 0
    v_mfma_f32_16x16x32_bf16 a[92:95], v[40:43], v[164:167], a[92:95]
    ds_read_b128 v[36:39], v1 offset:13312
    v_permlane16_swap_b32 v5, v48
    v_mfma_f32_16x16x32_bf16 a[92:95], v[44:47], v[172:175], a[92:95]
    s_waitcnt lgkmcnt(2)
    v_permlane16_swap_b32 v6, v50
    s_nop 0
    v_mfma_f32_16x16x32_bf16 a[0:3], v[24:27], v[176:179], a[0:3]
    ds_read_b128 v[40:43], v1 offset:2048
    v_add_f32 v5, v5, v48
    v_mfma_f32_16x16x32_bf16 a[0:3], v[28:31], v[184:187], a[0:3]
    v_add_f32 v6, v6, v50
    v_mov_b32 v48, v5
    v_mfma_f32_16x16x32_bf16 a[48:51], v[24:27], v[180:183], a[48:51]
    ds_read_b128 v[44:47], v1 offset:14336
    v_mov_b32 v50, v6
    v_mfma_f32_16x16x32_bf16 a[48:51], v[28:31], v[188:191], a[48:51]
    s_waitcnt lgkmcnt(2)
    s_nop 0
    v_permlane32_swap_b32 v5, v48
    v_mfma_f32_16x16x32_bf16 a[4:7], v[32:35], v[176:179], a[4:7]
    ds_read_b128 v[24:27], v1 offset:3072
    v_permlane32_swap_b32 v6, v50
    v_mfma_f32_16x16x32_bf16 a[4:7], v[36:39], v[184:187], a[4:7]
    s_nop 0
    v_add_f32 v5, v5, v48
    v_add_f32 v6, v6, v50
    v_mfma_f32_16x16x32_bf16 a[52:55], v[32:35], v[180:183], a[52:55]
    ds_read_b128 v[28:31], v1 offset:15360
    v_mfma_f32_16x16x32_bf16 a[52:55], v[36:39], v[188:191], a[52:55]
    s_waitcnt lgkmcnt(2)
    v_rcp_f32 v48, v5
    v_mfma_f32_16x16x32_bf16 a[8:11], v[40:43], v[176:179], a[8:11]
    ds_read_b128 v[32:35], v1 offset:4096
    v_mfma_f32_16x16x32_bf16 a[8:11], v[44:47], v[184:187], a[8:11]
    v_rcp_f32 v50, v6
    v_mfma_f32_16x16x32_bf16 a[56:59], v[40:43], v[180:183], a[56:59]
    s_nop 0
    ds_read_b128 v[36:39], v1 offset:16384
    v_mfma_f32_16x16x32_bf16 a[56:59], v[44:47], v[188:191], a[56:59]
    s_waitcnt lgkmcnt(2)
    v_exp_f32 v16, v80
    v_mfma_f32_16x16x32_bf16 a[12:15], v[24:27], v[176:179], a[12:15]
    ds_read_b128 v[40:43], v1 offset:5120
    v_mfma_f32_16x16x32_bf16 a[12:15], v[28:31], v[184:187], a[12:15]
    v_exp_f32 v17, v81
    v_mfma_f32_16x16x32_bf16 a[60:63], v[24:27], v[180:183], a[60:63]
    ds_read_b128 v[44:47], v1 offset:17408
    v_mfma_f32_16x16x32_bf16 a[60:63], v[28:31], v[188:191], a[60:63]
    s_waitcnt lgkmcnt(2)
    v_exp_f32 v18, v82
    v_mfma_f32_16x16x32_bf16 a[16:19], v[32:35], v[176:179], a[16:19]
    ds_read_b128 v[24:27], v1 offset:6144
    v_add_f32 v7, v7, v16
    v_mfma_f32_16x16x32_bf16 a[16:19], v[36:39], v[184:187], a[16:19]
    v_add_f32 v7, v7, v17
    v_exp_f32 v19, v83
    v_mfma_f32_16x16x32_bf16 a[64:67], v[32:35], v[180:183], a[64:67]
    ds_read_b128 v[28:31], v1 offset:18432
    v_cvt_pk_bf16_f32 v80, v16, v17
    v_mfma_f32_16x16x32_bf16 a[64:67], v[36:39], v[188:191], a[64:67]
    s_waitcnt lgkmcnt(2)
    v_exp_f32 v16, v112
    v_mfma_f32_16x16x32_bf16 a[20:23], v[40:43], v[176:179], a[20:23]
    ds_read_b128 v[32:35], v1 offset:7168
    v_add_f32 v7, v7, v18
    v_mfma_f32_16x16x32_bf16 a[20:23], v[44:47], v[184:187], a[20:23]
    v_add_f32 v7, v7, v19
    v_mfma_f32_16x16x32_bf16 a[68:71], v[40:43], v[180:183], a[68:71]
    ds_read_b128 v[36:39], v1 offset:19456
    v_mfma_f32_16x16x32_bf16 a[68:71], v[44:47], v[188:191], a[68:71]
    s_waitcnt lgkmcnt(2)
    v_exp_f32 v17, v113
    v_mfma_f32_16x16x32_bf16 a[24:27], v[24:27], v[176:179], a[24:27]
    ds_read_b128 v[40:43], v1 offset:8192
    v_cvt_pk_bf16_f32 v81, v18, v19
    v_mfma_f32_16x16x32_bf16 a[24:27], v[28:31], v[184:187], a[24:27]
    v_exp_f32 v18, v114
    v_mfma_f32_16x16x32_bf16 a[72:75], v[24:27], v[180:183], a[72:75]
    ds_read_b128 v[44:47], v1 offset:20480
    v_add_f32 v7, v7, v16
    v_mfma_f32_16x16x32_bf16 a[72:75], v[28:31], v[188:191], a[72:75]
    s_waitcnt lgkmcnt(2)
    v_add_f32 v7, v7, v17
    v_exp_f32 v19, v115
    v_mfma_f32_16x16x32_bf16 a[28:31], v[32:35], v[176:179], a[28:31]
    ds_read_b128 v[24:27], v1 offset:9216
    v_cvt_pk_bf16_f32 v82, v16, v17
    v_mfma_f32_16x16x32_bf16 a[28:31], v[36:39], v[184:187], a[28:31]
    s_waitcnt vmcnt(0)
    v_exp_f32 v16, v84
    v_mfma_f32_16x16x32_bf16 a[76:79], v[32:35], v[180:183], a[76:79]
    ds_read_b128 v[28:31], v1 offset:21504
    v_add_f32 v7, v7, v18
    v_mfma_f32_16x16x32_bf16 a[76:79], v[36:39], v[188:191], a[76:79]
    s_waitcnt lgkmcnt(2)
    s_barrier
    v_mfma_f32_16x16x32_bf16 a[32:35], v[40:43], v[176:179], a[32:35]
    ds_read_b128 v[32:35], v1 offset:10240
    v_add_f32 v7, v7, v19
    v_mfma_f32_16x16x32_bf16 a[32:35], v[44:47], v[184:187], a[32:35]
    v_exp_f32 v17, v85
    v_mfma_f32_16x16x32_bf16 a[80:83], v[40:43], v[180:183], a[80:83]
    ds_read_b128 v[36:39], v1 offset:22528
    v_cvt_pk_bf16_f32 v83, v18, v19
    v_mfma_f32_16x16x32_bf16 a[80:83], v[44:47], v[188:191], a[80:83]
    s_waitcnt lgkmcnt(2)
    v_exp_f32 v18, v86
    v_mfma_f32_16x16x32_bf16 a[36:39], v[24:27], v[176:179], a[36:39]
    ds_read_b128 v[40:43], v1 offset:11264
    v_add_f32 v8, v8, v16
    v_mfma_f32_16x16x32_bf16 a[36:39], v[28:31], v[184:187], a[36:39]
    v_add_f32 v8, v8, v17
    v_exp_f32 v19, v87
    v_mfma_f32_16x16x32_bf16 a[84:87], v[24:27], v[180:183], a[84:87]
    ds_read_b128 v[44:47], v1 offset:23552
    v_cvt_pk_bf16_f32 v84, v16, v17
    v_mfma_f32_16x16x32_bf16 a[84:87], v[28:31], v[188:191], a[84:87]
    s_waitcnt lgkmcnt(2)
    v_add_u32 v1, 49152, v1
    v_mfma_f32_16x16x32_bf16 a[40:43], v[32:35], v[176:179], a[40:43]
    ds_read_b128 v[24:27], v1 offset:0
    v_mfma_f32_16x16x32_bf16 a[40:43], v[36:39], v[184:187], a[40:43]
    v_exp_f32 v16, v116
    v_add_f32 v8, v8, v18
    v_mfma_f32_16x16x32_bf16 a[88:91], v[32:35], v[180:183], a[88:91]
    ds_read_b128 v[28:31], v1 offset:12288
    v_add_f32 v8, v8, v19
    v_mfma_f32_16x16x32_bf16 a[88:91], v[36:39], v[188:191], a[88:91]
    s_waitcnt lgkmcnt(2)
    v_exp_f32 v17, v117
    v_mfma_f32_16x16x32_bf16 a[44:47], v[40:43], v[176:179], a[44:47]
    ds_read_b128 v[32:35], v1 offset:1024
    v_cvt_pk_bf16_f32 v85, v18, v19
    v_mfma_f32_16x16x32_bf16 a[44:47], v[44:47], v[184:187], a[44:47]
    v_exp_f32 v18, v118
    v_mfma_f32_16x16x32_bf16 a[92:95], v[40:43], v[180:183], a[92:95]
    ds_read_b128 v[36:39], v1 offset:13312
    v_add_f32 v8, v8, v16
    v_mfma_f32_16x16x32_bf16 a[92:95], v[44:47], v[188:191], a[92:95]
    s_waitcnt lgkmcnt(2)
    v_add_f32 v8, v8, v17
    v_exp_f32 v19, v119
    v_cvt_pk_bf16_f32 v86, v16, v17
    v_add_f32 v8, v8, v18
    v_add_f32 v8, v8, v19
    v_cvt_pk_bf16_f32 v87, v18, v19
    v_mfma_f32_16x16x32_bf16 a[0:3], v[24:27], v[64:67], a[0:3]
    ds_read_b128 v[40:43], v1 offset:2048
    v_mfma_f32_16x16x32_bf16 a[0:3], v[28:31], v[72:75], a[0:3]
    v_exp_f32 v16, v88
    v_mfma_f32_16x16x32_bf16 a[48:51], v[24:27], v[68:71], a[48:51]
    ds_read_b128 v[44:47], v1 offset:14336
    v_mfma_f32_16x16x32_bf16 a[48:51], v[28:31], v[76:79], a[48:51]
    s_waitcnt lgkmcnt(2)
    v_exp_f32 v17, v89
    v_mfma_f32_16x16x32_bf16 a[4:7], v[32:35], v[64:67], a[4:7]
    ds_read_b128 v[24:27], v1 offset:3072
    v_mfma_f32_16x16x32_bf16 a[4:7], v[36:39], v[72:75], a[4:7]
    v_exp_f32 v18, v90
    v_mfma_f32_16x16x32_bf16 a[52:55], v[32:35], v[68:71], a[52:55]
    ds_read_b128 v[28:31], v1 offset:15360
    v_add_f32 v7, v7, v16
    v_mfma_f32_16x16x32_bf16 a[52:55], v[36:39], v[76:79], a[52:55]
    s_waitcnt lgkmcnt(2)
    v_add_f32 v7, v7, v17
    v_exp_f32 v19, v91
    v_mfma_f32_16x16x32_bf16 a[8:11], v[40:43], v[64:67], a[8:11]
    ds_read_b128 v[32:35], v1 offset:4096
    v_cvt_pk_bf16_f32 v88, v16, v17
    v_mfma_f32_16x16x32_bf16 a[8:11], v[44:47], v[72:75], a[8:11]
    v_exp_f32 v16, v120
    v_mfma_f32_16x16x32_bf16 a[56:59], v[40:43], v[68:71], a[56:59]
    ds_read_b128 v[36:39], v1 offset:16384
    v_add_f32 v7, v7, v18
    v_mfma_f32_16x16x32_bf16 a[56:59], v[44:47], v[76:79], a[56:59]
    s_waitcnt lgkmcnt(2)
    v_add_f32 v7, v7, v19
    v_exp_f32 v17, v121
    v_mfma_f32_16x16x32_bf16 a[12:15], v[24:27], v[64:67], a[12:15]
    ds_read_b128 v[40:43], v1 offset:5120
    v_cvt_pk_bf16_f32 v89, v18, v19
    v_mfma_f32_16x16x32_bf16 a[12:15], v[28:31], v[72:75], a[12:15]
    v_exp_f32 v18, v122
    v_mfma_f32_16x16x32_bf16 a[60:63], v[24:27], v[68:71], a[60:63]
    ds_read_b128 v[44:47], v1 offset:17408
    v_add_f32 v7, v7, v16
    v_mfma_f32_16x16x32_bf16 a[60:63], v[28:31], v[76:79], a[60:63]
    s_waitcnt lgkmcnt(2)
    v_add_f32 v7, v7, v17
    v_exp_f32 v19, v123
    v_mfma_f32_16x16x32_bf16 a[16:19], v[32:35], v[64:67], a[16:19]
    ds_read_b128 v[24:27], v1 offset:6144
    v_cvt_pk_bf16_f32 v90, v16, v17
    v_mfma_f32_16x16x32_bf16 a[16:19], v[36:39], v[72:75], a[16:19]
    v_exp_f32 v16, v92
    v_mfma_f32_16x16x32_bf16 a[64:67], v[32:35], v[68:71], a[64:67]
    ds_read_b128 v[28:31], v1 offset:18432
    v_add_f32 v7, v7, v18
    v_mfma_f32_16x16x32_bf16 a[64:67], v[36:39], v[76:79], a[64:67]
    s_waitcnt lgkmcnt(2)
    v_add_f32 v7, v7, v19
    v_exp_f32 v17, v93
    v_mfma_f32_16x16x32_bf16 a[20:23], v[40:43], v[64:67], a[20:23]
    ds_read_b128 v[32:35], v1 offset:7168
    v_cvt_pk_bf16_f32 v91, v18, v19
    v_mfma_f32_16x16x32_bf16 a[20:23], v[44:47], v[72:75], a[20:23]
    v_exp_f32 v18, v94
    v_mfma_f32_16x16x32_bf16 a[68:71], v[40:43], v[68:71], a[68:71]
    ds_read_b128 v[36:39], v1 offset:19456
    v_add_f32 v8, v8, v16
    v_mfma_f32_16x16x32_bf16 a[68:71], v[44:47], v[76:79], a[68:71]
    s_waitcnt lgkmcnt(2)
    v_add_f32 v8, v8, v17
    v_exp_f32 v19, v95
    v_mfma_f32_16x16x32_bf16 a[24:27], v[24:27], v[64:67], a[24:27]
    ds_read_b128 v[40:43], v1 offset:8192
    v_cvt_pk_bf16_f32 v92, v16, v17
    v_mfma_f32_16x16x32_bf16 a[24:27], v[28:31], v[72:75], a[24:27]
    v_exp_f32 v16, v124
    v_mfma_f32_16x16x32_bf16 a[72:75], v[24:27], v[68:71], a[72:75]
    ds_read_b128 v[44:47], v1 offset:20480
    v_add_f32 v8, v8, v18
    v_mfma_f32_16x16x32_bf16 a[72:75], v[28:31], v[76:79], a[72:75]
    s_waitcnt lgkmcnt(2)
    v_add_f32 v8, v8, v19
    v_exp_f32 v17, v125
    v_mfma_f32_16x16x32_bf16 a[28:31], v[32:35], v[64:67], a[28:31]
    ds_read_b128 v[24:27], v1 offset:9216
    v_cvt_pk_bf16_f32 v93, v18, v19
    v_mfma_f32_16x16x32_bf16 a[28:31], v[36:39], v[72:75], a[28:31]
    v_exp_f32 v18, v126
    v_mfma_f32_16x16x32_bf16 a[76:79], v[32:35], v[68:71], a[76:79]
    ds_read_b128 v[28:31], v1 offset:21504
    v_add_f32 v8, v8, v16
    v_mfma_f32_16x16x32_bf16 a[76:79], v[36:39], v[76:79], a[76:79]
    s_waitcnt lgkmcnt(2)
    v_add_f32 v8, v8, v17
    v_exp_f32 v19, v127
    v_mfma_f32_16x16x32_bf16 a[32:35], v[40:43], v[64:67], a[32:35]
    ds_read_b128 v[32:35], v1 offset:10240
    v_cvt_pk_bf16_f32 v94, v16, v17
    v_mfma_f32_16x16x32_bf16 a[32:35], v[44:47], v[72:75], a[32:35]
    v_add_f32 v8, v8, v18
    v_add_f32 v8, v8, v19
    v_mfma_f32_16x16x32_bf16 a[80:83], v[40:43], v[68:71], a[80:83]
    ds_read_b128 v[36:39], v1 offset:22528
    v_cvt_pk_bf16_f32 v95, v18, v19
    v_mfma_f32_16x16x32_bf16 a[80:83], v[44:47], v[76:79], a[80:83]
    s_waitcnt lgkmcnt(2)
    v_mfma_f32_16x16x32_bf16 a[36:39], v[24:27], v[64:67], a[36:39]
    ds_read_b128 v[40:43], v1 offset:11264
    v_mfma_f32_16x16x32_bf16 a[36:39], v[28:31], v[72:75], a[36:39]
    v_mfma_f32_16x16x32_bf16 a[84:87], v[24:27], v[68:71], a[84:87]
    ds_read_b128 v[44:47], v1 offset:23552
    v_mfma_f32_16x16x32_bf16 a[84:87], v[28:31], v[76:79], a[84:87]
    s_waitcnt lgkmcnt(2)
    v_subrev_u32 v2, 98304, v2
    v_subrev_u32 v3, 98304, v3
    v_mfma_f32_16x16x32_bf16 a[40:43], v[32:35], v[64:67], a[40:43]
    ds_read_b128 v[24:27], v2 offset:0
    v_mfma_f32_16x16x32_bf16 a[40:43], v[36:39], v[72:75], a[40:43]
    v_mfma_f32_16x16x32_bf16 a[88:91], v[32:35], v[68:71], a[88:91]
    ds_read_b128 v[28:31], v3 offset:0
    v_mfma_f32_16x16x32_bf16 a[88:91], v[36:39], v[76:79], a[88:91]
    s_waitcnt lgkmcnt(2)
    v_mfma_f32_16x16x32_bf16 a[44:47], v[40:43], v[64:67], a[44:47]
    ds_read_b128 v[32:35], v2 offset:6144
    v_mfma_f32_16x16x32_bf16 a[44:47], v[44:47], v[72:75], a[44:47]
    v_mfma_f32_16x16x32_bf16 a[92:95], v[40:43], v[68:71], a[92:95]
    ds_read_b128 v[36:39], v3 offset:6144
    v_mfma_f32_16x16x32_bf16 a[92:95], v[44:47], v[76:79], a[92:95]
    s_waitcnt lgkmcnt(2)
    v_mfma_f32_16x16x32_bf16 v[160:163], v[24:27], a[240:243], v[136:139]
    ds_read_b128 v[40:43], v2 offset:128
    v_mfma_f32_16x16x32_bf16 v[160:163], v[28:31], a[244:247], v[160:163]
    v_mfma_f32_16x16x32_bf16 v[164:167], v[24:27], v[200:203], v[140:143]
    ds_read_b128 v[44:47], v3 offset:128
    v_mfma_f32_16x16x32_bf16 v[164:167], v[28:31], v[204:207], v[164:167]
    s_waitcnt lgkmcnt(2)
    v_mfma_f32_16x16x32_bf16 v[96:99], v[32:35], a[240:243], v[136:139]
    ds_read_b128 v[24:27], v2 offset:6272
    v_accvgpr_read_b32 v224, a0
    v_mfma_f32_16x16x32_bf16 v[96:99], v[36:39], a[244:247], v[96:99]
    v_accvgpr_read_b32 v225, a12
    v_accvgpr_read_b32 v226, a24
    v_accvgpr_read_b32 v227, a36
    v_accvgpr_read_b32 v228, a1
    v_accvgpr_read_b32 v229, a13
    v_accvgpr_read_b32 v230, a25
    v_accvgpr_read_b32 v231, a37
    v_mfma_f32_16x16x32_bf16 v[100:103], v[32:35], v[200:203], v[140:143]
    ds_read_b128 v[28:31], v3 offset:6272
    v_mul_f32 v224, v224, v48
    v_mfma_f32_16x16x32_bf16 v[100:103], v[36:39], v[204:207], v[100:103]
    s_waitcnt lgkmcnt(2)
    v_mul_f32 v225, v225, v48
    v_mul_f32 v226, v226, v48
    v_mul_f32 v227, v227, v48
    v_mul_f32 v228, v228, v48
    v_mul_f32 v229, v229, v48
    v_mul_f32 v230, v230, v48
    v_mul_f32 v231, v231, v48
    v_mfma_f32_16x16x32_bf16 v[160:163], v[40:43], a[248:251], v[160:163]
    ds_read_b128 v[32:35], v2 offset:256
    v_cvt_pk_bf16_f32 v224, v224, v225
    v_mfma_f32_16x16x32_bf16 v[160:163], v[44:47], a[252:255], v[160:163]
    v_cvt_pk_bf16_f32 v225, v226, v227
    v_cvt_pk_bf16_f32 v226, v228, v229
    v_cvt_pk_bf16_f32 v227, v230, v231
    v_accvgpr_read_b32 v232, a2
    v_accvgpr_read_b32 v233, a14
    v_accvgpr_read_b32 v234, a26
    v_accvgpr_read_b32 v235, a38
    v_accvgpr_read_b32 v236, a3
    v_mfma_f32_16x16x32_bf16 v[164:167], v[40:43], v[208:211], v[164:167]
    ds_read_b128 v[36:39], v3 offset:256
    v_accvgpr_read_b32 v237, a15
    v_mfma_f32_16x16x32_bf16 v[164:167], v[44:47], v[212:215], v[164:167]
    s_waitcnt lgkmcnt(2)
    v_accvgpr_read_b32 v238, a27
    v_accvgpr_read_b32 v239, a39
    v_mul_f32 v232, v232, v48
    v_mul_f32 v233, v233, v48
    v_mul_f32 v234, v234, v48
    v_mul_f32 v235, v235, v48
    v_mul_f32 v236, v236, v48
    v_mfma_f32_16x16x32_bf16 v[96:99], v[24:27], a[248:251], v[96:99]
    ds_read_b128 v[40:43], v2 offset:6400
    v_mul_f32 v237, v237, v48
    v_mfma_f32_16x16x32_bf16 v[96:99], v[28:31], a[252:255], v[96:99]
    v_mul_f32 v238, v238, v48
    v_mul_f32 v239, v239, v48
    v_cvt_pk_bf16_f32 v232, v232, v233
    v_cvt_pk_bf16_f32 v233, v234, v235
    v_cvt_pk_bf16_f32 v234, v236, v237
    v_cvt_pk_bf16_f32 v235, v238, v239
    s_not_b64 vcc, s[62:63]
    v_mfma_f32_16x16x32_bf16 v[100:103], v[24:27], v[208:211], v[100:103]
    ds_read_b128 v[44:47], v3 offset:6400
    v_cndmask_b32_dpp v148, v224, v232, vcc row_ror:8 row_mask:0xf bank_mask:0xf
    v_mfma_f32_16x16x32_bf16 v[100:103], v[28:31], v[212:215], v[100:103]
    s_waitcnt lgkmcnt(2)
    v_cndmask_b32_dpp v149, v225, v233, vcc row_ror:8 row_mask:0xf bank_mask:0xf
    v_cndmask_b32_dpp v150, v226, v234, vcc row_ror:8 row_mask:0xf bank_mask:0xf
    v_cndmask_b32_dpp v151, v227, v235, vcc row_ror:8 row_mask:0xf bank_mask:0xf
    s_mov_b64 vcc, s[62:63]
    v_cndmask_b32_dpp v144, v232, v224, vcc row_ror:8 row_mask:0xf bank_mask:0xf
    v_cndmask_b32_dpp v145, v233, v225, vcc row_ror:8 row_mask:0xf bank_mask:0xf
    v_cndmask_b32_dpp v146, v234, v226, vcc row_ror:8 row_mask:0xf bank_mask:0xf
    v_cndmask_b32_dpp v147, v235, v227, vcc row_ror:8 row_mask:0xf bank_mask:0xf
    v_mfma_f32_16x16x32_bf16 v[160:163], v[32:35], v[192:195], v[160:163]
    ds_read_b128 v[24:27], v2 offset:12288
    v_accvgpr_read_b32 v240, a4
    v_mfma_f32_16x16x32_bf16 v[160:163], v[36:39], v[196:199], v[160:163]
    v_accvgpr_read_b32 v241, a16
    v_accvgpr_read_b32 v242, a28
    v_accvgpr_read_b32 v243, a40
    v_accvgpr_read_b32 v244, a5
    v_accvgpr_read_b32 v245, a17
    v_accvgpr_read_b32 v246, a29
    v_accvgpr_read_b32 v247, a41
    v_mfma_f32_16x16x32_bf16 v[164:167], v[32:35], v[216:219], v[164:167]
    ds_read_b128 v[28:31], v3 offset:12288
    v_mfma_f32_16x16x32_bf16 v[164:167], v[36:39], v[220:223], v[164:167]
    s_waitcnt lgkmcnt(2)
    buffer_store_dwordx4 v[148:151], v56, s[12:15], s24 offen offset:3072 sc0 sc1
    v_mul_f32 v240, v240, v48
    v_mul_f32 v241, v241, v48
    v_mfma_f32_16x16x32_bf16 v[96:99], v[40:43], v[192:195], v[96:99]
    ds_read_b128 v[32:35], v2 offset:18432
    v_mul_f32 v242, v242, v48
    v_mfma_f32_16x16x32_bf16 v[96:99], v[44:47], v[196:199], v[96:99]
    v_mul_f32 v243, v243, v48
    v_mul_f32 v244, v244, v48
    v_mul_f32 v245, v245, v48
    v_mul_f32 v246, v246, v48
    v_mul_f32 v247, v247, v48
    v_cvt_pk_bf16_f32 v240, v240, v241
    v_cvt_pk_bf16_f32 v241, v242, v243
    v_cvt_pk_bf16_f32 v242, v244, v245
    v_mfma_f32_16x16x32_bf16 v[100:103], v[40:43], v[216:219], v[100:103]
    ds_read_b128 v[36:39], v3 offset:18432
    v_cvt_pk_bf16_f32 v243, v246, v247
    v_mfma_f32_16x16x32_bf16 v[100:103], v[44:47], v[220:223], v[100:103]
    s_waitcnt lgkmcnt(2)
    v_accvgpr_read_b32 v248, a6
    v_accvgpr_read_b32 v249, a18
    v_accvgpr_read_b32 v250, a30
    v_accvgpr_read_b32 v251, a42
    v_accvgpr_read_b32 v252, a7
    v_accvgpr_read_b32 v253, a19
    v_accvgpr_read_b32 v254, a31
    v_mfma_f32_16x16x32_bf16 v[168:171], v[24:27], a[240:243], v[136:139]
    ds_read_b128 v[40:43], v2 offset:12416
    v_accvgpr_read_b32 v255, a43
    v_mfma_f32_16x16x32_bf16 v[168:171], v[28:31], a[244:247], v[168:171]
    buffer_store_dwordx4 v[144:147], v56, s[12:15], s24 offen offset:0 sc0 sc1
    v_mul_f32 v248, v248, v48
    v_mul_f32 v249, v249, v48
    v_mfma_f32_16x16x32_bf16 v[172:175], v[24:27], v[200:203], v[140:143]
    ds_read_b128 v[44:47], v3 offset:12416
    v_mul_f32 v250, v250, v48
    v_mfma_f32_16x16x32_bf16 v[172:175], v[28:31], v[204:207], v[172:175]
    s_waitcnt lgkmcnt(2)
    v_mul_f32 v251, v251, v48
    v_mul_f32 v252, v252, v48
    v_mul_f32 v253, v253, v48
    v_mul_f32 v254, v254, v48
    v_mul_f32 v255, v255, v48
    v_cvt_pk_bf16_f32 v248, v248, v249
    v_cvt_pk_bf16_f32 v249, v250, v251
    v_cvt_pk_bf16_f32 v250, v252, v253
    v_mfma_f32_16x16x32_bf16 v[104:107], v[32:35], a[240:243], v[136:139]
    ds_read_b128 v[24:27], v2 offset:18560
    v_cvt_pk_bf16_f32 v251, v254, v255
    v_mfma_f32_16x16x32_bf16 v[104:107], v[36:39], a[244:247], v[104:107]
    s_not_b64 vcc, s[62:63]
    v_cndmask_b32_dpp v156, v240, v248, vcc row_ror:8 row_mask:0xf bank_mask:0xf
    v_cndmask_b32_dpp v157, v241, v249, vcc row_ror:8 row_mask:0xf bank_mask:0xf
    v_cndmask_b32_dpp v158, v242, v250, vcc row_ror:8 row_mask:0xf bank_mask:0xf
    v_cndmask_b32_dpp v159, v243, v251, vcc row_ror:8 row_mask:0xf bank_mask:0xf
    s_mov_b64 vcc, s[62:63]
    v_cndmask_b32_dpp v152, v248, v240, vcc row_ror:8 row_mask:0xf bank_mask:0xf
    v_cndmask_b32_dpp v153, v249, v241, vcc row_ror:8 row_mask:0xf bank_mask:0xf
    v_mfma_f32_16x16x32_bf16 v[108:111], v[32:35], v[200:203], v[140:143]
    ds_read_b128 v[28:31], v3 offset:18560
    v_cndmask_b32_dpp v154, v250, v242, vcc row_ror:8 row_mask:0xf bank_mask:0xf
    v_mfma_f32_16x16x32_bf16 v[108:111], v[36:39], v[204:207], v[108:111]
    s_waitcnt lgkmcnt(2)
    v_cndmask_b32_dpp v155, v251, v243, vcc row_ror:8 row_mask:0xf bank_mask:0xf
    v_accvgpr_read_b32 v224, a8
    v_accvgpr_read_b32 v225, a20
    v_accvgpr_read_b32 v226, a32
    v_accvgpr_read_b32 v227, a44
    v_accvgpr_read_b32 v228, a9
    v_accvgpr_read_b32 v229, a21
    v_mfma_f32_16x16x32_bf16 v[168:171], v[40:43], a[248:251], v[168:171]
    ds_read_b128 v[32:35], v2 offset:12544
    v_accvgpr_read_b32 v230, a33
    v_mfma_f32_16x16x32_bf16 v[168:171], v[44:47], a[252:255], v[168:171]
    v_accvgpr_read_b32 v231, a45
    v_exp_f32 v16, v160
    v_exp_f32 v17, v161
    v_exp_f32 v18, v162
    v_add_f32 v7, v7, v16
    v_mfma_f32_16x16x32_bf16 v[172:175], v[40:43], v[208:211], v[172:175]
    ds_read_b128 v[36:39], v3 offset:12544
    v_add_f32 v7, v7, v17
    v_mfma_f32_16x16x32_bf16 v[172:175], v[44:47], v[212:215], v[172:175]
    s_waitcnt lgkmcnt(2)
    buffer_store_dwordx4 v[156:159], v56, s[12:15], s24 offen offset:3200 sc0 sc1
    v_mul_f32 v224, v224, v48
    v_mul_f32 v225, v225, v48
    v_mfma_f32_16x16x32_bf16 v[104:107], v[24:27], a[248:251], v[104:107]
    ds_read_b128 v[40:43], v2 offset:18688
    v_mul_f32 v226, v226, v48
    v_mfma_f32_16x16x32_bf16 v[104:107], v[28:31], a[252:255], v[104:107]
    v_mul_f32 v227, v227, v48
    v_mul_f32 v228, v228, v48
    v_mul_f32 v229, v229, v48
    v_mul_f32 v230, v230, v48
    v_mul_f32 v231, v231, v48
    v_cvt_pk_bf16_f32 v224, v224, v225
    v_cvt_pk_bf16_f32 v225, v226, v227
    v_mfma_f32_16x16x32_bf16 v[108:111], v[24:27], v[208:211], v[108:111]
    ds_read_b128 v[44:47], v3 offset:18688
    v_cvt_pk_bf16_f32 v226, v228, v229
    v_mfma_f32_16x16x32_bf16 v[108:111], v[28:31], v[212:215], v[108:111]
    s_waitcnt lgkmcnt(2)
    v_add_u32 v2, 49152, v2
    v_add_u32 v3, 49152, v3
    v_cvt_pk_bf16_f32 v227, v230, v231
    v_accvgpr_read_b32 v232, a10
    v_accvgpr_read_b32 v233, a22
    v_accvgpr_read_b32 v234, a34
    v_accvgpr_read_b32 v235, a46
    v_accvgpr_read_b32 v236, a11
    v_mfma_f32_16x16x32_bf16 v[168:171], v[32:35], v[192:195], v[168:171]
    ds_read_b128 v[24:27], v2 offset:0
    v_accvgpr_read_b32 v237, a23
    v_mfma_f32_16x16x32_bf16 v[168:171], v[36:39], v[196:199], v[168:171]
    v_accvgpr_read_b32 v238, a35
    v_accvgpr_read_b32 v239, a47
    v_exp_f32 v19, v163
    v_cvt_pk_bf16_f32 v160, v16, v17
    v_exp_f32 v16, v96
    v_mfma_f32_16x16x32_bf16 v[172:175], v[32:35], v[216:219], v[172:175]
    ds_read_b128 v[28:31], v3 offset:0
    v_add_f32 v7, v7, v18
    v_mfma_f32_16x16x32_bf16 v[172:175], v[36:39], v[220:223], v[172:175]
    s_waitcnt lgkmcnt(2)
    buffer_store_dwordx4 v[152:155], v56, s[12:15], s24 offen offset:128 sc0 sc1
    v_mul_f32 v232, v232, v48
    v_mul_f32 v233, v233, v48
    v_mfma_f32_16x16x32_bf16 v[104:107], v[40:43], v[192:195], v[104:107]
    ds_read_b128 v[32:35], v2 offset:6144
    v_mul_f32 v234, v234, v48
    v_mfma_f32_16x16x32_bf16 v[104:107], v[44:47], v[196:199], v[104:107]
    v_mul_f32 v235, v235, v48
    v_mul_f32 v236, v236, v48
    v_mul_f32 v237, v237, v48
    v_mul_f32 v238, v238, v48
    v_mul_f32 v239, v239, v48
    v_cvt_pk_bf16_f32 v232, v232, v233
    v_cvt_pk_bf16_f32 v233, v234, v235
    v_cvt_pk_bf16_f32 v234, v236, v237
    v_mfma_f32_16x16x32_bf16 v[108:111], v[40:43], v[216:219], v[108:111]
    ds_read_b128 v[36:39], v3 offset:6144
    v_cvt_pk_bf16_f32 v235, v238, v239
    v_mfma_f32_16x16x32_bf16 v[108:111], v[44:47], v[220:223], v[108:111]
    s_waitcnt lgkmcnt(2)
    s_not_b64 vcc, s[62:63]
    v_cndmask_b32_dpp v132, v224, v232, vcc row_ror:8 row_mask:0xf bank_mask:0xf
    v_cndmask_b32_dpp v133, v225, v233, vcc row_ror:8 row_mask:0xf bank_mask:0xf
    v_cndmask_b32_dpp v134, v226, v234, vcc row_ror:8 row_mask:0xf bank_mask:0xf
    v_cndmask_b32_dpp v135, v227, v235, vcc row_ror:8 row_mask:0xf bank_mask:0xf
    s_mov_b64 vcc, s[62:63]
    v_cndmask_b32_dpp v128, v232, v224, vcc row_ror:8 row_mask:0xf bank_mask:0xf
    v_mfma_f32_16x16x32_bf16 v[176:179], v[24:27], a[240:243], v[136:139]
    ds_read_b128 v[40:43], v2 offset:128
    v_cndmask_b32_dpp v129, v233, v225, vcc row_ror:8 row_mask:0xf bank_mask:0xf
    v_mfma_f32_16x16x32_bf16 v[176:179], v[28:31], a[244:247], v[176:179]
    v_cndmask_b32_dpp v130, v234, v226, vcc row_ror:8 row_mask:0xf bank_mask:0xf
    v_cndmask_b32_dpp v131, v235, v227, vcc row_ror:8 row_mask:0xf bank_mask:0xf
    v_accvgpr_read_b32 v240, a48
    v_accvgpr_read_b32 v241, a60
    v_accvgpr_read_b32 v242, a72
    v_accvgpr_read_b32 v243, a84
    v_accvgpr_read_b32 v244, a49
    v_mfma_f32_16x16x32_bf16 v[180:183], v[24:27], v[200:203], v[140:143]
    ds_read_b128 v[44:47], v3 offset:128
    v_accvgpr_read_b32 v245, a61
    v_mfma_f32_16x16x32_bf16 v[180:183], v[28:31], v[204:207], v[180:183]
    s_waitcnt lgkmcnt(2)
    v_accvgpr_read_b32 v246, a73
    v_accvgpr_read_b32 v247, a85
    v_add_f32 v7, v7, v19
    v_exp_f32 v17, v97
    v_cvt_pk_bf16_f32 v161, v18, v19
    v_exp_f32 v18, v98
    v_mfma_f32_16x16x32_bf16 v[112:115], v[32:35], a[240:243], v[136:139]
    ds_read_b128 v[24:27], v2 offset:6272
    v_add_f32 v7, v7, v16
    v_mfma_f32_16x16x32_bf16 v[112:115], v[36:39], a[244:247], v[112:115]
    buffer_store_dwordx4 v[132:135], v56, s[12:15], s24 offen offset:3328 sc0 sc1
    v_mul_f32 v240, v240, v50
    v_mul_f32 v241, v241, v50
    v_mfma_f32_16x16x32_bf16 v[116:119], v[32:35], v[200:203], v[140:143]
    ds_read_b128 v[28:31], v3 offset:6272
    v_mul_f32 v242, v242, v50
    v_mfma_f32_16x16x32_bf16 v[116:119], v[36:39], v[204:207], v[116:119]
    s_waitcnt lgkmcnt(2)
    v_mul_f32 v243, v243, v50
    v_mul_f32 v244, v244, v50
    v_mul_f32 v245, v245, v50
    v_mul_f32 v246, v246, v50
    v_mul_f32 v247, v247, v50
    v_cvt_pk_bf16_f32 v240, v240, v241
    v_cvt_pk_bf16_f32 v241, v242, v243
    v_mfma_f32_16x16x32_bf16 v[176:179], v[40:43], a[248:251], v[176:179]
    ds_read_b128 v[32:35], v2 offset:256
    v_cvt_pk_bf16_f32 v242, v244, v245
    v_mfma_f32_16x16x32_bf16 v[176:179], v[44:47], a[252:255], v[176:179]
    v_cvt_pk_bf16_f32 v243, v246, v247
    v_accvgpr_read_b32 v248, a50
    v_add_f32 v7, v7, v17
    v_accvgpr_read_b32 v249, a62
    v_exp_f32 v19, v99
    v_accvgpr_read_b32 v250, a74
    v_accvgpr_read_b32 v251, a86
    v_mfma_f32_16x16x32_bf16 v[180:183], v[40:43], v[208:211], v[180:183]
    ds_read_b128 v[36:39], v3 offset:256
    v_accvgpr_read_b32 v252, a51
    v_mfma_f32_16x16x32_bf16 v[180:183], v[44:47], v[212:215], v[180:183]
    s_waitcnt lgkmcnt(2)
    v_cvt_pk_bf16_f32 v162, v16, v17
    v_exp_f32 v16, v164
    v_accvgpr_read_b32 v253, a63
    v_accvgpr_read_b32 v254, a75
    v_accvgpr_read_b32 v255, a87
    v_add_f32 v7, v7, v18
    v_mfma_f32_16x16x32_bf16 v[112:115], v[24:27], a[248:251], v[112:115]
    ds_read_b128 v[40:43], v2 offset:6400
    v_add_f32 v7, v7, v19
    v_mfma_f32_16x16x32_bf16 v[112:115], v[28:31], a[252:255], v[112:115]
    buffer_store_dwordx4 v[128:131], v56, s[12:15], s24 offen offset:256 sc0 sc1
    v_exp_f32 v17, v165
    v_mfma_f32_16x16x32_bf16 v[116:119], v[24:27], v[208:211], v[116:119]
    ds_read_b128 v[44:47], v3 offset:6400
    v_cvt_pk_bf16_f32 v163, v18, v19
    v_mfma_f32_16x16x32_bf16 v[116:119], v[28:31], v[212:215], v[116:119]
    s_waitcnt lgkmcnt(2)
    v_exp_f32 v18, v166
    v_mul_f32 v248, v248, v50
    v_mul_f32 v249, v249, v50
    v_mul_f32 v250, v250, v50
    v_add_f32 v8, v8, v16
    v_mul_f32 v251, v251, v50
    v_mul_f32 v252, v252, v50
    v_mfma_f32_16x16x32_bf16 v[176:179], v[32:35], v[192:195], v[176:179]
    ds_read_b128 v[24:27], v2 offset:12288
    v_add_f32 v8, v8, v17
    v_mfma_f32_16x16x32_bf16 v[176:179], v[36:39], v[196:199], v[176:179]
    v_exp_f32 v19, v167
    v_mul_f32 v253, v253, v50
    v_mul_f32 v254, v254, v50
    v_mul_f32 v255, v255, v50
    v_cvt_pk_bf16_f32 v164, v16, v17
    v_cvt_pk_bf16_f32 v248, v248, v249
    v_mfma_f32_16x16x32_bf16 v[180:183], v[32:35], v[216:219], v[180:183]
    ds_read_b128 v[28:31], v3 offset:12288
    v_cvt_pk_bf16_f32 v249, v250, v251
    v_mfma_f32_16x16x32_bf16 v[180:183], v[36:39], v[220:223], v[180:183]
    s_waitcnt lgkmcnt(2)
    v_exp_f32 v16, v100
    v_add_f32 v8, v8, v18
    v_cvt_pk_bf16_f32 v250, v252, v253
    v_cvt_pk_bf16_f32 v251, v254, v255
    v_add_f32 v8, v8, v19
    s_not_b64 vcc, s[62:63]
    v_mfma_f32_16x16x32_bf16 v[112:115], v[40:43], v[192:195], v[112:115]
    ds_read_b128 v[32:35], v2 offset:18432
    v_cndmask_b32_dpp v148, v240, v248, vcc row_ror:8 row_mask:0xf bank_mask:0xf
    v_mfma_f32_16x16x32_bf16 v[112:115], v[44:47], v[196:199], v[112:115]
    v_exp_f32 v17, v101
    v_cndmask_b32_dpp v149, v241, v249, vcc row_ror:8 row_mask:0xf bank_mask:0xf
    v_cvt_pk_bf16_f32 v165, v18, v19
    v_cndmask_b32_dpp v150, v242, v250, vcc row_ror:8 row_mask:0xf bank_mask:0xf
    v_cndmask_b32_dpp v151, v243, v251, vcc row_ror:8 row_mask:0xf bank_mask:0xf
    v_exp_f32 v18, v102
    v_mfma_f32_16x16x32_bf16 v[116:119], v[40:43], v[216:219], v[116:119]
    s_mov_b64 vcc, s[62:63]
    ds_read_b128 v[36:39], v3 offset:18432
    v_cndmask_b32_dpp v144, v248, v240, vcc row_ror:8 row_mask:0xf bank_mask:0xf
    v_mfma_f32_16x16x32_bf16 v[116:119], v[44:47], v[220:223], v[116:119]
    s_waitcnt lgkmcnt(2)
    v_add_f32 v8, v8, v16
    v_cndmask_b32_dpp v145, v249, v241, vcc row_ror:8 row_mask:0xf bank_mask:0xf
    v_add_f32 v8, v8, v17
    v_cndmask_b32_dpp v146, v250, v242, vcc row_ror:8 row_mask:0xf bank_mask:0xf
    v_cndmask_b32_dpp v147, v251, v243, vcc row_ror:8 row_mask:0xf bank_mask:0xf
    v_exp_f32 v19, v103
    v_mfma_f32_16x16x32_bf16 v[184:187], v[24:27], a[240:243], v[136:139]
    ds_read_b128 v[40:43], v2 offset:12416
    v_accvgpr_read_b32 v224, a52
    v_mfma_f32_16x16x32_bf16 v[184:187], v[28:31], a[244:247], v[184:187]
    v_cvt_pk_bf16_f32 v166, v16, v17
    v_accvgpr_read_b32 v225, a64
    v_accvgpr_read_b32 v226, a76
    v_add_f32 v8, v8, v18
    v_accvgpr_read_b32 v227, a88
    v_accvgpr_read_b32 v228, a53
    v_add_f32 v8, v8, v19
    v_mfma_f32_16x16x32_bf16 v[188:191], v[24:27], v[200:203], v[140:143]
    ds_read_b128 v[44:47], v3 offset:12416
    v_cvt_pk_bf16_f32 v167, v18, v19
    v_mfma_f32_16x16x32_bf16 v[188:191], v[28:31], v[204:207], v[188:191]
    s_waitcnt lgkmcnt(2)
    v_accvgpr_read_b32 v229, a65
    v_exp_f32 v16, v168
    v_accvgpr_read_b32 v230, a77
    v_accvgpr_read_b32 v231, a89
    v_exp_f32 v17, v169
    v_mfma_f32_16x16x32_bf16 v[120:123], v[32:35], a[240:243], v[136:139]
    ds_read_b128 v[24:27], v2 offset:18560
    v_mfma_f32_16x16x32_bf16 v[120:123], v[36:39], a[244:247], v[120:123]
    buffer_store_dwordx4 v[148:151], v56, s[12:15], s40 offen offset:3072 sc0 sc1
    v_exp_f32 v18, v170
    v_mul_f32 v224, v224, v50
    v_mfma_f32_16x16x32_bf16 v[124:127], v[32:35], v[200:203], v[140:143]
    ds_read_b128 v[28:31], v3 offset:18560
    v_add_f32 v7, v7, v16
    v_mfma_f32_16x16x32_bf16 v[124:127], v[36:39], v[204:207], v[124:127]
    s_waitcnt lgkmcnt(2)
    v_add_f32 v7, v7, v17
    v_mul_f32 v225, v225, v50
    v_mul_f32 v226, v226, v50
    v_exp_f32 v19, v171
    v_mul_f32 v227, v227, v50
    v_mul_f32 v228, v228, v50
    v_mul_f32 v229, v229, v50
    v_mfma_f32_16x16x32_bf16 v[184:187], v[40:43], a[248:251], v[184:187]
    ds_read_b128 v[32:35], v2 offset:12544
    v_cvt_pk_bf16_f32 v168, v16, v17
    v_mfma_f32_16x16x32_bf16 v[184:187], v[44:47], a[252:255], v[184:187]
    v_exp_f32 v16, v104
    v_mul_f32 v230, v230, v50
    v_mul_f32 v231, v231, v50
    v_cvt_pk_bf16_f32 v224, v224, v225
    v_cvt_pk_bf16_f32 v225, v226, v227
    v_cvt_pk_bf16_f32 v226, v228, v229
    v_mfma_f32_16x16x32_bf16 v[188:191], v[40:43], v[208:211], v[188:191]
    ds_read_b128 v[36:39], v3 offset:12544
    v_add_f32 v7, v7, v18
    v_mfma_f32_16x16x32_bf16 v[188:191], v[44:47], v[212:215], v[188:191]
    s_waitcnt lgkmcnt(2)
    v_add_f32 v7, v7, v19
    v_exp_f32 v17, v105
    v_cvt_pk_bf16_f32 v227, v230, v231
    v_accvgpr_read_b32 v232, a54
    v_accvgpr_read_b32 v233, a66
    v_accvgpr_read_b32 v234, a78
    v_mfma_f32_16x16x32_bf16 v[120:123], v[24:27], a[248:251], v[120:123]
    ds_read_b128 v[40:43], v2 offset:18688
    v_cvt_pk_bf16_f32 v169, v18, v19
    v_mfma_f32_16x16x32_bf16 v[120:123], v[28:31], a[252:255], v[120:123]
    v_exp_f32 v18, v106
    v_accvgpr_read_b32 v235, a90
    v_accvgpr_read_b32 v236, a55
    v_accvgpr_read_b32 v237, a67
    v_accvgpr_read_b32 v238, a79
    v_accvgpr_read_b32 v239, a91
    v_add_f32 v7, v7, v16
    v_mfma_f32_16x16x32_bf16 v[124:127], v[24:27], v[208:211], v[124:127]
    ds_read_b128 v[44:47], v3 offset:18688
    v_add_f32 v7, v7, v17
    v_mfma_f32_16x16x32_bf16 v[124:127], v[28:31], v[212:215], v[124:127]
    s_waitcnt lgkmcnt(2)
    v_add_u32 v22, 49152, v1
    v_mov_b32 v14, v1
    v_subrev_u32 v1, 49152, v1
    v_exp_f32 v19, v107
    v_cvt_pk_bf16_f32 v170, v16, v17
    v_mfma_f32_16x16x32_bf16 v[184:187], v[32:35], v[192:195], v[184:187]
    ds_read_b128 v[24:27], v22 offset:0
    v_mfma_f32_16x16x32_bf16 v[184:187], v[36:39], v[196:199], v[184:187]
    buffer_store_dwordx4 v[144:147], v56, s[12:15], s40 offen offset:0 sc0 sc1
    v_exp_f32 v16, v172
    v_mul_f32 v232, v232, v50
    v_mfma_f32_16x16x32_bf16 v[188:191], v[32:35], v[216:219], v[188:191]
    ds_read_b128 v[28:31], v22 offset:12288
    v_add_f32 v7, v7, v18
    v_mfma_f32_16x16x32_bf16 v[188:191], v[36:39], v[220:223], v[188:191]
    s_waitcnt lgkmcnt(2)
    v_add_f32 v7, v7, v19
    v_mul_f32 v233, v233, v50
    v_mul_f32 v234, v234, v50
    v_mul_f32 v235, v235, v50
    v_exp_f32 v17, v173
    v_mul_f32 v236, v236, v50
    v_mul_f32 v237, v237, v50
    v_mfma_f32_16x16x32_bf16 v[120:123], v[40:43], v[192:195], v[120:123]
    ds_read_b128 v[32:35], v22 offset:3072
    v_mul_f32 v238, v238, v50
    v_mfma_f32_16x16x32_bf16 v[120:123], v[44:47], v[196:199], v[120:123]
    v_cvt_pk_bf16_f32 v171, v18, v19
    v_mul_f32 v239, v239, v50
    v_exp_f32 v18, v174
    v_cvt_pk_bf16_f32 v232, v232, v233
    v_cvt_pk_bf16_f32 v233, v234, v235
    v_cvt_pk_bf16_f32 v234, v236, v237
    v_mfma_f32_16x16x32_bf16 v[124:127], v[40:43], v[216:219], v[124:127]
    ds_read_b128 v[36:39], v22 offset:15360
    v_add_f32 v8, v8, v16
    v_mfma_f32_16x16x32_bf16 v[124:127], v[44:47], v[220:223], v[124:127]
    s_waitcnt lgkmcnt(2)
    v_add_f32 v8, v8, v17
    v_cvt_pk_bf16_f32 v235, v238, v239
    s_not_b64 vcc, s[62:63]
    v_cndmask_b32_dpp v156, v224, v232, vcc row_ror:8 row_mask:0xf bank_mask:0xf
    v_cndmask_b32_dpp v157, v225, v233, vcc row_ror:8 row_mask:0xf bank_mask:0xf
    v_exp_f32 v19, v175
    v_mfma_f32_16x16x32_bf16 a[96:99], v[24:27], v[80:83], a[96:99]
    ds_read_b128 v[40:43], v22 offset:6144
    v_cndmask_b32_dpp v158, v226, v234, vcc row_ror:8 row_mask:0xf bank_mask:0xf
    v_mfma_f32_16x16x32_bf16 a[96:99], v[28:31], v[88:91], a[96:99]
    v_cvt_pk_bf16_f32 v172, v16, v17
    v_cndmask_b32_dpp v159, v227, v235, vcc row_ror:8 row_mask:0xf bank_mask:0xf
    s_mov_b64 vcc, s[62:63]
    v_cndmask_b32_dpp v152, v232, v224, vcc row_ror:8 row_mask:0xf bank_mask:0xf
    v_exp_f32 v16, v108
    v_cndmask_b32_dpp v153, v233, v225, vcc row_ror:8 row_mask:0xf bank_mask:0xf
    v_cndmask_b32_dpp v154, v234, v226, vcc row_ror:8 row_mask:0xf bank_mask:0xf
    v_mfma_f32_16x16x32_bf16 a[144:147], v[24:27], v[84:87], a[144:147]
    ds_read_b128 v[44:47], v22 offset:18432
    v_cndmask_b32_dpp v155, v235, v227, vcc row_ror:8 row_mask:0xf bank_mask:0xf
    v_mfma_f32_16x16x32_bf16 a[144:147], v[28:31], v[92:95], a[144:147]
    s_waitcnt lgkmcnt(2)
    v_add_f32 v8, v8, v18
    v_accvgpr_read_b32 v240, a56
    v_accvgpr_read_b32 v241, a68
    v_add_f32 v8, v8, v19
    v_accvgpr_read_b32 v242, a80
    v_accvgpr_read_b32 v243, a92
    v_accvgpr_read_b32 v244, a57
    v_mfma_f32_16x16x32_bf16 a[108:111], v[32:35], v[80:83], a[108:111]
    ds_read_b128 v[24:27], v22 offset:9216
    v_accvgpr_read_b32 v245, a69
    v_mfma_f32_16x16x32_bf16 a[108:111], v[36:39], v[88:91], a[108:111]
    v_exp_f32 v17, v109
    v_accvgpr_read_b32 v246, a81
    v_cvt_pk_bf16_f32 v173, v18, v19
    v_accvgpr_read_b32 v247, a93
    v_exp_f32 v18, v110
    v_mfma_f32_16x16x32_bf16 a[156:159], v[32:35], v[84:87], a[156:159]
    ds_read_b128 v[28:31], v22 offset:21504
    v_add_f32 v8, v8, v16
    v_mfma_f32_16x16x32_bf16 a[156:159], v[36:39], v[92:95], a[156:159]
    s_waitcnt lgkmcnt(2)
    buffer_store_dwordx4 v[156:159], v56, s[12:15], s40 offen offset:3200 sc0 sc1
    v_mul_f32 v240, v240, v50
    v_mul_f32 v241, v241, v50
    v_mul_f32 v242, v242, v50
    v_mfma_f32_16x16x32_bf16 a[120:123], v[40:43], v[80:83], a[120:123]
    ds_read_b128 v[32:35], v1 offset:0
    v_add_f32 v8, v8, v17
    v_mfma_f32_16x16x32_bf16 a[120:123], v[44:47], v[88:91], a[120:123]
    v_exp_f32 v19, v111
    v_mul_f32 v243, v243, v50
    v_mul_f32 v244, v244, v50
    v_mul_f32 v245, v245, v50
    v_mul_f32 v246, v246, v50
    v_mul_f32 v247, v247, v50
    v_mfma_f32_16x16x32_bf16 a[168:171], v[40:43], v[84:87], a[168:171]
    ds_read_b128 v[36:39], v1 offset:12288
    v_cvt_pk_bf16_f32 v240, v240, v241
    v_mfma_f32_16x16x32_bf16 a[168:171], v[44:47], v[92:95], a[168:171]
    s_waitcnt lgkmcnt(2)
    v_cvt_pk_bf16_f32 v174, v16, v17
    v_cvt_pk_bf16_f32 v241, v242, v243
    v_cvt_pk_bf16_f32 v242, v244, v245
    v_add_f32 v8, v8, v18
    v_cvt_pk_bf16_f32 v243, v246, v247
    v_accvgpr_read_b32 v248, a58
    v_accvgpr_read_b32 v249, a70
    v_mfma_f32_16x16x32_bf16 a[132:135], v[24:27], v[80:83], a[132:135]
    ds_read_b128 v[40:43], v1 offset:3072
    v_add_f32 v8, v8, v19
    v_mfma_f32_16x16x32_bf16 a[132:135], v[28:31], v[88:91], a[132:135]
    v_cvt_pk_bf16_f32 v175, v18, v19
    v_exp_f32 v16, v176
    v_exp_f32 v17, v177
    v_exp_f32 v18, v178
    v_add_f32 v7, v7, v16
    v_mfma_f32_16x16x32_bf16 a[180:183], v[24:27], v[84:87], a[180:183]
    ds_read_b128 v[44:47], v1 offset:15360
    v_add_f32 v7, v7, v17
    v_mfma_f32_16x16x32_bf16 a[180:183], v[28:31], v[92:95], a[180:183]
    s_waitcnt lgkmcnt(2)
    v_exp_f32 v19, v179
    v_cvt_pk_bf16_f32 v176, v16, v17
    v_exp_f32 v16, v112
    v_add_f32 v7, v7, v18
    v_add_f32 v7, v7, v19
    v_mfma_f32_16x16x32_bf16 a[96:99], v[32:35], v[160:163], a[96:99]
    ds_read_b128 v[24:27], v1 offset:6144
    v_accvgpr_read_b32 v250, a82
    v_mfma_f32_16x16x32_bf16 a[96:99], v[36:39], v[168:171], a[96:99]
    v_exp_f32 v17, v113
    v_cvt_pk_bf16_f32 v177, v18, v19
    v_exp_f32 v18, v114
    v_add_f32 v7, v7, v16
    v_add_f32 v7, v7, v17
    v_mfma_f32_16x16x32_bf16 a[144:147], v[32:35], v[164:167], a[144:147]
    ds_read_b128 v[28:31], v1 offset:18432
    v_accvgpr_read_b32 v251, a94
    v_mfma_f32_16x16x32_bf16 a[144:147], v[36:39], v[172:175], a[144:147]
    s_waitcnt lgkmcnt(2)
    v_exp_f32 v19, v115
    v_cvt_pk_bf16_f32 v178, v16, v17
    v_exp_f32 v16, v180
    v_add_f32 v7, v7, v18
    v_add_f32 v7, v7, v19
    v_accvgpr_read_b32 v252, a59
    v_mfma_f32_16x16x32_bf16 a[108:111], v[40:43], v[160:163], a[108:111]
    ds_read_b128 v[32:35], v1 offset:9216
    v_accvgpr_read_b32 v253, a71
    v_mfma_f32_16x16x32_bf16 a[108:111], v[44:47], v[168:171], a[108:111]
    v_exp_f32 v17, v181
    v_cvt_pk_bf16_f32 v179, v18, v19
    v_exp_f32 v18, v182
    v_add_f32 v8, v8, v16
    v_add_f32 v8, v8, v17
    v_mfma_f32_16x16x32_bf16 a[156:159], v[40:43], v[164:167], a[156:159]
    ds_read_b128 v[36:39], v1 offset:21504
    v_accvgpr_read_b32 v254, a83
    v_mfma_f32_16x16x32_bf16 a[156:159], v[44:47], v[172:175], a[156:159]
    s_waitcnt lgkmcnt(2)
    v_exp_f32 v19, v183
    v_cvt_pk_bf16_f32 v180, v16, v17
    v_exp_f32 v16, v116
    v_add_f32 v8, v8, v18
    v_add_f32 v8, v8, v19
    v_mfma_f32_16x16x32_bf16 a[120:123], v[24:27], v[160:163], a[120:123]
    ds_read_b128 v[40:43], v14 offset:0
    v_accvgpr_read_b32 v255, a95
    v_mfma_f32_16x16x32_bf16 a[120:123], v[28:31], v[168:171], a[120:123]
    buffer_store_dwordx4 v[152:155], v56, s[12:15], s40 offen offset:128 sc0 sc1
    v_exp_f32 v17, v117
    v_cvt_pk_bf16_f32 v181, v18, v19
    v_mfma_f32_16x16x32_bf16 a[168:171], v[24:27], v[164:167], a[168:171]
    ds_read_b128 v[44:47], v14 offset:12288
    v_mul_f32 v248, v248, v50
    v_mfma_f32_16x16x32_bf16 a[168:171], v[28:31], v[172:175], a[168:171]
    s_waitcnt lgkmcnt(2)
    v_exp_f32 v18, v118
    v_add_f32 v8, v8, v16
    v_add_f32 v8, v8, v17
    v_exp_f32 v19, v119
    v_cvt_pk_bf16_f32 v182, v16, v17
    v_mfma_f32_16x16x32_bf16 a[132:135], v[32:35], v[160:163], a[132:135]
    ds_read_b128 v[24:27], v14 offset:3072
    v_add_f32 v8, v8, v18
    v_mfma_f32_16x16x32_bf16 a[132:135], v[36:39], v[168:171], a[132:135]
    v_add_f32 v8, v8, v19
    v_cvt_pk_bf16_f32 v183, v18, v19
    v_exp_f32 v16, v184
    v_exp_f32 v17, v185
    v_exp_f32 v18, v186
    v_add_f32 v7, v7, v16
    v_add_f32 v7, v7, v17
    v_exp_f32 v19, v187
    v_cvt_pk_bf16_f32 v184, v16, v17
    v_exp_f32 v16, v120
    v_add_f32 v7, v7, v18
    v_add_f32 v7, v7, v19
    v_exp_f32 v17, v121
    v_cvt_pk_bf16_f32 v185, v18, v19
    v_exp_f32 v18, v122
    v_add_f32 v7, v7, v16
    v_add_f32 v7, v7, v17
    v_exp_f32 v19, v123
    v_cvt_pk_bf16_f32 v186, v16, v17
    v_exp_f32 v16, v188
    v_add_f32 v7, v7, v18
    v_add_f32 v7, v7, v19
    v_exp_f32 v17, v189
    v_cvt_pk_bf16_f32 v187, v18, v19
    v_exp_f32 v18, v190
    v_add_f32 v8, v8, v16
    v_add_f32 v8, v8, v17
    v_exp_f32 v19, v191
    v_cvt_pk_bf16_f32 v188, v16, v17
    v_exp_f32 v16, v124
    v_add_f32 v8, v8, v18
    v_add_f32 v8, v8, v19
    v_exp_f32 v17, v125
    v_cvt_pk_bf16_f32 v189, v18, v19
    v_exp_f32 v18, v126
    v_add_f32 v8, v8, v16
    v_add_f32 v8, v8, v17
    v_exp_f32 v19, v127
    v_cvt_pk_bf16_f32 v190, v16, v17
    v_add_f32 v8, v8, v18
    v_add_f32 v8, v8, v19
    v_cvt_pk_bf16_f32 v191, v18, v19
    v_mfma_f32_16x16x32_bf16 a[180:183], v[32:35], v[164:167], a[180:183]
    ds_read_b128 v[28:31], v14 offset:15360
    v_mov_b32 v52, v7
    v_mfma_f32_16x16x32_bf16 a[180:183], v[36:39], v[172:175], a[180:183]
    s_waitcnt lgkmcnt(2)
    v_mov_b32 v54, v8
    s_nop 0
    v_permlane16_swap_b32 v7, v52
    v_permlane16_swap_b32 v8, v54
    s_nop 0
    v_mul_f32 v249, v249, v50
    v_add_f32 v7, v7, v52
    v_mfma_f32_16x16x32_bf16 a[96:99], v[40:43], v[176:179], a[96:99]
    ds_read_b128 v[32:35], v14 offset:6144
    v_add_f32 v8, v8, v54
    v_mfma_f32_16x16x32_bf16 a[96:99], v[44:47], v[184:187], a[96:99]
    v_mul_f32 v250, v250, v50
    v_mov_b32 v52, v7
    v_mul_f32 v251, v251, v50
    v_mul_f32 v252, v252, v50
    v_mov_b32 v54, v8
    v_mul_f32 v253, v253, v50
    v_mul_f32 v254, v254, v50
    v_mfma_f32_16x16x32_bf16 a[144:147], v[40:43], v[180:183], a[144:147]
    s_nop 0
    ds_read_b128 v[36:39], v14 offset:18432
    v_mul_f32 v255, v255, v50
    v_mfma_f32_16x16x32_bf16 a[144:147], v[44:47], v[188:191], a[144:147]
    s_waitcnt lgkmcnt(2)
    v_permlane32_swap_b32 v7, v52
    v_cvt_pk_bf16_f32 v248, v248, v249
    v_permlane32_swap_b32 v8, v54
    v_cvt_pk_bf16_f32 v249, v250, v251
    s_nop 0
    v_cvt_pk_bf16_f32 v250, v252, v253
    v_cvt_pk_bf16_f32 v251, v254, v255
    v_add_f32 v7, v7, v52
    v_mfma_f32_16x16x32_bf16 a[108:111], v[24:27], v[176:179], a[108:111]
    s_not_b64 vcc, s[62:63]
    ds_read_b128 v[40:43], v14 offset:9216
    v_add_f32 v8, v8, v54
    v_mfma_f32_16x16x32_bf16 a[108:111], v[28:31], v[184:187], a[108:111]
    v_cndmask_b32_dpp v132, v240, v248, vcc row_ror:8 row_mask:0xf bank_mask:0xf
    v_rcp_f32 v52, v7
    v_cndmask_b32_dpp v133, v241, v249, vcc row_ror:8 row_mask:0xf bank_mask:0xf
    v_cndmask_b32_dpp v134, v242, v250, vcc row_ror:8 row_mask:0xf bank_mask:0xf
    v_cndmask_b32_dpp v135, v243, v251, vcc row_ror:8 row_mask:0xf bank_mask:0xf
    s_mov_b64 vcc, s[62:63]
    v_mfma_f32_16x16x32_bf16 a[156:159], v[24:27], v[180:183], a[156:159]
    ds_read_b128 v[44:47], v14 offset:21504
    v_cndmask_b32_dpp v128, v248, v240, vcc row_ror:8 row_mask:0xf bank_mask:0xf
    v_mfma_f32_16x16x32_bf16 a[156:159], v[28:31], v[188:191], a[156:159]
    s_waitcnt lgkmcnt(2)
    v_rcp_f32 v54, v8
    v_cndmask_b32_dpp v129, v249, v241, vcc row_ror:8 row_mask:0xf bank_mask:0xf
    v_cndmask_b32_dpp v130, v250, v242, vcc row_ror:8 row_mask:0xf bank_mask:0xf
    s_nop 0
    v_cndmask_b32_dpp v131, v251, v243, vcc row_ror:8 row_mask:0xf bank_mask:0xf
    v_max3_f32 v16, v5, v6, v7
    v_mfma_f32_16x16x32_bf16 a[120:123], v[32:35], v[176:179], a[120:123]
    ds_read_b128 v[24:27], v22 offset:1024
    v_max_f32 v16, v16, v8
    v_mfma_f32_16x16x32_bf16 a[120:123], v[36:39], v[184:187], a[120:123]
    buffer_store_dwordx4 v[132:135], v56, s[12:15], s40 offen offset:3328 sc0 sc1
    s_mov_b32 s29, 0x5f800000
    v_cmp_lt_f32 s[48:49], s29, v16
    v_mfma_f32_16x16x32_bf16 a[168:171], v[32:35], v[180:183], a[168:171]
    ds_read_b128 v[28:31], v22 offset:13312
    v_mfma_f32_16x16x32_bf16 a[168:171], v[36:39], v[188:191], a[168:171]
    s_waitcnt lgkmcnt(2)
    buffer_store_dwordx4 v[128:131], v56, s[12:15], s40 offen offset:256 sc0 sc1
    v_mfma_f32_16x16x32_bf16 a[132:135], v[40:43], v[176:179], a[132:135]
    ds_read_b128 v[32:35], v22 offset:4096
    v_mfma_f32_16x16x32_bf16 a[132:135], v[44:47], v[184:187], a[132:135]
    v_mfma_f32_16x16x32_bf16 a[180:183], v[40:43], v[180:183], a[180:183]
    ds_read_b128 v[36:39], v22 offset:16384
    v_mfma_f32_16x16x32_bf16 a[180:183], v[44:47], v[188:191], a[180:183]
    s_waitcnt lgkmcnt(2)
    v_mfma_f32_16x16x32_bf16 a[100:103], v[24:27], v[80:83], a[100:103]
    ds_read_b128 v[40:43], v22 offset:7168
    v_mfma_f32_16x16x32_bf16 a[100:103], v[28:31], v[88:91], a[100:103]
    v_mfma_f32_16x16x32_bf16 a[148:151], v[24:27], v[84:87], a[148:151]
    ds_read_b128 v[44:47], v22 offset:19456
    v_mfma_f32_16x16x32_bf16 a[148:151], v[28:31], v[92:95], a[148:151]
    s_waitcnt lgkmcnt(2)
    s_cmp_lg_u64 s[48:49], 0
    s_cbranch_scc1 L_slow
    v_mfma_f32_16x16x32_bf16 a[112:115], v[32:35], v[80:83], a[112:115]
    ds_read_b128 v[24:27], v22 offset:10240
    v_accvgpr_read_b32 v224, a96
    v_mfma_f32_16x16x32_bf16 a[112:115], v[36:39], v[88:91], a[112:115]
    v_accvgpr_read_b32 v225, a108
    v_accvgpr_read_b32 v226, a120
    v_accvgpr_read_b32 v227, a132
    v_accvgpr_read_b32 v228, a97
    v_accvgpr_read_b32 v229, a109
    v_accvgpr_read_b32 v230, a121
    v_accvgpr_read_b32 v231, a133
    v_mul_f32 v224, v224, v52
    v_mul_f32 v225, v225, v52
    v_mul_f32 v226, v226, v52
    v_mul_f32 v227, v227, v52
    v_mul_f32 v228, v228, v52
    v_mul_f32 v229, v229, v52
    v_mul_f32 v230, v230, v52
    v_mul_f32 v231, v231, v52
    v_cvt_pk_bf16_f32 v224, v224, v225
    v_cvt_pk_bf16_f32 v225, v226, v227
    v_cvt_pk_bf16_f32 v226, v228, v229
    v_cvt_pk_bf16_f32 v227, v230, v231
    v_accvgpr_read_b32 v232, a98
    v_accvgpr_read_b32 v233, a110
    v_accvgpr_read_b32 v234, a122
    v_accvgpr_read_b32 v235, a134
    v_accvgpr_read_b32 v236, a99
    v_accvgpr_read_b32 v237, a111
    v_accvgpr_read_b32 v238, a123
    v_accvgpr_read_b32 v239, a135
    v_mul_f32 v232, v232, v52
    v_mul_f32 v233, v233, v52
    v_mul_f32 v234, v234, v52
    v_mfma_f32_16x16x32_bf16 a[160:163], v[32:35], v[84:87], a[160:163]
    ds_read_b128 v[28:31], v22 offset:22528
    v_mul_f32 v235, v235, v52
    v_mfma_f32_16x16x32_bf16 a[160:163], v[36:39], v[92:95], a[160:163]
    s_waitcnt lgkmcnt(2)
    v_mul_f32 v236, v236, v52
    v_mul_f32 v237, v237, v52
    v_mul_f32 v238, v238, v52
    v_mul_f32 v239, v239, v52
    v_cvt_pk_bf16_f32 v232, v232, v233
    v_cvt_pk_bf16_f32 v233, v234, v235
    v_cvt_pk_bf16_f32 v234, v236, v237
    v_mfma_f32_16x16x32_bf16 a[124:127], v[40:43], v[80:83], a[124:127]
    ds_read_b128 v[32:35], v1 offset:1024
    v_cvt_pk_bf16_f32 v235, v238, v239
    v_mfma_f32_16x16x32_bf16 a[124:127], v[44:47], v[88:91], a[124:127]
    s_not_b64 vcc, s[62:63]
    v_cndmask_b32_dpp v148, v224, v232, vcc row_ror:8 row_mask:0xf bank_mask:0xf
    v_cndmask_b32_dpp v149, v225, v233, vcc row_ror:8 row_mask:0xf bank_mask:0xf
    v_cndmask_b32_dpp v150, v226, v234, vcc row_ror:8 row_mask:0xf bank_mask:0xf
    v_cndmask_b32_dpp v151, v227, v235, vcc row_ror:8 row_mask:0xf bank_mask:0xf
    v_mfma_f32_16x16x32_bf16 a[172:175], v[40:43], v[84:87], a[172:175]
    s_mov_b64 vcc, s[62:63]
    ds_read_b128 v[36:39], v1 offset:13312
    v_cndmask_b32_dpp v144, v232, v224, vcc row_ror:8 row_mask:0xf bank_mask:0xf
    v_mfma_f32_16x16x32_bf16 a[172:175], v[44:47], v[92:95], a[172:175]
    s_waitcnt lgkmcnt(2)
    v_cndmask_b32_dpp v145, v233, v225, vcc row_ror:8 row_mask:0xf bank_mask:0xf
    v_cndmask_b32_dpp v146, v234, v226, vcc row_ror:8 row_mask:0xf bank_mask:0xf
    v_cndmask_b32_dpp v147, v235, v227, vcc row_ror:8 row_mask:0xf bank_mask:0xf
    v_accvgpr_read_b32 v240, a144
    v_accvgpr_read_b32 v241, a156
    v_mfma_f32_16x16x32_bf16 a[136:139], v[24:27], v[80:83], a[136:139]
    ds_read_b128 v[40:43], v1 offset:4096
    v_accvgpr_read_b32 v242, a168
    v_mfma_f32_16x16x32_bf16 a[136:139], v[28:31], v[88:91], a[136:139]
    v_accvgpr_read_b32 v243, a180
    v_accvgpr_read_b32 v244, a145
    v_accvgpr_read_b32 v245, a157
    v_accvgpr_read_b32 v246, a169
    v_mfma_f32_16x16x32_bf16 a[184:187], v[24:27], v[84:87], a[184:187]
    ds_read_b128 v[44:47], v1 offset:16384
    v_accvgpr_read_b32 v247, a181
    v_mfma_f32_16x16x32_bf16 a[184:187], v[28:31], v[92:95], a[184:187]
    s_waitcnt lgkmcnt(2)
    buffer_store_dwordx4 v[148:151], v56, s[12:15], s41 offen offset:3072 sc0 sc1
    v_mfma_f32_16x16x32_bf16 a[100:103], v[32:35], v[160:163], a[100:103]
    ds_read_b128 v[24:27], v1 offset:7168
    v_mul_f32 v240, v240, v54
    v_mfma_f32_16x16x32_bf16 a[100:103], v[36:39], v[168:171], a[100:103]
    v_mul_f32 v241, v241, v54
    v_mul_f32 v242, v242, v54
    v_mul_f32 v243, v243, v54
    v_mul_f32 v244, v244, v54
    v_mfma_f32_16x16x32_bf16 a[148:151], v[32:35], v[164:167], a[148:151]
    ds_read_b128 v[28:31], v1 offset:19456
    v_mul_f32 v245, v245, v54
    v_mfma_f32_16x16x32_bf16 a[148:151], v[36:39], v[172:175], a[148:151]
    s_waitcnt lgkmcnt(2)
    v_mul_f32 v246, v246, v54
    v_mul_f32 v247, v247, v54
    v_cvt_pk_bf16_f32 v240, v240, v241
    v_cvt_pk_bf16_f32 v241, v242, v243
    v_cvt_pk_bf16_f32 v242, v244, v245
    v_mfma_f32_16x16x32_bf16 a[112:115], v[40:43], v[160:163], a[112:115]
    ds_read_b128 v[32:35], v1 offset:10240
    v_cvt_pk_bf16_f32 v243, v246, v247
    v_mfma_f32_16x16x32_bf16 a[112:115], v[44:47], v[168:171], a[112:115]
    v_accvgpr_read_b32 v248, a146
    v_accvgpr_read_b32 v249, a158
    v_accvgpr_read_b32 v250, a170
    v_accvgpr_read_b32 v251, a182
    v_mfma_f32_16x16x32_bf16 a[160:163], v[40:43], v[164:167], a[160:163]
    ds_read_b128 v[36:39], v1 offset:22528
    v_accvgpr_read_b32 v252, a147
    v_mfma_f32_16x16x32_bf16 a[160:163], v[44:47], v[172:175], a[160:163]
    s_waitcnt lgkmcnt(2)
    v_accvgpr_read_b32 v253, a159
    v_accvgpr_read_b32 v254, a171
    v_accvgpr_read_b32 v255, a183
    v_mfma_f32_16x16x32_bf16 a[124:127], v[24:27], v[160:163], a[124:127]
    ds_read_b128 v[40:43], v14 offset:1024
    v_mfma_f32_16x16x32_bf16 a[124:127], v[28:31], v[168:171], a[124:127]
    buffer_store_dwordx4 v[144:147], v56, s[12:15], s41 offen offset:0 sc0 sc1
    v_mul_f32 v248, v248, v54
    v_mul_f32 v249, v249, v54
    v_mfma_f32_16x16x32_bf16 a[172:175], v[24:27], v[164:167], a[172:175]
    ds_read_b128 v[44:47], v14 offset:13312
    v_mul_f32 v250, v250, v54
    v_mfma_f32_16x16x32_bf16 a[172:175], v[28:31], v[172:175], a[172:175]
    s_waitcnt lgkmcnt(2)
    v_mul_f32 v251, v251, v54
    v_mul_f32 v252, v252, v54
    v_mul_f32 v253, v253, v54
    v_mul_f32 v254, v254, v54
    v_mfma_f32_16x16x32_bf16 a[136:139], v[32:35], v[160:163], a[136:139]
    ds_read_b128 v[24:27], v14 offset:4096
    v_mul_f32 v255, v255, v54
    v_mfma_f32_16x16x32_bf16 a[136:139], v[36:39], v[168:171], a[136:139]
    v_cvt_pk_bf16_f32 v248, v248, v249
    v_cvt_pk_bf16_f32 v249, v250, v251
    v_cvt_pk_bf16_f32 v250, v252, v253
    v_cvt_pk_bf16_f32 v251, v254, v255
    s_not_b64 vcc, s[62:63]
    v_mfma_f32_16x16x32_bf16 a[184:187], v[32:35], v[164:167], a[184:187]
    ds_read_b128 v[28:31], v14 offset:16384
    v_cndmask_b32_dpp v156, v240, v248, vcc row_ror:8 row_mask:0xf bank_mask:0xf
    v_mfma_f32_16x16x32_bf16 a[184:187], v[36:39], v[172:175], a[184:187]
    s_waitcnt lgkmcnt(2)
    v_cndmask_b32_dpp v157, v241, v249, vcc row_ror:8 row_mask:0xf bank_mask:0xf
    v_cndmask_b32_dpp v158, v242, v250, vcc row_ror:8 row_mask:0xf bank_mask:0xf
    v_cndmask_b32_dpp v159, v243, v251, vcc row_ror:8 row_mask:0xf bank_mask:0xf
    s_mov_b64 vcc, s[62:63]
    v_mfma_f32_16x16x32_bf16 a[100:103], v[40:43], v[176:179], a[100:103]
    ds_read_b128 v[32:35], v14 offset:7168
    v_cndmask_b32_dpp v152, v248, v240, vcc row_ror:8 row_mask:0xf bank_mask:0xf
    v_mfma_f32_16x16x32_bf16 a[100:103], v[44:47], v[184:187], a[100:103]
    v_cndmask_b32_dpp v153, v249, v241, vcc row_ror:8 row_mask:0xf bank_mask:0xf
    v_cndmask_b32_dpp v154, v250, v242, vcc row_ror:8 row_mask:0xf bank_mask:0xf
    v_cndmask_b32_dpp v155, v251, v243, vcc row_ror:8 row_mask:0xf bank_mask:0xf
    v_mfma_f32_16x16x32_bf16 a[148:151], v[40:43], v[180:183], a[148:151]
    ds_read_b128 v[36:39], v14 offset:19456
    v_mfma_f32_16x16x32_bf16 a[148:151], v[44:47], v[188:191], a[148:151]
    s_waitcnt lgkmcnt(2)
    buffer_store_dwordx4 v[156:159], v56, s[12:15], s42 offen offset:3072 sc0 sc1
    v_mfma_f32_16x16x32_bf16 a[112:115], v[24:27], v[176:179], a[112:115]
    ds_read_b128 v[40:43], v14 offset:10240
    v_mfma_f32_16x16x32_bf16 a[112:115], v[28:31], v[184:187], a[112:115]
    buffer_store_dwordx4 v[152:155], v56, s[12:15], s42 offen offset:0 sc0 sc1
    v_mfma_f32_16x16x32_bf16 a[160:163], v[24:27], v[180:183], a[160:163]
    ds_read_b128 v[44:47], v14 offset:22528
    v_mfma_f32_16x16x32_bf16 a[160:163], v[28:31], v[188:191], a[160:163]
    s_waitcnt lgkmcnt(2)
    v_mfma_f32_16x16x32_bf16 a[124:127], v[32:35], v[176:179], a[124:127]
    ds_read_b128 v[24:27], v22 offset:2048
    v_mfma_f32_16x16x32_bf16 a[124:127], v[36:39], v[184:187], a[124:127]
    v_mfma_f32_16x16x32_bf16 a[172:175], v[32:35], v[180:183], a[172:175]
    ds_read_b128 v[28:31], v22 offset:14336
    v_mfma_f32_16x16x32_bf16 a[172:175], v[36:39], v[188:191], a[172:175]
    s_waitcnt lgkmcnt(2)
    v_mfma_f32_16x16x32_bf16 a[136:139], v[40:43], v[176:179], a[136:139]
    ds_read_b128 v[32:35], v22 offset:5120
    v_mfma_f32_16x16x32_bf16 a[136:139], v[44:47], v[184:187], a[136:139]
    v_mfma_f32_16x16x32_bf16 a[184:187], v[40:43], v[180:183], a[184:187]
    ds_read_b128 v[36:39], v22 offset:17408
    v_mfma_f32_16x16x32_bf16 a[184:187], v[44:47], v[188:191], a[184:187]
    s_waitcnt lgkmcnt(2)
    v_mfma_f32_16x16x32_bf16 a[104:107], v[24:27], v[80:83], a[104:107]
    ds_read_b128 v[40:43], v22 offset:8192
    v_mfma_f32_16x16x32_bf16 a[104:107], v[28:31], v[88:91], a[104:107]
    v_mfma_f32_16x16x32_bf16 a[152:155], v[24:27], v[84:87], a[152:155]
    ds_read_b128 v[44:47], v22 offset:20480
    v_mfma_f32_16x16x32_bf16 a[152:155], v[28:31], v[92:95], a[152:155]
    s_waitcnt lgkmcnt(2)
    v_mfma_f32_16x16x32_bf16 a[116:119], v[32:35], v[80:83], a[116:119]
    ds_read_b128 v[24:27], v22 offset:11264
    v_accvgpr_read_b32 v224, a100
    v_mfma_f32_16x16x32_bf16 a[116:119], v[36:39], v[88:91], a[116:119]
    v_accvgpr_read_b32 v225, a112
    v_accvgpr_read_b32 v226, a124
    v_accvgpr_read_b32 v227, a136
    v_accvgpr_read_b32 v228, a101
    v_accvgpr_read_b32 v229, a113
    v_accvgpr_read_b32 v230, a125
    v_accvgpr_read_b32 v231, a137
    v_mul_f32 v224, v224, v52
    v_mul_f32 v225, v225, v52
    v_mul_f32 v226, v226, v52
    v_mul_f32 v227, v227, v52
    v_mul_f32 v228, v228, v52
    v_mul_f32 v229, v229, v52
    v_mul_f32 v230, v230, v52
    v_mul_f32 v231, v231, v52
    v_cvt_pk_bf16_f32 v224, v224, v225
    v_cvt_pk_bf16_f32 v225, v226, v227
    v_cvt_pk_bf16_f32 v226, v228, v229
    v_cvt_pk_bf16_f32 v227, v230, v231
    v_accvgpr_read_b32 v232, a102
    v_accvgpr_read_b32 v233, a114
    v_accvgpr_read_b32 v234, a126
    v_accvgpr_read_b32 v235, a138
    v_mfma_f32_16x16x32_bf16 a[164:167], v[32:35], v[84:87], a[164:167]
    ds_read_b128 v[28:31], v22 offset:23552
    v_accvgpr_read_b32 v236, a103
    v_mfma_f32_16x16x32_bf16 a[164:167], v[36:39], v[92:95], a[164:167]
    s_waitcnt lgkmcnt(2)
    v_accvgpr_read_b32 v237, a115
    v_accvgpr_read_b32 v238, a127
    v_accvgpr_read_b32 v239, a139
    v_mul_f32 v232, v232, v52
    v_mfma_f32_16x16x32_bf16 a[128:131], v[40:43], v[80:83], a[128:131]
    ds_read_b128 v[32:35], v1 offset:2048
    v_mul_f32 v233, v233, v52
    v_mfma_f32_16x16x32_bf16 a[128:131], v[44:47], v[88:91], a[128:131]
    v_mul_f32 v234, v234, v52
    v_mul_f32 v235, v235, v52
    v_mul_f32 v236, v236, v52
    v_mul_f32 v237, v237, v52
    v_mul_f32 v238, v238, v52
    v_mfma_f32_16x16x32_bf16 a[176:179], v[40:43], v[84:87], a[176:179]
    ds_read_b128 v[36:39], v1 offset:14336
    v_mul_f32 v239, v239, v52
    v_mfma_f32_16x16x32_bf16 a[176:179], v[44:47], v[92:95], a[176:179]
    s_waitcnt lgkmcnt(2)
    v_cvt_pk_bf16_f32 v232, v232, v233
    v_cvt_pk_bf16_f32 v233, v234, v235
    v_cvt_pk_bf16_f32 v234, v236, v237
    v_cvt_pk_bf16_f32 v235, v238, v239
    v_mfma_f32_16x16x32_bf16 a[140:143], v[24:27], v[80:83], a[140:143]
    s_not_b64 vcc, s[62:63]
    ds_read_b128 v[40:43], v1 offset:5120
    v_cndmask_b32_dpp v132, v224, v232, vcc row_ror:8 row_mask:0xf bank_mask:0xf
    v_mfma_f32_16x16x32_bf16 a[140:143], v[28:31], v[88:91], a[140:143]
    v_cndmask_b32_dpp v133, v225, v233, vcc row_ror:8 row_mask:0xf bank_mask:0xf
    v_cndmask_b32_dpp v134, v226, v234, vcc row_ror:8 row_mask:0xf bank_mask:0xf
    v_cndmask_b32_dpp v135, v227, v235, vcc row_ror:8 row_mask:0xf bank_mask:0xf
    s_mov_b64 vcc, s[62:63]
    v_cndmask_b32_dpp v128, v232, v224, vcc row_ror:8 row_mask:0xf bank_mask:0xf
    v_mfma_f32_16x16x32_bf16 a[188:191], v[24:27], v[84:87], a[188:191]
    ds_read_b128 v[44:47], v1 offset:17408
    v_cndmask_b32_dpp v129, v233, v225, vcc row_ror:8 row_mask:0xf bank_mask:0xf
    v_mfma_f32_16x16x32_bf16 a[188:191], v[28:31], v[92:95], a[188:191]
    s_waitcnt lgkmcnt(2)
    v_cndmask_b32_dpp v130, v234, v226, vcc row_ror:8 row_mask:0xf bank_mask:0xf
    v_cndmask_b32_dpp v131, v235, v227, vcc row_ror:8 row_mask:0xf bank_mask:0xf
    v_accvgpr_read_b32 v240, a148
    v_accvgpr_read_b32 v241, a160
    v_mfma_f32_16x16x32_bf16 a[104:107], v[32:35], v[160:163], a[104:107]
    ds_read_b128 v[24:27], v1 offset:8192
    v_accvgpr_read_b32 v242, a172
    v_mfma_f32_16x16x32_bf16 a[104:107], v[36:39], v[168:171], a[104:107]
    v_accvgpr_read_b32 v243, a184
    v_accvgpr_read_b32 v244, a149
    v_accvgpr_read_b32 v245, a161
    v_accvgpr_read_b32 v246, a173
    v_accvgpr_read_b32 v247, a185
    v_mfma_f32_16x16x32_bf16 a[152:155], v[32:35], v[164:167], a[152:155]
    ds_read_b128 v[28:31], v1 offset:20480
    v_mfma_f32_16x16x32_bf16 a[152:155], v[36:39], v[172:175], a[152:155]
    s_waitcnt lgkmcnt(2)
    buffer_store_dwordx4 v[132:135], v56, s[12:15], s41 offen offset:3200 sc0 sc1
    v_mfma_f32_16x16x32_bf16 a[116:119], v[40:43], v[160:163], a[116:119]
    ds_read_b128 v[32:35], v1 offset:11264
    v_mul_f32 v240, v240, v54
    v_mfma_f32_16x16x32_bf16 a[116:119], v[44:47], v[168:171], a[116:119]
    v_mul_f32 v241, v241, v54
    v_mul_f32 v242, v242, v54
    v_mul_f32 v243, v243, v54
    v_mul_f32 v244, v244, v54
    v_mfma_f32_16x16x32_bf16 a[164:167], v[40:43], v[164:167], a[164:167]
    ds_read_b128 v[36:39], v1 offset:23552
    v_mul_f32 v245, v245, v54
    v_mfma_f32_16x16x32_bf16 a[164:167], v[44:47], v[172:175], a[164:167]
    s_waitcnt lgkmcnt(2)
    v_mul_f32 v246, v246, v54
    v_mul_f32 v247, v247, v54
    v_cvt_pk_bf16_f32 v240, v240, v241
    v_cvt_pk_bf16_f32 v241, v242, v243
    v_cvt_pk_bf16_f32 v242, v244, v245
    v_mfma_f32_16x16x32_bf16 a[128:131], v[24:27], v[160:163], a[128:131]
    ds_read_b128 v[40:43], v14 offset:2048
    v_cvt_pk_bf16_f32 v243, v246, v247
    v_mfma_f32_16x16x32_bf16 a[128:131], v[28:31], v[168:171], a[128:131]
    v_accvgpr_read_b32 v248, a150
    v_accvgpr_read_b32 v249, a162
    v_accvgpr_read_b32 v250, a174
    v_accvgpr_read_b32 v251, a186
    v_mfma_f32_16x16x32_bf16 a[176:179], v[24:27], v[164:167], a[176:179]
    ds_read_b128 v[44:47], v14 offset:14336
    v_accvgpr_read_b32 v252, a151
    v_mfma_f32_16x16x32_bf16 a[176:179], v[28:31], v[172:175], a[176:179]
    s_waitcnt lgkmcnt(2)
    v_accvgpr_read_b32 v253, a163
    v_accvgpr_read_b32 v254, a175
    v_accvgpr_read_b32 v255, a187
    v_mfma_f32_16x16x32_bf16 a[140:143], v[32:35], v[160:163], a[140:143]
    ds_read_b128 v[24:27], v14 offset:5120
    v_mfma_f32_16x16x32_bf16 a[140:143], v[36:39], v[168:171], a[140:143]
    buffer_store_dwordx4 v[128:131], v56, s[12:15], s41 offen offset:128 sc0 sc1
    v_mul_f32 v248, v248, v54
    v_mfma_f32_16x16x32_bf16 a[188:191], v[32:35], v[164:167], a[188:191]
    ds_read_b128 v[28:31], v14 offset:17408
    v_mul_f32 v249, v249, v54
    v_mfma_f32_16x16x32_bf16 a[188:191], v[36:39], v[172:175], a[188:191]
    s_waitcnt lgkmcnt(2)
    v_mul_f32 v250, v250, v54
    v_mul_f32 v251, v251, v54
    v_mul_f32 v252, v252, v54
    v_mul_f32 v253, v253, v54
    v_mul_f32 v254, v254, v54
    v_mfma_f32_16x16x32_bf16 a[104:107], v[40:43], v[176:179], a[104:107]
    ds_read_b128 v[32:35], v14 offset:8192
    v_mul_f32 v255, v255, v54
    v_mfma_f32_16x16x32_bf16 a[104:107], v[44:47], v[184:187], a[104:107]
    v_cvt_pk_bf16_f32 v248, v248, v249
    v_cvt_pk_bf16_f32 v249, v250, v251
    v_cvt_pk_bf16_f32 v250, v252, v253
    v_cvt_pk_bf16_f32 v251, v254, v255
    v_mfma_f32_16x16x32_bf16 a[152:155], v[40:43], v[180:183], a[152:155]
    s_not_b64 vcc, s[62:63]
    ds_read_b128 v[36:39], v14 offset:20480
    v_cndmask_b32_dpp v148, v240, v248, vcc row_ror:8 row_mask:0xf bank_mask:0xf
    v_mfma_f32_16x16x32_bf16 a[152:155], v[44:47], v[188:191], a[152:155]
    s_waitcnt lgkmcnt(2)
    v_cndmask_b32_dpp v149, v241, v249, vcc row_ror:8 row_mask:0xf bank_mask:0xf
    v_cndmask_b32_dpp v150, v242, v250, vcc row_ror:8 row_mask:0xf bank_mask:0xf
    v_cndmask_b32_dpp v151, v243, v251, vcc row_ror:8 row_mask:0xf bank_mask:0xf
    s_mov_b64 vcc, s[62:63]
    v_cndmask_b32_dpp v144, v248, v240, vcc row_ror:8 row_mask:0xf bank_mask:0xf
    v_mfma_f32_16x16x32_bf16 a[116:119], v[24:27], v[176:179], a[116:119]
    ds_read_b128 v[40:43], v14 offset:11264
    v_cndmask_b32_dpp v145, v249, v241, vcc row_ror:8 row_mask:0xf bank_mask:0xf
    v_mfma_f32_16x16x32_bf16 a[116:119], v[28:31], v[184:187], a[116:119]
    v_cndmask_b32_dpp v146, v250, v242, vcc row_ror:8 row_mask:0xf bank_mask:0xf
    v_cndmask_b32_dpp v147, v251, v243, vcc row_ror:8 row_mask:0xf bank_mask:0xf
    v_mfma_f32_16x16x32_bf16 a[164:167], v[24:27], v[180:183], a[164:167]
    ds_read_b128 v[44:47], v14 offset:23552
    v_mfma_f32_16x16x32_bf16 a[164:167], v[28:31], v[188:191], a[164:167]
    s_waitcnt lgkmcnt(2)
    buffer_store_dwordx4 v[148:151], v56, s[12:15], s42 offen offset:3200 sc0 sc1
    v_mfma_f32_16x16x32_bf16 a[128:131], v[32:35], v[176:179], a[128:131]
    v_mfma_f32_16x16x32_bf16 a[128:131], v[36:39], v[184:187], a[128:131]
    buffer_store_dwordx4 v[144:147], v56, s[12:15], s42 offen offset:128 sc0 sc1
    v_mfma_f32_16x16x32_bf16 a[176:179], v[32:35], v[180:183], a[176:179]
    v_mfma_f32_16x16x32_bf16 a[176:179], v[36:39], v[188:191], a[176:179]
    s_waitcnt lgkmcnt(0)
    v_mfma_f32_16x16x32_bf16 a[140:143], v[40:43], v[176:179], a[140:143]
    v_mfma_f32_16x16x32_bf16 a[140:143], v[44:47], v[184:187], a[140:143]
    v_mfma_f32_16x16x32_bf16 a[188:191], v[40:43], v[180:183], a[188:191]
    v_mfma_f32_16x16x32_bf16 a[188:191], v[44:47], v[188:191], a[188:191]
    s_nop 7
    v_accvgpr_read_b32 v224, a104
    v_accvgpr_read_b32 v225, a116
    v_accvgpr_read_b32 v226, a128
    v_accvgpr_read_b32 v227, a140
    v_accvgpr_read_b32 v228, a105
    v_accvgpr_read_b32 v229, a117
    v_accvgpr_read_b32 v230, a129
    v_accvgpr_read_b32 v231, a141
    v_pk_mul_f32 v[224:225], v[224:225], v[52:53] op_sel_hi:[1,0]
    v_pk_mul_f32 v[226:227], v[226:227], v[52:53] op_sel_hi:[1,0]
    v_pk_mul_f32 v[228:229], v[228:229], v[52:53] op_sel_hi:[1,0]
    v_pk_mul_f32 v[230:231], v[230:231], v[52:53] op_sel_hi:[1,0]
    v_cvt_pk_bf16_f32 v224, v224, v225
    v_cvt_pk_bf16_f32 v225, v226, v227
    v_cvt_pk_bf16_f32 v226, v228, v229
    v_cvt_pk_bf16_f32 v227, v230, v231
    v_accvgpr_read_b32 v232, a106
    v_accvgpr_read_b32 v233, a118
    v_accvgpr_read_b32 v234, a130
    v_accvgpr_read_b32 v235, a142
    v_accvgpr_read_b32 v236, a107
    v_accvgpr_read_b32 v237, a119
    v_accvgpr_read_b32 v238, a131
    v_accvgpr_read_b32 v239, a143
    v_pk_mul_f32 v[232:233], v[232:233], v[52:53] op_sel_hi:[1,0]
    v_pk_mul_f32 v[234:235], v[234:235], v[52:53] op_sel_hi:[1,0]
    v_pk_mul_f32 v[236:237], v[236:237], v[52:53] op_sel_hi:[1,0]
    v_pk_mul_f32 v[238:239], v[238:239], v[52:53] op_sel_hi:[1,0]
    v_cvt_pk_bf16_f32 v232, v232, v233
    v_cvt_pk_bf16_f32 v233, v234, v235
    v_cvt_pk_bf16_f32 v234, v236, v237
    v_cvt_pk_bf16_f32 v235, v238, v239
    s_not_b64 vcc, s[62:63]
    v_cndmask_b32_dpp v156, v224, v232, vcc row_ror:8 row_mask:0xf bank_mask:0xf
    v_cndmask_b32_dpp v157, v225, v233, vcc row_ror:8 row_mask:0xf bank_mask:0xf
    v_cndmask_b32_dpp v158, v226, v234, vcc row_ror:8 row_mask:0xf bank_mask:0xf
    v_cndmask_b32_dpp v159, v227, v235, vcc row_ror:8 row_mask:0xf bank_mask:0xf
    s_mov_b64 vcc, s[62:63]
    v_cndmask_b32_dpp v152, v232, v224, vcc row_ror:8 row_mask:0xf bank_mask:0xf
    v_cndmask_b32_dpp v153, v233, v225, vcc row_ror:8 row_mask:0xf bank_mask:0xf
    v_cndmask_b32_dpp v154, v234, v226, vcc row_ror:8 row_mask:0xf bank_mask:0xf
    v_cndmask_b32_dpp v155, v235, v227, vcc row_ror:8 row_mask:0xf bank_mask:0xf
    buffer_store_dwordx4 v[156:159], v56, s[12:15], s41 offen offset:3328 sc0 sc1
    buffer_store_dwordx4 v[152:155], v56, s[12:15], s41 offen offset:256 sc0 sc1
    v_accvgpr_read_b32 v240, a152
    v_accvgpr_read_b32 v241, a164
    v_accvgpr_read_b32 v242, a176
    v_accvgpr_read_b32 v243, a188
    v_accvgpr_read_b32 v244, a153
    v_accvgpr_read_b32 v245, a165
    v_accvgpr_read_b32 v246, a177
    v_accvgpr_read_b32 v247, a189
    v_pk_mul_f32 v[240:241], v[240:241], v[54:55] op_sel_hi:[1,0]
    v_pk_mul_f32 v[242:243], v[242:243], v[54:55] op_sel_hi:[1,0]
    v_pk_mul_f32 v[244:245], v[244:245], v[54:55] op_sel_hi:[1,0]
    v_pk_mul_f32 v[246:247], v[246:247], v[54:55] op_sel_hi:[1,0]
    v_cvt_pk_bf16_f32 v240, v240, v241
    v_cvt_pk_bf16_f32 v241, v242, v243
    v_cvt_pk_bf16_f32 v242, v244, v245
    v_cvt_pk_bf16_f32 v243, v246, v247
    v_accvgpr_read_b32 v248, a154
    v_accvgpr_read_b32 v249, a166
    v_accvgpr_read_b32 v250, a178
    v_accvgpr_read_b32 v251, a190
    v_accvgpr_read_b32 v252, a155
    v_accvgpr_read_b32 v253, a167
    v_accvgpr_read_b32 v254, a179
    v_accvgpr_read_b32 v255, a191
    v_pk_mul_f32 v[248:249], v[248:249], v[54:55] op_sel_hi:[1,0]
    v_pk_mul_f32 v[250:251], v[250:251], v[54:55] op_sel_hi:[1,0]
    v_pk_mul_f32 v[252:253], v[252:253], v[54:55] op_sel_hi:[1,0]
    v_pk_mul_f32 v[254:255], v[254:255], v[54:55] op_sel_hi:[1,0]
    v_cvt_pk_bf16_f32 v248, v248, v249
    v_cvt_pk_bf16_f32 v249, v250, v251
    v_cvt_pk_bf16_f32 v250, v252, v253
    v_cvt_pk_bf16_f32 v251, v254, v255
    s_not_b64 vcc, s[62:63]
    v_cndmask_b32_dpp v132, v240, v248, vcc row_ror:8 row_mask:0xf bank_mask:0xf
    v_cndmask_b32_dpp v133, v241, v249, vcc row_ror:8 row_mask:0xf bank_mask:0xf
    v_cndmask_b32_dpp v134, v242, v250, vcc row_ror:8 row_mask:0xf bank_mask:0xf
    v_cndmask_b32_dpp v135, v243, v251, vcc row_ror:8 row_mask:0xf bank_mask:0xf
    s_mov_b64 vcc, s[62:63]
    v_cndmask_b32_dpp v128, v248, v240, vcc row_ror:8 row_mask:0xf bank_mask:0xf
    v_cndmask_b32_dpp v129, v249, v241, vcc row_ror:8 row_mask:0xf bank_mask:0xf
    v_cndmask_b32_dpp v130, v250, v242, vcc row_ror:8 row_mask:0xf bank_mask:0xf
    v_cndmask_b32_dpp v131, v251, v243, vcc row_ror:8 row_mask:0xf bank_mask:0xf
    buffer_store_dwordx4 v[132:135], v56, s[12:15], s42 offen offset:3328 sc0 sc1
    buffer_store_dwordx4 v[128:131], v56, s[12:15], s42 offen offset:256 sc0 sc1
L_fin:
L_done:
    s_endpgm
L_pollslow0:
    s_mov_b32 s59, 60
L_pollsm0:
    s_buffer_load_dwordx8 s[48:55], s[20:23], s44 glc
    s_waitcnt lgkmcnt(0)
    s_sub_u32 s48, s48, s92
    s_sub_u32 s49, s49, s92
    s_sub_u32 s50, s50, s92
    s_sub_u32 s51, s51, s92
    s_sub_u32 s52, s52, s92
    s_sub_u32 s53, s53, s92
    s_sub_u32 s54, s54, s92
    s_sub_u32 s55, s55, s92
    s_max_u32 s48, s48, s49
    s_max_u32 s48, s48, s50
    s_max_u32 s48, s48, s51
    s_max_u32 s48, s48, s52
    s_max_u32 s48, s48, s53
    s_max_u32 s48, s48, s54
    s_max_u32 s48, s48, s55
    s_cmp_lt_u32 s48, 16
    s_cbranch_scc1 L_pollok0
    s_sub_u32 s59, s59, 1
    s_cbranch_scc1 L_pollvec0
    s_sleep 1
    s_branch L_pollsm0
L_pollvec0:
    v_bfe_u32 v53, v4, 4, 6
    v_lshlrev_b32 v53, 2, v53
    s_sub_u32 s96, s96, 1
    s_cbranch_scc1 L_pollgiveup0
    s_sleep 2
    buffer_load_dword v52, v53, s[20:23], s44 offen sc1
    s_waitcnt vmcnt(0)
    s_cmp_lg_u32 s44, 0
    s_cbranch_scc1 L_nomix
    v_xor_b32 v53, s92, v52
    v_lshrrev_b32 v53, 5, v53
    v_add_u32 v53, -1, v53
    v_cmp_gt_u32 vcc, 31, v53
    s_nop 1
    s_and_b32 s59, vcc_lo, 0xff00
    s_cbranch_scc0 L_nomix
    buffer_store_dwordx4 v[224:227], v11, s[4:7], s33 offen offset:0 sc1
    v_xor_b32 v55, 16, v11
    buffer_store_dwordx4 v[228:231], v55, s[4:7], s33 offen offset:768 sc1
    v_xor_b32 v54, 32, v11
    buffer_store_dwordx4 v[232:235], v54, s[4:7], s33 offen offset:1536 sc1
    v_xor_b32 v55, 48, v11
    buffer_store_dwordx4 v[236:239], v55, s[4:7], s33 offen offset:2304 sc1
    buffer_store_dwordx4 v[112:115], v20, s[4:7], s35 offen offset:0 sc1
    buffer_store_dwordx4 v[116:119], v20, s[4:7], s35 offen offset:3072 sc1
    buffer_store_dwordx4 v[120:123], v20, s[4:7], s17 offen offset:0 sc1
    buffer_store_dwordx4 v[124:127], v20, s[4:7], s17 offen offset:3072 sc1
    s_waitcnt vmcnt(0)
    s_barrier
    s_and_b32 s92, s92, 0xfffffc00
    s_add_u32 s92, s92, 512
    v_mov_b32 v0, s92
    s_add_u32 s92, s92, 1
    s_mov_b32 s44, 32
    v_add_u32 v0, 1, v0
    buffer_store_dword v0, v13, s[20:23], 0 offen offset:32 sc1
    s_branch L_pollvec0
L_nomix:
    v_subrev_u32 v52, s92, v52
    v_cmp_lt_u32 vcc, 15, v52
    s_nop 0
    s_and_b32 s59, vcc_lo, 0xff
    s_cbranch_scc1 L_pollvec0
    s_branch L_pollok0
L_pollgiveup0:
    s_mov_b32 s96, 0
    s_branch L_pollok0
L_pollslow1:
    s_mov_b32 s59, 200
L_pollsm1:
    s_buffer_load_dwordx8 s[48:55], s[20:23], s44 glc
    s_waitcnt lgkmcnt(0)
    s_sub_u32 s48, s48, s92
    s_sub_u32 s49, s49, s92
    s_sub_u32 s50, s50, s92
    s_sub_u32 s51, s51, s92
    s_sub_u32 s52, s52, s92
    s_sub_u32 s53, s53, s92
    s_sub_u32 s54, s54, s92
    s_sub_u32 s55, s55, s92
    s_max_u32 s48, s48, s49
    s_max_u32 s48, s48, s50
    s_max_u32 s48, s48, s51
    s_max_u32 s48, s48, s52
    s_max_u32 s48, s48, s53
    s_max_u32 s48, s48, s54
    s_max_u32 s48, s48, s55
    s_cmp_lt_u32 s48, 16
    s_cbranch_scc1 L_pollok1
    s_sub_u32 s59, s59, 1
    s_cbranch_scc1 L_pollvec1
    s_sleep 1
    s_branch L_pollsm1
L_pollvec1:
    v_bfe_u32 v53, v4, 4, 6
    v_lshlrev_b32 v53, 2, v53
    s_sub_u32 s96, s96, 1
    s_cbranch_scc1 L_pollgiveup1
    s_sleep 2
    buffer_load_dword v52, v53, s[20:23], s44 offen sc1
    s_waitcnt vmcnt(0)
    v_subrev_u32 v52, s92, v52
    v_cmp_lt_u32 vcc, 15, v52
    s_nop 0
    s_and_b32 s59, vcc_lo, 0xff
    s_cbranch_scc1 L_pollvec1
    s_branch L_pollok1
L_pollgiveup1:
    s_mov_b32 s96, 0
    s_branch L_pollok1
L_pollslow2:
    s_mov_b32 s59, 200
L_pollsm2:
    s_buffer_load_dwordx8 s[48:55], s[20:23], s44 glc
    s_waitcnt lgkmcnt(0)
    s_sub_u32 s48, s48, s92
    s_sub_u32 s49, s49, s92
    s_sub_u32 s50, s50, s92
    s_sub_u32 s51, s51, s92
    s_sub_u32 s52, s52, s92
    s_sub_u32 s53, s53, s92
    s_sub_u32 s54, s54, s92
    s_sub_u32 s55, s55, s92
    s_max_u32 s48, s48, s49
    s_max_u32 s48, s48, s50
    s_max_u32 s48, s48, s51
    s_max_u32 s48, s48, s52
    s_max_u32 s48, s48, s53
    s_max_u32 s48, s48, s54
    s_max_u32 s48, s48, s55
    s_cmp_lt_u32 s48, 16
    s_cbranch_scc1 L_pollok2
    s_sub_u32 s59, s59, 1
    s_cbranch_scc1 L_pollvec2
    s_sleep 1
    s_branch L_pollsm2
L_pollvec2:
    v_bfe_u32 v53, v4, 4, 6
    v_lshlrev_b32 v53, 2, v53
    s_sub_u32 s96, s96, 1
    s_cbranch_scc1 L_pollgiveup2
    s_sleep 2
    buffer_load_dword v52, v53, s[20:23], s44 offen sc1
    s_waitcnt vmcnt(0)
    v_subrev_u32 v52, s92, v52
    v_cmp_lt_u32 vcc, 15, v52
    s_nop 0
    s_and_b32 s59, vcc_lo, 0xff
    s_cbranch_scc1 L_pollvec2
    s_branch L_pollok2
L_pollgiveup2:
    s_mov_b32 s96, 0
    s_branch L_pollok2
L_tagslow:
    s_sub_u32 s96, s96, 1
    s_cbranch_scc1 L_taggiveup
    s_sleep 2
    buffer_load_dword v0, off, s[88:91], s93 sc1
    s_waitcnt vmcnt(0)
    v_readfirstlane_b32 s42, v0
    s_nop 0
    s_cmp_eq_u32 s42, s46
    s_cbranch_scc1 L_tagslow
    s_cmp_eq_u32 s42, 0
    s_cbranch_scc1 L_tagslow
    s_branch L_tagok
L_taggiveup:
    s_mov_b32 s96, 0
    s_branch L_tagok
L_slow:
    s_waitcnt vmcnt(0) lgkmcnt(0)
    s_nop 15
    v_accvgpr_write_b32 a0, 0
    v_accvgpr_write_b32 a1, 0
    v_accvgpr_write_b32 a2, 0
    v_accvgpr_write_b32 a3, 0
    v_accvgpr_write_b32 a4, 0
    v_accvgpr_write_b32 a5, 0
    v_accvgpr_write_b32 a6, 0
    v_accvgpr_write_b32 a7, 0
    v_accvgpr_write_b32 a8, 0
    v_accvgpr_write_b32 a9, 0
    v_accvgpr_write_b32 a10, 0
    v_accvgpr_write_b32 a11, 0
    v_accvgpr_write_b32 a12, 0
    v_accvgpr_write_b32 a13, 0
    v_accvgpr_write_b32 a14, 0
    v_accvgpr_write_b32 a15, 0
    v_accvgpr_write_b32 a16, 0
    v_accvgpr_write_b32 a17, 0
    v_accvgpr_write_b32 a18, 0
    v_accvgpr_write_b32 a19, 0
    v_accvgpr_write_b32 a20, 0
    v_accvgpr_write_b32 a21, 0
    v_accvgpr_write_b32 a22, 0
    v_accvgpr_write_b32 a23, 0
    v_accvgpr_write_b32 a24, 0
    v_accvgpr_write_b32 a25, 0
    v_accvgpr_write_b32 a26, 0
    v_accvgpr_write_b32 a27, 0
    v_accvgpr_write_b32 a28, 0
    v_accvgpr_write_b32 a29, 0
    v_accvgpr_write_b32 a30, 0
    v_accvgpr_write_b32 a31, 0
    v_accvgpr_write_b32 a32, 0
    v_accvgpr_write_b32 a33, 0
    v_accvgpr_write_b32 a34, 0
    v_accvgpr_write_b32 a35, 0
    v_accvgpr_write_b32 a36, 0
    v_accvgpr_write_b32 a37, 0
    v_accvgpr_write_b32 a38, 0
    v_accvgpr_write_b32 a39, 0
    v_accvgpr_write_b32 a40, 0
    v_accvgpr_write_b32 a41, 0
    v_accvgpr_write_b32 a42, 0
    v_accvgpr_write_b32 a43, 0
    v_accvgpr_write_b32 a44, 0
    v_accvgpr_write_b32 a45, 0
    v_accvgpr_write_b32 a46, 0
    v_accvgpr_write_b32 a47, 0
    v_accvgpr_write_b32 a48, 0
    v_accvgpr_write_b32 a49, 0
    v_accvgpr_write_b32 a50, 0
    v_accvgpr_write_b32 a51, 0
    v_accvgpr_write_b32 a52, 0
    v_accvgpr_write_b32 a53, 0
    v_accvgpr_write_b32 a54, 0
    v_accvgpr_write_b32 a55, 0
    v_accvgpr_write_b32 a56, 0
    v_accvgpr_write_b32 a57, 0
    v_accvgpr_write_b32 a58, 0
    v_accvgpr_write_b32 a59, 0
    v_accvgpr_write_b32 a60, 0
    v_accvgpr_write_b32 a61, 0
    v_accvgpr_write_b32 a62, 0
    v_accvgpr_write_b32 a63, 0
    v_accvgpr_write_b32 a64, 0
    v_accvgpr_write_b32 a65, 0
    v_accvgpr_write_b32 a66, 0
    v_accvgpr_write_b32 a67, 0
    v_accvgpr_write_b32 a68, 0
    v_accvgpr_write_b32 a69, 0
    v_accvgpr_write_b32 a70, 0
    v_accvgpr_write_b32 a71, 0
    v_accvgpr_write_b32 a72, 0
    v_accvgpr_write_b32 a73, 0
    v_accvgpr_write_b32 a74, 0
    v_accvgpr_write_b32 a75, 0
    v_accvgpr_write_b32 a76, 0
    v_accvgpr_write_b32 a77, 0
    v_accvgpr_write_b32 a78, 0
    v_accvgpr_write_b32 a79, 0
    v_accvgpr_write_b32 a80, 0
    v_accvgpr_write_b32 a81, 0
    v_accvgpr_write_b32 a82, 0
    v_accvgpr_write_b32 a83, 0
    v_accvgpr_write_b32 a84, 0
    v_accvgpr_write_b32 a85, 0
    v_accvgpr_write_b32 a86, 0
    v_accvgpr_write_b32 a87, 0
    v_accvgpr_write_b32 a88, 0
    v_accvgpr_write_b32 a89, 0
    v_accvgpr_write_b32 a90, 0
    v_accvgpr_write_b32 a91, 0
    v_accvgpr_write_b32 a92, 0
    v_accvgpr_write_b32 a93, 0
    v_accvgpr_write_b32 a94, 0
    v_accvgpr_write_b32 a95, 0
    v_accvgpr_write_b32 a96, 0
    v_accvgpr_write_b32 a97, 0
    v_accvgpr_write_b32 a98, 0
    v_accvgpr_write_b32 a99, 0
    v_accvgpr_write_b32 a100, 0
    v_accvgpr_write_b32 a101, 0
    v_accvgpr_write_b32 a102, 0
    v_accvgpr_write_b32 a103, 0
    v_accvgpr_write_b32 a104, 0
    v_accvgpr_write_b32 a105, 0
    v_accvgpr_write_b32 a106, 0
    v_accvgpr_write_b32 a107, 0
    v_accvgpr_write_b32 a108, 0
    v_accvgpr_write_b32 a109, 0
    v_accvgpr_write_b32 a110, 0
    v_accvgpr_write_b32 a111, 0
    v_accvgpr_write_b32 a112, 0
    v_accvgpr_write_b32 a113, 0
    v_accvgpr_write_b32 a114, 0
    v_accvgpr_write_b32 a115, 0
    v_accvgpr_write_b32 a116, 0
    v_accvgpr_write_b32 a117, 0
    v_accvgpr_write_b32 a118, 0
    v_accvgpr_write_b32 a119, 0
    v_accvgpr_write_b32 a120, 0
    v_accvgpr_write_b32 a121, 0
    v_accvgpr_write_b32 a122, 0
    v_accvgpr_write_b32 a123, 0
    v_accvgpr_write_b32 a124, 0
    v_accvgpr_write_b32 a125, 0
    v_accvgpr_write_b32 a126, 0
    v_accvgpr_write_b32 a127, 0
    v_accvgpr_write_b32 a128, 0
    v_accvgpr_write_b32 a129, 0
    v_accvgpr_write_b32 a130, 0
    v_accvgpr_write_b32 a131, 0
    v_accvgpr_write_b32 a132, 0
    v_accvgpr_write_b32 a133, 0
    v_accvgpr_write_b32 a134, 0
    v_accvgpr_write_b32 a135, 0
    v_accvgpr_write_b32 a136, 0
    v_accvgpr_write_b32 a137, 0
    v_accvgpr_write_b32 a138, 0
    v_accvgpr_write_b32 a139, 0
    v_accvgpr_write_b32 a140, 0
    v_accvgpr_write_b32 a141, 0
    v_accvgpr_write_b32 a142, 0
    v_accvgpr_write_b32 a143, 0
    v_accvgpr_write_b32 a144, 0
    v_accvgpr_write_b32 a145, 0
    v_accvgpr_write_b32 a146, 0
    v_accvgpr_write_b32 a147, 0
    v_accvgpr_write_b32 a148, 0
    v_accvgpr_write_b32 a149, 0
    v_accvgpr_write_b32 a150, 0
    v_accvgpr_write_b32 a151, 0
    v_accvgpr_write_b32 a152, 0
    v_accvgpr_write_b32 a153, 0
    v_accvgpr_write_b32 a154, 0
    v_accvgpr_write_b32 a155, 0
    v_accvgpr_write_b32 a156, 0
    v_accvgpr_write_b32 a157, 0
    v_accvgpr_write_b32 a158, 0
    v_accvgpr_write_b32 a159, 0
    v_accvgpr_write_b32 a160, 0
    v_accvgpr_write_b32 a161, 0
    v_accvgpr_write_b32 a162, 0
    v_accvgpr_write_b32 a163, 0
    v_accvgpr_write_b32 a164, 0
    v_accvgpr_write_b32 a165, 0
    v_accvgpr_write_b32 a166, 0
    v_accvgpr_write_b32 a167, 0
    v_accvgpr_write_b32 a168, 0
    v_accvgpr_write_b32 a169, 0
    v_accvgpr_write_b32 a170, 0
    v_accvgpr_write_b32 a171, 0
    v_accvgpr_write_b32 a172, 0
    v_accvgpr_write_b32 a173, 0
    v_accvgpr_write_b32 a174, 0
    v_accvgpr_write_b32 a175, 0
    v_accvgpr_write_b32 a176, 0
    v_accvgpr_write_b32 a177, 0
    v_accvgpr_write_b32 a178, 0
    v_accvgpr_write_b32 a179, 0
    v_accvgpr_write_b32 a180, 0
    v_accvgpr_write_b32 a181, 0
    v_accvgpr_write_b32 a182, 0
    v_accvgpr_write_b32 a183, 0
    v_accvgpr_write_b32 a184, 0
    v_accvgpr_write_b32 a185, 0
    v_accvgpr_write_b32 a186, 0
    v_accvgpr_write_b32 a187, 0
    v_accvgpr_write_b32 a188, 0
    v_accvgpr_write_b32 a189, 0
    v_accvgpr_write_b32 a190, 0
    v_accvgpr_write_b32 a191, 0
    v_mov_b32 v5, 0
    v_mov_b32 v240, 0xff7fffff
    v_mov_b32 v6, 0
    v_mov_b32 v241, 0xff7fffff
    v_mov_b32 v7, 0
    v_mov_b32 v242, 0xff7fffff
    v_mov_b32 v8, 0
    v_mov_b32 v243, 0xff7fffff
    v_subrev_u32 v244, 49152, v2
    v_subrev_u32 v245, 49152, v3
    v_subrev_u32 v246, 24576, v1
    s_mov_b32 s48, 0
L_slowloop:
    s_add_u32 s49, s48, 6144
    s_add_u32 s50, s48, 12288
    s_add_u32 s51, s48, 16384
    s_add_u32 s52, s48, 20480
    buffer_load_dwordx4 v[64:67], v244, s[4:7], s48 offen offset:0 sc1
    buffer_load_dwordx4 v[68:71], v245, s[4:7], s48 offen offset:0 sc1
    buffer_load_dwordx4 v[72:75], v244, s[4:7], s49 offen offset:0 sc1
    buffer_load_dwordx4 v[76:79], v245, s[4:7], s49 offen offset:0 sc1
    buffer_load_dwordx4 v[80:83], v244, s[4:7], s48 offen offset:128 sc1
    buffer_load_dwordx4 v[84:87], v245, s[4:7], s48 offen offset:128 sc1
    buffer_load_dwordx4 v[88:91], v244, s[4:7], s49 offen offset:128 sc1
    buffer_load_dwordx4 v[92:95], v245, s[4:7], s49 offen offset:128 sc1
    buffer_load_dwordx4 v[96:99], v244, s[4:7], s48 offen offset:256 sc1
    buffer_load_dwordx4 v[100:103], v245, s[4:7], s48 offen offset:256 sc1
    buffer_load_dwordx4 v[104:107], v244, s[4:7], s49 offen offset:256 sc1
    buffer_load_dwordx4 v[108:111], v245, s[4:7], s49 offen offset:256 sc1
    buffer_load_dwordx4 v[112:115], v246, s[4:7], s50 offen offset:0 sc1
    buffer_load_dwordx4 v[116:119], v246, s[4:7], s50 offen offset:1024 sc1
    buffer_load_dwordx4 v[120:123], v246, s[4:7], s50 offen offset:2048 sc1
    buffer_load_dwordx4 v[124:127], v246, s[4:7], s50 offen offset:3072 sc1
    buffer_load_dwordx4 v[128:131], v246, s[4:7], s51 offen offset:0 sc1
    buffer_load_dwordx4 v[132:135], v246, s[4:7], s51 offen offset:1024 sc1
    buffer_load_dwordx4 v[136:139], v246, s[4:7], s51 offen offset:2048 sc1
    buffer_load_dwordx4 v[140:143], v246, s[4:7], s51 offen offset:3072 sc1
    buffer_load_dwordx4 v[144:147], v246, s[4:7], s52 offen offset:0 sc1
    buffer_load_dwordx4 v[148:151], v246, s[4:7], s52 offen offset:1024 sc1
    buffer_load_dwordx4 v[152:155], v246, s[4:7], s52 offen offset:2048 sc1
    buffer_load_dwordx4 v[156:159], v246, s[4:7], s52 offen offset:3072 sc1
    s_waitcnt vmcnt(12)
    v_mfma_f32_16x16x32_bf16 v[160:163], v[64:67], a[192:195], 0
    v_mfma_f32_16x16x32_bf16 v[168:171], v[64:67], a[216:219], 0
    v_mfma_f32_16x16x32_bf16 v[176:179], v[64:67], a[240:243], 0
    v_mfma_f32_16x16x32_bf16 v[184:187], v[64:67], v[200:203], 0
    v_mfma_f32_16x16x32_bf16 v[160:163], v[68:71], a[196:199], v[160:163]
    v_mfma_f32_16x16x32_bf16 v[168:171], v[68:71], a[220:223], v[168:171]
    v_mfma_f32_16x16x32_bf16 v[176:179], v[68:71], a[244:247], v[176:179]
    v_mfma_f32_16x16x32_bf16 v[184:187], v[68:71], v[204:207], v[184:187]
    v_mfma_f32_16x16x32_bf16 v[164:167], v[72:75], a[192:195], 0
    v_mfma_f32_16x16x32_bf16 v[172:175], v[72:75], a[216:219], 0
    v_mfma_f32_16x16x32_bf16 v[180:183], v[72:75], a[240:243], 0
    v_mfma_f32_16x16x32_bf16 v[188:191], v[72:75], v[200:203], 0
    v_mfma_f32_16x16x32_bf16 v[164:167], v[76:79], a[196:199], v[164:167]
    v_mfma_f32_16x16x32_bf16 v[172:175], v[76:79], a[220:223], v[172:175]
    v_mfma_f32_16x16x32_bf16 v[180:183], v[76:79], a[244:247], v[180:183]
    v_mfma_f32_16x16x32_bf16 v[188:191], v[76:79], v[204:207], v[188:191]
    v_mfma_f32_16x16x32_bf16 v[160:163], v[80:83], a[200:203], v[160:163]
    v_mfma_f32_16x16x32_bf16 v[168:171], v[80:83], a[224:227], v[168:171]
    v_mfma_f32_16x16x32_bf16 v[176:179], v[80:83], a[248:251], v[176:179]
    v_mfma_f32_16x16x32_bf16 v[184:187], v[80:83], v[208:211], v[184:187]
    v_mfma_f32_16x16x32_bf16 v[160:163], v[84:87], a[204:207], v[160:163]
    v_mfma_f32_16x16x32_bf16 v[168:171], v[84:87], a[228:231], v[168:171]
    v_mfma_f32_16x16x32_bf16 v[176:179], v[84:87], a[252:255], v[176:179]
    v_mfma_f32_16x16x32_bf16 v[184:187], v[84:87], v[212:215], v[184:187]
    v_mfma_f32_16x16x32_bf16 v[164:167], v[88:91], a[200:203], v[164:167]
    v_mfma_f32_16x16x32_bf16 v[172:175], v[88:91], a[224:227], v[172:175]
    v_mfma_f32_16x16x32_bf16 v[180:183], v[88:91], a[248:251], v[180:183]
    v_mfma_f32_16x16x32_bf16 v[188:191], v[88:91], v[208:211], v[188:191]
    v_mfma_f32_16x16x32_bf16 v[164:167], v[92:95], a[204:207], v[164:167]
    v_mfma_f32_16x16x32_bf16 v[172:175], v[92:95], a[228:231], v[172:175]
    v_mfma_f32_16x16x32_bf16 v[180:183], v[92:95], a[252:255], v[180:183]
    v_mfma_f32_16x16x32_bf16 v[188:191], v[92:95], v[212:215], v[188:191]
    v_mfma_f32_16x16x32_bf16 v[160:163], v[96:99], a[208:211], v[160:163]
    v_mfma_f32_16x16x32_bf16 v[168:171], v[96:99], a[232:235], v[168:171]
    v_mfma_f32_16x16x32_bf16 v[176:179], v[96:99], v[192:195], v[176:179]
    v_mfma_f32_16x16x32_bf16 v[184:187], v[96:99], v[216:219], v[184:187]
    v_mfma_f32_16x16x32_bf16 v[160:163], v[100:103], a[212:215], v[160:163]
    v_mfma_f32_16x16x32_bf16 v[168:171], v[100:103], a[236:239], v[168:171]
    v_mfma_f32_16x16x32_bf16 v[176:179], v[100:103], v[196:199], v[176:179]
    v_mfma_f32_16x16x32_bf16 v[184:187], v[100:103], v[220:223], v[184:187]
    v_mfma_f32_16x16x32_bf16 v[164:167], v[104:107], a[208:211], v[164:167]
    v_mfma_f32_16x16x32_bf16 v[172:175], v[104:107], a[232:235], v[172:175]
    v_mfma_f32_16x16x32_bf16 v[180:183], v[104:107], v[192:195], v[180:183]
    v_mfma_f32_16x16x32_bf16 v[188:191], v[104:107], v[216:219], v[188:191]
    v_mfma_f32_16x16x32_bf16 v[164:167], v[108:111], a[212:215], v[164:167]
    v_mfma_f32_16x16x32_bf16 v[172:175], v[108:111], a[236:239], v[172:175]
    v_mfma_f32_16x16x32_bf16 v[180:183], v[108:111], v[196:199], v[180:183]
    v_mfma_f32_16x16x32_bf16 v[188:191], v[108:111], v[220:223], v[188:191]
    s_nop 9
    v_max3_f32 v16, v160, v161, v162
    v_max3_f32 v16, v16, v163, v164
    v_max3_f32 v16, v16, v165, v166
    v_max3_f32 v16, v16, v167, v240
    v_mov_b32 v17, v16
    s_nop 1
    v_permlane16_swap_b32 v16, v17
    s_nop 1
    v_max_f32 v16, v16, v17
    v_mov_b32 v17, v16
    s_nop 1
    v_permlane32_swap_b32 v16, v17
    s_nop 1
    v_max_f32 v16, v16, v17
    v_sub_f32 v17, v240, v16
    v_exp_f32 v17, v17
    v_mov_b32 v240, v16
    v_sub_f32 v160, v160, v16
    v_sub_f32 v161, v161, v16
    v_sub_f32 v162, v162, v16
    v_sub_f32 v163, v163, v16
    v_sub_f32 v164, v164, v16
    v_sub_f32 v165, v165, v16
    v_sub_f32 v166, v166, v16
    v_sub_f32 v167, v167, v16
    v_exp_f32 v160, v160
    v_exp_f32 v161, v161
    v_exp_f32 v162, v162
    v_exp_f32 v163, v163
    v_exp_f32 v164, v164
    v_exp_f32 v165, v165
    v_exp_f32 v166, v166
    v_exp_f32 v167, v167
    v_mul_f32 v5, v5, v17
    v_add_f32 v5, v5, v160
    v_add_f32 v5, v5, v161
    v_add_f32 v5, v5, v162
    v_add_f32 v5, v5, v163
    v_add_f32 v5, v5, v164
    v_add_f32 v5, v5, v165
    v_add_f32 v5, v5, v166
    v_add_f32 v5, v5, v167
    v_cvt_pk_bf16_f32 v224, v160, v161
    v_cvt_pk_bf16_f32 v225, v162, v163
    v_cvt_pk_bf16_f32 v226, v164, v165
    v_cvt_pk_bf16_f32 v227, v166, v167
    v_accvgpr_read_b32 v18, a0
    v_mul_f32 v18, v18, v17
    v_accvgpr_write_b32 a0, v18
    v_accvgpr_read_b32 v19, a1
    v_mul_f32 v19, v19, v17
    v_accvgpr_write_b32 a1, v19
    v_accvgpr_read_b32 v18, a2
    v_mul_f32 v18, v18, v17
    v_accvgpr_write_b32 a2, v18
    v_accvgpr_read_b32 v19, a3
    v_mul_f32 v19, v19, v17
    v_accvgpr_write_b32 a3, v19
    v_accvgpr_read_b32 v18, a4
    v_mul_f32 v18, v18, v17
    v_accvgpr_write_b32 a4, v18
    v_accvgpr_read_b32 v19, a5
    v_mul_f32 v19, v19, v17
    v_accvgpr_write_b32 a5, v19
    v_accvgpr_read_b32 v18, a6
    v_mul_f32 v18, v18, v17
    v_accvgpr_write_b32 a6, v18
    v_accvgpr_read_b32 v19, a7
    v_mul_f32 v19, v19, v17
    v_accvgpr_write_b32 a7, v19
    v_accvgpr_read_b32 v18, a8
    v_mul_f32 v18, v18, v17
    v_accvgpr_write_b32 a8, v18
    v_accvgpr_read_b32 v19, a9
    v_mul_f32 v19, v19, v17
    v_accvgpr_write_b32 a9, v19
    v_accvgpr_read_b32 v18, a10
    v_mul_f32 v18, v18, v17
    v_accvgpr_write_b32 a10, v18
    v_accvgpr_read_b32 v19, a11
    v_mul_f32 v19, v19, v17
    v_accvgpr_write_b32 a11, v19
    v_accvgpr_read_b32 v18, a12
    v_mul_f32 v18, v18, v17
    v_accvgpr_write_b32 a12, v18
    v_accvgpr_read_b32 v19, a13
    v_mul_f32 v19, v19, v17
    v_accvgpr_write_b32 a13, v19
    v_accvgpr_read_b32 v18, a14
    v_mul_f32 v18, v18, v17
    v_accvgpr_write_b32 a14, v18
    v_accvgpr_read_b32 v19, a15
    v_mul_f32 v19, v19, v17
    v_accvgpr_write_b32 a15, v19
    v_accvgpr_read_b32 v18, a16
    v_mul_f32 v18, v18, v17
    v_accvgpr_write_b32 a16, v18
    v_accvgpr_read_b32 v19, a17
    v_mul_f32 v19, v19, v17
    v_accvgpr_write_b32 a17, v19
    v_accvgpr_read_b32 v18, a18
    v_mul_f32 v18, v18, v17
    v_accvgpr_write_b32 a18, v18
    v_accvgpr_read_b32 v19, a19
    v_mul_f32 v19, v19, v17
    v_accvgpr_write_b32 a19, v19
    v_accvgpr_read_b32 v18, a20
    v_mul_f32 v18, v18, v17
    v_accvgpr_write_b32 a20, v18
    v_accvgpr_read_b32 v19, a21
    v_mul_f32 v19, v19, v17
    v_accvgpr_write_b32 a21, v19
    v_accvgpr_read_b32 v18, a22
    v_mul_f32 v18, v18, v17
    v_accvgpr_write_b32 a22, v18
    v_accvgpr_read_b32 v19, a23
    v_mul_f32 v19, v19, v17
    v_accvgpr_write_b32 a23, v19
    v_accvgpr_read_b32 v18, a24
    v_mul_f32 v18, v18, v17
    v_accvgpr_write_b32 a24, v18
    v_accvgpr_read_b32 v19, a25
    v_mul_f32 v19, v19, v17
    v_accvgpr_write_b32 a25, v19
    v_accvgpr_read_b32 v18, a26
    v_mul_f32 v18, v18, v17
    v_accvgpr_write_b32 a26, v18
    v_accvgpr_read_b32 v19, a27
    v_mul_f32 v19, v19, v17
    v_accvgpr_write_b32 a27, v19
    v_accvgpr_read_b32 v18, a28
    v_mul_f32 v18, v18, v17
    v_accvgpr_write_b32 a28, v18
    v_accvgpr_read_b32 v19, a29
    v_mul_f32 v19, v19, v17
    v_accvgpr_write_b32 a29, v19
    v_accvgpr_read_b32 v18, a30
    v_mul_f32 v18, v18, v17
    v_accvgpr_write_b32 a30, v18
    v_accvgpr_read_b32 v19, a31
    v_mul_f32 v19, v19, v17
    v_accvgpr_write_b32 a31, v19
    v_accvgpr_read_b32 v18, a32
    v_mul_f32 v18, v18, v17
    v_accvgpr_write_b32 a32, v18
    v_accvgpr_read_b32 v19, a33
    v_mul_f32 v19, v19, v17
    v_accvgpr_write_b32 a33, v19
    v_accvgpr_read_b32 v18, a34
    v_mul_f32 v18, v18, v17
    v_accvgpr_write_b32 a34, v18
    v_accvgpr_read_b32 v19, a35
    v_mul_f32 v19, v19, v17
    v_accvgpr_write_b32 a35, v19
    v_accvgpr_read_b32 v18, a36
    v_mul_f32 v18, v18, v17
    v_accvgpr_write_b32 a36, v18
    v_accvgpr_read_b32 v19, a37
    v_mul_f32 v19, v19, v17
    v_accvgpr_write_b32 a37, v19
    v_accvgpr_read_b32 v18, a38
    v_mul_f32 v18, v18, v17
    v_accvgpr_write_b32 a38, v18
    v_accvgpr_read_b32 v19, a39
    v_mul_f32 v19, v19, v17
    v_accvgpr_write_b32 a39, v19
    v_accvgpr_read_b32 v18, a40
    v_mul_f32 v18, v18, v17
    v_accvgpr_write_b32 a40, v18
    v_accvgpr_read_b32 v19, a41
    v_mul_f32 v19, v19, v17
    v_accvgpr_write_b32 a41, v19
    v_accvgpr_read_b32 v18, a42
    v_mul_f32 v18, v18, v17
    v_accvgpr_write_b32 a42, v18
    v_accvgpr_read_b32 v19, a43
    v_mul_f32 v19, v19, v17
    v_accvgpr_write_b32 a43, v19
    v_accvgpr_read_b32 v18, a44
    v_mul_f32 v18, v18, v17
    v_accvgpr_write_b32 a44, v18
    v_accvgpr_read_b32 v19, a45
    v_mul_f32 v19, v19, v17
    v_accvgpr_write_b32 a45, v19
    v_accvgpr_read_b32 v18, a46
    v_mul_f32 v18, v18, v17
    v_accvgpr_write_b32 a46, v18
    v_accvgpr_read_b32 v19, a47
    v_mul_f32 v19, v19, v17
    v_accvgpr_write_b32 a47, v19
    v_max3_f32 v16, v168, v169, v170
    v_max3_f32 v16, v16, v171, v172
    v_max3_f32 v16, v16, v173, v174
    v_max3_f32 v16, v16, v175, v241
    v_mov_b32 v17, v16
    s_nop 1
    v_permlane16_swap_b32 v16, v17
    s_nop 1
    v_max_f32 v16, v16, v17
    v_mov_b32 v17, v16
    s_nop 1
    v_permlane32_swap_b32 v16, v17
    s_nop 1
    v_max_f32 v16, v16, v17
    v_sub_f32 v17, v241, v16
    v_exp_f32 v17, v17
    v_mov_b32 v241, v16
    v_sub_f32 v168, v168, v16
    v_sub_f32 v169, v169, v16
    v_sub_f32 v170, v170, v16
    v_sub_f32 v171, v171, v16
    v_sub_f32 v172, v172, v16
    v_sub_f32 v173, v173, v16
    v_sub_f32 v174, v174, v16
    v_sub_f32 v175, v175, v16
    v_exp_f32 v168, v168
    v_exp_f32 v169, v169
    v_exp_f32 v170, v170
    v_exp_f32 v171, v171
    v_exp_f32 v172, v172
    v_exp_f32 v173, v173
    v_exp_f32 v174, v174
    v_exp_f32 v175, v175
    v_mul_f32 v6, v6, v17
    v_add_f32 v6, v6, v168
    v_add_f32 v6, v6, v169
    v_add_f32 v6, v6, v170
    v_add_f32 v6, v6, v171
    v_add_f32 v6, v6, v172
    v_add_f32 v6, v6, v173
    v_add_f32 v6, v6, v174
    v_add_f32 v6, v6, v175
    v_cvt_pk_bf16_f32 v228, v168, v169
    v_cvt_pk_bf16_f32 v229, v170, v171
    v_cvt_pk_bf16_f32 v230, v172, v173
    v_cvt_pk_bf16_f32 v231, v174, v175
    v_accvgpr_read_b32 v18, a48
    v_mul_f32 v18, v18, v17
    v_accvgpr_write_b32 a48, v18
    v_accvgpr_read_b32 v19, a49
    v_mul_f32 v19, v19, v17
    v_accvgpr_write_b32 a49, v19
    v_accvgpr_read_b32 v18, a50
    v_mul_f32 v18, v18, v17
    v_accvgpr_write_b32 a50, v18
    v_accvgpr_read_b32 v19, a51
    v_mul_f32 v19, v19, v17
    v_accvgpr_write_b32 a51, v19
    v_accvgpr_read_b32 v18, a52
    v_mul_f32 v18, v18, v17
    v_accvgpr_write_b32 a52, v18
    v_accvgpr_read_b32 v19, a53
    v_mul_f32 v19, v19, v17
    v_accvgpr_write_b32 a53, v19
    v_accvgpr_read_b32 v18, a54
    v_mul_f32 v18, v18, v17
    v_accvgpr_write_b32 a54, v18
    v_accvgpr_read_b32 v19, a55
    v_mul_f32 v19, v19, v17
    v_accvgpr_write_b32 a55, v19
    v_accvgpr_read_b32 v18, a56
    v_mul_f32 v18, v18, v17
    v_accvgpr_write_b32 a56, v18
    v_accvgpr_read_b32 v19, a57
    v_mul_f32 v19, v19, v17
    v_accvgpr_write_b32 a57, v19
    v_accvgpr_read_b32 v18, a58
    v_mul_f32 v18, v18, v17
    v_accvgpr_write_b32 a58, v18
    v_accvgpr_read_b32 v19, a59
    v_mul_f32 v19, v19, v17
    v_accvgpr_write_b32 a59, v19
    v_accvgpr_read_b32 v18, a60
    v_mul_f32 v18, v18, v17
    v_accvgpr_write_b32 a60, v18
    v_accvgpr_read_b32 v19, a61
    v_mul_f32 v19, v19, v17
    v_accvgpr_write_b32 a61, v19
    v_accvgpr_read_b32 v18, a62
    v_mul_f32 v18, v18, v17
    v_accvgpr_write_b32 a62, v18
    v_accvgpr_read_b32 v19, a63
    v_mul_f32 v19, v19, v17
    v_accvgpr_write_b32 a63, v19
    v_accvgpr_read_b32 v18, a64
    v_mul_f32 v18, v18, v17
    v_accvgpr_write_b32 a64, v18
    v_accvgpr_read_b32 v19, a65
    v_mul_f32 v19, v19, v17
    v_accvgpr_write_b32 a65, v19
    v_accvgpr_read_b32 v18, a66
    v_mul_f32 v18, v18, v17
    v_accvgpr_write_b32 a66, v18
    v_accvgpr_read_b32 v19, a67
    v_mul_f32 v19, v19, v17
    v_accvgpr_write_b32 a67, v19
    v_accvgpr_read_b32 v18, a68
    v_mul_f32 v18, v18, v17
    v_accvgpr_write_b32 a68, v18
    v_accvgpr_read_b32 v19, a69
    v_mul_f32 v19, v19, v17
    v_accvgpr_write_b32 a69, v19
    v_accvgpr_read_b32 v18, a70
    v_mul_f32 v18, v18, v17
    v_accvgpr_write_b32 a70, v18
    v_accvgpr_read_b32 v19, a71
    v_mul_f32 v19, v19, v17
    v_accvgpr_write_b32 a71, v19
    v_accvgpr_read_b32 v18, a72
    v_mul_f32 v18, v18, v17
    v_accvgpr_write_b32 a72, v18
    v_accvgpr_read_b32 v19, a73
    v_mul_f32 v19, v19, v17
    v_accvgpr_write_b32 a73, v19
    v_accvgpr_read_b32 v18, a74
    v_mul_f32 v18, v18, v17
    v_accvgpr_write_b32 a74, v18
    v_accvgpr_read_b32 v19, a75
    v_mul_f32 v19, v19, v17
    v_accvgpr_write_b32 a75, v19
    v_accvgpr_read_b32 v18, a76
    v_mul_f32 v18, v18, v17
    v_accvgpr_write_b32 a76, v18
    v_accvgpr_read_b32 v19, a77
    v_mul_f32 v19, v19, v17
    v_accvgpr_write_b32 a77, v19
    v_accvgpr_read_b32 v18, a78
    v_mul_f32 v18, v18, v17
    v_accvgpr_write_b32 a78, v18
    v_accvgpr_read_b32 v19, a79
    v_mul_f32 v19, v19, v17
    v_accvgpr_write_b32 a79, v19
    v_accvgpr_read_b32 v18, a80
    v_mul_f32 v18, v18, v17
    v_accvgpr_write_b32 a80, v18
    v_accvgpr_read_b32 v19, a81
    v_mul_f32 v19, v19, v17
    v_accvgpr_write_b32 a81, v19
    v_accvgpr_read_b32 v18, a82
    v_mul_f32 v18, v18, v17
    v_accvgpr_write_b32 a82, v18
    v_accvgpr_read_b32 v19, a83
    v_mul_f32 v19, v19, v17
    v_accvgpr_write_b32 a83, v19
    v_accvgpr_read_b32 v18, a84
    v_mul_f32 v18, v18, v17
    v_accvgpr_write_b32 a84, v18
    v_accvgpr_read_b32 v19, a85
    v_mul_f32 v19, v19, v17
    v_accvgpr_write_b32 a85, v19
    v_accvgpr_read_b32 v18, a86
    v_mul_f32 v18, v18, v17
    v_accvgpr_write_b32 a86, v18
    v_accvgpr_read_b32 v19, a87
    v_mul_f32 v19, v19, v17
    v_accvgpr_write_b32 a87, v19
    v_accvgpr_read_b32 v18, a88
    v_mul_f32 v18, v18, v17
    v_accvgpr_write_b32 a88, v18
    v_accvgpr_read_b32 v19, a89
    v_mul_f32 v19, v19, v17
    v_accvgpr_write_b32 a89, v19
    v_accvgpr_read_b32 v18, a90
    v_mul_f32 v18, v18, v17
    v_accvgpr_write_b32 a90, v18
    v_accvgpr_read_b32 v19, a91
    v_mul_f32 v19, v19, v17
    v_accvgpr_write_b32 a91, v19
    v_accvgpr_read_b32 v18, a92
    v_mul_f32 v18, v18, v17
    v_accvgpr_write_b32 a92, v18
    v_accvgpr_read_b32 v19, a93
    v_mul_f32 v19, v19, v17
    v_accvgpr_write_b32 a93, v19
    v_accvgpr_read_b32 v18, a94
    v_mul_f32 v18, v18, v17
    v_accvgpr_write_b32 a94, v18
    v_accvgpr_read_b32 v19, a95
    v_mul_f32 v19, v19, v17
    v_accvgpr_write_b32 a95, v19
    v_max3_f32 v16, v176, v177, v178
    v_max3_f32 v16, v16, v179, v180
    v_max3_f32 v16, v16, v181, v182
    v_max3_f32 v16, v16, v183, v242
    v_mov_b32 v17, v16
    s_nop 1
    v_permlane16_swap_b32 v16, v17
    s_nop 1
    v_max_f32 v16, v16, v17
    v_mov_b32 v17, v16
    s_nop 1
    v_permlane32_swap_b32 v16, v17
    s_nop 1
    v_max_f32 v16, v16, v17
    v_sub_f32 v17, v242, v16
    v_exp_f32 v17, v17
    v_mov_b32 v242, v16
    v_sub_f32 v176, v176, v16
    v_sub_f32 v177, v177, v16
    v_sub_f32 v178, v178, v16
    v_sub_f32 v179, v179, v16
    v_sub_f32 v180, v180, v16
    v_sub_f32 v181, v181, v16
    v_sub_f32 v182, v182, v16
    v_sub_f32 v183, v183, v16
    v_exp_f32 v176, v176
    v_exp_f32 v177, v177
    v_exp_f32 v178, v178
    v_exp_f32 v179, v179
    v_exp_f32 v180, v180
    v_exp_f32 v181, v181
    v_exp_f32 v182, v182
    v_exp_f32 v183, v183
    v_mul_f32 v7, v7, v17
    v_add_f32 v7, v7, v176
    v_add_f32 v7, v7, v177
    v_add_f32 v7, v7, v178
    v_add_f32 v7, v7, v179
    v_add_f32 v7, v7, v180
    v_add_f32 v7, v7, v181
    v_add_f32 v7, v7, v182
    v_add_f32 v7, v7, v183
    v_cvt_pk_bf16_f32 v232, v176, v177
    v_cvt_pk_bf16_f32 v233, v178, v179
    v_cvt_pk_bf16_f32 v234, v180, v181
    v_cvt_pk_bf16_f32 v235, v182, v183
    v_accvgpr_read_b32 v18, a96
    v_mul_f32 v18, v18, v17
    v_accvgpr_write_b32 a96, v18
    v_accvgpr_read_b32 v19, a97
    v_mul_f32 v19, v19, v17
    v_accvgpr_write_b32 a97, v19
    v_accvgpr_read_b32 v18, a98
    v_mul_f32 v18, v18, v17
    v_accvgpr_write_b32 a98, v18
    v_accvgpr_read_b32 v19, a99
    v_mul_f32 v19, v19, v17
    v_accvgpr_write_b32 a99, v19
    v_accvgpr_read_b32 v18, a100
    v_mul_f32 v18, v18, v17
    v_accvgpr_write_b32 a100, v18
    v_accvgpr_read_b32 v19, a101
    v_mul_f32 v19, v19, v17
    v_accvgpr_write_b32 a101, v19
    v_accvgpr_read_b32 v18, a102
    v_mul_f32 v18, v18, v17
    v_accvgpr_write_b32 a102, v18
    v_accvgpr_read_b32 v19, a103
    v_mul_f32 v19, v19, v17
    v_accvgpr_write_b32 a103, v19
    v_accvgpr_read_b32 v18, a104
    v_mul_f32 v18, v18, v17
    v_accvgpr_write_b32 a104, v18
    v_accvgpr_read_b32 v19, a105
    v_mul_f32 v19, v19, v17
    v_accvgpr_write_b32 a105, v19
    v_accvgpr_read_b32 v18, a106
    v_mul_f32 v18, v18, v17
    v_accvgpr_write_b32 a106, v18
    v_accvgpr_read_b32 v19, a107
    v_mul_f32 v19, v19, v17
    v_accvgpr_write_b32 a107, v19
    v_accvgpr_read_b32 v18, a108
    v_mul_f32 v18, v18, v17
    v_accvgpr_write_b32 a108, v18
    v_accvgpr_read_b32 v19, a109
    v_mul_f32 v19, v19, v17
    v_accvgpr_write_b32 a109, v19
    v_accvgpr_read_b32 v18, a110
    v_mul_f32 v18, v18, v17
    v_accvgpr_write_b32 a110, v18
    v_accvgpr_read_b32 v19, a111
    v_mul_f32 v19, v19, v17
    v_accvgpr_write_b32 a111, v19
    v_accvgpr_read_b32 v18, a112
    v_mul_f32 v18, v18, v17
    v_accvgpr_write_b32 a112, v18
    v_accvgpr_read_b32 v19, a113
    v_mul_f32 v19, v19, v17
    v_accvgpr_write_b32 a113, v19
    v_accvgpr_read_b32 v18, a114
    v_mul_f32 v18, v18, v17
    v_accvgpr_write_b32 a114, v18
    v_accvgpr_read_b32 v19, a115
    v_mul_f32 v19, v19, v17
    v_accvgpr_write_b32 a115, v19
    v_accvgpr_read_b32 v18, a116
    v_mul_f32 v18, v18, v17
    v_accvgpr_write_b32 a116, v18
    v_accvgpr_read_b32 v19, a117
    v_mul_f32 v19, v19, v17
    v_accvgpr_write_b32 a117, v19
    v_accvgpr_read_b32 v18, a118
    v_mul_f32 v18, v18, v17
    v_accvgpr_write_b32 a118, v18
    v_accvgpr_read_b32 v19, a119
    v_mul_f32 v19, v19, v17
    v_accvgpr_write_b32 a119, v19
    v_accvgpr_read_b32 v18, a120
    v_mul_f32 v18, v18, v17
    v_accvgpr_write_b32 a120, v18
    v_accvgpr_read_b32 v19, a121
    v_mul_f32 v19, v19, v17
    v_accvgpr_write_b32 a121, v19
    v_accvgpr_read_b32 v18, a122
    v_mul_f32 v18, v18, v17
    v_accvgpr_write_b32 a122, v18
    v_accvgpr_read_b32 v19, a123
    v_mul_f32 v19, v19, v17
    v_accvgpr_write_b32 a123, v19
    v_accvgpr_read_b32 v18, a124
    v_mul_f32 v18, v18, v17
    v_accvgpr_write_b32 a124, v18
    v_accvgpr_read_b32 v19, a125
    v_mul_f32 v19, v19, v17
    v_accvgpr_write_b32 a125, v19
    v_accvgpr_read_b32 v18, a126
    v_mul_f32 v18, v18, v17
    v_accvgpr_write_b32 a126, v18
    v_accvgpr_read_b32 v19, a127
    v_mul_f32 v19, v19, v17
    v_accvgpr_write_b32 a127, v19
    v_accvgpr_read_b32 v18, a128
    v_mul_f32 v18, v18, v17
    v_accvgpr_write_b32 a128, v18
    v_accvgpr_read_b32 v19, a129
    v_mul_f32 v19, v19, v17
    v_accvgpr_write_b32 a129, v19
    v_accvgpr_read_b32 v18, a130
    v_mul_f32 v18, v18, v17
    v_accvgpr_write_b32 a130, v18
    v_accvgpr_read_b32 v19, a131
    v_mul_f32 v19, v19, v17
    v_accvgpr_write_b32 a131, v19
    v_accvgpr_read_b32 v18, a132
    v_mul_f32 v18, v18, v17
    v_accvgpr_write_b32 a132, v18
    v_accvgpr_read_b32 v19, a133
    v_mul_f32 v19, v19, v17
    v_accvgpr_write_b32 a133, v19
    v_accvgpr_read_b32 v18, a134
    v_mul_f32 v18, v18, v17
    v_accvgpr_write_b32 a134, v18
    v_accvgpr_read_b32 v19, a135
    v_mul_f32 v19, v19, v17
    v_accvgpr_write_b32 a135, v19
    v_accvgpr_read_b32 v18, a136
    v_mul_f32 v18, v18, v17
    v_accvgpr_write_b32 a136, v18
    v_accvgpr_read_b32 v19, a137
    v_mul_f32 v19, v19, v17
    v_accvgpr_write_b32 a137, v19
    v_accvgpr_read_b32 v18, a138
    v_mul_f32 v18, v18, v17
    v_accvgpr_write_b32 a138, v18
    v_accvgpr_read_b32 v19, a139
    v_mul_f32 v19, v19, v17
    v_accvgpr_write_b32 a139, v19
    v_accvgpr_read_b32 v18, a140
    v_mul_f32 v18, v18, v17
    v_accvgpr_write_b32 a140, v18
    v_accvgpr_read_b32 v19, a141
    v_mul_f32 v19, v19, v17
    v_accvgpr_write_b32 a141, v19
    v_accvgpr_read_b32 v18, a142
    v_mul_f32 v18, v18, v17
    v_accvgpr_write_b32 a142, v18
    v_accvgpr_read_b32 v19, a143
    v_mul_f32 v19, v19, v17
    v_accvgpr_write_b32 a143, v19
    v_max3_f32 v16, v184, v185, v186
    v_max3_f32 v16, v16, v187, v188
    v_max3_f32 v16, v16, v189, v190
    v_max3_f32 v16, v16, v191, v243
    v_mov_b32 v17, v16
    s_nop 1
    v_permlane16_swap_b32 v16, v17
    s_nop 1
    v_max_f32 v16, v16, v17
    v_mov_b32 v17, v16
    s_nop 1
    v_permlane32_swap_b32 v16, v17
    s_nop 1
    v_max_f32 v16, v16, v17
    v_sub_f32 v17, v243, v16
    v_exp_f32 v17, v17
    v_mov_b32 v243, v16
    v_sub_f32 v184, v184, v16
    v_sub_f32 v185, v185, v16
    v_sub_f32 v186, v186, v16
    v_sub_f32 v187, v187, v16
    v_sub_f32 v188, v188, v16
    v_sub_f32 v189, v189, v16
    v_sub_f32 v190, v190, v16
    v_sub_f32 v191, v191, v16
    v_exp_f32 v184, v184
    v_exp_f32 v185, v185
    v_exp_f32 v186, v186
    v_exp_f32 v187, v187
    v_exp_f32 v188, v188
    v_exp_f32 v189, v189
    v_exp_f32 v190, v190
    v_exp_f32 v191, v191
    v_mul_f32 v8, v8, v17
    v_add_f32 v8, v8, v184
    v_add_f32 v8, v8, v185
    v_add_f32 v8, v8, v186
    v_add_f32 v8, v8, v187
    v_add_f32 v8, v8, v188
    v_add_f32 v8, v8, v189
    v_add_f32 v8, v8, v190
    v_add_f32 v8, v8, v191
    v_cvt_pk_bf16_f32 v236, v184, v185
    v_cvt_pk_bf16_f32 v237, v186, v187
    v_cvt_pk_bf16_f32 v238, v188, v189
    v_cvt_pk_bf16_f32 v239, v190, v191
    v_accvgpr_read_b32 v18, a144
    v_mul_f32 v18, v18, v17
    v_accvgpr_write_b32 a144, v18
    v_accvgpr_read_b32 v19, a145
    v_mul_f32 v19, v19, v17
    v_accvgpr_write_b32 a145, v19
    v_accvgpr_read_b32 v18, a146
    v_mul_f32 v18, v18, v17
    v_accvgpr_write_b32 a146, v18
    v_accvgpr_read_b32 v19, a147
    v_mul_f32 v19, v19, v17
    v_accvgpr_write_b32 a147, v19
    v_accvgpr_read_b32 v18, a148
    v_mul_f32 v18, v18, v17
    v_accvgpr_write_b32 a148, v18
    v_accvgpr_read_b32 v19, a149
    v_mul_f32 v19, v19, v17
    v_accvgpr_write_b32 a149, v19
    v_accvgpr_read_b32 v18, a150
    v_mul_f32 v18, v18, v17
    v_accvgpr_write_b32 a150, v18
    v_accvgpr_read_b32 v19, a151
    v_mul_f32 v19, v19, v17
    v_accvgpr_write_b32 a151, v19
    v_accvgpr_read_b32 v18, a152
    v_mul_f32 v18, v18, v17
    v_accvgpr_write_b32 a152, v18
    v_accvgpr_read_b32 v19, a153
    v_mul_f32 v19, v19, v17
    v_accvgpr_write_b32 a153, v19
    v_accvgpr_read_b32 v18, a154
    v_mul_f32 v18, v18, v17
    v_accvgpr_write_b32 a154, v18
    v_accvgpr_read_b32 v19, a155
    v_mul_f32 v19, v19, v17
    v_accvgpr_write_b32 a155, v19
    v_accvgpr_read_b32 v18, a156
    v_mul_f32 v18, v18, v17
    v_accvgpr_write_b32 a156, v18
    v_accvgpr_read_b32 v19, a157
    v_mul_f32 v19, v19, v17
    v_accvgpr_write_b32 a157, v19
    v_accvgpr_read_b32 v18, a158
    v_mul_f32 v18, v18, v17
    v_accvgpr_write_b32 a158, v18
    v_accvgpr_read_b32 v19, a159
    v_mul_f32 v19, v19, v17
    v_accvgpr_write_b32 a159, v19
    v_accvgpr_read_b32 v18, a160
    v_mul_f32 v18, v18, v17
    v_accvgpr_write_b32 a160, v18
    v_accvgpr_read_b32 v19, a161
    v_mul_f32 v19, v19, v17
    v_accvgpr_write_b32 a161, v19
    v_accvgpr_read_b32 v18, a162
    v_mul_f32 v18, v18, v17
    v_accvgpr_write_b32 a162, v18
    v_accvgpr_read_b32 v19, a163
    v_mul_f32 v19, v19, v17
    v_accvgpr_write_b32 a163, v19
    v_accvgpr_read_b32 v18, a164
    v_mul_f32 v18, v18, v17
    v_accvgpr_write_b32 a164, v18
    v_accvgpr_read_b32 v19, a165
    v_mul_f32 v19, v19, v17
    v_accvgpr_write_b32 a165, v19
    v_accvgpr_read_b32 v18, a166
    v_mul_f32 v18, v18, v17
    v_accvgpr_write_b32 a166, v18
    v_accvgpr_read_b32 v19, a167
    v_mul_f32 v19, v19, v17
    v_accvgpr_write_b32 a167, v19
    v_accvgpr_read_b32 v18, a168
    v_mul_f32 v18, v18, v17
    v_accvgpr_write_b32 a168, v18
    v_accvgpr_read_b32 v19, a169
    v_mul_f32 v19, v19, v17
    v_accvgpr_write_b32 a169, v19
    v_accvgpr_read_b32 v18, a170
    v_mul_f32 v18, v18, v17
    v_accvgpr_write_b32 a170, v18
    v_accvgpr_read_b32 v19, a171
    v_mul_f32 v19, v19, v17
    v_accvgpr_write_b32 a171, v19
    v_accvgpr_read_b32 v18, a172
    v_mul_f32 v18, v18, v17
    v_accvgpr_write_b32 a172, v18
    v_accvgpr_read_b32 v19, a173
    v_mul_f32 v19, v19, v17
    v_accvgpr_write_b32 a173, v19
    v_accvgpr_read_b32 v18, a174
    v_mul_f32 v18, v18, v17
    v_accvgpr_write_b32 a174, v18
    v_accvgpr_read_b32 v19, a175
    v_mul_f32 v19, v19, v17
    v_accvgpr_write_b32 a175, v19
    v_accvgpr_read_b32 v18, a176
    v_mul_f32 v18, v18, v17
    v_accvgpr_write_b32 a176, v18
    v_accvgpr_read_b32 v19, a177
    v_mul_f32 v19, v19, v17
    v_accvgpr_write_b32 a177, v19
    v_accvgpr_read_b32 v18, a178
    v_mul_f32 v18, v18, v17
    v_accvgpr_write_b32 a178, v18
    v_accvgpr_read_b32 v19, a179
    v_mul_f32 v19, v19, v17
    v_accvgpr_write_b32 a179, v19
    v_accvgpr_read_b32 v18, a180
    v_mul_f32 v18, v18, v17
    v_accvgpr_write_b32 a180, v18
    v_accvgpr_read_b32 v19, a181
    v_mul_f32 v19, v19, v17
    v_accvgpr_write_b32 a181, v19
    v_accvgpr_read_b32 v18, a182
    v_mul_f32 v18, v18, v17
    v_accvgpr_write_b32 a182, v18
    v_accvgpr_read_b32 v19, a183
    v_mul_f32 v19, v19, v17
    v_accvgpr_write_b32 a183, v19
    v_accvgpr_read_b32 v18, a184
    v_mul_f32 v18, v18, v17
    v_accvgpr_write_b32 a184, v18
    v_accvgpr_read_b32 v19, a185
    v_mul_f32 v19, v19, v17
    v_accvgpr_write_b32 a185, v19
    v_accvgpr_read_b32 v18, a186
    v_mul_f32 v18, v18, v17
    v_accvgpr_write_b32 a186, v18
    v_accvgpr_read_b32 v19, a187
    v_mul_f32 v19, v19, v17
    v_accvgpr_write_b32 a187, v19
    v_accvgpr_read_b32 v18, a188
    v_mul_f32 v18, v18, v17
    v_accvgpr_write_b32 a188, v18
    v_accvgpr_read_b32 v19, a189
    v_mul_f32 v19, v19, v17
    v_accvgpr_write_b32 a189, v19
    v_accvgpr_read_b32 v18, a190
    v_mul_f32 v18, v18, v17
    v_accvgpr_write_b32 a190, v18
    v_accvgpr_read_b32 v19, a191
    v_mul_f32 v19, v19, v17
    v_accvgpr_write_b32 a191, v19
    s_waitcnt vmcnt(0)
    s_nop 1
    v_mfma_f32_16x16x32_bf16 a[0:3], v[112:115], v[224:227], a[0:3]
    v_mfma_f32_16x16x32_bf16 a[48:51], v[112:115], v[228:231], a[48:51]
    v_mfma_f32_16x16x32_bf16 a[96:99], v[112:115], v[232:235], a[96:99]
    v_mfma_f32_16x16x32_bf16 a[144:147], v[112:115], v[236:239], a[144:147]
    v_mfma_f32_16x16x32_bf16 a[4:7], v[116:119], v[224:227], a[4:7]
    v_mfma_f32_16x16x32_bf16 a[52:55], v[116:119], v[228:231], a[52:55]
    v_mfma_f32_16x16x32_bf16 a[100:103], v[116:119], v[232:235], a[100:103]
    v_mfma_f32_16x16x32_bf16 a[148:151], v[116:119], v[236:239], a[148:151]
    v_mfma_f32_16x16x32_bf16 a[8:11], v[120:123], v[224:227], a[8:11]
    v_mfma_f32_16x16x32_bf16 a[56:59], v[120:123], v[228:231], a[56:59]
    v_mfma_f32_16x16x32_bf16 a[104:107], v[120:123], v[232:235], a[104:107]
    v_mfma_f32_16x16x32_bf16 a[152:155], v[120:123], v[236:239], a[152:155]
    v_mfma_f32_16x16x32_bf16 a[12:15], v[124:127], v[224:227], a[12:15]
    v_mfma_f32_16x16x32_bf16 a[60:63], v[124:127], v[228:231], a[60:63]
    v_mfma_f32_16x16x32_bf16 a[108:111], v[124:127], v[232:235], a[108:111]
    v_mfma_f32_16x16x32_bf16 a[156:159], v[124:127], v[236:239], a[156:159]
    v_mfma_f32_16x16x32_bf16 a[16:19], v[128:131], v[224:227], a[16:19]
    v_mfma_f32_16x16x32_bf16 a[64:67], v[128:131], v[228:231], a[64:67]
    v_mfma_f32_16x16x32_bf16 a[112:115], v[128:131], v[232:235], a[112:115]
    v_mfma_f32_16x16x32_bf16 a[160:163], v[128:131], v[236:239], a[160:163]
    v_mfma_f32_16x16x32_bf16 a[20:23], v[132:135], v[224:227], a[20:23]
    v_mfma_f32_16x16x32_bf16 a[68:71], v[132:135], v[228:231], a[68:71]
    v_mfma_f32_16x16x32_bf16 a[116:119], v[132:135], v[232:235], a[116:119]
    v_mfma_f32_16x16x32_bf16 a[164:167], v[132:135], v[236:239], a[164:167]
    v_mfma_f32_16x16x32_bf16 a[24:27], v[136:139], v[224:227], a[24:27]
    v_mfma_f32_16x16x32_bf16 a[72:75], v[136:139], v[228:231], a[72:75]
    v_mfma_f32_16x16x32_bf16 a[120:123], v[136:139], v[232:235], a[120:123]
    v_mfma_f32_16x16x32_bf16 a[168:171], v[136:139], v[236:239], a[168:171]
    v_mfma_f32_16x16x32_bf16 a[28:31], v[140:143], v[224:227], a[28:31]
    v_mfma_f32_16x16x32_bf16 a[76:79], v[140:143], v[228:231], a[76:79]
    v_mfma_f32_16x16x32_bf16 a[124:127], v[140:143], v[232:235], a[124:127]
    v_mfma_f32_16x16x32_bf16 a[172:175], v[140:143], v[236:239], a[172:175]
    v_mfma_f32_16x16x32_bf16 a[32:35], v[144:147], v[224:227], a[32:35]
    v_mfma_f32_16x16x32_bf16 a[80:83], v[144:147], v[228:231], a[80:83]
    v_mfma_f32_16x16x32_bf16 a[128:131], v[144:147], v[232:235], a[128:131]
    v_mfma_f32_16x16x32_bf16 a[176:179], v[144:147], v[236:239], a[176:179]
    v_mfma_f32_16x16x32_bf16 a[36:39], v[148:151], v[224:227], a[36:39]
    v_mfma_f32_16x16x32_bf16 a[84:87], v[148:151], v[228:231], a[84:87]
    v_mfma_f32_16x16x32_bf16 a[132:135], v[148:151], v[232:235], a[132:135]
    v_mfma_f32_16x16x32_bf16 a[180:183], v[148:151], v[236:239], a[180:183]
    v_mfma_f32_16x16x32_bf16 a[40:43], v[152:155], v[224:227], a[40:43]
    v_mfma_f32_16x16x32_bf16 a[88:91], v[152:155], v[228:231], a[88:91]
    v_mfma_f32_16x16x32_bf16 a[136:139], v[152:155], v[232:235], a[136:139]
    v_mfma_f32_16x16x32_bf16 a[184:187], v[152:155], v[236:239], a[184:187]
    v_mfma_f32_16x16x32_bf16 a[44:47], v[156:159], v[224:227], a[44:47]
    v_mfma_f32_16x16x32_bf16 a[92:95], v[156:159], v[228:231], a[92:95]
    v_mfma_f32_16x16x32_bf16 a[140:143], v[156:159], v[232:235], a[140:143]
    v_mfma_f32_16x16x32_bf16 a[188:191], v[156:159], v[236:239], a[188:191]
    s_add_u32 s48, s48, 24576
    s_cmp_lt_u32 s48, 1572864
    s_nop 7
    s_cbranch_scc1 L_slowloop
    v_mov_b32 v48, v5
    v_mov_b32 v50, v6
    s_nop 0
    v_permlane16_swap_b32 v5, v48
    v_permlane16_swap_b32 v6, v50
    s_nop 0
    v_add_f32 v5, v5, v48
    v_add_f32 v6, v6, v50
    v_mov_b32 v48, v5
    v_mov_b32 v50, v6
    s_nop 0
    v_permlane32_swap_b32 v5, v48
    v_permlane32_swap_b32 v6, v50
    s_nop 0
    v_add_f32 v5, v5, v48
    v_add_f32 v6, v6, v50
    v_rcp_f32 v48, v5
    v_rcp_f32 v50, v6
    s_nop 0
    v_mov_b32 v52, v7
    v_mov_b32 v54, v8
    s_nop 0
    v_permlane16_swap_b32 v7, v52
    v_permlane16_swap_b32 v8, v54
    s_nop 0
    v_add_f32 v7, v7, v52
    v_add_f32 v8, v8, v54
    v_mov_b32 v52, v7
    v_mov_b32 v54, v8
    s_nop 0
    v_permlane32_swap_b32 v7, v52
    v_permlane32_swap_b32 v8, v54
    s_nop 0
    v_add_f32 v7, v7, v52
    v_add_f32 v8, v8, v54
    v_rcp_f32 v52, v7
    v_rcp_f32 v54, v8
    s_nop 0
    v_accvgpr_read_b32 v64, a0
    v_accvgpr_read_b32 v65, a12
    v_accvgpr_read_b32 v66, a24
    v_accvgpr_read_b32 v67, a36
    v_accvgpr_read_b32 v68, a1
    v_accvgpr_read_b32 v69, a13
    v_accvgpr_read_b32 v70, a25
    v_accvgpr_read_b32 v71, a37
    v_pk_mul_f32 v[64:65], v[64:65], v[48:49] op_sel_hi:[1,0]
    v_pk_mul_f32 v[66:67], v[66:67], v[48:49] op_sel_hi:[1,0]
    v_pk_mul_f32 v[68:69], v[68:69], v[48:49] op_sel_hi:[1,0]
    v_pk_mul_f32 v[70:71], v[70:71], v[48:49] op_sel_hi:[1,0]
    v_cvt_pk_bf16_f32 v64, v64, v65
    v_cvt_pk_bf16_f32 v65, v66, v67
    v_cvt_pk_bf16_f32 v66, v68, v69
    v_cvt_pk_bf16_f32 v67, v70, v71
    v_accvgpr_read_b32 v72, a2
    v_accvgpr_read_b32 v73, a14
    v_accvgpr_read_b32 v74, a26
    v_accvgpr_read_b32 v75, a38
    v_accvgpr_read_b32 v76, a3
    v_accvgpr_read_b32 v77, a15
    v_accvgpr_read_b32 v78, a27
    v_accvgpr_read_b32 v79, a39
    v_pk_mul_f32 v[72:73], v[72:73], v[48:49] op_sel_hi:[1,0]
    v_pk_mul_f32 v[74:75], v[74:75], v[48:49] op_sel_hi:[1,0]
    v_pk_mul_f32 v[76:77], v[76:77], v[48:49] op_sel_hi:[1,0]
    v_pk_mul_f32 v[78:79], v[78:79], v[48:49] op_sel_hi:[1,0]
    v_cvt_pk_bf16_f32 v72, v72, v73
    v_cvt_pk_bf16_f32 v73, v74, v75
    v_cvt_pk_bf16_f32 v74, v76, v77
    v_cvt_pk_bf16_f32 v75, v78, v79
    s_not_b64 vcc, s[62:63]
    v_cndmask_b32_dpp v132, v64, v72, vcc row_ror:8 row_mask:0xf bank_mask:0xf
    v_cndmask_b32_dpp v133, v65, v73, vcc row_ror:8 row_mask:0xf bank_mask:0xf
    v_cndmask_b32_dpp v134, v66, v74, vcc row_ror:8 row_mask:0xf bank_mask:0xf
    v_cndmask_b32_dpp v135, v67, v75, vcc row_ror:8 row_mask:0xf bank_mask:0xf
    s_mov_b64 vcc, s[62:63]
    v_cndmask_b32_dpp v128, v72, v64, vcc row_ror:8 row_mask:0xf bank_mask:0xf
    v_cndmask_b32_dpp v129, v73, v65, vcc row_ror:8 row_mask:0xf bank_mask:0xf
    v_cndmask_b32_dpp v130, v74, v66, vcc row_ror:8 row_mask:0xf bank_mask:0xf
    v_cndmask_b32_dpp v131, v75, v67, vcc row_ror:8 row_mask:0xf bank_mask:0xf
    v_accvgpr_read_b32 v80, a4
    v_accvgpr_read_b32 v81, a16
    v_accvgpr_read_b32 v82, a28
    v_accvgpr_read_b32 v83, a40
    v_accvgpr_read_b32 v84, a5
    v_accvgpr_read_b32 v85, a17
    v_accvgpr_read_b32 v86, a29
    v_accvgpr_read_b32 v87, a41
    buffer_store_dwordx4 v[132:135], v56, s[12:15], s24 offen offset:3072 sc0 sc1
    v_pk_mul_f32 v[80:81], v[80:81], v[48:49] op_sel_hi:[1,0]
    v_pk_mul_f32 v[82:83], v[82:83], v[48:49] op_sel_hi:[1,0]
    v_pk_mul_f32 v[84:85], v[84:85], v[48:49] op_sel_hi:[1,0]
    v_pk_mul_f32 v[86:87], v[86:87], v[48:49] op_sel_hi:[1,0]
    v_cvt_pk_bf16_f32 v80, v80, v81
    v_cvt_pk_bf16_f32 v81, v82, v83
    v_cvt_pk_bf16_f32 v82, v84, v85
    v_cvt_pk_bf16_f32 v83, v86, v87
    v_accvgpr_read_b32 v88, a6
    v_accvgpr_read_b32 v89, a18
    v_accvgpr_read_b32 v90, a30
    v_accvgpr_read_b32 v91, a42
    v_accvgpr_read_b32 v92, a7
    v_accvgpr_read_b32 v93, a19
    v_accvgpr_read_b32 v94, a31
    v_accvgpr_read_b32 v95, a43
    buffer_store_dwordx4 v[128:131], v56, s[12:15], s24 offen offset:0 sc0 sc1
    v_pk_mul_f32 v[88:89], v[88:89], v[48:49] op_sel_hi:[1,0]
    v_pk_mul_f32 v[90:91], v[90:91], v[48:49] op_sel_hi:[1,0]
    v_pk_mul_f32 v[92:93], v[92:93], v[48:49] op_sel_hi:[1,0]
    v_pk_mul_f32 v[94:95], v[94:95], v[48:49] op_sel_hi:[1,0]
    v_cvt_pk_bf16_f32 v88, v88, v89
    v_cvt_pk_bf16_f32 v89, v90, v91
    v_cvt_pk_bf16_f32 v90, v92, v93
    v_cvt_pk_bf16_f32 v91, v94, v95
    s_not_b64 vcc, s[62:63]
    v_cndmask_b32_dpp v140, v80, v88, vcc row_ror:8 row_mask:0xf bank_mask:0xf
    v_cndmask_b32_dpp v141, v81, v89, vcc row_ror:8 row_mask:0xf bank_mask:0xf
    v_cndmask_b32_dpp v142, v82, v90, vcc row_ror:8 row_mask:0xf bank_mask:0xf
    v_cndmask_b32_dpp v143, v83, v91, vcc row_ror:8 row_mask:0xf bank_mask:0xf
    s_mov_b64 vcc, s[62:63]
    v_cndmask_b32_dpp v136, v88, v80, vcc row_ror:8 row_mask:0xf bank_mask:0xf
    v_cndmask_b32_dpp v137, v89, v81, vcc row_ror:8 row_mask:0xf bank_mask:0xf
    v_cndmask_b32_dpp v138, v90, v82, vcc row_ror:8 row_mask:0xf bank_mask:0xf
    v_cndmask_b32_dpp v139, v91, v83, vcc row_ror:8 row_mask:0xf bank_mask:0xf
    v_accvgpr_read_b32 v96, a8
    v_accvgpr_read_b32 v97, a20
    v_accvgpr_read_b32 v98, a32
    v_accvgpr_read_b32 v99, a44
    v_accvgpr_read_b32 v100, a9
    v_accvgpr_read_b32 v101, a21
    v_accvgpr_read_b32 v102, a33
    v_accvgpr_read_b32 v103, a45
    buffer_store_dwordx4 v[140:143], v56, s[12:15], s24 offen offset:3200 sc0 sc1
    v_pk_mul_f32 v[96:97], v[96:97], v[48:49] op_sel_hi:[1,0]
    v_pk_mul_f32 v[98:99], v[98:99], v[48:49] op_sel_hi:[1,0]
    v_pk_mul_f32 v[100:101], v[100:101], v[48:49] op_sel_hi:[1,0]
    v_pk_mul_f32 v[102:103], v[102:103], v[48:49] op_sel_hi:[1,0]
    v_cvt_pk_bf16_f32 v96, v96, v97
    v_cvt_pk_bf16_f32 v97, v98, v99
    v_cvt_pk_bf16_f32 v98, v100, v101
    v_cvt_pk_bf16_f32 v99, v102, v103
    v_accvgpr_read_b32 v104, a10
    v_accvgpr_read_b32 v105, a22
    v_accvgpr_read_b32 v106, a34
    v_accvgpr_read_b32 v107, a46
    v_accvgpr_read_b32 v108, a11
    v_accvgpr_read_b32 v109, a23
    v_accvgpr_read_b32 v110, a35
    v_accvgpr_read_b32 v111, a47
    buffer_store_dwordx4 v[136:139], v56, s[12:15], s24 offen offset:128 sc0 sc1
    v_pk_mul_f32 v[104:105], v[104:105], v[48:49] op_sel_hi:[1,0]
    v_pk_mul_f32 v[106:107], v[106:107], v[48:49] op_sel_hi:[1,0]
    v_pk_mul_f32 v[108:109], v[108:109], v[48:49] op_sel_hi:[1,0]
    v_pk_mul_f32 v[110:111], v[110:111], v[48:49] op_sel_hi:[1,0]
    v_cvt_pk_bf16_f32 v104, v104, v105
    v_cvt_pk_bf16_f32 v105, v106, v107
    v_cvt_pk_bf16_f32 v106, v108, v109
    v_cvt_pk_bf16_f32 v107, v110, v111
    s_not_b64 vcc, s[62:63]
    v_cndmask_b32_dpp v148, v96, v104, vcc row_ror:8 row_mask:0xf bank_mask:0xf
    v_cndmask_b32_dpp v149, v97, v105, vcc row_ror:8 row_mask:0xf bank_mask:0xf
    v_cndmask_b32_dpp v150, v98, v106, vcc row_ror:8 row_mask:0xf bank_mask:0xf
    v_cndmask_b32_dpp v151, v99, v107, vcc row_ror:8 row_mask:0xf bank_mask:0xf
    s_mov_b64 vcc, s[62:63]
    v_cndmask_b32_dpp v144, v104, v96, vcc row_ror:8 row_mask:0xf bank_mask:0xf
    v_cndmask_b32_dpp v145, v105, v97, vcc row_ror:8 row_mask:0xf bank_mask:0xf
    v_cndmask_b32_dpp v146, v106, v98, vcc row_ror:8 row_mask:0xf bank_mask:0xf
    v_cndmask_b32_dpp v147, v107, v99, vcc row_ror:8 row_mask:0xf bank_mask:0xf
    v_accvgpr_read_b32 v112, a48
    v_accvgpr_read_b32 v113, a60
    v_accvgpr_read_b32 v114, a72
    v_accvgpr_read_b32 v115, a84
    v_accvgpr_read_b32 v116, a49
    v_accvgpr_read_b32 v117, a61
    v_accvgpr_read_b32 v118, a73
    v_accvgpr_read_b32 v119, a85
    buffer_store_dwordx4 v[148:151], v56, s[12:15], s24 offen offset:3328 sc0 sc1
    v_pk_mul_f32 v[112:113], v[112:113], v[50:51] op_sel_hi:[1,0]
    v_pk_mul_f32 v[114:115], v[114:115], v[50:51] op_sel_hi:[1,0]
    v_pk_mul_f32 v[116:117], v[116:117], v[50:51] op_sel_hi:[1,0]
    v_pk_mul_f32 v[118:119], v[118:119], v[50:51] op_sel_hi:[1,0]
    v_cvt_pk_bf16_f32 v112, v112, v113
    v_cvt_pk_bf16_f32 v113, v114, v115
    v_cvt_pk_bf16_f32 v114, v116, v117
    v_cvt_pk_bf16_f32 v115, v118, v119
    v_accvgpr_read_b32 v120, a50
    v_accvgpr_read_b32 v121, a62
    v_accvgpr_read_b32 v122, a74
    v_accvgpr_read_b32 v123, a86
    v_accvgpr_read_b32 v124, a51
    v_accvgpr_read_b32 v125, a63
    v_accvgpr_read_b32 v126, a75
    v_accvgpr_read_b32 v127, a87
    buffer_store_dwordx4 v[144:147], v56, s[12:15], s24 offen offset:256 sc0 sc1
    v_pk_mul_f32 v[120:121], v[120:121], v[50:51] op_sel_hi:[1,0]
    v_pk_mul_f32 v[122:123], v[122:123], v[50:51] op_sel_hi:[1,0]
    v_pk_mul_f32 v[124:125], v[124:125], v[50:51] op_sel_hi:[1,0]
    v_pk_mul_f32 v[126:127], v[126:127], v[50:51] op_sel_hi:[1,0]
    v_cvt_pk_bf16_f32 v120, v120, v121
    v_cvt_pk_bf16_f32 v121, v122, v123
    v_cvt_pk_bf16_f32 v122, v124, v125
    v_cvt_pk_bf16_f32 v123, v126, v127
    s_not_b64 vcc, s[62:63]
    v_cndmask_b32_dpp v156, v112, v120, vcc row_ror:8 row_mask:0xf bank_mask:0xf
    v_cndmask_b32_dpp v157, v113, v121, vcc row_ror:8 row_mask:0xf bank_mask:0xf
    v_cndmask_b32_dpp v158, v114, v122, vcc row_ror:8 row_mask:0xf bank_mask:0xf
    v_cndmask_b32_dpp v159, v115, v123, vcc row_ror:8 row_mask:0xf bank_mask:0xf
    s_mov_b64 vcc, s[62:63]
    v_cndmask_b32_dpp v152, v120, v112, vcc row_ror:8 row_mask:0xf bank_mask:0xf
    v_cndmask_b32_dpp v153, v121, v113, vcc row_ror:8 row_mask:0xf bank_mask:0xf
    v_cndmask_b32_dpp v154, v122, v114, vcc row_ror:8 row_mask:0xf bank_mask:0xf
    v_cndmask_b32_dpp v155, v123, v115, vcc row_ror:8 row_mask:0xf bank_mask:0xf
    v_accvgpr_read_b32 v64, a52
    v_accvgpr_read_b32 v65, a64
    v_accvgpr_read_b32 v66, a76
    v_accvgpr_read_b32 v67, a88
    v_accvgpr_read_b32 v68, a53
    v_accvgpr_read_b32 v69, a65
    v_accvgpr_read_b32 v70, a77
    v_accvgpr_read_b32 v71, a89
    buffer_store_dwordx4 v[156:159], v56, s[12:15], s40 offen offset:3072 sc0 sc1
    v_pk_mul_f32 v[64:65], v[64:65], v[50:51] op_sel_hi:[1,0]
    v_pk_mul_f32 v[66:67], v[66:67], v[50:51] op_sel_hi:[1,0]
    v_pk_mul_f32 v[68:69], v[68:69], v[50:51] op_sel_hi:[1,0]
    v_pk_mul_f32 v[70:71], v[70:71], v[50:51] op_sel_hi:[1,0]
    v_cvt_pk_bf16_f32 v64, v64, v65
    v_cvt_pk_bf16_f32 v65, v66, v67
    v_cvt_pk_bf16_f32 v66, v68, v69
    v_cvt_pk_bf16_f32 v67, v70, v71
    v_accvgpr_read_b32 v72, a54
    v_accvgpr_read_b32 v73, a66
    v_accvgpr_read_b32 v74, a78
    v_accvgpr_read_b32 v75, a90
    v_accvgpr_read_b32 v76, a55
    v_accvgpr_read_b32 v77, a67
    v_accvgpr_read_b32 v78, a79
    v_accvgpr_read_b32 v79, a91
    buffer_store_dwordx4 v[152:155], v56, s[12:15], s40 offen offset:0 sc0 sc1
    v_pk_mul_f32 v[72:73], v[72:73], v[50:51] op_sel_hi:[1,0]
    v_pk_mul_f32 v[74:75], v[74:75], v[50:51] op_sel_hi:[1,0]
    v_pk_mul_f32 v[76:77], v[76:77], v[50:51] op_sel_hi:[1,0]
    v_pk_mul_f32 v[78:79], v[78:79], v[50:51] op_sel_hi:[1,0]
    v_cvt_pk_bf16_f32 v72, v72, v73
    v_cvt_pk_bf16_f32 v73, v74, v75
    v_cvt_pk_bf16_f32 v74, v76, v77
    v_cvt_pk_bf16_f32 v75, v78, v79
    s_not_b64 vcc, s[62:63]
    v_cndmask_b32_dpp v132, v64, v72, vcc row_ror:8 row_mask:0xf bank_mask:0xf
    v_cndmask_b32_dpp v133, v65, v73, vcc row_ror:8 row_mask:0xf bank_mask:0xf
    v_cndmask_b32_dpp v134, v66, v74, vcc row_ror:8 row_mask:0xf bank_mask:0xf
    v_cndmask_b32_dpp v135, v67, v75, vcc row_ror:8 row_mask:0xf bank_mask:0xf
    s_mov_b64 vcc, s[62:63]
    v_cndmask_b32_dpp v128, v72, v64, vcc row_ror:8 row_mask:0xf bank_mask:0xf
    v_cndmask_b32_dpp v129, v73, v65, vcc row_ror:8 row_mask:0xf bank_mask:0xf
    v_cndmask_b32_dpp v130, v74, v66, vcc row_ror:8 row_mask:0xf bank_mask:0xf
    v_cndmask_b32_dpp v131, v75, v67, vcc row_ror:8 row_mask:0xf bank_mask:0xf
    v_accvgpr_read_b32 v80, a56
    v_accvgpr_read_b32 v81, a68
    v_accvgpr_read_b32 v82, a80
    v_accvgpr_read_b32 v83, a92
    v_accvgpr_read_b32 v84, a57
    v_accvgpr_read_b32 v85, a69
    v_accvgpr_read_b32 v86, a81
    v_accvgpr_read_b32 v87, a93
    buffer_store_dwordx4 v[132:135], v56, s[12:15], s40 offen offset:3200 sc0 sc1
    v_pk_mul_f32 v[80:81], v[80:81], v[50:51] op_sel_hi:[1,0]
    v_pk_mul_f32 v[82:83], v[82:83], v[50:51] op_sel_hi:[1,0]
    v_pk_mul_f32 v[84:85], v[84:85], v[50:51] op_sel_hi:[1,0]
    v_pk_mul_f32 v[86:87], v[86:87], v[50:51] op_sel_hi:[1,0]
    v_cvt_pk_bf16_f32 v80, v80, v81
    v_cvt_pk_bf16_f32 v81, v82, v83
    v_cvt_pk_bf16_f32 v82, v84, v85
    v_cvt_pk_bf16_f32 v83, v86, v87
    v_accvgpr_read_b32 v88, a58
    v_accvgpr_read_b32 v89, a70
    v_accvgpr_read_b32 v90, a82
    v_accvgpr_read_b32 v91, a94
    v_accvgpr_read_b32 v92, a59
    v_accvgpr_read_b32 v93, a71
    v_accvgpr_read_b32 v94, a83
    v_accvgpr_read_b32 v95, a95
    buffer_store_dwordx4 v[128:131], v56, s[12:15], s40 offen offset:128 sc0 sc1
    v_pk_mul_f32 v[88:89], v[88:89], v[50:51] op_sel_hi:[1,0]
    v_pk_mul_f32 v[90:91], v[90:91], v[50:51] op_sel_hi:[1,0]
    v_pk_mul_f32 v[92:93], v[92:93], v[50:51] op_sel_hi:[1,0]
    v_pk_mul_f32 v[94:95], v[94:95], v[50:51] op_sel_hi:[1,0]
    v_cvt_pk_bf16_f32 v88, v88, v89
    v_cvt_pk_bf16_f32 v89, v90, v91
    v_cvt_pk_bf16_f32 v90, v92, v93
    v_cvt_pk_bf16_f32 v91, v94, v95
    s_not_b64 vcc, s[62:63]
    v_cndmask_b32_dpp v140, v80, v88, vcc row_ror:8 row_mask:0xf bank_mask:0xf
    v_cndmask_b32_dpp v141, v81, v89, vcc row_ror:8 row_mask:0xf bank_mask:0xf
    v_cndmask_b32_dpp v142, v82, v90, vcc row_ror:8 row_mask:0xf bank_mask:0xf
    v_cndmask_b32_dpp v143, v83, v91, vcc row_ror:8 row_mask:0xf bank_mask:0xf
    s_mov_b64 vcc, s[62:63]
    v_cndmask_b32_dpp v136, v88, v80, vcc row_ror:8 row_mask:0xf bank_mask:0xf
    v_cndmask_b32_dpp v137, v89, v81, vcc row_ror:8 row_mask:0xf bank_mask:0xf
    v_cndmask_b32_dpp v138, v90, v82, vcc row_ror:8 row_mask:0xf bank_mask:0xf
    v_cndmask_b32_dpp v139, v91, v83, vcc row_ror:8 row_mask:0xf bank_mask:0xf
    v_accvgpr_read_b32 v96, a96
    v_accvgpr_read_b32 v97, a108
    v_accvgpr_read_b32 v98, a120
    v_accvgpr_read_b32 v99, a132
    v_accvgpr_read_b32 v100, a97
    v_accvgpr_read_b32 v101, a109
    v_accvgpr_read_b32 v102, a121
    v_accvgpr_read_b32 v103, a133
    buffer_store_dwordx4 v[140:143], v56, s[12:15], s40 offen offset:3328 sc0 sc1
    v_pk_mul_f32 v[96:97], v[96:97], v[52:53] op_sel_hi:[1,0]
    v_pk_mul_f32 v[98:99], v[98:99], v[52:53] op_sel_hi:[1,0]
    v_pk_mul_f32 v[100:101], v[100:101], v[52:53] op_sel_hi:[1,0]
    v_pk_mul_f32 v[102:103], v[102:103], v[52:53] op_sel_hi:[1,0]
    v_cvt_pk_bf16_f32 v96, v96, v97
    v_cvt_pk_bf16_f32 v97, v98, v99
    v_cvt_pk_bf16_f32 v98, v100, v101
    v_cvt_pk_bf16_f32 v99, v102, v103
    v_accvgpr_read_b32 v104, a98
    v_accvgpr_read_b32 v105, a110
    v_accvgpr_read_b32 v106, a122
    v_accvgpr_read_b32 v107, a134
    v_accvgpr_read_b32 v108, a99
    v_accvgpr_read_b32 v109, a111
    v_accvgpr_read_b32 v110, a123
    v_accvgpr_read_b32 v111, a135
    buffer_store_dwordx4 v[136:139], v56, s[12:15], s40 offen offset:256 sc0 sc1
    v_pk_mul_f32 v[104:105], v[104:105], v[52:53] op_sel_hi:[1,0]
    v_pk_mul_f32 v[106:107], v[106:107], v[52:53] op_sel_hi:[1,0]
    v_pk_mul_f32 v[108:109], v[108:109], v[52:53] op_sel_hi:[1,0]
    v_pk_mul_f32 v[110:111], v[110:111], v[52:53] op_sel_hi:[1,0]
    v_cvt_pk_bf16_f32 v104, v104, v105
    v_cvt_pk_bf16_f32 v105, v106, v107
    v_cvt_pk_bf16_f32 v106, v108, v109
    v_cvt_pk_bf16_f32 v107, v110, v111
    s_not_b64 vcc, s[62:63]
    v_cndmask_b32_dpp v148, v96, v104, vcc row_ror:8 row_mask:0xf bank_mask:0xf
    v_cndmask_b32_dpp v149, v97, v105, vcc row_ror:8 row_mask:0xf bank_mask:0xf
    v_cndmask_b32_dpp v150, v98, v106, vcc row_ror:8 row_mask:0xf bank_mask:0xf
    v_cndmask_b32_dpp v151, v99, v107, vcc row_ror:8 row_mask:0xf bank_mask:0xf
    s_mov_b64 vcc, s[62:63]
    v_cndmask_b32_dpp v144, v104, v96, vcc row_ror:8 row_mask:0xf bank_mask:0xf
    v_cndmask_b32_dpp v145, v105, v97, vcc row_ror:8 row_mask:0xf bank_mask:0xf
    v_cndmask_b32_dpp v146, v106, v98, vcc row_ror:8 row_mask:0xf bank_mask:0xf
    v_cndmask_b32_dpp v147, v107, v99, vcc row_ror:8 row_mask:0xf bank_mask:0xf
    v_accvgpr_read_b32 v112, a100
    v_accvgpr_read_b32 v113, a112
    v_accvgpr_read_b32 v114, a124
    v_accvgpr_read_b32 v115, a136
    v_accvgpr_read_b32 v116, a101
    v_accvgpr_read_b32 v117, a113
    v_accvgpr_read_b32 v118, a125
    v_accvgpr_read_b32 v119, a137
    buffer_store_dwordx4 v[148:151], v56, s[12:15], s41 offen offset:3072 sc0 sc1
    v_pk_mul_f32 v[112:113], v[112:113], v[52:53] op_sel_hi:[1,0]
    v_pk_mul_f32 v[114:115], v[114:115], v[52:53] op_sel_hi:[1,0]
    v_pk_mul_f32 v[116:117], v[116:117], v[52:53] op_sel_hi:[1,0]
    v_pk_mul_f32 v[118:119], v[118:119], v[52:53] op_sel_hi:[1,0]
    v_cvt_pk_bf16_f32 v112, v112, v113
    v_cvt_pk_bf16_f32 v113, v114, v115
    v_cvt_pk_bf16_f32 v114, v116, v117
    v_cvt_pk_bf16_f32 v115, v118, v119
    v_accvgpr_read_b32 v120, a102
    v_accvgpr_read_b32 v121, a114
    v_accvgpr_read_b32 v122, a126
    v_accvgpr_read_b32 v123, a138
    v_accvgpr_read_b32 v124, a103
    v_accvgpr_read_b32 v125, a115
    v_accvgpr_read_b32 v126, a127
    v_accvgpr_read_b32 v127, a139
    buffer_store_dwordx4 v[144:147], v56, s[12:15], s41 offen offset:0 sc0 sc1
    v_pk_mul_f32 v[120:121], v[120:121], v[52:53] op_sel_hi:[1,0]
    v_pk_mul_f32 v[122:123], v[122:123], v[52:53] op_sel_hi:[1,0]
    v_pk_mul_f32 v[124:125], v[124:125], v[52:53] op_sel_hi:[1,0]
    v_pk_mul_f32 v[126:127], v[126:127], v[52:53] op_sel_hi:[1,0]
    v_cvt_pk_bf16_f32 v120, v120, v121
    v_cvt_pk_bf16_f32 v121, v122, v123
    v_cvt_pk_bf16_f32 v122, v124, v125
    v_cvt_pk_bf16_f32 v123, v126, v127
    s_not_b64 vcc, s[62:63]
    v_cndmask_b32_dpp v156, v112, v120, vcc row_ror:8 row_mask:0xf bank_mask:0xf
    v_cndmask_b32_dpp v157, v113, v121, vcc row_ror:8 row_mask:0xf bank_mask:0xf
    v_cndmask_b32_dpp v158, v114, v122, vcc row_ror:8 row_mask:0xf bank_mask:0xf
    v_cndmask_b32_dpp v159, v115, v123, vcc row_ror:8 row_mask:0xf bank_mask:0xf
    s_mov_b64 vcc, s[62:63]
    v_cndmask_b32_dpp v152, v120, v112, vcc row_ror:8 row_mask:0xf bank_mask:0xf
    v_cndmask_b32_dpp v153, v121, v113, vcc row_ror:8 row_mask:0xf bank_mask:0xf
    v_cndmask_b32_dpp v154, v122, v114, vcc row_ror:8 row_mask:0xf bank_mask:0xf
    v_cndmask_b32_dpp v155, v123, v115, vcc row_ror:8 row_mask:0xf bank_mask:0xf
    v_accvgpr_read_b32 v64, a104
    v_accvgpr_read_b32 v65, a116
    v_accvgpr_read_b32 v66, a128
    v_accvgpr_read_b32 v67, a140
    v_accvgpr_read_b32 v68, a105
    v_accvgpr_read_b32 v69, a117
    v_accvgpr_read_b32 v70, a129
    v_accvgpr_read_b32 v71, a141
    buffer_store_dwordx4 v[156:159], v56, s[12:15], s41 offen offset:3200 sc0 sc1
    v_pk_mul_f32 v[64:65], v[64:65], v[52:53] op_sel_hi:[1,0]
    v_pk_mul_f32 v[66:67], v[66:67], v[52:53] op_sel_hi:[1,0]
    v_pk_mul_f32 v[68:69], v[68:69], v[52:53] op_sel_hi:[1,0]
    v_pk_mul_f32 v[70:71], v[70:71], v[52:53] op_sel_hi:[1,0]
    v_cvt_pk_bf16_f32 v64, v64, v65
    v_cvt_pk_bf16_f32 v65, v66, v67
    v_cvt_pk_bf16_f32 v66, v68, v69
    v_cvt_pk_bf16_f32 v67, v70, v71
    v_accvgpr_read_b32 v72, a106
    v_accvgpr_read_b32 v73, a118
    v_accvgpr_read_b32 v74, a130
    v_accvgpr_read_b32 v75, a142
    v_accvgpr_read_b32 v76, a107
    v_accvgpr_read_b32 v77, a119
    v_accvgpr_read_b32 v78, a131
    v_accvgpr_read_b32 v79, a143
    buffer_store_dwordx4 v[152:155], v56, s[12:15], s41 offen offset:128 sc0 sc1
    v_pk_mul_f32 v[72:73], v[72:73], v[52:53] op_sel_hi:[1,0]
    v_pk_mul_f32 v[74:75], v[74:75], v[52:53] op_sel_hi:[1,0]
    v_pk_mul_f32 v[76:77], v[76:77], v[52:53] op_sel_hi:[1,0]
    v_pk_mul_f32 v[78:79], v[78:79], v[52:53] op_sel_hi:[1,0]
    v_cvt_pk_bf16_f32 v72, v72, v73
    v_cvt_pk_bf16_f32 v73, v74, v75
    v_cvt_pk_bf16_f32 v74, v76, v77
    v_cvt_pk_bf16_f32 v75, v78, v79
    s_not_b64 vcc, s[62:63]
    v_cndmask_b32_dpp v132, v64, v72, vcc row_ror:8 row_mask:0xf bank_mask:0xf
    v_cndmask_b32_dpp v133, v65, v73, vcc row_ror:8 row_mask:0xf bank_mask:0xf
    v_cndmask_b32_dpp v134, v66, v74, vcc row_ror:8 row_mask:0xf bank_mask:0xf
    v_cndmask_b32_dpp v135, v67, v75, vcc row_ror:8 row_mask:0xf bank_mask:0xf
    s_mov_b64 vcc, s[62:63]
    v_cndmask_b32_dpp v128, v72, v64, vcc row_ror:8 row_mask:0xf bank_mask:0xf
    v_cndmask_b32_dpp v129, v73, v65, vcc row_ror:8 row_mask:0xf bank_mask:0xf
    v_cndmask_b32_dpp v130, v74, v66, vcc row_ror:8 row_mask:0xf bank_mask:0xf
    v_cndmask_b32_dpp v131, v75, v67, vcc row_ror:8 row_mask:0xf bank_mask:0xf
    v_accvgpr_read_b32 v80, a144
    v_accvgpr_read_b32 v81, a156
    v_accvgpr_read_b32 v82, a168
    v_accvgpr_read_b32 v83, a180
    v_accvgpr_read_b32 v84, a145
    v_accvgpr_read_b32 v85, a157
    v_accvgpr_read_b32 v86, a169
    v_accvgpr_read_b32 v87, a181
    buffer_store_dwordx4 v[132:135], v56, s[12:15], s41 offen offset:3328 sc0 sc1
    v_pk_mul_f32 v[80:81], v[80:81], v[54:55] op_sel_hi:[1,0]
    v_pk_mul_f32 v[82:83], v[82:83], v[54:55] op_sel_hi:[1,0]
    v_pk_mul_f32 v[84:85], v[84:85], v[54:55] op_sel_hi:[1,0]
    v_pk_mul_f32 v[86:87], v[86:87], v[54:55] op_sel_hi:[1,0]
    v_cvt_pk_bf16_f32 v80, v80, v81
    v_cvt_pk_bf16_f32 v81, v82, v83
    v_cvt_pk_bf16_f32 v82, v84, v85
    v_cvt_pk_bf16_f32 v83, v86, v87
    v_accvgpr_read_b32 v88, a146
    v_accvgpr_read_b32 v89, a158
    v_accvgpr_read_b32 v90, a170
    v_accvgpr_read_b32 v91, a182
    v_accvgpr_read_b32 v92, a147
    v_accvgpr_read_b32 v93, a159
    v_accvgpr_read_b32 v94, a171
    v_accvgpr_read_b32 v95, a183
    buffer_store_dwordx4 v[128:131], v56, s[12:15], s41 offen offset:256 sc0 sc1
    v_pk_mul_f32 v[88:89], v[88:89], v[54:55] op_sel_hi:[1,0]
    v_pk_mul_f32 v[90:91], v[90:91], v[54:55] op_sel_hi:[1,0]
    v_pk_mul_f32 v[92:93], v[92:93], v[54:55] op_sel_hi:[1,0]
    v_pk_mul_f32 v[94:95], v[94:95], v[54:55] op_sel_hi:[1,0]
    v_cvt_pk_bf16_f32 v88, v88, v89
    v_cvt_pk_bf16_f32 v89, v90, v91
    v_cvt_pk_bf16_f32 v90, v92, v93
    v_cvt_pk_bf16_f32 v91, v94, v95
    s_not_b64 vcc, s[62:63]
    v_cndmask_b32_dpp v140, v80, v88, vcc row_ror:8 row_mask:0xf bank_mask:0xf
    v_cndmask_b32_dpp v141, v81, v89, vcc row_ror:8 row_mask:0xf bank_mask:0xf
    v_cndmask_b32_dpp v142, v82, v90, vcc row_ror:8 row_mask:0xf bank_mask:0xf
    v_cndmask_b32_dpp v143, v83, v91, vcc row_ror:8 row_mask:0xf bank_mask:0xf
    s_mov_b64 vcc, s[62:63]
    v_cndmask_b32_dpp v136, v88, v80, vcc row_ror:8 row_mask:0xf bank_mask:0xf
    v_cndmask_b32_dpp v137, v89, v81, vcc row_ror:8 row_mask:0xf bank_mask:0xf
    v_cndmask_b32_dpp v138, v90, v82, vcc row_ror:8 row_mask:0xf bank_mask:0xf
    v_cndmask_b32_dpp v139, v91, v83, vcc row_ror:8 row_mask:0xf bank_mask:0xf
    v_accvgpr_read_b32 v96, a148
    v_accvgpr_read_b32 v97, a160
    v_accvgpr_read_b32 v98, a172
    v_accvgpr_read_b32 v99, a184
    v_accvgpr_read_b32 v100, a149
    v_accvgpr_read_b32 v101, a161
    v_accvgpr_read_b32 v102, a173
    v_accvgpr_read_b32 v103, a185
    buffer_store_dwordx4 v[140:143], v56, s[12:15], s42 offen offset:3072 sc0 sc1
    v_pk_mul_f32 v[96:97], v[96:97], v[54:55] op_sel_hi:[1,0]
    v_pk_mul_f32 v[98:99], v[98:99], v[54:55] op_sel_hi:[1,0]
    v_pk_mul_f32 v[100:101], v[100:101], v[54:55] op_sel_hi:[1,0]
    v_pk_mul_f32 v[102:103], v[102:103], v[54:55] op_sel_hi:[1,0]
    v_cvt_pk_bf16_f32 v96, v96, v97
    v_cvt_pk_bf16_f32 v97, v98, v99
    v_cvt_pk_bf16_f32 v98, v100, v101
    v_cvt_pk_bf16_f32 v99, v102, v103
    v_accvgpr_read_b32 v104, a150
    v_accvgpr_read_b32 v105, a162
    v_accvgpr_read_b32 v106, a174
    v_accvgpr_read_b32 v107, a186
    v_accvgpr_read_b32 v108, a151
    v_accvgpr_read_b32 v109, a163
    v_accvgpr_read_b32 v110, a175
    v_accvgpr_read_b32 v111, a187
    buffer_store_dwordx4 v[136:139], v56, s[12:15], s42 offen offset:0 sc0 sc1
    v_pk_mul_f32 v[104:105], v[104:105], v[54:55] op_sel_hi:[1,0]
    v_pk_mul_f32 v[106:107], v[106:107], v[54:55] op_sel_hi:[1,0]
    v_pk_mul_f32 v[108:109], v[108:109], v[54:55] op_sel_hi:[1,0]
    v_pk_mul_f32 v[110:111], v[110:111], v[54:55] op_sel_hi:[1,0]
    v_cvt_pk_bf16_f32 v104, v104, v105
    v_cvt_pk_bf16_f32 v105, v106, v107
    v_cvt_pk_bf16_f32 v106, v108, v109
    v_cvt_pk_bf16_f32 v107, v110, v111
    s_not_b64 vcc, s[62:63]
    v_cndmask_b32_dpp v148, v96, v104, vcc row_ror:8 row_mask:0xf bank_mask:0xf
    v_cndmask_b32_dpp v149, v97, v105, vcc row_ror:8 row_mask:0xf bank_mask:0xf
    v_cndmask_b32_dpp v150, v98, v106, vcc row_ror:8 row_mask:0xf bank_mask:0xf
    v_cndmask_b32_dpp v151, v99, v107, vcc row_ror:8 row_mask:0xf bank_mask:0xf
    s_mov_b64 vcc, s[62:63]
    v_cndmask_b32_dpp v144, v104, v96, vcc row_ror:8 row_mask:0xf bank_mask:0xf
    v_cndmask_b32_dpp v145, v105, v97, vcc row_ror:8 row_mask:0xf bank_mask:0xf
    v_cndmask_b32_dpp v146, v106, v98, vcc row_ror:8 row_mask:0xf bank_mask:0xf
    v_cndmask_b32_dpp v147, v107, v99, vcc row_ror:8 row_mask:0xf bank_mask:0xf
    v_accvgpr_read_b32 v112, a152
    v_accvgpr_read_b32 v113, a164
    v_accvgpr_read_b32 v114, a176
    v_accvgpr_read_b32 v115, a188
    v_accvgpr_read_b32 v116, a153
    v_accvgpr_read_b32 v117, a165
    v_accvgpr_read_b32 v118, a177
    v_accvgpr_read_b32 v119, a189
    buffer_store_dwordx4 v[148:151], v56, s[12:15], s42 offen offset:3200 sc0 sc1
    v_pk_mul_f32 v[112:113], v[112:113], v[54:55] op_sel_hi:[1,0]
    v_pk_mul_f32 v[114:115], v[114:115], v[54:55] op_sel_hi:[1,0]
    v_pk_mul_f32 v[116:117], v[116:117], v[54:55] op_sel_hi:[1,0]
    v_pk_mul_f32 v[118:119], v[118:119], v[54:55] op_sel_hi:[1,0]
    v_cvt_pk_bf16_f32 v112, v112, v113
    v_cvt_pk_bf16_f32 v113, v114, v115
    v_cvt_pk_bf16_f32 v114, v116, v117
    v_cvt_pk_bf16_f32 v115, v118, v119
    v_accvgpr_read_b32 v120, a154
    v_accvgpr_read_b32 v121, a166
    v_accvgpr_read_b32 v122, a178
    v_accvgpr_read_b32 v123, a190
    v_accvgpr_read_b32 v124, a155
    v_accvgpr_read_b32 v125, a167
    v_accvgpr_read_b32 v126, a179
    v_accvgpr_read_b32 v127, a191
    buffer_store_dwordx4 v[144:147], v56, s[12:15], s42 offen offset:128 sc0 sc1
    v_pk_mul_f32 v[120:121], v[120:121], v[54:55] op_sel_hi:[1,0]
    v_pk_mul_f32 v[122:123], v[122:123], v[54:55] op_sel_hi:[1,0]
    v_pk_mul_f32 v[124:125], v[124:125], v[54:55] op_sel_hi:[1,0]
    v_pk_mul_f32 v[126:127], v[126:127], v[54:55] op_sel_hi:[1,0]
    v_cvt_pk_bf16_f32 v120, v120, v121
    v_cvt_pk_bf16_f32 v121, v122, v123
    v_cvt_pk_bf16_f32 v122, v124, v125
    v_cvt_pk_bf16_f32 v123, v126, v127
    s_not_b64 vcc, s[62:63]
    v_cndmask_b32_dpp v156, v112, v120, vcc row_ror:8 row_mask:0xf bank_mask:0xf
    v_cndmask_b32_dpp v157, v113, v121, vcc row_ror:8 row_mask:0xf bank_mask:0xf
    v_cndmask_b32_dpp v158, v114, v122, vcc row_ror:8 row_mask:0xf bank_mask:0xf
    v_cndmask_b32_dpp v159, v115, v123, vcc row_ror:8 row_mask:0xf bank_mask:0xf
    s_mov_b64 vcc, s[62:63]
    v_cndmask_b32_dpp v152, v120, v112, vcc row_ror:8 row_mask:0xf bank_mask:0xf
    v_cndmask_b32_dpp v153, v121, v113, vcc row_ror:8 row_mask:0xf bank_mask:0xf
    v_cndmask_b32_dpp v154, v122, v114, vcc row_ror:8 row_mask:0xf bank_mask:0xf
    v_cndmask_b32_dpp v155, v123, v115, vcc row_ror:8 row_mask:0xf bank_mask:0xf
    buffer_store_dwordx4 v[156:159], v56, s[12:15], s42 offen offset:3328 sc0 sc1
    buffer_store_dwordx4 v[152:155], v56, s[12:15], s42 offen offset:256 sc0 sc1
    s_branch L_fin
.section .rodata,"a"
.p2align 6
.amdhsa_kernel standalone__kv_cache_quant_int4_int2_kv_with_per_channel_or_per_token_scales__prompt_kernel
  .amdhsa_next_free_vgpr 512
  .amdhsa_next_free_sgpr 102
  .amdhsa_accum_offset 256
  .amdhsa_group_segment_fixed_size 0
  .amdhsa_kernarg_size 80
  .amdhsa_user_sgpr_count 2
  .amdhsa_user_sgpr_kernarg_segment_ptr 1
  .amdhsa_system_sgpr_workgroup_id_x 1
.end_amdhsa_kernel
```

```asm
; @launch grid=(256,1,1) block=(256,1,1) lds=147584
.amdgcn_target "amdgcn-amd-amdhsa--gfx950"
.text
.globl standalone__kv_cache_quant_int4_int2_kv_with_per_channel_or_per_token_scales__prompt_kernel
.p2align 8
.type standalone__kv_cache_quant_int4_int2_kv_with_per_channel_or_per_token_scales__prompt_kernel,@function
standalone__kv_cache_quant_int4_int2_kv_with_per_channel_or_per_token_scales__prompt_kernel:
    s_cmp_ge_u32 s2, 256
    s_cbranch_scc1 L_done
    s_load_dwordx16 s[40:55], s[0:1], 0
    s_load_dwordx4 s[16:19], s[0:1], 64
    s_and_b32 s94, s2, 7
    s_lshr_b32 s95, s2, 3
    s_lshr_b32 s24, s95, 3
    s_lshl_b32 s94, s94, 2
    s_add_u32 s94, s94, s24
    s_and_b32 s95, s95, 7
    s_getpc_b64 s[60:61]
L_pc:
    s_sub_u32 s60, s60, L_pc-standalone__kv_cache_quant_int4_int2_kv_with_per_channel_or_per_token_scales__prompt_kernel
    s_subb_u32 s61, s61, 0
    s_mov_b32 s62, L_slow-standalone__kv_cache_quant_int4_int2_kv_with_per_channel_or_per_token_scales__prompt_kernel
    s_mov_b32 s63, 0x20000
    s_lshr_b32 s22, s2, 3
    s_lshl_b32 s22, s22, 12
    v_lshlrev_b32 v30, 4, v0
    buffer_load_dwordx4 v[128:131], v30, s[60:63], s22 offen
    v_lshrrev_b32 v24, 6, v0
    v_and_b32 v25, 63, v0
    v_readfirstlane_b32 s25, v24
    v_lshlrev_b32 v1, 4, v25
    v_mul_u32_u24 v26, 43, v25
    v_lshrrev_b32 v26, 10, v26
    v_mul_u32_u24 v27, 24, v26
    v_sub_u32 v27, v25, v27
    v_lshrrev_b32 v28, 1, v24
    v_and_b32 v29, 1, v24
    v_lshlrev_b32 v30, 4, v29
    v_lshl_add_u32 v30, v28, 2, v30
    v_add_u32 v30, v30, v26
    v_mul_u32_u24 v30, 768, v30
    v_lshrrev_b32 v48, 1, v26
    v_lshlrev_b32 v48, 30, v48
    v_lshl_add_u32 v30, v27, 4, v30
    v_or_b32 v9, v30, v48
    v_lshl_or_b32 v10, v27, 3, v48
    v_mul_u32_u24 v30, 6144, v24
    v_add3_u32 v12, v30, v1, v48
    s_mov_b32 s66, 1572864
    s_mov_b32 s67, 0x20000
    s_mov_b32 s70, 1572864
    s_mov_b32 s71, 0x20000
    s_mov_b32 s74, 12288
    s_mov_b32 s75, 0x20000
    s_mov_b32 s78, 12288
    s_mov_b32 s79, 0x20000
    s_mov_b32 s82, 4096
    s_mov_b32 s83, 0x20000
    s_mov_b32 s86, 4096
    s_mov_b32 s87, 0x20000
    s_mov_b32 s22, 64
    s_mov_b32 s23, 0x20000
    s_mul_i32 s33, s95, 24576
    s_add_u32 s34, s33, 6144
    s_mov_b32 s35, s33
    s_lshr_b32 s36, s95, 1
    s_mul_i32 s36, s36, 384
    s_lshl_b32 s37, s95, 6
    s_lshl_b32 s24, s25, 4
    s_add_u32 s37, s37, s24
    s_mul_i32 s24, s94, 1572864
    s_mul_i32 s56, s94, 12288
    s_lshl_b32 s57, s94, 12
    s_lshl_b32 s58, s94, 10
    s_add_u32 s58, s58, 51380320
    s_or_b32 s39, s95, s25
    s_waitcnt lgkmcnt(0)
    s_add_u32 s64, s42, s24
    s_addc_u32 s65, s43, 0
    s_add_u32 s72, s46, s56
    s_addc_u32 s73, s47, 0
    s_add_u32 s76, s48, s56
    s_addc_u32 s77, s49, 0
    buffer_load_dwordx4 v[224:227], v9, s[64:67], s33 offen offset:0 nt
    buffer_load_dwordx4 v[228:231], v9, s[64:67], s33 offen offset:1536 nt
    buffer_load_dwordx4 v[232:235], v9, s[64:67], s34 offen offset:0 nt
    buffer_load_dwordx4 v[236:239], v9, s[64:67], s34 offen offset:1536 nt
    buffer_load_dwordx2 v[32:33], v10, s[72:75], s36 offen offset:0
    buffer_load_dwordx2 v[34:35], v10, s[76:79], s36 offen offset:0
    buffer_load_dwordx2 v[36:37], v10, s[72:75], s36 offen offset:192
    buffer_load_dwordx2 v[38:39], v10, s[76:79], s36 offen offset:192
    s_add_u32 s20, s18, s58
    s_addc_u32 s21, s19, 0
    s_add_u32 s80, s50, s57
    s_addc_u32 s81, s51, 0
    s_add_u32 s84, s52, s57
    s_addc_u32 s85, s53, 0
    s_add_u32 s68, s44, s24
    s_addc_u32 s69, s45, 0
    s_mul_i32 s59, s94, 786432
    s_add_u32 s12, s54, s59
    s_addc_u32 s13, s55, 0
    s_add_u32 s8, s40, s59
    s_addc_u32 s9, s41, 0
    s_cmp_lg_u32 s39, 0
    s_cbranch_scc1 L_notleader0
    s_buffer_load_dwordx16 s[40:55], s[20:23], 0 glc
L_notleader0:
    buffer_load_dwordx4 v[240:243], v9, s[64:67], s33 offen offset:384 nt
    buffer_load_dwordx4 v[244:247], v9, s[64:67], s33 offen offset:1920 nt
    buffer_load_dwordx4 v[248:251], v9, s[64:67], s34 offen offset:384 nt
    buffer_load_dwordx4 v[252:255], v9, s[64:67], s34 offen offset:1920 nt
    s_add_u32 s4, s18, s24
    s_addc_u32 s5, s19, 0
    s_mov_b32 s6, 1572864
    s_mov_b32 s7, 0x20000
    s_mov_b32 s10, 786432
    s_mov_b32 s11, 0x20000
    s_mov_b32 s88, s16
    s_mov_b32 s89, s17
    s_add_u32 s16, s33, 3072
    s_add_u32 s17, s33, 6144
    s_mov_b32 s90, 256
    s_mov_b32 s91, 0x20000
    s_lshl_b32 s93, s94, 3
    s_cmp_lg_u32 s39, 0
    s_cbranch_scc1 L_notleader
    s_waitcnt lgkmcnt(0)
    s_mov_b32 s59, 1
    s_lshr_b32 s40, s40, 10
    s_min_u32 s40, s40, 31
    s_bitset1_b32 s59, s40
    s_lshr_b32 s41, s41, 10
    s_min_u32 s41, s41, 31
    s_bitset1_b32 s59, s41
    s_lshr_b32 s42, s42, 10
    s_min_u32 s42, s42, 31
    s_bitset1_b32 s59, s42
    s_lshr_b32 s43, s43, 10
    s_min_u32 s43, s43, 31
    s_bitset1_b32 s59, s43
    s_lshr_b32 s44, s44, 10
    s_min_u32 s44, s44, 31
    s_bitset1_b32 s59, s44
    s_lshr_b32 s45, s45, 10
    s_min_u32 s45, s45, 31
    s_bitset1_b32 s59, s45
    s_lshr_b32 s46, s46, 10
    s_min_u32 s46, s46, 31
    s_bitset1_b32 s59, s46
    s_lshr_b32 s47, s47, 10
    s_min_u32 s47, s47, 31
    s_bitset1_b32 s59, s47
    s_lshr_b32 s48, s48, 10
    s_min_u32 s48, s48, 31
    s_bitset1_b32 s59, s48
    s_lshr_b32 s49, s49, 10
    s_min_u32 s49, s49, 31
    s_bitset1_b32 s59, s49
    s_lshr_b32 s50, s50, 10
    s_min_u32 s50, s50, 31
    s_bitset1_b32 s59, s50
    s_lshr_b32 s51, s51, 10
    s_min_u32 s51, s51, 31
    s_bitset1_b32 s59, s51
    s_lshr_b32 s52, s52, 10
    s_min_u32 s52, s52, 31
    s_bitset1_b32 s59, s52
    s_lshr_b32 s53, s53, 10
    s_min_u32 s53, s53, 31
    s_bitset1_b32 s59, s53
    s_lshr_b32 s54, s54, 10
    s_min_u32 s54, s54, 31
    s_bitset1_b32 s59, s54
    s_lshr_b32 s55, s55, 10
    s_min_u32 s55, s55, 31
    s_bitset1_b32 s59, s55
    s_ff0_i32_b32 s59, s59
    s_lshl_b32 s59, s59, 10
    v_mov_b32 v52, s59
    s_mov_b64 exec, 1
    buffer_store_dword v52, off, s[88:91], s93 sc1
    s_mov_b64 exec, -1
L_notleader:
    s_lshl_b32 s24, s95, 2
    s_add_u32 s24, s24, 32
    s_buffer_load_dword s46, s[20:23], s24 glc
    s_getreg_b32 s45, hwreg(HW_REG_XCC_ID, 0, 4)
    s_lshl_b32 s45, s45, 5
    s_mov_b32 s44, 0
    buffer_load_dwordx4 v[112:115], v12, s[68:71], s35 offen offset:0 nt
    buffer_load_dwordx4 v[116:119], v12, s[68:71], s35 offen offset:768 nt
    buffer_load_dwordx4 v[120:123], v12, s[68:71], s35 offen offset:1536 nt
    buffer_load_dwordx4 v[124:127], v12, s[68:71], s35 offen offset:2304 nt
    buffer_load_dwordx2 v[40:41], off, s[80:83], s37 offset:0
    buffer_load_dwordx2 v[42:43], off, s[84:87], s37 offset:0
    buffer_load_dwordx2 v[44:45], off, s[80:83], s37 offset:8
    buffer_load_dwordx2 v[46:47], off, s[84:87], s37 offset:8
    s_mov_b32 s14, 786432
    s_mov_b32 s15, 0x20000
    s_lshl_b32 s24, s25, 8
    s_add_u32 s93, s93, s24
    v_mul_u32_u24 v30, 3072, v24
    v_add_u32 v4, v30, v1
    v_lshl_add_u32 v30, v24, 3, v26
    v_mul_u32_u24 v30, 384, v30
    v_lshlrev_b32 v31, 2, v29
    v_xor_b32 v31, v27, v31
    v_lshl_add_u32 v30, v31, 4, v30
    v_or_b32 v11, v30, v48
    v_lshlrev_b32 v30, 8, v24
    v_add_u32 v30, 12288, v30
    v_lshrrev_b32 v31, 4, v25
    v_lshl_add_u32 v30, v31, 10, v30
    v_and_b32 v31, 15, v25
    v_lshl_add_u32 v30, v31, 4, v30
    v_or_b32 v20, v30, v48
    s_lshl_b32 s24, s95, 2
    v_lshl_add_u32 v13, v0, 2, s24
    v_cmp_lt_u32 vcc, 0, v0
    v_mov_b32 v30, 0x40000000
    s_nop 0
    v_cndmask_b32 v13, v13, v30, vcc
    s_mul_i32 s26, s25, 3072
    s_add_u32 s26, s26, 12288
    s_add_u32 s56, s26, 24576
    s_add_u32 s24, s95, 1
    s_and_b32 s24, s24, 7
    s_mul_i32 s32, s24, 24576
    s_add_u32 s27, s32, 12288
    s_mov_b32 s28, 98304
    s_mov_b32 s30, 73728
    v_add_u32 v1, 24576, v1
    s_mov_b32 s38, 0x3dd53b95
    s_mov_b32 s97, 0xffff0000
    s_mov_b32 s96, 100000
    v_and_b32 v26, 15, v25
    v_lshrrev_b32 v27, 4, v25
    v_bfe_u32 v28, v25, 1, 3
    v_xor_b32 v29, v27, v28
    v_mul_u32_u24 v30, 384, v26
    v_lshl_add_u32 v2, v29, 4, v30
    v_xor_b32 v3, 64, v2
    s_mul_i32 s40, s25, 6144
    s_add_u32 s40, s40, 73728
    v_lshrrev_b32 v29, 1, v27
    v_xor_b32 v29, v29, v28
    v_lshl_add_u32 v31, v29, 4, v30
    v_and_b32 v29, 1, v27
    v_lshl_add_u32 v31, v29, 3, v31
    v_xor_b32 v22, 0, v31
    v_add_u32 v22, s40, v22
    v_xor_b32 v23, 32, v31
    v_add_u32 v23, s40, v23
    v_xor_b32 v142, 64, v31
    v_add_u32 v142, s40, v142
    v_xor_b32 v143, 96, v31
    v_add_u32 v143, s40, v143
    s_lshl_b32 s24, s95, 2
    s_add_u32 s24, s24, s25
    s_mul_i32 s24, s24, 24576
    v_add_u32 v26, 0, v25
    v_mul_u32_u24 v27, 2731, v26
    v_lshrrev_b32 v27, 17, v27
    v_and_b32 v27, 7, v27
    v_xor_b32 v26, v26, v27
    v_lshlrev_b32 v136, 4, v26
    v_add_u32 v136, s24, v136
    v_add_u32 v26, 64, v25
    v_mul_u32_u24 v27, 2731, v26
    v_lshrrev_b32 v27, 17, v27
    v_and_b32 v27, 7, v27
    v_xor_b32 v26, v26, v27
    v_lshlrev_b32 v137, 4, v26
    v_add_u32 v137, s24, v137
    v_add_u32 v26, 128, v25
    v_mul_u32_u24 v27, 2731, v26
    v_lshrrev_b32 v27, 17, v27
    v_and_b32 v27, 7, v27
    v_xor_b32 v26, v26, v27
    v_lshlrev_b32 v138, 4, v26
    v_add_u32 v138, s24, v138
    v_add_u32 v26, 192, v25
    v_mul_u32_u24 v27, 2731, v26
    v_lshrrev_b32 v27, 17, v27
    v_and_b32 v27, 7, v27
    v_xor_b32 v26, v26, v27
    v_lshlrev_b32 v139, 4, v26
    v_add_u32 v139, s24, v139
    v_add_u32 v26, 256, v25
    v_mul_u32_u24 v27, 2731, v26
    v_lshrrev_b32 v27, 17, v27
    v_and_b32 v27, 7, v27
    v_xor_b32 v26, v26, v27
    v_lshlrev_b32 v140, 4, v26
    v_add_u32 v140, s24, v140
    v_add_u32 v26, 320, v25
    v_mul_u32_u24 v27, 2731, v26
    v_lshrrev_b32 v27, 17, v27
    v_and_b32 v27, 7, v27
    v_xor_b32 v26, v26, v27
    v_lshlrev_b32 v141, 4, v26
    v_add_u32 v141, s24, v141
    v_mov_b32 v5, 0
    v_mov_b32 v6, 0
    v_mov_b32 v7, 0
    v_mov_b32 v8, 0
    s_mov_b32 s62, -1
    s_mov_b32 s63, 0xffff
    s_waitcnt vmcnt(12)
    buffer_load_dwordx4 v[80:83], v12, s[68:71], s16 offen offset:0 nt
    buffer_load_dwordx4 v[84:87], v12, s[68:71], s16 offen offset:768 nt
    buffer_load_dwordx4 v[88:91], v12, s[68:71], s16 offen offset:1536 nt
    buffer_load_dwordx4 v[92:95], v12, s[68:71], s16 offen offset:2304 nt
    v_lshlrev_b32 v48, 16, v32
    v_and_b32 v49, s97, v32
    v_lshlrev_b32 v50, 16, v34
    v_and_b32 v51, s97, v34
    v_mul_f32 v48, s38, v48
    v_mul_f32 v49, s38, v49
    v_mul_f32_e64 v50, -v50, v48
    v_mul_f32_e64 v51, -v51, v49
    v_cvt_f32_i32 v224, v224
    v_cvt_f32_i32 v225, v225
    v_fma_f32 v224, v224, v48, v50
    v_fma_f32 v225, v225, v49, v51
    v_cvt_pk_bf16_f32 v224, v224, v225
    v_cvt_f32_i32 v228, v228
    v_cvt_f32_i32 v229, v229
    v_fma_f32 v228, v228, v48, v50
    v_fma_f32 v229, v229, v49, v51
    v_cvt_pk_bf16_f32 v228, v228, v229
    v_cvt_f32_i32 v232, v232
    v_cvt_f32_i32 v233, v233
    v_fma_f32 v232, v232, v48, v50
    v_fma_f32 v233, v233, v49, v51
    v_cvt_pk_bf16_f32 v232, v232, v233
    v_cvt_f32_i32 v236, v236
    v_cvt_f32_i32 v237, v237
    v_fma_f32 v236, v236, v48, v50
    v_fma_f32 v237, v237, v49, v51
    v_cvt_pk_bf16_f32 v236, v236, v237
    v_lshlrev_b32 v48, 16, v33
    v_and_b32 v49, s97, v33
    v_lshlrev_b32 v50, 16, v35
    v_and_b32 v51, s97, v35
    v_mul_f32 v48, s38, v48
    v_mul_f32 v49, s38, v49
    v_mul_f32_e64 v50, -v50, v48
    v_mul_f32_e64 v51, -v51, v49
    v_cvt_f32_i32 v226, v226
    v_cvt_f32_i32 v227, v227
    v_fma_f32 v226, v226, v48, v50
    v_fma_f32 v227, v227, v49, v51
    v_cvt_pk_bf16_f32 v225, v226, v227
    v_cvt_f32_i32 v230, v230
    v_cvt_f32_i32 v231, v231
    v_fma_f32 v230, v230, v48, v50
    v_fma_f32 v231, v231, v49, v51
    v_cvt_pk_bf16_f32 v229, v230, v231
    v_cvt_f32_i32 v234, v234
    v_cvt_f32_i32 v235, v235
    v_fma_f32 v234, v234, v48, v50
    v_fma_f32 v235, v235, v49, v51
    v_cvt_pk_bf16_f32 v233, v234, v235
    v_cvt_f32_i32 v238, v238
    v_cvt_f32_i32 v239, v239
    v_fma_f32 v238, v238, v48, v50
    v_fma_f32 v239, v239, v49, v51
    v_cvt_pk_bf16_f32 v237, v238, v239
    s_waitcnt vmcnt(12)
    v_lshlrev_b32 v48, 16, v36
    v_and_b32 v49, s97, v36
    v_lshlrev_b32 v50, 16, v38
    v_and_b32 v51, s97, v38
    v_mul_f32 v48, s38, v48
    v_mul_f32 v49, s38, v49
    v_mul_f32_e64 v50, -v50, v48
    v_mul_f32_e64 v51, -v51, v49
    v_cvt_f32_i32 v240, v240
    v_cvt_f32_i32 v241, v241
    v_fma_f32 v240, v240, v48, v50
    v_fma_f32 v241, v241, v49, v51
    v_cvt_pk_bf16_f32 v226, v240, v241
    v_cvt_f32_i32 v244, v244
    v_cvt_f32_i32 v245, v245
    v_fma_f32 v244, v244, v48, v50
    v_fma_f32 v245, v245, v49, v51
    v_cvt_pk_bf16_f32 v230, v244, v245
    v_cvt_f32_i32 v248, v248
    v_cvt_f32_i32 v249, v249
    v_fma_f32 v248, v248, v48, v50
    v_fma_f32 v249, v249, v49, v51
    v_cvt_pk_bf16_f32 v234, v248, v249
    v_cvt_f32_i32 v252, v252
    v_cvt_f32_i32 v253, v253
    v_fma_f32 v252, v252, v48, v50
    v_fma_f32 v253, v253, v49, v51
    v_cvt_pk_bf16_f32 v238, v252, v253
    v_lshlrev_b32 v48, 16, v37
    v_and_b32 v49, s97, v37
    v_lshlrev_b32 v50, 16, v39
    v_and_b32 v51, s97, v39
    v_mul_f32 v48, s38, v48
    v_mul_f32 v49, s38, v49
    v_mul_f32_e64 v50, -v50, v48
    v_mul_f32_e64 v51, -v51, v49
    v_cvt_f32_i32 v242, v242
    v_cvt_f32_i32 v243, v243
    v_fma_f32 v242, v242, v48, v50
    v_fma_f32 v243, v243, v49, v51
    v_cvt_pk_bf16_f32 v227, v242, v243
    v_cvt_f32_i32 v246, v246
    v_cvt_f32_i32 v247, v247
    v_fma_f32 v246, v246, v48, v50
    v_fma_f32 v247, v247, v49, v51
    v_cvt_pk_bf16_f32 v231, v246, v247
    v_cvt_f32_i32 v250, v250
    v_cvt_f32_i32 v251, v251
    v_fma_f32 v250, v250, v48, v50
    v_fma_f32 v251, v251, v49, v51
    v_cvt_pk_bf16_f32 v235, v250, v251
    v_cvt_f32_i32 v254, v254
    v_cvt_f32_i32 v255, v255
    v_fma_f32 v254, v254, v48, v50
    v_fma_f32 v255, v255, v49, v51
    v_cvt_pk_bf16_f32 v239, v254, v255
    buffer_store_dwordx4 v[224:227], v11, s[4:7], s33 offen offset:0
    s_mov_b64 exec, s[62:63]
    ds_write_b128 v11, v[224:227] offset:0
    s_mov_b64 exec, -1
    v_xor_b32 v55, 16, v11
    buffer_store_dwordx4 v[228:231], v55, s[4:7], s33 offen offset:768
    s_mov_b64 exec, s[62:63]
    ds_write_b128 v55, v[228:231] offset:768
    s_mov_b64 exec, -1
    v_xor_b32 v54, 32, v11
    buffer_store_dwordx4 v[232:235], v54, s[4:7], s33 offen offset:1536
    s_mov_b64 exec, s[62:63]
    ds_write_b128 v54, v[232:235] offset:1536
    s_mov_b64 exec, -1
    v_xor_b32 v55, 48, v11
    buffer_store_dwordx4 v[236:239], v55, s[4:7], s33 offen offset:2304
    s_mov_b64 exec, s[62:63]
    ds_write_b128 v55, v[236:239] offset:2304
    s_mov_b64 exec, -1
    s_mov_b32 s41, 0
    s_add_u32 m0, s40, 24576
    s_nop 0
    buffer_load_dwordx4 v136, s[8:11], s41 offen nt lds
    s_add_u32 m0, s40, 25600
    s_nop 0
    buffer_load_dwordx4 v137, s[8:11], s41 offen nt lds
    s_add_u32 m0, s40, 26624
    s_nop 0
    buffer_load_dwordx4 v138, s[8:11], s41 offen nt lds
    s_add_u32 m0, s40, 27648
    s_nop 0
    buffer_load_dwordx4 v139, s[8:11], s41 offen nt lds
    s_add_u32 m0, s40, 28672
    s_nop 0
    buffer_load_dwordx4 v140, s[8:11], s41 offen nt lds
    s_add_u32 m0, s40, 29696
    s_waitcnt vmcnt(20)
    buffer_load_dwordx4 v141, s[8:11], s41 offen nt lds
    s_waitcnt vmcnt(14)
    v_lshlrev_b32 v48, 16, v40
    v_and_b32 v49, s97, v40
    v_lshlrev_b32 v50, 16, v42
    v_and_b32 v51, s97, v42
    v_mul_f32_e64 v50, -v50, v48
    v_mul_f32_e64 v51, -v51, v49
    v_cvt_f32_i32 v112, v112
    v_cvt_f32_i32 v116, v116
    v_fma_f32 v112, v112, v48, v50
    v_fma_f32 v116, v116, v49, v51
    v_cvt_f32_i32 v113, v113
    v_cvt_f32_i32 v117, v117
    v_fma_f32 v113, v113, v48, v50
    v_fma_f32 v117, v117, v49, v51
    v_cvt_f32_i32 v114, v114
    v_cvt_f32_i32 v118, v118
    v_fma_f32 v114, v114, v48, v50
    v_fma_f32 v118, v118, v49, v51
    v_cvt_f32_i32 v115, v115
    v_cvt_f32_i32 v119, v119
    v_fma_f32 v115, v115, v48, v50
    v_fma_f32 v119, v119, v49, v51
    v_lshlrev_b32 v48, 16, v41
    v_and_b32 v49, s97, v41
    v_lshlrev_b32 v50, 16, v43
    v_and_b32 v51, s97, v43
    v_mul_f32_e64 v50, -v50, v48
    v_mul_f32_e64 v51, -v51, v49
    v_cvt_f32_i32 v120, v120
    v_cvt_f32_i32 v124, v124
    v_fma_f32 v120, v120, v48, v50
    v_fma_f32 v124, v124, v49, v51
    v_cvt_f32_i32 v121, v121
    v_cvt_f32_i32 v125, v125
    v_fma_f32 v121, v121, v48, v50
    v_fma_f32 v125, v125, v49, v51
    v_cvt_f32_i32 v122, v122
    v_cvt_f32_i32 v126, v126
    v_fma_f32 v122, v122, v48, v50
    v_fma_f32 v126, v126, v49, v51
    v_cvt_f32_i32 v123, v123
    v_cvt_f32_i32 v127, v127
    v_fma_f32 v123, v123, v48, v50
    v_fma_f32 v127, v127, v49, v51
    v_cvt_pk_bf16_f32 v112, v112, v116
    v_cvt_pk_bf16_f32 v116, v113, v117
    v_cvt_pk_bf16_f32 v113, v120, v124
    v_cvt_pk_bf16_f32 v117, v121, v125
    v_cvt_pk_bf16_f32 v120, v114, v118
    v_cvt_pk_bf16_f32 v121, v122, v126
    v_cvt_pk_bf16_f32 v124, v115, v119
    v_cvt_pk_bf16_f32 v125, v123, v127
    s_waitcnt vmcnt(10)
    v_lshlrev_b32 v48, 16, v44
    v_and_b32 v49, s97, v44
    v_lshlrev_b32 v50, 16, v46
    v_and_b32 v51, s97, v46
    v_mul_f32_e64 v50, -v50, v48
    v_mul_f32_e64 v51, -v51, v49
    v_cvt_f32_i32 v80, v80
    v_cvt_f32_i32 v84, v84
    v_fma_f32 v80, v80, v48, v50
    v_fma_f32 v84, v84, v49, v51
    v_cvt_f32_i32 v81, v81
    v_cvt_f32_i32 v85, v85
    v_fma_f32 v81, v81, v48, v50
    v_fma_f32 v85, v85, v49, v51
    v_cvt_f32_i32 v82, v82
    v_cvt_f32_i32 v86, v86
    v_fma_f32 v82, v82, v48, v50
    v_fma_f32 v86, v86, v49, v51
    v_cvt_f32_i32 v83, v83
    v_cvt_f32_i32 v87, v87
    v_fma_f32 v83, v83, v48, v50
    v_fma_f32 v87, v87, v49, v51
    v_lshlrev_b32 v48, 16, v45
    v_and_b32 v49, s97, v45
    v_lshlrev_b32 v50, 16, v47
    v_and_b32 v51, s97, v47
    v_mul_f32_e64 v50, -v50, v48
    v_mul_f32_e64 v51, -v51, v49
    v_cvt_f32_i32 v88, v88
    v_cvt_f32_i32 v92, v92
    v_fma_f32 v88, v88, v48, v50
    v_fma_f32 v92, v92, v49, v51
    v_cvt_f32_i32 v89, v89
    v_cvt_f32_i32 v93, v93
    v_fma_f32 v89, v89, v48, v50
    v_fma_f32 v93, v93, v49, v51
    v_cvt_f32_i32 v90, v90
    v_cvt_f32_i32 v94, v94
    v_fma_f32 v90, v90, v48, v50
    v_fma_f32 v94, v94, v49, v51
    v_cvt_f32_i32 v91, v91
    v_cvt_f32_i32 v95, v95
    v_fma_f32 v91, v91, v48, v50
    v_fma_f32 v95, v95, v49, v51
    v_cvt_pk_bf16_f32 v114, v80, v84
    v_cvt_pk_bf16_f32 v118, v81, v85
    v_cvt_pk_bf16_f32 v115, v88, v92
    v_cvt_pk_bf16_f32 v119, v89, v93
    v_cvt_pk_bf16_f32 v122, v82, v86
    v_cvt_pk_bf16_f32 v123, v90, v94
    v_cvt_pk_bf16_f32 v126, v83, v87
    v_cvt_pk_bf16_f32 v127, v91, v95
    buffer_store_dwordx4 v[112:115], v20, s[4:7], s35 offen offset:0
    buffer_store_dwordx4 v[116:119], v20, s[4:7], s35 offen offset:3072
    buffer_store_dwordx4 v[120:123], v20, s[4:7], s17 offen offset:0
    buffer_store_dwordx4 v[124:127], v20, s[4:7], s17 offen offset:3072
    s_mov_b64 exec, s[62:63]
    ds_write_b128 v20, v[112:115] offset:12288
    ds_write_b128 v20, v[116:119] offset:15360
    ds_write_b128 v20, v[120:123] offset:18432
    ds_write_b128 v20, v[124:127] offset:21504
    s_mov_b64 exec, -1
    buffer_load_dword v0, off, s[88:91], s93 sc1
    s_mov_b32 s41, 6144
    s_add_u32 m0, s40, 0
    s_nop 0
    buffer_load_dwordx4 v136, s[8:11], s41 offen nt lds
    s_add_u32 m0, s40, 1024
    s_nop 0
    buffer_load_dwordx4 v137, s[8:11], s41 offen nt lds
    s_add_u32 m0, s40, 2048
    s_nop 0
    buffer_load_dwordx4 v138, s[8:11], s41 offen nt lds
    s_add_u32 m0, s40, 3072
    s_nop 0
    buffer_load_dwordx4 v139, s[8:11], s41 offen nt lds
    s_add_u32 m0, s40, 4096
    s_nop 0
    buffer_load_dwordx4 v140, s[8:11], s41 offen nt lds
    s_add_u32 m0, s40, 5120
    s_waitcnt vmcnt(15)
    buffer_load_dwordx4 v141, s[8:11], s41 offen nt lds
    s_waitcnt vmcnt(6)
    s_cmp_lg_u32 s25, 0
    s_cbranch_scc1 L_tagdone
    v_readfirstlane_b32 s42, v0
    s_mov_b32 s39, 100
    s_waitcnt lgkmcnt(0)
    s_and_b32 s46, s46, 0xfffffc00
L_tagretry:
    s_cmp_eq_u32 s42, s46
    s_cselect_b32 s42, 0, s42
    s_cmp_lg_u32 s42, 0
    s_cbranch_scc1 L_tagok
    s_sub_u32 s39, s39, 1
    s_cbranch_scc1 L_tagslow
    s_sleep 4
    s_buffer_load_dword s42, s[88:91], s93 glc
    s_waitcnt lgkmcnt(0)
    s_branch L_tagretry
L_tagok:
    s_add_u32 s42, s42, s45
    v_mov_b32 v0, s42
    v_mov_b32 v16, 147456
    ds_write_b32 v16, v0
L_tagdone:
    s_waitcnt lgkmcnt(0)
    s_barrier
    v_add_u32 v0, 1, v0
    buffer_store_dword v0, v13, s[20:23], 0 offen
    buffer_store_dword v0, v13, s[20:23], 0 offen offset:32 sc1
    v_mov_b32 v16, 147456
    ds_read_b32 v17, v16
    s_mov_b32 s88, s60
    s_mov_b32 s89, s61
    s_mov_b32 s90, L_slow-standalone__kv_cache_quant_int4_int2_kv_with_per_channel_or_per_token_scales__prompt_kernel
    s_lshr_b32 s24, s2, 3
    s_mul_i32 s93, s24, 43
    s_lshr_b32 s93, s93, 7
    s_mul_i32 s39, s93, 3
    s_sub_u32 s24, s24, s39
    s_lshl_b32 s24, s24, 10
    s_mul_i32 s93, s93, 12288
    s_add_u32 s93, s93, s24
    ds_read_b128 v[144:147], v2 offset:0
    ds_read_b128 v[148:151], v3 offset:0
    ds_read_b128 v[152:155], v2 offset:6144
    ds_read_b128 v[156:159], v3 offset:6144
    ds_read_b128 v[160:163], v2 offset:128
    ds_read_b128 v[164:167], v3 offset:128
    ds_read_b128 v[168:171], v2 offset:6272
    ds_read_b128 v[172:175], v3 offset:6272
    ds_read_b128 v[176:179], v2 offset:256
    ds_read_b128 v[180:183], v3 offset:256
    ds_read_b128 v[184:187], v2 offset:6400
    ds_read_b128 v[188:191], v3 offset:6400
    s_waitcnt vmcnt(13)
    ds_read_b64 a[192:193], v22 offset:24576
    ds_read_b64 a[194:195], v142 offset:24704
    ds_read_b64 a[196:197], v23 offset:24576
    ds_read_b64 a[198:199], v143 offset:24704
    ds_read_b64 a[200:201], v142 offset:24576
    ds_read_b64 a[202:203], v22 offset:24832
    ds_read_b64 a[204:205], v143 offset:24576
    ds_read_b64 a[206:207], v23 offset:24832
    ds_read_b64 a[208:209], v22 offset:24704
    ds_read_b64 a[210:211], v142 offset:24832
    ds_read_b64 a[212:213], v23 offset:24704
    ds_read_b64 a[214:215], v143 offset:24832
    s_waitcnt lgkmcnt(15)
    v_readfirstlane_b32 s92, v17
    s_add_u32 s92, s92, 1
    s_mov_b32 s41, 12288
    s_add_u32 m0, s40, 49152
    s_nop 0
    buffer_load_dwordx4 v136, s[8:11], s41 offen nt lds
    s_add_u32 m0, s40, 50176
    s_nop 0
    buffer_load_dwordx4 v137, s[8:11], s41 offen nt lds
    s_add_u32 m0, s40, 51200
    s_nop 0
    buffer_load_dwordx4 v138, s[8:11], s41 offen nt lds
    s_waitcnt lgkmcnt(0)
    v_mfma_f32_16x16x32_bf16 v[64:67], v[144:147], a[192:195], 0
    v_mfma_f32_16x16x32_bf16 v[64:67], v[148:151], a[196:199], v[64:67]
    v_mfma_f32_16x16x32_bf16 v[64:67], v[160:163], a[200:203], v[64:67]
    v_mfma_f32_16x16x32_bf16 v[64:67], v[164:167], a[204:207], v[64:67]
    v_mfma_f32_16x16x32_bf16 v[64:67], v[176:179], a[208:211], v[64:67]
    v_mfma_f32_16x16x32_bf16 v[64:67], v[180:183], a[212:215], v[64:67]
    v_mfma_f32_16x16x32_bf16 v[96:99], v[152:155], a[192:195], 0
    v_mfma_f32_16x16x32_bf16 v[96:99], v[156:159], a[196:199], v[96:99]
    v_mfma_f32_16x16x32_bf16 v[96:99], v[168:171], a[200:203], v[96:99]
    v_mfma_f32_16x16x32_bf16 v[96:99], v[172:175], a[204:207], v[96:99]
    v_mfma_f32_16x16x32_bf16 v[96:99], v[184:187], a[208:211], v[96:99]
    v_mfma_f32_16x16x32_bf16 v[96:99], v[188:191], a[212:215], v[96:99]
    s_waitcnt vmcnt(5)
    ds_read_b64 a[216:217], v22 offset:0
    ds_read_b64 a[218:219], v142 offset:128
    ds_read_b64 a[220:221], v23 offset:0
    ds_read_b64 a[222:223], v143 offset:128
    ds_read_b64 a[224:225], v142 offset:0
    ds_read_b64 a[226:227], v22 offset:256
    ds_read_b64 a[228:229], v143 offset:0
    ds_read_b64 a[230:231], v23 offset:256
    ds_read_b64 a[232:233], v22 offset:128
    ds_read_b64 a[234:235], v142 offset:256
    ds_read_b64 a[236:237], v23 offset:128
    ds_read_b64 a[238:239], v143 offset:256
    s_mov_b32 s41, 12288
    s_add_u32 m0, s40, 52224
    s_nop 0
    buffer_load_dwordx4 v139, s[8:11], s41 offen nt lds
    s_add_u32 m0, s40, 53248
    s_nop 0
    buffer_load_dwordx4 v140, s[8:11], s41 offen nt lds
    s_add_u32 m0, s40, 54272
    s_nop 0
    buffer_load_dwordx4 v141, s[8:11], s41 offen nt lds
    s_waitcnt lgkmcnt(0)
    v_mfma_f32_16x16x32_bf16 v[68:71], v[144:147], a[216:219], 0
    v_mfma_f32_16x16x32_bf16 v[68:71], v[148:151], a[220:223], v[68:71]
    v_mfma_f32_16x16x32_bf16 v[68:71], v[160:163], a[224:227], v[68:71]
    v_mfma_f32_16x16x32_bf16 v[68:71], v[164:167], a[228:231], v[68:71]
    v_mfma_f32_16x16x32_bf16 v[68:71], v[176:179], a[232:235], v[68:71]
    v_mfma_f32_16x16x32_bf16 v[68:71], v[180:183], a[236:239], v[68:71]
    v_mfma_f32_16x16x32_bf16 v[100:103], v[152:155], a[216:219], 0
    v_mfma_f32_16x16x32_bf16 v[100:103], v[156:159], a[220:223], v[100:103]
    v_mfma_f32_16x16x32_bf16 v[100:103], v[168:171], a[224:227], v[100:103]
    v_mfma_f32_16x16x32_bf16 v[100:103], v[172:175], a[228:231], v[100:103]
    v_mfma_f32_16x16x32_bf16 v[100:103], v[184:187], a[232:235], v[100:103]
    v_mfma_f32_16x16x32_bf16 v[100:103], v[188:191], a[236:239], v[100:103]
    s_nop 7
    ds_read_b128 v[24:27], v1 offset:0
    ds_read_b128 v[28:31], v1 offset:1024
    ds_read_b128 v[32:35], v1 offset:2048
    ds_read_b128 v[36:39], v1 offset:3072
    s_mov_b32 s41, 18432
    s_add_u32 m0, s40, 24576
    s_nop 0
    buffer_load_dwordx4 v136, s[8:11], s41 offen nt lds
    v_max3_f32 v48, v64, v65, v66
    v_max3_f32 v50, v68, v69, v70
    v_max3_f32 v48, v48, v67, v96
    v_max3_f32 v50, v50, v71, v100
    v_max3_f32 v48, v48, v97, v98
    v_max3_f32 v50, v50, v101, v102
    v_max_f32 v48, v48, v99
    v_max_f32 v50, v50, v103
    v_mov_b32 v49, v48
    v_mov_b32 v51, v50
    s_nop 0
    v_permlane16_swap_b32 v48, v49
    v_permlane16_swap_b32 v50, v51
    s_nop 0
    v_max_f32 v48, v48, v49
    v_max_f32 v50, v50, v51
    v_mov_b32 v49, v48
    v_mov_b32 v51, v50
    s_nop 0
    v_permlane32_swap_b32 v48, v49
    v_permlane32_swap_b32 v50, v51
    s_nop 0
    v_max_f32 v48, v48, v49
    v_max_f32 v50, v50, v51
    v_sub_f32 v128, 0, v48
    v_sub_f32 v129, 0, v48
    v_sub_f32 v130, 0, v48
    v_sub_f32 v131, 0, v48
    v_sub_f32 v132, 0, v50
    v_sub_f32 v133, 0, v50
    s_add_u32 m0, s40, 25600
    s_nop 0
    buffer_load_dwordx4 v137, s[8:11], s41 offen nt lds
    v_sub_f32 v134, 0, v50
    v_sub_f32 v135, 0, v50
    v_add_f32 v64, v64, v128
    v_add_f32 v65, v65, v128
    v_add_f32 v66, v66, v128
    v_add_f32 v67, v67, v128
    v_add_f32 v96, v96, v128
    v_add_f32 v97, v97, v128
    v_add_f32 v98, v98, v128
    v_add_f32 v99, v99, v128
    v_add_f32 v68, v68, v132
    v_add_f32 v69, v69, v132
    v_add_f32 v70, v70, v132
    v_add_f32 v71, v71, v132
    v_add_f32 v100, v100, v132
    v_add_f32 v101, v101, v132
    v_add_f32 v102, v102, v132
    v_add_f32 v103, v103, v132
    v_exp_f32 v16, v64
    v_exp_f32 v17, v65
    v_exp_f32 v18, v66
    v_add_f32 v5, v5, v16
    v_add_f32 v5, v5, v17
    v_exp_f32 v19, v67
    v_cvt_pk_bf16_f32 v64, v16, v17
    v_exp_f32 v16, v96
    v_add_f32 v5, v5, v18
    v_add_f32 v5, v5, v19
    v_exp_f32 v17, v97
    s_add_u32 m0, s40, 26624
    s_nop 0
    buffer_load_dwordx4 v138, s[8:11], s41 offen nt lds
    v_cvt_pk_bf16_f32 v65, v18, v19
    v_exp_f32 v18, v98
    v_add_f32 v5, v5, v16
    v_add_f32 v5, v5, v17
    v_exp_f32 v19, v99
    v_cvt_pk_bf16_f32 v66, v16, v17
    v_exp_f32 v16, v68
    v_add_f32 v5, v5, v18
    v_add_f32 v5, v5, v19
    v_exp_f32 v17, v69
    v_cvt_pk_bf16_f32 v67, v18, v19
    v_exp_f32 v18, v70
    v_add_f32 v6, v6, v16
    v_add_f32 v6, v6, v17
    v_exp_f32 v19, v71
    v_cvt_pk_bf16_f32 v68, v16, v17
    v_exp_f32 v16, v100
    v_add_f32 v6, v6, v18
    v_add_f32 v6, v6, v19
    v_exp_f32 v17, v101
    v_cvt_pk_bf16_f32 v69, v18, v19
    v_exp_f32 v18, v102
    v_add_f32 v6, v6, v16
    v_add_f32 v6, v6, v17
    v_exp_f32 v19, v103
    v_cvt_pk_bf16_f32 v70, v16, v17
    v_add_f32 v6, v6, v18
    v_add_f32 v6, v6, v19
    v_cvt_pk_bf16_f32 v71, v18, v19
    s_buffer_load_dwordx8 s[48:55], s[20:23], s44 glc
    s_waitcnt lgkmcnt(2)
    v_mfma_f32_16x16x32_bf16 a[0:3], v[64:67], v[24:27], 0
    ds_read_b128 v[40:43], v1 offset:4096
    v_mfma_f32_16x16x32_bf16 a[4:7], v[64:67], v[28:31], 0
    v_mfma_f32_16x16x32_bf16 a[48:51], v[68:71], v[24:27], 0
    ds_read_b128 v[44:47], v1 offset:5120
    v_mfma_f32_16x16x32_bf16 a[52:55], v[68:71], v[28:31], 0
    s_waitcnt lgkmcnt(2)
    v_mfma_f32_16x16x32_bf16 a[8:11], v[64:67], v[32:35], 0
    ds_read_b128 v[24:27], v1 offset:6144
    v_mfma_f32_16x16x32_bf16 a[12:15], v[64:67], v[36:39], 0
    v_mfma_f32_16x16x32_bf16 a[56:59], v[68:71], v[32:35], 0
    ds_read_b128 v[28:31], v1 offset:7168
    v_mfma_f32_16x16x32_bf16 a[60:63], v[68:71], v[36:39], 0
    s_waitcnt lgkmcnt(2)
    v_mfma_f32_16x16x32_bf16 a[16:19], v[64:67], v[40:43], 0
    ds_read_b128 v[32:35], v1 offset:8192
    v_mfma_f32_16x16x32_bf16 a[20:23], v[64:67], v[44:47], 0
    v_mfma_f32_16x16x32_bf16 a[64:67], v[68:71], v[40:43], 0
    ds_read_b128 v[36:39], v1 offset:9216
    v_mfma_f32_16x16x32_bf16 a[68:71], v[68:71], v[44:47], 0
    s_waitcnt lgkmcnt(2)
    v_mfma_f32_16x16x32_bf16 a[24:27], v[64:67], v[24:27], 0
    ds_read_b128 v[40:43], v1 offset:10240
    v_mfma_f32_16x16x32_bf16 a[28:31], v[64:67], v[28:31], 0
    v_mfma_f32_16x16x32_bf16 a[72:75], v[68:71], v[24:27], 0
    ds_read_b128 v[44:47], v1 offset:11264
    v_mfma_f32_16x16x32_bf16 a[76:79], v[68:71], v[28:31], 0
    s_waitcnt lgkmcnt(2)
    v_mfma_f32_16x16x32_bf16 a[32:35], v[64:67], v[32:35], 0
    v_mfma_f32_16x16x32_bf16 a[36:39], v[64:67], v[36:39], 0
    v_mfma_f32_16x16x32_bf16 a[80:83], v[68:71], v[32:35], 0
    v_mfma_f32_16x16x32_bf16 a[84:87], v[68:71], v[36:39], 0
    s_waitcnt lgkmcnt(0)
    v_mfma_f32_16x16x32_bf16 a[40:43], v[64:67], v[40:43], 0
    v_mfma_f32_16x16x32_bf16 a[44:47], v[64:67], v[44:47], 0
    v_mfma_f32_16x16x32_bf16 a[88:91], v[68:71], v[40:43], 0
    v_mfma_f32_16x16x32_bf16 a[92:95], v[68:71], v[44:47], 0
    s_waitcnt lgkmcnt(0)
    s_sub_u32 s48, s48, s92
    s_sub_u32 s49, s49, s92
    s_sub_u32 s50, s50, s92
    s_sub_u32 s51, s51, s92
    s_sub_u32 s52, s52, s92
    s_sub_u32 s53, s53, s92
    s_sub_u32 s54, s54, s92
    s_sub_u32 s55, s55, s92
    s_max_u32 s48, s48, s49
    s_max_u32 s48, s48, s50
    s_max_u32 s48, s48, s51
    s_max_u32 s48, s48, s52
    s_max_u32 s48, s48, s53
    s_max_u32 s48, s48, s54
    s_max_u32 s48, s48, s55
    s_cmp_ge_u32 s48, 16
    s_cbranch_scc1 L_pollslow0
L_pollok0:
    s_add_u32 s92, s92, 1
    s_mov_b32 s44, 32
    s_mov_b32 m0, s26
    s_nop 0
    buffer_load_dwordx4 v4, s[4:7], s32 offen offset:0 sc1 lds
    buffer_load_dwordx4 v4, s[4:7], s32 offen offset:1024 sc1 lds
    buffer_load_dwordx4 v4, s[4:7], s32 offen offset:2048 sc1 lds
    s_add_u32 s32, s32, 24576
    s_sub_u32 s57, s32, 196608
    s_min_u32 s32, s32, s57
    s_add_u32 s26, s26, 36864
    s_sub_u32 s57, s26, 147456
    s_min_u32 s26, s26, s57
    s_mov_b32 m0, s26
    s_waitcnt vmcnt(11)
    buffer_load_dwordx4 v4, s[4:7], s32 offen offset:0 sc1 lds
    s_waitcnt vmcnt(11)
    buffer_load_dwordx4 v4, s[4:7], s32 offen offset:1024 sc1 lds
    s_waitcnt vmcnt(11)
    buffer_load_dwordx4 v4, s[4:7], s32 offen offset:2048 sc1 lds
    s_add_u32 s32, s32, 24576
    s_sub_u32 s57, s32, 196608
    s_min_u32 s32, s32, s57
    s_add_u32 s26, s26, 12288
    s_mov_b32 m0, s26
    s_waitcnt vmcnt(11)
    buffer_load_dwordx4 v4, s[4:7], s32 offen offset:0 sc1 lds
    s_waitcnt vmcnt(11)
    buffer_load_dwordx4 v4, s[4:7], s32 offen offset:1024 sc1 lds
    s_waitcnt vmcnt(11)
    buffer_load_dwordx4 v4, s[4:7], s32 offen offset:2048 sc1 lds
    s_add_u32 s32, s32, 24576
    s_sub_u32 s57, s32, 196608
    s_min_u32 s32, s32, s57
    s_add_u32 s26, s26, 36864
    s_sub_u32 s57, s26, 147456
    s_min_u32 s26, s26, s57
    s_mov_b32 m0, s56
    s_waitcnt vmcnt(11)
    buffer_load_dwordx4 v4, s[4:7], s27 offen offset:0 sc1 lds
    s_waitcnt vmcnt(11)
    buffer_load_dwordx4 v4, s[4:7], s27 offen offset:1024 sc1 lds
    s_waitcnt vmcnt(11)
    buffer_load_dwordx4 v4, s[4:7], s27 offen offset:2048 sc1 lds
    s_add_u32 s27, s27, 24576
    s_sub_u32 s58, s27, 196608
    s_min_u32 s27, s27, s58
    s_add_u32 s56, s56, 36864
    s_sub_u32 s58, s56, 147456
    s_min_u32 s56, s56, s58
    s_add_u32 s33, s33, 196608
    s_add_u32 s34, s34, 196608
    s_add_u32 s36, s36, 1536
    s_add_u32 s35, s35, 196608
    s_add_u32 s16, s16, 196608
    s_add_u32 s17, s17, 196608
    s_add_u32 s37, s37, 512
    s_waitcnt vmcnt(9)
    s_barrier
    ds_read_b128 v[24:27], v2 offset:12288
    ds_read_b128 v[28:31], v3 offset:12288
    ds_read_b128 v[32:35], v2 offset:18432
    ds_read_b128 v[36:39], v3 offset:18432
    s_waitcnt lgkmcnt(2)
    v_mfma_f32_16x16x32_bf16 v[72:75], v[24:27], a[192:195], v[128:131]
    s_mov_b32 m0, s56
    ds_read_b128 v[40:43], v2 offset:12416
    v_mfma_f32_16x16x32_bf16 v[72:75], v[28:31], a[196:199], v[72:75]
    buffer_load_dwordx4 v4, s[4:7], s27 offen offset:0 sc1 lds
    v_mfma_f32_16x16x32_bf16 v[76:79], v[24:27], a[216:219], v[132:135]
    ds_read_b128 v[44:47], v3 offset:12416
    v_mfma_f32_16x16x32_bf16 v[76:79], v[28:31], a[220:223], v[76:79]
    s_waitcnt lgkmcnt(2)
    buffer_load_dwordx4 v4, s[4:7], s27 offen offset:1024 sc1 lds
    v_mfma_f32_16x16x32_bf16 v[104:107], v[32:35], a[192:195], v[128:131]
    ds_read_b128 v[24:27], v2 offset:18560
    v_mfma_f32_16x16x32_bf16 v[104:107], v[36:39], a[196:199], v[104:107]
    buffer_load_dwordx4 v4, s[4:7], s27 offen offset:2048 sc1 lds
    v_mfma_f32_16x16x32_bf16 v[108:111], v[32:35], a[216:219], v[132:135]
    s_add_u32 s27, s27, 24576
    ds_read_b128 v[28:31], v3 offset:18560
    v_mfma_f32_16x16x32_bf16 v[108:111], v[36:39], a[220:223], v[108:111]
    s_waitcnt lgkmcnt(2)
    s_sub_u32 s58, s27, 196608
    v_mfma_f32_16x16x32_bf16 v[72:75], v[40:43], a[200:203], v[72:75]
    ds_read_b128 v[32:35], v2 offset:12544
    v_mfma_f32_16x16x32_bf16 v[72:75], v[44:47], a[204:207], v[72:75]
    s_min_u32 s27, s27, s58
    v_mfma_f32_16x16x32_bf16 v[76:79], v[40:43], a[224:227], v[76:79]
    s_add_u32 s56, s56, 12288
    ds_read_b128 v[36:39], v3 offset:12544
    v_mfma_f32_16x16x32_bf16 v[76:79], v[44:47], a[228:231], v[76:79]
    s_waitcnt lgkmcnt(2)
    s_mov_b32 m0, s56
    v_mfma_f32_16x16x32_bf16 v[104:107], v[24:27], a[200:203], v[104:107]
    ds_read_b128 v[40:43], v2 offset:18688
    v_mfma_f32_16x16x32_bf16 v[104:107], v[28:31], a[204:207], v[104:107]
    s_waitcnt vmcnt(6)
    buffer_load_dwordx4 v4, s[4:7], s27 offen offset:0 sc1 lds
    v_mfma_f32_16x16x32_bf16 v[108:111], v[24:27], a[224:227], v[108:111]
    ds_read_b128 v[44:47], v3 offset:18688
    v_mfma_f32_16x16x32_bf16 v[108:111], v[28:31], a[228:231], v[108:111]
    s_waitcnt lgkmcnt(2)
    s_barrier
    v_add_u32 v2, 49152, v2
    v_add_u32 v3, 49152, v3
    v_mfma_f32_16x16x32_bf16 v[72:75], v[32:35], a[208:211], v[72:75]
    ds_read_b128 v[24:27], v2 offset:0
    v_mfma_f32_16x16x32_bf16 v[72:75], v[36:39], a[212:215], v[72:75]
    buffer_load_dwordx4 v4, s[4:7], s27 offen offset:1024 sc1 lds
    v_mfma_f32_16x16x32_bf16 v[76:79], v[32:35], a[232:235], v[76:79]
    ds_read_b128 v[28:31], v3 offset:0
    v_mfma_f32_16x16x32_bf16 v[76:79], v[36:39], a[236:239], v[76:79]
    s_waitcnt lgkmcnt(2)
    buffer_load_dwordx4 v4, s[4:7], s27 offen offset:2048 sc1 lds
    v_mfma_f32_16x16x32_bf16 v[104:107], v[40:43], a[208:211], v[104:107]
    ds_read_b128 v[32:35], v2 offset:6144
    v_mfma_f32_16x16x32_bf16 v[104:107], v[44:47], a[212:215], v[104:107]
    v_mfma_f32_16x16x32_bf16 v[108:111], v[40:43], a[232:235], v[108:111]
    s_add_u32 s27, s27, 24576
    ds_read_b128 v[36:39], v3 offset:6144
    s_sub_u32 s58, s27, 196608
    v_mfma_f32_16x16x32_bf16 v[108:111], v[44:47], a[236:239], v[108:111]
    s_waitcnt lgkmcnt(2)
    s_min_u32 s27, s27, s58
    s_add_u32 s56, s56, 36864
    s_sub_u32 s58, s56, 147456
    s_min_u32 s56, s56, s58
    v_mfma_f32_16x16x32_bf16 v[80:83], v[24:27], a[192:195], v[128:131]
    s_mov_b32 s41, 18432
    ds_read_b128 v[40:43], v2 offset:128
    s_add_u32 m0, s40, 27648
    v_mfma_f32_16x16x32_bf16 v[80:83], v[28:31], a[196:199], v[80:83]
    v_mfma_f32_16x16x32_bf16 v[84:87], v[24:27], a[216:219], v[132:135]
    ds_read_b128 v[44:47], v3 offset:128
    v_mfma_f32_16x16x32_bf16 v[84:87], v[28:31], a[220:223], v[84:87]
    s_waitcnt lgkmcnt(2)
    buffer_load_dwordx4 v139, s[8:11], s41 offen nt lds
    v_mfma_f32_16x16x32_bf16 v[112:115], v[32:35], a[192:195], v[128:131]
    ds_read_b128 v[24:27], v2 offset:6272
    v_mfma_f32_16x16x32_bf16 v[112:115], v[36:39], a[196:199], v[112:115]
    v_exp_f32 v16, v72
    v_mfma_f32_16x16x32_bf16 v[116:119], v[32:35], a[216:219], v[132:135]
    s_add_u32 m0, s40, 28672
    ds_read_b128 v[28:31], v3 offset:6272
    v_mfma_f32_16x16x32_bf16 v[116:119], v[36:39], a[220:223], v[116:119]
    s_waitcnt lgkmcnt(2)
    v_exp_f32 v17, v73
    v_mfma_f32_16x16x32_bf16 v[80:83], v[40:43], a[200:203], v[80:83]
    ds_read_b128 v[32:35], v2 offset:256
    v_mfma_f32_16x16x32_bf16 v[80:83], v[44:47], a[204:207], v[80:83]
    buffer_load_dwordx4 v140, s[8:11], s41 offen nt lds
    v_mfma_f32_16x16x32_bf16 v[84:87], v[40:43], a[224:227], v[84:87]
    ds_read_b128 v[36:39], v3 offset:256
    v_mfma_f32_16x16x32_bf16 v[84:87], v[44:47], a[228:231], v[84:87]
    s_waitcnt lgkmcnt(2)
    v_exp_f32 v18, v74
    v_mfma_f32_16x16x32_bf16 v[112:115], v[24:27], a[200:203], v[112:115]
    ds_read_b128 v[40:43], v2 offset:6400
    v_add_f32 v5, v5, v16
    v_mfma_f32_16x16x32_bf16 v[112:115], v[28:31], a[204:207], v[112:115]
    s_add_u32 m0, s40, 29696
    v_add_f32 v5, v5, v17
    v_mfma_f32_16x16x32_bf16 v[116:119], v[24:27], a[224:227], v[116:119]
    ds_read_b128 v[44:47], v3 offset:6400
    v_mfma_f32_16x16x32_bf16 v[116:119], v[28:31], a[228:231], v[116:119]
    s_waitcnt lgkmcnt(2)
    v_exp_f32 v19, v75
    v_cvt_pk_bf16_f32 v72, v16, v17
    v_mfma_f32_16x16x32_bf16 v[80:83], v[32:35], a[208:211], v[80:83]
    ds_read_b128 v[24:27], v2 offset:12288
    v_mfma_f32_16x16x32_bf16 v[80:83], v[36:39], a[212:215], v[80:83]
    buffer_load_dwordx4 v141, s[8:11], s41 offen nt lds
    v_mfma_f32_16x16x32_bf16 v[84:87], v[32:35], a[232:235], v[84:87]
    ds_read_b128 v[28:31], v3 offset:12288
    v_mfma_f32_16x16x32_bf16 v[84:87], v[36:39], a[236:239], v[84:87]
    s_waitcnt lgkmcnt(2)
    v_exp_f32 v16, v104
    v_add_f32 v5, v5, v18
    v_mfma_f32_16x16x32_bf16 v[112:115], v[40:43], a[208:211], v[112:115]
    ds_read_b128 v[32:35], v2 offset:18432
    v_add_f32 v5, v5, v19
    v_mfma_f32_16x16x32_bf16 v[112:115], v[44:47], a[212:215], v[112:115]
    v_exp_f32 v17, v105
    v_cvt_pk_bf16_f32 v73, v18, v19
    v_mfma_f32_16x16x32_bf16 v[116:119], v[40:43], a[232:235], v[116:119]
    ds_read_b128 v[36:39], v3 offset:18432
    v_mfma_f32_16x16x32_bf16 v[116:119], v[44:47], a[236:239], v[116:119]
    s_waitcnt lgkmcnt(2)
    v_exp_f32 v18, v106
    v_add_f32 v5, v5, v16
    v_mfma_f32_16x16x32_bf16 v[88:91], v[24:27], a[192:195], v[128:131]
    ds_read_b128 v[40:43], v2 offset:12416
    v_add_f32 v5, v5, v17
    v_mfma_f32_16x16x32_bf16 v[88:91], v[28:31], a[196:199], v[88:91]
    s_waitcnt vmcnt(11)
    buffer_load_dwordx2 v[56:57], v10, s[72:75], s36 offen offset:0
    v_mfma_f32_16x16x32_bf16 v[92:95], v[24:27], a[216:219], v[132:135]
    ds_read_b128 v[44:47], v3 offset:12416
    v_mfma_f32_16x16x32_bf16 v[92:95], v[28:31], a[220:223], v[92:95]
    s_waitcnt lgkmcnt(2)
    v_exp_f32 v19, v107
    v_cvt_pk_bf16_f32 v74, v16, v17
    v_mfma_f32_16x16x32_bf16 v[120:123], v[32:35], a[192:195], v[128:131]
    ds_read_b128 v[24:27], v2 offset:18560
    v_mfma_f32_16x16x32_bf16 v[120:123], v[36:39], a[196:199], v[120:123]
    buffer_load_dwordx2 v[58:59], v10, s[76:79], s36 offen offset:0
    v_mfma_f32_16x16x32_bf16 v[124:127], v[32:35], a[216:219], v[132:135]
    ds_read_b128 v[28:31], v3 offset:18560
    v_mfma_f32_16x16x32_bf16 v[124:127], v[36:39], a[220:223], v[124:127]
    s_waitcnt lgkmcnt(2)
    v_exp_f32 v16, v76
    v_add_f32 v5, v5, v18
    v_mfma_f32_16x16x32_bf16 v[88:91], v[40:43], a[200:203], v[88:91]
    ds_read_b128 v[32:35], v2 offset:12544
    v_add_f32 v5, v5, v19
    v_mfma_f32_16x16x32_bf16 v[88:91], v[44:47], a[204:207], v[88:91]
    s_waitcnt vmcnt(12)
    buffer_load_dwordx4 v[224:227], v9, s[64:67], s33 offen offset:0 nt
    v_mfma_f32_16x16x32_bf16 v[92:95], v[40:43], a[224:227], v[92:95]
    ds_read_b128 v[36:39], v3 offset:12544
    v_mfma_f32_16x16x32_bf16 v[92:95], v[44:47], a[228:231], v[92:95]
    s_waitcnt lgkmcnt(2)
    v_exp_f32 v17, v77
    v_cvt_pk_bf16_f32 v75, v18, v19
    v_mfma_f32_16x16x32_bf16 v[120:123], v[24:27], a[200:203], v[120:123]
    ds_read_b128 v[40:43], v2 offset:18688
    v_mfma_f32_16x16x32_bf16 v[120:123], v[28:31], a[204:207], v[120:123]
    s_waitcnt vmcnt(6)
    buffer_load_dwordx4 v[228:231], v9, s[64:67], s33 offen offset:1536 nt
    v_mfma_f32_16x16x32_bf16 v[124:127], v[24:27], a[224:227], v[124:127]
    ds_read_b128 v[44:47], v3 offset:18688
    v_mfma_f32_16x16x32_bf16 v[124:127], v[28:31], a[228:231], v[124:127]
    s_waitcnt lgkmcnt(2)
    s_barrier
    v_mfma_f32_16x16x32_bf16 v[88:91], v[32:35], a[208:211], v[88:91]
    ds_read_b128 v[24:27], v1 offset:12288
    v_mfma_f32_16x16x32_bf16 v[88:91], v[36:39], a[212:215], v[88:91]
    buffer_load_dwordx4 v[232:235], v9, s[64:67], s34 offen offset:0 nt
    v_mfma_f32_16x16x32_bf16 v[92:95], v[32:35], a[232:235], v[92:95]
    ds_read_b128 v[28:31], v1 offset:13312
    v_mfma_f32_16x16x32_bf16 v[92:95], v[36:39], a[236:239], v[92:95]
    s_waitcnt lgkmcnt(2)
    v_exp_f32 v18, v78
    v_add_f32 v6, v6, v16
    v_mfma_f32_16x16x32_bf16 v[120:123], v[40:43], a[208:211], v[120:123]
    ds_read_b128 v[32:35], v1 offset:14336
    v_add_f32 v6, v6, v17
    v_mfma_f32_16x16x32_bf16 v[120:123], v[44:47], a[212:215], v[120:123]
    buffer_load_dwordx4 v[236:239], v9, s[64:67], s34 offen offset:1536 nt
    v_mfma_f32_16x16x32_bf16 v[124:127], v[40:43], a[232:235], v[124:127]
    ds_read_b128 v[36:39], v1 offset:15360
    v_mfma_f32_16x16x32_bf16 v[124:127], v[44:47], a[236:239], v[124:127]
    s_waitcnt lgkmcnt(2)
    v_exp_f32 v19, v79
    v_cvt_pk_bf16_f32 v76, v16, v17
    v_exp_f32 v16, v108
    v_add_f32 v6, v6, v18
    v_add_f32 v6, v6, v19
    v_exp_f32 v17, v109
    v_cvt_pk_bf16_f32 v77, v18, v19
    v_exp_f32 v18, v110
    v_add_f32 v6, v6, v16
    v_add_f32 v6, v6, v17
    v_exp_f32 v19, v111
    v_cvt_pk_bf16_f32 v78, v16, v17
    v_add_f32 v6, v6, v18
    v_add_f32 v6, v6, v19
    v_cvt_pk_bf16_f32 v79, v18, v19
    v_mfma_f32_16x16x32_bf16 a[0:3], v[72:75], v[24:27], a[0:3]
    ds_read_b128 v[40:43], v1 offset:16384
    v_mfma_f32_16x16x32_bf16 a[4:7], v[72:75], v[28:31], a[4:7]
    buffer_load_dwordx2 v[60:61], v10, s[72:75], s36 offen offset:192
    v_mfma_f32_16x16x32_bf16 a[48:51], v[76:79], v[24:27], a[48:51]
    ds_read_b128 v[44:47], v1 offset:17408
    v_mfma_f32_16x16x32_bf16 a[52:55], v[76:79], v[28:31], a[52:55]
    s_waitcnt lgkmcnt(2)
    v_exp_f32 v16, v80
    v_mfma_f32_16x16x32_bf16 a[8:11], v[72:75], v[32:35], a[8:11]
    ds_read_b128 v[24:27], v1 offset:18432
    v_mfma_f32_16x16x32_bf16 a[12:15], v[72:75], v[36:39], a[12:15]
    buffer_load_dwordx2 v[62:63], v10, s[76:79], s36 offen offset:192
    v_mfma_f32_16x16x32_bf16 a[56:59], v[76:79], v[32:35], a[56:59]
    ds_read_b128 v[28:31], v1 offset:19456
    v_mfma_f32_16x16x32_bf16 a[60:63], v[76:79], v[36:39], a[60:63]
    s_waitcnt lgkmcnt(2)
    v_exp_f32 v17, v81
    v_mfma_f32_16x16x32_bf16 a[16:19], v[72:75], v[40:43], a[16:19]
    ds_read_b128 v[32:35], v1 offset:20480
    v_mfma_f32_16x16x32_bf16 a[20:23], v[72:75], v[44:47], a[20:23]
    buffer_load_dwordx4 v[240:243], v9, s[64:67], s33 offen offset:384 nt
    v_mfma_f32_16x16x32_bf16 a[64:67], v[76:79], v[40:43], a[64:67]
    ds_read_b128 v[36:39], v1 offset:21504
    v_mfma_f32_16x16x32_bf16 a[68:71], v[76:79], v[44:47], a[68:71]
    s_waitcnt lgkmcnt(2)
    v_exp_f32 v18, v82
    v_add_f32 v5, v5, v16
    v_mfma_f32_16x16x32_bf16 a[24:27], v[72:75], v[24:27], a[24:27]
    ds_read_b128 v[40:43], v1 offset:22528
    v_add_f32 v5, v5, v17
    v_mfma_f32_16x16x32_bf16 a[28:31], v[72:75], v[28:31], a[28:31]
    buffer_load_dwordx4 v[244:247], v9, s[64:67], s33 offen offset:1920 nt
    v_mfma_f32_16x16x32_bf16 a[72:75], v[76:79], v[24:27], a[72:75]
    ds_read_b128 v[44:47], v1 offset:23552
    v_mfma_f32_16x16x32_bf16 a[76:79], v[76:79], v[28:31], a[76:79]
    s_waitcnt lgkmcnt(2)
    v_add_u32 v1, 49152, v1
    v_exp_f32 v19, v83
    v_mfma_f32_16x16x32_bf16 a[32:35], v[72:75], v[32:35], a[32:35]
    ds_read_b128 v[24:27], v1 offset:0
    v_cvt_pk_bf16_f32 v80, v16, v17
    v_mfma_f32_16x16x32_bf16 a[36:39], v[72:75], v[36:39], a[36:39]
    buffer_load_dwordx4 v[248:251], v9, s[64:67], s34 offen offset:384 nt
    v_mfma_f32_16x16x32_bf16 a[80:83], v[76:79], v[32:35], a[80:83]
    ds_read_b128 v[28:31], v1 offset:1024
    v_mfma_f32_16x16x32_bf16 a[84:87], v[76:79], v[36:39], a[84:87]
    s_waitcnt lgkmcnt(2)
    v_exp_f32 v16, v112
    v_add_f32 v5, v5, v18
    v_mfma_f32_16x16x32_bf16 a[40:43], v[72:75], v[40:43], a[40:43]
    ds_read_b128 v[32:35], v1 offset:2048
    v_add_f32 v5, v5, v19
    v_mfma_f32_16x16x32_bf16 a[44:47], v[72:75], v[44:47], a[44:47]
    buffer_load_dwordx4 v[252:255], v9, s[64:67], s34 offen offset:1920 nt
    v_mfma_f32_16x16x32_bf16 a[88:91], v[76:79], v[40:43], a[88:91]
    ds_read_b128 v[36:39], v1 offset:3072
    v_mfma_f32_16x16x32_bf16 a[92:95], v[76:79], v[44:47], a[92:95]
    s_waitcnt lgkmcnt(2)
    v_exp_f32 v17, v113
    v_cvt_pk_bf16_f32 v81, v18, v19
    v_exp_f32 v18, v114
    v_add_f32 v5, v5, v16
    v_add_f32 v5, v5, v17
    v_exp_f32 v19, v115
    v_cvt_pk_bf16_f32 v82, v16, v17
    v_exp_f32 v16, v84
    v_add_f32 v5, v5, v18
    v_add_f32 v5, v5, v19
    v_exp_f32 v17, v85
    v_cvt_pk_bf16_f32 v83, v18, v19
    v_exp_f32 v18, v86
    v_add_f32 v6, v6, v16
    v_add_f32 v6, v6, v17
    v_exp_f32 v19, v87
    v_cvt_pk_bf16_f32 v84, v16, v17
    v_exp_f32 v16, v116
    v_add_f32 v6, v6, v18
    v_add_f32 v6, v6, v19
    v_exp_f32 v17, v117
    v_cvt_pk_bf16_f32 v85, v18, v19
    v_exp_f32 v18, v118
    v_add_f32 v6, v6, v16
    v_add_f32 v6, v6, v17
    v_exp_f32 v19, v119
    v_cvt_pk_bf16_f32 v86, v16, v17
    v_add_f32 v6, v6, v18
    v_add_f32 v6, v6, v19
    v_cvt_pk_bf16_f32 v87, v18, v19
    v_mfma_f32_16x16x32_bf16 a[0:3], v[80:83], v[24:27], a[0:3]
    ds_read_b128 v[40:43], v1 offset:4096
    v_mfma_f32_16x16x32_bf16 a[4:7], v[80:83], v[28:31], a[4:7]
    buffer_load_dwordx4 v[144:147], v12, s[68:71], s35 offen offset:0 nt
    v_mfma_f32_16x16x32_bf16 a[48:51], v[84:87], v[24:27], a[48:51]
    ds_read_b128 v[44:47], v1 offset:5120
    v_mfma_f32_16x16x32_bf16 a[52:55], v[84:87], v[28:31], a[52:55]
    s_waitcnt lgkmcnt(2)
    v_exp_f32 v16, v88
    v_mfma_f32_16x16x32_bf16 a[8:11], v[80:83], v[32:35], a[8:11]
    ds_read_b128 v[24:27], v1 offset:6144
    v_mfma_f32_16x16x32_bf16 a[12:15], v[80:83], v[36:39], a[12:15]
    buffer_load_dwordx4 v[148:151], v12, s[68:71], s35 offen offset:768 nt
    v_mfma_f32_16x16x32_bf16 a[56:59], v[84:87], v[32:35], a[56:59]
    ds_read_b128 v[28:31], v1 offset:7168
    v_mfma_f32_16x16x32_bf16 a[60:63], v[84:87], v[36:39], a[60:63]
    s_waitcnt lgkmcnt(2)
    v_exp_f32 v17, v89
    v_mfma_f32_16x16x32_bf16 a[16:19], v[80:83], v[40:43], a[16:19]
    ds_read_b128 v[32:35], v1 offset:8192
    v_mfma_f32_16x16x32_bf16 a[20:23], v[80:83], v[44:47], a[20:23]
    v_exp_f32 v18, v90
    v_add_f32 v5, v5, v16
    v_mfma_f32_16x16x32_bf16 a[64:67], v[84:87], v[40:43], a[64:67]
    ds_read_b128 v[36:39], v1 offset:9216
    v_add_f32 v5, v5, v17
    v_mfma_f32_16x16x32_bf16 a[68:71], v[84:87], v[44:47], a[68:71]
    s_waitcnt lgkmcnt(2)
    s_waitcnt vmcnt(16)
    buffer_load_dwordx4 v[152:155], v12, s[68:71], s35 offen offset:1536 nt
    v_mfma_f32_16x16x32_bf16 a[24:27], v[80:83], v[24:27], a[24:27]
    ds_read_b128 v[40:43], v1 offset:10240
    v_mfma_f32_16x16x32_bf16 a[28:31], v[80:83], v[28:31], a[28:31]
    v_exp_f32 v19, v91
    v_cvt_pk_bf16_f32 v88, v16, v17
    v_mfma_f32_16x16x32_bf16 a[72:75], v[84:87], v[24:27], a[72:75]
    ds_read_b128 v[44:47], v1 offset:11264
    v_mfma_f32_16x16x32_bf16 a[76:79], v[84:87], v[28:31], a[76:79]
    s_waitcnt lgkmcnt(2)
    v_exp_f32 v16, v120
    v_add_f32 v5, v5, v18
    v_mfma_f32_16x16x32_bf16 a[32:35], v[80:83], v[32:35], a[32:35]
    s_waitcnt vmcnt(39)
    ds_read_b128 v[24:27], v1 offset:12288
    v_add_f32 v5, v5, v19
    v_mfma_f32_16x16x32_bf16 a[36:39], v[80:83], v[36:39], a[36:39]
    v_exp_f32 v17, v121
    v_cvt_pk_bf16_f32 v89, v18, v19
    v_mfma_f32_16x16x32_bf16 a[80:83], v[84:87], v[32:35], a[80:83]
    ds_read_b128 v[28:31], v1 offset:13312
    ds_read_b64 a[240:241], v22 offset:49152
    v_mfma_f32_16x16x32_bf16 a[84:87], v[84:87], v[36:39], a[84:87]
    s_waitcnt lgkmcnt(3)
    s_waitcnt vmcnt(16)
    buffer_load_dwordx4 v[156:159], v12, s[68:71], s35 offen offset:2304 nt
    v_mfma_f32_16x16x32_bf16 a[40:43], v[80:83], v[40:43], a[40:43]
    ds_read_b128 v[32:35], v1 offset:14336
    ds_read_b64 a[242:243], v142 offset:49280
    v_mfma_f32_16x16x32_bf16 a[44:47], v[80:83], v[44:47], a[44:47]
    v_exp_f32 v18, v122
    v_add_f32 v5, v5, v16
    v_add_f32 v5, v5, v17
    v_exp_f32 v19, v123
    v_cvt_pk_bf16_f32 v90, v16, v17
    v_exp_f32 v16, v92
    v_add_f32 v5, v5, v18
    v_add_f32 v5, v5, v19
    v_exp_f32 v17, v93
    v_cvt_pk_bf16_f32 v91, v18, v19
    v_exp_f32 v18, v94
    v_add_f32 v6, v6, v16
    v_add_f32 v6, v6, v17
    v_exp_f32 v19, v95
    v_cvt_pk_bf16_f32 v92, v16, v17
    v_exp_f32 v16, v124
    v_add_f32 v6, v6, v18
    v_add_f32 v6, v6, v19
    v_exp_f32 v17, v125
    v_cvt_pk_bf16_f32 v93, v18, v19
    v_exp_f32 v18, v126
    v_add_f32 v6, v6, v16
    v_add_f32 v6, v6, v17
    v_exp_f32 v19, v127
    v_cvt_pk_bf16_f32 v94, v16, v17
    v_add_f32 v6, v6, v18
    v_add_f32 v6, v6, v19
    v_cvt_pk_bf16_f32 v95, v18, v19
    v_mfma_f32_16x16x32_bf16 a[88:91], v[84:87], v[40:43], a[88:91]
    ds_read_b128 v[36:39], v1 offset:15360
    ds_read_b64 a[244:245], v23 offset:49152
    v_mfma_f32_16x16x32_bf16 a[92:95], v[84:87], v[44:47], a[92:95]
    s_waitcnt lgkmcnt(5)
    ds_read_b64 a[246:247], v143 offset:49280
    ds_read_b64 a[248:249], v142 offset:49152
    v_mfma_f32_16x16x32_bf16 a[0:3], v[88:91], v[24:27], a[0:3]
    ds_read_b128 v[40:43], v1 offset:16384
    ds_read_b64 a[250:251], v22 offset:49408
    v_mfma_f32_16x16x32_bf16 a[4:7], v[88:91], v[28:31], a[4:7]
    ds_read_b64 a[252:253], v143 offset:49152
    ds_read_b64 a[254:255], v23 offset:49408
    v_mfma_f32_16x16x32_bf16 a[48:51], v[92:95], v[24:27], a[48:51]
    ds_read_b128 v[44:47], v1 offset:17408
    ds_read_b64 v[192:193], v22 offset:49280
    v_mfma_f32_16x16x32_bf16 a[52:55], v[92:95], v[28:31], a[52:55]
    s_waitcnt lgkmcnt(9)
    ds_read_b64 v[194:195], v142 offset:49408
    ds_read_b64 v[196:197], v23 offset:49280
    v_mfma_f32_16x16x32_bf16 a[8:11], v[88:91], v[32:35], a[8:11]
    ds_read_b128 v[24:27], v1 offset:18432
    ds_read_b64 v[198:199], v143 offset:49408
    v_mfma_f32_16x16x32_bf16 a[12:15], v[88:91], v[36:39], a[12:15]
    s_waitcnt vmcnt(16)
    v_mfma_f32_16x16x32_bf16 a[56:59], v[92:95], v[32:35], a[56:59]
    ds_read_b128 v[28:31], v1 offset:19456
    ds_read_b64 v[200:201], v22 offset:24576
    v_mfma_f32_16x16x32_bf16 a[60:63], v[92:95], v[36:39], a[60:63]
    s_waitcnt lgkmcnt(7)
    v_mfma_f32_16x16x32_bf16 a[16:19], v[88:91], v[40:43], a[16:19]
    ds_read_b128 v[32:35], v1 offset:20480
    ds_read_b64 v[202:203], v142 offset:24704
    v_mfma_f32_16x16x32_bf16 a[20:23], v[88:91], v[44:47], a[20:23]
    ds_read_b64 v[204:205], v23 offset:24576
    v_mfma_f32_16x16x32_bf16 a[64:67], v[92:95], v[40:43], a[64:67]
    ds_read_b128 v[36:39], v1 offset:21504
    ds_read_b64 v[206:207], v143 offset:24704
    v_mfma_f32_16x16x32_bf16 a[68:71], v[92:95], v[44:47], a[68:71]
    s_waitcnt lgkmcnt(6)
    ds_read_b64 v[208:209], v142 offset:24576
    v_mfma_f32_16x16x32_bf16 a[24:27], v[88:91], v[24:27], a[24:27]
    ds_read_b128 v[40:43], v1 offset:22528
    ds_read_b64 v[210:211], v22 offset:24832
    v_mfma_f32_16x16x32_bf16 a[28:31], v[88:91], v[28:31], a[28:31]
    v_mfma_f32_16x16x32_bf16 a[72:75], v[92:95], v[24:27], a[72:75]
    ds_read_b128 v[44:47], v1 offset:23552
    ds_read_b64 v[212:213], v143 offset:24576
    v_mfma_f32_16x16x32_bf16 a[76:79], v[92:95], v[28:31], a[76:79]
    s_waitcnt lgkmcnt(6)
    v_subrev_u32 v2, 49152, v2
    v_subrev_u32 v3, 49152, v3
    v_mfma_f32_16x16x32_bf16 a[32:35], v[88:91], v[32:35], a[32:35]
    ds_read_b128 v[24:27], v2 offset:0
    ds_read_b64 v[214:215], v23 offset:24832
    v_mfma_f32_16x16x32_bf16 a[36:39], v[88:91], v[36:39], a[36:39]
    ds_read_b64 v[216:217], v22 offset:24704
    ds_read_b64 v[218:219], v142 offset:24832
    v_mfma_f32_16x16x32_bf16 a[80:83], v[92:95], v[32:35], a[80:83]
    ds_read_b128 v[28:31], v3 offset:0
    ds_read_b64 v[220:221], v23 offset:24704
    v_mfma_f32_16x16x32_bf16 a[84:87], v[92:95], v[36:39], a[84:87]
    s_waitcnt lgkmcnt(7)
    v_mfma_f32_16x16x32_bf16 a[40:43], v[88:91], v[40:43], a[40:43]
    ds_read_b128 v[32:35], v2 offset:6144
    ds_read_b64 v[222:223], v143 offset:24832
    v_mfma_f32_16x16x32_bf16 a[44:47], v[88:91], v[44:47], a[44:47]
    v_mfma_f32_16x16x32_bf16 a[88:91], v[92:95], v[40:43], a[88:91]
    ds_read_b128 v[36:39], v3 offset:6144
    v_mfma_f32_16x16x32_bf16 a[92:95], v[92:95], v[44:47], a[92:95]
    s_waitcnt lgkmcnt(4)
    s_waitcnt lgkmcnt(0)
    s_barrier
    v_mfma_f32_16x16x32_bf16 v[160:163], v[24:27], a[240:243], 0
    s_waitcnt vmcnt(10)
    ds_read_b128 v[40:43], v2 offset:128
    v_lshlrev_b32 v48, 16, v56
    v_mfma_f32_16x16x32_bf16 v[160:163], v[28:31], a[244:247], v[160:163]
    s_mov_b32 m0, s26
    v_and_b32 v49, s97, v56
    v_lshlrev_b32 v50, 16, v58
    v_mfma_f32_16x16x32_bf16 v[164:167], v[24:27], v[200:203], 0
    ds_read_b128 v[44:47], v3 offset:128
    v_and_b32 v51, s97, v58
    v_mfma_f32_16x16x32_bf16 v[164:167], v[28:31], v[204:207], v[164:167]
    s_waitcnt lgkmcnt(2)
    buffer_load_dwordx4 v4, s[4:7], s32 offen offset:0 sc1 lds
    v_mfma_f32_16x16x32_bf16 v[96:99], v[32:35], a[240:243], 0
    ds_read_b128 v[24:27], v2 offset:6272
    v_mul_f32 v48, s38, v48
    v_mfma_f32_16x16x32_bf16 v[96:99], v[36:39], a[244:247], v[96:99]
    v_mul_f32 v49, s38, v49
    v_mul_f32_e64 v50, -v50, v48
    v_mfma_f32_16x16x32_bf16 v[100:103], v[32:35], v[200:203], 0
    ds_read_b128 v[28:31], v3 offset:6272
    v_mul_f32_e64 v51, -v51, v49
    v_mfma_f32_16x16x32_bf16 v[100:103], v[36:39], v[204:207], v[100:103]
    s_waitcnt lgkmcnt(2)
    buffer_load_dwordx4 v4, s[4:7], s32 offen offset:1024 sc1 lds
    v_mfma_f32_16x16x32_bf16 v[160:163], v[40:43], a[248:251], v[160:163]
    ds_read_b128 v[32:35], v2 offset:256
    v_cvt_f32_i32 v224, v224
    v_mfma_f32_16x16x32_bf16 v[160:163], v[44:47], a[252:255], v[160:163]
    v_cvt_f32_i32 v225, v225
    v_fma_f32 v224, v224, v48, v50
    v_mfma_f32_16x16x32_bf16 v[164:167], v[40:43], v[208:211], v[164:167]
    ds_read_b128 v[36:39], v3 offset:256
    v_fma_f32 v225, v225, v49, v51
    v_mfma_f32_16x16x32_bf16 v[164:167], v[44:47], v[212:215], v[164:167]
    s_waitcnt lgkmcnt(2)
    buffer_load_dwordx4 v4, s[4:7], s32 offen offset:2048 sc1 lds
    v_cvt_pk_bf16_f32 v224, v224, v225
    v_mfma_f32_16x16x32_bf16 v[96:99], v[24:27], a[248:251], v[96:99]
    s_add_u32 s32, s32, 24576
    ds_read_b128 v[40:43], v2 offset:6400
    v_cvt_f32_i32 v228, v228
    v_mfma_f32_16x16x32_bf16 v[96:99], v[28:31], a[252:255], v[96:99]
    s_sub_u32 s57, s32, 196608
    v_cvt_f32_i32 v229, v229
    v_fma_f32 v228, v228, v48, v50
    v_mfma_f32_16x16x32_bf16 v[100:103], v[24:27], v[208:211], v[100:103]
    s_min_u32 s32, s32, s57
    ds_read_b128 v[44:47], v3 offset:6400
    v_fma_f32 v229, v229, v49, v51
    v_mfma_f32_16x16x32_bf16 v[100:103], v[28:31], v[212:215], v[100:103]
    s_waitcnt lgkmcnt(2)
    v_cvt_pk_bf16_f32 v228, v228, v229
    v_cvt_f32_i32 v232, v232
    v_cvt_f32_i32 v233, v233
    v_mfma_f32_16x16x32_bf16 v[160:163], v[32:35], v[192:195], v[160:163]
    s_add_u32 s26, s26, 12288
    ds_read_b128 v[24:27], v2 offset:12288
    v_fma_f32 v232, v232, v48, v50
    v_mfma_f32_16x16x32_bf16 v[160:163], v[36:39], v[196:199], v[160:163]
    s_mov_b32 m0, s26
    v_fma_f32 v233, v233, v49, v51
    v_cvt_pk_bf16_f32 v232, v232, v233
    v_mfma_f32_16x16x32_bf16 v[164:167], v[32:35], v[216:219], v[164:167]
    ds_read_b128 v[28:31], v3 offset:12288
    v_cvt_f32_i32 v236, v236
    v_mfma_f32_16x16x32_bf16 v[164:167], v[36:39], v[220:223], v[164:167]
    s_waitcnt lgkmcnt(2)
    buffer_load_dwordx4 v4, s[4:7], s32 offen offset:0 sc1 lds
    v_cvt_f32_i32 v237, v237
    v_mfma_f32_16x16x32_bf16 v[96:99], v[40:43], v[192:195], v[96:99]
    ds_read_b128 v[32:35], v2 offset:18432
    v_fma_f32 v236, v236, v48, v50
    v_mfma_f32_16x16x32_bf16 v[96:99], v[44:47], v[196:199], v[96:99]
    v_fma_f32 v237, v237, v49, v51
    v_cvt_pk_bf16_f32 v236, v236, v237
    v_lshlrev_b32 v48, 16, v57
    v_mfma_f32_16x16x32_bf16 v[100:103], v[40:43], v[216:219], v[100:103]
    ds_read_b128 v[36:39], v3 offset:18432
    v_and_b32 v49, s97, v57
    v_mfma_f32_16x16x32_bf16 v[100:103], v[44:47], v[220:223], v[100:103]
    s_waitcnt lgkmcnt(2)
    buffer_load_dwordx4 v4, s[4:7], s32 offen offset:1024 sc1 lds
    v_lshlrev_b32 v50, 16, v59
    v_mfma_f32_16x16x32_bf16 v[168:171], v[24:27], a[240:243], 0
    ds_read_b128 v[40:43], v2 offset:12416
    s_waitcnt vmcnt(13)
    buffer_load_dwordx4 v4, s[4:7], s32 offen offset:2048 sc1 lds
    v_mfma_f32_16x16x32_bf16 v[168:171], v[28:31], a[244:247], v[168:171]
    v_and_b32 v51, s97, v59
    v_mul_f32 v48, s38, v48
    v_mul_f32 v49, s38, v49
    v_mfma_f32_16x16x32_bf16 v[172:175], v[24:27], v[200:203], 0
    s_add_u32 s32, s32, 24576
    ds_read_b128 v[44:47], v3 offset:12416
    v_mul_f32_e64 v50, -v50, v48
    v_mfma_f32_16x16x32_bf16 v[172:175], v[28:31], v[204:207], v[172:175]
    s_waitcnt lgkmcnt(2)
    v_mul_f32_e64 v51, -v51, v49
    v_cvt_f32_i32 v226, v226
    v_cvt_f32_i32 v227, v227
    v_mfma_f32_16x16x32_bf16 v[104:107], v[32:35], a[240:243], 0
    s_sub_u32 s57, s32, 196608
    ds_read_b128 v[24:27], v2 offset:18560
    v_fma_f32 v226, v226, v48, v50
    v_mfma_f32_16x16x32_bf16 v[104:107], v[36:39], a[244:247], v[104:107]
    v_fma_f32 v227, v227, v49, v51
    v_cvt_pk_bf16_f32 v225, v226, v227
    v_cvt_f32_i32 v230, v230
    v_mfma_f32_16x16x32_bf16 v[108:111], v[32:35], v[200:203], 0
    s_min_u32 s32, s32, s57
    ds_read_b128 v[28:31], v3 offset:18560
    v_cvt_f32_i32 v231, v231
    v_mfma_f32_16x16x32_bf16 v[108:111], v[36:39], v[204:207], v[108:111]
    s_waitcnt lgkmcnt(2)
    v_fma_f32 v230, v230, v48, v50
    v_fma_f32 v231, v231, v49, v51
    v_cvt_pk_bf16_f32 v229, v230, v231
    v_mfma_f32_16x16x32_bf16 v[168:171], v[40:43], a[248:251], v[168:171]
    s_add_u32 s26, s26, 36864
    ds_read_b128 v[32:35], v2 offset:12544
    v_cvt_f32_i32 v234, v234
    v_mfma_f32_16x16x32_bf16 v[168:171], v[44:47], a[252:255], v[168:171]
    v_cvt_f32_i32 v235, v235
    v_fma_f32 v234, v234, v48, v50
    v_max3_f32 v16, v160, v161, v162
    v_mfma_f32_16x16x32_bf16 v[172:175], v[40:43], v[208:211], v[172:175]
    ds_read_b128 v[36:39], v3 offset:12544
    v_fma_f32 v235, v235, v49, v51
    v_cvt_pk_bf16_f32 v233, v234, v235
    v_cvt_f32_i32 v238, v238
    v_cvt_f32_i32 v239, v239
    v_fma_f32 v238, v238, v48, v50
    v_fma_f32 v239, v239, v49, v51
    v_cvt_pk_bf16_f32 v237, v238, v239
    v_mfma_f32_16x16x32_bf16 v[172:175], v[44:47], v[212:215], v[172:175]
    s_waitcnt lgkmcnt(2)
    v_max3_f32 v18, v164, v165, v166
    v_max3_f32 v16, v16, v163, v96
    v_max3_f32 v18, v18, v167, v100
    v_mfma_f32_16x16x32_bf16 v[104:107], v[24:27], a[248:251], v[104:107]
    s_sub_u32 s57, s26, 147456
    ds_read_b128 v[40:43], v2 offset:18688
    s_min_u32 s26, s26, s57
    v_mfma_f32_16x16x32_bf16 v[104:107], v[28:31], a[252:255], v[104:107]
    s_waitcnt vmcnt(13)
    buffer_load_dwordx2 v[56:57], off, s[80:83], s37 offset:0
    v_max3_f32 v16, v16, v97, v98
    v_mfma_f32_16x16x32_bf16 v[108:111], v[24:27], v[208:211], v[108:111]
    s_waitcnt vmcnt(11)
    ds_read_b128 v[44:47], v3 offset:18688
    v_max3_f32 v18, v18, v101, v102
    v_mfma_f32_16x16x32_bf16 v[108:111], v[28:31], v[212:215], v[108:111]
    s_waitcnt lgkmcnt(2)
    v_add_u32 v2, 49152, v2
    v_add_u32 v3, 49152, v3
    v_max_f32 v16, v16, v99
    v_mfma_f32_16x16x32_bf16 v[168:171], v[32:35], v[192:195], v[168:171]
    ds_read_b128 v[24:27], v2 offset:0
    v_max_f32 v18, v18, v103
    v_mfma_f32_16x16x32_bf16 v[168:171], v[36:39], v[196:199], v[168:171]
    v_mov_b32 v17, v16
    v_mov_b32 v19, v18
    s_nop 0
    v_mfma_f32_16x16x32_bf16 v[172:175], v[32:35], v[216:219], v[172:175]
    ds_read_b128 v[28:31], v3 offset:0
    v_permlane16_swap_b32 v16, v17
    v_mfma_f32_16x16x32_bf16 v[172:175], v[36:39], v[220:223], v[172:175]
    s_waitcnt lgkmcnt(2)
    buffer_load_dwordx2 v[58:59], off, s[84:87], s37 offset:0
    v_permlane16_swap_b32 v18, v19
    v_mfma_f32_16x16x32_bf16 v[104:107], v[40:43], v[192:195], v[104:107]
    s_nop 0
    ds_read_b128 v[32:35], v2 offset:6144
    v_max_f32 v16, v16, v17
    v_mfma_f32_16x16x32_bf16 v[104:107], v[44:47], v[196:199], v[104:107]
    v_max_f32 v18, v18, v19
    v_mov_b32 v17, v16
    v_mov_b32 v19, v18
    s_nop 0
    v_permlane32_swap_b32 v16, v17
    v_permlane32_swap_b32 v18, v19
    s_nop 0
    v_max_f32 v16, v16, v17
    v_max_f32 v18, v18, v19
    v_sub_f32 v136, 0, v16
    v_sub_f32 v137, 0, v16
    v_sub_f32 v138, 0, v16
    v_sub_f32 v139, 0, v16
    v_sub_f32 v140, 0, v18
    v_sub_f32 v141, 0, v18
    v_sub_f32 v142, 0, v18
    v_sub_f32 v143, 0, v18
    v_mfma_f32_16x16x32_bf16 v[108:111], v[40:43], v[216:219], v[108:111]
    ds_read_b128 v[36:39], v3 offset:6144
    v_lshlrev_b32 v48, 16, v60
    v_mfma_f32_16x16x32_bf16 v[108:111], v[44:47], v[220:223], v[108:111]
    s_waitcnt lgkmcnt(2)
    v_and_b32 v49, s97, v60
    v_lshlrev_b32 v50, 16, v62
    v_and_b32 v51, s97, v62
    v_mfma_f32_16x16x32_bf16 v[176:179], v[24:27], a[240:243], v[136:139]
    ds_read_b128 v[40:43], v2 offset:128
    v_mul_f32 v48, s38, v48
    v_mfma_f32_16x16x32_bf16 v[176:179], v[28:31], a[244:247], v[176:179]
    v_mul_f32 v49, s38, v49
    v_mul_f32_e64 v50, -v50, v48
    v_mul_f32_e64 v51, -v51, v49
    v_mfma_f32_16x16x32_bf16 v[180:183], v[24:27], v[200:203], v[140:143]
    ds_read_b128 v[44:47], v3 offset:128
    v_cvt_f32_i32 v240, v240
    v_mfma_f32_16x16x32_bf16 v[180:183], v[28:31], v[204:207], v[180:183]
    s_waitcnt lgkmcnt(2)
    v_cvt_f32_i32 v241, v241
    v_fma_f32 v240, v240, v48, v50
    v_fma_f32 v241, v241, v49, v51
    v_mfma_f32_16x16x32_bf16 v[112:115], v[32:35], a[240:243], v[136:139]
    ds_read_b128 v[24:27], v2 offset:6272
    v_cvt_pk_bf16_f32 v226, v240, v241
    v_mfma_f32_16x16x32_bf16 v[112:115], v[36:39], a[244:247], v[112:115]
    v_add_f32 v160, v160, v136
    v_add_f32 v161, v161, v136
    v_cvt_f32_i32 v244, v244
    v_mfma_f32_16x16x32_bf16 v[116:119], v[32:35], v[200:203], v[140:143]
    ds_read_b128 v[28:31], v3 offset:6272
    v_add_f32 v162, v162, v136
    v_mfma_f32_16x16x32_bf16 v[116:119], v[36:39], v[204:207], v[116:119]
    s_waitcnt lgkmcnt(2)
    v_add_f32 v163, v163, v136
    v_cvt_f32_i32 v245, v245
    v_add_f32 v96, v96, v136
    v_mfma_f32_16x16x32_bf16 v[176:179], v[40:43], a[248:251], v[176:179]
    ds_read_b128 v[32:35], v2 offset:256
    v_add_f32 v97, v97, v136
    v_mfma_f32_16x16x32_bf16 v[176:179], v[44:47], a[252:255], v[176:179]
    v_fma_f32 v244, v244, v48, v50
    v_add_f32 v98, v98, v136
    v_add_f32 v99, v99, v136
    v_mfma_f32_16x16x32_bf16 v[180:183], v[40:43], v[208:211], v[180:183]
    ds_read_b128 v[36:39], v3 offset:256
    v_fma_f32 v245, v245, v49, v51
    v_mfma_f32_16x16x32_bf16 v[180:183], v[44:47], v[212:215], v[180:183]
    s_waitcnt lgkmcnt(2)
    v_add_f32 v164, v164, v140
    v_cvt_pk_bf16_f32 v230, v244, v245
    v_add_f32 v165, v165, v140
    v_mfma_f32_16x16x32_bf16 v[112:115], v[24:27], a[248:251], v[112:115]
    ds_read_b128 v[40:43], v2 offset:6400
    v_cvt_f32_i32 v248, v248
    v_mfma_f32_16x16x32_bf16 v[112:115], v[28:31], a[252:255], v[112:115]
    v_add_f32 v166, v166, v140
    v_add_f32 v167, v167, v140
    v_cvt_f32_i32 v249, v249
    v_mfma_f32_16x16x32_bf16 v[116:119], v[24:27], v[208:211], v[116:119]
    ds_read_b128 v[44:47], v3 offset:6400
    v_add_f32 v100, v100, v140
    v_mfma_f32_16x16x32_bf16 v[116:119], v[28:31], v[212:215], v[116:119]
    s_waitcnt lgkmcnt(2)
    v_fma_f32 v248, v248, v48, v50
    v_fma_f32 v249, v249, v49, v51
    v_add_f32 v101, v101, v140
    v_mfma_f32_16x16x32_bf16 v[176:179], v[32:35], v[192:195], v[176:179]
    ds_read_b128 v[24:27], v2 offset:12288
    v_cvt_pk_bf16_f32 v234, v248, v249
    v_mfma_f32_16x16x32_bf16 v[176:179], v[36:39], v[196:199], v[176:179]
    v_cvt_f32_i32 v252, v252
    v_add_f32 v102, v102, v140
    v_add_f32 v103, v103, v140
    v_mfma_f32_16x16x32_bf16 v[180:183], v[32:35], v[216:219], v[180:183]
    ds_read_b128 v[28:31], v3 offset:12288
    v_cvt_f32_i32 v253, v253
    v_mfma_f32_16x16x32_bf16 v[180:183], v[36:39], v[220:223], v[180:183]
    s_waitcnt lgkmcnt(2)
    v_fma_f32 v252, v252, v48, v50
    v_fma_f32 v253, v253, v49, v51
    v_cvt_pk_bf16_f32 v238, v252, v253
    v_mfma_f32_16x16x32_bf16 v[112:115], v[40:43], v[192:195], v[112:115]
    ds_read_b128 v[32:35], v2 offset:18432
    v_lshlrev_b32 v48, 16, v61
    v_mfma_f32_16x16x32_bf16 v[112:115], v[44:47], v[196:199], v[112:115]
    v_and_b32 v49, s97, v61
    v_lshlrev_b32 v50, 16, v63
    v_and_b32 v51, s97, v63
    v_mfma_f32_16x16x32_bf16 v[116:119], v[40:43], v[216:219], v[116:119]
    ds_read_b128 v[36:39], v3 offset:18432
    v_mul_f32 v48, s38, v48
    v_mfma_f32_16x16x32_bf16 v[116:119], v[44:47], v[220:223], v[116:119]
    s_waitcnt lgkmcnt(2)
    v_mul_f32 v49, s38, v49
    v_mul_f32_e64 v50, -v50, v48
    v_mul_f32_e64 v51, -v51, v49
    v_mfma_f32_16x16x32_bf16 v[184:187], v[24:27], a[240:243], v[136:139]
    ds_read_b128 v[40:43], v2 offset:12416
    v_cvt_f32_i32 v242, v242
    v_cvt_f32_i32 v243, v243
    v_fma_f32 v242, v242, v48, v50
    v_fma_f32 v243, v243, v49, v51
    v_cvt_pk_bf16_f32 v227, v242, v243
    v_cvt_f32_i32 v246, v246
    v_cvt_f32_i32 v247, v247
    v_fma_f32 v246, v246, v48, v50
    v_fma_f32 v247, v247, v49, v51
    v_cvt_pk_bf16_f32 v231, v246, v247
    v_cvt_f32_i32 v250, v250
    v_cvt_f32_i32 v251, v251
    v_fma_f32 v250, v250, v48, v50
    v_fma_f32 v251, v251, v49, v51
    v_cvt_pk_bf16_f32 v235, v250, v251
    v_cvt_f32_i32 v254, v254
    v_cvt_f32_i32 v255, v255
    v_fma_f32 v254, v254, v48, v50
    v_fma_f32 v255, v255, v49, v51
    v_cvt_pk_bf16_f32 v239, v254, v255
    v_mfma_f32_16x16x32_bf16 v[184:187], v[28:31], a[244:247], v[184:187]
    buffer_store_dwordx4 v[224:227], v11, s[4:7], s33 offen offset:0 sc1
    v_mfma_f32_16x16x32_bf16 v[188:191], v[24:27], v[200:203], v[140:143]
    ds_read_b128 v[44:47], v3 offset:12416
    v_xor_b32 v55, 16, v11
    v_mfma_f32_16x16x32_bf16 v[188:191], v[28:31], v[204:207], v[188:191]
    s_waitcnt lgkmcnt(2)
    v_exp_f32 v16, v160
    v_mfma_f32_16x16x32_bf16 v[120:123], v[32:35], a[240:243], v[136:139]
    ds_read_b128 v[24:27], v2 offset:18560
    v_mfma_f32_16x16x32_bf16 v[120:123], v[36:39], a[244:247], v[120:123]
    buffer_store_dwordx4 v[228:231], v55, s[4:7], s33 offen offset:768 sc1
    v_mfma_f32_16x16x32_bf16 v[124:127], v[32:35], v[200:203], v[140:143]
    ds_read_b128 v[28:31], v3 offset:18560
    v_mfma_f32_16x16x32_bf16 v[124:127], v[36:39], v[204:207], v[124:127]
    s_waitcnt lgkmcnt(2)
    v_exp_f32 v17, v161
    v_mfma_f32_16x16x32_bf16 v[184:187], v[40:43], a[248:251], v[184:187]
    ds_read_b128 v[32:35], v2 offset:12544
    v_mfma_f32_16x16x32_bf16 v[184:187], v[44:47], a[252:255], v[184:187]
    v_exp_f32 v18, v162
    v_add_f32 v7, v7, v16
    v_mfma_f32_16x16x32_bf16 v[188:191], v[40:43], v[208:211], v[188:191]
    ds_read_b128 v[36:39], v3 offset:12544
    v_add_f32 v7, v7, v17
    v_mfma_f32_16x16x32_bf16 v[188:191], v[44:47], v[212:215], v[188:191]
    s_waitcnt lgkmcnt(2)
    v_exp_f32 v19, v163
    v_cvt_pk_bf16_f32 v160, v16, v17
    v_mfma_f32_16x16x32_bf16 v[120:123], v[24:27], a[248:251], v[120:123]
    ds_read_b128 v[40:43], v2 offset:18688
    v_xor_b32 v54, 32, v11
    v_mfma_f32_16x16x32_bf16 v[120:123], v[28:31], a[252:255], v[120:123]
    s_waitcnt vmcnt(4)
    v_exp_f32 v16, v96
    v_add_f32 v7, v7, v18
    v_mfma_f32_16x16x32_bf16 v[124:127], v[24:27], v[208:211], v[124:127]
    ds_read_b128 v[44:47], v3 offset:18688
    v_add_f32 v7, v7, v19
    v_mfma_f32_16x16x32_bf16 v[124:127], v[28:31], v[212:215], v[124:127]
    s_waitcnt lgkmcnt(2)
    s_barrier
    v_add_u32 v2, 49152, v2
    v_add_u32 v3, 49152, v3
    v_mfma_f32_16x16x32_bf16 v[184:187], v[32:35], v[192:195], v[184:187]
    ds_read_b128 v[24:27], v2 offset:0
    v_xor_b32 v55, 48, v11
    v_mfma_f32_16x16x32_bf16 v[184:187], v[36:39], v[196:199], v[184:187]
    buffer_store_dwordx4 v[232:235], v54, s[4:7], s33 offen offset:1536 sc1
    v_mfma_f32_16x16x32_bf16 v[188:191], v[32:35], v[216:219], v[188:191]
    ds_read_b128 v[28:31], v3 offset:0
    v_mfma_f32_16x16x32_bf16 v[188:191], v[36:39], v[220:223], v[188:191]
    s_waitcnt lgkmcnt(2)
    v_exp_f32 v17, v97
    v_cvt_pk_bf16_f32 v161, v18, v19
    v_mfma_f32_16x16x32_bf16 v[120:123], v[40:43], v[192:195], v[120:123]
    ds_read_b128 v[32:35], v2 offset:6144
    v_mfma_f32_16x16x32_bf16 v[120:123], v[44:47], v[196:199], v[120:123]
    buffer_store_dwordx4 v[236:239], v55, s[4:7], s33 offen offset:2304 sc1
    v_mfma_f32_16x16x32_bf16 v[124:127], v[40:43], v[216:219], v[124:127]
    ds_read_b128 v[36:39], v3 offset:6144
    v_mfma_f32_16x16x32_bf16 v[124:127], v[44:47], v[220:223], v[124:127]
    s_waitcnt lgkmcnt(2)
    v_exp_f32 v18, v98
    v_add_f32 v7, v7, v16
    v_add_f32 v7, v7, v17
    v_exp_f32 v19, v99
    v_cvt_pk_bf16_f32 v162, v16, v17
    v_exp_f32 v16, v164
    v_add_f32 v7, v7, v18
    v_add_f32 v7, v7, v19
    v_exp_f32 v17, v165
    v_cvt_pk_bf16_f32 v163, v18, v19
    v_exp_f32 v18, v166
    v_add_f32 v8, v8, v16
    v_add_f32 v8, v8, v17
    v_exp_f32 v19, v167
    v_cvt_pk_bf16_f32 v164, v16, v17
    v_exp_f32 v16, v100
    v_add_f32 v8, v8, v18
    v_add_f32 v8, v8, v19
    v_exp_f32 v17, v101
    v_cvt_pk_bf16_f32 v165, v18, v19
    v_exp_f32 v18, v102
    v_add_f32 v8, v8, v16
    v_add_f32 v8, v8, v17
    v_exp_f32 v19, v103
    v_cvt_pk_bf16_f32 v166, v16, v17
    v_add_f32 v8, v8, v18
    v_add_f32 v8, v8, v19
    v_cvt_pk_bf16_f32 v167, v18, v19
    v_add_f32 v168, v168, v136
    v_add_f32 v169, v169, v136
    v_add_f32 v170, v170, v136
    v_add_f32 v171, v171, v136
    v_add_f32 v104, v104, v136
    v_add_f32 v105, v105, v136
    v_add_f32 v106, v106, v136
    v_add_f32 v107, v107, v136
    v_add_f32 v172, v172, v140
    v_add_f32 v173, v173, v140
    v_add_f32 v174, v174, v140
    v_add_f32 v175, v175, v140
    v_add_f32 v108, v108, v140
    v_add_f32 v109, v109, v140
    v_add_f32 v110, v110, v140
    v_add_f32 v111, v111, v140
    v_exp_f32 v16, v168
    v_exp_f32 v17, v169
    v_exp_f32 v18, v170
    v_add_f32 v7, v7, v16
    v_add_f32 v7, v7, v17
    v_exp_f32 v19, v171
    v_cvt_pk_bf16_f32 v168, v16, v17
    v_exp_f32 v16, v104
    v_add_f32 v7, v7, v18
    v_add_f32 v7, v7, v19
    v_exp_f32 v17, v105
    v_cvt_pk_bf16_f32 v169, v18, v19
    v_exp_f32 v18, v106
    v_add_f32 v7, v7, v16
    v_add_f32 v7, v7, v17
    v_exp_f32 v19, v107
    v_cvt_pk_bf16_f32 v170, v16, v17
    v_exp_f32 v16, v172
    v_add_f32 v7, v7, v18
    v_add_f32 v7, v7, v19
    v_exp_f32 v17, v173
    v_cvt_pk_bf16_f32 v171, v18, v19
    v_exp_f32 v18, v174
    v_add_f32 v8, v8, v16
    v_add_f32 v8, v8, v17
    v_exp_f32 v19, v175
    v_cvt_pk_bf16_f32 v172, v16, v17
    v_exp_f32 v16, v108
    v_add_f32 v8, v8, v18
    v_add_f32 v8, v8, v19
    v_exp_f32 v17, v109
    v_cvt_pk_bf16_f32 v173, v18, v19
    v_exp_f32 v18, v110
    v_add_f32 v8, v8, v16
    v_add_f32 v8, v8, v17
    v_exp_f32 v19, v111
    v_cvt_pk_bf16_f32 v174, v16, v17
    v_add_f32 v8, v8, v18
    v_add_f32 v8, v8, v19
    v_cvt_pk_bf16_f32 v175, v18, v19
    v_mfma_f32_16x16x32_bf16 v[64:67], v[24:27], a[192:195], v[128:131]
    ds_read_b128 v[40:43], v2 offset:128
    v_mfma_f32_16x16x32_bf16 v[64:67], v[28:31], a[196:199], v[64:67]
    buffer_load_dwordx2 v[60:61], off, s[80:83], s37 offset:8
    v_mfma_f32_16x16x32_bf16 v[68:71], v[24:27], a[216:219], v[132:135]
    v_exp_f32 v16, v176
    v_mfma_f32_16x16x32_bf16 v[68:71], v[28:31], a[220:223], v[68:71]
    v_exp_f32 v17, v177
    v_mfma_f32_16x16x32_bf16 v[72:75], v[24:27], a[240:243], v[136:139]
    ds_read_b128 v[44:47], v3 offset:128
    v_mfma_f32_16x16x32_bf16 v[72:75], v[28:31], a[244:247], v[72:75]
    buffer_load_dwordx2 v[62:63], off, s[84:87], s37 offset:8
    v_mfma_f32_16x16x32_bf16 v[76:79], v[24:27], v[200:203], v[140:143]
    v_exp_f32 v18, v178
    v_mfma_f32_16x16x32_bf16 v[76:79], v[28:31], v[204:207], v[76:79]
    s_waitcnt lgkmcnt(2)
    v_add_f32 v7, v7, v16
    v_add_f32 v7, v7, v17
    v_mfma_f32_16x16x32_bf16 v[96:99], v[32:35], a[192:195], v[128:131]
    ds_read_b128 v[24:27], v2 offset:6272
    v_mfma_f32_16x16x32_bf16 v[96:99], v[36:39], a[196:199], v[96:99]
    buffer_load_dwordx4 v[240:243], v12, s[68:71], s16 offen offset:0 nt
    v_mfma_f32_16x16x32_bf16 v[100:103], v[32:35], a[216:219], v[132:135]
    s_waitcnt vmcnt(7)
    v_exp_f32 v19, v179
    v_mfma_f32_16x16x32_bf16 v[100:103], v[36:39], a[220:223], v[100:103]
    v_cvt_pk_bf16_f32 v176, v16, v17
    v_exp_f32 v16, v112
    v_mfma_f32_16x16x32_bf16 v[104:107], v[32:35], a[240:243], v[136:139]
    ds_read_b128 v[28:31], v3 offset:6272
    v_add_f32 v7, v7, v18
    v_mfma_f32_16x16x32_bf16 v[104:107], v[36:39], a[244:247], v[104:107]
    buffer_load_dwordx4 v[244:247], v12, s[68:71], s16 offen offset:768 nt
    v_add_f32 v7, v7, v19
    v_mfma_f32_16x16x32_bf16 v[108:111], v[32:35], v[200:203], v[140:143]
    v_exp_f32 v17, v113
    v_mfma_f32_16x16x32_bf16 v[108:111], v[36:39], v[204:207], v[108:111]
    s_waitcnt lgkmcnt(2)
    v_cvt_pk_bf16_f32 v177, v18, v19
    v_exp_f32 v18, v114
    v_mfma_f32_16x16x32_bf16 v[64:67], v[40:43], a[200:203], v[64:67]
    ds_read_b128 v[32:35], v2 offset:256
    v_add_f32 v7, v7, v16
    v_mfma_f32_16x16x32_bf16 v[64:67], v[44:47], a[204:207], v[64:67]
    buffer_load_dwordx4 v[248:251], v12, s[68:71], s16 offen offset:1536 nt
    v_add_f32 v7, v7, v17
    v_mfma_f32_16x16x32_bf16 v[68:71], v[40:43], a[224:227], v[68:71]
    v_exp_f32 v19, v115
    v_mfma_f32_16x16x32_bf16 v[68:71], v[44:47], a[228:231], v[68:71]
    v_cvt_pk_bf16_f32 v178, v16, v17
    v_exp_f32 v16, v180
    v_mfma_f32_16x16x32_bf16 v[72:75], v[40:43], a[248:251], v[72:75]
    ds_read_b128 v[36:39], v3 offset:256
    v_add_f32 v7, v7, v18
    v_mfma_f32_16x16x32_bf16 v[72:75], v[44:47], a[252:255], v[72:75]
    buffer_load_dwordx4 v[252:255], v12, s[68:71], s16 offen offset:2304 nt
    v_add_f32 v7, v7, v19
    v_mfma_f32_16x16x32_bf16 v[76:79], v[40:43], v[208:211], v[76:79]
    v_exp_f32 v17, v181
    v_mfma_f32_16x16x32_bf16 v[76:79], v[44:47], v[212:215], v[76:79]
    s_waitcnt lgkmcnt(2)
    v_cvt_pk_bf16_f32 v179, v18, v19
    v_exp_f32 v18, v182
    v_mfma_f32_16x16x32_bf16 v[96:99], v[24:27], a[200:203], v[96:99]
    s_mov_b32 m0, s26
    ds_read_b128 v[40:43], v2 offset:6400
    v_add_f32 v8, v8, v16
    v_mfma_f32_16x16x32_bf16 v[96:99], v[28:31], a[204:207], v[96:99]
    buffer_load_dwordx4 v4, s[4:7], s32 offen offset:0 sc1 lds
    v_add_f32 v8, v8, v17
    v_mfma_f32_16x16x32_bf16 v[100:103], v[24:27], a[224:227], v[100:103]
    v_exp_f32 v19, v183
    v_mfma_f32_16x16x32_bf16 v[100:103], v[28:31], a[228:231], v[100:103]
    v_cvt_pk_bf16_f32 v180, v16, v17
    v_exp_f32 v16, v116
    v_mfma_f32_16x16x32_bf16 v[104:107], v[24:27], a[248:251], v[104:107]
    ds_read_b128 v[44:47], v3 offset:6400
    v_add_f32 v8, v8, v18
    v_mfma_f32_16x16x32_bf16 v[104:107], v[28:31], a[252:255], v[104:107]
    buffer_load_dwordx4 v4, s[4:7], s32 offen offset:1024 sc1 lds
    v_add_f32 v8, v8, v19
    v_mfma_f32_16x16x32_bf16 v[108:111], v[24:27], v[208:211], v[108:111]
    v_exp_f32 v17, v117
    v_mfma_f32_16x16x32_bf16 v[108:111], v[28:31], v[212:215], v[108:111]
    s_waitcnt lgkmcnt(2)
    v_cvt_pk_bf16_f32 v181, v18, v19
    v_exp_f32 v18, v118
    v_mfma_f32_16x16x32_bf16 v[64:67], v[32:35], a[208:211], v[64:67]
    ds_read_b128 v[24:27], v2 offset:12288
    v_add_f32 v8, v8, v16
    v_mfma_f32_16x16x32_bf16 v[64:67], v[36:39], a[212:215], v[64:67]
    buffer_load_dwordx4 v4, s[4:7], s32 offen offset:2048 sc1 lds
    v_add_f32 v8, v8, v17
    v_mfma_f32_16x16x32_bf16 v[68:71], v[32:35], a[232:235], v[68:71]
    s_add_u32 s32, s32, 24576
    v_exp_f32 v19, v119
    v_mfma_f32_16x16x32_bf16 v[68:71], v[36:39], a[236:239], v[68:71]
    v_cvt_pk_bf16_f32 v182, v16, v17
    v_add_f32 v8, v8, v18
    v_add_f32 v8, v8, v19
    v_mfma_f32_16x16x32_bf16 v[72:75], v[32:35], v[192:195], v[72:75]
    s_sub_u32 s57, s32, 196608
    ds_read_b128 v[28:31], v3 offset:12288
    v_cvt_pk_bf16_f32 v183, v18, v19
    v_mfma_f32_16x16x32_bf16 v[72:75], v[36:39], v[196:199], v[72:75]
    s_waitcnt lgkmcnt(2)
    v_exp_f32 v16, v184
    v_lshlrev_b32 v48, 16, v56
    v_mfma_f32_16x16x32_bf16 v[76:79], v[32:35], v[216:219], v[76:79]
    s_waitcnt vmcnt(9)
    v_exp_f32 v17, v185
    v_mfma_f32_16x16x32_bf16 v[76:79], v[36:39], v[220:223], v[76:79]
    s_barrier
    v_exp_f32 v18, v186
    v_mfma_f32_16x16x32_bf16 v[96:99], v[40:43], a[208:211], v[96:99]
    s_min_u32 s32, s32, s57
    ds_read_b128 v[32:35], v2 offset:18432
    v_add_f32 v7, v7, v16
    v_mfma_f32_16x16x32_bf16 v[96:99], v[44:47], a[212:215], v[96:99]
    v_add_f32 v7, v7, v17
    v_exp_f32 v19, v187
    v_mfma_f32_16x16x32_bf16 v[100:103], v[40:43], a[232:235], v[100:103]
    s_add_u32 s26, s26, 12288
    v_cvt_pk_bf16_f32 v184, v16, v17
    v_and_b32 v49, s97, v56
    v_mfma_f32_16x16x32_bf16 v[100:103], v[44:47], a[236:239], v[100:103]
    v_exp_f32 v16, v120
    v_add_f32 v7, v7, v18
    v_mfma_f32_16x16x32_bf16 v[104:107], v[40:43], v[192:195], v[104:107]
    s_mov_b32 m0, s26
    ds_read_b128 v[36:39], v3 offset:18432
    v_add_f32 v7, v7, v19
    v_mfma_f32_16x16x32_bf16 v[104:107], v[44:47], v[196:199], v[104:107]
    buffer_load_dwordx4 v4, s[4:7], s32 offen offset:0 sc1 lds
    v_lshlrev_b32 v50, 16, v58
    v_mfma_f32_16x16x32_bf16 v[108:111], v[40:43], v[216:219], v[108:111]
    v_exp_f32 v17, v121
    v_mfma_f32_16x16x32_bf16 v[108:111], v[44:47], v[220:223], v[108:111]
    s_waitcnt lgkmcnt(2)
    v_cvt_pk_bf16_f32 v185, v18, v19
    v_exp_f32 v18, v122
    v_mfma_f32_16x16x32_bf16 v[80:83], v[24:27], a[192:195], v[128:131]
    ds_read_b128 v[40:43], v2 offset:12416
    v_add_f32 v7, v7, v16
    v_mfma_f32_16x16x32_bf16 v[80:83], v[28:31], a[196:199], v[80:83]
    buffer_load_dwordx4 v4, s[4:7], s32 offen offset:1024 sc1 lds
    v_add_f32 v7, v7, v17
    v_mfma_f32_16x16x32_bf16 v[84:87], v[24:27], a[216:219], v[132:135]
    v_exp_f32 v19, v123
    v_mfma_f32_16x16x32_bf16 v[84:87], v[28:31], a[220:223], v[84:87]
    v_cvt_pk_bf16_f32 v186, v16, v17
    v_exp_f32 v16, v188
    v_mfma_f32_16x16x32_bf16 v[88:91], v[24:27], a[240:243], v[136:139]
    ds_read_b128 v[44:47], v3 offset:12416
    v_add_f32 v7, v7, v18
    v_mfma_f32_16x16x32_bf16 v[88:91], v[28:31], a[244:247], v[88:91]
    v_add_u32 v0, 1, v0
    buffer_store_dword v0, v13, s[20:23], 0 offen offset:32 sc1
    v_mfma_f32_16x16x32_bf16 v[92:95], v[24:27], v[200:203], v[140:143]
    v_add_f32 v7, v7, v19
    v_exp_f32 v17, v189
    v_cvt_pk_bf16_f32 v187, v18, v19
    v_exp_f32 v18, v190
    v_add_f32 v8, v8, v16
    v_add_f32 v8, v8, v17
    v_exp_f32 v19, v191
    v_cvt_pk_bf16_f32 v188, v16, v17
    v_exp_f32 v16, v124
    v_add_f32 v8, v8, v18
    v_add_f32 v8, v8, v19
    v_exp_f32 v17, v125
    v_cvt_pk_bf16_f32 v189, v18, v19
    v_exp_f32 v18, v126
    v_add_f32 v8, v8, v16
    v_add_f32 v8, v8, v17
    v_exp_f32 v19, v127
    v_cvt_pk_bf16_f32 v190, v16, v17
    v_add_f32 v8, v8, v18
    v_add_f32 v8, v8, v19
    v_cvt_pk_bf16_f32 v191, v18, v19
    v_mfma_f32_16x16x32_bf16 v[92:95], v[28:31], v[204:207], v[92:95]
    s_waitcnt lgkmcnt(2)
    v_and_b32 v51, s97, v58
    v_mul_f32_e64 v50, -v50, v48
    v_mul_f32_e64 v51, -v51, v49
    v_mfma_f32_16x16x32_bf16 v[112:115], v[32:35], a[192:195], v[128:131]
    ds_read_b128 v[24:27], v2 offset:18560
    v_cvt_f32_i32 v144, v144
    v_mfma_f32_16x16x32_bf16 v[112:115], v[36:39], a[196:199], v[112:115]
    buffer_load_dwordx4 v4, s[4:7], s32 offen offset:2048 sc1 lds
    v_cvt_f32_i32 v148, v148
    v_mfma_f32_16x16x32_bf16 v[116:119], v[32:35], a[216:219], v[132:135]
    s_mov_b32 s32, 196608
    v_fma_f32 v144, v144, v48, v50
    v_fma_f32 v148, v148, v49, v51
    v_mfma_f32_16x16x32_bf16 v[116:119], v[36:39], a[220:223], v[116:119]
    v_cvt_f32_i32 v145, v145
    v_cvt_f32_i32 v149, v149
    v_fma_f32 v145, v145, v48, v50
    v_mfma_f32_16x16x32_bf16 v[120:123], v[32:35], a[240:243], v[136:139]
    s_add_u32 s26, s26, 36864
    ds_read_b128 v[28:31], v3 offset:18560
    v_fma_f32 v149, v149, v49, v51
    v_mfma_f32_16x16x32_bf16 v[120:123], v[36:39], a[244:247], v[120:123]
    v_cvt_f32_i32 v146, v146
    v_cvt_f32_i32 v150, v150
    v_fma_f32 v146, v146, v48, v50
    v_mfma_f32_16x16x32_bf16 v[124:127], v[32:35], v[200:203], v[140:143]
    s_sub_u32 s57, s26, 147456
    v_fma_f32 v150, v150, v49, v51
    v_cvt_f32_i32 v147, v147
    v_mfma_f32_16x16x32_bf16 v[124:127], v[36:39], v[204:207], v[124:127]
    s_waitcnt lgkmcnt(2)
    v_cvt_f32_i32 v151, v151
    v_exp_f32 v16, v64
    v_mfma_f32_16x16x32_bf16 v[80:83], v[40:43], a[200:203], v[80:83]
    s_min_u32 s26, s26, s57
    ds_read_b128 v[32:35], v2 offset:12544
    v_fma_f32 v147, v147, v48, v50
    v_mfma_f32_16x16x32_bf16 v[80:83], v[44:47], a[204:207], v[80:83]
    v_exp_f32 v17, v65
    v_fma_f32 v151, v151, v49, v51
    v_mfma_f32_16x16x32_bf16 v[84:87], v[40:43], a[224:227], v[84:87]
    s_mov_b32 m0, s56
    v_exp_f32 v18, v66
    v_mfma_f32_16x16x32_bf16 v[84:87], v[44:47], a[228:231], v[84:87]
    buffer_load_dwordx4 v4, s[4:7], s27 offen offset:0 sc1 lds
    v_lshlrev_b32 v48, 16, v57
    v_mfma_f32_16x16x32_bf16 v[88:91], v[40:43], a[248:251], v[88:91]
    ds_read_b128 v[36:39], v3 offset:12544
    v_add_f32 v5, v5, v16
    v_mfma_f32_16x16x32_bf16 v[88:91], v[44:47], a[252:255], v[88:91]
    v_add_f32 v5, v5, v17
    v_and_b32 v49, s97, v57
    v_lshlrev_b32 v50, 16, v59
    v_mfma_f32_16x16x32_bf16 v[92:95], v[40:43], v[208:211], v[92:95]
    v_exp_f32 v19, v67
    v_mfma_f32_16x16x32_bf16 v[92:95], v[44:47], v[212:215], v[92:95]
    s_waitcnt lgkmcnt(2)
    buffer_load_dwordx4 v4, s[4:7], s27 offen offset:1024 sc1 lds
    v_cvt_pk_bf16_f32 v64, v16, v17
    v_mfma_f32_16x16x32_bf16 v[112:115], v[24:27], a[200:203], v[112:115]
    ds_read_b128 v[40:43], v2 offset:18688
    v_and_b32 v51, s97, v59
    v_mfma_f32_16x16x32_bf16 v[112:115], v[28:31], a[204:207], v[112:115]
    v_exp_f32 v16, v96
    v_add_f32 v5, v5, v18
    v_mfma_f32_16x16x32_bf16 v[116:119], v[24:27], a[224:227], v[116:119]
    v_add_f32 v5, v5, v19
    v_mul_f32_e64 v50, -v50, v48
    v_mfma_f32_16x16x32_bf16 v[116:119], v[28:31], a[228:231], v[116:119]
    s_waitcnt vmcnt(13)
    buffer_load_dwordx4 v4, s[4:7], s27 offen offset:2048 sc1 lds
    v_mul_f32_e64 v51, -v51, v49
    v_mfma_f32_16x16x32_bf16 v[120:123], v[24:27], a[248:251], v[120:123]
    s_add_u32 s27, s27, 24576
    ds_read_b128 v[44:47], v3 offset:18688
    v_cvt_f32_i32 v152, v152
    v_mfma_f32_16x16x32_bf16 v[120:123], v[28:31], a[252:255], v[120:123]
    s_waitcnt lgkmcnt(2)
    v_exp_f32 v17, v97
    v_cvt_pk_bf16_f32 v65, v18, v19
    v_mfma_f32_16x16x32_bf16 v[124:127], v[24:27], v[208:211], v[124:127]
    s_sub_u32 s58, s27, 196608
    v_exp_f32 v18, v98
    v_mfma_f32_16x16x32_bf16 v[124:127], v[28:31], v[212:215], v[124:127]
    s_barrier
    v_subrev_u32 v1, 49152, v1
    v_add_f32 v5, v5, v16
    v_mfma_f32_16x16x32_bf16 v[80:83], v[32:35], a[208:211], v[80:83]
    s_min_u32 s27, s27, s58
    ds_read_b128 v[24:27], v1 offset:0
    v_add_f32 v5, v5, v17
    v_mfma_f32_16x16x32_bf16 v[80:83], v[36:39], a[212:215], v[80:83]
    v_exp_f32 v19, v99
    v_cvt_f32_i32 v156, v156
    v_mfma_f32_16x16x32_bf16 v[84:87], v[32:35], a[232:235], v[84:87]
    s_add_u32 s56, s56, 12288
    v_cvt_pk_bf16_f32 v66, v16, v17
    v_fma_f32 v152, v152, v48, v50
    v_mfma_f32_16x16x32_bf16 v[84:87], v[36:39], a[236:239], v[84:87]
    v_exp_f32 v16, v68
    v_fma_f32 v156, v156, v49, v51
    v_mfma_f32_16x16x32_bf16 v[88:91], v[32:35], v[192:195], v[88:91]
    s_mov_b32 m0, s56
    ds_read_b128 v[28:31], v1 offset:12288
    v_add_f32 v5, v5, v18
    v_mfma_f32_16x16x32_bf16 v[88:91], v[36:39], v[196:199], v[88:91]
    s_waitcnt vmcnt(12)
    buffer_load_dwordx4 v4, s[4:7], s27 offen offset:0 sc1 lds
    v_add_f32 v5, v5, v19
    v_mfma_f32_16x16x32_bf16 v[92:95], v[32:35], v[216:219], v[92:95]
    v_exp_f32 v17, v69
    v_mfma_f32_16x16x32_bf16 v[92:95], v[36:39], v[220:223], v[92:95]
    s_waitcnt lgkmcnt(2)
    v_cvt_f32_i32 v153, v153
    v_cvt_pk_bf16_f32 v67, v18, v19
    v_cvt_f32_i32 v157, v157
    v_mfma_f32_16x16x32_bf16 v[112:115], v[40:43], a[208:211], v[112:115]
    ds_read_b128 v[32:35], v1 offset:1024
    v_fma_f32 v153, v153, v48, v50
    v_mfma_f32_16x16x32_bf16 v[112:115], v[44:47], a[212:215], v[112:115]
    s_waitcnt vmcnt(12)
    buffer_load_dwordx4 v4, s[4:7], s27 offen offset:1024 sc1 lds
    v_fma_f32 v157, v157, v49, v51
    v_mfma_f32_16x16x32_bf16 v[116:119], v[40:43], a[232:235], v[116:119]
    s_waitcnt vmcnt(12)
    buffer_load_dwordx4 v4, s[4:7], s27 offen offset:2048 sc1 lds
    v_mfma_f32_16x16x32_bf16 v[116:119], v[44:47], a[236:239], v[116:119]
    v_exp_f32 v18, v70
    v_add_f32 v6, v6, v16
    v_mfma_f32_16x16x32_bf16 v[120:123], v[40:43], v[192:195], v[120:123]
    s_add_u32 s27, s27, 24576
    ds_read_b128 v[36:39], v1 offset:13312
    v_add_f32 v6, v6, v17
    v_mfma_f32_16x16x32_bf16 v[120:123], v[44:47], v[196:199], v[120:123]
    v_exp_f32 v19, v71
    v_cvt_pk_bf16_f32 v68, v16, v17
    v_mfma_f32_16x16x32_bf16 v[124:127], v[40:43], v[216:219], v[124:127]
    s_sub_u32 s58, s27, 196608
    v_exp_f32 v16, v100
    v_mfma_f32_16x16x32_bf16 v[124:127], v[44:47], v[220:223], v[124:127]
    s_waitcnt lgkmcnt(2)
    v_cvt_f32_i32 v154, v154
    v_add_f32 v6, v6, v18
    v_cvt_f32_i32 v158, v158
    v_add_f32 v6, v6, v19
    v_fma_f32 v154, v154, v48, v50
    v_exp_f32 v17, v101
    v_fma_f32 v158, v158, v49, v51
    v_cvt_f32_i32 v155, v155
    v_cvt_pk_bf16_f32 v69, v18, v19
    v_cvt_f32_i32 v159, v159
    v_exp_f32 v18, v102
    v_fma_f32 v155, v155, v48, v50
    v_fma_f32 v159, v159, v49, v51
    v_add_f32 v6, v6, v16
    v_cvt_pk_bf16_f32 v144, v144, v148
    v_add_f32 v6, v6, v17
    v_cvt_pk_bf16_f32 v148, v145, v149
    v_exp_f32 v19, v103
    v_cvt_pk_bf16_f32 v145, v152, v156
    v_cvt_pk_bf16_f32 v149, v153, v157
    v_cvt_pk_bf16_f32 v70, v16, v17
    s_min_u32 s27, s27, s58
    v_cvt_pk_bf16_f32 v152, v146, v150
    v_add_f32 v6, v6, v18
    s_add_u32 s56, s56, 36864
    v_cvt_pk_bf16_f32 v153, v154, v158
    v_add_f32 v6, v6, v19
    s_sub_u32 s58, s56, 147456
    v_cvt_pk_bf16_f32 v156, v147, v151
    v_cvt_pk_bf16_f32 v71, v18, v19
    s_min_u32 s56, s56, s58
    v_cvt_pk_bf16_f32 v157, v155, v159
    s_mov_b32 s31, 7
    v_mfma_f32_16x16x32_bf16 a[96:99], v[160:163], v[24:27], 0
    s_add_u32 s33, s33, 196608
    ds_read_b128 v[40:43], v1 offset:2048
    v_mfma_f32_16x16x32_bf16 a[96:99], v[168:171], v[28:31], a[96:99]
    s_add_u32 s34, s34, 196608
    v_exp_f32 v16, v72
    v_mfma_f32_16x16x32_bf16 a[144:147], v[164:167], v[24:27], 0
    s_add_u32 s36, s36, 1536
    ds_read_b128 v[44:47], v1 offset:14336
    v_mfma_f32_16x16x32_bf16 a[144:147], v[172:175], v[28:31], a[144:147]
    s_waitcnt lgkmcnt(2)
    v_exp_f32 v17, v73
    v_mfma_f32_16x16x32_bf16 a[100:103], v[160:163], v[32:35], 0
    ds_read_b128 v[24:27], v1 offset:3072
    v_mfma_f32_16x16x32_bf16 a[100:103], v[168:171], v[36:39], a[100:103]
    s_waitcnt vmcnt(12)
    buffer_load_dwordx2 v[56:57], v10, s[72:75], s36 offen offset:0
    v_mfma_f32_16x16x32_bf16 a[148:151], v[164:167], v[32:35], 0
    ds_read_b128 v[28:31], v1 offset:15360
    v_mfma_f32_16x16x32_bf16 a[148:151], v[172:175], v[36:39], a[148:151]
    s_waitcnt lgkmcnt(2)
    v_exp_f32 v18, v74
    v_mfma_f32_16x16x32_bf16 a[104:107], v[160:163], v[40:43], 0
    ds_read_b128 v[32:35], v1 offset:4096
    v_add_f32 v7, v7, v16
    v_mfma_f32_16x16x32_bf16 a[104:107], v[168:171], v[44:47], a[104:107]
    buffer_load_dwordx2 v[58:59], v10, s[76:79], s36 offen offset:0
    v_mfma_f32_16x16x32_bf16 a[152:155], v[164:167], v[40:43], 0
    ds_read_b128 v[36:39], v1 offset:16384
    v_add_f32 v7, v7, v17
    v_mfma_f32_16x16x32_bf16 a[152:155], v[172:175], v[44:47], a[152:155]
    s_waitcnt lgkmcnt(2)
    v_exp_f32 v19, v75
    v_mfma_f32_16x16x32_bf16 a[108:111], v[160:163], v[24:27], 0
    ds_read_b128 v[40:43], v1 offset:5120
    v_cvt_pk_bf16_f32 v72, v16, v17
    v_mfma_f32_16x16x32_bf16 a[108:111], v[168:171], v[28:31], a[108:111]
    s_waitcnt vmcnt(13)
    buffer_load_dwordx4 v[224:227], v9, s[64:67], s33 offen offset:0 nt
    v_mfma_f32_16x16x32_bf16 a[156:159], v[164:167], v[24:27], 0
    ds_read_b128 v[44:47], v1 offset:17408
    v_mfma_f32_16x16x32_bf16 a[156:159], v[172:175], v[28:31], a[156:159]
    s_waitcnt lgkmcnt(2)
    v_exp_f32 v16, v104
    v_mfma_f32_16x16x32_bf16 a[112:115], v[160:163], v[32:35], 0
    ds_read_b128 v[24:27], v1 offset:6144
    v_add_f32 v7, v7, v18
    v_mfma_f32_16x16x32_bf16 a[112:115], v[168:171], v[36:39], a[112:115]
    s_waitcnt vmcnt(13)
    buffer_load_dwordx4 v[228:231], v9, s[64:67], s33 offen offset:1536 nt
    v_add_f32 v7, v7, v19
    v_mfma_f32_16x16x32_bf16 a[160:163], v[164:167], v[32:35], 0
    ds_read_b128 v[28:31], v1 offset:18432
    v_mfma_f32_16x16x32_bf16 a[160:163], v[172:175], v[36:39], a[160:163]
    s_waitcnt lgkmcnt(2)
    v_exp_f32 v17, v105
    v_cvt_pk_bf16_f32 v73, v18, v19
    v_mfma_f32_16x16x32_bf16 a[116:119], v[160:163], v[40:43], 0
    ds_read_b128 v[32:35], v1 offset:7168
    v_mfma_f32_16x16x32_bf16 a[116:119], v[168:171], v[44:47], a[116:119]
    buffer_load_dwordx4 v[232:235], v9, s[64:67], s34 offen offset:0 nt
    v_mfma_f32_16x16x32_bf16 a[164:167], v[164:167], v[40:43], 0
    ds_read_b128 v[36:39], v1 offset:19456
    v_mfma_f32_16x16x32_bf16 a[164:167], v[172:175], v[44:47], a[164:167]
    s_waitcnt lgkmcnt(2)
    v_exp_f32 v18, v106
    v_add_f32 v7, v7, v16
    v_mfma_f32_16x16x32_bf16 a[120:123], v[160:163], v[24:27], 0
    ds_read_b128 v[40:43], v1 offset:8192
    v_add_f32 v7, v7, v17
    v_mfma_f32_16x16x32_bf16 a[120:123], v[168:171], v[28:31], a[120:123]
    s_waitcnt vmcnt(14)
    buffer_load_dwordx4 v[236:239], v9, s[64:67], s34 offen offset:1536 nt
    v_mfma_f32_16x16x32_bf16 a[168:171], v[164:167], v[24:27], 0
    ds_read_b128 v[44:47], v1 offset:20480
    v_mfma_f32_16x16x32_bf16 a[168:171], v[172:175], v[28:31], a[168:171]
    s_waitcnt lgkmcnt(2)
    v_exp_f32 v19, v107
    v_cvt_pk_bf16_f32 v74, v16, v17
    v_mfma_f32_16x16x32_bf16 a[124:127], v[160:163], v[32:35], 0
    ds_read_b128 v[24:27], v1 offset:9216
    v_mfma_f32_16x16x32_bf16 a[124:127], v[168:171], v[36:39], a[124:127]
    v_exp_f32 v16, v76
    v_add_f32 v7, v7, v18
    v_mfma_f32_16x16x32_bf16 a[172:175], v[164:167], v[32:35], 0
    s_waitcnt vmcnt(19)
    ds_read_b128 v[28:31], v1 offset:21504
    v_add_f32 v7, v7, v19
    v_mfma_f32_16x16x32_bf16 a[172:175], v[172:175], v[36:39], a[172:175]
    s_waitcnt lgkmcnt(2)
    v_exp_f32 v17, v77
    v_cvt_pk_bf16_f32 v75, v18, v19
    v_mfma_f32_16x16x32_bf16 a[128:131], v[160:163], v[40:43], 0
    s_add_u32 s29, s28, 49152
    ds_read_b128 v[32:35], v1 offset:10240
    v_lshlrev_b32 v48, 16, v60
    v_mfma_f32_16x16x32_bf16 a[128:131], v[168:171], v[44:47], a[128:131]
    v_exp_f32 v18, v78
    v_add_f32 v8, v8, v16
    v_mfma_f32_16x16x32_bf16 a[176:179], v[164:167], v[40:43], 0
    s_sub_u32 s3, s29, 147456
    ds_read_b128 v[36:39], v1 offset:22528
    v_add_f32 v8, v8, v17
    v_mfma_f32_16x16x32_bf16 a[176:179], v[172:175], v[44:47], a[176:179]
    s_waitcnt lgkmcnt(2)
    v_exp_f32 v19, v79
    v_mfma_f32_16x16x32_bf16 a[132:135], v[160:163], v[24:27], 0
    s_min_u32 s29, s29, s3
    ds_read_b128 v[40:43], v1 offset:11264
    v_cvt_pk_bf16_f32 v76, v16, v17
    v_mfma_f32_16x16x32_bf16 a[132:135], v[168:171], v[28:31], a[132:135]
    v_exp_f32 v16, v108
    v_mfma_f32_16x16x32_bf16 a[180:183], v[164:167], v[24:27], 0
    s_sub_u32 s3, s29, s28
    ds_read_b128 v[44:47], v1 offset:23552
    v_and_b32 v49, s97, v60
    v_mfma_f32_16x16x32_bf16 a[180:183], v[172:175], v[28:31], a[180:183]
    s_waitcnt lgkmcnt(2)
    v_add_u32 v1, 49152, v1
    v_add_f32 v8, v8, v18
    v_mfma_f32_16x16x32_bf16 a[136:139], v[160:163], v[32:35], 0
    ds_read_b128 v[24:27], v1 offset:0
    v_add_f32 v8, v8, v19
    v_mfma_f32_16x16x32_bf16 a[136:139], v[168:171], v[36:39], a[136:139]
    v_lshlrev_b32 v50, 16, v62
    v_exp_f32 v17, v109
    v_mfma_f32_16x16x32_bf16 a[184:187], v[164:167], v[32:35], 0
    ds_read_b128 v[28:31], v1 offset:12288
    v_and_b32 v51, s97, v62
    v_mfma_f32_16x16x32_bf16 a[184:187], v[172:175], v[36:39], a[184:187]
    s_waitcnt lgkmcnt(2)
    v_cvt_pk_bf16_f32 v77, v18, v19
    v_mul_f32_e64 v50, -v50, v48
    v_mfma_f32_16x16x32_bf16 a[140:143], v[160:163], v[40:43], 0
    s_mov_b32 s28, s29
    ds_read_b128 v[32:35], v1 offset:1024
    v_bfe_u32 v53, v4, 4, 6
    v_mfma_f32_16x16x32_bf16 a[140:143], v[168:171], v[44:47], a[140:143]
    v_exp_f32 v18, v110
    v_mul_f32_e64 v51, -v51, v49
    v_mfma_f32_16x16x32_bf16 a[188:191], v[164:167], v[40:43], 0
    ds_read_b128 v[36:39], v1 offset:13312
    v_lshlrev_b32 v53, 2, v53
    v_mfma_f32_16x16x32_bf16 a[188:191], v[172:175], v[44:47], a[188:191]
    s_waitcnt lgkmcnt(2)
    s_barrier
    v_add_f32 v8, v8, v16
    v_mfma_f32_16x16x32_bf16 a[96:99], v[176:179], v[24:27], a[96:99]
    ds_read_b128 v[40:43], v1 offset:2048
    buffer_load_dword v52, v53, s[20:23], s44 offen sc1
    v_mfma_f32_16x16x32_bf16 a[96:99], v[184:187], v[28:31], a[96:99]
    v_add_f32 v8, v8, v17
    v_cvt_f32_i32 v240, v240
    v_cvt_f32_i32 v244, v244
    v_mfma_f32_16x16x32_bf16 a[144:147], v[180:183], v[24:27], a[144:147]
    ds_read_b128 v[44:47], v1 offset:14336
    v_fma_f32 v240, v240, v48, v50
    v_mfma_f32_16x16x32_bf16 a[144:147], v[188:191], v[28:31], a[144:147]
    s_waitcnt lgkmcnt(2)
    v_exp_f32 v19, v111
    v_cvt_pk_bf16_f32 v78, v16, v17
    v_mfma_f32_16x16x32_bf16 a[100:103], v[176:179], v[32:35], a[100:103]
    s_mov_b32 m0, s56
    ds_read_b128 v[24:27], v1 offset:3072
    v_add_f32 v8, v8, v18
    v_mfma_f32_16x16x32_bf16 a[100:103], v[184:187], v[36:39], a[100:103]
    s_waitcnt vmcnt(15)
    buffer_load_dwordx4 v4, s[4:7], s27 offen offset:0 sc1 lds
    v_add_f32 v8, v8, v19
    v_mfma_f32_16x16x32_bf16 a[148:151], v[180:183], v[32:35], a[148:151]
    ds_read_b128 v[28:31], v1 offset:15360
    v_fma_f32 v244, v244, v49, v51
    v_mfma_f32_16x16x32_bf16 a[148:151], v[188:191], v[36:39], a[148:151]
    s_waitcnt lgkmcnt(2)
    v_cvt_pk_bf16_f32 v79, v18, v19
    v_cvt_f32_i32 v241, v241
    v_cvt_f32_i32 v245, v245
    v_mfma_f32_16x16x32_bf16 a[104:107], v[176:179], v[40:43], a[104:107]
    ds_read_b128 v[32:35], v1 offset:4096
    v_fma_f32 v241, v241, v48, v50
    v_mfma_f32_16x16x32_bf16 a[104:107], v[184:187], v[44:47], a[104:107]
    s_waitcnt vmcnt(14)
    buffer_load_dwordx4 v4, s[4:7], s27 offen offset:1024 sc1 lds
    v_fma_f32 v245, v245, v49, v51
    v_mfma_f32_16x16x32_bf16 a[152:155], v[180:183], v[40:43], a[152:155]
    ds_read_b128 v[36:39], v1 offset:16384
    v_cvt_f32_i32 v242, v242
    v_mfma_f32_16x16x32_bf16 a[152:155], v[188:191], v[44:47], a[152:155]
    s_waitcnt lgkmcnt(2)
    v_exp_f32 v16, v80
    v_cvt_f32_i32 v246, v246
    v_mfma_f32_16x16x32_bf16 a[108:111], v[176:179], v[24:27], a[108:111]
    ds_read_b128 v[40:43], v1 offset:5120
    v_fma_f32 v242, v242, v48, v50
    v_mfma_f32_16x16x32_bf16 a[108:111], v[184:187], v[28:31], a[108:111]
    s_waitcnt vmcnt(14)
    buffer_load_dwordx4 v4, s[4:7], s27 offen offset:2048 sc1 lds
    v_fma_f32 v246, v246, v49, v51
    v_mfma_f32_16x16x32_bf16 a[156:159], v[180:183], v[24:27], a[156:159]
    s_add_u32 s27, s27, 24576
    ds_read_b128 v[44:47], v1 offset:17408
    v_cvt_f32_i32 v243, v243
    v_mfma_f32_16x16x32_bf16 a[156:159], v[188:191], v[28:31], a[156:159]
    s_waitcnt lgkmcnt(2)
    v_exp_f32 v17, v81
    v_cvt_f32_i32 v247, v247
    v_mfma_f32_16x16x32_bf16 a[112:115], v[176:179], v[32:35], a[112:115]
    s_sub_u32 s58, s27, 196608
    ds_read_b128 v[24:27], v1 offset:6144
    v_fma_f32 v243, v243, v48, v50
    v_mfma_f32_16x16x32_bf16 a[112:115], v[184:187], v[36:39], a[112:115]
    v_exp_f32 v18, v82
    v_add_f32 v5, v5, v16
    v_mfma_f32_16x16x32_bf16 a[160:163], v[180:183], v[32:35], a[160:163]
    s_min_u32 s27, s27, s58
    ds_read_b128 v[28:31], v1 offset:18432
    v_add_f32 v5, v5, v17
    v_mfma_f32_16x16x32_bf16 a[160:163], v[188:191], v[36:39], a[160:163]
    s_waitcnt lgkmcnt(2)
    v_exp_f32 v19, v83
    v_cvt_pk_bf16_f32 v80, v16, v17
    v_mfma_f32_16x16x32_bf16 a[116:119], v[176:179], v[40:43], a[116:119]
    s_add_u32 s56, s56, 12288
    ds_read_b128 v[32:35], v1 offset:7168
    v_fma_f32 v247, v247, v49, v51
    v_mfma_f32_16x16x32_bf16 a[116:119], v[184:187], v[44:47], a[116:119]
    v_exp_f32 v16, v112
    v_add_f32 v5, v5, v18
    v_mfma_f32_16x16x32_bf16 a[164:167], v[180:183], v[40:43], a[164:167]
    ds_read_b128 v[36:39], v1 offset:19456
    v_add_u32 v2, s3, v2
    v_add_u32 v3, s3, v3
    v_mfma_f32_16x16x32_bf16 a[164:167], v[188:191], v[44:47], a[164:167]
    s_waitcnt lgkmcnt(2)
    v_add_f32 v5, v5, v19
    v_exp_f32 v17, v113
    v_mfma_f32_16x16x32_bf16 a[120:123], v[176:179], v[24:27], a[120:123]
    s_mov_b32 m0, s56
    ds_read_b128 v[40:43], v1 offset:8192
    v_cvt_pk_bf16_f32 v81, v18, v19
    v_mfma_f32_16x16x32_bf16 a[120:123], v[184:187], v[28:31], a[120:123]
    s_waitcnt vmcnt(14)
    buffer_load_dwordx4 v4, s[4:7], s27 offen offset:0 sc1 lds
    v_lshlrev_b32 v48, 16, v61
    v_mfma_f32_16x16x32_bf16 a[168:171], v[180:183], v[24:27], a[168:171]
    ds_read_b128 v[44:47], v1 offset:20480
    v_and_b32 v49, s97, v61
    v_mfma_f32_16x16x32_bf16 a[168:171], v[188:191], v[28:31], a[168:171]
    s_waitcnt lgkmcnt(2)
    v_exp_f32 v18, v114
    v_add_f32 v5, v5, v16
    v_mfma_f32_16x16x32_bf16 a[124:127], v[176:179], v[32:35], a[124:127]
    ds_read_b128 v[24:27], v1 offset:9216
    v_add_f32 v5, v5, v17
    v_mfma_f32_16x16x32_bf16 a[124:127], v[184:187], v[36:39], a[124:127]
    s_waitcnt vmcnt(14)
    buffer_load_dwordx4 v4, s[4:7], s27 offen offset:1024 sc1 lds
    v_lshlrev_b32 v50, 16, v63
    v_mfma_f32_16x16x32_bf16 a[172:175], v[180:183], v[32:35], a[172:175]
    ds_read_b128 v[28:31], v1 offset:21504
    v_and_b32 v51, s97, v63
    v_mfma_f32_16x16x32_bf16 a[172:175], v[188:191], v[36:39], a[172:175]
    s_waitcnt lgkmcnt(2)
    v_exp_f32 v19, v115
    v_cvt_pk_bf16_f32 v82, v16, v17
    v_mfma_f32_16x16x32_bf16 a[128:131], v[176:179], v[40:43], a[128:131]
    ds_read_b128 v[32:35], v1 offset:10240
    v_mul_f32_e64 v50, -v50, v48
    v_mfma_f32_16x16x32_bf16 a[128:131], v[184:187], v[44:47], a[128:131]
    s_waitcnt vmcnt(14)
    buffer_load_dwordx4 v4, s[4:7], s27 offen offset:2048 sc1 lds
    v_mul_f32_e64 v51, -v51, v49
    v_mfma_f32_16x16x32_bf16 a[176:179], v[180:183], v[40:43], a[176:179]
    ds_read_b128 v[36:39], v1 offset:22528
    v_cvt_f32_i32 v248, v248
    v_mfma_f32_16x16x32_bf16 a[176:179], v[188:191], v[44:47], a[176:179]
    s_waitcnt lgkmcnt(2)
    v_exp_f32 v16, v84
    v_add_f32 v5, v5, v18
    v_mfma_f32_16x16x32_bf16 a[132:135], v[176:179], v[24:27], a[132:135]
    ds_read_b128 v[40:43], v1 offset:11264
    v_add_f32 v5, v5, v19
    v_mfma_f32_16x16x32_bf16 a[132:135], v[184:187], v[28:31], a[132:135]
    s_waitcnt vmcnt(19)
    v_exp_f32 v17, v85
    v_cvt_f32_i32 v252, v252
    v_mfma_f32_16x16x32_bf16 a[180:183], v[180:183], v[24:27], a[180:183]
    s_mov_b32 s27, 208896
    ds_read_b128 v[44:47], v1 offset:23552
    v_cvt_pk_bf16_f32 v83, v18, v19
    v_mfma_f32_16x16x32_bf16 a[180:183], v[188:191], v[28:31], a[180:183]
    s_waitcnt lgkmcnt(2)
    s_barrier
    v_fma_f32 v248, v248, v48, v50
    v_mfma_f32_16x16x32_bf16 a[136:139], v[176:179], v[32:35], a[136:139]
    s_add_u32 s56, s56, 36864
    ds_read_b128 v[24:27], v2 offset:0
    v_fma_f32 v252, v252, v49, v51
    v_mfma_f32_16x16x32_bf16 a[136:139], v[184:187], v[36:39], a[136:139]
    v_exp_f32 v18, v86
    v_add_f32 v6, v6, v16
    v_mfma_f32_16x16x32_bf16 a[184:187], v[180:183], v[32:35], a[184:187]
    s_sub_u32 s58, s56, 147456
    ds_read_b128 v[28:31], v3 offset:0
    v_cvt_f32_i32 v249, v249
    v_mfma_f32_16x16x32_bf16 a[184:187], v[188:191], v[36:39], a[184:187]
    s_waitcnt lgkmcnt(2)
    v_add_f32 v6, v6, v17
    v_cvt_f32_i32 v253, v253
    v_fma_f32 v249, v249, v48, v50
    v_mfma_f32_16x16x32_bf16 a[140:143], v[176:179], v[40:43], a[140:143]
    s_nop 0
    ds_read_b128 v[32:35], v2 offset:6144
    v_fma_f32 v253, v253, v49, v51
    v_mfma_f32_16x16x32_bf16 a[140:143], v[184:187], v[44:47], a[140:143]
    s_min_u32 s56, s56, s58
    v_exp_f32 v19, v87
    v_cvt_pk_bf16_f32 v84, v16, v17
    v_mfma_f32_16x16x32_bf16 a[188:191], v[180:183], v[40:43], a[188:191]
    s_waitcnt lgkmcnt(1)
    ds_read_b128 v[36:39], v3 offset:6144
    v_exp_f32 v16, v116
    v_cvt_f32_i32 v250, v250
    v_add_f32 v6, v6, v18
    v_cvt_f32_i32 v254, v254
    v_add_f32 v6, v6, v19
    v_fma_f32 v250, v250, v48, v50
    v_exp_f32 v17, v117
    v_fma_f32 v254, v254, v49, v51
    v_cvt_f32_i32 v251, v251
    v_cvt_pk_bf16_f32 v85, v18, v19
    v_cvt_f32_i32 v255, v255
    v_exp_f32 v18, v118
    v_fma_f32 v251, v251, v48, v50
    v_fma_f32 v255, v255, v49, v51
    v_add_f32 v6, v6, v16
    v_cvt_pk_bf16_f32 v146, v240, v244
    v_add_f32 v6, v6, v17
    v_cvt_pk_bf16_f32 v150, v241, v245
    v_exp_f32 v19, v119
    v_cvt_pk_bf16_f32 v147, v248, v252
    v_cvt_pk_bf16_f32 v151, v249, v253
    v_cvt_pk_bf16_f32 v86, v16, v17
    v_cvt_pk_bf16_f32 v154, v242, v246
    v_add_f32 v6, v6, v18
    v_cvt_pk_bf16_f32 v155, v250, v254
    v_add_f32 v6, v6, v19
    v_cvt_pk_bf16_f32 v158, v243, v247
    v_cvt_pk_bf16_f32 v87, v18, v19
    v_cvt_pk_bf16_f32 v159, v251, v255
    v_mfma_f32_16x16x32_bf16 a[188:191], v[188:191], v[44:47], a[188:191]
    s_branch L_join
.p2align 6
L_loop:
    v_mfma_f32_16x16x32_bf16 v[160:163], v[24:27], a[192:195], v[128:131]
    s_mov_b32 m0, s56
    ds_read_b128 v[40:43], v2 offset:128
    v_fma_f32 v250, v250, v48, v50
    v_mfma_f32_16x16x32_bf16 v[160:163], v[28:31], a[196:199], v[160:163]
    buffer_load_dwordx4 v4, s[4:7], s27 offen offset:0 sc1 lds
    v_mfma_f32_16x16x32_bf16 v[164:167], v[24:27], a[216:219], v[132:135]
    v_exp_f32 v16, v88
    v_mfma_f32_16x16x32_bf16 v[164:167], v[28:31], a[220:223], v[164:167]
    v_exp_f32 v17, v89
    v_mfma_f32_16x16x32_bf16 v[168:171], v[24:27], a[240:243], v[136:139]
    ds_read_b128 v[44:47], v3 offset:128
    v_fma_f32 v251, v251, v49, v51
    v_mfma_f32_16x16x32_bf16 v[168:171], v[28:31], a[244:247], v[168:171]
    v_exp_f32 v18, v90
    v_mfma_f32_16x16x32_bf16 v[172:175], v[24:27], v[200:203], v[140:143]
    v_add_f32 v7, v7, v16
    v_add_f32 v7, v7, v17
    v_mfma_f32_16x16x32_bf16 v[172:175], v[28:31], v[204:207], v[172:175]
    s_waitcnt lgkmcnt(2)
    v_exp_f32 v19, v91
    v_mfma_f32_16x16x32_bf16 v[96:99], v[32:35], a[192:195], v[128:131]
    ds_read_b128 v[24:27], v2 offset:6272
    v_cvt_pk_bf16_f32 v235, v250, v251
    v_mfma_f32_16x16x32_bf16 v[96:99], v[36:39], a[196:199], v[96:99]
    buffer_load_dwordx4 v4, s[4:7], s27 offen offset:1024 sc1 lds
    v_mfma_f32_16x16x32_bf16 v[100:103], v[32:35], a[216:219], v[132:135]
    v_cvt_pk_bf16_f32 v88, v16, v17
    v_cvt_f32_i32 v254, v254
    v_mfma_f32_16x16x32_bf16 v[100:103], v[36:39], a[220:223], v[100:103]
    v_exp_f32 v16, v120
    v_mfma_f32_16x16x32_bf16 v[104:107], v[32:35], a[240:243], v[136:139]
    ds_read_b128 v[28:31], v3 offset:6272
    v_add_f32 v7, v7, v18
    v_mfma_f32_16x16x32_bf16 v[104:107], v[36:39], a[244:247], v[104:107]
    v_add_f32 v7, v7, v19
    v_cvt_f32_i32 v255, v255
    v_mfma_f32_16x16x32_bf16 v[108:111], v[32:35], v[200:203], v[140:143]
    v_exp_f32 v17, v121
    v_mfma_f32_16x16x32_bf16 v[108:111], v[36:39], v[204:207], v[108:111]
    s_waitcnt lgkmcnt(2)
    v_cvt_pk_bf16_f32 v89, v18, v19
    v_fma_f32 v254, v254, v48, v50
    v_mfma_f32_16x16x32_bf16 v[160:163], v[40:43], a[200:203], v[160:163]
    ds_read_b128 v[32:35], v2 offset:256
    v_mfma_f32_16x16x32_bf16 v[160:163], v[44:47], a[204:207], v[160:163]
    v_exp_f32 v18, v122
    v_mfma_f32_16x16x32_bf16 v[164:167], v[40:43], a[224:227], v[164:167]
    v_add_f32 v7, v7, v16
    v_add_f32 v7, v7, v17
    v_mfma_f32_16x16x32_bf16 v[164:167], v[44:47], a[228:231], v[164:167]
    buffer_load_dwordx4 v4, s[4:7], s27 offen offset:2048 sc1 lds
    v_mfma_f32_16x16x32_bf16 v[168:171], v[40:43], a[248:251], v[168:171]
    ds_read_b128 v[36:39], v3 offset:256
    v_fma_f32 v255, v255, v49, v51
    v_mfma_f32_16x16x32_bf16 v[168:171], v[44:47], a[252:255], v[168:171]
    v_exp_f32 v19, v123
    v_mfma_f32_16x16x32_bf16 v[172:175], v[40:43], v[208:211], v[172:175]
    v_cvt_pk_bf16_f32 v90, v16, v17
    v_cvt_pk_bf16_f32 v239, v254, v255
    v_mfma_f32_16x16x32_bf16 v[172:175], v[44:47], v[212:215], v[172:175]
    s_waitcnt lgkmcnt(2)
    v_exp_f32 v16, v92
    v_mfma_f32_16x16x32_bf16 v[96:99], v[24:27], a[200:203], v[96:99]
    ds_read_b128 v[40:43], v2 offset:6400
    v_add_f32 v7, v7, v18
    v_mfma_f32_16x16x32_bf16 v[96:99], v[28:31], a[204:207], v[96:99]
    s_add_u32 s27, s27, 24576
    v_add_f32 v7, v7, v19
    v_mfma_f32_16x16x32_bf16 v[100:103], v[24:27], a[224:227], v[100:103]
    v_exp_f32 v17, v93
    v_mfma_f32_16x16x32_bf16 v[100:103], v[28:31], a[228:231], v[100:103]
    v_cvt_pk_bf16_f32 v91, v18, v19
    v_mfma_f32_16x16x32_bf16 v[104:107], v[24:27], a[248:251], v[104:107]
    ds_read_b128 v[44:47], v3 offset:6400
    v_mfma_f32_16x16x32_bf16 v[104:107], v[28:31], a[252:255], v[104:107]
    v_exp_f32 v18, v94
    v_mfma_f32_16x16x32_bf16 v[108:111], v[24:27], v[208:211], v[108:111]
    s_add_u32 s29, s30, 49152
    v_add_f32 v8, v8, v16
    v_add_f32 v8, v8, v17
    v_mfma_f32_16x16x32_bf16 v[108:111], v[28:31], v[212:215], v[108:111]
    s_waitcnt lgkmcnt(2)
    v_exp_f32 v19, v95
    v_mfma_f32_16x16x32_bf16 v[160:163], v[32:35], a[208:211], v[160:163]
    s_waitcnt vmcnt(11)
    ds_read_b128 v[24:27], v2 offset:12288
    v_cvt_pk_bf16_f32 v92, v16, v17
    v_mfma_f32_16x16x32_bf16 v[160:163], v[36:39], a[212:215], v[160:163]
    s_sub_u32 s3, s29, 147456
    buffer_load_dwordx2 v[60:61], off, s[80:83], s37 offset:8
    v_mfma_f32_16x16x32_bf16 v[164:167], v[32:35], a[232:235], v[164:167]
    s_add_u32 s56, s56, 12288
    v_exp_f32 v16, v124
    v_mfma_f32_16x16x32_bf16 v[164:167], v[36:39], a[236:239], v[164:167]
    s_min_u32 s29, s29, s3
    v_add_f32 v8, v8, v18
    v_lshlrev_b32 v48, 16, v56
    v_mfma_f32_16x16x32_bf16 v[168:171], v[32:35], v[192:195], v[168:171]
    s_mov_b32 m0, s56
    ds_read_b128 v[28:31], v3 offset:12288
    v_add_f32 v8, v8, v19
    v_mfma_f32_16x16x32_bf16 v[168:171], v[36:39], v[196:199], v[168:171]
    buffer_load_dwordx2 v[62:63], off, s[84:87], s37 offset:8
    v_mfma_f32_16x16x32_bf16 v[172:175], v[32:35], v[216:219], v[172:175]
    v_exp_f32 v17, v125
    v_mfma_f32_16x16x32_bf16 v[172:175], v[36:39], v[220:223], v[172:175]
    s_waitcnt lgkmcnt(2)
    v_cvt_pk_bf16_f32 v93, v18, v19
    v_and_b32 v49, s97, v56
    v_mfma_f32_16x16x32_bf16 v[96:99], v[40:43], a[208:211], v[96:99]
    ds_read_b128 v[32:35], v2 offset:18432
    v_lshlrev_b32 v50, 16, v58
    v_mfma_f32_16x16x32_bf16 v[96:99], v[44:47], a[212:215], v[96:99]
    s_sub_u32 s3, s29, s30
    v_exp_f32 v18, v126
    v_mfma_f32_16x16x32_bf16 v[100:103], v[40:43], a[232:235], v[100:103]
    v_add_f32 v8, v8, v16
    v_add_f32 v8, v8, v17
    v_mfma_f32_16x16x32_bf16 v[100:103], v[44:47], a[236:239], v[100:103]
    buffer_load_dwordx4 v4, s[4:7], s27 offen offset:0 sc1 lds
    v_mfma_f32_16x16x32_bf16 v[104:107], v[40:43], v[192:195], v[104:107]
    ds_read_b128 v[36:39], v3 offset:18432
    v_and_b32 v51, s97, v58
    v_mfma_f32_16x16x32_bf16 v[104:107], v[44:47], v[196:199], v[104:107]
    v_exp_f32 v19, v127
    v_mfma_f32_16x16x32_bf16 v[108:111], v[40:43], v[216:219], v[108:111]
    v_cvt_pk_bf16_f32 v94, v16, v17
    v_add_f32 v8, v8, v18
    v_mfma_f32_16x16x32_bf16 v[108:111], v[44:47], v[220:223], v[108:111]
    s_waitcnt lgkmcnt(2)
    buffer_load_dwordx4 v[240:243], v12, s[68:71], s16 offen offset:0 nt
    v_mfma_f32_16x16x32_bf16 v[176:179], v[24:27], a[192:195], v[128:131]
    ds_read_b128 v[40:43], v2 offset:12416
    v_add_f32 v8, v8, v19
    v_mfma_f32_16x16x32_bf16 v[176:179], v[28:31], a[196:199], v[176:179]
    s_mov_b32 s30, s29
    v_cvt_pk_bf16_f32 v95, v18, v19
    v_mul_f32_e64 v50, -v50, v48
    v_mfma_f32_16x16x32_bf16 v[180:183], v[24:27], a[216:219], v[132:135]
    v_exp_f32 v16, v160
    v_mfma_f32_16x16x32_bf16 v[180:183], v[28:31], a[220:223], v[180:183]
    buffer_load_dwordx4 v4, s[4:7], s27 offen offset:1024 sc1 lds
    v_mfma_f32_16x16x32_bf16 v[184:187], v[24:27], a[240:243], v[136:139]
    ds_read_b128 v[44:47], v3 offset:12416
    v_mul_f32_e64 v51, -v51, v49
    v_mfma_f32_16x16x32_bf16 v[184:187], v[28:31], a[244:247], v[184:187]
    v_exp_f32 v17, v161
    v_mfma_f32_16x16x32_bf16 v[188:191], v[24:27], v[200:203], v[140:143]
    v_exp_f32 v18, v162
    v_mfma_f32_16x16x32_bf16 v[188:191], v[28:31], v[204:207], v[188:191]
    s_waitcnt lgkmcnt(2)
    buffer_load_dwordx4 v[244:247], v12, s[68:71], s16 offen offset:768 nt
    v_mfma_f32_16x16x32_bf16 v[112:115], v[32:35], a[192:195], v[128:131]
    ds_read_b128 v[24:27], v2 offset:18560
    v_add_f32 v5, v5, v16
    v_mfma_f32_16x16x32_bf16 v[112:115], v[36:39], a[196:199], v[112:115]
    v_add_f32 v5, v5, v17
    v_cvt_f32_i32 v144, v144
    v_mfma_f32_16x16x32_bf16 v[116:119], v[32:35], a[216:219], v[132:135]
    v_exp_f32 v19, v163
    v_mfma_f32_16x16x32_bf16 v[116:119], v[36:39], a[220:223], v[116:119]
    v_cvt_pk_bf16_f32 v160, v16, v17
    v_cvt_f32_i32 v148, v148
    v_mfma_f32_16x16x32_bf16 v[120:123], v[32:35], a[240:243], v[136:139]
    ds_read_b128 v[28:31], v3 offset:18560
    v_fma_f32 v144, v144, v48, v50
    v_mfma_f32_16x16x32_bf16 v[120:123], v[36:39], a[244:247], v[120:123]
    buffer_load_dwordx4 v[248:251], v12, s[68:71], s16 offen offset:1536 nt
    v_mfma_f32_16x16x32_bf16 v[124:127], v[32:35], v[200:203], v[140:143]
    v_exp_f32 v16, v96
    v_mfma_f32_16x16x32_bf16 v[124:127], v[36:39], v[204:207], v[124:127]
    s_waitcnt lgkmcnt(2)
    v_add_f32 v5, v5, v18
    v_add_f32 v5, v5, v19
    v_mfma_f32_16x16x32_bf16 v[176:179], v[40:43], a[200:203], v[176:179]
    ds_read_b128 v[32:35], v2 offset:12544
    v_fma_f32 v148, v148, v49, v51
    v_mfma_f32_16x16x32_bf16 v[176:179], v[44:47], a[204:207], v[176:179]
    buffer_load_dwordx4 v4, s[4:7], s27 offen offset:2048 sc1 lds
    v_mfma_f32_16x16x32_bf16 v[180:183], v[40:43], a[224:227], v[180:183]
    v_exp_f32 v17, v97
    v_mfma_f32_16x16x32_bf16 v[180:183], v[44:47], a[228:231], v[180:183]
    v_cvt_pk_bf16_f32 v161, v18, v19
    v_cvt_f32_i32 v145, v145
    v_mfma_f32_16x16x32_bf16 v[184:187], v[40:43], a[248:251], v[184:187]
    ds_read_b128 v[36:39], v3 offset:12544
    v_add_u32 v1, s3, v1
    v_mfma_f32_16x16x32_bf16 v[184:187], v[44:47], a[252:255], v[184:187]
    buffer_load_dwordx4 v[252:255], v12, s[68:71], s16 offen offset:2304 nt
    v_mfma_f32_16x16x32_bf16 v[188:191], v[40:43], v[208:211], v[188:191]
    v_exp_f32 v18, v98
    v_mfma_f32_16x16x32_bf16 v[188:191], v[44:47], v[212:215], v[188:191]
    s_waitcnt lgkmcnt(2)
    v_add_f32 v5, v5, v16
    v_add_f32 v5, v5, v17
    v_mfma_f32_16x16x32_bf16 v[112:115], v[24:27], a[200:203], v[112:115]
    ds_read_b128 v[40:43], v2 offset:18688
    v_cvt_f32_i32 v149, v149
    v_mfma_f32_16x16x32_bf16 v[112:115], v[28:31], a[204:207], v[112:115]
    v_exp_f32 v19, v99
    v_cvt_pk_bf16_f32 v162, v16, v17
    v_mfma_f32_16x16x32_bf16 v[116:119], v[24:27], a[224:227], v[116:119]
    v_exp_f32 v16, v164
    v_mfma_f32_16x16x32_bf16 v[116:119], v[28:31], a[228:231], v[116:119]
    s_add_u32 s27, s27, 24576
    v_add_f32 v5, v5, v18
    v_add_f32 v5, v5, v19
    v_mfma_f32_16x16x32_bf16 v[120:123], v[24:27], a[248:251], v[120:123]
    s_add_u32 s56, s56, 36864
    ds_read_b128 v[44:47], v3 offset:18688
    v_fma_f32 v145, v145, v48, v50
    v_mfma_f32_16x16x32_bf16 v[120:123], v[28:31], a[252:255], v[120:123]
    s_waitcnt lgkmcnt(2)
    v_exp_f32 v17, v165
    v_mfma_f32_16x16x32_bf16 v[124:127], v[24:27], v[208:211], v[124:127]
    s_waitcnt vmcnt(12)
    v_cvt_pk_bf16_f32 v163, v18, v19
    v_fma_f32 v149, v149, v49, v51
    v_mfma_f32_16x16x32_bf16 v[124:127], v[28:31], v[212:215], v[124:127]
    s_barrier
    s_sub_u32 s58, s56, 147456
    v_mfma_f32_16x16x32_bf16 v[176:179], v[32:35], a[208:211], v[176:179]
    s_min_u32 s56, s56, s58
    ds_read_b128 v[24:27], v1 offset:0
    v_cvt_f32_i32 v146, v146
    v_mfma_f32_16x16x32_bf16 v[176:179], v[36:39], a[212:215], v[176:179]
    v_exp_f32 v18, v166
    v_mfma_f32_16x16x32_bf16 v[180:183], v[32:35], a[232:235], v[180:183]
    v_add_f32 v6, v6, v16
    v_add_f32 v6, v6, v17
    v_mfma_f32_16x16x32_bf16 v[180:183], v[36:39], a[236:239], v[180:183]
    v_exp_f32 v19, v167
    v_mfma_f32_16x16x32_bf16 v[184:187], v[32:35], v[192:195], v[184:187]
    ds_read_b128 v[28:31], v1 offset:12288
    v_cvt_pk_bf16_f32 v164, v16, v17
    v_mfma_f32_16x16x32_bf16 v[184:187], v[36:39], v[196:199], v[184:187]
    v_exp_f32 v16, v100
    v_mfma_f32_16x16x32_bf16 v[188:191], v[32:35], v[216:219], v[188:191]
    v_add_f32 v6, v6, v18
    v_add_f32 v6, v6, v19
    v_mfma_f32_16x16x32_bf16 v[188:191], v[36:39], v[220:223], v[188:191]
    s_waitcnt lgkmcnt(2)
    v_exp_f32 v17, v101
    v_mfma_f32_16x16x32_bf16 v[112:115], v[40:43], a[208:211], v[112:115]
    ds_read_b128 v[32:35], v1 offset:1024
    v_cvt_pk_bf16_f32 v165, v18, v19
    v_mfma_f32_16x16x32_bf16 v[112:115], v[44:47], a[212:215], v[112:115]
    v_exp_f32 v18, v102
    v_mfma_f32_16x16x32_bf16 v[116:119], v[40:43], a[232:235], v[116:119]
    v_add_f32 v6, v6, v16
    v_cvt_f32_i32 v150, v150
    v_mfma_f32_16x16x32_bf16 v[116:119], v[44:47], a[236:239], v[116:119]
    v_add_f32 v6, v6, v17
    v_fma_f32 v146, v146, v48, v50
    v_mfma_f32_16x16x32_bf16 v[120:123], v[40:43], v[192:195], v[120:123]
    ds_read_b128 v[36:39], v1 offset:13312
    v_fma_f32 v150, v150, v49, v51
    v_mfma_f32_16x16x32_bf16 v[120:123], v[44:47], v[196:199], v[120:123]
    v_exp_f32 v19, v103
    v_mfma_f32_16x16x32_bf16 v[124:127], v[40:43], v[216:219], v[124:127]
    v_cvt_pk_bf16_f32 v166, v16, v17
    v_add_f32 v6, v6, v18
    v_mfma_f32_16x16x32_bf16 v[124:127], v[44:47], v[220:223], v[124:127]
    s_waitcnt lgkmcnt(2)
    v_add_f32 v6, v6, v19
    v_cvt_pk_bf16_f32 v167, v18, v19
    v_mfma_f32_16x16x32_bf16 a[0:3], v[64:67], v[24:27], a[0:3]
    ds_read_b128 v[40:43], v1 offset:2048
    v_cvt_f32_i32 v147, v147
    v_mfma_f32_16x16x32_bf16 a[0:3], v[80:83], v[28:31], a[0:3]
    buffer_store_dwordx4 v[224:227], v11, s[4:7], s33 offen offset:0 sc1
    v_mfma_f32_16x16x32_bf16 a[48:51], v[68:71], v[24:27], a[48:51]
    v_exp_f32 v16, v168
    v_mfma_f32_16x16x32_bf16 a[48:51], v[84:87], v[28:31], a[48:51]
    v_exp_f32 v17, v169
    v_mfma_f32_16x16x32_bf16 a[96:99], v[72:75], v[24:27], a[96:99]
    ds_read_b128 v[44:47], v1 offset:14336
    v_xor_b32 v55, 16, v11
    v_mfma_f32_16x16x32_bf16 a[96:99], v[88:91], v[28:31], a[96:99]
    v_exp_f32 v18, v170
    v_mfma_f32_16x16x32_bf16 a[144:147], v[76:79], v[24:27], a[144:147]
    v_add_f32 v7, v7, v16
    v_add_f32 v7, v7, v17
    v_mfma_f32_16x16x32_bf16 a[144:147], v[92:95], v[28:31], a[144:147]
    s_waitcnt lgkmcnt(2)
    v_exp_f32 v19, v171
    v_mfma_f32_16x16x32_bf16 a[4:7], v[64:67], v[32:35], a[4:7]
    ds_read_b128 v[24:27], v1 offset:3072
    v_cvt_f32_i32 v151, v151
    v_mfma_f32_16x16x32_bf16 a[4:7], v[80:83], v[36:39], a[4:7]
    buffer_store_dwordx4 v[228:231], v55, s[4:7], s33 offen offset:768 sc1
    v_mfma_f32_16x16x32_bf16 a[52:55], v[68:71], v[32:35], a[52:55]
    v_cvt_pk_bf16_f32 v168, v16, v17
    v_fma_f32 v147, v147, v48, v50
    v_mfma_f32_16x16x32_bf16 a[52:55], v[84:87], v[36:39], a[52:55]
    v_exp_f32 v16, v104
    v_mfma_f32_16x16x32_bf16 a[100:103], v[72:75], v[32:35], a[100:103]
    ds_read_b128 v[28:31], v1 offset:15360
    v_add_f32 v7, v7, v18
    v_mfma_f32_16x16x32_bf16 a[100:103], v[88:91], v[36:39], a[100:103]
    v_add_f32 v7, v7, v19
    v_xor_b32 v54, 32, v11
    v_mfma_f32_16x16x32_bf16 a[148:151], v[76:79], v[32:35], a[148:151]
    v_exp_f32 v17, v105
    v_mfma_f32_16x16x32_bf16 a[148:151], v[92:95], v[36:39], a[148:151]
    s_waitcnt lgkmcnt(2)
    v_cvt_pk_bf16_f32 v169, v18, v19
    v_fma_f32 v151, v151, v49, v51
    v_mfma_f32_16x16x32_bf16 a[8:11], v[64:67], v[40:43], a[8:11]
    ds_read_b128 v[32:35], v1 offset:4096
    v_lshlrev_b32 v48, 16, v57
    v_mfma_f32_16x16x32_bf16 a[8:11], v[80:83], v[44:47], a[8:11]
    buffer_store_dwordx4 v[232:235], v54, s[4:7], s33 offen offset:1536 sc1
    v_mfma_f32_16x16x32_bf16 a[56:59], v[68:71], v[40:43], a[56:59]
    v_exp_f32 v18, v106
    v_mfma_f32_16x16x32_bf16 a[56:59], v[84:87], v[44:47], a[56:59]
    v_add_f32 v7, v7, v16
    v_add_f32 v7, v7, v17
    v_mfma_f32_16x16x32_bf16 a[104:107], v[72:75], v[40:43], a[104:107]
    ds_read_b128 v[36:39], v1 offset:16384
    v_xor_b32 v55, 48, v11
    v_mfma_f32_16x16x32_bf16 a[104:107], v[88:91], v[44:47], a[104:107]
    v_exp_f32 v19, v107
    v_mfma_f32_16x16x32_bf16 a[152:155], v[76:79], v[40:43], a[152:155]
    v_cvt_pk_bf16_f32 v170, v16, v17
    v_and_b32 v49, s97, v57
    v_mfma_f32_16x16x32_bf16 a[152:155], v[92:95], v[44:47], a[152:155]
    s_waitcnt lgkmcnt(2)
    v_exp_f32 v16, v172
    v_mfma_f32_16x16x32_bf16 a[12:15], v[64:67], v[24:27], a[12:15]
    ds_read_b128 v[40:43], v1 offset:5120
    v_add_f32 v7, v7, v18
    v_mfma_f32_16x16x32_bf16 a[12:15], v[80:83], v[28:31], a[12:15]
    buffer_store_dwordx4 v[236:239], v55, s[4:7], s33 offen offset:2304 sc1
    v_mfma_f32_16x16x32_bf16 a[60:63], v[68:71], v[24:27], a[60:63]
    v_add_f32 v7, v7, v19
    v_lshlrev_b32 v50, 16, v59
    v_mfma_f32_16x16x32_bf16 a[60:63], v[84:87], v[28:31], a[60:63]
    v_exp_f32 v17, v173
    v_mfma_f32_16x16x32_bf16 a[108:111], v[72:75], v[24:27], a[108:111]
    ds_read_b128 v[44:47], v1 offset:17408
    v_cvt_pk_bf16_f32 v171, v18, v19
    v_mfma_f32_16x16x32_bf16 a[108:111], v[88:91], v[28:31], a[108:111]
    v_exp_f32 v18, v174
    v_mfma_f32_16x16x32_bf16 a[156:159], v[76:79], v[24:27], a[156:159]
    s_add_u32 s29, s28, 49152
    v_add_f32 v8, v8, v16
    v_add_f32 v8, v8, v17
    v_mfma_f32_16x16x32_bf16 a[156:159], v[92:95], v[28:31], a[156:159]
    s_waitcnt lgkmcnt(2)
    v_exp_f32 v19, v175
    v_mfma_f32_16x16x32_bf16 a[16:19], v[64:67], v[32:35], a[16:19]
    s_sub_u32 s3, s29, 147456
    ds_read_b128 v[24:27], v1 offset:6144
    v_cvt_pk_bf16_f32 v172, v16, v17
    v_mfma_f32_16x16x32_bf16 a[16:19], v[80:83], v[36:39], a[16:19]
    s_mov_b32 m0, s26
    v_exp_f32 v16, v108
    v_mfma_f32_16x16x32_bf16 a[64:67], v[68:71], v[32:35], a[64:67]
    s_min_u32 s29, s29, s3
    v_and_b32 v51, s97, v59
    v_add_f32 v8, v8, v18
    v_mfma_f32_16x16x32_bf16 a[64:67], v[84:87], v[36:39], a[64:67]
    buffer_load_dwordx4 v4, s[4:7], s32 offen offset:0 sc1 lds
    v_mfma_f32_16x16x32_bf16 a[112:115], v[72:75], v[32:35], a[112:115]
    ds_read_b128 v[28:31], v1 offset:18432
    v_add_f32 v8, v8, v19
    v_mfma_f32_16x16x32_bf16 a[112:115], v[88:91], v[36:39], a[112:115]
    v_exp_f32 v17, v109
    v_mfma_f32_16x16x32_bf16 a[160:163], v[76:79], v[32:35], a[160:163]
    v_cvt_pk_bf16_f32 v173, v18, v19
    v_mul_f32_e64 v50, -v50, v48
    v_mfma_f32_16x16x32_bf16 a[160:163], v[92:95], v[36:39], a[160:163]
    s_waitcnt lgkmcnt(2)
    buffer_load_dwordx4 v4, s[4:7], s32 offen offset:1024 sc1 lds
    v_mfma_f32_16x16x32_bf16 a[20:23], v[64:67], v[40:43], a[20:23]
    s_sub_u32 s3, s29, s28
    ds_read_b128 v[32:35], v1 offset:7168
    v_mul_f32_e64 v51, -v51, v49
    v_mfma_f32_16x16x32_bf16 a[20:23], v[80:83], v[44:47], a[20:23]
    v_exp_f32 v18, v110
    v_mfma_f32_16x16x32_bf16 a[68:71], v[68:71], v[40:43], a[68:71]
    v_add_f32 v8, v8, v16
    v_add_f32 v8, v8, v17
    v_mfma_f32_16x16x32_bf16 a[68:71], v[84:87], v[44:47], a[68:71]
    buffer_load_dwordx4 v4, s[4:7], s32 offen offset:2048 sc1 lds
    v_mfma_f32_16x16x32_bf16 a[116:119], v[72:75], v[40:43], a[116:119]
    ds_read_b128 v[36:39], v1 offset:19456
    v_cvt_f32_i32 v152, v152
    v_mfma_f32_16x16x32_bf16 a[116:119], v[88:91], v[44:47], a[116:119]
    v_exp_f32 v19, v111
    v_mfma_f32_16x16x32_bf16 a[164:167], v[76:79], v[40:43], a[164:167]
    s_mov_b32 s28, s29
    v_cvt_pk_bf16_f32 v174, v16, v17
    v_add_f32 v8, v8, v18
    v_mfma_f32_16x16x32_bf16 a[164:167], v[92:95], v[44:47], a[164:167]
    s_waitcnt lgkmcnt(2)
    v_add_f32 v8, v8, v19
    v_cvt_pk_bf16_f32 v175, v18, v19
    v_mfma_f32_16x16x32_bf16 a[24:27], v[64:67], v[24:27], a[24:27]
    s_add_u32 s32, s32, 24576
    ds_read_b128 v[40:43], v1 offset:8192
    v_cvt_f32_i32 v156, v156
    v_mfma_f32_16x16x32_bf16 a[24:27], v[80:83], v[28:31], a[24:27]
    v_exp_f32 v16, v176
    v_mfma_f32_16x16x32_bf16 a[72:75], v[68:71], v[24:27], a[72:75]
    s_add_u32 s26, s26, 12288
    v_exp_f32 v17, v177
    v_mfma_f32_16x16x32_bf16 a[72:75], v[84:87], v[28:31], a[72:75]
    v_exp_f32 v18, v178
    v_mfma_f32_16x16x32_bf16 a[120:123], v[72:75], v[24:27], a[120:123]
    s_mov_b32 m0, s26
    ds_read_b128 v[44:47], v1 offset:20480
    v_add_f32 v5, v5, v16
    v_mfma_f32_16x16x32_bf16 a[120:123], v[88:91], v[28:31], a[120:123]
    v_add_f32 v5, v5, v17
    v_fma_f32 v152, v152, v48, v50
    v_mfma_f32_16x16x32_bf16 a[168:171], v[76:79], v[24:27], a[168:171]
    v_exp_f32 v19, v179
    v_mfma_f32_16x16x32_bf16 a[168:171], v[92:95], v[28:31], a[168:171]
    s_waitcnt lgkmcnt(2)
    v_cvt_pk_bf16_f32 v176, v16, v17
    v_fma_f32 v156, v156, v49, v51
    v_mfma_f32_16x16x32_bf16 a[28:31], v[64:67], v[32:35], a[28:31]
    ds_read_b128 v[24:27], v1 offset:9216
    v_add_u32 v2, s3, v2
    v_mfma_f32_16x16x32_bf16 a[28:31], v[80:83], v[36:39], a[28:31]
    buffer_load_dwordx4 v4, s[4:7], s32 offen offset:0 sc1 lds
    v_mfma_f32_16x16x32_bf16 a[76:79], v[68:71], v[32:35], a[76:79]
    v_exp_f32 v16, v112
    v_mfma_f32_16x16x32_bf16 a[76:79], v[84:87], v[36:39], a[76:79]
    v_add_f32 v5, v5, v18
    v_add_f32 v5, v5, v19
    v_mfma_f32_16x16x32_bf16 a[124:127], v[72:75], v[32:35], a[124:127]
    ds_read_b128 v[28:31], v1 offset:21504
    v_cvt_f32_i32 v153, v153
    v_mfma_f32_16x16x32_bf16 a[124:127], v[88:91], v[36:39], a[124:127]
    buffer_load_dwordx4 v4, s[4:7], s32 offen offset:1024 sc1 lds
    v_mfma_f32_16x16x32_bf16 a[172:175], v[76:79], v[32:35], a[172:175]
    v_exp_f32 v17, v113
    v_mfma_f32_16x16x32_bf16 a[172:175], v[92:95], v[36:39], a[172:175]
    s_waitcnt lgkmcnt(2)
    v_cvt_pk_bf16_f32 v177, v18, v19
    v_add_u32 v3, s3, v3
    v_mfma_f32_16x16x32_bf16 a[32:35], v[64:67], v[40:43], a[32:35]
    ds_read_b128 v[32:35], v1 offset:10240
    v_cvt_f32_i32 v157, v157
    v_mfma_f32_16x16x32_bf16 a[32:35], v[80:83], v[44:47], a[32:35]
    v_exp_f32 v18, v114
    v_mfma_f32_16x16x32_bf16 a[80:83], v[68:71], v[40:43], a[80:83]
    v_add_f32 v5, v5, v16
    v_add_f32 v5, v5, v17
    v_mfma_f32_16x16x32_bf16 a[80:83], v[84:87], v[44:47], a[80:83]
    buffer_load_dwordx4 v4, s[4:7], s32 offen offset:2048 sc1 lds
    v_mfma_f32_16x16x32_bf16 a[128:131], v[72:75], v[40:43], a[128:131]
    ds_read_b128 v[36:39], v1 offset:22528
    v_mfma_f32_16x16x32_bf16 a[128:131], v[88:91], v[44:47], a[128:131]
    v_exp_f32 v19, v115
    v_mfma_f32_16x16x32_bf16 a[176:179], v[76:79], v[40:43], a[176:179]
    v_cvt_pk_bf16_f32 v178, v16, v17
    v_fma_f32 v153, v153, v48, v50
    v_mfma_f32_16x16x32_bf16 a[176:179], v[92:95], v[44:47], a[176:179]
    s_waitcnt lgkmcnt(2)
    v_exp_f32 v16, v180
    v_mfma_f32_16x16x32_bf16 a[36:39], v[64:67], v[24:27], a[36:39]
    ds_read_b128 v[40:43], v1 offset:11264
    v_add_f32 v5, v5, v18
    v_mfma_f32_16x16x32_bf16 a[36:39], v[80:83], v[28:31], a[36:39]
    v_add_f32 v5, v5, v19
    v_mfma_f32_16x16x32_bf16 a[84:87], v[68:71], v[24:27], a[84:87]
    v_exp_f32 v17, v181
    v_mfma_f32_16x16x32_bf16 a[84:87], v[84:87], v[28:31], a[84:87]
    s_add_u32 s32, s32, 24576
    v_cvt_pk_bf16_f32 v179, v18, v19
    s_add_u32 s26, s26, 36864
    v_mfma_f32_16x16x32_bf16 a[132:135], v[72:75], v[24:27], a[132:135]
    s_sub_u32 s57, s26, 147456
    ds_read_b128 v[44:47], v1 offset:23552
    v_fma_f32 v157, v157, v49, v51
    v_mfma_f32_16x16x32_bf16 a[132:135], v[88:91], v[28:31], a[132:135]
    s_waitcnt lgkmcnt(2)
    v_exp_f32 v18, v182
    v_mfma_f32_16x16x32_bf16 a[180:183], v[76:79], v[24:27], a[180:183]
    s_waitcnt vmcnt(6)
    v_add_f32 v6, v6, v16
    v_add_f32 v6, v6, v17
    v_mfma_f32_16x16x32_bf16 a[180:183], v[92:95], v[28:31], a[180:183]
    s_barrier
    v_cvt_f32_i32 v154, v154
    v_mfma_f32_16x16x32_bf16 a[40:43], v[64:67], v[32:35], a[40:43]
    s_min_u32 s26, s26, s57
    ds_read_b128 v[24:27], v2 offset:0
    v_add_u32 v0, 1, v0
    v_mfma_f32_16x16x32_bf16 a[40:43], v[80:83], v[36:39], a[40:43]
    buffer_store_dword v0, v13, s[20:23], 0 offen offset:32 sc1
    v_mfma_f32_16x16x32_bf16 a[88:91], v[68:71], v[32:35], a[88:91]
    v_exp_f32 v19, v183
    v_mfma_f32_16x16x32_bf16 a[88:91], v[84:87], v[36:39], a[88:91]
    v_cvt_pk_bf16_f32 v180, v16, v17
    v_cvt_f32_i32 v158, v158
    v_mfma_f32_16x16x32_bf16 a[136:139], v[72:75], v[32:35], a[136:139]
    ds_read_b128 v[28:31], v3 offset:0
    v_mfma_f32_16x16x32_bf16 a[136:139], v[88:91], v[36:39], a[136:139]
    v_exp_f32 v16, v116
    v_mfma_f32_16x16x32_bf16 a[184:187], v[76:79], v[32:35], a[184:187]
    v_add_f32 v6, v6, v18
    v_add_f32 v6, v6, v19
    v_mfma_f32_16x16x32_bf16 a[184:187], v[92:95], v[36:39], a[184:187]
    s_waitcnt lgkmcnt(2)
    v_exp_f32 v17, v117
    v_mfma_f32_16x16x32_bf16 a[44:47], v[64:67], v[40:43], a[44:47]
    ds_read_b128 v[32:35], v2 offset:6144
    v_cvt_pk_bf16_f32 v181, v18, v19
    v_mfma_f32_16x16x32_bf16 a[44:47], v[80:83], v[44:47], a[44:47]
    v_exp_f32 v18, v118
    v_mfma_f32_16x16x32_bf16 a[92:95], v[68:71], v[40:43], a[92:95]
    v_add_f32 v6, v6, v16
    v_add_f32 v6, v6, v17
    v_mfma_f32_16x16x32_bf16 a[92:95], v[84:87], v[44:47], a[92:95]
    v_exp_f32 v19, v119
    v_mfma_f32_16x16x32_bf16 a[140:143], v[72:75], v[40:43], a[140:143]
    ds_read_b128 v[36:39], v3 offset:6144
    v_cvt_pk_bf16_f32 v182, v16, v17
    v_mfma_f32_16x16x32_bf16 a[140:143], v[88:91], v[44:47], a[140:143]
    v_add_f32 v6, v6, v18
    v_add_f32 v6, v6, v19
    v_mfma_f32_16x16x32_bf16 a[188:191], v[76:79], v[40:43], a[188:191]
    v_cvt_pk_bf16_f32 v183, v18, v19
    v_mfma_f32_16x16x32_bf16 a[188:191], v[92:95], v[44:47], a[188:191]
    s_waitcnt lgkmcnt(2)
    v_mfma_f32_16x16x32_bf16 v[64:67], v[24:27], a[192:195], v[128:131]
    s_add_u32 s33, s33, 196608
    ds_read_b128 v[40:43], v2 offset:128
    v_fma_f32 v154, v154, v48, v50
    v_mfma_f32_16x16x32_bf16 v[64:67], v[28:31], a[196:199], v[64:67]
    s_mov_b32 m0, s56
    v_exp_f32 v16, v184
    v_mfma_f32_16x16x32_bf16 v[68:71], v[24:27], a[216:219], v[132:135]
    s_add_u32 s34, s34, 196608
    v_exp_f32 v17, v185
    v_mfma_f32_16x16x32_bf16 v[68:71], v[28:31], a[220:223], v[68:71]
    s_add_u32 s36, s36, 1536
    buffer_load_dwordx4 v4, s[4:7], s27 offen offset:0 sc1 lds
    v_mfma_f32_16x16x32_bf16 v[72:75], v[24:27], a[240:243], v[136:139]
    ds_read_b128 v[44:47], v3 offset:128
    v_fma_f32 v158, v158, v49, v51
    v_mfma_f32_16x16x32_bf16 v[72:75], v[28:31], a[244:247], v[72:75]
    v_exp_f32 v18, v186
    v_mfma_f32_16x16x32_bf16 v[76:79], v[24:27], v[200:203], v[140:143]
    v_add_f32 v7, v7, v16
    v_add_f32 v7, v7, v17
    v_mfma_f32_16x16x32_bf16 v[76:79], v[28:31], v[204:207], v[76:79]
    s_waitcnt lgkmcnt(2)
    buffer_load_dwordx2 v[56:57], v10, s[72:75], s36 offen offset:0
    v_mfma_f32_16x16x32_bf16 v[96:99], v[32:35], a[192:195], v[128:131]
    ds_read_b128 v[24:27], v2 offset:6272
    v_cvt_f32_i32 v155, v155
    v_mfma_f32_16x16x32_bf16 v[96:99], v[36:39], a[196:199], v[96:99]
    v_exp_f32 v19, v187
    v_mfma_f32_16x16x32_bf16 v[100:103], v[32:35], a[216:219], v[132:135]
    v_cvt_pk_bf16_f32 v184, v16, v17
    v_cvt_f32_i32 v159, v159
    v_mfma_f32_16x16x32_bf16 v[100:103], v[36:39], a[220:223], v[100:103]
    buffer_load_dwordx4 v4, s[4:7], s27 offen offset:1024 sc1 lds
    v_mfma_f32_16x16x32_bf16 v[104:107], v[32:35], a[240:243], v[136:139]
    ds_read_b128 v[28:31], v3 offset:6272
    v_fma_f32 v155, v155, v48, v50
    v_mfma_f32_16x16x32_bf16 v[104:107], v[36:39], a[244:247], v[104:107]
    v_exp_f32 v16, v120
    v_mfma_f32_16x16x32_bf16 v[108:111], v[32:35], v[200:203], v[140:143]
    v_add_f32 v7, v7, v18
    v_add_f32 v7, v7, v19
    v_mfma_f32_16x16x32_bf16 v[108:111], v[36:39], v[204:207], v[108:111]
    s_waitcnt lgkmcnt(2)
    buffer_load_dwordx2 v[58:59], v10, s[76:79], s36 offen offset:0
    v_mfma_f32_16x16x32_bf16 v[64:67], v[40:43], a[200:203], v[64:67]
    ds_read_b128 v[32:35], v2 offset:256
    v_fma_f32 v159, v159, v49, v51
    v_mfma_f32_16x16x32_bf16 v[64:67], v[44:47], a[204:207], v[64:67]
    v_exp_f32 v17, v121
    v_mfma_f32_16x16x32_bf16 v[68:71], v[40:43], a[224:227], v[68:71]
    v_cvt_pk_bf16_f32 v185, v18, v19
    v_cvt_pk_bf16_f32 v144, v144, v148
    v_mfma_f32_16x16x32_bf16 v[68:71], v[44:47], a[228:231], v[68:71]
    buffer_load_dwordx4 v[224:227], v9, s[64:67], s33 offen offset:0 nt
    v_mfma_f32_16x16x32_bf16 v[72:75], v[40:43], a[248:251], v[72:75]
    ds_read_b128 v[36:39], v3 offset:256
    v_cvt_pk_bf16_f32 v148, v145, v149
    v_mfma_f32_16x16x32_bf16 v[72:75], v[44:47], a[252:255], v[72:75]
    v_exp_f32 v18, v122
    v_mfma_f32_16x16x32_bf16 v[76:79], v[40:43], v[208:211], v[76:79]
    v_add_f32 v7, v7, v16
    v_add_f32 v7, v7, v17
    v_mfma_f32_16x16x32_bf16 v[76:79], v[44:47], v[212:215], v[76:79]
    s_waitcnt lgkmcnt(2)
    buffer_load_dwordx4 v4, s[4:7], s27 offen offset:2048 sc1 lds
    v_mfma_f32_16x16x32_bf16 v[96:99], v[24:27], a[200:203], v[96:99]
    ds_read_b128 v[40:43], v2 offset:6400
    v_cvt_pk_bf16_f32 v145, v152, v156
    v_mfma_f32_16x16x32_bf16 v[96:99], v[28:31], a[204:207], v[96:99]
    v_exp_f32 v19, v123
    v_cvt_pk_bf16_f32 v186, v16, v17
    v_mfma_f32_16x16x32_bf16 v[100:103], v[24:27], a[224:227], v[100:103]
    v_exp_f32 v16, v188
    v_mfma_f32_16x16x32_bf16 v[100:103], v[28:31], a[228:231], v[100:103]
    buffer_load_dwordx4 v[228:231], v9, s[64:67], s33 offen offset:1536 nt
    v_mfma_f32_16x16x32_bf16 v[104:107], v[24:27], a[248:251], v[104:107]
    ds_read_b128 v[44:47], v3 offset:6400
    v_add_f32 v7, v7, v18
    v_mfma_f32_16x16x32_bf16 v[104:107], v[28:31], a[252:255], v[104:107]
    v_add_f32 v7, v7, v19
    v_cvt_pk_bf16_f32 v149, v153, v157
    v_mfma_f32_16x16x32_bf16 v[108:111], v[24:27], v[208:211], v[108:111]
    s_add_u32 s29, s30, 49152
    v_exp_f32 v17, v189
    v_mfma_f32_16x16x32_bf16 v[108:111], v[28:31], v[212:215], v[108:111]
    s_waitcnt lgkmcnt(2)
    buffer_load_dwordx4 v[232:235], v9, s[64:67], s34 offen offset:0 nt
    v_cvt_pk_bf16_f32 v187, v18, v19
    v_mfma_f32_16x16x32_bf16 v[64:67], v[32:35], a[208:211], v[64:67]
    s_sub_u32 s3, s29, 147456
    ds_read_b128 v[24:27], v2 offset:12288
    s_add_u32 s27, s27, 24576
    v_mfma_f32_16x16x32_bf16 v[64:67], v[36:39], a[212:215], v[64:67]
    s_min_u32 s29, s29, s3
    v_exp_f32 v18, v190
    v_mfma_f32_16x16x32_bf16 v[68:71], v[32:35], a[232:235], v[68:71]
    v_add_f32 v8, v8, v16
    v_add_f32 v8, v8, v17
    v_mfma_f32_16x16x32_bf16 v[68:71], v[36:39], a[236:239], v[68:71]
    buffer_load_dwordx4 v[236:239], v9, s[64:67], s34 offen offset:1536 nt
    v_mfma_f32_16x16x32_bf16 v[72:75], v[32:35], v[192:195], v[72:75]
    s_add_u32 s56, s56, 12288
    ds_read_b128 v[28:31], v3 offset:12288
    v_cvt_pk_bf16_f32 v152, v146, v150
    v_mfma_f32_16x16x32_bf16 v[72:75], v[36:39], v[196:199], v[72:75]
    v_exp_f32 v19, v191
    v_cvt_pk_bf16_f32 v188, v16, v17
    v_mfma_f32_16x16x32_bf16 v[76:79], v[32:35], v[216:219], v[76:79]
    v_exp_f32 v16, v124
    v_mfma_f32_16x16x32_bf16 v[76:79], v[36:39], v[220:223], v[76:79]
    s_waitcnt lgkmcnt(2)
    v_add_f32 v8, v8, v18
    v_add_f32 v8, v8, v19
    v_mfma_f32_16x16x32_bf16 v[96:99], v[40:43], a[208:211], v[96:99]
    ds_read_b128 v[32:35], v2 offset:18432
    v_cvt_pk_bf16_f32 v153, v154, v158
    v_mfma_f32_16x16x32_bf16 v[96:99], v[44:47], a[212:215], v[96:99]
    s_sub_u32 s3, s29, s30
    v_exp_f32 v17, v125
    v_mfma_f32_16x16x32_bf16 v[100:103], v[40:43], a[232:235], v[100:103]
    s_mov_b32 m0, s56
    v_cvt_pk_bf16_f32 v189, v18, v19
    v_cvt_pk_bf16_f32 v156, v147, v151
    v_mfma_f32_16x16x32_bf16 v[100:103], v[44:47], a[236:239], v[100:103]
    v_exp_f32 v18, v126
    v_mfma_f32_16x16x32_bf16 v[104:107], v[40:43], v[192:195], v[104:107]
    ds_read_b128 v[36:39], v3 offset:18432
    v_add_f32 v8, v8, v16
    v_mfma_f32_16x16x32_bf16 v[104:107], v[44:47], v[196:199], v[104:107]
    v_add_f32 v8, v8, v17
    v_cvt_pk_bf16_f32 v157, v155, v159
    v_mfma_f32_16x16x32_bf16 v[108:111], v[40:43], v[216:219], v[108:111]
    v_exp_f32 v19, v127
    v_mfma_f32_16x16x32_bf16 v[108:111], v[44:47], v[220:223], v[108:111]
    s_waitcnt lgkmcnt(2)
    v_cvt_pk_bf16_f32 v190, v16, v17
    v_add_f32 v8, v8, v18
    v_mfma_f32_16x16x32_bf16 v[80:83], v[24:27], a[192:195], v[128:131]
    ds_read_b128 v[40:43], v2 offset:12416
    v_add_f32 v8, v8, v19
    v_mfma_f32_16x16x32_bf16 v[80:83], v[28:31], a[196:199], v[80:83]
    s_mov_b32 s30, s29
    v_cvt_pk_bf16_f32 v191, v18, v19
    v_mfma_f32_16x16x32_bf16 v[84:87], v[24:27], a[216:219], v[132:135]
    v_exp_f32 v16, v64
    v_mfma_f32_16x16x32_bf16 v[84:87], v[28:31], a[220:223], v[84:87]
    s_waitcnt vmcnt(20)
    buffer_load_dwordx4 v4, s[4:7], s27 offen offset:0 sc1 lds
    v_mfma_f32_16x16x32_bf16 v[88:91], v[24:27], a[240:243], v[136:139]
    ds_read_b128 v[44:47], v3 offset:12416
    v_lshlrev_b32 v48, 16, v60
    v_mfma_f32_16x16x32_bf16 v[88:91], v[28:31], a[244:247], v[88:91]
    v_exp_f32 v17, v65
    v_mfma_f32_16x16x32_bf16 v[92:95], v[24:27], v[200:203], v[140:143]
    v_exp_f32 v18, v66
    v_mfma_f32_16x16x32_bf16 v[92:95], v[28:31], v[204:207], v[92:95]
    s_waitcnt lgkmcnt(2)
    v_add_f32 v5, v5, v16
    v_add_f32 v5, v5, v17
    v_mfma_f32_16x16x32_bf16 v[112:115], v[32:35], a[192:195], v[128:131]
    ds_read_b128 v[24:27], v2 offset:18560
    v_and_b32 v49, s97, v60
    v_mfma_f32_16x16x32_bf16 v[112:115], v[36:39], a[196:199], v[112:115]
    v_exp_f32 v19, v67
    v_mfma_f32_16x16x32_bf16 v[116:119], v[32:35], a[216:219], v[132:135]
    v_cvt_pk_bf16_f32 v64, v16, v17
    v_lshlrev_b32 v50, 16, v62
    v_mfma_f32_16x16x32_bf16 v[116:119], v[36:39], a[220:223], v[116:119]
    v_exp_f32 v16, v96
    v_mfma_f32_16x16x32_bf16 v[120:123], v[32:35], a[240:243], v[136:139]
    ds_read_b128 v[28:31], v3 offset:18560
    v_add_f32 v5, v5, v18
    v_mfma_f32_16x16x32_bf16 v[120:123], v[36:39], a[244:247], v[120:123]
    v_add_f32 v5, v5, v19
    v_and_b32 v51, s97, v62
    v_mfma_f32_16x16x32_bf16 v[124:127], v[32:35], v[200:203], v[140:143]
    v_exp_f32 v17, v97
    v_mfma_f32_16x16x32_bf16 v[124:127], v[36:39], v[204:207], v[124:127]
    s_waitcnt lgkmcnt(2)
    buffer_load_dwordx4 v4, s[4:7], s27 offen offset:1024 sc1 lds
    v_mfma_f32_16x16x32_bf16 v[80:83], v[40:43], a[200:203], v[80:83]
    ds_read_b128 v[32:35], v2 offset:12544
    v_cvt_pk_bf16_f32 v65, v18, v19
    v_mfma_f32_16x16x32_bf16 v[80:83], v[44:47], a[204:207], v[80:83]
    v_exp_f32 v18, v98
    v_mfma_f32_16x16x32_bf16 v[84:87], v[40:43], a[224:227], v[84:87]
    v_add_f32 v5, v5, v16
    v_add_f32 v5, v5, v17
    v_mfma_f32_16x16x32_bf16 v[84:87], v[44:47], a[228:231], v[84:87]
    v_exp_f32 v19, v99
    v_mfma_f32_16x16x32_bf16 v[88:91], v[40:43], a[248:251], v[88:91]
    ds_read_b128 v[36:39], v3 offset:12544
    v_cvt_pk_bf16_f32 v66, v16, v17
    v_mfma_f32_16x16x32_bf16 v[88:91], v[44:47], a[252:255], v[88:91]
    v_exp_f32 v16, v68
    v_mfma_f32_16x16x32_bf16 v[92:95], v[40:43], v[208:211], v[92:95]
    v_mul_f32_e64 v50, -v50, v48
    v_add_u32 v1, s3, v1
    v_mfma_f32_16x16x32_bf16 v[92:95], v[44:47], v[212:215], v[92:95]
    s_waitcnt lgkmcnt(2)
    v_add_f32 v5, v5, v18
    v_mul_f32_e64 v51, -v51, v49
    v_mfma_f32_16x16x32_bf16 v[112:115], v[24:27], a[200:203], v[112:115]
    ds_read_b128 v[40:43], v2 offset:18688
    v_add_f32 v5, v5, v19
    v_mfma_f32_16x16x32_bf16 v[112:115], v[28:31], a[204:207], v[112:115]
    buffer_load_dwordx4 v4, s[4:7], s27 offen offset:2048 sc1 lds
    v_mfma_f32_16x16x32_bf16 v[116:119], v[24:27], a[224:227], v[116:119]
    v_exp_f32 v17, v69
    v_mfma_f32_16x16x32_bf16 v[116:119], v[28:31], a[228:231], v[116:119]
    v_cvt_pk_bf16_f32 v67, v18, v19
    v_cvt_f32_i32 v240, v240
    v_mfma_f32_16x16x32_bf16 v[120:123], v[24:27], a[248:251], v[120:123]
    ds_read_b128 v[44:47], v3 offset:18688
    v_cvt_f32_i32 v244, v244
    v_mfma_f32_16x16x32_bf16 v[120:123], v[28:31], a[252:255], v[120:123]
    s_waitcnt lgkmcnt(2)
    v_exp_f32 v18, v70
    v_mfma_f32_16x16x32_bf16 v[124:127], v[24:27], v[208:211], v[124:127]
    s_waitcnt vmcnt(24)
    v_add_f32 v6, v6, v16
    v_add_f32 v6, v6, v17
    v_mfma_f32_16x16x32_bf16 v[124:127], v[28:31], v[212:215], v[124:127]
    s_barrier
    v_fma_f32 v240, v240, v48, v50
    v_mfma_f32_16x16x32_bf16 v[80:83], v[32:35], a[208:211], v[80:83]
    ds_read_b128 v[24:27], v1 offset:0
    v_fma_f32 v244, v244, v49, v51
    v_mfma_f32_16x16x32_bf16 v[80:83], v[36:39], a[212:215], v[80:83]
    v_exp_f32 v19, v71
    v_mfma_f32_16x16x32_bf16 v[84:87], v[32:35], a[232:235], v[84:87]
    v_cvt_pk_bf16_f32 v68, v16, v17
    v_mfma_f32_16x16x32_bf16 v[84:87], v[36:39], a[236:239], v[84:87]
    v_exp_f32 v16, v100
    v_mfma_f32_16x16x32_bf16 v[88:91], v[32:35], v[192:195], v[88:91]
    ds_read_b128 v[28:31], v1 offset:12288
    v_add_f32 v6, v6, v18
    v_mfma_f32_16x16x32_bf16 v[88:91], v[36:39], v[196:199], v[88:91]
    v_add_f32 v6, v6, v19
    v_cvt_f32_i32 v241, v241
    v_mfma_f32_16x16x32_bf16 v[92:95], v[32:35], v[216:219], v[92:95]
    v_exp_f32 v17, v101
    v_mfma_f32_16x16x32_bf16 v[92:95], v[36:39], v[220:223], v[92:95]
    s_waitcnt lgkmcnt(2)
    v_cvt_pk_bf16_f32 v69, v18, v19
    v_cvt_f32_i32 v245, v245
    v_mfma_f32_16x16x32_bf16 v[112:115], v[40:43], a[208:211], v[112:115]
    ds_read_b128 v[32:35], v1 offset:1024
    v_mfma_f32_16x16x32_bf16 v[112:115], v[44:47], a[212:215], v[112:115]
    v_exp_f32 v18, v102
    v_mfma_f32_16x16x32_bf16 v[116:119], v[40:43], a[232:235], v[116:119]
    v_add_f32 v6, v6, v16
    v_add_f32 v6, v6, v17
    v_mfma_f32_16x16x32_bf16 v[116:119], v[44:47], a[236:239], v[116:119]
    s_add_u32 s27, s27, 24576
    v_exp_f32 v19, v103
    v_mfma_f32_16x16x32_bf16 v[120:123], v[40:43], v[192:195], v[120:123]
    s_add_u32 s56, s56, 36864
    ds_read_b128 v[36:39], v1 offset:13312
    v_cvt_pk_bf16_f32 v70, v16, v17
    v_mfma_f32_16x16x32_bf16 v[120:123], v[44:47], v[196:199], v[120:123]
    s_sub_u32 s58, s56, 147456
    v_add_f32 v6, v6, v18
    v_add_f32 v6, v6, v19
    v_mfma_f32_16x16x32_bf16 v[124:127], v[40:43], v[216:219], v[124:127]
    s_min_u32 s56, s56, s58
    v_cvt_pk_bf16_f32 v71, v18, v19
    v_mfma_f32_16x16x32_bf16 v[124:127], v[44:47], v[220:223], v[124:127]
    s_waitcnt lgkmcnt(2)
    v_mfma_f32_16x16x32_bf16 a[0:3], v[160:163], v[24:27], a[0:3]
    s_mov_b32 m0, s56
    ds_read_b128 v[40:43], v1 offset:2048
    v_fma_f32 v241, v241, v48, v50
    v_mfma_f32_16x16x32_bf16 a[0:3], v[176:179], v[28:31], a[0:3]
    buffer_load_dwordx4 v4, s[4:7], s27 offen offset:0 sc1 lds
    v_mfma_f32_16x16x32_bf16 a[48:51], v[164:167], v[24:27], a[48:51]
    v_exp_f32 v16, v72
    v_mfma_f32_16x16x32_bf16 a[48:51], v[180:183], v[28:31], a[48:51]
    v_exp_f32 v17, v73
    v_mfma_f32_16x16x32_bf16 a[96:99], v[168:171], v[24:27], a[96:99]
    ds_read_b128 v[44:47], v1 offset:14336
    v_fma_f32 v245, v245, v49, v51
    v_mfma_f32_16x16x32_bf16 a[96:99], v[184:187], v[28:31], a[96:99]
    v_exp_f32 v18, v74
    v_mfma_f32_16x16x32_bf16 a[144:147], v[172:175], v[24:27], a[144:147]
    v_add_f32 v7, v7, v16
    v_add_f32 v7, v7, v17
    v_mfma_f32_16x16x32_bf16 a[144:147], v[188:191], v[28:31], a[144:147]
    s_waitcnt lgkmcnt(2)
    v_exp_f32 v19, v75
    v_mfma_f32_16x16x32_bf16 a[4:7], v[160:163], v[32:35], a[4:7]
    ds_read_b128 v[24:27], v1 offset:3072
    v_cvt_f32_i32 v242, v242
    v_mfma_f32_16x16x32_bf16 a[4:7], v[176:179], v[36:39], a[4:7]
    buffer_load_dwordx4 v4, s[4:7], s27 offen offset:1024 sc1 lds
    v_mfma_f32_16x16x32_bf16 a[52:55], v[164:167], v[32:35], a[52:55]
    v_cvt_pk_bf16_f32 v72, v16, v17
    v_cvt_f32_i32 v246, v246
    v_mfma_f32_16x16x32_bf16 a[52:55], v[180:183], v[36:39], a[52:55]
    v_exp_f32 v16, v104
    v_mfma_f32_16x16x32_bf16 a[100:103], v[168:171], v[32:35], a[100:103]
    ds_read_b128 v[28:31], v1 offset:15360
    v_add_f32 v7, v7, v18
    v_mfma_f32_16x16x32_bf16 a[100:103], v[184:187], v[36:39], a[100:103]
    v_add_f32 v7, v7, v19
    v_bfe_u32 v53, v4, 4, 6
    v_mfma_f32_16x16x32_bf16 a[148:151], v[172:175], v[32:35], a[148:151]
    v_exp_f32 v17, v105
    v_mfma_f32_16x16x32_bf16 a[148:151], v[188:191], v[36:39], a[148:151]
    s_waitcnt lgkmcnt(2)
    v_fma_f32 v242, v242, v48, v50
    v_cvt_pk_bf16_f32 v73, v18, v19
    v_mfma_f32_16x16x32_bf16 a[8:11], v[160:163], v[40:43], a[8:11]
    ds_read_b128 v[32:35], v1 offset:4096
    v_fma_f32 v246, v246, v49, v51
    v_mfma_f32_16x16x32_bf16 a[8:11], v[176:179], v[44:47], a[8:11]
    v_exp_f32 v18, v106
    v_mfma_f32_16x16x32_bf16 a[56:59], v[164:167], v[40:43], a[56:59]
    v_lshlrev_b32 v53, 2, v53
    v_add_f32 v7, v7, v16
    v_mfma_f32_16x16x32_bf16 a[56:59], v[180:183], v[44:47], a[56:59]
    buffer_load_dword v52, v53, s[20:23], s44 offen sc1
    v_mfma_f32_16x16x32_bf16 a[104:107], v[168:171], v[40:43], a[104:107]
    ds_read_b128 v[36:39], v1 offset:16384
    v_add_f32 v7, v7, v17
    v_mfma_f32_16x16x32_bf16 a[104:107], v[184:187], v[44:47], a[104:107]
    v_exp_f32 v19, v107
    v_mfma_f32_16x16x32_bf16 a[152:155], v[172:175], v[40:43], a[152:155]
    v_cvt_f32_i32 v243, v243
    v_cvt_pk_bf16_f32 v74, v16, v17
    v_mfma_f32_16x16x32_bf16 a[152:155], v[188:191], v[44:47], a[152:155]
    s_waitcnt lgkmcnt(2)
    buffer_load_dwordx4 v4, s[4:7], s27 offen offset:2048 sc1 lds
    v_mfma_f32_16x16x32_bf16 a[12:15], v[160:163], v[24:27], a[12:15]
    ds_read_b128 v[40:43], v1 offset:5120
    v_cvt_f32_i32 v247, v247
    v_mfma_f32_16x16x32_bf16 a[12:15], v[176:179], v[28:31], a[12:15]
    s_add_u32 s27, s27, 24576
    v_exp_f32 v16, v76
    v_mfma_f32_16x16x32_bf16 a[60:63], v[164:167], v[24:27], a[60:63]
    v_add_f32 v7, v7, v18
    v_add_f32 v7, v7, v19
    v_mfma_f32_16x16x32_bf16 a[60:63], v[180:183], v[28:31], a[60:63]
    v_fma_f32 v243, v243, v48, v50
    v_fma_f32 v247, v247, v49, v51
    v_mfma_f32_16x16x32_bf16 a[108:111], v[168:171], v[24:27], a[108:111]
    ds_read_b128 v[44:47], v1 offset:17408
    v_lshlrev_b32 v48, 16, v61
    v_mfma_f32_16x16x32_bf16 a[108:111], v[184:187], v[28:31], a[108:111]
    v_exp_f32 v17, v77
    v_mfma_f32_16x16x32_bf16 a[156:159], v[172:175], v[24:27], a[156:159]
    s_add_u32 s29, s28, 49152
    v_cvt_pk_bf16_f32 v75, v18, v19
    v_and_b32 v49, s97, v61
    v_mfma_f32_16x16x32_bf16 a[156:159], v[188:191], v[28:31], a[156:159]
    s_waitcnt lgkmcnt(2)
    v_exp_f32 v18, v78
    v_mfma_f32_16x16x32_bf16 a[16:19], v[160:163], v[32:35], a[16:19]
    s_sub_u32 s3, s29, 147456
    ds_read_b128 v[24:27], v1 offset:6144
    v_add_f32 v8, v8, v16
    v_mfma_f32_16x16x32_bf16 a[16:19], v[176:179], v[36:39], a[16:19]
    s_add_u32 s56, s56, 12288
    v_add_f32 v8, v8, v17
    v_lshlrev_b32 v50, 16, v63
    v_mfma_f32_16x16x32_bf16 a[64:67], v[164:167], v[32:35], a[64:67]
    s_min_u32 s29, s29, s3
    v_exp_f32 v19, v79
    v_mfma_f32_16x16x32_bf16 a[64:67], v[180:183], v[36:39], a[64:67]
    s_mov_b32 m0, s56
    v_cvt_pk_bf16_f32 v76, v16, v17
    v_and_b32 v51, s97, v63
    v_mfma_f32_16x16x32_bf16 a[112:115], v[168:171], v[32:35], a[112:115]
    ds_read_b128 v[28:31], v1 offset:18432
    v_mul_f32_e64 v50, -v50, v48
    v_mfma_f32_16x16x32_bf16 a[112:115], v[184:187], v[36:39], a[112:115]
    v_exp_f32 v16, v108
    v_mfma_f32_16x16x32_bf16 a[160:163], v[172:175], v[32:35], a[160:163]
    v_add_f32 v8, v8, v18
    v_add_f32 v8, v8, v19
    v_mfma_f32_16x16x32_bf16 a[160:163], v[188:191], v[36:39], a[160:163]
    s_waitcnt lgkmcnt(2)
    v_exp_f32 v17, v109
    v_mfma_f32_16x16x32_bf16 a[20:23], v[160:163], v[40:43], a[20:23]
    s_sub_u32 s3, s29, s28
    ds_read_b128 v[32:35], v1 offset:7168
    v_cvt_pk_bf16_f32 v77, v18, v19
    v_mfma_f32_16x16x32_bf16 a[20:23], v[176:179], v[44:47], a[20:23]
    v_exp_f32 v18, v110
    v_mfma_f32_16x16x32_bf16 a[68:71], v[164:167], v[40:43], a[68:71]
    v_mul_f32_e64 v51, -v51, v49
    v_add_f32 v8, v8, v16
    v_mfma_f32_16x16x32_bf16 a[68:71], v[180:183], v[44:47], a[68:71]
    buffer_load_dwordx4 v4, s[4:7], s27 offen offset:0 sc1 lds
    v_mfma_f32_16x16x32_bf16 a[116:119], v[168:171], v[40:43], a[116:119]
    ds_read_b128 v[36:39], v1 offset:19456
    v_add_f32 v8, v8, v17
    v_mfma_f32_16x16x32_bf16 a[116:119], v[184:187], v[44:47], a[116:119]
    v_exp_f32 v19, v111
    v_mfma_f32_16x16x32_bf16 a[164:167], v[172:175], v[40:43], a[164:167]
    s_mov_b32 s28, s29
    v_cvt_f32_i32 v248, v248
    v_cvt_pk_bf16_f32 v78, v16, v17
    v_mfma_f32_16x16x32_bf16 a[164:167], v[188:191], v[44:47], a[164:167]
    s_waitcnt lgkmcnt(2)
    v_add_f32 v8, v8, v18
    v_cvt_f32_i32 v252, v252
    v_mfma_f32_16x16x32_bf16 a[24:27], v[160:163], v[24:27], a[24:27]
    ds_read_b128 v[40:43], v1 offset:8192
    v_add_f32 v8, v8, v19
    v_mfma_f32_16x16x32_bf16 a[24:27], v[176:179], v[28:31], a[24:27]
    v_cvt_pk_bf16_f32 v79, v18, v19
    v_fma_f32 v248, v248, v48, v50
    v_mfma_f32_16x16x32_bf16 a[72:75], v[164:167], v[24:27], a[72:75]
    v_exp_f32 v16, v80
    v_mfma_f32_16x16x32_bf16 a[72:75], v[180:183], v[28:31], a[72:75]
    buffer_load_dwordx4 v4, s[4:7], s27 offen offset:1024 sc1 lds
    v_mfma_f32_16x16x32_bf16 a[120:123], v[168:171], v[24:27], a[120:123]
    ds_read_b128 v[44:47], v1 offset:20480
    v_fma_f32 v252, v252, v49, v51
    v_mfma_f32_16x16x32_bf16 a[120:123], v[184:187], v[28:31], a[120:123]
    v_exp_f32 v17, v81
    v_mfma_f32_16x16x32_bf16 a[168:171], v[172:175], v[24:27], a[168:171]
    v_exp_f32 v18, v82
    v_mfma_f32_16x16x32_bf16 a[168:171], v[188:191], v[28:31], a[168:171]
    s_waitcnt lgkmcnt(2)
    v_cvt_f32_i32 v249, v249
    v_add_f32 v5, v5, v16
    v_mfma_f32_16x16x32_bf16 a[28:31], v[160:163], v[32:35], a[28:31]
    ds_read_b128 v[24:27], v1 offset:9216
    v_add_f32 v5, v5, v17
    v_mfma_f32_16x16x32_bf16 a[28:31], v[176:179], v[36:39], a[28:31]
    v_exp_f32 v19, v83
    v_mfma_f32_16x16x32_bf16 a[76:79], v[164:167], v[32:35], a[76:79]
    v_cvt_f32_i32 v253, v253
    v_cvt_pk_bf16_f32 v80, v16, v17
    v_mfma_f32_16x16x32_bf16 a[76:79], v[180:183], v[36:39], a[76:79]
    v_exp_f32 v16, v112
    v_mfma_f32_16x16x32_bf16 a[124:127], v[168:171], v[32:35], a[124:127]
    ds_read_b128 v[28:31], v1 offset:21504
    v_fma_f32 v249, v249, v48, v50
    v_mfma_f32_16x16x32_bf16 a[124:127], v[184:187], v[36:39], a[124:127]
    buffer_load_dwordx4 v4, s[4:7], s27 offen offset:2048 sc1 lds
    v_mfma_f32_16x16x32_bf16 a[172:175], v[172:175], v[32:35], a[172:175]
    v_add_f32 v5, v5, v18
    v_add_f32 v5, v5, v19
    v_mfma_f32_16x16x32_bf16 a[172:175], v[188:191], v[36:39], a[172:175]
    s_waitcnt lgkmcnt(2)
    v_exp_f32 v17, v113
    v_mfma_f32_16x16x32_bf16 a[32:35], v[160:163], v[40:43], a[32:35]
    ds_read_b128 v[32:35], v1 offset:10240
    v_fma_f32 v253, v253, v49, v51
    v_mfma_f32_16x16x32_bf16 a[32:35], v[176:179], v[44:47], a[32:35]
    v_cvt_pk_bf16_f32 v81, v18, v19
    v_cvt_f32_i32 v250, v250
    v_mfma_f32_16x16x32_bf16 a[80:83], v[164:167], v[40:43], a[80:83]
    v_exp_f32 v18, v114
    v_mfma_f32_16x16x32_bf16 a[80:83], v[180:183], v[44:47], a[80:83]
    v_cvt_f32_i32 v254, v254
    v_add_f32 v5, v5, v16
    v_mfma_f32_16x16x32_bf16 a[128:131], v[168:171], v[40:43], a[128:131]
    ds_read_b128 v[36:39], v1 offset:22528
    v_add_f32 v5, v5, v17
    v_mfma_f32_16x16x32_bf16 a[128:131], v[184:187], v[44:47], a[128:131]
    v_exp_f32 v19, v115
    v_mfma_f32_16x16x32_bf16 a[176:179], v[172:175], v[40:43], a[176:179]
    v_fma_f32 v250, v250, v48, v50
    v_cvt_pk_bf16_f32 v82, v16, v17
    v_mfma_f32_16x16x32_bf16 a[176:179], v[188:191], v[44:47], a[176:179]
    s_waitcnt lgkmcnt(2)
    v_exp_f32 v16, v84
    v_mfma_f32_16x16x32_bf16 a[36:39], v[160:163], v[24:27], a[36:39]
    ds_read_b128 v[40:43], v1 offset:11264
    v_fma_f32 v254, v254, v49, v51
    v_mfma_f32_16x16x32_bf16 a[36:39], v[176:179], v[28:31], a[36:39]
    v_add_u32 v2, s3, v2
    v_add_f32 v5, v5, v18
    v_mfma_f32_16x16x32_bf16 a[84:87], v[164:167], v[24:27], a[84:87]
    v_add_f32 v5, v5, v19
    v_cvt_f32_i32 v251, v251
    v_mfma_f32_16x16x32_bf16 a[84:87], v[180:183], v[28:31], a[84:87]
    s_add_u32 s27, s27, 24576
    v_exp_f32 v17, v85
    v_mfma_f32_16x16x32_bf16 a[132:135], v[168:171], v[24:27], a[132:135]
    s_add_u32 s56, s56, 36864
    ds_read_b128 v[44:47], v1 offset:23552
    v_add_u32 v3, s3, v3
    v_mfma_f32_16x16x32_bf16 a[132:135], v[184:187], v[28:31], a[132:135]
    s_waitcnt lgkmcnt(2)
    v_cvt_pk_bf16_f32 v83, v18, v19
    v_cvt_f32_i32 v255, v255
    v_mfma_f32_16x16x32_bf16 a[180:183], v[172:175], v[24:27], a[180:183]
    s_waitcnt vmcnt(20)
    v_exp_f32 v18, v86
    v_mfma_f32_16x16x32_bf16 a[180:183], v[188:191], v[28:31], a[180:183]
    s_barrier
    v_fma_f32 v251, v251, v48, v50
    v_mfma_f32_16x16x32_bf16 a[40:43], v[160:163], v[32:35], a[40:43]
    s_sub_u32 s58, s56, 147456
    ds_read_b128 v[24:27], v2 offset:0
    v_add_f32 v6, v6, v16
    v_mfma_f32_16x16x32_bf16 a[40:43], v[176:179], v[36:39], a[40:43]
    s_min_u32 s56, s56, s58
    buffer_load_dword v15, v4, s[88:91], s93 offen
    v_mfma_f32_16x16x32_bf16 a[88:91], v[164:167], v[32:35], a[88:91]
    v_add_f32 v6, v6, v17
    v_fma_f32 v255, v255, v49, v51
    v_mfma_f32_16x16x32_bf16 a[88:91], v[180:183], v[36:39], a[88:91]
    v_exp_f32 v19, v87
    v_mfma_f32_16x16x32_bf16 a[136:139], v[168:171], v[32:35], a[136:139]
    ds_read_b128 v[28:31], v3 offset:0
    v_cvt_pk_bf16_f32 v84, v16, v17
    v_mfma_f32_16x16x32_bf16 a[136:139], v[184:187], v[36:39], a[136:139]
    v_exp_f32 v16, v116
    v_mfma_f32_16x16x32_bf16 a[184:187], v[172:175], v[32:35], a[184:187]
    v_add_f32 v6, v6, v18
    v_cvt_pk_bf16_f32 v146, v240, v244
    v_mfma_f32_16x16x32_bf16 a[184:187], v[188:191], v[36:39], a[184:187]
    s_waitcnt lgkmcnt(2)
    v_add_f32 v6, v6, v19
    v_cvt_pk_bf16_f32 v150, v241, v245
    v_mfma_f32_16x16x32_bf16 a[44:47], v[160:163], v[40:43], a[44:47]
    ds_read_b128 v[32:35], v2 offset:6144
    v_cvt_pk_bf16_f32 v147, v248, v252
    v_mfma_f32_16x16x32_bf16 a[44:47], v[176:179], v[44:47], a[44:47]
    v_exp_f32 v17, v117
    v_mfma_f32_16x16x32_bf16 a[92:95], v[164:167], v[40:43], a[92:95]
    v_cvt_pk_bf16_f32 v85, v18, v19
    v_cvt_pk_bf16_f32 v151, v249, v253
    v_mfma_f32_16x16x32_bf16 a[92:95], v[180:183], v[44:47], a[92:95]
    v_exp_f32 v18, v118
    v_mfma_f32_16x16x32_bf16 a[140:143], v[168:171], v[40:43], a[140:143]
    ds_read_b128 v[36:39], v3 offset:6144
    v_add_f32 v6, v6, v16
    v_mfma_f32_16x16x32_bf16 a[140:143], v[184:187], v[44:47], a[140:143]
    v_add_f32 v6, v6, v17
    v_cvt_pk_bf16_f32 v154, v242, v246
    v_mfma_f32_16x16x32_bf16 a[188:191], v[172:175], v[40:43], a[188:191]
    v_exp_f32 v19, v119
    v_mfma_f32_16x16x32_bf16 a[188:191], v[188:191], v[44:47], a[188:191]
    s_waitcnt lgkmcnt(2)
    v_cvt_pk_bf16_f32 v86, v16, v17
    v_add_f32 v6, v6, v18
    v_cvt_pk_bf16_f32 v155, v250, v254
    v_add_f32 v6, v6, v19
    v_cvt_pk_bf16_f32 v158, v243, v247
    v_cvt_pk_bf16_f32 v87, v18, v19
    v_cvt_pk_bf16_f32 v159, v251, v255
L_join:
    v_mfma_f32_16x16x32_bf16 v[160:163], v[24:27], a[192:195], v[128:131]
    s_waitcnt vmcnt(7)
    ds_read_b128 v[40:43], v2 offset:128
    v_lshlrev_b32 v48, 16, v56
    v_mfma_f32_16x16x32_bf16 v[160:163], v[28:31], a[196:199], v[160:163]
    s_waitcnt vmcnt(5)
    v_subrev_u32 v52, s92, v52
    v_cmp_lt_u32 vcc, 15, v52
    v_mfma_f32_16x16x32_bf16 v[164:167], v[24:27], a[216:219], v[132:135]
    v_exp_f32 v16, v88
    v_mfma_f32_16x16x32_bf16 v[164:167], v[28:31], a[220:223], v[164:167]
    v_exp_f32 v17, v89
    v_mfma_f32_16x16x32_bf16 v[168:171], v[24:27], a[240:243], v[136:139]
    s_and_b32 s59, vcc_lo, 0xff
    ds_read_b128 v[44:47], v3 offset:128
    v_and_b32 v49, s97, v56
    v_mfma_f32_16x16x32_bf16 v[168:171], v[28:31], a[244:247], v[168:171]
    s_cbranch_scc1 L_pollslow1
L_pollok1:
    v_mfma_f32_16x16x32_bf16 v[172:175], v[24:27], v[200:203], v[140:143]
    s_add_u32 s92, s92, 1
    v_exp_f32 v18, v90
    v_mfma_f32_16x16x32_bf16 v[172:175], v[28:31], v[204:207], v[172:175]
    s_waitcnt lgkmcnt(2)
    v_add_f32 v7, v7, v16
    v_add_f32 v7, v7, v17
    v_mfma_f32_16x16x32_bf16 v[96:99], v[32:35], a[192:195], v[128:131]
    ds_read_b128 v[24:27], v2 offset:6272
    v_lshlrev_b32 v50, 16, v58
    v_mfma_f32_16x16x32_bf16 v[96:99], v[36:39], a[196:199], v[96:99]
    buffer_store_dwordx4 v[144:147], v20, s[4:7], s35 offen offset:0 sc1
    v_mfma_f32_16x16x32_bf16 v[100:103], v[32:35], a[216:219], v[132:135]
    v_exp_f32 v19, v91
    v_mfma_f32_16x16x32_bf16 v[100:103], v[36:39], a[220:223], v[100:103]
    v_cvt_pk_bf16_f32 v88, v16, v17
    v_mfma_f32_16x16x32_bf16 v[104:107], v[32:35], a[240:243], v[136:139]
    ds_read_b128 v[28:31], v3 offset:6272
    v_mfma_f32_16x16x32_bf16 v[104:107], v[36:39], a[244:247], v[104:107]
    v_exp_f32 v16, v120
    v_mfma_f32_16x16x32_bf16 v[108:111], v[32:35], v[200:203], v[140:143]
    v_add_f32 v7, v7, v18
    v_add_f32 v7, v7, v19
    v_mfma_f32_16x16x32_bf16 v[108:111], v[36:39], v[204:207], v[108:111]
    s_waitcnt lgkmcnt(2)
    v_exp_f32 v17, v121
    v_mfma_f32_16x16x32_bf16 v[160:163], v[40:43], a[200:203], v[160:163]
    ds_read_b128 v[32:35], v2 offset:256
    v_cvt_pk_bf16_f32 v89, v18, v19
    v_mfma_f32_16x16x32_bf16 v[160:163], v[44:47], a[204:207], v[160:163]
    buffer_store_dwordx4 v[148:151], v20, s[4:7], s35 offen offset:3072 sc1
    v_mfma_f32_16x16x32_bf16 v[164:167], v[40:43], a[224:227], v[164:167]
    v_exp_f32 v18, v122
    v_mfma_f32_16x16x32_bf16 v[164:167], v[44:47], a[228:231], v[164:167]
    v_add_f32 v7, v7, v16
    v_add_f32 v7, v7, v17
    v_mfma_f32_16x16x32_bf16 v[168:171], v[40:43], a[248:251], v[168:171]
    ds_read_b128 v[36:39], v3 offset:256
    v_and_b32 v51, s97, v58
    v_mfma_f32_16x16x32_bf16 v[168:171], v[44:47], a[252:255], v[168:171]
    v_exp_f32 v19, v123
    v_mfma_f32_16x16x32_bf16 v[172:175], v[40:43], v[208:211], v[172:175]
    v_cvt_pk_bf16_f32 v90, v16, v17
    v_mul_f32 v48, s38, v48
    v_mfma_f32_16x16x32_bf16 v[172:175], v[44:47], v[212:215], v[172:175]
    s_waitcnt lgkmcnt(2)
    v_exp_f32 v16, v92
    v_mfma_f32_16x16x32_bf16 v[96:99], v[24:27], a[200:203], v[96:99]
    ds_read_b128 v[40:43], v2 offset:6400
    v_add_f32 v7, v7, v18
    v_mfma_f32_16x16x32_bf16 v[96:99], v[28:31], a[204:207], v[96:99]
    buffer_store_dwordx4 v[152:155], v20, s[4:7], s17 offen offset:0 sc1
    v_mfma_f32_16x16x32_bf16 v[100:103], v[24:27], a[224:227], v[100:103]
    v_add_f32 v7, v7, v19
    v_mul_f32 v49, s38, v49
    v_mfma_f32_16x16x32_bf16 v[100:103], v[28:31], a[228:231], v[100:103]
    v_exp_f32 v17, v93
    v_mfma_f32_16x16x32_bf16 v[104:107], v[24:27], a[248:251], v[104:107]
    ds_read_b128 v[44:47], v3 offset:6400
    v_cvt_pk_bf16_f32 v91, v18, v19
    v_mfma_f32_16x16x32_bf16 v[104:107], v[28:31], a[252:255], v[104:107]
    v_exp_f32 v18, v94
    v_mfma_f32_16x16x32_bf16 v[108:111], v[24:27], v[208:211], v[108:111]
    s_add_u32 s29, s30, 49152
    v_add_f32 v8, v8, v16
    v_add_f32 v8, v8, v17
    v_mfma_f32_16x16x32_bf16 v[108:111], v[28:31], v[212:215], v[108:111]
    s_waitcnt lgkmcnt(2)
    v_exp_f32 v19, v95
    v_mfma_f32_16x16x32_bf16 v[160:163], v[32:35], a[208:211], v[160:163]
    s_sub_u32 s3, s29, 147456
    ds_read_b128 v[24:27], v2 offset:12288
    v_cvt_pk_bf16_f32 v92, v16, v17
    v_mfma_f32_16x16x32_bf16 v[160:163], v[36:39], a[212:215], v[160:163]
    buffer_store_dwordx4 v[156:159], v20, s[4:7], s17 offen offset:3072 sc1
    v_mfma_f32_16x16x32_bf16 v[164:167], v[32:35], a[232:235], v[164:167]
    s_min_u32 s29, s29, s3
    v_exp_f32 v16, v124
    v_mfma_f32_16x16x32_bf16 v[164:167], v[36:39], a[236:239], v[164:167]
    v_add_f32 v8, v8, v18
    v_add_f32 v8, v8, v19
    v_mfma_f32_16x16x32_bf16 v[168:171], v[32:35], v[192:195], v[168:171]
    ds_read_b128 v[28:31], v3 offset:12288
    v_mul_f32_e64 v50, -v50, v48
    v_mfma_f32_16x16x32_bf16 v[168:171], v[36:39], v[196:199], v[168:171]
    v_exp_f32 v17, v125
    v_mfma_f32_16x16x32_bf16 v[172:175], v[32:35], v[216:219], v[172:175]
    v_cvt_pk_bf16_f32 v93, v18, v19
    v_mul_f32_e64 v51, -v51, v49
    v_mfma_f32_16x16x32_bf16 v[172:175], v[36:39], v[220:223], v[172:175]
    s_waitcnt lgkmcnt(2)
    v_exp_f32 v18, v126
    v_mfma_f32_16x16x32_bf16 v[96:99], v[40:43], a[208:211], v[96:99]
    ds_read_b128 v[32:35], v2 offset:18432
    v_add_f32 v8, v8, v16
    v_mfma_f32_16x16x32_bf16 v[96:99], v[44:47], a[212:215], v[96:99]
    s_mov_b32 m0, s26
    v_add_f32 v8, v8, v17
    s_sub_u32 s3, s29, s30
    v_mfma_f32_16x16x32_bf16 v[100:103], v[40:43], a[232:235], v[100:103]
    v_exp_f32 v19, v127
    v_mfma_f32_16x16x32_bf16 v[100:103], v[44:47], a[236:239], v[100:103]
    buffer_load_dwordx4 v4, s[4:7], s32 offen offset:0 sc1 lds
    v_mfma_f32_16x16x32_bf16 v[104:107], v[40:43], v[192:195], v[104:107]
    ds_read_b128 v[36:39], v3 offset:18432
    v_cvt_pk_bf16_f32 v94, v16, v17
    v_mfma_f32_16x16x32_bf16 v[104:107], v[44:47], v[196:199], v[104:107]
    v_add_f32 v8, v8, v18
    v_add_f32 v8, v8, v19
    v_mfma_f32_16x16x32_bf16 v[108:111], v[40:43], v[216:219], v[108:111]
    v_cvt_pk_bf16_f32 v95, v18, v19
    v_cvt_f32_i32 v224, v224
    v_mfma_f32_16x16x32_bf16 v[108:111], v[44:47], v[220:223], v[108:111]
    s_waitcnt lgkmcnt(2)
    buffer_load_dwordx4 v4, s[4:7], s32 offen offset:1024 sc1 lds
    v_mfma_f32_16x16x32_bf16 v[176:179], v[24:27], a[192:195], v[128:131]
    ds_read_b128 v[40:43], v2 offset:12416
    v_cvt_f32_i32 v225, v225
    v_mfma_f32_16x16x32_bf16 v[176:179], v[28:31], a[196:199], v[176:179]
    s_mov_b32 s30, s29
    v_exp_f32 v16, v160
    v_mfma_f32_16x16x32_bf16 v[180:183], v[24:27], a[216:219], v[132:135]
    v_exp_f32 v17, v161
    v_mfma_f32_16x16x32_bf16 v[180:183], v[28:31], a[220:223], v[180:183]
    buffer_load_dwordx4 v4, s[4:7], s32 offen offset:2048 sc1 lds
    v_mfma_f32_16x16x32_bf16 v[184:187], v[24:27], a[240:243], v[136:139]
    s_add_u32 s32, s32, 24576
    ds_read_b128 v[44:47], v3 offset:12416
    v_mfma_f32_16x16x32_bf16 v[184:187], v[28:31], a[244:247], v[184:187]
    v_exp_f32 v18, v162
    v_mfma_f32_16x16x32_bf16 v[188:191], v[24:27], v[200:203], v[140:143]
    s_add_u32 s26, s26, 12288
    v_add_f32 v5, v5, v16
    v_add_f32 v5, v5, v17
    v_mfma_f32_16x16x32_bf16 v[188:191], v[28:31], v[204:207], v[188:191]
    s_waitcnt lgkmcnt(2)
    v_exp_f32 v19, v163
    v_mfma_f32_16x16x32_bf16 v[112:115], v[32:35], a[192:195], v[128:131]
    s_mov_b32 m0, s26
    ds_read_b128 v[24:27], v2 offset:18560
    v_cvt_pk_bf16_f32 v160, v16, v17
    v_mfma_f32_16x16x32_bf16 v[112:115], v[36:39], a[196:199], v[112:115]
    v_exp_f32 v16, v96
    v_mfma_f32_16x16x32_bf16 v[116:119], v[32:35], a[216:219], v[132:135]
    v_add_f32 v5, v5, v18
    v_fma_f32 v224, v224, v48, v50
    v_mfma_f32_16x16x32_bf16 v[116:119], v[36:39], a[220:223], v[116:119]
    v_add_f32 v5, v5, v19
    v_fma_f32 v225, v225, v49, v51
    v_mfma_f32_16x16x32_bf16 v[120:123], v[32:35], a[240:243], v[136:139]
    ds_read_b128 v[28:31], v3 offset:18560
    v_add_u32 v1, s3, v1
    v_mfma_f32_16x16x32_bf16 v[120:123], v[36:39], a[244:247], v[120:123]
    buffer_load_dwordx4 v4, s[4:7], s32 offen offset:0 sc1 lds
    v_mfma_f32_16x16x32_bf16 v[124:127], v[32:35], v[200:203], v[140:143]
    v_exp_f32 v17, v97
    v_mfma_f32_16x16x32_bf16 v[124:127], v[36:39], v[204:207], v[124:127]
    s_waitcnt lgkmcnt(2)
    v_cvt_pk_bf16_f32 v161, v18, v19
    v_mfma_f32_16x16x32_bf16 v[176:179], v[40:43], a[200:203], v[176:179]
    ds_read_b128 v[32:35], v2 offset:12544
    v_cvt_pk_bf16_f32 v224, v224, v225
    v_mfma_f32_16x16x32_bf16 v[176:179], v[44:47], a[204:207], v[176:179]
    buffer_load_dwordx4 v4, s[4:7], s32 offen offset:1024 sc1 lds
    v_mfma_f32_16x16x32_bf16 v[180:183], v[40:43], a[224:227], v[180:183]
    v_exp_f32 v18, v98
    v_mfma_f32_16x16x32_bf16 v[180:183], v[44:47], a[228:231], v[180:183]
    v_add_f32 v5, v5, v16
    v_add_f32 v5, v5, v17
    v_mfma_f32_16x16x32_bf16 v[184:187], v[40:43], a[248:251], v[184:187]
    ds_read_b128 v[36:39], v3 offset:12544
    v_mfma_f32_16x16x32_bf16 v[184:187], v[44:47], a[252:255], v[184:187]
    buffer_load_dwordx4 v4, s[4:7], s32 offen offset:2048 sc1 lds
    v_mfma_f32_16x16x32_bf16 v[188:191], v[40:43], v[208:211], v[188:191]
    v_exp_f32 v19, v99
    v_mfma_f32_16x16x32_bf16 v[188:191], v[44:47], v[212:215], v[188:191]
    s_waitcnt lgkmcnt(2)
    v_cvt_pk_bf16_f32 v162, v16, v17
    v_cvt_f32_i32 v228, v228
    v_mfma_f32_16x16x32_bf16 v[112:115], v[24:27], a[200:203], v[112:115]
    ds_read_b128 v[40:43], v2 offset:18688
    v_mfma_f32_16x16x32_bf16 v[112:115], v[28:31], a[204:207], v[112:115]
    v_exp_f32 v16, v164
    v_mfma_f32_16x16x32_bf16 v[116:119], v[24:27], a[224:227], v[116:119]
    v_add_f32 v5, v5, v18
    v_add_f32 v5, v5, v19
    v_mfma_f32_16x16x32_bf16 v[116:119], v[28:31], a[228:231], v[116:119]
    s_add_u32 s32, s32, 24576
    v_exp_f32 v17, v165
    v_mfma_f32_16x16x32_bf16 v[120:123], v[24:27], a[248:251], v[120:123]
    s_add_u32 s26, s26, 36864
    ds_read_b128 v[44:47], v3 offset:18688
    v_cvt_pk_bf16_f32 v163, v18, v19
    v_mfma_f32_16x16x32_bf16 v[120:123], v[28:31], a[252:255], v[120:123]
    s_waitcnt lgkmcnt(2)
    v_exp_f32 v18, v166
    v_mfma_f32_16x16x32_bf16 v[124:127], v[24:27], v[208:211], v[124:127]
    s_waitcnt vmcnt(6)
    v_add_f32 v6, v6, v16
    v_add_f32 v6, v6, v17
    v_mfma_f32_16x16x32_bf16 v[124:127], v[28:31], v[212:215], v[124:127]
    s_barrier
    s_sub_u32 s57, s26, 147456
    v_mfma_f32_16x16x32_bf16 v[176:179], v[32:35], a[208:211], v[176:179]
    s_min_u32 s26, s26, s57
    ds_read_b128 v[24:27], v1 offset:0
    v_add_u32 v0, 1, v0
    v_mfma_f32_16x16x32_bf16 v[176:179], v[36:39], a[212:215], v[176:179]
    buffer_store_dword v0, v13, s[20:23], 0 offen offset:32 sc1
    v_mfma_f32_16x16x32_bf16 v[180:183], v[32:35], a[232:235], v[180:183]
    v_exp_f32 v19, v167
    v_mfma_f32_16x16x32_bf16 v[180:183], v[36:39], a[236:239], v[180:183]
    v_cvt_pk_bf16_f32 v164, v16, v17
    v_cvt_f32_i32 v229, v229
    v_mfma_f32_16x16x32_bf16 v[184:187], v[32:35], v[192:195], v[184:187]
    ds_read_b128 v[28:31], v1 offset:12288
    v_fma_f32 v228, v228, v48, v50
    v_mfma_f32_16x16x32_bf16 v[184:187], v[36:39], v[196:199], v[184:187]
    v_exp_f32 v16, v100
    v_mfma_f32_16x16x32_bf16 v[188:191], v[32:35], v[216:219], v[188:191]
    v_add_f32 v6, v6, v18
    v_add_f32 v6, v6, v19
    v_mfma_f32_16x16x32_bf16 v[188:191], v[36:39], v[220:223], v[188:191]
    s_waitcnt lgkmcnt(2)
    v_exp_f32 v17, v101
    v_mfma_f32_16x16x32_bf16 v[112:115], v[40:43], a[208:211], v[112:115]
    ds_read_b128 v[32:35], v1 offset:1024
    v_cvt_pk_bf16_f32 v165, v18, v19
    v_mfma_f32_16x16x32_bf16 v[112:115], v[44:47], a[212:215], v[112:115]
    v_exp_f32 v18, v102
    v_mfma_f32_16x16x32_bf16 v[116:119], v[40:43], a[232:235], v[116:119]
    v_add_f32 v6, v6, v16
    v_add_f32 v6, v6, v17
    v_mfma_f32_16x16x32_bf16 v[116:119], v[44:47], a[236:239], v[116:119]
    v_exp_f32 v19, v103
    v_mfma_f32_16x16x32_bf16 v[120:123], v[40:43], v[192:195], v[120:123]
    ds_read_b128 v[36:39], v1 offset:13312
    v_cvt_pk_bf16_f32 v166, v16, v17
    v_mfma_f32_16x16x32_bf16 v[120:123], v[44:47], v[196:199], v[120:123]
    v_add_f32 v6, v6, v18
    v_add_f32 v6, v6, v19
    v_mfma_f32_16x16x32_bf16 v[124:127], v[40:43], v[216:219], v[124:127]
    v_cvt_pk_bf16_f32 v167, v18, v19
    v_mfma_f32_16x16x32_bf16 v[124:127], v[44:47], v[220:223], v[124:127]
    s_waitcnt lgkmcnt(2)
    v_mfma_f32_16x16x32_bf16 a[0:3], v[64:67], v[24:27], a[0:3]
    s_mov_b32 m0, s26
    ds_read_b128 v[40:43], v1 offset:2048
    v_fma_f32 v229, v229, v49, v51
    v_mfma_f32_16x16x32_bf16 a[0:3], v[80:83], v[28:31], a[0:3]
    buffer_load_dwordx2 v[60:61], v10, s[72:75], s36 offen offset:192
    v_mfma_f32_16x16x32_bf16 a[48:51], v[68:71], v[24:27], a[48:51]
    v_exp_f32 v16, v168
    v_mfma_f32_16x16x32_bf16 a[48:51], v[84:87], v[28:31], a[48:51]
    v_exp_f32 v17, v169
    v_mfma_f32_16x16x32_bf16 a[96:99], v[72:75], v[24:27], a[96:99]
    ds_read_b128 v[44:47], v1 offset:14336
    v_cvt_pk_bf16_f32 v228, v228, v229
    v_mfma_f32_16x16x32_bf16 a[96:99], v[88:91], v[28:31], a[96:99]
    buffer_load_dwordx4 v4, s[4:7], s32 offen offset:0 sc1 lds
    v_mfma_f32_16x16x32_bf16 a[144:147], v[76:79], v[24:27], a[144:147]
    v_exp_f32 v18, v170
    v_mfma_f32_16x16x32_bf16 a[144:147], v[92:95], v[28:31], a[144:147]
    s_waitcnt lgkmcnt(2)
    v_add_f32 v7, v7, v16
    v_add_f32 v7, v7, v17
    v_mfma_f32_16x16x32_bf16 a[4:7], v[64:67], v[32:35], a[4:7]
    ds_read_b128 v[24:27], v1 offset:3072
    v_cvt_f32_i32 v232, v232
    v_mfma_f32_16x16x32_bf16 a[4:7], v[80:83], v[36:39], a[4:7]
    buffer_load_dwordx2 v[62:63], v10, s[76:79], s36 offen offset:192
    v_mfma_f32_16x16x32_bf16 a[52:55], v[68:71], v[32:35], a[52:55]
    v_exp_f32 v19, v171
    v_mfma_f32_16x16x32_bf16 a[52:55], v[84:87], v[36:39], a[52:55]
    v_cvt_pk_bf16_f32 v168, v16, v17
    v_cvt_f32_i32 v233, v233
    v_mfma_f32_16x16x32_bf16 a[100:103], v[72:75], v[32:35], a[100:103]
    ds_read_b128 v[28:31], v1 offset:15360
    v_fma_f32 v232, v232, v48, v50
    v_mfma_f32_16x16x32_bf16 a[100:103], v[88:91], v[36:39], a[100:103]
    buffer_load_dwordx4 v[240:243], v9, s[64:67], s33 offen offset:384 nt
    v_mfma_f32_16x16x32_bf16 a[148:151], v[76:79], v[32:35], a[148:151]
    v_exp_f32 v16, v104
    v_mfma_f32_16x16x32_bf16 a[148:151], v[92:95], v[36:39], a[148:151]
    s_waitcnt lgkmcnt(2)
    v_add_f32 v7, v7, v18
    v_add_f32 v7, v7, v19
    v_mfma_f32_16x16x32_bf16 a[8:11], v[64:67], v[40:43], a[8:11]
    ds_read_b128 v[32:35], v1 offset:4096
    v_fma_f32 v233, v233, v49, v51
    v_mfma_f32_16x16x32_bf16 a[8:11], v[80:83], v[44:47], a[8:11]
    buffer_load_dwordx4 v4, s[4:7], s32 offen offset:1024 sc1 lds
    v_mfma_f32_16x16x32_bf16 a[56:59], v[68:71], v[40:43], a[56:59]
    v_exp_f32 v17, v105
    v_mfma_f32_16x16x32_bf16 a[56:59], v[84:87], v[44:47], a[56:59]
    v_cvt_pk_bf16_f32 v169, v18, v19
    v_cvt_pk_bf16_f32 v232, v232, v233
    v_mfma_f32_16x16x32_bf16 a[104:107], v[72:75], v[40:43], a[104:107]
    ds_read_b128 v[36:39], v1 offset:16384
    v_cvt_f32_i32 v236, v236
    v_mfma_f32_16x16x32_bf16 a[104:107], v[88:91], v[44:47], a[104:107]
    buffer_load_dwordx4 v[244:247], v9, s[64:67], s33 offen offset:1920 nt
    v_mfma_f32_16x16x32_bf16 a[152:155], v[76:79], v[40:43], a[152:155]
    v_exp_f32 v18, v106
    v_mfma_f32_16x16x32_bf16 a[152:155], v[92:95], v[44:47], a[152:155]
    s_waitcnt lgkmcnt(2)
    v_add_f32 v7, v7, v16
    v_add_f32 v7, v7, v17
    v_mfma_f32_16x16x32_bf16 a[12:15], v[64:67], v[24:27], a[12:15]
    ds_read_b128 v[40:43], v1 offset:5120
    v_cvt_f32_i32 v237, v237
    v_mfma_f32_16x16x32_bf16 a[12:15], v[80:83], v[28:31], a[12:15]
    buffer_load_dwordx4 v4, s[4:7], s32 offen offset:2048 sc1 lds
    v_mfma_f32_16x16x32_bf16 a[60:63], v[68:71], v[24:27], a[60:63]
    v_exp_f32 v19, v107
    v_mfma_f32_16x16x32_bf16 a[60:63], v[84:87], v[28:31], a[60:63]
    v_cvt_pk_bf16_f32 v170, v16, v17
    v_exp_f32 v16, v172
    v_mfma_f32_16x16x32_bf16 a[108:111], v[72:75], v[24:27], a[108:111]
    ds_read_b128 v[44:47], v1 offset:17408
    v_add_f32 v7, v7, v18
    v_mfma_f32_16x16x32_bf16 a[108:111], v[88:91], v[28:31], a[108:111]
    buffer_load_dwordx4 v[248:251], v9, s[64:67], s34 offen offset:384 nt
    v_add_f32 v7, v7, v19
    v_mfma_f32_16x16x32_bf16 a[156:159], v[76:79], v[24:27], a[156:159]
    s_add_u32 s29, s28, 49152
    v_exp_f32 v17, v173
    v_mfma_f32_16x16x32_bf16 a[156:159], v[92:95], v[28:31], a[156:159]
    s_waitcnt lgkmcnt(2)
    v_cvt_pk_bf16_f32 v171, v18, v19
    v_fma_f32 v236, v236, v48, v50
    v_mfma_f32_16x16x32_bf16 a[16:19], v[64:67], v[32:35], a[16:19]
    s_sub_u32 s3, s29, 147456
    ds_read_b128 v[24:27], v1 offset:6144
    v_fma_f32 v237, v237, v49, v51
    v_mfma_f32_16x16x32_bf16 a[16:19], v[80:83], v[36:39], a[16:19]
    s_add_u32 s32, s32, 24576
    buffer_load_dwordx4 v[252:255], v9, s[64:67], s34 offen offset:1920 nt
    v_mfma_f32_16x16x32_bf16 a[64:67], v[68:71], v[32:35], a[64:67]
    s_min_u32 s29, s29, s3
    v_exp_f32 v18, v174
    v_mfma_f32_16x16x32_bf16 a[64:67], v[84:87], v[36:39], a[64:67]
    v_add_f32 v8, v8, v16
    v_add_f32 v8, v8, v17
    v_mfma_f32_16x16x32_bf16 a[112:115], v[72:75], v[32:35], a[112:115]
    s_add_u32 s26, s26, 12288
    ds_read_b128 v[28:31], v1 offset:18432
    v_cvt_pk_bf16_f32 v236, v236, v237
    v_mfma_f32_16x16x32_bf16 a[112:115], v[88:91], v[36:39], a[112:115]
    v_exp_f32 v19, v175
    v_cvt_pk_bf16_f32 v172, v16, v17
    v_mfma_f32_16x16x32_bf16 a[160:163], v[76:79], v[32:35], a[160:163]
    v_exp_f32 v16, v108
    v_mfma_f32_16x16x32_bf16 a[160:163], v[92:95], v[36:39], a[160:163]
    s_waitcnt lgkmcnt(2)
    v_add_f32 v8, v8, v18
    v_add_f32 v8, v8, v19
    v_mfma_f32_16x16x32_bf16 a[20:23], v[64:67], v[40:43], a[20:23]
    s_sub_u32 s3, s29, s28
    ds_read_b128 v[32:35], v1 offset:7168
    v_lshlrev_b32 v48, 16, v57
    v_mfma_f32_16x16x32_bf16 a[20:23], v[80:83], v[44:47], a[20:23]
    v_exp_f32 v17, v109
    v_mfma_f32_16x16x32_bf16 a[68:71], v[68:71], v[40:43], a[68:71]
    s_mov_b32 m0, s26
    v_cvt_pk_bf16_f32 v173, v18, v19
    v_and_b32 v49, s97, v57
    v_mfma_f32_16x16x32_bf16 a[68:71], v[84:87], v[44:47], a[68:71]
    v_exp_f32 v18, v110
    v_mfma_f32_16x16x32_bf16 a[116:119], v[72:75], v[40:43], a[116:119]
    ds_read_b128 v[36:39], v1 offset:19456
    v_add_f32 v8, v8, v16
    v_mfma_f32_16x16x32_bf16 a[116:119], v[88:91], v[44:47], a[116:119]
    v_add_f32 v8, v8, v17
    v_mfma_f32_16x16x32_bf16 a[164:167], v[76:79], v[40:43], a[164:167]
    s_mov_b32 s28, s29
    v_exp_f32 v19, v111
    v_mfma_f32_16x16x32_bf16 a[164:167], v[92:95], v[44:47], a[164:167]
    s_waitcnt lgkmcnt(2)
    v_cvt_pk_bf16_f32 v174, v16, v17
    v_add_f32 v8, v8, v18
    v_mfma_f32_16x16x32_bf16 a[24:27], v[64:67], v[24:27], a[24:27]
    ds_read_b128 v[40:43], v1 offset:8192
    v_add_f32 v8, v8, v19
    v_mfma_f32_16x16x32_bf16 a[24:27], v[80:83], v[28:31], a[24:27]
    v_cvt_pk_bf16_f32 v175, v18, v19
    v_lshlrev_b32 v50, 16, v59
    v_mfma_f32_16x16x32_bf16 a[72:75], v[68:71], v[24:27], a[72:75]
    v_exp_f32 v16, v176
    v_mfma_f32_16x16x32_bf16 a[72:75], v[84:87], v[28:31], a[72:75]
    buffer_load_dwordx4 v4, s[4:7], s32 offen offset:0 sc1 lds
    v_mfma_f32_16x16x32_bf16 a[120:123], v[72:75], v[24:27], a[120:123]
    ds_read_b128 v[44:47], v1 offset:20480
    v_and_b32 v51, s97, v59
    v_mfma_f32_16x16x32_bf16 a[120:123], v[88:91], v[28:31], a[120:123]
    v_exp_f32 v17, v177
    v_mfma_f32_16x16x32_bf16 a[168:171], v[76:79], v[24:27], a[168:171]
    v_exp_f32 v18, v178
    v_mfma_f32_16x16x32_bf16 a[168:171], v[92:95], v[28:31], a[168:171]
    s_waitcnt lgkmcnt(2)
    v_add_f32 v5, v5, v16
    v_add_f32 v5, v5, v17
    v_mfma_f32_16x16x32_bf16 a[28:31], v[64:67], v[32:35], a[28:31]
    ds_read_b128 v[24:27], v1 offset:9216
    v_mul_f32 v48, s38, v48
    v_mfma_f32_16x16x32_bf16 a[28:31], v[80:83], v[36:39], a[28:31]
    v_exp_f32 v19, v179
    v_mfma_f32_16x16x32_bf16 a[76:79], v[68:71], v[32:35], a[76:79]
    v_cvt_pk_bf16_f32 v176, v16, v17
    v_add_u32 v2, s3, v2
    v_mfma_f32_16x16x32_bf16 a[76:79], v[84:87], v[36:39], a[76:79]
    v_exp_f32 v16, v112
    v_mfma_f32_16x16x32_bf16 a[124:127], v[72:75], v[32:35], a[124:127]
    ds_read_b128 v[28:31], v1 offset:21504
    v_add_f32 v5, v5, v18
    v_mfma_f32_16x16x32_bf16 a[124:127], v[88:91], v[36:39], a[124:127]
    v_add_f32 v5, v5, v19
    v_mul_f32 v49, s38, v49
    v_mfma_f32_16x16x32_bf16 a[172:175], v[76:79], v[32:35], a[172:175]
    v_exp_f32 v17, v113
    v_mfma_f32_16x16x32_bf16 a[172:175], v[92:95], v[36:39], a[172:175]
    s_waitcnt lgkmcnt(2)
    buffer_load_dwordx4 v4, s[4:7], s32 offen offset:1024 sc1 lds
    v_mfma_f32_16x16x32_bf16 a[32:35], v[64:67], v[40:43], a[32:35]
    ds_read_b128 v[32:35], v1 offset:10240
    v_cvt_pk_bf16_f32 v177, v18, v19
    v_mfma_f32_16x16x32_bf16 a[32:35], v[80:83], v[44:47], a[32:35]
    v_exp_f32 v18, v114
    v_mfma_f32_16x16x32_bf16 a[80:83], v[68:71], v[40:43], a[80:83]
    v_add_f32 v5, v5, v16
    v_add_f32 v5, v5, v17
    v_mfma_f32_16x16x32_bf16 a[80:83], v[84:87], v[44:47], a[80:83]
    v_exp_f32 v19, v115
    v_mfma_f32_16x16x32_bf16 a[128:131], v[72:75], v[40:43], a[128:131]
    ds_read_b128 v[36:39], v1 offset:22528
    v_mul_f32_e64 v50, -v50, v48
    v_mfma_f32_16x16x32_bf16 a[128:131], v[88:91], v[44:47], a[128:131]
    v_cvt_pk_bf16_f32 v178, v16, v17
    v_mul_f32_e64 v51, -v51, v49
    v_mfma_f32_16x16x32_bf16 a[176:179], v[76:79], v[40:43], a[176:179]
    v_exp_f32 v16, v180
    v_mfma_f32_16x16x32_bf16 a[176:179], v[92:95], v[44:47], a[176:179]
    s_waitcnt lgkmcnt(2)
    v_add_f32 v5, v5, v18
    v_add_u32 v3, s3, v3
    v_mfma_f32_16x16x32_bf16 a[36:39], v[64:67], v[24:27], a[36:39]
    ds_read_b128 v[40:43], v1 offset:11264
    v_add_f32 v5, v5, v19
    v_mfma_f32_16x16x32_bf16 a[36:39], v[80:83], v[28:31], a[36:39]
    buffer_load_dwordx4 v4, s[4:7], s32 offen offset:2048 sc1 lds
    v_mfma_f32_16x16x32_bf16 a[84:87], v[68:71], v[24:27], a[84:87]
    v_exp_f32 v17, v181
    v_mfma_f32_16x16x32_bf16 a[84:87], v[84:87], v[28:31], a[84:87]
    v_cvt_pk_bf16_f32 v179, v18, v19
    v_cvt_f32_i32 v226, v226
    v_mfma_f32_16x16x32_bf16 a[132:135], v[72:75], v[24:27], a[132:135]
    ds_read_b128 v[44:47], v1 offset:23552
    v_cvt_f32_i32 v227, v227
    v_mfma_f32_16x16x32_bf16 a[132:135], v[88:91], v[28:31], a[132:135]
    s_waitcnt lgkmcnt(2)
    v_exp_f32 v18, v182
    v_mfma_f32_16x16x32_bf16 a[180:183], v[76:79], v[24:27], a[180:183]
    s_waitcnt vmcnt(13)
    v_add_f32 v6, v6, v16
    v_add_f32 v6, v6, v17
    v_mfma_f32_16x16x32_bf16 a[180:183], v[92:95], v[28:31], a[180:183]
    s_barrier
    v_fma_f32 v226, v226, v48, v50
    v_mfma_f32_16x16x32_bf16 a[40:43], v[64:67], v[32:35], a[40:43]
    ds_read_b128 v[24:27], v2 offset:0
    v_fma_f32 v227, v227, v49, v51
    v_mfma_f32_16x16x32_bf16 a[40:43], v[80:83], v[36:39], a[40:43]
    v_exp_f32 v19, v183
    v_mfma_f32_16x16x32_bf16 a[88:91], v[68:71], v[32:35], a[88:91]
    v_cvt_pk_bf16_f32 v180, v16, v17
    v_mfma_f32_16x16x32_bf16 a[88:91], v[84:87], v[36:39], a[88:91]
    v_exp_f32 v16, v116
    v_mfma_f32_16x16x32_bf16 a[136:139], v[72:75], v[32:35], a[136:139]
    ds_read_b128 v[28:31], v3 offset:0
    v_add_f32 v6, v6, v18
    v_mfma_f32_16x16x32_bf16 a[136:139], v[88:91], v[36:39], a[136:139]
    v_add_f32 v6, v6, v19
    v_cvt_pk_bf16_f32 v225, v226, v227
    v_mfma_f32_16x16x32_bf16 a[184:187], v[76:79], v[32:35], a[184:187]
    v_exp_f32 v17, v117
    v_mfma_f32_16x16x32_bf16 a[184:187], v[92:95], v[36:39], a[184:187]
    s_waitcnt lgkmcnt(2)
    v_cvt_pk_bf16_f32 v181, v18, v19
    v_cvt_f32_i32 v230, v230
    v_mfma_f32_16x16x32_bf16 a[44:47], v[64:67], v[40:43], a[44:47]
    ds_read_b128 v[32:35], v2 offset:6144
    v_mfma_f32_16x16x32_bf16 a[44:47], v[80:83], v[44:47], a[44:47]
    v_exp_f32 v18, v118
    v_mfma_f32_16x16x32_bf16 a[92:95], v[68:71], v[40:43], a[92:95]
    v_add_f32 v6, v6, v16
    v_add_f32 v6, v6, v17
    v_mfma_f32_16x16x32_bf16 a[92:95], v[84:87], v[44:47], a[92:95]
    s_add_u32 s32, s32, 24576
    v_exp_f32 v19, v119
    v_mfma_f32_16x16x32_bf16 a[140:143], v[72:75], v[40:43], a[140:143]
    s_add_u32 s26, s26, 36864
    ds_read_b128 v[36:39], v3 offset:6144
    v_cvt_pk_bf16_f32 v182, v16, v17
    v_mfma_f32_16x16x32_bf16 a[140:143], v[88:91], v[44:47], a[140:143]
    s_sub_u32 s57, s26, 147456
    v_add_f32 v6, v6, v18
    v_add_f32 v6, v6, v19
    v_mfma_f32_16x16x32_bf16 a[188:191], v[76:79], v[40:43], a[188:191]
    s_min_u32 s26, s26, s57
    v_cvt_pk_bf16_f32 v183, v18, v19
    v_mfma_f32_16x16x32_bf16 a[188:191], v[92:95], v[44:47], a[188:191]
    s_waitcnt lgkmcnt(2)
    v_mfma_f32_16x16x32_bf16 v[64:67], v[24:27], a[192:195], v[128:131]
    ds_read_b128 v[40:43], v2 offset:128
    v_cvt_f32_i32 v231, v231
    v_mfma_f32_16x16x32_bf16 v[64:67], v[28:31], a[196:199], v[64:67]
    v_exp_f32 v16, v184
    v_mfma_f32_16x16x32_bf16 v[68:71], v[24:27], a[216:219], v[132:135]
    v_exp_f32 v17, v185
    v_mfma_f32_16x16x32_bf16 v[68:71], v[28:31], a[220:223], v[68:71]
    v_bfe_u32 v53, v4, 4, 6
    v_fma_f32 v230, v230, v48, v50
    v_mfma_f32_16x16x32_bf16 v[72:75], v[24:27], a[240:243], v[136:139]
    ds_read_b128 v[44:47], v3 offset:128
    v_lshlrev_b32 v53, 2, v53
    v_mfma_f32_16x16x32_bf16 v[72:75], v[28:31], a[244:247], v[72:75]
    buffer_load_dword v52, v53, s[20:23], s44 offen sc1
    v_mfma_f32_16x16x32_bf16 v[76:79], v[24:27], v[200:203], v[140:143]
    v_exp_f32 v18, v186
    v_mfma_f32_16x16x32_bf16 v[76:79], v[28:31], v[204:207], v[76:79]
    s_waitcnt lgkmcnt(2)
    v_add_f32 v7, v7, v16
    v_add_f32 v7, v7, v17
    v_mfma_f32_16x16x32_bf16 v[96:99], v[32:35], a[192:195], v[128:131]
    ds_read_b128 v[24:27], v2 offset:6272
    v_fma_f32 v231, v231, v49, v51
    v_mfma_f32_16x16x32_bf16 v[96:99], v[36:39], a[196:199], v[96:99]
    v_exp_f32 v19, v187
    v_mfma_f32_16x16x32_bf16 v[100:103], v[32:35], a[216:219], v[132:135]
    v_cvt_pk_bf16_f32 v184, v16, v17
    v_cvt_pk_bf16_f32 v229, v230, v231
    v_mfma_f32_16x16x32_bf16 v[100:103], v[36:39], a[220:223], v[100:103]
    s_add_u32 s35, s35, 196608
    v_exp_f32 v16, v120
    v_mfma_f32_16x16x32_bf16 v[104:107], v[32:35], a[240:243], v[136:139]
    s_mov_b32 m0, s26
    ds_read_b128 v[28:31], v3 offset:6272
    v_add_f32 v7, v7, v18
    v_mfma_f32_16x16x32_bf16 v[104:107], v[36:39], a[244:247], v[104:107]
    s_add_u32 s16, s16, 196608
    buffer_load_dwordx4 v4, s[4:7], s32 offen offset:0 sc1 lds
    v_mfma_f32_16x16x32_bf16 v[108:111], v[32:35], v[200:203], v[140:143]
    s_add_u32 s17, s17, 196608
    v_add_f32 v7, v7, v19
    v_cvt_f32_i32 v234, v234
    v_mfma_f32_16x16x32_bf16 v[108:111], v[36:39], v[204:207], v[108:111]
    s_waitcnt lgkmcnt(2)
    v_exp_f32 v17, v121
    v_mfma_f32_16x16x32_bf16 v[64:67], v[40:43], a[200:203], v[64:67]
    s_add_u32 s37, s37, 512
    ds_read_b128 v[32:35], v2 offset:256
    v_cvt_pk_bf16_f32 v185, v18, v19
    v_mfma_f32_16x16x32_bf16 v[64:67], v[44:47], a[204:207], v[64:67]
    v_exp_f32 v18, v122
    v_mfma_f32_16x16x32_bf16 v[68:71], v[40:43], a[224:227], v[68:71]
    v_add_f32 v7, v7, v16
    v_add_f32 v7, v7, v17
    v_mfma_f32_16x16x32_bf16 v[68:71], v[44:47], a[228:231], v[68:71]
    v_exp_f32 v19, v123
    v_mfma_f32_16x16x32_bf16 v[72:75], v[40:43], a[248:251], v[72:75]
    ds_read_b128 v[36:39], v3 offset:256
    v_cvt_pk_bf16_f32 v186, v16, v17
    v_mfma_f32_16x16x32_bf16 v[72:75], v[44:47], a[252:255], v[72:75]
    buffer_load_dwordx4 v4, s[4:7], s32 offen offset:1024 sc1 lds
    v_mfma_f32_16x16x32_bf16 v[76:79], v[40:43], v[208:211], v[76:79]
    v_exp_f32 v16, v188
    v_mfma_f32_16x16x32_bf16 v[76:79], v[44:47], v[212:215], v[76:79]
    s_waitcnt lgkmcnt(2)
    v_add_f32 v7, v7, v18
    v_cvt_f32_i32 v235, v235
    v_mfma_f32_16x16x32_bf16 v[96:99], v[24:27], a[200:203], v[96:99]
    ds_read_b128 v[40:43], v2 offset:6400
    v_add_f32 v7, v7, v19
    v_mfma_f32_16x16x32_bf16 v[96:99], v[28:31], a[204:207], v[96:99]
    buffer_load_dwordx2 v[56:57], off, s[80:83], s37 offset:0
    v_mfma_f32_16x16x32_bf16 v[100:103], v[24:27], a[224:227], v[100:103]
    v_exp_f32 v17, v189
    v_mfma_f32_16x16x32_bf16 v[100:103], v[28:31], a[228:231], v[100:103]
    v_cvt_pk_bf16_f32 v187, v18, v19
    v_fma_f32 v234, v234, v48, v50
    v_mfma_f32_16x16x32_bf16 v[104:107], v[24:27], a[248:251], v[104:107]
    ds_read_b128 v[44:47], v3 offset:6400
    v_fma_f32 v235, v235, v49, v51
    v_mfma_f32_16x16x32_bf16 v[104:107], v[28:31], a[252:255], v[104:107]
    buffer_load_dwordx2 v[58:59], off, s[84:87], s37 offset:0
    v_mfma_f32_16x16x32_bf16 v[108:111], v[24:27], v[208:211], v[108:111]
    s_add_u32 s29, s30, 49152
    v_exp_f32 v18, v190
    v_mfma_f32_16x16x32_bf16 v[108:111], v[28:31], v[212:215], v[108:111]
    s_waitcnt lgkmcnt(2)
    v_add_f32 v8, v8, v16
    v_add_f32 v8, v8, v17
    v_mfma_f32_16x16x32_bf16 v[64:67], v[32:35], a[208:211], v[64:67]
    s_sub_u32 s3, s29, 147456
    ds_read_b128 v[24:27], v2 offset:12288
    v_cvt_pk_bf16_f32 v233, v234, v235
    v_mfma_f32_16x16x32_bf16 v[64:67], v[36:39], a[212:215], v[64:67]
    s_min_u32 s29, s29, s3
    buffer_load_dwordx4 v4, s[4:7], s32 offen offset:2048 sc1 lds
    v_mfma_f32_16x16x32_bf16 v[68:71], v[32:35], a[232:235], v[68:71]
    v_exp_f32 v19, v191
    v_mfma_f32_16x16x32_bf16 v[68:71], v[36:39], a[236:239], v[68:71]
    v_cvt_pk_bf16_f32 v188, v16, v17
    v_cvt_f32_i32 v238, v238
    v_mfma_f32_16x16x32_bf16 v[72:75], v[32:35], v[192:195], v[72:75]
    ds_read_b128 v[28:31], v3 offset:12288
    v_mfma_f32_16x16x32_bf16 v[72:75], v[36:39], v[196:199], v[72:75]
    buffer_load_dwordx4 v[144:147], v12, s[68:71], s35 offen offset:0 nt
    v_mfma_f32_16x16x32_bf16 v[76:79], v[32:35], v[216:219], v[76:79]
    v_exp_f32 v16, v124
    v_mfma_f32_16x16x32_bf16 v[76:79], v[36:39], v[220:223], v[76:79]
    s_waitcnt lgkmcnt(2)
    v_add_f32 v8, v8, v18
    v_add_f32 v8, v8, v19
    v_mfma_f32_16x16x32_bf16 v[96:99], v[40:43], a[208:211], v[96:99]
    s_add_u32 s32, s32, 24576
    ds_read_b128 v[32:35], v2 offset:18432
    v_cvt_f32_i32 v239, v239
    v_mfma_f32_16x16x32_bf16 v[96:99], v[44:47], a[212:215], v[96:99]
    s_sub_u32 s3, s29, s30
    v_exp_f32 v17, v125
    v_mfma_f32_16x16x32_bf16 v[100:103], v[40:43], a[232:235], v[100:103]
    v_cvt_pk_bf16_f32 v189, v18, v19
    v_fma_f32 v238, v238, v48, v50
    v_mfma_f32_16x16x32_bf16 v[100:103], v[44:47], a[236:239], v[100:103]
    v_exp_f32 v18, v126
    v_mfma_f32_16x16x32_bf16 v[104:107], v[40:43], v[192:195], v[104:107]
    s_add_u32 s26, s26, 12288
    ds_read_b128 v[36:39], v3 offset:18432
    v_add_f32 v8, v8, v16
    v_mfma_f32_16x16x32_bf16 v[104:107], v[44:47], v[196:199], v[104:107]
    buffer_load_dwordx4 v[148:151], v12, s[68:71], s35 offen offset:768 nt
    v_mfma_f32_16x16x32_bf16 v[108:111], v[40:43], v[216:219], v[108:111]
    v_add_f32 v8, v8, v17
    v_fma_f32 v239, v239, v49, v51
    v_mfma_f32_16x16x32_bf16 v[108:111], v[44:47], v[220:223], v[108:111]
    s_waitcnt lgkmcnt(2)
    v_exp_f32 v19, v127
    v_mfma_f32_16x16x32_bf16 v[80:83], v[24:27], a[192:195], v[128:131]
    ds_read_b128 v[40:43], v2 offset:12416
    v_cvt_pk_bf16_f32 v190, v16, v17
    v_mfma_f32_16x16x32_bf16 v[80:83], v[28:31], a[196:199], v[80:83]
    s_mov_b32 m0, s26
    v_add_f32 v8, v8, v18
    v_add_f32 v8, v8, v19
    v_mfma_f32_16x16x32_bf16 v[84:87], v[24:27], a[216:219], v[132:135]
    s_mov_b32 s30, s29
    v_cvt_pk_bf16_f32 v191, v18, v19
    v_cvt_pk_bf16_f32 v237, v238, v239
    v_mfma_f32_16x16x32_bf16 v[84:87], v[28:31], a[220:223], v[84:87]
    v_exp_f32 v16, v64
    v_mfma_f32_16x16x32_bf16 v[88:91], v[24:27], a[240:243], v[136:139]
    ds_read_b128 v[44:47], v3 offset:12416
    v_mfma_f32_16x16x32_bf16 v[88:91], v[28:31], a[244:247], v[88:91]
    buffer_load_dwordx4 v[152:155], v12, s[68:71], s35 offen offset:1536 nt
    v_mfma_f32_16x16x32_bf16 v[92:95], v[24:27], v[200:203], v[140:143]
    v_exp_f32 v17, v65
    v_mfma_f32_16x16x32_bf16 v[92:95], v[28:31], v[204:207], v[92:95]
    s_waitcnt lgkmcnt(2)
    v_exp_f32 v18, v66
    v_mfma_f32_16x16x32_bf16 v[112:115], v[32:35], a[192:195], v[128:131]
    ds_read_b128 v[24:27], v2 offset:18560
    v_add_f32 v5, v5, v16
    v_mfma_f32_16x16x32_bf16 v[112:115], v[36:39], a[196:199], v[112:115]
    buffer_load_dwordx4 v4, s[4:7], s32 offen offset:0 sc1 lds
    v_mfma_f32_16x16x32_bf16 v[116:119], v[32:35], a[216:219], v[132:135]
    v_add_f32 v5, v5, v17
    v_add_u32 v1, s3, v1
    v_mfma_f32_16x16x32_bf16 v[116:119], v[36:39], a[220:223], v[116:119]
    v_exp_f32 v19, v67
    v_mfma_f32_16x16x32_bf16 v[120:123], v[32:35], a[240:243], v[136:139]
    ds_read_b128 v[28:31], v3 offset:18560
    v_cvt_pk_bf16_f32 v64, v16, v17
    v_mfma_f32_16x16x32_bf16 v[120:123], v[36:39], a[244:247], v[120:123]
    s_waitcnt vmcnt(13)
    buffer_load_dwordx4 v[156:159], v12, s[68:71], s35 offen offset:2304 nt
    v_mfma_f32_16x16x32_bf16 v[124:127], v[32:35], v[200:203], v[140:143]
    v_exp_f32 v16, v96
    v_mfma_f32_16x16x32_bf16 v[124:127], v[36:39], v[204:207], v[124:127]
    s_waitcnt lgkmcnt(2)
    v_add_f32 v5, v5, v18
    v_add_f32 v5, v5, v19
    v_mfma_f32_16x16x32_bf16 v[80:83], v[40:43], a[200:203], v[80:83]
    ds_read_b128 v[32:35], v2 offset:12544
    v_lshlrev_b32 v48, 16, v60
    v_mfma_f32_16x16x32_bf16 v[80:83], v[44:47], a[204:207], v[80:83]
    v_exp_f32 v17, v97
    v_mfma_f32_16x16x32_bf16 v[84:87], v[40:43], a[224:227], v[84:87]
    v_cvt_pk_bf16_f32 v65, v18, v19
    v_and_b32 v49, s97, v60
    v_mfma_f32_16x16x32_bf16 v[84:87], v[44:47], a[228:231], v[84:87]
    buffer_load_dwordx4 v4, s[4:7], s32 offen offset:1024 sc1 lds
    v_mfma_f32_16x16x32_bf16 v[88:91], v[40:43], a[248:251], v[88:91]
    ds_read_b128 v[36:39], v3 offset:12544
    v_lshlrev_b32 v50, 16, v62
    v_mfma_f32_16x16x32_bf16 v[88:91], v[44:47], a[252:255], v[88:91]
    v_exp_f32 v18, v98
    v_mfma_f32_16x16x32_bf16 v[92:95], v[40:43], v[208:211], v[92:95]
    v_add_f32 v5, v5, v16
    v_add_f32 v5, v5, v17
    v_mfma_f32_16x16x32_bf16 v[92:95], v[44:47], v[212:215], v[92:95]
    s_waitcnt lgkmcnt(2)
    v_exp_f32 v19, v99
    v_mfma_f32_16x16x32_bf16 v[112:115], v[24:27], a[200:203], v[112:115]
    ds_read_b128 v[40:43], v2 offset:18688
    v_cvt_pk_bf16_f32 v66, v16, v17
    v_mfma_f32_16x16x32_bf16 v[112:115], v[28:31], a[204:207], v[112:115]
    v_exp_f32 v16, v68
    v_mfma_f32_16x16x32_bf16 v[116:119], v[24:27], a[224:227], v[116:119]
    v_add_f32 v5, v5, v18
    v_add_f32 v5, v5, v19
    v_mfma_f32_16x16x32_bf16 v[116:119], v[28:31], a[228:231], v[116:119]
    v_exp_f32 v17, v69
    v_mfma_f32_16x16x32_bf16 v[120:123], v[24:27], a[248:251], v[120:123]
    ds_read_b128 v[44:47], v3 offset:18688
    v_cvt_pk_bf16_f32 v67, v18, v19
    v_mfma_f32_16x16x32_bf16 v[120:123], v[28:31], a[252:255], v[120:123]
    s_waitcnt lgkmcnt(2)
    buffer_load_dwordx4 v4, s[4:7], s32 offen offset:2048 sc1 lds
    v_mfma_f32_16x16x32_bf16 v[124:127], v[24:27], v[208:211], v[124:127]
    s_waitcnt vmcnt(36)
    v_exp_f32 v18, v70
    v_mfma_f32_16x16x32_bf16 v[124:127], v[28:31], v[212:215], v[124:127]
    s_barrier
    v_add_f32 v6, v6, v16
    v_mfma_f32_16x16x32_bf16 v[80:83], v[32:35], a[208:211], v[80:83]
    ds_read_b128 v[24:27], v1 offset:0
    v_add_f32 v6, v6, v17
    v_mfma_f32_16x16x32_bf16 v[80:83], v[36:39], a[212:215], v[80:83]
    v_exp_f32 v19, v71
    v_mfma_f32_16x16x32_bf16 v[84:87], v[32:35], a[232:235], v[84:87]
    v_cvt_pk_bf16_f32 v68, v16, v17
    v_and_b32 v51, s97, v62
    v_mfma_f32_16x16x32_bf16 v[84:87], v[36:39], a[236:239], v[84:87]
    v_exp_f32 v16, v100
    v_mfma_f32_16x16x32_bf16 v[88:91], v[32:35], v[192:195], v[88:91]
    ds_read_b128 v[28:31], v1 offset:12288
    v_add_f32 v6, v6, v18
    v_mfma_f32_16x16x32_bf16 v[88:91], v[36:39], v[196:199], v[88:91]
    v_add_f32 v6, v6, v19
    v_mul_f32 v48, s38, v48
    v_mfma_f32_16x16x32_bf16 v[92:95], v[32:35], v[216:219], v[92:95]
    v_exp_f32 v17, v101
    v_mfma_f32_16x16x32_bf16 v[92:95], v[36:39], v[220:223], v[92:95]
    s_waitcnt lgkmcnt(2)
    v_cvt_pk_bf16_f32 v69, v18, v19
    v_mul_f32 v49, s38, v49
    v_mfma_f32_16x16x32_bf16 v[112:115], v[40:43], a[208:211], v[112:115]
    ds_read_b128 v[32:35], v1 offset:1024
    v_mul_f32_e64 v50, -v50, v48
    v_mfma_f32_16x16x32_bf16 v[112:115], v[44:47], a[212:215], v[112:115]
    v_exp_f32 v18, v102
    v_mfma_f32_16x16x32_bf16 v[116:119], v[40:43], a[232:235], v[116:119]
    v_add_f32 v6, v6, v16
    v_add_f32 v6, v6, v17
    v_mfma_f32_16x16x32_bf16 v[116:119], v[44:47], a[236:239], v[116:119]
    v_exp_f32 v19, v103
    v_mfma_f32_16x16x32_bf16 v[120:123], v[40:43], v[192:195], v[120:123]
    ds_read_b128 v[36:39], v1 offset:13312
    v_cvt_pk_bf16_f32 v70, v16, v17
    v_mfma_f32_16x16x32_bf16 v[120:123], v[44:47], v[196:199], v[120:123]
    s_add_u32 s32, s32, 24576
    v_add_f32 v6, v6, v18
    v_mul_f32_e64 v51, -v51, v49
    v_mfma_f32_16x16x32_bf16 v[124:127], v[40:43], v[216:219], v[124:127]
    s_add_u32 s26, s26, 36864
    v_add_f32 v6, v6, v19
    s_sub_u32 s57, s26, 147456
    v_mfma_f32_16x16x32_bf16 v[124:127], v[44:47], v[220:223], v[124:127]
    s_waitcnt lgkmcnt(2)
    v_cvt_pk_bf16_f32 v71, v18, v19
    s_min_u32 s26, s26, s57
    v_mfma_f32_16x16x32_bf16 a[0:3], v[160:163], v[24:27], a[0:3]
    ds_read_b128 v[40:43], v1 offset:2048
    v_cvt_f32_i32 v240, v240
    v_mfma_f32_16x16x32_bf16 a[0:3], v[176:179], v[28:31], a[0:3]
    s_waitcnt vmcnt(12)
    v_subrev_u32 v52, s92, v52
    v_cmp_lt_u32 vcc, 15, v52
    v_mfma_f32_16x16x32_bf16 a[48:51], v[164:167], v[24:27], a[48:51]
    v_exp_f32 v16, v72
    v_mfma_f32_16x16x32_bf16 a[48:51], v[180:183], v[28:31], a[48:51]
    v_exp_f32 v17, v73
    v_mfma_f32_16x16x32_bf16 a[96:99], v[168:171], v[24:27], a[96:99]
    s_and_b32 s59, vcc_lo, 0xff
    ds_read_b128 v[44:47], v1 offset:14336
    v_cvt_f32_i32 v241, v241
    v_mfma_f32_16x16x32_bf16 a[96:99], v[184:187], v[28:31], a[96:99]
    s_cbranch_scc1 L_pollslow2
L_pollok2:
    v_mfma_f32_16x16x32_bf16 a[144:147], v[172:175], v[24:27], a[144:147]
    s_add_u32 s92, s92, 1
    v_exp_f32 v18, v74
    v_mfma_f32_16x16x32_bf16 a[144:147], v[188:191], v[28:31], a[144:147]
    s_waitcnt lgkmcnt(2)
    v_add_f32 v7, v7, v16
    v_add_f32 v7, v7, v17
    v_mfma_f32_16x16x32_bf16 a[4:7], v[160:163], v[32:35], a[4:7]
    s_mov_b32 m0, s56
    ds_read_b128 v[24:27], v1 offset:3072
    v_fma_f32 v240, v240, v48, v50
    v_mfma_f32_16x16x32_bf16 a[4:7], v[176:179], v[36:39], a[4:7]
    buffer_load_dwordx4 v4, s[4:7], s27 offen offset:0 sc1 lds
    v_mfma_f32_16x16x32_bf16 a[52:55], v[164:167], v[32:35], a[52:55]
    v_exp_f32 v19, v75
    v_mfma_f32_16x16x32_bf16 a[52:55], v[180:183], v[36:39], a[52:55]
    v_cvt_pk_bf16_f32 v72, v16, v17
    v_fma_f32 v241, v241, v49, v51
    v_mfma_f32_16x16x32_bf16 a[100:103], v[168:171], v[32:35], a[100:103]
    ds_read_b128 v[28:31], v1 offset:15360
    v_cvt_pk_bf16_f32 v226, v240, v241
    v_mfma_f32_16x16x32_bf16 a[100:103], v[184:187], v[36:39], a[100:103]
    v_exp_f32 v16, v104
    v_mfma_f32_16x16x32_bf16 a[148:151], v[172:175], v[32:35], a[148:151]
    v_add_f32 v7, v7, v18
    v_add_f32 v7, v7, v19
    v_mfma_f32_16x16x32_bf16 a[148:151], v[188:191], v[36:39], a[148:151]
    s_waitcnt lgkmcnt(2)
    v_exp_f32 v17, v105
    v_mfma_f32_16x16x32_bf16 a[8:11], v[160:163], v[40:43], a[8:11]
    ds_read_b128 v[32:35], v1 offset:4096
    v_cvt_pk_bf16_f32 v73, v18, v19
    v_mfma_f32_16x16x32_bf16 a[8:11], v[176:179], v[44:47], a[8:11]
    buffer_load_dwordx4 v4, s[4:7], s27 offen offset:1024 sc1 lds
    v_mfma_f32_16x16x32_bf16 a[56:59], v[164:167], v[40:43], a[56:59]
    v_exp_f32 v18, v106
    v_mfma_f32_16x16x32_bf16 a[56:59], v[180:183], v[44:47], a[56:59]
    v_add_f32 v7, v7, v16
    v_cvt_f32_i32 v244, v244
    v_mfma_f32_16x16x32_bf16 a[104:107], v[168:171], v[40:43], a[104:107]
    ds_read_b128 v[36:39], v1 offset:16384
    v_add_f32 v7, v7, v17
    v_mfma_f32_16x16x32_bf16 a[104:107], v[184:187], v[44:47], a[104:107]
    v_exp_f32 v19, v107
    v_mfma_f32_16x16x32_bf16 a[152:155], v[172:175], v[40:43], a[152:155]
    v_cvt_f32_i32 v245, v245
    v_cvt_pk_bf16_f32 v74, v16, v17
    v_mfma_f32_16x16x32_bf16 a[152:155], v[188:191], v[44:47], a[152:155]
    s_waitcnt lgkmcnt(2)
    v_exp_f32 v16, v76
    v_mfma_f32_16x16x32_bf16 a[12:15], v[160:163], v[24:27], a[12:15]
    ds_read_b128 v[40:43], v1 offset:5120
    v_fma_f32 v244, v244, v48, v50
    v_mfma_f32_16x16x32_bf16 a[12:15], v[176:179], v[28:31], a[12:15]
    buffer_load_dwordx4 v4, s[4:7], s27 offen offset:2048 sc1 lds
    v_mfma_f32_16x16x32_bf16 a[60:63], v[164:167], v[24:27], a[60:63]
    v_add_f32 v7, v7, v18
    v_add_f32 v7, v7, v19
    v_mfma_f32_16x16x32_bf16 a[60:63], v[180:183], v[28:31], a[60:63]
    v_exp_f32 v17, v77
    v_mfma_f32_16x16x32_bf16 a[108:111], v[168:171], v[24:27], a[108:111]
    ds_read_b128 v[44:47], v1 offset:17408
    v_fma_f32 v245, v245, v49, v51
    v_mfma_f32_16x16x32_bf16 a[108:111], v[184:187], v[28:31], a[108:111]
    v_cvt_pk_bf16_f32 v75, v18, v19
    v_cvt_pk_bf16_f32 v230, v244, v245
    v_mfma_f32_16x16x32_bf16 a[156:159], v[172:175], v[24:27], a[156:159]
    s_add_u32 s29, s28, 49152
    v_exp_f32 v18, v78
    v_mfma_f32_16x16x32_bf16 a[156:159], v[188:191], v[28:31], a[156:159]
    s_waitcnt lgkmcnt(2)
    v_add_f32 v8, v8, v16
    v_cvt_f32_i32 v248, v248
    v_mfma_f32_16x16x32_bf16 a[16:19], v[160:163], v[32:35], a[16:19]
    s_sub_u32 s3, s29, 147456
    ds_read_b128 v[24:27], v1 offset:6144
    v_add_f32 v8, v8, v17
    v_mfma_f32_16x16x32_bf16 a[16:19], v[176:179], v[36:39], a[16:19]
    s_add_u32 s27, s27, 24576
    v_exp_f32 v19, v79
    v_mfma_f32_16x16x32_bf16 a[64:67], v[164:167], v[32:35], a[64:67]
    s_min_u32 s29, s29, s3
    v_cvt_f32_i32 v249, v249
    v_cvt_pk_bf16_f32 v76, v16, v17
    v_mfma_f32_16x16x32_bf16 a[64:67], v[180:183], v[36:39], a[64:67]
    s_add_u32 s56, s56, 12288
    v_exp_f32 v16, v108
    v_mfma_f32_16x16x32_bf16 a[112:115], v[168:171], v[32:35], a[112:115]
    ds_read_b128 v[28:31], v1 offset:18432
    v_fma_f32 v248, v248, v48, v50
    v_mfma_f32_16x16x32_bf16 a[112:115], v[184:187], v[36:39], a[112:115]
    v_add_f32 v8, v8, v18
    v_fma_f32 v249, v249, v49, v51
    v_mfma_f32_16x16x32_bf16 a[160:163], v[172:175], v[32:35], a[160:163]
    v_add_f32 v8, v8, v19
    v_cvt_pk_bf16_f32 v234, v248, v249
    v_mfma_f32_16x16x32_bf16 a[160:163], v[188:191], v[36:39], a[160:163]
    s_waitcnt lgkmcnt(2)
    v_exp_f32 v17, v109
    v_mfma_f32_16x16x32_bf16 a[20:23], v[160:163], v[40:43], a[20:23]
    s_mov_b32 m0, s56
    ds_read_b128 v[32:35], v1 offset:7168
    v_cvt_pk_bf16_f32 v77, v18, v19
    v_mfma_f32_16x16x32_bf16 a[20:23], v[176:179], v[44:47], a[20:23]
    s_sub_u32 s3, s29, s28
    v_exp_f32 v18, v110
    v_mfma_f32_16x16x32_bf16 a[68:71], v[164:167], v[40:43], a[68:71]
    v_cvt_f32_i32 v252, v252
    v_add_f32 v8, v8, v16
    v_mfma_f32_16x16x32_bf16 a[68:71], v[180:183], v[44:47], a[68:71]
    v_add_f32 v8, v8, v17
    v_cvt_f32_i32 v253, v253
    v_mfma_f32_16x16x32_bf16 a[116:119], v[168:171], v[40:43], a[116:119]
    ds_read_b128 v[36:39], v1 offset:19456
    v_fma_f32 v252, v252, v48, v50
    v_mfma_f32_16x16x32_bf16 a[116:119], v[184:187], v[44:47], a[116:119]
    buffer_load_dwordx4 v4, s[4:7], s27 offen offset:0 sc1 lds
    v_mfma_f32_16x16x32_bf16 a[164:167], v[172:175], v[40:43], a[164:167]
    s_mov_b32 s28, s29
    v_exp_f32 v19, v111
    v_mfma_f32_16x16x32_bf16 a[164:167], v[188:191], v[44:47], a[164:167]
    s_waitcnt lgkmcnt(2)
    v_cvt_pk_bf16_f32 v78, v16, v17
    v_add_f32 v8, v8, v18
    v_mfma_f32_16x16x32_bf16 a[24:27], v[160:163], v[24:27], a[24:27]
    ds_read_b128 v[40:43], v1 offset:8192
    v_add_f32 v8, v8, v19
    v_mfma_f32_16x16x32_bf16 a[24:27], v[176:179], v[28:31], a[24:27]
    v_cvt_pk_bf16_f32 v79, v18, v19
    v_fma_f32 v253, v253, v49, v51
    v_mfma_f32_16x16x32_bf16 a[72:75], v[164:167], v[24:27], a[72:75]
    v_exp_f32 v16, v80
    v_mfma_f32_16x16x32_bf16 a[72:75], v[180:183], v[28:31], a[72:75]
    v_exp_f32 v17, v81
    v_mfma_f32_16x16x32_bf16 a[120:123], v[168:171], v[24:27], a[120:123]
    ds_read_b128 v[44:47], v1 offset:20480
    v_cvt_pk_bf16_f32 v238, v252, v253
    v_mfma_f32_16x16x32_bf16 a[120:123], v[184:187], v[28:31], a[120:123]
    v_exp_f32 v18, v82
    v_mfma_f32_16x16x32_bf16 a[168:171], v[172:175], v[24:27], a[168:171]
    v_lshlrev_b32 v48, 16, v61
    v_add_f32 v5, v5, v16
    v_mfma_f32_16x16x32_bf16 a[168:171], v[188:191], v[28:31], a[168:171]
    s_waitcnt lgkmcnt(2)
    buffer_load_dwordx4 v4, s[4:7], s27 offen offset:1024 sc1 lds
    v_mfma_f32_16x16x32_bf16 a[28:31], v[160:163], v[32:35], a[28:31]
    ds_read_b128 v[24:27], v1 offset:9216
    v_add_f32 v5, v5, v17
    v_mfma_f32_16x16x32_bf16 a[28:31], v[176:179], v[36:39], a[28:31]
    v_exp_f32 v19, v83
    v_mfma_f32_16x16x32_bf16 a[76:79], v[164:167], v[32:35], a[76:79]
    v_and_b32 v49, s97, v61
    v_cvt_pk_bf16_f32 v80, v16, v17
    v_mfma_f32_16x16x32_bf16 a[76:79], v[180:183], v[36:39], a[76:79]
    v_exp_f32 v16, v112
    v_mfma_f32_16x16x32_bf16 a[124:127], v[168:171], v[32:35], a[124:127]
    ds_read_b128 v[28:31], v1 offset:21504
    v_lshlrev_b32 v50, 16, v63
    v_mfma_f32_16x16x32_bf16 a[124:127], v[184:187], v[36:39], a[124:127]
    v_add_f32 v5, v5, v18
    v_and_b32 v51, s97, v63
    v_mfma_f32_16x16x32_bf16 a[172:175], v[172:175], v[32:35], a[172:175]
    v_add_f32 v5, v5, v19
    v_mul_f32 v48, s38, v48
    v_mfma_f32_16x16x32_bf16 a[172:175], v[188:191], v[36:39], a[172:175]
    s_waitcnt lgkmcnt(2)
    buffer_load_dwordx4 v4, s[4:7], s27 offen offset:2048 sc1 lds
    v_mfma_f32_16x16x32_bf16 a[32:35], v[160:163], v[40:43], a[32:35]
    ds_read_b128 v[32:35], v1 offset:10240
    v_mul_f32 v49, s38, v49
    v_mfma_f32_16x16x32_bf16 a[32:35], v[176:179], v[44:47], a[32:35]
    v_exp_f32 v17, v113
    v_mfma_f32_16x16x32_bf16 a[80:83], v[164:167], v[40:43], a[80:83]
    v_cvt_pk_bf16_f32 v81, v18, v19
    v_mul_f32_e64 v50, -v50, v48
    v_mfma_f32_16x16x32_bf16 a[80:83], v[180:183], v[44:47], a[80:83]
    v_exp_f32 v18, v114
    v_mfma_f32_16x16x32_bf16 a[128:131], v[168:171], v[40:43], a[128:131]
    ds_read_b128 v[36:39], v1 offset:22528
    v_add_f32 v5, v5, v16
    v_mfma_f32_16x16x32_bf16 a[128:131], v[184:187], v[44:47], a[128:131]
    v_add_f32 v5, v5, v17
    v_mul_f32_e64 v51, -v51, v49
    v_mfma_f32_16x16x32_bf16 a[176:179], v[172:175], v[40:43], a[176:179]
    v_exp_f32 v19, v115
    v_mfma_f32_16x16x32_bf16 a[176:179], v[188:191], v[44:47], a[176:179]
    s_waitcnt lgkmcnt(2)
    v_cvt_pk_bf16_f32 v82, v16, v17
    v_add_u32 v2, s3, v2
    v_mfma_f32_16x16x32_bf16 a[36:39], v[160:163], v[24:27], a[36:39]
    ds_read_b128 v[40:43], v1 offset:11264
    v_cvt_f32_i32 v242, v242
    v_mfma_f32_16x16x32_bf16 a[36:39], v[176:179], v[28:31], a[36:39]
    v_exp_f32 v16, v84
    v_mfma_f32_16x16x32_bf16 a[84:87], v[164:167], v[24:27], a[84:87]
    v_add_f32 v5, v5, v18
    v_add_f32 v5, v5, v19
    v_mfma_f32_16x16x32_bf16 a[84:87], v[180:183], v[28:31], a[84:87]
    s_add_u32 s27, s27, 24576
    v_exp_f32 v17, v85
    v_mfma_f32_16x16x32_bf16 a[132:135], v[168:171], v[24:27], a[132:135]
    s_add_u32 s56, s56, 36864
    ds_read_b128 v[44:47], v1 offset:23552
    v_add_u32 v3, s3, v3
    v_mfma_f32_16x16x32_bf16 a[132:135], v[184:187], v[28:31], a[132:135]
    s_waitcnt lgkmcnt(2)
    v_cvt_pk_bf16_f32 v83, v18, v19
    v_cvt_f32_i32 v243, v243
    v_mfma_f32_16x16x32_bf16 a[180:183], v[172:175], v[24:27], a[180:183]
    s_waitcnt vmcnt(19)
    v_exp_f32 v18, v86
    v_mfma_f32_16x16x32_bf16 a[180:183], v[188:191], v[28:31], a[180:183]
    s_barrier
    v_add_f32 v6, v6, v16
    v_mfma_f32_16x16x32_bf16 a[40:43], v[160:163], v[32:35], a[40:43]
    s_sub_u32 s58, s56, 147456
    ds_read_b128 v[24:27], v2 offset:0
    v_add_f32 v6, v6, v17
    v_mfma_f32_16x16x32_bf16 a[40:43], v[176:179], v[36:39], a[40:43]
    s_min_u32 s56, s56, s58
    v_exp_f32 v19, v87
    v_mfma_f32_16x16x32_bf16 a[88:91], v[164:167], v[32:35], a[88:91]
    v_fma_f32 v242, v242, v48, v50
    v_fma_f32 v243, v243, v49, v51
    v_mfma_f32_16x16x32_bf16 a[88:91], v[180:183], v[36:39], a[88:91]
    v_cvt_pk_bf16_f32 v84, v16, v17
    v_cvt_pk_bf16_f32 v227, v242, v243
    v_mfma_f32_16x16x32_bf16 a[136:139], v[168:171], v[32:35], a[136:139]
    ds_read_b128 v[28:31], v3 offset:0
    v_cvt_f32_i32 v246, v246
    v_mfma_f32_16x16x32_bf16 a[136:139], v[184:187], v[36:39], a[136:139]
    v_exp_f32 v16, v116
    v_mfma_f32_16x16x32_bf16 a[184:187], v[172:175], v[32:35], a[184:187]
    v_add_f32 v6, v6, v18
    v_add_f32 v6, v6, v19
    v_mfma_f32_16x16x32_bf16 a[184:187], v[188:191], v[36:39], a[184:187]
    s_waitcnt lgkmcnt(2)
    v_exp_f32 v17, v117
    v_mfma_f32_16x16x32_bf16 a[44:47], v[160:163], v[40:43], a[44:47]
    ds_read_b128 v[32:35], v2 offset:6144
    v_cvt_pk_bf16_f32 v85, v18, v19
    v_mfma_f32_16x16x32_bf16 a[44:47], v[176:179], v[44:47], a[44:47]
    v_exp_f32 v18, v118
    v_mfma_f32_16x16x32_bf16 a[92:95], v[164:167], v[40:43], a[92:95]
    v_cvt_f32_i32 v247, v247
    v_fma_f32 v246, v246, v48, v50
    v_mfma_f32_16x16x32_bf16 a[92:95], v[180:183], v[44:47], a[92:95]
    v_add_f32 v6, v6, v16
    v_add_f32 v6, v6, v17
    v_mfma_f32_16x16x32_bf16 a[140:143], v[168:171], v[40:43], a[140:143]
    s_sub_u32 s31, s31, 1
    ds_read_b128 v[36:39], v3 offset:6144
    v_fma_f32 v247, v247, v49, v51
    v_mfma_f32_16x16x32_bf16 a[140:143], v[184:187], v[44:47], a[140:143]
    v_exp_f32 v19, v119
    v_mfma_f32_16x16x32_bf16 a[188:191], v[172:175], v[40:43], a[188:191]
    s_waitcnt lgkmcnt(2)
    s_cmp_lg_u32 s31, 0
    v_cvt_pk_bf16_f32 v86, v16, v17
    v_add_f32 v6, v6, v18
    v_cvt_pk_bf16_f32 v231, v246, v247
    v_add_f32 v6, v6, v19
    v_cvt_f32_i32 v250, v250
    v_cvt_pk_bf16_f32 v87, v18, v19
    v_cvt_f32_i32 v251, v251
    v_mfma_f32_16x16x32_bf16 a[188:191], v[188:191], v[44:47], a[188:191]
    s_cbranch_scc1 L_loop
    v_mfma_f32_16x16x32_bf16 v[160:163], v[24:27], a[192:195], v[128:131]
    s_mov_b32 m0, s26
    ds_read_b128 v[40:43], v2 offset:128
    v_mfma_f32_16x16x32_bf16 v[160:163], v[28:31], a[196:199], v[160:163]
    buffer_load_dwordx4 v4, s[4:7], s32 offen offset:0 sc1 lds
    v_mfma_f32_16x16x32_bf16 v[164:167], v[24:27], a[216:219], v[132:135]
    ds_read_b128 v[44:47], v3 offset:128
    v_mfma_f32_16x16x32_bf16 v[164:167], v[28:31], a[220:223], v[164:167]
    s_waitcnt lgkmcnt(2)
    v_exp_f32 v16, v88
    v_mfma_f32_16x16x32_bf16 v[96:99], v[32:35], a[192:195], v[128:131]
    ds_read_b128 v[24:27], v2 offset:6272
    v_mfma_f32_16x16x32_bf16 v[96:99], v[36:39], a[196:199], v[96:99]
    buffer_load_dwordx4 v4, s[4:7], s32 offen offset:1024 sc1 lds
    v_mfma_f32_16x16x32_bf16 v[100:103], v[32:35], a[216:219], v[132:135]
    ds_read_b128 v[28:31], v3 offset:6272
    v_mfma_f32_16x16x32_bf16 v[100:103], v[36:39], a[220:223], v[100:103]
    s_waitcnt lgkmcnt(2)
    v_exp_f32 v17, v89
    v_mfma_f32_16x16x32_bf16 v[160:163], v[40:43], a[200:203], v[160:163]
    ds_read_b128 v[32:35], v2 offset:256
    v_mfma_f32_16x16x32_bf16 v[160:163], v[44:47], a[204:207], v[160:163]
    v_exp_f32 v18, v90
    v_mfma_f32_16x16x32_bf16 v[164:167], v[40:43], a[224:227], v[164:167]
    ds_read_b128 v[36:39], v3 offset:256
    v_add_f32 v7, v7, v16
    v_mfma_f32_16x16x32_bf16 v[164:167], v[44:47], a[228:231], v[164:167]
    s_waitcnt lgkmcnt(2)
    buffer_load_dwordx4 v4, s[4:7], s32 offen offset:2048 sc1 lds
    v_add_f32 v7, v7, v17
    v_mfma_f32_16x16x32_bf16 v[96:99], v[24:27], a[200:203], v[96:99]
    ds_read_b128 v[40:43], v2 offset:6400
    v_mfma_f32_16x16x32_bf16 v[96:99], v[28:31], a[204:207], v[96:99]
    v_exp_f32 v19, v91
    v_cvt_pk_bf16_f32 v88, v16, v17
    v_mfma_f32_16x16x32_bf16 v[100:103], v[24:27], a[224:227], v[100:103]
    s_add_u32 s32, s32, 24576
    ds_read_b128 v[44:47], v3 offset:6400
    v_mfma_f32_16x16x32_bf16 v[100:103], v[28:31], a[228:231], v[100:103]
    s_waitcnt lgkmcnt(2)
    v_exp_f32 v16, v120
    v_mfma_f32_16x16x32_bf16 v[160:163], v[32:35], a[208:211], v[160:163]
    s_add_u32 s26, s26, 12288
    ds_read_b128 v[24:27], v2 offset:12288
    v_add_f32 v7, v7, v18
    v_mfma_f32_16x16x32_bf16 v[160:163], v[36:39], a[212:215], v[160:163]
    v_add_f32 v7, v7, v19
    v_mfma_f32_16x16x32_bf16 v[164:167], v[32:35], a[232:235], v[164:167]
    s_mov_b32 m0, s26
    ds_read_b128 v[28:31], v3 offset:12288
    v_mfma_f32_16x16x32_bf16 v[164:167], v[36:39], a[236:239], v[164:167]
    s_waitcnt lgkmcnt(2)
    v_exp_f32 v17, v121
    v_cvt_pk_bf16_f32 v89, v18, v19
    v_mfma_f32_16x16x32_bf16 v[96:99], v[40:43], a[208:211], v[96:99]
    ds_read_b128 v[32:35], v2 offset:18432
    v_mfma_f32_16x16x32_bf16 v[96:99], v[44:47], a[212:215], v[96:99]
    v_exp_f32 v18, v122
    v_mfma_f32_16x16x32_bf16 v[100:103], v[40:43], a[232:235], v[100:103]
    ds_read_b128 v[36:39], v3 offset:18432
    v_add_f32 v7, v7, v16
    v_mfma_f32_16x16x32_bf16 v[100:103], v[44:47], a[236:239], v[100:103]
    s_waitcnt lgkmcnt(2)
    buffer_load_dwordx4 v4, s[4:7], s32 offen offset:0 sc1 lds
    v_add_f32 v7, v7, v17
    v_mfma_f32_16x16x32_bf16 v[168:171], v[24:27], a[192:195], v[128:131]
    ds_read_b128 v[40:43], v2 offset:12416
    v_mfma_f32_16x16x32_bf16 v[168:171], v[28:31], a[196:199], v[168:171]
    v_exp_f32 v19, v123
    v_cvt_pk_bf16_f32 v90, v16, v17
    v_mfma_f32_16x16x32_bf16 v[172:175], v[24:27], a[216:219], v[132:135]
    ds_read_b128 v[44:47], v3 offset:12416
    v_mfma_f32_16x16x32_bf16 v[172:175], v[28:31], a[220:223], v[172:175]
    s_waitcnt lgkmcnt(2)
    buffer_load_dwordx4 v4, s[4:7], s32 offen offset:1024 sc1 lds
    v_mfma_f32_16x16x32_bf16 v[104:107], v[32:35], a[192:195], v[128:131]
    ds_read_b128 v[24:27], v2 offset:18560
    v_mfma_f32_16x16x32_bf16 v[104:107], v[36:39], a[196:199], v[104:107]
    v_exp_f32 v16, v92
    v_add_f32 v7, v7, v18
    v_mfma_f32_16x16x32_bf16 v[108:111], v[32:35], a[216:219], v[132:135]
    s_add_u32 s29, s30, 49152
    ds_read_b128 v[28:31], v3 offset:18560
    v_add_f32 v7, v7, v19
    v_mfma_f32_16x16x32_bf16 v[108:111], v[36:39], a[220:223], v[108:111]
    s_waitcnt lgkmcnt(2)
    v_exp_f32 v17, v93
    v_cvt_pk_bf16_f32 v91, v18, v19
    v_mfma_f32_16x16x32_bf16 v[168:171], v[40:43], a[200:203], v[168:171]
    s_sub_u32 s3, s29, 147456
    ds_read_b128 v[32:35], v2 offset:12544
    v_mfma_f32_16x16x32_bf16 v[168:171], v[44:47], a[204:207], v[168:171]
    s_min_u32 s29, s29, s3
    buffer_load_dwordx4 v4, s[4:7], s32 offen offset:2048 sc1 lds
    v_mfma_f32_16x16x32_bf16 v[172:175], v[40:43], a[224:227], v[172:175]
    ds_read_b128 v[36:39], v3 offset:12544
    v_mfma_f32_16x16x32_bf16 v[172:175], v[44:47], a[228:231], v[172:175]
    s_waitcnt lgkmcnt(2)
    v_exp_f32 v18, v94
    v_add_f32 v8, v8, v16
    v_mfma_f32_16x16x32_bf16 v[104:107], v[24:27], a[200:203], v[104:107]
    s_add_u32 s32, s32, 24576
    ds_read_b128 v[40:43], v2 offset:18688
    v_add_f32 v8, v8, v17
    v_mfma_f32_16x16x32_bf16 v[104:107], v[28:31], a[204:207], v[104:107]
    v_exp_f32 v19, v95
    v_cvt_pk_bf16_f32 v92, v16, v17
    v_mfma_f32_16x16x32_bf16 v[108:111], v[24:27], a[224:227], v[108:111]
    ds_read_b128 v[44:47], v3 offset:18688
    v_mfma_f32_16x16x32_bf16 v[108:111], v[28:31], a[228:231], v[108:111]
    s_waitcnt lgkmcnt(2)
    v_subrev_u32 v2, 98304, v2
    v_subrev_u32 v3, 98304, v3
    v_mfma_f32_16x16x32_bf16 v[168:171], v[32:35], a[208:211], v[168:171]
    s_add_u32 s26, s26, 36864
    ds_read_b128 v[24:27], v2 offset:0
    v_mfma_f32_16x16x32_bf16 v[168:171], v[36:39], a[212:215], v[168:171]
    v_exp_f32 v16, v124
    v_add_f32 v8, v8, v18
    v_mfma_f32_16x16x32_bf16 v[172:175], v[32:35], a[232:235], v[172:175]
    s_sub_u32 s57, s26, 147456
    ds_read_b128 v[28:31], v3 offset:0
    v_add_f32 v8, v8, v19
    v_mfma_f32_16x16x32_bf16 v[172:175], v[36:39], a[236:239], v[172:175]
    s_waitcnt lgkmcnt(2)
    v_exp_f32 v17, v125
    v_cvt_pk_bf16_f32 v93, v18, v19
    v_mfma_f32_16x16x32_bf16 v[104:107], v[40:43], a[208:211], v[104:107]
    s_min_u32 s26, s26, s57
    ds_read_b128 v[32:35], v2 offset:6144
    s_sub_u32 s3, s29, s30
    v_mfma_f32_16x16x32_bf16 v[104:107], v[44:47], a[212:215], v[104:107]
    v_exp_f32 v18, v126
    v_mfma_f32_16x16x32_bf16 v[108:111], v[40:43], a[232:235], v[108:111]
    s_mov_b32 m0, s56
    ds_read_b128 v[36:39], v3 offset:6144
    v_add_f32 v8, v8, v16
    v_mfma_f32_16x16x32_bf16 v[108:111], v[44:47], a[236:239], v[108:111]
    s_waitcnt lgkmcnt(2)
    v_add_f32 v8, v8, v17
    v_mfma_f32_16x16x32_bf16 v[176:179], v[24:27], a[192:195], v[128:131]
    ds_read_b128 v[40:43], v2 offset:128
    v_mfma_f32_16x16x32_bf16 v[176:179], v[28:31], a[196:199], v[176:179]
    v_exp_f32 v19, v127
    v_cvt_pk_bf16_f32 v94, v16, v17
    v_mfma_f32_16x16x32_bf16 v[180:183], v[24:27], a[216:219], v[132:135]
    ds_read_b128 v[44:47], v3 offset:128
    v_add_f32 v8, v8, v18
    v_add_f32 v8, v8, v19
    v_cvt_pk_bf16_f32 v95, v18, v19
    v_mfma_f32_16x16x32_bf16 v[180:183], v[28:31], a[220:223], v[180:183]
    s_waitcnt lgkmcnt(2)
    buffer_load_dwordx4 v4, s[4:7], s27 offen offset:0 sc1 lds
    v_mfma_f32_16x16x32_bf16 v[112:115], v[32:35], a[192:195], v[128:131]
    s_mov_b32 s30, s29
    ds_read_b128 v[24:27], v2 offset:6272
    v_mfma_f32_16x16x32_bf16 v[112:115], v[36:39], a[196:199], v[112:115]
    v_exp_f32 v16, v160
    v_mfma_f32_16x16x32_bf16 v[116:119], v[32:35], a[216:219], v[132:135]
    ds_read_b128 v[28:31], v3 offset:6272
    v_mfma_f32_16x16x32_bf16 v[116:119], v[36:39], a[220:223], v[116:119]
    s_waitcnt lgkmcnt(2)
    buffer_load_dwordx4 v4, s[4:7], s27 offen offset:1024 sc1 lds
    v_mfma_f32_16x16x32_bf16 v[176:179], v[40:43], a[200:203], v[176:179]
    ds_read_b128 v[32:35], v2 offset:256
    v_mfma_f32_16x16x32_bf16 v[176:179], v[44:47], a[204:207], v[176:179]
    v_exp_f32 v17, v161
    v_mfma_f32_16x16x32_bf16 v[180:183], v[40:43], a[224:227], v[180:183]
    ds_read_b128 v[36:39], v3 offset:256
    v_add_u32 v1, s3, v1
    v_mfma_f32_16x16x32_bf16 v[180:183], v[44:47], a[228:231], v[180:183]
    s_waitcnt lgkmcnt(2)
    v_exp_f32 v18, v162
    v_add_f32 v5, v5, v16
    v_mfma_f32_16x16x32_bf16 v[112:115], v[24:27], a[200:203], v[112:115]
    ds_read_b128 v[40:43], v2 offset:6400
    v_add_f32 v5, v5, v17
    v_mfma_f32_16x16x32_bf16 v[112:115], v[28:31], a[204:207], v[112:115]
    buffer_load_dwordx4 v4, s[4:7], s27 offen offset:2048 sc1 lds
    v_mfma_f32_16x16x32_bf16 v[116:119], v[24:27], a[224:227], v[116:119]
    ds_read_b128 v[44:47], v3 offset:6400
    v_mfma_f32_16x16x32_bf16 v[116:119], v[28:31], a[228:231], v[116:119]
    s_waitcnt lgkmcnt(2)
    v_exp_f32 v19, v163
    v_cvt_pk_bf16_f32 v160, v16, v17
    v_mfma_f32_16x16x32_bf16 v[176:179], v[32:35], a[208:211], v[176:179]
    s_add_u32 s27, s27, 24576
    ds_read_b128 v[24:27], v2 offset:12288
    v_mfma_f32_16x16x32_bf16 v[176:179], v[36:39], a[212:215], v[176:179]
    v_exp_f32 v16, v96
    v_add_f32 v5, v5, v18
    v_mfma_f32_16x16x32_bf16 v[180:183], v[32:35], a[232:235], v[180:183]
    s_add_u32 s56, s56, 12288
    ds_read_b128 v[28:31], v3 offset:12288
    v_add_f32 v5, v5, v19
    v_mfma_f32_16x16x32_bf16 v[180:183], v[36:39], a[236:239], v[180:183]
    s_waitcnt lgkmcnt(2)
    v_exp_f32 v17, v97
    v_cvt_pk_bf16_f32 v161, v18, v19
    v_mfma_f32_16x16x32_bf16 v[112:115], v[40:43], a[208:211], v[112:115]
    ds_read_b128 v[32:35], v2 offset:18432
    v_mfma_f32_16x16x32_bf16 v[112:115], v[44:47], a[212:215], v[112:115]
    s_mov_b32 m0, s56
    v_exp_f32 v18, v98
    v_mfma_f32_16x16x32_bf16 v[116:119], v[40:43], a[232:235], v[116:119]
    ds_read_b128 v[36:39], v3 offset:18432
    v_add_f32 v5, v5, v16
    v_mfma_f32_16x16x32_bf16 v[116:119], v[44:47], a[236:239], v[116:119]
    s_waitcnt lgkmcnt(2)
    v_add_f32 v5, v5, v17
    v_mfma_f32_16x16x32_bf16 v[184:187], v[24:27], a[192:195], v[128:131]
    ds_read_b128 v[40:43], v2 offset:12416
    v_mfma_f32_16x16x32_bf16 v[184:187], v[28:31], a[196:199], v[184:187]
    buffer_load_dwordx4 v4, s[4:7], s27 offen offset:0 sc1 lds
    v_mfma_f32_16x16x32_bf16 v[188:191], v[24:27], a[216:219], v[132:135]
    ds_read_b128 v[44:47], v3 offset:12416
    v_mfma_f32_16x16x32_bf16 v[188:191], v[28:31], a[220:223], v[188:191]
    s_waitcnt lgkmcnt(2)
    v_exp_f32 v19, v99
    v_cvt_pk_bf16_f32 v162, v16, v17
    v_mfma_f32_16x16x32_bf16 v[120:123], v[32:35], a[192:195], v[128:131]
    ds_read_b128 v[24:27], v2 offset:18560
    v_mfma_f32_16x16x32_bf16 v[120:123], v[36:39], a[196:199], v[120:123]
    s_waitcnt vmcnt(10)
    v_exp_f32 v16, v164
    v_add_f32 v5, v5, v18
    v_mfma_f32_16x16x32_bf16 v[124:127], v[32:35], a[216:219], v[132:135]
    ds_read_b128 v[28:31], v3 offset:18560
    v_add_f32 v5, v5, v19
    v_mfma_f32_16x16x32_bf16 v[124:127], v[36:39], a[220:223], v[124:127]
    s_waitcnt lgkmcnt(2)
    s_barrier
    v_mfma_f32_16x16x32_bf16 v[184:187], v[40:43], a[200:203], v[184:187]
    ds_read_b128 v[32:35], v2 offset:12544
    v_mfma_f32_16x16x32_bf16 v[184:187], v[44:47], a[204:207], v[184:187]
    buffer_load_dwordx4 v4, s[4:7], s27 offen offset:1024 sc1 lds
    v_mfma_f32_16x16x32_bf16 v[188:191], v[40:43], a[224:227], v[188:191]
    ds_read_b128 v[36:39], v3 offset:12544
    v_mfma_f32_16x16x32_bf16 v[188:191], v[44:47], a[228:231], v[188:191]
    s_waitcnt lgkmcnt(2)
    v_exp_f32 v17, v165
    v_cvt_pk_bf16_f32 v163, v18, v19
    v_mfma_f32_16x16x32_bf16 v[120:123], v[24:27], a[200:203], v[120:123]
    ds_read_b128 v[40:43], v2 offset:18688
    v_mfma_f32_16x16x32_bf16 v[120:123], v[28:31], a[204:207], v[120:123]
    buffer_load_dwordx4 v4, s[4:7], s27 offen offset:2048 sc1 lds
    v_mfma_f32_16x16x32_bf16 v[124:127], v[24:27], a[224:227], v[124:127]
    ds_read_b128 v[44:47], v3 offset:18688
    v_mfma_f32_16x16x32_bf16 v[124:127], v[28:31], a[228:231], v[124:127]
    s_waitcnt lgkmcnt(2)
    v_exp_f32 v18, v166
    v_add_f32 v6, v6, v16
    v_mfma_f32_16x16x32_bf16 v[184:187], v[32:35], a[208:211], v[184:187]
    ds_read_b128 v[24:27], v1 offset:0
    v_add_f32 v6, v6, v17
    v_mfma_f32_16x16x32_bf16 v[184:187], v[36:39], a[212:215], v[184:187]
    v_exp_f32 v19, v167
    v_cvt_pk_bf16_f32 v164, v16, v17
    v_mfma_f32_16x16x32_bf16 v[188:191], v[32:35], a[232:235], v[188:191]
    ds_read_b128 v[28:31], v1 offset:12288
    v_mfma_f32_16x16x32_bf16 v[188:191], v[36:39], a[236:239], v[188:191]
    s_waitcnt lgkmcnt(2)
    v_exp_f32 v16, v100
    v_add_f32 v6, v6, v18
    v_mfma_f32_16x16x32_bf16 v[120:123], v[40:43], a[208:211], v[120:123]
    s_add_u32 s27, s27, 24576
    ds_read_b128 v[32:35], v1 offset:1024
    v_add_f32 v6, v6, v19
    v_mfma_f32_16x16x32_bf16 v[120:123], v[44:47], a[212:215], v[120:123]
    v_exp_f32 v17, v101
    v_cvt_pk_bf16_f32 v165, v18, v19
    v_mfma_f32_16x16x32_bf16 v[124:127], v[40:43], a[232:235], v[124:127]
    s_add_u32 s56, s56, 36864
    ds_read_b128 v[36:39], v1 offset:13312
    s_sub_u32 s58, s56, 147456
    v_mfma_f32_16x16x32_bf16 v[124:127], v[44:47], a[236:239], v[124:127]
    s_waitcnt lgkmcnt(2)
    v_exp_f32 v18, v102
    v_add_f32 v6, v6, v16
    v_add_f32 v6, v6, v17
    v_exp_f32 v19, v103
    v_cvt_pk_bf16_f32 v166, v16, v17
    v_add_f32 v6, v6, v18
    v_add_f32 v6, v6, v19
    v_cvt_pk_bf16_f32 v167, v18, v19
    s_min_u32 s56, s56, s58
    v_mfma_f32_16x16x32_bf16 a[0:3], v[64:67], v[24:27], a[0:3]
    s_mov_b32 m0, s56
    ds_read_b128 v[40:43], v1 offset:2048
    v_bfe_u32 v57, v4, 8, 2
    v_mfma_f32_16x16x32_bf16 a[0:3], v[80:83], v[28:31], a[0:3]
    buffer_load_dwordx4 v4, s[4:7], s27 offen offset:0 sc1 lds
    v_mfma_f32_16x16x32_bf16 a[48:51], v[68:71], v[24:27], a[48:51]
    v_exp_f32 v16, v168
    v_mfma_f32_16x16x32_bf16 a[48:51], v[84:87], v[28:31], a[48:51]
    v_exp_f32 v17, v169
    v_mfma_f32_16x16x32_bf16 a[96:99], v[72:75], v[24:27], a[96:99]
    ds_read_b128 v[44:47], v1 offset:14336
    v_mul_u32_u24 v56, 1536, v57
    v_mfma_f32_16x16x32_bf16 a[96:99], v[88:91], v[28:31], a[96:99]
    v_exp_f32 v18, v170
    v_mfma_f32_16x16x32_bf16 a[144:147], v[76:79], v[24:27], a[144:147]
    v_add_f32 v5, v5, v16
    v_add_f32 v5, v5, v17
    v_mfma_f32_16x16x32_bf16 a[144:147], v[92:95], v[28:31], a[144:147]
    s_waitcnt lgkmcnt(2)
    buffer_load_dwordx4 v4, s[4:7], s27 offen offset:1024 sc1 lds
    v_mfma_f32_16x16x32_bf16 a[4:7], v[64:67], v[32:35], a[4:7]
    ds_read_b128 v[24:27], v1 offset:3072
    v_lshlrev_b32 v58, 4, v57
    v_mfma_f32_16x16x32_bf16 a[4:7], v[80:83], v[36:39], a[4:7]
    v_exp_f32 v19, v171
    v_mfma_f32_16x16x32_bf16 a[52:55], v[68:71], v[32:35], a[52:55]
    v_cvt_pk_bf16_f32 v168, v16, v17
    v_mfma_f32_16x16x32_bf16 a[52:55], v[84:87], v[36:39], a[52:55]
    v_exp_f32 v16, v104
    v_mfma_f32_16x16x32_bf16 a[100:103], v[72:75], v[32:35], a[100:103]
    ds_read_b128 v[28:31], v1 offset:15360
    v_add_f32 v5, v5, v18
    v_mfma_f32_16x16x32_bf16 a[100:103], v[88:91], v[36:39], a[100:103]
    v_add_f32 v5, v5, v19
    v_bfe_u32 v57, v4, 4, 4
    v_mfma_f32_16x16x32_bf16 a[148:151], v[76:79], v[32:35], a[148:151]
    v_exp_f32 v17, v105
    v_mfma_f32_16x16x32_bf16 a[148:151], v[92:95], v[36:39], a[148:151]
    s_waitcnt lgkmcnt(2)
    buffer_load_dwordx4 v4, s[4:7], s27 offen offset:2048 sc1 lds
    v_mfma_f32_16x16x32_bf16 a[8:11], v[64:67], v[40:43], a[8:11]
    ds_read_b128 v[32:35], v1 offset:4096
    v_cvt_pk_bf16_f32 v169, v18, v19
    v_mfma_f32_16x16x32_bf16 a[8:11], v[80:83], v[44:47], a[8:11]
    v_exp_f32 v18, v106
    v_mfma_f32_16x16x32_bf16 a[56:59], v[68:71], v[40:43], a[56:59]
    v_add_f32 v5, v5, v16
    v_add_f32 v5, v5, v17
    v_mfma_f32_16x16x32_bf16 a[56:59], v[84:87], v[44:47], a[56:59]
    v_exp_f32 v19, v107
    v_mfma_f32_16x16x32_bf16 a[104:107], v[72:75], v[40:43], a[104:107]
    s_add_u32 s27, s27, 24576
    ds_read_b128 v[36:39], v1 offset:16384
    v_cvt_pk_bf16_f32 v170, v16, v17
    v_mfma_f32_16x16x32_bf16 a[104:107], v[88:91], v[44:47], a[104:107]
    v_exp_f32 v16, v172
    v_mfma_f32_16x16x32_bf16 a[152:155], v[76:79], v[40:43], a[152:155]
    v_add_f32 v5, v5, v18
    v_add_f32 v5, v5, v19
    v_mfma_f32_16x16x32_bf16 a[152:155], v[92:95], v[44:47], a[152:155]
    s_waitcnt lgkmcnt(2)
    v_exp_f32 v17, v173
    v_mfma_f32_16x16x32_bf16 a[12:15], v[64:67], v[24:27], a[12:15]
    s_add_u32 s56, s56, 12288
    ds_read_b128 v[40:43], v1 offset:5120
    v_lshl_add_u32 v56, v57, 3, v56
    v_mfma_f32_16x16x32_bf16 a[12:15], v[80:83], v[28:31], a[12:15]
    v_cvt_pk_bf16_f32 v171, v18, v19
    v_mfma_f32_16x16x32_bf16 a[60:63], v[68:71], v[24:27], a[60:63]
    v_exp_f32 v18, v174
    v_mfma_f32_16x16x32_bf16 a[60:63], v[84:87], v[28:31], a[60:63]
    v_add_f32 v6, v6, v16
    v_mfma_f32_16x16x32_bf16 a[108:111], v[72:75], v[24:27], a[108:111]
    s_mov_b32 m0, s56
    ds_read_b128 v[44:47], v1 offset:17408
    v_add_f32 v6, v6, v17
    v_mfma_f32_16x16x32_bf16 a[108:111], v[88:91], v[28:31], a[108:111]
    v_exp_f32 v19, v175
    v_mfma_f32_16x16x32_bf16 a[156:159], v[76:79], v[24:27], a[156:159]
    s_lshl_b32 s24, s95, 2
    v_mfma_f32_16x16x32_bf16 a[156:159], v[92:95], v[28:31], a[156:159]
    s_waitcnt lgkmcnt(2)
    v_cvt_pk_bf16_f32 v172, v16, v17
    v_mfma_f32_16x16x32_bf16 a[16:19], v[64:67], v[32:35], a[16:19]
    ds_read_b128 v[24:27], v1 offset:6144
    v_mfma_f32_16x16x32_bf16 a[16:19], v[80:83], v[36:39], a[16:19]
    v_exp_f32 v16, v108
    v_mfma_f32_16x16x32_bf16 a[64:67], v[68:71], v[32:35], a[64:67]
    v_add_f32 v6, v6, v18
    v_add_f32 v6, v6, v19
    v_mfma_f32_16x16x32_bf16 a[64:67], v[84:87], v[36:39], a[64:67]
    buffer_load_dwordx4 v4, s[4:7], s27 offen offset:0 sc1 lds
    v_mfma_f32_16x16x32_bf16 a[112:115], v[72:75], v[32:35], a[112:115]
    ds_read_b128 v[28:31], v1 offset:18432
    v_mfma_f32_16x16x32_bf16 a[112:115], v[88:91], v[36:39], a[112:115]
    v_exp_f32 v17, v109
    v_mfma_f32_16x16x32_bf16 a[160:163], v[76:79], v[32:35], a[160:163]
    v_cvt_pk_bf16_f32 v173, v18, v19
    v_mfma_f32_16x16x32_bf16 a[160:163], v[92:95], v[36:39], a[160:163]
    s_waitcnt lgkmcnt(2)
    v_exp_f32 v18, v110
    v_mfma_f32_16x16x32_bf16 a[20:23], v[64:67], v[40:43], a[20:23]
    s_add_u32 s24, s24, s25
    ds_read_b128 v[32:35], v1 offset:7168
    v_add_f32 v6, v6, v16
    v_mfma_f32_16x16x32_bf16 a[20:23], v[80:83], v[44:47], a[20:23]
    buffer_load_dwordx4 v4, s[4:7], s27 offen offset:1024 sc1 lds
    v_mfma_f32_16x16x32_bf16 a[68:71], v[68:71], v[40:43], a[68:71]
    v_add_f32 v6, v6, v17
    v_mfma_f32_16x16x32_bf16 a[68:71], v[84:87], v[44:47], a[68:71]
    v_exp_f32 v19, v111
    v_mfma_f32_16x16x32_bf16 a[116:119], v[72:75], v[40:43], a[116:119]
    ds_read_b128 v[36:39], v1 offset:19456
    v_cvt_pk_bf16_f32 v174, v16, v17
    v_mfma_f32_16x16x32_bf16 a[116:119], v[88:91], v[44:47], a[116:119]
    v_add_f32 v6, v6, v18
    v_add_f32 v6, v6, v19
    v_mfma_f32_16x16x32_bf16 a[164:167], v[76:79], v[40:43], a[164:167]
    v_cvt_pk_bf16_f32 v175, v18, v19
    v_mfma_f32_16x16x32_bf16 a[164:167], v[92:95], v[44:47], a[164:167]
    s_waitcnt lgkmcnt(2)
    v_exp_f32 v16, v176
    v_mfma_f32_16x16x32_bf16 a[24:27], v[64:67], v[24:27], a[24:27]
    s_mul_i32 s24, s24, 24576
    ds_read_b128 v[40:43], v1 offset:8192
    v_mfma_f32_16x16x32_bf16 a[24:27], v[80:83], v[28:31], a[24:27]
    buffer_load_dwordx4 v4, s[4:7], s27 offen offset:2048 sc1 lds
    v_mfma_f32_16x16x32_bf16 a[72:75], v[68:71], v[24:27], a[72:75]
    v_exp_f32 v17, v177
    v_mfma_f32_16x16x32_bf16 a[72:75], v[84:87], v[28:31], a[72:75]
    v_exp_f32 v18, v178
    v_mfma_f32_16x16x32_bf16 a[120:123], v[72:75], v[24:27], a[120:123]
    ds_read_b128 v[44:47], v1 offset:20480
    v_add_f32 v5, v5, v16
    v_mfma_f32_16x16x32_bf16 a[120:123], v[88:91], v[28:31], a[120:123]
    v_add_f32 v5, v5, v17
    v_mfma_f32_16x16x32_bf16 a[168:171], v[76:79], v[24:27], a[168:171]
    v_exp_f32 v19, v179
    v_mfma_f32_16x16x32_bf16 a[168:171], v[92:95], v[28:31], a[168:171]
    s_waitcnt lgkmcnt(2)
    v_cvt_pk_bf16_f32 v176, v16, v17
    v_mfma_f32_16x16x32_bf16 a[28:31], v[64:67], v[32:35], a[28:31]
    s_add_u32 s40, s24, 6144
    ds_read_b128 v[24:27], v1 offset:9216
    v_mfma_f32_16x16x32_bf16 a[28:31], v[80:83], v[36:39], a[28:31]
    v_exp_f32 v16, v112
    v_mfma_f32_16x16x32_bf16 a[76:79], v[68:71], v[32:35], a[76:79]
    v_add_f32 v5, v5, v18
    v_add_f32 v5, v5, v19
    v_mfma_f32_16x16x32_bf16 a[76:79], v[84:87], v[36:39], a[76:79]
    v_exp_f32 v17, v113
    v_mfma_f32_16x16x32_bf16 a[124:127], v[72:75], v[32:35], a[124:127]
    ds_read_b128 v[28:31], v1 offset:21504
    v_mfma_f32_16x16x32_bf16 a[124:127], v[88:91], v[36:39], a[124:127]
    s_add_u32 s27, s27, 24576
    v_cvt_pk_bf16_f32 v177, v18, v19
    s_add_u32 s56, s56, 36864
    v_mfma_f32_16x16x32_bf16 a[172:175], v[76:79], v[32:35], a[172:175]
    s_sub_u32 s58, s56, 147456
    v_exp_f32 v18, v114
    v_mfma_f32_16x16x32_bf16 a[172:175], v[92:95], v[36:39], a[172:175]
    s_waitcnt lgkmcnt(2)
    v_add_f32 v5, v5, v16
    v_mfma_f32_16x16x32_bf16 a[32:35], v[64:67], v[40:43], a[32:35]
    ds_read_b128 v[32:35], v1 offset:10240
    v_add_f32 v5, v5, v17
    v_mfma_f32_16x16x32_bf16 a[32:35], v[80:83], v[44:47], a[32:35]
    s_add_u32 s41, s24, 12288
    v_exp_f32 v19, v115
    v_mfma_f32_16x16x32_bf16 a[80:83], v[68:71], v[40:43], a[80:83]
    s_min_u32 s56, s56, s58
    v_mfma_f32_16x16x32_bf16 a[80:83], v[84:87], v[44:47], a[80:83]
    v_cvt_pk_bf16_f32 v178, v16, v17
    v_mfma_f32_16x16x32_bf16 a[128:131], v[72:75], v[40:43], a[128:131]
    ds_read_b128 v[36:39], v1 offset:22528
    v_mfma_f32_16x16x32_bf16 a[128:131], v[88:91], v[44:47], a[128:131]
    v_exp_f32 v16, v180
    v_mfma_f32_16x16x32_bf16 a[176:179], v[76:79], v[40:43], a[176:179]
    v_add_f32 v5, v5, v18
    v_add_f32 v5, v5, v19
    v_mfma_f32_16x16x32_bf16 a[176:179], v[92:95], v[44:47], a[176:179]
    s_waitcnt lgkmcnt(2)
    v_exp_f32 v17, v181
    v_mfma_f32_16x16x32_bf16 a[36:39], v[64:67], v[24:27], a[36:39]
    ds_read_b128 v[40:43], v1 offset:11264
    v_mfma_f32_16x16x32_bf16 a[36:39], v[80:83], v[28:31], a[36:39]
    v_cvt_pk_bf16_f32 v179, v18, v19
    v_mfma_f32_16x16x32_bf16 a[84:87], v[68:71], v[24:27], a[84:87]
    s_add_u32 s42, s24, 18432
    v_exp_f32 v18, v182
    v_mfma_f32_16x16x32_bf16 a[84:87], v[84:87], v[28:31], a[84:87]
    v_add_f32 v6, v6, v16
    v_mfma_f32_16x16x32_bf16 a[132:135], v[72:75], v[24:27], a[132:135]
    ds_read_b128 v[44:47], v1 offset:23552
    v_add_f32 v6, v6, v17
    v_mfma_f32_16x16x32_bf16 a[132:135], v[88:91], v[28:31], a[132:135]
    s_waitcnt lgkmcnt(2)
    v_exp_f32 v19, v183
    v_mfma_f32_16x16x32_bf16 a[180:183], v[76:79], v[24:27], a[180:183]
    s_waitcnt vmcnt(6)
    v_mfma_f32_16x16x32_bf16 a[180:183], v[92:95], v[28:31], a[180:183]
    s_barrier
    v_add_u32 v2, 49152, v2
    v_add_u32 v3, 49152, v3
    v_mfma_f32_16x16x32_bf16 a[40:43], v[64:67], v[32:35], a[40:43]
    ds_read_b128 v[24:27], v2 offset:0
    v_cvt_pk_bf16_f32 v180, v16, v17
    v_mfma_f32_16x16x32_bf16 a[40:43], v[80:83], v[36:39], a[40:43]
    v_exp_f32 v16, v116
    v_mfma_f32_16x16x32_bf16 a[88:91], v[68:71], v[32:35], a[88:91]
    v_add_f32 v6, v6, v18
    v_add_f32 v6, v6, v19
    v_mfma_f32_16x16x32_bf16 a[88:91], v[84:87], v[36:39], a[88:91]
    v_exp_f32 v17, v117
    v_mfma_f32_16x16x32_bf16 a[136:139], v[72:75], v[32:35], a[136:139]
    ds_read_b128 v[28:31], v3 offset:0
    v_mfma_f32_16x16x32_bf16 a[136:139], v[88:91], v[36:39], a[136:139]
    v_cvt_pk_bf16_f32 v181, v18, v19
    v_mfma_f32_16x16x32_bf16 a[184:187], v[76:79], v[32:35], a[184:187]
    v_exp_f32 v18, v118
    v_mfma_f32_16x16x32_bf16 a[184:187], v[92:95], v[36:39], a[184:187]
    s_waitcnt lgkmcnt(2)
    v_add_f32 v6, v6, v16
    v_mfma_f32_16x16x32_bf16 a[44:47], v[64:67], v[40:43], a[44:47]
    ds_read_b128 v[32:35], v2 offset:6144
    v_add_f32 v6, v6, v17
    v_mfma_f32_16x16x32_bf16 a[44:47], v[80:83], v[44:47], a[44:47]
    v_exp_f32 v19, v119
    v_mfma_f32_16x16x32_bf16 a[92:95], v[68:71], v[40:43], a[92:95]
    v_mfma_f32_16x16x32_bf16 a[92:95], v[84:87], v[44:47], a[92:95]
    v_cvt_pk_bf16_f32 v182, v16, v17
    v_mfma_f32_16x16x32_bf16 a[140:143], v[72:75], v[40:43], a[140:143]
    ds_read_b128 v[36:39], v3 offset:6144
    v_add_f32 v6, v6, v18
    v_mfma_f32_16x16x32_bf16 a[140:143], v[88:91], v[44:47], a[140:143]
    v_add_f32 v6, v6, v19
    v_cvt_pk_bf16_f32 v183, v18, v19
    v_mfma_f32_16x16x32_bf16 a[188:191], v[76:79], v[40:43], a[188:191]
    v_mfma_f32_16x16x32_bf16 a[188:191], v[92:95], v[44:47], a[188:191]
    s_waitcnt lgkmcnt(2)
    v_mfma_f32_16x16x32_bf16 v[64:67], v[24:27], a[192:195], v[128:131]
    ds_read_b128 v[40:43], v2 offset:128
    v_mfma_f32_16x16x32_bf16 v[64:67], v[28:31], a[196:199], v[64:67]
    v_exp_f32 v16, v184
    v_mfma_f32_16x16x32_bf16 v[68:71], v[24:27], a[216:219], v[132:135]
    ds_read_b128 v[44:47], v3 offset:128
    v_mfma_f32_16x16x32_bf16 v[68:71], v[28:31], a[220:223], v[68:71]
    s_waitcnt lgkmcnt(2)
    v_exp_f32 v17, v185
    v_mfma_f32_16x16x32_bf16 v[96:99], v[32:35], a[192:195], v[128:131]
    ds_read_b128 v[24:27], v2 offset:6272
    v_mfma_f32_16x16x32_bf16 v[96:99], v[36:39], a[196:199], v[96:99]
    v_exp_f32 v18, v186
    v_mfma_f32_16x16x32_bf16 v[100:103], v[32:35], a[216:219], v[132:135]
    ds_read_b128 v[28:31], v3 offset:6272
    v_add_f32 v5, v5, v16
    v_mfma_f32_16x16x32_bf16 v[100:103], v[36:39], a[220:223], v[100:103]
    s_waitcnt lgkmcnt(2)
    v_add_f32 v5, v5, v17
    v_mfma_f32_16x16x32_bf16 v[64:67], v[40:43], a[200:203], v[64:67]
    ds_read_b128 v[32:35], v2 offset:256
    v_mfma_f32_16x16x32_bf16 v[64:67], v[44:47], a[204:207], v[64:67]
    v_exp_f32 v19, v187
    v_mfma_f32_16x16x32_bf16 v[68:71], v[40:43], a[224:227], v[68:71]
    ds_read_b128 v[36:39], v3 offset:256
    v_cvt_pk_bf16_f32 v184, v16, v17
    v_mfma_f32_16x16x32_bf16 v[68:71], v[44:47], a[228:231], v[68:71]
    s_waitcnt lgkmcnt(2)
    v_exp_f32 v16, v120
    v_mfma_f32_16x16x32_bf16 v[96:99], v[24:27], a[200:203], v[96:99]
    ds_read_b128 v[40:43], v2 offset:6400
    v_add_f32 v5, v5, v18
    v_mfma_f32_16x16x32_bf16 v[96:99], v[28:31], a[204:207], v[96:99]
    s_waitcnt vmcnt(0)
    v_add_f32 v5, v5, v19
    v_mfma_f32_16x16x32_bf16 v[100:103], v[24:27], a[224:227], v[100:103]
    ds_read_b128 v[44:47], v3 offset:6400
    v_mfma_f32_16x16x32_bf16 v[100:103], v[28:31], a[228:231], v[100:103]
    s_waitcnt lgkmcnt(2)
    s_barrier
    v_mfma_f32_16x16x32_bf16 v[64:67], v[32:35], a[208:211], v[64:67]
    s_mov_b32 m0, s56
    ds_read_b128 v[24:27], v2 offset:12288
    v_mfma_f32_16x16x32_bf16 v[64:67], v[36:39], a[212:215], v[64:67]
    buffer_load_dwordx4 v4, s[4:7], s27 offen offset:0 sc1 lds
    v_mfma_f32_16x16x32_bf16 v[68:71], v[32:35], a[232:235], v[68:71]
    ds_read_b128 v[28:31], v3 offset:12288
    v_mfma_f32_16x16x32_bf16 v[68:71], v[36:39], a[236:239], v[68:71]
    s_waitcnt lgkmcnt(2)
    v_exp_f32 v17, v121
    v_cvt_pk_bf16_f32 v185, v18, v19
    v_mfma_f32_16x16x32_bf16 v[96:99], v[40:43], a[208:211], v[96:99]
    ds_read_b128 v[32:35], v2 offset:18432
    v_mfma_f32_16x16x32_bf16 v[96:99], v[44:47], a[212:215], v[96:99]
    buffer_load_dwordx4 v4, s[4:7], s27 offen offset:1024 sc1 lds
    v_mfma_f32_16x16x32_bf16 v[100:103], v[40:43], a[232:235], v[100:103]
    ds_read_b128 v[36:39], v3 offset:18432
    v_mfma_f32_16x16x32_bf16 v[100:103], v[44:47], a[236:239], v[100:103]
    s_waitcnt lgkmcnt(2)
    v_exp_f32 v18, v122
    v_add_f32 v5, v5, v16
    v_mfma_f32_16x16x32_bf16 v[72:75], v[24:27], a[192:195], v[128:131]
    ds_read_b128 v[40:43], v2 offset:12416
    v_add_f32 v5, v5, v17
    v_mfma_f32_16x16x32_bf16 v[72:75], v[28:31], a[196:199], v[72:75]
    v_exp_f32 v19, v123
    v_cvt_pk_bf16_f32 v186, v16, v17
    v_mfma_f32_16x16x32_bf16 v[76:79], v[24:27], a[216:219], v[132:135]
    ds_read_b128 v[44:47], v3 offset:12416
    v_mfma_f32_16x16x32_bf16 v[76:79], v[28:31], a[220:223], v[76:79]
    s_waitcnt lgkmcnt(2)
    buffer_load_dwordx4 v4, s[4:7], s27 offen offset:2048 sc1 lds
    v_mfma_f32_16x16x32_bf16 v[104:107], v[32:35], a[192:195], v[128:131]
    ds_read_b128 v[24:27], v2 offset:18560
    v_mfma_f32_16x16x32_bf16 v[104:107], v[36:39], a[196:199], v[104:107]
    v_exp_f32 v16, v188
    v_add_f32 v5, v5, v18
    v_mfma_f32_16x16x32_bf16 v[108:111], v[32:35], a[216:219], v[132:135]
    ds_read_b128 v[28:31], v3 offset:18560
    v_add_f32 v5, v5, v19
    v_mfma_f32_16x16x32_bf16 v[108:111], v[36:39], a[220:223], v[108:111]
    s_waitcnt lgkmcnt(2)
    v_exp_f32 v17, v189
    v_cvt_pk_bf16_f32 v187, v18, v19
    v_mfma_f32_16x16x32_bf16 v[72:75], v[40:43], a[200:203], v[72:75]
    s_add_u32 s27, s27, 24576
    ds_read_b128 v[32:35], v2 offset:12544
    v_mfma_f32_16x16x32_bf16 v[72:75], v[44:47], a[204:207], v[72:75]
    v_exp_f32 v18, v190
    v_mfma_f32_16x16x32_bf16 v[76:79], v[40:43], a[224:227], v[76:79]
    s_add_u32 s56, s56, 12288
    ds_read_b128 v[36:39], v3 offset:12544
    v_add_f32 v6, v6, v16
    v_mfma_f32_16x16x32_bf16 v[76:79], v[44:47], a[228:231], v[76:79]
    s_waitcnt lgkmcnt(2)
    v_add_f32 v6, v6, v17
    v_mfma_f32_16x16x32_bf16 v[104:107], v[24:27], a[200:203], v[104:107]
    ds_read_b128 v[40:43], v2 offset:18688
    v_mfma_f32_16x16x32_bf16 v[104:107], v[28:31], a[204:207], v[104:107]
    v_exp_f32 v19, v191
    v_cvt_pk_bf16_f32 v188, v16, v17
    v_mfma_f32_16x16x32_bf16 v[108:111], v[24:27], a[224:227], v[108:111]
    s_mov_b32 m0, s56
    ds_read_b128 v[44:47], v3 offset:18688
    v_mfma_f32_16x16x32_bf16 v[108:111], v[28:31], a[228:231], v[108:111]
    s_waitcnt lgkmcnt(2)
    v_add_u32 v2, 49152, v2
    v_add_u32 v3, 49152, v3
    v_mfma_f32_16x16x32_bf16 v[72:75], v[32:35], a[208:211], v[72:75]
    ds_read_b128 v[24:27], v2 offset:0
    v_mfma_f32_16x16x32_bf16 v[72:75], v[36:39], a[212:215], v[72:75]
    buffer_load_dwordx4 v4, s[4:7], s27 offen offset:0 sc1 lds
    v_mfma_f32_16x16x32_bf16 v[76:79], v[32:35], a[232:235], v[76:79]
    ds_read_b128 v[28:31], v3 offset:0
    v_mfma_f32_16x16x32_bf16 v[76:79], v[36:39], a[236:239], v[76:79]
    s_waitcnt lgkmcnt(2)
    v_exp_f32 v16, v124
    v_add_f32 v6, v6, v18
    v_mfma_f32_16x16x32_bf16 v[104:107], v[40:43], a[208:211], v[104:107]
    ds_read_b128 v[32:35], v2 offset:6144
    v_add_f32 v6, v6, v19
    v_mfma_f32_16x16x32_bf16 v[104:107], v[44:47], a[212:215], v[104:107]
    v_exp_f32 v17, v125
    v_cvt_pk_bf16_f32 v189, v18, v19
    v_mfma_f32_16x16x32_bf16 v[108:111], v[40:43], a[232:235], v[108:111]
    ds_read_b128 v[36:39], v3 offset:6144
    v_mfma_f32_16x16x32_bf16 v[108:111], v[44:47], a[236:239], v[108:111]
    s_waitcnt lgkmcnt(2)
    buffer_load_dwordx4 v4, s[4:7], s27 offen offset:1024 sc1 lds
    v_mfma_f32_16x16x32_bf16 v[80:83], v[24:27], a[240:243], v[136:139]
    ds_read_b128 v[40:43], v2 offset:128
    v_mfma_f32_16x16x32_bf16 v[80:83], v[28:31], a[244:247], v[80:83]
    v_exp_f32 v18, v126
    v_add_f32 v6, v6, v16
    v_mfma_f32_16x16x32_bf16 v[84:87], v[24:27], v[200:203], v[140:143]
    ds_read_b128 v[44:47], v3 offset:128
    v_add_f32 v6, v6, v17
    v_exp_f32 v19, v127
    v_cvt_pk_bf16_f32 v190, v16, v17
    v_add_f32 v6, v6, v18
    v_add_f32 v6, v6, v19
    v_cvt_pk_bf16_f32 v191, v18, v19
    v_mfma_f32_16x16x32_bf16 v[84:87], v[28:31], v[204:207], v[84:87]
    s_waitcnt lgkmcnt(2)
    v_exp_f32 v16, v64
    v_mfma_f32_16x16x32_bf16 v[112:115], v[32:35], a[240:243], v[136:139]
    ds_read_b128 v[24:27], v2 offset:6272
    v_mfma_f32_16x16x32_bf16 v[112:115], v[36:39], a[244:247], v[112:115]
    buffer_load_dwordx4 v4, s[4:7], s27 offen offset:2048 sc1 lds
    v_mfma_f32_16x16x32_bf16 v[116:119], v[32:35], v[200:203], v[140:143]
    ds_read_b128 v[28:31], v3 offset:6272
    v_mfma_f32_16x16x32_bf16 v[116:119], v[36:39], v[204:207], v[116:119]
    s_waitcnt lgkmcnt(2)
    v_exp_f32 v17, v65
    v_mfma_f32_16x16x32_bf16 v[80:83], v[40:43], a[248:251], v[80:83]
    ds_read_b128 v[32:35], v2 offset:256
    v_mfma_f32_16x16x32_bf16 v[80:83], v[44:47], a[252:255], v[80:83]
    v_exp_f32 v18, v66
    v_mfma_f32_16x16x32_bf16 v[84:87], v[40:43], v[208:211], v[84:87]
    ds_read_b128 v[36:39], v3 offset:256
    v_add_f32 v5, v5, v16
    v_mfma_f32_16x16x32_bf16 v[84:87], v[44:47], v[212:215], v[84:87]
    s_waitcnt lgkmcnt(2)
    v_add_f32 v5, v5, v17
    v_mfma_f32_16x16x32_bf16 v[112:115], v[24:27], a[248:251], v[112:115]
    ds_read_b128 v[40:43], v2 offset:6400
    v_mfma_f32_16x16x32_bf16 v[112:115], v[28:31], a[252:255], v[112:115]
    v_exp_f32 v19, v67
    v_cvt_pk_bf16_f32 v64, v16, v17
    v_mfma_f32_16x16x32_bf16 v[116:119], v[24:27], v[208:211], v[116:119]
    s_add_u32 s27, s27, 24576
    ds_read_b128 v[44:47], v3 offset:6400
    s_add_u32 s56, s56, 36864
    v_mfma_f32_16x16x32_bf16 v[116:119], v[28:31], v[212:215], v[116:119]
    s_waitcnt lgkmcnt(2)
    v_exp_f32 v16, v96
    v_mfma_f32_16x16x32_bf16 v[80:83], v[32:35], v[192:195], v[80:83]
    s_sub_u32 s58, s56, 147456
    ds_read_b128 v[24:27], v2 offset:12288
    v_add_f32 v5, v5, v18
    v_mfma_f32_16x16x32_bf16 v[80:83], v[36:39], v[196:199], v[80:83]
    s_min_u32 s56, s56, s58
    v_add_f32 v5, v5, v19
    v_mfma_f32_16x16x32_bf16 v[84:87], v[32:35], v[216:219], v[84:87]
    ds_read_b128 v[28:31], v3 offset:12288
    v_mfma_f32_16x16x32_bf16 v[84:87], v[36:39], v[220:223], v[84:87]
    s_waitcnt lgkmcnt(2)
    v_exp_f32 v17, v97
    v_cvt_pk_bf16_f32 v65, v18, v19
    v_mfma_f32_16x16x32_bf16 v[112:115], v[40:43], v[192:195], v[112:115]
    ds_read_b128 v[32:35], v2 offset:18432
    v_mfma_f32_16x16x32_bf16 v[112:115], v[44:47], v[196:199], v[112:115]
    v_exp_f32 v18, v98
    v_mfma_f32_16x16x32_bf16 v[116:119], v[40:43], v[216:219], v[116:119]
    ds_read_b128 v[36:39], v3 offset:18432
    v_add_f32 v5, v5, v16
    v_mfma_f32_16x16x32_bf16 v[116:119], v[44:47], v[220:223], v[116:119]
    s_waitcnt lgkmcnt(2)
    v_add_f32 v5, v5, v17
    v_mfma_f32_16x16x32_bf16 v[88:91], v[24:27], a[240:243], v[136:139]
    ds_read_b128 v[40:43], v2 offset:12416
    v_mfma_f32_16x16x32_bf16 v[88:91], v[28:31], a[244:247], v[88:91]
    v_exp_f32 v19, v99
    v_cvt_pk_bf16_f32 v66, v16, v17
    v_mfma_f32_16x16x32_bf16 v[92:95], v[24:27], v[200:203], v[140:143]
    ds_read_b128 v[44:47], v3 offset:12416
    v_mfma_f32_16x16x32_bf16 v[92:95], v[28:31], v[204:207], v[92:95]
    s_waitcnt lgkmcnt(2)
    v_exp_f32 v16, v68
    v_mfma_f32_16x16x32_bf16 v[120:123], v[32:35], a[240:243], v[136:139]
    ds_read_b128 v[24:27], v2 offset:18560
    v_add_f32 v5, v5, v18
    v_mfma_f32_16x16x32_bf16 v[120:123], v[36:39], a[244:247], v[120:123]
    v_add_f32 v5, v5, v19
    v_mfma_f32_16x16x32_bf16 v[124:127], v[32:35], v[200:203], v[140:143]
    ds_read_b128 v[28:31], v3 offset:18560
    v_mfma_f32_16x16x32_bf16 v[124:127], v[36:39], v[204:207], v[124:127]
    s_waitcnt lgkmcnt(2)
    v_exp_f32 v17, v69
    v_cvt_pk_bf16_f32 v67, v18, v19
    v_mfma_f32_16x16x32_bf16 v[88:91], v[40:43], a[248:251], v[88:91]
    ds_read_b128 v[32:35], v2 offset:12544
    v_mfma_f32_16x16x32_bf16 v[88:91], v[44:47], a[252:255], v[88:91]
    v_exp_f32 v18, v70
    v_mfma_f32_16x16x32_bf16 v[92:95], v[40:43], v[208:211], v[92:95]
    ds_read_b128 v[36:39], v3 offset:12544
    v_add_f32 v6, v6, v16
    v_mfma_f32_16x16x32_bf16 v[92:95], v[44:47], v[212:215], v[92:95]
    s_waitcnt lgkmcnt(2)
    v_add_f32 v6, v6, v17
    v_mfma_f32_16x16x32_bf16 v[120:123], v[24:27], a[248:251], v[120:123]
    ds_read_b128 v[40:43], v2 offset:18688
    v_mfma_f32_16x16x32_bf16 v[120:123], v[28:31], a[252:255], v[120:123]
    v_exp_f32 v19, v71
    v_cvt_pk_bf16_f32 v68, v16, v17
    v_mfma_f32_16x16x32_bf16 v[124:127], v[24:27], v[208:211], v[124:127]
    ds_read_b128 v[44:47], v3 offset:18688
    v_mfma_f32_16x16x32_bf16 v[124:127], v[28:31], v[212:215], v[124:127]
    s_waitcnt lgkmcnt(2)
    v_add_u32 v1, 49152, v1
    v_exp_f32 v16, v100
    v_mfma_f32_16x16x32_bf16 v[88:91], v[32:35], v[192:195], v[88:91]
    ds_read_b128 v[24:27], v1 offset:0
    v_add_f32 v6, v6, v18
    v_mfma_f32_16x16x32_bf16 v[88:91], v[36:39], v[196:199], v[88:91]
    v_add_f32 v6, v6, v19
    v_mfma_f32_16x16x32_bf16 v[92:95], v[32:35], v[216:219], v[92:95]
    ds_read_b128 v[28:31], v1 offset:12288
    v_mfma_f32_16x16x32_bf16 v[92:95], v[36:39], v[220:223], v[92:95]
    s_waitcnt lgkmcnt(2)
    v_exp_f32 v17, v101
    v_cvt_pk_bf16_f32 v69, v18, v19
    v_mfma_f32_16x16x32_bf16 v[120:123], v[40:43], v[192:195], v[120:123]
    ds_read_b128 v[32:35], v1 offset:1024
    v_mfma_f32_16x16x32_bf16 v[120:123], v[44:47], v[196:199], v[120:123]
    v_exp_f32 v18, v102
    v_mfma_f32_16x16x32_bf16 v[124:127], v[40:43], v[216:219], v[124:127]
    ds_read_b128 v[36:39], v1 offset:13312
    v_add_f32 v6, v6, v16
    v_mfma_f32_16x16x32_bf16 v[124:127], v[44:47], v[220:223], v[124:127]
    s_waitcnt lgkmcnt(2)
    v_add_f32 v6, v6, v17
    v_exp_f32 v19, v103
    v_cvt_pk_bf16_f32 v70, v16, v17
    v_add_f32 v6, v6, v18
    v_add_f32 v6, v6, v19
    v_cvt_pk_bf16_f32 v71, v18, v19
    v_mfma_f32_16x16x32_bf16 a[0:3], v[160:163], v[24:27], a[0:3]
    ds_read_b128 v[40:43], v1 offset:2048
    v_mfma_f32_16x16x32_bf16 a[0:3], v[168:171], v[28:31], a[0:3]
    v_exp_f32 v16, v72
    v_mfma_f32_16x16x32_bf16 a[48:51], v[164:167], v[24:27], a[48:51]
    ds_read_b128 v[44:47], v1 offset:14336
    v_mfma_f32_16x16x32_bf16 a[48:51], v[172:175], v[28:31], a[48:51]
    s_waitcnt lgkmcnt(2)
    v_exp_f32 v17, v73
    v_mfma_f32_16x16x32_bf16 a[4:7], v[160:163], v[32:35], a[4:7]
    ds_read_b128 v[24:27], v1 offset:3072
    v_mfma_f32_16x16x32_bf16 a[4:7], v[168:171], v[36:39], a[4:7]
    v_exp_f32 v18, v74
    v_mfma_f32_16x16x32_bf16 a[52:55], v[164:167], v[32:35], a[52:55]
    ds_read_b128 v[28:31], v1 offset:15360
    v_add_f32 v5, v5, v16
    v_mfma_f32_16x16x32_bf16 a[52:55], v[172:175], v[36:39], a[52:55]
    s_waitcnt lgkmcnt(2)
    v_add_f32 v5, v5, v17
    v_mfma_f32_16x16x32_bf16 a[8:11], v[160:163], v[40:43], a[8:11]
    ds_read_b128 v[32:35], v1 offset:4096
    v_mfma_f32_16x16x32_bf16 a[8:11], v[168:171], v[44:47], a[8:11]
    v_exp_f32 v19, v75
    v_mfma_f32_16x16x32_bf16 a[56:59], v[164:167], v[40:43], a[56:59]
    ds_read_b128 v[36:39], v1 offset:16384
    v_cvt_pk_bf16_f32 v72, v16, v17
    v_mfma_f32_16x16x32_bf16 a[56:59], v[172:175], v[44:47], a[56:59]
    s_waitcnt lgkmcnt(2)
    v_exp_f32 v16, v104
    v_mfma_f32_16x16x32_bf16 a[12:15], v[160:163], v[24:27], a[12:15]
    ds_read_b128 v[40:43], v1 offset:5120
    v_add_f32 v5, v5, v18
    v_mfma_f32_16x16x32_bf16 a[12:15], v[168:171], v[28:31], a[12:15]
    v_add_f32 v5, v5, v19
    v_mfma_f32_16x16x32_bf16 a[60:63], v[164:167], v[24:27], a[60:63]
    ds_read_b128 v[44:47], v1 offset:17408
    v_mfma_f32_16x16x32_bf16 a[60:63], v[172:175], v[28:31], a[60:63]
    s_waitcnt lgkmcnt(2)
    v_exp_f32 v17, v105
    v_mfma_f32_16x16x32_bf16 a[16:19], v[160:163], v[32:35], a[16:19]
    ds_read_b128 v[24:27], v1 offset:6144
    v_cvt_pk_bf16_f32 v73, v18, v19
    v_mfma_f32_16x16x32_bf16 a[16:19], v[168:171], v[36:39], a[16:19]
    v_exp_f32 v18, v106
    v_mfma_f32_16x16x32_bf16 a[64:67], v[164:167], v[32:35], a[64:67]
    ds_read_b128 v[28:31], v1 offset:18432
    v_add_f32 v5, v5, v16
    v_mfma_f32_16x16x32_bf16 a[64:67], v[172:175], v[36:39], a[64:67]
    s_waitcnt lgkmcnt(2)
    v_add_f32 v5, v5, v17
    v_mfma_f32_16x16x32_bf16 a[20:23], v[160:163], v[40:43], a[20:23]
    ds_read_b128 v[32:35], v1 offset:7168
    v_mfma_f32_16x16x32_bf16 a[20:23], v[168:171], v[44:47], a[20:23]
    v_exp_f32 v19, v107
    v_mfma_f32_16x16x32_bf16 a[68:71], v[164:167], v[40:43], a[68:71]
    ds_read_b128 v[36:39], v1 offset:19456
    v_cvt_pk_bf16_f32 v74, v16, v17
    v_mfma_f32_16x16x32_bf16 a[68:71], v[172:175], v[44:47], a[68:71]
    s_waitcnt lgkmcnt(2)
    v_exp_f32 v16, v76
    v_mfma_f32_16x16x32_bf16 a[24:27], v[160:163], v[24:27], a[24:27]
    ds_read_b128 v[40:43], v1 offset:8192
    v_add_f32 v5, v5, v18
    v_mfma_f32_16x16x32_bf16 a[24:27], v[168:171], v[28:31], a[24:27]
    v_add_f32 v5, v5, v19
    v_mfma_f32_16x16x32_bf16 a[72:75], v[164:167], v[24:27], a[72:75]
    ds_read_b128 v[44:47], v1 offset:20480
    v_mfma_f32_16x16x32_bf16 a[72:75], v[172:175], v[28:31], a[72:75]
    s_waitcnt lgkmcnt(2)
    v_exp_f32 v17, v77
    v_mfma_f32_16x16x32_bf16 a[28:31], v[160:163], v[32:35], a[28:31]
    ds_read_b128 v[24:27], v1 offset:9216
    v_cvt_pk_bf16_f32 v75, v18, v19
    v_mfma_f32_16x16x32_bf16 a[28:31], v[168:171], v[36:39], a[28:31]
    v_exp_f32 v18, v78
    v_mfma_f32_16x16x32_bf16 a[76:79], v[164:167], v[32:35], a[76:79]
    ds_read_b128 v[28:31], v1 offset:21504
    v_add_f32 v6, v6, v16
    v_mfma_f32_16x16x32_bf16 a[76:79], v[172:175], v[36:39], a[76:79]
    s_waitcnt lgkmcnt(2)
    v_add_f32 v6, v6, v17
    v_mfma_f32_16x16x32_bf16 a[32:35], v[160:163], v[40:43], a[32:35]
    ds_read_b128 v[32:35], v1 offset:10240
    v_mfma_f32_16x16x32_bf16 a[32:35], v[168:171], v[44:47], a[32:35]
    v_exp_f32 v19, v79
    v_mfma_f32_16x16x32_bf16 a[80:83], v[164:167], v[40:43], a[80:83]
    ds_read_b128 v[36:39], v1 offset:22528
    v_cvt_pk_bf16_f32 v76, v16, v17
    v_mfma_f32_16x16x32_bf16 a[80:83], v[172:175], v[44:47], a[80:83]
    s_waitcnt lgkmcnt(2)
    v_exp_f32 v16, v108
    v_mfma_f32_16x16x32_bf16 a[36:39], v[160:163], v[24:27], a[36:39]
    ds_read_b128 v[40:43], v1 offset:11264
    v_add_f32 v6, v6, v18
    v_mfma_f32_16x16x32_bf16 a[36:39], v[168:171], v[28:31], a[36:39]
    v_add_f32 v6, v6, v19
    v_mfma_f32_16x16x32_bf16 a[84:87], v[164:167], v[24:27], a[84:87]
    ds_read_b128 v[44:47], v1 offset:23552
    v_mfma_f32_16x16x32_bf16 a[84:87], v[172:175], v[28:31], a[84:87]
    s_waitcnt lgkmcnt(2)
    v_subrev_u32 v1, 98304, v1
    v_mfma_f32_16x16x32_bf16 a[40:43], v[160:163], v[32:35], a[40:43]
    ds_read_b128 v[24:27], v1 offset:0
    v_mfma_f32_16x16x32_bf16 a[40:43], v[168:171], v[36:39], a[40:43]
    v_exp_f32 v17, v109
    v_mfma_f32_16x16x32_bf16 a[88:91], v[164:167], v[32:35], a[88:91]
    ds_read_b128 v[28:31], v1 offset:12288
    v_cvt_pk_bf16_f32 v77, v18, v19
    v_mfma_f32_16x16x32_bf16 a[88:91], v[172:175], v[36:39], a[88:91]
    s_waitcnt lgkmcnt(2)
    v_exp_f32 v18, v110
    v_mfma_f32_16x16x32_bf16 a[44:47], v[160:163], v[40:43], a[44:47]
    ds_read_b128 v[32:35], v1 offset:1024
    v_add_f32 v6, v6, v16
    v_mfma_f32_16x16x32_bf16 a[44:47], v[168:171], v[44:47], a[44:47]
    v_add_f32 v6, v6, v17
    v_mfma_f32_16x16x32_bf16 a[92:95], v[164:167], v[40:43], a[92:95]
    ds_read_b128 v[36:39], v1 offset:13312
    v_mfma_f32_16x16x32_bf16 a[92:95], v[172:175], v[44:47], a[92:95]
    s_waitcnt lgkmcnt(2)
    v_exp_f32 v19, v111
    v_mfma_f32_16x16x32_bf16 a[0:3], v[176:179], v[24:27], a[0:3]
    ds_read_b128 v[40:43], v1 offset:2048
    v_cvt_pk_bf16_f32 v78, v16, v17
    v_mfma_f32_16x16x32_bf16 a[0:3], v[184:187], v[28:31], a[0:3]
    v_add_f32 v6, v6, v18
    v_add_f32 v6, v6, v19
    v_mfma_f32_16x16x32_bf16 a[48:51], v[180:183], v[24:27], a[48:51]
    ds_read_b128 v[44:47], v1 offset:14336
    v_cvt_pk_bf16_f32 v79, v18, v19
    v_mfma_f32_16x16x32_bf16 a[48:51], v[188:191], v[28:31], a[48:51]
    s_waitcnt lgkmcnt(2)
    v_exp_f32 v16, v80
    v_mfma_f32_16x16x32_bf16 a[4:7], v[176:179], v[32:35], a[4:7]
    ds_read_b128 v[24:27], v1 offset:3072
    v_mfma_f32_16x16x32_bf16 a[4:7], v[184:187], v[36:39], a[4:7]
    v_exp_f32 v17, v81
    v_mfma_f32_16x16x32_bf16 a[52:55], v[180:183], v[32:35], a[52:55]
    ds_read_b128 v[28:31], v1 offset:15360
    v_mfma_f32_16x16x32_bf16 a[52:55], v[188:191], v[36:39], a[52:55]
    s_waitcnt lgkmcnt(2)
    v_exp_f32 v18, v82
    v_mfma_f32_16x16x32_bf16 a[8:11], v[176:179], v[40:43], a[8:11]
    ds_read_b128 v[32:35], v1 offset:4096
    v_add_f32 v7, v7, v16
    v_mfma_f32_16x16x32_bf16 a[8:11], v[184:187], v[44:47], a[8:11]
    v_add_f32 v7, v7, v17
    v_mfma_f32_16x16x32_bf16 a[56:59], v[180:183], v[40:43], a[56:59]
    ds_read_b128 v[36:39], v1 offset:16384
    v_mfma_f32_16x16x32_bf16 a[56:59], v[188:191], v[44:47], a[56:59]
    s_waitcnt lgkmcnt(2)
    v_exp_f32 v19, v83
    v_mfma_f32_16x16x32_bf16 a[12:15], v[176:179], v[24:27], a[12:15]
    ds_read_b128 v[40:43], v1 offset:5120
    v_cvt_pk_bf16_f32 v80, v16, v17
    v_mfma_f32_16x16x32_bf16 a[12:15], v[184:187], v[28:31], a[12:15]
    v_exp_f32 v16, v112
    v_mfma_f32_16x16x32_bf16 a[60:63], v[180:183], v[24:27], a[60:63]
    ds_read_b128 v[44:47], v1 offset:17408
    v_add_f32 v7, v7, v18
    v_mfma_f32_16x16x32_bf16 a[60:63], v[188:191], v[28:31], a[60:63]
    s_waitcnt lgkmcnt(2)
    v_add_f32 v7, v7, v19
    v_mfma_f32_16x16x32_bf16 a[16:19], v[176:179], v[32:35], a[16:19]
    ds_read_b128 v[24:27], v1 offset:6144
    v_mfma_f32_16x16x32_bf16 a[16:19], v[184:187], v[36:39], a[16:19]
    v_exp_f32 v17, v113
    v_mfma_f32_16x16x32_bf16 a[64:67], v[180:183], v[32:35], a[64:67]
    ds_read_b128 v[28:31], v1 offset:18432
    v_cvt_pk_bf16_f32 v81, v18, v19
    v_mfma_f32_16x16x32_bf16 a[64:67], v[188:191], v[36:39], a[64:67]
    s_waitcnt lgkmcnt(2)
    v_exp_f32 v18, v114
    v_mfma_f32_16x16x32_bf16 a[20:23], v[176:179], v[40:43], a[20:23]
    ds_read_b128 v[32:35], v1 offset:7168
    v_add_f32 v7, v7, v16
    v_mfma_f32_16x16x32_bf16 a[20:23], v[184:187], v[44:47], a[20:23]
    v_add_f32 v7, v7, v17
    v_mfma_f32_16x16x32_bf16 a[68:71], v[180:183], v[40:43], a[68:71]
    ds_read_b128 v[36:39], v1 offset:19456
    v_mfma_f32_16x16x32_bf16 a[68:71], v[188:191], v[44:47], a[68:71]
    s_waitcnt lgkmcnt(2)
    v_exp_f32 v19, v115
    v_mfma_f32_16x16x32_bf16 a[24:27], v[176:179], v[24:27], a[24:27]
    ds_read_b128 v[40:43], v1 offset:8192
    v_cvt_pk_bf16_f32 v82, v16, v17
    v_mfma_f32_16x16x32_bf16 a[24:27], v[184:187], v[28:31], a[24:27]
    v_exp_f32 v16, v84
    v_mfma_f32_16x16x32_bf16 a[72:75], v[180:183], v[24:27], a[72:75]
    ds_read_b128 v[44:47], v1 offset:20480
    v_add_f32 v7, v7, v18
    v_mfma_f32_16x16x32_bf16 a[72:75], v[188:191], v[28:31], a[72:75]
    s_waitcnt lgkmcnt(2)
    v_add_f32 v7, v7, v19
    v_mfma_f32_16x16x32_bf16 a[28:31], v[176:179], v[32:35], a[28:31]
    ds_read_b128 v[24:27], v1 offset:9216
    v_mfma_f32_16x16x32_bf16 a[28:31], v[184:187], v[36:39], a[28:31]
    s_waitcnt vmcnt(0)
    v_exp_f32 v17, v85
    v_mfma_f32_16x16x32_bf16 a[76:79], v[180:183], v[32:35], a[76:79]
    ds_read_b128 v[28:31], v1 offset:21504
    v_cvt_pk_bf16_f32 v83, v18, v19
    v_mfma_f32_16x16x32_bf16 a[76:79], v[188:191], v[36:39], a[76:79]
    s_waitcnt lgkmcnt(2)
    s_barrier
    v_mfma_f32_16x16x32_bf16 a[32:35], v[176:179], v[40:43], a[32:35]
    ds_read_b128 v[32:35], v1 offset:10240
    v_mfma_f32_16x16x32_bf16 a[32:35], v[184:187], v[44:47], a[32:35]
    v_exp_f32 v18, v86
    v_mfma_f32_16x16x32_bf16 a[80:83], v[180:183], v[40:43], a[80:83]
    ds_read_b128 v[36:39], v1 offset:22528
    v_add_f32 v8, v8, v16
    v_mfma_f32_16x16x32_bf16 a[80:83], v[188:191], v[44:47], a[80:83]
    s_waitcnt lgkmcnt(2)
    v_add_f32 v8, v8, v17
    v_mfma_f32_16x16x32_bf16 a[36:39], v[176:179], v[24:27], a[36:39]
    ds_read_b128 v[40:43], v1 offset:11264
    v_mfma_f32_16x16x32_bf16 a[36:39], v[184:187], v[28:31], a[36:39]
    v_exp_f32 v19, v87
    v_cvt_pk_bf16_f32 v84, v16, v17
    v_mfma_f32_16x16x32_bf16 a[84:87], v[180:183], v[24:27], a[84:87]
    ds_read_b128 v[44:47], v1 offset:23552
    v_mfma_f32_16x16x32_bf16 a[84:87], v[188:191], v[28:31], a[84:87]
    s_waitcnt lgkmcnt(2)
    v_add_u32 v1, 49152, v1
    v_exp_f32 v16, v116
    v_mfma_f32_16x16x32_bf16 a[40:43], v[176:179], v[32:35], a[40:43]
    ds_read_b128 v[24:27], v1 offset:0
    v_add_f32 v8, v8, v18
    v_mfma_f32_16x16x32_bf16 a[40:43], v[184:187], v[36:39], a[40:43]
    v_add_f32 v8, v8, v19
    v_mfma_f32_16x16x32_bf16 a[88:91], v[180:183], v[32:35], a[88:91]
    ds_read_b128 v[28:31], v1 offset:12288
    v_mfma_f32_16x16x32_bf16 a[88:91], v[188:191], v[36:39], a[88:91]
    s_waitcnt lgkmcnt(2)
    v_exp_f32 v17, v117
    v_cvt_pk_bf16_f32 v85, v18, v19
    v_mfma_f32_16x16x32_bf16 a[44:47], v[176:179], v[40:43], a[44:47]
    ds_read_b128 v[32:35], v1 offset:1024
    v_mfma_f32_16x16x32_bf16 a[44:47], v[184:187], v[44:47], a[44:47]
    v_exp_f32 v18, v118
    v_mfma_f32_16x16x32_bf16 a[92:95], v[180:183], v[40:43], a[92:95]
    ds_read_b128 v[36:39], v1 offset:13312
    v_add_f32 v8, v8, v16
    v_mfma_f32_16x16x32_bf16 a[92:95], v[188:191], v[44:47], a[92:95]
    s_waitcnt lgkmcnt(2)
    v_add_f32 v8, v8, v17
    v_exp_f32 v19, v119
    v_cvt_pk_bf16_f32 v86, v16, v17
    v_add_f32 v8, v8, v18
    v_add_f32 v8, v8, v19
    v_cvt_pk_bf16_f32 v87, v18, v19
    v_mfma_f32_16x16x32_bf16 a[0:3], v[64:67], v[24:27], a[0:3]
    ds_read_b128 v[40:43], v1 offset:2048
    v_mov_b32 v16, v5
    v_mfma_f32_16x16x32_bf16 a[0:3], v[72:75], v[28:31], a[0:3]
    v_mov_b32 v17, v6
    s_nop 0
    v_mfma_f32_16x16x32_bf16 a[48:51], v[68:71], v[24:27], a[48:51]
    ds_read_b128 v[44:47], v1 offset:14336
    v_permlane16_swap_b32 v5, v16
    v_mfma_f32_16x16x32_bf16 a[48:51], v[76:79], v[28:31], a[48:51]
    s_waitcnt lgkmcnt(2)
    v_permlane16_swap_b32 v6, v17
    s_nop 0
    v_mfma_f32_16x16x32_bf16 a[4:7], v[64:67], v[32:35], a[4:7]
    ds_read_b128 v[24:27], v1 offset:3072
    v_add_f32 v5, v5, v16
    v_mfma_f32_16x16x32_bf16 a[4:7], v[72:75], v[36:39], a[4:7]
    v_add_f32 v6, v6, v17
    v_mov_b32 v16, v5
    v_mfma_f32_16x16x32_bf16 a[52:55], v[68:71], v[32:35], a[52:55]
    ds_read_b128 v[28:31], v1 offset:15360
    v_mov_b32 v17, v6
    v_mfma_f32_16x16x32_bf16 a[52:55], v[76:79], v[36:39], a[52:55]
    s_waitcnt lgkmcnt(2)
    s_nop 0
    v_permlane32_swap_b32 v5, v16
    v_permlane32_swap_b32 v6, v17
    v_mfma_f32_16x16x32_bf16 a[8:11], v[64:67], v[40:43], a[8:11]
    s_nop 0
    ds_read_b128 v[32:35], v1 offset:4096
    v_add_f32 v5, v5, v16
    v_mfma_f32_16x16x32_bf16 a[8:11], v[72:75], v[44:47], a[8:11]
    v_add_f32 v6, v6, v17
    v_rcp_f32 v16, v5
    v_mfma_f32_16x16x32_bf16 a[56:59], v[68:71], v[40:43], a[56:59]
    ds_read_b128 v[36:39], v1 offset:16384
    v_mfma_f32_16x16x32_bf16 a[56:59], v[76:79], v[44:47], a[56:59]
    s_waitcnt lgkmcnt(2)
    v_rcp_f32 v17, v6
    v_mfma_f32_16x16x32_bf16 a[12:15], v[64:67], v[24:27], a[12:15]
    s_nop 0
    ds_read_b128 v[40:43], v1 offset:5120
    ds_bpermute_b32 v48, v58, v16 offset:0
    v_mfma_f32_16x16x32_bf16 a[12:15], v[72:75], v[28:31], a[12:15]
    ds_bpermute_b32 v49, v58, v16 offset:4
    ds_bpermute_b32 v50, v58, v16 offset:8
    v_mfma_f32_16x16x32_bf16 a[60:63], v[68:71], v[24:27], a[60:63]
    ds_read_b128 v[44:47], v1 offset:17408
    ds_bpermute_b32 v51, v58, v16 offset:12
    v_mfma_f32_16x16x32_bf16 a[60:63], v[76:79], v[28:31], a[60:63]
    s_waitcnt lgkmcnt(6)
    ds_bpermute_b32 v52, v58, v17 offset:0
    ds_bpermute_b32 v53, v58, v17 offset:4
    v_mfma_f32_16x16x32_bf16 a[16:19], v[64:67], v[32:35], a[16:19]
    ds_read_b128 v[24:27], v1 offset:6144
    ds_bpermute_b32 v54, v58, v17 offset:8
    v_mfma_f32_16x16x32_bf16 a[16:19], v[72:75], v[36:39], a[16:19]
    ds_bpermute_b32 v55, v58, v17 offset:12
    v_exp_f32 v16, v88
    v_mfma_f32_16x16x32_bf16 a[64:67], v[68:71], v[32:35], a[64:67]
    ds_read_b128 v[28:31], v1 offset:18432
    v_mfma_f32_16x16x32_bf16 a[64:67], v[76:79], v[36:39], a[64:67]
    s_waitcnt lgkmcnt(7)
    v_exp_f32 v17, v89
    v_mfma_f32_16x16x32_bf16 a[20:23], v[64:67], v[40:43], a[20:23]
    ds_read_b128 v[32:35], v1 offset:7168
    v_mfma_f32_16x16x32_bf16 a[20:23], v[72:75], v[44:47], a[20:23]
    v_exp_f32 v18, v90
    v_mfma_f32_16x16x32_bf16 a[68:71], v[68:71], v[40:43], a[68:71]
    ds_read_b128 v[36:39], v1 offset:19456
    v_add_f32 v7, v7, v16
    v_mfma_f32_16x16x32_bf16 a[68:71], v[76:79], v[44:47], a[68:71]
    s_waitcnt lgkmcnt(2)
    v_add_f32 v7, v7, v17
    v_exp_f32 v19, v91
    v_mfma_f32_16x16x32_bf16 a[24:27], v[64:67], v[24:27], a[24:27]
    ds_read_b128 v[40:43], v1 offset:8192
    v_cvt_pk_bf16_f32 v88, v16, v17
    v_mfma_f32_16x16x32_bf16 a[24:27], v[72:75], v[28:31], a[24:27]
    v_exp_f32 v16, v120
    v_mfma_f32_16x16x32_bf16 a[72:75], v[68:71], v[24:27], a[72:75]
    ds_read_b128 v[44:47], v1 offset:20480
    v_add_f32 v7, v7, v18
    v_mfma_f32_16x16x32_bf16 a[72:75], v[76:79], v[28:31], a[72:75]
    s_waitcnt lgkmcnt(2)
    v_add_f32 v7, v7, v19
    v_exp_f32 v17, v121
    v_mfma_f32_16x16x32_bf16 a[28:31], v[64:67], v[32:35], a[28:31]
    ds_read_b128 v[24:27], v1 offset:9216
    v_cvt_pk_bf16_f32 v89, v18, v19
    v_mfma_f32_16x16x32_bf16 a[28:31], v[72:75], v[36:39], a[28:31]
    v_exp_f32 v18, v122
    v_mfma_f32_16x16x32_bf16 a[76:79], v[68:71], v[32:35], a[76:79]
    ds_read_b128 v[28:31], v1 offset:21504
    v_add_f32 v7, v7, v16
    v_mfma_f32_16x16x32_bf16 a[76:79], v[76:79], v[36:39], a[76:79]
    s_waitcnt lgkmcnt(2)
    v_add_f32 v7, v7, v17
    v_exp_f32 v19, v123
    v_mfma_f32_16x16x32_bf16 a[32:35], v[64:67], v[40:43], a[32:35]
    ds_read_b128 v[32:35], v1 offset:10240
    v_cvt_pk_bf16_f32 v90, v16, v17
    v_mfma_f32_16x16x32_bf16 a[32:35], v[72:75], v[44:47], a[32:35]
    v_exp_f32 v16, v92
    v_mfma_f32_16x16x32_bf16 a[80:83], v[68:71], v[40:43], a[80:83]
    ds_read_b128 v[36:39], v1 offset:22528
    v_add_f32 v7, v7, v18
    v_mfma_f32_16x16x32_bf16 a[80:83], v[76:79], v[44:47], a[80:83]
    s_waitcnt lgkmcnt(2)
    v_add_f32 v7, v7, v19
    v_exp_f32 v17, v93
    v_mfma_f32_16x16x32_bf16 a[36:39], v[64:67], v[24:27], a[36:39]
    ds_read_b128 v[40:43], v1 offset:11264
    v_cvt_pk_bf16_f32 v91, v18, v19
    v_mfma_f32_16x16x32_bf16 a[36:39], v[72:75], v[28:31], a[36:39]
    v_exp_f32 v18, v94
    v_mfma_f32_16x16x32_bf16 a[84:87], v[68:71], v[24:27], a[84:87]
    ds_read_b128 v[44:47], v1 offset:23552
    v_add_f32 v8, v8, v16
    v_mfma_f32_16x16x32_bf16 a[84:87], v[76:79], v[28:31], a[84:87]
    s_waitcnt lgkmcnt(2)
    v_subrev_u32 v2, 98304, v2
    v_subrev_u32 v3, 98304, v3
    v_mfma_f32_16x16x32_bf16 a[40:43], v[64:67], v[32:35], a[40:43]
    ds_read_b128 v[24:27], v2 offset:0
    v_add_f32 v8, v8, v17
    v_mfma_f32_16x16x32_bf16 a[40:43], v[72:75], v[36:39], a[40:43]
    v_exp_f32 v19, v95
    v_mfma_f32_16x16x32_bf16 a[88:91], v[68:71], v[32:35], a[88:91]
    ds_read_b128 v[28:31], v3 offset:0
    v_cvt_pk_bf16_f32 v92, v16, v17
    v_mfma_f32_16x16x32_bf16 a[88:91], v[76:79], v[36:39], a[88:91]
    s_waitcnt lgkmcnt(2)
    v_exp_f32 v16, v124
    v_add_f32 v8, v8, v18
    v_mfma_f32_16x16x32_bf16 a[44:47], v[64:67], v[40:43], a[44:47]
    ds_read_b128 v[32:35], v2 offset:6144
    v_add_f32 v8, v8, v19
    v_mfma_f32_16x16x32_bf16 a[44:47], v[72:75], v[44:47], a[44:47]
    v_exp_f32 v17, v125
    v_mfma_f32_16x16x32_bf16 a[92:95], v[68:71], v[40:43], a[92:95]
    ds_read_b128 v[36:39], v3 offset:6144
    v_cvt_pk_bf16_f32 v93, v18, v19
    v_mfma_f32_16x16x32_bf16 a[92:95], v[76:79], v[44:47], a[92:95]
    s_waitcnt lgkmcnt(2)
    v_exp_f32 v18, v126
    v_mfma_f32_16x16x32_bf16 v[160:163], v[24:27], a[240:243], v[136:139]
    ds_read_b128 v[40:43], v2 offset:128
    v_add_f32 v8, v8, v16
    v_mfma_f32_16x16x32_bf16 v[160:163], v[28:31], a[244:247], v[160:163]
    v_add_f32 v8, v8, v17
    v_exp_f32 v19, v127
    v_mfma_f32_16x16x32_bf16 v[164:167], v[24:27], v[200:203], v[140:143]
    ds_read_b128 v[44:47], v3 offset:128
    v_cvt_pk_bf16_f32 v94, v16, v17
    v_mfma_f32_16x16x32_bf16 v[164:167], v[28:31], v[204:207], v[164:167]
    s_waitcnt lgkmcnt(2)
    v_add_f32 v8, v8, v18
    v_add_f32 v8, v8, v19
    v_mfma_f32_16x16x32_bf16 v[96:99], v[32:35], a[240:243], v[136:139]
    ds_read_b128 v[24:27], v2 offset:6272
    v_accvgpr_read_b32 v224, a0
    v_mfma_f32_16x16x32_bf16 v[96:99], v[36:39], a[244:247], v[96:99]
    v_accvgpr_read_b32 v225, a12
    v_accvgpr_read_b32 v226, a24
    v_accvgpr_read_b32 v227, a36
    s_waitcnt lgkmcnt(15)
    v_mul_f32 v224, v224, v48
    v_mul_f32 v225, v225, v48
    v_mfma_f32_16x16x32_bf16 v[100:103], v[32:35], v[200:203], v[140:143]
    ds_read_b128 v[28:31], v3 offset:6272
    v_mul_f32 v226, v226, v48
    v_mfma_f32_16x16x32_bf16 v[100:103], v[36:39], v[204:207], v[100:103]
    s_waitcnt lgkmcnt(2)
    v_mul_f32 v227, v227, v48
    v_cvt_pk_bf16_f32 v224, v224, v225
    v_cvt_pk_bf16_f32 v225, v226, v227
    v_accvgpr_read_b32 v228, a1
    v_accvgpr_read_b32 v229, a13
    v_accvgpr_read_b32 v230, a25
    v_mfma_f32_16x16x32_bf16 v[160:163], v[40:43], a[248:251], v[160:163]
    ds_read_b128 v[32:35], v2 offset:256
    v_accvgpr_read_b32 v231, a37
    v_mfma_f32_16x16x32_bf16 v[160:163], v[44:47], a[252:255], v[160:163]
    buffer_store_dwordx2 v[224:225], v56, s[12:15], s24 offen offset:0 sc0 sc1
    v_mul_f32 v228, v228, v49
    v_mul_f32 v229, v229, v49
    v_mul_f32 v230, v230, v49
    v_mfma_f32_16x16x32_bf16 v[164:167], v[40:43], v[208:211], v[164:167]
    ds_read_b128 v[36:39], v3 offset:256
    v_mul_f32 v231, v231, v49
    v_mfma_f32_16x16x32_bf16 v[164:167], v[44:47], v[212:215], v[164:167]
    s_waitcnt lgkmcnt(2)
    v_cvt_pk_bf16_f32 v228, v228, v229
    v_cvt_pk_bf16_f32 v229, v230, v231
    v_accvgpr_read_b32 v232, a2
    v_accvgpr_read_b32 v233, a14
    v_accvgpr_read_b32 v234, a26
    v_accvgpr_read_b32 v235, a38
    v_mfma_f32_16x16x32_bf16 v[96:99], v[24:27], a[248:251], v[96:99]
    ds_read_b128 v[40:43], v2 offset:6400
    v_mul_f32 v232, v232, v50
    v_mfma_f32_16x16x32_bf16 v[96:99], v[28:31], a[252:255], v[96:99]
    buffer_store_dwordx2 v[228:229], v56, s[12:15], s24 offen offset:384 sc0 sc1
    v_mul_f32 v233, v233, v50
    v_mul_f32 v234, v234, v50
    v_mul_f32 v235, v235, v50
    v_mfma_f32_16x16x32_bf16 v[100:103], v[24:27], v[208:211], v[100:103]
    ds_read_b128 v[44:47], v3 offset:6400
    v_cvt_pk_bf16_f32 v232, v232, v233
    v_mfma_f32_16x16x32_bf16 v[100:103], v[28:31], v[212:215], v[100:103]
    s_waitcnt lgkmcnt(2)
    v_cvt_pk_bf16_f32 v233, v234, v235
    v_accvgpr_read_b32 v236, a3
    v_accvgpr_read_b32 v237, a15
    v_accvgpr_read_b32 v238, a27
    v_accvgpr_read_b32 v239, a39
    v_mfma_f32_16x16x32_bf16 v[160:163], v[32:35], v[192:195], v[160:163]
    ds_read_b128 v[24:27], v2 offset:12288
    v_mul_f32 v236, v236, v51
    v_mfma_f32_16x16x32_bf16 v[160:163], v[36:39], v[196:199], v[160:163]
    buffer_store_dwordx2 v[232:233], v56, s[12:15], s24 offen offset:768 sc0 sc1
    v_mul_f32 v237, v237, v51
    v_mul_f32 v238, v238, v51
    v_mul_f32 v239, v239, v51
    v_mfma_f32_16x16x32_bf16 v[164:167], v[32:35], v[216:219], v[164:167]
    ds_read_b128 v[28:31], v3 offset:12288
    v_cvt_pk_bf16_f32 v236, v236, v237
    v_mfma_f32_16x16x32_bf16 v[164:167], v[36:39], v[220:223], v[164:167]
    s_waitcnt lgkmcnt(2)
    v_cvt_pk_bf16_f32 v237, v238, v239
    v_accvgpr_read_b32 v240, a4
    v_accvgpr_read_b32 v241, a16
    v_accvgpr_read_b32 v242, a28
    v_accvgpr_read_b32 v243, a40
    v_mul_f32 v240, v240, v48
    v_mfma_f32_16x16x32_bf16 v[96:99], v[40:43], v[192:195], v[96:99]
    ds_read_b128 v[32:35], v2 offset:18432
    v_mul_f32 v241, v241, v48
    v_mfma_f32_16x16x32_bf16 v[96:99], v[44:47], v[196:199], v[96:99]
    buffer_store_dwordx2 v[236:237], v56, s[12:15], s24 offen offset:1152 sc0 sc1
    v_mul_f32 v242, v242, v48
    v_mul_f32 v243, v243, v48
    v_cvt_pk_bf16_f32 v240, v240, v241
    v_mfma_f32_16x16x32_bf16 v[100:103], v[40:43], v[216:219], v[100:103]
    ds_read_b128 v[36:39], v3 offset:18432
    v_cvt_pk_bf16_f32 v241, v242, v243
    v_mfma_f32_16x16x32_bf16 v[100:103], v[44:47], v[220:223], v[100:103]
    s_waitcnt lgkmcnt(2)
    buffer_store_dwordx2 v[240:241], v56, s[12:15], s24 offen offset:128 sc0 sc1
    v_accvgpr_read_b32 v244, a5
    v_accvgpr_read_b32 v245, a17
    v_accvgpr_read_b32 v246, a29
    v_mfma_f32_16x16x32_bf16 v[168:171], v[24:27], a[240:243], v[136:139]
    ds_read_b128 v[40:43], v2 offset:12416
    v_accvgpr_read_b32 v247, a41
    v_mfma_f32_16x16x32_bf16 v[168:171], v[28:31], a[244:247], v[168:171]
    v_mul_f32 v244, v244, v49
    v_mul_f32 v245, v245, v49
    v_mul_f32 v246, v246, v49
    v_mul_f32 v247, v247, v49
    v_cvt_pk_bf16_f32 v244, v244, v245
    v_cvt_pk_bf16_f32 v245, v246, v247
    v_mfma_f32_16x16x32_bf16 v[172:175], v[24:27], v[200:203], v[140:143]
    ds_read_b128 v[44:47], v3 offset:12416
    v_accvgpr_read_b32 v248, a6
    v_mfma_f32_16x16x32_bf16 v[172:175], v[28:31], v[204:207], v[172:175]
    s_waitcnt lgkmcnt(2)
    buffer_store_dwordx2 v[244:245], v56, s[12:15], s24 offen offset:512 sc0 sc1
    v_accvgpr_read_b32 v249, a18
    v_accvgpr_read_b32 v250, a30
    v_accvgpr_read_b32 v251, a42
    v_mfma_f32_16x16x32_bf16 v[104:107], v[32:35], a[240:243], v[136:139]
    ds_read_b128 v[24:27], v2 offset:18560
    v_mul_f32 v248, v248, v50
    v_mfma_f32_16x16x32_bf16 v[104:107], v[36:39], a[244:247], v[104:107]
    v_mul_f32 v249, v249, v50
    v_mul_f32 v250, v250, v50
    v_mul_f32 v251, v251, v50
    v_cvt_pk_bf16_f32 v248, v248, v249
    v_cvt_pk_bf16_f32 v249, v250, v251
    v_accvgpr_read_b32 v252, a7
    v_mfma_f32_16x16x32_bf16 v[108:111], v[32:35], v[200:203], v[140:143]
    ds_read_b128 v[28:31], v3 offset:18560
    v_accvgpr_read_b32 v253, a19
    v_mfma_f32_16x16x32_bf16 v[108:111], v[36:39], v[204:207], v[108:111]
    s_waitcnt lgkmcnt(2)
    buffer_store_dwordx2 v[248:249], v56, s[12:15], s24 offen offset:896 sc0 sc1
    v_accvgpr_read_b32 v254, a31
    v_accvgpr_read_b32 v255, a43
    v_mul_f32 v252, v252, v51
    v_mfma_f32_16x16x32_bf16 v[168:171], v[40:43], a[248:251], v[168:171]
    ds_read_b128 v[32:35], v2 offset:12544
    v_mul_f32 v253, v253, v51
    v_mfma_f32_16x16x32_bf16 v[168:171], v[44:47], a[252:255], v[168:171]
    v_mul_f32 v254, v254, v51
    v_mul_f32 v255, v255, v51
    v_cvt_pk_bf16_f32 v252, v252, v253
    v_cvt_pk_bf16_f32 v253, v254, v255
    v_accvgpr_read_b32 v224, a8
    v_accvgpr_read_b32 v225, a20
    v_mfma_f32_16x16x32_bf16 v[172:175], v[40:43], v[208:211], v[172:175]
    ds_read_b128 v[36:39], v3 offset:12544
    v_accvgpr_read_b32 v226, a32
    v_mfma_f32_16x16x32_bf16 v[172:175], v[44:47], v[212:215], v[172:175]
    s_waitcnt lgkmcnt(2)
    buffer_store_dwordx2 v[252:253], v56, s[12:15], s24 offen offset:1280 sc0 sc1
    v_accvgpr_read_b32 v227, a44
    v_mul_f32 v224, v224, v48
    v_mul_f32 v225, v225, v48
    v_mfma_f32_16x16x32_bf16 v[104:107], v[24:27], a[248:251], v[104:107]
    ds_read_b128 v[40:43], v2 offset:18688
    v_mul_f32 v226, v226, v48
    v_mfma_f32_16x16x32_bf16 v[104:107], v[28:31], a[252:255], v[104:107]
    v_mul_f32 v227, v227, v48
    v_cvt_pk_bf16_f32 v224, v224, v225
    v_cvt_pk_bf16_f32 v225, v226, v227
    v_accvgpr_read_b32 v228, a9
    v_accvgpr_read_b32 v229, a21
    v_accvgpr_read_b32 v230, a33
    v_mfma_f32_16x16x32_bf16 v[108:111], v[24:27], v[208:211], v[108:111]
    ds_read_b128 v[44:47], v3 offset:18688
    v_accvgpr_read_b32 v231, a45
    v_mfma_f32_16x16x32_bf16 v[108:111], v[28:31], v[212:215], v[108:111]
    s_waitcnt lgkmcnt(2)
    buffer_store_dwordx2 v[224:225], v56, s[12:15], s24 offen offset:256 sc0 sc1
    v_add_u32 v2, 49152, v2
    v_add_u32 v3, 49152, v3
    v_mul_f32 v228, v228, v49
    v_mfma_f32_16x16x32_bf16 v[168:171], v[32:35], v[192:195], v[168:171]
    ds_read_b128 v[24:27], v2 offset:0
    v_mul_f32 v229, v229, v49
    v_mfma_f32_16x16x32_bf16 v[168:171], v[36:39], v[196:199], v[168:171]
    v_mul_f32 v230, v230, v49
    v_mul_f32 v231, v231, v49
    v_cvt_pk_bf16_f32 v228, v228, v229
    v_cvt_pk_bf16_f32 v229, v230, v231
    v_accvgpr_read_b32 v232, a10
    v_accvgpr_read_b32 v233, a22
    v_mfma_f32_16x16x32_bf16 v[172:175], v[32:35], v[216:219], v[172:175]
    ds_read_b128 v[28:31], v3 offset:0
    v_accvgpr_read_b32 v234, a34
    v_mfma_f32_16x16x32_bf16 v[172:175], v[36:39], v[220:223], v[172:175]
    s_waitcnt lgkmcnt(2)
    buffer_store_dwordx2 v[228:229], v56, s[12:15], s24 offen offset:640 sc0 sc1
    v_accvgpr_read_b32 v235, a46
    v_mul_f32 v232, v232, v50
    v_mul_f32 v233, v233, v50
    v_mfma_f32_16x16x32_bf16 v[104:107], v[40:43], v[192:195], v[104:107]
    ds_read_b128 v[32:35], v2 offset:6144
    v_mul_f32 v234, v234, v50
    v_mfma_f32_16x16x32_bf16 v[104:107], v[44:47], v[196:199], v[104:107]
    v_cvt_pk_bf16_f32 v95, v18, v19
    v_exp_f32 v16, v160
    v_exp_f32 v17, v161
    v_mul_f32 v235, v235, v50
    v_mfma_f32_16x16x32_bf16 v[108:111], v[40:43], v[216:219], v[108:111]
    ds_read_b128 v[36:39], v3 offset:6144
    v_cvt_pk_bf16_f32 v232, v232, v233
    v_mfma_f32_16x16x32_bf16 v[108:111], v[44:47], v[220:223], v[108:111]
    s_waitcnt lgkmcnt(2)
    v_exp_f32 v18, v162
    v_add_f32 v7, v7, v16
    v_add_f32 v7, v7, v17
    v_exp_f32 v19, v163
    v_mfma_f32_16x16x32_bf16 v[176:179], v[24:27], a[240:243], v[136:139]
    ds_read_b128 v[40:43], v2 offset:128
    v_cvt_pk_bf16_f32 v160, v16, v17
    v_mfma_f32_16x16x32_bf16 v[176:179], v[28:31], a[244:247], v[176:179]
    v_exp_f32 v16, v96
    v_add_f32 v7, v7, v18
    v_add_f32 v7, v7, v19
    v_exp_f32 v17, v97
    v_mfma_f32_16x16x32_bf16 v[180:183], v[24:27], v[200:203], v[140:143]
    ds_read_b128 v[44:47], v3 offset:128
    v_cvt_pk_bf16_f32 v161, v18, v19
    v_mfma_f32_16x16x32_bf16 v[180:183], v[28:31], v[204:207], v[180:183]
    s_waitcnt lgkmcnt(2)
    v_exp_f32 v18, v98
    v_add_f32 v7, v7, v16
    v_add_f32 v7, v7, v17
    v_exp_f32 v19, v99
    v_mfma_f32_16x16x32_bf16 v[112:115], v[32:35], a[240:243], v[136:139]
    ds_read_b128 v[24:27], v2 offset:6272
    v_cvt_pk_bf16_f32 v162, v16, v17
    v_mfma_f32_16x16x32_bf16 v[112:115], v[36:39], a[244:247], v[112:115]
    v_exp_f32 v16, v164
    v_add_f32 v7, v7, v18
    v_add_f32 v7, v7, v19
    v_exp_f32 v17, v165
    v_mfma_f32_16x16x32_bf16 v[116:119], v[32:35], v[200:203], v[140:143]
    ds_read_b128 v[28:31], v3 offset:6272
    v_cvt_pk_bf16_f32 v163, v18, v19
    v_mfma_f32_16x16x32_bf16 v[116:119], v[36:39], v[204:207], v[116:119]
    s_waitcnt lgkmcnt(2)
    v_exp_f32 v18, v166
    v_add_f32 v8, v8, v16
    v_add_f32 v8, v8, v17
    v_exp_f32 v19, v167
    v_mfma_f32_16x16x32_bf16 v[176:179], v[40:43], a[248:251], v[176:179]
    ds_read_b128 v[32:35], v2 offset:256
    v_cvt_pk_bf16_f32 v164, v16, v17
    v_mfma_f32_16x16x32_bf16 v[176:179], v[44:47], a[252:255], v[176:179]
    v_exp_f32 v16, v100
    v_cvt_pk_bf16_f32 v233, v234, v235
    v_accvgpr_read_b32 v236, a11
    v_accvgpr_read_b32 v237, a23
    v_accvgpr_read_b32 v238, a35
    v_mfma_f32_16x16x32_bf16 v[180:183], v[40:43], v[208:211], v[180:183]
    ds_read_b128 v[36:39], v3 offset:256
    v_add_f32 v8, v8, v18
    v_mfma_f32_16x16x32_bf16 v[180:183], v[44:47], v[212:215], v[180:183]
    s_waitcnt lgkmcnt(2)
    buffer_store_dwordx2 v[232:233], v56, s[12:15], s24 offen offset:1024 sc0 sc1
    v_add_f32 v8, v8, v19
    v_accvgpr_read_b32 v239, a47
    v_mul_f32 v236, v236, v51
    v_mfma_f32_16x16x32_bf16 v[112:115], v[24:27], a[248:251], v[112:115]
    ds_read_b128 v[40:43], v2 offset:6400
    v_mul_f32 v237, v237, v51
    v_mfma_f32_16x16x32_bf16 v[112:115], v[28:31], a[252:255], v[112:115]
    v_exp_f32 v17, v101
    v_cvt_pk_bf16_f32 v165, v18, v19
    v_mul_f32 v238, v238, v51
    v_mul_f32 v239, v239, v51
    v_cvt_pk_bf16_f32 v236, v236, v237
    v_mfma_f32_16x16x32_bf16 v[116:119], v[24:27], v[208:211], v[116:119]
    ds_read_b128 v[44:47], v3 offset:6400
    v_cvt_pk_bf16_f32 v237, v238, v239
    v_mfma_f32_16x16x32_bf16 v[116:119], v[28:31], v[212:215], v[116:119]
    s_waitcnt lgkmcnt(2)
    buffer_store_dwordx2 v[236:237], v56, s[12:15], s24 offen offset:1408 sc0 sc1
    v_exp_f32 v18, v102
    v_mfma_f32_16x16x32_bf16 v[176:179], v[32:35], v[192:195], v[176:179]
    ds_read_b128 v[24:27], v2 offset:12288
    v_add_f32 v8, v8, v16
    v_mfma_f32_16x16x32_bf16 v[176:179], v[36:39], v[196:199], v[176:179]
    v_add_f32 v8, v8, v17
    v_exp_f32 v19, v103
    v_accvgpr_read_b32 v240, a48
    v_accvgpr_read_b32 v241, a60
    v_accvgpr_read_b32 v242, a72
    v_mfma_f32_16x16x32_bf16 v[180:183], v[32:35], v[216:219], v[180:183]
    ds_read_b128 v[28:31], v3 offset:12288
    v_cvt_pk_bf16_f32 v166, v16, v17
    v_mfma_f32_16x16x32_bf16 v[180:183], v[36:39], v[220:223], v[180:183]
    s_waitcnt lgkmcnt(2)
    v_add_f32 v8, v8, v18
    v_accvgpr_read_b32 v243, a84
    s_waitcnt lgkmcnt(15)
    v_add_f32 v8, v8, v19
    v_mul_f32 v240, v240, v52
    v_mul_f32 v241, v241, v52
    v_mfma_f32_16x16x32_bf16 v[112:115], v[40:43], v[192:195], v[112:115]
    ds_read_b128 v[32:35], v2 offset:18432
    v_cvt_pk_bf16_f32 v167, v18, v19
    v_mfma_f32_16x16x32_bf16 v[112:115], v[44:47], v[196:199], v[112:115]
    v_exp_f32 v16, v168
    v_mul_f32 v242, v242, v52
    v_mul_f32 v243, v243, v52
    v_cvt_pk_bf16_f32 v240, v240, v241
    v_cvt_pk_bf16_f32 v241, v242, v243
    v_mfma_f32_16x16x32_bf16 v[116:119], v[40:43], v[216:219], v[116:119]
    ds_read_b128 v[36:39], v3 offset:18432
    v_accvgpr_read_b32 v244, a49
    v_mfma_f32_16x16x32_bf16 v[116:119], v[44:47], v[220:223], v[116:119]
    s_waitcnt lgkmcnt(2)
    buffer_store_dwordx2 v[240:241], v56, s[12:15], s40 offen offset:0 sc0 sc1
    v_exp_f32 v17, v169
    v_accvgpr_read_b32 v245, a61
    v_mfma_f32_16x16x32_bf16 v[184:187], v[24:27], a[240:243], v[136:139]
    ds_read_b128 v[40:43], v2 offset:12416
    v_accvgpr_read_b32 v246, a73
    v_mfma_f32_16x16x32_bf16 v[184:187], v[28:31], a[244:247], v[184:187]
    v_exp_f32 v18, v170
    v_add_f32 v7, v7, v16
    v_accvgpr_read_b32 v247, a85
    v_mul_f32 v244, v244, v53
    v_add_f32 v7, v7, v17
    v_mfma_f32_16x16x32_bf16 v[188:191], v[24:27], v[200:203], v[140:143]
    ds_read_b128 v[44:47], v3 offset:12416
    v_mul_f32 v245, v245, v53
    v_mfma_f32_16x16x32_bf16 v[188:191], v[28:31], v[204:207], v[188:191]
    s_waitcnt lgkmcnt(2)
    v_exp_f32 v19, v171
    v_mul_f32 v246, v246, v53
    v_mul_f32 v247, v247, v53
    v_cvt_pk_bf16_f32 v168, v16, v17
    v_cvt_pk_bf16_f32 v244, v244, v245
    v_mfma_f32_16x16x32_bf16 v[120:123], v[32:35], a[240:243], v[136:139]
    ds_read_b128 v[24:27], v2 offset:18560
    v_cvt_pk_bf16_f32 v245, v246, v247
    v_mfma_f32_16x16x32_bf16 v[120:123], v[36:39], a[244:247], v[120:123]
    buffer_store_dwordx2 v[244:245], v56, s[12:15], s40 offen offset:384 sc0 sc1
    v_exp_f32 v16, v104
    v_accvgpr_read_b32 v248, a50
    v_mfma_f32_16x16x32_bf16 v[124:127], v[32:35], v[200:203], v[140:143]
    ds_read_b128 v[28:31], v3 offset:18560
    v_add_f32 v7, v7, v18
    v_mfma_f32_16x16x32_bf16 v[124:127], v[36:39], v[204:207], v[124:127]
    s_waitcnt lgkmcnt(2)
    v_add_f32 v7, v7, v19
    v_accvgpr_read_b32 v249, a62
    v_accvgpr_read_b32 v250, a74
    v_exp_f32 v17, v105
    v_accvgpr_read_b32 v251, a86
    v_mfma_f32_16x16x32_bf16 v[184:187], v[40:43], a[248:251], v[184:187]
    ds_read_b128 v[32:35], v2 offset:12544
    v_mul_f32 v248, v248, v54
    v_mfma_f32_16x16x32_bf16 v[184:187], v[44:47], a[252:255], v[184:187]
    v_cvt_pk_bf16_f32 v169, v18, v19
    v_mul_f32 v249, v249, v54
    v_exp_f32 v18, v106
    v_mul_f32 v250, v250, v54
    v_mul_f32 v251, v251, v54
    v_mfma_f32_16x16x32_bf16 v[188:191], v[40:43], v[208:211], v[188:191]
    ds_read_b128 v[36:39], v3 offset:12544
    v_cvt_pk_bf16_f32 v248, v248, v249
    v_mfma_f32_16x16x32_bf16 v[188:191], v[44:47], v[212:215], v[188:191]
    s_waitcnt lgkmcnt(2)
    v_add_f32 v7, v7, v16
    v_cvt_pk_bf16_f32 v249, v250, v251
    v_add_f32 v7, v7, v17
    v_accvgpr_read_b32 v252, a51
    v_accvgpr_read_b32 v253, a63
    v_accvgpr_read_b32 v254, a75
    v_mfma_f32_16x16x32_bf16 v[120:123], v[24:27], a[248:251], v[120:123]
    ds_read_b128 v[40:43], v2 offset:18688
    v_accvgpr_read_b32 v255, a87
    v_mfma_f32_16x16x32_bf16 v[120:123], v[28:31], a[252:255], v[120:123]
    buffer_store_dwordx2 v[248:249], v56, s[12:15], s40 offen offset:768 sc0 sc1
    v_exp_f32 v19, v107
    v_cvt_pk_bf16_f32 v170, v16, v17
    v_mfma_f32_16x16x32_bf16 v[124:127], v[24:27], v[208:211], v[124:127]
    ds_read_b128 v[44:47], v3 offset:18688
    v_mul_f32 v252, v252, v55
    v_mfma_f32_16x16x32_bf16 v[124:127], v[28:31], v[212:215], v[124:127]
    s_waitcnt lgkmcnt(2)
    v_add_u32 v22, 49152, v1
    v_mov_b32 v14, v1
    v_subrev_u32 v1, 49152, v1
    v_exp_f32 v16, v172
    v_mul_f32 v253, v253, v55
    v_mfma_f32_16x16x32_bf16 v[184:187], v[32:35], v[192:195], v[184:187]
    ds_read_b128 v[24:27], v22 offset:0
    v_add_f32 v7, v7, v18
    v_mfma_f32_16x16x32_bf16 v[184:187], v[36:39], v[196:199], v[184:187]
    v_add_f32 v7, v7, v19
    v_mul_f32 v254, v254, v55
    v_mul_f32 v255, v255, v55
    v_exp_f32 v17, v173
    v_cvt_pk_bf16_f32 v252, v252, v253
    v_mfma_f32_16x16x32_bf16 v[188:191], v[32:35], v[216:219], v[188:191]
    ds_read_b128 v[28:31], v22 offset:12288
    v_cvt_pk_bf16_f32 v253, v254, v255
    v_mfma_f32_16x16x32_bf16 v[188:191], v[36:39], v[220:223], v[188:191]
    s_waitcnt lgkmcnt(2)
    buffer_store_dwordx2 v[252:253], v56, s[12:15], s40 offen offset:1152 sc0 sc1
    v_cvt_pk_bf16_f32 v171, v18, v19
    v_accvgpr_read_b32 v224, a52
    v_accvgpr_read_b32 v225, a64
    v_mfma_f32_16x16x32_bf16 v[120:123], v[40:43], v[192:195], v[120:123]
    ds_read_b128 v[32:35], v22 offset:3072
    v_accvgpr_read_b32 v226, a76
    v_mfma_f32_16x16x32_bf16 v[120:123], v[44:47], v[196:199], v[120:123]
    v_exp_f32 v18, v174
    v_add_f32 v8, v8, v16
    v_accvgpr_read_b32 v227, a88
    v_mul_f32 v224, v224, v52
    v_mul_f32 v225, v225, v52
    v_mfma_f32_16x16x32_bf16 v[124:127], v[40:43], v[216:219], v[124:127]
    ds_read_b128 v[36:39], v22 offset:15360
    v_add_f32 v8, v8, v17
    v_mfma_f32_16x16x32_bf16 v[124:127], v[44:47], v[220:223], v[124:127]
    s_waitcnt lgkmcnt(2)
    v_exp_f32 v19, v175
    v_mul_f32 v226, v226, v52
    v_mul_f32 v227, v227, v52
    v_cvt_pk_bf16_f32 v224, v224, v225
    v_cvt_pk_bf16_f32 v225, v226, v227
    v_mfma_f32_16x16x32_bf16 a[96:99], v[80:83], v[24:27], a[96:99]
    ds_read_b128 v[40:43], v22 offset:6144
    v_cvt_pk_bf16_f32 v172, v16, v17
    v_mfma_f32_16x16x32_bf16 a[96:99], v[88:91], v[28:31], a[96:99]
    buffer_store_dwordx2 v[224:225], v56, s[12:15], s40 offen offset:128 sc0 sc1
    v_exp_f32 v16, v108
    v_accvgpr_read_b32 v228, a53
    v_mfma_f32_16x16x32_bf16 a[144:147], v[84:87], v[24:27], a[144:147]
    ds_read_b128 v[44:47], v22 offset:18432
    v_accvgpr_read_b32 v229, a65
    v_mfma_f32_16x16x32_bf16 a[144:147], v[92:95], v[28:31], a[144:147]
    s_waitcnt lgkmcnt(2)
    v_add_f32 v8, v8, v18
    v_add_f32 v8, v8, v19
    v_accvgpr_read_b32 v230, a77
    v_accvgpr_read_b32 v231, a89
    v_mul_f32 v228, v228, v53
    v_mul_f32 v229, v229, v53
    v_mfma_f32_16x16x32_bf16 a[108:111], v[80:83], v[32:35], a[108:111]
    ds_read_b128 v[24:27], v22 offset:9216
    v_mul_f32 v230, v230, v53
    v_mfma_f32_16x16x32_bf16 a[108:111], v[88:91], v[36:39], a[108:111]
    v_exp_f32 v17, v109
    v_cvt_pk_bf16_f32 v173, v18, v19
    v_mul_f32 v231, v231, v53
    v_cvt_pk_bf16_f32 v228, v228, v229
    v_cvt_pk_bf16_f32 v229, v230, v231
    v_mfma_f32_16x16x32_bf16 a[156:159], v[84:87], v[32:35], a[156:159]
    ds_read_b128 v[28:31], v22 offset:21504
    v_accvgpr_read_b32 v232, a54
    v_mfma_f32_16x16x32_bf16 a[156:159], v[92:95], v[36:39], a[156:159]
    s_waitcnt lgkmcnt(2)
    buffer_store_dwordx2 v[228:229], v56, s[12:15], s40 offen offset:512 sc0 sc1
    v_exp_f32 v18, v110
    v_accvgpr_read_b32 v233, a66
    v_mfma_f32_16x16x32_bf16 a[120:123], v[80:83], v[40:43], a[120:123]
    ds_read_b128 v[32:35], v1 offset:0
    v_add_f32 v8, v8, v16
    v_mfma_f32_16x16x32_bf16 a[120:123], v[88:91], v[44:47], a[120:123]
    v_add_f32 v8, v8, v17
    v_accvgpr_read_b32 v234, a78
    v_exp_f32 v19, v111
    v_accvgpr_read_b32 v235, a90
    v_mul_f32 v232, v232, v54
    v_mfma_f32_16x16x32_bf16 a[168:171], v[84:87], v[40:43], a[168:171]
    ds_read_b128 v[36:39], v1 offset:12288
    v_mul_f32 v233, v233, v54
    v_mfma_f32_16x16x32_bf16 a[168:171], v[92:95], v[44:47], a[168:171]
    s_waitcnt lgkmcnt(2)
    v_cvt_pk_bf16_f32 v174, v16, v17
    v_mul_f32 v234, v234, v54
    v_mul_f32 v235, v235, v54
    v_cvt_pk_bf16_f32 v232, v232, v233
    v_cvt_pk_bf16_f32 v233, v234, v235
    v_accvgpr_read_b32 v236, a55
    v_mfma_f32_16x16x32_bf16 a[132:135], v[80:83], v[24:27], a[132:135]
    ds_read_b128 v[40:43], v1 offset:3072
    v_add_f32 v8, v8, v18
    v_mfma_f32_16x16x32_bf16 a[132:135], v[88:91], v[28:31], a[132:135]
    buffer_store_dwordx2 v[232:233], v56, s[12:15], s40 offen offset:896 sc0 sc1
    v_add_f32 v8, v8, v19
    v_cvt_pk_bf16_f32 v175, v18, v19
    v_mfma_f32_16x16x32_bf16 a[180:183], v[84:87], v[24:27], a[180:183]
    ds_read_b128 v[44:47], v1 offset:15360
    v_accvgpr_read_b32 v237, a67
    v_mfma_f32_16x16x32_bf16 a[180:183], v[92:95], v[28:31], a[180:183]
    s_waitcnt lgkmcnt(2)
    v_exp_f32 v16, v176
    v_exp_f32 v17, v177
    v_exp_f32 v18, v178
    v_mfma_f32_16x16x32_bf16 a[96:99], v[160:163], v[32:35], a[96:99]
    ds_read_b128 v[24:27], v1 offset:6144
    v_add_f32 v7, v7, v16
    v_mfma_f32_16x16x32_bf16 a[96:99], v[168:171], v[36:39], a[96:99]
    v_add_f32 v7, v7, v17
    v_exp_f32 v19, v179
    v_cvt_pk_bf16_f32 v176, v16, v17
    v_exp_f32 v16, v112
    v_mfma_f32_16x16x32_bf16 a[144:147], v[164:167], v[32:35], a[144:147]
    ds_read_b128 v[28:31], v1 offset:18432
    v_add_f32 v7, v7, v18
    v_mfma_f32_16x16x32_bf16 a[144:147], v[172:175], v[36:39], a[144:147]
    s_waitcnt lgkmcnt(2)
    v_add_f32 v7, v7, v19
    v_exp_f32 v17, v113
    v_cvt_pk_bf16_f32 v177, v18, v19
    v_exp_f32 v18, v114
    v_mfma_f32_16x16x32_bf16 a[108:111], v[160:163], v[40:43], a[108:111]
    ds_read_b128 v[32:35], v1 offset:9216
    v_add_f32 v7, v7, v16
    v_mfma_f32_16x16x32_bf16 a[108:111], v[168:171], v[44:47], a[108:111]
    v_add_f32 v7, v7, v17
    v_exp_f32 v19, v115
    v_cvt_pk_bf16_f32 v178, v16, v17
    v_exp_f32 v16, v180
    v_mfma_f32_16x16x32_bf16 a[156:159], v[164:167], v[40:43], a[156:159]
    ds_read_b128 v[36:39], v1 offset:21504
    v_add_f32 v7, v7, v18
    v_mfma_f32_16x16x32_bf16 a[156:159], v[172:175], v[44:47], a[156:159]
    s_waitcnt lgkmcnt(2)
    v_add_f32 v7, v7, v19
    v_exp_f32 v17, v181
    v_cvt_pk_bf16_f32 v179, v18, v19
    v_exp_f32 v18, v182
    v_mfma_f32_16x16x32_bf16 a[120:123], v[160:163], v[24:27], a[120:123]
    ds_read_b128 v[40:43], v14 offset:0
    v_add_f32 v8, v8, v16
    v_mfma_f32_16x16x32_bf16 a[120:123], v[168:171], v[28:31], a[120:123]
    v_add_f32 v8, v8, v17
    v_exp_f32 v19, v183
    v_cvt_pk_bf16_f32 v180, v16, v17
    v_exp_f32 v16, v116
    v_mfma_f32_16x16x32_bf16 a[168:171], v[164:167], v[24:27], a[168:171]
    ds_read_b128 v[44:47], v14 offset:12288
    v_add_f32 v8, v8, v18
    v_mfma_f32_16x16x32_bf16 a[168:171], v[172:175], v[28:31], a[168:171]
    s_waitcnt lgkmcnt(2)
    v_add_f32 v8, v8, v19
    v_exp_f32 v17, v117
    v_cvt_pk_bf16_f32 v181, v18, v19
    v_exp_f32 v18, v118
    v_mfma_f32_16x16x32_bf16 a[132:135], v[160:163], v[32:35], a[132:135]
    ds_read_b128 v[24:27], v14 offset:3072
    v_add_f32 v8, v8, v16
    v_mfma_f32_16x16x32_bf16 a[132:135], v[168:171], v[36:39], a[132:135]
    v_add_f32 v8, v8, v17
    v_exp_f32 v19, v119
    v_cvt_pk_bf16_f32 v182, v16, v17
    v_add_f32 v8, v8, v18
    v_add_f32 v8, v8, v19
    v_cvt_pk_bf16_f32 v183, v18, v19
    v_exp_f32 v16, v184
    v_exp_f32 v17, v185
    v_exp_f32 v18, v186
    v_add_f32 v7, v7, v16
    v_add_f32 v7, v7, v17
    v_exp_f32 v19, v187
    v_cvt_pk_bf16_f32 v184, v16, v17
    v_exp_f32 v16, v120
    v_add_f32 v7, v7, v18
    v_add_f32 v7, v7, v19
    v_exp_f32 v17, v121
    v_cvt_pk_bf16_f32 v185, v18, v19
    v_exp_f32 v18, v122
    v_add_f32 v7, v7, v16
    v_add_f32 v7, v7, v17
    v_exp_f32 v19, v123
    v_cvt_pk_bf16_f32 v186, v16, v17
    v_exp_f32 v16, v188
    v_add_f32 v7, v7, v18
    v_add_f32 v7, v7, v19
    v_exp_f32 v17, v189
    v_cvt_pk_bf16_f32 v187, v18, v19
    v_exp_f32 v18, v190
    v_add_f32 v8, v8, v16
    v_add_f32 v8, v8, v17
    v_exp_f32 v19, v191
    v_cvt_pk_bf16_f32 v188, v16, v17
    v_exp_f32 v16, v124
    v_add_f32 v8, v8, v18
    v_add_f32 v8, v8, v19
    v_exp_f32 v17, v125
    v_cvt_pk_bf16_f32 v189, v18, v19
    v_exp_f32 v18, v126
    v_add_f32 v8, v8, v16
    v_add_f32 v8, v8, v17
    v_exp_f32 v19, v127
    v_cvt_pk_bf16_f32 v190, v16, v17
    v_add_f32 v8, v8, v18
    v_add_f32 v8, v8, v19
    v_cvt_pk_bf16_f32 v191, v18, v19
    v_mfma_f32_16x16x32_bf16 a[180:183], v[164:167], v[32:35], a[180:183]
    ds_read_b128 v[28:31], v14 offset:15360
    v_mov_b32 v16, v7
    v_mfma_f32_16x16x32_bf16 a[180:183], v[172:175], v[36:39], a[180:183]
    s_waitcnt lgkmcnt(2)
    v_mov_b32 v17, v8
    s_nop 0
    v_permlane16_swap_b32 v7, v16
    v_accvgpr_read_b32 v238, a79
    v_permlane16_swap_b32 v8, v17
    v_mfma_f32_16x16x32_bf16 a[96:99], v[176:179], v[40:43], a[96:99]
    s_nop 0
    ds_read_b128 v[32:35], v14 offset:6144
    v_accvgpr_read_b32 v239, a91
    v_mfma_f32_16x16x32_bf16 a[96:99], v[184:187], v[44:47], a[96:99]
    v_add_f32 v7, v7, v16
    v_mul_f32 v236, v236, v55
    v_mul_f32 v237, v237, v55
    v_add_f32 v8, v8, v17
    v_mul_f32 v238, v238, v55
    v_mul_f32 v239, v239, v55
    v_mfma_f32_16x16x32_bf16 a[144:147], v[180:183], v[40:43], a[144:147]
    ds_read_b128 v[36:39], v14 offset:18432
    v_mov_b32 v16, v7
    v_mfma_f32_16x16x32_bf16 a[144:147], v[188:191], v[44:47], a[144:147]
    s_waitcnt lgkmcnt(2)
    v_mov_b32 v17, v8
    s_nop 0
    v_cvt_pk_bf16_f32 v236, v236, v237
    v_cvt_pk_bf16_f32 v237, v238, v239
    v_permlane32_swap_b32 v7, v16
    v_accvgpr_read_b32 v240, a56
    v_mfma_f32_16x16x32_bf16 a[108:111], v[176:179], v[24:27], a[108:111]
    ds_read_b128 v[40:43], v14 offset:9216
    v_permlane32_swap_b32 v8, v17
    v_mfma_f32_16x16x32_bf16 a[108:111], v[184:187], v[28:31], a[108:111]
    buffer_store_dwordx2 v[236:237], v56, s[12:15], s40 offen offset:1280 sc0 sc1
    s_nop 0
    v_accvgpr_read_b32 v241, a68
    v_add_f32 v7, v7, v16
    v_mfma_f32_16x16x32_bf16 a[156:159], v[180:183], v[24:27], a[156:159]
    ds_read_b128 v[44:47], v14 offset:21504
    v_add_f32 v8, v8, v17
    v_mfma_f32_16x16x32_bf16 a[156:159], v[188:191], v[28:31], a[156:159]
    s_waitcnt lgkmcnt(2)
    v_rcp_f32 v16, v7
    v_accvgpr_read_b32 v242, a80
    v_accvgpr_read_b32 v243, a92
    v_mul_f32 v240, v240, v52
    v_mul_f32 v241, v241, v52
    v_mfma_f32_16x16x32_bf16 a[120:123], v[176:179], v[32:35], a[120:123]
    ds_read_b128 v[24:27], v22 offset:1024
    v_mul_f32 v242, v242, v52
    v_mfma_f32_16x16x32_bf16 a[120:123], v[184:187], v[36:39], a[120:123]
    v_rcp_f32 v17, v8
    s_nop 0
    v_mul_f32 v243, v243, v52
    v_cvt_pk_bf16_f32 v240, v240, v241
    v_cvt_pk_bf16_f32 v241, v242, v243
    v_mfma_f32_16x16x32_bf16 a[168:171], v[180:183], v[32:35], a[168:171]
    ds_read_b128 v[28:31], v22 offset:13312
    ds_bpermute_b32 v128, v58, v16 offset:0
    v_mfma_f32_16x16x32_bf16 a[168:171], v[188:191], v[36:39], a[168:171]
    s_waitcnt lgkmcnt(3)
    ds_bpermute_b32 v129, v58, v16 offset:4
    ds_bpermute_b32 v130, v58, v16 offset:8
    ds_bpermute_b32 v131, v58, v16 offset:12
    ds_bpermute_b32 v132, v58, v17 offset:0
    ds_bpermute_b32 v133, v58, v17 offset:4
    ds_bpermute_b32 v134, v58, v17 offset:8
    v_mfma_f32_16x16x32_bf16 a[132:135], v[176:179], v[40:43], a[132:135]
    ds_read_b128 v[32:35], v22 offset:4096
    ds_bpermute_b32 v135, v58, v17 offset:12
    v_mfma_f32_16x16x32_bf16 a[132:135], v[184:187], v[44:47], a[132:135]
    buffer_store_dwordx2 v[240:241], v56, s[12:15], s40 offen offset:256 sc0 sc1
    v_accvgpr_read_b32 v244, a57
    v_accvgpr_read_b32 v245, a69
    v_accvgpr_read_b32 v246, a81
    v_mfma_f32_16x16x32_bf16 a[180:183], v[180:183], v[40:43], a[180:183]
    ds_read_b128 v[36:39], v22 offset:16384
    v_max3_f32 v18, v5, v6, v7
    v_max_f32 v18, v18, v8
    s_mov_b32 s29, 0x5f800000
    v_cmp_lt_f32 s[48:49], s29, v18
    v_mfma_f32_16x16x32_bf16 a[180:183], v[188:191], v[44:47], a[180:183]
    s_waitcnt lgkmcnt(10)
    v_accvgpr_read_b32 v247, a93
    v_mul_f32 v244, v244, v53
    v_mul_f32 v245, v245, v53
    v_mul_f32 v246, v246, v53
    v_mul_f32 v247, v247, v53
    v_mfma_f32_16x16x32_bf16 a[100:103], v[80:83], v[24:27], a[100:103]
    ds_read_b128 v[40:43], v22 offset:7168
    v_cvt_pk_bf16_f32 v244, v244, v245
    v_mfma_f32_16x16x32_bf16 a[100:103], v[88:91], v[28:31], a[100:103]
    v_cvt_pk_bf16_f32 v245, v246, v247
    v_accvgpr_read_b32 v248, a58
    v_accvgpr_read_b32 v249, a70
    v_accvgpr_read_b32 v250, a82
    v_accvgpr_read_b32 v251, a94
    v_mul_f32 v248, v248, v54
    v_mfma_f32_16x16x32_bf16 a[148:151], v[84:87], v[24:27], a[148:151]
    ds_read_b128 v[44:47], v22 offset:19456
    v_mul_f32 v249, v249, v54
    v_mfma_f32_16x16x32_bf16 a[148:151], v[92:95], v[28:31], a[148:151]
    s_waitcnt lgkmcnt(2)
    s_cmp_lg_u64 s[48:49], 0
    s_cbranch_scc1 L_slow
    v_mul_f32 v250, v250, v54
    v_mul_f32 v251, v251, v54
    v_mfma_f32_16x16x32_bf16 a[112:115], v[80:83], v[32:35], a[112:115]
    ds_read_b128 v[24:27], v22 offset:10240
    v_cvt_pk_bf16_f32 v248, v248, v249
    v_mfma_f32_16x16x32_bf16 a[112:115], v[88:91], v[36:39], a[112:115]
    buffer_store_dwordx2 v[244:245], v56, s[12:15], s40 offen offset:640 sc0 sc1
    v_cvt_pk_bf16_f32 v249, v250, v251
    v_accvgpr_read_b32 v252, a59
    v_accvgpr_read_b32 v253, a71
    v_mfma_f32_16x16x32_bf16 a[160:163], v[84:87], v[32:35], a[160:163]
    ds_read_b128 v[28:31], v22 offset:22528
    v_accvgpr_read_b32 v254, a83
    v_mfma_f32_16x16x32_bf16 a[160:163], v[92:95], v[36:39], a[160:163]
    s_waitcnt lgkmcnt(2)
    buffer_store_dwordx2 v[248:249], v56, s[12:15], s40 offen offset:1024 sc0 sc1
    v_accvgpr_read_b32 v255, a95
    v_mul_f32 v252, v252, v55
    v_mul_f32 v253, v253, v55
    v_mfma_f32_16x16x32_bf16 a[124:127], v[80:83], v[40:43], a[124:127]
    ds_read_b128 v[32:35], v1 offset:1024
    v_mul_f32 v254, v254, v55
    v_mul_f32 v255, v255, v55
    v_cvt_pk_bf16_f32 v252, v252, v253
    v_cvt_pk_bf16_f32 v253, v254, v255
    v_mfma_f32_16x16x32_bf16 a[124:127], v[88:91], v[44:47], a[124:127]
    buffer_store_dwordx2 v[252:253], v56, s[12:15], s40 offen offset:1408 sc0 sc1
    v_accvgpr_read_b32 v224, a96
    v_accvgpr_read_b32 v225, a108
    v_mfma_f32_16x16x32_bf16 a[172:175], v[84:87], v[40:43], a[172:175]
    ds_read_b128 v[36:39], v1 offset:13312
    v_accvgpr_read_b32 v226, a120
    v_mfma_f32_16x16x32_bf16 a[172:175], v[92:95], v[44:47], a[172:175]
    s_waitcnt lgkmcnt(2)
    v_accvgpr_read_b32 v227, a132
    s_waitcnt lgkmcnt(12)
    v_mul_f32 v224, v224, v128
    v_mul_f32 v225, v225, v128
    v_mul_f32 v226, v226, v128
    v_mul_f32 v227, v227, v128
    v_mfma_f32_16x16x32_bf16 a[136:139], v[80:83], v[24:27], a[136:139]
    ds_read_b128 v[40:43], v1 offset:4096
    v_cvt_pk_bf16_f32 v224, v224, v225
    v_mfma_f32_16x16x32_bf16 a[136:139], v[88:91], v[28:31], a[136:139]
    v_cvt_pk_bf16_f32 v225, v226, v227
    v_accvgpr_read_b32 v228, a97
    v_accvgpr_read_b32 v229, a109
    v_accvgpr_read_b32 v230, a121
    v_accvgpr_read_b32 v231, a133
    v_mul_f32 v228, v228, v129
    v_mfma_f32_16x16x32_bf16 a[184:187], v[84:87], v[24:27], a[184:187]
    ds_read_b128 v[44:47], v1 offset:16384
    v_mul_f32 v229, v229, v129
    v_mfma_f32_16x16x32_bf16 a[184:187], v[92:95], v[28:31], a[184:187]
    s_waitcnt lgkmcnt(2)
    buffer_store_dwordx2 v[224:225], v56, s[12:15], s41 offen offset:0 sc0 sc1
    v_mul_f32 v230, v230, v129
    v_mul_f32 v231, v231, v129
    v_cvt_pk_bf16_f32 v228, v228, v229
    v_mfma_f32_16x16x32_bf16 a[100:103], v[160:163], v[32:35], a[100:103]
    ds_read_b128 v[24:27], v1 offset:7168
    v_cvt_pk_bf16_f32 v229, v230, v231
    v_mfma_f32_16x16x32_bf16 a[100:103], v[168:171], v[36:39], a[100:103]
    buffer_store_dwordx2 v[228:229], v56, s[12:15], s41 offen offset:384 sc0 sc1
    v_accvgpr_read_b32 v232, a98
    v_accvgpr_read_b32 v233, a110
    v_accvgpr_read_b32 v234, a122
    v_mfma_f32_16x16x32_bf16 a[148:151], v[164:167], v[32:35], a[148:151]
    ds_read_b128 v[28:31], v1 offset:19456
    v_accvgpr_read_b32 v235, a134
    v_mfma_f32_16x16x32_bf16 a[148:151], v[172:175], v[36:39], a[148:151]
    s_waitcnt lgkmcnt(2)
    v_mul_f32 v232, v232, v130
    v_mul_f32 v233, v233, v130
    v_mul_f32 v234, v234, v130
    v_mul_f32 v235, v235, v130
    v_cvt_pk_bf16_f32 v232, v232, v233
    v_cvt_pk_bf16_f32 v233, v234, v235
    v_mfma_f32_16x16x32_bf16 a[112:115], v[160:163], v[40:43], a[112:115]
    ds_read_b128 v[32:35], v1 offset:10240
    v_accvgpr_read_b32 v236, a99
    v_mfma_f32_16x16x32_bf16 a[112:115], v[168:171], v[44:47], a[112:115]
    buffer_store_dwordx2 v[232:233], v56, s[12:15], s41 offen offset:768 sc0 sc1
    v_accvgpr_read_b32 v237, a111
    v_accvgpr_read_b32 v238, a123
    v_accvgpr_read_b32 v239, a135
    v_mfma_f32_16x16x32_bf16 a[160:163], v[164:167], v[40:43], a[160:163]
    ds_read_b128 v[36:39], v1 offset:22528
    v_mul_f32 v236, v236, v131
    v_mfma_f32_16x16x32_bf16 a[160:163], v[172:175], v[44:47], a[160:163]
    s_waitcnt lgkmcnt(2)
    v_mul_f32 v237, v237, v131
    v_mul_f32 v238, v238, v131
    v_mul_f32 v239, v239, v131
    v_cvt_pk_bf16_f32 v236, v236, v237
    v_cvt_pk_bf16_f32 v237, v238, v239
    v_accvgpr_read_b32 v240, a144
    v_mfma_f32_16x16x32_bf16 a[124:127], v[160:163], v[24:27], a[124:127]
    ds_read_b128 v[40:43], v14 offset:1024
    v_accvgpr_read_b32 v241, a156
    v_mfma_f32_16x16x32_bf16 a[124:127], v[168:171], v[28:31], a[124:127]
    buffer_store_dwordx2 v[236:237], v56, s[12:15], s41 offen offset:1152 sc0 sc1
    v_accvgpr_read_b32 v242, a168
    v_accvgpr_read_b32 v243, a180
    s_waitcnt lgkmcnt(14)
    v_mfma_f32_16x16x32_bf16 a[172:175], v[164:167], v[24:27], a[172:175]
    ds_read_b128 v[44:47], v14 offset:13312
    v_mul_f32 v240, v240, v132
    v_mfma_f32_16x16x32_bf16 a[172:175], v[172:175], v[28:31], a[172:175]
    s_waitcnt lgkmcnt(2)
    v_mul_f32 v241, v241, v132
    v_mul_f32 v242, v242, v132
    v_mul_f32 v243, v243, v132
    v_cvt_pk_bf16_f32 v240, v240, v241
    v_cvt_pk_bf16_f32 v241, v242, v243
    v_accvgpr_read_b32 v244, a145
    v_mfma_f32_16x16x32_bf16 a[136:139], v[160:163], v[32:35], a[136:139]
    ds_read_b128 v[24:27], v14 offset:4096
    v_accvgpr_read_b32 v245, a157
    v_mfma_f32_16x16x32_bf16 a[136:139], v[168:171], v[36:39], a[136:139]
    buffer_store_dwordx2 v[240:241], v56, s[12:15], s42 offen offset:0 sc0 sc1
    v_accvgpr_read_b32 v246, a169
    v_accvgpr_read_b32 v247, a181
    v_mul_f32 v244, v244, v133
    v_mfma_f32_16x16x32_bf16 a[184:187], v[164:167], v[32:35], a[184:187]
    ds_read_b128 v[28:31], v14 offset:16384
    v_mul_f32 v245, v245, v133
    v_mfma_f32_16x16x32_bf16 a[184:187], v[172:175], v[36:39], a[184:187]
    s_waitcnt lgkmcnt(2)
    v_mul_f32 v246, v246, v133
    v_mul_f32 v247, v247, v133
    v_cvt_pk_bf16_f32 v244, v244, v245
    v_cvt_pk_bf16_f32 v245, v246, v247
    v_accvgpr_read_b32 v248, a146
    v_accvgpr_read_b32 v249, a158
    v_mfma_f32_16x16x32_bf16 a[100:103], v[176:179], v[40:43], a[100:103]
    ds_read_b128 v[32:35], v14 offset:7168
    v_accvgpr_read_b32 v250, a170
    v_mfma_f32_16x16x32_bf16 a[100:103], v[184:187], v[44:47], a[100:103]
    buffer_store_dwordx2 v[244:245], v56, s[12:15], s42 offen offset:384 sc0 sc1
    v_accvgpr_read_b32 v251, a182
    v_mul_f32 v248, v248, v134
    v_mul_f32 v249, v249, v134
    v_mfma_f32_16x16x32_bf16 a[148:151], v[180:183], v[40:43], a[148:151]
    ds_read_b128 v[36:39], v14 offset:19456
    v_mul_f32 v250, v250, v134
    v_mfma_f32_16x16x32_bf16 a[148:151], v[188:191], v[44:47], a[148:151]
    s_waitcnt lgkmcnt(2)
    v_mul_f32 v251, v251, v134
    v_cvt_pk_bf16_f32 v248, v248, v249
    v_cvt_pk_bf16_f32 v249, v250, v251
    v_accvgpr_read_b32 v252, a147
    v_accvgpr_read_b32 v253, a159
    v_accvgpr_read_b32 v254, a171
    v_mfma_f32_16x16x32_bf16 a[112:115], v[176:179], v[24:27], a[112:115]
    ds_read_b128 v[40:43], v14 offset:10240
    v_accvgpr_read_b32 v255, a183
    v_mfma_f32_16x16x32_bf16 a[112:115], v[184:187], v[28:31], a[112:115]
    buffer_store_dwordx2 v[248:249], v56, s[12:15], s42 offen offset:768 sc0 sc1
    v_mul_f32 v252, v252, v135
    v_mul_f32 v253, v253, v135
    v_mul_f32 v254, v254, v135
    v_mfma_f32_16x16x32_bf16 a[160:163], v[180:183], v[24:27], a[160:163]
    ds_read_b128 v[44:47], v14 offset:22528
    v_mul_f32 v255, v255, v135
    v_mfma_f32_16x16x32_bf16 a[160:163], v[188:191], v[28:31], a[160:163]
    s_waitcnt lgkmcnt(2)
    v_cvt_pk_bf16_f32 v252, v252, v253
    v_cvt_pk_bf16_f32 v253, v254, v255
    v_mfma_f32_16x16x32_bf16 a[124:127], v[176:179], v[32:35], a[124:127]
    ds_read_b128 v[24:27], v22 offset:2048
    v_mfma_f32_16x16x32_bf16 a[124:127], v[184:187], v[36:39], a[124:127]
    buffer_store_dwordx2 v[252:253], v56, s[12:15], s42 offen offset:1152 sc0 sc1
    v_mfma_f32_16x16x32_bf16 a[172:175], v[180:183], v[32:35], a[172:175]
    ds_read_b128 v[28:31], v22 offset:14336
    v_mfma_f32_16x16x32_bf16 a[172:175], v[188:191], v[36:39], a[172:175]
    s_waitcnt lgkmcnt(2)
    v_mfma_f32_16x16x32_bf16 a[136:139], v[176:179], v[40:43], a[136:139]
    ds_read_b128 v[32:35], v22 offset:5120
    v_mfma_f32_16x16x32_bf16 a[136:139], v[184:187], v[44:47], a[136:139]
    v_mfma_f32_16x16x32_bf16 a[184:187], v[180:183], v[40:43], a[184:187]
    ds_read_b128 v[36:39], v22 offset:17408
    v_mfma_f32_16x16x32_bf16 a[184:187], v[188:191], v[44:47], a[184:187]
    s_waitcnt lgkmcnt(2)
    v_mfma_f32_16x16x32_bf16 a[104:107], v[80:83], v[24:27], a[104:107]
    ds_read_b128 v[40:43], v22 offset:8192
    v_mfma_f32_16x16x32_bf16 a[104:107], v[88:91], v[28:31], a[104:107]
    v_mfma_f32_16x16x32_bf16 a[152:155], v[84:87], v[24:27], a[152:155]
    ds_read_b128 v[44:47], v22 offset:20480
    v_mfma_f32_16x16x32_bf16 a[152:155], v[92:95], v[28:31], a[152:155]
    s_waitcnt lgkmcnt(2)
    v_mfma_f32_16x16x32_bf16 a[116:119], v[80:83], v[32:35], a[116:119]
    ds_read_b128 v[24:27], v22 offset:11264
    v_accvgpr_read_b32 v224, a100
    v_mfma_f32_16x16x32_bf16 a[116:119], v[88:91], v[36:39], a[116:119]
    v_accvgpr_read_b32 v225, a112
    v_accvgpr_read_b32 v226, a124
    v_accvgpr_read_b32 v227, a136
    v_mul_f32 v224, v224, v128
    v_mul_f32 v225, v225, v128
    v_mul_f32 v226, v226, v128
    v_mul_f32 v227, v227, v128
    v_cvt_pk_bf16_f32 v224, v224, v225
    v_cvt_pk_bf16_f32 v225, v226, v227
    v_accvgpr_read_b32 v228, a101
    v_accvgpr_read_b32 v229, a113
    v_accvgpr_read_b32 v230, a125
    v_accvgpr_read_b32 v231, a137
    v_mul_f32 v228, v228, v129
    v_mul_f32 v229, v229, v129
    v_mul_f32 v230, v230, v129
    v_mul_f32 v231, v231, v129
    v_cvt_pk_bf16_f32 v228, v228, v229
    v_cvt_pk_bf16_f32 v229, v230, v231
    v_accvgpr_read_b32 v232, a102
    v_accvgpr_read_b32 v233, a114
    v_accvgpr_read_b32 v234, a126
    v_accvgpr_read_b32 v235, a138
    v_mul_f32 v232, v232, v130
    v_mul_f32 v233, v233, v130
    v_mul_f32 v234, v234, v130
    v_mul_f32 v235, v235, v130
    v_cvt_pk_bf16_f32 v232, v232, v233
    v_cvt_pk_bf16_f32 v233, v234, v235
    v_accvgpr_read_b32 v236, a103
    v_accvgpr_read_b32 v237, a115
    v_accvgpr_read_b32 v238, a127
    v_accvgpr_read_b32 v239, a139
    v_mfma_f32_16x16x32_bf16 a[164:167], v[84:87], v[32:35], a[164:167]
    ds_read_b128 v[28:31], v22 offset:23552
    v_mul_f32 v236, v236, v131
    v_mfma_f32_16x16x32_bf16 a[164:167], v[92:95], v[36:39], a[164:167]
    s_waitcnt lgkmcnt(2)
    buffer_store_dwordx2 v[224:225], v56, s[12:15], s41 offen offset:128 sc0 sc1
    v_mul_f32 v237, v237, v131
    v_mul_f32 v238, v238, v131
    v_mfma_f32_16x16x32_bf16 a[128:131], v[80:83], v[40:43], a[128:131]
    ds_read_b128 v[32:35], v1 offset:2048
    v_mul_f32 v239, v239, v131
    v_mfma_f32_16x16x32_bf16 a[128:131], v[88:91], v[44:47], a[128:131]
    buffer_store_dwordx2 v[228:229], v56, s[12:15], s41 offen offset:512 sc0 sc1
    v_cvt_pk_bf16_f32 v236, v236, v237
    v_cvt_pk_bf16_f32 v237, v238, v239
    v_accvgpr_read_b32 v240, a148
    v_mfma_f32_16x16x32_bf16 a[176:179], v[84:87], v[40:43], a[176:179]
    ds_read_b128 v[36:39], v1 offset:14336
    v_accvgpr_read_b32 v241, a160
    v_mfma_f32_16x16x32_bf16 a[176:179], v[92:95], v[44:47], a[176:179]
    s_waitcnt lgkmcnt(2)
    buffer_store_dwordx2 v[232:233], v56, s[12:15], s41 offen offset:896 sc0 sc1
    v_accvgpr_read_b32 v242, a172
    v_accvgpr_read_b32 v243, a184
    v_mul_f32 v240, v240, v132
    v_mfma_f32_16x16x32_bf16 a[140:143], v[80:83], v[24:27], a[140:143]
    ds_read_b128 v[40:43], v1 offset:5120
    v_mul_f32 v241, v241, v132
    v_mfma_f32_16x16x32_bf16 a[140:143], v[88:91], v[28:31], a[140:143]
    buffer_store_dwordx2 v[236:237], v56, s[12:15], s41 offen offset:1280 sc0 sc1
    v_mul_f32 v242, v242, v132
    v_mul_f32 v243, v243, v132
    v_cvt_pk_bf16_f32 v240, v240, v241
    v_mfma_f32_16x16x32_bf16 a[188:191], v[84:87], v[24:27], a[188:191]
    ds_read_b128 v[44:47], v1 offset:17408
    v_cvt_pk_bf16_f32 v241, v242, v243
    v_mfma_f32_16x16x32_bf16 a[188:191], v[92:95], v[28:31], a[188:191]
    s_waitcnt lgkmcnt(2)
    buffer_store_dwordx2 v[240:241], v56, s[12:15], s42 offen offset:128 sc0 sc1
    v_accvgpr_read_b32 v244, a149
    v_accvgpr_read_b32 v245, a161
    v_accvgpr_read_b32 v246, a173
    v_mfma_f32_16x16x32_bf16 a[104:107], v[160:163], v[32:35], a[104:107]
    ds_read_b128 v[24:27], v1 offset:8192
    v_accvgpr_read_b32 v247, a185
    v_mfma_f32_16x16x32_bf16 a[104:107], v[168:171], v[36:39], a[104:107]
    v_mul_f32 v244, v244, v133
    v_mul_f32 v245, v245, v133
    v_mul_f32 v246, v246, v133
    v_mul_f32 v247, v247, v133
    v_cvt_pk_bf16_f32 v244, v244, v245
    v_cvt_pk_bf16_f32 v245, v246, v247
    v_mfma_f32_16x16x32_bf16 a[152:155], v[164:167], v[32:35], a[152:155]
    ds_read_b128 v[28:31], v1 offset:20480
    v_accvgpr_read_b32 v248, a150
    v_mfma_f32_16x16x32_bf16 a[152:155], v[172:175], v[36:39], a[152:155]
    s_waitcnt lgkmcnt(2)
    buffer_store_dwordx2 v[244:245], v56, s[12:15], s42 offen offset:512 sc0 sc1
    v_accvgpr_read_b32 v249, a162
    v_accvgpr_read_b32 v250, a174
    v_accvgpr_read_b32 v251, a186
    v_mfma_f32_16x16x32_bf16 a[116:119], v[160:163], v[40:43], a[116:119]
    ds_read_b128 v[32:35], v1 offset:11264
    v_mul_f32 v248, v248, v134
    v_mfma_f32_16x16x32_bf16 a[116:119], v[168:171], v[44:47], a[116:119]
    v_mul_f32 v249, v249, v134
    v_mul_f32 v250, v250, v134
    v_mul_f32 v251, v251, v134
    v_cvt_pk_bf16_f32 v248, v248, v249
    v_cvt_pk_bf16_f32 v249, v250, v251
    v_accvgpr_read_b32 v252, a151
    v_mfma_f32_16x16x32_bf16 a[164:167], v[164:167], v[40:43], a[164:167]
    ds_read_b128 v[36:39], v1 offset:23552
    v_accvgpr_read_b32 v253, a163
    v_mfma_f32_16x16x32_bf16 a[164:167], v[172:175], v[44:47], a[164:167]
    s_waitcnt lgkmcnt(2)
    buffer_store_dwordx2 v[248:249], v56, s[12:15], s42 offen offset:896 sc0 sc1
    v_accvgpr_read_b32 v254, a175
    v_accvgpr_read_b32 v255, a187
    v_mul_f32 v252, v252, v135
    v_mfma_f32_16x16x32_bf16 a[128:131], v[160:163], v[24:27], a[128:131]
    ds_read_b128 v[40:43], v14 offset:2048
    v_mul_f32 v253, v253, v135
    v_mfma_f32_16x16x32_bf16 a[128:131], v[168:171], v[28:31], a[128:131]
    v_mul_f32 v254, v254, v135
    v_mul_f32 v255, v255, v135
    v_cvt_pk_bf16_f32 v252, v252, v253
    v_cvt_pk_bf16_f32 v253, v254, v255
    v_mfma_f32_16x16x32_bf16 a[176:179], v[164:167], v[24:27], a[176:179]
    ds_read_b128 v[44:47], v14 offset:14336
    v_mfma_f32_16x16x32_bf16 a[176:179], v[172:175], v[28:31], a[176:179]
    s_waitcnt lgkmcnt(2)
    buffer_store_dwordx2 v[252:253], v56, s[12:15], s42 offen offset:1280 sc0 sc1
    v_mfma_f32_16x16x32_bf16 a[140:143], v[160:163], v[32:35], a[140:143]
    ds_read_b128 v[24:27], v14 offset:5120
    v_mfma_f32_16x16x32_bf16 a[140:143], v[168:171], v[36:39], a[140:143]
    v_mfma_f32_16x16x32_bf16 a[188:191], v[164:167], v[32:35], a[188:191]
    ds_read_b128 v[28:31], v14 offset:17408
    v_mfma_f32_16x16x32_bf16 a[188:191], v[172:175], v[36:39], a[188:191]
    s_waitcnt lgkmcnt(2)
    v_mfma_f32_16x16x32_bf16 a[104:107], v[176:179], v[40:43], a[104:107]
    ds_read_b128 v[32:35], v14 offset:8192
    v_mfma_f32_16x16x32_bf16 a[104:107], v[184:187], v[44:47], a[104:107]
    v_mfma_f32_16x16x32_bf16 a[152:155], v[180:183], v[40:43], a[152:155]
    ds_read_b128 v[36:39], v14 offset:20480
    v_mfma_f32_16x16x32_bf16 a[152:155], v[188:191], v[44:47], a[152:155]
    s_waitcnt lgkmcnt(2)
    v_mfma_f32_16x16x32_bf16 a[116:119], v[176:179], v[24:27], a[116:119]
    ds_read_b128 v[40:43], v14 offset:11264
    v_mfma_f32_16x16x32_bf16 a[116:119], v[184:187], v[28:31], a[116:119]
    v_mfma_f32_16x16x32_bf16 a[164:167], v[180:183], v[24:27], a[164:167]
    ds_read_b128 v[44:47], v14 offset:23552
    v_mfma_f32_16x16x32_bf16 a[164:167], v[188:191], v[28:31], a[164:167]
    s_waitcnt lgkmcnt(2)
    v_mfma_f32_16x16x32_bf16 a[128:131], v[176:179], v[32:35], a[128:131]
    v_mfma_f32_16x16x32_bf16 a[128:131], v[184:187], v[36:39], a[128:131]
    v_mfma_f32_16x16x32_bf16 a[176:179], v[180:183], v[32:35], a[176:179]
    v_mfma_f32_16x16x32_bf16 a[176:179], v[188:191], v[36:39], a[176:179]
    s_waitcnt lgkmcnt(0)
    v_mfma_f32_16x16x32_bf16 a[140:143], v[176:179], v[40:43], a[140:143]
    v_mfma_f32_16x16x32_bf16 a[140:143], v[184:187], v[44:47], a[140:143]
    v_mfma_f32_16x16x32_bf16 a[188:191], v[180:183], v[40:43], a[188:191]
    v_mfma_f32_16x16x32_bf16 a[188:191], v[188:191], v[44:47], a[188:191]
    s_nop 7
    v_accvgpr_read_b32 v224, a104
    v_accvgpr_read_b32 v225, a116
    v_accvgpr_read_b32 v226, a128
    v_accvgpr_read_b32 v227, a140
    v_pk_mul_f32 v[224:225], v[224:225], v[128:129] op_sel_hi:[1,0]
    v_pk_mul_f32 v[226:227], v[226:227], v[128:129] op_sel_hi:[1,0]
    v_cvt_pk_bf16_f32 v224, v224, v225
    v_cvt_pk_bf16_f32 v225, v226, v227
    v_accvgpr_read_b32 v228, a105
    v_accvgpr_read_b32 v229, a117
    v_accvgpr_read_b32 v230, a129
    v_accvgpr_read_b32 v231, a141
    v_pk_mul_f32 v[228:229], v[228:229], v[128:129] op_sel:[0,1] op_sel_hi:[1,1]
    v_pk_mul_f32 v[230:231], v[230:231], v[128:129] op_sel:[0,1] op_sel_hi:[1,1]
    v_cvt_pk_bf16_f32 v228, v228, v229
    v_cvt_pk_bf16_f32 v229, v230, v231
    buffer_store_dwordx2 v[224:225], v56, s[12:15], s41 offen offset:256 sc0 sc1
    v_accvgpr_read_b32 v232, a106
    v_accvgpr_read_b32 v233, a118
    v_accvgpr_read_b32 v234, a130
    v_accvgpr_read_b32 v235, a142
    v_pk_mul_f32 v[232:233], v[232:233], v[130:131] op_sel_hi:[1,0]
    v_pk_mul_f32 v[234:235], v[234:235], v[130:131] op_sel_hi:[1,0]
    v_cvt_pk_bf16_f32 v232, v232, v233
    v_cvt_pk_bf16_f32 v233, v234, v235
    buffer_store_dwordx2 v[228:229], v56, s[12:15], s41 offen offset:640 sc0 sc1
    v_accvgpr_read_b32 v236, a107
    v_accvgpr_read_b32 v237, a119
    v_accvgpr_read_b32 v238, a131
    v_accvgpr_read_b32 v239, a143
    v_pk_mul_f32 v[236:237], v[236:237], v[130:131] op_sel:[0,1] op_sel_hi:[1,1]
    v_pk_mul_f32 v[238:239], v[238:239], v[130:131] op_sel:[0,1] op_sel_hi:[1,1]
    v_cvt_pk_bf16_f32 v236, v236, v237
    v_cvt_pk_bf16_f32 v237, v238, v239
    buffer_store_dwordx2 v[232:233], v56, s[12:15], s41 offen offset:1024 sc0 sc1
    buffer_store_dwordx2 v[236:237], v56, s[12:15], s41 offen offset:1408 sc0 sc1
    v_accvgpr_read_b32 v240, a152
    v_accvgpr_read_b32 v241, a164
    v_accvgpr_read_b32 v242, a176
    v_accvgpr_read_b32 v243, a188
    v_pk_mul_f32 v[240:241], v[240:241], v[132:133] op_sel_hi:[1,0]
    v_pk_mul_f32 v[242:243], v[242:243], v[132:133] op_sel_hi:[1,0]
    v_cvt_pk_bf16_f32 v240, v240, v241
    v_cvt_pk_bf16_f32 v241, v242, v243
    v_accvgpr_read_b32 v244, a153
    v_accvgpr_read_b32 v245, a165
    v_accvgpr_read_b32 v246, a177
    v_accvgpr_read_b32 v247, a189
    v_pk_mul_f32 v[244:245], v[244:245], v[132:133] op_sel:[0,1] op_sel_hi:[1,1]
    v_pk_mul_f32 v[246:247], v[246:247], v[132:133] op_sel:[0,1] op_sel_hi:[1,1]
    v_cvt_pk_bf16_f32 v244, v244, v245
    v_cvt_pk_bf16_f32 v245, v246, v247
    buffer_store_dwordx2 v[240:241], v56, s[12:15], s42 offen offset:256 sc0 sc1
    v_accvgpr_read_b32 v248, a154
    v_accvgpr_read_b32 v249, a166
    v_accvgpr_read_b32 v250, a178
    v_accvgpr_read_b32 v251, a190
    v_pk_mul_f32 v[248:249], v[248:249], v[134:135] op_sel_hi:[1,0]
    v_pk_mul_f32 v[250:251], v[250:251], v[134:135] op_sel_hi:[1,0]
    v_cvt_pk_bf16_f32 v248, v248, v249
    v_cvt_pk_bf16_f32 v249, v250, v251
    buffer_store_dwordx2 v[244:245], v56, s[12:15], s42 offen offset:640 sc0 sc1
    v_accvgpr_read_b32 v252, a155
    v_accvgpr_read_b32 v253, a167
    v_accvgpr_read_b32 v254, a179
    v_accvgpr_read_b32 v255, a191
    v_pk_mul_f32 v[252:253], v[252:253], v[134:135] op_sel:[0,1] op_sel_hi:[1,1]
    v_pk_mul_f32 v[254:255], v[254:255], v[134:135] op_sel:[0,1] op_sel_hi:[1,1]
    v_cvt_pk_bf16_f32 v252, v252, v253
    v_cvt_pk_bf16_f32 v253, v254, v255
    buffer_store_dwordx2 v[248:249], v56, s[12:15], s42 offen offset:1024 sc0 sc1
    buffer_store_dwordx2 v[252:253], v56, s[12:15], s42 offen offset:1408 sc0 sc1
L_fin:
L_done:
    s_endpgm
L_pollslow0:
    s_mov_b32 s59, 60
L_pollsm0:
    s_buffer_load_dwordx8 s[48:55], s[20:23], s44 glc
    s_waitcnt lgkmcnt(0)
    s_sub_u32 s48, s48, s92
    s_sub_u32 s49, s49, s92
    s_sub_u32 s50, s50, s92
    s_sub_u32 s51, s51, s92
    s_sub_u32 s52, s52, s92
    s_sub_u32 s53, s53, s92
    s_sub_u32 s54, s54, s92
    s_sub_u32 s55, s55, s92
    s_max_u32 s48, s48, s49
    s_max_u32 s48, s48, s50
    s_max_u32 s48, s48, s51
    s_max_u32 s48, s48, s52
    s_max_u32 s48, s48, s53
    s_max_u32 s48, s48, s54
    s_max_u32 s48, s48, s55
    s_cmp_lt_u32 s48, 16
    s_cbranch_scc1 L_pollok0
    s_sub_u32 s59, s59, 1
    s_cbranch_scc1 L_pollvec0
    s_sleep 1
    s_branch L_pollsm0
L_pollvec0:
    v_bfe_u32 v53, v4, 4, 6
    v_lshlrev_b32 v53, 2, v53
    s_sub_u32 s96, s96, 1
    s_cbranch_scc1 L_pollgiveup0
    s_sleep 2
    buffer_load_dword v52, v53, s[20:23], s44 offen sc1
    s_waitcnt vmcnt(0)
    s_cmp_lg_u32 s44, 0
    s_cbranch_scc1 L_nomix
    v_xor_b32 v53, s92, v52
    v_lshrrev_b32 v53, 5, v53
    v_add_u32 v53, -1, v53
    v_cmp_gt_u32 vcc, 31, v53
    s_nop 1
    s_and_b32 s59, vcc_lo, 0xff00
    s_cbranch_scc0 L_nomix
    buffer_store_dwordx4 v[224:227], v11, s[4:7], s33 offen offset:0 sc1
    v_xor_b32 v55, 16, v11
    buffer_store_dwordx4 v[228:231], v55, s[4:7], s33 offen offset:768 sc1
    v_xor_b32 v54, 32, v11
    buffer_store_dwordx4 v[232:235], v54, s[4:7], s33 offen offset:1536 sc1
    v_xor_b32 v55, 48, v11
    buffer_store_dwordx4 v[236:239], v55, s[4:7], s33 offen offset:2304 sc1
    buffer_store_dwordx4 v[112:115], v20, s[4:7], s35 offen offset:0 sc1
    buffer_store_dwordx4 v[116:119], v20, s[4:7], s35 offen offset:3072 sc1
    buffer_store_dwordx4 v[120:123], v20, s[4:7], s17 offen offset:0 sc1
    buffer_store_dwordx4 v[124:127], v20, s[4:7], s17 offen offset:3072 sc1
    s_waitcnt vmcnt(0)
    s_barrier
    s_and_b32 s92, s92, 0xfffffc00
    s_add_u32 s92, s92, 512
    v_mov_b32 v0, s92
    s_add_u32 s92, s92, 1
    s_mov_b32 s44, 32
    v_add_u32 v0, 1, v0
    buffer_store_dword v0, v13, s[20:23], 0 offen offset:32 sc1
    s_branch L_pollvec0
L_nomix:
    v_subrev_u32 v52, s92, v52
    v_cmp_lt_u32 vcc, 15, v52
    s_nop 0
    s_and_b32 s59, vcc_lo, 0xff
    s_cbranch_scc1 L_pollvec0
    s_branch L_pollok0
L_pollgiveup0:
    s_mov_b32 s96, 0
    s_branch L_pollok0
L_pollslow1:
    s_mov_b32 s59, 200
L_pollsm1:
    s_buffer_load_dwordx8 s[48:55], s[20:23], s44 glc
    s_waitcnt lgkmcnt(0)
    s_sub_u32 s48, s48, s92
    s_sub_u32 s49, s49, s92
    s_sub_u32 s50, s50, s92
    s_sub_u32 s51, s51, s92
    s_sub_u32 s52, s52, s92
    s_sub_u32 s53, s53, s92
    s_sub_u32 s54, s54, s92
    s_sub_u32 s55, s55, s92
    s_max_u32 s48, s48, s49
    s_max_u32 s48, s48, s50
    s_max_u32 s48, s48, s51
    s_max_u32 s48, s48, s52
    s_max_u32 s48, s48, s53
    s_max_u32 s48, s48, s54
    s_max_u32 s48, s48, s55
    s_cmp_lt_u32 s48, 16
    s_cbranch_scc1 L_pollok1
    s_sub_u32 s59, s59, 1
    s_cbranch_scc1 L_pollvec1
    s_sleep 1
    s_branch L_pollsm1
L_pollvec1:
    v_bfe_u32 v53, v4, 4, 6
    v_lshlrev_b32 v53, 2, v53
    s_sub_u32 s96, s96, 1
    s_cbranch_scc1 L_pollgiveup1
    s_sleep 2
    buffer_load_dword v52, v53, s[20:23], s44 offen sc1
    s_waitcnt vmcnt(0)
    v_subrev_u32 v52, s92, v52
    v_cmp_lt_u32 vcc, 15, v52
    s_nop 0
    s_and_b32 s59, vcc_lo, 0xff
    s_cbranch_scc1 L_pollvec1
    s_branch L_pollok1
L_pollgiveup1:
    s_mov_b32 s96, 0
    s_branch L_pollok1
L_pollslow2:
    s_mov_b32 s59, 200
L_pollsm2:
    s_buffer_load_dwordx8 s[48:55], s[20:23], s44 glc
    s_waitcnt lgkmcnt(0)
    s_sub_u32 s48, s48, s92
    s_sub_u32 s49, s49, s92
    s_sub_u32 s50, s50, s92
    s_sub_u32 s51, s51, s92
    s_sub_u32 s52, s52, s92
    s_sub_u32 s53, s53, s92
    s_sub_u32 s54, s54, s92
    s_sub_u32 s55, s55, s92
    s_max_u32 s48, s48, s49
    s_max_u32 s48, s48, s50
    s_max_u32 s48, s48, s51
    s_max_u32 s48, s48, s52
    s_max_u32 s48, s48, s53
    s_max_u32 s48, s48, s54
    s_max_u32 s48, s48, s55
    s_cmp_lt_u32 s48, 16
    s_cbranch_scc1 L_pollok2
    s_sub_u32 s59, s59, 1
    s_cbranch_scc1 L_pollvec2
    s_sleep 1
    s_branch L_pollsm2
L_pollvec2:
    v_bfe_u32 v53, v4, 4, 6
    v_lshlrev_b32 v53, 2, v53
    s_sub_u32 s96, s96, 1
    s_cbranch_scc1 L_pollgiveup2
    s_sleep 2
    buffer_load_dword v52, v53, s[20:23], s44 offen sc1
    s_waitcnt vmcnt(0)
    v_subrev_u32 v52, s92, v52
    v_cmp_lt_u32 vcc, 15, v52
    s_nop 0
    s_and_b32 s59, vcc_lo, 0xff
    s_cbranch_scc1 L_pollvec2
    s_branch L_pollok2
L_pollgiveup2:
    s_mov_b32 s96, 0
    s_branch L_pollok2
L_tagslow:
    s_sub_u32 s96, s96, 1
    s_cbranch_scc1 L_taggiveup
    s_sleep 2
    buffer_load_dword v0, off, s[88:91], s93 sc1
    s_waitcnt vmcnt(0)
    v_readfirstlane_b32 s42, v0
    s_nop 0
    s_cmp_eq_u32 s42, s46
    s_cbranch_scc1 L_tagslow
    s_cmp_eq_u32 s42, 0
    s_cbranch_scc1 L_tagslow
    s_branch L_tagok
L_taggiveup:
    s_mov_b32 s96, 0
    s_branch L_tagok
L_slow:
    s_waitcnt vmcnt(0) lgkmcnt(0)
    s_nop 15
    v_accvgpr_write_b32 a0, 0
    v_accvgpr_write_b32 a1, 0
    v_accvgpr_write_b32 a2, 0
    v_accvgpr_write_b32 a3, 0
    v_accvgpr_write_b32 a4, 0
    v_accvgpr_write_b32 a5, 0
    v_accvgpr_write_b32 a6, 0
    v_accvgpr_write_b32 a7, 0
    v_accvgpr_write_b32 a8, 0
    v_accvgpr_write_b32 a9, 0
    v_accvgpr_write_b32 a10, 0
    v_accvgpr_write_b32 a11, 0
    v_accvgpr_write_b32 a12, 0
    v_accvgpr_write_b32 a13, 0
    v_accvgpr_write_b32 a14, 0
    v_accvgpr_write_b32 a15, 0
    v_accvgpr_write_b32 a16, 0
    v_accvgpr_write_b32 a17, 0
    v_accvgpr_write_b32 a18, 0
    v_accvgpr_write_b32 a19, 0
    v_accvgpr_write_b32 a20, 0
    v_accvgpr_write_b32 a21, 0
    v_accvgpr_write_b32 a22, 0
    v_accvgpr_write_b32 a23, 0
    v_accvgpr_write_b32 a24, 0
    v_accvgpr_write_b32 a25, 0
    v_accvgpr_write_b32 a26, 0
    v_accvgpr_write_b32 a27, 0
    v_accvgpr_write_b32 a28, 0
    v_accvgpr_write_b32 a29, 0
    v_accvgpr_write_b32 a30, 0
    v_accvgpr_write_b32 a31, 0
    v_accvgpr_write_b32 a32, 0
    v_accvgpr_write_b32 a33, 0
    v_accvgpr_write_b32 a34, 0
    v_accvgpr_write_b32 a35, 0
    v_accvgpr_write_b32 a36, 0
    v_accvgpr_write_b32 a37, 0
    v_accvgpr_write_b32 a38, 0
    v_accvgpr_write_b32 a39, 0
    v_accvgpr_write_b32 a40, 0
    v_accvgpr_write_b32 a41, 0
    v_accvgpr_write_b32 a42, 0
    v_accvgpr_write_b32 a43, 0
    v_accvgpr_write_b32 a44, 0
    v_accvgpr_write_b32 a45, 0
    v_accvgpr_write_b32 a46, 0
    v_accvgpr_write_b32 a47, 0
    v_accvgpr_write_b32 a48, 0
    v_accvgpr_write_b32 a49, 0
    v_accvgpr_write_b32 a50, 0
    v_accvgpr_write_b32 a51, 0
    v_accvgpr_write_b32 a52, 0
    v_accvgpr_write_b32 a53, 0
    v_accvgpr_write_b32 a54, 0
    v_accvgpr_write_b32 a55, 0
    v_accvgpr_write_b32 a56, 0
    v_accvgpr_write_b32 a57, 0
    v_accvgpr_write_b32 a58, 0
    v_accvgpr_write_b32 a59, 0
    v_accvgpr_write_b32 a60, 0
    v_accvgpr_write_b32 a61, 0
    v_accvgpr_write_b32 a62, 0
    v_accvgpr_write_b32 a63, 0
    v_accvgpr_write_b32 a64, 0
    v_accvgpr_write_b32 a65, 0
    v_accvgpr_write_b32 a66, 0
    v_accvgpr_write_b32 a67, 0
    v_accvgpr_write_b32 a68, 0
    v_accvgpr_write_b32 a69, 0
    v_accvgpr_write_b32 a70, 0
    v_accvgpr_write_b32 a71, 0
    v_accvgpr_write_b32 a72, 0
    v_accvgpr_write_b32 a73, 0
    v_accvgpr_write_b32 a74, 0
    v_accvgpr_write_b32 a75, 0
    v_accvgpr_write_b32 a76, 0
    v_accvgpr_write_b32 a77, 0
    v_accvgpr_write_b32 a78, 0
    v_accvgpr_write_b32 a79, 0
    v_accvgpr_write_b32 a80, 0
    v_accvgpr_write_b32 a81, 0
    v_accvgpr_write_b32 a82, 0
    v_accvgpr_write_b32 a83, 0
    v_accvgpr_write_b32 a84, 0
    v_accvgpr_write_b32 a85, 0
    v_accvgpr_write_b32 a86, 0
    v_accvgpr_write_b32 a87, 0
    v_accvgpr_write_b32 a88, 0
    v_accvgpr_write_b32 a89, 0
    v_accvgpr_write_b32 a90, 0
    v_accvgpr_write_b32 a91, 0
    v_accvgpr_write_b32 a92, 0
    v_accvgpr_write_b32 a93, 0
    v_accvgpr_write_b32 a94, 0
    v_accvgpr_write_b32 a95, 0
    v_accvgpr_write_b32 a96, 0
    v_accvgpr_write_b32 a97, 0
    v_accvgpr_write_b32 a98, 0
    v_accvgpr_write_b32 a99, 0
    v_accvgpr_write_b32 a100, 0
    v_accvgpr_write_b32 a101, 0
    v_accvgpr_write_b32 a102, 0
    v_accvgpr_write_b32 a103, 0
    v_accvgpr_write_b32 a104, 0
    v_accvgpr_write_b32 a105, 0
    v_accvgpr_write_b32 a106, 0
    v_accvgpr_write_b32 a107, 0
    v_accvgpr_write_b32 a108, 0
    v_accvgpr_write_b32 a109, 0
    v_accvgpr_write_b32 a110, 0
    v_accvgpr_write_b32 a111, 0
    v_accvgpr_write_b32 a112, 0
    v_accvgpr_write_b32 a113, 0
    v_accvgpr_write_b32 a114, 0
    v_accvgpr_write_b32 a115, 0
    v_accvgpr_write_b32 a116, 0
    v_accvgpr_write_b32 a117, 0
    v_accvgpr_write_b32 a118, 0
    v_accvgpr_write_b32 a119, 0
    v_accvgpr_write_b32 a120, 0
    v_accvgpr_write_b32 a121, 0
    v_accvgpr_write_b32 a122, 0
    v_accvgpr_write_b32 a123, 0
    v_accvgpr_write_b32 a124, 0
    v_accvgpr_write_b32 a125, 0
    v_accvgpr_write_b32 a126, 0
    v_accvgpr_write_b32 a127, 0
    v_accvgpr_write_b32 a128, 0
    v_accvgpr_write_b32 a129, 0
    v_accvgpr_write_b32 a130, 0
    v_accvgpr_write_b32 a131, 0
    v_accvgpr_write_b32 a132, 0
    v_accvgpr_write_b32 a133, 0
    v_accvgpr_write_b32 a134, 0
    v_accvgpr_write_b32 a135, 0
    v_accvgpr_write_b32 a136, 0
    v_accvgpr_write_b32 a137, 0
    v_accvgpr_write_b32 a138, 0
    v_accvgpr_write_b32 a139, 0
    v_accvgpr_write_b32 a140, 0
    v_accvgpr_write_b32 a141, 0
    v_accvgpr_write_b32 a142, 0
    v_accvgpr_write_b32 a143, 0
    v_accvgpr_write_b32 a144, 0
    v_accvgpr_write_b32 a145, 0
    v_accvgpr_write_b32 a146, 0
    v_accvgpr_write_b32 a147, 0
    v_accvgpr_write_b32 a148, 0
    v_accvgpr_write_b32 a149, 0
    v_accvgpr_write_b32 a150, 0
    v_accvgpr_write_b32 a151, 0
    v_accvgpr_write_b32 a152, 0
    v_accvgpr_write_b32 a153, 0
    v_accvgpr_write_b32 a154, 0
    v_accvgpr_write_b32 a155, 0
    v_accvgpr_write_b32 a156, 0
    v_accvgpr_write_b32 a157, 0
    v_accvgpr_write_b32 a158, 0
    v_accvgpr_write_b32 a159, 0
    v_accvgpr_write_b32 a160, 0
    v_accvgpr_write_b32 a161, 0
    v_accvgpr_write_b32 a162, 0
    v_accvgpr_write_b32 a163, 0
    v_accvgpr_write_b32 a164, 0
    v_accvgpr_write_b32 a165, 0
    v_accvgpr_write_b32 a166, 0
    v_accvgpr_write_b32 a167, 0
    v_accvgpr_write_b32 a168, 0
    v_accvgpr_write_b32 a169, 0
    v_accvgpr_write_b32 a170, 0
    v_accvgpr_write_b32 a171, 0
    v_accvgpr_write_b32 a172, 0
    v_accvgpr_write_b32 a173, 0
    v_accvgpr_write_b32 a174, 0
    v_accvgpr_write_b32 a175, 0
    v_accvgpr_write_b32 a176, 0
    v_accvgpr_write_b32 a177, 0
    v_accvgpr_write_b32 a178, 0
    v_accvgpr_write_b32 a179, 0
    v_accvgpr_write_b32 a180, 0
    v_accvgpr_write_b32 a181, 0
    v_accvgpr_write_b32 a182, 0
    v_accvgpr_write_b32 a183, 0
    v_accvgpr_write_b32 a184, 0
    v_accvgpr_write_b32 a185, 0
    v_accvgpr_write_b32 a186, 0
    v_accvgpr_write_b32 a187, 0
    v_accvgpr_write_b32 a188, 0
    v_accvgpr_write_b32 a189, 0
    v_accvgpr_write_b32 a190, 0
    v_accvgpr_write_b32 a191, 0
    v_mov_b32 v5, 0
    v_mov_b32 v240, 0xff7fffff
    v_mov_b32 v6, 0
    v_mov_b32 v241, 0xff7fffff
    v_mov_b32 v7, 0
    v_mov_b32 v242, 0xff7fffff
    v_mov_b32 v8, 0
    v_mov_b32 v243, 0xff7fffff
    v_subrev_u32 v244, 49152, v2
    v_subrev_u32 v245, 49152, v3
    v_subrev_u32 v246, 24576, v1
    s_mov_b32 s48, 0
L_slowloop:
    s_add_u32 s49, s48, 6144
    s_add_u32 s50, s48, 12288
    s_add_u32 s51, s48, 16384
    s_add_u32 s52, s48, 20480
    buffer_load_dwordx4 v[64:67], v244, s[4:7], s48 offen offset:0 sc1
    buffer_load_dwordx4 v[68:71], v245, s[4:7], s48 offen offset:0 sc1
    buffer_load_dwordx4 v[72:75], v244, s[4:7], s49 offen offset:0 sc1
    buffer_load_dwordx4 v[76:79], v245, s[4:7], s49 offen offset:0 sc1
    buffer_load_dwordx4 v[80:83], v244, s[4:7], s48 offen offset:128 sc1
    buffer_load_dwordx4 v[84:87], v245, s[4:7], s48 offen offset:128 sc1
    buffer_load_dwordx4 v[88:91], v244, s[4:7], s49 offen offset:128 sc1
    buffer_load_dwordx4 v[92:95], v245, s[4:7], s49 offen offset:128 sc1
    buffer_load_dwordx4 v[96:99], v244, s[4:7], s48 offen offset:256 sc1
    buffer_load_dwordx4 v[100:103], v245, s[4:7], s48 offen offset:256 sc1
    buffer_load_dwordx4 v[104:107], v244, s[4:7], s49 offen offset:256 sc1
    buffer_load_dwordx4 v[108:111], v245, s[4:7], s49 offen offset:256 sc1
    buffer_load_dwordx4 v[112:115], v246, s[4:7], s50 offen offset:0 sc1
    buffer_load_dwordx4 v[116:119], v246, s[4:7], s50 offen offset:1024 sc1
    buffer_load_dwordx4 v[120:123], v246, s[4:7], s50 offen offset:2048 sc1
    buffer_load_dwordx4 v[124:127], v246, s[4:7], s50 offen offset:3072 sc1
    buffer_load_dwordx4 v[128:131], v246, s[4:7], s51 offen offset:0 sc1
    buffer_load_dwordx4 v[132:135], v246, s[4:7], s51 offen offset:1024 sc1
    buffer_load_dwordx4 v[136:139], v246, s[4:7], s51 offen offset:2048 sc1
    buffer_load_dwordx4 v[140:143], v246, s[4:7], s51 offen offset:3072 sc1
    buffer_load_dwordx4 v[144:147], v246, s[4:7], s52 offen offset:0 sc1
    buffer_load_dwordx4 v[148:151], v246, s[4:7], s52 offen offset:1024 sc1
    buffer_load_dwordx4 v[152:155], v246, s[4:7], s52 offen offset:2048 sc1
    buffer_load_dwordx4 v[156:159], v246, s[4:7], s52 offen offset:3072 sc1
    s_waitcnt vmcnt(12)
    v_mfma_f32_16x16x32_bf16 v[160:163], v[64:67], a[192:195], 0
    v_mfma_f32_16x16x32_bf16 v[168:171], v[64:67], a[216:219], 0
    v_mfma_f32_16x16x32_bf16 v[176:179], v[64:67], a[240:243], 0
    v_mfma_f32_16x16x32_bf16 v[184:187], v[64:67], v[200:203], 0
    v_mfma_f32_16x16x32_bf16 v[160:163], v[68:71], a[196:199], v[160:163]
    v_mfma_f32_16x16x32_bf16 v[168:171], v[68:71], a[220:223], v[168:171]
    v_mfma_f32_16x16x32_bf16 v[176:179], v[68:71], a[244:247], v[176:179]
    v_mfma_f32_16x16x32_bf16 v[184:187], v[68:71], v[204:207], v[184:187]
    v_mfma_f32_16x16x32_bf16 v[164:167], v[72:75], a[192:195], 0
    v_mfma_f32_16x16x32_bf16 v[172:175], v[72:75], a[216:219], 0
    v_mfma_f32_16x16x32_bf16 v[180:183], v[72:75], a[240:243], 0
    v_mfma_f32_16x16x32_bf16 v[188:191], v[72:75], v[200:203], 0
    v_mfma_f32_16x16x32_bf16 v[164:167], v[76:79], a[196:199], v[164:167]
    v_mfma_f32_16x16x32_bf16 v[172:175], v[76:79], a[220:223], v[172:175]
    v_mfma_f32_16x16x32_bf16 v[180:183], v[76:79], a[244:247], v[180:183]
    v_mfma_f32_16x16x32_bf16 v[188:191], v[76:79], v[204:207], v[188:191]
    v_mfma_f32_16x16x32_bf16 v[160:163], v[80:83], a[200:203], v[160:163]
    v_mfma_f32_16x16x32_bf16 v[168:171], v[80:83], a[224:227], v[168:171]
    v_mfma_f32_16x16x32_bf16 v[176:179], v[80:83], a[248:251], v[176:179]
    v_mfma_f32_16x16x32_bf16 v[184:187], v[80:83], v[208:211], v[184:187]
    v_mfma_f32_16x16x32_bf16 v[160:163], v[84:87], a[204:207], v[160:163]
    v_mfma_f32_16x16x32_bf16 v[168:171], v[84:87], a[228:231], v[168:171]
    v_mfma_f32_16x16x32_bf16 v[176:179], v[84:87], a[252:255], v[176:179]
    v_mfma_f32_16x16x32_bf16 v[184:187], v[84:87], v[212:215], v[184:187]
    v_mfma_f32_16x16x32_bf16 v[164:167], v[88:91], a[200:203], v[164:167]
    v_mfma_f32_16x16x32_bf16 v[172:175], v[88:91], a[224:227], v[172:175]
    v_mfma_f32_16x16x32_bf16 v[180:183], v[88:91], a[248:251], v[180:183]
    v_mfma_f32_16x16x32_bf16 v[188:191], v[88:91], v[208:211], v[188:191]
    v_mfma_f32_16x16x32_bf16 v[164:167], v[92:95], a[204:207], v[164:167]
    v_mfma_f32_16x16x32_bf16 v[172:175], v[92:95], a[228:231], v[172:175]
    v_mfma_f32_16x16x32_bf16 v[180:183], v[92:95], a[252:255], v[180:183]
    v_mfma_f32_16x16x32_bf16 v[188:191], v[92:95], v[212:215], v[188:191]
    v_mfma_f32_16x16x32_bf16 v[160:163], v[96:99], a[208:211], v[160:163]
    v_mfma_f32_16x16x32_bf16 v[168:171], v[96:99], a[232:235], v[168:171]
    v_mfma_f32_16x16x32_bf16 v[176:179], v[96:99], v[192:195], v[176:179]
    v_mfma_f32_16x16x32_bf16 v[184:187], v[96:99], v[216:219], v[184:187]
    v_mfma_f32_16x16x32_bf16 v[160:163], v[100:103], a[212:215], v[160:163]
    v_mfma_f32_16x16x32_bf16 v[168:171], v[100:103], a[236:239], v[168:171]
    v_mfma_f32_16x16x32_bf16 v[176:179], v[100:103], v[196:199], v[176:179]
    v_mfma_f32_16x16x32_bf16 v[184:187], v[100:103], v[220:223], v[184:187]
    v_mfma_f32_16x16x32_bf16 v[164:167], v[104:107], a[208:211], v[164:167]
    v_mfma_f32_16x16x32_bf16 v[172:175], v[104:107], a[232:235], v[172:175]
    v_mfma_f32_16x16x32_bf16 v[180:183], v[104:107], v[192:195], v[180:183]
    v_mfma_f32_16x16x32_bf16 v[188:191], v[104:107], v[216:219], v[188:191]
    v_mfma_f32_16x16x32_bf16 v[164:167], v[108:111], a[212:215], v[164:167]
    v_mfma_f32_16x16x32_bf16 v[172:175], v[108:111], a[236:239], v[172:175]
    v_mfma_f32_16x16x32_bf16 v[180:183], v[108:111], v[196:199], v[180:183]
    v_mfma_f32_16x16x32_bf16 v[188:191], v[108:111], v[220:223], v[188:191]
    s_nop 9
    v_max3_f32 v16, v160, v161, v162
    v_max3_f32 v16, v16, v163, v164
    v_max3_f32 v16, v16, v165, v166
    v_max3_f32 v16, v16, v167, v240
    v_mov_b32 v17, v16
    s_nop 1
    v_permlane16_swap_b32 v16, v17
    s_nop 1
    v_max_f32 v16, v16, v17
    v_mov_b32 v17, v16
    s_nop 1
    v_permlane32_swap_b32 v16, v17
    s_nop 1
    v_max_f32 v16, v16, v17
    v_sub_f32 v17, v240, v16
    v_exp_f32 v17, v17
    v_mov_b32 v240, v16
    v_sub_f32 v160, v160, v16
    v_sub_f32 v161, v161, v16
    v_sub_f32 v162, v162, v16
    v_sub_f32 v163, v163, v16
    v_sub_f32 v164, v164, v16
    v_sub_f32 v165, v165, v16
    v_sub_f32 v166, v166, v16
    v_sub_f32 v167, v167, v16
    v_exp_f32 v160, v160
    v_exp_f32 v161, v161
    v_exp_f32 v162, v162
    v_exp_f32 v163, v163
    v_exp_f32 v164, v164
    v_exp_f32 v165, v165
    v_exp_f32 v166, v166
    v_exp_f32 v167, v167
    v_mul_f32 v5, v5, v17
    v_add_f32 v5, v5, v160
    v_add_f32 v5, v5, v161
    v_add_f32 v5, v5, v162
    v_add_f32 v5, v5, v163
    v_add_f32 v5, v5, v164
    v_add_f32 v5, v5, v165
    v_add_f32 v5, v5, v166
    v_add_f32 v5, v5, v167
    v_cvt_pk_bf16_f32 v224, v160, v161
    v_cvt_pk_bf16_f32 v225, v162, v163
    v_cvt_pk_bf16_f32 v226, v164, v165
    v_cvt_pk_bf16_f32 v227, v166, v167
    ds_bpermute_b32 v248, v58, v17 offset:0
    ds_bpermute_b32 v249, v58, v17 offset:4
    ds_bpermute_b32 v250, v58, v17 offset:8
    ds_bpermute_b32 v251, v58, v17 offset:12
    s_waitcnt lgkmcnt(0)
    v_accvgpr_read_b32 v18, a0
    v_mul_f32 v18, v18, v248
    v_accvgpr_write_b32 a0, v18
    v_accvgpr_read_b32 v19, a1
    v_mul_f32 v19, v19, v249
    v_accvgpr_write_b32 a1, v19
    v_accvgpr_read_b32 v18, a2
    v_mul_f32 v18, v18, v250
    v_accvgpr_write_b32 a2, v18
    v_accvgpr_read_b32 v19, a3
    v_mul_f32 v19, v19, v251
    v_accvgpr_write_b32 a3, v19
    v_accvgpr_read_b32 v18, a4
    v_mul_f32 v18, v18, v248
    v_accvgpr_write_b32 a4, v18
    v_accvgpr_read_b32 v19, a5
    v_mul_f32 v19, v19, v249
    v_accvgpr_write_b32 a5, v19
    v_accvgpr_read_b32 v18, a6
    v_mul_f32 v18, v18, v250
    v_accvgpr_write_b32 a6, v18
    v_accvgpr_read_b32 v19, a7
    v_mul_f32 v19, v19, v251
    v_accvgpr_write_b32 a7, v19
    v_accvgpr_read_b32 v18, a8
    v_mul_f32 v18, v18, v248
    v_accvgpr_write_b32 a8, v18
    v_accvgpr_read_b32 v19, a9
    v_mul_f32 v19, v19, v249
    v_accvgpr_write_b32 a9, v19
    v_accvgpr_read_b32 v18, a10
    v_mul_f32 v18, v18, v250
    v_accvgpr_write_b32 a10, v18
    v_accvgpr_read_b32 v19, a11
    v_mul_f32 v19, v19, v251
    v_accvgpr_write_b32 a11, v19
    v_accvgpr_read_b32 v18, a12
    v_mul_f32 v18, v18, v248
    v_accvgpr_write_b32 a12, v18
    v_accvgpr_read_b32 v19, a13
    v_mul_f32 v19, v19, v249
    v_accvgpr_write_b32 a13, v19
    v_accvgpr_read_b32 v18, a14
    v_mul_f32 v18, v18, v250
    v_accvgpr_write_b32 a14, v18
    v_accvgpr_read_b32 v19, a15
    v_mul_f32 v19, v19, v251
    v_accvgpr_write_b32 a15, v19
    v_accvgpr_read_b32 v18, a16
    v_mul_f32 v18, v18, v248
    v_accvgpr_write_b32 a16, v18
    v_accvgpr_read_b32 v19, a17
    v_mul_f32 v19, v19, v249
    v_accvgpr_write_b32 a17, v19
    v_accvgpr_read_b32 v18, a18
    v_mul_f32 v18, v18, v250
    v_accvgpr_write_b32 a18, v18
    v_accvgpr_read_b32 v19, a19
    v_mul_f32 v19, v19, v251
    v_accvgpr_write_b32 a19, v19
    v_accvgpr_read_b32 v18, a20
    v_mul_f32 v18, v18, v248
    v_accvgpr_write_b32 a20, v18
    v_accvgpr_read_b32 v19, a21
    v_mul_f32 v19, v19, v249
    v_accvgpr_write_b32 a21, v19
    v_accvgpr_read_b32 v18, a22
    v_mul_f32 v18, v18, v250
    v_accvgpr_write_b32 a22, v18
    v_accvgpr_read_b32 v19, a23
    v_mul_f32 v19, v19, v251
    v_accvgpr_write_b32 a23, v19
    v_accvgpr_read_b32 v18, a24
    v_mul_f32 v18, v18, v248
    v_accvgpr_write_b32 a24, v18
    v_accvgpr_read_b32 v19, a25
    v_mul_f32 v19, v19, v249
    v_accvgpr_write_b32 a25, v19
    v_accvgpr_read_b32 v18, a26
    v_mul_f32 v18, v18, v250
    v_accvgpr_write_b32 a26, v18
    v_accvgpr_read_b32 v19, a27
    v_mul_f32 v19, v19, v251
    v_accvgpr_write_b32 a27, v19
    v_accvgpr_read_b32 v18, a28
    v_mul_f32 v18, v18, v248
    v_accvgpr_write_b32 a28, v18
    v_accvgpr_read_b32 v19, a29
    v_mul_f32 v19, v19, v249
    v_accvgpr_write_b32 a29, v19
    v_accvgpr_read_b32 v18, a30
    v_mul_f32 v18, v18, v250
    v_accvgpr_write_b32 a30, v18
    v_accvgpr_read_b32 v19, a31
    v_mul_f32 v19, v19, v251
    v_accvgpr_write_b32 a31, v19
    v_accvgpr_read_b32 v18, a32
    v_mul_f32 v18, v18, v248
    v_accvgpr_write_b32 a32, v18
    v_accvgpr_read_b32 v19, a33
    v_mul_f32 v19, v19, v249
    v_accvgpr_write_b32 a33, v19
    v_accvgpr_read_b32 v18, a34
    v_mul_f32 v18, v18, v250
    v_accvgpr_write_b32 a34, v18
    v_accvgpr_read_b32 v19, a35
    v_mul_f32 v19, v19, v251
    v_accvgpr_write_b32 a35, v19
    v_accvgpr_read_b32 v18, a36
    v_mul_f32 v18, v18, v248
    v_accvgpr_write_b32 a36, v18
    v_accvgpr_read_b32 v19, a37
    v_mul_f32 v19, v19, v249
    v_accvgpr_write_b32 a37, v19
    v_accvgpr_read_b32 v18, a38
    v_mul_f32 v18, v18, v250
    v_accvgpr_write_b32 a38, v18
    v_accvgpr_read_b32 v19, a39
    v_mul_f32 v19, v19, v251
    v_accvgpr_write_b32 a39, v19
    v_accvgpr_read_b32 v18, a40
    v_mul_f32 v18, v18, v248
    v_accvgpr_write_b32 a40, v18
    v_accvgpr_read_b32 v19, a41
    v_mul_f32 v19, v19, v249
    v_accvgpr_write_b32 a41, v19
    v_accvgpr_read_b32 v18, a42
    v_mul_f32 v18, v18, v250
    v_accvgpr_write_b32 a42, v18
    v_accvgpr_read_b32 v19, a43
    v_mul_f32 v19, v19, v251
    v_accvgpr_write_b32 a43, v19
    v_accvgpr_read_b32 v18, a44
    v_mul_f32 v18, v18, v248
    v_accvgpr_write_b32 a44, v18
    v_accvgpr_read_b32 v19, a45
    v_mul_f32 v19, v19, v249
    v_accvgpr_write_b32 a45, v19
    v_accvgpr_read_b32 v18, a46
    v_mul_f32 v18, v18, v250
    v_accvgpr_write_b32 a46, v18
    v_accvgpr_read_b32 v19, a47
    v_mul_f32 v19, v19, v251
    v_accvgpr_write_b32 a47, v19
    v_max3_f32 v16, v168, v169, v170
    v_max3_f32 v16, v16, v171, v172
    v_max3_f32 v16, v16, v173, v174
    v_max3_f32 v16, v16, v175, v241
    v_mov_b32 v17, v16
    s_nop 1
    v_permlane16_swap_b32 v16, v17
    s_nop 1
    v_max_f32 v16, v16, v17
    v_mov_b32 v17, v16
    s_nop 1
    v_permlane32_swap_b32 v16, v17
    s_nop 1
    v_max_f32 v16, v16, v17
    v_sub_f32 v17, v241, v16
    v_exp_f32 v17, v17
    v_mov_b32 v241, v16
    v_sub_f32 v168, v168, v16
    v_sub_f32 v169, v169, v16
    v_sub_f32 v170, v170, v16
    v_sub_f32 v171, v171, v16
    v_sub_f32 v172, v172, v16
    v_sub_f32 v173, v173, v16
    v_sub_f32 v174, v174, v16
    v_sub_f32 v175, v175, v16
    v_exp_f32 v168, v168
    v_exp_f32 v169, v169
    v_exp_f32 v170, v170
    v_exp_f32 v171, v171
    v_exp_f32 v172, v172
    v_exp_f32 v173, v173
    v_exp_f32 v174, v174
    v_exp_f32 v175, v175
    v_mul_f32 v6, v6, v17
    v_add_f32 v6, v6, v168
    v_add_f32 v6, v6, v169
    v_add_f32 v6, v6, v170
    v_add_f32 v6, v6, v171
    v_add_f32 v6, v6, v172
    v_add_f32 v6, v6, v173
    v_add_f32 v6, v6, v174
    v_add_f32 v6, v6, v175
    v_cvt_pk_bf16_f32 v228, v168, v169
    v_cvt_pk_bf16_f32 v229, v170, v171
    v_cvt_pk_bf16_f32 v230, v172, v173
    v_cvt_pk_bf16_f32 v231, v174, v175
    ds_bpermute_b32 v248, v58, v17 offset:0
    ds_bpermute_b32 v249, v58, v17 offset:4
    ds_bpermute_b32 v250, v58, v17 offset:8
    ds_bpermute_b32 v251, v58, v17 offset:12
    s_waitcnt lgkmcnt(0)
    v_accvgpr_read_b32 v18, a48
    v_mul_f32 v18, v18, v248
    v_accvgpr_write_b32 a48, v18
    v_accvgpr_read_b32 v19, a49
    v_mul_f32 v19, v19, v249
    v_accvgpr_write_b32 a49, v19
    v_accvgpr_read_b32 v18, a50
    v_mul_f32 v18, v18, v250
    v_accvgpr_write_b32 a50, v18
    v_accvgpr_read_b32 v19, a51
    v_mul_f32 v19, v19, v251
    v_accvgpr_write_b32 a51, v19
    v_accvgpr_read_b32 v18, a52
    v_mul_f32 v18, v18, v248
    v_accvgpr_write_b32 a52, v18
    v_accvgpr_read_b32 v19, a53
    v_mul_f32 v19, v19, v249
    v_accvgpr_write_b32 a53, v19
    v_accvgpr_read_b32 v18, a54
    v_mul_f32 v18, v18, v250
    v_accvgpr_write_b32 a54, v18
    v_accvgpr_read_b32 v19, a55
    v_mul_f32 v19, v19, v251
    v_accvgpr_write_b32 a55, v19
    v_accvgpr_read_b32 v18, a56
    v_mul_f32 v18, v18, v248
    v_accvgpr_write_b32 a56, v18
    v_accvgpr_read_b32 v19, a57
    v_mul_f32 v19, v19, v249
    v_accvgpr_write_b32 a57, v19
    v_accvgpr_read_b32 v18, a58
    v_mul_f32 v18, v18, v250
    v_accvgpr_write_b32 a58, v18
    v_accvgpr_read_b32 v19, a59
    v_mul_f32 v19, v19, v251
    v_accvgpr_write_b32 a59, v19
    v_accvgpr_read_b32 v18, a60
    v_mul_f32 v18, v18, v248
    v_accvgpr_write_b32 a60, v18
    v_accvgpr_read_b32 v19, a61
    v_mul_f32 v19, v19, v249
    v_accvgpr_write_b32 a61, v19
    v_accvgpr_read_b32 v18, a62
    v_mul_f32 v18, v18, v250
    v_accvgpr_write_b32 a62, v18
    v_accvgpr_read_b32 v19, a63
    v_mul_f32 v19, v19, v251
    v_accvgpr_write_b32 a63, v19
    v_accvgpr_read_b32 v18, a64
    v_mul_f32 v18, v18, v248
    v_accvgpr_write_b32 a64, v18
    v_accvgpr_read_b32 v19, a65
    v_mul_f32 v19, v19, v249
    v_accvgpr_write_b32 a65, v19
    v_accvgpr_read_b32 v18, a66
    v_mul_f32 v18, v18, v250
    v_accvgpr_write_b32 a66, v18
    v_accvgpr_read_b32 v19, a67
    v_mul_f32 v19, v19, v251
    v_accvgpr_write_b32 a67, v19
    v_accvgpr_read_b32 v18, a68
    v_mul_f32 v18, v18, v248
    v_accvgpr_write_b32 a68, v18
    v_accvgpr_read_b32 v19, a69
    v_mul_f32 v19, v19, v249
    v_accvgpr_write_b32 a69, v19
    v_accvgpr_read_b32 v18, a70
    v_mul_f32 v18, v18, v250
    v_accvgpr_write_b32 a70, v18
    v_accvgpr_read_b32 v19, a71
    v_mul_f32 v19, v19, v251
    v_accvgpr_write_b32 a71, v19
    v_accvgpr_read_b32 v18, a72
    v_mul_f32 v18, v18, v248
    v_accvgpr_write_b32 a72, v18
    v_accvgpr_read_b32 v19, a73
    v_mul_f32 v19, v19, v249
    v_accvgpr_write_b32 a73, v19
    v_accvgpr_read_b32 v18, a74
    v_mul_f32 v18, v18, v250
    v_accvgpr_write_b32 a74, v18
    v_accvgpr_read_b32 v19, a75
    v_mul_f32 v19, v19, v251
    v_accvgpr_write_b32 a75, v19
    v_accvgpr_read_b32 v18, a76
    v_mul_f32 v18, v18, v248
    v_accvgpr_write_b32 a76, v18
    v_accvgpr_read_b32 v19, a77
    v_mul_f32 v19, v19, v249
    v_accvgpr_write_b32 a77, v19
    v_accvgpr_read_b32 v18, a78
    v_mul_f32 v18, v18, v250
    v_accvgpr_write_b32 a78, v18
    v_accvgpr_read_b32 v19, a79
    v_mul_f32 v19, v19, v251
    v_accvgpr_write_b32 a79, v19
    v_accvgpr_read_b32 v18, a80
    v_mul_f32 v18, v18, v248
    v_accvgpr_write_b32 a80, v18
    v_accvgpr_read_b32 v19, a81
    v_mul_f32 v19, v19, v249
    v_accvgpr_write_b32 a81, v19
    v_accvgpr_read_b32 v18, a82
    v_mul_f32 v18, v18, v250
    v_accvgpr_write_b32 a82, v18
    v_accvgpr_read_b32 v19, a83
    v_mul_f32 v19, v19, v251
    v_accvgpr_write_b32 a83, v19
    v_accvgpr_read_b32 v18, a84
    v_mul_f32 v18, v18, v248
    v_accvgpr_write_b32 a84, v18
    v_accvgpr_read_b32 v19, a85
    v_mul_f32 v19, v19, v249
    v_accvgpr_write_b32 a85, v19
    v_accvgpr_read_b32 v18, a86
    v_mul_f32 v18, v18, v250
    v_accvgpr_write_b32 a86, v18
    v_accvgpr_read_b32 v19, a87
    v_mul_f32 v19, v19, v251
    v_accvgpr_write_b32 a87, v19
    v_accvgpr_read_b32 v18, a88
    v_mul_f32 v18, v18, v248
    v_accvgpr_write_b32 a88, v18
    v_accvgpr_read_b32 v19, a89
    v_mul_f32 v19, v19, v249
    v_accvgpr_write_b32 a89, v19
    v_accvgpr_read_b32 v18, a90
    v_mul_f32 v18, v18, v250
    v_accvgpr_write_b32 a90, v18
    v_accvgpr_read_b32 v19, a91
    v_mul_f32 v19, v19, v251
    v_accvgpr_write_b32 a91, v19
    v_accvgpr_read_b32 v18, a92
    v_mul_f32 v18, v18, v248
    v_accvgpr_write_b32 a92, v18
    v_accvgpr_read_b32 v19, a93
    v_mul_f32 v19, v19, v249
    v_accvgpr_write_b32 a93, v19
    v_accvgpr_read_b32 v18, a94
    v_mul_f32 v18, v18, v250
    v_accvgpr_write_b32 a94, v18
    v_accvgpr_read_b32 v19, a95
    v_mul_f32 v19, v19, v251
    v_accvgpr_write_b32 a95, v19
    v_max3_f32 v16, v176, v177, v178
    v_max3_f32 v16, v16, v179, v180
    v_max3_f32 v16, v16, v181, v182
    v_max3_f32 v16, v16, v183, v242
    v_mov_b32 v17, v16
    s_nop 1
    v_permlane16_swap_b32 v16, v17
    s_nop 1
    v_max_f32 v16, v16, v17
    v_mov_b32 v17, v16
    s_nop 1
    v_permlane32_swap_b32 v16, v17
    s_nop 1
    v_max_f32 v16, v16, v17
    v_sub_f32 v17, v242, v16
    v_exp_f32 v17, v17
    v_mov_b32 v242, v16
    v_sub_f32 v176, v176, v16
    v_sub_f32 v177, v177, v16
    v_sub_f32 v178, v178, v16
    v_sub_f32 v179, v179, v16
    v_sub_f32 v180, v180, v16
    v_sub_f32 v181, v181, v16
    v_sub_f32 v182, v182, v16
    v_sub_f32 v183, v183, v16
    v_exp_f32 v176, v176
    v_exp_f32 v177, v177
    v_exp_f32 v178, v178
    v_exp_f32 v179, v179
    v_exp_f32 v180, v180
    v_exp_f32 v181, v181
    v_exp_f32 v182, v182
    v_exp_f32 v183, v183
    v_mul_f32 v7, v7, v17
    v_add_f32 v7, v7, v176
    v_add_f32 v7, v7, v177
    v_add_f32 v7, v7, v178
    v_add_f32 v7, v7, v179
    v_add_f32 v7, v7, v180
    v_add_f32 v7, v7, v181
    v_add_f32 v7, v7, v182
    v_add_f32 v7, v7, v183
    v_cvt_pk_bf16_f32 v232, v176, v177
    v_cvt_pk_bf16_f32 v233, v178, v179
    v_cvt_pk_bf16_f32 v234, v180, v181
    v_cvt_pk_bf16_f32 v235, v182, v183
    ds_bpermute_b32 v248, v58, v17 offset:0
    ds_bpermute_b32 v249, v58, v17 offset:4
    ds_bpermute_b32 v250, v58, v17 offset:8
    ds_bpermute_b32 v251, v58, v17 offset:12
    s_waitcnt lgkmcnt(0)
    v_accvgpr_read_b32 v18, a96
    v_mul_f32 v18, v18, v248
    v_accvgpr_write_b32 a96, v18
    v_accvgpr_read_b32 v19, a97
    v_mul_f32 v19, v19, v249
    v_accvgpr_write_b32 a97, v19
    v_accvgpr_read_b32 v18, a98
    v_mul_f32 v18, v18, v250
    v_accvgpr_write_b32 a98, v18
    v_accvgpr_read_b32 v19, a99
    v_mul_f32 v19, v19, v251
    v_accvgpr_write_b32 a99, v19
    v_accvgpr_read_b32 v18, a100
    v_mul_f32 v18, v18, v248
    v_accvgpr_write_b32 a100, v18
    v_accvgpr_read_b32 v19, a101
    v_mul_f32 v19, v19, v249
    v_accvgpr_write_b32 a101, v19
    v_accvgpr_read_b32 v18, a102
    v_mul_f32 v18, v18, v250
    v_accvgpr_write_b32 a102, v18
    v_accvgpr_read_b32 v19, a103
    v_mul_f32 v19, v19, v251
    v_accvgpr_write_b32 a103, v19
    v_accvgpr_read_b32 v18, a104
    v_mul_f32 v18, v18, v248
    v_accvgpr_write_b32 a104, v18
    v_accvgpr_read_b32 v19, a105
    v_mul_f32 v19, v19, v249
    v_accvgpr_write_b32 a105, v19
    v_accvgpr_read_b32 v18, a106
    v_mul_f32 v18, v18, v250
    v_accvgpr_write_b32 a106, v18
    v_accvgpr_read_b32 v19, a107
    v_mul_f32 v19, v19, v251
    v_accvgpr_write_b32 a107, v19
    v_accvgpr_read_b32 v18, a108
    v_mul_f32 v18, v18, v248
    v_accvgpr_write_b32 a108, v18
    v_accvgpr_read_b32 v19, a109
    v_mul_f32 v19, v19, v249
    v_accvgpr_write_b32 a109, v19
    v_accvgpr_read_b32 v18, a110
    v_mul_f32 v18, v18, v250
    v_accvgpr_write_b32 a110, v18
    v_accvgpr_read_b32 v19, a111
    v_mul_f32 v19, v19, v251
    v_accvgpr_write_b32 a111, v19
    v_accvgpr_read_b32 v18, a112
    v_mul_f32 v18, v18, v248
    v_accvgpr_write_b32 a112, v18
    v_accvgpr_read_b32 v19, a113
    v_mul_f32 v19, v19, v249
    v_accvgpr_write_b32 a113, v19
    v_accvgpr_read_b32 v18, a114
    v_mul_f32 v18, v18, v250
    v_accvgpr_write_b32 a114, v18
    v_accvgpr_read_b32 v19, a115
    v_mul_f32 v19, v19, v251
    v_accvgpr_write_b32 a115, v19
    v_accvgpr_read_b32 v18, a116
    v_mul_f32 v18, v18, v248
    v_accvgpr_write_b32 a116, v18
    v_accvgpr_read_b32 v19, a117
    v_mul_f32 v19, v19, v249
    v_accvgpr_write_b32 a117, v19
    v_accvgpr_read_b32 v18, a118
    v_mul_f32 v18, v18, v250
    v_accvgpr_write_b32 a118, v18
    v_accvgpr_read_b32 v19, a119
    v_mul_f32 v19, v19, v251
    v_accvgpr_write_b32 a119, v19
    v_accvgpr_read_b32 v18, a120
    v_mul_f32 v18, v18, v248
    v_accvgpr_write_b32 a120, v18
    v_accvgpr_read_b32 v19, a121
    v_mul_f32 v19, v19, v249
    v_accvgpr_write_b32 a121, v19
    v_accvgpr_read_b32 v18, a122
    v_mul_f32 v18, v18, v250
    v_accvgpr_write_b32 a122, v18
    v_accvgpr_read_b32 v19, a123
    v_mul_f32 v19, v19, v251
    v_accvgpr_write_b32 a123, v19
    v_accvgpr_read_b32 v18, a124
    v_mul_f32 v18, v18, v248
    v_accvgpr_write_b32 a124, v18
    v_accvgpr_read_b32 v19, a125
    v_mul_f32 v19, v19, v249
    v_accvgpr_write_b32 a125, v19
    v_accvgpr_read_b32 v18, a126
    v_mul_f32 v18, v18, v250
    v_accvgpr_write_b32 a126, v18
    v_accvgpr_read_b32 v19, a127
    v_mul_f32 v19, v19, v251
    v_accvgpr_write_b32 a127, v19
    v_accvgpr_read_b32 v18, a128
    v_mul_f32 v18, v18, v248
    v_accvgpr_write_b32 a128, v18
    v_accvgpr_read_b32 v19, a129
    v_mul_f32 v19, v19, v249
    v_accvgpr_write_b32 a129, v19
    v_accvgpr_read_b32 v18, a130
    v_mul_f32 v18, v18, v250
    v_accvgpr_write_b32 a130, v18
    v_accvgpr_read_b32 v19, a131
    v_mul_f32 v19, v19, v251
    v_accvgpr_write_b32 a131, v19
    v_accvgpr_read_b32 v18, a132
    v_mul_f32 v18, v18, v248
    v_accvgpr_write_b32 a132, v18
    v_accvgpr_read_b32 v19, a133
    v_mul_f32 v19, v19, v249
    v_accvgpr_write_b32 a133, v19
    v_accvgpr_read_b32 v18, a134
    v_mul_f32 v18, v18, v250
    v_accvgpr_write_b32 a134, v18
    v_accvgpr_read_b32 v19, a135
    v_mul_f32 v19, v19, v251
    v_accvgpr_write_b32 a135, v19
    v_accvgpr_read_b32 v18, a136
    v_mul_f32 v18, v18, v248
    v_accvgpr_write_b32 a136, v18
    v_accvgpr_read_b32 v19, a137
    v_mul_f32 v19, v19, v249
    v_accvgpr_write_b32 a137, v19
    v_accvgpr_read_b32 v18, a138
    v_mul_f32 v18, v18, v250
    v_accvgpr_write_b32 a138, v18
    v_accvgpr_read_b32 v19, a139
    v_mul_f32 v19, v19, v251
    v_accvgpr_write_b32 a139, v19
    v_accvgpr_read_b32 v18, a140
    v_mul_f32 v18, v18, v248
    v_accvgpr_write_b32 a140, v18
    v_accvgpr_read_b32 v19, a141
    v_mul_f32 v19, v19, v249
    v_accvgpr_write_b32 a141, v19
    v_accvgpr_read_b32 v18, a142
    v_mul_f32 v18, v18, v250
    v_accvgpr_write_b32 a142, v18
    v_accvgpr_read_b32 v19, a143
    v_mul_f32 v19, v19, v251
    v_accvgpr_write_b32 a143, v19
    v_max3_f32 v16, v184, v185, v186
    v_max3_f32 v16, v16, v187, v188
    v_max3_f32 v16, v16, v189, v190
    v_max3_f32 v16, v16, v191, v243
    v_mov_b32 v17, v16
    s_nop 1
    v_permlane16_swap_b32 v16, v17
    s_nop 1
    v_max_f32 v16, v16, v17
    v_mov_b32 v17, v16
    s_nop 1
    v_permlane32_swap_b32 v16, v17
    s_nop 1
    v_max_f32 v16, v16, v17
    v_sub_f32 v17, v243, v16
    v_exp_f32 v17, v17
    v_mov_b32 v243, v16
    v_sub_f32 v184, v184, v16
    v_sub_f32 v185, v185, v16
    v_sub_f32 v186, v186, v16
    v_sub_f32 v187, v187, v16
    v_sub_f32 v188, v188, v16
    v_sub_f32 v189, v189, v16
    v_sub_f32 v190, v190, v16
    v_sub_f32 v191, v191, v16
    v_exp_f32 v184, v184
    v_exp_f32 v185, v185
    v_exp_f32 v186, v186
    v_exp_f32 v187, v187
    v_exp_f32 v188, v188
    v_exp_f32 v189, v189
    v_exp_f32 v190, v190
    v_exp_f32 v191, v191
    v_mul_f32 v8, v8, v17
    v_add_f32 v8, v8, v184
    v_add_f32 v8, v8, v185
    v_add_f32 v8, v8, v186
    v_add_f32 v8, v8, v187
    v_add_f32 v8, v8, v188
    v_add_f32 v8, v8, v189
    v_add_f32 v8, v8, v190
    v_add_f32 v8, v8, v191
    v_cvt_pk_bf16_f32 v236, v184, v185
    v_cvt_pk_bf16_f32 v237, v186, v187
    v_cvt_pk_bf16_f32 v238, v188, v189
    v_cvt_pk_bf16_f32 v239, v190, v191
    ds_bpermute_b32 v248, v58, v17 offset:0
    ds_bpermute_b32 v249, v58, v17 offset:4
    ds_bpermute_b32 v250, v58, v17 offset:8
    ds_bpermute_b32 v251, v58, v17 offset:12
    s_waitcnt lgkmcnt(0)
    v_accvgpr_read_b32 v18, a144
    v_mul_f32 v18, v18, v248
    v_accvgpr_write_b32 a144, v18
    v_accvgpr_read_b32 v19, a145
    v_mul_f32 v19, v19, v249
    v_accvgpr_write_b32 a145, v19
    v_accvgpr_read_b32 v18, a146
    v_mul_f32 v18, v18, v250
    v_accvgpr_write_b32 a146, v18
    v_accvgpr_read_b32 v19, a147
    v_mul_f32 v19, v19, v251
    v_accvgpr_write_b32 a147, v19
    v_accvgpr_read_b32 v18, a148
    v_mul_f32 v18, v18, v248
    v_accvgpr_write_b32 a148, v18
    v_accvgpr_read_b32 v19, a149
    v_mul_f32 v19, v19, v249
    v_accvgpr_write_b32 a149, v19
    v_accvgpr_read_b32 v18, a150
    v_mul_f32 v18, v18, v250
    v_accvgpr_write_b32 a150, v18
    v_accvgpr_read_b32 v19, a151
    v_mul_f32 v19, v19, v251
    v_accvgpr_write_b32 a151, v19
    v_accvgpr_read_b32 v18, a152
    v_mul_f32 v18, v18, v248
    v_accvgpr_write_b32 a152, v18
    v_accvgpr_read_b32 v19, a153
    v_mul_f32 v19, v19, v249
    v_accvgpr_write_b32 a153, v19
    v_accvgpr_read_b32 v18, a154
    v_mul_f32 v18, v18, v250
    v_accvgpr_write_b32 a154, v18
    v_accvgpr_read_b32 v19, a155
    v_mul_f32 v19, v19, v251
    v_accvgpr_write_b32 a155, v19
    v_accvgpr_read_b32 v18, a156
    v_mul_f32 v18, v18, v248
    v_accvgpr_write_b32 a156, v18
    v_accvgpr_read_b32 v19, a157
    v_mul_f32 v19, v19, v249
    v_accvgpr_write_b32 a157, v19
    v_accvgpr_read_b32 v18, a158
    v_mul_f32 v18, v18, v250
    v_accvgpr_write_b32 a158, v18
    v_accvgpr_read_b32 v19, a159
    v_mul_f32 v19, v19, v251
    v_accvgpr_write_b32 a159, v19
    v_accvgpr_read_b32 v18, a160
    v_mul_f32 v18, v18, v248
    v_accvgpr_write_b32 a160, v18
    v_accvgpr_read_b32 v19, a161
    v_mul_f32 v19, v19, v249
    v_accvgpr_write_b32 a161, v19
    v_accvgpr_read_b32 v18, a162
    v_mul_f32 v18, v18, v250
    v_accvgpr_write_b32 a162, v18
    v_accvgpr_read_b32 v19, a163
    v_mul_f32 v19, v19, v251
    v_accvgpr_write_b32 a163, v19
    v_accvgpr_read_b32 v18, a164
    v_mul_f32 v18, v18, v248
    v_accvgpr_write_b32 a164, v18
    v_accvgpr_read_b32 v19, a165
    v_mul_f32 v19, v19, v249
    v_accvgpr_write_b32 a165, v19
    v_accvgpr_read_b32 v18, a166
    v_mul_f32 v18, v18, v250
    v_accvgpr_write_b32 a166, v18
    v_accvgpr_read_b32 v19, a167
    v_mul_f32 v19, v19, v251
    v_accvgpr_write_b32 a167, v19
    v_accvgpr_read_b32 v18, a168
    v_mul_f32 v18, v18, v248
    v_accvgpr_write_b32 a168, v18
    v_accvgpr_read_b32 v19, a169
    v_mul_f32 v19, v19, v249
    v_accvgpr_write_b32 a169, v19
    v_accvgpr_read_b32 v18, a170
    v_mul_f32 v18, v18, v250
    v_accvgpr_write_b32 a170, v18
    v_accvgpr_read_b32 v19, a171
    v_mul_f32 v19, v19, v251
    v_accvgpr_write_b32 a171, v19
    v_accvgpr_read_b32 v18, a172
    v_mul_f32 v18, v18, v248
    v_accvgpr_write_b32 a172, v18
    v_accvgpr_read_b32 v19, a173
    v_mul_f32 v19, v19, v249
    v_accvgpr_write_b32 a173, v19
    v_accvgpr_read_b32 v18, a174
    v_mul_f32 v18, v18, v250
    v_accvgpr_write_b32 a174, v18
    v_accvgpr_read_b32 v19, a175
    v_mul_f32 v19, v19, v251
    v_accvgpr_write_b32 a175, v19
    v_accvgpr_read_b32 v18, a176
    v_mul_f32 v18, v18, v248
    v_accvgpr_write_b32 a176, v18
    v_accvgpr_read_b32 v19, a177
    v_mul_f32 v19, v19, v249
    v_accvgpr_write_b32 a177, v19
    v_accvgpr_read_b32 v18, a178
    v_mul_f32 v18, v18, v250
    v_accvgpr_write_b32 a178, v18
    v_accvgpr_read_b32 v19, a179
    v_mul_f32 v19, v19, v251
    v_accvgpr_write_b32 a179, v19
    v_accvgpr_read_b32 v18, a180
    v_mul_f32 v18, v18, v248
    v_accvgpr_write_b32 a180, v18
    v_accvgpr_read_b32 v19, a181
    v_mul_f32 v19, v19, v249
    v_accvgpr_write_b32 a181, v19
    v_accvgpr_read_b32 v18, a182
    v_mul_f32 v18, v18, v250
    v_accvgpr_write_b32 a182, v18
    v_accvgpr_read_b32 v19, a183
    v_mul_f32 v19, v19, v251
    v_accvgpr_write_b32 a183, v19
    v_accvgpr_read_b32 v18, a184
    v_mul_f32 v18, v18, v248
    v_accvgpr_write_b32 a184, v18
    v_accvgpr_read_b32 v19, a185
    v_mul_f32 v19, v19, v249
    v_accvgpr_write_b32 a185, v19
    v_accvgpr_read_b32 v18, a186
    v_mul_f32 v18, v18, v250
    v_accvgpr_write_b32 a186, v18
    v_accvgpr_read_b32 v19, a187
    v_mul_f32 v19, v19, v251
    v_accvgpr_write_b32 a187, v19
    v_accvgpr_read_b32 v18, a188
    v_mul_f32 v18, v18, v248
    v_accvgpr_write_b32 a188, v18
    v_accvgpr_read_b32 v19, a189
    v_mul_f32 v19, v19, v249
    v_accvgpr_write_b32 a189, v19
    v_accvgpr_read_b32 v18, a190
    v_mul_f32 v18, v18, v250
    v_accvgpr_write_b32 a190, v18
    v_accvgpr_read_b32 v19, a191
    v_mul_f32 v19, v19, v251
    v_accvgpr_write_b32 a191, v19
    s_waitcnt vmcnt(0)
    s_nop 1
    v_mfma_f32_16x16x32_bf16 a[0:3], v[224:227], v[112:115], a[0:3]
    v_mfma_f32_16x16x32_bf16 a[48:51], v[228:231], v[112:115], a[48:51]
    v_mfma_f32_16x16x32_bf16 a[96:99], v[232:235], v[112:115], a[96:99]
    v_mfma_f32_16x16x32_bf16 a[144:147], v[236:239], v[112:115], a[144:147]
    v_mfma_f32_16x16x32_bf16 a[4:7], v[224:227], v[116:119], a[4:7]
    v_mfma_f32_16x16x32_bf16 a[52:55], v[228:231], v[116:119], a[52:55]
    v_mfma_f32_16x16x32_bf16 a[100:103], v[232:235], v[116:119], a[100:103]
    v_mfma_f32_16x16x32_bf16 a[148:151], v[236:239], v[116:119], a[148:151]
    v_mfma_f32_16x16x32_bf16 a[8:11], v[224:227], v[120:123], a[8:11]
    v_mfma_f32_16x16x32_bf16 a[56:59], v[228:231], v[120:123], a[56:59]
    v_mfma_f32_16x16x32_bf16 a[104:107], v[232:235], v[120:123], a[104:107]
    v_mfma_f32_16x16x32_bf16 a[152:155], v[236:239], v[120:123], a[152:155]
    v_mfma_f32_16x16x32_bf16 a[12:15], v[224:227], v[124:127], a[12:15]
    v_mfma_f32_16x16x32_bf16 a[60:63], v[228:231], v[124:127], a[60:63]
    v_mfma_f32_16x16x32_bf16 a[108:111], v[232:235], v[124:127], a[108:111]
    v_mfma_f32_16x16x32_bf16 a[156:159], v[236:239], v[124:127], a[156:159]
    v_mfma_f32_16x16x32_bf16 a[16:19], v[224:227], v[128:131], a[16:19]
    v_mfma_f32_16x16x32_bf16 a[64:67], v[228:231], v[128:131], a[64:67]
    v_mfma_f32_16x16x32_bf16 a[112:115], v[232:235], v[128:131], a[112:115]
    v_mfma_f32_16x16x32_bf16 a[160:163], v[236:239], v[128:131], a[160:163]
    v_mfma_f32_16x16x32_bf16 a[20:23], v[224:227], v[132:135], a[20:23]
    v_mfma_f32_16x16x32_bf16 a[68:71], v[228:231], v[132:135], a[68:71]
    v_mfma_f32_16x16x32_bf16 a[116:119], v[232:235], v[132:135], a[116:119]
    v_mfma_f32_16x16x32_bf16 a[164:167], v[236:239], v[132:135], a[164:167]
    v_mfma_f32_16x16x32_bf16 a[24:27], v[224:227], v[136:139], a[24:27]
    v_mfma_f32_16x16x32_bf16 a[72:75], v[228:231], v[136:139], a[72:75]
    v_mfma_f32_16x16x32_bf16 a[120:123], v[232:235], v[136:139], a[120:123]
    v_mfma_f32_16x16x32_bf16 a[168:171], v[236:239], v[136:139], a[168:171]
    v_mfma_f32_16x16x32_bf16 a[28:31], v[224:227], v[140:143], a[28:31]
    v_mfma_f32_16x16x32_bf16 a[76:79], v[228:231], v[140:143], a[76:79]
    v_mfma_f32_16x16x32_bf16 a[124:127], v[232:235], v[140:143], a[124:127]
    v_mfma_f32_16x16x32_bf16 a[172:175], v[236:239], v[140:143], a[172:175]
    v_mfma_f32_16x16x32_bf16 a[32:35], v[224:227], v[144:147], a[32:35]
    v_mfma_f32_16x16x32_bf16 a[80:83], v[228:231], v[144:147], a[80:83]
    v_mfma_f32_16x16x32_bf16 a[128:131], v[232:235], v[144:147], a[128:131]
    v_mfma_f32_16x16x32_bf16 a[176:179], v[236:239], v[144:147], a[176:179]
    v_mfma_f32_16x16x32_bf16 a[36:39], v[224:227], v[148:151], a[36:39]
    v_mfma_f32_16x16x32_bf16 a[84:87], v[228:231], v[148:151], a[84:87]
    v_mfma_f32_16x16x32_bf16 a[132:135], v[232:235], v[148:151], a[132:135]
    v_mfma_f32_16x16x32_bf16 a[180:183], v[236:239], v[148:151], a[180:183]
    v_mfma_f32_16x16x32_bf16 a[40:43], v[224:227], v[152:155], a[40:43]
    v_mfma_f32_16x16x32_bf16 a[88:91], v[228:231], v[152:155], a[88:91]
    v_mfma_f32_16x16x32_bf16 a[136:139], v[232:235], v[152:155], a[136:139]
    v_mfma_f32_16x16x32_bf16 a[184:187], v[236:239], v[152:155], a[184:187]
    v_mfma_f32_16x16x32_bf16 a[44:47], v[224:227], v[156:159], a[44:47]
    v_mfma_f32_16x16x32_bf16 a[92:95], v[228:231], v[156:159], a[92:95]
    v_mfma_f32_16x16x32_bf16 a[140:143], v[232:235], v[156:159], a[140:143]
    v_mfma_f32_16x16x32_bf16 a[188:191], v[236:239], v[156:159], a[188:191]
    s_add_u32 s48, s48, 24576
    s_cmp_lt_u32 s48, 1572864
    s_nop 7
    s_cbranch_scc1 L_slowloop
    v_mov_b32 v16, v5
    v_mov_b32 v17, v6
    s_nop 0
    v_permlane16_swap_b32 v5, v16
    v_permlane16_swap_b32 v6, v17
    s_nop 0
    v_add_f32 v5, v5, v16
    v_add_f32 v6, v6, v17
    v_mov_b32 v16, v5
    v_mov_b32 v17, v6
    s_nop 0
    v_permlane32_swap_b32 v5, v16
    v_permlane32_swap_b32 v6, v17
    s_nop 0
    v_add_f32 v5, v5, v16
    v_add_f32 v6, v6, v17
    v_rcp_f32 v16, v5
    v_rcp_f32 v17, v6
    s_nop 0
    ds_bpermute_b32 v48, v58, v16 offset:0
    ds_bpermute_b32 v49, v58, v16 offset:4
    ds_bpermute_b32 v50, v58, v16 offset:8
    ds_bpermute_b32 v51, v58, v16 offset:12
    ds_bpermute_b32 v52, v58, v17 offset:0
    ds_bpermute_b32 v53, v58, v17 offset:4
    ds_bpermute_b32 v54, v58, v17 offset:8
    ds_bpermute_b32 v55, v58, v17 offset:12
    v_mov_b32 v16, v7
    v_mov_b32 v17, v8
    s_nop 0
    v_permlane16_swap_b32 v7, v16
    v_permlane16_swap_b32 v8, v17
    s_nop 0
    v_add_f32 v7, v7, v16
    v_add_f32 v8, v8, v17
    v_mov_b32 v16, v7
    v_mov_b32 v17, v8
    s_nop 0
    v_permlane32_swap_b32 v7, v16
    v_permlane32_swap_b32 v8, v17
    s_nop 0
    v_add_f32 v7, v7, v16
    v_add_f32 v8, v8, v17
    v_rcp_f32 v16, v7
    v_rcp_f32 v17, v8
    s_nop 0
    ds_bpermute_b32 v128, v58, v16 offset:0
    ds_bpermute_b32 v129, v58, v16 offset:4
    ds_bpermute_b32 v130, v58, v16 offset:8
    ds_bpermute_b32 v131, v58, v16 offset:12
    ds_bpermute_b32 v132, v58, v17 offset:0
    ds_bpermute_b32 v133, v58, v17 offset:4
    ds_bpermute_b32 v134, v58, v17 offset:8
    ds_bpermute_b32 v135, v58, v17 offset:12
    v_accvgpr_read_b32 v64, a0
    v_accvgpr_read_b32 v65, a12
    v_accvgpr_read_b32 v66, a24
    v_accvgpr_read_b32 v67, a36
    s_waitcnt lgkmcnt(12)
    v_pk_mul_f32 v[64:65], v[64:65], v[48:49] op_sel_hi:[1,0]
    v_pk_mul_f32 v[66:67], v[66:67], v[48:49] op_sel_hi:[1,0]
    v_cvt_pk_bf16_f32 v64, v64, v65
    v_cvt_pk_bf16_f32 v65, v66, v67
    v_accvgpr_read_b32 v68, a1
    v_accvgpr_read_b32 v69, a13
    v_accvgpr_read_b32 v70, a25
    v_accvgpr_read_b32 v71, a37
    v_pk_mul_f32 v[68:69], v[68:69], v[48:49] op_sel:[0,1] op_sel_hi:[1,1]
    v_pk_mul_f32 v[70:71], v[70:71], v[48:49] op_sel:[0,1] op_sel_hi:[1,1]
    v_cvt_pk_bf16_f32 v68, v68, v69
    v_cvt_pk_bf16_f32 v69, v70, v71
    buffer_store_dwordx2 v[64:65], v56, s[12:15], s24 offen offset:0 sc0 sc1
    v_accvgpr_read_b32 v72, a2
    v_accvgpr_read_b32 v73, a14
    v_accvgpr_read_b32 v74, a26
    v_accvgpr_read_b32 v75, a38
    v_pk_mul_f32 v[72:73], v[72:73], v[50:51] op_sel_hi:[1,0]
    v_pk_mul_f32 v[74:75], v[74:75], v[50:51] op_sel_hi:[1,0]
    v_cvt_pk_bf16_f32 v72, v72, v73
    v_cvt_pk_bf16_f32 v73, v74, v75
    buffer_store_dwordx2 v[68:69], v56, s[12:15], s24 offen offset:384 sc0 sc1
    v_accvgpr_read_b32 v76, a3
    v_accvgpr_read_b32 v77, a15
    v_accvgpr_read_b32 v78, a27
    v_accvgpr_read_b32 v79, a39
    v_pk_mul_f32 v[76:77], v[76:77], v[50:51] op_sel:[0,1] op_sel_hi:[1,1]
    v_pk_mul_f32 v[78:79], v[78:79], v[50:51] op_sel:[0,1] op_sel_hi:[1,1]
    v_cvt_pk_bf16_f32 v76, v76, v77
    v_cvt_pk_bf16_f32 v77, v78, v79
    buffer_store_dwordx2 v[72:73], v56, s[12:15], s24 offen offset:768 sc0 sc1
    v_accvgpr_read_b32 v80, a4
    v_accvgpr_read_b32 v81, a16
    v_accvgpr_read_b32 v82, a28
    v_accvgpr_read_b32 v83, a40
    v_pk_mul_f32 v[80:81], v[80:81], v[48:49] op_sel_hi:[1,0]
    v_pk_mul_f32 v[82:83], v[82:83], v[48:49] op_sel_hi:[1,0]
    v_cvt_pk_bf16_f32 v80, v80, v81
    v_cvt_pk_bf16_f32 v81, v82, v83
    buffer_store_dwordx2 v[76:77], v56, s[12:15], s24 offen offset:1152 sc0 sc1
    v_accvgpr_read_b32 v84, a5
    v_accvgpr_read_b32 v85, a17
    v_accvgpr_read_b32 v86, a29
    v_accvgpr_read_b32 v87, a41
    v_pk_mul_f32 v[84:85], v[84:85], v[48:49] op_sel:[0,1] op_sel_hi:[1,1]
    v_pk_mul_f32 v[86:87], v[86:87], v[48:49] op_sel:[0,1] op_sel_hi:[1,1]
    v_cvt_pk_bf16_f32 v84, v84, v85
    v_cvt_pk_bf16_f32 v85, v86, v87
    buffer_store_dwordx2 v[80:81], v56, s[12:15], s24 offen offset:128 sc0 sc1
    v_accvgpr_read_b32 v88, a6
    v_accvgpr_read_b32 v89, a18
    v_accvgpr_read_b32 v90, a30
    v_accvgpr_read_b32 v91, a42
    v_pk_mul_f32 v[88:89], v[88:89], v[50:51] op_sel_hi:[1,0]
    v_pk_mul_f32 v[90:91], v[90:91], v[50:51] op_sel_hi:[1,0]
    v_cvt_pk_bf16_f32 v88, v88, v89
    v_cvt_pk_bf16_f32 v89, v90, v91
    buffer_store_dwordx2 v[84:85], v56, s[12:15], s24 offen offset:512 sc0 sc1
    v_accvgpr_read_b32 v92, a7
    v_accvgpr_read_b32 v93, a19
    v_accvgpr_read_b32 v94, a31
    v_accvgpr_read_b32 v95, a43
    v_pk_mul_f32 v[92:93], v[92:93], v[50:51] op_sel:[0,1] op_sel_hi:[1,1]
    v_pk_mul_f32 v[94:95], v[94:95], v[50:51] op_sel:[0,1] op_sel_hi:[1,1]
    v_cvt_pk_bf16_f32 v92, v92, v93
    v_cvt_pk_bf16_f32 v93, v94, v95
    buffer_store_dwordx2 v[88:89], v56, s[12:15], s24 offen offset:896 sc0 sc1
    v_accvgpr_read_b32 v96, a8
    v_accvgpr_read_b32 v97, a20
    v_accvgpr_read_b32 v98, a32
    v_accvgpr_read_b32 v99, a44
    v_pk_mul_f32 v[96:97], v[96:97], v[48:49] op_sel_hi:[1,0]
    v_pk_mul_f32 v[98:99], v[98:99], v[48:49] op_sel_hi:[1,0]
    v_cvt_pk_bf16_f32 v96, v96, v97
    v_cvt_pk_bf16_f32 v97, v98, v99
    buffer_store_dwordx2 v[92:93], v56, s[12:15], s24 offen offset:1280 sc0 sc1
    v_accvgpr_read_b32 v100, a9
    v_accvgpr_read_b32 v101, a21
    v_accvgpr_read_b32 v102, a33
    v_accvgpr_read_b32 v103, a45
    v_pk_mul_f32 v[100:101], v[100:101], v[48:49] op_sel:[0,1] op_sel_hi:[1,1]
    v_pk_mul_f32 v[102:103], v[102:103], v[48:49] op_sel:[0,1] op_sel_hi:[1,1]
    v_cvt_pk_bf16_f32 v100, v100, v101
    v_cvt_pk_bf16_f32 v101, v102, v103
    buffer_store_dwordx2 v[96:97], v56, s[12:15], s24 offen offset:256 sc0 sc1
    v_accvgpr_read_b32 v104, a10
    v_accvgpr_read_b32 v105, a22
    v_accvgpr_read_b32 v106, a34
    v_accvgpr_read_b32 v107, a46
    v_pk_mul_f32 v[104:105], v[104:105], v[50:51] op_sel_hi:[1,0]
    v_pk_mul_f32 v[106:107], v[106:107], v[50:51] op_sel_hi:[1,0]
    v_cvt_pk_bf16_f32 v104, v104, v105
    v_cvt_pk_bf16_f32 v105, v106, v107
    buffer_store_dwordx2 v[100:101], v56, s[12:15], s24 offen offset:640 sc0 sc1
    v_accvgpr_read_b32 v108, a11
    v_accvgpr_read_b32 v109, a23
    v_accvgpr_read_b32 v110, a35
    v_accvgpr_read_b32 v111, a47
    v_pk_mul_f32 v[108:109], v[108:109], v[50:51] op_sel:[0,1] op_sel_hi:[1,1]
    v_pk_mul_f32 v[110:111], v[110:111], v[50:51] op_sel:[0,1] op_sel_hi:[1,1]
    v_cvt_pk_bf16_f32 v108, v108, v109
    v_cvt_pk_bf16_f32 v109, v110, v111
    buffer_store_dwordx2 v[104:105], v56, s[12:15], s24 offen offset:1024 sc0 sc1
    v_accvgpr_read_b32 v112, a48
    v_accvgpr_read_b32 v113, a60
    v_accvgpr_read_b32 v114, a72
    v_accvgpr_read_b32 v115, a84
    s_waitcnt lgkmcnt(8)
    v_pk_mul_f32 v[112:113], v[112:113], v[52:53] op_sel_hi:[1,0]
    v_pk_mul_f32 v[114:115], v[114:115], v[52:53] op_sel_hi:[1,0]
    v_cvt_pk_bf16_f32 v112, v112, v113
    v_cvt_pk_bf16_f32 v113, v114, v115
    buffer_store_dwordx2 v[108:109], v56, s[12:15], s24 offen offset:1408 sc0 sc1
    v_accvgpr_read_b32 v116, a49
    v_accvgpr_read_b32 v117, a61
    v_accvgpr_read_b32 v118, a73
    v_accvgpr_read_b32 v119, a85
    v_pk_mul_f32 v[116:117], v[116:117], v[52:53] op_sel:[0,1] op_sel_hi:[1,1]
    v_pk_mul_f32 v[118:119], v[118:119], v[52:53] op_sel:[0,1] op_sel_hi:[1,1]
    v_cvt_pk_bf16_f32 v116, v116, v117
    v_cvt_pk_bf16_f32 v117, v118, v119
    buffer_store_dwordx2 v[112:113], v56, s[12:15], s40 offen offset:0 sc0 sc1
    v_accvgpr_read_b32 v120, a50
    v_accvgpr_read_b32 v121, a62
    v_accvgpr_read_b32 v122, a74
    v_accvgpr_read_b32 v123, a86
    v_pk_mul_f32 v[120:121], v[120:121], v[54:55] op_sel_hi:[1,0]
    v_pk_mul_f32 v[122:123], v[122:123], v[54:55] op_sel_hi:[1,0]
    v_cvt_pk_bf16_f32 v120, v120, v121
    v_cvt_pk_bf16_f32 v121, v122, v123
    buffer_store_dwordx2 v[116:117], v56, s[12:15], s40 offen offset:384 sc0 sc1
    v_accvgpr_read_b32 v124, a51
    v_accvgpr_read_b32 v125, a63
    v_accvgpr_read_b32 v126, a75
    v_accvgpr_read_b32 v127, a87
    v_pk_mul_f32 v[124:125], v[124:125], v[54:55] op_sel:[0,1] op_sel_hi:[1,1]
    v_pk_mul_f32 v[126:127], v[126:127], v[54:55] op_sel:[0,1] op_sel_hi:[1,1]
    v_cvt_pk_bf16_f32 v124, v124, v125
    v_cvt_pk_bf16_f32 v125, v126, v127
    buffer_store_dwordx2 v[120:121], v56, s[12:15], s40 offen offset:768 sc0 sc1
    v_accvgpr_read_b32 v64, a52
    v_accvgpr_read_b32 v65, a64
    v_accvgpr_read_b32 v66, a76
    v_accvgpr_read_b32 v67, a88
    v_pk_mul_f32 v[64:65], v[64:65], v[52:53] op_sel_hi:[1,0]
    v_pk_mul_f32 v[66:67], v[66:67], v[52:53] op_sel_hi:[1,0]
    v_cvt_pk_bf16_f32 v64, v64, v65
    v_cvt_pk_bf16_f32 v65, v66, v67
    buffer_store_dwordx2 v[124:125], v56, s[12:15], s40 offen offset:1152 sc0 sc1
    v_accvgpr_read_b32 v68, a53
    v_accvgpr_read_b32 v69, a65
    v_accvgpr_read_b32 v70, a77
    v_accvgpr_read_b32 v71, a89
    v_pk_mul_f32 v[68:69], v[68:69], v[52:53] op_sel:[0,1] op_sel_hi:[1,1]
    v_pk_mul_f32 v[70:71], v[70:71], v[52:53] op_sel:[0,1] op_sel_hi:[1,1]
    v_cvt_pk_bf16_f32 v68, v68, v69
    v_cvt_pk_bf16_f32 v69, v70, v71
    buffer_store_dwordx2 v[64:65], v56, s[12:15], s40 offen offset:128 sc0 sc1
    v_accvgpr_read_b32 v72, a54
    v_accvgpr_read_b32 v73, a66
    v_accvgpr_read_b32 v74, a78
    v_accvgpr_read_b32 v75, a90
    v_pk_mul_f32 v[72:73], v[72:73], v[54:55] op_sel_hi:[1,0]
    v_pk_mul_f32 v[74:75], v[74:75], v[54:55] op_sel_hi:[1,0]
    v_cvt_pk_bf16_f32 v72, v72, v73
    v_cvt_pk_bf16_f32 v73, v74, v75
    buffer_store_dwordx2 v[68:69], v56, s[12:15], s40 offen offset:512 sc0 sc1
    v_accvgpr_read_b32 v76, a55
    v_accvgpr_read_b32 v77, a67
    v_accvgpr_read_b32 v78, a79
    v_accvgpr_read_b32 v79, a91
    v_pk_mul_f32 v[76:77], v[76:77], v[54:55] op_sel:[0,1] op_sel_hi:[1,1]
    v_pk_mul_f32 v[78:79], v[78:79], v[54:55] op_sel:[0,1] op_sel_hi:[1,1]
    v_cvt_pk_bf16_f32 v76, v76, v77
    v_cvt_pk_bf16_f32 v77, v78, v79
    buffer_store_dwordx2 v[72:73], v56, s[12:15], s40 offen offset:896 sc0 sc1
    v_accvgpr_read_b32 v80, a56
    v_accvgpr_read_b32 v81, a68
    v_accvgpr_read_b32 v82, a80
    v_accvgpr_read_b32 v83, a92
    v_pk_mul_f32 v[80:81], v[80:81], v[52:53] op_sel_hi:[1,0]
    v_pk_mul_f32 v[82:83], v[82:83], v[52:53] op_sel_hi:[1,0]
    v_cvt_pk_bf16_f32 v80, v80, v81
    v_cvt_pk_bf16_f32 v81, v82, v83
    buffer_store_dwordx2 v[76:77], v56, s[12:15], s40 offen offset:1280 sc0 sc1
    v_accvgpr_read_b32 v84, a57
    v_accvgpr_read_b32 v85, a69
    v_accvgpr_read_b32 v86, a81
    v_accvgpr_read_b32 v87, a93
    v_pk_mul_f32 v[84:85], v[84:85], v[52:53] op_sel:[0,1] op_sel_hi:[1,1]
    v_pk_mul_f32 v[86:87], v[86:87], v[52:53] op_sel:[0,1] op_sel_hi:[1,1]
    v_cvt_pk_bf16_f32 v84, v84, v85
    v_cvt_pk_bf16_f32 v85, v86, v87
    buffer_store_dwordx2 v[80:81], v56, s[12:15], s40 offen offset:256 sc0 sc1
    v_accvgpr_read_b32 v88, a58
    v_accvgpr_read_b32 v89, a70
    v_accvgpr_read_b32 v90, a82
    v_accvgpr_read_b32 v91, a94
    v_pk_mul_f32 v[88:89], v[88:89], v[54:55] op_sel_hi:[1,0]
    v_pk_mul_f32 v[90:91], v[90:91], v[54:55] op_sel_hi:[1,0]
    v_cvt_pk_bf16_f32 v88, v88, v89
    v_cvt_pk_bf16_f32 v89, v90, v91
    buffer_store_dwordx2 v[84:85], v56, s[12:15], s40 offen offset:640 sc0 sc1
    v_accvgpr_read_b32 v92, a59
    v_accvgpr_read_b32 v93, a71
    v_accvgpr_read_b32 v94, a83
    v_accvgpr_read_b32 v95, a95
    v_pk_mul_f32 v[92:93], v[92:93], v[54:55] op_sel:[0,1] op_sel_hi:[1,1]
    v_pk_mul_f32 v[94:95], v[94:95], v[54:55] op_sel:[0,1] op_sel_hi:[1,1]
    v_cvt_pk_bf16_f32 v92, v92, v93
    v_cvt_pk_bf16_f32 v93, v94, v95
    buffer_store_dwordx2 v[88:89], v56, s[12:15], s40 offen offset:1024 sc0 sc1
    v_accvgpr_read_b32 v96, a96
    v_accvgpr_read_b32 v97, a108
    v_accvgpr_read_b32 v98, a120
    v_accvgpr_read_b32 v99, a132
    s_waitcnt lgkmcnt(4)
    v_pk_mul_f32 v[96:97], v[96:97], v[128:129] op_sel_hi:[1,0]
    v_pk_mul_f32 v[98:99], v[98:99], v[128:129] op_sel_hi:[1,0]
    v_cvt_pk_bf16_f32 v96, v96, v97
    v_cvt_pk_bf16_f32 v97, v98, v99
    buffer_store_dwordx2 v[92:93], v56, s[12:15], s40 offen offset:1408 sc0 sc1
    v_accvgpr_read_b32 v100, a97
    v_accvgpr_read_b32 v101, a109
    v_accvgpr_read_b32 v102, a121
    v_accvgpr_read_b32 v103, a133
    v_pk_mul_f32 v[100:101], v[100:101], v[128:129] op_sel:[0,1] op_sel_hi:[1,1]
    v_pk_mul_f32 v[102:103], v[102:103], v[128:129] op_sel:[0,1] op_sel_hi:[1,1]
    v_cvt_pk_bf16_f32 v100, v100, v101
    v_cvt_pk_bf16_f32 v101, v102, v103
    buffer_store_dwordx2 v[96:97], v56, s[12:15], s41 offen offset:0 sc0 sc1
    v_accvgpr_read_b32 v104, a98
    v_accvgpr_read_b32 v105, a110
    v_accvgpr_read_b32 v106, a122
    v_accvgpr_read_b32 v107, a134
    v_pk_mul_f32 v[104:105], v[104:105], v[130:131] op_sel_hi:[1,0]
    v_pk_mul_f32 v[106:107], v[106:107], v[130:131] op_sel_hi:[1,0]
    v_cvt_pk_bf16_f32 v104, v104, v105
    v_cvt_pk_bf16_f32 v105, v106, v107
    buffer_store_dwordx2 v[100:101], v56, s[12:15], s41 offen offset:384 sc0 sc1
    v_accvgpr_read_b32 v108, a99
    v_accvgpr_read_b32 v109, a111
    v_accvgpr_read_b32 v110, a123
    v_accvgpr_read_b32 v111, a135
    v_pk_mul_f32 v[108:109], v[108:109], v[130:131] op_sel:[0,1] op_sel_hi:[1,1]
    v_pk_mul_f32 v[110:111], v[110:111], v[130:131] op_sel:[0,1] op_sel_hi:[1,1]
    v_cvt_pk_bf16_f32 v108, v108, v109
    v_cvt_pk_bf16_f32 v109, v110, v111
    buffer_store_dwordx2 v[104:105], v56, s[12:15], s41 offen offset:768 sc0 sc1
    v_accvgpr_read_b32 v112, a100
    v_accvgpr_read_b32 v113, a112
    v_accvgpr_read_b32 v114, a124
    v_accvgpr_read_b32 v115, a136
    v_pk_mul_f32 v[112:113], v[112:113], v[128:129] op_sel_hi:[1,0]
    v_pk_mul_f32 v[114:115], v[114:115], v[128:129] op_sel_hi:[1,0]
    v_cvt_pk_bf16_f32 v112, v112, v113
    v_cvt_pk_bf16_f32 v113, v114, v115
    buffer_store_dwordx2 v[108:109], v56, s[12:15], s41 offen offset:1152 sc0 sc1
    v_accvgpr_read_b32 v116, a101
    v_accvgpr_read_b32 v117, a113
    v_accvgpr_read_b32 v118, a125
    v_accvgpr_read_b32 v119, a137
    v_pk_mul_f32 v[116:117], v[116:117], v[128:129] op_sel:[0,1] op_sel_hi:[1,1]
    v_pk_mul_f32 v[118:119], v[118:119], v[128:129] op_sel:[0,1] op_sel_hi:[1,1]
    v_cvt_pk_bf16_f32 v116, v116, v117
    v_cvt_pk_bf16_f32 v117, v118, v119
    buffer_store_dwordx2 v[112:113], v56, s[12:15], s41 offen offset:128 sc0 sc1
    v_accvgpr_read_b32 v120, a102
    v_accvgpr_read_b32 v121, a114
    v_accvgpr_read_b32 v122, a126
    v_accvgpr_read_b32 v123, a138
    v_pk_mul_f32 v[120:121], v[120:121], v[130:131] op_sel_hi:[1,0]
    v_pk_mul_f32 v[122:123], v[122:123], v[130:131] op_sel_hi:[1,0]
    v_cvt_pk_bf16_f32 v120, v120, v121
    v_cvt_pk_bf16_f32 v121, v122, v123
    buffer_store_dwordx2 v[116:117], v56, s[12:15], s41 offen offset:512 sc0 sc1
    v_accvgpr_read_b32 v124, a103
    v_accvgpr_read_b32 v125, a115
    v_accvgpr_read_b32 v126, a127
    v_accvgpr_read_b32 v127, a139
    v_pk_mul_f32 v[124:125], v[124:125], v[130:131] op_sel:[0,1] op_sel_hi:[1,1]
    v_pk_mul_f32 v[126:127], v[126:127], v[130:131] op_sel:[0,1] op_sel_hi:[1,1]
    v_cvt_pk_bf16_f32 v124, v124, v125
    v_cvt_pk_bf16_f32 v125, v126, v127
    buffer_store_dwordx2 v[120:121], v56, s[12:15], s41 offen offset:896 sc0 sc1
    v_accvgpr_read_b32 v64, a104
    v_accvgpr_read_b32 v65, a116
    v_accvgpr_read_b32 v66, a128
    v_accvgpr_read_b32 v67, a140
    v_pk_mul_f32 v[64:65], v[64:65], v[128:129] op_sel_hi:[1,0]
    v_pk_mul_f32 v[66:67], v[66:67], v[128:129] op_sel_hi:[1,0]
    v_cvt_pk_bf16_f32 v64, v64, v65
    v_cvt_pk_bf16_f32 v65, v66, v67
    buffer_store_dwordx2 v[124:125], v56, s[12:15], s41 offen offset:1280 sc0 sc1
    v_accvgpr_read_b32 v68, a105
    v_accvgpr_read_b32 v69, a117
    v_accvgpr_read_b32 v70, a129
    v_accvgpr_read_b32 v71, a141
    v_pk_mul_f32 v[68:69], v[68:69], v[128:129] op_sel:[0,1] op_sel_hi:[1,1]
    v_pk_mul_f32 v[70:71], v[70:71], v[128:129] op_sel:[0,1] op_sel_hi:[1,1]
    v_cvt_pk_bf16_f32 v68, v68, v69
    v_cvt_pk_bf16_f32 v69, v70, v71
    buffer_store_dwordx2 v[64:65], v56, s[12:15], s41 offen offset:256 sc0 sc1
    v_accvgpr_read_b32 v72, a106
    v_accvgpr_read_b32 v73, a118
    v_accvgpr_read_b32 v74, a130
    v_accvgpr_read_b32 v75, a142
    v_pk_mul_f32 v[72:73], v[72:73], v[130:131] op_sel_hi:[1,0]
    v_pk_mul_f32 v[74:75], v[74:75], v[130:131] op_sel_hi:[1,0]
    v_cvt_pk_bf16_f32 v72, v72, v73
    v_cvt_pk_bf16_f32 v73, v74, v75
    buffer_store_dwordx2 v[68:69], v56, s[12:15], s41 offen offset:640 sc0 sc1
    v_accvgpr_read_b32 v76, a107
    v_accvgpr_read_b32 v77, a119
    v_accvgpr_read_b32 v78, a131
    v_accvgpr_read_b32 v79, a143
    v_pk_mul_f32 v[76:77], v[76:77], v[130:131] op_sel:[0,1] op_sel_hi:[1,1]
    v_pk_mul_f32 v[78:79], v[78:79], v[130:131] op_sel:[0,1] op_sel_hi:[1,1]
    v_cvt_pk_bf16_f32 v76, v76, v77
    v_cvt_pk_bf16_f32 v77, v78, v79
    buffer_store_dwordx2 v[72:73], v56, s[12:15], s41 offen offset:1024 sc0 sc1
    v_accvgpr_read_b32 v80, a144
    v_accvgpr_read_b32 v81, a156
    v_accvgpr_read_b32 v82, a168
    v_accvgpr_read_b32 v83, a180
    s_waitcnt lgkmcnt(0)
    v_pk_mul_f32 v[80:81], v[80:81], v[132:133] op_sel_hi:[1,0]
    v_pk_mul_f32 v[82:83], v[82:83], v[132:133] op_sel_hi:[1,0]
    v_cvt_pk_bf16_f32 v80, v80, v81
    v_cvt_pk_bf16_f32 v81, v82, v83
    buffer_store_dwordx2 v[76:77], v56, s[12:15], s41 offen offset:1408 sc0 sc1
    v_accvgpr_read_b32 v84, a145
    v_accvgpr_read_b32 v85, a157
    v_accvgpr_read_b32 v86, a169
    v_accvgpr_read_b32 v87, a181
    v_pk_mul_f32 v[84:85], v[84:85], v[132:133] op_sel:[0,1] op_sel_hi:[1,1]
    v_pk_mul_f32 v[86:87], v[86:87], v[132:133] op_sel:[0,1] op_sel_hi:[1,1]
    v_cvt_pk_bf16_f32 v84, v84, v85
    v_cvt_pk_bf16_f32 v85, v86, v87
    buffer_store_dwordx2 v[80:81], v56, s[12:15], s42 offen offset:0 sc0 sc1
    v_accvgpr_read_b32 v88, a146
    v_accvgpr_read_b32 v89, a158
    v_accvgpr_read_b32 v90, a170
    v_accvgpr_read_b32 v91, a182
    v_pk_mul_f32 v[88:89], v[88:89], v[134:135] op_sel_hi:[1,0]
    v_pk_mul_f32 v[90:91], v[90:91], v[134:135] op_sel_hi:[1,0]
    v_cvt_pk_bf16_f32 v88, v88, v89
    v_cvt_pk_bf16_f32 v89, v90, v91
    buffer_store_dwordx2 v[84:85], v56, s[12:15], s42 offen offset:384 sc0 sc1
    v_accvgpr_read_b32 v92, a147
    v_accvgpr_read_b32 v93, a159
    v_accvgpr_read_b32 v94, a171
    v_accvgpr_read_b32 v95, a183
    v_pk_mul_f32 v[92:93], v[92:93], v[134:135] op_sel:[0,1] op_sel_hi:[1,1]
    v_pk_mul_f32 v[94:95], v[94:95], v[134:135] op_sel:[0,1] op_sel_hi:[1,1]
    v_cvt_pk_bf16_f32 v92, v92, v93
    v_cvt_pk_bf16_f32 v93, v94, v95
    buffer_store_dwordx2 v[88:89], v56, s[12:15], s42 offen offset:768 sc0 sc1
    v_accvgpr_read_b32 v96, a148
    v_accvgpr_read_b32 v97, a160
    v_accvgpr_read_b32 v98, a172
    v_accvgpr_read_b32 v99, a184
    v_pk_mul_f32 v[96:97], v[96:97], v[132:133] op_sel_hi:[1,0]
    v_pk_mul_f32 v[98:99], v[98:99], v[132:133] op_sel_hi:[1,0]
    v_cvt_pk_bf16_f32 v96, v96, v97
    v_cvt_pk_bf16_f32 v97, v98, v99
    buffer_store_dwordx2 v[92:93], v56, s[12:15], s42 offen offset:1152 sc0 sc1
    v_accvgpr_read_b32 v100, a149
    v_accvgpr_read_b32 v101, a161
    v_accvgpr_read_b32 v102, a173
    v_accvgpr_read_b32 v103, a185
    v_pk_mul_f32 v[100:101], v[100:101], v[132:133] op_sel:[0,1] op_sel_hi:[1,1]
    v_pk_mul_f32 v[102:103], v[102:103], v[132:133] op_sel:[0,1] op_sel_hi:[1,1]
    v_cvt_pk_bf16_f32 v100, v100, v101
    v_cvt_pk_bf16_f32 v101, v102, v103
    buffer_store_dwordx2 v[96:97], v56, s[12:15], s42 offen offset:128 sc0 sc1
    v_accvgpr_read_b32 v104, a150
    v_accvgpr_read_b32 v105, a162
    v_accvgpr_read_b32 v106, a174
    v_accvgpr_read_b32 v107, a186
    v_pk_mul_f32 v[104:105], v[104:105], v[134:135] op_sel_hi:[1,0]
    v_pk_mul_f32 v[106:107], v[106:107], v[134:135] op_sel_hi:[1,0]
    v_cvt_pk_bf16_f32 v104, v104, v105
    v_cvt_pk_bf16_f32 v105, v106, v107
    buffer_store_dwordx2 v[100:101], v56, s[12:15], s42 offen offset:512 sc0 sc1
    v_accvgpr_read_b32 v108, a151
    v_accvgpr_read_b32 v109, a163
    v_accvgpr_read_b32 v110, a175
    v_accvgpr_read_b32 v111, a187
    v_pk_mul_f32 v[108:109], v[108:109], v[134:135] op_sel:[0,1] op_sel_hi:[1,1]
    v_pk_mul_f32 v[110:111], v[110:111], v[134:135] op_sel:[0,1] op_sel_hi:[1,1]
    v_cvt_pk_bf16_f32 v108, v108, v109
    v_cvt_pk_bf16_f32 v109, v110, v111
    buffer_store_dwordx2 v[104:105], v56, s[12:15], s42 offen offset:896 sc0 sc1
    v_accvgpr_read_b32 v112, a152
    v_accvgpr_read_b32 v113, a164
    v_accvgpr_read_b32 v114, a176
    v_accvgpr_read_b32 v115, a188
    v_pk_mul_f32 v[112:113], v[112:113], v[132:133] op_sel_hi:[1,0]
    v_pk_mul_f32 v[114:115], v[114:115], v[132:133] op_sel_hi:[1,0]
    v_cvt_pk_bf16_f32 v112, v112, v113
    v_cvt_pk_bf16_f32 v113, v114, v115
    buffer_store_dwordx2 v[108:109], v56, s[12:15], s42 offen offset:1280 sc0 sc1
    v_accvgpr_read_b32 v116, a153
    v_accvgpr_read_b32 v117, a165
    v_accvgpr_read_b32 v118, a177
    v_accvgpr_read_b32 v119, a189
    v_pk_mul_f32 v[116:117], v[116:117], v[132:133] op_sel:[0,1] op_sel_hi:[1,1]
    v_pk_mul_f32 v[118:119], v[118:119], v[132:133] op_sel:[0,1] op_sel_hi:[1,1]
    v_cvt_pk_bf16_f32 v116, v116, v117
    v_cvt_pk_bf16_f32 v117, v118, v119
    buffer_store_dwordx2 v[112:113], v56, s[12:15], s42 offen offset:256 sc0 sc1
    v_accvgpr_read_b32 v120, a154
    v_accvgpr_read_b32 v121, a166
    v_accvgpr_read_b32 v122, a178
    v_accvgpr_read_b32 v123, a190
    v_pk_mul_f32 v[120:121], v[120:121], v[134:135] op_sel_hi:[1,0]
    v_pk_mul_f32 v[122:123], v[122:123], v[134:135] op_sel_hi:[1,0]
    v_cvt_pk_bf16_f32 v120, v120, v121
    v_cvt_pk_bf16_f32 v121, v122, v123
    buffer_store_dwordx2 v[116:117], v56, s[12:15], s42 offen offset:640 sc0 sc1
    v_accvgpr_read_b32 v124, a155
    v_accvgpr_read_b32 v125, a167
    v_accvgpr_read_b32 v126, a179
    v_accvgpr_read_b32 v127, a191
    v_pk_mul_f32 v[124:125], v[124:125], v[134:135] op_sel:[0,1] op_sel_hi:[1,1]
    v_pk_mul_f32 v[126:127], v[126:127], v[134:135] op_sel:[0,1] op_sel_hi:[1,1]
    v_cvt_pk_bf16_f32 v124, v124, v125
    v_cvt_pk_bf16_f32 v125, v126, v127
    buffer_store_dwordx2 v[120:121], v56, s[12:15], s42 offen offset:1024 sc0 sc1
    buffer_store_dwordx2 v[124:125], v56, s[12:15], s42 offen offset:1408 sc0 sc1
    s_branch L_fin
.section .rodata,"a"
.p2align 6
.amdhsa_kernel standalone__kv_cache_quant_int4_int2_kv_with_per_channel_or_per_token_scales__prompt_kernel
  .amdhsa_next_free_vgpr 512
  .amdhsa_next_free_sgpr 102
  .amdhsa_accum_offset 256
  .amdhsa_group_segment_fixed_size 0
  .amdhsa_kernarg_size 80
  .amdhsa_user_sgpr_count 2
  .amdhsa_user_sgpr_kernarg_segment_ptr 1
  .amdhsa_system_sgpr_workgroup_id_x 1
.end_amdhsa_kernel
```

```asm
; @launch grid=(256,1,1) block=(256,1,1) lds=147584
.amdgcn_target "amdgcn-amd-amdhsa--gfx950"
.text
.globl standalone__kv_cache_quant_int4_int2_kv_with_per_channel_or_per_token_scales__prompt_kernel
.p2align 8
.type standalone__kv_cache_quant_int4_int2_kv_with_per_channel_or_per_token_scales__prompt_kernel,@function
standalone__kv_cache_quant_int4_int2_kv_with_per_channel_or_per_token_scales__prompt_kernel:
    s_cmp_ge_u32 s2, 256
    s_cbranch_scc1 L_done
    s_load_dwordx16 s[40:55], s[0:1], 0
    s_load_dwordx4 s[16:19], s[0:1], 64
    s_and_b32 s94, s2, 7
    s_lshr_b32 s95, s2, 3
    s_lshr_b32 s24, s95, 3
    s_lshl_b32 s94, s94, 2
    s_add_u32 s94, s94, s24
    s_and_b32 s95, s95, 7
    s_getpc_b64 s[60:61]
L_pc:
    s_sub_u32 s60, s60, L_pc-standalone__kv_cache_quant_int4_int2_kv_with_per_channel_or_per_token_scales__prompt_kernel
    s_subb_u32 s61, s61, 0
    s_mov_b32 s62, L_slow-standalone__kv_cache_quant_int4_int2_kv_with_per_channel_or_per_token_scales__prompt_kernel
    s_mov_b32 s63, 0x20000
    s_lshr_b32 s22, s2, 3
    s_lshl_b32 s22, s22, 12
    v_lshlrev_b32 v30, 4, v0
    buffer_load_dwordx4 v[128:131], v30, s[60:63], s22 offen
    v_lshrrev_b32 v24, 6, v0
    v_and_b32 v25, 63, v0
    v_readfirstlane_b32 s25, v24
    v_lshlrev_b32 v1, 4, v25
    v_mul_u32_u24 v26, 43, v25
    v_lshrrev_b32 v26, 10, v26
    v_mul_u32_u24 v27, 24, v26
    v_sub_u32 v27, v25, v27
    v_lshrrev_b32 v28, 1, v24
    v_and_b32 v29, 1, v24
    v_lshlrev_b32 v30, 4, v29
    v_lshl_add_u32 v30, v28, 2, v30
    v_add_u32 v30, v30, v26
    v_mul_u32_u24 v30, 768, v30
    v_lshrrev_b32 v48, 1, v26
    v_lshlrev_b32 v48, 30, v48
    v_lshl_add_u32 v30, v27, 4, v30
    v_or_b32 v9, v30, v48
    v_lshl_or_b32 v10, v27, 3, v48
    v_mul_u32_u24 v30, 6144, v24
    v_add3_u32 v12, v30, v1, v48
    s_mov_b32 s66, 1572864
    s_mov_b32 s67, 0x20000
    s_mov_b32 s70, 1572864
    s_mov_b32 s71, 0x20000
    s_mov_b32 s74, 12288
    s_mov_b32 s75, 0x20000
    s_mov_b32 s78, 12288
    s_mov_b32 s79, 0x20000
    s_mov_b32 s82, 4096
    s_mov_b32 s83, 0x20000
    s_mov_b32 s86, 4096
    s_mov_b32 s87, 0x20000
    s_mov_b32 s22, 64
    s_mov_b32 s23, 0x20000
    s_mul_i32 s33, s95, 24576
    s_add_u32 s34, s33, 6144
    s_mov_b32 s35, s33
    s_lshr_b32 s36, s95, 1
    s_mul_i32 s36, s36, 384
    s_lshl_b32 s37, s95, 6
    s_lshl_b32 s24, s25, 4
    s_add_u32 s37, s37, s24
    s_mul_i32 s24, s94, 1572864
    s_mul_i32 s56, s94, 12288
    s_lshl_b32 s57, s94, 12
    s_lshl_b32 s58, s94, 10
    s_add_u32 s58, s58, 51380320
    s_or_b32 s39, s95, s25
    s_waitcnt lgkmcnt(0)
    s_add_u32 s64, s42, s24
    s_addc_u32 s65, s43, 0
    s_add_u32 s72, s46, s56
    s_addc_u32 s73, s47, 0
    s_add_u32 s76, s48, s56
    s_addc_u32 s77, s49, 0
    buffer_load_dwordx4 v[224:227], v9, s[64:67], s33 offen offset:0 nt
    buffer_load_dwordx4 v[228:231], v9, s[64:67], s33 offen offset:1536 nt
    buffer_load_dwordx4 v[232:235], v9, s[64:67], s34 offen offset:0 nt
    buffer_load_dwordx4 v[236:239], v9, s[64:67], s34 offen offset:1536 nt
    buffer_load_dwordx2 v[32:33], v10, s[72:75], s36 offen offset:0
    buffer_load_dwordx2 v[34:35], v10, s[76:79], s36 offen offset:0
    buffer_load_dwordx2 v[36:37], v10, s[72:75], s36 offen offset:192
    buffer_load_dwordx2 v[38:39], v10, s[76:79], s36 offen offset:192
    s_add_u32 s20, s18, s58
    s_addc_u32 s21, s19, 0
    s_add_u32 s80, s50, s57
    s_addc_u32 s81, s51, 0
    s_add_u32 s84, s52, s57
    s_addc_u32 s85, s53, 0
    s_add_u32 s68, s44, s24
    s_addc_u32 s69, s45, 0
    s_mul_i32 s59, s94, 786432
    s_add_u32 s12, s54, s59
    s_addc_u32 s13, s55, 0
    s_add_u32 s8, s40, s59
    s_addc_u32 s9, s41, 0
    s_cmp_lg_u32 s39, 0
    s_cbranch_scc1 L_notleader0
    s_buffer_load_dwordx16 s[40:55], s[20:23], 0 glc
L_notleader0:
    buffer_load_dwordx4 v[240:243], v9, s[64:67], s33 offen offset:384 nt
    buffer_load_dwordx4 v[244:247], v9, s[64:67], s33 offen offset:1920 nt
    buffer_load_dwordx4 v[248:251], v9, s[64:67], s34 offen offset:384 nt
    buffer_load_dwordx4 v[252:255], v9, s[64:67], s34 offen offset:1920 nt
    s_add_u32 s4, s18, s24
    s_addc_u32 s5, s19, 0
    s_mov_b32 s6, 1572864
    s_mov_b32 s7, 0x20000
    s_mov_b32 s10, 786432
    s_mov_b32 s11, 0x20000
    s_mov_b32 s88, s16
    s_mov_b32 s89, s17
    s_add_u32 s16, s33, 3072
    s_add_u32 s17, s33, 6144
    s_mov_b32 s90, 256
    s_mov_b32 s91, 0x20000
    s_lshl_b32 s93, s94, 3
    s_cmp_lg_u32 s39, 0
    s_cbranch_scc1 L_notleader
    s_waitcnt lgkmcnt(0)
    s_mov_b32 s59, 1
    s_lshr_b32 s40, s40, 10
    s_min_u32 s40, s40, 31
    s_bitset1_b32 s59, s40
    s_lshr_b32 s41, s41, 10
    s_min_u32 s41, s41, 31
    s_bitset1_b32 s59, s41
    s_lshr_b32 s42, s42, 10
    s_min_u32 s42, s42, 31
    s_bitset1_b32 s59, s42
    s_lshr_b32 s43, s43, 10
    s_min_u32 s43, s43, 31
    s_bitset1_b32 s59, s43
    s_lshr_b32 s44, s44, 10
    s_min_u32 s44, s44, 31
    s_bitset1_b32 s59, s44
    s_lshr_b32 s45, s45, 10
    s_min_u32 s45, s45, 31
    s_bitset1_b32 s59, s45
    s_lshr_b32 s46, s46, 10
    s_min_u32 s46, s46, 31
    s_bitset1_b32 s59, s46
    s_lshr_b32 s47, s47, 10
    s_min_u32 s47, s47, 31
    s_bitset1_b32 s59, s47
    s_lshr_b32 s48, s48, 10
    s_min_u32 s48, s48, 31
    s_bitset1_b32 s59, s48
    s_lshr_b32 s49, s49, 10
    s_min_u32 s49, s49, 31
    s_bitset1_b32 s59, s49
    s_lshr_b32 s50, s50, 10
    s_min_u32 s50, s50, 31
    s_bitset1_b32 s59, s50
    s_lshr_b32 s51, s51, 10
    s_min_u32 s51, s51, 31
    s_bitset1_b32 s59, s51
    s_lshr_b32 s52, s52, 10
    s_min_u32 s52, s52, 31
    s_bitset1_b32 s59, s52
    s_lshr_b32 s53, s53, 10
    s_min_u32 s53, s53, 31
    s_bitset1_b32 s59, s53
    s_lshr_b32 s54, s54, 10
    s_min_u32 s54, s54, 31
    s_bitset1_b32 s59, s54
    s_lshr_b32 s55, s55, 10
    s_min_u32 s55, s55, 31
    s_bitset1_b32 s59, s55
    s_ff0_i32_b32 s59, s59
    s_lshl_b32 s59, s59, 10
    v_mov_b32 v52, s59
    s_mov_b64 exec, 1
    buffer_store_dword v52, off, s[88:91], s93 sc1
    s_mov_b64 exec, -1
L_notleader:
    s_lshl_b32 s24, s95, 2
    s_add_u32 s24, s24, 32
    s_buffer_load_dword s46, s[20:23], s24 glc
    s_getreg_b32 s45, hwreg(HW_REG_XCC_ID, 0, 4)
    s_lshl_b32 s45, s45, 5
    s_mov_b32 s44, 0
    buffer_load_dwordx4 v[112:115], v12, s[68:71], s35 offen offset:0 nt
    buffer_load_dwordx4 v[116:119], v12, s[68:71], s35 offen offset:768 nt
    buffer_load_dwordx4 v[120:123], v12, s[68:71], s35 offen offset:1536 nt
    buffer_load_dwordx4 v[124:127], v12, s[68:71], s35 offen offset:2304 nt
    buffer_load_dwordx2 v[40:41], off, s[80:83], s37 offset:0
    buffer_load_dwordx2 v[42:43], off, s[84:87], s37 offset:0
    buffer_load_dwordx2 v[44:45], off, s[80:83], s37 offset:8
    buffer_load_dwordx2 v[46:47], off, s[84:87], s37 offset:8
    s_mov_b32 s14, 786432
    s_mov_b32 s15, 0x20000
    s_lshl_b32 s24, s25, 8
    s_add_u32 s93, s93, s24
    v_mul_u32_u24 v30, 3072, v24
    v_add_u32 v4, v30, v1
    v_lshl_add_u32 v30, v24, 3, v26
    v_mul_u32_u24 v30, 384, v30
    v_lshlrev_b32 v31, 2, v29
    v_xor_b32 v31, v27, v31
    v_lshl_add_u32 v30, v31, 4, v30
    v_or_b32 v11, v30, v48
    v_lshlrev_b32 v30, 8, v24
    v_add_u32 v30, 12288, v30
    v_lshrrev_b32 v31, 4, v25
    v_lshl_add_u32 v30, v31, 10, v30
    v_and_b32 v31, 15, v25
    v_lshl_add_u32 v30, v31, 4, v30
    v_or_b32 v20, v30, v48
    s_lshl_b32 s24, s95, 2
    v_lshl_add_u32 v13, v0, 2, s24
    v_cmp_lt_u32 vcc, 0, v0
    v_mov_b32 v30, 0x40000000
    s_nop 0
    v_cndmask_b32 v13, v13, v30, vcc
    s_mul_i32 s26, s25, 3072
    s_add_u32 s26, s26, 12288
    s_add_u32 s56, s26, 24576
    s_add_u32 s24, s95, 1
    s_and_b32 s24, s24, 7
    s_mul_i32 s32, s24, 24576
    s_add_u32 s27, s32, 12288
    s_mov_b32 s28, 98304
    s_mov_b32 s30, 73728
    v_add_u32 v1, 24576, v1
    s_mov_b32 s38, 0x3dd53b95
    s_mov_b32 s97, 0xffff0000
    s_mov_b32 s96, 100000
    v_and_b32 v26, 15, v25
    v_lshrrev_b32 v27, 4, v25
    v_bfe_u32 v28, v25, 1, 3
    v_xor_b32 v29, v27, v28
    v_mul_u32_u24 v30, 384, v26
    v_lshl_add_u32 v2, v29, 4, v30
    v_xor_b32 v3, 64, v2
    s_mul_i32 s40, s25, 6144
    s_add_u32 s40, s40, 73728
    v_lshrrev_b32 v29, 1, v27
    v_xor_b32 v29, v29, v28
    v_lshl_add_u32 v31, v29, 4, v30
    v_and_b32 v29, 1, v27
    v_lshl_add_u32 v31, v29, 3, v31
    v_xor_b32 v22, 0, v31
    v_add_u32 v22, s40, v22
    v_xor_b32 v23, 32, v31
    v_add_u32 v23, s40, v23
    v_xor_b32 v142, 64, v31
    v_add_u32 v142, s40, v142
    v_xor_b32 v143, 96, v31
    v_add_u32 v143, s40, v143
    s_lshl_b32 s24, s95, 2
    s_add_u32 s24, s24, s25
    s_mul_i32 s24, s24, 24576
    v_add_u32 v26, 0, v25
    v_mul_u32_u24 v27, 2731, v26
    v_lshrrev_b32 v27, 17, v27
    v_and_b32 v27, 7, v27
    v_xor_b32 v26, v26, v27
    v_lshlrev_b32 v136, 4, v26
    v_add_u32 v136, s24, v136
    v_add_u32 v26, 64, v25
    v_mul_u32_u24 v27, 2731, v26
    v_lshrrev_b32 v27, 17, v27
    v_and_b32 v27, 7, v27
    v_xor_b32 v26, v26, v27
    v_lshlrev_b32 v137, 4, v26
    v_add_u32 v137, s24, v137
    v_add_u32 v26, 128, v25
    v_mul_u32_u24 v27, 2731, v26
    v_lshrrev_b32 v27, 17, v27
    v_and_b32 v27, 7, v27
    v_xor_b32 v26, v26, v27
    v_lshlrev_b32 v138, 4, v26
    v_add_u32 v138, s24, v138
    v_add_u32 v26, 192, v25
    v_mul_u32_u24 v27, 2731, v26
    v_lshrrev_b32 v27, 17, v27
    v_and_b32 v27, 7, v27
    v_xor_b32 v26, v26, v27
    v_lshlrev_b32 v139, 4, v26
    v_add_u32 v139, s24, v139
    v_add_u32 v26, 256, v25
    v_mul_u32_u24 v27, 2731, v26
    v_lshrrev_b32 v27, 17, v27
    v_and_b32 v27, 7, v27
    v_xor_b32 v26, v26, v27
    v_lshlrev_b32 v140, 4, v26
    v_add_u32 v140, s24, v140
    v_add_u32 v26, 320, v25
    v_mul_u32_u24 v27, 2731, v26
    v_lshrrev_b32 v27, 17, v27
    v_and_b32 v27, 7, v27
    v_xor_b32 v26, v26, v27
    v_lshlrev_b32 v141, 4, v26
    v_add_u32 v141, s24, v141
    v_mov_b32 v5, 0
    v_mov_b32 v6, 0
    v_mov_b32 v7, 0
    v_mov_b32 v8, 0
    s_mov_b32 s62, -1
    s_mov_b32 s63, 0xffff
    s_waitcnt vmcnt(12)
    buffer_load_dwordx4 v[80:83], v12, s[68:71], s16 offen offset:0 nt
    buffer_load_dwordx4 v[84:87], v12, s[68:71], s16 offen offset:768 nt
    buffer_load_dwordx4 v[88:91], v12, s[68:71], s16 offen offset:1536 nt
    buffer_load_dwordx4 v[92:95], v12, s[68:71], s16 offen offset:2304 nt
    v_lshlrev_b32 v48, 16, v32
    v_and_b32 v49, s97, v32
    v_lshlrev_b32 v50, 16, v34
    v_and_b32 v51, s97, v34
    v_mul_f32 v48, s38, v48
    v_mul_f32 v49, s38, v49
    v_mul_f32_e64 v50, -v50, v48
    v_mul_f32_e64 v51, -v51, v49
    v_cvt_f32_i32 v224, v224
    v_cvt_f32_i32 v225, v225
    v_fma_f32 v224, v224, v48, v50
    v_fma_f32 v225, v225, v49, v51
    v_cvt_pk_bf16_f32 v224, v224, v225
    v_cvt_f32_i32 v228, v228
    v_cvt_f32_i32 v229, v229
    v_fma_f32 v228, v228, v48, v50
    v_fma_f32 v229, v229, v49, v51
    v_cvt_pk_bf16_f32 v228, v228, v229
    v_cvt_f32_i32 v232, v232
    v_cvt_f32_i32 v233, v233
    v_fma_f32 v232, v232, v48, v50
    v_fma_f32 v233, v233, v49, v51
    v_cvt_pk_bf16_f32 v232, v232, v233
    v_cvt_f32_i32 v236, v236
    v_cvt_f32_i32 v237, v237
    v_fma_f32 v236, v236, v48, v50
    v_fma_f32 v237, v237, v49, v51
    v_cvt_pk_bf16_f32 v236, v236, v237
    v_lshlrev_b32 v48, 16, v33
    v_and_b32 v49, s97, v33
    v_lshlrev_b32 v50, 16, v35
    v_and_b32 v51, s97, v35
    v_mul_f32 v48, s38, v48
    v_mul_f32 v49, s38, v49
    v_mul_f32_e64 v50, -v50, v48
    v_mul_f32_e64 v51, -v51, v49
    v_cvt_f32_i32 v226, v226
    v_cvt_f32_i32 v227, v227
    v_fma_f32 v226, v226, v48, v50
    v_fma_f32 v227, v227, v49, v51
    v_cvt_pk_bf16_f32 v225, v226, v227
    v_cvt_f32_i32 v230, v230
    v_cvt_f32_i32 v231, v231
    v_fma_f32 v230, v230, v48, v50
    v_fma_f32 v231, v231, v49, v51
    v_cvt_pk_bf16_f32 v229, v230, v231
    v_cvt_f32_i32 v234, v234
    v_cvt_f32_i32 v235, v235
    v_fma_f32 v234, v234, v48, v50
    v_fma_f32 v235, v235, v49, v51
    v_cvt_pk_bf16_f32 v233, v234, v235
    v_cvt_f32_i32 v238, v238
    v_cvt_f32_i32 v239, v239
    v_fma_f32 v238, v238, v48, v50
    v_fma_f32 v239, v239, v49, v51
    v_cvt_pk_bf16_f32 v237, v238, v239
    s_waitcnt vmcnt(12)
    v_lshlrev_b32 v48, 16, v36
    v_and_b32 v49, s97, v36
    v_lshlrev_b32 v50, 16, v38
    v_and_b32 v51, s97, v38
    v_mul_f32 v48, s38, v48
    v_mul_f32 v49, s38, v49
    v_mul_f32_e64 v50, -v50, v48
    v_mul_f32_e64 v51, -v51, v49
    v_cvt_f32_i32 v240, v240
    v_cvt_f32_i32 v241, v241
    v_fma_f32 v240, v240, v48, v50
    v_fma_f32 v241, v241, v49, v51
    v_cvt_pk_bf16_f32 v226, v240, v241
    v_cvt_f32_i32 v244, v244
    v_cvt_f32_i32 v245, v245
    v_fma_f32 v244, v244, v48, v50
    v_fma_f32 v245, v245, v49, v51
    v_cvt_pk_bf16_f32 v230, v244, v245
    v_cvt_f32_i32 v248, v248
    v_cvt_f32_i32 v249, v249
    v_fma_f32 v248, v248, v48, v50
    v_fma_f32 v249, v249, v49, v51
    v_cvt_pk_bf16_f32 v234, v248, v249
    v_cvt_f32_i32 v252, v252
    v_cvt_f32_i32 v253, v253
    v_fma_f32 v252, v252, v48, v50
    v_fma_f32 v253, v253, v49, v51
    v_cvt_pk_bf16_f32 v238, v252, v253
    v_lshlrev_b32 v48, 16, v37
    v_and_b32 v49, s97, v37
    v_lshlrev_b32 v50, 16, v39
    v_and_b32 v51, s97, v39
    v_mul_f32 v48, s38, v48
    v_mul_f32 v49, s38, v49
    v_mul_f32_e64 v50, -v50, v48
    v_mul_f32_e64 v51, -v51, v49
    v_cvt_f32_i32 v242, v242
    v_cvt_f32_i32 v243, v243
    v_fma_f32 v242, v242, v48, v50
    v_fma_f32 v243, v243, v49, v51
    v_cvt_pk_bf16_f32 v227, v242, v243
    v_cvt_f32_i32 v246, v246
    v_cvt_f32_i32 v247, v247
    v_fma_f32 v246, v246, v48, v50
    v_fma_f32 v247, v247, v49, v51
    v_cvt_pk_bf16_f32 v231, v246, v247
    v_cvt_f32_i32 v250, v250
    v_cvt_f32_i32 v251, v251
    v_fma_f32 v250, v250, v48, v50
    v_fma_f32 v251, v251, v49, v51
    v_cvt_pk_bf16_f32 v235, v250, v251
    v_cvt_f32_i32 v254, v254
    v_cvt_f32_i32 v255, v255
    v_fma_f32 v254, v254, v48, v50
    v_fma_f32 v255, v255, v49, v51
    v_cvt_pk_bf16_f32 v239, v254, v255
    buffer_store_dwordx4 v[224:227], v11, s[4:7], s33 offen offset:0
    s_mov_b64 exec, s[62:63]
    ds_write_b128 v11, v[224:227] offset:0
    s_mov_b64 exec, -1
    v_xor_b32 v55, 16, v11
    buffer_store_dwordx4 v[228:231], v55, s[4:7], s33 offen offset:768
    s_mov_b64 exec, s[62:63]
    ds_write_b128 v55, v[228:231] offset:768
    s_mov_b64 exec, -1
    v_xor_b32 v54, 32, v11
    buffer_store_dwordx4 v[232:235], v54, s[4:7], s33 offen offset:1536
    s_mov_b64 exec, s[62:63]
    ds_write_b128 v54, v[232:235] offset:1536
    s_mov_b64 exec, -1
    v_xor_b32 v55, 48, v11
    buffer_store_dwordx4 v[236:239], v55, s[4:7], s33 offen offset:2304
    s_mov_b64 exec, s[62:63]
    ds_write_b128 v55, v[236:239] offset:2304
    s_mov_b64 exec, -1
    s_mov_b32 s41, 0
    s_add_u32 m0, s40, 24576
    s_nop 0
    buffer_load_dwordx4 v136, s[8:11], s41 offen nt lds
    s_add_u32 m0, s40, 25600
    s_nop 0
    buffer_load_dwordx4 v137, s[8:11], s41 offen nt lds
    s_add_u32 m0, s40, 26624
    s_nop 0
    buffer_load_dwordx4 v138, s[8:11], s41 offen nt lds
    s_add_u32 m0, s40, 27648
    s_nop 0
    buffer_load_dwordx4 v139, s[8:11], s41 offen nt lds
    s_add_u32 m0, s40, 28672
    s_nop 0
    buffer_load_dwordx4 v140, s[8:11], s41 offen nt lds
    s_add_u32 m0, s40, 29696
    s_waitcnt vmcnt(20)
    buffer_load_dwordx4 v141, s[8:11], s41 offen nt lds
    s_waitcnt vmcnt(14)
    v_lshlrev_b32 v48, 16, v40
    v_and_b32 v49, s97, v40
    v_lshlrev_b32 v50, 16, v42
    v_and_b32 v51, s97, v42
    v_mul_f32_e64 v50, -v50, v48
    v_mul_f32_e64 v51, -v51, v49
    v_cvt_f32_i32 v112, v112
    v_cvt_f32_i32 v116, v116
    v_fma_f32 v112, v112, v48, v50
    v_fma_f32 v116, v116, v49, v51
    v_cvt_f32_i32 v113, v113
    v_cvt_f32_i32 v117, v117
    v_fma_f32 v113, v113, v48, v50
    v_fma_f32 v117, v117, v49, v51
    v_cvt_f32_i32 v114, v114
    v_cvt_f32_i32 v118, v118
    v_fma_f32 v114, v114, v48, v50
    v_fma_f32 v118, v118, v49, v51
    v_cvt_f32_i32 v115, v115
    v_cvt_f32_i32 v119, v119
    v_fma_f32 v115, v115, v48, v50
    v_fma_f32 v119, v119, v49, v51
    v_lshlrev_b32 v48, 16, v41
    v_and_b32 v49, s97, v41
    v_lshlrev_b32 v50, 16, v43
    v_and_b32 v51, s97, v43
    v_mul_f32_e64 v50, -v50, v48
    v_mul_f32_e64 v51, -v51, v49
    v_cvt_f32_i32 v120, v120
    v_cvt_f32_i32 v124, v124
    v_fma_f32 v120, v120, v48, v50
    v_fma_f32 v124, v124, v49, v51
    v_cvt_f32_i32 v121, v121
    v_cvt_f32_i32 v125, v125
    v_fma_f32 v121, v121, v48, v50
    v_fma_f32 v125, v125, v49, v51
    v_cvt_f32_i32 v122, v122
    v_cvt_f32_i32 v126, v126
    v_fma_f32 v122, v122, v48, v50
    v_fma_f32 v126, v126, v49, v51
    v_cvt_f32_i32 v123, v123
    v_cvt_f32_i32 v127, v127
    v_fma_f32 v123, v123, v48, v50
    v_fma_f32 v127, v127, v49, v51
    v_cvt_pk_bf16_f32 v112, v112, v116
    v_cvt_pk_bf16_f32 v116, v113, v117
    v_cvt_pk_bf16_f32 v113, v120, v124
    v_cvt_pk_bf16_f32 v117, v121, v125
    v_cvt_pk_bf16_f32 v120, v114, v118
    v_cvt_pk_bf16_f32 v121, v122, v126
    v_cvt_pk_bf16_f32 v124, v115, v119
    v_cvt_pk_bf16_f32 v125, v123, v127
    s_waitcnt vmcnt(10)
    v_lshlrev_b32 v48, 16, v44
    v_and_b32 v49, s97, v44
    v_lshlrev_b32 v50, 16, v46
    v_and_b32 v51, s97, v46
    v_mul_f32_e64 v50, -v50, v48
    v_mul_f32_e64 v51, -v51, v49
    v_cvt_f32_i32 v80, v80
    v_cvt_f32_i32 v84, v84
    v_fma_f32 v80, v80, v48, v50
    v_fma_f32 v84, v84, v49, v51
    v_cvt_f32_i32 v81, v81
    v_cvt_f32_i32 v85, v85
    v_fma_f32 v81, v81, v48, v50
    v_fma_f32 v85, v85, v49, v51
    v_cvt_f32_i32 v82, v82
    v_cvt_f32_i32 v86, v86
    v_fma_f32 v82, v82, v48, v50
    v_fma_f32 v86, v86, v49, v51
    v_cvt_f32_i32 v83, v83
    v_cvt_f32_i32 v87, v87
    v_fma_f32 v83, v83, v48, v50
    v_fma_f32 v87, v87, v49, v51
    v_lshlrev_b32 v48, 16, v45
    v_and_b32 v49, s97, v45
    v_lshlrev_b32 v50, 16, v47
    v_and_b32 v51, s97, v47
    v_mul_f32_e64 v50, -v50, v48
    v_mul_f32_e64 v51, -v51, v49
    v_cvt_f32_i32 v88, v88
    v_cvt_f32_i32 v92, v92
    v_fma_f32 v88, v88, v48, v50
    v_fma_f32 v92, v92, v49, v51
    v_cvt_f32_i32 v89, v89
    v_cvt_f32_i32 v93, v93
    v_fma_f32 v89, v89, v48, v50
    v_fma_f32 v93, v93, v49, v51
    v_cvt_f32_i32 v90, v90
    v_cvt_f32_i32 v94, v94
    v_fma_f32 v90, v90, v48, v50
    v_fma_f32 v94, v94, v49, v51
    v_cvt_f32_i32 v91, v91
    v_cvt_f32_i32 v95, v95
    v_fma_f32 v91, v91, v48, v50
    v_fma_f32 v95, v95, v49, v51
    v_cvt_pk_bf16_f32 v114, v80, v84
    v_cvt_pk_bf16_f32 v118, v81, v85
    v_cvt_pk_bf16_f32 v115, v88, v92
    v_cvt_pk_bf16_f32 v119, v89, v93
    v_cvt_pk_bf16_f32 v122, v82, v86
    v_cvt_pk_bf16_f32 v123, v90, v94
    v_cvt_pk_bf16_f32 v126, v83, v87
    v_cvt_pk_bf16_f32 v127, v91, v95
    buffer_store_dwordx4 v[112:115], v20, s[4:7], s35 offen offset:0
    buffer_store_dwordx4 v[116:119], v20, s[4:7], s35 offen offset:3072
    buffer_store_dwordx4 v[120:123], v20, s[4:7], s17 offen offset:0
    buffer_store_dwordx4 v[124:127], v20, s[4:7], s17 offen offset:3072
    s_mov_b64 exec, s[62:63]
    ds_write_b128 v20, v[112:115] offset:12288
    ds_write_b128 v20, v[116:119] offset:15360
    ds_write_b128 v20, v[120:123] offset:18432
    ds_write_b128 v20, v[124:127] offset:21504
    s_mov_b64 exec, -1
    buffer_load_dword v0, off, s[88:91], s93 sc1
    s_mov_b32 s41, 6144
    s_add_u32 m0, s40, 0
    s_nop 0
    buffer_load_dwordx4 v136, s[8:11], s41 offen nt lds
    s_add_u32 m0, s40, 1024
    s_nop 0
    buffer_load_dwordx4 v137, s[8:11], s41 offen nt lds
    s_add_u32 m0, s40, 2048
    s_nop 0
    buffer_load_dwordx4 v138, s[8:11], s41 offen nt lds
    s_add_u32 m0, s40, 3072
    s_nop 0
    buffer_load_dwordx4 v139, s[8:11], s41 offen nt lds
    s_add_u32 m0, s40, 4096
    s_nop 0
    buffer_load_dwordx4 v140, s[8:11], s41 offen nt lds
    s_add_u32 m0, s40, 5120
    s_waitcnt vmcnt(15)
    buffer_load_dwordx4 v141, s[8:11], s41 offen nt lds
    s_waitcnt vmcnt(6)
    s_cmp_lg_u32 s25, 0
    s_cbranch_scc1 L_tagdone
    v_readfirstlane_b32 s42, v0
    s_mov_b32 s39, 100
    s_waitcnt lgkmcnt(0)
    s_and_b32 s46, s46, 0xfffffc00
L_tagretry:
    s_cmp_eq_u32 s42, s46
    s_cselect_b32 s42, 0, s42
    s_cmp_lg_u32 s42, 0
    s_cbranch_scc1 L_tagok
    s_sub_u32 s39, s39, 1
    s_cbranch_scc1 L_tagslow
    s_sleep 4
    s_buffer_load_dword s42, s[88:91], s93 glc
    s_waitcnt lgkmcnt(0)
    s_branch L_tagretry
L_tagok:
    s_add_u32 s42, s42, s45
    v_mov_b32 v0, s42
    v_mov_b32 v16, 147456
    ds_write_b32 v16, v0
L_tagdone:
    s_waitcnt lgkmcnt(0)
    s_barrier
    v_add_u32 v0, 1, v0
    buffer_store_dword v0, v13, s[20:23], 0 offen
    buffer_store_dword v0, v13, s[20:23], 0 offen offset:32 sc1
    v_mov_b32 v16, 147456
    ds_read_b32 v17, v16
    s_mov_b32 s88, s60
    s_mov_b32 s89, s61
    s_mov_b32 s90, L_slow-standalone__kv_cache_quant_int4_int2_kv_with_per_channel_or_per_token_scales__prompt_kernel
    s_lshr_b32 s24, s2, 3
    s_mul_i32 s93, s24, 43
    s_lshr_b32 s93, s93, 7
    s_mul_i32 s39, s93, 3
    s_sub_u32 s24, s24, s39
    s_lshl_b32 s24, s24, 10
    s_mul_i32 s93, s93, 12288
    s_add_u32 s93, s93, s24
    ds_read_b128 v[144:147], v2 offset:0
    ds_read_b128 v[148:151], v3 offset:0
    ds_read_b128 v[152:155], v2 offset:6144
    ds_read_b128 v[156:159], v3 offset:6144
    ds_read_b128 v[160:163], v2 offset:128
    ds_read_b128 v[164:167], v3 offset:128
    ds_read_b128 v[168:171], v2 offset:6272
    ds_read_b128 v[172:175], v3 offset:6272
    ds_read_b128 v[176:179], v2 offset:256
    ds_read_b128 v[180:183], v3 offset:256
    ds_read_b128 v[184:187], v2 offset:6400
    ds_read_b128 v[188:191], v3 offset:6400
    s_waitcnt vmcnt(13)
    ds_read_b64 a[192:193], v22 offset:24576
    ds_read_b64 a[194:195], v142 offset:24704
    ds_read_b64 a[196:197], v23 offset:24576
    ds_read_b64 a[198:199], v143 offset:24704
    ds_read_b64 a[200:201], v142 offset:24576
    ds_read_b64 a[202:203], v22 offset:24832
    ds_read_b64 a[204:205], v143 offset:24576
    ds_read_b64 a[206:207], v23 offset:24832
    ds_read_b64 a[208:209], v22 offset:24704
    ds_read_b64 a[210:211], v142 offset:24832
    ds_read_b64 a[212:213], v23 offset:24704
    ds_read_b64 a[214:215], v143 offset:24832
    s_waitcnt lgkmcnt(15)
    v_readfirstlane_b32 s92, v17
    s_add_u32 s92, s92, 1
    s_mov_b32 s41, 12288
    s_add_u32 m0, s40, 49152
    s_nop 0
    buffer_load_dwordx4 v136, s[8:11], s41 offen nt lds
    s_add_u32 m0, s40, 50176
    s_nop 0
    buffer_load_dwordx4 v137, s[8:11], s41 offen nt lds
    s_add_u32 m0, s40, 51200
    s_nop 0
    buffer_load_dwordx4 v138, s[8:11], s41 offen nt lds
    s_waitcnt lgkmcnt(0)
    v_mfma_f32_16x16x32_bf16 v[64:67], v[144:147], a[192:195], 0
    v_mfma_f32_16x16x32_bf16 v[64:67], v[148:151], a[196:199], v[64:67]
    v_mfma_f32_16x16x32_bf16 v[64:67], v[160:163], a[200:203], v[64:67]
    v_mfma_f32_16x16x32_bf16 v[64:67], v[164:167], a[204:207], v[64:67]
    v_mfma_f32_16x16x32_bf16 v[64:67], v[176:179], a[208:211], v[64:67]
    v_mfma_f32_16x16x32_bf16 v[64:67], v[180:183], a[212:215], v[64:67]
    v_mfma_f32_16x16x32_bf16 v[96:99], v[152:155], a[192:195], 0
    v_mfma_f32_16x16x32_bf16 v[96:99], v[156:159], a[196:199], v[96:99]
    v_mfma_f32_16x16x32_bf16 v[96:99], v[168:171], a[200:203], v[96:99]
    v_mfma_f32_16x16x32_bf16 v[96:99], v[172:175], a[204:207], v[96:99]
    v_mfma_f32_16x16x32_bf16 v[96:99], v[184:187], a[208:211], v[96:99]
    v_mfma_f32_16x16x32_bf16 v[96:99], v[188:191], a[212:215], v[96:99]
    s_nop 7
    v_max3_f32 v48, v64, v65, v66
    v_max3_f32 v50, v67, v96, v97
    v_max3_f32 v48, v48, v98, v99
    v_max_f32 v48, v48, v50
    v_mov_b32 v49, v48
    s_nop 1
    v_permlane16_swap_b32 v48, v49
    s_nop 1
    v_max_f32 v48, v48, v49
    v_mov_b32 v49, v48
    s_nop 1
    v_permlane32_swap_b32 v48, v49
    s_nop 1
    v_max_f32 v48, v48, v49
    v_sub_f32 v64, v64, v48
    v_sub_f32 v65, v65, v48
    v_sub_f32 v66, v66, v48
    v_sub_f32 v67, v67, v48
    v_sub_f32 v96, v96, v48
    v_sub_f32 v97, v97, v48
    v_sub_f32 v98, v98, v48
    v_sub_f32 v99, v99, v48
    v_exp_f32 v64, v64
    v_exp_f32 v65, v65
    v_exp_f32 v66, v66
    v_exp_f32 v67, v67
    v_exp_f32 v96, v96
    v_exp_f32 v97, v97
    v_exp_f32 v98, v98
    v_exp_f32 v99, v99
    v_sub_f32 v128, 0, v48
    v_sub_f32 v129, 0, v48
    v_sub_f32 v130, 0, v48
    v_sub_f32 v131, 0, v48
    v_add_f32 v5, v5, v64
    v_add_f32 v5, v5, v65
    v_add_f32 v5, v5, v66
    v_add_f32 v5, v5, v67
    v_add_f32 v5, v5, v96
    v_add_f32 v5, v5, v97
    v_add_f32 v5, v5, v98
    v_add_f32 v5, v5, v99
    v_cvt_pk_bf16_f32 v64, v64, v65
    v_cvt_pk_bf16_f32 v65, v66, v67
    v_cvt_pk_bf16_f32 v66, v96, v97
    v_cvt_pk_bf16_f32 v67, v98, v99
    s_waitcnt vmcnt(5)
    ds_read_b64 a[216:217], v22 offset:0
    ds_read_b64 a[218:219], v142 offset:128
    ds_read_b64 a[220:221], v23 offset:0
    ds_read_b64 a[222:223], v143 offset:128
    ds_read_b64 a[224:225], v142 offset:0
    ds_read_b64 a[226:227], v22 offset:256
    ds_read_b64 a[228:229], v143 offset:0
    ds_read_b64 a[230:231], v23 offset:256
    ds_read_b64 a[232:233], v22 offset:128
    ds_read_b64 a[234:235], v142 offset:256
    ds_read_b64 a[236:237], v23 offset:128
    ds_read_b64 a[238:239], v143 offset:256
    s_mov_b32 s41, 12288
    s_add_u32 m0, s40, 52224
    s_nop 0
    buffer_load_dwordx4 v139, s[8:11], s41 offen nt lds
    s_add_u32 m0, s40, 53248
    s_nop 0
    buffer_load_dwordx4 v140, s[8:11], s41 offen nt lds
    s_add_u32 m0, s40, 54272
    s_nop 0
    buffer_load_dwordx4 v141, s[8:11], s41 offen nt lds
    s_waitcnt lgkmcnt(0)
    v_mfma_f32_16x16x32_bf16 v[68:71], v[144:147], a[216:219], 0
    v_mfma_f32_16x16x32_bf16 v[68:71], v[148:151], a[220:223], v[68:71]
    v_mfma_f32_16x16x32_bf16 v[68:71], v[160:163], a[224:227], v[68:71]
    v_mfma_f32_16x16x32_bf16 v[68:71], v[164:167], a[228:231], v[68:71]
    v_mfma_f32_16x16x32_bf16 v[68:71], v[176:179], a[232:235], v[68:71]
    v_mfma_f32_16x16x32_bf16 v[68:71], v[180:183], a[236:239], v[68:71]
    v_mfma_f32_16x16x32_bf16 v[100:103], v[152:155], a[216:219], 0
    v_mfma_f32_16x16x32_bf16 v[100:103], v[156:159], a[220:223], v[100:103]
    v_mfma_f32_16x16x32_bf16 v[100:103], v[168:171], a[224:227], v[100:103]
    v_mfma_f32_16x16x32_bf16 v[100:103], v[172:175], a[228:231], v[100:103]
    v_mfma_f32_16x16x32_bf16 v[100:103], v[184:187], a[232:235], v[100:103]
    v_mfma_f32_16x16x32_bf16 v[100:103], v[188:191], a[236:239], v[100:103]
    s_nop 7
    ds_read_b128 v[24:27], v1 offset:0
    ds_read_b128 v[28:31], v1 offset:1024
    ds_read_b128 v[32:35], v1 offset:2048
    ds_read_b128 v[36:39], v1 offset:3072
    s_mov_b32 s41, 18432
    s_add_u32 m0, s40, 24576
    s_nop 0
    buffer_load_dwordx4 v136, s[8:11], s41 offen nt lds
    v_max3_f32 v48, v68, v69, v70
    v_max3_f32 v50, v71, v100, v101
    v_max3_f32 v48, v48, v102, v103
    v_max_f32 v48, v48, v50
    v_mov_b32 v49, v48
    s_nop 1
    v_permlane16_swap_b32 v48, v49
    s_nop 1
    v_max_f32 v48, v48, v49
    v_mov_b32 v49, v48
    s_nop 1
    v_permlane32_swap_b32 v48, v49
    s_nop 1
    v_max_f32 v48, v48, v49
    v_sub_f32 v68, v68, v48
    v_sub_f32 v69, v69, v48
    s_add_u32 m0, s40, 25600
    s_nop 0
    buffer_load_dwordx4 v137, s[8:11], s41 offen nt lds
    v_sub_f32 v70, v70, v48
    v_sub_f32 v71, v71, v48
    v_sub_f32 v100, v100, v48
    v_sub_f32 v101, v101, v48
    v_sub_f32 v102, v102, v48
    v_sub_f32 v103, v103, v48
    v_exp_f32 v68, v68
    v_exp_f32 v69, v69
    v_exp_f32 v70, v70
    v_exp_f32 v71, v71
    v_exp_f32 v100, v100
    v_exp_f32 v101, v101
    v_exp_f32 v102, v102
    v_exp_f32 v103, v103
    v_sub_f32 v132, 0, v48
    s_add_u32 m0, s40, 26624
    s_nop 0
    buffer_load_dwordx4 v138, s[8:11], s41 offen nt lds
    v_sub_f32 v133, 0, v48
    v_sub_f32 v134, 0, v48
    v_sub_f32 v135, 0, v48
    v_add_f32 v6, v6, v68
    v_add_f32 v6, v6, v69
    v_add_f32 v6, v6, v70
    v_add_f32 v6, v6, v71
    v_add_f32 v6, v6, v100
    v_add_f32 v6, v6, v101
    v_add_f32 v6, v6, v102
    v_add_f32 v6, v6, v103
    v_cvt_pk_bf16_f32 v68, v68, v69
    v_cvt_pk_bf16_f32 v69, v70, v71
    v_cvt_pk_bf16_f32 v70, v100, v101
    v_cvt_pk_bf16_f32 v71, v102, v103
    s_buffer_load_dwordx8 s[48:55], s[20:23], s44 glc
    s_waitcnt lgkmcnt(2)
    v_mfma_f32_16x16x32_bf16 a[0:3], v[64:67], v[24:27], 0
    ds_read_b128 v[40:43], v1 offset:4096
    v_mfma_f32_16x16x32_bf16 a[4:7], v[64:67], v[28:31], 0
    v_mfma_f32_16x16x32_bf16 a[48:51], v[68:71], v[24:27], 0
    ds_read_b128 v[44:47], v1 offset:5120
    v_mfma_f32_16x16x32_bf16 a[52:55], v[68:71], v[28:31], 0
    s_waitcnt lgkmcnt(2)
    v_mfma_f32_16x16x32_bf16 a[8:11], v[64:67], v[32:35], 0
    ds_read_b128 v[24:27], v1 offset:6144
    v_mfma_f32_16x16x32_bf16 a[12:15], v[64:67], v[36:39], 0
    v_mfma_f32_16x16x32_bf16 a[56:59], v[68:71], v[32:35], 0
    ds_read_b128 v[28:31], v1 offset:7168
    v_mfma_f32_16x16x32_bf16 a[60:63], v[68:71], v[36:39], 0
    s_waitcnt lgkmcnt(2)
    v_mfma_f32_16x16x32_bf16 a[16:19], v[64:67], v[40:43], 0
    ds_read_b128 v[32:35], v1 offset:8192
    v_mfma_f32_16x16x32_bf16 a[20:23], v[64:67], v[44:47], 0
    v_mfma_f32_16x16x32_bf16 a[64:67], v[68:71], v[40:43], 0
    ds_read_b128 v[36:39], v1 offset:9216
    v_mfma_f32_16x16x32_bf16 a[68:71], v[68:71], v[44:47], 0
    s_waitcnt lgkmcnt(2)
    v_mfma_f32_16x16x32_bf16 a[24:27], v[64:67], v[24:27], 0
    ds_read_b128 v[40:43], v1 offset:10240
    v_mfma_f32_16x16x32_bf16 a[28:31], v[64:67], v[28:31], 0
    v_mfma_f32_16x16x32_bf16 a[72:75], v[68:71], v[24:27], 0
    ds_read_b128 v[44:47], v1 offset:11264
    v_mfma_f32_16x16x32_bf16 a[76:79], v[68:71], v[28:31], 0
    s_waitcnt lgkmcnt(2)
    v_mfma_f32_16x16x32_bf16 a[32:35], v[64:67], v[32:35], 0
    v_mfma_f32_16x16x32_bf16 a[36:39], v[64:67], v[36:39], 0
    v_mfma_f32_16x16x32_bf16 a[80:83], v[68:71], v[32:35], 0
    v_mfma_f32_16x16x32_bf16 a[84:87], v[68:71], v[36:39], 0
    s_waitcnt lgkmcnt(0)
    v_mfma_f32_16x16x32_bf16 a[40:43], v[64:67], v[40:43], 0
    v_mfma_f32_16x16x32_bf16 a[44:47], v[64:67], v[44:47], 0
    v_mfma_f32_16x16x32_bf16 a[88:91], v[68:71], v[40:43], 0
    v_mfma_f32_16x16x32_bf16 a[92:95], v[68:71], v[44:47], 0
    s_waitcnt lgkmcnt(0)
    s_sub_u32 s48, s48, s92
    s_sub_u32 s49, s49, s92
    s_sub_u32 s50, s50, s92
    s_sub_u32 s51, s51, s92
    s_sub_u32 s52, s52, s92
    s_sub_u32 s53, s53, s92
    s_sub_u32 s54, s54, s92
    s_sub_u32 s55, s55, s92
    s_max_u32 s48, s48, s49
    s_max_u32 s48, s48, s50
    s_max_u32 s48, s48, s51
    s_max_u32 s48, s48, s52
    s_max_u32 s48, s48, s53
    s_max_u32 s48, s48, s54
    s_max_u32 s48, s48, s55
    s_cmp_ge_u32 s48, 16
    s_cbranch_scc1 L_pollslow0
L_pollok0:
    s_add_u32 s92, s92, 1
    s_mov_b32 s44, 32
    s_mov_b32 m0, s26
    s_nop 0
    buffer_load_dwordx4 v4, s[4:7], s32 offen offset:0 sc1 lds
    buffer_load_dwordx4 v4, s[4:7], s32 offen offset:1024 sc1 lds
    buffer_load_dwordx4 v4, s[4:7], s32 offen offset:2048 sc1 lds
    s_add_u32 s32, s32, 24576
    s_sub_u32 s57, s32, 196608
    s_min_u32 s32, s32, s57
    s_add_u32 s26, s26, 36864
    s_sub_u32 s57, s26, 147456
    s_min_u32 s26, s26, s57
    s_mov_b32 m0, s26
    s_waitcnt vmcnt(11)
    buffer_load_dwordx4 v4, s[4:7], s32 offen offset:0 sc1 lds
    s_waitcnt vmcnt(11)
    buffer_load_dwordx4 v4, s[4:7], s32 offen offset:1024 sc1 lds
    s_waitcnt vmcnt(11)
    buffer_load_dwordx4 v4, s[4:7], s32 offen offset:2048 sc1 lds
    s_add_u32 s32, s32, 24576
    s_sub_u32 s57, s32, 196608
    s_min_u32 s32, s32, s57
    s_add_u32 s26, s26, 12288
    s_mov_b32 m0, s26
    s_waitcnt vmcnt(11)
    buffer_load_dwordx4 v4, s[4:7], s32 offen offset:0 sc1 lds
    s_waitcnt vmcnt(11)
    buffer_load_dwordx4 v4, s[4:7], s32 offen offset:1024 sc1 lds
    s_waitcnt vmcnt(11)
    buffer_load_dwordx4 v4, s[4:7], s32 offen offset:2048 sc1 lds
    s_add_u32 s32, s32, 24576
    s_sub_u32 s57, s32, 196608
    s_min_u32 s32, s32, s57
    s_add_u32 s26, s26, 36864
    s_sub_u32 s57, s26, 147456
    s_min_u32 s26, s26, s57
    s_mov_b32 m0, s56
    s_waitcnt vmcnt(11)
    buffer_load_dwordx4 v4, s[4:7], s27 offen offset:0 sc1 lds
    s_waitcnt vmcnt(11)
    buffer_load_dwordx4 v4, s[4:7], s27 offen offset:1024 sc1 lds
    s_waitcnt vmcnt(11)
    buffer_load_dwordx4 v4, s[4:7], s27 offen offset:2048 sc1 lds
    s_add_u32 s27, s27, 24576
    s_sub_u32 s58, s27, 196608
    s_min_u32 s27, s27, s58
    s_add_u32 s56, s56, 36864
    s_sub_u32 s58, s56, 147456
    s_min_u32 s56, s56, s58
    s_add_u32 s33, s33, 196608
    s_add_u32 s34, s34, 196608
    s_add_u32 s36, s36, 1536
    s_add_u32 s35, s35, 196608
    s_add_u32 s16, s16, 196608
    s_add_u32 s17, s17, 196608
    s_add_u32 s37, s37, 512
    s_waitcnt vmcnt(9)
    s_barrier
    ds_read_b128 v[24:27], v2 offset:12288
    ds_read_b128 v[28:31], v3 offset:12288
    ds_read_b128 v[32:35], v2 offset:18432
    ds_read_b128 v[36:39], v3 offset:18432
    s_waitcnt lgkmcnt(2)
    v_mfma_f32_16x16x32_bf16 v[72:75], v[24:27], a[192:195], v[128:131]
    s_mov_b32 m0, s56
    ds_read_b128 v[40:43], v2 offset:12416
    v_mfma_f32_16x16x32_bf16 v[72:75], v[28:31], a[196:199], v[72:75]
    buffer_load_dwordx4 v4, s[4:7], s27 offen offset:0 sc1 lds
    v_mfma_f32_16x16x32_bf16 v[76:79], v[24:27], a[216:219], v[132:135]
    ds_read_b128 v[44:47], v3 offset:12416
    v_mfma_f32_16x16x32_bf16 v[76:79], v[28:31], a[220:223], v[76:79]
    s_waitcnt lgkmcnt(2)
    buffer_load_dwordx4 v4, s[4:7], s27 offen offset:1024 sc1 lds
    v_mfma_f32_16x16x32_bf16 v[104:107], v[32:35], a[192:195], v[128:131]
    ds_read_b128 v[24:27], v2 offset:18560
    v_mfma_f32_16x16x32_bf16 v[104:107], v[36:39], a[196:199], v[104:107]
    buffer_load_dwordx4 v4, s[4:7], s27 offen offset:2048 sc1 lds
    v_mfma_f32_16x16x32_bf16 v[108:111], v[32:35], a[216:219], v[132:135]
    s_add_u32 s27, s27, 24576
    ds_read_b128 v[28:31], v3 offset:18560
    v_mfma_f32_16x16x32_bf16 v[108:111], v[36:39], a[220:223], v[108:111]
    s_waitcnt lgkmcnt(2)
    s_sub_u32 s58, s27, 196608
    v_mfma_f32_16x16x32_bf16 v[72:75], v[40:43], a[200:203], v[72:75]
    ds_read_b128 v[32:35], v2 offset:12544
    v_mfma_f32_16x16x32_bf16 v[72:75], v[44:47], a[204:207], v[72:75]
    s_min_u32 s27, s27, s58
    v_mfma_f32_16x16x32_bf16 v[76:79], v[40:43], a[224:227], v[76:79]
    s_add_u32 s56, s56, 12288
    ds_read_b128 v[36:39], v3 offset:12544
    v_mfma_f32_16x16x32_bf16 v[76:79], v[44:47], a[228:231], v[76:79]
    s_waitcnt lgkmcnt(2)
    s_mov_b32 m0, s56
    v_mfma_f32_16x16x32_bf16 v[104:107], v[24:27], a[200:203], v[104:107]
    ds_read_b128 v[40:43], v2 offset:18688
    v_mfma_f32_16x16x32_bf16 v[104:107], v[28:31], a[204:207], v[104:107]
    s_waitcnt vmcnt(6)
    buffer_load_dwordx4 v4, s[4:7], s27 offen offset:0 sc1 lds
    v_mfma_f32_16x16x32_bf16 v[108:111], v[24:27], a[224:227], v[108:111]
    ds_read_b128 v[44:47], v3 offset:18688
    v_mfma_f32_16x16x32_bf16 v[108:111], v[28:31], a[228:231], v[108:111]
    s_waitcnt lgkmcnt(2)
    s_barrier
    v_add_u32 v2, 49152, v2
    v_add_u32 v3, 49152, v3
    v_mfma_f32_16x16x32_bf16 v[72:75], v[32:35], a[208:211], v[72:75]
    ds_read_b128 v[24:27], v2 offset:0
    v_mfma_f32_16x16x32_bf16 v[72:75], v[36:39], a[212:215], v[72:75]
    buffer_load_dwordx4 v4, s[4:7], s27 offen offset:1024 sc1 lds
    v_mfma_f32_16x16x32_bf16 v[76:79], v[32:35], a[232:235], v[76:79]
    ds_read_b128 v[28:31], v3 offset:0
    v_mfma_f32_16x16x32_bf16 v[76:79], v[36:39], a[236:239], v[76:79]
    s_waitcnt lgkmcnt(2)
    buffer_load_dwordx4 v4, s[4:7], s27 offen offset:2048 sc1 lds
    v_mfma_f32_16x16x32_bf16 v[104:107], v[40:43], a[208:211], v[104:107]
    ds_read_b128 v[32:35], v2 offset:6144
    v_mfma_f32_16x16x32_bf16 v[104:107], v[44:47], a[212:215], v[104:107]
    v_mfma_f32_16x16x32_bf16 v[108:111], v[40:43], a[232:235], v[108:111]
    s_add_u32 s27, s27, 24576
    ds_read_b128 v[36:39], v3 offset:6144
    s_sub_u32 s58, s27, 196608
    v_mfma_f32_16x16x32_bf16 v[108:111], v[44:47], a[236:239], v[108:111]
    s_waitcnt lgkmcnt(2)
    s_min_u32 s27, s27, s58
    s_add_u32 s56, s56, 36864
    s_sub_u32 s58, s56, 147456
    s_min_u32 s56, s56, s58
    v_mfma_f32_16x16x32_bf16 v[80:83], v[24:27], a[192:195], v[128:131]
    s_mov_b32 s41, 18432
    ds_read_b128 v[40:43], v2 offset:128
    s_add_u32 m0, s40, 27648
    v_mfma_f32_16x16x32_bf16 v[80:83], v[28:31], a[196:199], v[80:83]
    v_mfma_f32_16x16x32_bf16 v[84:87], v[24:27], a[216:219], v[132:135]
    ds_read_b128 v[44:47], v3 offset:128
    v_mfma_f32_16x16x32_bf16 v[84:87], v[28:31], a[220:223], v[84:87]
    s_waitcnt lgkmcnt(2)
    buffer_load_dwordx4 v139, s[8:11], s41 offen nt lds
    v_mfma_f32_16x16x32_bf16 v[112:115], v[32:35], a[192:195], v[128:131]
    ds_read_b128 v[24:27], v2 offset:6272
    v_mfma_f32_16x16x32_bf16 v[112:115], v[36:39], a[196:199], v[112:115]
    v_exp_f32 v16, v72
    v_mfma_f32_16x16x32_bf16 v[116:119], v[32:35], a[216:219], v[132:135]
    s_add_u32 m0, s40, 28672
    ds_read_b128 v[28:31], v3 offset:6272
    v_mfma_f32_16x16x32_bf16 v[116:119], v[36:39], a[220:223], v[116:119]
    s_waitcnt lgkmcnt(2)
    v_exp_f32 v17, v73
    v_mfma_f32_16x16x32_bf16 v[80:83], v[40:43], a[200:203], v[80:83]
    ds_read_b128 v[32:35], v2 offset:256
    v_mfma_f32_16x16x32_bf16 v[80:83], v[44:47], a[204:207], v[80:83]
    buffer_load_dwordx4 v140, s[8:11], s41 offen nt lds
    v_mfma_f32_16x16x32_bf16 v[84:87], v[40:43], a[224:227], v[84:87]
    ds_read_b128 v[36:39], v3 offset:256
    v_mfma_f32_16x16x32_bf16 v[84:87], v[44:47], a[228:231], v[84:87]
    s_waitcnt lgkmcnt(2)
    v_exp_f32 v18, v74
    v_mfma_f32_16x16x32_bf16 v[112:115], v[24:27], a[200:203], v[112:115]
    ds_read_b128 v[40:43], v2 offset:6400
    v_add_f32 v5, v5, v16
    v_mfma_f32_16x16x32_bf16 v[112:115], v[28:31], a[204:207], v[112:115]
    s_add_u32 m0, s40, 29696
    v_add_f32 v5, v5, v17
    v_mfma_f32_16x16x32_bf16 v[116:119], v[24:27], a[224:227], v[116:119]
    ds_read_b128 v[44:47], v3 offset:6400
    v_mfma_f32_16x16x32_bf16 v[116:119], v[28:31], a[228:231], v[116:119]
    s_waitcnt lgkmcnt(2)
    v_exp_f32 v19, v75
    v_cvt_pk_bf16_f32 v72, v16, v17
    v_mfma_f32_16x16x32_bf16 v[80:83], v[32:35], a[208:211], v[80:83]
    ds_read_b128 v[24:27], v2 offset:12288
    v_mfma_f32_16x16x32_bf16 v[80:83], v[36:39], a[212:215], v[80:83]
    buffer_load_dwordx4 v141, s[8:11], s41 offen nt lds
    v_mfma_f32_16x16x32_bf16 v[84:87], v[32:35], a[232:235], v[84:87]
    ds_read_b128 v[28:31], v3 offset:12288
    v_mfma_f32_16x16x32_bf16 v[84:87], v[36:39], a[236:239], v[84:87]
    s_waitcnt lgkmcnt(2)
    v_exp_f32 v16, v104
    v_add_f32 v5, v5, v18
    v_mfma_f32_16x16x32_bf16 v[112:115], v[40:43], a[208:211], v[112:115]
    ds_read_b128 v[32:35], v2 offset:18432
    v_add_f32 v5, v5, v19
    v_mfma_f32_16x16x32_bf16 v[112:115], v[44:47], a[212:215], v[112:115]
    v_exp_f32 v17, v105
    v_cvt_pk_bf16_f32 v73, v18, v19
    v_mfma_f32_16x16x32_bf16 v[116:119], v[40:43], a[232:235], v[116:119]
    ds_read_b128 v[36:39], v3 offset:18432
    v_mfma_f32_16x16x32_bf16 v[116:119], v[44:47], a[236:239], v[116:119]
    s_waitcnt lgkmcnt(2)
    v_exp_f32 v18, v106
    v_add_f32 v5, v5, v16
    v_mfma_f32_16x16x32_bf16 v[88:91], v[24:27], a[192:195], v[128:131]
    ds_read_b128 v[40:43], v2 offset:12416
    v_add_f32 v5, v5, v17
    v_mfma_f32_16x16x32_bf16 v[88:91], v[28:31], a[196:199], v[88:91]
    s_waitcnt vmcnt(11)
    buffer_load_dwordx2 v[56:57], v10, s[72:75], s36 offen offset:0
    v_mfma_f32_16x16x32_bf16 v[92:95], v[24:27], a[216:219], v[132:135]
    ds_read_b128 v[44:47], v3 offset:12416
    v_mfma_f32_16x16x32_bf16 v[92:95], v[28:31], a[220:223], v[92:95]
    s_waitcnt lgkmcnt(2)
    v_exp_f32 v19, v107
    v_cvt_pk_bf16_f32 v74, v16, v17
    v_mfma_f32_16x16x32_bf16 v[120:123], v[32:35], a[192:195], v[128:131]
    ds_read_b128 v[24:27], v2 offset:18560
    v_mfma_f32_16x16x32_bf16 v[120:123], v[36:39], a[196:199], v[120:123]
    buffer_load_dwordx2 v[58:59], v10, s[76:79], s36 offen offset:0
    v_mfma_f32_16x16x32_bf16 v[124:127], v[32:35], a[216:219], v[132:135]
    ds_read_b128 v[28:31], v3 offset:18560
    v_mfma_f32_16x16x32_bf16 v[124:127], v[36:39], a[220:223], v[124:127]
    s_waitcnt lgkmcnt(2)
    v_exp_f32 v16, v76
    v_add_f32 v5, v5, v18
    v_mfma_f32_16x16x32_bf16 v[88:91], v[40:43], a[200:203], v[88:91]
    ds_read_b128 v[32:35], v2 offset:12544
    v_add_f32 v5, v5, v19
    v_mfma_f32_16x16x32_bf16 v[88:91], v[44:47], a[204:207], v[88:91]
    s_waitcnt vmcnt(12)
    buffer_load_dwordx4 v[224:227], v9, s[64:67], s33 offen offset:0 nt
    v_mfma_f32_16x16x32_bf16 v[92:95], v[40:43], a[224:227], v[92:95]
    ds_read_b128 v[36:39], v3 offset:12544
    v_mfma_f32_16x16x32_bf16 v[92:95], v[44:47], a[228:231], v[92:95]
    s_waitcnt lgkmcnt(2)
    v_exp_f32 v17, v77
    v_cvt_pk_bf16_f32 v75, v18, v19
    v_mfma_f32_16x16x32_bf16 v[120:123], v[24:27], a[200:203], v[120:123]
    ds_read_b128 v[40:43], v2 offset:18688
    v_mfma_f32_16x16x32_bf16 v[120:123], v[28:31], a[204:207], v[120:123]
    s_waitcnt vmcnt(6)
    buffer_load_dwordx4 v[228:231], v9, s[64:67], s33 offen offset:1536 nt
    v_mfma_f32_16x16x32_bf16 v[124:127], v[24:27], a[224:227], v[124:127]
    ds_read_b128 v[44:47], v3 offset:18688
    v_mfma_f32_16x16x32_bf16 v[124:127], v[28:31], a[228:231], v[124:127]
    s_waitcnt lgkmcnt(2)
    s_barrier
    v_mfma_f32_16x16x32_bf16 v[88:91], v[32:35], a[208:211], v[88:91]
    ds_read_b128 v[24:27], v1 offset:12288
    v_mfma_f32_16x16x32_bf16 v[88:91], v[36:39], a[212:215], v[88:91]
    buffer_load_dwordx4 v[232:235], v9, s[64:67], s34 offen offset:0 nt
    v_mfma_f32_16x16x32_bf16 v[92:95], v[32:35], a[232:235], v[92:95]
    ds_read_b128 v[28:31], v1 offset:13312
    v_mfma_f32_16x16x32_bf16 v[92:95], v[36:39], a[236:239], v[92:95]
    s_waitcnt lgkmcnt(2)
    v_exp_f32 v18, v78
    v_add_f32 v6, v6, v16
    v_mfma_f32_16x16x32_bf16 v[120:123], v[40:43], a[208:211], v[120:123]
    ds_read_b128 v[32:35], v1 offset:14336
    v_add_f32 v6, v6, v17
    v_mfma_f32_16x16x32_bf16 v[120:123], v[44:47], a[212:215], v[120:123]
    buffer_load_dwordx4 v[236:239], v9, s[64:67], s34 offen offset:1536 nt
    v_mfma_f32_16x16x32_bf16 v[124:127], v[40:43], a[232:235], v[124:127]
    ds_read_b128 v[36:39], v1 offset:15360
    v_mfma_f32_16x16x32_bf16 v[124:127], v[44:47], a[236:239], v[124:127]
    s_waitcnt lgkmcnt(2)
    v_exp_f32 v19, v79
    v_cvt_pk_bf16_f32 v76, v16, v17
    v_exp_f32 v16, v108
    v_add_f32 v6, v6, v18
    v_add_f32 v6, v6, v19
    v_exp_f32 v17, v109
    v_cvt_pk_bf16_f32 v77, v18, v19
    v_exp_f32 v18, v110
    v_add_f32 v6, v6, v16
    v_add_f32 v6, v6, v17
    v_exp_f32 v19, v111
    v_cvt_pk_bf16_f32 v78, v16, v17
    v_add_f32 v6, v6, v18
    v_add_f32 v6, v6, v19
    v_cvt_pk_bf16_f32 v79, v18, v19
    v_mfma_f32_16x16x32_bf16 a[0:3], v[72:75], v[24:27], a[0:3]
    ds_read_b128 v[40:43], v1 offset:16384
    v_mfma_f32_16x16x32_bf16 a[4:7], v[72:75], v[28:31], a[4:7]
    buffer_load_dwordx2 v[60:61], v10, s[72:75], s36 offen offset:192
    v_mfma_f32_16x16x32_bf16 a[48:51], v[76:79], v[24:27], a[48:51]
    ds_read_b128 v[44:47], v1 offset:17408
    v_mfma_f32_16x16x32_bf16 a[52:55], v[76:79], v[28:31], a[52:55]
    s_waitcnt lgkmcnt(2)
    v_exp_f32 v16, v80
    v_mfma_f32_16x16x32_bf16 a[8:11], v[72:75], v[32:35], a[8:11]
    ds_read_b128 v[24:27], v1 offset:18432
    v_mfma_f32_16x16x32_bf16 a[12:15], v[72:75], v[36:39], a[12:15]
    buffer_load_dwordx2 v[62:63], v10, s[76:79], s36 offen offset:192
    v_mfma_f32_16x16x32_bf16 a[56:59], v[76:79], v[32:35], a[56:59]
    ds_read_b128 v[28:31], v1 offset:19456
    v_mfma_f32_16x16x32_bf16 a[60:63], v[76:79], v[36:39], a[60:63]
    s_waitcnt lgkmcnt(2)
    v_exp_f32 v17, v81
    v_mfma_f32_16x16x32_bf16 a[16:19], v[72:75], v[40:43], a[16:19]
    ds_read_b128 v[32:35], v1 offset:20480
    v_mfma_f32_16x16x32_bf16 a[20:23], v[72:75], v[44:47], a[20:23]
    buffer_load_dwordx4 v[240:243], v9, s[64:67], s33 offen offset:384 nt
    v_mfma_f32_16x16x32_bf16 a[64:67], v[76:79], v[40:43], a[64:67]
    ds_read_b128 v[36:39], v1 offset:21504
    v_mfma_f32_16x16x32_bf16 a[68:71], v[76:79], v[44:47], a[68:71]
    s_waitcnt lgkmcnt(2)
    v_exp_f32 v18, v82
    v_add_f32 v5, v5, v16
    v_mfma_f32_16x16x32_bf16 a[24:27], v[72:75], v[24:27], a[24:27]
    ds_read_b128 v[40:43], v1 offset:22528
    v_add_f32 v5, v5, v17
    v_mfma_f32_16x16x32_bf16 a[28:31], v[72:75], v[28:31], a[28:31]
    buffer_load_dwordx4 v[244:247], v9, s[64:67], s33 offen offset:1920 nt
    v_mfma_f32_16x16x32_bf16 a[72:75], v[76:79], v[24:27], a[72:75]
    ds_read_b128 v[44:47], v1 offset:23552
    v_mfma_f32_16x16x32_bf16 a[76:79], v[76:79], v[28:31], a[76:79]
    s_waitcnt lgkmcnt(2)
    v_add_u32 v1, 49152, v1
    v_exp_f32 v19, v83
    v_mfma_f32_16x16x32_bf16 a[32:35], v[72:75], v[32:35], a[32:35]
    ds_read_b128 v[24:27], v1 offset:0
    v_cvt_pk_bf16_f32 v80, v16, v17
    v_mfma_f32_16x16x32_bf16 a[36:39], v[72:75], v[36:39], a[36:39]
    buffer_load_dwordx4 v[248:251], v9, s[64:67], s34 offen offset:384 nt
    v_mfma_f32_16x16x32_bf16 a[80:83], v[76:79], v[32:35], a[80:83]
    ds_read_b128 v[28:31], v1 offset:1024
    v_mfma_f32_16x16x32_bf16 a[84:87], v[76:79], v[36:39], a[84:87]
    s_waitcnt lgkmcnt(2)
    v_exp_f32 v16, v112
    v_add_f32 v5, v5, v18
    v_mfma_f32_16x16x32_bf16 a[40:43], v[72:75], v[40:43], a[40:43]
    ds_read_b128 v[32:35], v1 offset:2048
    v_add_f32 v5, v5, v19
    v_mfma_f32_16x16x32_bf16 a[44:47], v[72:75], v[44:47], a[44:47]
    buffer_load_dwordx4 v[252:255], v9, s[64:67], s34 offen offset:1920 nt
    v_mfma_f32_16x16x32_bf16 a[88:91], v[76:79], v[40:43], a[88:91]
    ds_read_b128 v[36:39], v1 offset:3072
    v_mfma_f32_16x16x32_bf16 a[92:95], v[76:79], v[44:47], a[92:95]
    s_waitcnt lgkmcnt(2)
    v_exp_f32 v17, v113
    v_cvt_pk_bf16_f32 v81, v18, v19
    v_exp_f32 v18, v114
    v_add_f32 v5, v5, v16
    v_add_f32 v5, v5, v17
    v_exp_f32 v19, v115
    v_cvt_pk_bf16_f32 v82, v16, v17
    v_exp_f32 v16, v84
    v_add_f32 v5, v5, v18
    v_add_f32 v5, v5, v19
    v_exp_f32 v17, v85
    v_cvt_pk_bf16_f32 v83, v18, v19
    v_exp_f32 v18, v86
    v_add_f32 v6, v6, v16
    v_add_f32 v6, v6, v17
    v_exp_f32 v19, v87
    v_cvt_pk_bf16_f32 v84, v16, v17
    v_exp_f32 v16, v116
    v_add_f32 v6, v6, v18
    v_add_f32 v6, v6, v19
    v_exp_f32 v17, v117
    v_cvt_pk_bf16_f32 v85, v18, v19
    v_exp_f32 v18, v118
    v_add_f32 v6, v6, v16
    v_add_f32 v6, v6, v17
    v_exp_f32 v19, v119
    v_cvt_pk_bf16_f32 v86, v16, v17
    v_add_f32 v6, v6, v18
    v_add_f32 v6, v6, v19
    v_cvt_pk_bf16_f32 v87, v18, v19
    v_mfma_f32_16x16x32_bf16 a[0:3], v[80:83], v[24:27], a[0:3]
    ds_read_b128 v[40:43], v1 offset:4096
    v_mfma_f32_16x16x32_bf16 a[4:7], v[80:83], v[28:31], a[4:7]
    buffer_load_dwordx4 v[144:147], v12, s[68:71], s35 offen offset:0 nt
    v_mfma_f32_16x16x32_bf16 a[48:51], v[84:87], v[24:27], a[48:51]
    ds_read_b128 v[44:47], v1 offset:5120
    v_mfma_f32_16x16x32_bf16 a[52:55], v[84:87], v[28:31], a[52:55]
    s_waitcnt lgkmcnt(2)
    v_exp_f32 v16, v88
    v_mfma_f32_16x16x32_bf16 a[8:11], v[80:83], v[32:35], a[8:11]
    ds_read_b128 v[24:27], v1 offset:6144
    v_mfma_f32_16x16x32_bf16 a[12:15], v[80:83], v[36:39], a[12:15]
    buffer_load_dwordx4 v[148:151], v12, s[68:71], s35 offen offset:768 nt
    v_mfma_f32_16x16x32_bf16 a[56:59], v[84:87], v[32:35], a[56:59]
    ds_read_b128 v[28:31], v1 offset:7168
    v_mfma_f32_16x16x32_bf16 a[60:63], v[84:87], v[36:39], a[60:63]
    s_waitcnt lgkmcnt(2)
    v_exp_f32 v17, v89
    v_mfma_f32_16x16x32_bf16 a[16:19], v[80:83], v[40:43], a[16:19]
    ds_read_b128 v[32:35], v1 offset:8192
    v_mfma_f32_16x16x32_bf16 a[20:23], v[80:83], v[44:47], a[20:23]
    v_exp_f32 v18, v90
    v_add_f32 v5, v5, v16
    v_mfma_f32_16x16x32_bf16 a[64:67], v[84:87], v[40:43], a[64:67]
    ds_read_b128 v[36:39], v1 offset:9216
    v_add_f32 v5, v5, v17
    v_mfma_f32_16x16x32_bf16 a[68:71], v[84:87], v[44:47], a[68:71]
    s_waitcnt lgkmcnt(2)
    s_waitcnt vmcnt(16)
    buffer_load_dwordx4 v[152:155], v12, s[68:71], s35 offen offset:1536 nt
    v_mfma_f32_16x16x32_bf16 a[24:27], v[80:83], v[24:27], a[24:27]
    ds_read_b128 v[40:43], v1 offset:10240
    v_mfma_f32_16x16x32_bf16 a[28:31], v[80:83], v[28:31], a[28:31]
    v_exp_f32 v19, v91
    v_cvt_pk_bf16_f32 v88, v16, v17
    v_mfma_f32_16x16x32_bf16 a[72:75], v[84:87], v[24:27], a[72:75]
    ds_read_b128 v[44:47], v1 offset:11264
    v_mfma_f32_16x16x32_bf16 a[76:79], v[84:87], v[28:31], a[76:79]
    s_waitcnt lgkmcnt(2)
    v_exp_f32 v16, v120
    v_add_f32 v5, v5, v18
    v_mfma_f32_16x16x32_bf16 a[32:35], v[80:83], v[32:35], a[32:35]
    s_waitcnt vmcnt(39)
    ds_read_b128 v[24:27], v1 offset:12288
    v_add_f32 v5, v5, v19
    v_mfma_f32_16x16x32_bf16 a[36:39], v[80:83], v[36:39], a[36:39]
    v_exp_f32 v17, v121
    v_cvt_pk_bf16_f32 v89, v18, v19
    v_mfma_f32_16x16x32_bf16 a[80:83], v[84:87], v[32:35], a[80:83]
    ds_read_b128 v[28:31], v1 offset:13312
    ds_read_b64 a[240:241], v22 offset:49152
    v_mfma_f32_16x16x32_bf16 a[84:87], v[84:87], v[36:39], a[84:87]
    s_waitcnt lgkmcnt(3)
    s_waitcnt vmcnt(16)
    buffer_load_dwordx4 v[156:159], v12, s[68:71], s35 offen offset:2304 nt
    v_mfma_f32_16x16x32_bf16 a[40:43], v[80:83], v[40:43], a[40:43]
    ds_read_b128 v[32:35], v1 offset:14336
    ds_read_b64 a[242:243], v142 offset:49280
    v_mfma_f32_16x16x32_bf16 a[44:47], v[80:83], v[44:47], a[44:47]
    v_exp_f32 v18, v122
    v_add_f32 v5, v5, v16
    v_add_f32 v5, v5, v17
    v_exp_f32 v19, v123
    v_cvt_pk_bf16_f32 v90, v16, v17
    v_exp_f32 v16, v92
    v_add_f32 v5, v5, v18
    v_add_f32 v5, v5, v19
    v_exp_f32 v17, v93
    v_cvt_pk_bf16_f32 v91, v18, v19
    v_exp_f32 v18, v94
    v_add_f32 v6, v6, v16
    v_add_f32 v6, v6, v17
    v_exp_f32 v19, v95
    v_cvt_pk_bf16_f32 v92, v16, v17
    v_exp_f32 v16, v124
    v_add_f32 v6, v6, v18
    v_add_f32 v6, v6, v19
    v_exp_f32 v17, v125
    v_cvt_pk_bf16_f32 v93, v18, v19
    v_exp_f32 v18, v126
    v_add_f32 v6, v6, v16
    v_add_f32 v6, v6, v17
    v_exp_f32 v19, v127
    v_cvt_pk_bf16_f32 v94, v16, v17
    v_add_f32 v6, v6, v18
    v_add_f32 v6, v6, v19
    v_cvt_pk_bf16_f32 v95, v18, v19
    v_mfma_f32_16x16x32_bf16 a[88:91], v[84:87], v[40:43], a[88:91]
    ds_read_b128 v[36:39], v1 offset:15360
    ds_read_b64 a[244:245], v23 offset:49152
    v_mfma_f32_16x16x32_bf16 a[92:95], v[84:87], v[44:47], a[92:95]
    s_waitcnt lgkmcnt(5)
    ds_read_b64 a[246:247], v143 offset:49280
    ds_read_b64 a[248:249], v142 offset:49152
    v_mfma_f32_16x16x32_bf16 a[0:3], v[88:91], v[24:27], a[0:3]
    ds_read_b128 v[40:43], v1 offset:16384
    ds_read_b64 a[250:251], v22 offset:49408
    v_mfma_f32_16x16x32_bf16 a[4:7], v[88:91], v[28:31], a[4:7]
    ds_read_b64 a[252:253], v143 offset:49152
    ds_read_b64 a[254:255], v23 offset:49408
    v_mfma_f32_16x16x32_bf16 a[48:51], v[92:95], v[24:27], a[48:51]
    ds_read_b128 v[44:47], v1 offset:17408
    ds_read_b64 v[192:193], v22 offset:49280
    v_mfma_f32_16x16x32_bf16 a[52:55], v[92:95], v[28:31], a[52:55]
    s_waitcnt lgkmcnt(9)
    ds_read_b64 v[194:195], v142 offset:49408
    ds_read_b64 v[196:197], v23 offset:49280
    v_mfma_f32_16x16x32_bf16 a[8:11], v[88:91], v[32:35], a[8:11]
    ds_read_b128 v[24:27], v1 offset:18432
    ds_read_b64 v[198:199], v143 offset:49408
    v_mfma_f32_16x16x32_bf16 a[12:15], v[88:91], v[36:39], a[12:15]
    s_waitcnt vmcnt(16)
    v_mfma_f32_16x16x32_bf16 a[56:59], v[92:95], v[32:35], a[56:59]
    ds_read_b128 v[28:31], v1 offset:19456
    ds_read_b64 v[200:201], v22 offset:24576
    v_mfma_f32_16x16x32_bf16 a[60:63], v[92:95], v[36:39], a[60:63]
    s_waitcnt lgkmcnt(7)
    v_mfma_f32_16x16x32_bf16 a[16:19], v[88:91], v[40:43], a[16:19]
    ds_read_b128 v[32:35], v1 offset:20480
    ds_read_b64 v[202:203], v142 offset:24704
    v_mfma_f32_16x16x32_bf16 a[20:23], v[88:91], v[44:47], a[20:23]
    ds_read_b64 v[204:205], v23 offset:24576
    v_mfma_f32_16x16x32_bf16 a[64:67], v[92:95], v[40:43], a[64:67]
    ds_read_b128 v[36:39], v1 offset:21504
    ds_read_b64 v[206:207], v143 offset:24704
    v_mfma_f32_16x16x32_bf16 a[68:71], v[92:95], v[44:47], a[68:71]
    s_waitcnt lgkmcnt(6)
    ds_read_b64 v[208:209], v142 offset:24576
    v_mfma_f32_16x16x32_bf16 a[24:27], v[88:91], v[24:27], a[24:27]
    ds_read_b128 v[40:43], v1 offset:22528
    ds_read_b64 v[210:211], v22 offset:24832
    v_mfma_f32_16x16x32_bf16 a[28:31], v[88:91], v[28:31], a[28:31]
    v_mfma_f32_16x16x32_bf16 a[72:75], v[92:95], v[24:27], a[72:75]
    ds_read_b128 v[44:47], v1 offset:23552
    ds_read_b64 v[212:213], v143 offset:24576
    v_mfma_f32_16x16x32_bf16 a[76:79], v[92:95], v[28:31], a[76:79]
    s_waitcnt lgkmcnt(6)
    v_subrev_u32 v2, 49152, v2
    v_subrev_u32 v3, 49152, v3
    v_mfma_f32_16x16x32_bf16 a[32:35], v[88:91], v[32:35], a[32:35]
    ds_read_b128 v[24:27], v2 offset:0
    ds_read_b64 v[214:215], v23 offset:24832
    v_mfma_f32_16x16x32_bf16 a[36:39], v[88:91], v[36:39], a[36:39]
    ds_read_b64 v[216:217], v22 offset:24704
    ds_read_b64 v[218:219], v142 offset:24832
    v_mfma_f32_16x16x32_bf16 a[80:83], v[92:95], v[32:35], a[80:83]
    ds_read_b128 v[28:31], v3 offset:0
    ds_read_b64 v[220:221], v23 offset:24704
    v_mfma_f32_16x16x32_bf16 a[84:87], v[92:95], v[36:39], a[84:87]
    s_waitcnt lgkmcnt(7)
    v_mfma_f32_16x16x32_bf16 a[40:43], v[88:91], v[40:43], a[40:43]
    ds_read_b128 v[32:35], v2 offset:6144
    ds_read_b64 v[222:223], v143 offset:24832
    v_mfma_f32_16x16x32_bf16 a[44:47], v[88:91], v[44:47], a[44:47]
    v_mfma_f32_16x16x32_bf16 a[88:91], v[92:95], v[40:43], a[88:91]
    ds_read_b128 v[36:39], v3 offset:6144
    v_mfma_f32_16x16x32_bf16 a[92:95], v[92:95], v[44:47], a[92:95]
    s_waitcnt lgkmcnt(4)
    s_waitcnt lgkmcnt(0)
    s_barrier
    v_mfma_f32_16x16x32_bf16 v[160:163], v[24:27], a[240:243], 0
    s_waitcnt vmcnt(10)
    ds_read_b128 v[40:43], v2 offset:128
    v_lshlrev_b32 v48, 16, v56
    v_mfma_f32_16x16x32_bf16 v[160:163], v[28:31], a[244:247], v[160:163]
    s_mov_b32 m0, s26
    v_and_b32 v49, s97, v56
    v_lshlrev_b32 v50, 16, v58
    v_mfma_f32_16x16x32_bf16 v[164:167], v[24:27], v[200:203], 0
    ds_read_b128 v[44:47], v3 offset:128
    v_and_b32 v51, s97, v58
    v_mfma_f32_16x16x32_bf16 v[164:167], v[28:31], v[204:207], v[164:167]
    s_waitcnt lgkmcnt(2)
    buffer_load_dwordx4 v4, s[4:7], s32 offen offset:0 sc1 lds
    v_mfma_f32_16x16x32_bf16 v[96:99], v[32:35], a[240:243], 0
    ds_read_b128 v[24:27], v2 offset:6272
    v_mul_f32 v48, s38, v48
    v_mfma_f32_16x16x32_bf16 v[96:99], v[36:39], a[244:247], v[96:99]
    v_mul_f32 v49, s38, v49
    v_mul_f32_e64 v50, -v50, v48
    v_mfma_f32_16x16x32_bf16 v[100:103], v[32:35], v[200:203], 0
    ds_read_b128 v[28:31], v3 offset:6272
    v_mul_f32_e64 v51, -v51, v49
    v_mfma_f32_16x16x32_bf16 v[100:103], v[36:39], v[204:207], v[100:103]
    s_waitcnt lgkmcnt(2)
    buffer_load_dwordx4 v4, s[4:7], s32 offen offset:1024 sc1 lds
    v_mfma_f32_16x16x32_bf16 v[160:163], v[40:43], a[248:251], v[160:163]
    ds_read_b128 v[32:35], v2 offset:256
    v_cvt_f32_i32 v224, v224
    v_mfma_f32_16x16x32_bf16 v[160:163], v[44:47], a[252:255], v[160:163]
    v_cvt_f32_i32 v225, v225
    v_fma_f32 v224, v224, v48, v50
    v_mfma_f32_16x16x32_bf16 v[164:167], v[40:43], v[208:211], v[164:167]
    ds_read_b128 v[36:39], v3 offset:256
    v_fma_f32 v225, v225, v49, v51
    v_mfma_f32_16x16x32_bf16 v[164:167], v[44:47], v[212:215], v[164:167]
    s_waitcnt lgkmcnt(2)
    buffer_load_dwordx4 v4, s[4:7], s32 offen offset:2048 sc1 lds
    v_cvt_pk_bf16_f32 v224, v224, v225
    v_mfma_f32_16x16x32_bf16 v[96:99], v[24:27], a[248:251], v[96:99]
    s_add_u32 s32, s32, 24576
    ds_read_b128 v[40:43], v2 offset:6400
    v_cvt_f32_i32 v228, v228
    v_mfma_f32_16x16x32_bf16 v[96:99], v[28:31], a[252:255], v[96:99]
    s_sub_u32 s57, s32, 196608
    v_cvt_f32_i32 v229, v229
    v_fma_f32 v228, v228, v48, v50
    v_mfma_f32_16x16x32_bf16 v[100:103], v[24:27], v[208:211], v[100:103]
    s_min_u32 s32, s32, s57
    ds_read_b128 v[44:47], v3 offset:6400
    v_fma_f32 v229, v229, v49, v51
    v_mfma_f32_16x16x32_bf16 v[100:103], v[28:31], v[212:215], v[100:103]
    s_waitcnt lgkmcnt(2)
    v_cvt_pk_bf16_f32 v228, v228, v229
    v_cvt_f32_i32 v232, v232
    v_cvt_f32_i32 v233, v233
    v_mfma_f32_16x16x32_bf16 v[160:163], v[32:35], v[192:195], v[160:163]
    s_add_u32 s26, s26, 12288
    ds_read_b128 v[24:27], v2 offset:12288
    v_fma_f32 v232, v232, v48, v50
    v_mfma_f32_16x16x32_bf16 v[160:163], v[36:39], v[196:199], v[160:163]
    s_mov_b32 m0, s26
    v_fma_f32 v233, v233, v49, v51
    v_cvt_pk_bf16_f32 v232, v232, v233
    v_mfma_f32_16x16x32_bf16 v[164:167], v[32:35], v[216:219], v[164:167]
    ds_read_b128 v[28:31], v3 offset:12288
    v_cvt_f32_i32 v236, v236
    v_mfma_f32_16x16x32_bf16 v[164:167], v[36:39], v[220:223], v[164:167]
    s_waitcnt lgkmcnt(2)
    buffer_load_dwordx4 v4, s[4:7], s32 offen offset:0 sc1 lds
    v_cvt_f32_i32 v237, v237
    v_mfma_f32_16x16x32_bf16 v[96:99], v[40:43], v[192:195], v[96:99]
    ds_read_b128 v[32:35], v2 offset:18432
    v_fma_f32 v236, v236, v48, v50
    v_mfma_f32_16x16x32_bf16 v[96:99], v[44:47], v[196:199], v[96:99]
    v_fma_f32 v237, v237, v49, v51
    v_cvt_pk_bf16_f32 v236, v236, v237
    v_lshlrev_b32 v48, 16, v57
    v_mfma_f32_16x16x32_bf16 v[100:103], v[40:43], v[216:219], v[100:103]
    ds_read_b128 v[36:39], v3 offset:18432
    v_and_b32 v49, s97, v57
    v_mfma_f32_16x16x32_bf16 v[100:103], v[44:47], v[220:223], v[100:103]
    s_waitcnt lgkmcnt(2)
    buffer_load_dwordx4 v4, s[4:7], s32 offen offset:1024 sc1 lds
    v_lshlrev_b32 v50, 16, v59
    v_mfma_f32_16x16x32_bf16 v[168:171], v[24:27], a[240:243], 0
    ds_read_b128 v[40:43], v2 offset:12416
    s_waitcnt vmcnt(13)
    buffer_load_dwordx4 v4, s[4:7], s32 offen offset:2048 sc1 lds
    v_mfma_f32_16x16x32_bf16 v[168:171], v[28:31], a[244:247], v[168:171]
    v_and_b32 v51, s97, v59
    v_mul_f32 v48, s38, v48
    v_mul_f32 v49, s38, v49
    v_mfma_f32_16x16x32_bf16 v[172:175], v[24:27], v[200:203], 0
    s_add_u32 s32, s32, 24576
    ds_read_b128 v[44:47], v3 offset:12416
    v_mul_f32_e64 v50, -v50, v48
    v_mfma_f32_16x16x32_bf16 v[172:175], v[28:31], v[204:207], v[172:175]
    s_waitcnt lgkmcnt(2)
    v_mul_f32_e64 v51, -v51, v49
    v_cvt_f32_i32 v226, v226
    v_cvt_f32_i32 v227, v227
    v_mfma_f32_16x16x32_bf16 v[104:107], v[32:35], a[240:243], 0
    s_sub_u32 s57, s32, 196608
    ds_read_b128 v[24:27], v2 offset:18560
    v_fma_f32 v226, v226, v48, v50
    v_mfma_f32_16x16x32_bf16 v[104:107], v[36:39], a[244:247], v[104:107]
    v_fma_f32 v227, v227, v49, v51
    v_cvt_pk_bf16_f32 v225, v226, v227
    v_cvt_f32_i32 v230, v230
    v_mfma_f32_16x16x32_bf16 v[108:111], v[32:35], v[200:203], 0
    s_min_u32 s32, s32, s57
    ds_read_b128 v[28:31], v3 offset:18560
    v_cvt_f32_i32 v231, v231
    v_mfma_f32_16x16x32_bf16 v[108:111], v[36:39], v[204:207], v[108:111]
    s_waitcnt lgkmcnt(2)
    v_fma_f32 v230, v230, v48, v50
    v_fma_f32 v231, v231, v49, v51
    v_cvt_pk_bf16_f32 v229, v230, v231
    v_mfma_f32_16x16x32_bf16 v[168:171], v[40:43], a[248:251], v[168:171]
    s_add_u32 s26, s26, 36864
    ds_read_b128 v[32:35], v2 offset:12544
    v_cvt_f32_i32 v234, v234
    v_mfma_f32_16x16x32_bf16 v[168:171], v[44:47], a[252:255], v[168:171]
    v_cvt_f32_i32 v235, v235
    v_fma_f32 v234, v234, v48, v50
    v_max3_f32 v16, v160, v161, v162
    v_mfma_f32_16x16x32_bf16 v[172:175], v[40:43], v[208:211], v[172:175]
    ds_read_b128 v[36:39], v3 offset:12544
    v_fma_f32 v235, v235, v49, v51
    v_cvt_pk_bf16_f32 v233, v234, v235
    v_cvt_f32_i32 v238, v238
    v_cvt_f32_i32 v239, v239
    v_fma_f32 v238, v238, v48, v50
    v_fma_f32 v239, v239, v49, v51
    v_cvt_pk_bf16_f32 v237, v238, v239
    v_mfma_f32_16x16x32_bf16 v[172:175], v[44:47], v[212:215], v[172:175]
    s_waitcnt lgkmcnt(2)
    v_max3_f32 v18, v164, v165, v166
    v_max3_f32 v16, v16, v163, v96
    v_max3_f32 v18, v18, v167, v100
    v_mfma_f32_16x16x32_bf16 v[104:107], v[24:27], a[248:251], v[104:107]
    s_sub_u32 s57, s26, 147456
    ds_read_b128 v[40:43], v2 offset:18688
    s_min_u32 s26, s26, s57
    v_mfma_f32_16x16x32_bf16 v[104:107], v[28:31], a[252:255], v[104:107]
    s_waitcnt vmcnt(13)
    buffer_load_dwordx2 v[56:57], off, s[80:83], s37 offset:0
    v_max3_f32 v16, v16, v97, v98
    v_mfma_f32_16x16x32_bf16 v[108:111], v[24:27], v[208:211], v[108:111]
    s_waitcnt vmcnt(11)
    ds_read_b128 v[44:47], v3 offset:18688
    v_max3_f32 v18, v18, v101, v102
    v_mfma_f32_16x16x32_bf16 v[108:111], v[28:31], v[212:215], v[108:111]
    s_waitcnt lgkmcnt(2)
    v_add_u32 v2, 49152, v2
    v_add_u32 v3, 49152, v3
    v_max_f32 v16, v16, v99
    v_mfma_f32_16x16x32_bf16 v[168:171], v[32:35], v[192:195], v[168:171]
    ds_read_b128 v[24:27], v2 offset:0
    v_max_f32 v18, v18, v103
    v_mfma_f32_16x16x32_bf16 v[168:171], v[36:39], v[196:199], v[168:171]
    v_mov_b32 v17, v16
    v_mov_b32 v19, v18
    s_nop 0
    v_mfma_f32_16x16x32_bf16 v[172:175], v[32:35], v[216:219], v[172:175]
    ds_read_b128 v[28:31], v3 offset:0
    v_permlane16_swap_b32 v16, v17
    v_mfma_f32_16x16x32_bf16 v[172:175], v[36:39], v[220:223], v[172:175]
    s_waitcnt lgkmcnt(2)
    buffer_load_dwordx2 v[58:59], off, s[84:87], s37 offset:0
    v_permlane16_swap_b32 v18, v19
    v_mfma_f32_16x16x32_bf16 v[104:107], v[40:43], v[192:195], v[104:107]
    s_nop 0
    ds_read_b128 v[32:35], v2 offset:6144
    v_max_f32 v16, v16, v17
    v_mfma_f32_16x16x32_bf16 v[104:107], v[44:47], v[196:199], v[104:107]
    v_max_f32 v18, v18, v19
    v_mov_b32 v17, v16
    v_mov_b32 v19, v18
    s_nop 0
    v_permlane32_swap_b32 v16, v17
    v_permlane32_swap_b32 v18, v19
    s_nop 0
    v_max_f32 v16, v16, v17
    v_max_f32 v18, v18, v19
    v_sub_f32 v136, 0, v16
    v_sub_f32 v137, 0, v16
    v_sub_f32 v138, 0, v16
    v_sub_f32 v139, 0, v16
    v_sub_f32 v140, 0, v18
    v_sub_f32 v141, 0, v18
    v_sub_f32 v142, 0, v18
    v_sub_f32 v143, 0, v18
    v_mfma_f32_16x16x32_bf16 v[108:111], v[40:43], v[216:219], v[108:111]
    ds_read_b128 v[36:39], v3 offset:6144
    v_lshlrev_b32 v48, 16, v60
    v_mfma_f32_16x16x32_bf16 v[108:111], v[44:47], v[220:223], v[108:111]
    s_waitcnt lgkmcnt(2)
    v_and_b32 v49, s97, v60
    v_lshlrev_b32 v50, 16, v62
    v_and_b32 v51, s97, v62
    v_mfma_f32_16x16x32_bf16 v[176:179], v[24:27], a[240:243], v[136:139]
    ds_read_b128 v[40:43], v2 offset:128
    v_mul_f32 v48, s38, v48
    v_mfma_f32_16x16x32_bf16 v[176:179], v[28:31], a[244:247], v[176:179]
    v_mul_f32 v49, s38, v49
    v_mul_f32_e64 v50, -v50, v48
    v_mul_f32_e64 v51, -v51, v49
    v_mfma_f32_16x16x32_bf16 v[180:183], v[24:27], v[200:203], v[140:143]
    ds_read_b128 v[44:47], v3 offset:128
    v_cvt_f32_i32 v240, v240
    v_mfma_f32_16x16x32_bf16 v[180:183], v[28:31], v[204:207], v[180:183]
    s_waitcnt lgkmcnt(2)
    v_cvt_f32_i32 v241, v241
    v_fma_f32 v240, v240, v48, v50
    v_fma_f32 v241, v241, v49, v51
    v_mfma_f32_16x16x32_bf16 v[112:115], v[32:35], a[240:243], v[136:139]
    ds_read_b128 v[24:27], v2 offset:6272
    v_cvt_pk_bf16_f32 v226, v240, v241
    v_mfma_f32_16x16x32_bf16 v[112:115], v[36:39], a[244:247], v[112:115]
    v_add_f32 v160, v160, v136
    v_add_f32 v161, v161, v136
    v_cvt_f32_i32 v244, v244
    v_mfma_f32_16x16x32_bf16 v[116:119], v[32:35], v[200:203], v[140:143]
    ds_read_b128 v[28:31], v3 offset:6272
    v_add_f32 v162, v162, v136
    v_mfma_f32_16x16x32_bf16 v[116:119], v[36:39], v[204:207], v[116:119]
    s_waitcnt lgkmcnt(2)
    v_add_f32 v163, v163, v136
    v_cvt_f32_i32 v245, v245
    v_add_f32 v96, v96, v136
    v_mfma_f32_16x16x32_bf16 v[176:179], v[40:43], a[248:251], v[176:179]
    ds_read_b128 v[32:35], v2 offset:256
    v_add_f32 v97, v97, v136
    v_mfma_f32_16x16x32_bf16 v[176:179], v[44:47], a[252:255], v[176:179]
    v_fma_f32 v244, v244, v48, v50
    v_add_f32 v98, v98, v136
    v_add_f32 v99, v99, v136
    v_mfma_f32_16x16x32_bf16 v[180:183], v[40:43], v[208:211], v[180:183]
    ds_read_b128 v[36:39], v3 offset:256
    v_fma_f32 v245, v245, v49, v51
    v_mfma_f32_16x16x32_bf16 v[180:183], v[44:47], v[212:215], v[180:183]
    s_waitcnt lgkmcnt(2)
    v_add_f32 v164, v164, v140
    v_cvt_pk_bf16_f32 v230, v244, v245
    v_add_f32 v165, v165, v140
    v_mfma_f32_16x16x32_bf16 v[112:115], v[24:27], a[248:251], v[112:115]
    ds_read_b128 v[40:43], v2 offset:6400
    v_cvt_f32_i32 v248, v248
    v_mfma_f32_16x16x32_bf16 v[112:115], v[28:31], a[252:255], v[112:115]
    v_add_f32 v166, v166, v140
    v_add_f32 v167, v167, v140
    v_cvt_f32_i32 v249, v249
    v_mfma_f32_16x16x32_bf16 v[116:119], v[24:27], v[208:211], v[116:119]
    ds_read_b128 v[44:47], v3 offset:6400
    v_add_f32 v100, v100, v140
    v_mfma_f32_16x16x32_bf16 v[116:119], v[28:31], v[212:215], v[116:119]
    s_waitcnt lgkmcnt(2)
    v_fma_f32 v248, v248, v48, v50
    v_fma_f32 v249, v249, v49, v51
    v_add_f32 v101, v101, v140
    v_mfma_f32_16x16x32_bf16 v[176:179], v[32:35], v[192:195], v[176:179]
    ds_read_b128 v[24:27], v2 offset:12288
    v_cvt_pk_bf16_f32 v234, v248, v249
    v_mfma_f32_16x16x32_bf16 v[176:179], v[36:39], v[196:199], v[176:179]
    v_cvt_f32_i32 v252, v252
    v_add_f32 v102, v102, v140
    v_add_f32 v103, v103, v140
    v_mfma_f32_16x16x32_bf16 v[180:183], v[32:35], v[216:219], v[180:183]
    ds_read_b128 v[28:31], v3 offset:12288
    v_cvt_f32_i32 v253, v253
    v_mfma_f32_16x16x32_bf16 v[180:183], v[36:39], v[220:223], v[180:183]
    s_waitcnt lgkmcnt(2)
    v_fma_f32 v252, v252, v48, v50
    v_fma_f32 v253, v253, v49, v51
    v_cvt_pk_bf16_f32 v238, v252, v253
    v_mfma_f32_16x16x32_bf16 v[112:115], v[40:43], v[192:195], v[112:115]
    ds_read_b128 v[32:35], v2 offset:18432
    v_lshlrev_b32 v48, 16, v61
    v_mfma_f32_16x16x32_bf16 v[112:115], v[44:47], v[196:199], v[112:115]
    v_and_b32 v49, s97, v61
    v_lshlrev_b32 v50, 16, v63
    v_and_b32 v51, s97, v63
    v_mfma_f32_16x16x32_bf16 v[116:119], v[40:43], v[216:219], v[116:119]
    ds_read_b128 v[36:39], v3 offset:18432
    v_mul_f32 v48, s38, v48
    v_mfma_f32_16x16x32_bf16 v[116:119], v[44:47], v[220:223], v[116:119]
    s_waitcnt lgkmcnt(2)
    v_mul_f32 v49, s38, v49
    v_mul_f32_e64 v50, -v50, v48
    v_mul_f32_e64 v51, -v51, v49
    v_mfma_f32_16x16x32_bf16 v[184:187], v[24:27], a[240:243], v[136:139]
    ds_read_b128 v[40:43], v2 offset:12416
    v_cvt_f32_i32 v242, v242
    v_cvt_f32_i32 v243, v243
    v_fma_f32 v242, v242, v48, v50
    v_fma_f32 v243, v243, v49, v51
    v_cvt_pk_bf16_f32 v227, v242, v243
    v_cvt_f32_i32 v246, v246
    v_cvt_f32_i32 v247, v247
    v_fma_f32 v246, v246, v48, v50
    v_fma_f32 v247, v247, v49, v51
    v_cvt_pk_bf16_f32 v231, v246, v247
    v_cvt_f32_i32 v250, v250
    v_cvt_f32_i32 v251, v251
    v_fma_f32 v250, v250, v48, v50
    v_fma_f32 v251, v251, v49, v51
    v_cvt_pk_bf16_f32 v235, v250, v251
    v_cvt_f32_i32 v254, v254
    v_cvt_f32_i32 v255, v255
    v_fma_f32 v254, v254, v48, v50
    v_fma_f32 v255, v255, v49, v51
    v_cvt_pk_bf16_f32 v239, v254, v255
    v_mfma_f32_16x16x32_bf16 v[184:187], v[28:31], a[244:247], v[184:187]
    buffer_store_dwordx4 v[224:227], v11, s[4:7], s33 offen offset:0 sc1
    v_mfma_f32_16x16x32_bf16 v[188:191], v[24:27], v[200:203], v[140:143]
    ds_read_b128 v[44:47], v3 offset:12416
    v_xor_b32 v55, 16, v11
    v_mfma_f32_16x16x32_bf16 v[188:191], v[28:31], v[204:207], v[188:191]
    s_waitcnt lgkmcnt(2)
    v_exp_f32 v16, v160
    v_mfma_f32_16x16x32_bf16 v[120:123], v[32:35], a[240:243], v[136:139]
    ds_read_b128 v[24:27], v2 offset:18560
    v_mfma_f32_16x16x32_bf16 v[120:123], v[36:39], a[244:247], v[120:123]
    buffer_store_dwordx4 v[228:231], v55, s[4:7], s33 offen offset:768 sc1
    v_mfma_f32_16x16x32_bf16 v[124:127], v[32:35], v[200:203], v[140:143]
    ds_read_b128 v[28:31], v3 offset:18560
    v_mfma_f32_16x16x32_bf16 v[124:127], v[36:39], v[204:207], v[124:127]
    s_waitcnt lgkmcnt(2)
    v_exp_f32 v17, v161
    v_mfma_f32_16x16x32_bf16 v[184:187], v[40:43], a[248:251], v[184:187]
    ds_read_b128 v[32:35], v2 offset:12544
    v_mfma_f32_16x16x32_bf16 v[184:187], v[44:47], a[252:255], v[184:187]
    v_exp_f32 v18, v162
    v_add_f32 v7, v7, v16
    v_mfma_f32_16x16x32_bf16 v[188:191], v[40:43], v[208:211], v[188:191]
    ds_read_b128 v[36:39], v3 offset:12544
    v_add_f32 v7, v7, v17
    v_mfma_f32_16x16x32_bf16 v[188:191], v[44:47], v[212:215], v[188:191]
    s_waitcnt lgkmcnt(2)
    v_exp_f32 v19, v163
    v_cvt_pk_bf16_f32 v160, v16, v17
    v_mfma_f32_16x16x32_bf16 v[120:123], v[24:27], a[248:251], v[120:123]
    ds_read_b128 v[40:43], v2 offset:18688
    v_xor_b32 v54, 32, v11
    v_mfma_f32_16x16x32_bf16 v[120:123], v[28:31], a[252:255], v[120:123]
    s_waitcnt vmcnt(4)
    v_exp_f32 v16, v96
    v_add_f32 v7, v7, v18
    v_mfma_f32_16x16x32_bf16 v[124:127], v[24:27], v[208:211], v[124:127]
    ds_read_b128 v[44:47], v3 offset:18688
    v_add_f32 v7, v7, v19
    v_mfma_f32_16x16x32_bf16 v[124:127], v[28:31], v[212:215], v[124:127]
    s_waitcnt lgkmcnt(2)
    s_barrier
    v_add_u32 v2, 49152, v2
    v_add_u32 v3, 49152, v3
    v_mfma_f32_16x16x32_bf16 v[184:187], v[32:35], v[192:195], v[184:187]
    ds_read_b128 v[24:27], v2 offset:0
    v_xor_b32 v55, 48, v11
    v_mfma_f32_16x16x32_bf16 v[184:187], v[36:39], v[196:199], v[184:187]
    buffer_store_dwordx4 v[232:235], v54, s[4:7], s33 offen offset:1536 sc1
    v_mfma_f32_16x16x32_bf16 v[188:191], v[32:35], v[216:219], v[188:191]
    ds_read_b128 v[28:31], v3 offset:0
    v_mfma_f32_16x16x32_bf16 v[188:191], v[36:39], v[220:223], v[188:191]
    s_waitcnt lgkmcnt(2)
    v_exp_f32 v17, v97
    v_cvt_pk_bf16_f32 v161, v18, v19
    v_mfma_f32_16x16x32_bf16 v[120:123], v[40:43], v[192:195], v[120:123]
    ds_read_b128 v[32:35], v2 offset:6144
    v_mfma_f32_16x16x32_bf16 v[120:123], v[44:47], v[196:199], v[120:123]
    buffer_store_dwordx4 v[236:239], v55, s[4:7], s33 offen offset:2304 sc1
    v_mfma_f32_16x16x32_bf16 v[124:127], v[40:43], v[216:219], v[124:127]
    ds_read_b128 v[36:39], v3 offset:6144
    v_mfma_f32_16x16x32_bf16 v[124:127], v[44:47], v[220:223], v[124:127]
    s_waitcnt lgkmcnt(2)
    v_exp_f32 v18, v98
    v_add_f32 v7, v7, v16
    v_add_f32 v7, v7, v17
    v_exp_f32 v19, v99
    v_cvt_pk_bf16_f32 v162, v16, v17
    v_exp_f32 v16, v164
    v_add_f32 v7, v7, v18
    v_add_f32 v7, v7, v19
    v_exp_f32 v17, v165
    v_cvt_pk_bf16_f32 v163, v18, v19
    v_exp_f32 v18, v166
    v_add_f32 v8, v8, v16
    v_add_f32 v8, v8, v17
    v_exp_f32 v19, v167
    v_cvt_pk_bf16_f32 v164, v16, v17
    v_exp_f32 v16, v100
    v_add_f32 v8, v8, v18
    v_add_f32 v8, v8, v19
    v_exp_f32 v17, v101
    v_cvt_pk_bf16_f32 v165, v18, v19
    v_exp_f32 v18, v102
    v_add_f32 v8, v8, v16
    v_add_f32 v8, v8, v17
    v_exp_f32 v19, v103
    v_cvt_pk_bf16_f32 v166, v16, v17
    v_add_f32 v8, v8, v18
    v_add_f32 v8, v8, v19
    v_cvt_pk_bf16_f32 v167, v18, v19
    v_add_f32 v168, v168, v136
    v_add_f32 v169, v169, v136
    v_add_f32 v170, v170, v136
    v_add_f32 v171, v171, v136
    v_add_f32 v104, v104, v136
    v_add_f32 v105, v105, v136
    v_add_f32 v106, v106, v136
    v_add_f32 v107, v107, v136
    v_add_f32 v172, v172, v140
    v_add_f32 v173, v173, v140
    v_add_f32 v174, v174, v140
    v_add_f32 v175, v175, v140
    v_add_f32 v108, v108, v140
    v_add_f32 v109, v109, v140
    v_add_f32 v110, v110, v140
    v_add_f32 v111, v111, v140
    v_exp_f32 v16, v168
    v_exp_f32 v17, v169
    v_exp_f32 v18, v170
    v_add_f32 v7, v7, v16
    v_add_f32 v7, v7, v17
    v_exp_f32 v19, v171
    v_cvt_pk_bf16_f32 v168, v16, v17
    v_exp_f32 v16, v104
    v_add_f32 v7, v7, v18
    v_add_f32 v7, v7, v19
    v_exp_f32 v17, v105
    v_cvt_pk_bf16_f32 v169, v18, v19
    v_exp_f32 v18, v106
    v_add_f32 v7, v7, v16
    v_add_f32 v7, v7, v17
    v_exp_f32 v19, v107
    v_cvt_pk_bf16_f32 v170, v16, v17
    v_exp_f32 v16, v172
    v_add_f32 v7, v7, v18
    v_add_f32 v7, v7, v19
    v_exp_f32 v17, v173
    v_cvt_pk_bf16_f32 v171, v18, v19
    v_exp_f32 v18, v174
    v_add_f32 v8, v8, v16
    v_add_f32 v8, v8, v17
    v_exp_f32 v19, v175
    v_cvt_pk_bf16_f32 v172, v16, v17
    v_exp_f32 v16, v108
    v_add_f32 v8, v8, v18
    v_add_f32 v8, v8, v19
    v_exp_f32 v17, v109
    v_cvt_pk_bf16_f32 v173, v18, v19
    v_exp_f32 v18, v110
    v_add_f32 v8, v8, v16
    v_add_f32 v8, v8, v17
    v_exp_f32 v19, v111
    v_cvt_pk_bf16_f32 v174, v16, v17
    v_add_f32 v8, v8, v18
    v_add_f32 v8, v8, v19
    v_cvt_pk_bf16_f32 v175, v18, v19
    v_mfma_f32_16x16x32_bf16 v[64:67], v[24:27], a[192:195], v[128:131]
    ds_read_b128 v[40:43], v2 offset:128
    v_mfma_f32_16x16x32_bf16 v[64:67], v[28:31], a[196:199], v[64:67]
    buffer_load_dwordx2 v[60:61], off, s[80:83], s37 offset:8
    v_mfma_f32_16x16x32_bf16 v[68:71], v[24:27], a[216:219], v[132:135]
    v_exp_f32 v16, v176
    v_mfma_f32_16x16x32_bf16 v[68:71], v[28:31], a[220:223], v[68:71]
    v_exp_f32 v17, v177
    v_mfma_f32_16x16x32_bf16 v[72:75], v[24:27], a[240:243], v[136:139]
    ds_read_b128 v[44:47], v3 offset:128
    v_mfma_f32_16x16x32_bf16 v[72:75], v[28:31], a[244:247], v[72:75]
    buffer_load_dwordx2 v[62:63], off, s[84:87], s37 offset:8
    v_mfma_f32_16x16x32_bf16 v[76:79], v[24:27], v[200:203], v[140:143]
    v_exp_f32 v18, v178
    v_mfma_f32_16x16x32_bf16 v[76:79], v[28:31], v[204:207], v[76:79]
    s_waitcnt lgkmcnt(2)
    v_add_f32 v7, v7, v16
    v_add_f32 v7, v7, v17
    v_mfma_f32_16x16x32_bf16 v[96:99], v[32:35], a[192:195], v[128:131]
    ds_read_b128 v[24:27], v2 offset:6272
    v_mfma_f32_16x16x32_bf16 v[96:99], v[36:39], a[196:199], v[96:99]
    buffer_load_dwordx4 v[240:243], v12, s[68:71], s16 offen offset:0 nt
    v_mfma_f32_16x16x32_bf16 v[100:103], v[32:35], a[216:219], v[132:135]
    s_waitcnt vmcnt(7)
    v_exp_f32 v19, v179
    v_mfma_f32_16x16x32_bf16 v[100:103], v[36:39], a[220:223], v[100:103]
    v_cvt_pk_bf16_f32 v176, v16, v17
    v_exp_f32 v16, v112
    v_mfma_f32_16x16x32_bf16 v[104:107], v[32:35], a[240:243], v[136:139]
    ds_read_b128 v[28:31], v3 offset:6272
    v_add_f32 v7, v7, v18
    v_mfma_f32_16x16x32_bf16 v[104:107], v[36:39], a[244:247], v[104:107]
    buffer_load_dwordx4 v[244:247], v12, s[68:71], s16 offen offset:768 nt
    v_add_f32 v7, v7, v19
    v_mfma_f32_16x16x32_bf16 v[108:111], v[32:35], v[200:203], v[140:143]
    v_exp_f32 v17, v113
    v_mfma_f32_16x16x32_bf16 v[108:111], v[36:39], v[204:207], v[108:111]
    s_waitcnt lgkmcnt(2)
    v_cvt_pk_bf16_f32 v177, v18, v19
    v_exp_f32 v18, v114
    v_mfma_f32_16x16x32_bf16 v[64:67], v[40:43], a[200:203], v[64:67]
    ds_read_b128 v[32:35], v2 offset:256
    v_add_f32 v7, v7, v16
    v_mfma_f32_16x16x32_bf16 v[64:67], v[44:47], a[204:207], v[64:67]
    buffer_load_dwordx4 v[248:251], v12, s[68:71], s16 offen offset:1536 nt
    v_add_f32 v7, v7, v17
    v_mfma_f32_16x16x32_bf16 v[68:71], v[40:43], a[224:227], v[68:71]
    v_exp_f32 v19, v115
    v_mfma_f32_16x16x32_bf16 v[68:71], v[44:47], a[228:231], v[68:71]
    v_cvt_pk_bf16_f32 v178, v16, v17
    v_exp_f32 v16, v180
    v_mfma_f32_16x16x32_bf16 v[72:75], v[40:43], a[248:251], v[72:75]
    ds_read_b128 v[36:39], v3 offset:256
    v_add_f32 v7, v7, v18
    v_mfma_f32_16x16x32_bf16 v[72:75], v[44:47], a[252:255], v[72:75]
    buffer_load_dwordx4 v[252:255], v12, s[68:71], s16 offen offset:2304 nt
    v_add_f32 v7, v7, v19
    v_mfma_f32_16x16x32_bf16 v[76:79], v[40:43], v[208:211], v[76:79]
    v_exp_f32 v17, v181
    v_mfma_f32_16x16x32_bf16 v[76:79], v[44:47], v[212:215], v[76:79]
    s_waitcnt lgkmcnt(2)
    v_cvt_pk_bf16_f32 v179, v18, v19
    v_exp_f32 v18, v182
    v_mfma_f32_16x16x32_bf16 v[96:99], v[24:27], a[200:203], v[96:99]
    s_mov_b32 m0, s26
    ds_read_b128 v[40:43], v2 offset:6400
    v_add_f32 v8, v8, v16
    v_mfma_f32_16x16x32_bf16 v[96:99], v[28:31], a[204:207], v[96:99]
    buffer_load_dwordx4 v4, s[4:7], s32 offen offset:0 sc1 lds
    v_add_f32 v8, v8, v17
    v_mfma_f32_16x16x32_bf16 v[100:103], v[24:27], a[224:227], v[100:103]
    v_exp_f32 v19, v183
    v_mfma_f32_16x16x32_bf16 v[100:103], v[28:31], a[228:231], v[100:103]
    v_cvt_pk_bf16_f32 v180, v16, v17
    v_exp_f32 v16, v116
    v_mfma_f32_16x16x32_bf16 v[104:107], v[24:27], a[248:251], v[104:107]
    ds_read_b128 v[44:47], v3 offset:6400
    v_add_f32 v8, v8, v18
    v_mfma_f32_16x16x32_bf16 v[104:107], v[28:31], a[252:255], v[104:107]
    buffer_load_dwordx4 v4, s[4:7], s32 offen offset:1024 sc1 lds
    v_add_f32 v8, v8, v19
    v_mfma_f32_16x16x32_bf16 v[108:111], v[24:27], v[208:211], v[108:111]
    v_exp_f32 v17, v117
    v_mfma_f32_16x16x32_bf16 v[108:111], v[28:31], v[212:215], v[108:111]
    s_waitcnt lgkmcnt(2)
    v_cvt_pk_bf16_f32 v181, v18, v19
    v_exp_f32 v18, v118
    v_mfma_f32_16x16x32_bf16 v[64:67], v[32:35], a[208:211], v[64:67]
    ds_read_b128 v[24:27], v2 offset:12288
    v_add_f32 v8, v8, v16
    v_mfma_f32_16x16x32_bf16 v[64:67], v[36:39], a[212:215], v[64:67]
    buffer_load_dwordx4 v4, s[4:7], s32 offen offset:2048 sc1 lds
    v_add_f32 v8, v8, v17
    v_mfma_f32_16x16x32_bf16 v[68:71], v[32:35], a[232:235], v[68:71]
    s_add_u32 s32, s32, 24576
    v_exp_f32 v19, v119
    v_mfma_f32_16x16x32_bf16 v[68:71], v[36:39], a[236:239], v[68:71]
    v_cvt_pk_bf16_f32 v182, v16, v17
    v_add_f32 v8, v8, v18
    v_add_f32 v8, v8, v19
    v_mfma_f32_16x16x32_bf16 v[72:75], v[32:35], v[192:195], v[72:75]
    s_sub_u32 s57, s32, 196608
    ds_read_b128 v[28:31], v3 offset:12288
    v_cvt_pk_bf16_f32 v183, v18, v19
    v_mfma_f32_16x16x32_bf16 v[72:75], v[36:39], v[196:199], v[72:75]
    s_waitcnt lgkmcnt(2)
    v_exp_f32 v16, v184
    v_lshlrev_b32 v48, 16, v56
    v_mfma_f32_16x16x32_bf16 v[76:79], v[32:35], v[216:219], v[76:79]
    s_waitcnt vmcnt(9)
    v_exp_f32 v17, v185
    v_mfma_f32_16x16x32_bf16 v[76:79], v[36:39], v[220:223], v[76:79]
    s_barrier
    v_exp_f32 v18, v186
    v_mfma_f32_16x16x32_bf16 v[96:99], v[40:43], a[208:211], v[96:99]
    s_min_u32 s32, s32, s57
    ds_read_b128 v[32:35], v2 offset:18432
    v_add_f32 v7, v7, v16
    v_mfma_f32_16x16x32_bf16 v[96:99], v[44:47], a[212:215], v[96:99]
    v_add_f32 v7, v7, v17
    v_exp_f32 v19, v187
    v_mfma_f32_16x16x32_bf16 v[100:103], v[40:43], a[232:235], v[100:103]
    s_add_u32 s26, s26, 12288
    v_cvt_pk_bf16_f32 v184, v16, v17
    v_and_b32 v49, s97, v56
    v_mfma_f32_16x16x32_bf16 v[100:103], v[44:47], a[236:239], v[100:103]
    v_exp_f32 v16, v120
    v_add_f32 v7, v7, v18
    v_mfma_f32_16x16x32_bf16 v[104:107], v[40:43], v[192:195], v[104:107]
    s_mov_b32 m0, s26
    ds_read_b128 v[36:39], v3 offset:18432
    v_add_f32 v7, v7, v19
    v_mfma_f32_16x16x32_bf16 v[104:107], v[44:47], v[196:199], v[104:107]
    buffer_load_dwordx4 v4, s[4:7], s32 offen offset:0 sc1 lds
    v_lshlrev_b32 v50, 16, v58
    v_mfma_f32_16x16x32_bf16 v[108:111], v[40:43], v[216:219], v[108:111]
    v_exp_f32 v17, v121
    v_mfma_f32_16x16x32_bf16 v[108:111], v[44:47], v[220:223], v[108:111]
    s_waitcnt lgkmcnt(2)
    v_cvt_pk_bf16_f32 v185, v18, v19
    v_exp_f32 v18, v122
    v_mfma_f32_16x16x32_bf16 v[80:83], v[24:27], a[192:195], v[128:131]
    ds_read_b128 v[40:43], v2 offset:12416
    v_add_f32 v7, v7, v16
    v_mfma_f32_16x16x32_bf16 v[80:83], v[28:31], a[196:199], v[80:83]
    buffer_load_dwordx4 v4, s[4:7], s32 offen offset:1024 sc1 lds
    v_add_f32 v7, v7, v17
    v_mfma_f32_16x16x32_bf16 v[84:87], v[24:27], a[216:219], v[132:135]
    v_exp_f32 v19, v123
    v_mfma_f32_16x16x32_bf16 v[84:87], v[28:31], a[220:223], v[84:87]
    v_cvt_pk_bf16_f32 v186, v16, v17
    v_exp_f32 v16, v188
    v_mfma_f32_16x16x32_bf16 v[88:91], v[24:27], a[240:243], v[136:139]
    ds_read_b128 v[44:47], v3 offset:12416
    v_add_f32 v7, v7, v18
    v_mfma_f32_16x16x32_bf16 v[88:91], v[28:31], a[244:247], v[88:91]
    v_add_u32 v0, 1, v0
    buffer_store_dword v0, v13, s[20:23], 0 offen offset:32 sc1
    v_mfma_f32_16x16x32_bf16 v[92:95], v[24:27], v[200:203], v[140:143]
    v_add_f32 v7, v7, v19
    v_exp_f32 v17, v189
    v_cvt_pk_bf16_f32 v187, v18, v19
    v_exp_f32 v18, v190
    v_add_f32 v8, v8, v16
    v_add_f32 v8, v8, v17
    v_exp_f32 v19, v191
    v_cvt_pk_bf16_f32 v188, v16, v17
    v_exp_f32 v16, v124
    v_add_f32 v8, v8, v18
    v_add_f32 v8, v8, v19
    v_exp_f32 v17, v125
    v_cvt_pk_bf16_f32 v189, v18, v19
    v_exp_f32 v18, v126
    v_add_f32 v8, v8, v16
    v_add_f32 v8, v8, v17
    v_exp_f32 v19, v127
    v_cvt_pk_bf16_f32 v190, v16, v17
    v_add_f32 v8, v8, v18
    v_add_f32 v8, v8, v19
    v_cvt_pk_bf16_f32 v191, v18, v19
    v_mfma_f32_16x16x32_bf16 v[92:95], v[28:31], v[204:207], v[92:95]
    s_waitcnt lgkmcnt(2)
    v_and_b32 v51, s97, v58
    v_mul_f32_e64 v50, -v50, v48
    v_mul_f32_e64 v51, -v51, v49
    v_mfma_f32_16x16x32_bf16 v[112:115], v[32:35], a[192:195], v[128:131]
    ds_read_b128 v[24:27], v2 offset:18560
    v_cvt_f32_i32 v144, v144
    v_mfma_f32_16x16x32_bf16 v[112:115], v[36:39], a[196:199], v[112:115]
    buffer_load_dwordx4 v4, s[4:7], s32 offen offset:2048 sc1 lds
    v_cvt_f32_i32 v148, v148
    v_mfma_f32_16x16x32_bf16 v[116:119], v[32:35], a[216:219], v[132:135]
    s_mov_b32 s32, 196608
    v_fma_f32 v144, v144, v48, v50
    v_fma_f32 v148, v148, v49, v51
    v_mfma_f32_16x16x32_bf16 v[116:119], v[36:39], a[220:223], v[116:119]
    v_cvt_f32_i32 v145, v145
    v_cvt_f32_i32 v149, v149
    v_fma_f32 v145, v145, v48, v50
    v_mfma_f32_16x16x32_bf16 v[120:123], v[32:35], a[240:243], v[136:139]
    s_add_u32 s26, s26, 36864
    ds_read_b128 v[28:31], v3 offset:18560
    v_fma_f32 v149, v149, v49, v51
    v_mfma_f32_16x16x32_bf16 v[120:123], v[36:39], a[244:247], v[120:123]
    v_cvt_f32_i32 v146, v146
    v_cvt_f32_i32 v150, v150
    v_fma_f32 v146, v146, v48, v50
    v_mfma_f32_16x16x32_bf16 v[124:127], v[32:35], v[200:203], v[140:143]
    s_sub_u32 s57, s26, 147456
    v_fma_f32 v150, v150, v49, v51
    v_cvt_f32_i32 v147, v147
    v_mfma_f32_16x16x32_bf16 v[124:127], v[36:39], v[204:207], v[124:127]
    s_waitcnt lgkmcnt(2)
    v_cvt_f32_i32 v151, v151
    v_exp_f32 v16, v64
    v_mfma_f32_16x16x32_bf16 v[80:83], v[40:43], a[200:203], v[80:83]
    s_min_u32 s26, s26, s57
    ds_read_b128 v[32:35], v2 offset:12544
    v_fma_f32 v147, v147, v48, v50
    v_mfma_f32_16x16x32_bf16 v[80:83], v[44:47], a[204:207], v[80:83]
    v_exp_f32 v17, v65
    v_fma_f32 v151, v151, v49, v51
    v_mfma_f32_16x16x32_bf16 v[84:87], v[40:43], a[224:227], v[84:87]
    s_mov_b32 m0, s56
    v_exp_f32 v18, v66
    v_mfma_f32_16x16x32_bf16 v[84:87], v[44:47], a[228:231], v[84:87]
    buffer_load_dwordx4 v4, s[4:7], s27 offen offset:0 sc1 lds
    v_lshlrev_b32 v48, 16, v57
    v_mfma_f32_16x16x32_bf16 v[88:91], v[40:43], a[248:251], v[88:91]
    ds_read_b128 v[36:39], v3 offset:12544
    v_add_f32 v5, v5, v16
    v_mfma_f32_16x16x32_bf16 v[88:91], v[44:47], a[252:255], v[88:91]
    v_add_f32 v5, v5, v17
    v_and_b32 v49, s97, v57
    v_lshlrev_b32 v50, 16, v59
    v_mfma_f32_16x16x32_bf16 v[92:95], v[40:43], v[208:211], v[92:95]
    v_exp_f32 v19, v67
    v_mfma_f32_16x16x32_bf16 v[92:95], v[44:47], v[212:215], v[92:95]
    s_waitcnt lgkmcnt(2)
    buffer_load_dwordx4 v4, s[4:7], s27 offen offset:1024 sc1 lds
    v_cvt_pk_bf16_f32 v64, v16, v17
    v_mfma_f32_16x16x32_bf16 v[112:115], v[24:27], a[200:203], v[112:115]
    ds_read_b128 v[40:43], v2 offset:18688
    v_and_b32 v51, s97, v59
    v_mfma_f32_16x16x32_bf16 v[112:115], v[28:31], a[204:207], v[112:115]
    v_exp_f32 v16, v96
    v_add_f32 v5, v5, v18
    v_mfma_f32_16x16x32_bf16 v[116:119], v[24:27], a[224:227], v[116:119]
    v_add_f32 v5, v5, v19
    v_mul_f32_e64 v50, -v50, v48
    v_mfma_f32_16x16x32_bf16 v[116:119], v[28:31], a[228:231], v[116:119]
    s_waitcnt vmcnt(13)
    buffer_load_dwordx4 v4, s[4:7], s27 offen offset:2048 sc1 lds
    v_mul_f32_e64 v51, -v51, v49
    v_mfma_f32_16x16x32_bf16 v[120:123], v[24:27], a[248:251], v[120:123]
    s_add_u32 s27, s27, 24576
    ds_read_b128 v[44:47], v3 offset:18688
    v_cvt_f32_i32 v152, v152
    v_mfma_f32_16x16x32_bf16 v[120:123], v[28:31], a[252:255], v[120:123]
    s_waitcnt lgkmcnt(2)
    v_exp_f32 v17, v97
    v_cvt_pk_bf16_f32 v65, v18, v19
    v_mfma_f32_16x16x32_bf16 v[124:127], v[24:27], v[208:211], v[124:127]
    s_sub_u32 s58, s27, 196608
    v_exp_f32 v18, v98
    v_mfma_f32_16x16x32_bf16 v[124:127], v[28:31], v[212:215], v[124:127]
    s_barrier
    v_subrev_u32 v1, 49152, v1
    v_add_f32 v5, v5, v16
    v_mfma_f32_16x16x32_bf16 v[80:83], v[32:35], a[208:211], v[80:83]
    s_min_u32 s27, s27, s58
    ds_read_b128 v[24:27], v1 offset:0
    v_add_f32 v5, v5, v17
    v_mfma_f32_16x16x32_bf16 v[80:83], v[36:39], a[212:215], v[80:83]
    v_exp_f32 v19, v99
    v_cvt_f32_i32 v156, v156
    v_mfma_f32_16x16x32_bf16 v[84:87], v[32:35], a[232:235], v[84:87]
    s_add_u32 s56, s56, 12288
    v_cvt_pk_bf16_f32 v66, v16, v17
    v_fma_f32 v152, v152, v48, v50
    v_mfma_f32_16x16x32_bf16 v[84:87], v[36:39], a[236:239], v[84:87]
    v_exp_f32 v16, v68
    v_fma_f32 v156, v156, v49, v51
    v_mfma_f32_16x16x32_bf16 v[88:91], v[32:35], v[192:195], v[88:91]
    s_mov_b32 m0, s56
    ds_read_b128 v[28:31], v1 offset:12288
    v_add_f32 v5, v5, v18
    v_mfma_f32_16x16x32_bf16 v[88:91], v[36:39], v[196:199], v[88:91]
    s_waitcnt vmcnt(12)
    buffer_load_dwordx4 v4, s[4:7], s27 offen offset:0 sc1 lds
    v_add_f32 v5, v5, v19
    v_mfma_f32_16x16x32_bf16 v[92:95], v[32:35], v[216:219], v[92:95]
    v_exp_f32 v17, v69
    v_mfma_f32_16x16x32_bf16 v[92:95], v[36:39], v[220:223], v[92:95]
    s_waitcnt lgkmcnt(2)
    v_cvt_f32_i32 v153, v153
    v_cvt_pk_bf16_f32 v67, v18, v19
    v_cvt_f32_i32 v157, v157
    v_mfma_f32_16x16x32_bf16 v[112:115], v[40:43], a[208:211], v[112:115]
    ds_read_b128 v[32:35], v1 offset:1024
    v_fma_f32 v153, v153, v48, v50
    v_mfma_f32_16x16x32_bf16 v[112:115], v[44:47], a[212:215], v[112:115]
    s_waitcnt vmcnt(12)
    buffer_load_dwordx4 v4, s[4:7], s27 offen offset:1024 sc1 lds
    v_fma_f32 v157, v157, v49, v51
    v_mfma_f32_16x16x32_bf16 v[116:119], v[40:43], a[232:235], v[116:119]
    s_waitcnt vmcnt(12)
    buffer_load_dwordx4 v4, s[4:7], s27 offen offset:2048 sc1 lds
    v_mfma_f32_16x16x32_bf16 v[116:119], v[44:47], a[236:239], v[116:119]
    v_exp_f32 v18, v70
    v_add_f32 v6, v6, v16
    v_mfma_f32_16x16x32_bf16 v[120:123], v[40:43], v[192:195], v[120:123]
    s_add_u32 s27, s27, 24576
    ds_read_b128 v[36:39], v1 offset:13312
    v_add_f32 v6, v6, v17
    v_mfma_f32_16x16x32_bf16 v[120:123], v[44:47], v[196:199], v[120:123]
    v_exp_f32 v19, v71
    v_cvt_pk_bf16_f32 v68, v16, v17
    v_mfma_f32_16x16x32_bf16 v[124:127], v[40:43], v[216:219], v[124:127]
    s_sub_u32 s58, s27, 196608
    v_exp_f32 v16, v100
    v_mfma_f32_16x16x32_bf16 v[124:127], v[44:47], v[220:223], v[124:127]
    s_waitcnt lgkmcnt(2)
    v_cvt_f32_i32 v154, v154
    v_add_f32 v6, v6, v18
    v_cvt_f32_i32 v158, v158
    v_add_f32 v6, v6, v19
    v_fma_f32 v154, v154, v48, v50
    v_exp_f32 v17, v101
    v_fma_f32 v158, v158, v49, v51
    v_cvt_f32_i32 v155, v155
    v_cvt_pk_bf16_f32 v69, v18, v19
    v_cvt_f32_i32 v159, v159
    v_exp_f32 v18, v102
    v_fma_f32 v155, v155, v48, v50
    v_fma_f32 v159, v159, v49, v51
    v_add_f32 v6, v6, v16
    v_cvt_pk_bf16_f32 v144, v144, v148
    v_add_f32 v6, v6, v17
    v_cvt_pk_bf16_f32 v148, v145, v149
    v_exp_f32 v19, v103
    v_cvt_pk_bf16_f32 v145, v152, v156
    v_cvt_pk_bf16_f32 v149, v153, v157
    v_cvt_pk_bf16_f32 v70, v16, v17
    s_min_u32 s27, s27, s58
    v_cvt_pk_bf16_f32 v152, v146, v150
    v_add_f32 v6, v6, v18
    s_add_u32 s56, s56, 36864
    v_cvt_pk_bf16_f32 v153, v154, v158
    v_add_f32 v6, v6, v19
    s_sub_u32 s58, s56, 147456
    v_cvt_pk_bf16_f32 v156, v147, v151
    v_cvt_pk_bf16_f32 v71, v18, v19
    s_min_u32 s56, s56, s58
    v_cvt_pk_bf16_f32 v157, v155, v159
    s_mov_b32 s31, 7
    v_mfma_f32_16x16x32_bf16 a[96:99], v[160:163], v[24:27], 0
    s_add_u32 s33, s33, 196608
    ds_read_b128 v[40:43], v1 offset:2048
    v_mfma_f32_16x16x32_bf16 a[96:99], v[168:171], v[28:31], a[96:99]
    s_add_u32 s34, s34, 196608
    v_exp_f32 v16, v72
    v_mfma_f32_16x16x32_bf16 a[144:147], v[164:167], v[24:27], 0
    s_add_u32 s36, s36, 1536
    ds_read_b128 v[44:47], v1 offset:14336
    v_mfma_f32_16x16x32_bf16 a[144:147], v[172:175], v[28:31], a[144:147]
    s_waitcnt lgkmcnt(2)
    v_exp_f32 v17, v73
    v_mfma_f32_16x16x32_bf16 a[100:103], v[160:163], v[32:35], 0
    ds_read_b128 v[24:27], v1 offset:3072
    v_mfma_f32_16x16x32_bf16 a[100:103], v[168:171], v[36:39], a[100:103]
    s_waitcnt vmcnt(12)
    buffer_load_dwordx2 v[56:57], v10, s[72:75], s36 offen offset:0
    v_mfma_f32_16x16x32_bf16 a[148:151], v[164:167], v[32:35], 0
    ds_read_b128 v[28:31], v1 offset:15360
    v_mfma_f32_16x16x32_bf16 a[148:151], v[172:175], v[36:39], a[148:151]
    s_waitcnt lgkmcnt(2)
    v_exp_f32 v18, v74
    v_mfma_f32_16x16x32_bf16 a[104:107], v[160:163], v[40:43], 0
    ds_read_b128 v[32:35], v1 offset:4096
    v_add_f32 v7, v7, v16
    v_mfma_f32_16x16x32_bf16 a[104:107], v[168:171], v[44:47], a[104:107]
    buffer_load_dwordx2 v[58:59], v10, s[76:79], s36 offen offset:0
    v_mfma_f32_16x16x32_bf16 a[152:155], v[164:167], v[40:43], 0
    ds_read_b128 v[36:39], v1 offset:16384
    v_add_f32 v7, v7, v17
    v_mfma_f32_16x16x32_bf16 a[152:155], v[172:175], v[44:47], a[152:155]
    s_waitcnt lgkmcnt(2)
    v_exp_f32 v19, v75
    v_mfma_f32_16x16x32_bf16 a[108:111], v[160:163], v[24:27], 0
    ds_read_b128 v[40:43], v1 offset:5120
    v_cvt_pk_bf16_f32 v72, v16, v17
    v_mfma_f32_16x16x32_bf16 a[108:111], v[168:171], v[28:31], a[108:111]
    s_waitcnt vmcnt(13)
    buffer_load_dwordx4 v[224:227], v9, s[64:67], s33 offen offset:0 nt
    v_mfma_f32_16x16x32_bf16 a[156:159], v[164:167], v[24:27], 0
    ds_read_b128 v[44:47], v1 offset:17408
    v_mfma_f32_16x16x32_bf16 a[156:159], v[172:175], v[28:31], a[156:159]
    s_waitcnt lgkmcnt(2)
    v_exp_f32 v16, v104
    v_mfma_f32_16x16x32_bf16 a[112:115], v[160:163], v[32:35], 0
    ds_read_b128 v[24:27], v1 offset:6144
    v_add_f32 v7, v7, v18
    v_mfma_f32_16x16x32_bf16 a[112:115], v[168:171], v[36:39], a[112:115]
    s_waitcnt vmcnt(13)
    buffer_load_dwordx4 v[228:231], v9, s[64:67], s33 offen offset:1536 nt
    v_add_f32 v7, v7, v19
    v_mfma_f32_16x16x32_bf16 a[160:163], v[164:167], v[32:35], 0
    ds_read_b128 v[28:31], v1 offset:18432
    v_mfma_f32_16x16x32_bf16 a[160:163], v[172:175], v[36:39], a[160:163]
    s_waitcnt lgkmcnt(2)
    v_exp_f32 v17, v105
    v_cvt_pk_bf16_f32 v73, v18, v19
    v_mfma_f32_16x16x32_bf16 a[116:119], v[160:163], v[40:43], 0
    ds_read_b128 v[32:35], v1 offset:7168
    v_mfma_f32_16x16x32_bf16 a[116:119], v[168:171], v[44:47], a[116:119]
    buffer_load_dwordx4 v[232:235], v9, s[64:67], s34 offen offset:0 nt
    v_mfma_f32_16x16x32_bf16 a[164:167], v[164:167], v[40:43], 0
    ds_read_b128 v[36:39], v1 offset:19456
    v_mfma_f32_16x16x32_bf16 a[164:167], v[172:175], v[44:47], a[164:167]
    s_waitcnt lgkmcnt(2)
    v_exp_f32 v18, v106
    v_add_f32 v7, v7, v16
    v_mfma_f32_16x16x32_bf16 a[120:123], v[160:163], v[24:27], 0
    ds_read_b128 v[40:43], v1 offset:8192
    v_add_f32 v7, v7, v17
    v_mfma_f32_16x16x32_bf16 a[120:123], v[168:171], v[28:31], a[120:123]
    s_waitcnt vmcnt(14)
    buffer_load_dwordx4 v[236:239], v9, s[64:67], s34 offen offset:1536 nt
    v_mfma_f32_16x16x32_bf16 a[168:171], v[164:167], v[24:27], 0
    ds_read_b128 v[44:47], v1 offset:20480
    v_mfma_f32_16x16x32_bf16 a[168:171], v[172:175], v[28:31], a[168:171]
    s_waitcnt lgkmcnt(2)
    v_exp_f32 v19, v107
    v_cvt_pk_bf16_f32 v74, v16, v17
    v_mfma_f32_16x16x32_bf16 a[124:127], v[160:163], v[32:35], 0
    ds_read_b128 v[24:27], v1 offset:9216
    v_mfma_f32_16x16x32_bf16 a[124:127], v[168:171], v[36:39], a[124:127]
    v_exp_f32 v16, v76
    v_add_f32 v7, v7, v18
    v_mfma_f32_16x16x32_bf16 a[172:175], v[164:167], v[32:35], 0
    s_waitcnt vmcnt(19)
    ds_read_b128 v[28:31], v1 offset:21504
    v_add_f32 v7, v7, v19
    v_mfma_f32_16x16x32_bf16 a[172:175], v[172:175], v[36:39], a[172:175]
    s_waitcnt lgkmcnt(2)
    v_exp_f32 v17, v77
    v_cvt_pk_bf16_f32 v75, v18, v19
    v_mfma_f32_16x16x32_bf16 a[128:131], v[160:163], v[40:43], 0
    s_add_u32 s29, s28, 49152
    ds_read_b128 v[32:35], v1 offset:10240
    v_lshlrev_b32 v48, 16, v60
    v_mfma_f32_16x16x32_bf16 a[128:131], v[168:171], v[44:47], a[128:131]
    v_exp_f32 v18, v78
    v_add_f32 v8, v8, v16
    v_mfma_f32_16x16x32_bf16 a[176:179], v[164:167], v[40:43], 0
    s_sub_u32 s3, s29, 147456
    ds_read_b128 v[36:39], v1 offset:22528
    v_add_f32 v8, v8, v17
    v_mfma_f32_16x16x32_bf16 a[176:179], v[172:175], v[44:47], a[176:179]
    s_waitcnt lgkmcnt(2)
    v_exp_f32 v19, v79
    v_mfma_f32_16x16x32_bf16 a[132:135], v[160:163], v[24:27], 0
    s_min_u32 s29, s29, s3
    ds_read_b128 v[40:43], v1 offset:11264
    v_cvt_pk_bf16_f32 v76, v16, v17
    v_mfma_f32_16x16x32_bf16 a[132:135], v[168:171], v[28:31], a[132:135]
    v_exp_f32 v16, v108
    v_mfma_f32_16x16x32_bf16 a[180:183], v[164:167], v[24:27], 0
    s_sub_u32 s3, s29, s28
    ds_read_b128 v[44:47], v1 offset:23552
    v_and_b32 v49, s97, v60
    v_mfma_f32_16x16x32_bf16 a[180:183], v[172:175], v[28:31], a[180:183]
    s_waitcnt lgkmcnt(2)
    v_add_u32 v1, 49152, v1
    v_add_f32 v8, v8, v18
    v_mfma_f32_16x16x32_bf16 a[136:139], v[160:163], v[32:35], 0
    ds_read_b128 v[24:27], v1 offset:0
    v_add_f32 v8, v8, v19
    v_mfma_f32_16x16x32_bf16 a[136:139], v[168:171], v[36:39], a[136:139]
    v_lshlrev_b32 v50, 16, v62
    v_exp_f32 v17, v109
    v_mfma_f32_16x16x32_bf16 a[184:187], v[164:167], v[32:35], 0
    ds_read_b128 v[28:31], v1 offset:12288
    v_and_b32 v51, s97, v62
    v_mfma_f32_16x16x32_bf16 a[184:187], v[172:175], v[36:39], a[184:187]
    s_waitcnt lgkmcnt(2)
    v_cvt_pk_bf16_f32 v77, v18, v19
    v_mul_f32_e64 v50, -v50, v48
    v_mfma_f32_16x16x32_bf16 a[140:143], v[160:163], v[40:43], 0
    s_mov_b32 s28, s29
    ds_read_b128 v[32:35], v1 offset:1024
    v_bfe_u32 v53, v4, 4, 6
    v_mfma_f32_16x16x32_bf16 a[140:143], v[168:171], v[44:47], a[140:143]
    v_exp_f32 v18, v110
    v_mul_f32_e64 v51, -v51, v49
    v_mfma_f32_16x16x32_bf16 a[188:191], v[164:167], v[40:43], 0
    ds_read_b128 v[36:39], v1 offset:13312
    v_lshlrev_b32 v53, 2, v53
    v_mfma_f32_16x16x32_bf16 a[188:191], v[172:175], v[44:47], a[188:191]
    s_waitcnt lgkmcnt(2)
    s_barrier
    v_add_f32 v8, v8, v16
    v_mfma_f32_16x16x32_bf16 a[96:99], v[176:179], v[24:27], a[96:99]
    ds_read_b128 v[40:43], v1 offset:2048
    buffer_load_dword v52, v53, s[20:23], s44 offen sc1
    v_mfma_f32_16x16x32_bf16 a[96:99], v[184:187], v[28:31], a[96:99]
    v_add_f32 v8, v8, v17
    v_cvt_f32_i32 v240, v240
    v_cvt_f32_i32 v244, v244
    v_mfma_f32_16x16x32_bf16 a[144:147], v[180:183], v[24:27], a[144:147]
    ds_read_b128 v[44:47], v1 offset:14336
    v_fma_f32 v240, v240, v48, v50
    v_mfma_f32_16x16x32_bf16 a[144:147], v[188:191], v[28:31], a[144:147]
    s_waitcnt lgkmcnt(2)
    v_exp_f32 v19, v111
    v_cvt_pk_bf16_f32 v78, v16, v17
    v_mfma_f32_16x16x32_bf16 a[100:103], v[176:179], v[32:35], a[100:103]
    s_mov_b32 m0, s56
    ds_read_b128 v[24:27], v1 offset:3072
    v_add_f32 v8, v8, v18
    v_mfma_f32_16x16x32_bf16 a[100:103], v[184:187], v[36:39], a[100:103]
    s_waitcnt vmcnt(15)
    buffer_load_dwordx4 v4, s[4:7], s27 offen offset:0 sc1 lds
    v_add_f32 v8, v8, v19
    v_mfma_f32_16x16x32_bf16 a[148:151], v[180:183], v[32:35], a[148:151]
    ds_read_b128 v[28:31], v1 offset:15360
    v_fma_f32 v244, v244, v49, v51
    v_mfma_f32_16x16x32_bf16 a[148:151], v[188:191], v[36:39], a[148:151]
    s_waitcnt lgkmcnt(2)
    v_cvt_pk_bf16_f32 v79, v18, v19
    v_cvt_f32_i32 v241, v241
    v_cvt_f32_i32 v245, v245
    v_mfma_f32_16x16x32_bf16 a[104:107], v[176:179], v[40:43], a[104:107]
    ds_read_b128 v[32:35], v1 offset:4096
    v_fma_f32 v241, v241, v48, v50
    v_mfma_f32_16x16x32_bf16 a[104:107], v[184:187], v[44:47], a[104:107]
    s_waitcnt vmcnt(14)
    buffer_load_dwordx4 v4, s[4:7], s27 offen offset:1024 sc1 lds
    v_fma_f32 v245, v245, v49, v51
    v_mfma_f32_16x16x32_bf16 a[152:155], v[180:183], v[40:43], a[152:155]
    ds_read_b128 v[36:39], v1 offset:16384
    v_cvt_f32_i32 v242, v242
    v_mfma_f32_16x16x32_bf16 a[152:155], v[188:191], v[44:47], a[152:155]
    s_waitcnt lgkmcnt(2)
    v_exp_f32 v16, v80
    v_cvt_f32_i32 v246, v246
    v_mfma_f32_16x16x32_bf16 a[108:111], v[176:179], v[24:27], a[108:111]
    ds_read_b128 v[40:43], v1 offset:5120
    v_fma_f32 v242, v242, v48, v50
    v_mfma_f32_16x16x32_bf16 a[108:111], v[184:187], v[28:31], a[108:111]
    s_waitcnt vmcnt(14)
    buffer_load_dwordx4 v4, s[4:7], s27 offen offset:2048 sc1 lds
    v_fma_f32 v246, v246, v49, v51
    v_mfma_f32_16x16x32_bf16 a[156:159], v[180:183], v[24:27], a[156:159]
    s_add_u32 s27, s27, 24576
    ds_read_b128 v[44:47], v1 offset:17408
    v_cvt_f32_i32 v243, v243
    v_mfma_f32_16x16x32_bf16 a[156:159], v[188:191], v[28:31], a[156:159]
    s_waitcnt lgkmcnt(2)
    v_exp_f32 v17, v81
    v_cvt_f32_i32 v247, v247
    v_mfma_f32_16x16x32_bf16 a[112:115], v[176:179], v[32:35], a[112:115]
    s_sub_u32 s58, s27, 196608
    ds_read_b128 v[24:27], v1 offset:6144
    v_fma_f32 v243, v243, v48, v50
    v_mfma_f32_16x16x32_bf16 a[112:115], v[184:187], v[36:39], a[112:115]
    v_exp_f32 v18, v82
    v_add_f32 v5, v5, v16
    v_mfma_f32_16x16x32_bf16 a[160:163], v[180:183], v[32:35], a[160:163]
    s_min_u32 s27, s27, s58
    ds_read_b128 v[28:31], v1 offset:18432
    v_add_f32 v5, v5, v17
    v_mfma_f32_16x16x32_bf16 a[160:163], v[188:191], v[36:39], a[160:163]
    s_waitcnt lgkmcnt(2)
    v_exp_f32 v19, v83
    v_cvt_pk_bf16_f32 v80, v16, v17
    v_mfma_f32_16x16x32_bf16 a[116:119], v[176:179], v[40:43], a[116:119]
    s_add_u32 s56, s56, 12288
    ds_read_b128 v[32:35], v1 offset:7168
    v_fma_f32 v247, v247, v49, v51
    v_mfma_f32_16x16x32_bf16 a[116:119], v[184:187], v[44:47], a[116:119]
    v_exp_f32 v16, v112
    v_add_f32 v5, v5, v18
    v_mfma_f32_16x16x32_bf16 a[164:167], v[180:183], v[40:43], a[164:167]
    ds_read_b128 v[36:39], v1 offset:19456
    v_add_u32 v2, s3, v2
    v_add_u32 v3, s3, v3
    v_mfma_f32_16x16x32_bf16 a[164:167], v[188:191], v[44:47], a[164:167]
    s_waitcnt lgkmcnt(2)
    v_add_f32 v5, v5, v19
    v_exp_f32 v17, v113
    v_mfma_f32_16x16x32_bf16 a[120:123], v[176:179], v[24:27], a[120:123]
    s_mov_b32 m0, s56
    ds_read_b128 v[40:43], v1 offset:8192
    v_cvt_pk_bf16_f32 v81, v18, v19
    v_mfma_f32_16x16x32_bf16 a[120:123], v[184:187], v[28:31], a[120:123]
    s_waitcnt vmcnt(14)
    buffer_load_dwordx4 v4, s[4:7], s27 offen offset:0 sc1 lds
    v_lshlrev_b32 v48, 16, v61
    v_mfma_f32_16x16x32_bf16 a[168:171], v[180:183], v[24:27], a[168:171]
    ds_read_b128 v[44:47], v1 offset:20480
    v_and_b32 v49, s97, v61
    v_mfma_f32_16x16x32_bf16 a[168:171], v[188:191], v[28:31], a[168:171]
    s_waitcnt lgkmcnt(2)
    v_exp_f32 v18, v114
    v_add_f32 v5, v5, v16
    v_mfma_f32_16x16x32_bf16 a[124:127], v[176:179], v[32:35], a[124:127]
    ds_read_b128 v[24:27], v1 offset:9216
    v_add_f32 v5, v5, v17
    v_mfma_f32_16x16x32_bf16 a[124:127], v[184:187], v[36:39], a[124:127]
    s_waitcnt vmcnt(14)
    buffer_load_dwordx4 v4, s[4:7], s27 offen offset:1024 sc1 lds
    v_lshlrev_b32 v50, 16, v63
    v_mfma_f32_16x16x32_bf16 a[172:175], v[180:183], v[32:35], a[172:175]
    ds_read_b128 v[28:31], v1 offset:21504
    v_and_b32 v51, s97, v63
    v_mfma_f32_16x16x32_bf16 a[172:175], v[188:191], v[36:39], a[172:175]
    s_waitcnt lgkmcnt(2)
    v_exp_f32 v19, v115
    v_cvt_pk_bf16_f32 v82, v16, v17
    v_mfma_f32_16x16x32_bf16 a[128:131], v[176:179], v[40:43], a[128:131]
    ds_read_b128 v[32:35], v1 offset:10240
    v_mul_f32_e64 v50, -v50, v48
    v_mfma_f32_16x16x32_bf16 a[128:131], v[184:187], v[44:47], a[128:131]
    s_waitcnt vmcnt(14)
    buffer_load_dwordx4 v4, s[4:7], s27 offen offset:2048 sc1 lds
    v_mul_f32_e64 v51, -v51, v49
    v_mfma_f32_16x16x32_bf16 a[176:179], v[180:183], v[40:43], a[176:179]
    ds_read_b128 v[36:39], v1 offset:22528
    v_cvt_f32_i32 v248, v248
    v_mfma_f32_16x16x32_bf16 a[176:179], v[188:191], v[44:47], a[176:179]
    s_waitcnt lgkmcnt(2)
    v_exp_f32 v16, v84
    v_add_f32 v5, v5, v18
    v_mfma_f32_16x16x32_bf16 a[132:135], v[176:179], v[24:27], a[132:135]
    ds_read_b128 v[40:43], v1 offset:11264
    v_add_f32 v5, v5, v19
    v_mfma_f32_16x16x32_bf16 a[132:135], v[184:187], v[28:31], a[132:135]
    s_waitcnt vmcnt(19)
    v_exp_f32 v17, v85
    v_cvt_f32_i32 v252, v252
    v_mfma_f32_16x16x32_bf16 a[180:183], v[180:183], v[24:27], a[180:183]
    s_mov_b32 s27, 208896
    ds_read_b128 v[44:47], v1 offset:23552
    v_cvt_pk_bf16_f32 v83, v18, v19
    v_mfma_f32_16x16x32_bf16 a[180:183], v[188:191], v[28:31], a[180:183]
    s_waitcnt lgkmcnt(2)
    s_barrier
    v_fma_f32 v248, v248, v48, v50
    v_mfma_f32_16x16x32_bf16 a[136:139], v[176:179], v[32:35], a[136:139]
    s_add_u32 s56, s56, 36864
    ds_read_b128 v[24:27], v2 offset:0
    v_fma_f32 v252, v252, v49, v51
    v_mfma_f32_16x16x32_bf16 a[136:139], v[184:187], v[36:39], a[136:139]
    v_exp_f32 v18, v86
    v_add_f32 v6, v6, v16
    v_mfma_f32_16x16x32_bf16 a[184:187], v[180:183], v[32:35], a[184:187]
    s_sub_u32 s58, s56, 147456
    ds_read_b128 v[28:31], v3 offset:0
    v_cvt_f32_i32 v249, v249
    v_mfma_f32_16x16x32_bf16 a[184:187], v[188:191], v[36:39], a[184:187]
    s_waitcnt lgkmcnt(2)
    v_add_f32 v6, v6, v17
    v_cvt_f32_i32 v253, v253
    v_fma_f32 v249, v249, v48, v50
    v_mfma_f32_16x16x32_bf16 a[140:143], v[176:179], v[40:43], a[140:143]
    s_nop 0
    ds_read_b128 v[32:35], v2 offset:6144
    v_fma_f32 v253, v253, v49, v51
    v_mfma_f32_16x16x32_bf16 a[140:143], v[184:187], v[44:47], a[140:143]
    s_min_u32 s56, s56, s58
    v_exp_f32 v19, v87
    v_cvt_pk_bf16_f32 v84, v16, v17
    v_mfma_f32_16x16x32_bf16 a[188:191], v[180:183], v[40:43], a[188:191]
    s_waitcnt lgkmcnt(1)
    ds_read_b128 v[36:39], v3 offset:6144
    v_exp_f32 v16, v116
    v_cvt_f32_i32 v250, v250
    v_add_f32 v6, v6, v18
    v_cvt_f32_i32 v254, v254
    v_add_f32 v6, v6, v19
    v_fma_f32 v250, v250, v48, v50
    v_exp_f32 v17, v117
    v_fma_f32 v254, v254, v49, v51
    v_cvt_f32_i32 v251, v251
    v_cvt_pk_bf16_f32 v85, v18, v19
    v_cvt_f32_i32 v255, v255
    v_exp_f32 v18, v118
    v_fma_f32 v251, v251, v48, v50
    v_fma_f32 v255, v255, v49, v51
    v_add_f32 v6, v6, v16
    v_cvt_pk_bf16_f32 v146, v240, v244
    v_add_f32 v6, v6, v17
    v_cvt_pk_bf16_f32 v150, v241, v245
    v_exp_f32 v19, v119
    v_cvt_pk_bf16_f32 v147, v248, v252
    v_cvt_pk_bf16_f32 v151, v249, v253
    v_cvt_pk_bf16_f32 v86, v16, v17
    v_cvt_pk_bf16_f32 v154, v242, v246
    v_add_f32 v6, v6, v18
    v_cvt_pk_bf16_f32 v155, v250, v254
    v_add_f32 v6, v6, v19
    v_cvt_pk_bf16_f32 v158, v243, v247
    v_cvt_pk_bf16_f32 v87, v18, v19
    v_cvt_pk_bf16_f32 v159, v251, v255
    v_mfma_f32_16x16x32_bf16 a[188:191], v[188:191], v[44:47], a[188:191]
    s_branch L_join
.p2align 6
L_loop:
    v_mfma_f32_16x16x32_bf16 v[160:163], v[24:27], a[192:195], v[128:131]
    s_mov_b32 m0, s56
    ds_read_b128 v[40:43], v2 offset:128
    v_fma_f32 v250, v250, v48, v50
    v_mfma_f32_16x16x32_bf16 v[160:163], v[28:31], a[196:199], v[160:163]
    buffer_load_dwordx4 v4, s[4:7], s27 offen offset:0 sc1 lds
    v_mfma_f32_16x16x32_bf16 v[164:167], v[24:27], a[216:219], v[132:135]
    v_exp_f32 v16, v88
    v_mfma_f32_16x16x32_bf16 v[164:167], v[28:31], a[220:223], v[164:167]
    v_exp_f32 v17, v89
    v_mfma_f32_16x16x32_bf16 v[168:171], v[24:27], a[240:243], v[136:139]
    ds_read_b128 v[44:47], v3 offset:128
    v_fma_f32 v251, v251, v49, v51
    v_mfma_f32_16x16x32_bf16 v[168:171], v[28:31], a[244:247], v[168:171]
    v_exp_f32 v18, v90
    v_mfma_f32_16x16x32_bf16 v[172:175], v[24:27], v[200:203], v[140:143]
    v_add_f32 v7, v7, v16
    v_add_f32 v7, v7, v17
    v_mfma_f32_16x16x32_bf16 v[172:175], v[28:31], v[204:207], v[172:175]
    s_waitcnt lgkmcnt(2)
    v_exp_f32 v19, v91
    v_mfma_f32_16x16x32_bf16 v[96:99], v[32:35], a[192:195], v[128:131]
    ds_read_b128 v[24:27], v2 offset:6272
    v_cvt_pk_bf16_f32 v235, v250, v251
    v_mfma_f32_16x16x32_bf16 v[96:99], v[36:39], a[196:199], v[96:99]
    buffer_load_dwordx4 v4, s[4:7], s27 offen offset:1024 sc1 lds
    v_mfma_f32_16x16x32_bf16 v[100:103], v[32:35], a[216:219], v[132:135]
    v_cvt_pk_bf16_f32 v88, v16, v17
    v_cvt_f32_i32 v254, v254
    v_mfma_f32_16x16x32_bf16 v[100:103], v[36:39], a[220:223], v[100:103]
    v_exp_f32 v16, v120
    v_mfma_f32_16x16x32_bf16 v[104:107], v[32:35], a[240:243], v[136:139]
    ds_read_b128 v[28:31], v3 offset:6272
    v_add_f32 v7, v7, v18
    v_mfma_f32_16x16x32_bf16 v[104:107], v[36:39], a[244:247], v[104:107]
    v_add_f32 v7, v7, v19
    v_cvt_f32_i32 v255, v255
    v_mfma_f32_16x16x32_bf16 v[108:111], v[32:35], v[200:203], v[140:143]
    v_exp_f32 v17, v121
    v_mfma_f32_16x16x32_bf16 v[108:111], v[36:39], v[204:207], v[108:111]
    s_waitcnt lgkmcnt(2)
    v_cvt_pk_bf16_f32 v89, v18, v19
    v_fma_f32 v254, v254, v48, v50
    v_mfma_f32_16x16x32_bf16 v[160:163], v[40:43], a[200:203], v[160:163]
    ds_read_b128 v[32:35], v2 offset:256
    v_mfma_f32_16x16x32_bf16 v[160:163], v[44:47], a[204:207], v[160:163]
    v_exp_f32 v18, v122
    v_mfma_f32_16x16x32_bf16 v[164:167], v[40:43], a[224:227], v[164:167]
    v_add_f32 v7, v7, v16
    v_add_f32 v7, v7, v17
    v_mfma_f32_16x16x32_bf16 v[164:167], v[44:47], a[228:231], v[164:167]
    buffer_load_dwordx4 v4, s[4:7], s27 offen offset:2048 sc1 lds
    v_mfma_f32_16x16x32_bf16 v[168:171], v[40:43], a[248:251], v[168:171]
    ds_read_b128 v[36:39], v3 offset:256
    v_fma_f32 v255, v255, v49, v51
    v_mfma_f32_16x16x32_bf16 v[168:171], v[44:47], a[252:255], v[168:171]
    v_exp_f32 v19, v123
    v_mfma_f32_16x16x32_bf16 v[172:175], v[40:43], v[208:211], v[172:175]
    v_cvt_pk_bf16_f32 v90, v16, v17
    v_cvt_pk_bf16_f32 v239, v254, v255
    v_mfma_f32_16x16x32_bf16 v[172:175], v[44:47], v[212:215], v[172:175]
    s_waitcnt lgkmcnt(2)
    v_exp_f32 v16, v92
    v_mfma_f32_16x16x32_bf16 v[96:99], v[24:27], a[200:203], v[96:99]
    ds_read_b128 v[40:43], v2 offset:6400
    v_add_f32 v7, v7, v18
    v_mfma_f32_16x16x32_bf16 v[96:99], v[28:31], a[204:207], v[96:99]
    s_add_u32 s27, s27, 24576
    v_add_f32 v7, v7, v19
    v_mfma_f32_16x16x32_bf16 v[100:103], v[24:27], a[224:227], v[100:103]
    v_exp_f32 v17, v93
    v_mfma_f32_16x16x32_bf16 v[100:103], v[28:31], a[228:231], v[100:103]
    v_cvt_pk_bf16_f32 v91, v18, v19
    v_mfma_f32_16x16x32_bf16 v[104:107], v[24:27], a[248:251], v[104:107]
    ds_read_b128 v[44:47], v3 offset:6400
    v_mfma_f32_16x16x32_bf16 v[104:107], v[28:31], a[252:255], v[104:107]
    v_exp_f32 v18, v94
    v_mfma_f32_16x16x32_bf16 v[108:111], v[24:27], v[208:211], v[108:111]
    s_add_u32 s29, s30, 49152
    v_add_f32 v8, v8, v16
    v_add_f32 v8, v8, v17
    v_mfma_f32_16x16x32_bf16 v[108:111], v[28:31], v[212:215], v[108:111]
    s_waitcnt lgkmcnt(2)
    v_exp_f32 v19, v95
    v_mfma_f32_16x16x32_bf16 v[160:163], v[32:35], a[208:211], v[160:163]
    s_waitcnt vmcnt(11)
    ds_read_b128 v[24:27], v2 offset:12288
    v_cvt_pk_bf16_f32 v92, v16, v17
    v_mfma_f32_16x16x32_bf16 v[160:163], v[36:39], a[212:215], v[160:163]
    s_sub_u32 s3, s29, 147456
    buffer_load_dwordx2 v[60:61], off, s[80:83], s37 offset:8
    v_mfma_f32_16x16x32_bf16 v[164:167], v[32:35], a[232:235], v[164:167]
    s_add_u32 s56, s56, 12288
    v_exp_f32 v16, v124
    v_mfma_f32_16x16x32_bf16 v[164:167], v[36:39], a[236:239], v[164:167]
    s_min_u32 s29, s29, s3
    v_add_f32 v8, v8, v18
    v_lshlrev_b32 v48, 16, v56
    v_mfma_f32_16x16x32_bf16 v[168:171], v[32:35], v[192:195], v[168:171]
    s_mov_b32 m0, s56
    ds_read_b128 v[28:31], v3 offset:12288
    v_add_f32 v8, v8, v19
    v_mfma_f32_16x16x32_bf16 v[168:171], v[36:39], v[196:199], v[168:171]
    buffer_load_dwordx2 v[62:63], off, s[84:87], s37 offset:8
    v_mfma_f32_16x16x32_bf16 v[172:175], v[32:35], v[216:219], v[172:175]
    v_exp_f32 v17, v125
    v_mfma_f32_16x16x32_bf16 v[172:175], v[36:39], v[220:223], v[172:175]
    s_waitcnt lgkmcnt(2)
    v_cvt_pk_bf16_f32 v93, v18, v19
    v_and_b32 v49, s97, v56
    v_mfma_f32_16x16x32_bf16 v[96:99], v[40:43], a[208:211], v[96:99]
    ds_read_b128 v[32:35], v2 offset:18432
    v_lshlrev_b32 v50, 16, v58
    v_mfma_f32_16x16x32_bf16 v[96:99], v[44:47], a[212:215], v[96:99]
    s_sub_u32 s3, s29, s30
    v_exp_f32 v18, v126
    v_mfma_f32_16x16x32_bf16 v[100:103], v[40:43], a[232:235], v[100:103]
    v_add_f32 v8, v8, v16
    v_add_f32 v8, v8, v17
    v_mfma_f32_16x16x32_bf16 v[100:103], v[44:47], a[236:239], v[100:103]
    buffer_load_dwordx4 v4, s[4:7], s27 offen offset:0 sc1 lds
    v_mfma_f32_16x16x32_bf16 v[104:107], v[40:43], v[192:195], v[104:107]
    ds_read_b128 v[36:39], v3 offset:18432
    v_and_b32 v51, s97, v58
    v_mfma_f32_16x16x32_bf16 v[104:107], v[44:47], v[196:199], v[104:107]
    v_exp_f32 v19, v127
    v_mfma_f32_16x16x32_bf16 v[108:111], v[40:43], v[216:219], v[108:111]
    v_cvt_pk_bf16_f32 v94, v16, v17
    v_add_f32 v8, v8, v18
    v_mfma_f32_16x16x32_bf16 v[108:111], v[44:47], v[220:223], v[108:111]
    s_waitcnt lgkmcnt(2)
    buffer_load_dwordx4 v[240:243], v12, s[68:71], s16 offen offset:0 nt
    v_mfma_f32_16x16x32_bf16 v[176:179], v[24:27], a[192:195], v[128:131]
    ds_read_b128 v[40:43], v2 offset:12416
    v_add_f32 v8, v8, v19
    v_mfma_f32_16x16x32_bf16 v[176:179], v[28:31], a[196:199], v[176:179]
    s_mov_b32 s30, s29
    v_cvt_pk_bf16_f32 v95, v18, v19
    v_mul_f32_e64 v50, -v50, v48
    v_mfma_f32_16x16x32_bf16 v[180:183], v[24:27], a[216:219], v[132:135]
    v_exp_f32 v16, v160
    v_mfma_f32_16x16x32_bf16 v[180:183], v[28:31], a[220:223], v[180:183]
    buffer_load_dwordx4 v4, s[4:7], s27 offen offset:1024 sc1 lds
    v_mfma_f32_16x16x32_bf16 v[184:187], v[24:27], a[240:243], v[136:139]
    ds_read_b128 v[44:47], v3 offset:12416
    v_mul_f32_e64 v51, -v51, v49
    v_mfma_f32_16x16x32_bf16 v[184:187], v[28:31], a[244:247], v[184:187]
    v_exp_f32 v17, v161
    v_mfma_f32_16x16x32_bf16 v[188:191], v[24:27], v[200:203], v[140:143]
    v_exp_f32 v18, v162
    v_mfma_f32_16x16x32_bf16 v[188:191], v[28:31], v[204:207], v[188:191]
    s_waitcnt lgkmcnt(2)
    buffer_load_dwordx4 v[244:247], v12, s[68:71], s16 offen offset:768 nt
    v_mfma_f32_16x16x32_bf16 v[112:115], v[32:35], a[192:195], v[128:131]
    ds_read_b128 v[24:27], v2 offset:18560
    v_add_f32 v5, v5, v16
    v_mfma_f32_16x16x32_bf16 v[112:115], v[36:39], a[196:199], v[112:115]
    v_add_f32 v5, v5, v17
    v_cvt_f32_i32 v144, v144
    v_mfma_f32_16x16x32_bf16 v[116:119], v[32:35], a[216:219], v[132:135]
    v_exp_f32 v19, v163
    v_mfma_f32_16x16x32_bf16 v[116:119], v[36:39], a[220:223], v[116:119]
    v_cvt_pk_bf16_f32 v160, v16, v17
    v_cvt_f32_i32 v148, v148
    v_mfma_f32_16x16x32_bf16 v[120:123], v[32:35], a[240:243], v[136:139]
    ds_read_b128 v[28:31], v3 offset:18560
    v_fma_f32 v144, v144, v48, v50
    v_mfma_f32_16x16x32_bf16 v[120:123], v[36:39], a[244:247], v[120:123]
    buffer_load_dwordx4 v[248:251], v12, s[68:71], s16 offen offset:1536 nt
    v_mfma_f32_16x16x32_bf16 v[124:127], v[32:35], v[200:203], v[140:143]
    v_exp_f32 v16, v96
    v_mfma_f32_16x16x32_bf16 v[124:127], v[36:39], v[204:207], v[124:127]
    s_waitcnt lgkmcnt(2)
    v_add_f32 v5, v5, v18
    v_add_f32 v5, v5, v19
    v_mfma_f32_16x16x32_bf16 v[176:179], v[40:43], a[200:203], v[176:179]
    ds_read_b128 v[32:35], v2 offset:12544
    v_fma_f32 v148, v148, v49, v51
    v_mfma_f32_16x16x32_bf16 v[176:179], v[44:47], a[204:207], v[176:179]
    buffer_load_dwordx4 v4, s[4:7], s27 offen offset:2048 sc1 lds
    v_mfma_f32_16x16x32_bf16 v[180:183], v[40:43], a[224:227], v[180:183]
    v_exp_f32 v17, v97
    v_mfma_f32_16x16x32_bf16 v[180:183], v[44:47], a[228:231], v[180:183]
    v_cvt_pk_bf16_f32 v161, v18, v19
    v_cvt_f32_i32 v145, v145
    v_mfma_f32_16x16x32_bf16 v[184:187], v[40:43], a[248:251], v[184:187]
    ds_read_b128 v[36:39], v3 offset:12544
    v_add_u32 v1, s3, v1
    v_mfma_f32_16x16x32_bf16 v[184:187], v[44:47], a[252:255], v[184:187]
    buffer_load_dwordx4 v[252:255], v12, s[68:71], s16 offen offset:2304 nt
    v_mfma_f32_16x16x32_bf16 v[188:191], v[40:43], v[208:211], v[188:191]
    v_exp_f32 v18, v98
    v_mfma_f32_16x16x32_bf16 v[188:191], v[44:47], v[212:215], v[188:191]
    s_waitcnt lgkmcnt(2)
    v_add_f32 v5, v5, v16
    v_add_f32 v5, v5, v17
    v_mfma_f32_16x16x32_bf16 v[112:115], v[24:27], a[200:203], v[112:115]
    ds_read_b128 v[40:43], v2 offset:18688
    v_cvt_f32_i32 v149, v149
    v_mfma_f32_16x16x32_bf16 v[112:115], v[28:31], a[204:207], v[112:115]
    v_exp_f32 v19, v99
    v_cvt_pk_bf16_f32 v162, v16, v17
    v_mfma_f32_16x16x32_bf16 v[116:119], v[24:27], a[224:227], v[116:119]
    v_exp_f32 v16, v164
    v_mfma_f32_16x16x32_bf16 v[116:119], v[28:31], a[228:231], v[116:119]
    s_add_u32 s27, s27, 24576
    v_add_f32 v5, v5, v18
    v_add_f32 v5, v5, v19
    v_mfma_f32_16x16x32_bf16 v[120:123], v[24:27], a[248:251], v[120:123]
    s_add_u32 s56, s56, 36864
    ds_read_b128 v[44:47], v3 offset:18688
    v_fma_f32 v145, v145, v48, v50
    v_mfma_f32_16x16x32_bf16 v[120:123], v[28:31], a[252:255], v[120:123]
    s_waitcnt lgkmcnt(2)
    v_exp_f32 v17, v165
    v_mfma_f32_16x16x32_bf16 v[124:127], v[24:27], v[208:211], v[124:127]
    s_waitcnt vmcnt(12)
    v_cvt_pk_bf16_f32 v163, v18, v19
    v_fma_f32 v149, v149, v49, v51
    v_mfma_f32_16x16x32_bf16 v[124:127], v[28:31], v[212:215], v[124:127]
    s_barrier
    s_sub_u32 s58, s56, 147456
    v_mfma_f32_16x16x32_bf16 v[176:179], v[32:35], a[208:211], v[176:179]
    s_min_u32 s56, s56, s58
    ds_read_b128 v[24:27], v1 offset:0
    v_cvt_f32_i32 v146, v146
    v_mfma_f32_16x16x32_bf16 v[176:179], v[36:39], a[212:215], v[176:179]
    v_exp_f32 v18, v166
    v_mfma_f32_16x16x32_bf16 v[180:183], v[32:35], a[232:235], v[180:183]
    v_add_f32 v6, v6, v16
    v_add_f32 v6, v6, v17
    v_mfma_f32_16x16x32_bf16 v[180:183], v[36:39], a[236:239], v[180:183]
    v_exp_f32 v19, v167
    v_mfma_f32_16x16x32_bf16 v[184:187], v[32:35], v[192:195], v[184:187]
    ds_read_b128 v[28:31], v1 offset:12288
    v_cvt_pk_bf16_f32 v164, v16, v17
    v_mfma_f32_16x16x32_bf16 v[184:187], v[36:39], v[196:199], v[184:187]
    v_exp_f32 v16, v100
    v_mfma_f32_16x16x32_bf16 v[188:191], v[32:35], v[216:219], v[188:191]
    v_add_f32 v6, v6, v18
    v_add_f32 v6, v6, v19
    v_mfma_f32_16x16x32_bf16 v[188:191], v[36:39], v[220:223], v[188:191]
    s_waitcnt lgkmcnt(2)
    v_exp_f32 v17, v101
    v_mfma_f32_16x16x32_bf16 v[112:115], v[40:43], a[208:211], v[112:115]
    ds_read_b128 v[32:35], v1 offset:1024
    v_cvt_pk_bf16_f32 v165, v18, v19
    v_mfma_f32_16x16x32_bf16 v[112:115], v[44:47], a[212:215], v[112:115]
    v_exp_f32 v18, v102
    v_mfma_f32_16x16x32_bf16 v[116:119], v[40:43], a[232:235], v[116:119]
    v_add_f32 v6, v6, v16
    v_cvt_f32_i32 v150, v150
    v_mfma_f32_16x16x32_bf16 v[116:119], v[44:47], a[236:239], v[116:119]
    v_add_f32 v6, v6, v17
    v_fma_f32 v146, v146, v48, v50
    v_mfma_f32_16x16x32_bf16 v[120:123], v[40:43], v[192:195], v[120:123]
    ds_read_b128 v[36:39], v1 offset:13312
    v_fma_f32 v150, v150, v49, v51
    v_mfma_f32_16x16x32_bf16 v[120:123], v[44:47], v[196:199], v[120:123]
    v_exp_f32 v19, v103
    v_mfma_f32_16x16x32_bf16 v[124:127], v[40:43], v[216:219], v[124:127]
    v_cvt_pk_bf16_f32 v166, v16, v17
    v_add_f32 v6, v6, v18
    v_mfma_f32_16x16x32_bf16 v[124:127], v[44:47], v[220:223], v[124:127]
    s_waitcnt lgkmcnt(2)
    v_add_f32 v6, v6, v19
    v_cvt_pk_bf16_f32 v167, v18, v19
    v_mfma_f32_16x16x32_bf16 a[0:3], v[64:67], v[24:27], a[0:3]
    ds_read_b128 v[40:43], v1 offset:2048
    v_cvt_f32_i32 v147, v147
    v_mfma_f32_16x16x32_bf16 a[0:3], v[80:83], v[28:31], a[0:3]
    buffer_store_dwordx4 v[224:227], v11, s[4:7], s33 offen offset:0 sc1
    v_mfma_f32_16x16x32_bf16 a[48:51], v[68:71], v[24:27], a[48:51]
    v_exp_f32 v16, v168
    v_mfma_f32_16x16x32_bf16 a[48:51], v[84:87], v[28:31], a[48:51]
    v_exp_f32 v17, v169
    v_mfma_f32_16x16x32_bf16 a[96:99], v[72:75], v[24:27], a[96:99]
    ds_read_b128 v[44:47], v1 offset:14336
    v_xor_b32 v55, 16, v11
    v_mfma_f32_16x16x32_bf16 a[96:99], v[88:91], v[28:31], a[96:99]
    v_exp_f32 v18, v170
    v_mfma_f32_16x16x32_bf16 a[144:147], v[76:79], v[24:27], a[144:147]
    v_add_f32 v7, v7, v16
    v_add_f32 v7, v7, v17
    v_mfma_f32_16x16x32_bf16 a[144:147], v[92:95], v[28:31], a[144:147]
    s_waitcnt lgkmcnt(2)
    v_exp_f32 v19, v171
    v_mfma_f32_16x16x32_bf16 a[4:7], v[64:67], v[32:35], a[4:7]
    ds_read_b128 v[24:27], v1 offset:3072
    v_cvt_f32_i32 v151, v151
    v_mfma_f32_16x16x32_bf16 a[4:7], v[80:83], v[36:39], a[4:7]
    buffer_store_dwordx4 v[228:231], v55, s[4:7], s33 offen offset:768 sc1
    v_mfma_f32_16x16x32_bf16 a[52:55], v[68:71], v[32:35], a[52:55]
    v_cvt_pk_bf16_f32 v168, v16, v17
    v_fma_f32 v147, v147, v48, v50
    v_mfma_f32_16x16x32_bf16 a[52:55], v[84:87], v[36:39], a[52:55]
    v_exp_f32 v16, v104
    v_mfma_f32_16x16x32_bf16 a[100:103], v[72:75], v[32:35], a[100:103]
    ds_read_b128 v[28:31], v1 offset:15360
    v_add_f32 v7, v7, v18
    v_mfma_f32_16x16x32_bf16 a[100:103], v[88:91], v[36:39], a[100:103]
    v_add_f32 v7, v7, v19
    v_xor_b32 v54, 32, v11
    v_mfma_f32_16x16x32_bf16 a[148:151], v[76:79], v[32:35], a[148:151]
    v_exp_f32 v17, v105
    v_mfma_f32_16x16x32_bf16 a[148:151], v[92:95], v[36:39], a[148:151]
    s_waitcnt lgkmcnt(2)
    v_cvt_pk_bf16_f32 v169, v18, v19
    v_fma_f32 v151, v151, v49, v51
    v_mfma_f32_16x16x32_bf16 a[8:11], v[64:67], v[40:43], a[8:11]
    ds_read_b128 v[32:35], v1 offset:4096
    v_lshlrev_b32 v48, 16, v57
    v_mfma_f32_16x16x32_bf16 a[8:11], v[80:83], v[44:47], a[8:11]
    buffer_store_dwordx4 v[232:235], v54, s[4:7], s33 offen offset:1536 sc1
    v_mfma_f32_16x16x32_bf16 a[56:59], v[68:71], v[40:43], a[56:59]
    v_exp_f32 v18, v106
    v_mfma_f32_16x16x32_bf16 a[56:59], v[84:87], v[44:47], a[56:59]
    v_add_f32 v7, v7, v16
    v_add_f32 v7, v7, v17
    v_mfma_f32_16x16x32_bf16 a[104:107], v[72:75], v[40:43], a[104:107]
    ds_read_b128 v[36:39], v1 offset:16384
    v_xor_b32 v55, 48, v11
    v_mfma_f32_16x16x32_bf16 a[104:107], v[88:91], v[44:47], a[104:107]
    v_exp_f32 v19, v107
    v_mfma_f32_16x16x32_bf16 a[152:155], v[76:79], v[40:43], a[152:155]
    v_cvt_pk_bf16_f32 v170, v16, v17
    v_and_b32 v49, s97, v57
    v_mfma_f32_16x16x32_bf16 a[152:155], v[92:95], v[44:47], a[152:155]
    s_waitcnt lgkmcnt(2)
    v_exp_f32 v16, v172
    v_mfma_f32_16x16x32_bf16 a[12:15], v[64:67], v[24:27], a[12:15]
    ds_read_b128 v[40:43], v1 offset:5120
    v_add_f32 v7, v7, v18
    v_mfma_f32_16x16x32_bf16 a[12:15], v[80:83], v[28:31], a[12:15]
    buffer_store_dwordx4 v[236:239], v55, s[4:7], s33 offen offset:2304 sc1
    v_mfma_f32_16x16x32_bf16 a[60:63], v[68:71], v[24:27], a[60:63]
    v_add_f32 v7, v7, v19
    v_lshlrev_b32 v50, 16, v59
    v_mfma_f32_16x16x32_bf16 a[60:63], v[84:87], v[28:31], a[60:63]
    v_exp_f32 v17, v173
    v_mfma_f32_16x16x32_bf16 a[108:111], v[72:75], v[24:27], a[108:111]
    ds_read_b128 v[44:47], v1 offset:17408
    v_cvt_pk_bf16_f32 v171, v18, v19
    v_mfma_f32_16x16x32_bf16 a[108:111], v[88:91], v[28:31], a[108:111]
    v_exp_f32 v18, v174
    v_mfma_f32_16x16x32_bf16 a[156:159], v[76:79], v[24:27], a[156:159]
    s_add_u32 s29, s28, 49152
    v_add_f32 v8, v8, v16
    v_add_f32 v8, v8, v17
    v_mfma_f32_16x16x32_bf16 a[156:159], v[92:95], v[28:31], a[156:159]
    s_waitcnt lgkmcnt(2)
    v_exp_f32 v19, v175
    v_mfma_f32_16x16x32_bf16 a[16:19], v[64:67], v[32:35], a[16:19]
    s_sub_u32 s3, s29, 147456
    ds_read_b128 v[24:27], v1 offset:6144
    v_cvt_pk_bf16_f32 v172, v16, v17
    v_mfma_f32_16x16x32_bf16 a[16:19], v[80:83], v[36:39], a[16:19]
    s_mov_b32 m0, s26
    v_exp_f32 v16, v108
    v_mfma_f32_16x16x32_bf16 a[64:67], v[68:71], v[32:35], a[64:67]
    s_min_u32 s29, s29, s3
    v_and_b32 v51, s97, v59
    v_add_f32 v8, v8, v18
    v_mfma_f32_16x16x32_bf16 a[64:67], v[84:87], v[36:39], a[64:67]
    buffer_load_dwordx4 v4, s[4:7], s32 offen offset:0 sc1 lds
    v_mfma_f32_16x16x32_bf16 a[112:115], v[72:75], v[32:35], a[112:115]
    ds_read_b128 v[28:31], v1 offset:18432
    v_add_f32 v8, v8, v19
    v_mfma_f32_16x16x32_bf16 a[112:115], v[88:91], v[36:39], a[112:115]
    v_exp_f32 v17, v109
    v_mfma_f32_16x16x32_bf16 a[160:163], v[76:79], v[32:35], a[160:163]
    v_cvt_pk_bf16_f32 v173, v18, v19
    v_mul_f32_e64 v50, -v50, v48
    v_mfma_f32_16x16x32_bf16 a[160:163], v[92:95], v[36:39], a[160:163]
    s_waitcnt lgkmcnt(2)
    buffer_load_dwordx4 v4, s[4:7], s32 offen offset:1024 sc1 lds
    v_mfma_f32_16x16x32_bf16 a[20:23], v[64:67], v[40:43], a[20:23]
    s_sub_u32 s3, s29, s28
    ds_read_b128 v[32:35], v1 offset:7168
    v_mul_f32_e64 v51, -v51, v49
    v_mfma_f32_16x16x32_bf16 a[20:23], v[80:83], v[44:47], a[20:23]
    v_exp_f32 v18, v110
    v_mfma_f32_16x16x32_bf16 a[68:71], v[68:71], v[40:43], a[68:71]
    v_add_f32 v8, v8, v16
    v_add_f32 v8, v8, v17
    v_mfma_f32_16x16x32_bf16 a[68:71], v[84:87], v[44:47], a[68:71]
    buffer_load_dwordx4 v4, s[4:7], s32 offen offset:2048 sc1 lds
    v_mfma_f32_16x16x32_bf16 a[116:119], v[72:75], v[40:43], a[116:119]
    ds_read_b128 v[36:39], v1 offset:19456
    v_cvt_f32_i32 v152, v152
    v_mfma_f32_16x16x32_bf16 a[116:119], v[88:91], v[44:47], a[116:119]
    v_exp_f32 v19, v111
    v_mfma_f32_16x16x32_bf16 a[164:167], v[76:79], v[40:43], a[164:167]
    s_mov_b32 s28, s29
    v_cvt_pk_bf16_f32 v174, v16, v17
    v_add_f32 v8, v8, v18
    v_mfma_f32_16x16x32_bf16 a[164:167], v[92:95], v[44:47], a[164:167]
    s_waitcnt lgkmcnt(2)
    v_add_f32 v8, v8, v19
    v_cvt_pk_bf16_f32 v175, v18, v19
    v_mfma_f32_16x16x32_bf16 a[24:27], v[64:67], v[24:27], a[24:27]
    s_add_u32 s32, s32, 24576
    ds_read_b128 v[40:43], v1 offset:8192
    v_cvt_f32_i32 v156, v156
    v_mfma_f32_16x16x32_bf16 a[24:27], v[80:83], v[28:31], a[24:27]
    v_exp_f32 v16, v176
    v_mfma_f32_16x16x32_bf16 a[72:75], v[68:71], v[24:27], a[72:75]
    s_add_u32 s26, s26, 12288
    v_exp_f32 v17, v177
    v_mfma_f32_16x16x32_bf16 a[72:75], v[84:87], v[28:31], a[72:75]
    v_exp_f32 v18, v178
    v_mfma_f32_16x16x32_bf16 a[120:123], v[72:75], v[24:27], a[120:123]
    s_mov_b32 m0, s26
    ds_read_b128 v[44:47], v1 offset:20480
    v_add_f32 v5, v5, v16
    v_mfma_f32_16x16x32_bf16 a[120:123], v[88:91], v[28:31], a[120:123]
    v_add_f32 v5, v5, v17
    v_fma_f32 v152, v152, v48, v50
    v_mfma_f32_16x16x32_bf16 a[168:171], v[76:79], v[24:27], a[168:171]
    v_exp_f32 v19, v179
    v_mfma_f32_16x16x32_bf16 a[168:171], v[92:95], v[28:31], a[168:171]
    s_waitcnt lgkmcnt(2)
    v_cvt_pk_bf16_f32 v176, v16, v17
    v_fma_f32 v156, v156, v49, v51
    v_mfma_f32_16x16x32_bf16 a[28:31], v[64:67], v[32:35], a[28:31]
    ds_read_b128 v[24:27], v1 offset:9216
    v_add_u32 v2, s3, v2
    v_mfma_f32_16x16x32_bf16 a[28:31], v[80:83], v[36:39], a[28:31]
    buffer_load_dwordx4 v4, s[4:7], s32 offen offset:0 sc1 lds
    v_mfma_f32_16x16x32_bf16 a[76:79], v[68:71], v[32:35], a[76:79]
    v_exp_f32 v16, v112
    v_mfma_f32_16x16x32_bf16 a[76:79], v[84:87], v[36:39], a[76:79]
    v_add_f32 v5, v5, v18
    v_add_f32 v5, v5, v19
    v_mfma_f32_16x16x32_bf16 a[124:127], v[72:75], v[32:35], a[124:127]
    ds_read_b128 v[28:31], v1 offset:21504
    v_cvt_f32_i32 v153, v153
    v_mfma_f32_16x16x32_bf16 a[124:127], v[88:91], v[36:39], a[124:127]
    buffer_load_dwordx4 v4, s[4:7], s32 offen offset:1024 sc1 lds
    v_mfma_f32_16x16x32_bf16 a[172:175], v[76:79], v[32:35], a[172:175]
    v_exp_f32 v17, v113
    v_mfma_f32_16x16x32_bf16 a[172:175], v[92:95], v[36:39], a[172:175]
    s_waitcnt lgkmcnt(2)
    v_cvt_pk_bf16_f32 v177, v18, v19
    v_add_u32 v3, s3, v3
    v_mfma_f32_16x16x32_bf16 a[32:35], v[64:67], v[40:43], a[32:35]
    ds_read_b128 v[32:35], v1 offset:10240
    v_cvt_f32_i32 v157, v157
    v_mfma_f32_16x16x32_bf16 a[32:35], v[80:83], v[44:47], a[32:35]
    v_exp_f32 v18, v114
    v_mfma_f32_16x16x32_bf16 a[80:83], v[68:71], v[40:43], a[80:83]
    v_add_f32 v5, v5, v16
    v_add_f32 v5, v5, v17
    v_mfma_f32_16x16x32_bf16 a[80:83], v[84:87], v[44:47], a[80:83]
    buffer_load_dwordx4 v4, s[4:7], s32 offen offset:2048 sc1 lds
    v_mfma_f32_16x16x32_bf16 a[128:131], v[72:75], v[40:43], a[128:131]
    ds_read_b128 v[36:39], v1 offset:22528
    v_mfma_f32_16x16x32_bf16 a[128:131], v[88:91], v[44:47], a[128:131]
    v_exp_f32 v19, v115
    v_mfma_f32_16x16x32_bf16 a[176:179], v[76:79], v[40:43], a[176:179]
    v_cvt_pk_bf16_f32 v178, v16, v17
    v_fma_f32 v153, v153, v48, v50
    v_mfma_f32_16x16x32_bf16 a[176:179], v[92:95], v[44:47], a[176:179]
    s_waitcnt lgkmcnt(2)
    v_exp_f32 v16, v180
    v_mfma_f32_16x16x32_bf16 a[36:39], v[64:67], v[24:27], a[36:39]
    ds_read_b128 v[40:43], v1 offset:11264
    v_add_f32 v5, v5, v18
    v_mfma_f32_16x16x32_bf16 a[36:39], v[80:83], v[28:31], a[36:39]
    v_add_f32 v5, v5, v19
    v_mfma_f32_16x16x32_bf16 a[84:87], v[68:71], v[24:27], a[84:87]
    v_exp_f32 v17, v181
    v_mfma_f32_16x16x32_bf16 a[84:87], v[84:87], v[28:31], a[84:87]
    s_add_u32 s32, s32, 24576
    v_cvt_pk_bf16_f32 v179, v18, v19
    s_add_u32 s26, s26, 36864
    v_mfma_f32_16x16x32_bf16 a[132:135], v[72:75], v[24:27], a[132:135]
    s_sub_u32 s57, s26, 147456
    ds_read_b128 v[44:47], v1 offset:23552
    v_fma_f32 v157, v157, v49, v51
    v_mfma_f32_16x16x32_bf16 a[132:135], v[88:91], v[28:31], a[132:135]
    s_waitcnt lgkmcnt(2)
    v_exp_f32 v18, v182
    v_mfma_f32_16x16x32_bf16 a[180:183], v[76:79], v[24:27], a[180:183]
    s_waitcnt vmcnt(6)
    v_add_f32 v6, v6, v16
    v_add_f32 v6, v6, v17
    v_mfma_f32_16x16x32_bf16 a[180:183], v[92:95], v[28:31], a[180:183]
    s_barrier
    v_cvt_f32_i32 v154, v154
    v_mfma_f32_16x16x32_bf16 a[40:43], v[64:67], v[32:35], a[40:43]
    s_min_u32 s26, s26, s57
    ds_read_b128 v[24:27], v2 offset:0
    v_add_u32 v0, 1, v0
    v_mfma_f32_16x16x32_bf16 a[40:43], v[80:83], v[36:39], a[40:43]
    buffer_store_dword v0, v13, s[20:23], 0 offen offset:32 sc1
    v_mfma_f32_16x16x32_bf16 a[88:91], v[68:71], v[32:35], a[88:91]
    v_exp_f32 v19, v183
    v_mfma_f32_16x16x32_bf16 a[88:91], v[84:87], v[36:39], a[88:91]
    v_cvt_pk_bf16_f32 v180, v16, v17
    v_cvt_f32_i32 v158, v158
    v_mfma_f32_16x16x32_bf16 a[136:139], v[72:75], v[32:35], a[136:139]
    ds_read_b128 v[28:31], v3 offset:0
    v_mfma_f32_16x16x32_bf16 a[136:139], v[88:91], v[36:39], a[136:139]
    v_exp_f32 v16, v116
    v_mfma_f32_16x16x32_bf16 a[184:187], v[76:79], v[32:35], a[184:187]
    v_add_f32 v6, v6, v18
    v_add_f32 v6, v6, v19
    v_mfma_f32_16x16x32_bf16 a[184:187], v[92:95], v[36:39], a[184:187]
    s_waitcnt lgkmcnt(2)
    v_exp_f32 v17, v117
    v_mfma_f32_16x16x32_bf16 a[44:47], v[64:67], v[40:43], a[44:47]
    ds_read_b128 v[32:35], v2 offset:6144
    v_cvt_pk_bf16_f32 v181, v18, v19
    v_mfma_f32_16x16x32_bf16 a[44:47], v[80:83], v[44:47], a[44:47]
    v_exp_f32 v18, v118
    v_mfma_f32_16x16x32_bf16 a[92:95], v[68:71], v[40:43], a[92:95]
    v_add_f32 v6, v6, v16
    v_add_f32 v6, v6, v17
    v_mfma_f32_16x16x32_bf16 a[92:95], v[84:87], v[44:47], a[92:95]
    v_exp_f32 v19, v119
    v_mfma_f32_16x16x32_bf16 a[140:143], v[72:75], v[40:43], a[140:143]
    ds_read_b128 v[36:39], v3 offset:6144
    v_cvt_pk_bf16_f32 v182, v16, v17
    v_mfma_f32_16x16x32_bf16 a[140:143], v[88:91], v[44:47], a[140:143]
    v_add_f32 v6, v6, v18
    v_add_f32 v6, v6, v19
    v_mfma_f32_16x16x32_bf16 a[188:191], v[76:79], v[40:43], a[188:191]
    v_cvt_pk_bf16_f32 v183, v18, v19
    v_mfma_f32_16x16x32_bf16 a[188:191], v[92:95], v[44:47], a[188:191]
    s_waitcnt lgkmcnt(2)
    v_mfma_f32_16x16x32_bf16 v[64:67], v[24:27], a[192:195], v[128:131]
    s_add_u32 s33, s33, 196608
    ds_read_b128 v[40:43], v2 offset:128
    v_fma_f32 v154, v154, v48, v50
    v_mfma_f32_16x16x32_bf16 v[64:67], v[28:31], a[196:199], v[64:67]
    s_mov_b32 m0, s56
    v_exp_f32 v16, v184
    v_mfma_f32_16x16x32_bf16 v[68:71], v[24:27], a[216:219], v[132:135]
    s_add_u32 s34, s34, 196608
    v_exp_f32 v17, v185
    v_mfma_f32_16x16x32_bf16 v[68:71], v[28:31], a[220:223], v[68:71]
    s_add_u32 s36, s36, 1536
    buffer_load_dwordx4 v4, s[4:7], s27 offen offset:0 sc1 lds
    v_mfma_f32_16x16x32_bf16 v[72:75], v[24:27], a[240:243], v[136:139]
    ds_read_b128 v[44:47], v3 offset:128
    v_fma_f32 v158, v158, v49, v51
    v_mfma_f32_16x16x32_bf16 v[72:75], v[28:31], a[244:247], v[72:75]
    v_exp_f32 v18, v186
    v_mfma_f32_16x16x32_bf16 v[76:79], v[24:27], v[200:203], v[140:143]
    v_add_f32 v7, v7, v16
    v_add_f32 v7, v7, v17
    v_mfma_f32_16x16x32_bf16 v[76:79], v[28:31], v[204:207], v[76:79]
    s_waitcnt lgkmcnt(2)
    buffer_load_dwordx2 v[56:57], v10, s[72:75], s36 offen offset:0
    v_mfma_f32_16x16x32_bf16 v[96:99], v[32:35], a[192:195], v[128:131]
    ds_read_b128 v[24:27], v2 offset:6272
    v_cvt_f32_i32 v155, v155
    v_mfma_f32_16x16x32_bf16 v[96:99], v[36:39], a[196:199], v[96:99]
    v_exp_f32 v19, v187
    v_mfma_f32_16x16x32_bf16 v[100:103], v[32:35], a[216:219], v[132:135]
    v_cvt_pk_bf16_f32 v184, v16, v17
    v_cvt_f32_i32 v159, v159
    v_mfma_f32_16x16x32_bf16 v[100:103], v[36:39], a[220:223], v[100:103]
    buffer_load_dwordx4 v4, s[4:7], s27 offen offset:1024 sc1 lds
    v_mfma_f32_16x16x32_bf16 v[104:107], v[32:35], a[240:243], v[136:139]
    ds_read_b128 v[28:31], v3 offset:6272
    v_fma_f32 v155, v155, v48, v50
    v_mfma_f32_16x16x32_bf16 v[104:107], v[36:39], a[244:247], v[104:107]
    v_exp_f32 v16, v120
    v_mfma_f32_16x16x32_bf16 v[108:111], v[32:35], v[200:203], v[140:143]
    v_add_f32 v7, v7, v18
    v_add_f32 v7, v7, v19
    v_mfma_f32_16x16x32_bf16 v[108:111], v[36:39], v[204:207], v[108:111]
    s_waitcnt lgkmcnt(2)
    buffer_load_dwordx2 v[58:59], v10, s[76:79], s36 offen offset:0
    v_mfma_f32_16x16x32_bf16 v[64:67], v[40:43], a[200:203], v[64:67]
    ds_read_b128 v[32:35], v2 offset:256
    v_fma_f32 v159, v159, v49, v51
    v_mfma_f32_16x16x32_bf16 v[64:67], v[44:47], a[204:207], v[64:67]
    v_exp_f32 v17, v121
    v_mfma_f32_16x16x32_bf16 v[68:71], v[40:43], a[224:227], v[68:71]
    v_cvt_pk_bf16_f32 v185, v18, v19
    v_cvt_pk_bf16_f32 v144, v144, v148
    v_mfma_f32_16x16x32_bf16 v[68:71], v[44:47], a[228:231], v[68:71]
    buffer_load_dwordx4 v[224:227], v9, s[64:67], s33 offen offset:0 nt
    v_mfma_f32_16x16x32_bf16 v[72:75], v[40:43], a[248:251], v[72:75]
    ds_read_b128 v[36:39], v3 offset:256
    v_cvt_pk_bf16_f32 v148, v145, v149
    v_mfma_f32_16x16x32_bf16 v[72:75], v[44:47], a[252:255], v[72:75]
    v_exp_f32 v18, v122
    v_mfma_f32_16x16x32_bf16 v[76:79], v[40:43], v[208:211], v[76:79]
    v_add_f32 v7, v7, v16
    v_add_f32 v7, v7, v17
    v_mfma_f32_16x16x32_bf16 v[76:79], v[44:47], v[212:215], v[76:79]
    s_waitcnt lgkmcnt(2)
    buffer_load_dwordx4 v4, s[4:7], s27 offen offset:2048 sc1 lds
    v_mfma_f32_16x16x32_bf16 v[96:99], v[24:27], a[200:203], v[96:99]
    ds_read_b128 v[40:43], v2 offset:6400
    v_cvt_pk_bf16_f32 v145, v152, v156
    v_mfma_f32_16x16x32_bf16 v[96:99], v[28:31], a[204:207], v[96:99]
    v_exp_f32 v19, v123
    v_cvt_pk_bf16_f32 v186, v16, v17
    v_mfma_f32_16x16x32_bf16 v[100:103], v[24:27], a[224:227], v[100:103]
    v_exp_f32 v16, v188
    v_mfma_f32_16x16x32_bf16 v[100:103], v[28:31], a[228:231], v[100:103]
    buffer_load_dwordx4 v[228:231], v9, s[64:67], s33 offen offset:1536 nt
    v_mfma_f32_16x16x32_bf16 v[104:107], v[24:27], a[248:251], v[104:107]
    ds_read_b128 v[44:47], v3 offset:6400
    v_add_f32 v7, v7, v18
    v_mfma_f32_16x16x32_bf16 v[104:107], v[28:31], a[252:255], v[104:107]
    v_add_f32 v7, v7, v19
    v_cvt_pk_bf16_f32 v149, v153, v157
    v_mfma_f32_16x16x32_bf16 v[108:111], v[24:27], v[208:211], v[108:111]
    s_add_u32 s29, s30, 49152
    v_exp_f32 v17, v189
    v_mfma_f32_16x16x32_bf16 v[108:111], v[28:31], v[212:215], v[108:111]
    s_waitcnt lgkmcnt(2)
    buffer_load_dwordx4 v[232:235], v9, s[64:67], s34 offen offset:0 nt
    v_cvt_pk_bf16_f32 v187, v18, v19
    v_mfma_f32_16x16x32_bf16 v[64:67], v[32:35], a[208:211], v[64:67]
    s_sub_u32 s3, s29, 147456
    ds_read_b128 v[24:27], v2 offset:12288
    s_add_u32 s27, s27, 24576
    v_mfma_f32_16x16x32_bf16 v[64:67], v[36:39], a[212:215], v[64:67]
    s_min_u32 s29, s29, s3
    v_exp_f32 v18, v190
    v_mfma_f32_16x16x32_bf16 v[68:71], v[32:35], a[232:235], v[68:71]
    v_add_f32 v8, v8, v16
    v_add_f32 v8, v8, v17
    v_mfma_f32_16x16x32_bf16 v[68:71], v[36:39], a[236:239], v[68:71]
    buffer_load_dwordx4 v[236:239], v9, s[64:67], s34 offen offset:1536 nt
    v_mfma_f32_16x16x32_bf16 v[72:75], v[32:35], v[192:195], v[72:75]
    s_add_u32 s56, s56, 12288
    ds_read_b128 v[28:31], v3 offset:12288
    v_cvt_pk_bf16_f32 v152, v146, v150
    v_mfma_f32_16x16x32_bf16 v[72:75], v[36:39], v[196:199], v[72:75]
    v_exp_f32 v19, v191
    v_cvt_pk_bf16_f32 v188, v16, v17
    v_mfma_f32_16x16x32_bf16 v[76:79], v[32:35], v[216:219], v[76:79]
    v_exp_f32 v16, v124
    v_mfma_f32_16x16x32_bf16 v[76:79], v[36:39], v[220:223], v[76:79]
    s_waitcnt lgkmcnt(2)
    v_add_f32 v8, v8, v18
    v_add_f32 v8, v8, v19
    v_mfma_f32_16x16x32_bf16 v[96:99], v[40:43], a[208:211], v[96:99]
    ds_read_b128 v[32:35], v2 offset:18432
    v_cvt_pk_bf16_f32 v153, v154, v158
    v_mfma_f32_16x16x32_bf16 v[96:99], v[44:47], a[212:215], v[96:99]
    s_sub_u32 s3, s29, s30
    v_exp_f32 v17, v125
    v_mfma_f32_16x16x32_bf16 v[100:103], v[40:43], a[232:235], v[100:103]
    s_mov_b32 m0, s56
    v_cvt_pk_bf16_f32 v189, v18, v19
    v_cvt_pk_bf16_f32 v156, v147, v151
    v_mfma_f32_16x16x32_bf16 v[100:103], v[44:47], a[236:239], v[100:103]
    v_exp_f32 v18, v126
    v_mfma_f32_16x16x32_bf16 v[104:107], v[40:43], v[192:195], v[104:107]
    ds_read_b128 v[36:39], v3 offset:18432
    v_add_f32 v8, v8, v16
    v_mfma_f32_16x16x32_bf16 v[104:107], v[44:47], v[196:199], v[104:107]
    v_add_f32 v8, v8, v17
    v_cvt_pk_bf16_f32 v157, v155, v159
    v_mfma_f32_16x16x32_bf16 v[108:111], v[40:43], v[216:219], v[108:111]
    v_exp_f32 v19, v127
    v_mfma_f32_16x16x32_bf16 v[108:111], v[44:47], v[220:223], v[108:111]
    s_waitcnt lgkmcnt(2)
    v_cvt_pk_bf16_f32 v190, v16, v17
    v_add_f32 v8, v8, v18
    v_mfma_f32_16x16x32_bf16 v[80:83], v[24:27], a[192:195], v[128:131]
    ds_read_b128 v[40:43], v2 offset:12416
    v_add_f32 v8, v8, v19
    v_mfma_f32_16x16x32_bf16 v[80:83], v[28:31], a[196:199], v[80:83]
    s_mov_b32 s30, s29
    v_cvt_pk_bf16_f32 v191, v18, v19
    v_mfma_f32_16x16x32_bf16 v[84:87], v[24:27], a[216:219], v[132:135]
    v_exp_f32 v16, v64
    v_mfma_f32_16x16x32_bf16 v[84:87], v[28:31], a[220:223], v[84:87]
    s_waitcnt vmcnt(20)
    buffer_load_dwordx4 v4, s[4:7], s27 offen offset:0 sc1 lds
    v_mfma_f32_16x16x32_bf16 v[88:91], v[24:27], a[240:243], v[136:139]
    ds_read_b128 v[44:47], v3 offset:12416
    v_lshlrev_b32 v48, 16, v60
    v_mfma_f32_16x16x32_bf16 v[88:91], v[28:31], a[244:247], v[88:91]
    v_exp_f32 v17, v65
    v_mfma_f32_16x16x32_bf16 v[92:95], v[24:27], v[200:203], v[140:143]
    v_exp_f32 v18, v66
    v_mfma_f32_16x16x32_bf16 v[92:95], v[28:31], v[204:207], v[92:95]
    s_waitcnt lgkmcnt(2)
    v_add_f32 v5, v5, v16
    v_add_f32 v5, v5, v17
    v_mfma_f32_16x16x32_bf16 v[112:115], v[32:35], a[192:195], v[128:131]
    ds_read_b128 v[24:27], v2 offset:18560
    v_and_b32 v49, s97, v60
    v_mfma_f32_16x16x32_bf16 v[112:115], v[36:39], a[196:199], v[112:115]
    v_exp_f32 v19, v67
    v_mfma_f32_16x16x32_bf16 v[116:119], v[32:35], a[216:219], v[132:135]
    v_cvt_pk_bf16_f32 v64, v16, v17
    v_lshlrev_b32 v50, 16, v62
    v_mfma_f32_16x16x32_bf16 v[116:119], v[36:39], a[220:223], v[116:119]
    v_exp_f32 v16, v96
    v_mfma_f32_16x16x32_bf16 v[120:123], v[32:35], a[240:243], v[136:139]
    ds_read_b128 v[28:31], v3 offset:18560
    v_add_f32 v5, v5, v18
    v_mfma_f32_16x16x32_bf16 v[120:123], v[36:39], a[244:247], v[120:123]
    v_add_f32 v5, v5, v19
    v_and_b32 v51, s97, v62
    v_mfma_f32_16x16x32_bf16 v[124:127], v[32:35], v[200:203], v[140:143]
    v_exp_f32 v17, v97
    v_mfma_f32_16x16x32_bf16 v[124:127], v[36:39], v[204:207], v[124:127]
    s_waitcnt lgkmcnt(2)
    buffer_load_dwordx4 v4, s[4:7], s27 offen offset:1024 sc1 lds
    v_mfma_f32_16x16x32_bf16 v[80:83], v[40:43], a[200:203], v[80:83]
    ds_read_b128 v[32:35], v2 offset:12544
    v_cvt_pk_bf16_f32 v65, v18, v19
    v_mfma_f32_16x16x32_bf16 v[80:83], v[44:47], a[204:207], v[80:83]
    v_exp_f32 v18, v98
    v_mfma_f32_16x16x32_bf16 v[84:87], v[40:43], a[224:227], v[84:87]
    v_add_f32 v5, v5, v16
    v_add_f32 v5, v5, v17
    v_mfma_f32_16x16x32_bf16 v[84:87], v[44:47], a[228:231], v[84:87]
    v_exp_f32 v19, v99
    v_mfma_f32_16x16x32_bf16 v[88:91], v[40:43], a[248:251], v[88:91]
    ds_read_b128 v[36:39], v3 offset:12544
    v_cvt_pk_bf16_f32 v66, v16, v17
    v_mfma_f32_16x16x32_bf16 v[88:91], v[44:47], a[252:255], v[88:91]
    v_exp_f32 v16, v68
    v_mfma_f32_16x16x32_bf16 v[92:95], v[40:43], v[208:211], v[92:95]
    v_mul_f32_e64 v50, -v50, v48
    v_add_u32 v1, s3, v1
    v_mfma_f32_16x16x32_bf16 v[92:95], v[44:47], v[212:215], v[92:95]
    s_waitcnt lgkmcnt(2)
    v_add_f32 v5, v5, v18
    v_mul_f32_e64 v51, -v51, v49
    v_mfma_f32_16x16x32_bf16 v[112:115], v[24:27], a[200:203], v[112:115]
    ds_read_b128 v[40:43], v2 offset:18688
    v_add_f32 v5, v5, v19
    v_mfma_f32_16x16x32_bf16 v[112:115], v[28:31], a[204:207], v[112:115]
    buffer_load_dwordx4 v4, s[4:7], s27 offen offset:2048 sc1 lds
    v_mfma_f32_16x16x32_bf16 v[116:119], v[24:27], a[224:227], v[116:119]
    v_exp_f32 v17, v69
    v_mfma_f32_16x16x32_bf16 v[116:119], v[28:31], a[228:231], v[116:119]
    v_cvt_pk_bf16_f32 v67, v18, v19
    v_cvt_f32_i32 v240, v240
    v_mfma_f32_16x16x32_bf16 v[120:123], v[24:27], a[248:251], v[120:123]
    ds_read_b128 v[44:47], v3 offset:18688
    v_cvt_f32_i32 v244, v244
    v_mfma_f32_16x16x32_bf16 v[120:123], v[28:31], a[252:255], v[120:123]
    s_waitcnt lgkmcnt(2)
    v_exp_f32 v18, v70
    v_mfma_f32_16x16x32_bf16 v[124:127], v[24:27], v[208:211], v[124:127]
    s_waitcnt vmcnt(24)
    v_add_f32 v6, v6, v16
    v_add_f32 v6, v6, v17
    v_mfma_f32_16x16x32_bf16 v[124:127], v[28:31], v[212:215], v[124:127]
    s_barrier
    v_fma_f32 v240, v240, v48, v50
    v_mfma_f32_16x16x32_bf16 v[80:83], v[32:35], a[208:211], v[80:83]
    ds_read_b128 v[24:27], v1 offset:0
    v_fma_f32 v244, v244, v49, v51
    v_mfma_f32_16x16x32_bf16 v[80:83], v[36:39], a[212:215], v[80:83]
    v_exp_f32 v19, v71
    v_mfma_f32_16x16x32_bf16 v[84:87], v[32:35], a[232:235], v[84:87]
    v_cvt_pk_bf16_f32 v68, v16, v17
    v_mfma_f32_16x16x32_bf16 v[84:87], v[36:39], a[236:239], v[84:87]
    v_exp_f32 v16, v100
    v_mfma_f32_16x16x32_bf16 v[88:91], v[32:35], v[192:195], v[88:91]
    ds_read_b128 v[28:31], v1 offset:12288
    v_add_f32 v6, v6, v18
    v_mfma_f32_16x16x32_bf16 v[88:91], v[36:39], v[196:199], v[88:91]
    v_add_f32 v6, v6, v19
    v_cvt_f32_i32 v241, v241
    v_mfma_f32_16x16x32_bf16 v[92:95], v[32:35], v[216:219], v[92:95]
    v_exp_f32 v17, v101
    v_mfma_f32_16x16x32_bf16 v[92:95], v[36:39], v[220:223], v[92:95]
    s_waitcnt lgkmcnt(2)
    v_cvt_pk_bf16_f32 v69, v18, v19
    v_cvt_f32_i32 v245, v245
    v_mfma_f32_16x16x32_bf16 v[112:115], v[40:43], a[208:211], v[112:115]
    ds_read_b128 v[32:35], v1 offset:1024
    v_mfma_f32_16x16x32_bf16 v[112:115], v[44:47], a[212:215], v[112:115]
    v_exp_f32 v18, v102
    v_mfma_f32_16x16x32_bf16 v[116:119], v[40:43], a[232:235], v[116:119]
    v_add_f32 v6, v6, v16
    v_add_f32 v6, v6, v17
    v_mfma_f32_16x16x32_bf16 v[116:119], v[44:47], a[236:239], v[116:119]
    s_add_u32 s27, s27, 24576
    v_exp_f32 v19, v103
    v_mfma_f32_16x16x32_bf16 v[120:123], v[40:43], v[192:195], v[120:123]
    s_add_u32 s56, s56, 36864
    ds_read_b128 v[36:39], v1 offset:13312
    v_cvt_pk_bf16_f32 v70, v16, v17
    v_mfma_f32_16x16x32_bf16 v[120:123], v[44:47], v[196:199], v[120:123]
    s_sub_u32 s58, s56, 147456
    v_add_f32 v6, v6, v18
    v_add_f32 v6, v6, v19
    v_mfma_f32_16x16x32_bf16 v[124:127], v[40:43], v[216:219], v[124:127]
    s_min_u32 s56, s56, s58
    v_cvt_pk_bf16_f32 v71, v18, v19
    v_mfma_f32_16x16x32_bf16 v[124:127], v[44:47], v[220:223], v[124:127]
    s_waitcnt lgkmcnt(2)
    v_mfma_f32_16x16x32_bf16 a[0:3], v[160:163], v[24:27], a[0:3]
    s_mov_b32 m0, s56
    ds_read_b128 v[40:43], v1 offset:2048
    v_fma_f32 v241, v241, v48, v50
    v_mfma_f32_16x16x32_bf16 a[0:3], v[176:179], v[28:31], a[0:3]
    buffer_load_dwordx4 v4, s[4:7], s27 offen offset:0 sc1 lds
    v_mfma_f32_16x16x32_bf16 a[48:51], v[164:167], v[24:27], a[48:51]
    v_exp_f32 v16, v72
    v_mfma_f32_16x16x32_bf16 a[48:51], v[180:183], v[28:31], a[48:51]
    v_exp_f32 v17, v73
    v_mfma_f32_16x16x32_bf16 a[96:99], v[168:171], v[24:27], a[96:99]
    ds_read_b128 v[44:47], v1 offset:14336
    v_fma_f32 v245, v245, v49, v51
    v_mfma_f32_16x16x32_bf16 a[96:99], v[184:187], v[28:31], a[96:99]
    v_exp_f32 v18, v74
    v_mfma_f32_16x16x32_bf16 a[144:147], v[172:175], v[24:27], a[144:147]
    v_add_f32 v7, v7, v16
    v_add_f32 v7, v7, v17
    v_mfma_f32_16x16x32_bf16 a[144:147], v[188:191], v[28:31], a[144:147]
    s_waitcnt lgkmcnt(2)
    v_exp_f32 v19, v75
    v_mfma_f32_16x16x32_bf16 a[4:7], v[160:163], v[32:35], a[4:7]
    ds_read_b128 v[24:27], v1 offset:3072
    v_cvt_f32_i32 v242, v242
    v_mfma_f32_16x16x32_bf16 a[4:7], v[176:179], v[36:39], a[4:7]
    buffer_load_dwordx4 v4, s[4:7], s27 offen offset:1024 sc1 lds
    v_mfma_f32_16x16x32_bf16 a[52:55], v[164:167], v[32:35], a[52:55]
    v_cvt_pk_bf16_f32 v72, v16, v17
    v_cvt_f32_i32 v246, v246
    v_mfma_f32_16x16x32_bf16 a[52:55], v[180:183], v[36:39], a[52:55]
    v_exp_f32 v16, v104
    v_mfma_f32_16x16x32_bf16 a[100:103], v[168:171], v[32:35], a[100:103]
    ds_read_b128 v[28:31], v1 offset:15360
    v_add_f32 v7, v7, v18
    v_mfma_f32_16x16x32_bf16 a[100:103], v[184:187], v[36:39], a[100:103]
    v_add_f32 v7, v7, v19
    v_bfe_u32 v53, v4, 4, 6
    v_mfma_f32_16x16x32_bf16 a[148:151], v[172:175], v[32:35], a[148:151]
    v_exp_f32 v17, v105
    v_mfma_f32_16x16x32_bf16 a[148:151], v[188:191], v[36:39], a[148:151]
    s_waitcnt lgkmcnt(2)
    v_fma_f32 v242, v242, v48, v50
    v_cvt_pk_bf16_f32 v73, v18, v19
    v_mfma_f32_16x16x32_bf16 a[8:11], v[160:163], v[40:43], a[8:11]
    ds_read_b128 v[32:35], v1 offset:4096
    v_fma_f32 v246, v246, v49, v51
    v_mfma_f32_16x16x32_bf16 a[8:11], v[176:179], v[44:47], a[8:11]
    v_exp_f32 v18, v106
    v_mfma_f32_16x16x32_bf16 a[56:59], v[164:167], v[40:43], a[56:59]
    v_lshlrev_b32 v53, 2, v53
    v_add_f32 v7, v7, v16
    v_mfma_f32_16x16x32_bf16 a[56:59], v[180:183], v[44:47], a[56:59]
    buffer_load_dword v52, v53, s[20:23], s44 offen sc1
    v_mfma_f32_16x16x32_bf16 a[104:107], v[168:171], v[40:43], a[104:107]
    ds_read_b128 v[36:39], v1 offset:16384
    v_add_f32 v7, v7, v17
    v_mfma_f32_16x16x32_bf16 a[104:107], v[184:187], v[44:47], a[104:107]
    v_exp_f32 v19, v107
    v_mfma_f32_16x16x32_bf16 a[152:155], v[172:175], v[40:43], a[152:155]
    v_cvt_f32_i32 v243, v243
    v_cvt_pk_bf16_f32 v74, v16, v17
    v_mfma_f32_16x16x32_bf16 a[152:155], v[188:191], v[44:47], a[152:155]
    s_waitcnt lgkmcnt(2)
    buffer_load_dwordx4 v4, s[4:7], s27 offen offset:2048 sc1 lds
    v_mfma_f32_16x16x32_bf16 a[12:15], v[160:163], v[24:27], a[12:15]
    ds_read_b128 v[40:43], v1 offset:5120
    v_cvt_f32_i32 v247, v247
    v_mfma_f32_16x16x32_bf16 a[12:15], v[176:179], v[28:31], a[12:15]
    s_add_u32 s27, s27, 24576
    v_exp_f32 v16, v76
    v_mfma_f32_16x16x32_bf16 a[60:63], v[164:167], v[24:27], a[60:63]
    v_add_f32 v7, v7, v18
    v_add_f32 v7, v7, v19
    v_mfma_f32_16x16x32_bf16 a[60:63], v[180:183], v[28:31], a[60:63]
    v_fma_f32 v243, v243, v48, v50
    v_fma_f32 v247, v247, v49, v51
    v_mfma_f32_16x16x32_bf16 a[108:111], v[168:171], v[24:27], a[108:111]
    ds_read_b128 v[44:47], v1 offset:17408
    v_lshlrev_b32 v48, 16, v61
    v_mfma_f32_16x16x32_bf16 a[108:111], v[184:187], v[28:31], a[108:111]
    v_exp_f32 v17, v77
    v_mfma_f32_16x16x32_bf16 a[156:159], v[172:175], v[24:27], a[156:159]
    s_add_u32 s29, s28, 49152
    v_cvt_pk_bf16_f32 v75, v18, v19
    v_and_b32 v49, s97, v61
    v_mfma_f32_16x16x32_bf16 a[156:159], v[188:191], v[28:31], a[156:159]
    s_waitcnt lgkmcnt(2)
    v_exp_f32 v18, v78
    v_mfma_f32_16x16x32_bf16 a[16:19], v[160:163], v[32:35], a[16:19]
    s_sub_u32 s3, s29, 147456
    ds_read_b128 v[24:27], v1 offset:6144
    v_add_f32 v8, v8, v16
    v_mfma_f32_16x16x32_bf16 a[16:19], v[176:179], v[36:39], a[16:19]
    s_add_u32 s56, s56, 12288
    v_add_f32 v8, v8, v17
    v_lshlrev_b32 v50, 16, v63
    v_mfma_f32_16x16x32_bf16 a[64:67], v[164:167], v[32:35], a[64:67]
    s_min_u32 s29, s29, s3
    v_exp_f32 v19, v79
    v_mfma_f32_16x16x32_bf16 a[64:67], v[180:183], v[36:39], a[64:67]
    s_mov_b32 m0, s56
    v_cvt_pk_bf16_f32 v76, v16, v17
    v_and_b32 v51, s97, v63
    v_mfma_f32_16x16x32_bf16 a[112:115], v[168:171], v[32:35], a[112:115]
    ds_read_b128 v[28:31], v1 offset:18432
    v_mul_f32_e64 v50, -v50, v48
    v_mfma_f32_16x16x32_bf16 a[112:115], v[184:187], v[36:39], a[112:115]
    v_exp_f32 v16, v108
    v_mfma_f32_16x16x32_bf16 a[160:163], v[172:175], v[32:35], a[160:163]
    v_add_f32 v8, v8, v18
    v_add_f32 v8, v8, v19
    v_mfma_f32_16x16x32_bf16 a[160:163], v[188:191], v[36:39], a[160:163]
    s_waitcnt lgkmcnt(2)
    v_exp_f32 v17, v109
    v_mfma_f32_16x16x32_bf16 a[20:23], v[160:163], v[40:43], a[20:23]
    s_sub_u32 s3, s29, s28
    ds_read_b128 v[32:35], v1 offset:7168
    v_cvt_pk_bf16_f32 v77, v18, v19
    v_mfma_f32_16x16x32_bf16 a[20:23], v[176:179], v[44:47], a[20:23]
    v_exp_f32 v18, v110
    v_mfma_f32_16x16x32_bf16 a[68:71], v[164:167], v[40:43], a[68:71]
    v_mul_f32_e64 v51, -v51, v49
    v_add_f32 v8, v8, v16
    v_mfma_f32_16x16x32_bf16 a[68:71], v[180:183], v[44:47], a[68:71]
    buffer_load_dwordx4 v4, s[4:7], s27 offen offset:0 sc1 lds
    v_mfma_f32_16x16x32_bf16 a[116:119], v[168:171], v[40:43], a[116:119]
    ds_read_b128 v[36:39], v1 offset:19456
    v_add_f32 v8, v8, v17
    v_mfma_f32_16x16x32_bf16 a[116:119], v[184:187], v[44:47], a[116:119]
    v_exp_f32 v19, v111
    v_mfma_f32_16x16x32_bf16 a[164:167], v[172:175], v[40:43], a[164:167]
    s_mov_b32 s28, s29
    v_cvt_f32_i32 v248, v248
    v_cvt_pk_bf16_f32 v78, v16, v17
    v_mfma_f32_16x16x32_bf16 a[164:167], v[188:191], v[44:47], a[164:167]
    s_waitcnt lgkmcnt(2)
    v_add_f32 v8, v8, v18
    v_cvt_f32_i32 v252, v252
    v_mfma_f32_16x16x32_bf16 a[24:27], v[160:163], v[24:27], a[24:27]
    ds_read_b128 v[40:43], v1 offset:8192
    v_add_f32 v8, v8, v19
    v_mfma_f32_16x16x32_bf16 a[24:27], v[176:179], v[28:31], a[24:27]
    v_cvt_pk_bf16_f32 v79, v18, v19
    v_fma_f32 v248, v248, v48, v50
    v_mfma_f32_16x16x32_bf16 a[72:75], v[164:167], v[24:27], a[72:75]
    v_exp_f32 v16, v80
    v_mfma_f32_16x16x32_bf16 a[72:75], v[180:183], v[28:31], a[72:75]
    buffer_load_dwordx4 v4, s[4:7], s27 offen offset:1024 sc1 lds
    v_mfma_f32_16x16x32_bf16 a[120:123], v[168:171], v[24:27], a[120:123]
    ds_read_b128 v[44:47], v1 offset:20480
    v_fma_f32 v252, v252, v49, v51
    v_mfma_f32_16x16x32_bf16 a[120:123], v[184:187], v[28:31], a[120:123]
    v_exp_f32 v17, v81
    v_mfma_f32_16x16x32_bf16 a[168:171], v[172:175], v[24:27], a[168:171]
    v_exp_f32 v18, v82
    v_mfma_f32_16x16x32_bf16 a[168:171], v[188:191], v[28:31], a[168:171]
    s_waitcnt lgkmcnt(2)
    v_cvt_f32_i32 v249, v249
    v_add_f32 v5, v5, v16
    v_mfma_f32_16x16x32_bf16 a[28:31], v[160:163], v[32:35], a[28:31]
    ds_read_b128 v[24:27], v1 offset:9216
    v_add_f32 v5, v5, v17
    v_mfma_f32_16x16x32_bf16 a[28:31], v[176:179], v[36:39], a[28:31]
    v_exp_f32 v19, v83
    v_mfma_f32_16x16x32_bf16 a[76:79], v[164:167], v[32:35], a[76:79]
    v_cvt_f32_i32 v253, v253
    v_cvt_pk_bf16_f32 v80, v16, v17
    v_mfma_f32_16x16x32_bf16 a[76:79], v[180:183], v[36:39], a[76:79]
    v_exp_f32 v16, v112
    v_mfma_f32_16x16x32_bf16 a[124:127], v[168:171], v[32:35], a[124:127]
    ds_read_b128 v[28:31], v1 offset:21504
    v_fma_f32 v249, v249, v48, v50
    v_mfma_f32_16x16x32_bf16 a[124:127], v[184:187], v[36:39], a[124:127]
    buffer_load_dwordx4 v4, s[4:7], s27 offen offset:2048 sc1 lds
    v_mfma_f32_16x16x32_bf16 a[172:175], v[172:175], v[32:35], a[172:175]
    v_add_f32 v5, v5, v18
    v_add_f32 v5, v5, v19
    v_mfma_f32_16x16x32_bf16 a[172:175], v[188:191], v[36:39], a[172:175]
    s_waitcnt lgkmcnt(2)
    v_exp_f32 v17, v113
    v_mfma_f32_16x16x32_bf16 a[32:35], v[160:163], v[40:43], a[32:35]
    ds_read_b128 v[32:35], v1 offset:10240
    v_fma_f32 v253, v253, v49, v51
    v_mfma_f32_16x16x32_bf16 a[32:35], v[176:179], v[44:47], a[32:35]
    v_cvt_pk_bf16_f32 v81, v18, v19
    v_cvt_f32_i32 v250, v250
    v_mfma_f32_16x16x32_bf16 a[80:83], v[164:167], v[40:43], a[80:83]
    v_exp_f32 v18, v114
    v_mfma_f32_16x16x32_bf16 a[80:83], v[180:183], v[44:47], a[80:83]
    v_cvt_f32_i32 v254, v254
    v_add_f32 v5, v5, v16
    v_mfma_f32_16x16x32_bf16 a[128:131], v[168:171], v[40:43], a[128:131]
    ds_read_b128 v[36:39], v1 offset:22528
    v_add_f32 v5, v5, v17
    v_mfma_f32_16x16x32_bf16 a[128:131], v[184:187], v[44:47], a[128:131]
    v_exp_f32 v19, v115
    v_mfma_f32_16x16x32_bf16 a[176:179], v[172:175], v[40:43], a[176:179]
    v_fma_f32 v250, v250, v48, v50
    v_cvt_pk_bf16_f32 v82, v16, v17
    v_mfma_f32_16x16x32_bf16 a[176:179], v[188:191], v[44:47], a[176:179]
    s_waitcnt lgkmcnt(2)
    v_exp_f32 v16, v84
    v_mfma_f32_16x16x32_bf16 a[36:39], v[160:163], v[24:27], a[36:39]
    ds_read_b128 v[40:43], v1 offset:11264
    v_fma_f32 v254, v254, v49, v51
    v_mfma_f32_16x16x32_bf16 a[36:39], v[176:179], v[28:31], a[36:39]
    v_add_u32 v2, s3, v2
    v_add_f32 v5, v5, v18
    v_mfma_f32_16x16x32_bf16 a[84:87], v[164:167], v[24:27], a[84:87]
    v_add_f32 v5, v5, v19
    v_cvt_f32_i32 v251, v251
    v_mfma_f32_16x16x32_bf16 a[84:87], v[180:183], v[28:31], a[84:87]
    s_add_u32 s27, s27, 24576
    v_exp_f32 v17, v85
    v_mfma_f32_16x16x32_bf16 a[132:135], v[168:171], v[24:27], a[132:135]
    s_add_u32 s56, s56, 36864
    ds_read_b128 v[44:47], v1 offset:23552
    v_add_u32 v3, s3, v3
    v_mfma_f32_16x16x32_bf16 a[132:135], v[184:187], v[28:31], a[132:135]
    s_waitcnt lgkmcnt(2)
    v_cvt_pk_bf16_f32 v83, v18, v19
    v_cvt_f32_i32 v255, v255
    v_mfma_f32_16x16x32_bf16 a[180:183], v[172:175], v[24:27], a[180:183]
    s_waitcnt vmcnt(20)
    v_exp_f32 v18, v86
    v_mfma_f32_16x16x32_bf16 a[180:183], v[188:191], v[28:31], a[180:183]
    s_barrier
    v_fma_f32 v251, v251, v48, v50
    v_mfma_f32_16x16x32_bf16 a[40:43], v[160:163], v[32:35], a[40:43]
    s_sub_u32 s58, s56, 147456
    ds_read_b128 v[24:27], v2 offset:0
    v_add_f32 v6, v6, v16
    v_mfma_f32_16x16x32_bf16 a[40:43], v[176:179], v[36:39], a[40:43]
    s_min_u32 s56, s56, s58
    buffer_load_dword v15, v4, s[88:91], s93 offen
    v_mfma_f32_16x16x32_bf16 a[88:91], v[164:167], v[32:35], a[88:91]
    v_add_f32 v6, v6, v17
    v_fma_f32 v255, v255, v49, v51
    v_mfma_f32_16x16x32_bf16 a[88:91], v[180:183], v[36:39], a[88:91]
    v_exp_f32 v19, v87
    v_mfma_f32_16x16x32_bf16 a[136:139], v[168:171], v[32:35], a[136:139]
    ds_read_b128 v[28:31], v3 offset:0
    v_cvt_pk_bf16_f32 v84, v16, v17
    v_mfma_f32_16x16x32_bf16 a[136:139], v[184:187], v[36:39], a[136:139]
    v_exp_f32 v16, v116
    v_mfma_f32_16x16x32_bf16 a[184:187], v[172:175], v[32:35], a[184:187]
    v_add_f32 v6, v6, v18
    v_cvt_pk_bf16_f32 v146, v240, v244
    v_mfma_f32_16x16x32_bf16 a[184:187], v[188:191], v[36:39], a[184:187]
    s_waitcnt lgkmcnt(2)
    v_add_f32 v6, v6, v19
    v_cvt_pk_bf16_f32 v150, v241, v245
    v_mfma_f32_16x16x32_bf16 a[44:47], v[160:163], v[40:43], a[44:47]
    ds_read_b128 v[32:35], v2 offset:6144
    v_cvt_pk_bf16_f32 v147, v248, v252
    v_mfma_f32_16x16x32_bf16 a[44:47], v[176:179], v[44:47], a[44:47]
    v_exp_f32 v17, v117
    v_mfma_f32_16x16x32_bf16 a[92:95], v[164:167], v[40:43], a[92:95]
    v_cvt_pk_bf16_f32 v85, v18, v19
    v_cvt_pk_bf16_f32 v151, v249, v253
    v_mfma_f32_16x16x32_bf16 a[92:95], v[180:183], v[44:47], a[92:95]
    v_exp_f32 v18, v118
    v_mfma_f32_16x16x32_bf16 a[140:143], v[168:171], v[40:43], a[140:143]
    ds_read_b128 v[36:39], v3 offset:6144
    v_add_f32 v6, v6, v16
    v_mfma_f32_16x16x32_bf16 a[140:143], v[184:187], v[44:47], a[140:143]
    v_add_f32 v6, v6, v17
    v_cvt_pk_bf16_f32 v154, v242, v246
    v_mfma_f32_16x16x32_bf16 a[188:191], v[172:175], v[40:43], a[188:191]
    v_exp_f32 v19, v119
    v_mfma_f32_16x16x32_bf16 a[188:191], v[188:191], v[44:47], a[188:191]
    s_waitcnt lgkmcnt(2)
    v_cvt_pk_bf16_f32 v86, v16, v17
    v_add_f32 v6, v6, v18
    v_cvt_pk_bf16_f32 v155, v250, v254
    v_add_f32 v6, v6, v19
    v_cvt_pk_bf16_f32 v158, v243, v247
    v_cvt_pk_bf16_f32 v87, v18, v19
    v_cvt_pk_bf16_f32 v159, v251, v255
L_join:
    v_mfma_f32_16x16x32_bf16 v[160:163], v[24:27], a[192:195], v[128:131]
    s_waitcnt vmcnt(7)
    ds_read_b128 v[40:43], v2 offset:128
    v_lshlrev_b32 v48, 16, v56
    v_mfma_f32_16x16x32_bf16 v[160:163], v[28:31], a[196:199], v[160:163]
    s_waitcnt vmcnt(5)
    v_subrev_u32 v52, s92, v52
    v_cmp_lt_u32 vcc, 15, v52
    v_mfma_f32_16x16x32_bf16 v[164:167], v[24:27], a[216:219], v[132:135]
    v_exp_f32 v16, v88
    v_mfma_f32_16x16x32_bf16 v[164:167], v[28:31], a[220:223], v[164:167]
    v_exp_f32 v17, v89
    v_mfma_f32_16x16x32_bf16 v[168:171], v[24:27], a[240:243], v[136:139]
    s_and_b32 s59, vcc_lo, 0xff
    ds_read_b128 v[44:47], v3 offset:128
    v_and_b32 v49, s97, v56
    v_mfma_f32_16x16x32_bf16 v[168:171], v[28:31], a[244:247], v[168:171]
    s_cbranch_scc1 L_pollslow1
L_pollok1:
    v_mfma_f32_16x16x32_bf16 v[172:175], v[24:27], v[200:203], v[140:143]
    s_add_u32 s92, s92, 1
    v_exp_f32 v18, v90
    v_mfma_f32_16x16x32_bf16 v[172:175], v[28:31], v[204:207], v[172:175]
    s_waitcnt lgkmcnt(2)
    v_add_f32 v7, v7, v16
    v_add_f32 v7, v7, v17
    v_mfma_f32_16x16x32_bf16 v[96:99], v[32:35], a[192:195], v[128:131]
    ds_read_b128 v[24:27], v2 offset:6272
    v_lshlrev_b32 v50, 16, v58
    v_mfma_f32_16x16x32_bf16 v[96:99], v[36:39], a[196:199], v[96:99]
    buffer_store_dwordx4 v[144:147], v20, s[4:7], s35 offen offset:0 sc1
    v_mfma_f32_16x16x32_bf16 v[100:103], v[32:35], a[216:219], v[132:135]
    v_exp_f32 v19, v91
    v_mfma_f32_16x16x32_bf16 v[100:103], v[36:39], a[220:223], v[100:103]
    v_cvt_pk_bf16_f32 v88, v16, v17
    v_mfma_f32_16x16x32_bf16 v[104:107], v[32:35], a[240:243], v[136:139]
    ds_read_b128 v[28:31], v3 offset:6272
    v_mfma_f32_16x16x32_bf16 v[104:107], v[36:39], a[244:247], v[104:107]
    v_exp_f32 v16, v120
    v_mfma_f32_16x16x32_bf16 v[108:111], v[32:35], v[200:203], v[140:143]
    v_add_f32 v7, v7, v18
    v_add_f32 v7, v7, v19
    v_mfma_f32_16x16x32_bf16 v[108:111], v[36:39], v[204:207], v[108:111]
    s_waitcnt lgkmcnt(2)
    v_exp_f32 v17, v121
    v_mfma_f32_16x16x32_bf16 v[160:163], v[40:43], a[200:203], v[160:163]
    ds_read_b128 v[32:35], v2 offset:256
    v_cvt_pk_bf16_f32 v89, v18, v19
    v_mfma_f32_16x16x32_bf16 v[160:163], v[44:47], a[204:207], v[160:163]
    buffer_store_dwordx4 v[148:151], v20, s[4:7], s35 offen offset:3072 sc1
    v_mfma_f32_16x16x32_bf16 v[164:167], v[40:43], a[224:227], v[164:167]
    v_exp_f32 v18, v122
    v_mfma_f32_16x16x32_bf16 v[164:167], v[44:47], a[228:231], v[164:167]
    v_add_f32 v7, v7, v16
    v_add_f32 v7, v7, v17
    v_mfma_f32_16x16x32_bf16 v[168:171], v[40:43], a[248:251], v[168:171]
    ds_read_b128 v[36:39], v3 offset:256
    v_and_b32 v51, s97, v58
    v_mfma_f32_16x16x32_bf16 v[168:171], v[44:47], a[252:255], v[168:171]
    v_exp_f32 v19, v123
    v_mfma_f32_16x16x32_bf16 v[172:175], v[40:43], v[208:211], v[172:175]
    v_cvt_pk_bf16_f32 v90, v16, v17
    v_mul_f32 v48, s38, v48
    v_mfma_f32_16x16x32_bf16 v[172:175], v[44:47], v[212:215], v[172:175]
    s_waitcnt lgkmcnt(2)
    v_exp_f32 v16, v92
    v_mfma_f32_16x16x32_bf16 v[96:99], v[24:27], a[200:203], v[96:99]
    ds_read_b128 v[40:43], v2 offset:6400
    v_add_f32 v7, v7, v18
    v_mfma_f32_16x16x32_bf16 v[96:99], v[28:31], a[204:207], v[96:99]
    buffer_store_dwordx4 v[152:155], v20, s[4:7], s17 offen offset:0 sc1
    v_mfma_f32_16x16x32_bf16 v[100:103], v[24:27], a[224:227], v[100:103]
    v_add_f32 v7, v7, v19
    v_mul_f32 v49, s38, v49
    v_mfma_f32_16x16x32_bf16 v[100:103], v[28:31], a[228:231], v[100:103]
    v_exp_f32 v17, v93
    v_mfma_f32_16x16x32_bf16 v[104:107], v[24:27], a[248:251], v[104:107]
    ds_read_b128 v[44:47], v3 offset:6400
    v_cvt_pk_bf16_f32 v91, v18, v19
    v_mfma_f32_16x16x32_bf16 v[104:107], v[28:31], a[252:255], v[104:107]
    v_exp_f32 v18, v94
    v_mfma_f32_16x16x32_bf16 v[108:111], v[24:27], v[208:211], v[108:111]
    s_add_u32 s29, s30, 49152
    v_add_f32 v8, v8, v16
    v_add_f32 v8, v8, v17
    v_mfma_f32_16x16x32_bf16 v[108:111], v[28:31], v[212:215], v[108:111]
    s_waitcnt lgkmcnt(2)
    v_exp_f32 v19, v95
    v_mfma_f32_16x16x32_bf16 v[160:163], v[32:35], a[208:211], v[160:163]
    s_sub_u32 s3, s29, 147456
    ds_read_b128 v[24:27], v2 offset:12288
    v_cvt_pk_bf16_f32 v92, v16, v17
    v_mfma_f32_16x16x32_bf16 v[160:163], v[36:39], a[212:215], v[160:163]
    buffer_store_dwordx4 v[156:159], v20, s[4:7], s17 offen offset:3072 sc1
    v_mfma_f32_16x16x32_bf16 v[164:167], v[32:35], a[232:235], v[164:167]
    s_min_u32 s29, s29, s3
    v_exp_f32 v16, v124
    v_mfma_f32_16x16x32_bf16 v[164:167], v[36:39], a[236:239], v[164:167]
    v_add_f32 v8, v8, v18
    v_add_f32 v8, v8, v19
    v_mfma_f32_16x16x32_bf16 v[168:171], v[32:35], v[192:195], v[168:171]
    ds_read_b128 v[28:31], v3 offset:12288
    v_mul_f32_e64 v50, -v50, v48
    v_mfma_f32_16x16x32_bf16 v[168:171], v[36:39], v[196:199], v[168:171]
    v_exp_f32 v17, v125
    v_mfma_f32_16x16x32_bf16 v[172:175], v[32:35], v[216:219], v[172:175]
    v_cvt_pk_bf16_f32 v93, v18, v19
    v_mul_f32_e64 v51, -v51, v49
    v_mfma_f32_16x16x32_bf16 v[172:175], v[36:39], v[220:223], v[172:175]
    s_waitcnt lgkmcnt(2)
    v_exp_f32 v18, v126
    v_mfma_f32_16x16x32_bf16 v[96:99], v[40:43], a[208:211], v[96:99]
    ds_read_b128 v[32:35], v2 offset:18432
    v_add_f32 v8, v8, v16
    v_mfma_f32_16x16x32_bf16 v[96:99], v[44:47], a[212:215], v[96:99]
    s_mov_b32 m0, s26
    v_add_f32 v8, v8, v17
    s_sub_u32 s3, s29, s30
    v_mfma_f32_16x16x32_bf16 v[100:103], v[40:43], a[232:235], v[100:103]
    v_exp_f32 v19, v127
    v_mfma_f32_16x16x32_bf16 v[100:103], v[44:47], a[236:239], v[100:103]
    buffer_load_dwordx4 v4, s[4:7], s32 offen offset:0 sc1 lds
    v_mfma_f32_16x16x32_bf16 v[104:107], v[40:43], v[192:195], v[104:107]
    ds_read_b128 v[36:39], v3 offset:18432
    v_cvt_pk_bf16_f32 v94, v16, v17
    v_mfma_f32_16x16x32_bf16 v[104:107], v[44:47], v[196:199], v[104:107]
    v_add_f32 v8, v8, v18
    v_add_f32 v8, v8, v19
    v_mfma_f32_16x16x32_bf16 v[108:111], v[40:43], v[216:219], v[108:111]
    v_cvt_pk_bf16_f32 v95, v18, v19
    v_cvt_f32_i32 v224, v224
    v_mfma_f32_16x16x32_bf16 v[108:111], v[44:47], v[220:223], v[108:111]
    s_waitcnt lgkmcnt(2)
    buffer_load_dwordx4 v4, s[4:7], s32 offen offset:1024 sc1 lds
    v_mfma_f32_16x16x32_bf16 v[176:179], v[24:27], a[192:195], v[128:131]
    ds_read_b128 v[40:43], v2 offset:12416
    v_cvt_f32_i32 v225, v225
    v_mfma_f32_16x16x32_bf16 v[176:179], v[28:31], a[196:199], v[176:179]
    s_mov_b32 s30, s29
    v_exp_f32 v16, v160
    v_mfma_f32_16x16x32_bf16 v[180:183], v[24:27], a[216:219], v[132:135]
    v_exp_f32 v17, v161
    v_mfma_f32_16x16x32_bf16 v[180:183], v[28:31], a[220:223], v[180:183]
    buffer_load_dwordx4 v4, s[4:7], s32 offen offset:2048 sc1 lds
    v_mfma_f32_16x16x32_bf16 v[184:187], v[24:27], a[240:243], v[136:139]
    s_add_u32 s32, s32, 24576
    ds_read_b128 v[44:47], v3 offset:12416
    v_mfma_f32_16x16x32_bf16 v[184:187], v[28:31], a[244:247], v[184:187]
    v_exp_f32 v18, v162
    v_mfma_f32_16x16x32_bf16 v[188:191], v[24:27], v[200:203], v[140:143]
    s_add_u32 s26, s26, 12288
    v_add_f32 v5, v5, v16
    v_add_f32 v5, v5, v17
    v_mfma_f32_16x16x32_bf16 v[188:191], v[28:31], v[204:207], v[188:191]
    s_waitcnt lgkmcnt(2)
    v_exp_f32 v19, v163
    v_mfma_f32_16x16x32_bf16 v[112:115], v[32:35], a[192:195], v[128:131]
    s_mov_b32 m0, s26
    ds_read_b128 v[24:27], v2 offset:18560
    v_cvt_pk_bf16_f32 v160, v16, v17
    v_mfma_f32_16x16x32_bf16 v[112:115], v[36:39], a[196:199], v[112:115]
    v_exp_f32 v16, v96
    v_mfma_f32_16x16x32_bf16 v[116:119], v[32:35], a[216:219], v[132:135]
    v_add_f32 v5, v5, v18
    v_fma_f32 v224, v224, v48, v50
    v_mfma_f32_16x16x32_bf16 v[116:119], v[36:39], a[220:223], v[116:119]
    v_add_f32 v5, v5, v19
    v_fma_f32 v225, v225, v49, v51
    v_mfma_f32_16x16x32_bf16 v[120:123], v[32:35], a[240:243], v[136:139]
    ds_read_b128 v[28:31], v3 offset:18560
    v_add_u32 v1, s3, v1
    v_mfma_f32_16x16x32_bf16 v[120:123], v[36:39], a[244:247], v[120:123]
    buffer_load_dwordx4 v4, s[4:7], s32 offen offset:0 sc1 lds
    v_mfma_f32_16x16x32_bf16 v[124:127], v[32:35], v[200:203], v[140:143]
    v_exp_f32 v17, v97
    v_mfma_f32_16x16x32_bf16 v[124:127], v[36:39], v[204:207], v[124:127]
    s_waitcnt lgkmcnt(2)
    v_cvt_pk_bf16_f32 v161, v18, v19
    v_mfma_f32_16x16x32_bf16 v[176:179], v[40:43], a[200:203], v[176:179]
    ds_read_b128 v[32:35], v2 offset:12544
    v_cvt_pk_bf16_f32 v224, v224, v225
    v_mfma_f32_16x16x32_bf16 v[176:179], v[44:47], a[204:207], v[176:179]
    buffer_load_dwordx4 v4, s[4:7], s32 offen offset:1024 sc1 lds
    v_mfma_f32_16x16x32_bf16 v[180:183], v[40:43], a[224:227], v[180:183]
    v_exp_f32 v18, v98
    v_mfma_f32_16x16x32_bf16 v[180:183], v[44:47], a[228:231], v[180:183]
    v_add_f32 v5, v5, v16
    v_add_f32 v5, v5, v17
    v_mfma_f32_16x16x32_bf16 v[184:187], v[40:43], a[248:251], v[184:187]
    ds_read_b128 v[36:39], v3 offset:12544
    v_mfma_f32_16x16x32_bf16 v[184:187], v[44:47], a[252:255], v[184:187]
    buffer_load_dwordx4 v4, s[4:7], s32 offen offset:2048 sc1 lds
    v_mfma_f32_16x16x32_bf16 v[188:191], v[40:43], v[208:211], v[188:191]
    v_exp_f32 v19, v99
    v_mfma_f32_16x16x32_bf16 v[188:191], v[44:47], v[212:215], v[188:191]
    s_waitcnt lgkmcnt(2)
    v_cvt_pk_bf16_f32 v162, v16, v17
    v_cvt_f32_i32 v228, v228
    v_mfma_f32_16x16x32_bf16 v[112:115], v[24:27], a[200:203], v[112:115]
    ds_read_b128 v[40:43], v2 offset:18688
    v_mfma_f32_16x16x32_bf16 v[112:115], v[28:31], a[204:207], v[112:115]
    v_exp_f32 v16, v164
    v_mfma_f32_16x16x32_bf16 v[116:119], v[24:27], a[224:227], v[116:119]
    v_add_f32 v5, v5, v18
    v_add_f32 v5, v5, v19
    v_mfma_f32_16x16x32_bf16 v[116:119], v[28:31], a[228:231], v[116:119]
    s_add_u32 s32, s32, 24576
    v_exp_f32 v17, v165
    v_mfma_f32_16x16x32_bf16 v[120:123], v[24:27], a[248:251], v[120:123]
    s_add_u32 s26, s26, 36864
    ds_read_b128 v[44:47], v3 offset:18688
    v_cvt_pk_bf16_f32 v163, v18, v19
    v_mfma_f32_16x16x32_bf16 v[120:123], v[28:31], a[252:255], v[120:123]
    s_waitcnt lgkmcnt(2)
    v_exp_f32 v18, v166
    v_mfma_f32_16x16x32_bf16 v[124:127], v[24:27], v[208:211], v[124:127]
    s_waitcnt vmcnt(6)
    v_add_f32 v6, v6, v16
    v_add_f32 v6, v6, v17
    v_mfma_f32_16x16x32_bf16 v[124:127], v[28:31], v[212:215], v[124:127]
    s_barrier
    s_sub_u32 s57, s26, 147456
    v_mfma_f32_16x16x32_bf16 v[176:179], v[32:35], a[208:211], v[176:179]
    s_min_u32 s26, s26, s57
    ds_read_b128 v[24:27], v1 offset:0
    v_add_u32 v0, 1, v0
    v_mfma_f32_16x16x32_bf16 v[176:179], v[36:39], a[212:215], v[176:179]
    buffer_store_dword v0, v13, s[20:23], 0 offen offset:32 sc1
    v_mfma_f32_16x16x32_bf16 v[180:183], v[32:35], a[232:235], v[180:183]
    v_exp_f32 v19, v167
    v_mfma_f32_16x16x32_bf16 v[180:183], v[36:39], a[236:239], v[180:183]
    v_cvt_pk_bf16_f32 v164, v16, v17
    v_cvt_f32_i32 v229, v229
    v_mfma_f32_16x16x32_bf16 v[184:187], v[32:35], v[192:195], v[184:187]
    ds_read_b128 v[28:31], v1 offset:12288
    v_fma_f32 v228, v228, v48, v50
    v_mfma_f32_16x16x32_bf16 v[184:187], v[36:39], v[196:199], v[184:187]
    v_exp_f32 v16, v100
    v_mfma_f32_16x16x32_bf16 v[188:191], v[32:35], v[216:219], v[188:191]
    v_add_f32 v6, v6, v18
    v_add_f32 v6, v6, v19
    v_mfma_f32_16x16x32_bf16 v[188:191], v[36:39], v[220:223], v[188:191]
    s_waitcnt lgkmcnt(2)
    v_exp_f32 v17, v101
    v_mfma_f32_16x16x32_bf16 v[112:115], v[40:43], a[208:211], v[112:115]
    ds_read_b128 v[32:35], v1 offset:1024
    v_cvt_pk_bf16_f32 v165, v18, v19
    v_mfma_f32_16x16x32_bf16 v[112:115], v[44:47], a[212:215], v[112:115]
    v_exp_f32 v18, v102
    v_mfma_f32_16x16x32_bf16 v[116:119], v[40:43], a[232:235], v[116:119]
    v_add_f32 v6, v6, v16
    v_add_f32 v6, v6, v17
    v_mfma_f32_16x16x32_bf16 v[116:119], v[44:47], a[236:239], v[116:119]
    v_exp_f32 v19, v103
    v_mfma_f32_16x16x32_bf16 v[120:123], v[40:43], v[192:195], v[120:123]
    ds_read_b128 v[36:39], v1 offset:13312
    v_cvt_pk_bf16_f32 v166, v16, v17
    v_mfma_f32_16x16x32_bf16 v[120:123], v[44:47], v[196:199], v[120:123]
    v_add_f32 v6, v6, v18
    v_add_f32 v6, v6, v19
    v_mfma_f32_16x16x32_bf16 v[124:127], v[40:43], v[216:219], v[124:127]
    v_cvt_pk_bf16_f32 v167, v18, v19
    v_mfma_f32_16x16x32_bf16 v[124:127], v[44:47], v[220:223], v[124:127]
    s_waitcnt lgkmcnt(2)
    v_mfma_f32_16x16x32_bf16 a[0:3], v[64:67], v[24:27], a[0:3]
    s_mov_b32 m0, s26
    ds_read_b128 v[40:43], v1 offset:2048
    v_fma_f32 v229, v229, v49, v51
    v_mfma_f32_16x16x32_bf16 a[0:3], v[80:83], v[28:31], a[0:3]
    buffer_load_dwordx2 v[60:61], v10, s[72:75], s36 offen offset:192
    v_mfma_f32_16x16x32_bf16 a[48:51], v[68:71], v[24:27], a[48:51]
    v_exp_f32 v16, v168
    v_mfma_f32_16x16x32_bf16 a[48:51], v[84:87], v[28:31], a[48:51]
    v_exp_f32 v17, v169
    v_mfma_f32_16x16x32_bf16 a[96:99], v[72:75], v[24:27], a[96:99]
    ds_read_b128 v[44:47], v1 offset:14336
    v_cvt_pk_bf16_f32 v228, v228, v229
    v_mfma_f32_16x16x32_bf16 a[96:99], v[88:91], v[28:31], a[96:99]
    buffer_load_dwordx4 v4, s[4:7], s32 offen offset:0 sc1 lds
    v_mfma_f32_16x16x32_bf16 a[144:147], v[76:79], v[24:27], a[144:147]
    v_exp_f32 v18, v170
    v_mfma_f32_16x16x32_bf16 a[144:147], v[92:95], v[28:31], a[144:147]
    s_waitcnt lgkmcnt(2)
    v_add_f32 v7, v7, v16
    v_add_f32 v7, v7, v17
    v_mfma_f32_16x16x32_bf16 a[4:7], v[64:67], v[32:35], a[4:7]
    ds_read_b128 v[24:27], v1 offset:3072
    v_cvt_f32_i32 v232, v232
    v_mfma_f32_16x16x32_bf16 a[4:7], v[80:83], v[36:39], a[4:7]
    buffer_load_dwordx2 v[62:63], v10, s[76:79], s36 offen offset:192
    v_mfma_f32_16x16x32_bf16 a[52:55], v[68:71], v[32:35], a[52:55]
    v_exp_f32 v19, v171
    v_mfma_f32_16x16x32_bf16 a[52:55], v[84:87], v[36:39], a[52:55]
    v_cvt_pk_bf16_f32 v168, v16, v17
    v_cvt_f32_i32 v233, v233
    v_mfma_f32_16x16x32_bf16 a[100:103], v[72:75], v[32:35], a[100:103]
    ds_read_b128 v[28:31], v1 offset:15360
    v_fma_f32 v232, v232, v48, v50
    v_mfma_f32_16x16x32_bf16 a[100:103], v[88:91], v[36:39], a[100:103]
    buffer_load_dwordx4 v[240:243], v9, s[64:67], s33 offen offset:384 nt
    v_mfma_f32_16x16x32_bf16 a[148:151], v[76:79], v[32:35], a[148:151]
    v_exp_f32 v16, v104
    v_mfma_f32_16x16x32_bf16 a[148:151], v[92:95], v[36:39], a[148:151]
    s_waitcnt lgkmcnt(2)
    v_add_f32 v7, v7, v18
    v_add_f32 v7, v7, v19
    v_mfma_f32_16x16x32_bf16 a[8:11], v[64:67], v[40:43], a[8:11]
    ds_read_b128 v[32:35], v1 offset:4096
    v_fma_f32 v233, v233, v49, v51
    v_mfma_f32_16x16x32_bf16 a[8:11], v[80:83], v[44:47], a[8:11]
    buffer_load_dwordx4 v4, s[4:7], s32 offen offset:1024 sc1 lds
    v_mfma_f32_16x16x32_bf16 a[56:59], v[68:71], v[40:43], a[56:59]
    v_exp_f32 v17, v105
    v_mfma_f32_16x16x32_bf16 a[56:59], v[84:87], v[44:47], a[56:59]
    v_cvt_pk_bf16_f32 v169, v18, v19
    v_cvt_pk_bf16_f32 v232, v232, v233
    v_mfma_f32_16x16x32_bf16 a[104:107], v[72:75], v[40:43], a[104:107]
    ds_read_b128 v[36:39], v1 offset:16384
    v_cvt_f32_i32 v236, v236
    v_mfma_f32_16x16x32_bf16 a[104:107], v[88:91], v[44:47], a[104:107]
    buffer_load_dwordx4 v[244:247], v9, s[64:67], s33 offen offset:1920 nt
    v_mfma_f32_16x16x32_bf16 a[152:155], v[76:79], v[40:43], a[152:155]
    v_exp_f32 v18, v106
    v_mfma_f32_16x16x32_bf16 a[152:155], v[92:95], v[44:47], a[152:155]
    s_waitcnt lgkmcnt(2)
    v_add_f32 v7, v7, v16
    v_add_f32 v7, v7, v17
    v_mfma_f32_16x16x32_bf16 a[12:15], v[64:67], v[24:27], a[12:15]
    ds_read_b128 v[40:43], v1 offset:5120
    v_cvt_f32_i32 v237, v237
    v_mfma_f32_16x16x32_bf16 a[12:15], v[80:83], v[28:31], a[12:15]
    buffer_load_dwordx4 v4, s[4:7], s32 offen offset:2048 sc1 lds
    v_mfma_f32_16x16x32_bf16 a[60:63], v[68:71], v[24:27], a[60:63]
    v_exp_f32 v19, v107
    v_mfma_f32_16x16x32_bf16 a[60:63], v[84:87], v[28:31], a[60:63]
    v_cvt_pk_bf16_f32 v170, v16, v17
    v_exp_f32 v16, v172
    v_mfma_f32_16x16x32_bf16 a[108:111], v[72:75], v[24:27], a[108:111]
    ds_read_b128 v[44:47], v1 offset:17408
    v_add_f32 v7, v7, v18
    v_mfma_f32_16x16x32_bf16 a[108:111], v[88:91], v[28:31], a[108:111]
    buffer_load_dwordx4 v[248:251], v9, s[64:67], s34 offen offset:384 nt
    v_add_f32 v7, v7, v19
    v_mfma_f32_16x16x32_bf16 a[156:159], v[76:79], v[24:27], a[156:159]
    s_add_u32 s29, s28, 49152
    v_exp_f32 v17, v173
    v_mfma_f32_16x16x32_bf16 a[156:159], v[92:95], v[28:31], a[156:159]
    s_waitcnt lgkmcnt(2)
    v_cvt_pk_bf16_f32 v171, v18, v19
    v_fma_f32 v236, v236, v48, v50
    v_mfma_f32_16x16x32_bf16 a[16:19], v[64:67], v[32:35], a[16:19]
    s_sub_u32 s3, s29, 147456
    ds_read_b128 v[24:27], v1 offset:6144
    v_fma_f32 v237, v237, v49, v51
    v_mfma_f32_16x16x32_bf16 a[16:19], v[80:83], v[36:39], a[16:19]
    s_add_u32 s32, s32, 24576
    buffer_load_dwordx4 v[252:255], v9, s[64:67], s34 offen offset:1920 nt
    v_mfma_f32_16x16x32_bf16 a[64:67], v[68:71], v[32:35], a[64:67]
    s_min_u32 s29, s29, s3
    v_exp_f32 v18, v174
    v_mfma_f32_16x16x32_bf16 a[64:67], v[84:87], v[36:39], a[64:67]
    v_add_f32 v8, v8, v16
    v_add_f32 v8, v8, v17
    v_mfma_f32_16x16x32_bf16 a[112:115], v[72:75], v[32:35], a[112:115]
    s_add_u32 s26, s26, 12288
    ds_read_b128 v[28:31], v1 offset:18432
    v_cvt_pk_bf16_f32 v236, v236, v237
    v_mfma_f32_16x16x32_bf16 a[112:115], v[88:91], v[36:39], a[112:115]
    v_exp_f32 v19, v175
    v_cvt_pk_bf16_f32 v172, v16, v17
    v_mfma_f32_16x16x32_bf16 a[160:163], v[76:79], v[32:35], a[160:163]
    v_exp_f32 v16, v108
    v_mfma_f32_16x16x32_bf16 a[160:163], v[92:95], v[36:39], a[160:163]
    s_waitcnt lgkmcnt(2)
    v_add_f32 v8, v8, v18
    v_add_f32 v8, v8, v19
    v_mfma_f32_16x16x32_bf16 a[20:23], v[64:67], v[40:43], a[20:23]
    s_sub_u32 s3, s29, s28
    ds_read_b128 v[32:35], v1 offset:7168
    v_lshlrev_b32 v48, 16, v57
    v_mfma_f32_16x16x32_bf16 a[20:23], v[80:83], v[44:47], a[20:23]
    v_exp_f32 v17, v109
    v_mfma_f32_16x16x32_bf16 a[68:71], v[68:71], v[40:43], a[68:71]
    s_mov_b32 m0, s26
    v_cvt_pk_bf16_f32 v173, v18, v19
    v_and_b32 v49, s97, v57
    v_mfma_f32_16x16x32_bf16 a[68:71], v[84:87], v[44:47], a[68:71]
    v_exp_f32 v18, v110
    v_mfma_f32_16x16x32_bf16 a[116:119], v[72:75], v[40:43], a[116:119]
    ds_read_b128 v[36:39], v1 offset:19456
    v_add_f32 v8, v8, v16
    v_mfma_f32_16x16x32_bf16 a[116:119], v[88:91], v[44:47], a[116:119]
    v_add_f32 v8, v8, v17
    v_mfma_f32_16x16x32_bf16 a[164:167], v[76:79], v[40:43], a[164:167]
    s_mov_b32 s28, s29
    v_exp_f32 v19, v111
    v_mfma_f32_16x16x32_bf16 a[164:167], v[92:95], v[44:47], a[164:167]
    s_waitcnt lgkmcnt(2)
    v_cvt_pk_bf16_f32 v174, v16, v17
    v_add_f32 v8, v8, v18
    v_mfma_f32_16x16x32_bf16 a[24:27], v[64:67], v[24:27], a[24:27]
    ds_read_b128 v[40:43], v1 offset:8192
    v_add_f32 v8, v8, v19
    v_mfma_f32_16x16x32_bf16 a[24:27], v[80:83], v[28:31], a[24:27]
    v_cvt_pk_bf16_f32 v175, v18, v19
    v_lshlrev_b32 v50, 16, v59
    v_mfma_f32_16x16x32_bf16 a[72:75], v[68:71], v[24:27], a[72:75]
    v_exp_f32 v16, v176
    v_mfma_f32_16x16x32_bf16 a[72:75], v[84:87], v[28:31], a[72:75]
    buffer_load_dwordx4 v4, s[4:7], s32 offen offset:0 sc1 lds
    v_mfma_f32_16x16x32_bf16 a[120:123], v[72:75], v[24:27], a[120:123]
    ds_read_b128 v[44:47], v1 offset:20480
    v_and_b32 v51, s97, v59
    v_mfma_f32_16x16x32_bf16 a[120:123], v[88:91], v[28:31], a[120:123]
    v_exp_f32 v17, v177
    v_mfma_f32_16x16x32_bf16 a[168:171], v[76:79], v[24:27], a[168:171]
    v_exp_f32 v18, v178
    v_mfma_f32_16x16x32_bf16 a[168:171], v[92:95], v[28:31], a[168:171]
    s_waitcnt lgkmcnt(2)
    v_add_f32 v5, v5, v16
    v_add_f32 v5, v5, v17
    v_mfma_f32_16x16x32_bf16 a[28:31], v[64:67], v[32:35], a[28:31]
    ds_read_b128 v[24:27], v1 offset:9216
    v_mul_f32 v48, s38, v48
    v_mfma_f32_16x16x32_bf16 a[28:31], v[80:83], v[36:39], a[28:31]
    v_exp_f32 v19, v179
    v_mfma_f32_16x16x32_bf16 a[76:79], v[68:71], v[32:35], a[76:79]
    v_cvt_pk_bf16_f32 v176, v16, v17
    v_add_u32 v2, s3, v2
    v_mfma_f32_16x16x32_bf16 a[76:79], v[84:87], v[36:39], a[76:79]
    v_exp_f32 v16, v112
    v_mfma_f32_16x16x32_bf16 a[124:127], v[72:75], v[32:35], a[124:127]
    ds_read_b128 v[28:31], v1 offset:21504
    v_add_f32 v5, v5, v18
    v_mfma_f32_16x16x32_bf16 a[124:127], v[88:91], v[36:39], a[124:127]
    v_add_f32 v5, v5, v19
    v_mul_f32 v49, s38, v49
    v_mfma_f32_16x16x32_bf16 a[172:175], v[76:79], v[32:35], a[172:175]
    v_exp_f32 v17, v113
    v_mfma_f32_16x16x32_bf16 a[172:175], v[92:95], v[36:39], a[172:175]
    s_waitcnt lgkmcnt(2)
    buffer_load_dwordx4 v4, s[4:7], s32 offen offset:1024 sc1 lds
    v_mfma_f32_16x16x32_bf16 a[32:35], v[64:67], v[40:43], a[32:35]
    ds_read_b128 v[32:35], v1 offset:10240
    v_cvt_pk_bf16_f32 v177, v18, v19
    v_mfma_f32_16x16x32_bf16 a[32:35], v[80:83], v[44:47], a[32:35]
    v_exp_f32 v18, v114
    v_mfma_f32_16x16x32_bf16 a[80:83], v[68:71], v[40:43], a[80:83]
    v_add_f32 v5, v5, v16
    v_add_f32 v5, v5, v17
    v_mfma_f32_16x16x32_bf16 a[80:83], v[84:87], v[44:47], a[80:83]
    v_exp_f32 v19, v115
    v_mfma_f32_16x16x32_bf16 a[128:131], v[72:75], v[40:43], a[128:131]
    ds_read_b128 v[36:39], v1 offset:22528
    v_mul_f32_e64 v50, -v50, v48
    v_mfma_f32_16x16x32_bf16 a[128:131], v[88:91], v[44:47], a[128:131]
    v_cvt_pk_bf16_f32 v178, v16, v17
    v_mul_f32_e64 v51, -v51, v49
    v_mfma_f32_16x16x32_bf16 a[176:179], v[76:79], v[40:43], a[176:179]
    v_exp_f32 v16, v180
    v_mfma_f32_16x16x32_bf16 a[176:179], v[92:95], v[44:47], a[176:179]
    s_waitcnt lgkmcnt(2)
    v_add_f32 v5, v5, v18
    v_add_u32 v3, s3, v3
    v_mfma_f32_16x16x32_bf16 a[36:39], v[64:67], v[24:27], a[36:39]
    ds_read_b128 v[40:43], v1 offset:11264
    v_add_f32 v5, v5, v19
    v_mfma_f32_16x16x32_bf16 a[36:39], v[80:83], v[28:31], a[36:39]
    buffer_load_dwordx4 v4, s[4:7], s32 offen offset:2048 sc1 lds
    v_mfma_f32_16x16x32_bf16 a[84:87], v[68:71], v[24:27], a[84:87]
    v_exp_f32 v17, v181
    v_mfma_f32_16x16x32_bf16 a[84:87], v[84:87], v[28:31], a[84:87]
    v_cvt_pk_bf16_f32 v179, v18, v19
    v_cvt_f32_i32 v226, v226
    v_mfma_f32_16x16x32_bf16 a[132:135], v[72:75], v[24:27], a[132:135]
    ds_read_b128 v[44:47], v1 offset:23552
    v_cvt_f32_i32 v227, v227
    v_mfma_f32_16x16x32_bf16 a[132:135], v[88:91], v[28:31], a[132:135]
    s_waitcnt lgkmcnt(2)
    v_exp_f32 v18, v182
    v_mfma_f32_16x16x32_bf16 a[180:183], v[76:79], v[24:27], a[180:183]
    s_waitcnt vmcnt(13)
    v_add_f32 v6, v6, v16
    v_add_f32 v6, v6, v17
    v_mfma_f32_16x16x32_bf16 a[180:183], v[92:95], v[28:31], a[180:183]
    s_barrier
    v_fma_f32 v226, v226, v48, v50
    v_mfma_f32_16x16x32_bf16 a[40:43], v[64:67], v[32:35], a[40:43]
    ds_read_b128 v[24:27], v2 offset:0
    v_fma_f32 v227, v227, v49, v51
    v_mfma_f32_16x16x32_bf16 a[40:43], v[80:83], v[36:39], a[40:43]
    v_exp_f32 v19, v183
    v_mfma_f32_16x16x32_bf16 a[88:91], v[68:71], v[32:35], a[88:91]
    v_cvt_pk_bf16_f32 v180, v16, v17
    v_mfma_f32_16x16x32_bf16 a[88:91], v[84:87], v[36:39], a[88:91]
    v_exp_f32 v16, v116
    v_mfma_f32_16x16x32_bf16 a[136:139], v[72:75], v[32:35], a[136:139]
    ds_read_b128 v[28:31], v3 offset:0
    v_add_f32 v6, v6, v18
    v_mfma_f32_16x16x32_bf16 a[136:139], v[88:91], v[36:39], a[136:139]
    v_add_f32 v6, v6, v19
    v_cvt_pk_bf16_f32 v225, v226, v227
    v_mfma_f32_16x16x32_bf16 a[184:187], v[76:79], v[32:35], a[184:187]
    v_exp_f32 v17, v117
    v_mfma_f32_16x16x32_bf16 a[184:187], v[92:95], v[36:39], a[184:187]
    s_waitcnt lgkmcnt(2)
    v_cvt_pk_bf16_f32 v181, v18, v19
    v_cvt_f32_i32 v230, v230
    v_mfma_f32_16x16x32_bf16 a[44:47], v[64:67], v[40:43], a[44:47]
    ds_read_b128 v[32:35], v2 offset:6144
    v_mfma_f32_16x16x32_bf16 a[44:47], v[80:83], v[44:47], a[44:47]
    v_exp_f32 v18, v118
    v_mfma_f32_16x16x32_bf16 a[92:95], v[68:71], v[40:43], a[92:95]
    v_add_f32 v6, v6, v16
    v_add_f32 v6, v6, v17
    v_mfma_f32_16x16x32_bf16 a[92:95], v[84:87], v[44:47], a[92:95]
    s_add_u32 s32, s32, 24576
    v_exp_f32 v19, v119
    v_mfma_f32_16x16x32_bf16 a[140:143], v[72:75], v[40:43], a[140:143]
    s_add_u32 s26, s26, 36864
    ds_read_b128 v[36:39], v3 offset:6144
    v_cvt_pk_bf16_f32 v182, v16, v17
    v_mfma_f32_16x16x32_bf16 a[140:143], v[88:91], v[44:47], a[140:143]
    s_sub_u32 s57, s26, 147456
    v_add_f32 v6, v6, v18
    v_add_f32 v6, v6, v19
    v_mfma_f32_16x16x32_bf16 a[188:191], v[76:79], v[40:43], a[188:191]
    s_min_u32 s26, s26, s57
    v_cvt_pk_bf16_f32 v183, v18, v19
    v_mfma_f32_16x16x32_bf16 a[188:191], v[92:95], v[44:47], a[188:191]
    s_waitcnt lgkmcnt(2)
    v_mfma_f32_16x16x32_bf16 v[64:67], v[24:27], a[192:195], v[128:131]
    ds_read_b128 v[40:43], v2 offset:128
    v_cvt_f32_i32 v231, v231
    v_mfma_f32_16x16x32_bf16 v[64:67], v[28:31], a[196:199], v[64:67]
    v_exp_f32 v16, v184
    v_mfma_f32_16x16x32_bf16 v[68:71], v[24:27], a[216:219], v[132:135]
    v_exp_f32 v17, v185
    v_mfma_f32_16x16x32_bf16 v[68:71], v[28:31], a[220:223], v[68:71]
    v_bfe_u32 v53, v4, 4, 6
    v_fma_f32 v230, v230, v48, v50
    v_mfma_f32_16x16x32_bf16 v[72:75], v[24:27], a[240:243], v[136:139]
    ds_read_b128 v[44:47], v3 offset:128
    v_lshlrev_b32 v53, 2, v53
    v_mfma_f32_16x16x32_bf16 v[72:75], v[28:31], a[244:247], v[72:75]
    buffer_load_dword v52, v53, s[20:23], s44 offen sc1
    v_mfma_f32_16x16x32_bf16 v[76:79], v[24:27], v[200:203], v[140:143]
    v_exp_f32 v18, v186
    v_mfma_f32_16x16x32_bf16 v[76:79], v[28:31], v[204:207], v[76:79]
    s_waitcnt lgkmcnt(2)
    v_add_f32 v7, v7, v16
    v_add_f32 v7, v7, v17
    v_mfma_f32_16x16x32_bf16 v[96:99], v[32:35], a[192:195], v[128:131]
    ds_read_b128 v[24:27], v2 offset:6272
    v_fma_f32 v231, v231, v49, v51
    v_mfma_f32_16x16x32_bf16 v[96:99], v[36:39], a[196:199], v[96:99]
    v_exp_f32 v19, v187
    v_mfma_f32_16x16x32_bf16 v[100:103], v[32:35], a[216:219], v[132:135]
    v_cvt_pk_bf16_f32 v184, v16, v17
    v_cvt_pk_bf16_f32 v229, v230, v231
    v_mfma_f32_16x16x32_bf16 v[100:103], v[36:39], a[220:223], v[100:103]
    s_add_u32 s35, s35, 196608
    v_exp_f32 v16, v120
    v_mfma_f32_16x16x32_bf16 v[104:107], v[32:35], a[240:243], v[136:139]
    s_mov_b32 m0, s26
    ds_read_b128 v[28:31], v3 offset:6272
    v_add_f32 v7, v7, v18
    v_mfma_f32_16x16x32_bf16 v[104:107], v[36:39], a[244:247], v[104:107]
    s_add_u32 s16, s16, 196608
    buffer_load_dwordx4 v4, s[4:7], s32 offen offset:0 sc1 lds
    v_mfma_f32_16x16x32_bf16 v[108:111], v[32:35], v[200:203], v[140:143]
    s_add_u32 s17, s17, 196608
    v_add_f32 v7, v7, v19
    v_cvt_f32_i32 v234, v234
    v_mfma_f32_16x16x32_bf16 v[108:111], v[36:39], v[204:207], v[108:111]
    s_waitcnt lgkmcnt(2)
    v_exp_f32 v17, v121
    v_mfma_f32_16x16x32_bf16 v[64:67], v[40:43], a[200:203], v[64:67]
    s_add_u32 s37, s37, 512
    ds_read_b128 v[32:35], v2 offset:256
    v_cvt_pk_bf16_f32 v185, v18, v19
    v_mfma_f32_16x16x32_bf16 v[64:67], v[44:47], a[204:207], v[64:67]
    v_exp_f32 v18, v122
    v_mfma_f32_16x16x32_bf16 v[68:71], v[40:43], a[224:227], v[68:71]
    v_add_f32 v7, v7, v16
    v_add_f32 v7, v7, v17
    v_mfma_f32_16x16x32_bf16 v[68:71], v[44:47], a[228:231], v[68:71]
    v_exp_f32 v19, v123
    v_mfma_f32_16x16x32_bf16 v[72:75], v[40:43], a[248:251], v[72:75]
    ds_read_b128 v[36:39], v3 offset:256
    v_cvt_pk_bf16_f32 v186, v16, v17
    v_mfma_f32_16x16x32_bf16 v[72:75], v[44:47], a[252:255], v[72:75]
    buffer_load_dwordx4 v4, s[4:7], s32 offen offset:1024 sc1 lds
    v_mfma_f32_16x16x32_bf16 v[76:79], v[40:43], v[208:211], v[76:79]
    v_exp_f32 v16, v188
    v_mfma_f32_16x16x32_bf16 v[76:79], v[44:47], v[212:215], v[76:79]
    s_waitcnt lgkmcnt(2)
    v_add_f32 v7, v7, v18
    v_cvt_f32_i32 v235, v235
    v_mfma_f32_16x16x32_bf16 v[96:99], v[24:27], a[200:203], v[96:99]
    ds_read_b128 v[40:43], v2 offset:6400
    v_add_f32 v7, v7, v19
    v_mfma_f32_16x16x32_bf16 v[96:99], v[28:31], a[204:207], v[96:99]
    buffer_load_dwordx2 v[56:57], off, s[80:83], s37 offset:0
    v_mfma_f32_16x16x32_bf16 v[100:103], v[24:27], a[224:227], v[100:103]
    v_exp_f32 v17, v189
    v_mfma_f32_16x16x32_bf16 v[100:103], v[28:31], a[228:231], v[100:103]
    v_cvt_pk_bf16_f32 v187, v18, v19
    v_fma_f32 v234, v234, v48, v50
    v_mfma_f32_16x16x32_bf16 v[104:107], v[24:27], a[248:251], v[104:107]
    ds_read_b128 v[44:47], v3 offset:6400
    v_fma_f32 v235, v235, v49, v51
    v_mfma_f32_16x16x32_bf16 v[104:107], v[28:31], a[252:255], v[104:107]
    buffer_load_dwordx2 v[58:59], off, s[84:87], s37 offset:0
    v_mfma_f32_16x16x32_bf16 v[108:111], v[24:27], v[208:211], v[108:111]
    s_add_u32 s29, s30, 49152
    v_exp_f32 v18, v190
    v_mfma_f32_16x16x32_bf16 v[108:111], v[28:31], v[212:215], v[108:111]
    s_waitcnt lgkmcnt(2)
    v_add_f32 v8, v8, v16
    v_add_f32 v8, v8, v17
    v_mfma_f32_16x16x32_bf16 v[64:67], v[32:35], a[208:211], v[64:67]
    s_sub_u32 s3, s29, 147456
    ds_read_b128 v[24:27], v2 offset:12288
    v_cvt_pk_bf16_f32 v233, v234, v235
    v_mfma_f32_16x16x32_bf16 v[64:67], v[36:39], a[212:215], v[64:67]
    s_min_u32 s29, s29, s3
    buffer_load_dwordx4 v4, s[4:7], s32 offen offset:2048 sc1 lds
    v_mfma_f32_16x16x32_bf16 v[68:71], v[32:35], a[232:235], v[68:71]
    v_exp_f32 v19, v191
    v_mfma_f32_16x16x32_bf16 v[68:71], v[36:39], a[236:239], v[68:71]
    v_cvt_pk_bf16_f32 v188, v16, v17
    v_cvt_f32_i32 v238, v238
    v_mfma_f32_16x16x32_bf16 v[72:75], v[32:35], v[192:195], v[72:75]
    ds_read_b128 v[28:31], v3 offset:12288
    v_mfma_f32_16x16x32_bf16 v[72:75], v[36:39], v[196:199], v[72:75]
    buffer_load_dwordx4 v[144:147], v12, s[68:71], s35 offen offset:0 nt
    v_mfma_f32_16x16x32_bf16 v[76:79], v[32:35], v[216:219], v[76:79]
    v_exp_f32 v16, v124
    v_mfma_f32_16x16x32_bf16 v[76:79], v[36:39], v[220:223], v[76:79]
    s_waitcnt lgkmcnt(2)
    v_add_f32 v8, v8, v18
    v_add_f32 v8, v8, v19
    v_mfma_f32_16x16x32_bf16 v[96:99], v[40:43], a[208:211], v[96:99]
    s_add_u32 s32, s32, 24576
    ds_read_b128 v[32:35], v2 offset:18432
    v_cvt_f32_i32 v239, v239
    v_mfma_f32_16x16x32_bf16 v[96:99], v[44:47], a[212:215], v[96:99]
    s_sub_u32 s3, s29, s30
    v_exp_f32 v17, v125
    v_mfma_f32_16x16x32_bf16 v[100:103], v[40:43], a[232:235], v[100:103]
    v_cvt_pk_bf16_f32 v189, v18, v19
    v_fma_f32 v238, v238, v48, v50
    v_mfma_f32_16x16x32_bf16 v[100:103], v[44:47], a[236:239], v[100:103]
    v_exp_f32 v18, v126
    v_mfma_f32_16x16x32_bf16 v[104:107], v[40:43], v[192:195], v[104:107]
    s_add_u32 s26, s26, 12288
    ds_read_b128 v[36:39], v3 offset:18432
    v_add_f32 v8, v8, v16
    v_mfma_f32_16x16x32_bf16 v[104:107], v[44:47], v[196:199], v[104:107]
    buffer_load_dwordx4 v[148:151], v12, s[68:71], s35 offen offset:768 nt
    v_mfma_f32_16x16x32_bf16 v[108:111], v[40:43], v[216:219], v[108:111]
    v_add_f32 v8, v8, v17
    v_fma_f32 v239, v239, v49, v51
    v_mfma_f32_16x16x32_bf16 v[108:111], v[44:47], v[220:223], v[108:111]
    s_waitcnt lgkmcnt(2)
    v_exp_f32 v19, v127
    v_mfma_f32_16x16x32_bf16 v[80:83], v[24:27], a[192:195], v[128:131]
    ds_read_b128 v[40:43], v2 offset:12416
    v_cvt_pk_bf16_f32 v190, v16, v17
    v_mfma_f32_16x16x32_bf16 v[80:83], v[28:31], a[196:199], v[80:83]
    s_mov_b32 m0, s26
    v_add_f32 v8, v8, v18
    v_add_f32 v8, v8, v19
    v_mfma_f32_16x16x32_bf16 v[84:87], v[24:27], a[216:219], v[132:135]
    s_mov_b32 s30, s29
    v_cvt_pk_bf16_f32 v191, v18, v19
    v_cvt_pk_bf16_f32 v237, v238, v239
    v_mfma_f32_16x16x32_bf16 v[84:87], v[28:31], a[220:223], v[84:87]
    v_exp_f32 v16, v64
    v_mfma_f32_16x16x32_bf16 v[88:91], v[24:27], a[240:243], v[136:139]
    ds_read_b128 v[44:47], v3 offset:12416
    v_mfma_f32_16x16x32_bf16 v[88:91], v[28:31], a[244:247], v[88:91]
    buffer_load_dwordx4 v[152:155], v12, s[68:71], s35 offen offset:1536 nt
    v_mfma_f32_16x16x32_bf16 v[92:95], v[24:27], v[200:203], v[140:143]
    v_exp_f32 v17, v65
    v_mfma_f32_16x16x32_bf16 v[92:95], v[28:31], v[204:207], v[92:95]
    s_waitcnt lgkmcnt(2)
    v_exp_f32 v18, v66
    v_mfma_f32_16x16x32_bf16 v[112:115], v[32:35], a[192:195], v[128:131]
    ds_read_b128 v[24:27], v2 offset:18560
    v_add_f32 v5, v5, v16
    v_mfma_f32_16x16x32_bf16 v[112:115], v[36:39], a[196:199], v[112:115]
    buffer_load_dwordx4 v4, s[4:7], s32 offen offset:0 sc1 lds
    v_mfma_f32_16x16x32_bf16 v[116:119], v[32:35], a[216:219], v[132:135]
    v_add_f32 v5, v5, v17
    v_add_u32 v1, s3, v1
    v_mfma_f32_16x16x32_bf16 v[116:119], v[36:39], a[220:223], v[116:119]
    v_exp_f32 v19, v67
    v_mfma_f32_16x16x32_bf16 v[120:123], v[32:35], a[240:243], v[136:139]
    ds_read_b128 v[28:31], v3 offset:18560
    v_cvt_pk_bf16_f32 v64, v16, v17
    v_mfma_f32_16x16x32_bf16 v[120:123], v[36:39], a[244:247], v[120:123]
    s_waitcnt vmcnt(13)
    buffer_load_dwordx4 v[156:159], v12, s[68:71], s35 offen offset:2304 nt
    v_mfma_f32_16x16x32_bf16 v[124:127], v[32:35], v[200:203], v[140:143]
    v_exp_f32 v16, v96
    v_mfma_f32_16x16x32_bf16 v[124:127], v[36:39], v[204:207], v[124:127]
    s_waitcnt lgkmcnt(2)
    v_add_f32 v5, v5, v18
    v_add_f32 v5, v5, v19
    v_mfma_f32_16x16x32_bf16 v[80:83], v[40:43], a[200:203], v[80:83]
    ds_read_b128 v[32:35], v2 offset:12544
    v_lshlrev_b32 v48, 16, v60
    v_mfma_f32_16x16x32_bf16 v[80:83], v[44:47], a[204:207], v[80:83]
    v_exp_f32 v17, v97
    v_mfma_f32_16x16x32_bf16 v[84:87], v[40:43], a[224:227], v[84:87]
    v_cvt_pk_bf16_f32 v65, v18, v19
    v_and_b32 v49, s97, v60
    v_mfma_f32_16x16x32_bf16 v[84:87], v[44:47], a[228:231], v[84:87]
    buffer_load_dwordx4 v4, s[4:7], s32 offen offset:1024 sc1 lds
    v_mfma_f32_16x16x32_bf16 v[88:91], v[40:43], a[248:251], v[88:91]
    ds_read_b128 v[36:39], v3 offset:12544
    v_lshlrev_b32 v50, 16, v62
    v_mfma_f32_16x16x32_bf16 v[88:91], v[44:47], a[252:255], v[88:91]
    v_exp_f32 v18, v98
    v_mfma_f32_16x16x32_bf16 v[92:95], v[40:43], v[208:211], v[92:95]
    v_add_f32 v5, v5, v16
    v_add_f32 v5, v5, v17
    v_mfma_f32_16x16x32_bf16 v[92:95], v[44:47], v[212:215], v[92:95]
    s_waitcnt lgkmcnt(2)
    v_exp_f32 v19, v99
    v_mfma_f32_16x16x32_bf16 v[112:115], v[24:27], a[200:203], v[112:115]
    ds_read_b128 v[40:43], v2 offset:18688
    v_cvt_pk_bf16_f32 v66, v16, v17
    v_mfma_f32_16x16x32_bf16 v[112:115], v[28:31], a[204:207], v[112:115]
    v_exp_f32 v16, v68
    v_mfma_f32_16x16x32_bf16 v[116:119], v[24:27], a[224:227], v[116:119]
    v_add_f32 v5, v5, v18
    v_add_f32 v5, v5, v19
    v_mfma_f32_16x16x32_bf16 v[116:119], v[28:31], a[228:231], v[116:119]
    v_exp_f32 v17, v69
    v_mfma_f32_16x16x32_bf16 v[120:123], v[24:27], a[248:251], v[120:123]
    ds_read_b128 v[44:47], v3 offset:18688
    v_cvt_pk_bf16_f32 v67, v18, v19
    v_mfma_f32_16x16x32_bf16 v[120:123], v[28:31], a[252:255], v[120:123]
    s_waitcnt lgkmcnt(2)
    buffer_load_dwordx4 v4, s[4:7], s32 offen offset:2048 sc1 lds
    v_mfma_f32_16x16x32_bf16 v[124:127], v[24:27], v[208:211], v[124:127]
    s_waitcnt vmcnt(36)
    v_exp_f32 v18, v70
    v_mfma_f32_16x16x32_bf16 v[124:127], v[28:31], v[212:215], v[124:127]
    s_barrier
    v_add_f32 v6, v6, v16
    v_mfma_f32_16x16x32_bf16 v[80:83], v[32:35], a[208:211], v[80:83]
    ds_read_b128 v[24:27], v1 offset:0
    v_add_f32 v6, v6, v17
    v_mfma_f32_16x16x32_bf16 v[80:83], v[36:39], a[212:215], v[80:83]
    v_exp_f32 v19, v71
    v_mfma_f32_16x16x32_bf16 v[84:87], v[32:35], a[232:235], v[84:87]
    v_cvt_pk_bf16_f32 v68, v16, v17
    v_and_b32 v51, s97, v62
    v_mfma_f32_16x16x32_bf16 v[84:87], v[36:39], a[236:239], v[84:87]
    v_exp_f32 v16, v100
    v_mfma_f32_16x16x32_bf16 v[88:91], v[32:35], v[192:195], v[88:91]
    ds_read_b128 v[28:31], v1 offset:12288
    v_add_f32 v6, v6, v18
    v_mfma_f32_16x16x32_bf16 v[88:91], v[36:39], v[196:199], v[88:91]
    v_add_f32 v6, v6, v19
    v_mul_f32 v48, s38, v48
    v_mfma_f32_16x16x32_bf16 v[92:95], v[32:35], v[216:219], v[92:95]
    v_exp_f32 v17, v101
    v_mfma_f32_16x16x32_bf16 v[92:95], v[36:39], v[220:223], v[92:95]
    s_waitcnt lgkmcnt(2)
    v_cvt_pk_bf16_f32 v69, v18, v19
    v_mul_f32 v49, s38, v49
    v_mfma_f32_16x16x32_bf16 v[112:115], v[40:43], a[208:211], v[112:115]
    ds_read_b128 v[32:35], v1 offset:1024
    v_mul_f32_e64 v50, -v50, v48
    v_mfma_f32_16x16x32_bf16 v[112:115], v[44:47], a[212:215], v[112:115]
    v_exp_f32 v18, v102
    v_mfma_f32_16x16x32_bf16 v[116:119], v[40:43], a[232:235], v[116:119]
    v_add_f32 v6, v6, v16
    v_add_f32 v6, v6, v17
    v_mfma_f32_16x16x32_bf16 v[116:119], v[44:47], a[236:239], v[116:119]
    v_exp_f32 v19, v103
    v_mfma_f32_16x16x32_bf16 v[120:123], v[40:43], v[192:195], v[120:123]
    ds_read_b128 v[36:39], v1 offset:13312
    v_cvt_pk_bf16_f32 v70, v16, v17
    v_mfma_f32_16x16x32_bf16 v[120:123], v[44:47], v[196:199], v[120:123]
    s_add_u32 s32, s32, 24576
    v_add_f32 v6, v6, v18
    v_mul_f32_e64 v51, -v51, v49
    v_mfma_f32_16x16x32_bf16 v[124:127], v[40:43], v[216:219], v[124:127]
    s_add_u32 s26, s26, 36864
    v_add_f32 v6, v6, v19
    s_sub_u32 s57, s26, 147456
    v_mfma_f32_16x16x32_bf16 v[124:127], v[44:47], v[220:223], v[124:127]
    s_waitcnt lgkmcnt(2)
    v_cvt_pk_bf16_f32 v71, v18, v19
    s_min_u32 s26, s26, s57
    v_mfma_f32_16x16x32_bf16 a[0:3], v[160:163], v[24:27], a[0:3]
    ds_read_b128 v[40:43], v1 offset:2048
    v_cvt_f32_i32 v240, v240
    v_mfma_f32_16x16x32_bf16 a[0:3], v[176:179], v[28:31], a[0:3]
    s_waitcnt vmcnt(12)
    v_subrev_u32 v52, s92, v52
    v_cmp_lt_u32 vcc, 15, v52
    v_mfma_f32_16x16x32_bf16 a[48:51], v[164:167], v[24:27], a[48:51]
    v_exp_f32 v16, v72
    v_mfma_f32_16x16x32_bf16 a[48:51], v[180:183], v[28:31], a[48:51]
    v_exp_f32 v17, v73
    v_mfma_f32_16x16x32_bf16 a[96:99], v[168:171], v[24:27], a[96:99]
    s_and_b32 s59, vcc_lo, 0xff
    ds_read_b128 v[44:47], v1 offset:14336
    v_cvt_f32_i32 v241, v241
    v_mfma_f32_16x16x32_bf16 a[96:99], v[184:187], v[28:31], a[96:99]
    s_cbranch_scc1 L_pollslow2
L_pollok2:
    v_mfma_f32_16x16x32_bf16 a[144:147], v[172:175], v[24:27], a[144:147]
    s_add_u32 s92, s92, 1
    v_exp_f32 v18, v74
    v_mfma_f32_16x16x32_bf16 a[144:147], v[188:191], v[28:31], a[144:147]
    s_waitcnt lgkmcnt(2)
    v_add_f32 v7, v7, v16
    v_add_f32 v7, v7, v17
    v_mfma_f32_16x16x32_bf16 a[4:7], v[160:163], v[32:35], a[4:7]
    s_mov_b32 m0, s56
    ds_read_b128 v[24:27], v1 offset:3072
    v_fma_f32 v240, v240, v48, v50
    v_mfma_f32_16x16x32_bf16 a[4:7], v[176:179], v[36:39], a[4:7]
    buffer_load_dwordx4 v4, s[4:7], s27 offen offset:0 sc1 lds
    v_mfma_f32_16x16x32_bf16 a[52:55], v[164:167], v[32:35], a[52:55]
    v_exp_f32 v19, v75
    v_mfma_f32_16x16x32_bf16 a[52:55], v[180:183], v[36:39], a[52:55]
    v_cvt_pk_bf16_f32 v72, v16, v17
    v_fma_f32 v241, v241, v49, v51
    v_mfma_f32_16x16x32_bf16 a[100:103], v[168:171], v[32:35], a[100:103]
    ds_read_b128 v[28:31], v1 offset:15360
    v_cvt_pk_bf16_f32 v226, v240, v241
    v_mfma_f32_16x16x32_bf16 a[100:103], v[184:187], v[36:39], a[100:103]
    v_exp_f32 v16, v104
    v_mfma_f32_16x16x32_bf16 a[148:151], v[172:175], v[32:35], a[148:151]
    v_add_f32 v7, v7, v18
    v_add_f32 v7, v7, v19
    v_mfma_f32_16x16x32_bf16 a[148:151], v[188:191], v[36:39], a[148:151]
    s_waitcnt lgkmcnt(2)
    v_exp_f32 v17, v105
    v_mfma_f32_16x16x32_bf16 a[8:11], v[160:163], v[40:43], a[8:11]
    ds_read_b128 v[32:35], v1 offset:4096
    v_cvt_pk_bf16_f32 v73, v18, v19
    v_mfma_f32_16x16x32_bf16 a[8:11], v[176:179], v[44:47], a[8:11]
    buffer_load_dwordx4 v4, s[4:7], s27 offen offset:1024 sc1 lds
    v_mfma_f32_16x16x32_bf16 a[56:59], v[164:167], v[40:43], a[56:59]
    v_exp_f32 v18, v106
    v_mfma_f32_16x16x32_bf16 a[56:59], v[180:183], v[44:47], a[56:59]
    v_add_f32 v7, v7, v16
    v_cvt_f32_i32 v244, v244
    v_mfma_f32_16x16x32_bf16 a[104:107], v[168:171], v[40:43], a[104:107]
    ds_read_b128 v[36:39], v1 offset:16384
    v_add_f32 v7, v7, v17
    v_mfma_f32_16x16x32_bf16 a[104:107], v[184:187], v[44:47], a[104:107]
    v_exp_f32 v19, v107
    v_mfma_f32_16x16x32_bf16 a[152:155], v[172:175], v[40:43], a[152:155]
    v_cvt_f32_i32 v245, v245
    v_cvt_pk_bf16_f32 v74, v16, v17
    v_mfma_f32_16x16x32_bf16 a[152:155], v[188:191], v[44:47], a[152:155]
    s_waitcnt lgkmcnt(2)
    v_exp_f32 v16, v76
    v_mfma_f32_16x16x32_bf16 a[12:15], v[160:163], v[24:27], a[12:15]
    ds_read_b128 v[40:43], v1 offset:5120
    v_fma_f32 v244, v244, v48, v50
    v_mfma_f32_16x16x32_bf16 a[12:15], v[176:179], v[28:31], a[12:15]
    buffer_load_dwordx4 v4, s[4:7], s27 offen offset:2048 sc1 lds
    v_mfma_f32_16x16x32_bf16 a[60:63], v[164:167], v[24:27], a[60:63]
    v_add_f32 v7, v7, v18
    v_add_f32 v7, v7, v19
    v_mfma_f32_16x16x32_bf16 a[60:63], v[180:183], v[28:31], a[60:63]
    v_exp_f32 v17, v77
    v_mfma_f32_16x16x32_bf16 a[108:111], v[168:171], v[24:27], a[108:111]
    ds_read_b128 v[44:47], v1 offset:17408
    v_fma_f32 v245, v245, v49, v51
    v_mfma_f32_16x16x32_bf16 a[108:111], v[184:187], v[28:31], a[108:111]
    v_cvt_pk_bf16_f32 v75, v18, v19
    v_cvt_pk_bf16_f32 v230, v244, v245
    v_mfma_f32_16x16x32_bf16 a[156:159], v[172:175], v[24:27], a[156:159]
    s_add_u32 s29, s28, 49152
    v_exp_f32 v18, v78
    v_mfma_f32_16x16x32_bf16 a[156:159], v[188:191], v[28:31], a[156:159]
    s_waitcnt lgkmcnt(2)
    v_add_f32 v8, v8, v16
    v_cvt_f32_i32 v248, v248
    v_mfma_f32_16x16x32_bf16 a[16:19], v[160:163], v[32:35], a[16:19]
    s_sub_u32 s3, s29, 147456
    ds_read_b128 v[24:27], v1 offset:6144
    v_add_f32 v8, v8, v17
    v_mfma_f32_16x16x32_bf16 a[16:19], v[176:179], v[36:39], a[16:19]
    s_add_u32 s27, s27, 24576
    v_exp_f32 v19, v79
    v_mfma_f32_16x16x32_bf16 a[64:67], v[164:167], v[32:35], a[64:67]
    s_min_u32 s29, s29, s3
    v_cvt_f32_i32 v249, v249
    v_cvt_pk_bf16_f32 v76, v16, v17
    v_mfma_f32_16x16x32_bf16 a[64:67], v[180:183], v[36:39], a[64:67]
    s_add_u32 s56, s56, 12288
    v_exp_f32 v16, v108
    v_mfma_f32_16x16x32_bf16 a[112:115], v[168:171], v[32:35], a[112:115]
    ds_read_b128 v[28:31], v1 offset:18432
    v_fma_f32 v248, v248, v48, v50
    v_mfma_f32_16x16x32_bf16 a[112:115], v[184:187], v[36:39], a[112:115]
    v_add_f32 v8, v8, v18
    v_fma_f32 v249, v249, v49, v51
    v_mfma_f32_16x16x32_bf16 a[160:163], v[172:175], v[32:35], a[160:163]
    v_add_f32 v8, v8, v19
    v_cvt_pk_bf16_f32 v234, v248, v249
    v_mfma_f32_16x16x32_bf16 a[160:163], v[188:191], v[36:39], a[160:163]
    s_waitcnt lgkmcnt(2)
    v_exp_f32 v17, v109
    v_mfma_f32_16x16x32_bf16 a[20:23], v[160:163], v[40:43], a[20:23]
    s_mov_b32 m0, s56
    ds_read_b128 v[32:35], v1 offset:7168
    v_cvt_pk_bf16_f32 v77, v18, v19
    v_mfma_f32_16x16x32_bf16 a[20:23], v[176:179], v[44:47], a[20:23]
    s_sub_u32 s3, s29, s28
    v_exp_f32 v18, v110
    v_mfma_f32_16x16x32_bf16 a[68:71], v[164:167], v[40:43], a[68:71]
    v_cvt_f32_i32 v252, v252
    v_add_f32 v8, v8, v16
    v_mfma_f32_16x16x32_bf16 a[68:71], v[180:183], v[44:47], a[68:71]
    v_add_f32 v8, v8, v17
    v_cvt_f32_i32 v253, v253
    v_mfma_f32_16x16x32_bf16 a[116:119], v[168:171], v[40:43], a[116:119]
    ds_read_b128 v[36:39], v1 offset:19456
    v_fma_f32 v252, v252, v48, v50
    v_mfma_f32_16x16x32_bf16 a[116:119], v[184:187], v[44:47], a[116:119]
    buffer_load_dwordx4 v4, s[4:7], s27 offen offset:0 sc1 lds
    v_mfma_f32_16x16x32_bf16 a[164:167], v[172:175], v[40:43], a[164:167]
    s_mov_b32 s28, s29
    v_exp_f32 v19, v111
    v_mfma_f32_16x16x32_bf16 a[164:167], v[188:191], v[44:47], a[164:167]
    s_waitcnt lgkmcnt(2)
    v_cvt_pk_bf16_f32 v78, v16, v17
    v_add_f32 v8, v8, v18
    v_mfma_f32_16x16x32_bf16 a[24:27], v[160:163], v[24:27], a[24:27]
    ds_read_b128 v[40:43], v1 offset:8192
    v_add_f32 v8, v8, v19
    v_mfma_f32_16x16x32_bf16 a[24:27], v[176:179], v[28:31], a[24:27]
    v_cvt_pk_bf16_f32 v79, v18, v19
    v_fma_f32 v253, v253, v49, v51
    v_mfma_f32_16x16x32_bf16 a[72:75], v[164:167], v[24:27], a[72:75]
    v_exp_f32 v16, v80
    v_mfma_f32_16x16x32_bf16 a[72:75], v[180:183], v[28:31], a[72:75]
    v_exp_f32 v17, v81
    v_mfma_f32_16x16x32_bf16 a[120:123], v[168:171], v[24:27], a[120:123]
    ds_read_b128 v[44:47], v1 offset:20480
    v_cvt_pk_bf16_f32 v238, v252, v253
    v_mfma_f32_16x16x32_bf16 a[120:123], v[184:187], v[28:31], a[120:123]
    v_exp_f32 v18, v82
    v_mfma_f32_16x16x32_bf16 a[168:171], v[172:175], v[24:27], a[168:171]
    v_lshlrev_b32 v48, 16, v61
    v_add_f32 v5, v5, v16
    v_mfma_f32_16x16x32_bf16 a[168:171], v[188:191], v[28:31], a[168:171]
    s_waitcnt lgkmcnt(2)
    buffer_load_dwordx4 v4, s[4:7], s27 offen offset:1024 sc1 lds
    v_mfma_f32_16x16x32_bf16 a[28:31], v[160:163], v[32:35], a[28:31]
    ds_read_b128 v[24:27], v1 offset:9216
    v_add_f32 v5, v5, v17
    v_mfma_f32_16x16x32_bf16 a[28:31], v[176:179], v[36:39], a[28:31]
    v_exp_f32 v19, v83
    v_mfma_f32_16x16x32_bf16 a[76:79], v[164:167], v[32:35], a[76:79]
    v_and_b32 v49, s97, v61
    v_cvt_pk_bf16_f32 v80, v16, v17
    v_mfma_f32_16x16x32_bf16 a[76:79], v[180:183], v[36:39], a[76:79]
    v_exp_f32 v16, v112
    v_mfma_f32_16x16x32_bf16 a[124:127], v[168:171], v[32:35], a[124:127]
    ds_read_b128 v[28:31], v1 offset:21504
    v_lshlrev_b32 v50, 16, v63
    v_mfma_f32_16x16x32_bf16 a[124:127], v[184:187], v[36:39], a[124:127]
    v_add_f32 v5, v5, v18
    v_and_b32 v51, s97, v63
    v_mfma_f32_16x16x32_bf16 a[172:175], v[172:175], v[32:35], a[172:175]
    v_add_f32 v5, v5, v19
    v_mul_f32 v48, s38, v48
    v_mfma_f32_16x16x32_bf16 a[172:175], v[188:191], v[36:39], a[172:175]
    s_waitcnt lgkmcnt(2)
    buffer_load_dwordx4 v4, s[4:7], s27 offen offset:2048 sc1 lds
    v_mfma_f32_16x16x32_bf16 a[32:35], v[160:163], v[40:43], a[32:35]
    ds_read_b128 v[32:35], v1 offset:10240
    v_mul_f32 v49, s38, v49
    v_mfma_f32_16x16x32_bf16 a[32:35], v[176:179], v[44:47], a[32:35]
    v_exp_f32 v17, v113
    v_mfma_f32_16x16x32_bf16 a[80:83], v[164:167], v[40:43], a[80:83]
    v_cvt_pk_bf16_f32 v81, v18, v19
    v_mul_f32_e64 v50, -v50, v48
    v_mfma_f32_16x16x32_bf16 a[80:83], v[180:183], v[44:47], a[80:83]
    v_exp_f32 v18, v114
    v_mfma_f32_16x16x32_bf16 a[128:131], v[168:171], v[40:43], a[128:131]
    ds_read_b128 v[36:39], v1 offset:22528
    v_add_f32 v5, v5, v16
    v_mfma_f32_16x16x32_bf16 a[128:131], v[184:187], v[44:47], a[128:131]
    v_add_f32 v5, v5, v17
    v_mul_f32_e64 v51, -v51, v49
    v_mfma_f32_16x16x32_bf16 a[176:179], v[172:175], v[40:43], a[176:179]
    v_exp_f32 v19, v115
    v_mfma_f32_16x16x32_bf16 a[176:179], v[188:191], v[44:47], a[176:179]
    s_waitcnt lgkmcnt(2)
    v_cvt_pk_bf16_f32 v82, v16, v17
    v_add_u32 v2, s3, v2
    v_mfma_f32_16x16x32_bf16 a[36:39], v[160:163], v[24:27], a[36:39]
    ds_read_b128 v[40:43], v1 offset:11264
    v_cvt_f32_i32 v242, v242
    v_mfma_f32_16x16x32_bf16 a[36:39], v[176:179], v[28:31], a[36:39]
    v_exp_f32 v16, v84
    v_mfma_f32_16x16x32_bf16 a[84:87], v[164:167], v[24:27], a[84:87]
    v_add_f32 v5, v5, v18
    v_add_f32 v5, v5, v19
    v_mfma_f32_16x16x32_bf16 a[84:87], v[180:183], v[28:31], a[84:87]
    s_add_u32 s27, s27, 24576
    v_exp_f32 v17, v85
    v_mfma_f32_16x16x32_bf16 a[132:135], v[168:171], v[24:27], a[132:135]
    s_add_u32 s56, s56, 36864
    ds_read_b128 v[44:47], v1 offset:23552
    v_add_u32 v3, s3, v3
    v_mfma_f32_16x16x32_bf16 a[132:135], v[184:187], v[28:31], a[132:135]
    s_waitcnt lgkmcnt(2)
    v_cvt_pk_bf16_f32 v83, v18, v19
    v_cvt_f32_i32 v243, v243
    v_mfma_f32_16x16x32_bf16 a[180:183], v[172:175], v[24:27], a[180:183]
    s_waitcnt vmcnt(19)
    v_exp_f32 v18, v86
    v_mfma_f32_16x16x32_bf16 a[180:183], v[188:191], v[28:31], a[180:183]
    s_barrier
    v_add_f32 v6, v6, v16
    v_mfma_f32_16x16x32_bf16 a[40:43], v[160:163], v[32:35], a[40:43]
    s_sub_u32 s58, s56, 147456
    ds_read_b128 v[24:27], v2 offset:0
    v_add_f32 v6, v6, v17
    v_mfma_f32_16x16x32_bf16 a[40:43], v[176:179], v[36:39], a[40:43]
    s_min_u32 s56, s56, s58
    v_exp_f32 v19, v87
    v_mfma_f32_16x16x32_bf16 a[88:91], v[164:167], v[32:35], a[88:91]
    v_fma_f32 v242, v242, v48, v50
    v_fma_f32 v243, v243, v49, v51
    v_mfma_f32_16x16x32_bf16 a[88:91], v[180:183], v[36:39], a[88:91]
    v_cvt_pk_bf16_f32 v84, v16, v17
    v_cvt_pk_bf16_f32 v227, v242, v243
    v_mfma_f32_16x16x32_bf16 a[136:139], v[168:171], v[32:35], a[136:139]
    ds_read_b128 v[28:31], v3 offset:0
    v_cvt_f32_i32 v246, v246
    v_mfma_f32_16x16x32_bf16 a[136:139], v[184:187], v[36:39], a[136:139]
    v_exp_f32 v16, v116
    v_mfma_f32_16x16x32_bf16 a[184:187], v[172:175], v[32:35], a[184:187]
    v_add_f32 v6, v6, v18
    v_add_f32 v6, v6, v19
    v_mfma_f32_16x16x32_bf16 a[184:187], v[188:191], v[36:39], a[184:187]
    s_waitcnt lgkmcnt(2)
    v_exp_f32 v17, v117
    v_mfma_f32_16x16x32_bf16 a[44:47], v[160:163], v[40:43], a[44:47]
    ds_read_b128 v[32:35], v2 offset:6144
    v_cvt_pk_bf16_f32 v85, v18, v19
    v_mfma_f32_16x16x32_bf16 a[44:47], v[176:179], v[44:47], a[44:47]
    v_exp_f32 v18, v118
    v_mfma_f32_16x16x32_bf16 a[92:95], v[164:167], v[40:43], a[92:95]
    v_cvt_f32_i32 v247, v247
    v_fma_f32 v246, v246, v48, v50
    v_mfma_f32_16x16x32_bf16 a[92:95], v[180:183], v[44:47], a[92:95]
    v_add_f32 v6, v6, v16
    v_add_f32 v6, v6, v17
    v_mfma_f32_16x16x32_bf16 a[140:143], v[168:171], v[40:43], a[140:143]
    s_sub_u32 s31, s31, 1
    ds_read_b128 v[36:39], v3 offset:6144
    v_fma_f32 v247, v247, v49, v51
    v_mfma_f32_16x16x32_bf16 a[140:143], v[184:187], v[44:47], a[140:143]
    v_exp_f32 v19, v119
    v_mfma_f32_16x16x32_bf16 a[188:191], v[172:175], v[40:43], a[188:191]
    s_waitcnt lgkmcnt(2)
    s_cmp_lg_u32 s31, 0
    v_cvt_pk_bf16_f32 v86, v16, v17
    v_add_f32 v6, v6, v18
    v_cvt_pk_bf16_f32 v231, v246, v247
    v_add_f32 v6, v6, v19
    v_cvt_f32_i32 v250, v250
    v_cvt_pk_bf16_f32 v87, v18, v19
    v_cvt_f32_i32 v251, v251
    v_mfma_f32_16x16x32_bf16 a[188:191], v[188:191], v[44:47], a[188:191]
    s_cbranch_scc1 L_loop
    v_mfma_f32_16x16x32_bf16 v[160:163], v[24:27], a[192:195], v[128:131]
    s_mov_b32 m0, s26
    ds_read_b128 v[40:43], v2 offset:128
    v_mfma_f32_16x16x32_bf16 v[160:163], v[28:31], a[196:199], v[160:163]
    buffer_load_dwordx4 v4, s[4:7], s32 offen offset:0 sc1 lds
    v_mfma_f32_16x16x32_bf16 v[164:167], v[24:27], a[216:219], v[132:135]
    ds_read_b128 v[44:47], v3 offset:128
    v_mfma_f32_16x16x32_bf16 v[164:167], v[28:31], a[220:223], v[164:167]
    s_waitcnt lgkmcnt(2)
    v_exp_f32 v16, v88
    v_mfma_f32_16x16x32_bf16 v[96:99], v[32:35], a[192:195], v[128:131]
    ds_read_b128 v[24:27], v2 offset:6272
    v_mfma_f32_16x16x32_bf16 v[96:99], v[36:39], a[196:199], v[96:99]
    buffer_load_dwordx4 v4, s[4:7], s32 offen offset:1024 sc1 lds
    v_mfma_f32_16x16x32_bf16 v[100:103], v[32:35], a[216:219], v[132:135]
    ds_read_b128 v[28:31], v3 offset:6272
    v_mfma_f32_16x16x32_bf16 v[100:103], v[36:39], a[220:223], v[100:103]
    s_waitcnt lgkmcnt(2)
    v_exp_f32 v17, v89
    v_mfma_f32_16x16x32_bf16 v[160:163], v[40:43], a[200:203], v[160:163]
    ds_read_b128 v[32:35], v2 offset:256
    v_mfma_f32_16x16x32_bf16 v[160:163], v[44:47], a[204:207], v[160:163]
    v_exp_f32 v18, v90
    v_mfma_f32_16x16x32_bf16 v[164:167], v[40:43], a[224:227], v[164:167]
    ds_read_b128 v[36:39], v3 offset:256
    v_add_f32 v7, v7, v16
    v_mfma_f32_16x16x32_bf16 v[164:167], v[44:47], a[228:231], v[164:167]
    s_waitcnt lgkmcnt(2)
    buffer_load_dwordx4 v4, s[4:7], s32 offen offset:2048 sc1 lds
    v_add_f32 v7, v7, v17
    v_mfma_f32_16x16x32_bf16 v[96:99], v[24:27], a[200:203], v[96:99]
    ds_read_b128 v[40:43], v2 offset:6400
    v_mfma_f32_16x16x32_bf16 v[96:99], v[28:31], a[204:207], v[96:99]
    v_exp_f32 v19, v91
    v_cvt_pk_bf16_f32 v88, v16, v17
    v_mfma_f32_16x16x32_bf16 v[100:103], v[24:27], a[224:227], v[100:103]
    s_add_u32 s32, s32, 24576
    ds_read_b128 v[44:47], v3 offset:6400
    v_mfma_f32_16x16x32_bf16 v[100:103], v[28:31], a[228:231], v[100:103]
    s_waitcnt lgkmcnt(2)
    v_exp_f32 v16, v120
    v_mfma_f32_16x16x32_bf16 v[160:163], v[32:35], a[208:211], v[160:163]
    s_add_u32 s26, s26, 12288
    ds_read_b128 v[24:27], v2 offset:12288
    v_add_f32 v7, v7, v18
    v_mfma_f32_16x16x32_bf16 v[160:163], v[36:39], a[212:215], v[160:163]
    v_add_f32 v7, v7, v19
    v_mfma_f32_16x16x32_bf16 v[164:167], v[32:35], a[232:235], v[164:167]
    s_mov_b32 m0, s26
    ds_read_b128 v[28:31], v3 offset:12288
    v_mfma_f32_16x16x32_bf16 v[164:167], v[36:39], a[236:239], v[164:167]
    s_waitcnt lgkmcnt(2)
    v_exp_f32 v17, v121
    v_cvt_pk_bf16_f32 v89, v18, v19
    v_mfma_f32_16x16x32_bf16 v[96:99], v[40:43], a[208:211], v[96:99]
    ds_read_b128 v[32:35], v2 offset:18432
    v_mfma_f32_16x16x32_bf16 v[96:99], v[44:47], a[212:215], v[96:99]
    v_exp_f32 v18, v122
    v_mfma_f32_16x16x32_bf16 v[100:103], v[40:43], a[232:235], v[100:103]
    ds_read_b128 v[36:39], v3 offset:18432
    v_add_f32 v7, v7, v16
    v_mfma_f32_16x16x32_bf16 v[100:103], v[44:47], a[236:239], v[100:103]
    s_waitcnt lgkmcnt(2)
    buffer_load_dwordx4 v4, s[4:7], s32 offen offset:0 sc1 lds
    v_add_f32 v7, v7, v17
    v_mfma_f32_16x16x32_bf16 v[168:171], v[24:27], a[192:195], v[128:131]
    ds_read_b128 v[40:43], v2 offset:12416
    v_mfma_f32_16x16x32_bf16 v[168:171], v[28:31], a[196:199], v[168:171]
    v_exp_f32 v19, v123
    v_cvt_pk_bf16_f32 v90, v16, v17
    v_mfma_f32_16x16x32_bf16 v[172:175], v[24:27], a[216:219], v[132:135]
    ds_read_b128 v[44:47], v3 offset:12416
    v_mfma_f32_16x16x32_bf16 v[172:175], v[28:31], a[220:223], v[172:175]
    s_waitcnt lgkmcnt(2)
    buffer_load_dwordx4 v4, s[4:7], s32 offen offset:1024 sc1 lds
    v_mfma_f32_16x16x32_bf16 v[104:107], v[32:35], a[192:195], v[128:131]
    ds_read_b128 v[24:27], v2 offset:18560
    v_mfma_f32_16x16x32_bf16 v[104:107], v[36:39], a[196:199], v[104:107]
    v_exp_f32 v16, v92
    v_add_f32 v7, v7, v18
    v_mfma_f32_16x16x32_bf16 v[108:111], v[32:35], a[216:219], v[132:135]
    s_add_u32 s29, s30, 49152
    ds_read_b128 v[28:31], v3 offset:18560
    v_add_f32 v7, v7, v19
    v_mfma_f32_16x16x32_bf16 v[108:111], v[36:39], a[220:223], v[108:111]
    s_waitcnt lgkmcnt(2)
    v_exp_f32 v17, v93
    v_cvt_pk_bf16_f32 v91, v18, v19
    v_mfma_f32_16x16x32_bf16 v[168:171], v[40:43], a[200:203], v[168:171]
    s_sub_u32 s3, s29, 147456
    ds_read_b128 v[32:35], v2 offset:12544
    v_mfma_f32_16x16x32_bf16 v[168:171], v[44:47], a[204:207], v[168:171]
    s_min_u32 s29, s29, s3
    buffer_load_dwordx4 v4, s[4:7], s32 offen offset:2048 sc1 lds
    v_mfma_f32_16x16x32_bf16 v[172:175], v[40:43], a[224:227], v[172:175]
    ds_read_b128 v[36:39], v3 offset:12544
    v_mfma_f32_16x16x32_bf16 v[172:175], v[44:47], a[228:231], v[172:175]
    s_waitcnt lgkmcnt(2)
    v_exp_f32 v18, v94
    v_add_f32 v8, v8, v16
    v_mfma_f32_16x16x32_bf16 v[104:107], v[24:27], a[200:203], v[104:107]
    s_add_u32 s32, s32, 24576
    ds_read_b128 v[40:43], v2 offset:18688
    v_add_f32 v8, v8, v17
    v_mfma_f32_16x16x32_bf16 v[104:107], v[28:31], a[204:207], v[104:107]
    v_exp_f32 v19, v95
    v_cvt_pk_bf16_f32 v92, v16, v17
    v_mfma_f32_16x16x32_bf16 v[108:111], v[24:27], a[224:227], v[108:111]
    ds_read_b128 v[44:47], v3 offset:18688
    v_mfma_f32_16x16x32_bf16 v[108:111], v[28:31], a[228:231], v[108:111]
    s_waitcnt lgkmcnt(2)
    v_subrev_u32 v2, 98304, v2
    v_subrev_u32 v3, 98304, v3
    v_mfma_f32_16x16x32_bf16 v[168:171], v[32:35], a[208:211], v[168:171]
    s_add_u32 s26, s26, 36864
    ds_read_b128 v[24:27], v2 offset:0
    v_mfma_f32_16x16x32_bf16 v[168:171], v[36:39], a[212:215], v[168:171]
    v_exp_f32 v16, v124
    v_add_f32 v8, v8, v18
    v_mfma_f32_16x16x32_bf16 v[172:175], v[32:35], a[232:235], v[172:175]
    s_sub_u32 s57, s26, 147456
    ds_read_b128 v[28:31], v3 offset:0
    v_add_f32 v8, v8, v19
    v_mfma_f32_16x16x32_bf16 v[172:175], v[36:39], a[236:239], v[172:175]
    s_waitcnt lgkmcnt(2)
    v_exp_f32 v17, v125
    v_cvt_pk_bf16_f32 v93, v18, v19
    v_mfma_f32_16x16x32_bf16 v[104:107], v[40:43], a[208:211], v[104:107]
    s_min_u32 s26, s26, s57
    ds_read_b128 v[32:35], v2 offset:6144
    s_sub_u32 s3, s29, s30
    v_mfma_f32_16x16x32_bf16 v[104:107], v[44:47], a[212:215], v[104:107]
    v_exp_f32 v18, v126
    v_mfma_f32_16x16x32_bf16 v[108:111], v[40:43], a[232:235], v[108:111]
    s_mov_b32 m0, s56
    ds_read_b128 v[36:39], v3 offset:6144
    v_add_f32 v8, v8, v16
    v_mfma_f32_16x16x32_bf16 v[108:111], v[44:47], a[236:239], v[108:111]
    s_waitcnt lgkmcnt(2)
    v_add_f32 v8, v8, v17
    v_mfma_f32_16x16x32_bf16 v[176:179], v[24:27], a[192:195], v[128:131]
    ds_read_b128 v[40:43], v2 offset:128
    v_mfma_f32_16x16x32_bf16 v[176:179], v[28:31], a[196:199], v[176:179]
    v_exp_f32 v19, v127
    v_cvt_pk_bf16_f32 v94, v16, v17
    v_mfma_f32_16x16x32_bf16 v[180:183], v[24:27], a[216:219], v[132:135]
    ds_read_b128 v[44:47], v3 offset:128
    v_add_f32 v8, v8, v18
    v_add_f32 v8, v8, v19
    v_cvt_pk_bf16_f32 v95, v18, v19
    v_mfma_f32_16x16x32_bf16 v[180:183], v[28:31], a[220:223], v[180:183]
    s_waitcnt lgkmcnt(2)
    buffer_load_dwordx4 v4, s[4:7], s27 offen offset:0 sc1 lds
    v_mfma_f32_16x16x32_bf16 v[112:115], v[32:35], a[192:195], v[128:131]
    s_mov_b32 s30, s29
    ds_read_b128 v[24:27], v2 offset:6272
    v_mfma_f32_16x16x32_bf16 v[112:115], v[36:39], a[196:199], v[112:115]
    v_exp_f32 v16, v160
    v_mfma_f32_16x16x32_bf16 v[116:119], v[32:35], a[216:219], v[132:135]
    ds_read_b128 v[28:31], v3 offset:6272
    v_mfma_f32_16x16x32_bf16 v[116:119], v[36:39], a[220:223], v[116:119]
    s_waitcnt lgkmcnt(2)
    buffer_load_dwordx4 v4, s[4:7], s27 offen offset:1024 sc1 lds
    v_mfma_f32_16x16x32_bf16 v[176:179], v[40:43], a[200:203], v[176:179]
    ds_read_b128 v[32:35], v2 offset:256
    v_mfma_f32_16x16x32_bf16 v[176:179], v[44:47], a[204:207], v[176:179]
    v_exp_f32 v17, v161
    v_mfma_f32_16x16x32_bf16 v[180:183], v[40:43], a[224:227], v[180:183]
    ds_read_b128 v[36:39], v3 offset:256
    v_add_u32 v1, s3, v1
    v_mfma_f32_16x16x32_bf16 v[180:183], v[44:47], a[228:231], v[180:183]
    s_waitcnt lgkmcnt(2)
    v_exp_f32 v18, v162
    v_add_f32 v5, v5, v16
    v_mfma_f32_16x16x32_bf16 v[112:115], v[24:27], a[200:203], v[112:115]
    ds_read_b128 v[40:43], v2 offset:6400
    v_add_f32 v5, v5, v17
    v_mfma_f32_16x16x32_bf16 v[112:115], v[28:31], a[204:207], v[112:115]
    buffer_load_dwordx4 v4, s[4:7], s27 offen offset:2048 sc1 lds
    v_mfma_f32_16x16x32_bf16 v[116:119], v[24:27], a[224:227], v[116:119]
    ds_read_b128 v[44:47], v3 offset:6400
    v_mfma_f32_16x16x32_bf16 v[116:119], v[28:31], a[228:231], v[116:119]
    s_waitcnt lgkmcnt(2)
    v_exp_f32 v19, v163
    v_cvt_pk_bf16_f32 v160, v16, v17
    v_mfma_f32_16x16x32_bf16 v[176:179], v[32:35], a[208:211], v[176:179]
    s_add_u32 s27, s27, 24576
    ds_read_b128 v[24:27], v2 offset:12288
    v_mfma_f32_16x16x32_bf16 v[176:179], v[36:39], a[212:215], v[176:179]
    v_exp_f32 v16, v96
    v_add_f32 v5, v5, v18
    v_mfma_f32_16x16x32_bf16 v[180:183], v[32:35], a[232:235], v[180:183]
    s_add_u32 s56, s56, 12288
    ds_read_b128 v[28:31], v3 offset:12288
    v_add_f32 v5, v5, v19
    v_mfma_f32_16x16x32_bf16 v[180:183], v[36:39], a[236:239], v[180:183]
    s_waitcnt lgkmcnt(2)
    v_exp_f32 v17, v97
    v_cvt_pk_bf16_f32 v161, v18, v19
    v_mfma_f32_16x16x32_bf16 v[112:115], v[40:43], a[208:211], v[112:115]
    ds_read_b128 v[32:35], v2 offset:18432
    v_mfma_f32_16x16x32_bf16 v[112:115], v[44:47], a[212:215], v[112:115]
    s_mov_b32 m0, s56
    v_exp_f32 v18, v98
    v_mfma_f32_16x16x32_bf16 v[116:119], v[40:43], a[232:235], v[116:119]
    ds_read_b128 v[36:39], v3 offset:18432
    v_add_f32 v5, v5, v16
    v_mfma_f32_16x16x32_bf16 v[116:119], v[44:47], a[236:239], v[116:119]
    s_waitcnt lgkmcnt(2)
    v_add_f32 v5, v5, v17
    v_mfma_f32_16x16x32_bf16 v[184:187], v[24:27], a[192:195], v[128:131]
    ds_read_b128 v[40:43], v2 offset:12416
    v_mfma_f32_16x16x32_bf16 v[184:187], v[28:31], a[196:199], v[184:187]
    buffer_load_dwordx4 v4, s[4:7], s27 offen offset:0 sc1 lds
    v_mfma_f32_16x16x32_bf16 v[188:191], v[24:27], a[216:219], v[132:135]
    ds_read_b128 v[44:47], v3 offset:12416
    v_mfma_f32_16x16x32_bf16 v[188:191], v[28:31], a[220:223], v[188:191]
    s_waitcnt lgkmcnt(2)
    v_exp_f32 v19, v99
    v_cvt_pk_bf16_f32 v162, v16, v17
    v_mfma_f32_16x16x32_bf16 v[120:123], v[32:35], a[192:195], v[128:131]
    ds_read_b128 v[24:27], v2 offset:18560
    v_mfma_f32_16x16x32_bf16 v[120:123], v[36:39], a[196:199], v[120:123]
    s_waitcnt vmcnt(10)
    v_exp_f32 v16, v164
    v_add_f32 v5, v5, v18
    v_mfma_f32_16x16x32_bf16 v[124:127], v[32:35], a[216:219], v[132:135]
    ds_read_b128 v[28:31], v3 offset:18560
    v_add_f32 v5, v5, v19
    v_mfma_f32_16x16x32_bf16 v[124:127], v[36:39], a[220:223], v[124:127]
    s_waitcnt lgkmcnt(2)
    s_barrier
    v_mfma_f32_16x16x32_bf16 v[184:187], v[40:43], a[200:203], v[184:187]
    ds_read_b128 v[32:35], v2 offset:12544
    v_mfma_f32_16x16x32_bf16 v[184:187], v[44:47], a[204:207], v[184:187]
    buffer_load_dwordx4 v4, s[4:7], s27 offen offset:1024 sc1 lds
    v_mfma_f32_16x16x32_bf16 v[188:191], v[40:43], a[224:227], v[188:191]
    ds_read_b128 v[36:39], v3 offset:12544
    v_mfma_f32_16x16x32_bf16 v[188:191], v[44:47], a[228:231], v[188:191]
    s_waitcnt lgkmcnt(2)
    v_exp_f32 v17, v165
    v_cvt_pk_bf16_f32 v163, v18, v19
    v_mfma_f32_16x16x32_bf16 v[120:123], v[24:27], a[200:203], v[120:123]
    ds_read_b128 v[40:43], v2 offset:18688
    v_mfma_f32_16x16x32_bf16 v[120:123], v[28:31], a[204:207], v[120:123]
    buffer_load_dwordx4 v4, s[4:7], s27 offen offset:2048 sc1 lds
    v_mfma_f32_16x16x32_bf16 v[124:127], v[24:27], a[224:227], v[124:127]
    ds_read_b128 v[44:47], v3 offset:18688
    v_mfma_f32_16x16x32_bf16 v[124:127], v[28:31], a[228:231], v[124:127]
    s_waitcnt lgkmcnt(2)
    v_exp_f32 v18, v166
    v_add_f32 v6, v6, v16
    v_mfma_f32_16x16x32_bf16 v[184:187], v[32:35], a[208:211], v[184:187]
    ds_read_b128 v[24:27], v1 offset:0
    v_add_f32 v6, v6, v17
    v_mfma_f32_16x16x32_bf16 v[184:187], v[36:39], a[212:215], v[184:187]
    v_exp_f32 v19, v167
    v_cvt_pk_bf16_f32 v164, v16, v17
    v_mfma_f32_16x16x32_bf16 v[188:191], v[32:35], a[232:235], v[188:191]
    ds_read_b128 v[28:31], v1 offset:12288
    v_mfma_f32_16x16x32_bf16 v[188:191], v[36:39], a[236:239], v[188:191]
    s_waitcnt lgkmcnt(2)
    v_exp_f32 v16, v100
    v_add_f32 v6, v6, v18
    v_mfma_f32_16x16x32_bf16 v[120:123], v[40:43], a[208:211], v[120:123]
    s_add_u32 s27, s27, 24576
    ds_read_b128 v[32:35], v1 offset:1024
    v_add_f32 v6, v6, v19
    v_mfma_f32_16x16x32_bf16 v[120:123], v[44:47], a[212:215], v[120:123]
    v_exp_f32 v17, v101
    v_cvt_pk_bf16_f32 v165, v18, v19
    v_mfma_f32_16x16x32_bf16 v[124:127], v[40:43], a[232:235], v[124:127]
    s_add_u32 s56, s56, 36864
    ds_read_b128 v[36:39], v1 offset:13312
    s_sub_u32 s58, s56, 147456
    v_mfma_f32_16x16x32_bf16 v[124:127], v[44:47], a[236:239], v[124:127]
    s_waitcnt lgkmcnt(2)
    v_exp_f32 v18, v102
    v_add_f32 v6, v6, v16
    v_add_f32 v6, v6, v17
    v_exp_f32 v19, v103
    v_cvt_pk_bf16_f32 v166, v16, v17
    v_add_f32 v6, v6, v18
    v_add_f32 v6, v6, v19
    v_cvt_pk_bf16_f32 v167, v18, v19
    s_min_u32 s56, s56, s58
    v_mfma_f32_16x16x32_bf16 a[0:3], v[64:67], v[24:27], a[0:3]
    s_mov_b32 m0, s56
    ds_read_b128 v[40:43], v1 offset:2048
    v_bfe_u32 v57, v4, 8, 2
    v_mfma_f32_16x16x32_bf16 a[0:3], v[80:83], v[28:31], a[0:3]
    buffer_load_dwordx4 v4, s[4:7], s27 offen offset:0 sc1 lds
    v_mfma_f32_16x16x32_bf16 a[48:51], v[68:71], v[24:27], a[48:51]
    v_exp_f32 v16, v168
    v_mfma_f32_16x16x32_bf16 a[48:51], v[84:87], v[28:31], a[48:51]
    v_exp_f32 v17, v169
    v_mfma_f32_16x16x32_bf16 a[96:99], v[72:75], v[24:27], a[96:99]
    ds_read_b128 v[44:47], v1 offset:14336
    v_mul_u32_u24 v56, 1536, v57
    v_mfma_f32_16x16x32_bf16 a[96:99], v[88:91], v[28:31], a[96:99]
    v_exp_f32 v18, v170
    v_mfma_f32_16x16x32_bf16 a[144:147], v[76:79], v[24:27], a[144:147]
    v_add_f32 v5, v5, v16
    v_add_f32 v5, v5, v17
    v_mfma_f32_16x16x32_bf16 a[144:147], v[92:95], v[28:31], a[144:147]
    s_waitcnt lgkmcnt(2)
    buffer_load_dwordx4 v4, s[4:7], s27 offen offset:1024 sc1 lds
    v_mfma_f32_16x16x32_bf16 a[4:7], v[64:67], v[32:35], a[4:7]
    ds_read_b128 v[24:27], v1 offset:3072
    v_lshlrev_b32 v58, 4, v57
    v_mfma_f32_16x16x32_bf16 a[4:7], v[80:83], v[36:39], a[4:7]
    v_exp_f32 v19, v171
    v_mfma_f32_16x16x32_bf16 a[52:55], v[68:71], v[32:35], a[52:55]
    v_cvt_pk_bf16_f32 v168, v16, v17
    v_mfma_f32_16x16x32_bf16 a[52:55], v[84:87], v[36:39], a[52:55]
    v_exp_f32 v16, v104
    v_mfma_f32_16x16x32_bf16 a[100:103], v[72:75], v[32:35], a[100:103]
    ds_read_b128 v[28:31], v1 offset:15360
    v_add_f32 v5, v5, v18
    v_mfma_f32_16x16x32_bf16 a[100:103], v[88:91], v[36:39], a[100:103]
    v_add_f32 v5, v5, v19
    v_bfe_u32 v57, v4, 4, 4
    v_mfma_f32_16x16x32_bf16 a[148:151], v[76:79], v[32:35], a[148:151]
    v_exp_f32 v17, v105
    v_mfma_f32_16x16x32_bf16 a[148:151], v[92:95], v[36:39], a[148:151]
    s_waitcnt lgkmcnt(2)
    buffer_load_dwordx4 v4, s[4:7], s27 offen offset:2048 sc1 lds
    v_mfma_f32_16x16x32_bf16 a[8:11], v[64:67], v[40:43], a[8:11]
    ds_read_b128 v[32:35], v1 offset:4096
    v_cvt_pk_bf16_f32 v169, v18, v19
    v_mfma_f32_16x16x32_bf16 a[8:11], v[80:83], v[44:47], a[8:11]
    v_exp_f32 v18, v106
    v_mfma_f32_16x16x32_bf16 a[56:59], v[68:71], v[40:43], a[56:59]
    v_add_f32 v5, v5, v16
    v_add_f32 v5, v5, v17
    v_mfma_f32_16x16x32_bf16 a[56:59], v[84:87], v[44:47], a[56:59]
    v_exp_f32 v19, v107
    v_mfma_f32_16x16x32_bf16 a[104:107], v[72:75], v[40:43], a[104:107]
    s_add_u32 s27, s27, 24576
    ds_read_b128 v[36:39], v1 offset:16384
    v_cvt_pk_bf16_f32 v170, v16, v17
    v_mfma_f32_16x16x32_bf16 a[104:107], v[88:91], v[44:47], a[104:107]
    v_exp_f32 v16, v172
    v_mfma_f32_16x16x32_bf16 a[152:155], v[76:79], v[40:43], a[152:155]
    v_add_f32 v5, v5, v18
    v_lshl_add_u32 v56, v57, 3, v56
    v_mfma_f32_16x16x32_bf16 a[152:155], v[92:95], v[44:47], a[152:155]
    s_waitcnt lgkmcnt(2)
    v_add_f32 v5, v5, v19
    v_mfma_f32_16x16x32_bf16 a[12:15], v[64:67], v[24:27], a[12:15]
    s_add_u32 s56, s56, 12288
    ds_read_b128 v[40:43], v1 offset:5120
    v_mfma_f32_16x16x32_bf16 a[12:15], v[80:83], v[28:31], a[12:15]
    v_exp_f32 v17, v173
    v_mfma_f32_16x16x32_bf16 a[60:63], v[68:71], v[24:27], a[60:63]
    v_cvt_pk_bf16_f32 v171, v18, v19
    v_mfma_f32_16x16x32_bf16 a[60:63], v[84:87], v[28:31], a[60:63]
    v_exp_f32 v18, v174
    v_mfma_f32_16x16x32_bf16 a[108:111], v[72:75], v[24:27], a[108:111]
    s_mov_b32 m0, s56
    ds_read_b128 v[44:47], v1 offset:17408
    v_add_f32 v6, v6, v16
    v_mfma_f32_16x16x32_bf16 a[108:111], v[88:91], v[28:31], a[108:111]
    v_add_f32 v6, v6, v17
    v_mov_b32 v57, 1.0
    v_mfma_f32_16x16x32_bf16 a[156:159], v[76:79], v[24:27], a[156:159]
    v_exp_f32 v19, v175
    v_mfma_f32_16x16x32_bf16 a[156:159], v[92:95], v[28:31], a[156:159]
    s_waitcnt lgkmcnt(2)
    v_cvt_pk_bf16_f32 v172, v16, v17
    v_mfma_f32_16x16x32_bf16 a[16:19], v[64:67], v[32:35], a[16:19]
    ds_read_b128 v[24:27], v1 offset:6144
    v_mfma_f32_16x16x32_bf16 a[16:19], v[80:83], v[36:39], a[16:19]
    v_exp_f32 v16, v108
    v_mfma_f32_16x16x32_bf16 a[64:67], v[68:71], v[32:35], a[64:67]
    v_add_f32 v6, v6, v18
    v_add_f32 v6, v6, v19
    v_mfma_f32_16x16x32_bf16 a[64:67], v[84:87], v[36:39], a[64:67]
    s_lshl_b32 s24, s95, 2
    buffer_load_dwordx4 v4, s[4:7], s27 offen offset:0 sc1 lds
    v_mfma_f32_16x16x32_bf16 a[112:115], v[72:75], v[32:35], a[112:115]
    ds_read_b128 v[28:31], v1 offset:18432
    v_mfma_f32_16x16x32_bf16 a[112:115], v[88:91], v[36:39], a[112:115]
    v_exp_f32 v17, v109
    v_mfma_f32_16x16x32_bf16 a[160:163], v[76:79], v[32:35], a[160:163]
    v_cvt_pk_bf16_f32 v173, v18, v19
    v_mfma_f32_16x16x32_bf16 a[160:163], v[92:95], v[36:39], a[160:163]
    s_waitcnt lgkmcnt(2)
    v_exp_f32 v18, v110
    v_mfma_f32_16x16x32_bf16 a[20:23], v[64:67], v[40:43], a[20:23]
    ds_read_b128 v[32:35], v1 offset:7168
    v_add_f32 v6, v6, v16
    v_mfma_f32_16x16x32_bf16 a[20:23], v[80:83], v[44:47], a[20:23]
    buffer_load_dwordx4 v4, s[4:7], s27 offen offset:1024 sc1 lds
    v_mfma_f32_16x16x32_bf16 a[68:71], v[68:71], v[40:43], a[68:71]
    v_add_f32 v6, v6, v17
    v_mfma_f32_16x16x32_bf16 a[68:71], v[84:87], v[44:47], a[68:71]
    s_add_u32 s24, s24, s25
    v_exp_f32 v19, v111
    v_mfma_f32_16x16x32_bf16 a[116:119], v[72:75], v[40:43], a[116:119]
    ds_read_b128 v[36:39], v1 offset:19456
    v_cvt_pk_bf16_f32 v174, v16, v17
    v_mfma_f32_16x16x32_bf16 a[116:119], v[88:91], v[44:47], a[116:119]
    v_add_f32 v6, v6, v18
    v_add_f32 v6, v6, v19
    v_mfma_f32_16x16x32_bf16 a[164:167], v[76:79], v[40:43], a[164:167]
    v_cvt_pk_bf16_f32 v175, v18, v19
    v_mfma_f32_16x16x32_bf16 a[164:167], v[92:95], v[44:47], a[164:167]
    s_waitcnt lgkmcnt(2)
    v_exp_f32 v16, v176
    v_mfma_f32_16x16x32_bf16 a[24:27], v[64:67], v[24:27], a[24:27]
    ds_read_b128 v[40:43], v1 offset:8192
    v_mfma_f32_16x16x32_bf16 a[24:27], v[80:83], v[28:31], a[24:27]
    buffer_load_dwordx4 v4, s[4:7], s27 offen offset:2048 sc1 lds
    v_mfma_f32_16x16x32_bf16 a[72:75], v[68:71], v[24:27], a[72:75]
    v_exp_f32 v17, v177
    v_mfma_f32_16x16x32_bf16 a[72:75], v[84:87], v[28:31], a[72:75]
    s_mul_i32 s24, s24, 24576
    v_exp_f32 v18, v178
    v_mfma_f32_16x16x32_bf16 a[120:123], v[72:75], v[24:27], a[120:123]
    ds_read_b128 v[44:47], v1 offset:20480
    v_add_f32 v5, v5, v16
    v_mfma_f32_16x16x32_bf16 a[120:123], v[88:91], v[28:31], a[120:123]
    v_add_f32 v5, v5, v17
    v_mfma_f32_16x16x32_bf16 a[168:171], v[76:79], v[24:27], a[168:171]
    v_exp_f32 v19, v179
    v_mfma_f32_16x16x32_bf16 a[168:171], v[92:95], v[28:31], a[168:171]
    s_waitcnt lgkmcnt(2)
    v_cvt_pk_bf16_f32 v176, v16, v17
    v_mfma_f32_16x16x32_bf16 a[28:31], v[64:67], v[32:35], a[28:31]
    ds_read_b128 v[24:27], v1 offset:9216
    v_mfma_f32_16x16x32_bf16 a[28:31], v[80:83], v[36:39], a[28:31]
    v_exp_f32 v16, v112
    v_mfma_f32_16x16x32_bf16 a[76:79], v[68:71], v[32:35], a[76:79]
    v_add_f32 v5, v5, v18
    v_add_f32 v5, v5, v19
    v_mfma_f32_16x16x32_bf16 a[76:79], v[84:87], v[36:39], a[76:79]
    s_add_u32 s40, s24, 6144
    v_exp_f32 v17, v113
    v_mfma_f32_16x16x32_bf16 a[124:127], v[72:75], v[32:35], a[124:127]
    ds_read_b128 v[28:31], v1 offset:21504
    v_mfma_f32_16x16x32_bf16 a[124:127], v[88:91], v[36:39], a[124:127]
    s_add_u32 s27, s27, 24576
    v_cvt_pk_bf16_f32 v177, v18, v19
    s_add_u32 s56, s56, 36864
    v_mfma_f32_16x16x32_bf16 a[172:175], v[76:79], v[32:35], a[172:175]
    s_sub_u32 s58, s56, 147456
    v_exp_f32 v18, v114
    v_mfma_f32_16x16x32_bf16 a[172:175], v[92:95], v[36:39], a[172:175]
    s_waitcnt lgkmcnt(2)
    v_add_f32 v5, v5, v16
    v_mfma_f32_16x16x32_bf16 a[32:35], v[64:67], v[40:43], a[32:35]
    ds_read_b128 v[32:35], v1 offset:10240
    v_add_f32 v5, v5, v17
    v_mfma_f32_16x16x32_bf16 a[32:35], v[80:83], v[44:47], a[32:35]
    s_min_u32 s56, s56, s58
    v_exp_f32 v19, v115
    v_mfma_f32_16x16x32_bf16 a[80:83], v[68:71], v[40:43], a[80:83]
    v_mfma_f32_16x16x32_bf16 a[80:83], v[84:87], v[44:47], a[80:83]
    s_add_u32 s41, s24, 12288
    v_cvt_pk_bf16_f32 v178, v16, v17
    v_mfma_f32_16x16x32_bf16 a[128:131], v[72:75], v[40:43], a[128:131]
    ds_read_b128 v[36:39], v1 offset:22528
    v_mfma_f32_16x16x32_bf16 a[128:131], v[88:91], v[44:47], a[128:131]
    v_exp_f32 v16, v180
    v_mfma_f32_16x16x32_bf16 a[176:179], v[76:79], v[40:43], a[176:179]
    v_add_f32 v5, v5, v18
    v_add_f32 v5, v5, v19
    v_mfma_f32_16x16x32_bf16 a[176:179], v[92:95], v[44:47], a[176:179]
    s_waitcnt lgkmcnt(2)
    v_exp_f32 v17, v181
    v_mfma_f32_16x16x32_bf16 a[36:39], v[64:67], v[24:27], a[36:39]
    ds_read_b128 v[40:43], v1 offset:11264
    v_mfma_f32_16x16x32_bf16 a[36:39], v[80:83], v[28:31], a[36:39]
    v_cvt_pk_bf16_f32 v179, v18, v19
    v_mfma_f32_16x16x32_bf16 a[84:87], v[68:71], v[24:27], a[84:87]
    v_exp_f32 v18, v182
    v_mfma_f32_16x16x32_bf16 a[84:87], v[84:87], v[28:31], a[84:87]
    s_add_u32 s42, s24, 18432
    v_add_f32 v6, v6, v16
    v_mfma_f32_16x16x32_bf16 a[132:135], v[72:75], v[24:27], a[132:135]
    ds_read_b128 v[44:47], v1 offset:23552
    v_add_f32 v6, v6, v17
    v_mfma_f32_16x16x32_bf16 a[132:135], v[88:91], v[28:31], a[132:135]
    s_waitcnt lgkmcnt(2)
    v_exp_f32 v19, v183
    v_mfma_f32_16x16x32_bf16 a[180:183], v[76:79], v[24:27], a[180:183]
    s_waitcnt vmcnt(6)
    v_mfma_f32_16x16x32_bf16 a[180:183], v[92:95], v[28:31], a[180:183]
    s_barrier
    v_add_u32 v2, 49152, v2
    v_add_u32 v3, 49152, v3
    v_mfma_f32_16x16x32_bf16 a[40:43], v[64:67], v[32:35], a[40:43]
    ds_read_b128 v[24:27], v2 offset:0
    v_cvt_pk_bf16_f32 v180, v16, v17
    v_mfma_f32_16x16x32_bf16 a[40:43], v[80:83], v[36:39], a[40:43]
    v_exp_f32 v16, v116
    v_mfma_f32_16x16x32_bf16 a[88:91], v[68:71], v[32:35], a[88:91]
    v_add_f32 v6, v6, v18
    v_add_f32 v6, v6, v19
    v_mfma_f32_16x16x32_bf16 a[88:91], v[84:87], v[36:39], a[88:91]
    v_exp_f32 v17, v117
    v_mfma_f32_16x16x32_bf16 a[136:139], v[72:75], v[32:35], a[136:139]
    ds_read_b128 v[28:31], v3 offset:0
    v_mfma_f32_16x16x32_bf16 a[136:139], v[88:91], v[36:39], a[136:139]
    v_cvt_pk_bf16_f32 v181, v18, v19
    v_mfma_f32_16x16x32_bf16 a[184:187], v[76:79], v[32:35], a[184:187]
    v_exp_f32 v18, v118
    v_mfma_f32_16x16x32_bf16 a[184:187], v[92:95], v[36:39], a[184:187]
    s_waitcnt lgkmcnt(2)
    v_add_f32 v6, v6, v16
    v_mfma_f32_16x16x32_bf16 a[44:47], v[64:67], v[40:43], a[44:47]
    ds_read_b128 v[32:35], v2 offset:6144
    v_add_f32 v6, v6, v17
    v_mfma_f32_16x16x32_bf16 a[44:47], v[80:83], v[44:47], a[44:47]
    v_exp_f32 v19, v119
    v_mfma_f32_16x16x32_bf16 a[92:95], v[68:71], v[40:43], a[92:95]
    v_mfma_f32_16x16x32_bf16 a[92:95], v[84:87], v[44:47], a[92:95]
    v_cvt_pk_bf16_f32 v182, v16, v17
    v_mfma_f32_16x16x32_bf16 a[140:143], v[72:75], v[40:43], a[140:143]
    ds_read_b128 v[36:39], v3 offset:6144
    v_add_f32 v6, v6, v18
    v_mfma_f32_16x16x32_bf16 a[140:143], v[88:91], v[44:47], a[140:143]
    v_add_f32 v6, v6, v19
    v_cvt_pk_bf16_f32 v183, v18, v19
    v_mfma_f32_16x16x32_bf16 a[188:191], v[76:79], v[40:43], a[188:191]
    v_mfma_f32_16x16x32_bf16 a[188:191], v[92:95], v[44:47], a[188:191]
    s_waitcnt lgkmcnt(2)
    v_mfma_f32_16x16x32_bf16 v[64:67], v[24:27], a[192:195], v[128:131]
    ds_read_b128 v[40:43], v2 offset:128
    v_mfma_f32_16x16x32_bf16 v[64:67], v[28:31], a[196:199], v[64:67]
    v_exp_f32 v16, v184
    v_mfma_f32_16x16x32_bf16 v[68:71], v[24:27], a[216:219], v[132:135]
    ds_read_b128 v[44:47], v3 offset:128
    v_mfma_f32_16x16x32_bf16 v[68:71], v[28:31], a[220:223], v[68:71]
    s_waitcnt lgkmcnt(2)
    v_exp_f32 v17, v185
    v_mfma_f32_16x16x32_bf16 v[96:99], v[32:35], a[192:195], v[128:131]
    ds_read_b128 v[24:27], v2 offset:6272
    v_mfma_f32_16x16x32_bf16 v[96:99], v[36:39], a[196:199], v[96:99]
    v_exp_f32 v18, v186
    v_mfma_f32_16x16x32_bf16 v[100:103], v[32:35], a[216:219], v[132:135]
    ds_read_b128 v[28:31], v3 offset:6272
    v_add_f32 v5, v5, v16
    v_mfma_f32_16x16x32_bf16 v[100:103], v[36:39], a[220:223], v[100:103]
    s_waitcnt lgkmcnt(2)
    v_add_f32 v5, v5, v17
    v_mfma_f32_16x16x32_bf16 v[64:67], v[40:43], a[200:203], v[64:67]
    ds_read_b128 v[32:35], v2 offset:256
    v_mfma_f32_16x16x32_bf16 v[64:67], v[44:47], a[204:207], v[64:67]
    v_exp_f32 v19, v187
    v_mfma_f32_16x16x32_bf16 v[68:71], v[40:43], a[224:227], v[68:71]
    ds_read_b128 v[36:39], v3 offset:256
    v_cvt_pk_bf16_f32 v184, v16, v17
    v_mfma_f32_16x16x32_bf16 v[68:71], v[44:47], a[228:231], v[68:71]
    s_waitcnt lgkmcnt(2)
    v_exp_f32 v16, v120
    v_mfma_f32_16x16x32_bf16 v[96:99], v[24:27], a[200:203], v[96:99]
    ds_read_b128 v[40:43], v2 offset:6400
    v_add_f32 v5, v5, v18
    v_mfma_f32_16x16x32_bf16 v[96:99], v[28:31], a[204:207], v[96:99]
    s_waitcnt vmcnt(0)
    v_add_f32 v5, v5, v19
    v_mfma_f32_16x16x32_bf16 v[100:103], v[24:27], a[224:227], v[100:103]
    ds_read_b128 v[44:47], v3 offset:6400
    v_mfma_f32_16x16x32_bf16 v[100:103], v[28:31], a[228:231], v[100:103]
    s_waitcnt lgkmcnt(2)
    s_barrier
    v_mfma_f32_16x16x32_bf16 v[64:67], v[32:35], a[208:211], v[64:67]
    s_mov_b32 m0, s56
    ds_read_b128 v[24:27], v2 offset:12288
    v_mfma_f32_16x16x32_bf16 v[64:67], v[36:39], a[212:215], v[64:67]
    buffer_load_dwordx4 v4, s[4:7], s27 offen offset:0 sc1 lds
    v_mfma_f32_16x16x32_bf16 v[68:71], v[32:35], a[232:235], v[68:71]
    ds_read_b128 v[28:31], v3 offset:12288
    v_mfma_f32_16x16x32_bf16 v[68:71], v[36:39], a[236:239], v[68:71]
    s_waitcnt lgkmcnt(2)
    v_exp_f32 v17, v121
    v_cvt_pk_bf16_f32 v185, v18, v19
    v_mfma_f32_16x16x32_bf16 v[96:99], v[40:43], a[208:211], v[96:99]
    ds_read_b128 v[32:35], v2 offset:18432
    v_mfma_f32_16x16x32_bf16 v[96:99], v[44:47], a[212:215], v[96:99]
    buffer_load_dwordx4 v4, s[4:7], s27 offen offset:1024 sc1 lds
    v_mfma_f32_16x16x32_bf16 v[100:103], v[40:43], a[232:235], v[100:103]
    ds_read_b128 v[36:39], v3 offset:18432
    v_mfma_f32_16x16x32_bf16 v[100:103], v[44:47], a[236:239], v[100:103]
    s_waitcnt lgkmcnt(2)
    v_exp_f32 v18, v122
    v_add_f32 v5, v5, v16
    v_mfma_f32_16x16x32_bf16 v[72:75], v[24:27], a[192:195], v[128:131]
    ds_read_b128 v[40:43], v2 offset:12416
    v_add_f32 v5, v5, v17
    v_mfma_f32_16x16x32_bf16 v[72:75], v[28:31], a[196:199], v[72:75]
    v_exp_f32 v19, v123
    v_cvt_pk_bf16_f32 v186, v16, v17
    v_mfma_f32_16x16x32_bf16 v[76:79], v[24:27], a[216:219], v[132:135]
    ds_read_b128 v[44:47], v3 offset:12416
    v_mfma_f32_16x16x32_bf16 v[76:79], v[28:31], a[220:223], v[76:79]
    s_waitcnt lgkmcnt(2)
    buffer_load_dwordx4 v4, s[4:7], s27 offen offset:2048 sc1 lds
    v_mfma_f32_16x16x32_bf16 v[104:107], v[32:35], a[192:195], v[128:131]
    ds_read_b128 v[24:27], v2 offset:18560
    v_mfma_f32_16x16x32_bf16 v[104:107], v[36:39], a[196:199], v[104:107]
    v_exp_f32 v16, v188
    v_add_f32 v5, v5, v18
    v_mfma_f32_16x16x32_bf16 v[108:111], v[32:35], a[216:219], v[132:135]
    ds_read_b128 v[28:31], v3 offset:18560
    v_add_f32 v5, v5, v19
    v_mfma_f32_16x16x32_bf16 v[108:111], v[36:39], a[220:223], v[108:111]
    s_waitcnt lgkmcnt(2)
    v_exp_f32 v17, v189
    v_cvt_pk_bf16_f32 v187, v18, v19
    v_mfma_f32_16x16x32_bf16 v[72:75], v[40:43], a[200:203], v[72:75]
    s_add_u32 s27, s27, 24576
    ds_read_b128 v[32:35], v2 offset:12544
    v_mfma_f32_16x16x32_bf16 v[72:75], v[44:47], a[204:207], v[72:75]
    v_exp_f32 v18, v190
    v_mfma_f32_16x16x32_bf16 v[76:79], v[40:43], a[224:227], v[76:79]
    s_add_u32 s56, s56, 12288
    ds_read_b128 v[36:39], v3 offset:12544
    v_add_f32 v6, v6, v16
    v_mfma_f32_16x16x32_bf16 v[76:79], v[44:47], a[228:231], v[76:79]
    s_waitcnt lgkmcnt(2)
    v_add_f32 v6, v6, v17
    v_mfma_f32_16x16x32_bf16 v[104:107], v[24:27], a[200:203], v[104:107]
    ds_read_b128 v[40:43], v2 offset:18688
    v_mfma_f32_16x16x32_bf16 v[104:107], v[28:31], a[204:207], v[104:107]
    v_exp_f32 v19, v191
    v_cvt_pk_bf16_f32 v188, v16, v17
    v_mfma_f32_16x16x32_bf16 v[108:111], v[24:27], a[224:227], v[108:111]
    s_mov_b32 m0, s56
    ds_read_b128 v[44:47], v3 offset:18688
    v_mfma_f32_16x16x32_bf16 v[108:111], v[28:31], a[228:231], v[108:111]
    s_waitcnt lgkmcnt(2)
    v_add_u32 v2, 49152, v2
    v_add_u32 v3, 49152, v3
    v_mfma_f32_16x16x32_bf16 v[72:75], v[32:35], a[208:211], v[72:75]
    ds_read_b128 v[24:27], v2 offset:0
    v_mfma_f32_16x16x32_bf16 v[72:75], v[36:39], a[212:215], v[72:75]
    buffer_load_dwordx4 v4, s[4:7], s27 offen offset:0 sc1 lds
    v_mfma_f32_16x16x32_bf16 v[76:79], v[32:35], a[232:235], v[76:79]
    ds_read_b128 v[28:31], v3 offset:0
    v_mfma_f32_16x16x32_bf16 v[76:79], v[36:39], a[236:239], v[76:79]
    s_waitcnt lgkmcnt(2)
    v_exp_f32 v16, v124
    v_add_f32 v6, v6, v18
    v_mfma_f32_16x16x32_bf16 v[104:107], v[40:43], a[208:211], v[104:107]
    ds_read_b128 v[32:35], v2 offset:6144
    v_add_f32 v6, v6, v19
    v_mfma_f32_16x16x32_bf16 v[104:107], v[44:47], a[212:215], v[104:107]
    v_exp_f32 v17, v125
    v_cvt_pk_bf16_f32 v189, v18, v19
    v_mfma_f32_16x16x32_bf16 v[108:111], v[40:43], a[232:235], v[108:111]
    ds_read_b128 v[36:39], v3 offset:6144
    v_mfma_f32_16x16x32_bf16 v[108:111], v[44:47], a[236:239], v[108:111]
    s_waitcnt lgkmcnt(2)
    buffer_load_dwordx4 v4, s[4:7], s27 offen offset:1024 sc1 lds
    v_mfma_f32_16x16x32_bf16 v[80:83], v[24:27], a[240:243], v[136:139]
    ds_read_b128 v[40:43], v2 offset:128
    v_mfma_f32_16x16x32_bf16 v[80:83], v[28:31], a[244:247], v[80:83]
    v_exp_f32 v18, v126
    v_add_f32 v6, v6, v16
    v_mfma_f32_16x16x32_bf16 v[84:87], v[24:27], v[200:203], v[140:143]
    ds_read_b128 v[44:47], v3 offset:128
    v_add_f32 v6, v6, v17
    v_exp_f32 v19, v127
    v_cvt_pk_bf16_f32 v190, v16, v17
    v_add_f32 v6, v6, v18
    v_add_f32 v6, v6, v19
    v_cvt_pk_bf16_f32 v191, v18, v19
    v_mfma_f32_16x16x32_bf16 v[84:87], v[28:31], v[204:207], v[84:87]
    s_waitcnt lgkmcnt(2)
    v_exp_f32 v16, v64
    v_mfma_f32_16x16x32_bf16 v[112:115], v[32:35], a[240:243], v[136:139]
    ds_read_b128 v[24:27], v2 offset:6272
    v_mfma_f32_16x16x32_bf16 v[112:115], v[36:39], a[244:247], v[112:115]
    buffer_load_dwordx4 v4, s[4:7], s27 offen offset:2048 sc1 lds
    v_mfma_f32_16x16x32_bf16 v[116:119], v[32:35], v[200:203], v[140:143]
    ds_read_b128 v[28:31], v3 offset:6272
    v_mfma_f32_16x16x32_bf16 v[116:119], v[36:39], v[204:207], v[116:119]
    s_waitcnt lgkmcnt(2)
    v_exp_f32 v17, v65
    v_mfma_f32_16x16x32_bf16 v[80:83], v[40:43], a[248:251], v[80:83]
    ds_read_b128 v[32:35], v2 offset:256
    v_mfma_f32_16x16x32_bf16 v[80:83], v[44:47], a[252:255], v[80:83]
    v_exp_f32 v18, v66
    v_mfma_f32_16x16x32_bf16 v[84:87], v[40:43], v[208:211], v[84:87]
    ds_read_b128 v[36:39], v3 offset:256
    v_add_f32 v5, v5, v16
    v_mfma_f32_16x16x32_bf16 v[84:87], v[44:47], v[212:215], v[84:87]
    s_waitcnt lgkmcnt(2)
    v_add_f32 v5, v5, v17
    v_mfma_f32_16x16x32_bf16 v[112:115], v[24:27], a[248:251], v[112:115]
    ds_read_b128 v[40:43], v2 offset:6400
    v_mfma_f32_16x16x32_bf16 v[112:115], v[28:31], a[252:255], v[112:115]
    v_exp_f32 v19, v67
    v_cvt_pk_bf16_f32 v64, v16, v17
    v_mfma_f32_16x16x32_bf16 v[116:119], v[24:27], v[208:211], v[116:119]
    s_add_u32 s27, s27, 24576
    ds_read_b128 v[44:47], v3 offset:6400
    s_add_u32 s56, s56, 36864
    v_mfma_f32_16x16x32_bf16 v[116:119], v[28:31], v[212:215], v[116:119]
    s_waitcnt lgkmcnt(2)
    v_exp_f32 v16, v96
    v_mfma_f32_16x16x32_bf16 v[80:83], v[32:35], v[192:195], v[80:83]
    s_sub_u32 s58, s56, 147456
    ds_read_b128 v[24:27], v2 offset:12288
    v_add_f32 v5, v5, v18
    v_mfma_f32_16x16x32_bf16 v[80:83], v[36:39], v[196:199], v[80:83]
    s_min_u32 s56, s56, s58
    v_add_f32 v5, v5, v19
    v_mfma_f32_16x16x32_bf16 v[84:87], v[32:35], v[216:219], v[84:87]
    ds_read_b128 v[28:31], v3 offset:12288
    v_mfma_f32_16x16x32_bf16 v[84:87], v[36:39], v[220:223], v[84:87]
    s_waitcnt lgkmcnt(2)
    v_exp_f32 v17, v97
    v_cvt_pk_bf16_f32 v65, v18, v19
    v_mfma_f32_16x16x32_bf16 v[112:115], v[40:43], v[192:195], v[112:115]
    ds_read_b128 v[32:35], v2 offset:18432
    v_mfma_f32_16x16x32_bf16 v[112:115], v[44:47], v[196:199], v[112:115]
    v_exp_f32 v18, v98
    v_mfma_f32_16x16x32_bf16 v[116:119], v[40:43], v[216:219], v[116:119]
    ds_read_b128 v[36:39], v3 offset:18432
    v_add_f32 v5, v5, v16
    v_mfma_f32_16x16x32_bf16 v[116:119], v[44:47], v[220:223], v[116:119]
    s_waitcnt lgkmcnt(2)
    v_add_f32 v5, v5, v17
    v_mfma_f32_16x16x32_bf16 v[88:91], v[24:27], a[240:243], v[136:139]
    ds_read_b128 v[40:43], v2 offset:12416
    v_mfma_f32_16x16x32_bf16 v[88:91], v[28:31], a[244:247], v[88:91]
    v_exp_f32 v19, v99
    v_cvt_pk_bf16_f32 v66, v16, v17
    v_mfma_f32_16x16x32_bf16 v[92:95], v[24:27], v[200:203], v[140:143]
    ds_read_b128 v[44:47], v3 offset:12416
    v_mfma_f32_16x16x32_bf16 v[92:95], v[28:31], v[204:207], v[92:95]
    s_waitcnt lgkmcnt(2)
    v_exp_f32 v16, v68
    v_mfma_f32_16x16x32_bf16 v[120:123], v[32:35], a[240:243], v[136:139]
    ds_read_b128 v[24:27], v2 offset:18560
    v_add_f32 v5, v5, v18
    v_mfma_f32_16x16x32_bf16 v[120:123], v[36:39], a[244:247], v[120:123]
    v_add_f32 v5, v5, v19
    v_mfma_f32_16x16x32_bf16 v[124:127], v[32:35], v[200:203], v[140:143]
    ds_read_b128 v[28:31], v3 offset:18560
    v_mfma_f32_16x16x32_bf16 v[124:127], v[36:39], v[204:207], v[124:127]
    s_waitcnt lgkmcnt(2)
    v_exp_f32 v17, v69
    v_cvt_pk_bf16_f32 v67, v18, v19
    v_mfma_f32_16x16x32_bf16 v[88:91], v[40:43], a[248:251], v[88:91]
    ds_read_b128 v[32:35], v2 offset:12544
    v_mfma_f32_16x16x32_bf16 v[88:91], v[44:47], a[252:255], v[88:91]
    v_exp_f32 v18, v70
    v_mfma_f32_16x16x32_bf16 v[92:95], v[40:43], v[208:211], v[92:95]
    ds_read_b128 v[36:39], v3 offset:12544
    v_add_f32 v6, v6, v16
    v_mfma_f32_16x16x32_bf16 v[92:95], v[44:47], v[212:215], v[92:95]
    s_waitcnt lgkmcnt(2)
    v_add_f32 v6, v6, v17
    v_mfma_f32_16x16x32_bf16 v[120:123], v[24:27], a[248:251], v[120:123]
    ds_read_b128 v[40:43], v2 offset:18688
    v_mfma_f32_16x16x32_bf16 v[120:123], v[28:31], a[252:255], v[120:123]
    v_exp_f32 v19, v71
    v_cvt_pk_bf16_f32 v68, v16, v17
    v_mfma_f32_16x16x32_bf16 v[124:127], v[24:27], v[208:211], v[124:127]
    ds_read_b128 v[44:47], v3 offset:18688
    v_mfma_f32_16x16x32_bf16 v[124:127], v[28:31], v[212:215], v[124:127]
    s_waitcnt lgkmcnt(2)
    v_add_u32 v1, 49152, v1
    v_exp_f32 v16, v100
    v_mfma_f32_16x16x32_bf16 v[88:91], v[32:35], v[192:195], v[88:91]
    ds_read_b128 v[24:27], v1 offset:0
    v_add_f32 v6, v6, v18
    v_mfma_f32_16x16x32_bf16 v[88:91], v[36:39], v[196:199], v[88:91]
    v_add_f32 v6, v6, v19
    v_mfma_f32_16x16x32_bf16 v[92:95], v[32:35], v[216:219], v[92:95]
    ds_read_b128 v[28:31], v1 offset:12288
    v_mfma_f32_16x16x32_bf16 v[92:95], v[36:39], v[220:223], v[92:95]
    s_waitcnt lgkmcnt(2)
    v_exp_f32 v17, v101
    v_cvt_pk_bf16_f32 v69, v18, v19
    v_mfma_f32_16x16x32_bf16 v[120:123], v[40:43], v[192:195], v[120:123]
    ds_read_b128 v[32:35], v1 offset:1024
    v_mfma_f32_16x16x32_bf16 v[120:123], v[44:47], v[196:199], v[120:123]
    v_exp_f32 v18, v102
    v_mfma_f32_16x16x32_bf16 v[124:127], v[40:43], v[216:219], v[124:127]
    ds_read_b128 v[36:39], v1 offset:13312
    v_add_f32 v6, v6, v16
    v_mfma_f32_16x16x32_bf16 v[124:127], v[44:47], v[220:223], v[124:127]
    s_waitcnt lgkmcnt(2)
    v_add_f32 v6, v6, v17
    v_exp_f32 v19, v103
    v_cvt_pk_bf16_f32 v70, v16, v17
    v_add_f32 v6, v6, v18
    v_add_f32 v6, v6, v19
    v_cvt_pk_bf16_f32 v71, v18, v19
    v_mfma_f32_16x16x32_bf16 a[0:3], v[160:163], v[24:27], a[0:3]
    ds_read_b128 v[40:43], v1 offset:2048
    v_mfma_f32_16x16x32_bf16 a[0:3], v[168:171], v[28:31], a[0:3]
    v_exp_f32 v16, v72
    v_mfma_f32_16x16x32_bf16 a[48:51], v[164:167], v[24:27], a[48:51]
    ds_read_b128 v[44:47], v1 offset:14336
    v_mfma_f32_16x16x32_bf16 a[48:51], v[172:175], v[28:31], a[48:51]
    s_waitcnt lgkmcnt(2)
    v_exp_f32 v17, v73
    v_mfma_f32_16x16x32_bf16 a[4:7], v[160:163], v[32:35], a[4:7]
    ds_read_b128 v[24:27], v1 offset:3072
    v_mfma_f32_16x16x32_bf16 a[4:7], v[168:171], v[36:39], a[4:7]
    v_exp_f32 v18, v74
    v_mfma_f32_16x16x32_bf16 a[52:55], v[164:167], v[32:35], a[52:55]
    ds_read_b128 v[28:31], v1 offset:15360
    v_add_f32 v5, v5, v16
    v_mfma_f32_16x16x32_bf16 a[52:55], v[172:175], v[36:39], a[52:55]
    s_waitcnt lgkmcnt(2)
    v_add_f32 v5, v5, v17
    v_mfma_f32_16x16x32_bf16 a[8:11], v[160:163], v[40:43], a[8:11]
    ds_read_b128 v[32:35], v1 offset:4096
    v_mfma_f32_16x16x32_bf16 a[8:11], v[168:171], v[44:47], a[8:11]
    v_exp_f32 v19, v75
    v_mfma_f32_16x16x32_bf16 a[56:59], v[164:167], v[40:43], a[56:59]
    ds_read_b128 v[36:39], v1 offset:16384
    v_cvt_pk_bf16_f32 v72, v16, v17
    v_mfma_f32_16x16x32_bf16 a[56:59], v[172:175], v[44:47], a[56:59]
    s_waitcnt lgkmcnt(2)
    v_exp_f32 v16, v104
    v_mfma_f32_16x16x32_bf16 a[12:15], v[160:163], v[24:27], a[12:15]
    ds_read_b128 v[40:43], v1 offset:5120
    v_add_f32 v5, v5, v18
    v_mfma_f32_16x16x32_bf16 a[12:15], v[168:171], v[28:31], a[12:15]
    v_add_f32 v5, v5, v19
    v_mfma_f32_16x16x32_bf16 a[60:63], v[164:167], v[24:27], a[60:63]
    ds_read_b128 v[44:47], v1 offset:17408
    v_mfma_f32_16x16x32_bf16 a[60:63], v[172:175], v[28:31], a[60:63]
    s_waitcnt lgkmcnt(2)
    v_exp_f32 v17, v105
    v_mfma_f32_16x16x32_bf16 a[16:19], v[160:163], v[32:35], a[16:19]
    ds_read_b128 v[24:27], v1 offset:6144
    v_cvt_pk_bf16_f32 v73, v18, v19
    v_mfma_f32_16x16x32_bf16 a[16:19], v[168:171], v[36:39], a[16:19]
    v_exp_f32 v18, v106
    v_mfma_f32_16x16x32_bf16 a[64:67], v[164:167], v[32:35], a[64:67]
    ds_read_b128 v[28:31], v1 offset:18432
    v_add_f32 v5, v5, v16
    v_mfma_f32_16x16x32_bf16 a[64:67], v[172:175], v[36:39], a[64:67]
    s_waitcnt lgkmcnt(2)
    v_add_f32 v5, v5, v17
    v_mfma_f32_16x16x32_bf16 a[20:23], v[160:163], v[40:43], a[20:23]
    ds_read_b128 v[32:35], v1 offset:7168
    v_mfma_f32_16x16x32_bf16 a[20:23], v[168:171], v[44:47], a[20:23]
    v_exp_f32 v19, v107
    v_mfma_f32_16x16x32_bf16 a[68:71], v[164:167], v[40:43], a[68:71]
    ds_read_b128 v[36:39], v1 offset:19456
    v_cvt_pk_bf16_f32 v74, v16, v17
    v_mfma_f32_16x16x32_bf16 a[68:71], v[172:175], v[44:47], a[68:71]
    s_waitcnt lgkmcnt(2)
    v_exp_f32 v16, v76
    v_mfma_f32_16x16x32_bf16 a[24:27], v[160:163], v[24:27], a[24:27]
    ds_read_b128 v[40:43], v1 offset:8192
    v_add_f32 v5, v5, v18
    v_mfma_f32_16x16x32_bf16 a[24:27], v[168:171], v[28:31], a[24:27]
    v_add_f32 v5, v5, v19
    v_mfma_f32_16x16x32_bf16 a[72:75], v[164:167], v[24:27], a[72:75]
    ds_read_b128 v[44:47], v1 offset:20480
    v_mfma_f32_16x16x32_bf16 a[72:75], v[172:175], v[28:31], a[72:75]
    s_waitcnt lgkmcnt(2)
    v_exp_f32 v17, v77
    v_mfma_f32_16x16x32_bf16 a[28:31], v[160:163], v[32:35], a[28:31]
    ds_read_b128 v[24:27], v1 offset:9216
    v_cvt_pk_bf16_f32 v75, v18, v19
    v_mfma_f32_16x16x32_bf16 a[28:31], v[168:171], v[36:39], a[28:31]
    v_exp_f32 v18, v78
    v_mfma_f32_16x16x32_bf16 a[76:79], v[164:167], v[32:35], a[76:79]
    ds_read_b128 v[28:31], v1 offset:21504
    v_add_f32 v6, v6, v16
    v_mfma_f32_16x16x32_bf16 a[76:79], v[172:175], v[36:39], a[76:79]
    s_waitcnt lgkmcnt(2)
    v_add_f32 v6, v6, v17
    v_mfma_f32_16x16x32_bf16 a[32:35], v[160:163], v[40:43], a[32:35]
    ds_read_b128 v[32:35], v1 offset:10240
    v_mfma_f32_16x16x32_bf16 a[32:35], v[168:171], v[44:47], a[32:35]
    v_exp_f32 v19, v79
    v_mfma_f32_16x16x32_bf16 a[80:83], v[164:167], v[40:43], a[80:83]
    ds_read_b128 v[36:39], v1 offset:22528
    v_cvt_pk_bf16_f32 v76, v16, v17
    v_mfma_f32_16x16x32_bf16 a[80:83], v[172:175], v[44:47], a[80:83]
    s_waitcnt lgkmcnt(2)
    v_exp_f32 v16, v108
    v_mfma_f32_16x16x32_bf16 a[36:39], v[160:163], v[24:27], a[36:39]
    ds_read_b128 v[40:43], v1 offset:11264
    v_add_f32 v6, v6, v18
    v_mfma_f32_16x16x32_bf16 a[36:39], v[168:171], v[28:31], a[36:39]
    v_add_f32 v6, v6, v19
    v_mfma_f32_16x16x32_bf16 a[84:87], v[164:167], v[24:27], a[84:87]
    ds_read_b128 v[44:47], v1 offset:23552
    v_mfma_f32_16x16x32_bf16 a[84:87], v[172:175], v[28:31], a[84:87]
    s_waitcnt lgkmcnt(2)
    v_subrev_u32 v1, 98304, v1
    v_mfma_f32_16x16x32_bf16 a[40:43], v[160:163], v[32:35], a[40:43]
    ds_read_b128 v[24:27], v1 offset:0
    v_mfma_f32_16x16x32_bf16 a[40:43], v[168:171], v[36:39], a[40:43]
    v_exp_f32 v17, v109
    v_mfma_f32_16x16x32_bf16 a[88:91], v[164:167], v[32:35], a[88:91]
    ds_read_b128 v[28:31], v1 offset:12288
    v_cvt_pk_bf16_f32 v77, v18, v19
    v_mfma_f32_16x16x32_bf16 a[88:91], v[172:175], v[36:39], a[88:91]
    s_waitcnt lgkmcnt(2)
    v_exp_f32 v18, v110
    v_mfma_f32_16x16x32_bf16 a[44:47], v[160:163], v[40:43], a[44:47]
    ds_read_b128 v[32:35], v1 offset:1024
    v_add_f32 v6, v6, v16
    v_mfma_f32_16x16x32_bf16 a[44:47], v[168:171], v[44:47], a[44:47]
    v_add_f32 v6, v6, v17
    v_mfma_f32_16x16x32_bf16 a[92:95], v[164:167], v[40:43], a[92:95]
    ds_read_b128 v[36:39], v1 offset:13312
    v_mfma_f32_16x16x32_bf16 a[92:95], v[172:175], v[44:47], a[92:95]
    s_waitcnt lgkmcnt(2)
    v_exp_f32 v19, v111
    v_mfma_f32_16x16x32_bf16 a[0:3], v[176:179], v[24:27], a[0:3]
    ds_read_b128 v[40:43], v1 offset:2048
    v_cvt_pk_bf16_f32 v78, v16, v17
    v_mfma_f32_16x16x32_bf16 a[0:3], v[184:187], v[28:31], a[0:3]
    v_add_f32 v6, v6, v18
    v_add_f32 v6, v6, v19
    v_mfma_f32_16x16x32_bf16 a[48:51], v[180:183], v[24:27], a[48:51]
    ds_read_b128 v[44:47], v1 offset:14336
    v_cvt_pk_bf16_f32 v79, v18, v19
    v_mfma_f32_16x16x32_bf16 a[48:51], v[188:191], v[28:31], a[48:51]
    s_waitcnt lgkmcnt(2)
    v_exp_f32 v16, v80
    v_mfma_f32_16x16x32_bf16 a[4:7], v[176:179], v[32:35], a[4:7]
    ds_read_b128 v[24:27], v1 offset:3072
    v_mfma_f32_16x16x32_bf16 a[4:7], v[184:187], v[36:39], a[4:7]
    v_exp_f32 v17, v81
    v_mfma_f32_16x16x32_bf16 a[52:55], v[180:183], v[32:35], a[52:55]
    ds_read_b128 v[28:31], v1 offset:15360
    v_mfma_f32_16x16x32_bf16 a[52:55], v[188:191], v[36:39], a[52:55]
    s_waitcnt lgkmcnt(2)
    v_exp_f32 v18, v82
    v_mfma_f32_16x16x32_bf16 a[8:11], v[176:179], v[40:43], a[8:11]
    ds_read_b128 v[32:35], v1 offset:4096
    v_add_f32 v7, v7, v16
    v_mfma_f32_16x16x32_bf16 a[8:11], v[184:187], v[44:47], a[8:11]
    v_add_f32 v7, v7, v17
    v_mfma_f32_16x16x32_bf16 a[56:59], v[180:183], v[40:43], a[56:59]
    ds_read_b128 v[36:39], v1 offset:16384
    v_mfma_f32_16x16x32_bf16 a[56:59], v[188:191], v[44:47], a[56:59]
    s_waitcnt lgkmcnt(2)
    v_exp_f32 v19, v83
    v_mfma_f32_16x16x32_bf16 a[12:15], v[176:179], v[24:27], a[12:15]
    ds_read_b128 v[40:43], v1 offset:5120
    v_cvt_pk_bf16_f32 v80, v16, v17
    v_mfma_f32_16x16x32_bf16 a[12:15], v[184:187], v[28:31], a[12:15]
    v_exp_f32 v16, v112
    v_mfma_f32_16x16x32_bf16 a[60:63], v[180:183], v[24:27], a[60:63]
    ds_read_b128 v[44:47], v1 offset:17408
    v_add_f32 v7, v7, v18
    v_mfma_f32_16x16x32_bf16 a[60:63], v[188:191], v[28:31], a[60:63]
    s_waitcnt lgkmcnt(2)
    v_add_f32 v7, v7, v19
    v_mfma_f32_16x16x32_bf16 a[16:19], v[176:179], v[32:35], a[16:19]
    ds_read_b128 v[24:27], v1 offset:6144
    v_mfma_f32_16x16x32_bf16 a[16:19], v[184:187], v[36:39], a[16:19]
    v_exp_f32 v17, v113
    v_mfma_f32_16x16x32_bf16 a[64:67], v[180:183], v[32:35], a[64:67]
    ds_read_b128 v[28:31], v1 offset:18432
    v_cvt_pk_bf16_f32 v81, v18, v19
    v_mfma_f32_16x16x32_bf16 a[64:67], v[188:191], v[36:39], a[64:67]
    s_waitcnt lgkmcnt(2)
    v_exp_f32 v18, v114
    v_mfma_f32_16x16x32_bf16 a[20:23], v[176:179], v[40:43], a[20:23]
    ds_read_b128 v[32:35], v1 offset:7168
    v_add_f32 v7, v7, v16
    v_mfma_f32_16x16x32_bf16 a[20:23], v[184:187], v[44:47], a[20:23]
    v_add_f32 v7, v7, v17
    v_mfma_f32_16x16x32_bf16 a[68:71], v[180:183], v[40:43], a[68:71]
    ds_read_b128 v[36:39], v1 offset:19456
    v_mfma_f32_16x16x32_bf16 a[68:71], v[188:191], v[44:47], a[68:71]
    s_waitcnt lgkmcnt(2)
    v_exp_f32 v19, v115
    v_mfma_f32_16x16x32_bf16 a[24:27], v[176:179], v[24:27], a[24:27]
    ds_read_b128 v[40:43], v1 offset:8192
    v_cvt_pk_bf16_f32 v82, v16, v17
    v_mfma_f32_16x16x32_bf16 a[24:27], v[184:187], v[28:31], a[24:27]
    v_exp_f32 v16, v84
    v_mfma_f32_16x16x32_bf16 a[72:75], v[180:183], v[24:27], a[72:75]
    ds_read_b128 v[44:47], v1 offset:20480
    v_add_f32 v7, v7, v18
    v_mfma_f32_16x16x32_bf16 a[72:75], v[188:191], v[28:31], a[72:75]
    s_waitcnt lgkmcnt(2)
    v_add_f32 v7, v7, v19
    v_mfma_f32_16x16x32_bf16 a[28:31], v[176:179], v[32:35], a[28:31]
    ds_read_b128 v[24:27], v1 offset:9216
    v_mfma_f32_16x16x32_bf16 a[28:31], v[184:187], v[36:39], a[28:31]
    s_waitcnt vmcnt(0)
    v_exp_f32 v17, v85
    v_mfma_f32_16x16x32_bf16 a[76:79], v[180:183], v[32:35], a[76:79]
    ds_read_b128 v[28:31], v1 offset:21504
    v_cvt_pk_bf16_f32 v83, v18, v19
    v_mfma_f32_16x16x32_bf16 a[76:79], v[188:191], v[36:39], a[76:79]
    s_waitcnt lgkmcnt(2)
    s_barrier
    v_mfma_f32_16x16x32_bf16 a[32:35], v[176:179], v[40:43], a[32:35]
    ds_read_b128 v[32:35], v1 offset:10240
    v_mfma_f32_16x16x32_bf16 a[32:35], v[184:187], v[44:47], a[32:35]
    v_exp_f32 v18, v86
    v_mfma_f32_16x16x32_bf16 a[80:83], v[180:183], v[40:43], a[80:83]
    ds_read_b128 v[36:39], v1 offset:22528
    v_add_f32 v8, v8, v16
    v_mfma_f32_16x16x32_bf16 a[80:83], v[188:191], v[44:47], a[80:83]
    s_waitcnt lgkmcnt(2)
    v_add_f32 v8, v8, v17
    v_mfma_f32_16x16x32_bf16 a[36:39], v[176:179], v[24:27], a[36:39]
    ds_read_b128 v[40:43], v1 offset:11264
    v_mfma_f32_16x16x32_bf16 a[36:39], v[184:187], v[28:31], a[36:39]
    v_exp_f32 v19, v87
    v_cvt_pk_bf16_f32 v84, v16, v17
    v_mfma_f32_16x16x32_bf16 a[84:87], v[180:183], v[24:27], a[84:87]
    ds_read_b128 v[44:47], v1 offset:23552
    v_mfma_f32_16x16x32_bf16 a[84:87], v[188:191], v[28:31], a[84:87]
    s_waitcnt lgkmcnt(2)
    v_add_u32 v1, 49152, v1
    v_exp_f32 v16, v116
    v_mfma_f32_16x16x32_bf16 a[40:43], v[176:179], v[32:35], a[40:43]
    ds_read_b128 v[24:27], v1 offset:0
    v_add_f32 v8, v8, v18
    v_mfma_f32_16x16x32_bf16 a[40:43], v[184:187], v[36:39], a[40:43]
    v_add_f32 v8, v8, v19
    v_mfma_f32_16x16x32_bf16 a[88:91], v[180:183], v[32:35], a[88:91]
    ds_read_b128 v[28:31], v1 offset:12288
    v_mfma_f32_16x16x32_bf16 a[88:91], v[188:191], v[36:39], a[88:91]
    s_waitcnt lgkmcnt(2)
    v_exp_f32 v17, v117
    v_cvt_pk_bf16_f32 v85, v18, v19
    v_mfma_f32_16x16x32_bf16 a[44:47], v[176:179], v[40:43], a[44:47]
    ds_read_b128 v[32:35], v1 offset:1024
    v_mfma_f32_16x16x32_bf16 a[44:47], v[184:187], v[44:47], a[44:47]
    v_exp_f32 v18, v118
    v_mfma_f32_16x16x32_bf16 a[92:95], v[180:183], v[40:43], a[92:95]
    ds_read_b128 v[36:39], v1 offset:13312
    v_add_f32 v8, v8, v16
    v_mfma_f32_16x16x32_bf16 a[92:95], v[188:191], v[44:47], a[92:95]
    s_waitcnt lgkmcnt(2)
    v_add_f32 v8, v8, v17
    v_exp_f32 v19, v119
    v_cvt_pk_bf16_f32 v86, v16, v17
    v_add_f32 v8, v8, v18
    v_add_f32 v8, v8, v19
    v_cvt_pk_bf16_f32 v87, v18, v19
    v_mfma_f32_16x16x32_bf16 a[0:3], v[64:67], v[24:27], a[0:3]
    ds_read_b128 v[40:43], v1 offset:2048
    v_mfma_f32_16x16x32_bf16 a[0:3], v[72:75], v[28:31], a[0:3]
    v_exp_f32 v16, v88
    v_exp_f32 v17, v89
    v_exp_f32 v18, v90
    v_mfma_f32_16x16x4_f32 v[48:51], v5, v57, 0
    v_mfma_f32_16x16x32_bf16 a[48:51], v[68:71], v[24:27], a[48:51]
    ds_read_b128 v[44:47], v1 offset:14336
    v_add_f32 v7, v7, v16
    v_mfma_f32_16x16x32_bf16 a[48:51], v[76:79], v[28:31], a[48:51]
    s_waitcnt lgkmcnt(2)
    v_add_f32 v7, v7, v17
    v_exp_f32 v19, v91
    v_cvt_pk_bf16_f32 v88, v16, v17
    v_exp_f32 v16, v120
    v_mfma_f32_16x16x4_f32 v[52:55], v6, v57, 0
    v_mfma_f32_16x16x32_bf16 a[4:7], v[64:67], v[32:35], a[4:7]
    ds_read_b128 v[24:27], v1 offset:3072
    v_add_f32 v7, v7, v18
    v_mfma_f32_16x16x32_bf16 a[4:7], v[72:75], v[36:39], a[4:7]
    v_add_f32 v7, v7, v19
    v_exp_f32 v17, v121
    v_mfma_f32_16x16x32_bf16 a[52:55], v[68:71], v[32:35], a[52:55]
    ds_read_b128 v[28:31], v1 offset:15360
    v_cvt_pk_bf16_f32 v89, v18, v19
    v_mfma_f32_16x16x32_bf16 a[52:55], v[76:79], v[36:39], a[52:55]
    s_waitcnt lgkmcnt(2)
    v_exp_f32 v18, v122
    v_mfma_f32_16x16x32_bf16 a[8:11], v[64:67], v[40:43], a[8:11]
    ds_read_b128 v[32:35], v1 offset:4096
    v_add_f32 v7, v7, v16
    v_mfma_f32_16x16x32_bf16 a[8:11], v[72:75], v[44:47], a[8:11]
    v_add_f32 v7, v7, v17
    v_exp_f32 v19, v123
    v_mfma_f32_16x16x32_bf16 a[56:59], v[68:71], v[40:43], a[56:59]
    ds_read_b128 v[36:39], v1 offset:16384
    v_cvt_pk_bf16_f32 v90, v16, v17
    v_mfma_f32_16x16x32_bf16 a[56:59], v[76:79], v[44:47], a[56:59]
    s_waitcnt lgkmcnt(2)
    v_exp_f32 v16, v92
    v_mfma_f32_16x16x32_bf16 a[12:15], v[64:67], v[24:27], a[12:15]
    ds_read_b128 v[40:43], v1 offset:5120
    v_add_f32 v7, v7, v18
    v_mfma_f32_16x16x32_bf16 a[12:15], v[72:75], v[28:31], a[12:15]
    v_add_f32 v7, v7, v19
    v_exp_f32 v17, v93
    v_mfma_f32_16x16x32_bf16 a[60:63], v[68:71], v[24:27], a[60:63]
    ds_read_b128 v[44:47], v1 offset:17408
    v_cvt_pk_bf16_f32 v91, v18, v19
    v_mfma_f32_16x16x32_bf16 a[60:63], v[76:79], v[28:31], a[60:63]
    s_waitcnt lgkmcnt(2)
    v_exp_f32 v18, v94
    v_mfma_f32_16x16x32_bf16 a[16:19], v[64:67], v[32:35], a[16:19]
    ds_read_b128 v[24:27], v1 offset:6144
    v_add_f32 v8, v8, v16
    v_mfma_f32_16x16x32_bf16 a[16:19], v[72:75], v[36:39], a[16:19]
    v_add_f32 v8, v8, v17
    v_exp_f32 v19, v95
    v_mfma_f32_16x16x32_bf16 a[64:67], v[68:71], v[32:35], a[64:67]
    ds_read_b128 v[28:31], v1 offset:18432
    v_cvt_pk_bf16_f32 v92, v16, v17
    v_mfma_f32_16x16x32_bf16 a[64:67], v[76:79], v[36:39], a[64:67]
    s_waitcnt lgkmcnt(2)
    v_exp_f32 v16, v124
    v_mfma_f32_16x16x32_bf16 a[20:23], v[64:67], v[40:43], a[20:23]
    ds_read_b128 v[32:35], v1 offset:7168
    v_add_f32 v8, v8, v18
    v_mfma_f32_16x16x32_bf16 a[20:23], v[72:75], v[44:47], a[20:23]
    v_add_f32 v8, v8, v19
    v_exp_f32 v17, v125
    v_mfma_f32_16x16x32_bf16 a[68:71], v[68:71], v[40:43], a[68:71]
    ds_read_b128 v[36:39], v1 offset:19456
    v_cvt_pk_bf16_f32 v93, v18, v19
    v_mfma_f32_16x16x32_bf16 a[68:71], v[76:79], v[44:47], a[68:71]
    s_waitcnt lgkmcnt(2)
    v_exp_f32 v18, v126
    v_mfma_f32_16x16x32_bf16 a[24:27], v[64:67], v[24:27], a[24:27]
    ds_read_b128 v[40:43], v1 offset:8192
    v_add_f32 v8, v8, v16
    v_mfma_f32_16x16x32_bf16 a[24:27], v[72:75], v[28:31], a[24:27]
    v_add_f32 v8, v8, v17
    v_exp_f32 v19, v127
    v_mfma_f32_16x16x32_bf16 a[72:75], v[68:71], v[24:27], a[72:75]
    ds_read_b128 v[44:47], v1 offset:20480
    v_cvt_pk_bf16_f32 v94, v16, v17
    v_mfma_f32_16x16x32_bf16 a[72:75], v[76:79], v[28:31], a[72:75]
    s_waitcnt lgkmcnt(2)
    v_add_f32 v8, v8, v18
    v_add_f32 v8, v8, v19
    v_mfma_f32_16x16x32_bf16 a[28:31], v[64:67], v[32:35], a[28:31]
    ds_read_b128 v[24:27], v1 offset:9216
    v_cvt_pk_bf16_f32 v95, v18, v19
    v_mfma_f32_16x16x32_bf16 a[28:31], v[72:75], v[36:39], a[28:31]
    v_rcp_f32 v48, v48
    v_mfma_f32_16x16x32_bf16 a[76:79], v[68:71], v[32:35], a[76:79]
    ds_read_b128 v[28:31], v1 offset:21504
    v_mfma_f32_16x16x32_bf16 a[76:79], v[76:79], v[36:39], a[76:79]
    s_waitcnt lgkmcnt(2)
    v_rcp_f32 v49, v49
    v_mfma_f32_16x16x32_bf16 a[32:35], v[64:67], v[40:43], a[32:35]
    ds_read_b128 v[32:35], v1 offset:10240
    v_mfma_f32_16x16x32_bf16 a[32:35], v[72:75], v[44:47], a[32:35]
    v_rcp_f32 v50, v50
    v_mfma_f32_16x16x32_bf16 a[80:83], v[68:71], v[40:43], a[80:83]
    ds_read_b128 v[36:39], v1 offset:22528
    v_mfma_f32_16x16x32_bf16 a[80:83], v[76:79], v[44:47], a[80:83]
    s_waitcnt lgkmcnt(2)
    v_rcp_f32 v51, v51
    v_mfma_f32_16x16x32_bf16 a[36:39], v[64:67], v[24:27], a[36:39]
    ds_read_b128 v[40:43], v1 offset:11264
    v_mfma_f32_16x16x32_bf16 a[36:39], v[72:75], v[28:31], a[36:39]
    v_rcp_f32 v52, v52
    v_mfma_f32_16x16x32_bf16 a[84:87], v[68:71], v[24:27], a[84:87]
    ds_read_b128 v[44:47], v1 offset:23552
    v_mfma_f32_16x16x32_bf16 a[84:87], v[76:79], v[28:31], a[84:87]
    s_waitcnt lgkmcnt(2)
    v_subrev_u32 v2, 98304, v2
    v_subrev_u32 v3, 98304, v3
    v_mfma_f32_16x16x32_bf16 a[40:43], v[64:67], v[32:35], a[40:43]
    ds_read_b128 v[24:27], v2 offset:0
    v_mfma_f32_16x16x32_bf16 a[40:43], v[72:75], v[36:39], a[40:43]
    v_rcp_f32 v53, v53
    v_mfma_f32_16x16x32_bf16 a[88:91], v[68:71], v[32:35], a[88:91]
    ds_read_b128 v[28:31], v3 offset:0
    v_mfma_f32_16x16x32_bf16 a[88:91], v[76:79], v[36:39], a[88:91]
    s_waitcnt lgkmcnt(2)
    v_rcp_f32 v54, v54
    v_mfma_f32_16x16x32_bf16 a[44:47], v[64:67], v[40:43], a[44:47]
    ds_read_b128 v[32:35], v2 offset:6144
    v_mfma_f32_16x16x32_bf16 a[44:47], v[72:75], v[44:47], a[44:47]
    v_rcp_f32 v55, v55
    v_mfma_f32_16x16x32_bf16 a[92:95], v[68:71], v[40:43], a[92:95]
    ds_read_b128 v[36:39], v3 offset:6144
    v_mfma_f32_16x16x32_bf16 a[92:95], v[76:79], v[44:47], a[92:95]
    s_waitcnt lgkmcnt(2)
    v_mfma_f32_16x16x32_bf16 v[160:163], v[24:27], a[240:243], v[136:139]
    ds_read_b128 v[40:43], v2 offset:128
    v_mfma_f32_16x16x32_bf16 v[160:163], v[28:31], a[244:247], v[160:163]
    v_mfma_f32_16x16x32_bf16 v[164:167], v[24:27], v[200:203], v[140:143]
    ds_read_b128 v[44:47], v3 offset:128
    v_mfma_f32_16x16x32_bf16 v[164:167], v[28:31], v[204:207], v[164:167]
    s_waitcnt lgkmcnt(2)
    v_mfma_f32_16x16x32_bf16 v[96:99], v[32:35], a[240:243], v[136:139]
    ds_read_b128 v[24:27], v2 offset:6272
    v_accvgpr_read_b32 v224, a0
    v_mfma_f32_16x16x32_bf16 v[96:99], v[36:39], a[244:247], v[96:99]
    v_accvgpr_read_b32 v225, a12
    v_accvgpr_read_b32 v226, a24
    v_accvgpr_read_b32 v227, a36
    v_mul_f32 v224, v224, v48
    v_mul_f32 v225, v225, v48
    v_mfma_f32_16x16x32_bf16 v[100:103], v[32:35], v[200:203], v[140:143]
    ds_read_b128 v[28:31], v3 offset:6272
    v_mul_f32 v226, v226, v48
    v_mfma_f32_16x16x32_bf16 v[100:103], v[36:39], v[204:207], v[100:103]
    s_waitcnt lgkmcnt(2)
    v_mul_f32 v227, v227, v48
    v_cvt_pk_bf16_f32 v224, v224, v225
    v_cvt_pk_bf16_f32 v225, v226, v227
    v_accvgpr_read_b32 v228, a1
    v_accvgpr_read_b32 v229, a13
    v_accvgpr_read_b32 v230, a25
    v_mfma_f32_16x16x32_bf16 v[160:163], v[40:43], a[248:251], v[160:163]
    ds_read_b128 v[32:35], v2 offset:256
    v_accvgpr_read_b32 v231, a37
    v_mfma_f32_16x16x32_bf16 v[160:163], v[44:47], a[252:255], v[160:163]
    buffer_store_dwordx2 v[224:225], v56, s[12:15], s24 offen offset:0 sc0 sc1
    v_mul_f32 v228, v228, v49
    v_mul_f32 v229, v229, v49
    v_mul_f32 v230, v230, v49
    v_mfma_f32_16x16x32_bf16 v[164:167], v[40:43], v[208:211], v[164:167]
    ds_read_b128 v[36:39], v3 offset:256
    v_mul_f32 v231, v231, v49
    v_mfma_f32_16x16x32_bf16 v[164:167], v[44:47], v[212:215], v[164:167]
    s_waitcnt lgkmcnt(2)
    v_cvt_pk_bf16_f32 v228, v228, v229
    v_cvt_pk_bf16_f32 v229, v230, v231
    v_accvgpr_read_b32 v232, a2
    v_accvgpr_read_b32 v233, a14
    v_accvgpr_read_b32 v234, a26
    v_accvgpr_read_b32 v235, a38
    v_mfma_f32_16x16x32_bf16 v[96:99], v[24:27], a[248:251], v[96:99]
    ds_read_b128 v[40:43], v2 offset:6400
    v_mul_f32 v232, v232, v50
    v_mfma_f32_16x16x32_bf16 v[96:99], v[28:31], a[252:255], v[96:99]
    buffer_store_dwordx2 v[228:229], v56, s[12:15], s24 offen offset:384 sc0 sc1
    v_mul_f32 v233, v233, v50
    v_mul_f32 v234, v234, v50
    v_mul_f32 v235, v235, v50
    v_mfma_f32_16x16x32_bf16 v[100:103], v[24:27], v[208:211], v[100:103]
    ds_read_b128 v[44:47], v3 offset:6400
    v_cvt_pk_bf16_f32 v232, v232, v233
    v_mfma_f32_16x16x32_bf16 v[100:103], v[28:31], v[212:215], v[100:103]
    s_waitcnt lgkmcnt(2)
    v_cvt_pk_bf16_f32 v233, v234, v235
    v_accvgpr_read_b32 v236, a3
    v_accvgpr_read_b32 v237, a15
    v_accvgpr_read_b32 v238, a27
    v_accvgpr_read_b32 v239, a39
    v_mul_f32 v236, v236, v51
    v_mfma_f32_16x16x32_bf16 v[160:163], v[32:35], v[192:195], v[160:163]
    ds_read_b128 v[24:27], v2 offset:12288
    v_mul_f32 v237, v237, v51
    v_mfma_f32_16x16x32_bf16 v[160:163], v[36:39], v[196:199], v[160:163]
    buffer_store_dwordx2 v[232:233], v56, s[12:15], s24 offen offset:768 sc0 sc1
    v_mul_f32 v238, v238, v51
    v_mul_f32 v239, v239, v51
    v_cvt_pk_bf16_f32 v236, v236, v237
    v_mfma_f32_16x16x32_bf16 v[164:167], v[32:35], v[216:219], v[164:167]
    ds_read_b128 v[28:31], v3 offset:12288
    v_cvt_pk_bf16_f32 v237, v238, v239
    v_mfma_f32_16x16x32_bf16 v[164:167], v[36:39], v[220:223], v[164:167]
    s_waitcnt lgkmcnt(2)
    buffer_store_dwordx2 v[236:237], v56, s[12:15], s24 offen offset:1152 sc0 sc1
    v_accvgpr_read_b32 v240, a4
    v_accvgpr_read_b32 v241, a16
    v_accvgpr_read_b32 v242, a28
    v_mfma_f32_16x16x32_bf16 v[96:99], v[40:43], v[192:195], v[96:99]
    ds_read_b128 v[32:35], v2 offset:18432
    v_accvgpr_read_b32 v243, a40
    v_mfma_f32_16x16x32_bf16 v[96:99], v[44:47], v[196:199], v[96:99]
    v_mul_f32 v240, v240, v48
    v_mul_f32 v241, v241, v48
    v_mul_f32 v242, v242, v48
    v_mul_f32 v243, v243, v48
    v_cvt_pk_bf16_f32 v240, v240, v241
    v_cvt_pk_bf16_f32 v241, v242, v243
    v_mfma_f32_16x16x32_bf16 v[100:103], v[40:43], v[216:219], v[100:103]
    ds_read_b128 v[36:39], v3 offset:18432
    v_accvgpr_read_b32 v244, a5
    v_mfma_f32_16x16x32_bf16 v[100:103], v[44:47], v[220:223], v[100:103]
    s_waitcnt lgkmcnt(2)
    buffer_store_dwordx2 v[240:241], v56, s[12:15], s24 offen offset:128 sc0 sc1
    v_accvgpr_read_b32 v245, a17
    v_accvgpr_read_b32 v246, a29
    v_accvgpr_read_b32 v247, a41
    v_mfma_f32_16x16x32_bf16 v[168:171], v[24:27], a[240:243], v[136:139]
    ds_read_b128 v[40:43], v2 offset:12416
    v_mul_f32 v244, v244, v49
    v_mfma_f32_16x16x32_bf16 v[168:171], v[28:31], a[244:247], v[168:171]
    v_mul_f32 v245, v245, v49
    v_mul_f32 v246, v246, v49
    v_mul_f32 v247, v247, v49
    v_cvt_pk_bf16_f32 v244, v244, v245
    v_cvt_pk_bf16_f32 v245, v246, v247
    v_accvgpr_read_b32 v248, a6
    v_mfma_f32_16x16x32_bf16 v[172:175], v[24:27], v[200:203], v[140:143]
    ds_read_b128 v[44:47], v3 offset:12416
    v_accvgpr_read_b32 v249, a18
    v_mfma_f32_16x16x32_bf16 v[172:175], v[28:31], v[204:207], v[172:175]
    s_waitcnt lgkmcnt(2)
    buffer_store_dwordx2 v[244:245], v56, s[12:15], s24 offen offset:512 sc0 sc1
    v_accvgpr_read_b32 v250, a30
    v_accvgpr_read_b32 v251, a42
    v_mul_f32 v248, v248, v50
    v_mfma_f32_16x16x32_bf16 v[104:107], v[32:35], a[240:243], v[136:139]
    ds_read_b128 v[24:27], v2 offset:18560
    v_mul_f32 v249, v249, v50
    v_mfma_f32_16x16x32_bf16 v[104:107], v[36:39], a[244:247], v[104:107]
    v_mul_f32 v250, v250, v50
    v_mul_f32 v251, v251, v50
    v_cvt_pk_bf16_f32 v248, v248, v249
    v_exp_f32 v16, v160
    v_mfma_f32_16x16x32_bf16 v[108:111], v[32:35], v[200:203], v[140:143]
    ds_read_b128 v[28:31], v3 offset:18560
    v_cvt_pk_bf16_f32 v249, v250, v251
    v_mfma_f32_16x16x32_bf16 v[108:111], v[36:39], v[204:207], v[108:111]
    s_waitcnt lgkmcnt(2)
    buffer_store_dwordx2 v[248:249], v56, s[12:15], s24 offen offset:896 sc0 sc1
    v_accvgpr_read_b32 v252, a7
    v_exp_f32 v17, v161
    v_mfma_f32_16x16x32_bf16 v[168:171], v[40:43], a[248:251], v[168:171]
    ds_read_b128 v[32:35], v2 offset:12544
    v_accvgpr_read_b32 v253, a19
    v_mfma_f32_16x16x32_bf16 v[168:171], v[44:47], a[252:255], v[168:171]
    v_exp_f32 v18, v162
    v_accvgpr_read_b32 v254, a31
    v_accvgpr_read_b32 v255, a43
    v_mul_f32 v252, v252, v51
    v_add_f32 v7, v7, v16
    v_mfma_f32_16x16x32_bf16 v[172:175], v[40:43], v[208:211], v[172:175]
    ds_read_b128 v[36:39], v3 offset:12544
    v_mul_f32 v253, v253, v51
    v_mfma_f32_16x16x32_bf16 v[172:175], v[44:47], v[212:215], v[172:175]
    s_waitcnt lgkmcnt(2)
    v_add_f32 v7, v7, v17
    v_mul_f32 v254, v254, v51
    v_exp_f32 v19, v163
    v_mul_f32 v255, v255, v51
    v_cvt_pk_bf16_f32 v252, v252, v253
    v_mfma_f32_16x16x32_bf16 v[104:107], v[24:27], a[248:251], v[104:107]
    ds_read_b128 v[40:43], v2 offset:18688
    v_cvt_pk_bf16_f32 v160, v16, v17
    v_mfma_f32_16x16x32_bf16 v[104:107], v[28:31], a[252:255], v[104:107]
    v_cvt_pk_bf16_f32 v253, v254, v255
    v_exp_f32 v16, v96
    v_accvgpr_read_b32 v224, a8
    v_accvgpr_read_b32 v225, a20
    v_accvgpr_read_b32 v226, a32
    v_mfma_f32_16x16x32_bf16 v[108:111], v[24:27], v[208:211], v[108:111]
    ds_read_b128 v[44:47], v3 offset:18688
    v_add_f32 v7, v7, v18
    v_mfma_f32_16x16x32_bf16 v[108:111], v[28:31], v[212:215], v[108:111]
    s_waitcnt lgkmcnt(2)
    buffer_store_dwordx2 v[252:253], v56, s[12:15], s24 offen offset:1280 sc0 sc1
    v_add_u32 v2, 49152, v2
    v_add_u32 v3, 49152, v3
    v_add_f32 v7, v7, v19
    v_mfma_f32_16x16x32_bf16 v[168:171], v[32:35], v[192:195], v[168:171]
    ds_read_b128 v[24:27], v2 offset:0
    v_accvgpr_read_b32 v227, a44
    v_mfma_f32_16x16x32_bf16 v[168:171], v[36:39], v[196:199], v[168:171]
    v_exp_f32 v17, v97
    v_mul_f32 v224, v224, v48
    v_mul_f32 v225, v225, v48
    v_cvt_pk_bf16_f32 v161, v18, v19
    v_mul_f32 v226, v226, v48
    v_mfma_f32_16x16x32_bf16 v[172:175], v[32:35], v[216:219], v[172:175]
    ds_read_b128 v[28:31], v3 offset:0
    v_mul_f32 v227, v227, v48
    v_mfma_f32_16x16x32_bf16 v[172:175], v[36:39], v[220:223], v[172:175]
    s_waitcnt lgkmcnt(2)
    v_exp_f32 v18, v98
    v_cvt_pk_bf16_f32 v224, v224, v225
    v_add_f32 v7, v7, v16
    v_cvt_pk_bf16_f32 v225, v226, v227
    v_accvgpr_read_b32 v228, a9
    v_mfma_f32_16x16x32_bf16 v[104:107], v[40:43], v[192:195], v[104:107]
    ds_read_b128 v[32:35], v2 offset:6144
    v_add_f32 v7, v7, v17
    v_mfma_f32_16x16x32_bf16 v[104:107], v[44:47], v[196:199], v[104:107]
    buffer_store_dwordx2 v[224:225], v56, s[12:15], s24 offen offset:256 sc0 sc1
    v_exp_f32 v19, v99
    v_accvgpr_read_b32 v229, a21
    v_mfma_f32_16x16x32_bf16 v[108:111], v[40:43], v[216:219], v[108:111]
    ds_read_b128 v[36:39], v3 offset:6144
    v_accvgpr_read_b32 v230, a33
    v_mfma_f32_16x16x32_bf16 v[108:111], v[44:47], v[220:223], v[108:111]
    s_waitcnt lgkmcnt(2)
    v_cvt_pk_bf16_f32 v162, v16, v17
    v_accvgpr_read_b32 v231, a45
    v_exp_f32 v16, v164
    v_mul_f32 v228, v228, v49
    v_mul_f32 v229, v229, v49
    v_mfma_f32_16x16x32_bf16 v[176:179], v[24:27], a[240:243], v[136:139]
    ds_read_b128 v[40:43], v2 offset:128
    v_mul_f32 v230, v230, v49
    v_mfma_f32_16x16x32_bf16 v[176:179], v[28:31], a[244:247], v[176:179]
    v_add_f32 v7, v7, v18
    v_add_f32 v7, v7, v19
    v_mul_f32 v231, v231, v49
    v_cvt_pk_bf16_f32 v228, v228, v229
    v_exp_f32 v17, v165
    v_mfma_f32_16x16x32_bf16 v[180:183], v[24:27], v[200:203], v[140:143]
    ds_read_b128 v[44:47], v3 offset:128
    v_cvt_pk_bf16_f32 v229, v230, v231
    v_mfma_f32_16x16x32_bf16 v[180:183], v[28:31], v[204:207], v[180:183]
    s_waitcnt lgkmcnt(2)
    buffer_store_dwordx2 v[228:229], v56, s[12:15], s24 offen offset:640 sc0 sc1
    v_cvt_pk_bf16_f32 v163, v18, v19
    v_accvgpr_read_b32 v232, a10
    v_accvgpr_read_b32 v233, a22
    v_mfma_f32_16x16x32_bf16 v[112:115], v[32:35], a[240:243], v[136:139]
    ds_read_b128 v[24:27], v2 offset:6272
    v_accvgpr_read_b32 v234, a34
    v_mfma_f32_16x16x32_bf16 v[112:115], v[36:39], a[244:247], v[112:115]
    v_exp_f32 v18, v166
    v_accvgpr_read_b32 v235, a46
    v_add_f32 v8, v8, v16
    v_mul_f32 v232, v232, v50
    v_mfma_f32_16x16x32_bf16 v[116:119], v[32:35], v[200:203], v[140:143]
    ds_read_b128 v[28:31], v3 offset:6272
    v_add_f32 v8, v8, v17
    v_mfma_f32_16x16x32_bf16 v[116:119], v[36:39], v[204:207], v[116:119]
    s_waitcnt lgkmcnt(2)
    v_exp_f32 v19, v167
    v_mul_f32 v233, v233, v50
    v_mul_f32 v234, v234, v50
    v_mul_f32 v235, v235, v50
    v_cvt_pk_bf16_f32 v232, v232, v233
    v_mfma_f32_16x16x32_bf16 v[176:179], v[40:43], a[248:251], v[176:179]
    ds_read_b128 v[32:35], v2 offset:256
    v_cvt_pk_bf16_f32 v164, v16, v17
    v_mfma_f32_16x16x32_bf16 v[176:179], v[44:47], a[252:255], v[176:179]
    v_exp_f32 v16, v100
    v_cvt_pk_bf16_f32 v233, v234, v235
    v_accvgpr_read_b32 v236, a11
    v_accvgpr_read_b32 v237, a23
    v_add_f32 v8, v8, v18
    v_mfma_f32_16x16x32_bf16 v[180:183], v[40:43], v[208:211], v[180:183]
    ds_read_b128 v[36:39], v3 offset:256
    v_accvgpr_read_b32 v238, a35
    v_mfma_f32_16x16x32_bf16 v[180:183], v[44:47], v[212:215], v[180:183]
    s_waitcnt lgkmcnt(2)
    buffer_store_dwordx2 v[232:233], v56, s[12:15], s24 offen offset:1024 sc0 sc1
    v_add_f32 v8, v8, v19
    v_exp_f32 v17, v101
    v_mfma_f32_16x16x32_bf16 v[112:115], v[24:27], a[248:251], v[112:115]
    ds_read_b128 v[40:43], v2 offset:6400
    v_accvgpr_read_b32 v239, a47
    v_mfma_f32_16x16x32_bf16 v[112:115], v[28:31], a[252:255], v[112:115]
    v_mul_f32 v236, v236, v51
    v_cvt_pk_bf16_f32 v165, v18, v19
    v_mul_f32 v237, v237, v51
    v_mul_f32 v238, v238, v51
    v_exp_f32 v18, v102
    v_mfma_f32_16x16x32_bf16 v[116:119], v[24:27], v[208:211], v[116:119]
    ds_read_b128 v[44:47], v3 offset:6400
    v_mul_f32 v239, v239, v51
    v_mfma_f32_16x16x32_bf16 v[116:119], v[28:31], v[212:215], v[116:119]
    s_waitcnt lgkmcnt(2)
    v_add_f32 v8, v8, v16
    v_cvt_pk_bf16_f32 v236, v236, v237
    v_cvt_pk_bf16_f32 v237, v238, v239
    v_add_f32 v8, v8, v17
    v_accvgpr_read_b32 v240, a48
    v_accvgpr_read_b32 v241, a60
    v_mfma_f32_16x16x32_bf16 v[176:179], v[32:35], v[192:195], v[176:179]
    ds_read_b128 v[24:27], v2 offset:12288
    v_accvgpr_read_b32 v242, a72
    v_mfma_f32_16x16x32_bf16 v[176:179], v[36:39], v[196:199], v[176:179]
    buffer_store_dwordx2 v[236:237], v56, s[12:15], s24 offen offset:1408 sc0 sc1
    v_exp_f32 v19, v103
    v_cvt_pk_bf16_f32 v166, v16, v17
    v_mfma_f32_16x16x32_bf16 v[180:183], v[32:35], v[216:219], v[180:183]
    ds_read_b128 v[28:31], v3 offset:12288
    v_accvgpr_read_b32 v243, a84
    v_mfma_f32_16x16x32_bf16 v[180:183], v[36:39], v[220:223], v[180:183]
    s_waitcnt lgkmcnt(2)
    v_add_f32 v8, v8, v18
    v_add_f32 v8, v8, v19
    v_mul_f32 v240, v240, v52
    v_mul_f32 v241, v241, v52
    v_cvt_pk_bf16_f32 v167, v18, v19
    v_mul_f32 v242, v242, v52
    v_mfma_f32_16x16x32_bf16 v[112:115], v[40:43], v[192:195], v[112:115]
    ds_read_b128 v[32:35], v2 offset:18432
    v_mul_f32 v243, v243, v52
    v_mfma_f32_16x16x32_bf16 v[112:115], v[44:47], v[196:199], v[112:115]
    v_exp_f32 v16, v168
    v_cvt_pk_bf16_f32 v240, v240, v241
    v_cvt_pk_bf16_f32 v241, v242, v243
    v_exp_f32 v17, v169
    v_mfma_f32_16x16x32_bf16 v[116:119], v[40:43], v[216:219], v[116:119]
    ds_read_b128 v[36:39], v3 offset:18432
    v_accvgpr_read_b32 v244, a49
    v_mfma_f32_16x16x32_bf16 v[116:119], v[44:47], v[220:223], v[116:119]
    s_waitcnt lgkmcnt(2)
    buffer_store_dwordx2 v[240:241], v56, s[12:15], s40 offen offset:0 sc0 sc1
    v_exp_f32 v18, v170
    v_accvgpr_read_b32 v245, a61
    v_mfma_f32_16x16x32_bf16 v[184:187], v[24:27], a[240:243], v[136:139]
    ds_read_b128 v[40:43], v2 offset:12416
    v_accvgpr_read_b32 v246, a73
    v_mfma_f32_16x16x32_bf16 v[184:187], v[28:31], a[244:247], v[184:187]
    v_add_f32 v7, v7, v16
    v_accvgpr_read_b32 v247, a85
    v_mul_f32 v244, v244, v53
    v_add_f32 v7, v7, v17
    v_mul_f32 v245, v245, v53
    v_mul_f32 v246, v246, v53
    v_mfma_f32_16x16x32_bf16 v[188:191], v[24:27], v[200:203], v[140:143]
    ds_read_b128 v[44:47], v3 offset:12416
    v_mul_f32 v247, v247, v53
    v_mfma_f32_16x16x32_bf16 v[188:191], v[28:31], v[204:207], v[188:191]
    s_waitcnt lgkmcnt(2)
    v_exp_f32 v19, v171
    v_cvt_pk_bf16_f32 v168, v16, v17
    v_cvt_pk_bf16_f32 v244, v244, v245
    v_cvt_pk_bf16_f32 v245, v246, v247
    v_accvgpr_read_b32 v248, a50
    v_mfma_f32_16x16x32_bf16 v[120:123], v[32:35], a[240:243], v[136:139]
    ds_read_b128 v[24:27], v2 offset:18560
    v_accvgpr_read_b32 v249, a62
    v_mfma_f32_16x16x32_bf16 v[120:123], v[36:39], a[244:247], v[120:123]
    buffer_store_dwordx2 v[244:245], v56, s[12:15], s40 offen offset:384 sc0 sc1
    v_exp_f32 v16, v104
    v_mfma_f32_16x16x32_bf16 v[124:127], v[32:35], v[200:203], v[140:143]
    ds_read_b128 v[28:31], v3 offset:18560
    v_add_f32 v7, v7, v18
    v_mfma_f32_16x16x32_bf16 v[124:127], v[36:39], v[204:207], v[124:127]
    s_waitcnt lgkmcnt(2)
    v_add_f32 v7, v7, v19
    v_accvgpr_read_b32 v250, a74
    v_exp_f32 v17, v105
    v_accvgpr_read_b32 v251, a86
    v_mul_f32 v248, v248, v54
    v_mfma_f32_16x16x32_bf16 v[184:187], v[40:43], a[248:251], v[184:187]
    ds_read_b128 v[32:35], v2 offset:12544
    v_mul_f32 v249, v249, v54
    v_mfma_f32_16x16x32_bf16 v[184:187], v[44:47], a[252:255], v[184:187]
    v_cvt_pk_bf16_f32 v169, v18, v19
    v_exp_f32 v18, v106
    v_mul_f32 v250, v250, v54
    v_mul_f32 v251, v251, v54
    v_cvt_pk_bf16_f32 v248, v248, v249
    v_mfma_f32_16x16x32_bf16 v[188:191], v[40:43], v[208:211], v[188:191]
    ds_read_b128 v[36:39], v3 offset:12544
    v_add_f32 v7, v7, v16
    v_mfma_f32_16x16x32_bf16 v[188:191], v[44:47], v[212:215], v[188:191]
    s_waitcnt lgkmcnt(2)
    v_cvt_pk_bf16_f32 v249, v250, v251
    v_add_f32 v7, v7, v17
    v_accvgpr_read_b32 v252, a51
    v_accvgpr_read_b32 v253, a63
    v_exp_f32 v19, v107
    v_mfma_f32_16x16x32_bf16 v[120:123], v[24:27], a[248:251], v[120:123]
    ds_read_b128 v[40:43], v2 offset:18688
    v_accvgpr_read_b32 v254, a75
    v_mfma_f32_16x16x32_bf16 v[120:123], v[28:31], a[252:255], v[120:123]
    buffer_store_dwordx2 v[248:249], v56, s[12:15], s40 offen offset:768 sc0 sc1
    v_cvt_pk_bf16_f32 v170, v16, v17
    v_accvgpr_read_b32 v255, a87
    v_mul_f32 v252, v252, v55
    v_mfma_f32_16x16x32_bf16 v[124:127], v[24:27], v[208:211], v[124:127]
    ds_read_b128 v[44:47], v3 offset:18688
    v_mul_f32 v253, v253, v55
    v_mfma_f32_16x16x32_bf16 v[124:127], v[28:31], v[212:215], v[124:127]
    s_waitcnt lgkmcnt(2)
    v_add_u32 v22, 49152, v1
    v_mov_b32 v14, v1
    v_subrev_u32 v1, 49152, v1
    v_exp_f32 v16, v172
    v_mul_f32 v254, v254, v55
    v_mfma_f32_16x16x32_bf16 v[184:187], v[32:35], v[192:195], v[184:187]
    ds_read_b128 v[24:27], v22 offset:0
    v_add_f32 v7, v7, v18
    v_mfma_f32_16x16x32_bf16 v[184:187], v[36:39], v[196:199], v[184:187]
    v_add_f32 v7, v7, v19
    v_mul_f32 v255, v255, v55
    v_exp_f32 v17, v173
    v_cvt_pk_bf16_f32 v252, v252, v253
    v_cvt_pk_bf16_f32 v253, v254, v255
    v_mfma_f32_16x16x32_bf16 v[188:191], v[32:35], v[216:219], v[188:191]
    ds_read_b128 v[28:31], v22 offset:12288
    v_accvgpr_read_b32 v224, a52
    v_mfma_f32_16x16x32_bf16 v[188:191], v[36:39], v[220:223], v[188:191]
    s_waitcnt lgkmcnt(2)
    buffer_store_dwordx2 v[252:253], v56, s[12:15], s40 offen offset:1152 sc0 sc1
    v_cvt_pk_bf16_f32 v171, v18, v19
    v_accvgpr_read_b32 v225, a64
    v_accvgpr_read_b32 v226, a76
    v_mfma_f32_16x16x32_bf16 v[120:123], v[40:43], v[192:195], v[120:123]
    ds_read_b128 v[32:35], v22 offset:3072
    v_accvgpr_read_b32 v227, a88
    v_mfma_f32_16x16x32_bf16 v[120:123], v[44:47], v[196:199], v[120:123]
    v_exp_f32 v18, v174
    v_add_f32 v8, v8, v16
    v_mul_f32 v224, v224, v52
    v_mul_f32 v225, v225, v52
    v_add_f32 v8, v8, v17
    v_mfma_f32_16x16x32_bf16 v[124:127], v[40:43], v[216:219], v[124:127]
    ds_read_b128 v[36:39], v22 offset:15360
    v_mul_f32 v226, v226, v52
    v_mfma_f32_16x16x32_bf16 v[124:127], v[44:47], v[220:223], v[124:127]
    s_waitcnt lgkmcnt(2)
    v_exp_f32 v19, v175
    v_mul_f32 v227, v227, v52
    v_cvt_pk_bf16_f32 v224, v224, v225
    v_cvt_pk_bf16_f32 v225, v226, v227
    v_accvgpr_read_b32 v228, a53
    v_mfma_f32_16x16x32_bf16 a[96:99], v[80:83], v[24:27], a[96:99]
    ds_read_b128 v[40:43], v22 offset:6144
    v_cvt_pk_bf16_f32 v172, v16, v17
    v_mfma_f32_16x16x32_bf16 a[96:99], v[88:91], v[28:31], a[96:99]
    buffer_store_dwordx2 v[224:225], v56, s[12:15], s40 offen offset:128 sc0 sc1
    v_exp_f32 v16, v108
    v_accvgpr_read_b32 v229, a65
    v_mfma_f32_16x16x32_bf16 a[144:147], v[84:87], v[24:27], a[144:147]
    ds_read_b128 v[44:47], v22 offset:18432
    v_add_f32 v8, v8, v18
    v_mfma_f32_16x16x32_bf16 a[144:147], v[92:95], v[28:31], a[144:147]
    s_waitcnt lgkmcnt(2)
    v_add_f32 v8, v8, v19
    v_accvgpr_read_b32 v230, a77
    v_accvgpr_read_b32 v231, a89
    v_mul_f32 v228, v228, v53
    v_mul_f32 v229, v229, v53
    v_mul_f32 v230, v230, v53
    v_mfma_f32_16x16x32_bf16 a[108:111], v[80:83], v[32:35], a[108:111]
    ds_read_b128 v[24:27], v22 offset:9216
    v_mul_f32 v231, v231, v53
    v_mfma_f32_16x16x32_bf16 a[108:111], v[88:91], v[36:39], a[108:111]
    v_exp_f32 v17, v109
    v_cvt_pk_bf16_f32 v173, v18, v19
    v_cvt_pk_bf16_f32 v228, v228, v229
    v_cvt_pk_bf16_f32 v229, v230, v231
    v_accvgpr_read_b32 v232, a54
    v_mfma_f32_16x16x32_bf16 a[156:159], v[84:87], v[32:35], a[156:159]
    ds_read_b128 v[28:31], v22 offset:21504
    v_accvgpr_read_b32 v233, a66
    v_mfma_f32_16x16x32_bf16 a[156:159], v[92:95], v[36:39], a[156:159]
    s_waitcnt lgkmcnt(2)
    buffer_store_dwordx2 v[228:229], v56, s[12:15], s40 offen offset:512 sc0 sc1
    v_exp_f32 v18, v110
    v_mfma_f32_16x16x32_bf16 a[120:123], v[80:83], v[40:43], a[120:123]
    ds_read_b128 v[32:35], v1 offset:0
    v_add_f32 v8, v8, v16
    v_mfma_f32_16x16x32_bf16 a[120:123], v[88:91], v[44:47], a[120:123]
    v_add_f32 v8, v8, v17
    v_accvgpr_read_b32 v234, a78
    v_exp_f32 v19, v111
    v_accvgpr_read_b32 v235, a90
    v_mul_f32 v232, v232, v54
    v_mfma_f32_16x16x32_bf16 a[168:171], v[84:87], v[40:43], a[168:171]
    ds_read_b128 v[36:39], v1 offset:12288
    v_mul_f32 v233, v233, v54
    v_mfma_f32_16x16x32_bf16 a[168:171], v[92:95], v[44:47], a[168:171]
    s_waitcnt lgkmcnt(2)
    v_cvt_pk_bf16_f32 v174, v16, v17
    v_mul_f32 v234, v234, v54
    v_mul_f32 v235, v235, v54
    v_cvt_pk_bf16_f32 v232, v232, v233
    v_cvt_pk_bf16_f32 v233, v234, v235
    v_accvgpr_read_b32 v236, a55
    v_mfma_f32_16x16x32_bf16 a[132:135], v[80:83], v[24:27], a[132:135]
    ds_read_b128 v[40:43], v1 offset:3072
    v_add_f32 v8, v8, v18
    v_mfma_f32_16x16x32_bf16 a[132:135], v[88:91], v[28:31], a[132:135]
    buffer_store_dwordx2 v[232:233], v56, s[12:15], s40 offen offset:896 sc0 sc1
    v_add_f32 v8, v8, v19
    v_cvt_pk_bf16_f32 v175, v18, v19
    v_accvgpr_read_b32 v237, a67
    v_mfma_f32_16x16x32_bf16 a[180:183], v[84:87], v[24:27], a[180:183]
    ds_read_b128 v[44:47], v1 offset:15360
    v_accvgpr_read_b32 v238, a79
    v_mfma_f32_16x16x32_bf16 a[180:183], v[92:95], v[28:31], a[180:183]
    s_waitcnt lgkmcnt(2)
    v_exp_f32 v16, v176
    v_exp_f32 v17, v177
    v_exp_f32 v18, v178
    v_mfma_f32_16x16x32_bf16 a[96:99], v[160:163], v[32:35], a[96:99]
    ds_read_b128 v[24:27], v1 offset:6144
    v_add_f32 v7, v7, v16
    v_mfma_f32_16x16x32_bf16 a[96:99], v[168:171], v[36:39], a[96:99]
    v_add_f32 v7, v7, v17
    v_exp_f32 v19, v179
    v_cvt_pk_bf16_f32 v176, v16, v17
    v_exp_f32 v16, v112
    v_mfma_f32_16x16x32_bf16 a[144:147], v[164:167], v[32:35], a[144:147]
    ds_read_b128 v[28:31], v1 offset:18432
    v_add_f32 v7, v7, v18
    v_mfma_f32_16x16x32_bf16 a[144:147], v[172:175], v[36:39], a[144:147]
    s_waitcnt lgkmcnt(2)
    v_add_f32 v7, v7, v19
    v_exp_f32 v17, v113
    v_cvt_pk_bf16_f32 v177, v18, v19
    v_exp_f32 v18, v114
    v_mfma_f32_16x16x32_bf16 a[108:111], v[160:163], v[40:43], a[108:111]
    ds_read_b128 v[32:35], v1 offset:9216
    v_add_f32 v7, v7, v16
    v_mfma_f32_16x16x32_bf16 a[108:111], v[168:171], v[44:47], a[108:111]
    v_add_f32 v7, v7, v17
    v_exp_f32 v19, v115
    v_cvt_pk_bf16_f32 v178, v16, v17
    v_exp_f32 v16, v180
    v_mfma_f32_16x16x32_bf16 a[156:159], v[164:167], v[40:43], a[156:159]
    ds_read_b128 v[36:39], v1 offset:21504
    v_add_f32 v7, v7, v18
    v_mfma_f32_16x16x32_bf16 a[156:159], v[172:175], v[44:47], a[156:159]
    s_waitcnt lgkmcnt(2)
    v_add_f32 v7, v7, v19
    v_exp_f32 v17, v181
    v_cvt_pk_bf16_f32 v179, v18, v19
    v_exp_f32 v18, v182
    v_mfma_f32_16x16x32_bf16 a[120:123], v[160:163], v[24:27], a[120:123]
    ds_read_b128 v[40:43], v14 offset:0
    v_add_f32 v8, v8, v16
    v_mfma_f32_16x16x32_bf16 a[120:123], v[168:171], v[28:31], a[120:123]
    v_add_f32 v8, v8, v17
    v_exp_f32 v19, v183
    v_cvt_pk_bf16_f32 v180, v16, v17
    v_exp_f32 v16, v116
    v_mfma_f32_16x16x32_bf16 a[168:171], v[164:167], v[24:27], a[168:171]
    ds_read_b128 v[44:47], v14 offset:12288
    v_add_f32 v8, v8, v18
    v_mfma_f32_16x16x32_bf16 a[168:171], v[172:175], v[28:31], a[168:171]
    s_waitcnt lgkmcnt(2)
    v_add_f32 v8, v8, v19
    v_exp_f32 v17, v117
    v_cvt_pk_bf16_f32 v181, v18, v19
    v_exp_f32 v18, v118
    v_mfma_f32_16x16x32_bf16 a[132:135], v[160:163], v[32:35], a[132:135]
    ds_read_b128 v[24:27], v14 offset:3072
    v_add_f32 v8, v8, v16
    v_mfma_f32_16x16x32_bf16 a[132:135], v[168:171], v[36:39], a[132:135]
    v_add_f32 v8, v8, v17
    v_exp_f32 v19, v119
    v_cvt_pk_bf16_f32 v182, v16, v17
    v_add_f32 v8, v8, v18
    v_add_f32 v8, v8, v19
    v_cvt_pk_bf16_f32 v183, v18, v19
    v_exp_f32 v16, v184
    v_exp_f32 v17, v185
    v_exp_f32 v18, v186
    v_add_f32 v7, v7, v16
    v_add_f32 v7, v7, v17
    v_exp_f32 v19, v187
    v_cvt_pk_bf16_f32 v184, v16, v17
    v_exp_f32 v16, v120
    v_add_f32 v7, v7, v18
    v_add_f32 v7, v7, v19
    v_exp_f32 v17, v121
    v_cvt_pk_bf16_f32 v185, v18, v19
    v_exp_f32 v18, v122
    v_add_f32 v7, v7, v16
    v_add_f32 v7, v7, v17
    v_exp_f32 v19, v123
    v_cvt_pk_bf16_f32 v186, v16, v17
    v_exp_f32 v16, v188
    v_add_f32 v7, v7, v18
    v_add_f32 v7, v7, v19
    v_exp_f32 v17, v189
    v_cvt_pk_bf16_f32 v187, v18, v19
    v_exp_f32 v18, v190
    v_add_f32 v8, v8, v16
    v_add_f32 v8, v8, v17
    v_exp_f32 v19, v191
    v_cvt_pk_bf16_f32 v188, v16, v17
    v_exp_f32 v16, v124
    v_add_f32 v8, v8, v18
    v_add_f32 v8, v8, v19
    v_exp_f32 v17, v125
    v_cvt_pk_bf16_f32 v189, v18, v19
    v_exp_f32 v18, v126
    v_add_f32 v8, v8, v16
    v_add_f32 v8, v8, v17
    v_exp_f32 v19, v127
    v_cvt_pk_bf16_f32 v190, v16, v17
    v_add_f32 v8, v8, v18
    v_add_f32 v8, v8, v19
    v_cvt_pk_bf16_f32 v191, v18, v19
    v_mfma_f32_16x16x32_bf16 a[180:183], v[164:167], v[32:35], a[180:183]
    ds_read_b128 v[28:31], v14 offset:15360
    v_accvgpr_read_b32 v239, a91
    v_mfma_f32_16x16x32_bf16 a[180:183], v[172:175], v[36:39], a[180:183]
    s_waitcnt lgkmcnt(2)
    v_mul_f32 v236, v236, v55
    v_mul_f32 v237, v237, v55
    v_mul_f32 v238, v238, v55
    v_mul_f32 v239, v239, v55
    v_cvt_pk_bf16_f32 v236, v236, v237
    v_cvt_pk_bf16_f32 v237, v238, v239
    v_mfma_f32_16x16x4_f32 v[128:131], v7, v57, 0
    v_mfma_f32_16x16x32_bf16 a[96:99], v[176:179], v[40:43], a[96:99]
    ds_read_b128 v[32:35], v14 offset:6144
    v_accvgpr_read_b32 v240, a56
    v_mfma_f32_16x16x32_bf16 a[96:99], v[184:187], v[44:47], a[96:99]
    buffer_store_dwordx2 v[236:237], v56, s[12:15], s40 offen offset:1280 sc0 sc1
    v_accvgpr_read_b32 v241, a68
    v_accvgpr_read_b32 v242, a80
    v_accvgpr_read_b32 v243, a92
    v_mfma_f32_16x16x4_f32 v[132:135], v8, v57, 0
    v_mfma_f32_16x16x32_bf16 a[144:147], v[180:183], v[40:43], a[144:147]
    ds_read_b128 v[36:39], v14 offset:18432
    v_mul_f32 v240, v240, v52
    v_mfma_f32_16x16x32_bf16 a[144:147], v[188:191], v[44:47], a[144:147]
    s_waitcnt lgkmcnt(2)
    v_max3_f32 v18, v5, v6, v7
    v_mul_f32 v241, v241, v52
    v_max_f32 v18, v18, v8
    v_mul_f32 v242, v242, v52
    s_mov_b32 s29, 0x5f800000
    v_mfma_f32_16x16x32_bf16 a[108:111], v[176:179], v[24:27], a[108:111]
    ds_read_b128 v[40:43], v14 offset:9216
    v_mul_f32 v243, v243, v52
    v_mfma_f32_16x16x32_bf16 a[108:111], v[184:187], v[28:31], a[108:111]
    v_cmp_lt_f32 s[48:49], s29, v18
    v_cvt_pk_bf16_f32 v240, v240, v241
    v_cvt_pk_bf16_f32 v241, v242, v243
    v_accvgpr_read_b32 v244, a57
    v_accvgpr_read_b32 v245, a69
    v_accvgpr_read_b32 v246, a81
    v_mfma_f32_16x16x32_bf16 a[156:159], v[180:183], v[24:27], a[156:159]
    ds_read_b128 v[44:47], v14 offset:21504
    v_accvgpr_read_b32 v247, a93
    v_mfma_f32_16x16x32_bf16 a[156:159], v[188:191], v[28:31], a[156:159]
    s_waitcnt lgkmcnt(2)
    buffer_store_dwordx2 v[240:241], v56, s[12:15], s40 offen offset:256 sc0 sc1
    v_rcp_f32 v128, v128
    v_mul_f32 v244, v244, v53
    v_mfma_f32_16x16x32_bf16 a[120:123], v[176:179], v[32:35], a[120:123]
    ds_read_b128 v[24:27], v22 offset:1024
    v_mul_f32 v245, v245, v53
    v_mfma_f32_16x16x32_bf16 a[120:123], v[184:187], v[36:39], a[120:123]
    v_rcp_f32 v129, v129
    v_rcp_f32 v130, v130
    v_rcp_f32 v131, v131
    v_mfma_f32_16x16x32_bf16 a[168:171], v[180:183], v[32:35], a[168:171]
    ds_read_b128 v[28:31], v22 offset:13312
    v_mul_f32 v246, v246, v53
    v_mfma_f32_16x16x32_bf16 a[168:171], v[188:191], v[36:39], a[168:171]
    s_waitcnt lgkmcnt(2)
    v_rcp_f32 v132, v132
    v_mul_f32 v247, v247, v53
    v_cvt_pk_bf16_f32 v244, v244, v245
    v_rcp_f32 v133, v133
    v_mfma_f32_16x16x32_bf16 a[132:135], v[176:179], v[40:43], a[132:135]
    ds_read_b128 v[32:35], v22 offset:4096
    v_cvt_pk_bf16_f32 v245, v246, v247
    v_mfma_f32_16x16x32_bf16 a[132:135], v[184:187], v[44:47], a[132:135]
    buffer_store_dwordx2 v[244:245], v56, s[12:15], s40 offen offset:640 sc0 sc1
    v_rcp_f32 v134, v134
    v_accvgpr_read_b32 v248, a58
    v_mfma_f32_16x16x32_bf16 a[180:183], v[180:183], v[40:43], a[180:183]
    ds_read_b128 v[36:39], v22 offset:16384
    v_rcp_f32 v135, v135
    v_mfma_f32_16x16x32_bf16 a[180:183], v[188:191], v[44:47], a[180:183]
    s_waitcnt lgkmcnt(2)
    v_accvgpr_read_b32 v249, a70
    v_accvgpr_read_b32 v250, a82
    v_accvgpr_read_b32 v251, a94
    v_mul_f32 v248, v248, v54
    v_mul_f32 v249, v249, v54
    v_mfma_f32_16x16x32_bf16 a[100:103], v[80:83], v[24:27], a[100:103]
    ds_read_b128 v[40:43], v22 offset:7168
    v_mul_f32 v250, v250, v54
    v_mfma_f32_16x16x32_bf16 a[100:103], v[88:91], v[28:31], a[100:103]
    v_mul_f32 v251, v251, v54
    v_cvt_pk_bf16_f32 v248, v248, v249
    v_cvt_pk_bf16_f32 v249, v250, v251
    v_accvgpr_read_b32 v252, a59
    v_accvgpr_read_b32 v253, a71
    v_accvgpr_read_b32 v254, a83
    v_mfma_f32_16x16x32_bf16 a[148:151], v[84:87], v[24:27], a[148:151]
    ds_read_b128 v[44:47], v22 offset:19456
    v_accvgpr_read_b32 v255, a95
    v_mfma_f32_16x16x32_bf16 a[148:151], v[92:95], v[28:31], a[148:151]
    s_waitcnt lgkmcnt(2)
    s_cmp_lg_u64 s[48:49], 0
    s_cbranch_scc1 L_slow
    v_mul_f32 v252, v252, v55
    v_mul_f32 v253, v253, v55
    v_mfma_f32_16x16x32_bf16 a[112:115], v[80:83], v[32:35], a[112:115]
    ds_read_b128 v[24:27], v22 offset:10240
    v_mul_f32 v254, v254, v55
    v_mfma_f32_16x16x32_bf16 a[112:115], v[88:91], v[36:39], a[112:115]
    buffer_store_dwordx2 v[248:249], v56, s[12:15], s40 offen offset:1024 sc0 sc1
    v_mul_f32 v255, v255, v55
    v_cvt_pk_bf16_f32 v252, v252, v253
    v_cvt_pk_bf16_f32 v253, v254, v255
    v_mfma_f32_16x16x32_bf16 a[160:163], v[84:87], v[32:35], a[160:163]
    ds_read_b128 v[28:31], v22 offset:22528
    v_accvgpr_read_b32 v224, a96
    v_mfma_f32_16x16x32_bf16 a[160:163], v[92:95], v[36:39], a[160:163]
    s_waitcnt lgkmcnt(2)
    buffer_store_dwordx2 v[252:253], v56, s[12:15], s40 offen offset:1408 sc0 sc1
    v_accvgpr_read_b32 v225, a108
    v_accvgpr_read_b32 v226, a120
    v_accvgpr_read_b32 v227, a132
    v_mfma_f32_16x16x32_bf16 a[124:127], v[80:83], v[40:43], a[124:127]
    ds_read_b128 v[32:35], v1 offset:1024
    v_mul_f32 v224, v224, v128
    v_mfma_f32_16x16x32_bf16 a[124:127], v[88:91], v[44:47], a[124:127]
    v_mul_f32 v225, v225, v128
    v_mul_f32 v226, v226, v128
    v_mul_f32 v227, v227, v128
    v_cvt_pk_bf16_f32 v224, v224, v225
    v_cvt_pk_bf16_f32 v225, v226, v227
    v_accvgpr_read_b32 v228, a97
    v_mfma_f32_16x16x32_bf16 a[172:175], v[84:87], v[40:43], a[172:175]
    ds_read_b128 v[36:39], v1 offset:13312
    v_accvgpr_read_b32 v229, a109
    v_mfma_f32_16x16x32_bf16 a[172:175], v[92:95], v[44:47], a[172:175]
    s_waitcnt lgkmcnt(2)
    buffer_store_dwordx2 v[224:225], v56, s[12:15], s41 offen offset:0 sc0 sc1
    v_accvgpr_read_b32 v230, a121
    v_accvgpr_read_b32 v231, a133
    v_mul_f32 v228, v228, v129
    v_mfma_f32_16x16x32_bf16 a[136:139], v[80:83], v[24:27], a[136:139]
    ds_read_b128 v[40:43], v1 offset:4096
    v_mul_f32 v229, v229, v129
    v_mfma_f32_16x16x32_bf16 a[136:139], v[88:91], v[28:31], a[136:139]
    v_mul_f32 v230, v230, v129
    v_mul_f32 v231, v231, v129
    v_cvt_pk_bf16_f32 v228, v228, v229
    v_cvt_pk_bf16_f32 v229, v230, v231
    v_accvgpr_read_b32 v232, a98
    v_accvgpr_read_b32 v233, a110
    v_mfma_f32_16x16x32_bf16 a[184:187], v[84:87], v[24:27], a[184:187]
    ds_read_b128 v[44:47], v1 offset:16384
    v_accvgpr_read_b32 v234, a122
    v_mfma_f32_16x16x32_bf16 a[184:187], v[92:95], v[28:31], a[184:187]
    s_waitcnt lgkmcnt(2)
    buffer_store_dwordx2 v[228:229], v56, s[12:15], s41 offen offset:384 sc0 sc1
    v_accvgpr_read_b32 v235, a134
    v_mul_f32 v232, v232, v130
    v_mul_f32 v233, v233, v130
    v_mfma_f32_16x16x32_bf16 a[100:103], v[160:163], v[32:35], a[100:103]
    ds_read_b128 v[24:27], v1 offset:7168
    v_mul_f32 v234, v234, v130
    v_mfma_f32_16x16x32_bf16 a[100:103], v[168:171], v[36:39], a[100:103]
    v_mul_f32 v235, v235, v130
    v_cvt_pk_bf16_f32 v232, v232, v233
    v_cvt_pk_bf16_f32 v233, v234, v235
    v_accvgpr_read_b32 v236, a99
    v_accvgpr_read_b32 v237, a111
    v_accvgpr_read_b32 v238, a123
    v_mfma_f32_16x16x32_bf16 a[148:151], v[164:167], v[32:35], a[148:151]
    ds_read_b128 v[28:31], v1 offset:19456
    v_accvgpr_read_b32 v239, a135
    v_mfma_f32_16x16x32_bf16 a[148:151], v[172:175], v[36:39], a[148:151]
    s_waitcnt lgkmcnt(2)
    buffer_store_dwordx2 v[232:233], v56, s[12:15], s41 offen offset:768 sc0 sc1
    v_mul_f32 v236, v236, v131
    v_mul_f32 v237, v237, v131
    v_mul_f32 v238, v238, v131
    v_mfma_f32_16x16x32_bf16 a[112:115], v[160:163], v[40:43], a[112:115]
    ds_read_b128 v[32:35], v1 offset:10240
    v_mul_f32 v239, v239, v131
    v_mfma_f32_16x16x32_bf16 a[112:115], v[168:171], v[44:47], a[112:115]
    v_cvt_pk_bf16_f32 v236, v236, v237
    v_cvt_pk_bf16_f32 v237, v238, v239
    v_accvgpr_read_b32 v240, a144
    v_accvgpr_read_b32 v241, a156
    v_accvgpr_read_b32 v242, a168
    v_accvgpr_read_b32 v243, a180
    v_mfma_f32_16x16x32_bf16 a[160:163], v[164:167], v[40:43], a[160:163]
    ds_read_b128 v[36:39], v1 offset:22528
    v_mul_f32 v240, v240, v132
    v_mfma_f32_16x16x32_bf16 a[160:163], v[172:175], v[44:47], a[160:163]
    s_waitcnt lgkmcnt(2)
    buffer_store_dwordx2 v[236:237], v56, s[12:15], s41 offen offset:1152 sc0 sc1
    v_mul_f32 v241, v241, v132
    v_mul_f32 v242, v242, v132
    v_mul_f32 v243, v243, v132
    v_mfma_f32_16x16x32_bf16 a[124:127], v[160:163], v[24:27], a[124:127]
    ds_read_b128 v[40:43], v14 offset:1024
    v_cvt_pk_bf16_f32 v240, v240, v241
    v_mfma_f32_16x16x32_bf16 a[124:127], v[168:171], v[28:31], a[124:127]
    v_cvt_pk_bf16_f32 v241, v242, v243
    v_accvgpr_read_b32 v244, a145
    v_accvgpr_read_b32 v245, a157
    v_accvgpr_read_b32 v246, a169
    v_accvgpr_read_b32 v247, a181
    v_mfma_f32_16x16x32_bf16 a[172:175], v[164:167], v[24:27], a[172:175]
    ds_read_b128 v[44:47], v14 offset:13312
    v_mul_f32 v244, v244, v133
    v_mfma_f32_16x16x32_bf16 a[172:175], v[172:175], v[28:31], a[172:175]
    s_waitcnt lgkmcnt(2)
    buffer_store_dwordx2 v[240:241], v56, s[12:15], s42 offen offset:0 sc0 sc1
    v_mul_f32 v245, v245, v133
    v_mul_f32 v246, v246, v133
    v_mul_f32 v247, v247, v133
    v_mfma_f32_16x16x32_bf16 a[136:139], v[160:163], v[32:35], a[136:139]
    ds_read_b128 v[24:27], v14 offset:4096
    v_cvt_pk_bf16_f32 v244, v244, v245
    v_mfma_f32_16x16x32_bf16 a[136:139], v[168:171], v[36:39], a[136:139]
    v_cvt_pk_bf16_f32 v245, v246, v247
    v_accvgpr_read_b32 v248, a146
    v_accvgpr_read_b32 v249, a158
    v_accvgpr_read_b32 v250, a170
    v_accvgpr_read_b32 v251, a182
    v_mul_f32 v248, v248, v134
    v_mfma_f32_16x16x32_bf16 a[184:187], v[164:167], v[32:35], a[184:187]
    ds_read_b128 v[28:31], v14 offset:16384
    v_mul_f32 v249, v249, v134
    v_mfma_f32_16x16x32_bf16 a[184:187], v[172:175], v[36:39], a[184:187]
    s_waitcnt lgkmcnt(2)
    buffer_store_dwordx2 v[244:245], v56, s[12:15], s42 offen offset:384 sc0 sc1
    v_mul_f32 v250, v250, v134
    v_mul_f32 v251, v251, v134
    v_cvt_pk_bf16_f32 v248, v248, v249
    v_mfma_f32_16x16x32_bf16 a[100:103], v[176:179], v[40:43], a[100:103]
    ds_read_b128 v[32:35], v14 offset:7168
    v_cvt_pk_bf16_f32 v249, v250, v251
    v_mfma_f32_16x16x32_bf16 a[100:103], v[184:187], v[44:47], a[100:103]
    buffer_store_dwordx2 v[248:249], v56, s[12:15], s42 offen offset:768 sc0 sc1
    v_accvgpr_read_b32 v252, a147
    v_accvgpr_read_b32 v253, a159
    v_accvgpr_read_b32 v254, a171
    v_mfma_f32_16x16x32_bf16 a[148:151], v[180:183], v[40:43], a[148:151]
    ds_read_b128 v[36:39], v14 offset:19456
    v_accvgpr_read_b32 v255, a183
    v_mfma_f32_16x16x32_bf16 a[148:151], v[188:191], v[44:47], a[148:151]
    s_waitcnt lgkmcnt(2)
    v_mul_f32 v252, v252, v135
    v_mul_f32 v253, v253, v135
    v_mul_f32 v254, v254, v135
    v_mul_f32 v255, v255, v135
    v_cvt_pk_bf16_f32 v252, v252, v253
    v_cvt_pk_bf16_f32 v253, v254, v255
    v_mfma_f32_16x16x32_bf16 a[112:115], v[176:179], v[24:27], a[112:115]
    ds_read_b128 v[40:43], v14 offset:10240
    v_mfma_f32_16x16x32_bf16 a[112:115], v[184:187], v[28:31], a[112:115]
    buffer_store_dwordx2 v[252:253], v56, s[12:15], s42 offen offset:1152 sc0 sc1
    v_mfma_f32_16x16x32_bf16 a[160:163], v[180:183], v[24:27], a[160:163]
    ds_read_b128 v[44:47], v14 offset:22528
    v_mfma_f32_16x16x32_bf16 a[160:163], v[188:191], v[28:31], a[160:163]
    s_waitcnt lgkmcnt(2)
    v_mfma_f32_16x16x32_bf16 a[124:127], v[176:179], v[32:35], a[124:127]
    ds_read_b128 v[24:27], v22 offset:2048
    v_mfma_f32_16x16x32_bf16 a[124:127], v[184:187], v[36:39], a[124:127]
    v_mfma_f32_16x16x32_bf16 a[172:175], v[180:183], v[32:35], a[172:175]
    ds_read_b128 v[28:31], v22 offset:14336
    v_mfma_f32_16x16x32_bf16 a[172:175], v[188:191], v[36:39], a[172:175]
    s_waitcnt lgkmcnt(2)
    v_mfma_f32_16x16x32_bf16 a[136:139], v[176:179], v[40:43], a[136:139]
    ds_read_b128 v[32:35], v22 offset:5120
    v_mfma_f32_16x16x32_bf16 a[136:139], v[184:187], v[44:47], a[136:139]
    v_mfma_f32_16x16x32_bf16 a[184:187], v[180:183], v[40:43], a[184:187]
    ds_read_b128 v[36:39], v22 offset:17408
    v_mfma_f32_16x16x32_bf16 a[184:187], v[188:191], v[44:47], a[184:187]
    s_waitcnt lgkmcnt(2)
    v_mfma_f32_16x16x32_bf16 a[104:107], v[80:83], v[24:27], a[104:107]
    ds_read_b128 v[40:43], v22 offset:8192
    v_mfma_f32_16x16x32_bf16 a[104:107], v[88:91], v[28:31], a[104:107]
    v_mfma_f32_16x16x32_bf16 a[152:155], v[84:87], v[24:27], a[152:155]
    ds_read_b128 v[44:47], v22 offset:20480
    v_mfma_f32_16x16x32_bf16 a[152:155], v[92:95], v[28:31], a[152:155]
    s_waitcnt lgkmcnt(2)
    v_mfma_f32_16x16x32_bf16 a[116:119], v[80:83], v[32:35], a[116:119]
    ds_read_b128 v[24:27], v22 offset:11264
    v_accvgpr_read_b32 v224, a100
    v_mfma_f32_16x16x32_bf16 a[116:119], v[88:91], v[36:39], a[116:119]
    v_accvgpr_read_b32 v225, a112
    v_accvgpr_read_b32 v226, a124
    v_accvgpr_read_b32 v227, a136
    v_mul_f32 v224, v224, v128
    v_mul_f32 v225, v225, v128
    v_mul_f32 v226, v226, v128
    v_mul_f32 v227, v227, v128
    v_cvt_pk_bf16_f32 v224, v224, v225
    v_cvt_pk_bf16_f32 v225, v226, v227
    v_accvgpr_read_b32 v228, a101
    v_accvgpr_read_b32 v229, a113
    v_accvgpr_read_b32 v230, a125
    v_accvgpr_read_b32 v231, a137
    v_mul_f32 v228, v228, v129
    v_mul_f32 v229, v229, v129
    v_mul_f32 v230, v230, v129
    v_mul_f32 v231, v231, v129
    v_cvt_pk_bf16_f32 v228, v228, v229
    v_cvt_pk_bf16_f32 v229, v230, v231
    v_accvgpr_read_b32 v232, a102
    v_accvgpr_read_b32 v233, a114
    v_accvgpr_read_b32 v234, a126
    v_accvgpr_read_b32 v235, a138
    v_mul_f32 v232, v232, v130
    v_mul_f32 v233, v233, v130
    v_mul_f32 v234, v234, v130
    v_mul_f32 v235, v235, v130
    v_cvt_pk_bf16_f32 v232, v232, v233
    v_cvt_pk_bf16_f32 v233, v234, v235
    v_accvgpr_read_b32 v236, a103
    v_accvgpr_read_b32 v237, a115
    v_accvgpr_read_b32 v238, a127
    v_accvgpr_read_b32 v239, a139
    v_mul_f32 v236, v236, v131
    v_mul_f32 v237, v237, v131
    v_mul_f32 v238, v238, v131
    v_mfma_f32_16x16x32_bf16 a[164:167], v[84:87], v[32:35], a[164:167]
    ds_read_b128 v[28:31], v22 offset:23552
    v_mul_f32 v239, v239, v131
    v_mfma_f32_16x16x32_bf16 a[164:167], v[92:95], v[36:39], a[164:167]
    s_waitcnt lgkmcnt(2)
    buffer_store_dwordx2 v[224:225], v56, s[12:15], s41 offen offset:128 sc0 sc1
    v_cvt_pk_bf16_f32 v236, v236, v237
    v_cvt_pk_bf16_f32 v237, v238, v239
    v_accvgpr_read_b32 v240, a148
    v_mfma_f32_16x16x32_bf16 a[128:131], v[80:83], v[40:43], a[128:131]
    ds_read_b128 v[32:35], v1 offset:2048
    v_accvgpr_read_b32 v241, a160
    v_mfma_f32_16x16x32_bf16 a[128:131], v[88:91], v[44:47], a[128:131]
    buffer_store_dwordx2 v[228:229], v56, s[12:15], s41 offen offset:512 sc0 sc1
    v_accvgpr_read_b32 v242, a172
    v_accvgpr_read_b32 v243, a184
    v_mul_f32 v240, v240, v132
    v_mfma_f32_16x16x32_bf16 a[176:179], v[84:87], v[40:43], a[176:179]
    ds_read_b128 v[36:39], v1 offset:14336
    v_mul_f32 v241, v241, v132
    v_mfma_f32_16x16x32_bf16 a[176:179], v[92:95], v[44:47], a[176:179]
    s_waitcnt lgkmcnt(2)
    buffer_store_dwordx2 v[232:233], v56, s[12:15], s41 offen offset:896 sc0 sc1
    v_mul_f32 v242, v242, v132
    v_mul_f32 v243, v243, v132
    v_cvt_pk_bf16_f32 v240, v240, v241
    v_mfma_f32_16x16x32_bf16 a[140:143], v[80:83], v[24:27], a[140:143]
    ds_read_b128 v[40:43], v1 offset:5120
    v_cvt_pk_bf16_f32 v241, v242, v243
    v_mfma_f32_16x16x32_bf16 a[140:143], v[88:91], v[28:31], a[140:143]
    buffer_store_dwordx2 v[236:237], v56, s[12:15], s41 offen offset:1280 sc0 sc1
    v_accvgpr_read_b32 v244, a149
    v_accvgpr_read_b32 v245, a161
    v_accvgpr_read_b32 v246, a173
    v_mfma_f32_16x16x32_bf16 a[188:191], v[84:87], v[24:27], a[188:191]
    ds_read_b128 v[44:47], v1 offset:17408
    v_accvgpr_read_b32 v247, a185
    v_mfma_f32_16x16x32_bf16 a[188:191], v[92:95], v[28:31], a[188:191]
    s_waitcnt lgkmcnt(2)
    buffer_store_dwordx2 v[240:241], v56, s[12:15], s42 offen offset:128 sc0 sc1
    v_mul_f32 v244, v244, v133
    v_mul_f32 v245, v245, v133
    v_mul_f32 v246, v246, v133
    v_mfma_f32_16x16x32_bf16 a[104:107], v[160:163], v[32:35], a[104:107]
    ds_read_b128 v[24:27], v1 offset:8192
    v_mul_f32 v247, v247, v133
    v_mfma_f32_16x16x32_bf16 a[104:107], v[168:171], v[36:39], a[104:107]
    v_cvt_pk_bf16_f32 v244, v244, v245
    v_cvt_pk_bf16_f32 v245, v246, v247
    v_accvgpr_read_b32 v248, a150
    v_accvgpr_read_b32 v249, a162
    v_accvgpr_read_b32 v250, a174
    v_accvgpr_read_b32 v251, a186
    v_mfma_f32_16x16x32_bf16 a[152:155], v[164:167], v[32:35], a[152:155]
    ds_read_b128 v[28:31], v1 offset:20480
    v_mul_f32 v248, v248, v134
    v_mfma_f32_16x16x32_bf16 a[152:155], v[172:175], v[36:39], a[152:155]
    s_waitcnt lgkmcnt(2)
    buffer_store_dwordx2 v[244:245], v56, s[12:15], s42 offen offset:512 sc0 sc1
    v_mul_f32 v249, v249, v134
    v_mul_f32 v250, v250, v134
    v_mul_f32 v251, v251, v134
    v_mfma_f32_16x16x32_bf16 a[116:119], v[160:163], v[40:43], a[116:119]
    ds_read_b128 v[32:35], v1 offset:11264
    v_cvt_pk_bf16_f32 v248, v248, v249
    v_mfma_f32_16x16x32_bf16 a[116:119], v[168:171], v[44:47], a[116:119]
    v_cvt_pk_bf16_f32 v249, v250, v251
    v_accvgpr_read_b32 v252, a151
    v_accvgpr_read_b32 v253, a163
    v_accvgpr_read_b32 v254, a175
    v_accvgpr_read_b32 v255, a187
    v_mul_f32 v252, v252, v135
    v_mfma_f32_16x16x32_bf16 a[164:167], v[164:167], v[40:43], a[164:167]
    ds_read_b128 v[36:39], v1 offset:23552
    v_mul_f32 v253, v253, v135
    v_mfma_f32_16x16x32_bf16 a[164:167], v[172:175], v[44:47], a[164:167]
    s_waitcnt lgkmcnt(2)
    buffer_store_dwordx2 v[248:249], v56, s[12:15], s42 offen offset:896 sc0 sc1
    v_mul_f32 v254, v254, v135
    v_mul_f32 v255, v255, v135
    v_cvt_pk_bf16_f32 v252, v252, v253
    v_mfma_f32_16x16x32_bf16 a[128:131], v[160:163], v[24:27], a[128:131]
    ds_read_b128 v[40:43], v14 offset:2048
    v_cvt_pk_bf16_f32 v253, v254, v255
    v_mfma_f32_16x16x32_bf16 a[128:131], v[168:171], v[28:31], a[128:131]
    buffer_store_dwordx2 v[252:253], v56, s[12:15], s42 offen offset:1280 sc0 sc1
    v_mfma_f32_16x16x32_bf16 a[176:179], v[164:167], v[24:27], a[176:179]
    ds_read_b128 v[44:47], v14 offset:14336
    v_mfma_f32_16x16x32_bf16 a[176:179], v[172:175], v[28:31], a[176:179]
    s_waitcnt lgkmcnt(2)
    v_mfma_f32_16x16x32_bf16 a[140:143], v[160:163], v[32:35], a[140:143]
    ds_read_b128 v[24:27], v14 offset:5120
    v_mfma_f32_16x16x32_bf16 a[140:143], v[168:171], v[36:39], a[140:143]
    v_mfma_f32_16x16x32_bf16 a[188:191], v[164:167], v[32:35], a[188:191]
    ds_read_b128 v[28:31], v14 offset:17408
    v_mfma_f32_16x16x32_bf16 a[188:191], v[172:175], v[36:39], a[188:191]
    s_waitcnt lgkmcnt(2)
    v_mfma_f32_16x16x32_bf16 a[104:107], v[176:179], v[40:43], a[104:107]
    ds_read_b128 v[32:35], v14 offset:8192
    v_mfma_f32_16x16x32_bf16 a[104:107], v[184:187], v[44:47], a[104:107]
    v_mfma_f32_16x16x32_bf16 a[152:155], v[180:183], v[40:43], a[152:155]
    ds_read_b128 v[36:39], v14 offset:20480
    v_mfma_f32_16x16x32_bf16 a[152:155], v[188:191], v[44:47], a[152:155]
    s_waitcnt lgkmcnt(2)
    v_mfma_f32_16x16x32_bf16 a[116:119], v[176:179], v[24:27], a[116:119]
    ds_read_b128 v[40:43], v14 offset:11264
    v_mfma_f32_16x16x32_bf16 a[116:119], v[184:187], v[28:31], a[116:119]
    v_mfma_f32_16x16x32_bf16 a[164:167], v[180:183], v[24:27], a[164:167]
    ds_read_b128 v[44:47], v14 offset:23552
    v_mfma_f32_16x16x32_bf16 a[164:167], v[188:191], v[28:31], a[164:167]
    s_waitcnt lgkmcnt(2)
    v_mfma_f32_16x16x32_bf16 a[128:131], v[176:179], v[32:35], a[128:131]
    v_mfma_f32_16x16x32_bf16 a[128:131], v[184:187], v[36:39], a[128:131]
    v_mfma_f32_16x16x32_bf16 a[176:179], v[180:183], v[32:35], a[176:179]
    v_mfma_f32_16x16x32_bf16 a[176:179], v[188:191], v[36:39], a[176:179]
    s_waitcnt lgkmcnt(0)
    v_mfma_f32_16x16x32_bf16 a[140:143], v[176:179], v[40:43], a[140:143]
    v_mfma_f32_16x16x32_bf16 a[140:143], v[184:187], v[44:47], a[140:143]
    v_mfma_f32_16x16x32_bf16 a[188:191], v[180:183], v[40:43], a[188:191]
    v_mfma_f32_16x16x32_bf16 a[188:191], v[188:191], v[44:47], a[188:191]
    s_nop 7
    v_accvgpr_read_b32 v224, a104
    v_accvgpr_read_b32 v225, a116
    v_accvgpr_read_b32 v226, a128
    v_accvgpr_read_b32 v227, a140
    v_pk_mul_f32 v[224:225], v[224:225], v[128:129] op_sel_hi:[1,0]
    v_pk_mul_f32 v[226:227], v[226:227], v[128:129] op_sel_hi:[1,0]
    v_cvt_pk_bf16_f32 v224, v224, v225
    v_cvt_pk_bf16_f32 v225, v226, v227
    v_accvgpr_read_b32 v228, a105
    v_accvgpr_read_b32 v229, a117
    v_accvgpr_read_b32 v230, a129
    v_accvgpr_read_b32 v231, a141
    v_pk_mul_f32 v[228:229], v[228:229], v[128:129] op_sel:[0,1] op_sel_hi:[1,1]
    v_pk_mul_f32 v[230:231], v[230:231], v[128:129] op_sel:[0,1] op_sel_hi:[1,1]
    v_cvt_pk_bf16_f32 v228, v228, v229
    v_cvt_pk_bf16_f32 v229, v230, v231
    buffer_store_dwordx2 v[224:225], v56, s[12:15], s41 offen offset:256 sc0 sc1
    v_accvgpr_read_b32 v232, a106
    v_accvgpr_read_b32 v233, a118
    v_accvgpr_read_b32 v234, a130
    v_accvgpr_read_b32 v235, a142
    v_pk_mul_f32 v[232:233], v[232:233], v[130:131] op_sel_hi:[1,0]
    v_pk_mul_f32 v[234:235], v[234:235], v[130:131] op_sel_hi:[1,0]
    v_cvt_pk_bf16_f32 v232, v232, v233
    v_cvt_pk_bf16_f32 v233, v234, v235
    buffer_store_dwordx2 v[228:229], v56, s[12:15], s41 offen offset:640 sc0 sc1
    v_accvgpr_read_b32 v236, a107
    v_accvgpr_read_b32 v237, a119
    v_accvgpr_read_b32 v238, a131
    v_accvgpr_read_b32 v239, a143
    v_pk_mul_f32 v[236:237], v[236:237], v[130:131] op_sel:[0,1] op_sel_hi:[1,1]
    v_pk_mul_f32 v[238:239], v[238:239], v[130:131] op_sel:[0,1] op_sel_hi:[1,1]
    v_cvt_pk_bf16_f32 v236, v236, v237
    v_cvt_pk_bf16_f32 v237, v238, v239
    buffer_store_dwordx2 v[232:233], v56, s[12:15], s41 offen offset:1024 sc0 sc1
    buffer_store_dwordx2 v[236:237], v56, s[12:15], s41 offen offset:1408 sc0 sc1
    v_accvgpr_read_b32 v240, a152
    v_accvgpr_read_b32 v241, a164
    v_accvgpr_read_b32 v242, a176
    v_accvgpr_read_b32 v243, a188
    v_pk_mul_f32 v[240:241], v[240:241], v[132:133] op_sel_hi:[1,0]
    v_pk_mul_f32 v[242:243], v[242:243], v[132:133] op_sel_hi:[1,0]
    v_cvt_pk_bf16_f32 v240, v240, v241
    v_cvt_pk_bf16_f32 v241, v242, v243
    v_accvgpr_read_b32 v244, a153
    v_accvgpr_read_b32 v245, a165
    v_accvgpr_read_b32 v246, a177
    v_accvgpr_read_b32 v247, a189
    v_pk_mul_f32 v[244:245], v[244:245], v[132:133] op_sel:[0,1] op_sel_hi:[1,1]
    v_pk_mul_f32 v[246:247], v[246:247], v[132:133] op_sel:[0,1] op_sel_hi:[1,1]
    v_cvt_pk_bf16_f32 v244, v244, v245
    v_cvt_pk_bf16_f32 v245, v246, v247
    buffer_store_dwordx2 v[240:241], v56, s[12:15], s42 offen offset:256 sc0 sc1
    v_accvgpr_read_b32 v248, a154
    v_accvgpr_read_b32 v249, a166
    v_accvgpr_read_b32 v250, a178
    v_accvgpr_read_b32 v251, a190
    v_pk_mul_f32 v[248:249], v[248:249], v[134:135] op_sel_hi:[1,0]
    v_pk_mul_f32 v[250:251], v[250:251], v[134:135] op_sel_hi:[1,0]
    v_cvt_pk_bf16_f32 v248, v248, v249
    v_cvt_pk_bf16_f32 v249, v250, v251
    buffer_store_dwordx2 v[244:245], v56, s[12:15], s42 offen offset:640 sc0 sc1
    v_accvgpr_read_b32 v252, a155
    v_accvgpr_read_b32 v253, a167
    v_accvgpr_read_b32 v254, a179
    v_accvgpr_read_b32 v255, a191
    v_pk_mul_f32 v[252:253], v[252:253], v[134:135] op_sel:[0,1] op_sel_hi:[1,1]
    v_pk_mul_f32 v[254:255], v[254:255], v[134:135] op_sel:[0,1] op_sel_hi:[1,1]
    v_cvt_pk_bf16_f32 v252, v252, v253
    v_cvt_pk_bf16_f32 v253, v254, v255
    buffer_store_dwordx2 v[248:249], v56, s[12:15], s42 offen offset:1024 sc0 sc1
    buffer_store_dwordx2 v[252:253], v56, s[12:15], s42 offen offset:1408 sc0 sc1
L_fin:
L_done:
    s_endpgm
L_pollslow0:
    s_mov_b32 s59, 60
L_pollsm0:
    s_buffer_load_dwordx8 s[48:55], s[20:23], s44 glc
    s_waitcnt lgkmcnt(0)
    s_sub_u32 s48, s48, s92
    s_sub_u32 s49, s49, s92
    s_sub_u32 s50, s50, s92
    s_sub_u32 s51, s51, s92
    s_sub_u32 s52, s52, s92
    s_sub_u32 s53, s53, s92
    s_sub_u32 s54, s54, s92
    s_sub_u32 s55, s55, s92
    s_max_u32 s48, s48, s49
    s_max_u32 s48, s48, s50
    s_max_u32 s48, s48, s51
    s_max_u32 s48, s48, s52
    s_max_u32 s48, s48, s53
    s_max_u32 s48, s48, s54
    s_max_u32 s48, s48, s55
    s_cmp_lt_u32 s48, 16
    s_cbranch_scc1 L_pollok0
    s_sub_u32 s59, s59, 1
    s_cbranch_scc1 L_pollvec0
    s_sleep 1
    s_branch L_pollsm0
L_pollvec0:
    v_bfe_u32 v53, v4, 4, 6
    v_lshlrev_b32 v53, 2, v53
    s_sub_u32 s96, s96, 1
    s_cbranch_scc1 L_pollgiveup0
    s_sleep 2
    buffer_load_dword v52, v53, s[20:23], s44 offen sc1
    s_waitcnt vmcnt(0)
    s_cmp_lg_u32 s44, 0
    s_cbranch_scc1 L_nomix
    v_xor_b32 v53, s92, v52
    v_lshrrev_b32 v53, 5, v53
    v_add_u32 v53, -1, v53
    v_cmp_gt_u32 vcc, 31, v53
    s_nop 1
    s_and_b32 s59, vcc_lo, 0xff00
    s_cbranch_scc0 L_nomix
    buffer_store_dwordx4 v[224:227], v11, s[4:7], s33 offen offset:0 sc1
    v_xor_b32 v55, 16, v11
    buffer_store_dwordx4 v[228:231], v55, s[4:7], s33 offen offset:768 sc1
    v_xor_b32 v54, 32, v11
    buffer_store_dwordx4 v[232:235], v54, s[4:7], s33 offen offset:1536 sc1
    v_xor_b32 v55, 48, v11
    buffer_store_dwordx4 v[236:239], v55, s[4:7], s33 offen offset:2304 sc1
    buffer_store_dwordx4 v[112:115], v20, s[4:7], s35 offen offset:0 sc1
    buffer_store_dwordx4 v[116:119], v20, s[4:7], s35 offen offset:3072 sc1
    buffer_store_dwordx4 v[120:123], v20, s[4:7], s17 offen offset:0 sc1
    buffer_store_dwordx4 v[124:127], v20, s[4:7], s17 offen offset:3072 sc1
    s_waitcnt vmcnt(0)
    s_barrier
    s_and_b32 s92, s92, 0xfffffc00
    s_add_u32 s92, s92, 512
    v_mov_b32 v0, s92
    s_add_u32 s92, s92, 1
    s_mov_b32 s44, 32
    v_add_u32 v0, 1, v0
    buffer_store_dword v0, v13, s[20:23], 0 offen offset:32 sc1
    s_branch L_pollvec0
L_nomix:
    v_subrev_u32 v52, s92, v52
    v_cmp_lt_u32 vcc, 15, v52
    s_nop 0
    s_and_b32 s59, vcc_lo, 0xff
    s_cbranch_scc1 L_pollvec0
    s_branch L_pollok0
L_pollgiveup0:
    s_mov_b32 s96, 0
    s_branch L_pollok0
L_pollslow1:
    s_mov_b32 s59, 200
L_pollsm1:
    s_buffer_load_dwordx8 s[48:55], s[20:23], s44 glc
    s_waitcnt lgkmcnt(0)
    s_sub_u32 s48, s48, s92
    s_sub_u32 s49, s49, s92
    s_sub_u32 s50, s50, s92
    s_sub_u32 s51, s51, s92
    s_sub_u32 s52, s52, s92
    s_sub_u32 s53, s53, s92
    s_sub_u32 s54, s54, s92
    s_sub_u32 s55, s55, s92
    s_max_u32 s48, s48, s49
    s_max_u32 s48, s48, s50
    s_max_u32 s48, s48, s51
    s_max_u32 s48, s48, s52
    s_max_u32 s48, s48, s53
    s_max_u32 s48, s48, s54
    s_max_u32 s48, s48, s55
    s_cmp_lt_u32 s48, 16
    s_cbranch_scc1 L_pollok1
    s_sub_u32 s59, s59, 1
    s_cbranch_scc1 L_pollvec1
    s_sleep 1
    s_branch L_pollsm1
L_pollvec1:
    v_bfe_u32 v53, v4, 4, 6
    v_lshlrev_b32 v53, 2, v53
    s_sub_u32 s96, s96, 1
    s_cbranch_scc1 L_pollgiveup1
    s_sleep 2
    buffer_load_dword v52, v53, s[20:23], s44 offen sc1
    s_waitcnt vmcnt(0)
    v_subrev_u32 v52, s92, v52
    v_cmp_lt_u32 vcc, 15, v52
    s_nop 0
    s_and_b32 s59, vcc_lo, 0xff
    s_cbranch_scc1 L_pollvec1
    s_branch L_pollok1
L_pollgiveup1:
    s_mov_b32 s96, 0
    s_branch L_pollok1
L_pollslow2:
    s_mov_b32 s59, 200
L_pollsm2:
    s_buffer_load_dwordx8 s[48:55], s[20:23], s44 glc
    s_waitcnt lgkmcnt(0)
    s_sub_u32 s48, s48, s92
    s_sub_u32 s49, s49, s92
    s_sub_u32 s50, s50, s92
    s_sub_u32 s51, s51, s92
    s_sub_u32 s52, s52, s92
    s_sub_u32 s53, s53, s92
    s_sub_u32 s54, s54, s92
    s_sub_u32 s55, s55, s92
    s_max_u32 s48, s48, s49
    s_max_u32 s48, s48, s50
    s_max_u32 s48, s48, s51
    s_max_u32 s48, s48, s52
    s_max_u32 s48, s48, s53
    s_max_u32 s48, s48, s54
    s_max_u32 s48, s48, s55
    s_cmp_lt_u32 s48, 16
    s_cbranch_scc1 L_pollok2
    s_sub_u32 s59, s59, 1
    s_cbranch_scc1 L_pollvec2
    s_sleep 1
    s_branch L_pollsm2
L_pollvec2:
    v_bfe_u32 v53, v4, 4, 6
    v_lshlrev_b32 v53, 2, v53
    s_sub_u32 s96, s96, 1
    s_cbranch_scc1 L_pollgiveup2
    s_sleep 2
    buffer_load_dword v52, v53, s[20:23], s44 offen sc1
    s_waitcnt vmcnt(0)
    v_subrev_u32 v52, s92, v52
    v_cmp_lt_u32 vcc, 15, v52
    s_nop 0
    s_and_b32 s59, vcc_lo, 0xff
    s_cbranch_scc1 L_pollvec2
    s_branch L_pollok2
L_pollgiveup2:
    s_mov_b32 s96, 0
    s_branch L_pollok2
L_tagslow:
    s_sub_u32 s96, s96, 1
    s_cbranch_scc1 L_taggiveup
    s_sleep 2
    buffer_load_dword v0, off, s[88:91], s93 sc1
    s_waitcnt vmcnt(0)
    v_readfirstlane_b32 s42, v0
    s_nop 0
    s_cmp_eq_u32 s42, s46
    s_cbranch_scc1 L_tagslow
    s_cmp_eq_u32 s42, 0
    s_cbranch_scc1 L_tagslow
    s_branch L_tagok
L_taggiveup:
    s_mov_b32 s96, 0
    s_branch L_tagok
L_slow:
    s_waitcnt vmcnt(0) lgkmcnt(0)
    s_nop 15
    v_accvgpr_write_b32 a0, 0
    v_accvgpr_write_b32 a1, 0
    v_accvgpr_write_b32 a2, 0
    v_accvgpr_write_b32 a3, 0
    v_accvgpr_write_b32 a4, 0
    v_accvgpr_write_b32 a5, 0
    v_accvgpr_write_b32 a6, 0
    v_accvgpr_write_b32 a7, 0
    v_accvgpr_write_b32 a8, 0
    v_accvgpr_write_b32 a9, 0
    v_accvgpr_write_b32 a10, 0
    v_accvgpr_write_b32 a11, 0
    v_accvgpr_write_b32 a12, 0
    v_accvgpr_write_b32 a13, 0
    v_accvgpr_write_b32 a14, 0
    v_accvgpr_write_b32 a15, 0
    v_accvgpr_write_b32 a16, 0
    v_accvgpr_write_b32 a17, 0
    v_accvgpr_write_b32 a18, 0
    v_accvgpr_write_b32 a19, 0
    v_accvgpr_write_b32 a20, 0
    v_accvgpr_write_b32 a21, 0
    v_accvgpr_write_b32 a22, 0
    v_accvgpr_write_b32 a23, 0
    v_accvgpr_write_b32 a24, 0
    v_accvgpr_write_b32 a25, 0
    v_accvgpr_write_b32 a26, 0
    v_accvgpr_write_b32 a27, 0
    v_accvgpr_write_b32 a28, 0
    v_accvgpr_write_b32 a29, 0
    v_accvgpr_write_b32 a30, 0
    v_accvgpr_write_b32 a31, 0
    v_accvgpr_write_b32 a32, 0
    v_accvgpr_write_b32 a33, 0
    v_accvgpr_write_b32 a34, 0
    v_accvgpr_write_b32 a35, 0
    v_accvgpr_write_b32 a36, 0
    v_accvgpr_write_b32 a37, 0
    v_accvgpr_write_b32 a38, 0
    v_accvgpr_write_b32 a39, 0
    v_accvgpr_write_b32 a40, 0
    v_accvgpr_write_b32 a41, 0
    v_accvgpr_write_b32 a42, 0
    v_accvgpr_write_b32 a43, 0
    v_accvgpr_write_b32 a44, 0
    v_accvgpr_write_b32 a45, 0
    v_accvgpr_write_b32 a46, 0
    v_accvgpr_write_b32 a47, 0
    v_accvgpr_write_b32 a48, 0
    v_accvgpr_write_b32 a49, 0
    v_accvgpr_write_b32 a50, 0
    v_accvgpr_write_b32 a51, 0
    v_accvgpr_write_b32 a52, 0
    v_accvgpr_write_b32 a53, 0
    v_accvgpr_write_b32 a54, 0
    v_accvgpr_write_b32 a55, 0
    v_accvgpr_write_b32 a56, 0
    v_accvgpr_write_b32 a57, 0
    v_accvgpr_write_b32 a58, 0
    v_accvgpr_write_b32 a59, 0
    v_accvgpr_write_b32 a60, 0
    v_accvgpr_write_b32 a61, 0
    v_accvgpr_write_b32 a62, 0
    v_accvgpr_write_b32 a63, 0
    v_accvgpr_write_b32 a64, 0
    v_accvgpr_write_b32 a65, 0
    v_accvgpr_write_b32 a66, 0
    v_accvgpr_write_b32 a67, 0
    v_accvgpr_write_b32 a68, 0
    v_accvgpr_write_b32 a69, 0
    v_accvgpr_write_b32 a70, 0
    v_accvgpr_write_b32 a71, 0
    v_accvgpr_write_b32 a72, 0
    v_accvgpr_write_b32 a73, 0
    v_accvgpr_write_b32 a74, 0
    v_accvgpr_write_b32 a75, 0
    v_accvgpr_write_b32 a76, 0
    v_accvgpr_write_b32 a77, 0
    v_accvgpr_write_b32 a78, 0
    v_accvgpr_write_b32 a79, 0
    v_accvgpr_write_b32 a80, 0
    v_accvgpr_write_b32 a81, 0
    v_accvgpr_write_b32 a82, 0
    v_accvgpr_write_b32 a83, 0
    v_accvgpr_write_b32 a84, 0
    v_accvgpr_write_b32 a85, 0
    v_accvgpr_write_b32 a86, 0
    v_accvgpr_write_b32 a87, 0
    v_accvgpr_write_b32 a88, 0
    v_accvgpr_write_b32 a89, 0
    v_accvgpr_write_b32 a90, 0
    v_accvgpr_write_b32 a91, 0
    v_accvgpr_write_b32 a92, 0
    v_accvgpr_write_b32 a93, 0
    v_accvgpr_write_b32 a94, 0
    v_accvgpr_write_b32 a95, 0
    v_accvgpr_write_b32 a96, 0
    v_accvgpr_write_b32 a97, 0
    v_accvgpr_write_b32 a98, 0
    v_accvgpr_write_b32 a99, 0
    v_accvgpr_write_b32 a100, 0
    v_accvgpr_write_b32 a101, 0
    v_accvgpr_write_b32 a102, 0
    v_accvgpr_write_b32 a103, 0
    v_accvgpr_write_b32 a104, 0
    v_accvgpr_write_b32 a105, 0
    v_accvgpr_write_b32 a106, 0
    v_accvgpr_write_b32 a107, 0
    v_accvgpr_write_b32 a108, 0
    v_accvgpr_write_b32 a109, 0
    v_accvgpr_write_b32 a110, 0
    v_accvgpr_write_b32 a111, 0
    v_accvgpr_write_b32 a112, 0
    v_accvgpr_write_b32 a113, 0
    v_accvgpr_write_b32 a114, 0
    v_accvgpr_write_b32 a115, 0
    v_accvgpr_write_b32 a116, 0
    v_accvgpr_write_b32 a117, 0
    v_accvgpr_write_b32 a118, 0
    v_accvgpr_write_b32 a119, 0
    v_accvgpr_write_b32 a120, 0
    v_accvgpr_write_b32 a121, 0
    v_accvgpr_write_b32 a122, 0
    v_accvgpr_write_b32 a123, 0
    v_accvgpr_write_b32 a124, 0
    v_accvgpr_write_b32 a125, 0
    v_accvgpr_write_b32 a126, 0
    v_accvgpr_write_b32 a127, 0
    v_accvgpr_write_b32 a128, 0
    v_accvgpr_write_b32 a129, 0
    v_accvgpr_write_b32 a130, 0
    v_accvgpr_write_b32 a131, 0
    v_accvgpr_write_b32 a132, 0
    v_accvgpr_write_b32 a133, 0
    v_accvgpr_write_b32 a134, 0
    v_accvgpr_write_b32 a135, 0
    v_accvgpr_write_b32 a136, 0
    v_accvgpr_write_b32 a137, 0
    v_accvgpr_write_b32 a138, 0
    v_accvgpr_write_b32 a139, 0
    v_accvgpr_write_b32 a140, 0
    v_accvgpr_write_b32 a141, 0
    v_accvgpr_write_b32 a142, 0
    v_accvgpr_write_b32 a143, 0
    v_accvgpr_write_b32 a144, 0
    v_accvgpr_write_b32 a145, 0
    v_accvgpr_write_b32 a146, 0
    v_accvgpr_write_b32 a147, 0
    v_accvgpr_write_b32 a148, 0
    v_accvgpr_write_b32 a149, 0
    v_accvgpr_write_b32 a150, 0
    v_accvgpr_write_b32 a151, 0
    v_accvgpr_write_b32 a152, 0
    v_accvgpr_write_b32 a153, 0
    v_accvgpr_write_b32 a154, 0
    v_accvgpr_write_b32 a155, 0
    v_accvgpr_write_b32 a156, 0
    v_accvgpr_write_b32 a157, 0
    v_accvgpr_write_b32 a158, 0
    v_accvgpr_write_b32 a159, 0
    v_accvgpr_write_b32 a160, 0
    v_accvgpr_write_b32 a161, 0
    v_accvgpr_write_b32 a162, 0
    v_accvgpr_write_b32 a163, 0
    v_accvgpr_write_b32 a164, 0
    v_accvgpr_write_b32 a165, 0
    v_accvgpr_write_b32 a166, 0
    v_accvgpr_write_b32 a167, 0
    v_accvgpr_write_b32 a168, 0
    v_accvgpr_write_b32 a169, 0
    v_accvgpr_write_b32 a170, 0
    v_accvgpr_write_b32 a171, 0
    v_accvgpr_write_b32 a172, 0
    v_accvgpr_write_b32 a173, 0
    v_accvgpr_write_b32 a174, 0
    v_accvgpr_write_b32 a175, 0
    v_accvgpr_write_b32 a176, 0
    v_accvgpr_write_b32 a177, 0
    v_accvgpr_write_b32 a178, 0
    v_accvgpr_write_b32 a179, 0
    v_accvgpr_write_b32 a180, 0
    v_accvgpr_write_b32 a181, 0
    v_accvgpr_write_b32 a182, 0
    v_accvgpr_write_b32 a183, 0
    v_accvgpr_write_b32 a184, 0
    v_accvgpr_write_b32 a185, 0
    v_accvgpr_write_b32 a186, 0
    v_accvgpr_write_b32 a187, 0
    v_accvgpr_write_b32 a188, 0
    v_accvgpr_write_b32 a189, 0
    v_accvgpr_write_b32 a190, 0
    v_accvgpr_write_b32 a191, 0
    v_mov_b32 v5, 0
    v_mov_b32 v240, 0xff7fffff
    v_mov_b32 v6, 0
    v_mov_b32 v241, 0xff7fffff
    v_mov_b32 v7, 0
    v_mov_b32 v242, 0xff7fffff
    v_mov_b32 v8, 0
    v_mov_b32 v243, 0xff7fffff
    v_subrev_u32 v244, 49152, v2
    v_subrev_u32 v245, 49152, v3
    v_subrev_u32 v246, 24576, v1
    s_mov_b32 s48, 0
L_slowloop:
    s_add_u32 s49, s48, 6144
    s_add_u32 s50, s48, 12288
    s_add_u32 s51, s48, 16384
    s_add_u32 s52, s48, 20480
    buffer_load_dwordx4 v[64:67], v244, s[4:7], s48 offen offset:0 sc1
    buffer_load_dwordx4 v[68:71], v245, s[4:7], s48 offen offset:0 sc1
    buffer_load_dwordx4 v[72:75], v244, s[4:7], s49 offen offset:0 sc1
    buffer_load_dwordx4 v[76:79], v245, s[4:7], s49 offen offset:0 sc1
    buffer_load_dwordx4 v[80:83], v244, s[4:7], s48 offen offset:128 sc1
    buffer_load_dwordx4 v[84:87], v245, s[4:7], s48 offen offset:128 sc1
    buffer_load_dwordx4 v[88:91], v244, s[4:7], s49 offen offset:128 sc1
    buffer_load_dwordx4 v[92:95], v245, s[4:7], s49 offen offset:128 sc1
    buffer_load_dwordx4 v[96:99], v244, s[4:7], s48 offen offset:256 sc1
    buffer_load_dwordx4 v[100:103], v245, s[4:7], s48 offen offset:256 sc1
    buffer_load_dwordx4 v[104:107], v244, s[4:7], s49 offen offset:256 sc1
    buffer_load_dwordx4 v[108:111], v245, s[4:7], s49 offen offset:256 sc1
    buffer_load_dwordx4 v[112:115], v246, s[4:7], s50 offen offset:0 sc1
    buffer_load_dwordx4 v[116:119], v246, s[4:7], s50 offen offset:1024 sc1
    buffer_load_dwordx4 v[120:123], v246, s[4:7], s50 offen offset:2048 sc1
    buffer_load_dwordx4 v[124:127], v246, s[4:7], s50 offen offset:3072 sc1
    buffer_load_dwordx4 v[128:131], v246, s[4:7], s51 offen offset:0 sc1
    buffer_load_dwordx4 v[132:135], v246, s[4:7], s51 offen offset:1024 sc1
    buffer_load_dwordx4 v[136:139], v246, s[4:7], s51 offen offset:2048 sc1
    buffer_load_dwordx4 v[140:143], v246, s[4:7], s51 offen offset:3072 sc1
    buffer_load_dwordx4 v[144:147], v246, s[4:7], s52 offen offset:0 sc1
    buffer_load_dwordx4 v[148:151], v246, s[4:7], s52 offen offset:1024 sc1
    buffer_load_dwordx4 v[152:155], v246, s[4:7], s52 offen offset:2048 sc1
    buffer_load_dwordx4 v[156:159], v246, s[4:7], s52 offen offset:3072 sc1
    s_waitcnt vmcnt(12)
    v_mfma_f32_16x16x32_bf16 v[160:163], v[64:67], a[192:195], 0
    v_mfma_f32_16x16x32_bf16 v[168:171], v[64:67], a[216:219], 0
    v_mfma_f32_16x16x32_bf16 v[176:179], v[64:67], a[240:243], 0
    v_mfma_f32_16x16x32_bf16 v[184:187], v[64:67], v[200:203], 0
    v_mfma_f32_16x16x32_bf16 v[160:163], v[68:71], a[196:199], v[160:163]
    v_mfma_f32_16x16x32_bf16 v[168:171], v[68:71], a[220:223], v[168:171]
    v_mfma_f32_16x16x32_bf16 v[176:179], v[68:71], a[244:247], v[176:179]
    v_mfma_f32_16x16x32_bf16 v[184:187], v[68:71], v[204:207], v[184:187]
    v_mfma_f32_16x16x32_bf16 v[164:167], v[72:75], a[192:195], 0
    v_mfma_f32_16x16x32_bf16 v[172:175], v[72:75], a[216:219], 0
    v_mfma_f32_16x16x32_bf16 v[180:183], v[72:75], a[240:243], 0
    v_mfma_f32_16x16x32_bf16 v[188:191], v[72:75], v[200:203], 0
    v_mfma_f32_16x16x32_bf16 v[164:167], v[76:79], a[196:199], v[164:167]
    v_mfma_f32_16x16x32_bf16 v[172:175], v[76:79], a[220:223], v[172:175]
    v_mfma_f32_16x16x32_bf16 v[180:183], v[76:79], a[244:247], v[180:183]
    v_mfma_f32_16x16x32_bf16 v[188:191], v[76:79], v[204:207], v[188:191]
    v_mfma_f32_16x16x32_bf16 v[160:163], v[80:83], a[200:203], v[160:163]
    v_mfma_f32_16x16x32_bf16 v[168:171], v[80:83], a[224:227], v[168:171]
    v_mfma_f32_16x16x32_bf16 v[176:179], v[80:83], a[248:251], v[176:179]
    v_mfma_f32_16x16x32_bf16 v[184:187], v[80:83], v[208:211], v[184:187]
    v_mfma_f32_16x16x32_bf16 v[160:163], v[84:87], a[204:207], v[160:163]
    v_mfma_f32_16x16x32_bf16 v[168:171], v[84:87], a[228:231], v[168:171]
    v_mfma_f32_16x16x32_bf16 v[176:179], v[84:87], a[252:255], v[176:179]
    v_mfma_f32_16x16x32_bf16 v[184:187], v[84:87], v[212:215], v[184:187]
    v_mfma_f32_16x16x32_bf16 v[164:167], v[88:91], a[200:203], v[164:167]
    v_mfma_f32_16x16x32_bf16 v[172:175], v[88:91], a[224:227], v[172:175]
    v_mfma_f32_16x16x32_bf16 v[180:183], v[88:91], a[248:251], v[180:183]
    v_mfma_f32_16x16x32_bf16 v[188:191], v[88:91], v[208:211], v[188:191]
    v_mfma_f32_16x16x32_bf16 v[164:167], v[92:95], a[204:207], v[164:167]
    v_mfma_f32_16x16x32_bf16 v[172:175], v[92:95], a[228:231], v[172:175]
    v_mfma_f32_16x16x32_bf16 v[180:183], v[92:95], a[252:255], v[180:183]
    v_mfma_f32_16x16x32_bf16 v[188:191], v[92:95], v[212:215], v[188:191]
    v_mfma_f32_16x16x32_bf16 v[160:163], v[96:99], a[208:211], v[160:163]
    v_mfma_f32_16x16x32_bf16 v[168:171], v[96:99], a[232:235], v[168:171]
    v_mfma_f32_16x16x32_bf16 v[176:179], v[96:99], v[192:195], v[176:179]
    v_mfma_f32_16x16x32_bf16 v[184:187], v[96:99], v[216:219], v[184:187]
    v_mfma_f32_16x16x32_bf16 v[160:163], v[100:103], a[212:215], v[160:163]
    v_mfma_f32_16x16x32_bf16 v[168:171], v[100:103], a[236:239], v[168:171]
    v_mfma_f32_16x16x32_bf16 v[176:179], v[100:103], v[196:199], v[176:179]
    v_mfma_f32_16x16x32_bf16 v[184:187], v[100:103], v[220:223], v[184:187]
    v_mfma_f32_16x16x32_bf16 v[164:167], v[104:107], a[208:211], v[164:167]
    v_mfma_f32_16x16x32_bf16 v[172:175], v[104:107], a[232:235], v[172:175]
    v_mfma_f32_16x16x32_bf16 v[180:183], v[104:107], v[192:195], v[180:183]
    v_mfma_f32_16x16x32_bf16 v[188:191], v[104:107], v[216:219], v[188:191]
    v_mfma_f32_16x16x32_bf16 v[164:167], v[108:111], a[212:215], v[164:167]
    v_mfma_f32_16x16x32_bf16 v[172:175], v[108:111], a[236:239], v[172:175]
    v_mfma_f32_16x16x32_bf16 v[180:183], v[108:111], v[196:199], v[180:183]
    v_mfma_f32_16x16x32_bf16 v[188:191], v[108:111], v[220:223], v[188:191]
    s_nop 9
    v_max3_f32 v16, v160, v161, v162
    v_max3_f32 v16, v16, v163, v164
    v_max3_f32 v16, v16, v165, v166
    v_max3_f32 v16, v16, v167, v240
    v_mov_b32 v17, v16
    s_nop 1
    v_permlane16_swap_b32 v16, v17
    s_nop 1
    v_max_f32 v16, v16, v17
    v_mov_b32 v17, v16
    s_nop 1
    v_permlane32_swap_b32 v16, v17
    s_nop 1
    v_max_f32 v16, v16, v17
    v_sub_f32 v17, v240, v16
    v_exp_f32 v17, v17
    v_mov_b32 v240, v16
    v_sub_f32 v160, v160, v16
    v_sub_f32 v161, v161, v16
    v_sub_f32 v162, v162, v16
    v_sub_f32 v163, v163, v16
    v_sub_f32 v164, v164, v16
    v_sub_f32 v165, v165, v16
    v_sub_f32 v166, v166, v16
    v_sub_f32 v167, v167, v16
    v_exp_f32 v160, v160
    v_exp_f32 v161, v161
    v_exp_f32 v162, v162
    v_exp_f32 v163, v163
    v_exp_f32 v164, v164
    v_exp_f32 v165, v165
    v_exp_f32 v166, v166
    v_exp_f32 v167, v167
    v_mul_f32 v5, v5, v17
    v_add_f32 v5, v5, v160
    v_add_f32 v5, v5, v161
    v_add_f32 v5, v5, v162
    v_add_f32 v5, v5, v163
    v_add_f32 v5, v5, v164
    v_add_f32 v5, v5, v165
    v_add_f32 v5, v5, v166
    v_add_f32 v5, v5, v167
    v_cvt_pk_bf16_f32 v224, v160, v161
    v_cvt_pk_bf16_f32 v225, v162, v163
    v_cvt_pk_bf16_f32 v226, v164, v165
    v_cvt_pk_bf16_f32 v227, v166, v167
    ds_bpermute_b32 v248, v58, v17 offset:0
    ds_bpermute_b32 v249, v58, v17 offset:4
    ds_bpermute_b32 v250, v58, v17 offset:8
    ds_bpermute_b32 v251, v58, v17 offset:12
    s_waitcnt lgkmcnt(0)
    v_accvgpr_read_b32 v18, a0
    v_mul_f32 v18, v18, v248
    v_accvgpr_write_b32 a0, v18
    v_accvgpr_read_b32 v19, a1
    v_mul_f32 v19, v19, v249
    v_accvgpr_write_b32 a1, v19
    v_accvgpr_read_b32 v18, a2
    v_mul_f32 v18, v18, v250
    v_accvgpr_write_b32 a2, v18
    v_accvgpr_read_b32 v19, a3
    v_mul_f32 v19, v19, v251
    v_accvgpr_write_b32 a3, v19
    v_accvgpr_read_b32 v18, a4
    v_mul_f32 v18, v18, v248
    v_accvgpr_write_b32 a4, v18
    v_accvgpr_read_b32 v19, a5
    v_mul_f32 v19, v19, v249
    v_accvgpr_write_b32 a5, v19
    v_accvgpr_read_b32 v18, a6
    v_mul_f32 v18, v18, v250
    v_accvgpr_write_b32 a6, v18
    v_accvgpr_read_b32 v19, a7
    v_mul_f32 v19, v19, v251
    v_accvgpr_write_b32 a7, v19
    v_accvgpr_read_b32 v18, a8
    v_mul_f32 v18, v18, v248
    v_accvgpr_write_b32 a8, v18
    v_accvgpr_read_b32 v19, a9
    v_mul_f32 v19, v19, v249
    v_accvgpr_write_b32 a9, v19
    v_accvgpr_read_b32 v18, a10
    v_mul_f32 v18, v18, v250
    v_accvgpr_write_b32 a10, v18
    v_accvgpr_read_b32 v19, a11
    v_mul_f32 v19, v19, v251
    v_accvgpr_write_b32 a11, v19
    v_accvgpr_read_b32 v18, a12
    v_mul_f32 v18, v18, v248
    v_accvgpr_write_b32 a12, v18
    v_accvgpr_read_b32 v19, a13
    v_mul_f32 v19, v19, v249
    v_accvgpr_write_b32 a13, v19
    v_accvgpr_read_b32 v18, a14
    v_mul_f32 v18, v18, v250
    v_accvgpr_write_b32 a14, v18
    v_accvgpr_read_b32 v19, a15
    v_mul_f32 v19, v19, v251
    v_accvgpr_write_b32 a15, v19
    v_accvgpr_read_b32 v18, a16
    v_mul_f32 v18, v18, v248
    v_accvgpr_write_b32 a16, v18
    v_accvgpr_read_b32 v19, a17
    v_mul_f32 v19, v19, v249
    v_accvgpr_write_b32 a17, v19
    v_accvgpr_read_b32 v18, a18
    v_mul_f32 v18, v18, v250
    v_accvgpr_write_b32 a18, v18
    v_accvgpr_read_b32 v19, a19
    v_mul_f32 v19, v19, v251
    v_accvgpr_write_b32 a19, v19
    v_accvgpr_read_b32 v18, a20
    v_mul_f32 v18, v18, v248
    v_accvgpr_write_b32 a20, v18
    v_accvgpr_read_b32 v19, a21
    v_mul_f32 v19, v19, v249
    v_accvgpr_write_b32 a21, v19
    v_accvgpr_read_b32 v18, a22
    v_mul_f32 v18, v18, v250
    v_accvgpr_write_b32 a22, v18
    v_accvgpr_read_b32 v19, a23
    v_mul_f32 v19, v19, v251
    v_accvgpr_write_b32 a23, v19
    v_accvgpr_read_b32 v18, a24
    v_mul_f32 v18, v18, v248
    v_accvgpr_write_b32 a24, v18
    v_accvgpr_read_b32 v19, a25
    v_mul_f32 v19, v19, v249
    v_accvgpr_write_b32 a25, v19
    v_accvgpr_read_b32 v18, a26
    v_mul_f32 v18, v18, v250
    v_accvgpr_write_b32 a26, v18
    v_accvgpr_read_b32 v19, a27
    v_mul_f32 v19, v19, v251
    v_accvgpr_write_b32 a27, v19
    v_accvgpr_read_b32 v18, a28
    v_mul_f32 v18, v18, v248
    v_accvgpr_write_b32 a28, v18
    v_accvgpr_read_b32 v19, a29
    v_mul_f32 v19, v19, v249
    v_accvgpr_write_b32 a29, v19
    v_accvgpr_read_b32 v18, a30
    v_mul_f32 v18, v18, v250
    v_accvgpr_write_b32 a30, v18
    v_accvgpr_read_b32 v19, a31
    v_mul_f32 v19, v19, v251
    v_accvgpr_write_b32 a31, v19
    v_accvgpr_read_b32 v18, a32
    v_mul_f32 v18, v18, v248
    v_accvgpr_write_b32 a32, v18
    v_accvgpr_read_b32 v19, a33
    v_mul_f32 v19, v19, v249
    v_accvgpr_write_b32 a33, v19
    v_accvgpr_read_b32 v18, a34
    v_mul_f32 v18, v18, v250
    v_accvgpr_write_b32 a34, v18
    v_accvgpr_read_b32 v19, a35
    v_mul_f32 v19, v19, v251
    v_accvgpr_write_b32 a35, v19
    v_accvgpr_read_b32 v18, a36
    v_mul_f32 v18, v18, v248
    v_accvgpr_write_b32 a36, v18
    v_accvgpr_read_b32 v19, a37
    v_mul_f32 v19, v19, v249
    v_accvgpr_write_b32 a37, v19
    v_accvgpr_read_b32 v18, a38
    v_mul_f32 v18, v18, v250
    v_accvgpr_write_b32 a38, v18
    v_accvgpr_read_b32 v19, a39
    v_mul_f32 v19, v19, v251
    v_accvgpr_write_b32 a39, v19
    v_accvgpr_read_b32 v18, a40
    v_mul_f32 v18, v18, v248
    v_accvgpr_write_b32 a40, v18
    v_accvgpr_read_b32 v19, a41
    v_mul_f32 v19, v19, v249
    v_accvgpr_write_b32 a41, v19
    v_accvgpr_read_b32 v18, a42
    v_mul_f32 v18, v18, v250
    v_accvgpr_write_b32 a42, v18
    v_accvgpr_read_b32 v19, a43
    v_mul_f32 v19, v19, v251
    v_accvgpr_write_b32 a43, v19
    v_accvgpr_read_b32 v18, a44
    v_mul_f32 v18, v18, v248
    v_accvgpr_write_b32 a44, v18
    v_accvgpr_read_b32 v19, a45
    v_mul_f32 v19, v19, v249
    v_accvgpr_write_b32 a45, v19
    v_accvgpr_read_b32 v18, a46
    v_mul_f32 v18, v18, v250
    v_accvgpr_write_b32 a46, v18
    v_accvgpr_read_b32 v19, a47
    v_mul_f32 v19, v19, v251
    v_accvgpr_write_b32 a47, v19
    v_max3_f32 v16, v168, v169, v170
    v_max3_f32 v16, v16, v171, v172
    v_max3_f32 v16, v16, v173, v174
    v_max3_f32 v16, v16, v175, v241
    v_mov_b32 v17, v16
    s_nop 1
    v_permlane16_swap_b32 v16, v17
    s_nop 1
    v_max_f32 v16, v16, v17
    v_mov_b32 v17, v16
    s_nop 1
    v_permlane32_swap_b32 v16, v17
    s_nop 1
    v_max_f32 v16, v16, v17
    v_sub_f32 v17, v241, v16
    v_exp_f32 v17, v17
    v_mov_b32 v241, v16
    v_sub_f32 v168, v168, v16
    v_sub_f32 v169, v169, v16
    v_sub_f32 v170, v170, v16
    v_sub_f32 v171, v171, v16
    v_sub_f32 v172, v172, v16
    v_sub_f32 v173, v173, v16
    v_sub_f32 v174, v174, v16
    v_sub_f32 v175, v175, v16
    v_exp_f32 v168, v168
    v_exp_f32 v169, v169
    v_exp_f32 v170, v170
    v_exp_f32 v171, v171
    v_exp_f32 v172, v172
    v_exp_f32 v173, v173
    v_exp_f32 v174, v174
    v_exp_f32 v175, v175
    v_mul_f32 v6, v6, v17
    v_add_f32 v6, v6, v168
    v_add_f32 v6, v6, v169
    v_add_f32 v6, v6, v170
    v_add_f32 v6, v6, v171
    v_add_f32 v6, v6, v172
    v_add_f32 v6, v6, v173
    v_add_f32 v6, v6, v174
    v_add_f32 v6, v6, v175
    v_cvt_pk_bf16_f32 v228, v168, v169
    v_cvt_pk_bf16_f32 v229, v170, v171
    v_cvt_pk_bf16_f32 v230, v172, v173
    v_cvt_pk_bf16_f32 v231, v174, v175
    ds_bpermute_b32 v248, v58, v17 offset:0
    ds_bpermute_b32 v249, v58, v17 offset:4
    ds_bpermute_b32 v250, v58, v17 offset:8
    ds_bpermute_b32 v251, v58, v17 offset:12
    s_waitcnt lgkmcnt(0)
    v_accvgpr_read_b32 v18, a48
    v_mul_f32 v18, v18, v248
    v_accvgpr_write_b32 a48, v18
    v_accvgpr_read_b32 v19, a49
    v_mul_f32 v19, v19, v249
    v_accvgpr_write_b32 a49, v19
    v_accvgpr_read_b32 v18, a50
    v_mul_f32 v18, v18, v250
    v_accvgpr_write_b32 a50, v18
    v_accvgpr_read_b32 v19, a51
    v_mul_f32 v19, v19, v251
    v_accvgpr_write_b32 a51, v19
    v_accvgpr_read_b32 v18, a52
    v_mul_f32 v18, v18, v248
    v_accvgpr_write_b32 a52, v18
    v_accvgpr_read_b32 v19, a53
    v_mul_f32 v19, v19, v249
    v_accvgpr_write_b32 a53, v19
    v_accvgpr_read_b32 v18, a54
    v_mul_f32 v18, v18, v250
    v_accvgpr_write_b32 a54, v18
    v_accvgpr_read_b32 v19, a55
    v_mul_f32 v19, v19, v251
    v_accvgpr_write_b32 a55, v19
    v_accvgpr_read_b32 v18, a56
    v_mul_f32 v18, v18, v248
    v_accvgpr_write_b32 a56, v18
    v_accvgpr_read_b32 v19, a57
    v_mul_f32 v19, v19, v249
    v_accvgpr_write_b32 a57, v19
    v_accvgpr_read_b32 v18, a58
    v_mul_f32 v18, v18, v250
    v_accvgpr_write_b32 a58, v18
    v_accvgpr_read_b32 v19, a59
    v_mul_f32 v19, v19, v251
    v_accvgpr_write_b32 a59, v19
    v_accvgpr_read_b32 v18, a60
    v_mul_f32 v18, v18, v248
    v_accvgpr_write_b32 a60, v18
    v_accvgpr_read_b32 v19, a61
    v_mul_f32 v19, v19, v249
    v_accvgpr_write_b32 a61, v19
    v_accvgpr_read_b32 v18, a62
    v_mul_f32 v18, v18, v250
    v_accvgpr_write_b32 a62, v18
    v_accvgpr_read_b32 v19, a63
    v_mul_f32 v19, v19, v251
    v_accvgpr_write_b32 a63, v19
    v_accvgpr_read_b32 v18, a64
    v_mul_f32 v18, v18, v248
    v_accvgpr_write_b32 a64, v18
    v_accvgpr_read_b32 v19, a65
    v_mul_f32 v19, v19, v249
    v_accvgpr_write_b32 a65, v19
    v_accvgpr_read_b32 v18, a66
    v_mul_f32 v18, v18, v250
    v_accvgpr_write_b32 a66, v18
    v_accvgpr_read_b32 v19, a67
    v_mul_f32 v19, v19, v251
    v_accvgpr_write_b32 a67, v19
    v_accvgpr_read_b32 v18, a68
    v_mul_f32 v18, v18, v248
    v_accvgpr_write_b32 a68, v18
    v_accvgpr_read_b32 v19, a69
    v_mul_f32 v19, v19, v249
    v_accvgpr_write_b32 a69, v19
    v_accvgpr_read_b32 v18, a70
    v_mul_f32 v18, v18, v250
    v_accvgpr_write_b32 a70, v18
    v_accvgpr_read_b32 v19, a71
    v_mul_f32 v19, v19, v251
    v_accvgpr_write_b32 a71, v19
    v_accvgpr_read_b32 v18, a72
    v_mul_f32 v18, v18, v248
    v_accvgpr_write_b32 a72, v18
    v_accvgpr_read_b32 v19, a73
    v_mul_f32 v19, v19, v249
    v_accvgpr_write_b32 a73, v19
    v_accvgpr_read_b32 v18, a74
    v_mul_f32 v18, v18, v250
    v_accvgpr_write_b32 a74, v18
    v_accvgpr_read_b32 v19, a75
    v_mul_f32 v19, v19, v251
    v_accvgpr_write_b32 a75, v19
    v_accvgpr_read_b32 v18, a76
    v_mul_f32 v18, v18, v248
    v_accvgpr_write_b32 a76, v18
    v_accvgpr_read_b32 v19, a77
    v_mul_f32 v19, v19, v249
    v_accvgpr_write_b32 a77, v19
    v_accvgpr_read_b32 v18, a78
    v_mul_f32 v18, v18, v250
    v_accvgpr_write_b32 a78, v18
    v_accvgpr_read_b32 v19, a79
    v_mul_f32 v19, v19, v251
    v_accvgpr_write_b32 a79, v19
    v_accvgpr_read_b32 v18, a80
    v_mul_f32 v18, v18, v248
    v_accvgpr_write_b32 a80, v18
    v_accvgpr_read_b32 v19, a81
    v_mul_f32 v19, v19, v249
    v_accvgpr_write_b32 a81, v19
    v_accvgpr_read_b32 v18, a82
    v_mul_f32 v18, v18, v250
    v_accvgpr_write_b32 a82, v18
    v_accvgpr_read_b32 v19, a83
    v_mul_f32 v19, v19, v251
    v_accvgpr_write_b32 a83, v19
    v_accvgpr_read_b32 v18, a84
    v_mul_f32 v18, v18, v248
    v_accvgpr_write_b32 a84, v18
    v_accvgpr_read_b32 v19, a85
    v_mul_f32 v19, v19, v249
    v_accvgpr_write_b32 a85, v19
    v_accvgpr_read_b32 v18, a86
    v_mul_f32 v18, v18, v250
    v_accvgpr_write_b32 a86, v18
    v_accvgpr_read_b32 v19, a87
    v_mul_f32 v19, v19, v251
    v_accvgpr_write_b32 a87, v19
    v_accvgpr_read_b32 v18, a88
    v_mul_f32 v18, v18, v248
    v_accvgpr_write_b32 a88, v18
    v_accvgpr_read_b32 v19, a89
    v_mul_f32 v19, v19, v249
    v_accvgpr_write_b32 a89, v19
    v_accvgpr_read_b32 v18, a90
    v_mul_f32 v18, v18, v250
    v_accvgpr_write_b32 a90, v18
    v_accvgpr_read_b32 v19, a91
    v_mul_f32 v19, v19, v251
    v_accvgpr_write_b32 a91, v19
    v_accvgpr_read_b32 v18, a92
    v_mul_f32 v18, v18, v248
    v_accvgpr_write_b32 a92, v18
    v_accvgpr_read_b32 v19, a93
    v_mul_f32 v19, v19, v249
    v_accvgpr_write_b32 a93, v19
    v_accvgpr_read_b32 v18, a94
    v_mul_f32 v18, v18, v250
    v_accvgpr_write_b32 a94, v18
    v_accvgpr_read_b32 v19, a95
    v_mul_f32 v19, v19, v251
    v_accvgpr_write_b32 a95, v19
    v_max3_f32 v16, v176, v177, v178
    v_max3_f32 v16, v16, v179, v180
    v_max3_f32 v16, v16, v181, v182
    v_max3_f32 v16, v16, v183, v242
    v_mov_b32 v17, v16
    s_nop 1
    v_permlane16_swap_b32 v16, v17
    s_nop 1
    v_max_f32 v16, v16, v17
    v_mov_b32 v17, v16
    s_nop 1
    v_permlane32_swap_b32 v16, v17
    s_nop 1
    v_max_f32 v16, v16, v17
    v_sub_f32 v17, v242, v16
    v_exp_f32 v17, v17
    v_mov_b32 v242, v16
    v_sub_f32 v176, v176, v16
    v_sub_f32 v177, v177, v16
    v_sub_f32 v178, v178, v16
    v_sub_f32 v179, v179, v16
    v_sub_f32 v180, v180, v16
    v_sub_f32 v181, v181, v16
    v_sub_f32 v182, v182, v16
    v_sub_f32 v183, v183, v16
    v_exp_f32 v176, v176
    v_exp_f32 v177, v177
    v_exp_f32 v178, v178
    v_exp_f32 v179, v179
    v_exp_f32 v180, v180
    v_exp_f32 v181, v181
    v_exp_f32 v182, v182
    v_exp_f32 v183, v183
    v_mul_f32 v7, v7, v17
    v_add_f32 v7, v7, v176
    v_add_f32 v7, v7, v177
    v_add_f32 v7, v7, v178
    v_add_f32 v7, v7, v179
    v_add_f32 v7, v7, v180
    v_add_f32 v7, v7, v181
    v_add_f32 v7, v7, v182
    v_add_f32 v7, v7, v183
    v_cvt_pk_bf16_f32 v232, v176, v177
    v_cvt_pk_bf16_f32 v233, v178, v179
    v_cvt_pk_bf16_f32 v234, v180, v181
    v_cvt_pk_bf16_f32 v235, v182, v183
    ds_bpermute_b32 v248, v58, v17 offset:0
    ds_bpermute_b32 v249, v58, v17 offset:4
    ds_bpermute_b32 v250, v58, v17 offset:8
    ds_bpermute_b32 v251, v58, v17 offset:12
    s_waitcnt lgkmcnt(0)
    v_accvgpr_read_b32 v18, a96
    v_mul_f32 v18, v18, v248
    v_accvgpr_write_b32 a96, v18
    v_accvgpr_read_b32 v19, a97
    v_mul_f32 v19, v19, v249
    v_accvgpr_write_b32 a97, v19
    v_accvgpr_read_b32 v18, a98
    v_mul_f32 v18, v18, v250
    v_accvgpr_write_b32 a98, v18
    v_accvgpr_read_b32 v19, a99
    v_mul_f32 v19, v19, v251
    v_accvgpr_write_b32 a99, v19
    v_accvgpr_read_b32 v18, a100
    v_mul_f32 v18, v18, v248
    v_accvgpr_write_b32 a100, v18
    v_accvgpr_read_b32 v19, a101
    v_mul_f32 v19, v19, v249
    v_accvgpr_write_b32 a101, v19
    v_accvgpr_read_b32 v18, a102
    v_mul_f32 v18, v18, v250
    v_accvgpr_write_b32 a102, v18
    v_accvgpr_read_b32 v19, a103
    v_mul_f32 v19, v19, v251
    v_accvgpr_write_b32 a103, v19
    v_accvgpr_read_b32 v18, a104
    v_mul_f32 v18, v18, v248
    v_accvgpr_write_b32 a104, v18
    v_accvgpr_read_b32 v19, a105
    v_mul_f32 v19, v19, v249
    v_accvgpr_write_b32 a105, v19
    v_accvgpr_read_b32 v18, a106
    v_mul_f32 v18, v18, v250
    v_accvgpr_write_b32 a106, v18
    v_accvgpr_read_b32 v19, a107
    v_mul_f32 v19, v19, v251
    v_accvgpr_write_b32 a107, v19
    v_accvgpr_read_b32 v18, a108
    v_mul_f32 v18, v18, v248
    v_accvgpr_write_b32 a108, v18
    v_accvgpr_read_b32 v19, a109
    v_mul_f32 v19, v19, v249
    v_accvgpr_write_b32 a109, v19
    v_accvgpr_read_b32 v18, a110
    v_mul_f32 v18, v18, v250
    v_accvgpr_write_b32 a110, v18
    v_accvgpr_read_b32 v19, a111
    v_mul_f32 v19, v19, v251
    v_accvgpr_write_b32 a111, v19
    v_accvgpr_read_b32 v18, a112
    v_mul_f32 v18, v18, v248
    v_accvgpr_write_b32 a112, v18
    v_accvgpr_read_b32 v19, a113
    v_mul_f32 v19, v19, v249
    v_accvgpr_write_b32 a113, v19
    v_accvgpr_read_b32 v18, a114
    v_mul_f32 v18, v18, v250
    v_accvgpr_write_b32 a114, v18
    v_accvgpr_read_b32 v19, a115
    v_mul_f32 v19, v19, v251
    v_accvgpr_write_b32 a115, v19
    v_accvgpr_read_b32 v18, a116
    v_mul_f32 v18, v18, v248
    v_accvgpr_write_b32 a116, v18
    v_accvgpr_read_b32 v19, a117
    v_mul_f32 v19, v19, v249
    v_accvgpr_write_b32 a117, v19
    v_accvgpr_read_b32 v18, a118
    v_mul_f32 v18, v18, v250
    v_accvgpr_write_b32 a118, v18
    v_accvgpr_read_b32 v19, a119
    v_mul_f32 v19, v19, v251
    v_accvgpr_write_b32 a119, v19
    v_accvgpr_read_b32 v18, a120
    v_mul_f32 v18, v18, v248
    v_accvgpr_write_b32 a120, v18
    v_accvgpr_read_b32 v19, a121
    v_mul_f32 v19, v19, v249
    v_accvgpr_write_b32 a121, v19
    v_accvgpr_read_b32 v18, a122
    v_mul_f32 v18, v18, v250
    v_accvgpr_write_b32 a122, v18
    v_accvgpr_read_b32 v19, a123
    v_mul_f32 v19, v19, v251
    v_accvgpr_write_b32 a123, v19
    v_accvgpr_read_b32 v18, a124
    v_mul_f32 v18, v18, v248
    v_accvgpr_write_b32 a124, v18
    v_accvgpr_read_b32 v19, a125
    v_mul_f32 v19, v19, v249
    v_accvgpr_write_b32 a125, v19
    v_accvgpr_read_b32 v18, a126
    v_mul_f32 v18, v18, v250
    v_accvgpr_write_b32 a126, v18
    v_accvgpr_read_b32 v19, a127
    v_mul_f32 v19, v19, v251
    v_accvgpr_write_b32 a127, v19
    v_accvgpr_read_b32 v18, a128
    v_mul_f32 v18, v18, v248
    v_accvgpr_write_b32 a128, v18
    v_accvgpr_read_b32 v19, a129
    v_mul_f32 v19, v19, v249
    v_accvgpr_write_b32 a129, v19
    v_accvgpr_read_b32 v18, a130
    v_mul_f32 v18, v18, v250
    v_accvgpr_write_b32 a130, v18
    v_accvgpr_read_b32 v19, a131
    v_mul_f32 v19, v19, v251
    v_accvgpr_write_b32 a131, v19
    v_accvgpr_read_b32 v18, a132
    v_mul_f32 v18, v18, v248
    v_accvgpr_write_b32 a132, v18
    v_accvgpr_read_b32 v19, a133
    v_mul_f32 v19, v19, v249
    v_accvgpr_write_b32 a133, v19
    v_accvgpr_read_b32 v18, a134
    v_mul_f32 v18, v18, v250
    v_accvgpr_write_b32 a134, v18
    v_accvgpr_read_b32 v19, a135
    v_mul_f32 v19, v19, v251
    v_accvgpr_write_b32 a135, v19
    v_accvgpr_read_b32 v18, a136
    v_mul_f32 v18, v18, v248
    v_accvgpr_write_b32 a136, v18
    v_accvgpr_read_b32 v19, a137
    v_mul_f32 v19, v19, v249
    v_accvgpr_write_b32 a137, v19
    v_accvgpr_read_b32 v18, a138
    v_mul_f32 v18, v18, v250
    v_accvgpr_write_b32 a138, v18
    v_accvgpr_read_b32 v19, a139
    v_mul_f32 v19, v19, v251
    v_accvgpr_write_b32 a139, v19
    v_accvgpr_read_b32 v18, a140
    v_mul_f32 v18, v18, v248
    v_accvgpr_write_b32 a140, v18
    v_accvgpr_read_b32 v19, a141
    v_mul_f32 v19, v19, v249
    v_accvgpr_write_b32 a141, v19
    v_accvgpr_read_b32 v18, a142
    v_mul_f32 v18, v18, v250
    v_accvgpr_write_b32 a142, v18
    v_accvgpr_read_b32 v19, a143
    v_mul_f32 v19, v19, v251
    v_accvgpr_write_b32 a143, v19
    v_max3_f32 v16, v184, v185, v186
    v_max3_f32 v16, v16, v187, v188
    v_max3_f32 v16, v16, v189, v190
    v_max3_f32 v16, v16, v191, v243
    v_mov_b32 v17, v16
    s_nop 1
    v_permlane16_swap_b32 v16, v17
    s_nop 1
    v_max_f32 v16, v16, v17
    v_mov_b32 v17, v16
    s_nop 1
    v_permlane32_swap_b32 v16, v17
    s_nop 1
    v_max_f32 v16, v16, v17
    v_sub_f32 v17, v243, v16
    v_exp_f32 v17, v17
    v_mov_b32 v243, v16
    v_sub_f32 v184, v184, v16
    v_sub_f32 v185, v185, v16
    v_sub_f32 v186, v186, v16
    v_sub_f32 v187, v187, v16
    v_sub_f32 v188, v188, v16
    v_sub_f32 v189, v189, v16
    v_sub_f32 v190, v190, v16
    v_sub_f32 v191, v191, v16
    v_exp_f32 v184, v184
    v_exp_f32 v185, v185
    v_exp_f32 v186, v186
    v_exp_f32 v187, v187
    v_exp_f32 v188, v188
    v_exp_f32 v189, v189
    v_exp_f32 v190, v190
    v_exp_f32 v191, v191
    v_mul_f32 v8, v8, v17
    v_add_f32 v8, v8, v184
    v_add_f32 v8, v8, v185
    v_add_f32 v8, v8, v186
    v_add_f32 v8, v8, v187
    v_add_f32 v8, v8, v188
    v_add_f32 v8, v8, v189
    v_add_f32 v8, v8, v190
    v_add_f32 v8, v8, v191
    v_cvt_pk_bf16_f32 v236, v184, v185
    v_cvt_pk_bf16_f32 v237, v186, v187
    v_cvt_pk_bf16_f32 v238, v188, v189
    v_cvt_pk_bf16_f32 v239, v190, v191
    ds_bpermute_b32 v248, v58, v17 offset:0
    ds_bpermute_b32 v249, v58, v17 offset:4
    ds_bpermute_b32 v250, v58, v17 offset:8
    ds_bpermute_b32 v251, v58, v17 offset:12
    s_waitcnt lgkmcnt(0)
    v_accvgpr_read_b32 v18, a144
    v_mul_f32 v18, v18, v248
    v_accvgpr_write_b32 a144, v18
    v_accvgpr_read_b32 v19, a145
    v_mul_f32 v19, v19, v249
    v_accvgpr_write_b32 a145, v19
    v_accvgpr_read_b32 v18, a146
    v_mul_f32 v18, v18, v250
    v_accvgpr_write_b32 a146, v18
    v_accvgpr_read_b32 v19, a147
    v_mul_f32 v19, v19, v251
    v_accvgpr_write_b32 a147, v19
    v_accvgpr_read_b32 v18, a148
    v_mul_f32 v18, v18, v248
    v_accvgpr_write_b32 a148, v18
    v_accvgpr_read_b32 v19, a149
    v_mul_f32 v19, v19, v249
    v_accvgpr_write_b32 a149, v19
    v_accvgpr_read_b32 v18, a150
    v_mul_f32 v18, v18, v250
    v_accvgpr_write_b32 a150, v18
    v_accvgpr_read_b32 v19, a151
    v_mul_f32 v19, v19, v251
    v_accvgpr_write_b32 a151, v19
    v_accvgpr_read_b32 v18, a152
    v_mul_f32 v18, v18, v248
    v_accvgpr_write_b32 a152, v18
    v_accvgpr_read_b32 v19, a153
    v_mul_f32 v19, v19, v249
    v_accvgpr_write_b32 a153, v19
    v_accvgpr_read_b32 v18, a154
    v_mul_f32 v18, v18, v250
    v_accvgpr_write_b32 a154, v18
    v_accvgpr_read_b32 v19, a155
    v_mul_f32 v19, v19, v251
    v_accvgpr_write_b32 a155, v19
    v_accvgpr_read_b32 v18, a156
    v_mul_f32 v18, v18, v248
    v_accvgpr_write_b32 a156, v18
    v_accvgpr_read_b32 v19, a157
    v_mul_f32 v19, v19, v249
    v_accvgpr_write_b32 a157, v19
    v_accvgpr_read_b32 v18, a158
    v_mul_f32 v18, v18, v250
    v_accvgpr_write_b32 a158, v18
    v_accvgpr_read_b32 v19, a159
    v_mul_f32 v19, v19, v251
    v_accvgpr_write_b32 a159, v19
    v_accvgpr_read_b32 v18, a160
    v_mul_f32 v18, v18, v248
    v_accvgpr_write_b32 a160, v18
    v_accvgpr_read_b32 v19, a161
    v_mul_f32 v19, v19, v249
    v_accvgpr_write_b32 a161, v19
    v_accvgpr_read_b32 v18, a162
    v_mul_f32 v18, v18, v250
    v_accvgpr_write_b32 a162, v18
    v_accvgpr_read_b32 v19, a163
    v_mul_f32 v19, v19, v251
    v_accvgpr_write_b32 a163, v19
    v_accvgpr_read_b32 v18, a164
    v_mul_f32 v18, v18, v248
    v_accvgpr_write_b32 a164, v18
    v_accvgpr_read_b32 v19, a165
    v_mul_f32 v19, v19, v249
    v_accvgpr_write_b32 a165, v19
    v_accvgpr_read_b32 v18, a166
    v_mul_f32 v18, v18, v250
    v_accvgpr_write_b32 a166, v18
    v_accvgpr_read_b32 v19, a167
    v_mul_f32 v19, v19, v251
    v_accvgpr_write_b32 a167, v19
    v_accvgpr_read_b32 v18, a168
    v_mul_f32 v18, v18, v248
    v_accvgpr_write_b32 a168, v18
    v_accvgpr_read_b32 v19, a169
    v_mul_f32 v19, v19, v249
    v_accvgpr_write_b32 a169, v19
    v_accvgpr_read_b32 v18, a170
    v_mul_f32 v18, v18, v250
    v_accvgpr_write_b32 a170, v18
    v_accvgpr_read_b32 v19, a171
    v_mul_f32 v19, v19, v251
    v_accvgpr_write_b32 a171, v19
    v_accvgpr_read_b32 v18, a172
    v_mul_f32 v18, v18, v248
    v_accvgpr_write_b32 a172, v18
    v_accvgpr_read_b32 v19, a173
    v_mul_f32 v19, v19, v249
    v_accvgpr_write_b32 a173, v19
    v_accvgpr_read_b32 v18, a174
    v_mul_f32 v18, v18, v250
    v_accvgpr_write_b32 a174, v18
    v_accvgpr_read_b32 v19, a175
    v_mul_f32 v19, v19, v251
    v_accvgpr_write_b32 a175, v19
    v_accvgpr_read_b32 v18, a176
    v_mul_f32 v18, v18, v248
    v_accvgpr_write_b32 a176, v18
    v_accvgpr_read_b32 v19, a177
    v_mul_f32 v19, v19, v249
    v_accvgpr_write_b32 a177, v19
    v_accvgpr_read_b32 v18, a178
    v_mul_f32 v18, v18, v250
    v_accvgpr_write_b32 a178, v18
    v_accvgpr_read_b32 v19, a179
    v_mul_f32 v19, v19, v251
    v_accvgpr_write_b32 a179, v19
    v_accvgpr_read_b32 v18, a180
    v_mul_f32 v18, v18, v248
    v_accvgpr_write_b32 a180, v18
    v_accvgpr_read_b32 v19, a181
    v_mul_f32 v19, v19, v249
    v_accvgpr_write_b32 a181, v19
    v_accvgpr_read_b32 v18, a182
    v_mul_f32 v18, v18, v250
    v_accvgpr_write_b32 a182, v18
    v_accvgpr_read_b32 v19, a183
    v_mul_f32 v19, v19, v251
    v_accvgpr_write_b32 a183, v19
    v_accvgpr_read_b32 v18, a184
    v_mul_f32 v18, v18, v248
    v_accvgpr_write_b32 a184, v18
    v_accvgpr_read_b32 v19, a185
    v_mul_f32 v19, v19, v249
    v_accvgpr_write_b32 a185, v19
    v_accvgpr_read_b32 v18, a186
    v_mul_f32 v18, v18, v250
    v_accvgpr_write_b32 a186, v18
    v_accvgpr_read_b32 v19, a187
    v_mul_f32 v19, v19, v251
    v_accvgpr_write_b32 a187, v19
    v_accvgpr_read_b32 v18, a188
    v_mul_f32 v18, v18, v248
    v_accvgpr_write_b32 a188, v18
    v_accvgpr_read_b32 v19, a189
    v_mul_f32 v19, v19, v249
    v_accvgpr_write_b32 a189, v19
    v_accvgpr_read_b32 v18, a190
    v_mul_f32 v18, v18, v250
    v_accvgpr_write_b32 a190, v18
    v_accvgpr_read_b32 v19, a191
    v_mul_f32 v19, v19, v251
    v_accvgpr_write_b32 a191, v19
    s_waitcnt vmcnt(0)
    s_nop 1
    v_mfma_f32_16x16x32_bf16 a[0:3], v[224:227], v[112:115], a[0:3]
    v_mfma_f32_16x16x32_bf16 a[48:51], v[228:231], v[112:115], a[48:51]
    v_mfma_f32_16x16x32_bf16 a[96:99], v[232:235], v[112:115], a[96:99]
    v_mfma_f32_16x16x32_bf16 a[144:147], v[236:239], v[112:115], a[144:147]
    v_mfma_f32_16x16x32_bf16 a[4:7], v[224:227], v[116:119], a[4:7]
    v_mfma_f32_16x16x32_bf16 a[52:55], v[228:231], v[116:119], a[52:55]
    v_mfma_f32_16x16x32_bf16 a[100:103], v[232:235], v[116:119], a[100:103]
    v_mfma_f32_16x16x32_bf16 a[148:151], v[236:239], v[116:119], a[148:151]
    v_mfma_f32_16x16x32_bf16 a[8:11], v[224:227], v[120:123], a[8:11]
    v_mfma_f32_16x16x32_bf16 a[56:59], v[228:231], v[120:123], a[56:59]
    v_mfma_f32_16x16x32_bf16 a[104:107], v[232:235], v[120:123], a[104:107]
    v_mfma_f32_16x16x32_bf16 a[152:155], v[236:239], v[120:123], a[152:155]
    v_mfma_f32_16x16x32_bf16 a[12:15], v[224:227], v[124:127], a[12:15]
    v_mfma_f32_16x16x32_bf16 a[60:63], v[228:231], v[124:127], a[60:63]
    v_mfma_f32_16x16x32_bf16 a[108:111], v[232:235], v[124:127], a[108:111]
    v_mfma_f32_16x16x32_bf16 a[156:159], v[236:239], v[124:127], a[156:159]
    v_mfma_f32_16x16x32_bf16 a[16:19], v[224:227], v[128:131], a[16:19]
    v_mfma_f32_16x16x32_bf16 a[64:67], v[228:231], v[128:131], a[64:67]
    v_mfma_f32_16x16x32_bf16 a[112:115], v[232:235], v[128:131], a[112:115]
    v_mfma_f32_16x16x32_bf16 a[160:163], v[236:239], v[128:131], a[160:163]
    v_mfma_f32_16x16x32_bf16 a[20:23], v[224:227], v[132:135], a[20:23]
    v_mfma_f32_16x16x32_bf16 a[68:71], v[228:231], v[132:135], a[68:71]
    v_mfma_f32_16x16x32_bf16 a[116:119], v[232:235], v[132:135], a[116:119]
    v_mfma_f32_16x16x32_bf16 a[164:167], v[236:239], v[132:135], a[164:167]
    v_mfma_f32_16x16x32_bf16 a[24:27], v[224:227], v[136:139], a[24:27]
    v_mfma_f32_16x16x32_bf16 a[72:75], v[228:231], v[136:139], a[72:75]
    v_mfma_f32_16x16x32_bf16 a[120:123], v[232:235], v[136:139], a[120:123]
    v_mfma_f32_16x16x32_bf16 a[168:171], v[236:239], v[136:139], a[168:171]
    v_mfma_f32_16x16x32_bf16 a[28:31], v[224:227], v[140:143], a[28:31]
    v_mfma_f32_16x16x32_bf16 a[76:79], v[228:231], v[140:143], a[76:79]
    v_mfma_f32_16x16x32_bf16 a[124:127], v[232:235], v[140:143], a[124:127]
    v_mfma_f32_16x16x32_bf16 a[172:175], v[236:239], v[140:143], a[172:175]
    v_mfma_f32_16x16x32_bf16 a[32:35], v[224:227], v[144:147], a[32:35]
    v_mfma_f32_16x16x32_bf16 a[80:83], v[228:231], v[144:147], a[80:83]
    v_mfma_f32_16x16x32_bf16 a[128:131], v[232:235], v[144:147], a[128:131]
    v_mfma_f32_16x16x32_bf16 a[176:179], v[236:239], v[144:147], a[176:179]
    v_mfma_f32_16x16x32_bf16 a[36:39], v[224:227], v[148:151], a[36:39]
    v_mfma_f32_16x16x32_bf16 a[84:87], v[228:231], v[148:151], a[84:87]
    v_mfma_f32_16x16x32_bf16 a[132:135], v[232:235], v[148:151], a[132:135]
    v_mfma_f32_16x16x32_bf16 a[180:183], v[236:239], v[148:151], a[180:183]
    v_mfma_f32_16x16x32_bf16 a[40:43], v[224:227], v[152:155], a[40:43]
    v_mfma_f32_16x16x32_bf16 a[88:91], v[228:231], v[152:155], a[88:91]
    v_mfma_f32_16x16x32_bf16 a[136:139], v[232:235], v[152:155], a[136:139]
    v_mfma_f32_16x16x32_bf16 a[184:187], v[236:239], v[152:155], a[184:187]
    v_mfma_f32_16x16x32_bf16 a[44:47], v[224:227], v[156:159], a[44:47]
    v_mfma_f32_16x16x32_bf16 a[92:95], v[228:231], v[156:159], a[92:95]
    v_mfma_f32_16x16x32_bf16 a[140:143], v[232:235], v[156:159], a[140:143]
    v_mfma_f32_16x16x32_bf16 a[188:191], v[236:239], v[156:159], a[188:191]
    s_add_u32 s48, s48, 24576
    s_cmp_lt_u32 s48, 1572864
    s_nop 7
    s_cbranch_scc1 L_slowloop
    s_nop 1
    v_mfma_f32_16x16x4_f32 v[48:51], v5, v57, 0
    v_mfma_f32_16x16x4_f32 v[52:55], v6, v57, 0
    s_nop 7
    s_nop 1
    v_rcp_f32 v48, v48
    v_rcp_f32 v49, v49
    v_rcp_f32 v50, v50
    v_rcp_f32 v51, v51
    v_rcp_f32 v52, v52
    v_rcp_f32 v53, v53
    v_rcp_f32 v54, v54
    v_rcp_f32 v55, v55
    v_mfma_f32_16x16x4_f32 v[128:131], v7, v57, 0
    v_mfma_f32_16x16x4_f32 v[132:135], v8, v57, 0
    s_nop 7
    s_nop 1
    v_rcp_f32 v128, v128
    v_rcp_f32 v129, v129
    v_rcp_f32 v130, v130
    v_rcp_f32 v131, v131
    v_rcp_f32 v132, v132
    v_rcp_f32 v133, v133
    v_rcp_f32 v134, v134
    v_rcp_f32 v135, v135
    s_nop 0
    v_accvgpr_read_b32 v64, a0
    v_accvgpr_read_b32 v65, a12
    v_accvgpr_read_b32 v66, a24
    v_accvgpr_read_b32 v67, a36
    v_pk_mul_f32 v[64:65], v[64:65], v[48:49] op_sel_hi:[1,0]
    v_pk_mul_f32 v[66:67], v[66:67], v[48:49] op_sel_hi:[1,0]
    v_cvt_pk_bf16_f32 v64, v64, v65
    v_cvt_pk_bf16_f32 v65, v66, v67
    v_accvgpr_read_b32 v68, a1
    v_accvgpr_read_b32 v69, a13
    v_accvgpr_read_b32 v70, a25
    v_accvgpr_read_b32 v71, a37
    v_pk_mul_f32 v[68:69], v[68:69], v[48:49] op_sel:[0,1] op_sel_hi:[1,1]
    v_pk_mul_f32 v[70:71], v[70:71], v[48:49] op_sel:[0,1] op_sel_hi:[1,1]
    v_cvt_pk_bf16_f32 v68, v68, v69
    v_cvt_pk_bf16_f32 v69, v70, v71
    buffer_store_dwordx2 v[64:65], v56, s[12:15], s24 offen offset:0 sc0 sc1
    v_accvgpr_read_b32 v72, a2
    v_accvgpr_read_b32 v73, a14
    v_accvgpr_read_b32 v74, a26
    v_accvgpr_read_b32 v75, a38
    v_pk_mul_f32 v[72:73], v[72:73], v[50:51] op_sel_hi:[1,0]
    v_pk_mul_f32 v[74:75], v[74:75], v[50:51] op_sel_hi:[1,0]
    v_cvt_pk_bf16_f32 v72, v72, v73
    v_cvt_pk_bf16_f32 v73, v74, v75
    buffer_store_dwordx2 v[68:69], v56, s[12:15], s24 offen offset:384 sc0 sc1
    v_accvgpr_read_b32 v76, a3
    v_accvgpr_read_b32 v77, a15
    v_accvgpr_read_b32 v78, a27
    v_accvgpr_read_b32 v79, a39
    v_pk_mul_f32 v[76:77], v[76:77], v[50:51] op_sel:[0,1] op_sel_hi:[1,1]
    v_pk_mul_f32 v[78:79], v[78:79], v[50:51] op_sel:[0,1] op_sel_hi:[1,1]
    v_cvt_pk_bf16_f32 v76, v76, v77
    v_cvt_pk_bf16_f32 v77, v78, v79
    buffer_store_dwordx2 v[72:73], v56, s[12:15], s24 offen offset:768 sc0 sc1
    v_accvgpr_read_b32 v80, a4
    v_accvgpr_read_b32 v81, a16
    v_accvgpr_read_b32 v82, a28
    v_accvgpr_read_b32 v83, a40
    v_pk_mul_f32 v[80:81], v[80:81], v[48:49] op_sel_hi:[1,0]
    v_pk_mul_f32 v[82:83], v[82:83], v[48:49] op_sel_hi:[1,0]
    v_cvt_pk_bf16_f32 v80, v80, v81
    v_cvt_pk_bf16_f32 v81, v82, v83
    buffer_store_dwordx2 v[76:77], v56, s[12:15], s24 offen offset:1152 sc0 sc1
    v_accvgpr_read_b32 v84, a5
    v_accvgpr_read_b32 v85, a17
    v_accvgpr_read_b32 v86, a29
    v_accvgpr_read_b32 v87, a41
    v_pk_mul_f32 v[84:85], v[84:85], v[48:49] op_sel:[0,1] op_sel_hi:[1,1]
    v_pk_mul_f32 v[86:87], v[86:87], v[48:49] op_sel:[0,1] op_sel_hi:[1,1]
    v_cvt_pk_bf16_f32 v84, v84, v85
    v_cvt_pk_bf16_f32 v85, v86, v87
    buffer_store_dwordx2 v[80:81], v56, s[12:15], s24 offen offset:128 sc0 sc1
    v_accvgpr_read_b32 v88, a6
    v_accvgpr_read_b32 v89, a18
    v_accvgpr_read_b32 v90, a30
    v_accvgpr_read_b32 v91, a42
    v_pk_mul_f32 v[88:89], v[88:89], v[50:51] op_sel_hi:[1,0]
    v_pk_mul_f32 v[90:91], v[90:91], v[50:51] op_sel_hi:[1,0]
    v_cvt_pk_bf16_f32 v88, v88, v89
    v_cvt_pk_bf16_f32 v89, v90, v91
    buffer_store_dwordx2 v[84:85], v56, s[12:15], s24 offen offset:512 sc0 sc1
    v_accvgpr_read_b32 v92, a7
    v_accvgpr_read_b32 v93, a19
    v_accvgpr_read_b32 v94, a31
    v_accvgpr_read_b32 v95, a43
    v_pk_mul_f32 v[92:93], v[92:93], v[50:51] op_sel:[0,1] op_sel_hi:[1,1]
    v_pk_mul_f32 v[94:95], v[94:95], v[50:51] op_sel:[0,1] op_sel_hi:[1,1]
    v_cvt_pk_bf16_f32 v92, v92, v93
    v_cvt_pk_bf16_f32 v93, v94, v95
    buffer_store_dwordx2 v[88:89], v56, s[12:15], s24 offen offset:896 sc0 sc1
    v_accvgpr_read_b32 v96, a8
    v_accvgpr_read_b32 v97, a20
    v_accvgpr_read_b32 v98, a32
    v_accvgpr_read_b32 v99, a44
    v_pk_mul_f32 v[96:97], v[96:97], v[48:49] op_sel_hi:[1,0]
    v_pk_mul_f32 v[98:99], v[98:99], v[48:49] op_sel_hi:[1,0]
    v_cvt_pk_bf16_f32 v96, v96, v97
    v_cvt_pk_bf16_f32 v97, v98, v99
    buffer_store_dwordx2 v[92:93], v56, s[12:15], s24 offen offset:1280 sc0 sc1
    v_accvgpr_read_b32 v100, a9
    v_accvgpr_read_b32 v101, a21
    v_accvgpr_read_b32 v102, a33
    v_accvgpr_read_b32 v103, a45
    v_pk_mul_f32 v[100:101], v[100:101], v[48:49] op_sel:[0,1] op_sel_hi:[1,1]
    v_pk_mul_f32 v[102:103], v[102:103], v[48:49] op_sel:[0,1] op_sel_hi:[1,1]
    v_cvt_pk_bf16_f32 v100, v100, v101
    v_cvt_pk_bf16_f32 v101, v102, v103
    buffer_store_dwordx2 v[96:97], v56, s[12:15], s24 offen offset:256 sc0 sc1
    v_accvgpr_read_b32 v104, a10
    v_accvgpr_read_b32 v105, a22
    v_accvgpr_read_b32 v106, a34
    v_accvgpr_read_b32 v107, a46
    v_pk_mul_f32 v[104:105], v[104:105], v[50:51] op_sel_hi:[1,0]
    v_pk_mul_f32 v[106:107], v[106:107], v[50:51] op_sel_hi:[1,0]
    v_cvt_pk_bf16_f32 v104, v104, v105
    v_cvt_pk_bf16_f32 v105, v106, v107
    buffer_store_dwordx2 v[100:101], v56, s[12:15], s24 offen offset:640 sc0 sc1
    v_accvgpr_read_b32 v108, a11
    v_accvgpr_read_b32 v109, a23
    v_accvgpr_read_b32 v110, a35
    v_accvgpr_read_b32 v111, a47
    v_pk_mul_f32 v[108:109], v[108:109], v[50:51] op_sel:[0,1] op_sel_hi:[1,1]
    v_pk_mul_f32 v[110:111], v[110:111], v[50:51] op_sel:[0,1] op_sel_hi:[1,1]
    v_cvt_pk_bf16_f32 v108, v108, v109
    v_cvt_pk_bf16_f32 v109, v110, v111
    buffer_store_dwordx2 v[104:105], v56, s[12:15], s24 offen offset:1024 sc0 sc1
    v_accvgpr_read_b32 v112, a48
    v_accvgpr_read_b32 v113, a60
    v_accvgpr_read_b32 v114, a72
    v_accvgpr_read_b32 v115, a84
    v_pk_mul_f32 v[112:113], v[112:113], v[52:53] op_sel_hi:[1,0]
    v_pk_mul_f32 v[114:115], v[114:115], v[52:53] op_sel_hi:[1,0]
    v_cvt_pk_bf16_f32 v112, v112, v113
    v_cvt_pk_bf16_f32 v113, v114, v115
    buffer_store_dwordx2 v[108:109], v56, s[12:15], s24 offen offset:1408 sc0 sc1
    v_accvgpr_read_b32 v116, a49
    v_accvgpr_read_b32 v117, a61
    v_accvgpr_read_b32 v118, a73
    v_accvgpr_read_b32 v119, a85
    v_pk_mul_f32 v[116:117], v[116:117], v[52:53] op_sel:[0,1] op_sel_hi:[1,1]
    v_pk_mul_f32 v[118:119], v[118:119], v[52:53] op_sel:[0,1] op_sel_hi:[1,1]
    v_cvt_pk_bf16_f32 v116, v116, v117
    v_cvt_pk_bf16_f32 v117, v118, v119
    buffer_store_dwordx2 v[112:113], v56, s[12:15], s40 offen offset:0 sc0 sc1
    v_accvgpr_read_b32 v120, a50
    v_accvgpr_read_b32 v121, a62
    v_accvgpr_read_b32 v122, a74
    v_accvgpr_read_b32 v123, a86
    v_pk_mul_f32 v[120:121], v[120:121], v[54:55] op_sel_hi:[1,0]
    v_pk_mul_f32 v[122:123], v[122:123], v[54:55] op_sel_hi:[1,0]
    v_cvt_pk_bf16_f32 v120, v120, v121
    v_cvt_pk_bf16_f32 v121, v122, v123
    buffer_store_dwordx2 v[116:117], v56, s[12:15], s40 offen offset:384 sc0 sc1
    v_accvgpr_read_b32 v124, a51
    v_accvgpr_read_b32 v125, a63
    v_accvgpr_read_b32 v126, a75
    v_accvgpr_read_b32 v127, a87
    v_pk_mul_f32 v[124:125], v[124:125], v[54:55] op_sel:[0,1] op_sel_hi:[1,1]
    v_pk_mul_f32 v[126:127], v[126:127], v[54:55] op_sel:[0,1] op_sel_hi:[1,1]
    v_cvt_pk_bf16_f32 v124, v124, v125
    v_cvt_pk_bf16_f32 v125, v126, v127
    buffer_store_dwordx2 v[120:121], v56, s[12:15], s40 offen offset:768 sc0 sc1
    v_accvgpr_read_b32 v64, a52
    v_accvgpr_read_b32 v65, a64
    v_accvgpr_read_b32 v66, a76
    v_accvgpr_read_b32 v67, a88
    v_pk_mul_f32 v[64:65], v[64:65], v[52:53] op_sel_hi:[1,0]
    v_pk_mul_f32 v[66:67], v[66:67], v[52:53] op_sel_hi:[1,0]
    v_cvt_pk_bf16_f32 v64, v64, v65
    v_cvt_pk_bf16_f32 v65, v66, v67
    buffer_store_dwordx2 v[124:125], v56, s[12:15], s40 offen offset:1152 sc0 sc1
    v_accvgpr_read_b32 v68, a53
    v_accvgpr_read_b32 v69, a65
    v_accvgpr_read_b32 v70, a77
    v_accvgpr_read_b32 v71, a89
    v_pk_mul_f32 v[68:69], v[68:69], v[52:53] op_sel:[0,1] op_sel_hi:[1,1]
    v_pk_mul_f32 v[70:71], v[70:71], v[52:53] op_sel:[0,1] op_sel_hi:[1,1]
    v_cvt_pk_bf16_f32 v68, v68, v69
    v_cvt_pk_bf16_f32 v69, v70, v71
    buffer_store_dwordx2 v[64:65], v56, s[12:15], s40 offen offset:128 sc0 sc1
    v_accvgpr_read_b32 v72, a54
    v_accvgpr_read_b32 v73, a66
    v_accvgpr_read_b32 v74, a78
    v_accvgpr_read_b32 v75, a90
    v_pk_mul_f32 v[72:73], v[72:73], v[54:55] op_sel_hi:[1,0]
    v_pk_mul_f32 v[74:75], v[74:75], v[54:55] op_sel_hi:[1,0]
    v_cvt_pk_bf16_f32 v72, v72, v73
    v_cvt_pk_bf16_f32 v73, v74, v75
    buffer_store_dwordx2 v[68:69], v56, s[12:15], s40 offen offset:512 sc0 sc1
    v_accvgpr_read_b32 v76, a55
    v_accvgpr_read_b32 v77, a67
    v_accvgpr_read_b32 v78, a79
    v_accvgpr_read_b32 v79, a91
    v_pk_mul_f32 v[76:77], v[76:77], v[54:55] op_sel:[0,1] op_sel_hi:[1,1]
    v_pk_mul_f32 v[78:79], v[78:79], v[54:55] op_sel:[0,1] op_sel_hi:[1,1]
    v_cvt_pk_bf16_f32 v76, v76, v77
    v_cvt_pk_bf16_f32 v77, v78, v79
    buffer_store_dwordx2 v[72:73], v56, s[12:15], s40 offen offset:896 sc0 sc1
    v_accvgpr_read_b32 v80, a56
    v_accvgpr_read_b32 v81, a68
    v_accvgpr_read_b32 v82, a80
    v_accvgpr_read_b32 v83, a92
    v_pk_mul_f32 v[80:81], v[80:81], v[52:53] op_sel_hi:[1,0]
    v_pk_mul_f32 v[82:83], v[82:83], v[52:53] op_sel_hi:[1,0]
    v_cvt_pk_bf16_f32 v80, v80, v81
    v_cvt_pk_bf16_f32 v81, v82, v83
    buffer_store_dwordx2 v[76:77], v56, s[12:15], s40 offen offset:1280 sc0 sc1
    v_accvgpr_read_b32 v84, a57
    v_accvgpr_read_b32 v85, a69
    v_accvgpr_read_b32 v86, a81
    v_accvgpr_read_b32 v87, a93
    v_pk_mul_f32 v[84:85], v[84:85], v[52:53] op_sel:[0,1] op_sel_hi:[1,1]
    v_pk_mul_f32 v[86:87], v[86:87], v[52:53] op_sel:[0,1] op_sel_hi:[1,1]
    v_cvt_pk_bf16_f32 v84, v84, v85
    v_cvt_pk_bf16_f32 v85, v86, v87
    buffer_store_dwordx2 v[80:81], v56, s[12:15], s40 offen offset:256 sc0 sc1
    v_accvgpr_read_b32 v88, a58
    v_accvgpr_read_b32 v89, a70
    v_accvgpr_read_b32 v90, a82
    v_accvgpr_read_b32 v91, a94
    v_pk_mul_f32 v[88:89], v[88:89], v[54:55] op_sel_hi:[1,0]
    v_pk_mul_f32 v[90:91], v[90:91], v[54:55] op_sel_hi:[1,0]
    v_cvt_pk_bf16_f32 v88, v88, v89
    v_cvt_pk_bf16_f32 v89, v90, v91
    buffer_store_dwordx2 v[84:85], v56, s[12:15], s40 offen offset:640 sc0 sc1
    v_accvgpr_read_b32 v92, a59
    v_accvgpr_read_b32 v93, a71
    v_accvgpr_read_b32 v94, a83
    v_accvgpr_read_b32 v95, a95
    v_pk_mul_f32 v[92:93], v[92:93], v[54:55] op_sel:[0,1] op_sel_hi:[1,1]
    v_pk_mul_f32 v[94:95], v[94:95], v[54:55] op_sel:[0,1] op_sel_hi:[1,1]
    v_cvt_pk_bf16_f32 v92, v92, v93
    v_cvt_pk_bf16_f32 v93, v94, v95
    buffer_store_dwordx2 v[88:89], v56, s[12:15], s40 offen offset:1024 sc0 sc1
    v_accvgpr_read_b32 v96, a96
    v_accvgpr_read_b32 v97, a108
    v_accvgpr_read_b32 v98, a120
    v_accvgpr_read_b32 v99, a132
    v_pk_mul_f32 v[96:97], v[96:97], v[128:129] op_sel_hi:[1,0]
    v_pk_mul_f32 v[98:99], v[98:99], v[128:129] op_sel_hi:[1,0]
    v_cvt_pk_bf16_f32 v96, v96, v97
    v_cvt_pk_bf16_f32 v97, v98, v99
    buffer_store_dwordx2 v[92:93], v56, s[12:15], s40 offen offset:1408 sc0 sc1
    v_accvgpr_read_b32 v100, a97
    v_accvgpr_read_b32 v101, a109
    v_accvgpr_read_b32 v102, a121
    v_accvgpr_read_b32 v103, a133
    v_pk_mul_f32 v[100:101], v[100:101], v[128:129] op_sel:[0,1] op_sel_hi:[1,1]
    v_pk_mul_f32 v[102:103], v[102:103], v[128:129] op_sel:[0,1] op_sel_hi:[1,1]
    v_cvt_pk_bf16_f32 v100, v100, v101
    v_cvt_pk_bf16_f32 v101, v102, v103
    buffer_store_dwordx2 v[96:97], v56, s[12:15], s41 offen offset:0 sc0 sc1
    v_accvgpr_read_b32 v104, a98
    v_accvgpr_read_b32 v105, a110
    v_accvgpr_read_b32 v106, a122
    v_accvgpr_read_b32 v107, a134
    v_pk_mul_f32 v[104:105], v[104:105], v[130:131] op_sel_hi:[1,0]
    v_pk_mul_f32 v[106:107], v[106:107], v[130:131] op_sel_hi:[1,0]
    v_cvt_pk_bf16_f32 v104, v104, v105
    v_cvt_pk_bf16_f32 v105, v106, v107
    buffer_store_dwordx2 v[100:101], v56, s[12:15], s41 offen offset:384 sc0 sc1
    v_accvgpr_read_b32 v108, a99
    v_accvgpr_read_b32 v109, a111
    v_accvgpr_read_b32 v110, a123
    v_accvgpr_read_b32 v111, a135
    v_pk_mul_f32 v[108:109], v[108:109], v[130:131] op_sel:[0,1] op_sel_hi:[1,1]
    v_pk_mul_f32 v[110:111], v[110:111], v[130:131] op_sel:[0,1] op_sel_hi:[1,1]
    v_cvt_pk_bf16_f32 v108, v108, v109
    v_cvt_pk_bf16_f32 v109, v110, v111
    buffer_store_dwordx2 v[104:105], v56, s[12:15], s41 offen offset:768 sc0 sc1
    v_accvgpr_read_b32 v112, a100
    v_accvgpr_read_b32 v113, a112
    v_accvgpr_read_b32 v114, a124
    v_accvgpr_read_b32 v115, a136
    v_pk_mul_f32 v[112:113], v[112:113], v[128:129] op_sel_hi:[1,0]
    v_pk_mul_f32 v[114:115], v[114:115], v[128:129] op_sel_hi:[1,0]
    v_cvt_pk_bf16_f32 v112, v112, v113
    v_cvt_pk_bf16_f32 v113, v114, v115
    buffer_store_dwordx2 v[108:109], v56, s[12:15], s41 offen offset:1152 sc0 sc1
    v_accvgpr_read_b32 v116, a101
    v_accvgpr_read_b32 v117, a113
    v_accvgpr_read_b32 v118, a125
    v_accvgpr_read_b32 v119, a137
    v_pk_mul_f32 v[116:117], v[116:117], v[128:129] op_sel:[0,1] op_sel_hi:[1,1]
    v_pk_mul_f32 v[118:119], v[118:119], v[128:129] op_sel:[0,1] op_sel_hi:[1,1]
    v_cvt_pk_bf16_f32 v116, v116, v117
    v_cvt_pk_bf16_f32 v117, v118, v119
    buffer_store_dwordx2 v[112:113], v56, s[12:15], s41 offen offset:128 sc0 sc1
    v_accvgpr_read_b32 v120, a102
    v_accvgpr_read_b32 v121, a114
    v_accvgpr_read_b32 v122, a126
    v_accvgpr_read_b32 v123, a138
    v_pk_mul_f32 v[120:121], v[120:121], v[130:131] op_sel_hi:[1,0]
    v_pk_mul_f32 v[122:123], v[122:123], v[130:131] op_sel_hi:[1,0]
    v_cvt_pk_bf16_f32 v120, v120, v121
    v_cvt_pk_bf16_f32 v121, v122, v123
    buffer_store_dwordx2 v[116:117], v56, s[12:15], s41 offen offset:512 sc0 sc1
    v_accvgpr_read_b32 v124, a103
    v_accvgpr_read_b32 v125, a115
    v_accvgpr_read_b32 v126, a127
    v_accvgpr_read_b32 v127, a139
    v_pk_mul_f32 v[124:125], v[124:125], v[130:131] op_sel:[0,1] op_sel_hi:[1,1]
    v_pk_mul_f32 v[126:127], v[126:127], v[130:131] op_sel:[0,1] op_sel_hi:[1,1]
    v_cvt_pk_bf16_f32 v124, v124, v125
    v_cvt_pk_bf16_f32 v125, v126, v127
    buffer_store_dwordx2 v[120:121], v56, s[12:15], s41 offen offset:896 sc0 sc1
    v_accvgpr_read_b32 v64, a104
    v_accvgpr_read_b32 v65, a116
    v_accvgpr_read_b32 v66, a128
    v_accvgpr_read_b32 v67, a140
    v_pk_mul_f32 v[64:65], v[64:65], v[128:129] op_sel_hi:[1,0]
    v_pk_mul_f32 v[66:67], v[66:67], v[128:129] op_sel_hi:[1,0]
    v_cvt_pk_bf16_f32 v64, v64, v65
    v_cvt_pk_bf16_f32 v65, v66, v67
    buffer_store_dwordx2 v[124:125], v56, s[12:15], s41 offen offset:1280 sc0 sc1
    v_accvgpr_read_b32 v68, a105
    v_accvgpr_read_b32 v69, a117
    v_accvgpr_read_b32 v70, a129
    v_accvgpr_read_b32 v71, a141
    v_pk_mul_f32 v[68:69], v[68:69], v[128:129] op_sel:[0,1] op_sel_hi:[1,1]
    v_pk_mul_f32 v[70:71], v[70:71], v[128:129] op_sel:[0,1] op_sel_hi:[1,1]
    v_cvt_pk_bf16_f32 v68, v68, v69
    v_cvt_pk_bf16_f32 v69, v70, v71
    buffer_store_dwordx2 v[64:65], v56, s[12:15], s41 offen offset:256 sc0 sc1
    v_accvgpr_read_b32 v72, a106
    v_accvgpr_read_b32 v73, a118
    v_accvgpr_read_b32 v74, a130
    v_accvgpr_read_b32 v75, a142
    v_pk_mul_f32 v[72:73], v[72:73], v[130:131] op_sel_hi:[1,0]
    v_pk_mul_f32 v[74:75], v[74:75], v[130:131] op_sel_hi:[1,0]
    v_cvt_pk_bf16_f32 v72, v72, v73
    v_cvt_pk_bf16_f32 v73, v74, v75
    buffer_store_dwordx2 v[68:69], v56, s[12:15], s41 offen offset:640 sc0 sc1
    v_accvgpr_read_b32 v76, a107
    v_accvgpr_read_b32 v77, a119
    v_accvgpr_read_b32 v78, a131
    v_accvgpr_read_b32 v79, a143
    v_pk_mul_f32 v[76:77], v[76:77], v[130:131] op_sel:[0,1] op_sel_hi:[1,1]
    v_pk_mul_f32 v[78:79], v[78:79], v[130:131] op_sel:[0,1] op_sel_hi:[1,1]
    v_cvt_pk_bf16_f32 v76, v76, v77
    v_cvt_pk_bf16_f32 v77, v78, v79
    buffer_store_dwordx2 v[72:73], v56, s[12:15], s41 offen offset:1024 sc0 sc1
    v_accvgpr_read_b32 v80, a144
    v_accvgpr_read_b32 v81, a156
    v_accvgpr_read_b32 v82, a168
    v_accvgpr_read_b32 v83, a180
    v_pk_mul_f32 v[80:81], v[80:81], v[132:133] op_sel_hi:[1,0]
    v_pk_mul_f32 v[82:83], v[82:83], v[132:133] op_sel_hi:[1,0]
    v_cvt_pk_bf16_f32 v80, v80, v81
    v_cvt_pk_bf16_f32 v81, v82, v83
    buffer_store_dwordx2 v[76:77], v56, s[12:15], s41 offen offset:1408 sc0 sc1
    v_accvgpr_read_b32 v84, a145
    v_accvgpr_read_b32 v85, a157
    v_accvgpr_read_b32 v86, a169
    v_accvgpr_read_b32 v87, a181
    v_pk_mul_f32 v[84:85], v[84:85], v[132:133] op_sel:[0,1] op_sel_hi:[1,1]
    v_pk_mul_f32 v[86:87], v[86:87], v[132:133] op_sel:[0,1] op_sel_hi:[1,1]
    v_cvt_pk_bf16_f32 v84, v84, v85
    v_cvt_pk_bf16_f32 v85, v86, v87
    buffer_store_dwordx2 v[80:81], v56, s[12:15], s42 offen offset:0 sc0 sc1
    v_accvgpr_read_b32 v88, a146
    v_accvgpr_read_b32 v89, a158
    v_accvgpr_read_b32 v90, a170
    v_accvgpr_read_b32 v91, a182
    v_pk_mul_f32 v[88:89], v[88:89], v[134:135] op_sel_hi:[1,0]
    v_pk_mul_f32 v[90:91], v[90:91], v[134:135] op_sel_hi:[1,0]
    v_cvt_pk_bf16_f32 v88, v88, v89
    v_cvt_pk_bf16_f32 v89, v90, v91
    buffer_store_dwordx2 v[84:85], v56, s[12:15], s42 offen offset:384 sc0 sc1
    v_accvgpr_read_b32 v92, a147
    v_accvgpr_read_b32 v93, a159
    v_accvgpr_read_b32 v94, a171
    v_accvgpr_read_b32 v95, a183
    v_pk_mul_f32 v[92:93], v[92:93], v[134:135] op_sel:[0,1] op_sel_hi:[1,1]
    v_pk_mul_f32 v[94:95], v[94:95], v[134:135] op_sel:[0,1] op_sel_hi:[1,1]
    v_cvt_pk_bf16_f32 v92, v92, v93
    v_cvt_pk_bf16_f32 v93, v94, v95
    buffer_store_dwordx2 v[88:89], v56, s[12:15], s42 offen offset:768 sc0 sc1
    v_accvgpr_read_b32 v96, a148
    v_accvgpr_read_b32 v97, a160
    v_accvgpr_read_b32 v98, a172
    v_accvgpr_read_b32 v99, a184
    v_pk_mul_f32 v[96:97], v[96:97], v[132:133] op_sel_hi:[1,0]
    v_pk_mul_f32 v[98:99], v[98:99], v[132:133] op_sel_hi:[1,0]
    v_cvt_pk_bf16_f32 v96, v96, v97
    v_cvt_pk_bf16_f32 v97, v98, v99
    buffer_store_dwordx2 v[92:93], v56, s[12:15], s42 offen offset:1152 sc0 sc1
    v_accvgpr_read_b32 v100, a149
    v_accvgpr_read_b32 v101, a161
    v_accvgpr_read_b32 v102, a173
    v_accvgpr_read_b32 v103, a185
    v_pk_mul_f32 v[100:101], v[100:101], v[132:133] op_sel:[0,1] op_sel_hi:[1,1]
    v_pk_mul_f32 v[102:103], v[102:103], v[132:133] op_sel:[0,1] op_sel_hi:[1,1]
    v_cvt_pk_bf16_f32 v100, v100, v101
    v_cvt_pk_bf16_f32 v101, v102, v103
    buffer_store_dwordx2 v[96:97], v56, s[12:15], s42 offen offset:128 sc0 sc1
    v_accvgpr_read_b32 v104, a150
    v_accvgpr_read_b32 v105, a162
    v_accvgpr_read_b32 v106, a174
    v_accvgpr_read_b32 v107, a186
    v_pk_mul_f32 v[104:105], v[104:105], v[134:135] op_sel_hi:[1,0]
    v_pk_mul_f32 v[106:107], v[106:107], v[134:135] op_sel_hi:[1,0]
    v_cvt_pk_bf16_f32 v104, v104, v105
    v_cvt_pk_bf16_f32 v105, v106, v107
    buffer_store_dwordx2 v[100:101], v56, s[12:15], s42 offen offset:512 sc0 sc1
    v_accvgpr_read_b32 v108, a151
    v_accvgpr_read_b32 v109, a163
    v_accvgpr_read_b32 v110, a175
    v_accvgpr_read_b32 v111, a187
    v_pk_mul_f32 v[108:109], v[108:109], v[134:135] op_sel:[0,1] op_sel_hi:[1,1]
    v_pk_mul_f32 v[110:111], v[110:111], v[134:135] op_sel:[0,1] op_sel_hi:[1,1]
    v_cvt_pk_bf16_f32 v108, v108, v109
    v_cvt_pk_bf16_f32 v109, v110, v111
    buffer_store_dwordx2 v[104:105], v56, s[12:15], s42 offen offset:896 sc0 sc1
    v_accvgpr_read_b32 v112, a152
    v_accvgpr_read_b32 v113, a164
    v_accvgpr_read_b32 v114, a176
    v_accvgpr_read_b32 v115, a188
    v_pk_mul_f32 v[112:113], v[112:113], v[132:133] op_sel_hi:[1,0]
    v_pk_mul_f32 v[114:115], v[114:115], v[132:133] op_sel_hi:[1,0]
    v_cvt_pk_bf16_f32 v112, v112, v113
    v_cvt_pk_bf16_f32 v113, v114, v115
    buffer_store_dwordx2 v[108:109], v56, s[12:15], s42 offen offset:1280 sc0 sc1
    v_accvgpr_read_b32 v116, a153
    v_accvgpr_read_b32 v117, a165
    v_accvgpr_read_b32 v118, a177
    v_accvgpr_read_b32 v119, a189
    v_pk_mul_f32 v[116:117], v[116:117], v[132:133] op_sel:[0,1] op_sel_hi:[1,1]
    v_pk_mul_f32 v[118:119], v[118:119], v[132:133] op_sel:[0,1] op_sel_hi:[1,1]
    v_cvt_pk_bf16_f32 v116, v116, v117
    v_cvt_pk_bf16_f32 v117, v118, v119
    buffer_store_dwordx2 v[112:113], v56, s[12:15], s42 offen offset:256 sc0 sc1
    v_accvgpr_read_b32 v120, a154
    v_accvgpr_read_b32 v121, a166
    v_accvgpr_read_b32 v122, a178
    v_accvgpr_read_b32 v123, a190
    v_pk_mul_f32 v[120:121], v[120:121], v[134:135] op_sel_hi:[1,0]
    v_pk_mul_f32 v[122:123], v[122:123], v[134:135] op_sel_hi:[1,0]
    v_cvt_pk_bf16_f32 v120, v120, v121
    v_cvt_pk_bf16_f32 v121, v122, v123
    buffer_store_dwordx2 v[116:117], v56, s[12:15], s42 offen offset:640 sc0 sc1
    v_accvgpr_read_b32 v124, a155
    v_accvgpr_read_b32 v125, a167
    v_accvgpr_read_b32 v126, a179
    v_accvgpr_read_b32 v127, a191
    v_pk_mul_f32 v[124:125], v[124:125], v[134:135] op_sel:[0,1] op_sel_hi:[1,1]
    v_pk_mul_f32 v[126:127], v[126:127], v[134:135] op_sel:[0,1] op_sel_hi:[1,1]
    v_cvt_pk_bf16_f32 v124, v124, v125
    v_cvt_pk_bf16_f32 v125, v126, v127
    buffer_store_dwordx2 v[120:121], v56, s[12:15], s42 offen offset:1024 sc0 sc1
    buffer_store_dwordx2 v[124:125], v56, s[12:15], s42 offen offset:1408 sc0 sc1
    s_branch L_fin
.section .rodata,"a"
.p2align 6
.amdhsa_kernel standalone__kv_cache_quant_int4_int2_kv_with_per_channel_or_per_token_scales__prompt_kernel
  .amdhsa_next_free_vgpr 512
  .amdhsa_next_free_sgpr 102
  .amdhsa_accum_offset 256
  .amdhsa_group_segment_fixed_size 0
  .amdhsa_kernarg_size 80
  .amdhsa_user_sgpr_count 2
  .amdhsa_user_sgpr_kernarg_segment_ptr 1
  .amdhsa_system_sgpr_workgroup_id_x 1
.end_amdhsa_kernel
```

```asm
; @launch grid=(256,1,1) block=(256,1,1) lds=147584
.amdgcn_target "amdgcn-amd-amdhsa--gfx950"
.text
.globl standalone__kv_cache_quant_int4_int2_kv_with_per_channel_or_per_token_scales__prompt_kernel
.p2align 8
.type standalone__kv_cache_quant_int4_int2_kv_with_per_channel_or_per_token_scales__prompt_kernel,@function
standalone__kv_cache_quant_int4_int2_kv_with_per_channel_or_per_token_scales__prompt_kernel:
    s_cmp_ge_u32 s2, 256
    s_cbranch_scc1 L_done
    s_load_dwordx16 s[40:55], s[0:1], 0
    s_load_dwordx4 s[16:19], s[0:1], 64
    s_and_b32 s94, s2, 7
    s_lshr_b32 s95, s2, 3
    s_lshr_b32 s24, s95, 3
    s_lshl_b32 s94, s94, 2
    s_add_u32 s94, s94, s24
    s_and_b32 s95, s95, 7
    s_getpc_b64 s[60:61]
L_pc:
    s_sub_u32 s60, s60, L_pc-standalone__kv_cache_quant_int4_int2_kv_with_per_channel_or_per_token_scales__prompt_kernel
    s_subb_u32 s61, s61, 0
    s_mov_b32 s62, L_slow-standalone__kv_cache_quant_int4_int2_kv_with_per_channel_or_per_token_scales__prompt_kernel
    s_mov_b32 s63, 0x20000
    s_lshr_b32 s22, s2, 3
    s_lshl_b32 s22, s22, 12
    v_lshlrev_b32 v30, 4, v0
    buffer_load_dwordx4 v[128:131], v30, s[60:63], s22 offen
    v_lshrrev_b32 v24, 6, v0
    v_and_b32 v25, 63, v0
    v_readfirstlane_b32 s25, v24
    v_lshlrev_b32 v1, 4, v25
    v_mul_u32_u24 v26, 43, v25
    v_lshrrev_b32 v26, 10, v26
    v_mul_u32_u24 v27, 24, v26
    v_sub_u32 v27, v25, v27
    v_lshrrev_b32 v28, 1, v24
    v_and_b32 v29, 1, v24
    v_lshlrev_b32 v30, 4, v29
    v_lshl_add_u32 v30, v28, 2, v30
    v_add_u32 v30, v30, v26
    v_mul_u32_u24 v30, 768, v30
    v_lshrrev_b32 v48, 1, v26
    v_lshlrev_b32 v48, 30, v48
    v_lshl_add_u32 v30, v27, 4, v30
    v_or_b32 v9, v30, v48
    v_lshl_or_b32 v10, v27, 3, v48
    v_mul_u32_u24 v30, 6144, v24
    v_add3_u32 v12, v30, v1, v48
    s_mov_b32 s66, 1572864
    s_mov_b32 s67, 0x20000
    s_mov_b32 s70, 1572864
    s_mov_b32 s71, 0x20000
    s_mov_b32 s74, 12288
    s_mov_b32 s75, 0x20000
    s_mov_b32 s78, 12288
    s_mov_b32 s79, 0x20000
    s_mov_b32 s82, 4096
    s_mov_b32 s83, 0x20000
    s_mov_b32 s86, 4096
    s_mov_b32 s87, 0x20000
    s_mov_b32 s22, 64
    s_mov_b32 s23, 0x20000
    s_mul_i32 s33, s95, 24576
    s_add_u32 s34, s33, 6144
    s_mov_b32 s35, s33
    s_lshr_b32 s36, s95, 1
    s_mul_i32 s36, s36, 384
    s_lshl_b32 s37, s95, 6
    s_lshl_b32 s24, s25, 4
    s_add_u32 s37, s37, s24
    s_mul_i32 s24, s94, 1572864
    s_mul_i32 s56, s94, 12288
    s_lshl_b32 s57, s94, 12
    s_lshl_b32 s58, s94, 10
    s_add_u32 s58, s58, 51380320
    s_or_b32 s39, s95, s25
    s_waitcnt lgkmcnt(0)
    s_add_u32 s64, s42, s24
    s_addc_u32 s65, s43, 0
    s_add_u32 s72, s46, s56
    s_addc_u32 s73, s47, 0
    s_add_u32 s76, s48, s56
    s_addc_u32 s77, s49, 0
    buffer_load_dwordx4 v[224:227], v9, s[64:67], s33 offen offset:0 nt
    buffer_load_dwordx4 v[228:231], v9, s[64:67], s33 offen offset:1536 nt
    buffer_load_dwordx4 v[232:235], v9, s[64:67], s34 offen offset:0 nt
    buffer_load_dwordx4 v[236:239], v9, s[64:67], s34 offen offset:1536 nt
    buffer_load_dwordx2 v[32:33], v10, s[72:75], s36 offen offset:0
    buffer_load_dwordx2 v[34:35], v10, s[76:79], s36 offen offset:0
    buffer_load_dwordx2 v[36:37], v10, s[72:75], s36 offen offset:192
    buffer_load_dwordx2 v[38:39], v10, s[76:79], s36 offen offset:192
    s_add_u32 s20, s18, s58
    s_addc_u32 s21, s19, 0
    s_add_u32 s80, s50, s57
    s_addc_u32 s81, s51, 0
    s_add_u32 s84, s52, s57
    s_addc_u32 s85, s53, 0
    s_add_u32 s68, s44, s24
    s_addc_u32 s69, s45, 0
    s_mul_i32 s59, s94, 786432
    s_add_u32 s12, s54, s59
    s_addc_u32 s13, s55, 0
    s_add_u32 s8, s40, s59
    s_addc_u32 s9, s41, 0
    s_cmp_lg_u32 s39, 0
    s_cbranch_scc1 L_notleader0
    s_buffer_load_dwordx16 s[40:55], s[20:23], 0 glc
L_notleader0:
    buffer_load_dwordx4 v[240:243], v9, s[64:67], s33 offen offset:384 nt
    buffer_load_dwordx4 v[244:247], v9, s[64:67], s33 offen offset:1920 nt
    buffer_load_dwordx4 v[248:251], v9, s[64:67], s34 offen offset:384 nt
    buffer_load_dwordx4 v[252:255], v9, s[64:67], s34 offen offset:1920 nt
    s_add_u32 s4, s18, s24
    s_addc_u32 s5, s19, 0
    s_mov_b32 s6, 1572864
    s_mov_b32 s7, 0x20000
    s_mov_b32 s10, 786432
    s_mov_b32 s11, 0x20000
    s_mov_b32 s88, s16
    s_mov_b32 s89, s17
    s_add_u32 s16, s33, 3072
    s_add_u32 s17, s33, 6144
    s_mov_b32 s90, 256
    s_mov_b32 s91, 0x20000
    s_lshl_b32 s93, s94, 3
    s_cmp_lg_u32 s39, 0
    s_cbranch_scc1 L_notleader
    s_waitcnt lgkmcnt(0)
    s_mov_b32 s59, 1
    s_lshr_b32 s40, s40, 10
    s_min_u32 s40, s40, 31
    s_bitset1_b32 s59, s40
    s_lshr_b32 s41, s41, 10
    s_min_u32 s41, s41, 31
    s_bitset1_b32 s59, s41
    s_lshr_b32 s42, s42, 10
    s_min_u32 s42, s42, 31
    s_bitset1_b32 s59, s42
    s_lshr_b32 s43, s43, 10
    s_min_u32 s43, s43, 31
    s_bitset1_b32 s59, s43
    s_lshr_b32 s44, s44, 10
    s_min_u32 s44, s44, 31
    s_bitset1_b32 s59, s44
    s_lshr_b32 s45, s45, 10
    s_min_u32 s45, s45, 31
    s_bitset1_b32 s59, s45
    s_lshr_b32 s46, s46, 10
    s_min_u32 s46, s46, 31
    s_bitset1_b32 s59, s46
    s_lshr_b32 s47, s47, 10
    s_min_u32 s47, s47, 31
    s_bitset1_b32 s59, s47
    s_lshr_b32 s48, s48, 10
    s_min_u32 s48, s48, 31
    s_bitset1_b32 s59, s48
    s_lshr_b32 s49, s49, 10
    s_min_u32 s49, s49, 31
    s_bitset1_b32 s59, s49
    s_lshr_b32 s50, s50, 10
    s_min_u32 s50, s50, 31
    s_bitset1_b32 s59, s50
    s_lshr_b32 s51, s51, 10
    s_min_u32 s51, s51, 31
    s_bitset1_b32 s59, s51
    s_lshr_b32 s52, s52, 10
    s_min_u32 s52, s52, 31
    s_bitset1_b32 s59, s52
    s_lshr_b32 s53, s53, 10
    s_min_u32 s53, s53, 31
    s_bitset1_b32 s59, s53
    s_lshr_b32 s54, s54, 10
    s_min_u32 s54, s54, 31
    s_bitset1_b32 s59, s54
    s_lshr_b32 s55, s55, 10
    s_min_u32 s55, s55, 31
    s_bitset1_b32 s59, s55
    s_ff0_i32_b32 s59, s59
    s_lshl_b32 s59, s59, 10
    v_mov_b32 v52, s59
    s_mov_b64 exec, 1
    buffer_store_dword v52, off, s[88:91], s93 sc1
    s_mov_b64 exec, -1
L_notleader:
    s_lshl_b32 s24, s95, 2
    s_add_u32 s24, s24, 32
    s_buffer_load_dword s46, s[20:23], s24 glc
    s_getreg_b32 s45, hwreg(HW_REG_XCC_ID, 0, 4)
    s_lshl_b32 s45, s45, 5
    s_mov_b32 s44, 0
    buffer_load_dwordx4 v[112:115], v12, s[68:71], s35 offen offset:0 nt
    buffer_load_dwordx4 v[116:119], v12, s[68:71], s35 offen offset:768 nt
    buffer_load_dwordx4 v[120:123], v12, s[68:71], s35 offen offset:1536 nt
    buffer_load_dwordx4 v[124:127], v12, s[68:71], s35 offen offset:2304 nt
    buffer_load_dwordx2 v[40:41], off, s[80:83], s37 offset:0
    buffer_load_dwordx2 v[42:43], off, s[84:87], s37 offset:0
    buffer_load_dwordx2 v[44:45], off, s[80:83], s37 offset:8
    buffer_load_dwordx2 v[46:47], off, s[84:87], s37 offset:8
    s_mov_b32 s14, 786432
    s_mov_b32 s15, 0x20000
    s_lshl_b32 s24, s25, 8
    s_add_u32 s93, s93, s24
    v_mul_u32_u24 v30, 3072, v24
    v_add_u32 v4, v30, v1
    v_lshl_add_u32 v30, v24, 3, v26
    v_mul_u32_u24 v30, 384, v30
    v_lshlrev_b32 v31, 2, v29
    v_xor_b32 v31, v27, v31
    v_lshl_add_u32 v30, v31, 4, v30
    v_or_b32 v11, v30, v48
    v_lshlrev_b32 v30, 8, v24
    v_add_u32 v30, 12288, v30
    v_lshrrev_b32 v31, 4, v25
    v_lshl_add_u32 v30, v31, 10, v30
    v_and_b32 v31, 15, v25
    v_lshl_add_u32 v30, v31, 4, v30
    v_or_b32 v20, v30, v48
    s_lshl_b32 s24, s95, 2
    v_lshl_add_u32 v13, v0, 2, s24
    v_cmp_lt_u32 vcc, 0, v0
    v_mov_b32 v30, 0x40000000
    s_nop 0
    v_cndmask_b32 v13, v13, v30, vcc
    s_mul_i32 s26, s25, 3072
    s_add_u32 s26, s26, 12288
    s_add_u32 s56, s26, 24576
    s_add_u32 s24, s95, 1
    s_and_b32 s24, s24, 7
    s_mul_i32 s32, s24, 24576
    s_add_u32 s27, s32, 12288
    s_mov_b32 s28, 98304
    s_mov_b32 s30, 73728
    v_add_u32 v1, 24576, v1
    s_mov_b32 s38, 0x3dd53b95
    s_mov_b32 s97, 0xffff0000
    s_mov_b32 s96, 100000
    v_and_b32 v26, 15, v25
    v_lshrrev_b32 v27, 4, v25
    v_bfe_u32 v28, v25, 1, 3
    v_xor_b32 v29, v27, v28
    v_mul_u32_u24 v30, 384, v26
    v_lshl_add_u32 v2, v29, 4, v30
    v_xor_b32 v3, 64, v2
    s_mul_i32 s40, s25, 6144
    s_add_u32 s40, s40, 73728
    v_lshrrev_b32 v29, 1, v27
    v_xor_b32 v29, v29, v28
    v_lshl_add_u32 v31, v29, 4, v30
    v_and_b32 v29, 1, v27
    v_lshl_add_u32 v31, v29, 3, v31
    v_xor_b32 v22, 0, v31
    v_add_u32 v22, s40, v22
    v_xor_b32 v23, 32, v31
    v_add_u32 v23, s40, v23
    v_xor_b32 v142, 64, v31
    v_add_u32 v142, s40, v142
    v_xor_b32 v143, 96, v31
    v_add_u32 v143, s40, v143
    s_lshl_b32 s24, s95, 2
    s_add_u32 s24, s24, s25
    s_mul_i32 s24, s24, 24576
    v_add_u32 v26, 0, v25
    v_mul_u32_u24 v27, 2731, v26
    v_lshrrev_b32 v27, 17, v27
    v_and_b32 v27, 7, v27
    v_xor_b32 v26, v26, v27
    v_lshlrev_b32 v136, 4, v26
    v_add_u32 v136, s24, v136
    v_add_u32 v26, 64, v25
    v_mul_u32_u24 v27, 2731, v26
    v_lshrrev_b32 v27, 17, v27
    v_and_b32 v27, 7, v27
    v_xor_b32 v26, v26, v27
    v_lshlrev_b32 v137, 4, v26
    v_add_u32 v137, s24, v137
    v_add_u32 v26, 128, v25
    v_mul_u32_u24 v27, 2731, v26
    v_lshrrev_b32 v27, 17, v27
    v_and_b32 v27, 7, v27
    v_xor_b32 v26, v26, v27
    v_lshlrev_b32 v138, 4, v26
    v_add_u32 v138, s24, v138
    v_add_u32 v26, 192, v25
    v_mul_u32_u24 v27, 2731, v26
    v_lshrrev_b32 v27, 17, v27
    v_and_b32 v27, 7, v27
    v_xor_b32 v26, v26, v27
    v_lshlrev_b32 v139, 4, v26
    v_add_u32 v139, s24, v139
    v_add_u32 v26, 256, v25
    v_mul_u32_u24 v27, 2731, v26
    v_lshrrev_b32 v27, 17, v27
    v_and_b32 v27, 7, v27
    v_xor_b32 v26, v26, v27
    v_lshlrev_b32 v140, 4, v26
    v_add_u32 v140, s24, v140
    v_add_u32 v26, 320, v25
    v_mul_u32_u24 v27, 2731, v26
    v_lshrrev_b32 v27, 17, v27
    v_and_b32 v27, 7, v27
    v_xor_b32 v26, v26, v27
    v_lshlrev_b32 v141, 4, v26
    v_add_u32 v141, s24, v141
    v_mov_b32 v5, 0
    v_mov_b32 v6, 0
    v_mov_b32 v7, 0
    v_mov_b32 v8, 0
    s_mov_b32 s62, -1
    s_mov_b32 s63, 0xffff
    s_waitcnt vmcnt(12)
    buffer_load_dwordx4 v[80:83], v12, s[68:71], s16 offen offset:0 nt
    buffer_load_dwordx4 v[84:87], v12, s[68:71], s16 offen offset:768 nt
    buffer_load_dwordx4 v[88:91], v12, s[68:71], s16 offen offset:1536 nt
    buffer_load_dwordx4 v[92:95], v12, s[68:71], s16 offen offset:2304 nt
    v_lshlrev_b32 v48, 16, v32
    v_and_b32 v49, s97, v32
    v_lshlrev_b32 v50, 16, v34
    v_and_b32 v51, s97, v34
    v_mul_f32 v48, s38, v48
    v_mul_f32 v49, s38, v49
    v_mul_f32_e64 v50, -v50, v48
    v_mul_f32_e64 v51, -v51, v49
    v_cvt_f32_i32 v224, v224
    v_cvt_f32_i32 v225, v225
    v_fma_f32 v224, v224, v48, v50
    v_fma_f32 v225, v225, v49, v51
    v_cvt_pk_bf16_f32 v224, v224, v225
    v_cvt_f32_i32 v228, v228
    v_cvt_f32_i32 v229, v229
    v_fma_f32 v228, v228, v48, v50
    v_fma_f32 v229, v229, v49, v51
    v_cvt_pk_bf16_f32 v228, v228, v229
    v_cvt_f32_i32 v232, v232
    v_cvt_f32_i32 v233, v233
    v_fma_f32 v232, v232, v48, v50
    v_fma_f32 v233, v233, v49, v51
    v_cvt_pk_bf16_f32 v232, v232, v233
    v_cvt_f32_i32 v236, v236
    v_cvt_f32_i32 v237, v237
    v_fma_f32 v236, v236, v48, v50
    v_fma_f32 v237, v237, v49, v51
    v_cvt_pk_bf16_f32 v236, v236, v237
    v_lshlrev_b32 v48, 16, v33
    v_and_b32 v49, s97, v33
    v_lshlrev_b32 v50, 16, v35
    v_and_b32 v51, s97, v35
    v_mul_f32 v48, s38, v48
    v_mul_f32 v49, s38, v49
    v_mul_f32_e64 v50, -v50, v48
    v_mul_f32_e64 v51, -v51, v49
    v_cvt_f32_i32 v226, v226
    v_cvt_f32_i32 v227, v227
    v_fma_f32 v226, v226, v48, v50
    v_fma_f32 v227, v227, v49, v51
    v_cvt_pk_bf16_f32 v225, v226, v227
    v_cvt_f32_i32 v230, v230
    v_cvt_f32_i32 v231, v231
    v_fma_f32 v230, v230, v48, v50
    v_fma_f32 v231, v231, v49, v51
    v_cvt_pk_bf16_f32 v229, v230, v231
    v_cvt_f32_i32 v234, v234
    v_cvt_f32_i32 v235, v235
    v_fma_f32 v234, v234, v48, v50
    v_fma_f32 v235, v235, v49, v51
    v_cvt_pk_bf16_f32 v233, v234, v235
    v_cvt_f32_i32 v238, v238
    v_cvt_f32_i32 v239, v239
    v_fma_f32 v238, v238, v48, v50
    v_fma_f32 v239, v239, v49, v51
    v_cvt_pk_bf16_f32 v237, v238, v239
    s_waitcnt vmcnt(12)
    v_lshlrev_b32 v48, 16, v36
    v_and_b32 v49, s97, v36
    v_lshlrev_b32 v50, 16, v38
    v_and_b32 v51, s97, v38
    v_mul_f32 v48, s38, v48
    v_mul_f32 v49, s38, v49
    v_mul_f32_e64 v50, -v50, v48
    v_mul_f32_e64 v51, -v51, v49
    v_cvt_f32_i32 v240, v240
    v_cvt_f32_i32 v241, v241
    v_fma_f32 v240, v240, v48, v50
    v_fma_f32 v241, v241, v49, v51
    v_cvt_pk_bf16_f32 v226, v240, v241
    v_cvt_f32_i32 v244, v244
    v_cvt_f32_i32 v245, v245
    v_fma_f32 v244, v244, v48, v50
    v_fma_f32 v245, v245, v49, v51
    v_cvt_pk_bf16_f32 v230, v244, v245
    v_cvt_f32_i32 v248, v248
    v_cvt_f32_i32 v249, v249
    v_fma_f32 v248, v248, v48, v50
    v_fma_f32 v249, v249, v49, v51
    v_cvt_pk_bf16_f32 v234, v248, v249
    v_cvt_f32_i32 v252, v252
    v_cvt_f32_i32 v253, v253
    v_fma_f32 v252, v252, v48, v50
    v_fma_f32 v253, v253, v49, v51
    v_cvt_pk_bf16_f32 v238, v252, v253
    v_lshlrev_b32 v48, 16, v37
    v_and_b32 v49, s97, v37
    v_lshlrev_b32 v50, 16, v39
    v_and_b32 v51, s97, v39
    v_mul_f32 v48, s38, v48
    v_mul_f32 v49, s38, v49
    v_mul_f32_e64 v50, -v50, v48
    v_mul_f32_e64 v51, -v51, v49
    v_cvt_f32_i32 v242, v242
    v_cvt_f32_i32 v243, v243
    v_fma_f32 v242, v242, v48, v50
    v_fma_f32 v243, v243, v49, v51
    v_cvt_pk_bf16_f32 v227, v242, v243
    v_cvt_f32_i32 v246, v246
    v_cvt_f32_i32 v247, v247
    v_fma_f32 v246, v246, v48, v50
    v_fma_f32 v247, v247, v49, v51
    v_cvt_pk_bf16_f32 v231, v246, v247
    v_cvt_f32_i32 v250, v250
    v_cvt_f32_i32 v251, v251
    v_fma_f32 v250, v250, v48, v50
    v_fma_f32 v251, v251, v49, v51
    v_cvt_pk_bf16_f32 v235, v250, v251
    v_cvt_f32_i32 v254, v254
    v_cvt_f32_i32 v255, v255
    v_fma_f32 v254, v254, v48, v50
    v_fma_f32 v255, v255, v49, v51
    v_cvt_pk_bf16_f32 v239, v254, v255
    buffer_store_dwordx4 v[224:227], v11, s[4:7], s33 offen offset:0
    s_mov_b64 exec, s[62:63]
    ds_write_b128 v11, v[224:227] offset:0
    s_mov_b64 exec, -1
    v_xor_b32 v55, 16, v11
    buffer_store_dwordx4 v[228:231], v55, s[4:7], s33 offen offset:768
    s_mov_b64 exec, s[62:63]
    ds_write_b128 v55, v[228:231] offset:768
    s_mov_b64 exec, -1
    v_xor_b32 v54, 32, v11
    buffer_store_dwordx4 v[232:235], v54, s[4:7], s33 offen offset:1536
    s_mov_b64 exec, s[62:63]
    ds_write_b128 v54, v[232:235] offset:1536
    s_mov_b64 exec, -1
    v_xor_b32 v55, 48, v11
    buffer_store_dwordx4 v[236:239], v55, s[4:7], s33 offen offset:2304
    s_mov_b64 exec, s[62:63]
    ds_write_b128 v55, v[236:239] offset:2304
    s_mov_b64 exec, -1
    s_mov_b32 s41, 0
    s_add_u32 m0, s40, 24576
    s_nop 0
    buffer_load_dwordx4 v136, s[8:11], s41 offen nt lds
    s_add_u32 m0, s40, 25600
    s_nop 0
    buffer_load_dwordx4 v137, s[8:11], s41 offen nt lds
    s_add_u32 m0, s40, 26624
    s_nop 0
    buffer_load_dwordx4 v138, s[8:11], s41 offen nt lds
    s_add_u32 m0, s40, 27648
    s_nop 0
    buffer_load_dwordx4 v139, s[8:11], s41 offen nt lds
    s_add_u32 m0, s40, 28672
    s_nop 0
    buffer_load_dwordx4 v140, s[8:11], s41 offen nt lds
    s_add_u32 m0, s40, 29696
    s_waitcnt vmcnt(20)
    buffer_load_dwordx4 v141, s[8:11], s41 offen nt lds
    s_waitcnt vmcnt(14)
    v_lshlrev_b32 v48, 16, v40
    v_and_b32 v49, s97, v40
    v_lshlrev_b32 v50, 16, v42
    v_and_b32 v51, s97, v42
    v_mul_f32_e64 v50, -v50, v48
    v_mul_f32_e64 v51, -v51, v49
    v_cvt_f32_i32 v112, v112
    v_cvt_f32_i32 v116, v116
    v_fma_f32 v112, v112, v48, v50
    v_fma_f32 v116, v116, v49, v51
    v_cvt_f32_i32 v113, v113
    v_cvt_f32_i32 v117, v117
    v_fma_f32 v113, v113, v48, v50
    v_fma_f32 v117, v117, v49, v51
    v_cvt_f32_i32 v114, v114
    v_cvt_f32_i32 v118, v118
    v_fma_f32 v114, v114, v48, v50
    v_fma_f32 v118, v118, v49, v51
    v_cvt_f32_i32 v115, v115
    v_cvt_f32_i32 v119, v119
    v_fma_f32 v115, v115, v48, v50
    v_fma_f32 v119, v119, v49, v51
    v_lshlrev_b32 v48, 16, v41
    v_and_b32 v49, s97, v41
    v_lshlrev_b32 v50, 16, v43
    v_and_b32 v51, s97, v43
    v_mul_f32_e64 v50, -v50, v48
    v_mul_f32_e64 v51, -v51, v49
    v_cvt_f32_i32 v120, v120
    v_cvt_f32_i32 v124, v124
    v_fma_f32 v120, v120, v48, v50
    v_fma_f32 v124, v124, v49, v51
    v_cvt_f32_i32 v121, v121
    v_cvt_f32_i32 v125, v125
    v_fma_f32 v121, v121, v48, v50
    v_fma_f32 v125, v125, v49, v51
    v_cvt_f32_i32 v122, v122
    v_cvt_f32_i32 v126, v126
    v_fma_f32 v122, v122, v48, v50
    v_fma_f32 v126, v126, v49, v51
    v_cvt_f32_i32 v123, v123
    v_cvt_f32_i32 v127, v127
    v_fma_f32 v123, v123, v48, v50
    v_fma_f32 v127, v127, v49, v51
    v_cvt_pk_bf16_f32 v112, v112, v116
    v_cvt_pk_bf16_f32 v116, v113, v117
    v_cvt_pk_bf16_f32 v113, v120, v124
    v_cvt_pk_bf16_f32 v117, v121, v125
    v_cvt_pk_bf16_f32 v120, v114, v118
    v_cvt_pk_bf16_f32 v121, v122, v126
    v_cvt_pk_bf16_f32 v124, v115, v119
    v_cvt_pk_bf16_f32 v125, v123, v127
    s_waitcnt vmcnt(10)
    v_lshlrev_b32 v48, 16, v44
    v_and_b32 v49, s97, v44
    v_lshlrev_b32 v50, 16, v46
    v_and_b32 v51, s97, v46
    v_mul_f32_e64 v50, -v50, v48
    v_mul_f32_e64 v51, -v51, v49
    v_cvt_f32_i32 v80, v80
    v_cvt_f32_i32 v84, v84
    v_fma_f32 v80, v80, v48, v50
    v_fma_f32 v84, v84, v49, v51
    v_cvt_f32_i32 v81, v81
    v_cvt_f32_i32 v85, v85
    v_fma_f32 v81, v81, v48, v50
    v_fma_f32 v85, v85, v49, v51
    v_cvt_f32_i32 v82, v82
    v_cvt_f32_i32 v86, v86
    v_fma_f32 v82, v82, v48, v50
    v_fma_f32 v86, v86, v49, v51
    v_cvt_f32_i32 v83, v83
    v_cvt_f32_i32 v87, v87
    v_fma_f32 v83, v83, v48, v50
    v_fma_f32 v87, v87, v49, v51
    v_lshlrev_b32 v48, 16, v45
    v_and_b32 v49, s97, v45
    v_lshlrev_b32 v50, 16, v47
    v_and_b32 v51, s97, v47
    v_mul_f32_e64 v50, -v50, v48
    v_mul_f32_e64 v51, -v51, v49
    v_cvt_f32_i32 v88, v88
    v_cvt_f32_i32 v92, v92
    v_fma_f32 v88, v88, v48, v50
    v_fma_f32 v92, v92, v49, v51
    v_cvt_f32_i32 v89, v89
    v_cvt_f32_i32 v93, v93
    v_fma_f32 v89, v89, v48, v50
    v_fma_f32 v93, v93, v49, v51
    v_cvt_f32_i32 v90, v90
    v_cvt_f32_i32 v94, v94
    v_fma_f32 v90, v90, v48, v50
    v_fma_f32 v94, v94, v49, v51
    v_cvt_f32_i32 v91, v91
    v_cvt_f32_i32 v95, v95
    v_fma_f32 v91, v91, v48, v50
    v_fma_f32 v95, v95, v49, v51
    v_cvt_pk_bf16_f32 v114, v80, v84
    v_cvt_pk_bf16_f32 v118, v81, v85
    v_cvt_pk_bf16_f32 v115, v88, v92
    v_cvt_pk_bf16_f32 v119, v89, v93
    v_cvt_pk_bf16_f32 v122, v82, v86
    v_cvt_pk_bf16_f32 v123, v90, v94
    v_cvt_pk_bf16_f32 v126, v83, v87
    v_cvt_pk_bf16_f32 v127, v91, v95
    buffer_store_dwordx4 v[112:115], v20, s[4:7], s35 offen offset:0
    buffer_store_dwordx4 v[116:119], v20, s[4:7], s35 offen offset:3072
    buffer_store_dwordx4 v[120:123], v20, s[4:7], s17 offen offset:0
    buffer_store_dwordx4 v[124:127], v20, s[4:7], s17 offen offset:3072
    s_mov_b64 exec, s[62:63]
    ds_write_b128 v20, v[112:115] offset:12288
    ds_write_b128 v20, v[116:119] offset:15360
    ds_write_b128 v20, v[120:123] offset:18432
    ds_write_b128 v20, v[124:127] offset:21504
    s_mov_b64 exec, -1
    buffer_load_dword v0, off, s[88:91], s93 sc1
    s_mov_b32 s41, 6144
    s_add_u32 m0, s40, 0
    s_nop 0
    buffer_load_dwordx4 v136, s[8:11], s41 offen nt lds
    s_add_u32 m0, s40, 1024
    s_nop 0
    buffer_load_dwordx4 v137, s[8:11], s41 offen nt lds
    s_add_u32 m0, s40, 2048
    s_nop 0
    buffer_load_dwordx4 v138, s[8:11], s41 offen nt lds
    s_add_u32 m0, s40, 3072
    s_nop 0
    buffer_load_dwordx4 v139, s[8:11], s41 offen nt lds
    s_add_u32 m0, s40, 4096
    s_nop 0
    buffer_load_dwordx4 v140, s[8:11], s41 offen nt lds
    s_add_u32 m0, s40, 5120
    s_waitcnt vmcnt(15)
    buffer_load_dwordx4 v141, s[8:11], s41 offen nt lds
    s_waitcnt vmcnt(6)
    s_cmp_lg_u32 s25, 0
    s_cbranch_scc1 L_tagdone
    v_readfirstlane_b32 s42, v0
    s_mov_b32 s39, 100
    s_waitcnt lgkmcnt(0)
    s_and_b32 s46, s46, 0xfffffc00
L_tagretry:
    s_cmp_eq_u32 s42, s46
    s_cselect_b32 s42, 0, s42
    s_cmp_lg_u32 s42, 0
    s_cbranch_scc1 L_tagok
    s_sub_u32 s39, s39, 1
    s_cbranch_scc1 L_tagslow
    s_sleep 4
    s_buffer_load_dword s42, s[88:91], s93 glc
    s_waitcnt lgkmcnt(0)
    s_branch L_tagretry
L_tagok:
    s_add_u32 s42, s42, s45
    v_mov_b32 v0, s42
    v_mov_b32 v16, 147456
    ds_write_b32 v16, v0
L_tagdone:
    s_waitcnt lgkmcnt(0)
    s_barrier
    v_add_u32 v0, 1, v0
    buffer_store_dword v0, v13, s[20:23], 0 offen
    buffer_store_dword v0, v13, s[20:23], 0 offen offset:32 sc1
    v_mov_b32 v16, 147456
    ds_read_b32 v17, v16
    s_mov_b32 s88, s60
    s_mov_b32 s89, s61
    s_mov_b32 s90, L_slow-standalone__kv_cache_quant_int4_int2_kv_with_per_channel_or_per_token_scales__prompt_kernel
    s_lshr_b32 s24, s2, 3
    s_mul_i32 s93, s24, 43
    s_lshr_b32 s93, s93, 7
    s_mul_i32 s39, s93, 3
    s_sub_u32 s24, s24, s39
    s_lshl_b32 s24, s24, 10
    s_mul_i32 s93, s93, 12288
    s_add_u32 s93, s93, s24
    ds_read_b128 v[144:147], v2 offset:0
    ds_read_b128 v[148:151], v3 offset:0
    ds_read_b128 v[152:155], v2 offset:6144
    ds_read_b128 v[156:159], v3 offset:6144
    ds_read_b128 v[160:163], v2 offset:128
    ds_read_b128 v[164:167], v3 offset:128
    ds_read_b128 v[168:171], v2 offset:6272
    ds_read_b128 v[172:175], v3 offset:6272
    ds_read_b128 v[176:179], v2 offset:256
    ds_read_b128 v[180:183], v3 offset:256
    ds_read_b128 v[184:187], v2 offset:6400
    ds_read_b128 v[188:191], v3 offset:6400
    s_waitcnt vmcnt(13)
    ds_read_b64 a[192:193], v22 offset:24576
    ds_read_b64 a[194:195], v142 offset:24704
    ds_read_b64 a[196:197], v23 offset:24576
    ds_read_b64 a[198:199], v143 offset:24704
    ds_read_b64 a[200:201], v142 offset:24576
    ds_read_b64 a[202:203], v22 offset:24832
    ds_read_b64 a[204:205], v143 offset:24576
    ds_read_b64 a[206:207], v23 offset:24832
    ds_read_b64 a[208:209], v22 offset:24704
    ds_read_b64 a[210:211], v142 offset:24832
    ds_read_b64 a[212:213], v23 offset:24704
    ds_read_b64 a[214:215], v143 offset:24832
    s_waitcnt lgkmcnt(15)
    v_readfirstlane_b32 s92, v17
    s_add_u32 s92, s92, 1
    s_mov_b32 s41, 12288
    s_add_u32 m0, s40, 49152
    s_nop 0
    buffer_load_dwordx4 v136, s[8:11], s41 offen nt lds
    s_add_u32 m0, s40, 50176
    s_nop 0
    buffer_load_dwordx4 v137, s[8:11], s41 offen nt lds
    s_add_u32 m0, s40, 51200
    s_nop 0
    buffer_load_dwordx4 v138, s[8:11], s41 offen nt lds
    s_waitcnt lgkmcnt(0)
    v_mfma_f32_16x16x32_bf16 v[64:67], v[144:147], a[192:195], 0
    v_mfma_f32_16x16x32_bf16 v[64:67], v[148:151], a[196:199], v[64:67]
    v_mfma_f32_16x16x32_bf16 v[64:67], v[160:163], a[200:203], v[64:67]
    v_mfma_f32_16x16x32_bf16 v[64:67], v[164:167], a[204:207], v[64:67]
    v_mfma_f32_16x16x32_bf16 v[64:67], v[176:179], a[208:211], v[64:67]
    v_mfma_f32_16x16x32_bf16 v[64:67], v[180:183], a[212:215], v[64:67]
    v_mfma_f32_16x16x32_bf16 v[96:99], v[152:155], a[192:195], 0
    v_mfma_f32_16x16x32_bf16 v[96:99], v[156:159], a[196:199], v[96:99]
    v_mfma_f32_16x16x32_bf16 v[96:99], v[168:171], a[200:203], v[96:99]
    v_mfma_f32_16x16x32_bf16 v[96:99], v[172:175], a[204:207], v[96:99]
    v_mfma_f32_16x16x32_bf16 v[96:99], v[184:187], a[208:211], v[96:99]
    v_mfma_f32_16x16x32_bf16 v[96:99], v[188:191], a[212:215], v[96:99]
    s_nop 7
    v_max3_f32 v48, v64, v65, v66
    v_max3_f32 v50, v67, v96, v97
    v_max3_f32 v48, v48, v98, v99
    v_max_f32 v48, v48, v50
    v_mov_b32 v49, v48
    s_nop 1
    v_permlane16_swap_b32 v48, v49
    s_nop 1
    v_max_f32 v48, v48, v49
    v_mov_b32 v49, v48
    s_nop 1
    v_permlane32_swap_b32 v48, v49
    s_nop 1
    v_max_f32 v48, v48, v49
    v_sub_f32 v64, v64, v48
    v_sub_f32 v65, v65, v48
    v_sub_f32 v66, v66, v48
    v_sub_f32 v67, v67, v48
    v_sub_f32 v96, v96, v48
    v_sub_f32 v97, v97, v48
    v_sub_f32 v98, v98, v48
    v_sub_f32 v99, v99, v48
    v_exp_f32 v64, v64
    v_exp_f32 v65, v65
    v_exp_f32 v66, v66
    v_exp_f32 v67, v67
    v_exp_f32 v96, v96
    v_exp_f32 v97, v97
    v_exp_f32 v98, v98
    v_exp_f32 v99, v99
    v_sub_f32 v128, 0, v48
    v_sub_f32 v129, 0, v48
    v_sub_f32 v130, 0, v48
    v_sub_f32 v131, 0, v48
    v_add_f32 v5, v5, v64
    v_add_f32 v5, v5, v65
    v_add_f32 v5, v5, v66
    v_add_f32 v5, v5, v67
    v_add_f32 v5, v5, v96
    v_add_f32 v5, v5, v97
    v_add_f32 v5, v5, v98
    v_add_f32 v5, v5, v99
    v_cvt_pk_bf16_f32 v64, v64, v65
    v_cvt_pk_bf16_f32 v65, v66, v67
    v_cvt_pk_bf16_f32 v66, v96, v97
    v_cvt_pk_bf16_f32 v67, v98, v99
    s_waitcnt vmcnt(5)
    ds_read_b64 a[216:217], v22 offset:0
    ds_read_b64 a[218:219], v142 offset:128
    ds_read_b64 a[220:221], v23 offset:0
    ds_read_b64 a[222:223], v143 offset:128
    ds_read_b64 a[224:225], v142 offset:0
    ds_read_b64 a[226:227], v22 offset:256
    ds_read_b64 a[228:229], v143 offset:0
    ds_read_b64 a[230:231], v23 offset:256
    ds_read_b64 a[232:233], v22 offset:128
    ds_read_b64 a[234:235], v142 offset:256
    ds_read_b64 a[236:237], v23 offset:128
    ds_read_b64 a[238:239], v143 offset:256
    s_mov_b32 s41, 12288
    s_add_u32 m0, s40, 52224
    s_nop 0
    buffer_load_dwordx4 v139, s[8:11], s41 offen nt lds
    s_add_u32 m0, s40, 53248
    s_nop 0
    buffer_load_dwordx4 v140, s[8:11], s41 offen nt lds
    s_add_u32 m0, s40, 54272
    s_nop 0
    buffer_load_dwordx4 v141, s[8:11], s41 offen nt lds
    s_waitcnt lgkmcnt(0)
    v_mfma_f32_16x16x32_bf16 v[68:71], v[144:147], a[216:219], 0
    v_mfma_f32_16x16x32_bf16 v[68:71], v[148:151], a[220:223], v[68:71]
    v_mfma_f32_16x16x32_bf16 v[68:71], v[160:163], a[224:227], v[68:71]
    v_mfma_f32_16x16x32_bf16 v[68:71], v[164:167], a[228:231], v[68:71]
    v_mfma_f32_16x16x32_bf16 v[68:71], v[176:179], a[232:235], v[68:71]
    v_mfma_f32_16x16x32_bf16 v[68:71], v[180:183], a[236:239], v[68:71]
    v_mfma_f32_16x16x32_bf16 v[100:103], v[152:155], a[216:219], 0
    v_mfma_f32_16x16x32_bf16 v[100:103], v[156:159], a[220:223], v[100:103]
    v_mfma_f32_16x16x32_bf16 v[100:103], v[168:171], a[224:227], v[100:103]
    v_mfma_f32_16x16x32_bf16 v[100:103], v[172:175], a[228:231], v[100:103]
    v_mfma_f32_16x16x32_bf16 v[100:103], v[184:187], a[232:235], v[100:103]
    v_mfma_f32_16x16x32_bf16 v[100:103], v[188:191], a[236:239], v[100:103]
    s_nop 7
    ds_read_b128 v[24:27], v1 offset:0
    ds_read_b128 v[28:31], v1 offset:1024
    ds_read_b128 v[32:35], v1 offset:2048
    ds_read_b128 v[36:39], v1 offset:3072
    s_mov_b32 s41, 18432
    s_add_u32 m0, s40, 24576
    s_nop 0
    buffer_load_dwordx4 v136, s[8:11], s41 offen nt lds
    v_max3_f32 v48, v68, v69, v70
    v_max3_f32 v50, v71, v100, v101
    v_max3_f32 v48, v48, v102, v103
    v_max_f32 v48, v48, v50
    v_mov_b32 v49, v48
    s_nop 1
    v_permlane16_swap_b32 v48, v49
    s_nop 1
    v_max_f32 v48, v48, v49
    v_mov_b32 v49, v48
    s_nop 1
    v_permlane32_swap_b32 v48, v49
    s_nop 1
    v_max_f32 v48, v48, v49
    v_sub_f32 v68, v68, v48
    v_sub_f32 v69, v69, v48
    s_add_u32 m0, s40, 25600
    s_nop 0
    buffer_load_dwordx4 v137, s[8:11], s41 offen nt lds
    v_sub_f32 v70, v70, v48
    v_sub_f32 v71, v71, v48
    v_sub_f32 v100, v100, v48
    v_sub_f32 v101, v101, v48
    v_sub_f32 v102, v102, v48
    v_sub_f32 v103, v103, v48
    v_exp_f32 v68, v68
    v_exp_f32 v69, v69
    v_exp_f32 v70, v70
    v_exp_f32 v71, v71
    v_exp_f32 v100, v100
    v_exp_f32 v101, v101
    v_exp_f32 v102, v102
    v_exp_f32 v103, v103
    v_sub_f32 v132, 0, v48
    s_add_u32 m0, s40, 26624
    s_nop 0
    buffer_load_dwordx4 v138, s[8:11], s41 offen nt lds
    v_sub_f32 v133, 0, v48
    v_sub_f32 v134, 0, v48
    v_sub_f32 v135, 0, v48
    v_add_f32 v6, v6, v68
    v_add_f32 v6, v6, v69
    v_add_f32 v6, v6, v70
    v_add_f32 v6, v6, v71
    v_add_f32 v6, v6, v100
    v_add_f32 v6, v6, v101
    v_add_f32 v6, v6, v102
    v_add_f32 v6, v6, v103
    v_cvt_pk_bf16_f32 v68, v68, v69
    v_cvt_pk_bf16_f32 v69, v70, v71
    v_cvt_pk_bf16_f32 v70, v100, v101
    v_cvt_pk_bf16_f32 v71, v102, v103
    s_buffer_load_dwordx8 s[48:55], s[20:23], s44 glc
    s_waitcnt lgkmcnt(2)
    v_mfma_f32_16x16x32_bf16 a[0:3], v[64:67], v[24:27], 0
    ds_read_b128 v[40:43], v1 offset:4096
    v_mfma_f32_16x16x32_bf16 a[4:7], v[64:67], v[28:31], 0
    v_mfma_f32_16x16x32_bf16 a[48:51], v[68:71], v[24:27], 0
    ds_read_b128 v[44:47], v1 offset:5120
    v_mfma_f32_16x16x32_bf16 a[52:55], v[68:71], v[28:31], 0
    s_waitcnt lgkmcnt(2)
    v_mfma_f32_16x16x32_bf16 a[8:11], v[64:67], v[32:35], 0
    ds_read_b128 v[24:27], v1 offset:6144
    v_mfma_f32_16x16x32_bf16 a[12:15], v[64:67], v[36:39], 0
    v_mfma_f32_16x16x32_bf16 a[56:59], v[68:71], v[32:35], 0
    ds_read_b128 v[28:31], v1 offset:7168
    v_mfma_f32_16x16x32_bf16 a[60:63], v[68:71], v[36:39], 0
    s_waitcnt lgkmcnt(2)
    v_mfma_f32_16x16x32_bf16 a[16:19], v[64:67], v[40:43], 0
    ds_read_b128 v[32:35], v1 offset:8192
    v_mfma_f32_16x16x32_bf16 a[20:23], v[64:67], v[44:47], 0
    v_mfma_f32_16x16x32_bf16 a[64:67], v[68:71], v[40:43], 0
    ds_read_b128 v[36:39], v1 offset:9216
    v_mfma_f32_16x16x32_bf16 a[68:71], v[68:71], v[44:47], 0
    s_waitcnt lgkmcnt(2)
    v_mfma_f32_16x16x32_bf16 a[24:27], v[64:67], v[24:27], 0
    ds_read_b128 v[40:43], v1 offset:10240
    v_mfma_f32_16x16x32_bf16 a[28:31], v[64:67], v[28:31], 0
    v_mfma_f32_16x16x32_bf16 a[72:75], v[68:71], v[24:27], 0
    ds_read_b128 v[44:47], v1 offset:11264
    v_mfma_f32_16x16x32_bf16 a[76:79], v[68:71], v[28:31], 0
    s_waitcnt lgkmcnt(2)
    v_mfma_f32_16x16x32_bf16 a[32:35], v[64:67], v[32:35], 0
    v_mfma_f32_16x16x32_bf16 a[36:39], v[64:67], v[36:39], 0
    v_mfma_f32_16x16x32_bf16 a[80:83], v[68:71], v[32:35], 0
    v_mfma_f32_16x16x32_bf16 a[84:87], v[68:71], v[36:39], 0
    s_waitcnt lgkmcnt(0)
    v_mfma_f32_16x16x32_bf16 a[40:43], v[64:67], v[40:43], 0
    v_mfma_f32_16x16x32_bf16 a[44:47], v[64:67], v[44:47], 0
    v_mfma_f32_16x16x32_bf16 a[88:91], v[68:71], v[40:43], 0
    v_mfma_f32_16x16x32_bf16 a[92:95], v[68:71], v[44:47], 0
    s_waitcnt lgkmcnt(0)
    s_sub_u32 s48, s48, s92
    s_sub_u32 s49, s49, s92
    s_sub_u32 s50, s50, s92
    s_sub_u32 s51, s51, s92
    s_sub_u32 s52, s52, s92
    s_sub_u32 s53, s53, s92
    s_sub_u32 s54, s54, s92
    s_sub_u32 s55, s55, s92
    s_max_u32 s48, s48, s49
    s_max_u32 s48, s48, s50
    s_max_u32 s48, s48, s51
    s_max_u32 s48, s48, s52
    s_max_u32 s48, s48, s53
    s_max_u32 s48, s48, s54
    s_max_u32 s48, s48, s55
    s_cmp_ge_u32 s48, 16
    s_cbranch_scc1 L_pollslow0
L_pollok0:
    s_add_u32 s92, s92, 1
    s_mov_b32 s44, 32
    s_mov_b32 m0, s26
    s_nop 0
    buffer_load_dwordx4 v4, s[4:7], s32 offen offset:0 sc1 lds
    buffer_load_dwordx4 v4, s[4:7], s32 offen offset:1024 sc1 lds
    buffer_load_dwordx4 v4, s[4:7], s32 offen offset:2048 sc1 lds
    s_add_u32 s32, s32, 24576
    s_sub_u32 s57, s32, 196608
    s_min_u32 s32, s32, s57
    s_add_u32 s26, s26, 36864
    s_sub_u32 s57, s26, 147456
    s_min_u32 s26, s26, s57
    s_mov_b32 m0, s26
    s_waitcnt vmcnt(11)
    buffer_load_dwordx4 v4, s[4:7], s32 offen offset:0 sc1 lds
    s_waitcnt vmcnt(11)
    buffer_load_dwordx4 v4, s[4:7], s32 offen offset:1024 sc1 lds
    s_waitcnt vmcnt(11)
    buffer_load_dwordx4 v4, s[4:7], s32 offen offset:2048 sc1 lds
    s_add_u32 s32, s32, 24576
    s_sub_u32 s57, s32, 196608
    s_min_u32 s32, s32, s57
    s_add_u32 s26, s26, 12288
    s_mov_b32 m0, s26
    s_waitcnt vmcnt(11)
    buffer_load_dwordx4 v4, s[4:7], s32 offen offset:0 sc1 lds
    s_waitcnt vmcnt(11)
    buffer_load_dwordx4 v4, s[4:7], s32 offen offset:1024 sc1 lds
    s_waitcnt vmcnt(11)
    buffer_load_dwordx4 v4, s[4:7], s32 offen offset:2048 sc1 lds
    s_add_u32 s32, s32, 24576
    s_sub_u32 s57, s32, 196608
    s_min_u32 s32, s32, s57
    s_add_u32 s26, s26, 36864
    s_sub_u32 s57, s26, 147456
    s_min_u32 s26, s26, s57
    s_mov_b32 m0, s56
    s_waitcnt vmcnt(11)
    buffer_load_dwordx4 v4, s[4:7], s27 offen offset:0 sc1 lds
    s_waitcnt vmcnt(11)
    buffer_load_dwordx4 v4, s[4:7], s27 offen offset:1024 sc1 lds
    s_waitcnt vmcnt(11)
    buffer_load_dwordx4 v4, s[4:7], s27 offen offset:2048 sc1 lds
    s_add_u32 s27, s27, 24576
    s_sub_u32 s58, s27, 196608
    s_min_u32 s27, s27, s58
    s_add_u32 s56, s56, 36864
    s_sub_u32 s58, s56, 147456
    s_min_u32 s56, s56, s58
    s_add_u32 s33, s33, 196608
    s_add_u32 s34, s34, 196608
    s_add_u32 s36, s36, 1536
    s_add_u32 s35, s35, 196608
    s_add_u32 s16, s16, 196608
    s_add_u32 s17, s17, 196608
    s_add_u32 s37, s37, 512
    s_waitcnt vmcnt(9)
    s_barrier
    ds_read_b128 v[24:27], v2 offset:12288
    ds_read_b128 v[28:31], v3 offset:12288
    ds_read_b128 v[32:35], v2 offset:18432
    ds_read_b128 v[36:39], v3 offset:18432
    s_waitcnt lgkmcnt(2)
    v_mfma_f32_16x16x32_bf16 v[72:75], v[24:27], a[192:195], v[128:131]
    s_mov_b32 m0, s56
    ds_read_b128 v[40:43], v2 offset:12416
    v_mfma_f32_16x16x32_bf16 v[72:75], v[28:31], a[196:199], v[72:75]
    buffer_load_dwordx4 v4, s[4:7], s27 offen offset:0 sc1 lds
    v_mfma_f32_16x16x32_bf16 v[76:79], v[24:27], a[216:219], v[132:135]
    ds_read_b128 v[44:47], v3 offset:12416
    v_mfma_f32_16x16x32_bf16 v[76:79], v[28:31], a[220:223], v[76:79]
    s_waitcnt lgkmcnt(2)
    buffer_load_dwordx4 v4, s[4:7], s27 offen offset:1024 sc1 lds
    v_mfma_f32_16x16x32_bf16 v[104:107], v[32:35], a[192:195], v[128:131]
    ds_read_b128 v[24:27], v2 offset:18560
    v_mfma_f32_16x16x32_bf16 v[104:107], v[36:39], a[196:199], v[104:107]
    buffer_load_dwordx4 v4, s[4:7], s27 offen offset:2048 sc1 lds
    v_mfma_f32_16x16x32_bf16 v[108:111], v[32:35], a[216:219], v[132:135]
    s_add_u32 s27, s27, 24576
    ds_read_b128 v[28:31], v3 offset:18560
    v_mfma_f32_16x16x32_bf16 v[108:111], v[36:39], a[220:223], v[108:111]
    s_waitcnt lgkmcnt(2)
    s_sub_u32 s58, s27, 196608
    v_mfma_f32_16x16x32_bf16 v[72:75], v[40:43], a[200:203], v[72:75]
    ds_read_b128 v[32:35], v2 offset:12544
    v_mfma_f32_16x16x32_bf16 v[72:75], v[44:47], a[204:207], v[72:75]
    s_min_u32 s27, s27, s58
    v_mfma_f32_16x16x32_bf16 v[76:79], v[40:43], a[224:227], v[76:79]
    s_add_u32 s56, s56, 12288
    ds_read_b128 v[36:39], v3 offset:12544
    v_mfma_f32_16x16x32_bf16 v[76:79], v[44:47], a[228:231], v[76:79]
    s_waitcnt lgkmcnt(2)
    s_mov_b32 m0, s56
    v_mfma_f32_16x16x32_bf16 v[104:107], v[24:27], a[200:203], v[104:107]
    ds_read_b128 v[40:43], v2 offset:18688
    v_mfma_f32_16x16x32_bf16 v[104:107], v[28:31], a[204:207], v[104:107]
    s_waitcnt vmcnt(6)
    buffer_load_dwordx4 v4, s[4:7], s27 offen offset:0 sc1 lds
    v_mfma_f32_16x16x32_bf16 v[108:111], v[24:27], a[224:227], v[108:111]
    ds_read_b128 v[44:47], v3 offset:18688
    v_mfma_f32_16x16x32_bf16 v[108:111], v[28:31], a[228:231], v[108:111]
    s_waitcnt lgkmcnt(2)
    s_barrier
    v_add_u32 v2, 49152, v2
    v_add_u32 v3, 49152, v3
    v_mfma_f32_16x16x32_bf16 v[72:75], v[32:35], a[208:211], v[72:75]
    ds_read_b128 v[24:27], v2 offset:0
    v_mfma_f32_16x16x32_bf16 v[72:75], v[36:39], a[212:215], v[72:75]
    buffer_load_dwordx4 v4, s[4:7], s27 offen offset:1024 sc1 lds
    v_mfma_f32_16x16x32_bf16 v[76:79], v[32:35], a[232:235], v[76:79]
    ds_read_b128 v[28:31], v3 offset:0
    v_mfma_f32_16x16x32_bf16 v[76:79], v[36:39], a[236:239], v[76:79]
    s_waitcnt lgkmcnt(2)
    buffer_load_dwordx4 v4, s[4:7], s27 offen offset:2048 sc1 lds
    v_mfma_f32_16x16x32_bf16 v[104:107], v[40:43], a[208:211], v[104:107]
    ds_read_b128 v[32:35], v2 offset:6144
    v_mfma_f32_16x16x32_bf16 v[104:107], v[44:47], a[212:215], v[104:107]
    v_mfma_f32_16x16x32_bf16 v[108:111], v[40:43], a[232:235], v[108:111]
    s_add_u32 s27, s27, 24576
    ds_read_b128 v[36:39], v3 offset:6144
    s_sub_u32 s58, s27, 196608
    v_mfma_f32_16x16x32_bf16 v[108:111], v[44:47], a[236:239], v[108:111]
    s_waitcnt lgkmcnt(2)
    s_min_u32 s27, s27, s58
    s_add_u32 s56, s56, 36864
    s_sub_u32 s58, s56, 147456
    s_min_u32 s56, s56, s58
    v_mfma_f32_16x16x32_bf16 v[80:83], v[24:27], a[192:195], v[128:131]
    s_mov_b32 s41, 18432
    ds_read_b128 v[40:43], v2 offset:128
    s_add_u32 m0, s40, 27648
    v_mfma_f32_16x16x32_bf16 v[80:83], v[28:31], a[196:199], v[80:83]
    v_mfma_f32_16x16x32_bf16 v[84:87], v[24:27], a[216:219], v[132:135]
    ds_read_b128 v[44:47], v3 offset:128
    v_mfma_f32_16x16x32_bf16 v[84:87], v[28:31], a[220:223], v[84:87]
    s_waitcnt lgkmcnt(2)
    buffer_load_dwordx4 v139, s[8:11], s41 offen nt lds
    v_mfma_f32_16x16x32_bf16 v[112:115], v[32:35], a[192:195], v[128:131]
    ds_read_b128 v[24:27], v2 offset:6272
    v_mfma_f32_16x16x32_bf16 v[112:115], v[36:39], a[196:199], v[112:115]
    v_exp_f32 v16, v72
    v_mfma_f32_16x16x32_bf16 v[116:119], v[32:35], a[216:219], v[132:135]
    s_add_u32 m0, s40, 28672
    ds_read_b128 v[28:31], v3 offset:6272
    v_mfma_f32_16x16x32_bf16 v[116:119], v[36:39], a[220:223], v[116:119]
    s_waitcnt lgkmcnt(2)
    v_exp_f32 v17, v73
    v_mfma_f32_16x16x32_bf16 v[80:83], v[40:43], a[200:203], v[80:83]
    ds_read_b128 v[32:35], v2 offset:256
    v_mfma_f32_16x16x32_bf16 v[80:83], v[44:47], a[204:207], v[80:83]
    buffer_load_dwordx4 v140, s[8:11], s41 offen nt lds
    v_mfma_f32_16x16x32_bf16 v[84:87], v[40:43], a[224:227], v[84:87]
    ds_read_b128 v[36:39], v3 offset:256
    v_mfma_f32_16x16x32_bf16 v[84:87], v[44:47], a[228:231], v[84:87]
    s_waitcnt lgkmcnt(2)
    v_exp_f32 v18, v74
    v_mfma_f32_16x16x32_bf16 v[112:115], v[24:27], a[200:203], v[112:115]
    ds_read_b128 v[40:43], v2 offset:6400
    v_add_f32 v5, v5, v16
    v_mfma_f32_16x16x32_bf16 v[112:115], v[28:31], a[204:207], v[112:115]
    s_add_u32 m0, s40, 29696
    v_add_f32 v5, v5, v17
    v_mfma_f32_16x16x32_bf16 v[116:119], v[24:27], a[224:227], v[116:119]
    ds_read_b128 v[44:47], v3 offset:6400
    v_mfma_f32_16x16x32_bf16 v[116:119], v[28:31], a[228:231], v[116:119]
    s_waitcnt lgkmcnt(2)
    v_exp_f32 v19, v75
    v_cvt_pk_bf16_f32 v72, v16, v17
    v_mfma_f32_16x16x32_bf16 v[80:83], v[32:35], a[208:211], v[80:83]
    ds_read_b128 v[24:27], v2 offset:12288
    v_mfma_f32_16x16x32_bf16 v[80:83], v[36:39], a[212:215], v[80:83]
    buffer_load_dwordx4 v141, s[8:11], s41 offen nt lds
    v_mfma_f32_16x16x32_bf16 v[84:87], v[32:35], a[232:235], v[84:87]
    ds_read_b128 v[28:31], v3 offset:12288
    v_mfma_f32_16x16x32_bf16 v[84:87], v[36:39], a[236:239], v[84:87]
    s_waitcnt lgkmcnt(2)
    v_exp_f32 v16, v104
    v_add_f32 v5, v5, v18
    v_mfma_f32_16x16x32_bf16 v[112:115], v[40:43], a[208:211], v[112:115]
    ds_read_b128 v[32:35], v2 offset:18432
    v_add_f32 v5, v5, v19
    v_mfma_f32_16x16x32_bf16 v[112:115], v[44:47], a[212:215], v[112:115]
    v_exp_f32 v17, v105
    v_cvt_pk_bf16_f32 v73, v18, v19
    v_mfma_f32_16x16x32_bf16 v[116:119], v[40:43], a[232:235], v[116:119]
    ds_read_b128 v[36:39], v3 offset:18432
    v_mfma_f32_16x16x32_bf16 v[116:119], v[44:47], a[236:239], v[116:119]
    s_waitcnt lgkmcnt(2)
    v_exp_f32 v18, v106
    v_add_f32 v5, v5, v16
    v_mfma_f32_16x16x32_bf16 v[88:91], v[24:27], a[192:195], v[128:131]
    ds_read_b128 v[40:43], v2 offset:12416
    v_add_f32 v5, v5, v17
    v_mfma_f32_16x16x32_bf16 v[88:91], v[28:31], a[196:199], v[88:91]
    s_waitcnt vmcnt(11)
    buffer_load_dwordx2 v[56:57], v10, s[72:75], s36 offen offset:0
    v_mfma_f32_16x16x32_bf16 v[92:95], v[24:27], a[216:219], v[132:135]
    ds_read_b128 v[44:47], v3 offset:12416
    v_mfma_f32_16x16x32_bf16 v[92:95], v[28:31], a[220:223], v[92:95]
    s_waitcnt lgkmcnt(2)
    v_exp_f32 v19, v107
    v_cvt_pk_bf16_f32 v74, v16, v17
    v_mfma_f32_16x16x32_bf16 v[120:123], v[32:35], a[192:195], v[128:131]
    ds_read_b128 v[24:27], v2 offset:18560
    v_mfma_f32_16x16x32_bf16 v[120:123], v[36:39], a[196:199], v[120:123]
    buffer_load_dwordx2 v[58:59], v10, s[76:79], s36 offen offset:0
    v_mfma_f32_16x16x32_bf16 v[124:127], v[32:35], a[216:219], v[132:135]
    ds_read_b128 v[28:31], v3 offset:18560
    v_mfma_f32_16x16x32_bf16 v[124:127], v[36:39], a[220:223], v[124:127]
    s_waitcnt lgkmcnt(2)
    v_exp_f32 v16, v76
    v_add_f32 v5, v5, v18
    v_mfma_f32_16x16x32_bf16 v[88:91], v[40:43], a[200:203], v[88:91]
    ds_read_b128 v[32:35], v2 offset:12544
    v_add_f32 v5, v5, v19
    v_mfma_f32_16x16x32_bf16 v[88:91], v[44:47], a[204:207], v[88:91]
    s_waitcnt vmcnt(12)
    buffer_load_dwordx4 v[224:227], v9, s[64:67], s33 offen offset:0 nt
    v_mfma_f32_16x16x32_bf16 v[92:95], v[40:43], a[224:227], v[92:95]
    ds_read_b128 v[36:39], v3 offset:12544
    v_mfma_f32_16x16x32_bf16 v[92:95], v[44:47], a[228:231], v[92:95]
    s_waitcnt lgkmcnt(2)
    v_exp_f32 v17, v77
    v_cvt_pk_bf16_f32 v75, v18, v19
    v_mfma_f32_16x16x32_bf16 v[120:123], v[24:27], a[200:203], v[120:123]
    ds_read_b128 v[40:43], v2 offset:18688
    v_mfma_f32_16x16x32_bf16 v[120:123], v[28:31], a[204:207], v[120:123]
    s_waitcnt vmcnt(6)
    buffer_load_dwordx4 v[228:231], v9, s[64:67], s33 offen offset:1536 nt
    v_mfma_f32_16x16x32_bf16 v[124:127], v[24:27], a[224:227], v[124:127]
    ds_read_b128 v[44:47], v3 offset:18688
    v_mfma_f32_16x16x32_bf16 v[124:127], v[28:31], a[228:231], v[124:127]
    s_waitcnt lgkmcnt(2)
    s_barrier
    v_mfma_f32_16x16x32_bf16 v[88:91], v[32:35], a[208:211], v[88:91]
    ds_read_b128 v[24:27], v1 offset:12288
    v_mfma_f32_16x16x32_bf16 v[88:91], v[36:39], a[212:215], v[88:91]
    buffer_load_dwordx4 v[232:235], v9, s[64:67], s34 offen offset:0 nt
    v_mfma_f32_16x16x32_bf16 v[92:95], v[32:35], a[232:235], v[92:95]
    ds_read_b128 v[28:31], v1 offset:13312
    v_mfma_f32_16x16x32_bf16 v[92:95], v[36:39], a[236:239], v[92:95]
    s_waitcnt lgkmcnt(2)
    v_exp_f32 v18, v78
    v_add_f32 v6, v6, v16
    v_mfma_f32_16x16x32_bf16 v[120:123], v[40:43], a[208:211], v[120:123]
    ds_read_b128 v[32:35], v1 offset:14336
    v_add_f32 v6, v6, v17
    v_mfma_f32_16x16x32_bf16 v[120:123], v[44:47], a[212:215], v[120:123]
    buffer_load_dwordx4 v[236:239], v9, s[64:67], s34 offen offset:1536 nt
    v_mfma_f32_16x16x32_bf16 v[124:127], v[40:43], a[232:235], v[124:127]
    ds_read_b128 v[36:39], v1 offset:15360
    v_mfma_f32_16x16x32_bf16 v[124:127], v[44:47], a[236:239], v[124:127]
    s_waitcnt lgkmcnt(2)
    v_exp_f32 v19, v79
    v_cvt_pk_bf16_f32 v76, v16, v17
    v_exp_f32 v16, v108
    v_add_f32 v6, v6, v18
    v_add_f32 v6, v6, v19
    v_exp_f32 v17, v109
    v_cvt_pk_bf16_f32 v77, v18, v19
    v_exp_f32 v18, v110
    v_add_f32 v6, v6, v16
    v_add_f32 v6, v6, v17
    v_exp_f32 v19, v111
    v_cvt_pk_bf16_f32 v78, v16, v17
    v_add_f32 v6, v6, v18
    v_add_f32 v6, v6, v19
    v_cvt_pk_bf16_f32 v79, v18, v19
    v_mfma_f32_16x16x32_bf16 a[0:3], v[72:75], v[24:27], a[0:3]
    ds_read_b128 v[40:43], v1 offset:16384
    v_mfma_f32_16x16x32_bf16 a[4:7], v[72:75], v[28:31], a[4:7]
    buffer_load_dwordx2 v[60:61], v10, s[72:75], s36 offen offset:192
    v_mfma_f32_16x16x32_bf16 a[48:51], v[76:79], v[24:27], a[48:51]
    ds_read_b128 v[44:47], v1 offset:17408
    v_mfma_f32_16x16x32_bf16 a[52:55], v[76:79], v[28:31], a[52:55]
    s_waitcnt lgkmcnt(2)
    v_exp_f32 v16, v80
    v_mfma_f32_16x16x32_bf16 a[8:11], v[72:75], v[32:35], a[8:11]
    ds_read_b128 v[24:27], v1 offset:18432
    v_mfma_f32_16x16x32_bf16 a[12:15], v[72:75], v[36:39], a[12:15]
    buffer_load_dwordx2 v[62:63], v10, s[76:79], s36 offen offset:192
    v_mfma_f32_16x16x32_bf16 a[56:59], v[76:79], v[32:35], a[56:59]
    ds_read_b128 v[28:31], v1 offset:19456
    v_mfma_f32_16x16x32_bf16 a[60:63], v[76:79], v[36:39], a[60:63]
    s_waitcnt lgkmcnt(2)
    v_exp_f32 v17, v81
    v_mfma_f32_16x16x32_bf16 a[16:19], v[72:75], v[40:43], a[16:19]
    ds_read_b128 v[32:35], v1 offset:20480
    v_mfma_f32_16x16x32_bf16 a[20:23], v[72:75], v[44:47], a[20:23]
    buffer_load_dwordx4 v[240:243], v9, s[64:67], s33 offen offset:384 nt
    v_mfma_f32_16x16x32_bf16 a[64:67], v[76:79], v[40:43], a[64:67]
    ds_read_b128 v[36:39], v1 offset:21504
    v_mfma_f32_16x16x32_bf16 a[68:71], v[76:79], v[44:47], a[68:71]
    s_waitcnt lgkmcnt(2)
    v_exp_f32 v18, v82
    v_add_f32 v5, v5, v16
    v_mfma_f32_16x16x32_bf16 a[24:27], v[72:75], v[24:27], a[24:27]
    ds_read_b128 v[40:43], v1 offset:22528
    v_add_f32 v5, v5, v17
    v_mfma_f32_16x16x32_bf16 a[28:31], v[72:75], v[28:31], a[28:31]
    buffer_load_dwordx4 v[244:247], v9, s[64:67], s33 offen offset:1920 nt
    v_mfma_f32_16x16x32_bf16 a[72:75], v[76:79], v[24:27], a[72:75]
    ds_read_b128 v[44:47], v1 offset:23552
    v_mfma_f32_16x16x32_bf16 a[76:79], v[76:79], v[28:31], a[76:79]
    s_waitcnt lgkmcnt(2)
    v_add_u32 v1, 49152, v1
    v_exp_f32 v19, v83
    v_mfma_f32_16x16x32_bf16 a[32:35], v[72:75], v[32:35], a[32:35]
    ds_read_b128 v[24:27], v1 offset:0
    v_cvt_pk_bf16_f32 v80, v16, v17
    v_mfma_f32_16x16x32_bf16 a[36:39], v[72:75], v[36:39], a[36:39]
    buffer_load_dwordx4 v[248:251], v9, s[64:67], s34 offen offset:384 nt
    v_mfma_f32_16x16x32_bf16 a[80:83], v[76:79], v[32:35], a[80:83]
    ds_read_b128 v[28:31], v1 offset:1024
    v_mfma_f32_16x16x32_bf16 a[84:87], v[76:79], v[36:39], a[84:87]
    s_waitcnt lgkmcnt(2)
    v_exp_f32 v16, v112
    v_add_f32 v5, v5, v18
    v_mfma_f32_16x16x32_bf16 a[40:43], v[72:75], v[40:43], a[40:43]
    ds_read_b128 v[32:35], v1 offset:2048
    v_add_f32 v5, v5, v19
    v_mfma_f32_16x16x32_bf16 a[44:47], v[72:75], v[44:47], a[44:47]
    buffer_load_dwordx4 v[252:255], v9, s[64:67], s34 offen offset:1920 nt
    v_mfma_f32_16x16x32_bf16 a[88:91], v[76:79], v[40:43], a[88:91]
    ds_read_b128 v[36:39], v1 offset:3072
    v_mfma_f32_16x16x32_bf16 a[92:95], v[76:79], v[44:47], a[92:95]
    s_waitcnt lgkmcnt(2)
    v_exp_f32 v17, v113
    v_cvt_pk_bf16_f32 v81, v18, v19
    v_exp_f32 v18, v114
    v_add_f32 v5, v5, v16
    v_add_f32 v5, v5, v17
    v_exp_f32 v19, v115
    v_cvt_pk_bf16_f32 v82, v16, v17
    v_exp_f32 v16, v84
    v_add_f32 v5, v5, v18
    v_add_f32 v5, v5, v19
    v_exp_f32 v17, v85
    v_cvt_pk_bf16_f32 v83, v18, v19
    v_exp_f32 v18, v86
    v_add_f32 v6, v6, v16
    v_add_f32 v6, v6, v17
    v_exp_f32 v19, v87
    v_cvt_pk_bf16_f32 v84, v16, v17
    v_exp_f32 v16, v116
    v_add_f32 v6, v6, v18
    v_add_f32 v6, v6, v19
    v_exp_f32 v17, v117
    v_cvt_pk_bf16_f32 v85, v18, v19
    v_exp_f32 v18, v118
    v_add_f32 v6, v6, v16
    v_add_f32 v6, v6, v17
    v_exp_f32 v19, v119
    v_cvt_pk_bf16_f32 v86, v16, v17
    v_add_f32 v6, v6, v18
    v_add_f32 v6, v6, v19
    v_cvt_pk_bf16_f32 v87, v18, v19
    v_mfma_f32_16x16x32_bf16 a[0:3], v[80:83], v[24:27], a[0:3]
    ds_read_b128 v[40:43], v1 offset:4096
    v_mfma_f32_16x16x32_bf16 a[4:7], v[80:83], v[28:31], a[4:7]
    buffer_load_dwordx4 v[144:147], v12, s[68:71], s35 offen offset:0 nt
    v_mfma_f32_16x16x32_bf16 a[48:51], v[84:87], v[24:27], a[48:51]
    ds_read_b128 v[44:47], v1 offset:5120
    v_mfma_f32_16x16x32_bf16 a[52:55], v[84:87], v[28:31], a[52:55]
    s_waitcnt lgkmcnt(2)
    v_exp_f32 v16, v88
    v_mfma_f32_16x16x32_bf16 a[8:11], v[80:83], v[32:35], a[8:11]
    ds_read_b128 v[24:27], v1 offset:6144
    v_mfma_f32_16x16x32_bf16 a[12:15], v[80:83], v[36:39], a[12:15]
    buffer_load_dwordx4 v[148:151], v12, s[68:71], s35 offen offset:768 nt
    v_mfma_f32_16x16x32_bf16 a[56:59], v[84:87], v[32:35], a[56:59]
    ds_read_b128 v[28:31], v1 offset:7168
    v_mfma_f32_16x16x32_bf16 a[60:63], v[84:87], v[36:39], a[60:63]
    s_waitcnt lgkmcnt(2)
    v_exp_f32 v17, v89
    v_mfma_f32_16x16x32_bf16 a[16:19], v[80:83], v[40:43], a[16:19]
    ds_read_b128 v[32:35], v1 offset:8192
    v_mfma_f32_16x16x32_bf16 a[20:23], v[80:83], v[44:47], a[20:23]
    v_exp_f32 v18, v90
    v_add_f32 v5, v5, v16
    v_mfma_f32_16x16x32_bf16 a[64:67], v[84:87], v[40:43], a[64:67]
    ds_read_b128 v[36:39], v1 offset:9216
    v_add_f32 v5, v5, v17
    v_mfma_f32_16x16x32_bf16 a[68:71], v[84:87], v[44:47], a[68:71]
    s_waitcnt lgkmcnt(2)
    s_waitcnt vmcnt(16)
    buffer_load_dwordx4 v[152:155], v12, s[68:71], s35 offen offset:1536 nt
    v_mfma_f32_16x16x32_bf16 a[24:27], v[80:83], v[24:27], a[24:27]
    ds_read_b128 v[40:43], v1 offset:10240
    v_mfma_f32_16x16x32_bf16 a[28:31], v[80:83], v[28:31], a[28:31]
    v_exp_f32 v19, v91
    v_cvt_pk_bf16_f32 v88, v16, v17
    v_mfma_f32_16x16x32_bf16 a[72:75], v[84:87], v[24:27], a[72:75]
    ds_read_b128 v[44:47], v1 offset:11264
    v_mfma_f32_16x16x32_bf16 a[76:79], v[84:87], v[28:31], a[76:79]
    s_waitcnt lgkmcnt(2)
    v_exp_f32 v16, v120
    v_add_f32 v5, v5, v18
    v_mfma_f32_16x16x32_bf16 a[32:35], v[80:83], v[32:35], a[32:35]
    s_waitcnt vmcnt(39)
    ds_read_b128 v[24:27], v1 offset:12288
    v_add_f32 v5, v5, v19
    v_mfma_f32_16x16x32_bf16 a[36:39], v[80:83], v[36:39], a[36:39]
    v_exp_f32 v17, v121
    v_cvt_pk_bf16_f32 v89, v18, v19
    v_mfma_f32_16x16x32_bf16 a[80:83], v[84:87], v[32:35], a[80:83]
    ds_read_b128 v[28:31], v1 offset:13312
    ds_read_b64 a[240:241], v22 offset:49152
    v_mfma_f32_16x16x32_bf16 a[84:87], v[84:87], v[36:39], a[84:87]
    s_waitcnt lgkmcnt(3)
    s_waitcnt vmcnt(16)
    buffer_load_dwordx4 v[156:159], v12, s[68:71], s35 offen offset:2304 nt
    v_mfma_f32_16x16x32_bf16 a[40:43], v[80:83], v[40:43], a[40:43]
    ds_read_b128 v[32:35], v1 offset:14336
    ds_read_b64 a[242:243], v142 offset:49280
    v_mfma_f32_16x16x32_bf16 a[44:47], v[80:83], v[44:47], a[44:47]
    v_exp_f32 v18, v122
    v_add_f32 v5, v5, v16
    v_add_f32 v5, v5, v17
    v_exp_f32 v19, v123
    v_cvt_pk_bf16_f32 v90, v16, v17
    v_exp_f32 v16, v92
    v_add_f32 v5, v5, v18
    v_add_f32 v5, v5, v19
    v_exp_f32 v17, v93
    v_cvt_pk_bf16_f32 v91, v18, v19
    v_exp_f32 v18, v94
    v_add_f32 v6, v6, v16
    v_add_f32 v6, v6, v17
    v_exp_f32 v19, v95
    v_cvt_pk_bf16_f32 v92, v16, v17
    v_exp_f32 v16, v124
    v_add_f32 v6, v6, v18
    v_add_f32 v6, v6, v19
    v_exp_f32 v17, v125
    v_cvt_pk_bf16_f32 v93, v18, v19
    v_exp_f32 v18, v126
    v_add_f32 v6, v6, v16
    v_add_f32 v6, v6, v17
    v_exp_f32 v19, v127
    v_cvt_pk_bf16_f32 v94, v16, v17
    v_add_f32 v6, v6, v18
    v_add_f32 v6, v6, v19
    v_cvt_pk_bf16_f32 v95, v18, v19
    v_mfma_f32_16x16x32_bf16 a[88:91], v[84:87], v[40:43], a[88:91]
    ds_read_b128 v[36:39], v1 offset:15360
    ds_read_b64 a[244:245], v23 offset:49152
    v_mfma_f32_16x16x32_bf16 a[92:95], v[84:87], v[44:47], a[92:95]
    s_waitcnt lgkmcnt(5)
    ds_read_b64 a[246:247], v143 offset:49280
    ds_read_b64 a[248:249], v142 offset:49152
    v_mfma_f32_16x16x32_bf16 a[0:3], v[88:91], v[24:27], a[0:3]
    ds_read_b128 v[40:43], v1 offset:16384
    ds_read_b64 a[250:251], v22 offset:49408
    v_mfma_f32_16x16x32_bf16 a[4:7], v[88:91], v[28:31], a[4:7]
    ds_read_b64 a[252:253], v143 offset:49152
    ds_read_b64 a[254:255], v23 offset:49408
    v_mfma_f32_16x16x32_bf16 a[48:51], v[92:95], v[24:27], a[48:51]
    ds_read_b128 v[44:47], v1 offset:17408
    ds_read_b64 v[192:193], v22 offset:49280
    v_mfma_f32_16x16x32_bf16 a[52:55], v[92:95], v[28:31], a[52:55]
    s_waitcnt lgkmcnt(9)
    ds_read_b64 v[194:195], v142 offset:49408
    ds_read_b64 v[196:197], v23 offset:49280
    v_mfma_f32_16x16x32_bf16 a[8:11], v[88:91], v[32:35], a[8:11]
    ds_read_b128 v[24:27], v1 offset:18432
    ds_read_b64 v[198:199], v143 offset:49408
    v_mfma_f32_16x16x32_bf16 a[12:15], v[88:91], v[36:39], a[12:15]
    s_waitcnt vmcnt(16)
    v_mfma_f32_16x16x32_bf16 a[56:59], v[92:95], v[32:35], a[56:59]
    ds_read_b128 v[28:31], v1 offset:19456
    ds_read_b64 v[200:201], v22 offset:24576
    v_mfma_f32_16x16x32_bf16 a[60:63], v[92:95], v[36:39], a[60:63]
    s_waitcnt lgkmcnt(7)
    v_mfma_f32_16x16x32_bf16 a[16:19], v[88:91], v[40:43], a[16:19]
    ds_read_b128 v[32:35], v1 offset:20480
    ds_read_b64 v[202:203], v142 offset:24704
    v_mfma_f32_16x16x32_bf16 a[20:23], v[88:91], v[44:47], a[20:23]
    ds_read_b64 v[204:205], v23 offset:24576
    v_mfma_f32_16x16x32_bf16 a[64:67], v[92:95], v[40:43], a[64:67]
    ds_read_b128 v[36:39], v1 offset:21504
    ds_read_b64 v[206:207], v143 offset:24704
    v_mfma_f32_16x16x32_bf16 a[68:71], v[92:95], v[44:47], a[68:71]
    s_waitcnt lgkmcnt(6)
    ds_read_b64 v[208:209], v142 offset:24576
    v_mfma_f32_16x16x32_bf16 a[24:27], v[88:91], v[24:27], a[24:27]
    ds_read_b128 v[40:43], v1 offset:22528
    ds_read_b64 v[210:211], v22 offset:24832
    v_mfma_f32_16x16x32_bf16 a[28:31], v[88:91], v[28:31], a[28:31]
    v_mfma_f32_16x16x32_bf16 a[72:75], v[92:95], v[24:27], a[72:75]
    ds_read_b128 v[44:47], v1 offset:23552
    ds_read_b64 v[212:213], v143 offset:24576
    v_mfma_f32_16x16x32_bf16 a[76:79], v[92:95], v[28:31], a[76:79]
    s_waitcnt lgkmcnt(6)
    v_subrev_u32 v2, 49152, v2
    v_subrev_u32 v3, 49152, v3
    v_mfma_f32_16x16x32_bf16 a[32:35], v[88:91], v[32:35], a[32:35]
    ds_read_b128 v[24:27], v2 offset:0
    ds_read_b64 v[214:215], v23 offset:24832
    v_mfma_f32_16x16x32_bf16 a[36:39], v[88:91], v[36:39], a[36:39]
    ds_read_b64 v[216:217], v22 offset:24704
    ds_read_b64 v[218:219], v142 offset:24832
    v_mfma_f32_16x16x32_bf16 a[80:83], v[92:95], v[32:35], a[80:83]
    ds_read_b128 v[28:31], v3 offset:0
    ds_read_b64 v[220:221], v23 offset:24704
    v_mfma_f32_16x16x32_bf16 a[84:87], v[92:95], v[36:39], a[84:87]
    s_waitcnt lgkmcnt(7)
    v_mfma_f32_16x16x32_bf16 a[40:43], v[88:91], v[40:43], a[40:43]
    ds_read_b128 v[32:35], v2 offset:6144
    ds_read_b64 v[222:223], v143 offset:24832
    v_mfma_f32_16x16x32_bf16 a[44:47], v[88:91], v[44:47], a[44:47]
    v_mfma_f32_16x16x32_bf16 a[88:91], v[92:95], v[40:43], a[88:91]
    ds_read_b128 v[36:39], v3 offset:6144
    v_mfma_f32_16x16x32_bf16 a[92:95], v[92:95], v[44:47], a[92:95]
    s_waitcnt lgkmcnt(4)
    s_waitcnt lgkmcnt(0)
    s_barrier
    v_mfma_f32_16x16x32_bf16 v[160:163], v[24:27], a[240:243], 0
    s_waitcnt vmcnt(10)
    ds_read_b128 v[40:43], v2 offset:128
    v_lshlrev_b32 v48, 16, v56
    v_mfma_f32_16x16x32_bf16 v[160:163], v[28:31], a[244:247], v[160:163]
    s_mov_b32 m0, s26
    v_and_b32 v49, s97, v56
    v_lshlrev_b32 v50, 16, v58
    v_mfma_f32_16x16x32_bf16 v[164:167], v[24:27], v[200:203], 0
    ds_read_b128 v[44:47], v3 offset:128
    v_and_b32 v51, s97, v58
    v_mfma_f32_16x16x32_bf16 v[164:167], v[28:31], v[204:207], v[164:167]
    s_waitcnt lgkmcnt(2)
    buffer_load_dwordx4 v4, s[4:7], s32 offen offset:0 sc1 lds
    v_mfma_f32_16x16x32_bf16 v[96:99], v[32:35], a[240:243], 0
    ds_read_b128 v[24:27], v2 offset:6272
    v_mul_f32 v48, s38, v48
    v_mfma_f32_16x16x32_bf16 v[96:99], v[36:39], a[244:247], v[96:99]
    v_mul_f32 v49, s38, v49
    v_mul_f32_e64 v50, -v50, v48
    v_mfma_f32_16x16x32_bf16 v[100:103], v[32:35], v[200:203], 0
    ds_read_b128 v[28:31], v3 offset:6272
    v_mul_f32_e64 v51, -v51, v49
    v_mfma_f32_16x16x32_bf16 v[100:103], v[36:39], v[204:207], v[100:103]
    s_waitcnt lgkmcnt(2)
    buffer_load_dwordx4 v4, s[4:7], s32 offen offset:1024 sc1 lds
    v_mfma_f32_16x16x32_bf16 v[160:163], v[40:43], a[248:251], v[160:163]
    ds_read_b128 v[32:35], v2 offset:256
    v_cvt_f32_i32 v224, v224
    v_mfma_f32_16x16x32_bf16 v[160:163], v[44:47], a[252:255], v[160:163]
    v_cvt_f32_i32 v225, v225
    v_fma_f32 v224, v224, v48, v50
    v_mfma_f32_16x16x32_bf16 v[164:167], v[40:43], v[208:211], v[164:167]
    ds_read_b128 v[36:39], v3 offset:256
    v_fma_f32 v225, v225, v49, v51
    v_mfma_f32_16x16x32_bf16 v[164:167], v[44:47], v[212:215], v[164:167]
    s_waitcnt lgkmcnt(2)
    buffer_load_dwordx4 v4, s[4:7], s32 offen offset:2048 sc1 lds
    v_cvt_pk_bf16_f32 v224, v224, v225
    v_mfma_f32_16x16x32_bf16 v[96:99], v[24:27], a[248:251], v[96:99]
    s_add_u32 s32, s32, 24576
    ds_read_b128 v[40:43], v2 offset:6400
    v_cvt_f32_i32 v228, v228
    v_mfma_f32_16x16x32_bf16 v[96:99], v[28:31], a[252:255], v[96:99]
    s_sub_u32 s57, s32, 196608
    v_cvt_f32_i32 v229, v229
    v_fma_f32 v228, v228, v48, v50
    v_mfma_f32_16x16x32_bf16 v[100:103], v[24:27], v[208:211], v[100:103]
    s_min_u32 s32, s32, s57
    ds_read_b128 v[44:47], v3 offset:6400
    v_fma_f32 v229, v229, v49, v51
    v_mfma_f32_16x16x32_bf16 v[100:103], v[28:31], v[212:215], v[100:103]
    s_waitcnt lgkmcnt(2)
    v_cvt_pk_bf16_f32 v228, v228, v229
    v_cvt_f32_i32 v232, v232
    v_cvt_f32_i32 v233, v233
    v_mfma_f32_16x16x32_bf16 v[160:163], v[32:35], v[192:195], v[160:163]
    s_add_u32 s26, s26, 12288
    ds_read_b128 v[24:27], v2 offset:12288
    v_fma_f32 v232, v232, v48, v50
    v_mfma_f32_16x16x32_bf16 v[160:163], v[36:39], v[196:199], v[160:163]
    s_mov_b32 m0, s26
    v_fma_f32 v233, v233, v49, v51
    v_cvt_pk_bf16_f32 v232, v232, v233
    v_mfma_f32_16x16x32_bf16 v[164:167], v[32:35], v[216:219], v[164:167]
    ds_read_b128 v[28:31], v3 offset:12288
    v_cvt_f32_i32 v236, v236
    v_mfma_f32_16x16x32_bf16 v[164:167], v[36:39], v[220:223], v[164:167]
    s_waitcnt lgkmcnt(2)
    buffer_load_dwordx4 v4, s[4:7], s32 offen offset:0 sc1 lds
    v_cvt_f32_i32 v237, v237
    v_mfma_f32_16x16x32_bf16 v[96:99], v[40:43], v[192:195], v[96:99]
    ds_read_b128 v[32:35], v2 offset:18432
    v_fma_f32 v236, v236, v48, v50
    v_mfma_f32_16x16x32_bf16 v[96:99], v[44:47], v[196:199], v[96:99]
    v_fma_f32 v237, v237, v49, v51
    v_cvt_pk_bf16_f32 v236, v236, v237
    v_lshlrev_b32 v48, 16, v57
    v_mfma_f32_16x16x32_bf16 v[100:103], v[40:43], v[216:219], v[100:103]
    ds_read_b128 v[36:39], v3 offset:18432
    v_and_b32 v49, s97, v57
    v_mfma_f32_16x16x32_bf16 v[100:103], v[44:47], v[220:223], v[100:103]
    s_waitcnt lgkmcnt(2)
    buffer_load_dwordx4 v4, s[4:7], s32 offen offset:1024 sc1 lds
    v_lshlrev_b32 v50, 16, v59
    v_mfma_f32_16x16x32_bf16 v[168:171], v[24:27], a[240:243], 0
    ds_read_b128 v[40:43], v2 offset:12416
    s_waitcnt vmcnt(13)
    buffer_load_dwordx4 v4, s[4:7], s32 offen offset:2048 sc1 lds
    v_mfma_f32_16x16x32_bf16 v[168:171], v[28:31], a[244:247], v[168:171]
    v_and_b32 v51, s97, v59
    v_mul_f32 v48, s38, v48
    v_mul_f32 v49, s38, v49
    v_mfma_f32_16x16x32_bf16 v[172:175], v[24:27], v[200:203], 0
    s_add_u32 s32, s32, 24576
    ds_read_b128 v[44:47], v3 offset:12416
    v_mul_f32_e64 v50, -v50, v48
    v_mfma_f32_16x16x32_bf16 v[172:175], v[28:31], v[204:207], v[172:175]
    s_waitcnt lgkmcnt(2)
    v_mul_f32_e64 v51, -v51, v49
    v_cvt_f32_i32 v226, v226
    v_cvt_f32_i32 v227, v227
    v_mfma_f32_16x16x32_bf16 v[104:107], v[32:35], a[240:243], 0
    s_sub_u32 s57, s32, 196608
    ds_read_b128 v[24:27], v2 offset:18560
    v_fma_f32 v226, v226, v48, v50
    v_mfma_f32_16x16x32_bf16 v[104:107], v[36:39], a[244:247], v[104:107]
    v_fma_f32 v227, v227, v49, v51
    v_cvt_pk_bf16_f32 v225, v226, v227
    v_cvt_f32_i32 v230, v230
    v_mfma_f32_16x16x32_bf16 v[108:111], v[32:35], v[200:203], 0
    s_min_u32 s32, s32, s57
    ds_read_b128 v[28:31], v3 offset:18560
    v_cvt_f32_i32 v231, v231
    v_mfma_f32_16x16x32_bf16 v[108:111], v[36:39], v[204:207], v[108:111]
    s_waitcnt lgkmcnt(2)
    v_fma_f32 v230, v230, v48, v50
    v_fma_f32 v231, v231, v49, v51
    v_cvt_pk_bf16_f32 v229, v230, v231
    v_mfma_f32_16x16x32_bf16 v[168:171], v[40:43], a[248:251], v[168:171]
    s_add_u32 s26, s26, 36864
    ds_read_b128 v[32:35], v2 offset:12544
    v_cvt_f32_i32 v234, v234
    v_mfma_f32_16x16x32_bf16 v[168:171], v[44:47], a[252:255], v[168:171]
    v_cvt_f32_i32 v235, v235
    v_fma_f32 v234, v234, v48, v50
    v_max3_f32 v16, v160, v161, v162
    v_mfma_f32_16x16x32_bf16 v[172:175], v[40:43], v[208:211], v[172:175]
    ds_read_b128 v[36:39], v3 offset:12544
    v_fma_f32 v235, v235, v49, v51
    v_cvt_pk_bf16_f32 v233, v234, v235
    v_cvt_f32_i32 v238, v238
    v_cvt_f32_i32 v239, v239
    v_fma_f32 v238, v238, v48, v50
    v_fma_f32 v239, v239, v49, v51
    v_cvt_pk_bf16_f32 v237, v238, v239
    v_mfma_f32_16x16x32_bf16 v[172:175], v[44:47], v[212:215], v[172:175]
    s_waitcnt lgkmcnt(2)
    v_max3_f32 v18, v164, v165, v166
    v_max3_f32 v16, v16, v163, v96
    v_max3_f32 v18, v18, v167, v100
    v_mfma_f32_16x16x32_bf16 v[104:107], v[24:27], a[248:251], v[104:107]
    s_sub_u32 s57, s26, 147456
    ds_read_b128 v[40:43], v2 offset:18688
    s_min_u32 s26, s26, s57
    v_mfma_f32_16x16x32_bf16 v[104:107], v[28:31], a[252:255], v[104:107]
    s_waitcnt vmcnt(13)
    buffer_load_dwordx2 v[56:57], off, s[80:83], s37 offset:0
    v_max3_f32 v16, v16, v97, v98
    v_mfma_f32_16x16x32_bf16 v[108:111], v[24:27], v[208:211], v[108:111]
    s_waitcnt vmcnt(11)
    ds_read_b128 v[44:47], v3 offset:18688
    v_max3_f32 v18, v18, v101, v102
    v_mfma_f32_16x16x32_bf16 v[108:111], v[28:31], v[212:215], v[108:111]
    s_waitcnt lgkmcnt(2)
    v_add_u32 v2, 49152, v2
    v_add_u32 v3, 49152, v3
    v_max_f32 v16, v16, v99
    v_mfma_f32_16x16x32_bf16 v[168:171], v[32:35], v[192:195], v[168:171]
    ds_read_b128 v[24:27], v2 offset:0
    v_max_f32 v18, v18, v103
    v_mfma_f32_16x16x32_bf16 v[168:171], v[36:39], v[196:199], v[168:171]
    v_mov_b32 v17, v16
    v_mov_b32 v19, v18
    s_nop 0
    v_mfma_f32_16x16x32_bf16 v[172:175], v[32:35], v[216:219], v[172:175]
    ds_read_b128 v[28:31], v3 offset:0
    v_permlane16_swap_b32 v16, v17
    v_mfma_f32_16x16x32_bf16 v[172:175], v[36:39], v[220:223], v[172:175]
    s_waitcnt lgkmcnt(2)
    buffer_load_dwordx2 v[58:59], off, s[84:87], s37 offset:0
    v_permlane16_swap_b32 v18, v19
    v_mfma_f32_16x16x32_bf16 v[104:107], v[40:43], v[192:195], v[104:107]
    s_nop 0
    ds_read_b128 v[32:35], v2 offset:6144
    v_max_f32 v16, v16, v17
    v_mfma_f32_16x16x32_bf16 v[104:107], v[44:47], v[196:199], v[104:107]
    v_max_f32 v18, v18, v19
    v_mov_b32 v17, v16
    v_mov_b32 v19, v18
    s_nop 0
    v_permlane32_swap_b32 v16, v17
    v_permlane32_swap_b32 v18, v19
    s_nop 0
    v_max_f32 v16, v16, v17
    v_max_f32 v18, v18, v19
    v_sub_f32 v136, 0, v16
    v_sub_f32 v137, 0, v16
    v_sub_f32 v138, 0, v16
    v_sub_f32 v139, 0, v16
    v_sub_f32 v140, 0, v18
    v_sub_f32 v141, 0, v18
    v_sub_f32 v142, 0, v18
    v_sub_f32 v143, 0, v18
    v_mfma_f32_16x16x32_bf16 v[108:111], v[40:43], v[216:219], v[108:111]
    ds_read_b128 v[36:39], v3 offset:6144
    v_lshlrev_b32 v48, 16, v60
    v_mfma_f32_16x16x32_bf16 v[108:111], v[44:47], v[220:223], v[108:111]
    s_waitcnt lgkmcnt(2)
    v_and_b32 v49, s97, v60
    v_lshlrev_b32 v50, 16, v62
    v_and_b32 v51, s97, v62
    v_mfma_f32_16x16x32_bf16 v[176:179], v[24:27], a[240:243], v[136:139]
    ds_read_b128 v[40:43], v2 offset:128
    v_mul_f32 v48, s38, v48
    v_mfma_f32_16x16x32_bf16 v[176:179], v[28:31], a[244:247], v[176:179]
    v_mul_f32 v49, s38, v49
    v_mul_f32_e64 v50, -v50, v48
    v_mul_f32_e64 v51, -v51, v49
    v_mfma_f32_16x16x32_bf16 v[180:183], v[24:27], v[200:203], v[140:143]
    ds_read_b128 v[44:47], v3 offset:128
    v_cvt_f32_i32 v240, v240
    v_mfma_f32_16x16x32_bf16 v[180:183], v[28:31], v[204:207], v[180:183]
    s_waitcnt lgkmcnt(2)
    v_cvt_f32_i32 v241, v241
    v_fma_f32 v240, v240, v48, v50
    v_fma_f32 v241, v241, v49, v51
    v_mfma_f32_16x16x32_bf16 v[112:115], v[32:35], a[240:243], v[136:139]
    ds_read_b128 v[24:27], v2 offset:6272
    v_cvt_pk_bf16_f32 v226, v240, v241
    v_mfma_f32_16x16x32_bf16 v[112:115], v[36:39], a[244:247], v[112:115]
    v_add_f32 v160, v160, v136
    v_add_f32 v161, v161, v136
    v_cvt_f32_i32 v244, v244
    v_mfma_f32_16x16x32_bf16 v[116:119], v[32:35], v[200:203], v[140:143]
    ds_read_b128 v[28:31], v3 offset:6272
    v_add_f32 v162, v162, v136
    v_mfma_f32_16x16x32_bf16 v[116:119], v[36:39], v[204:207], v[116:119]
    s_waitcnt lgkmcnt(2)
    v_add_f32 v163, v163, v136
    v_cvt_f32_i32 v245, v245
    v_add_f32 v96, v96, v136
    v_mfma_f32_16x16x32_bf16 v[176:179], v[40:43], a[248:251], v[176:179]
    ds_read_b128 v[32:35], v2 offset:256
    v_add_f32 v97, v97, v136
    v_mfma_f32_16x16x32_bf16 v[176:179], v[44:47], a[252:255], v[176:179]
    v_fma_f32 v244, v244, v48, v50
    v_add_f32 v98, v98, v136
    v_add_f32 v99, v99, v136
    v_mfma_f32_16x16x32_bf16 v[180:183], v[40:43], v[208:211], v[180:183]
    ds_read_b128 v[36:39], v3 offset:256
    v_fma_f32 v245, v245, v49, v51
    v_mfma_f32_16x16x32_bf16 v[180:183], v[44:47], v[212:215], v[180:183]
    s_waitcnt lgkmcnt(2)
    v_add_f32 v164, v164, v140
    v_cvt_pk_bf16_f32 v230, v244, v245
    v_add_f32 v165, v165, v140
    v_mfma_f32_16x16x32_bf16 v[112:115], v[24:27], a[248:251], v[112:115]
    ds_read_b128 v[40:43], v2 offset:6400
    v_cvt_f32_i32 v248, v248
    v_mfma_f32_16x16x32_bf16 v[112:115], v[28:31], a[252:255], v[112:115]
    v_add_f32 v166, v166, v140
    v_add_f32 v167, v167, v140
    v_cvt_f32_i32 v249, v249
    v_mfma_f32_16x16x32_bf16 v[116:119], v[24:27], v[208:211], v[116:119]
    ds_read_b128 v[44:47], v3 offset:6400
    v_add_f32 v100, v100, v140
    v_mfma_f32_16x16x32_bf16 v[116:119], v[28:31], v[212:215], v[116:119]
    s_waitcnt lgkmcnt(2)
    v_fma_f32 v248, v248, v48, v50
    v_fma_f32 v249, v249, v49, v51
    v_add_f32 v101, v101, v140
    v_mfma_f32_16x16x32_bf16 v[176:179], v[32:35], v[192:195], v[176:179]
    ds_read_b128 v[24:27], v2 offset:12288
    v_cvt_pk_bf16_f32 v234, v248, v249
    v_mfma_f32_16x16x32_bf16 v[176:179], v[36:39], v[196:199], v[176:179]
    v_cvt_f32_i32 v252, v252
    v_add_f32 v102, v102, v140
    v_add_f32 v103, v103, v140
    v_mfma_f32_16x16x32_bf16 v[180:183], v[32:35], v[216:219], v[180:183]
    ds_read_b128 v[28:31], v3 offset:12288
    v_cvt_f32_i32 v253, v253
    v_mfma_f32_16x16x32_bf16 v[180:183], v[36:39], v[220:223], v[180:183]
    s_waitcnt lgkmcnt(2)
    v_fma_f32 v252, v252, v48, v50
    v_fma_f32 v253, v253, v49, v51
    v_cvt_pk_bf16_f32 v238, v252, v253
    v_mfma_f32_16x16x32_bf16 v[112:115], v[40:43], v[192:195], v[112:115]
    ds_read_b128 v[32:35], v2 offset:18432
    v_lshlrev_b32 v48, 16, v61
    v_mfma_f32_16x16x32_bf16 v[112:115], v[44:47], v[196:199], v[112:115]
    v_and_b32 v49, s97, v61
    v_lshlrev_b32 v50, 16, v63
    v_and_b32 v51, s97, v63
    v_mfma_f32_16x16x32_bf16 v[116:119], v[40:43], v[216:219], v[116:119]
    ds_read_b128 v[36:39], v3 offset:18432
    v_mul_f32 v48, s38, v48
    v_mfma_f32_16x16x32_bf16 v[116:119], v[44:47], v[220:223], v[116:119]
    s_waitcnt lgkmcnt(2)
    v_mul_f32 v49, s38, v49
    v_mul_f32_e64 v50, -v50, v48
    v_mul_f32_e64 v51, -v51, v49
    v_mfma_f32_16x16x32_bf16 v[184:187], v[24:27], a[240:243], v[136:139]
    ds_read_b128 v[40:43], v2 offset:12416
    v_cvt_f32_i32 v242, v242
    v_cvt_f32_i32 v243, v243
    v_fma_f32 v242, v242, v48, v50
    v_fma_f32 v243, v243, v49, v51
    v_cvt_pk_bf16_f32 v227, v242, v243
    v_cvt_f32_i32 v246, v246
    v_cvt_f32_i32 v247, v247
    v_fma_f32 v246, v246, v48, v50
    v_fma_f32 v247, v247, v49, v51
    v_cvt_pk_bf16_f32 v231, v246, v247
    v_cvt_f32_i32 v250, v250
    v_cvt_f32_i32 v251, v251
    v_fma_f32 v250, v250, v48, v50
    v_fma_f32 v251, v251, v49, v51
    v_cvt_pk_bf16_f32 v235, v250, v251
    v_cvt_f32_i32 v254, v254
    v_cvt_f32_i32 v255, v255
    v_fma_f32 v254, v254, v48, v50
    v_fma_f32 v255, v255, v49, v51
    v_cvt_pk_bf16_f32 v239, v254, v255
    v_mfma_f32_16x16x32_bf16 v[184:187], v[28:31], a[244:247], v[184:187]
    buffer_store_dwordx4 v[224:227], v11, s[4:7], s33 offen offset:0 sc1
    v_mfma_f32_16x16x32_bf16 v[188:191], v[24:27], v[200:203], v[140:143]
    ds_read_b128 v[44:47], v3 offset:12416
    v_xor_b32 v55, 16, v11
    v_mfma_f32_16x16x32_bf16 v[188:191], v[28:31], v[204:207], v[188:191]
    s_waitcnt lgkmcnt(2)
    v_exp_f32 v16, v160
    v_mfma_f32_16x16x32_bf16 v[120:123], v[32:35], a[240:243], v[136:139]
    ds_read_b128 v[24:27], v2 offset:18560
    v_mfma_f32_16x16x32_bf16 v[120:123], v[36:39], a[244:247], v[120:123]
    buffer_store_dwordx4 v[228:231], v55, s[4:7], s33 offen offset:768 sc1
    v_mfma_f32_16x16x32_bf16 v[124:127], v[32:35], v[200:203], v[140:143]
    ds_read_b128 v[28:31], v3 offset:18560
    v_mfma_f32_16x16x32_bf16 v[124:127], v[36:39], v[204:207], v[124:127]
    s_waitcnt lgkmcnt(2)
    v_exp_f32 v17, v161
    v_mfma_f32_16x16x32_bf16 v[184:187], v[40:43], a[248:251], v[184:187]
    ds_read_b128 v[32:35], v2 offset:12544
    v_mfma_f32_16x16x32_bf16 v[184:187], v[44:47], a[252:255], v[184:187]
    v_exp_f32 v18, v162
    v_add_f32 v7, v7, v16
    v_mfma_f32_16x16x32_bf16 v[188:191], v[40:43], v[208:211], v[188:191]
    ds_read_b128 v[36:39], v3 offset:12544
    v_add_f32 v7, v7, v17
    v_mfma_f32_16x16x32_bf16 v[188:191], v[44:47], v[212:215], v[188:191]
    s_waitcnt lgkmcnt(2)
    v_exp_f32 v19, v163
    v_cvt_pk_bf16_f32 v160, v16, v17
    v_mfma_f32_16x16x32_bf16 v[120:123], v[24:27], a[248:251], v[120:123]
    ds_read_b128 v[40:43], v2 offset:18688
    v_xor_b32 v54, 32, v11
    v_mfma_f32_16x16x32_bf16 v[120:123], v[28:31], a[252:255], v[120:123]
    s_waitcnt vmcnt(4)
    v_exp_f32 v16, v96
    v_add_f32 v7, v7, v18
    v_mfma_f32_16x16x32_bf16 v[124:127], v[24:27], v[208:211], v[124:127]
    ds_read_b128 v[44:47], v3 offset:18688
    v_add_f32 v7, v7, v19
    v_mfma_f32_16x16x32_bf16 v[124:127], v[28:31], v[212:215], v[124:127]
    s_waitcnt lgkmcnt(2)
    s_barrier
    v_add_u32 v2, 49152, v2
    v_add_u32 v3, 49152, v3
    v_mfma_f32_16x16x32_bf16 v[184:187], v[32:35], v[192:195], v[184:187]
    ds_read_b128 v[24:27], v2 offset:0
    v_xor_b32 v55, 48, v11
    v_mfma_f32_16x16x32_bf16 v[184:187], v[36:39], v[196:199], v[184:187]
    buffer_store_dwordx4 v[232:235], v54, s[4:7], s33 offen offset:1536 sc1
    v_mfma_f32_16x16x32_bf16 v[188:191], v[32:35], v[216:219], v[188:191]
    ds_read_b128 v[28:31], v3 offset:0
    v_mfma_f32_16x16x32_bf16 v[188:191], v[36:39], v[220:223], v[188:191]
    s_waitcnt lgkmcnt(2)
    v_exp_f32 v17, v97
    v_cvt_pk_bf16_f32 v161, v18, v19
    v_mfma_f32_16x16x32_bf16 v[120:123], v[40:43], v[192:195], v[120:123]
    ds_read_b128 v[32:35], v2 offset:6144
    v_mfma_f32_16x16x32_bf16 v[120:123], v[44:47], v[196:199], v[120:123]
    buffer_store_dwordx4 v[236:239], v55, s[4:7], s33 offen offset:2304 sc1
    v_mfma_f32_16x16x32_bf16 v[124:127], v[40:43], v[216:219], v[124:127]
    ds_read_b128 v[36:39], v3 offset:6144
    v_mfma_f32_16x16x32_bf16 v[124:127], v[44:47], v[220:223], v[124:127]
    s_waitcnt lgkmcnt(2)
    v_exp_f32 v18, v98
    v_add_f32 v7, v7, v16
    v_add_f32 v7, v7, v17
    v_exp_f32 v19, v99
    v_cvt_pk_bf16_f32 v162, v16, v17
    v_exp_f32 v16, v164
    v_add_f32 v7, v7, v18
    v_add_f32 v7, v7, v19
    v_exp_f32 v17, v165
    v_cvt_pk_bf16_f32 v163, v18, v19
    v_exp_f32 v18, v166
    v_add_f32 v8, v8, v16
    v_add_f32 v8, v8, v17
    v_exp_f32 v19, v167
    v_cvt_pk_bf16_f32 v164, v16, v17
    v_exp_f32 v16, v100
    v_add_f32 v8, v8, v18
    v_add_f32 v8, v8, v19
    v_exp_f32 v17, v101
    v_cvt_pk_bf16_f32 v165, v18, v19
    v_exp_f32 v18, v102
    v_add_f32 v8, v8, v16
    v_add_f32 v8, v8, v17
    v_exp_f32 v19, v103
    v_cvt_pk_bf16_f32 v166, v16, v17
    v_add_f32 v8, v8, v18
    v_add_f32 v8, v8, v19
    v_cvt_pk_bf16_f32 v167, v18, v19
    v_add_f32 v168, v168, v136
    v_add_f32 v169, v169, v136
    v_add_f32 v170, v170, v136
    v_add_f32 v171, v171, v136
    v_add_f32 v104, v104, v136
    v_add_f32 v105, v105, v136
    v_add_f32 v106, v106, v136
    v_add_f32 v107, v107, v136
    v_add_f32 v172, v172, v140
    v_add_f32 v173, v173, v140
    v_add_f32 v174, v174, v140
    v_add_f32 v175, v175, v140
    v_add_f32 v108, v108, v140
    v_add_f32 v109, v109, v140
    v_add_f32 v110, v110, v140
    v_add_f32 v111, v111, v140
    v_exp_f32 v16, v168
    v_exp_f32 v17, v169
    v_exp_f32 v18, v170
    v_add_f32 v7, v7, v16
    v_add_f32 v7, v7, v17
    v_exp_f32 v19, v171
    v_cvt_pk_bf16_f32 v168, v16, v17
    v_exp_f32 v16, v104
    v_add_f32 v7, v7, v18
    v_add_f32 v7, v7, v19
    v_exp_f32 v17, v105
    v_cvt_pk_bf16_f32 v169, v18, v19
    v_exp_f32 v18, v106
    v_add_f32 v7, v7, v16
    v_add_f32 v7, v7, v17
    v_exp_f32 v19, v107
    v_cvt_pk_bf16_f32 v170, v16, v17
    v_exp_f32 v16, v172
    v_add_f32 v7, v7, v18
    v_add_f32 v7, v7, v19
    v_exp_f32 v17, v173
    v_cvt_pk_bf16_f32 v171, v18, v19
    v_exp_f32 v18, v174
    v_add_f32 v8, v8, v16
    v_add_f32 v8, v8, v17
    v_exp_f32 v19, v175
    v_cvt_pk_bf16_f32 v172, v16, v17
    v_exp_f32 v16, v108
    v_add_f32 v8, v8, v18
    v_add_f32 v8, v8, v19
    v_exp_f32 v17, v109
    v_cvt_pk_bf16_f32 v173, v18, v19
    v_exp_f32 v18, v110
    v_add_f32 v8, v8, v16
    v_add_f32 v8, v8, v17
    v_exp_f32 v19, v111
    v_cvt_pk_bf16_f32 v174, v16, v17
    v_add_f32 v8, v8, v18
    v_add_f32 v8, v8, v19
    v_cvt_pk_bf16_f32 v175, v18, v19
    v_mfma_f32_16x16x32_bf16 v[64:67], v[24:27], a[192:195], v[128:131]
    ds_read_b128 v[40:43], v2 offset:128
    v_mfma_f32_16x16x32_bf16 v[64:67], v[28:31], a[196:199], v[64:67]
    buffer_load_dwordx2 v[60:61], off, s[80:83], s37 offset:8
    v_mfma_f32_16x16x32_bf16 v[68:71], v[24:27], a[216:219], v[132:135]
    v_exp_f32 v16, v176
    v_mfma_f32_16x16x32_bf16 v[68:71], v[28:31], a[220:223], v[68:71]
    v_exp_f32 v17, v177
    v_mfma_f32_16x16x32_bf16 v[72:75], v[24:27], a[240:243], v[136:139]
    ds_read_b128 v[44:47], v3 offset:128
    v_mfma_f32_16x16x32_bf16 v[72:75], v[28:31], a[244:247], v[72:75]
    buffer_load_dwordx2 v[62:63], off, s[84:87], s37 offset:8
    v_mfma_f32_16x16x32_bf16 v[76:79], v[24:27], v[200:203], v[140:143]
    v_exp_f32 v18, v178
    v_mfma_f32_16x16x32_bf16 v[76:79], v[28:31], v[204:207], v[76:79]
    s_waitcnt lgkmcnt(2)
    v_add_f32 v7, v7, v16
    v_add_f32 v7, v7, v17
    v_mfma_f32_16x16x32_bf16 v[96:99], v[32:35], a[192:195], v[128:131]
    ds_read_b128 v[24:27], v2 offset:6272
    v_mfma_f32_16x16x32_bf16 v[96:99], v[36:39], a[196:199], v[96:99]
    buffer_load_dwordx4 v[240:243], v12, s[68:71], s16 offen offset:0 nt
    v_mfma_f32_16x16x32_bf16 v[100:103], v[32:35], a[216:219], v[132:135]
    s_waitcnt vmcnt(7)
    v_exp_f32 v19, v179
    v_mfma_f32_16x16x32_bf16 v[100:103], v[36:39], a[220:223], v[100:103]
    v_cvt_pk_bf16_f32 v176, v16, v17
    v_exp_f32 v16, v112
    v_mfma_f32_16x16x32_bf16 v[104:107], v[32:35], a[240:243], v[136:139]
    ds_read_b128 v[28:31], v3 offset:6272
    v_add_f32 v7, v7, v18
    v_mfma_f32_16x16x32_bf16 v[104:107], v[36:39], a[244:247], v[104:107]
    buffer_load_dwordx4 v[244:247], v12, s[68:71], s16 offen offset:768 nt
    v_add_f32 v7, v7, v19
    v_mfma_f32_16x16x32_bf16 v[108:111], v[32:35], v[200:203], v[140:143]
    v_exp_f32 v17, v113
    v_mfma_f32_16x16x32_bf16 v[108:111], v[36:39], v[204:207], v[108:111]
    s_waitcnt lgkmcnt(2)
    v_cvt_pk_bf16_f32 v177, v18, v19
    v_exp_f32 v18, v114
    v_mfma_f32_16x16x32_bf16 v[64:67], v[40:43], a[200:203], v[64:67]
    ds_read_b128 v[32:35], v2 offset:256
    v_add_f32 v7, v7, v16
    v_mfma_f32_16x16x32_bf16 v[64:67], v[44:47], a[204:207], v[64:67]
    buffer_load_dwordx4 v[248:251], v12, s[68:71], s16 offen offset:1536 nt
    v_add_f32 v7, v7, v17
    v_mfma_f32_16x16x32_bf16 v[68:71], v[40:43], a[224:227], v[68:71]
    v_exp_f32 v19, v115
    v_mfma_f32_16x16x32_bf16 v[68:71], v[44:47], a[228:231], v[68:71]
    v_cvt_pk_bf16_f32 v178, v16, v17
    v_exp_f32 v16, v180
    v_mfma_f32_16x16x32_bf16 v[72:75], v[40:43], a[248:251], v[72:75]
    ds_read_b128 v[36:39], v3 offset:256
    v_add_f32 v7, v7, v18
    v_mfma_f32_16x16x32_bf16 v[72:75], v[44:47], a[252:255], v[72:75]
    buffer_load_dwordx4 v[252:255], v12, s[68:71], s16 offen offset:2304 nt
    v_add_f32 v7, v7, v19
    v_mfma_f32_16x16x32_bf16 v[76:79], v[40:43], v[208:211], v[76:79]
    v_exp_f32 v17, v181
    v_mfma_f32_16x16x32_bf16 v[76:79], v[44:47], v[212:215], v[76:79]
    s_waitcnt lgkmcnt(2)
    v_cvt_pk_bf16_f32 v179, v18, v19
    v_exp_f32 v18, v182
    v_mfma_f32_16x16x32_bf16 v[96:99], v[24:27], a[200:203], v[96:99]
    s_mov_b32 m0, s26
    ds_read_b128 v[40:43], v2 offset:6400
    v_add_f32 v8, v8, v16
    v_mfma_f32_16x16x32_bf16 v[96:99], v[28:31], a[204:207], v[96:99]
    buffer_load_dwordx4 v4, s[4:7], s32 offen offset:0 sc1 lds
    v_add_f32 v8, v8, v17
    v_mfma_f32_16x16x32_bf16 v[100:103], v[24:27], a[224:227], v[100:103]
    v_exp_f32 v19, v183
    v_mfma_f32_16x16x32_bf16 v[100:103], v[28:31], a[228:231], v[100:103]
    v_cvt_pk_bf16_f32 v180, v16, v17
    v_exp_f32 v16, v116
    v_mfma_f32_16x16x32_bf16 v[104:107], v[24:27], a[248:251], v[104:107]
    ds_read_b128 v[44:47], v3 offset:6400
    v_add_f32 v8, v8, v18
    v_mfma_f32_16x16x32_bf16 v[104:107], v[28:31], a[252:255], v[104:107]
    buffer_load_dwordx4 v4, s[4:7], s32 offen offset:1024 sc1 lds
    v_add_f32 v8, v8, v19
    v_mfma_f32_16x16x32_bf16 v[108:111], v[24:27], v[208:211], v[108:111]
    v_exp_f32 v17, v117
    v_mfma_f32_16x16x32_bf16 v[108:111], v[28:31], v[212:215], v[108:111]
    s_waitcnt lgkmcnt(2)
    v_cvt_pk_bf16_f32 v181, v18, v19
    v_exp_f32 v18, v118
    v_mfma_f32_16x16x32_bf16 v[64:67], v[32:35], a[208:211], v[64:67]
    ds_read_b128 v[24:27], v2 offset:12288
    v_add_f32 v8, v8, v16
    v_mfma_f32_16x16x32_bf16 v[64:67], v[36:39], a[212:215], v[64:67]
    buffer_load_dwordx4 v4, s[4:7], s32 offen offset:2048 sc1 lds
    v_add_f32 v8, v8, v17
    v_mfma_f32_16x16x32_bf16 v[68:71], v[32:35], a[232:235], v[68:71]
    s_add_u32 s32, s32, 24576
    v_exp_f32 v19, v119
    v_mfma_f32_16x16x32_bf16 v[68:71], v[36:39], a[236:239], v[68:71]
    v_cvt_pk_bf16_f32 v182, v16, v17
    v_add_f32 v8, v8, v18
    v_add_f32 v8, v8, v19
    v_mfma_f32_16x16x32_bf16 v[72:75], v[32:35], v[192:195], v[72:75]
    s_sub_u32 s57, s32, 196608
    ds_read_b128 v[28:31], v3 offset:12288
    v_cvt_pk_bf16_f32 v183, v18, v19
    v_mfma_f32_16x16x32_bf16 v[72:75], v[36:39], v[196:199], v[72:75]
    s_waitcnt lgkmcnt(2)
    v_exp_f32 v16, v184
    v_lshlrev_b32 v48, 16, v56
    v_mfma_f32_16x16x32_bf16 v[76:79], v[32:35], v[216:219], v[76:79]
    s_waitcnt vmcnt(9)
    v_exp_f32 v17, v185
    v_mfma_f32_16x16x32_bf16 v[76:79], v[36:39], v[220:223], v[76:79]
    s_barrier
    v_exp_f32 v18, v186
    v_mfma_f32_16x16x32_bf16 v[96:99], v[40:43], a[208:211], v[96:99]
    s_min_u32 s32, s32, s57
    ds_read_b128 v[32:35], v2 offset:18432
    v_add_f32 v7, v7, v16
    v_mfma_f32_16x16x32_bf16 v[96:99], v[44:47], a[212:215], v[96:99]
    v_add_f32 v7, v7, v17
    v_exp_f32 v19, v187
    v_mfma_f32_16x16x32_bf16 v[100:103], v[40:43], a[232:235], v[100:103]
    s_add_u32 s26, s26, 12288
    v_cvt_pk_bf16_f32 v184, v16, v17
    v_and_b32 v49, s97, v56
    v_mfma_f32_16x16x32_bf16 v[100:103], v[44:47], a[236:239], v[100:103]
    v_exp_f32 v16, v120
    v_add_f32 v7, v7, v18
    v_mfma_f32_16x16x32_bf16 v[104:107], v[40:43], v[192:195], v[104:107]
    s_mov_b32 m0, s26
    ds_read_b128 v[36:39], v3 offset:18432
    v_add_f32 v7, v7, v19
    v_mfma_f32_16x16x32_bf16 v[104:107], v[44:47], v[196:199], v[104:107]
    buffer_load_dwordx4 v4, s[4:7], s32 offen offset:0 sc1 lds
    v_lshlrev_b32 v50, 16, v58
    v_mfma_f32_16x16x32_bf16 v[108:111], v[40:43], v[216:219], v[108:111]
    v_exp_f32 v17, v121
    v_mfma_f32_16x16x32_bf16 v[108:111], v[44:47], v[220:223], v[108:111]
    s_waitcnt lgkmcnt(2)
    v_cvt_pk_bf16_f32 v185, v18, v19
    v_exp_f32 v18, v122
    v_mfma_f32_16x16x32_bf16 v[80:83], v[24:27], a[192:195], v[128:131]
    ds_read_b128 v[40:43], v2 offset:12416
    v_add_f32 v7, v7, v16
    v_mfma_f32_16x16x32_bf16 v[80:83], v[28:31], a[196:199], v[80:83]
    buffer_load_dwordx4 v4, s[4:7], s32 offen offset:1024 sc1 lds
    v_add_f32 v7, v7, v17
    v_mfma_f32_16x16x32_bf16 v[84:87], v[24:27], a[216:219], v[132:135]
    v_exp_f32 v19, v123
    v_mfma_f32_16x16x32_bf16 v[84:87], v[28:31], a[220:223], v[84:87]
    v_cvt_pk_bf16_f32 v186, v16, v17
    v_exp_f32 v16, v188
    v_mfma_f32_16x16x32_bf16 v[88:91], v[24:27], a[240:243], v[136:139]
    ds_read_b128 v[44:47], v3 offset:12416
    v_add_f32 v7, v7, v18
    v_mfma_f32_16x16x32_bf16 v[88:91], v[28:31], a[244:247], v[88:91]
    v_add_u32 v0, 1, v0
    buffer_store_dword v0, v13, s[20:23], 0 offen offset:32 sc1
    v_mfma_f32_16x16x32_bf16 v[92:95], v[24:27], v[200:203], v[140:143]
    v_add_f32 v7, v7, v19
    v_exp_f32 v17, v189
    v_cvt_pk_bf16_f32 v187, v18, v19
    v_exp_f32 v18, v190
    v_add_f32 v8, v8, v16
    v_add_f32 v8, v8, v17
    v_exp_f32 v19, v191
    v_cvt_pk_bf16_f32 v188, v16, v17
    v_exp_f32 v16, v124
    v_add_f32 v8, v8, v18
    v_add_f32 v8, v8, v19
    v_exp_f32 v17, v125
    v_cvt_pk_bf16_f32 v189, v18, v19
    v_exp_f32 v18, v126
    v_add_f32 v8, v8, v16
    v_add_f32 v8, v8, v17
    v_exp_f32 v19, v127
    v_cvt_pk_bf16_f32 v190, v16, v17
    v_add_f32 v8, v8, v18
    v_add_f32 v8, v8, v19
    v_cvt_pk_bf16_f32 v191, v18, v19
    v_mfma_f32_16x16x32_bf16 v[92:95], v[28:31], v[204:207], v[92:95]
    s_waitcnt lgkmcnt(2)
    v_and_b32 v51, s97, v58
    v_mul_f32_e64 v50, -v50, v48
    v_mul_f32_e64 v51, -v51, v49
    v_mfma_f32_16x16x32_bf16 v[112:115], v[32:35], a[192:195], v[128:131]
    ds_read_b128 v[24:27], v2 offset:18560
    v_cvt_f32_i32 v144, v144
    v_mfma_f32_16x16x32_bf16 v[112:115], v[36:39], a[196:199], v[112:115]
    buffer_load_dwordx4 v4, s[4:7], s32 offen offset:2048 sc1 lds
    v_cvt_f32_i32 v148, v148
    v_mfma_f32_16x16x32_bf16 v[116:119], v[32:35], a[216:219], v[132:135]
    s_mov_b32 s32, 196608
    v_fma_f32 v144, v144, v48, v50
    v_fma_f32 v148, v148, v49, v51
    v_mfma_f32_16x16x32_bf16 v[116:119], v[36:39], a[220:223], v[116:119]
    v_cvt_f32_i32 v145, v145
    v_cvt_f32_i32 v149, v149
    v_fma_f32 v145, v145, v48, v50
    v_mfma_f32_16x16x32_bf16 v[120:123], v[32:35], a[240:243], v[136:139]
    s_add_u32 s26, s26, 36864
    ds_read_b128 v[28:31], v3 offset:18560
    v_fma_f32 v149, v149, v49, v51
    v_mfma_f32_16x16x32_bf16 v[120:123], v[36:39], a[244:247], v[120:123]
    v_cvt_f32_i32 v146, v146
    v_cvt_f32_i32 v150, v150
    v_fma_f32 v146, v146, v48, v50
    v_mfma_f32_16x16x32_bf16 v[124:127], v[32:35], v[200:203], v[140:143]
    s_sub_u32 s57, s26, 147456
    v_fma_f32 v150, v150, v49, v51
    v_cvt_f32_i32 v147, v147
    v_mfma_f32_16x16x32_bf16 v[124:127], v[36:39], v[204:207], v[124:127]
    s_waitcnt lgkmcnt(2)
    v_cvt_f32_i32 v151, v151
    v_exp_f32 v16, v64
    v_mfma_f32_16x16x32_bf16 v[80:83], v[40:43], a[200:203], v[80:83]
    s_min_u32 s26, s26, s57
    ds_read_b128 v[32:35], v2 offset:12544
    v_fma_f32 v147, v147, v48, v50
    v_mfma_f32_16x16x32_bf16 v[80:83], v[44:47], a[204:207], v[80:83]
    v_exp_f32 v17, v65
    v_fma_f32 v151, v151, v49, v51
    v_mfma_f32_16x16x32_bf16 v[84:87], v[40:43], a[224:227], v[84:87]
    s_mov_b32 m0, s56
    v_exp_f32 v18, v66
    v_mfma_f32_16x16x32_bf16 v[84:87], v[44:47], a[228:231], v[84:87]
    buffer_load_dwordx4 v4, s[4:7], s27 offen offset:0 sc1 lds
    v_lshlrev_b32 v48, 16, v57
    v_mfma_f32_16x16x32_bf16 v[88:91], v[40:43], a[248:251], v[88:91]
    ds_read_b128 v[36:39], v3 offset:12544
    v_add_f32 v5, v5, v16
    v_mfma_f32_16x16x32_bf16 v[88:91], v[44:47], a[252:255], v[88:91]
    v_add_f32 v5, v5, v17
    v_and_b32 v49, s97, v57
    v_lshlrev_b32 v50, 16, v59
    v_mfma_f32_16x16x32_bf16 v[92:95], v[40:43], v[208:211], v[92:95]
    v_exp_f32 v19, v67
    v_mfma_f32_16x16x32_bf16 v[92:95], v[44:47], v[212:215], v[92:95]
    s_waitcnt lgkmcnt(2)
    buffer_load_dwordx4 v4, s[4:7], s27 offen offset:1024 sc1 lds
    v_cvt_pk_bf16_f32 v64, v16, v17
    v_mfma_f32_16x16x32_bf16 v[112:115], v[24:27], a[200:203], v[112:115]
    ds_read_b128 v[40:43], v2 offset:18688
    v_and_b32 v51, s97, v59
    v_mfma_f32_16x16x32_bf16 v[112:115], v[28:31], a[204:207], v[112:115]
    v_exp_f32 v16, v96
    v_add_f32 v5, v5, v18
    v_mfma_f32_16x16x32_bf16 v[116:119], v[24:27], a[224:227], v[116:119]
    v_add_f32 v5, v5, v19
    v_mul_f32_e64 v50, -v50, v48
    v_mfma_f32_16x16x32_bf16 v[116:119], v[28:31], a[228:231], v[116:119]
    s_waitcnt vmcnt(13)
    buffer_load_dwordx4 v4, s[4:7], s27 offen offset:2048 sc1 lds
    v_mul_f32_e64 v51, -v51, v49
    v_mfma_f32_16x16x32_bf16 v[120:123], v[24:27], a[248:251], v[120:123]
    s_add_u32 s27, s27, 24576
    ds_read_b128 v[44:47], v3 offset:18688
    v_cvt_f32_i32 v152, v152
    v_mfma_f32_16x16x32_bf16 v[120:123], v[28:31], a[252:255], v[120:123]
    s_waitcnt lgkmcnt(2)
    v_exp_f32 v17, v97
    v_cvt_pk_bf16_f32 v65, v18, v19
    v_mfma_f32_16x16x32_bf16 v[124:127], v[24:27], v[208:211], v[124:127]
    s_sub_u32 s58, s27, 196608
    v_exp_f32 v18, v98
    v_mfma_f32_16x16x32_bf16 v[124:127], v[28:31], v[212:215], v[124:127]
    s_barrier
    v_subrev_u32 v1, 49152, v1
    v_add_f32 v5, v5, v16
    v_mfma_f32_16x16x32_bf16 v[80:83], v[32:35], a[208:211], v[80:83]
    s_min_u32 s27, s27, s58
    ds_read_b128 v[24:27], v1 offset:0
    v_add_f32 v5, v5, v17
    v_mfma_f32_16x16x32_bf16 v[80:83], v[36:39], a[212:215], v[80:83]
    v_exp_f32 v19, v99
    v_cvt_f32_i32 v156, v156
    v_mfma_f32_16x16x32_bf16 v[84:87], v[32:35], a[232:235], v[84:87]
    s_add_u32 s56, s56, 12288
    v_cvt_pk_bf16_f32 v66, v16, v17
    v_fma_f32 v152, v152, v48, v50
    v_mfma_f32_16x16x32_bf16 v[84:87], v[36:39], a[236:239], v[84:87]
    v_exp_f32 v16, v68
    v_fma_f32 v156, v156, v49, v51
    v_mfma_f32_16x16x32_bf16 v[88:91], v[32:35], v[192:195], v[88:91]
    s_mov_b32 m0, s56
    ds_read_b128 v[28:31], v1 offset:12288
    v_add_f32 v5, v5, v18
    v_mfma_f32_16x16x32_bf16 v[88:91], v[36:39], v[196:199], v[88:91]
    s_waitcnt vmcnt(12)
    buffer_load_dwordx4 v4, s[4:7], s27 offen offset:0 sc1 lds
    v_add_f32 v5, v5, v19
    v_mfma_f32_16x16x32_bf16 v[92:95], v[32:35], v[216:219], v[92:95]
    v_exp_f32 v17, v69
    v_mfma_f32_16x16x32_bf16 v[92:95], v[36:39], v[220:223], v[92:95]
    s_waitcnt lgkmcnt(2)
    v_cvt_f32_i32 v153, v153
    v_cvt_pk_bf16_f32 v67, v18, v19
    v_cvt_f32_i32 v157, v157
    v_mfma_f32_16x16x32_bf16 v[112:115], v[40:43], a[208:211], v[112:115]
    ds_read_b128 v[32:35], v1 offset:1024
    v_fma_f32 v153, v153, v48, v50
    v_mfma_f32_16x16x32_bf16 v[112:115], v[44:47], a[212:215], v[112:115]
    s_waitcnt vmcnt(12)
    buffer_load_dwordx4 v4, s[4:7], s27 offen offset:1024 sc1 lds
    v_fma_f32 v157, v157, v49, v51
    v_mfma_f32_16x16x32_bf16 v[116:119], v[40:43], a[232:235], v[116:119]
    s_waitcnt vmcnt(12)
    buffer_load_dwordx4 v4, s[4:7], s27 offen offset:2048 sc1 lds
    v_mfma_f32_16x16x32_bf16 v[116:119], v[44:47], a[236:239], v[116:119]
    v_exp_f32 v18, v70
    v_add_f32 v6, v6, v16
    v_mfma_f32_16x16x32_bf16 v[120:123], v[40:43], v[192:195], v[120:123]
    s_add_u32 s27, s27, 24576
    ds_read_b128 v[36:39], v1 offset:13312
    v_add_f32 v6, v6, v17
    v_mfma_f32_16x16x32_bf16 v[120:123], v[44:47], v[196:199], v[120:123]
    v_exp_f32 v19, v71
    v_cvt_pk_bf16_f32 v68, v16, v17
    v_mfma_f32_16x16x32_bf16 v[124:127], v[40:43], v[216:219], v[124:127]
    s_sub_u32 s58, s27, 196608
    v_exp_f32 v16, v100
    v_mfma_f32_16x16x32_bf16 v[124:127], v[44:47], v[220:223], v[124:127]
    s_waitcnt lgkmcnt(2)
    v_cvt_f32_i32 v154, v154
    v_add_f32 v6, v6, v18
    v_cvt_f32_i32 v158, v158
    v_add_f32 v6, v6, v19
    v_fma_f32 v154, v154, v48, v50
    v_exp_f32 v17, v101
    v_fma_f32 v158, v158, v49, v51
    v_cvt_f32_i32 v155, v155
    v_cvt_pk_bf16_f32 v69, v18, v19
    v_cvt_f32_i32 v159, v159
    v_exp_f32 v18, v102
    v_fma_f32 v155, v155, v48, v50
    v_fma_f32 v159, v159, v49, v51
    v_add_f32 v6, v6, v16
    v_cvt_pk_bf16_f32 v144, v144, v148
    v_add_f32 v6, v6, v17
    v_cvt_pk_bf16_f32 v148, v145, v149
    v_exp_f32 v19, v103
    v_cvt_pk_bf16_f32 v145, v152, v156
    v_cvt_pk_bf16_f32 v149, v153, v157
    v_cvt_pk_bf16_f32 v70, v16, v17
    s_min_u32 s27, s27, s58
    v_cvt_pk_bf16_f32 v152, v146, v150
    v_add_f32 v6, v6, v18
    s_add_u32 s56, s56, 36864
    v_cvt_pk_bf16_f32 v153, v154, v158
    v_add_f32 v6, v6, v19
    s_sub_u32 s58, s56, 147456
    v_cvt_pk_bf16_f32 v156, v147, v151
    v_cvt_pk_bf16_f32 v71, v18, v19
    s_min_u32 s56, s56, s58
    v_cvt_pk_bf16_f32 v157, v155, v159
    s_mov_b32 s31, 7
    v_mfma_f32_16x16x32_bf16 a[96:99], v[160:163], v[24:27], 0
    s_add_u32 s33, s33, 196608
    ds_read_b128 v[40:43], v1 offset:2048
    v_mfma_f32_16x16x32_bf16 a[96:99], v[168:171], v[28:31], a[96:99]
    s_add_u32 s34, s34, 196608
    v_exp_f32 v16, v72
    v_mfma_f32_16x16x32_bf16 a[144:147], v[164:167], v[24:27], 0
    s_add_u32 s36, s36, 1536
    ds_read_b128 v[44:47], v1 offset:14336
    v_mfma_f32_16x16x32_bf16 a[144:147], v[172:175], v[28:31], a[144:147]
    s_waitcnt lgkmcnt(2)
    v_exp_f32 v17, v73
    v_mfma_f32_16x16x32_bf16 a[100:103], v[160:163], v[32:35], 0
    ds_read_b128 v[24:27], v1 offset:3072
    v_mfma_f32_16x16x32_bf16 a[100:103], v[168:171], v[36:39], a[100:103]
    s_waitcnt vmcnt(12)
    buffer_load_dwordx2 v[56:57], v10, s[72:75], s36 offen offset:0
    v_mfma_f32_16x16x32_bf16 a[148:151], v[164:167], v[32:35], 0
    ds_read_b128 v[28:31], v1 offset:15360
    v_mfma_f32_16x16x32_bf16 a[148:151], v[172:175], v[36:39], a[148:151]
    s_waitcnt lgkmcnt(2)
    v_exp_f32 v18, v74
    v_mfma_f32_16x16x32_bf16 a[104:107], v[160:163], v[40:43], 0
    ds_read_b128 v[32:35], v1 offset:4096
    v_add_f32 v7, v7, v16
    v_mfma_f32_16x16x32_bf16 a[104:107], v[168:171], v[44:47], a[104:107]
    buffer_load_dwordx2 v[58:59], v10, s[76:79], s36 offen offset:0
    v_mfma_f32_16x16x32_bf16 a[152:155], v[164:167], v[40:43], 0
    ds_read_b128 v[36:39], v1 offset:16384
    v_add_f32 v7, v7, v17
    v_mfma_f32_16x16x32_bf16 a[152:155], v[172:175], v[44:47], a[152:155]
    s_waitcnt lgkmcnt(2)
    v_exp_f32 v19, v75
    v_mfma_f32_16x16x32_bf16 a[108:111], v[160:163], v[24:27], 0
    ds_read_b128 v[40:43], v1 offset:5120
    v_cvt_pk_bf16_f32 v72, v16, v17
    v_mfma_f32_16x16x32_bf16 a[108:111], v[168:171], v[28:31], a[108:111]
    s_waitcnt vmcnt(13)
    buffer_load_dwordx4 v[224:227], v9, s[64:67], s33 offen offset:0 nt
    v_mfma_f32_16x16x32_bf16 a[156:159], v[164:167], v[24:27], 0
    ds_read_b128 v[44:47], v1 offset:17408
    v_mfma_f32_16x16x32_bf16 a[156:159], v[172:175], v[28:31], a[156:159]
    s_waitcnt lgkmcnt(2)
    v_exp_f32 v16, v104
    v_mfma_f32_16x16x32_bf16 a[112:115], v[160:163], v[32:35], 0
    ds_read_b128 v[24:27], v1 offset:6144
    v_add_f32 v7, v7, v18
    v_mfma_f32_16x16x32_bf16 a[112:115], v[168:171], v[36:39], a[112:115]
    s_waitcnt vmcnt(13)
    buffer_load_dwordx4 v[228:231], v9, s[64:67], s33 offen offset:1536 nt
    v_add_f32 v7, v7, v19
    v_mfma_f32_16x16x32_bf16 a[160:163], v[164:167], v[32:35], 0
    ds_read_b128 v[28:31], v1 offset:18432
    v_mfma_f32_16x16x32_bf16 a[160:163], v[172:175], v[36:39], a[160:163]
    s_waitcnt lgkmcnt(2)
    v_exp_f32 v17, v105
    v_cvt_pk_bf16_f32 v73, v18, v19
    v_mfma_f32_16x16x32_bf16 a[116:119], v[160:163], v[40:43], 0
    ds_read_b128 v[32:35], v1 offset:7168
    v_mfma_f32_16x16x32_bf16 a[116:119], v[168:171], v[44:47], a[116:119]
    buffer_load_dwordx4 v[232:235], v9, s[64:67], s34 offen offset:0 nt
    v_mfma_f32_16x16x32_bf16 a[164:167], v[164:167], v[40:43], 0
    ds_read_b128 v[36:39], v1 offset:19456
    v_mfma_f32_16x16x32_bf16 a[164:167], v[172:175], v[44:47], a[164:167]
    s_waitcnt lgkmcnt(2)
    v_exp_f32 v18, v106
    v_add_f32 v7, v7, v16
    v_mfma_f32_16x16x32_bf16 a[120:123], v[160:163], v[24:27], 0
    ds_read_b128 v[40:43], v1 offset:8192
    v_add_f32 v7, v7, v17
    v_mfma_f32_16x16x32_bf16 a[120:123], v[168:171], v[28:31], a[120:123]
    s_waitcnt vmcnt(14)
    buffer_load_dwordx4 v[236:239], v9, s[64:67], s34 offen offset:1536 nt
    v_mfma_f32_16x16x32_bf16 a[168:171], v[164:167], v[24:27], 0
    ds_read_b128 v[44:47], v1 offset:20480
    v_mfma_f32_16x16x32_bf16 a[168:171], v[172:175], v[28:31], a[168:171]
    s_waitcnt lgkmcnt(2)
    v_exp_f32 v19, v107
    v_cvt_pk_bf16_f32 v74, v16, v17
    v_mfma_f32_16x16x32_bf16 a[124:127], v[160:163], v[32:35], 0
    ds_read_b128 v[24:27], v1 offset:9216
    v_mfma_f32_16x16x32_bf16 a[124:127], v[168:171], v[36:39], a[124:127]
    v_exp_f32 v16, v76
    v_add_f32 v7, v7, v18
    v_mfma_f32_16x16x32_bf16 a[172:175], v[164:167], v[32:35], 0
    s_waitcnt vmcnt(19)
    ds_read_b128 v[28:31], v1 offset:21504
    v_add_f32 v7, v7, v19
    v_mfma_f32_16x16x32_bf16 a[172:175], v[172:175], v[36:39], a[172:175]
    s_waitcnt lgkmcnt(2)
    v_exp_f32 v17, v77
    v_cvt_pk_bf16_f32 v75, v18, v19
    v_mfma_f32_16x16x32_bf16 a[128:131], v[160:163], v[40:43], 0
    s_add_u32 s29, s28, 49152
    ds_read_b128 v[32:35], v1 offset:10240
    v_lshlrev_b32 v48, 16, v60
    v_mfma_f32_16x16x32_bf16 a[128:131], v[168:171], v[44:47], a[128:131]
    v_exp_f32 v18, v78
    v_add_f32 v8, v8, v16
    v_mfma_f32_16x16x32_bf16 a[176:179], v[164:167], v[40:43], 0
    s_sub_u32 s3, s29, 147456
    ds_read_b128 v[36:39], v1 offset:22528
    v_add_f32 v8, v8, v17
    v_mfma_f32_16x16x32_bf16 a[176:179], v[172:175], v[44:47], a[176:179]
    s_waitcnt lgkmcnt(2)
    v_exp_f32 v19, v79
    v_mfma_f32_16x16x32_bf16 a[132:135], v[160:163], v[24:27], 0
    s_min_u32 s29, s29, s3
    ds_read_b128 v[40:43], v1 offset:11264
    v_cvt_pk_bf16_f32 v76, v16, v17
    v_mfma_f32_16x16x32_bf16 a[132:135], v[168:171], v[28:31], a[132:135]
    v_exp_f32 v16, v108
    v_mfma_f32_16x16x32_bf16 a[180:183], v[164:167], v[24:27], 0
    s_sub_u32 s3, s29, s28
    ds_read_b128 v[44:47], v1 offset:23552
    v_and_b32 v49, s97, v60
    v_mfma_f32_16x16x32_bf16 a[180:183], v[172:175], v[28:31], a[180:183]
    s_waitcnt lgkmcnt(2)
    v_add_u32 v1, 49152, v1
    v_add_f32 v8, v8, v18
    v_mfma_f32_16x16x32_bf16 a[136:139], v[160:163], v[32:35], 0
    ds_read_b128 v[24:27], v1 offset:0
    v_add_f32 v8, v8, v19
    v_mfma_f32_16x16x32_bf16 a[136:139], v[168:171], v[36:39], a[136:139]
    v_lshlrev_b32 v50, 16, v62
    v_exp_f32 v17, v109
    v_mfma_f32_16x16x32_bf16 a[184:187], v[164:167], v[32:35], 0
    ds_read_b128 v[28:31], v1 offset:12288
    v_and_b32 v51, s97, v62
    v_mfma_f32_16x16x32_bf16 a[184:187], v[172:175], v[36:39], a[184:187]
    s_waitcnt lgkmcnt(2)
    v_cvt_pk_bf16_f32 v77, v18, v19
    v_mul_f32_e64 v50, -v50, v48
    v_mfma_f32_16x16x32_bf16 a[140:143], v[160:163], v[40:43], 0
    s_mov_b32 s28, s29
    ds_read_b128 v[32:35], v1 offset:1024
    v_bfe_u32 v53, v4, 4, 6
    v_mfma_f32_16x16x32_bf16 a[140:143], v[168:171], v[44:47], a[140:143]
    v_exp_f32 v18, v110
    v_mul_f32_e64 v51, -v51, v49
    v_mfma_f32_16x16x32_bf16 a[188:191], v[164:167], v[40:43], 0
    ds_read_b128 v[36:39], v1 offset:13312
    v_lshlrev_b32 v53, 2, v53
    v_mfma_f32_16x16x32_bf16 a[188:191], v[172:175], v[44:47], a[188:191]
    s_waitcnt lgkmcnt(2)
    s_barrier
    v_add_f32 v8, v8, v16
    v_mfma_f32_16x16x32_bf16 a[96:99], v[176:179], v[24:27], a[96:99]
    ds_read_b128 v[40:43], v1 offset:2048
    buffer_load_dword v52, v53, s[20:23], s44 offen sc1
    v_mfma_f32_16x16x32_bf16 a[96:99], v[184:187], v[28:31], a[96:99]
    v_add_f32 v8, v8, v17
    v_cvt_f32_i32 v240, v240
    v_cvt_f32_i32 v244, v244
    v_mfma_f32_16x16x32_bf16 a[144:147], v[180:183], v[24:27], a[144:147]
    ds_read_b128 v[44:47], v1 offset:14336
    v_fma_f32 v240, v240, v48, v50
    v_mfma_f32_16x16x32_bf16 a[144:147], v[188:191], v[28:31], a[144:147]
    s_waitcnt lgkmcnt(2)
    v_exp_f32 v19, v111
    v_cvt_pk_bf16_f32 v78, v16, v17
    v_mfma_f32_16x16x32_bf16 a[100:103], v[176:179], v[32:35], a[100:103]
    s_mov_b32 m0, s56
    ds_read_b128 v[24:27], v1 offset:3072
    v_add_f32 v8, v8, v18
    v_mfma_f32_16x16x32_bf16 a[100:103], v[184:187], v[36:39], a[100:103]
    s_waitcnt vmcnt(15)
    buffer_load_dwordx4 v4, s[4:7], s27 offen offset:0 sc1 lds
    v_add_f32 v8, v8, v19
    v_mfma_f32_16x16x32_bf16 a[148:151], v[180:183], v[32:35], a[148:151]
    ds_read_b128 v[28:31], v1 offset:15360
    v_fma_f32 v244, v244, v49, v51
    v_mfma_f32_16x16x32_bf16 a[148:151], v[188:191], v[36:39], a[148:151]
    s_waitcnt lgkmcnt(2)
    v_cvt_pk_bf16_f32 v79, v18, v19
    v_cvt_f32_i32 v241, v241
    v_cvt_f32_i32 v245, v245
    v_mfma_f32_16x16x32_bf16 a[104:107], v[176:179], v[40:43], a[104:107]
    ds_read_b128 v[32:35], v1 offset:4096
    v_fma_f32 v241, v241, v48, v50
    v_mfma_f32_16x16x32_bf16 a[104:107], v[184:187], v[44:47], a[104:107]
    s_waitcnt vmcnt(14)
    buffer_load_dwordx4 v4, s[4:7], s27 offen offset:1024 sc1 lds
    v_fma_f32 v245, v245, v49, v51
    v_mfma_f32_16x16x32_bf16 a[152:155], v[180:183], v[40:43], a[152:155]
    ds_read_b128 v[36:39], v1 offset:16384
    v_cvt_f32_i32 v242, v242
    v_mfma_f32_16x16x32_bf16 a[152:155], v[188:191], v[44:47], a[152:155]
    s_waitcnt lgkmcnt(2)
    v_exp_f32 v16, v80
    v_cvt_f32_i32 v246, v246
    v_mfma_f32_16x16x32_bf16 a[108:111], v[176:179], v[24:27], a[108:111]
    ds_read_b128 v[40:43], v1 offset:5120
    v_fma_f32 v242, v242, v48, v50
    v_mfma_f32_16x16x32_bf16 a[108:111], v[184:187], v[28:31], a[108:111]
    s_waitcnt vmcnt(14)
    buffer_load_dwordx4 v4, s[4:7], s27 offen offset:2048 sc1 lds
    v_fma_f32 v246, v246, v49, v51
    v_mfma_f32_16x16x32_bf16 a[156:159], v[180:183], v[24:27], a[156:159]
    s_add_u32 s27, s27, 24576
    ds_read_b128 v[44:47], v1 offset:17408
    v_cvt_f32_i32 v243, v243
    v_mfma_f32_16x16x32_bf16 a[156:159], v[188:191], v[28:31], a[156:159]
    s_waitcnt lgkmcnt(2)
    v_exp_f32 v17, v81
    v_cvt_f32_i32 v247, v247
    v_mfma_f32_16x16x32_bf16 a[112:115], v[176:179], v[32:35], a[112:115]
    s_sub_u32 s58, s27, 196608
    ds_read_b128 v[24:27], v1 offset:6144
    v_fma_f32 v243, v243, v48, v50
    v_mfma_f32_16x16x32_bf16 a[112:115], v[184:187], v[36:39], a[112:115]
    v_exp_f32 v18, v82
    v_add_f32 v5, v5, v16
    v_mfma_f32_16x16x32_bf16 a[160:163], v[180:183], v[32:35], a[160:163]
    s_min_u32 s27, s27, s58
    ds_read_b128 v[28:31], v1 offset:18432
    v_add_f32 v5, v5, v17
    v_mfma_f32_16x16x32_bf16 a[160:163], v[188:191], v[36:39], a[160:163]
    s_waitcnt lgkmcnt(2)
    v_exp_f32 v19, v83
    v_cvt_pk_bf16_f32 v80, v16, v17
    v_mfma_f32_16x16x32_bf16 a[116:119], v[176:179], v[40:43], a[116:119]
    s_add_u32 s56, s56, 12288
    ds_read_b128 v[32:35], v1 offset:7168
    v_fma_f32 v247, v247, v49, v51
    v_mfma_f32_16x16x32_bf16 a[116:119], v[184:187], v[44:47], a[116:119]
    v_exp_f32 v16, v112
    v_add_f32 v5, v5, v18
    v_mfma_f32_16x16x32_bf16 a[164:167], v[180:183], v[40:43], a[164:167]
    ds_read_b128 v[36:39], v1 offset:19456
    v_add_u32 v2, s3, v2
    v_add_u32 v3, s3, v3
    v_mfma_f32_16x16x32_bf16 a[164:167], v[188:191], v[44:47], a[164:167]
    s_waitcnt lgkmcnt(2)
    v_add_f32 v5, v5, v19
    v_exp_f32 v17, v113
    v_mfma_f32_16x16x32_bf16 a[120:123], v[176:179], v[24:27], a[120:123]
    s_mov_b32 m0, s56
    ds_read_b128 v[40:43], v1 offset:8192
    v_cvt_pk_bf16_f32 v81, v18, v19
    v_mfma_f32_16x16x32_bf16 a[120:123], v[184:187], v[28:31], a[120:123]
    s_waitcnt vmcnt(14)
    buffer_load_dwordx4 v4, s[4:7], s27 offen offset:0 sc1 lds
    v_lshlrev_b32 v48, 16, v61
    v_mfma_f32_16x16x32_bf16 a[168:171], v[180:183], v[24:27], a[168:171]
    ds_read_b128 v[44:47], v1 offset:20480
    v_and_b32 v49, s97, v61
    v_mfma_f32_16x16x32_bf16 a[168:171], v[188:191], v[28:31], a[168:171]
    s_waitcnt lgkmcnt(2)
    v_exp_f32 v18, v114
    v_add_f32 v5, v5, v16
    v_mfma_f32_16x16x32_bf16 a[124:127], v[176:179], v[32:35], a[124:127]
    ds_read_b128 v[24:27], v1 offset:9216
    v_add_f32 v5, v5, v17
    v_mfma_f32_16x16x32_bf16 a[124:127], v[184:187], v[36:39], a[124:127]
    s_waitcnt vmcnt(14)
    buffer_load_dwordx4 v4, s[4:7], s27 offen offset:1024 sc1 lds
    v_lshlrev_b32 v50, 16, v63
    v_mfma_f32_16x16x32_bf16 a[172:175], v[180:183], v[32:35], a[172:175]
    ds_read_b128 v[28:31], v1 offset:21504
    v_and_b32 v51, s97, v63
    v_mfma_f32_16x16x32_bf16 a[172:175], v[188:191], v[36:39], a[172:175]
    s_waitcnt lgkmcnt(2)
    v_exp_f32 v19, v115
    v_cvt_pk_bf16_f32 v82, v16, v17
    v_mfma_f32_16x16x32_bf16 a[128:131], v[176:179], v[40:43], a[128:131]
    ds_read_b128 v[32:35], v1 offset:10240
    v_mul_f32_e64 v50, -v50, v48
    v_mfma_f32_16x16x32_bf16 a[128:131], v[184:187], v[44:47], a[128:131]
    s_waitcnt vmcnt(14)
    buffer_load_dwordx4 v4, s[4:7], s27 offen offset:2048 sc1 lds
    v_mul_f32_e64 v51, -v51, v49
    v_mfma_f32_16x16x32_bf16 a[176:179], v[180:183], v[40:43], a[176:179]
    ds_read_b128 v[36:39], v1 offset:22528
    v_cvt_f32_i32 v248, v248
    v_mfma_f32_16x16x32_bf16 a[176:179], v[188:191], v[44:47], a[176:179]
    s_waitcnt lgkmcnt(2)
    v_exp_f32 v16, v84
    v_add_f32 v5, v5, v18
    v_mfma_f32_16x16x32_bf16 a[132:135], v[176:179], v[24:27], a[132:135]
    ds_read_b128 v[40:43], v1 offset:11264
    v_add_f32 v5, v5, v19
    v_mfma_f32_16x16x32_bf16 a[132:135], v[184:187], v[28:31], a[132:135]
    s_waitcnt vmcnt(19)
    v_exp_f32 v17, v85
    v_cvt_f32_i32 v252, v252
    v_mfma_f32_16x16x32_bf16 a[180:183], v[180:183], v[24:27], a[180:183]
    s_mov_b32 s27, 208896
    ds_read_b128 v[44:47], v1 offset:23552
    v_cvt_pk_bf16_f32 v83, v18, v19
    v_mfma_f32_16x16x32_bf16 a[180:183], v[188:191], v[28:31], a[180:183]
    s_waitcnt lgkmcnt(2)
    s_barrier
    v_fma_f32 v248, v248, v48, v50
    v_mfma_f32_16x16x32_bf16 a[136:139], v[176:179], v[32:35], a[136:139]
    s_add_u32 s56, s56, 36864
    ds_read_b128 v[24:27], v2 offset:0
    v_fma_f32 v252, v252, v49, v51
    v_mfma_f32_16x16x32_bf16 a[136:139], v[184:187], v[36:39], a[136:139]
    v_exp_f32 v18, v86
    v_add_f32 v6, v6, v16
    v_mfma_f32_16x16x32_bf16 a[184:187], v[180:183], v[32:35], a[184:187]
    s_sub_u32 s58, s56, 147456
    ds_read_b128 v[28:31], v3 offset:0
    v_cvt_f32_i32 v249, v249
    v_mfma_f32_16x16x32_bf16 a[184:187], v[188:191], v[36:39], a[184:187]
    s_waitcnt lgkmcnt(2)
    v_add_f32 v6, v6, v17
    v_cvt_f32_i32 v253, v253
    v_fma_f32 v249, v249, v48, v50
    v_mfma_f32_16x16x32_bf16 a[140:143], v[176:179], v[40:43], a[140:143]
    s_nop 0
    ds_read_b128 v[32:35], v2 offset:6144
    v_fma_f32 v253, v253, v49, v51
    v_mfma_f32_16x16x32_bf16 a[140:143], v[184:187], v[44:47], a[140:143]
    s_min_u32 s56, s56, s58
    v_exp_f32 v19, v87
    v_cvt_pk_bf16_f32 v84, v16, v17
    v_mfma_f32_16x16x32_bf16 a[188:191], v[180:183], v[40:43], a[188:191]
    s_waitcnt lgkmcnt(1)
    ds_read_b128 v[36:39], v3 offset:6144
    v_exp_f32 v16, v116
    v_cvt_f32_i32 v250, v250
    v_add_f32 v6, v6, v18
    v_cvt_f32_i32 v254, v254
    v_add_f32 v6, v6, v19
    v_fma_f32 v250, v250, v48, v50
    v_exp_f32 v17, v117
    v_fma_f32 v254, v254, v49, v51
    v_cvt_f32_i32 v251, v251
    v_cvt_pk_bf16_f32 v85, v18, v19
    v_cvt_f32_i32 v255, v255
    v_exp_f32 v18, v118
    v_fma_f32 v251, v251, v48, v50
    v_fma_f32 v255, v255, v49, v51
    v_add_f32 v6, v6, v16
    v_cvt_pk_bf16_f32 v146, v240, v244
    v_add_f32 v6, v6, v17
    v_cvt_pk_bf16_f32 v150, v241, v245
    v_exp_f32 v19, v119
    v_cvt_pk_bf16_f32 v147, v248, v252
    v_cvt_pk_bf16_f32 v151, v249, v253
    v_cvt_pk_bf16_f32 v86, v16, v17
    v_cvt_pk_bf16_f32 v154, v242, v246
    v_add_f32 v6, v6, v18
    v_cvt_pk_bf16_f32 v155, v250, v254
    v_add_f32 v6, v6, v19
    v_cvt_pk_bf16_f32 v158, v243, v247
    v_cvt_pk_bf16_f32 v87, v18, v19
    v_cvt_pk_bf16_f32 v159, v251, v255
    v_mfma_f32_16x16x32_bf16 a[188:191], v[188:191], v[44:47], a[188:191]
    s_branch L_join
.p2align 6
L_loop:
    v_mfma_f32_16x16x32_bf16 v[160:163], v[24:27], a[192:195], v[128:131]
    s_mov_b32 m0, s56
    ds_read_b128 v[40:43], v2 offset:128
    v_fma_f32 v250, v250, v48, v50
    v_mfma_f32_16x16x32_bf16 v[160:163], v[28:31], a[196:199], v[160:163]
    buffer_load_dwordx4 v4, s[4:7], s27 offen offset:0 sc1 lds
    v_mfma_f32_16x16x32_bf16 v[164:167], v[24:27], a[216:219], v[132:135]
    v_exp_f32 v16, v88
    v_mfma_f32_16x16x32_bf16 v[164:167], v[28:31], a[220:223], v[164:167]
    v_exp_f32 v17, v89
    v_mfma_f32_16x16x32_bf16 v[168:171], v[24:27], a[240:243], v[136:139]
    ds_read_b128 v[44:47], v3 offset:128
    v_fma_f32 v251, v251, v49, v51
    v_mfma_f32_16x16x32_bf16 v[168:171], v[28:31], a[244:247], v[168:171]
    v_exp_f32 v18, v90
    v_mfma_f32_16x16x32_bf16 v[172:175], v[24:27], v[200:203], v[140:143]
    v_add_f32 v7, v7, v16
    v_add_f32 v7, v7, v17
    v_mfma_f32_16x16x32_bf16 v[172:175], v[28:31], v[204:207], v[172:175]
    s_waitcnt lgkmcnt(2)
    v_exp_f32 v19, v91
    v_mfma_f32_16x16x32_bf16 v[96:99], v[32:35], a[192:195], v[128:131]
    ds_read_b128 v[24:27], v2 offset:6272
    v_cvt_pk_bf16_f32 v235, v250, v251
    v_mfma_f32_16x16x32_bf16 v[96:99], v[36:39], a[196:199], v[96:99]
    buffer_load_dwordx4 v4, s[4:7], s27 offen offset:1024 sc1 lds
    v_mfma_f32_16x16x32_bf16 v[100:103], v[32:35], a[216:219], v[132:135]
    v_cvt_pk_bf16_f32 v88, v16, v17
    v_cvt_f32_i32 v254, v254
    v_mfma_f32_16x16x32_bf16 v[100:103], v[36:39], a[220:223], v[100:103]
    v_exp_f32 v16, v120
    v_mfma_f32_16x16x32_bf16 v[104:107], v[32:35], a[240:243], v[136:139]
    ds_read_b128 v[28:31], v3 offset:6272
    v_add_f32 v7, v7, v18
    v_mfma_f32_16x16x32_bf16 v[104:107], v[36:39], a[244:247], v[104:107]
    v_add_f32 v7, v7, v19
    v_cvt_f32_i32 v255, v255
    v_mfma_f32_16x16x32_bf16 v[108:111], v[32:35], v[200:203], v[140:143]
    v_exp_f32 v17, v121
    v_mfma_f32_16x16x32_bf16 v[108:111], v[36:39], v[204:207], v[108:111]
    s_waitcnt lgkmcnt(2)
    v_cvt_pk_bf16_f32 v89, v18, v19
    v_fma_f32 v254, v254, v48, v50
    v_mfma_f32_16x16x32_bf16 v[160:163], v[40:43], a[200:203], v[160:163]
    ds_read_b128 v[32:35], v2 offset:256
    v_mfma_f32_16x16x32_bf16 v[160:163], v[44:47], a[204:207], v[160:163]
    v_exp_f32 v18, v122
    v_mfma_f32_16x16x32_bf16 v[164:167], v[40:43], a[224:227], v[164:167]
    v_add_f32 v7, v7, v16
    v_add_f32 v7, v7, v17
    v_mfma_f32_16x16x32_bf16 v[164:167], v[44:47], a[228:231], v[164:167]
    buffer_load_dwordx4 v4, s[4:7], s27 offen offset:2048 sc1 lds
    v_mfma_f32_16x16x32_bf16 v[168:171], v[40:43], a[248:251], v[168:171]
    ds_read_b128 v[36:39], v3 offset:256
    v_fma_f32 v255, v255, v49, v51
    v_mfma_f32_16x16x32_bf16 v[168:171], v[44:47], a[252:255], v[168:171]
    v_exp_f32 v19, v123
    v_mfma_f32_16x16x32_bf16 v[172:175], v[40:43], v[208:211], v[172:175]
    v_cvt_pk_bf16_f32 v90, v16, v17
    v_cvt_pk_bf16_f32 v239, v254, v255
    v_mfma_f32_16x16x32_bf16 v[172:175], v[44:47], v[212:215], v[172:175]
    s_waitcnt lgkmcnt(2)
    v_exp_f32 v16, v92
    v_mfma_f32_16x16x32_bf16 v[96:99], v[24:27], a[200:203], v[96:99]
    ds_read_b128 v[40:43], v2 offset:6400
    v_add_f32 v7, v7, v18
    v_mfma_f32_16x16x32_bf16 v[96:99], v[28:31], a[204:207], v[96:99]
    s_add_u32 s27, s27, 24576
    v_add_f32 v7, v7, v19
    v_mfma_f32_16x16x32_bf16 v[100:103], v[24:27], a[224:227], v[100:103]
    v_exp_f32 v17, v93
    v_mfma_f32_16x16x32_bf16 v[100:103], v[28:31], a[228:231], v[100:103]
    v_cvt_pk_bf16_f32 v91, v18, v19
    v_mfma_f32_16x16x32_bf16 v[104:107], v[24:27], a[248:251], v[104:107]
    ds_read_b128 v[44:47], v3 offset:6400
    v_mfma_f32_16x16x32_bf16 v[104:107], v[28:31], a[252:255], v[104:107]
    v_exp_f32 v18, v94
    v_mfma_f32_16x16x32_bf16 v[108:111], v[24:27], v[208:211], v[108:111]
    s_add_u32 s29, s30, 49152
    v_add_f32 v8, v8, v16
    v_add_f32 v8, v8, v17
    v_mfma_f32_16x16x32_bf16 v[108:111], v[28:31], v[212:215], v[108:111]
    s_waitcnt lgkmcnt(2)
    v_exp_f32 v19, v95
    v_mfma_f32_16x16x32_bf16 v[160:163], v[32:35], a[208:211], v[160:163]
    s_waitcnt vmcnt(11)
    ds_read_b128 v[24:27], v2 offset:12288
    v_cvt_pk_bf16_f32 v92, v16, v17
    v_mfma_f32_16x16x32_bf16 v[160:163], v[36:39], a[212:215], v[160:163]
    s_sub_u32 s3, s29, 147456
    buffer_load_dwordx2 v[60:61], off, s[80:83], s37 offset:8
    v_mfma_f32_16x16x32_bf16 v[164:167], v[32:35], a[232:235], v[164:167]
    s_add_u32 s56, s56, 12288
    v_exp_f32 v16, v124
    v_mfma_f32_16x16x32_bf16 v[164:167], v[36:39], a[236:239], v[164:167]
    s_min_u32 s29, s29, s3
    v_add_f32 v8, v8, v18
    v_lshlrev_b32 v48, 16, v56
    v_mfma_f32_16x16x32_bf16 v[168:171], v[32:35], v[192:195], v[168:171]
    s_mov_b32 m0, s56
    ds_read_b128 v[28:31], v3 offset:12288
    v_add_f32 v8, v8, v19
    v_mfma_f32_16x16x32_bf16 v[168:171], v[36:39], v[196:199], v[168:171]
    buffer_load_dwordx2 v[62:63], off, s[84:87], s37 offset:8
    v_mfma_f32_16x16x32_bf16 v[172:175], v[32:35], v[216:219], v[172:175]
    v_exp_f32 v17, v125
    v_mfma_f32_16x16x32_bf16 v[172:175], v[36:39], v[220:223], v[172:175]
    s_waitcnt lgkmcnt(2)
    v_cvt_pk_bf16_f32 v93, v18, v19
    v_and_b32 v49, s97, v56
    v_mfma_f32_16x16x32_bf16 v[96:99], v[40:43], a[208:211], v[96:99]
    ds_read_b128 v[32:35], v2 offset:18432
    v_lshlrev_b32 v50, 16, v58
    v_mfma_f32_16x16x32_bf16 v[96:99], v[44:47], a[212:215], v[96:99]
    s_sub_u32 s3, s29, s30
    v_exp_f32 v18, v126
    v_mfma_f32_16x16x32_bf16 v[100:103], v[40:43], a[232:235], v[100:103]
    v_add_f32 v8, v8, v16
    v_add_f32 v8, v8, v17
    v_mfma_f32_16x16x32_bf16 v[100:103], v[44:47], a[236:239], v[100:103]
    buffer_load_dwordx4 v4, s[4:7], s27 offen offset:0 sc1 lds
    v_mfma_f32_16x16x32_bf16 v[104:107], v[40:43], v[192:195], v[104:107]
    ds_read_b128 v[36:39], v3 offset:18432
    v_and_b32 v51, s97, v58
    v_mfma_f32_16x16x32_bf16 v[104:107], v[44:47], v[196:199], v[104:107]
    v_exp_f32 v19, v127
    v_mfma_f32_16x16x32_bf16 v[108:111], v[40:43], v[216:219], v[108:111]
    v_cvt_pk_bf16_f32 v94, v16, v17
    v_add_f32 v8, v8, v18
    v_mfma_f32_16x16x32_bf16 v[108:111], v[44:47], v[220:223], v[108:111]
    s_waitcnt lgkmcnt(2)
    buffer_load_dwordx4 v[240:243], v12, s[68:71], s16 offen offset:0 nt
    v_mfma_f32_16x16x32_bf16 v[176:179], v[24:27], a[192:195], v[128:131]
    ds_read_b128 v[40:43], v2 offset:12416
    v_add_f32 v8, v8, v19
    v_mfma_f32_16x16x32_bf16 v[176:179], v[28:31], a[196:199], v[176:179]
    s_mov_b32 s30, s29
    v_cvt_pk_bf16_f32 v95, v18, v19
    v_mul_f32_e64 v50, -v50, v48
    v_mfma_f32_16x16x32_bf16 v[180:183], v[24:27], a[216:219], v[132:135]
    v_exp_f32 v16, v160
    v_mfma_f32_16x16x32_bf16 v[180:183], v[28:31], a[220:223], v[180:183]
    buffer_load_dwordx4 v4, s[4:7], s27 offen offset:1024 sc1 lds
    v_mfma_f32_16x16x32_bf16 v[184:187], v[24:27], a[240:243], v[136:139]
    ds_read_b128 v[44:47], v3 offset:12416
    v_mul_f32_e64 v51, -v51, v49
    v_mfma_f32_16x16x32_bf16 v[184:187], v[28:31], a[244:247], v[184:187]
    v_exp_f32 v17, v161
    v_mfma_f32_16x16x32_bf16 v[188:191], v[24:27], v[200:203], v[140:143]
    v_exp_f32 v18, v162
    v_mfma_f32_16x16x32_bf16 v[188:191], v[28:31], v[204:207], v[188:191]
    s_waitcnt lgkmcnt(2)
    buffer_load_dwordx4 v[244:247], v12, s[68:71], s16 offen offset:768 nt
    v_mfma_f32_16x16x32_bf16 v[112:115], v[32:35], a[192:195], v[128:131]
    ds_read_b128 v[24:27], v2 offset:18560
    v_add_f32 v5, v5, v16
    v_mfma_f32_16x16x32_bf16 v[112:115], v[36:39], a[196:199], v[112:115]
    v_add_f32 v5, v5, v17
    v_cvt_f32_i32 v144, v144
    v_mfma_f32_16x16x32_bf16 v[116:119], v[32:35], a[216:219], v[132:135]
    v_exp_f32 v19, v163
    v_mfma_f32_16x16x32_bf16 v[116:119], v[36:39], a[220:223], v[116:119]
    v_cvt_pk_bf16_f32 v160, v16, v17
    v_cvt_f32_i32 v148, v148
    v_mfma_f32_16x16x32_bf16 v[120:123], v[32:35], a[240:243], v[136:139]
    ds_read_b128 v[28:31], v3 offset:18560
    v_fma_f32 v144, v144, v48, v50
    v_mfma_f32_16x16x32_bf16 v[120:123], v[36:39], a[244:247], v[120:123]
    buffer_load_dwordx4 v[248:251], v12, s[68:71], s16 offen offset:1536 nt
    v_mfma_f32_16x16x32_bf16 v[124:127], v[32:35], v[200:203], v[140:143]
    v_exp_f32 v16, v96
    v_mfma_f32_16x16x32_bf16 v[124:127], v[36:39], v[204:207], v[124:127]
    s_waitcnt lgkmcnt(2)
    v_add_f32 v5, v5, v18
    v_add_f32 v5, v5, v19
    v_mfma_f32_16x16x32_bf16 v[176:179], v[40:43], a[200:203], v[176:179]
    ds_read_b128 v[32:35], v2 offset:12544
    v_fma_f32 v148, v148, v49, v51
    v_mfma_f32_16x16x32_bf16 v[176:179], v[44:47], a[204:207], v[176:179]
    buffer_load_dwordx4 v4, s[4:7], s27 offen offset:2048 sc1 lds
    v_mfma_f32_16x16x32_bf16 v[180:183], v[40:43], a[224:227], v[180:183]
    v_exp_f32 v17, v97
    v_mfma_f32_16x16x32_bf16 v[180:183], v[44:47], a[228:231], v[180:183]
    v_cvt_pk_bf16_f32 v161, v18, v19
    v_cvt_f32_i32 v145, v145
    v_mfma_f32_16x16x32_bf16 v[184:187], v[40:43], a[248:251], v[184:187]
    ds_read_b128 v[36:39], v3 offset:12544
    v_add_u32 v1, s3, v1
    v_mfma_f32_16x16x32_bf16 v[184:187], v[44:47], a[252:255], v[184:187]
    buffer_load_dwordx4 v[252:255], v12, s[68:71], s16 offen offset:2304 nt
    v_mfma_f32_16x16x32_bf16 v[188:191], v[40:43], v[208:211], v[188:191]
    v_exp_f32 v18, v98
    v_mfma_f32_16x16x32_bf16 v[188:191], v[44:47], v[212:215], v[188:191]
    s_waitcnt lgkmcnt(2)
    v_add_f32 v5, v5, v16
    v_add_f32 v5, v5, v17
    v_mfma_f32_16x16x32_bf16 v[112:115], v[24:27], a[200:203], v[112:115]
    ds_read_b128 v[40:43], v2 offset:18688
    v_cvt_f32_i32 v149, v149
    v_mfma_f32_16x16x32_bf16 v[112:115], v[28:31], a[204:207], v[112:115]
    v_exp_f32 v19, v99
    v_cvt_pk_bf16_f32 v162, v16, v17
    v_mfma_f32_16x16x32_bf16 v[116:119], v[24:27], a[224:227], v[116:119]
    v_exp_f32 v16, v164
    v_mfma_f32_16x16x32_bf16 v[116:119], v[28:31], a[228:231], v[116:119]
    s_add_u32 s27, s27, 24576
    v_add_f32 v5, v5, v18
    v_add_f32 v5, v5, v19
    v_mfma_f32_16x16x32_bf16 v[120:123], v[24:27], a[248:251], v[120:123]
    s_add_u32 s56, s56, 36864
    ds_read_b128 v[44:47], v3 offset:18688
    v_fma_f32 v145, v145, v48, v50
    v_mfma_f32_16x16x32_bf16 v[120:123], v[28:31], a[252:255], v[120:123]
    s_waitcnt lgkmcnt(2)
    v_exp_f32 v17, v165
    v_mfma_f32_16x16x32_bf16 v[124:127], v[24:27], v[208:211], v[124:127]
    s_waitcnt vmcnt(12)
    v_cvt_pk_bf16_f32 v163, v18, v19
    v_fma_f32 v149, v149, v49, v51
    v_mfma_f32_16x16x32_bf16 v[124:127], v[28:31], v[212:215], v[124:127]
    s_barrier
    s_sub_u32 s58, s56, 147456
    v_mfma_f32_16x16x32_bf16 v[176:179], v[32:35], a[208:211], v[176:179]
    s_min_u32 s56, s56, s58
    ds_read_b128 v[24:27], v1 offset:0
    v_cvt_f32_i32 v146, v146
    v_mfma_f32_16x16x32_bf16 v[176:179], v[36:39], a[212:215], v[176:179]
    v_exp_f32 v18, v166
    v_mfma_f32_16x16x32_bf16 v[180:183], v[32:35], a[232:235], v[180:183]
    v_add_f32 v6, v6, v16
    v_add_f32 v6, v6, v17
    v_mfma_f32_16x16x32_bf16 v[180:183], v[36:39], a[236:239], v[180:183]
    v_exp_f32 v19, v167
    v_mfma_f32_16x16x32_bf16 v[184:187], v[32:35], v[192:195], v[184:187]
    ds_read_b128 v[28:31], v1 offset:12288
    v_cvt_pk_bf16_f32 v164, v16, v17
    v_mfma_f32_16x16x32_bf16 v[184:187], v[36:39], v[196:199], v[184:187]
    v_exp_f32 v16, v100
    v_mfma_f32_16x16x32_bf16 v[188:191], v[32:35], v[216:219], v[188:191]
    v_add_f32 v6, v6, v18
    v_add_f32 v6, v6, v19
    v_mfma_f32_16x16x32_bf16 v[188:191], v[36:39], v[220:223], v[188:191]
    s_waitcnt lgkmcnt(2)
    v_exp_f32 v17, v101
    v_mfma_f32_16x16x32_bf16 v[112:115], v[40:43], a[208:211], v[112:115]
    ds_read_b128 v[32:35], v1 offset:1024
    v_cvt_pk_bf16_f32 v165, v18, v19
    v_mfma_f32_16x16x32_bf16 v[112:115], v[44:47], a[212:215], v[112:115]
    v_exp_f32 v18, v102
    v_mfma_f32_16x16x32_bf16 v[116:119], v[40:43], a[232:235], v[116:119]
    v_add_f32 v6, v6, v16
    v_cvt_f32_i32 v150, v150
    v_mfma_f32_16x16x32_bf16 v[116:119], v[44:47], a[236:239], v[116:119]
    v_add_f32 v6, v6, v17
    v_fma_f32 v146, v146, v48, v50
    v_mfma_f32_16x16x32_bf16 v[120:123], v[40:43], v[192:195], v[120:123]
    ds_read_b128 v[36:39], v1 offset:13312
    v_fma_f32 v150, v150, v49, v51
    v_mfma_f32_16x16x32_bf16 v[120:123], v[44:47], v[196:199], v[120:123]
    v_exp_f32 v19, v103
    v_mfma_f32_16x16x32_bf16 v[124:127], v[40:43], v[216:219], v[124:127]
    v_cvt_pk_bf16_f32 v166, v16, v17
    v_add_f32 v6, v6, v18
    v_mfma_f32_16x16x32_bf16 v[124:127], v[44:47], v[220:223], v[124:127]
    s_waitcnt lgkmcnt(2)
    v_add_f32 v6, v6, v19
    v_cvt_pk_bf16_f32 v167, v18, v19
    v_mfma_f32_16x16x32_bf16 a[0:3], v[64:67], v[24:27], a[0:3]
    ds_read_b128 v[40:43], v1 offset:2048
    v_cvt_f32_i32 v147, v147
    v_mfma_f32_16x16x32_bf16 a[0:3], v[80:83], v[28:31], a[0:3]
    buffer_store_dwordx4 v[224:227], v11, s[4:7], s33 offen offset:0 sc1
    v_mfma_f32_16x16x32_bf16 a[48:51], v[68:71], v[24:27], a[48:51]
    v_exp_f32 v16, v168
    v_mfma_f32_16x16x32_bf16 a[48:51], v[84:87], v[28:31], a[48:51]
    v_exp_f32 v17, v169
    v_mfma_f32_16x16x32_bf16 a[96:99], v[72:75], v[24:27], a[96:99]
    ds_read_b128 v[44:47], v1 offset:14336
    v_xor_b32 v55, 16, v11
    v_mfma_f32_16x16x32_bf16 a[96:99], v[88:91], v[28:31], a[96:99]
    v_exp_f32 v18, v170
    v_mfma_f32_16x16x32_bf16 a[144:147], v[76:79], v[24:27], a[144:147]
    v_add_f32 v7, v7, v16
    v_add_f32 v7, v7, v17
    v_mfma_f32_16x16x32_bf16 a[144:147], v[92:95], v[28:31], a[144:147]
    s_waitcnt lgkmcnt(2)
    v_exp_f32 v19, v171
    v_mfma_f32_16x16x32_bf16 a[4:7], v[64:67], v[32:35], a[4:7]
    ds_read_b128 v[24:27], v1 offset:3072
    v_cvt_f32_i32 v151, v151
    v_mfma_f32_16x16x32_bf16 a[4:7], v[80:83], v[36:39], a[4:7]
    buffer_store_dwordx4 v[228:231], v55, s[4:7], s33 offen offset:768 sc1
    v_mfma_f32_16x16x32_bf16 a[52:55], v[68:71], v[32:35], a[52:55]
    v_cvt_pk_bf16_f32 v168, v16, v17
    v_fma_f32 v147, v147, v48, v50
    v_mfma_f32_16x16x32_bf16 a[52:55], v[84:87], v[36:39], a[52:55]
    v_exp_f32 v16, v104
    v_mfma_f32_16x16x32_bf16 a[100:103], v[72:75], v[32:35], a[100:103]
    ds_read_b128 v[28:31], v1 offset:15360
    v_add_f32 v7, v7, v18
    v_mfma_f32_16x16x32_bf16 a[100:103], v[88:91], v[36:39], a[100:103]
    v_add_f32 v7, v7, v19
    v_xor_b32 v54, 32, v11
    v_mfma_f32_16x16x32_bf16 a[148:151], v[76:79], v[32:35], a[148:151]
    v_exp_f32 v17, v105
    v_mfma_f32_16x16x32_bf16 a[148:151], v[92:95], v[36:39], a[148:151]
    s_waitcnt lgkmcnt(2)
    v_cvt_pk_bf16_f32 v169, v18, v19
    v_fma_f32 v151, v151, v49, v51
    v_mfma_f32_16x16x32_bf16 a[8:11], v[64:67], v[40:43], a[8:11]
    ds_read_b128 v[32:35], v1 offset:4096
    v_lshlrev_b32 v48, 16, v57
    v_mfma_f32_16x16x32_bf16 a[8:11], v[80:83], v[44:47], a[8:11]
    buffer_store_dwordx4 v[232:235], v54, s[4:7], s33 offen offset:1536 sc1
    v_mfma_f32_16x16x32_bf16 a[56:59], v[68:71], v[40:43], a[56:59]
    v_exp_f32 v18, v106
    v_mfma_f32_16x16x32_bf16 a[56:59], v[84:87], v[44:47], a[56:59]
    v_add_f32 v7, v7, v16
    v_add_f32 v7, v7, v17
    v_mfma_f32_16x16x32_bf16 a[104:107], v[72:75], v[40:43], a[104:107]
    ds_read_b128 v[36:39], v1 offset:16384
    v_xor_b32 v55, 48, v11
    v_mfma_f32_16x16x32_bf16 a[104:107], v[88:91], v[44:47], a[104:107]
    v_exp_f32 v19, v107
    v_mfma_f32_16x16x32_bf16 a[152:155], v[76:79], v[40:43], a[152:155]
    v_cvt_pk_bf16_f32 v170, v16, v17
    v_and_b32 v49, s97, v57
    v_mfma_f32_16x16x32_bf16 a[152:155], v[92:95], v[44:47], a[152:155]
    s_waitcnt lgkmcnt(2)
    v_exp_f32 v16, v172
    v_mfma_f32_16x16x32_bf16 a[12:15], v[64:67], v[24:27], a[12:15]
    ds_read_b128 v[40:43], v1 offset:5120
    v_add_f32 v7, v7, v18
    v_mfma_f32_16x16x32_bf16 a[12:15], v[80:83], v[28:31], a[12:15]
    buffer_store_dwordx4 v[236:239], v55, s[4:7], s33 offen offset:2304 sc1
    v_mfma_f32_16x16x32_bf16 a[60:63], v[68:71], v[24:27], a[60:63]
    v_add_f32 v7, v7, v19
    v_lshlrev_b32 v50, 16, v59
    v_mfma_f32_16x16x32_bf16 a[60:63], v[84:87], v[28:31], a[60:63]
    v_exp_f32 v17, v173
    v_mfma_f32_16x16x32_bf16 a[108:111], v[72:75], v[24:27], a[108:111]
    ds_read_b128 v[44:47], v1 offset:17408
    v_cvt_pk_bf16_f32 v171, v18, v19
    v_mfma_f32_16x16x32_bf16 a[108:111], v[88:91], v[28:31], a[108:111]
    v_exp_f32 v18, v174
    v_mfma_f32_16x16x32_bf16 a[156:159], v[76:79], v[24:27], a[156:159]
    s_add_u32 s29, s28, 49152
    v_add_f32 v8, v8, v16
    v_add_f32 v8, v8, v17
    v_mfma_f32_16x16x32_bf16 a[156:159], v[92:95], v[28:31], a[156:159]
    s_waitcnt lgkmcnt(2)
    v_exp_f32 v19, v175
    v_mfma_f32_16x16x32_bf16 a[16:19], v[64:67], v[32:35], a[16:19]
    s_sub_u32 s3, s29, 147456
    ds_read_b128 v[24:27], v1 offset:6144
    v_cvt_pk_bf16_f32 v172, v16, v17
    v_mfma_f32_16x16x32_bf16 a[16:19], v[80:83], v[36:39], a[16:19]
    s_mov_b32 m0, s26
    v_exp_f32 v16, v108
    v_mfma_f32_16x16x32_bf16 a[64:67], v[68:71], v[32:35], a[64:67]
    s_min_u32 s29, s29, s3
    v_and_b32 v51, s97, v59
    v_add_f32 v8, v8, v18
    v_mfma_f32_16x16x32_bf16 a[64:67], v[84:87], v[36:39], a[64:67]
    buffer_load_dwordx4 v4, s[4:7], s32 offen offset:0 sc1 lds
    v_mfma_f32_16x16x32_bf16 a[112:115], v[72:75], v[32:35], a[112:115]
    ds_read_b128 v[28:31], v1 offset:18432
    v_add_f32 v8, v8, v19
    v_mfma_f32_16x16x32_bf16 a[112:115], v[88:91], v[36:39], a[112:115]
    v_exp_f32 v17, v109
    v_mfma_f32_16x16x32_bf16 a[160:163], v[76:79], v[32:35], a[160:163]
    v_cvt_pk_bf16_f32 v173, v18, v19
    v_mul_f32_e64 v50, -v50, v48
    v_mfma_f32_16x16x32_bf16 a[160:163], v[92:95], v[36:39], a[160:163]
    s_waitcnt lgkmcnt(2)
    buffer_load_dwordx4 v4, s[4:7], s32 offen offset:1024 sc1 lds
    v_mfma_f32_16x16x32_bf16 a[20:23], v[64:67], v[40:43], a[20:23]
    s_sub_u32 s3, s29, s28
    ds_read_b128 v[32:35], v1 offset:7168
    v_mul_f32_e64 v51, -v51, v49
    v_mfma_f32_16x16x32_bf16 a[20:23], v[80:83], v[44:47], a[20:23]
    v_exp_f32 v18, v110
    v_mfma_f32_16x16x32_bf16 a[68:71], v[68:71], v[40:43], a[68:71]
    v_add_f32 v8, v8, v16
    v_add_f32 v8, v8, v17
    v_mfma_f32_16x16x32_bf16 a[68:71], v[84:87], v[44:47], a[68:71]
    buffer_load_dwordx4 v4, s[4:7], s32 offen offset:2048 sc1 lds
    v_mfma_f32_16x16x32_bf16 a[116:119], v[72:75], v[40:43], a[116:119]
    ds_read_b128 v[36:39], v1 offset:19456
    v_cvt_f32_i32 v152, v152
    v_mfma_f32_16x16x32_bf16 a[116:119], v[88:91], v[44:47], a[116:119]
    v_exp_f32 v19, v111
    v_mfma_f32_16x16x32_bf16 a[164:167], v[76:79], v[40:43], a[164:167]
    s_mov_b32 s28, s29
    v_cvt_pk_bf16_f32 v174, v16, v17
    v_add_f32 v8, v8, v18
    v_mfma_f32_16x16x32_bf16 a[164:167], v[92:95], v[44:47], a[164:167]
    s_waitcnt lgkmcnt(2)
    v_add_f32 v8, v8, v19
    v_cvt_pk_bf16_f32 v175, v18, v19
    v_mfma_f32_16x16x32_bf16 a[24:27], v[64:67], v[24:27], a[24:27]
    s_add_u32 s32, s32, 24576
    ds_read_b128 v[40:43], v1 offset:8192
    v_cvt_f32_i32 v156, v156
    v_mfma_f32_16x16x32_bf16 a[24:27], v[80:83], v[28:31], a[24:27]
    v_exp_f32 v16, v176
    v_mfma_f32_16x16x32_bf16 a[72:75], v[68:71], v[24:27], a[72:75]
    s_add_u32 s26, s26, 12288
    v_exp_f32 v17, v177
    v_mfma_f32_16x16x32_bf16 a[72:75], v[84:87], v[28:31], a[72:75]
    v_exp_f32 v18, v178
    v_mfma_f32_16x16x32_bf16 a[120:123], v[72:75], v[24:27], a[120:123]
    s_mov_b32 m0, s26
    ds_read_b128 v[44:47], v1 offset:20480
    v_add_f32 v5, v5, v16
    v_mfma_f32_16x16x32_bf16 a[120:123], v[88:91], v[28:31], a[120:123]
    v_add_f32 v5, v5, v17
    v_fma_f32 v152, v152, v48, v50
    v_mfma_f32_16x16x32_bf16 a[168:171], v[76:79], v[24:27], a[168:171]
    v_exp_f32 v19, v179
    v_mfma_f32_16x16x32_bf16 a[168:171], v[92:95], v[28:31], a[168:171]
    s_waitcnt lgkmcnt(2)
    v_cvt_pk_bf16_f32 v176, v16, v17
    v_fma_f32 v156, v156, v49, v51
    v_mfma_f32_16x16x32_bf16 a[28:31], v[64:67], v[32:35], a[28:31]
    ds_read_b128 v[24:27], v1 offset:9216
    v_add_u32 v2, s3, v2
    v_mfma_f32_16x16x32_bf16 a[28:31], v[80:83], v[36:39], a[28:31]
    buffer_load_dwordx4 v4, s[4:7], s32 offen offset:0 sc1 lds
    v_mfma_f32_16x16x32_bf16 a[76:79], v[68:71], v[32:35], a[76:79]
    v_exp_f32 v16, v112
    v_mfma_f32_16x16x32_bf16 a[76:79], v[84:87], v[36:39], a[76:79]
    v_add_f32 v5, v5, v18
    v_add_f32 v5, v5, v19
    v_mfma_f32_16x16x32_bf16 a[124:127], v[72:75], v[32:35], a[124:127]
    ds_read_b128 v[28:31], v1 offset:21504
    v_cvt_f32_i32 v153, v153
    v_mfma_f32_16x16x32_bf16 a[124:127], v[88:91], v[36:39], a[124:127]
    buffer_load_dwordx4 v4, s[4:7], s32 offen offset:1024 sc1 lds
    v_mfma_f32_16x16x32_bf16 a[172:175], v[76:79], v[32:35], a[172:175]
    v_exp_f32 v17, v113
    v_mfma_f32_16x16x32_bf16 a[172:175], v[92:95], v[36:39], a[172:175]
    s_waitcnt lgkmcnt(2)
    v_cvt_pk_bf16_f32 v177, v18, v19
    v_add_u32 v3, s3, v3
    v_mfma_f32_16x16x32_bf16 a[32:35], v[64:67], v[40:43], a[32:35]
    ds_read_b128 v[32:35], v1 offset:10240
    v_cvt_f32_i32 v157, v157
    v_mfma_f32_16x16x32_bf16 a[32:35], v[80:83], v[44:47], a[32:35]
    v_exp_f32 v18, v114
    v_mfma_f32_16x16x32_bf16 a[80:83], v[68:71], v[40:43], a[80:83]
    v_add_f32 v5, v5, v16
    v_add_f32 v5, v5, v17
    v_mfma_f32_16x16x32_bf16 a[80:83], v[84:87], v[44:47], a[80:83]
    buffer_load_dwordx4 v4, s[4:7], s32 offen offset:2048 sc1 lds
    v_mfma_f32_16x16x32_bf16 a[128:131], v[72:75], v[40:43], a[128:131]
    ds_read_b128 v[36:39], v1 offset:22528
    v_mfma_f32_16x16x32_bf16 a[128:131], v[88:91], v[44:47], a[128:131]
    v_exp_f32 v19, v115
    v_mfma_f32_16x16x32_bf16 a[176:179], v[76:79], v[40:43], a[176:179]
    v_cvt_pk_bf16_f32 v178, v16, v17
    v_fma_f32 v153, v153, v48, v50
    v_mfma_f32_16x16x32_bf16 a[176:179], v[92:95], v[44:47], a[176:179]
    s_waitcnt lgkmcnt(2)
    v_exp_f32 v16, v180
    v_mfma_f32_16x16x32_bf16 a[36:39], v[64:67], v[24:27], a[36:39]
    ds_read_b128 v[40:43], v1 offset:11264
    v_add_f32 v5, v5, v18
    v_mfma_f32_16x16x32_bf16 a[36:39], v[80:83], v[28:31], a[36:39]
    v_add_f32 v5, v5, v19
    v_mfma_f32_16x16x32_bf16 a[84:87], v[68:71], v[24:27], a[84:87]
    v_exp_f32 v17, v181
    v_mfma_f32_16x16x32_bf16 a[84:87], v[84:87], v[28:31], a[84:87]
    s_add_u32 s32, s32, 24576
    v_cvt_pk_bf16_f32 v179, v18, v19
    s_add_u32 s26, s26, 36864
    v_mfma_f32_16x16x32_bf16 a[132:135], v[72:75], v[24:27], a[132:135]
    s_sub_u32 s57, s26, 147456
    ds_read_b128 v[44:47], v1 offset:23552
    v_fma_f32 v157, v157, v49, v51
    v_mfma_f32_16x16x32_bf16 a[132:135], v[88:91], v[28:31], a[132:135]
    s_waitcnt lgkmcnt(2)
    v_exp_f32 v18, v182
    v_mfma_f32_16x16x32_bf16 a[180:183], v[76:79], v[24:27], a[180:183]
    s_waitcnt vmcnt(6)
    v_add_f32 v6, v6, v16
    v_add_f32 v6, v6, v17
    v_mfma_f32_16x16x32_bf16 a[180:183], v[92:95], v[28:31], a[180:183]
    s_barrier
    v_cvt_f32_i32 v154, v154
    v_mfma_f32_16x16x32_bf16 a[40:43], v[64:67], v[32:35], a[40:43]
    s_min_u32 s26, s26, s57
    ds_read_b128 v[24:27], v2 offset:0
    v_add_u32 v0, 1, v0
    v_mfma_f32_16x16x32_bf16 a[40:43], v[80:83], v[36:39], a[40:43]
    buffer_store_dword v0, v13, s[20:23], 0 offen offset:32 sc1
    v_mfma_f32_16x16x32_bf16 a[88:91], v[68:71], v[32:35], a[88:91]
    v_exp_f32 v19, v183
    v_mfma_f32_16x16x32_bf16 a[88:91], v[84:87], v[36:39], a[88:91]
    v_cvt_pk_bf16_f32 v180, v16, v17
    v_cvt_f32_i32 v158, v158
    v_mfma_f32_16x16x32_bf16 a[136:139], v[72:75], v[32:35], a[136:139]
    ds_read_b128 v[28:31], v3 offset:0
    v_mfma_f32_16x16x32_bf16 a[136:139], v[88:91], v[36:39], a[136:139]
    v_exp_f32 v16, v116
    v_mfma_f32_16x16x32_bf16 a[184:187], v[76:79], v[32:35], a[184:187]
    v_add_f32 v6, v6, v18
    v_add_f32 v6, v6, v19
    v_mfma_f32_16x16x32_bf16 a[184:187], v[92:95], v[36:39], a[184:187]
    s_waitcnt lgkmcnt(2)
    v_exp_f32 v17, v117
    v_mfma_f32_16x16x32_bf16 a[44:47], v[64:67], v[40:43], a[44:47]
    ds_read_b128 v[32:35], v2 offset:6144
    v_cvt_pk_bf16_f32 v181, v18, v19
    v_mfma_f32_16x16x32_bf16 a[44:47], v[80:83], v[44:47], a[44:47]
    v_exp_f32 v18, v118
    v_mfma_f32_16x16x32_bf16 a[92:95], v[68:71], v[40:43], a[92:95]
    v_add_f32 v6, v6, v16
    v_add_f32 v6, v6, v17
    v_mfma_f32_16x16x32_bf16 a[92:95], v[84:87], v[44:47], a[92:95]
    v_exp_f32 v19, v119
    v_mfma_f32_16x16x32_bf16 a[140:143], v[72:75], v[40:43], a[140:143]
    ds_read_b128 v[36:39], v3 offset:6144
    v_cvt_pk_bf16_f32 v182, v16, v17
    v_mfma_f32_16x16x32_bf16 a[140:143], v[88:91], v[44:47], a[140:143]
    v_add_f32 v6, v6, v18
    v_add_f32 v6, v6, v19
    v_mfma_f32_16x16x32_bf16 a[188:191], v[76:79], v[40:43], a[188:191]
    v_cvt_pk_bf16_f32 v183, v18, v19
    v_mfma_f32_16x16x32_bf16 a[188:191], v[92:95], v[44:47], a[188:191]
    s_waitcnt lgkmcnt(2)
    v_mfma_f32_16x16x32_bf16 v[64:67], v[24:27], a[192:195], v[128:131]
    s_add_u32 s33, s33, 196608
    ds_read_b128 v[40:43], v2 offset:128
    v_fma_f32 v154, v154, v48, v50
    v_mfma_f32_16x16x32_bf16 v[64:67], v[28:31], a[196:199], v[64:67]
    s_mov_b32 m0, s56
    v_exp_f32 v16, v184
    v_mfma_f32_16x16x32_bf16 v[68:71], v[24:27], a[216:219], v[132:135]
    s_add_u32 s34, s34, 196608
    v_exp_f32 v17, v185
    v_mfma_f32_16x16x32_bf16 v[68:71], v[28:31], a[220:223], v[68:71]
    s_add_u32 s36, s36, 1536
    buffer_load_dwordx4 v4, s[4:7], s27 offen offset:0 sc1 lds
    v_mfma_f32_16x16x32_bf16 v[72:75], v[24:27], a[240:243], v[136:139]
    ds_read_b128 v[44:47], v3 offset:128
    v_fma_f32 v158, v158, v49, v51
    v_mfma_f32_16x16x32_bf16 v[72:75], v[28:31], a[244:247], v[72:75]
    v_exp_f32 v18, v186
    v_mfma_f32_16x16x32_bf16 v[76:79], v[24:27], v[200:203], v[140:143]
    v_add_f32 v7, v7, v16
    v_add_f32 v7, v7, v17
    v_mfma_f32_16x16x32_bf16 v[76:79], v[28:31], v[204:207], v[76:79]
    s_waitcnt lgkmcnt(2)
    buffer_load_dwordx2 v[56:57], v10, s[72:75], s36 offen offset:0
    v_mfma_f32_16x16x32_bf16 v[96:99], v[32:35], a[192:195], v[128:131]
    ds_read_b128 v[24:27], v2 offset:6272
    v_cvt_f32_i32 v155, v155
    v_mfma_f32_16x16x32_bf16 v[96:99], v[36:39], a[196:199], v[96:99]
    v_exp_f32 v19, v187
    v_mfma_f32_16x16x32_bf16 v[100:103], v[32:35], a[216:219], v[132:135]
    v_cvt_pk_bf16_f32 v184, v16, v17
    v_cvt_f32_i32 v159, v159
    v_mfma_f32_16x16x32_bf16 v[100:103], v[36:39], a[220:223], v[100:103]
    buffer_load_dwordx4 v4, s[4:7], s27 offen offset:1024 sc1 lds
    v_mfma_f32_16x16x32_bf16 v[104:107], v[32:35], a[240:243], v[136:139]
    ds_read_b128 v[28:31], v3 offset:6272
    v_fma_f32 v155, v155, v48, v50
    v_mfma_f32_16x16x32_bf16 v[104:107], v[36:39], a[244:247], v[104:107]
    v_exp_f32 v16, v120
    v_mfma_f32_16x16x32_bf16 v[108:111], v[32:35], v[200:203], v[140:143]
    v_add_f32 v7, v7, v18
    v_add_f32 v7, v7, v19
    v_mfma_f32_16x16x32_bf16 v[108:111], v[36:39], v[204:207], v[108:111]
    s_waitcnt lgkmcnt(2)
    buffer_load_dwordx2 v[58:59], v10, s[76:79], s36 offen offset:0
    v_mfma_f32_16x16x32_bf16 v[64:67], v[40:43], a[200:203], v[64:67]
    ds_read_b128 v[32:35], v2 offset:256
    v_fma_f32 v159, v159, v49, v51
    v_mfma_f32_16x16x32_bf16 v[64:67], v[44:47], a[204:207], v[64:67]
    v_exp_f32 v17, v121
    v_mfma_f32_16x16x32_bf16 v[68:71], v[40:43], a[224:227], v[68:71]
    v_cvt_pk_bf16_f32 v185, v18, v19
    v_cvt_pk_bf16_f32 v144, v144, v148
    v_mfma_f32_16x16x32_bf16 v[68:71], v[44:47], a[228:231], v[68:71]
    buffer_load_dwordx4 v[224:227], v9, s[64:67], s33 offen offset:0 nt
    v_mfma_f32_16x16x32_bf16 v[72:75], v[40:43], a[248:251], v[72:75]
    ds_read_b128 v[36:39], v3 offset:256
    v_cvt_pk_bf16_f32 v148, v145, v149
    v_mfma_f32_16x16x32_bf16 v[72:75], v[44:47], a[252:255], v[72:75]
    v_exp_f32 v18, v122
    v_mfma_f32_16x16x32_bf16 v[76:79], v[40:43], v[208:211], v[76:79]
    v_add_f32 v7, v7, v16
    v_add_f32 v7, v7, v17
    v_mfma_f32_16x16x32_bf16 v[76:79], v[44:47], v[212:215], v[76:79]
    s_waitcnt lgkmcnt(2)
    buffer_load_dwordx4 v4, s[4:7], s27 offen offset:2048 sc1 lds
    v_mfma_f32_16x16x32_bf16 v[96:99], v[24:27], a[200:203], v[96:99]
    ds_read_b128 v[40:43], v2 offset:6400
    v_cvt_pk_bf16_f32 v145, v152, v156
    v_mfma_f32_16x16x32_bf16 v[96:99], v[28:31], a[204:207], v[96:99]
    v_exp_f32 v19, v123
    v_cvt_pk_bf16_f32 v186, v16, v17
    v_mfma_f32_16x16x32_bf16 v[100:103], v[24:27], a[224:227], v[100:103]
    v_exp_f32 v16, v188
    v_mfma_f32_16x16x32_bf16 v[100:103], v[28:31], a[228:231], v[100:103]
    buffer_load_dwordx4 v[228:231], v9, s[64:67], s33 offen offset:1536 nt
    v_mfma_f32_16x16x32_bf16 v[104:107], v[24:27], a[248:251], v[104:107]
    ds_read_b128 v[44:47], v3 offset:6400
    v_add_f32 v7, v7, v18
    v_mfma_f32_16x16x32_bf16 v[104:107], v[28:31], a[252:255], v[104:107]
    v_add_f32 v7, v7, v19
    v_cvt_pk_bf16_f32 v149, v153, v157
    v_mfma_f32_16x16x32_bf16 v[108:111], v[24:27], v[208:211], v[108:111]
    s_add_u32 s29, s30, 49152
    v_exp_f32 v17, v189
    v_mfma_f32_16x16x32_bf16 v[108:111], v[28:31], v[212:215], v[108:111]
    s_waitcnt lgkmcnt(2)
    buffer_load_dwordx4 v[232:235], v9, s[64:67], s34 offen offset:0 nt
    v_cvt_pk_bf16_f32 v187, v18, v19
    v_mfma_f32_16x16x32_bf16 v[64:67], v[32:35], a[208:211], v[64:67]
    s_sub_u32 s3, s29, 147456
    ds_read_b128 v[24:27], v2 offset:12288
    s_add_u32 s27, s27, 24576
    v_mfma_f32_16x16x32_bf16 v[64:67], v[36:39], a[212:215], v[64:67]
    s_min_u32 s29, s29, s3
    v_exp_f32 v18, v190
    v_mfma_f32_16x16x32_bf16 v[68:71], v[32:35], a[232:235], v[68:71]
    v_add_f32 v8, v8, v16
    v_add_f32 v8, v8, v17
    v_mfma_f32_16x16x32_bf16 v[68:71], v[36:39], a[236:239], v[68:71]
    buffer_load_dwordx4 v[236:239], v9, s[64:67], s34 offen offset:1536 nt
    v_mfma_f32_16x16x32_bf16 v[72:75], v[32:35], v[192:195], v[72:75]
    s_add_u32 s56, s56, 12288
    ds_read_b128 v[28:31], v3 offset:12288
    v_cvt_pk_bf16_f32 v152, v146, v150
    v_mfma_f32_16x16x32_bf16 v[72:75], v[36:39], v[196:199], v[72:75]
    v_exp_f32 v19, v191
    v_cvt_pk_bf16_f32 v188, v16, v17
    v_mfma_f32_16x16x32_bf16 v[76:79], v[32:35], v[216:219], v[76:79]
    v_exp_f32 v16, v124
    v_mfma_f32_16x16x32_bf16 v[76:79], v[36:39], v[220:223], v[76:79]
    s_waitcnt lgkmcnt(2)
    v_add_f32 v8, v8, v18
    v_add_f32 v8, v8, v19
    v_mfma_f32_16x16x32_bf16 v[96:99], v[40:43], a[208:211], v[96:99]
    ds_read_b128 v[32:35], v2 offset:18432
    v_cvt_pk_bf16_f32 v153, v154, v158
    v_mfma_f32_16x16x32_bf16 v[96:99], v[44:47], a[212:215], v[96:99]
    s_sub_u32 s3, s29, s30
    v_exp_f32 v17, v125
    v_mfma_f32_16x16x32_bf16 v[100:103], v[40:43], a[232:235], v[100:103]
    s_mov_b32 m0, s56
    v_cvt_pk_bf16_f32 v189, v18, v19
    v_cvt_pk_bf16_f32 v156, v147, v151
    v_mfma_f32_16x16x32_bf16 v[100:103], v[44:47], a[236:239], v[100:103]
    v_exp_f32 v18, v126
    v_mfma_f32_16x16x32_bf16 v[104:107], v[40:43], v[192:195], v[104:107]
    ds_read_b128 v[36:39], v3 offset:18432
    v_add_f32 v8, v8, v16
    v_mfma_f32_16x16x32_bf16 v[104:107], v[44:47], v[196:199], v[104:107]
    v_add_f32 v8, v8, v17
    v_cvt_pk_bf16_f32 v157, v155, v159
    v_mfma_f32_16x16x32_bf16 v[108:111], v[40:43], v[216:219], v[108:111]
    v_exp_f32 v19, v127
    v_mfma_f32_16x16x32_bf16 v[108:111], v[44:47], v[220:223], v[108:111]
    s_waitcnt lgkmcnt(2)
    v_cvt_pk_bf16_f32 v190, v16, v17
    v_add_f32 v8, v8, v18
    v_mfma_f32_16x16x32_bf16 v[80:83], v[24:27], a[192:195], v[128:131]
    ds_read_b128 v[40:43], v2 offset:12416
    v_add_f32 v8, v8, v19
    v_mfma_f32_16x16x32_bf16 v[80:83], v[28:31], a[196:199], v[80:83]
    s_mov_b32 s30, s29
    v_cvt_pk_bf16_f32 v191, v18, v19
    v_mfma_f32_16x16x32_bf16 v[84:87], v[24:27], a[216:219], v[132:135]
    v_exp_f32 v16, v64
    v_mfma_f32_16x16x32_bf16 v[84:87], v[28:31], a[220:223], v[84:87]
    s_waitcnt vmcnt(20)
    buffer_load_dwordx4 v4, s[4:7], s27 offen offset:0 sc1 lds
    v_mfma_f32_16x16x32_bf16 v[88:91], v[24:27], a[240:243], v[136:139]
    ds_read_b128 v[44:47], v3 offset:12416
    v_lshlrev_b32 v48, 16, v60
    v_mfma_f32_16x16x32_bf16 v[88:91], v[28:31], a[244:247], v[88:91]
    v_exp_f32 v17, v65
    v_mfma_f32_16x16x32_bf16 v[92:95], v[24:27], v[200:203], v[140:143]
    v_exp_f32 v18, v66
    v_mfma_f32_16x16x32_bf16 v[92:95], v[28:31], v[204:207], v[92:95]
    s_waitcnt lgkmcnt(2)
    v_add_f32 v5, v5, v16
    v_add_f32 v5, v5, v17
    v_mfma_f32_16x16x32_bf16 v[112:115], v[32:35], a[192:195], v[128:131]
    ds_read_b128 v[24:27], v2 offset:18560
    v_and_b32 v49, s97, v60
    v_mfma_f32_16x16x32_bf16 v[112:115], v[36:39], a[196:199], v[112:115]
    v_exp_f32 v19, v67
    v_mfma_f32_16x16x32_bf16 v[116:119], v[32:35], a[216:219], v[132:135]
    v_cvt_pk_bf16_f32 v64, v16, v17
    v_lshlrev_b32 v50, 16, v62
    v_mfma_f32_16x16x32_bf16 v[116:119], v[36:39], a[220:223], v[116:119]
    v_exp_f32 v16, v96
    v_mfma_f32_16x16x32_bf16 v[120:123], v[32:35], a[240:243], v[136:139]
    ds_read_b128 v[28:31], v3 offset:18560
    v_add_f32 v5, v5, v18
    v_mfma_f32_16x16x32_bf16 v[120:123], v[36:39], a[244:247], v[120:123]
    v_add_f32 v5, v5, v19
    v_and_b32 v51, s97, v62
    v_mfma_f32_16x16x32_bf16 v[124:127], v[32:35], v[200:203], v[140:143]
    v_exp_f32 v17, v97
    v_mfma_f32_16x16x32_bf16 v[124:127], v[36:39], v[204:207], v[124:127]
    s_waitcnt lgkmcnt(2)
    buffer_load_dwordx4 v4, s[4:7], s27 offen offset:1024 sc1 lds
    v_mfma_f32_16x16x32_bf16 v[80:83], v[40:43], a[200:203], v[80:83]
    ds_read_b128 v[32:35], v2 offset:12544
    v_cvt_pk_bf16_f32 v65, v18, v19
    v_mfma_f32_16x16x32_bf16 v[80:83], v[44:47], a[204:207], v[80:83]
    v_exp_f32 v18, v98
    v_mfma_f32_16x16x32_bf16 v[84:87], v[40:43], a[224:227], v[84:87]
    v_add_f32 v5, v5, v16
    v_add_f32 v5, v5, v17
    v_mfma_f32_16x16x32_bf16 v[84:87], v[44:47], a[228:231], v[84:87]
    v_exp_f32 v19, v99
    v_mfma_f32_16x16x32_bf16 v[88:91], v[40:43], a[248:251], v[88:91]
    ds_read_b128 v[36:39], v3 offset:12544
    v_cvt_pk_bf16_f32 v66, v16, v17
    v_mfma_f32_16x16x32_bf16 v[88:91], v[44:47], a[252:255], v[88:91]
    v_exp_f32 v16, v68
    v_mfma_f32_16x16x32_bf16 v[92:95], v[40:43], v[208:211], v[92:95]
    v_mul_f32_e64 v50, -v50, v48
    v_add_u32 v1, s3, v1
    v_mfma_f32_16x16x32_bf16 v[92:95], v[44:47], v[212:215], v[92:95]
    s_waitcnt lgkmcnt(2)
    v_add_f32 v5, v5, v18
    v_mul_f32_e64 v51, -v51, v49
    v_mfma_f32_16x16x32_bf16 v[112:115], v[24:27], a[200:203], v[112:115]
    ds_read_b128 v[40:43], v2 offset:18688
    v_add_f32 v5, v5, v19
    v_mfma_f32_16x16x32_bf16 v[112:115], v[28:31], a[204:207], v[112:115]
    buffer_load_dwordx4 v4, s[4:7], s27 offen offset:2048 sc1 lds
    v_mfma_f32_16x16x32_bf16 v[116:119], v[24:27], a[224:227], v[116:119]
    v_exp_f32 v17, v69
    v_mfma_f32_16x16x32_bf16 v[116:119], v[28:31], a[228:231], v[116:119]
    v_cvt_pk_bf16_f32 v67, v18, v19
    v_cvt_f32_i32 v240, v240
    v_mfma_f32_16x16x32_bf16 v[120:123], v[24:27], a[248:251], v[120:123]
    ds_read_b128 v[44:47], v3 offset:18688
    v_cvt_f32_i32 v244, v244
    v_mfma_f32_16x16x32_bf16 v[120:123], v[28:31], a[252:255], v[120:123]
    s_waitcnt lgkmcnt(2)
    v_exp_f32 v18, v70
    v_mfma_f32_16x16x32_bf16 v[124:127], v[24:27], v[208:211], v[124:127]
    s_waitcnt vmcnt(13)
    v_add_f32 v6, v6, v16
    v_add_f32 v6, v6, v17
    v_mfma_f32_16x16x32_bf16 v[124:127], v[28:31], v[212:215], v[124:127]
    s_barrier
    v_fma_f32 v240, v240, v48, v50
    v_mfma_f32_16x16x32_bf16 v[80:83], v[32:35], a[208:211], v[80:83]
    ds_read_b128 v[24:27], v1 offset:0
    v_fma_f32 v244, v244, v49, v51
    v_mfma_f32_16x16x32_bf16 v[80:83], v[36:39], a[212:215], v[80:83]
    v_exp_f32 v19, v71
    v_mfma_f32_16x16x32_bf16 v[84:87], v[32:35], a[232:235], v[84:87]
    v_cvt_pk_bf16_f32 v68, v16, v17
    v_mfma_f32_16x16x32_bf16 v[84:87], v[36:39], a[236:239], v[84:87]
    v_exp_f32 v16, v100
    v_mfma_f32_16x16x32_bf16 v[88:91], v[32:35], v[192:195], v[88:91]
    ds_read_b128 v[28:31], v1 offset:12288
    v_add_f32 v6, v6, v18
    v_mfma_f32_16x16x32_bf16 v[88:91], v[36:39], v[196:199], v[88:91]
    v_add_f32 v6, v6, v19
    v_cvt_f32_i32 v241, v241
    v_mfma_f32_16x16x32_bf16 v[92:95], v[32:35], v[216:219], v[92:95]
    v_exp_f32 v17, v101
    v_mfma_f32_16x16x32_bf16 v[92:95], v[36:39], v[220:223], v[92:95]
    s_waitcnt lgkmcnt(2)
    v_cvt_pk_bf16_f32 v69, v18, v19
    v_cvt_f32_i32 v245, v245
    v_mfma_f32_16x16x32_bf16 v[112:115], v[40:43], a[208:211], v[112:115]
    ds_read_b128 v[32:35], v1 offset:1024
    v_mfma_f32_16x16x32_bf16 v[112:115], v[44:47], a[212:215], v[112:115]
    v_exp_f32 v18, v102
    v_mfma_f32_16x16x32_bf16 v[116:119], v[40:43], a[232:235], v[116:119]
    v_add_f32 v6, v6, v16
    v_add_f32 v6, v6, v17
    v_mfma_f32_16x16x32_bf16 v[116:119], v[44:47], a[236:239], v[116:119]
    s_add_u32 s27, s27, 24576
    v_exp_f32 v19, v103
    v_mfma_f32_16x16x32_bf16 v[120:123], v[40:43], v[192:195], v[120:123]
    s_add_u32 s56, s56, 36864
    ds_read_b128 v[36:39], v1 offset:13312
    v_cvt_pk_bf16_f32 v70, v16, v17
    v_mfma_f32_16x16x32_bf16 v[120:123], v[44:47], v[196:199], v[120:123]
    s_sub_u32 s58, s56, 147456
    v_add_f32 v6, v6, v18
    v_add_f32 v6, v6, v19
    v_mfma_f32_16x16x32_bf16 v[124:127], v[40:43], v[216:219], v[124:127]
    s_min_u32 s56, s56, s58
    v_cvt_pk_bf16_f32 v71, v18, v19
    v_mfma_f32_16x16x32_bf16 v[124:127], v[44:47], v[220:223], v[124:127]
    s_waitcnt lgkmcnt(2)
    v_mfma_f32_16x16x32_bf16 a[0:3], v[160:163], v[24:27], a[0:3]
    s_mov_b32 m0, s56
    ds_read_b128 v[40:43], v1 offset:2048
    v_fma_f32 v241, v241, v48, v50
    v_mfma_f32_16x16x32_bf16 a[0:3], v[176:179], v[28:31], a[0:3]
    buffer_load_dwordx4 v4, s[4:7], s27 offen offset:0 sc1 lds
    v_mfma_f32_16x16x32_bf16 a[48:51], v[164:167], v[24:27], a[48:51]
    v_exp_f32 v16, v72
    v_mfma_f32_16x16x32_bf16 a[48:51], v[180:183], v[28:31], a[48:51]
    v_exp_f32 v17, v73
    v_mfma_f32_16x16x32_bf16 a[96:99], v[168:171], v[24:27], a[96:99]
    ds_read_b128 v[44:47], v1 offset:14336
    v_fma_f32 v245, v245, v49, v51
    v_mfma_f32_16x16x32_bf16 a[96:99], v[184:187], v[28:31], a[96:99]
    v_exp_f32 v18, v74
    v_mfma_f32_16x16x32_bf16 a[144:147], v[172:175], v[24:27], a[144:147]
    v_add_f32 v7, v7, v16
    v_add_f32 v7, v7, v17
    v_mfma_f32_16x16x32_bf16 a[144:147], v[188:191], v[28:31], a[144:147]
    s_waitcnt lgkmcnt(2)
    v_exp_f32 v19, v75
    v_mfma_f32_16x16x32_bf16 a[4:7], v[160:163], v[32:35], a[4:7]
    ds_read_b128 v[24:27], v1 offset:3072
    v_cvt_f32_i32 v242, v242
    v_mfma_f32_16x16x32_bf16 a[4:7], v[176:179], v[36:39], a[4:7]
    buffer_load_dwordx4 v4, s[4:7], s27 offen offset:1024 sc1 lds
    v_mfma_f32_16x16x32_bf16 a[52:55], v[164:167], v[32:35], a[52:55]
    v_cvt_pk_bf16_f32 v72, v16, v17
    v_cvt_f32_i32 v246, v246
    v_mfma_f32_16x16x32_bf16 a[52:55], v[180:183], v[36:39], a[52:55]
    v_exp_f32 v16, v104
    v_mfma_f32_16x16x32_bf16 a[100:103], v[168:171], v[32:35], a[100:103]
    ds_read_b128 v[28:31], v1 offset:15360
    v_add_f32 v7, v7, v18
    v_mfma_f32_16x16x32_bf16 a[100:103], v[184:187], v[36:39], a[100:103]
    v_add_f32 v7, v7, v19
    v_bfe_u32 v53, v4, 4, 6
    v_mfma_f32_16x16x32_bf16 a[148:151], v[172:175], v[32:35], a[148:151]
    v_exp_f32 v17, v105
    v_mfma_f32_16x16x32_bf16 a[148:151], v[188:191], v[36:39], a[148:151]
    s_waitcnt lgkmcnt(2)
    v_fma_f32 v242, v242, v48, v50
    v_cvt_pk_bf16_f32 v73, v18, v19
    v_mfma_f32_16x16x32_bf16 a[8:11], v[160:163], v[40:43], a[8:11]
    ds_read_b128 v[32:35], v1 offset:4096
    v_fma_f32 v246, v246, v49, v51
    v_mfma_f32_16x16x32_bf16 a[8:11], v[176:179], v[44:47], a[8:11]
    v_exp_f32 v18, v106
    v_mfma_f32_16x16x32_bf16 a[56:59], v[164:167], v[40:43], a[56:59]
    v_lshlrev_b32 v53, 2, v53
    v_add_f32 v7, v7, v16
    v_mfma_f32_16x16x32_bf16 a[56:59], v[180:183], v[44:47], a[56:59]
    buffer_load_dword v52, v53, s[20:23], s44 offen sc1
    v_mfma_f32_16x16x32_bf16 a[104:107], v[168:171], v[40:43], a[104:107]
    ds_read_b128 v[36:39], v1 offset:16384
    v_add_f32 v7, v7, v17
    v_mfma_f32_16x16x32_bf16 a[104:107], v[184:187], v[44:47], a[104:107]
    v_exp_f32 v19, v107
    v_mfma_f32_16x16x32_bf16 a[152:155], v[172:175], v[40:43], a[152:155]
    v_cvt_f32_i32 v243, v243
    v_cvt_pk_bf16_f32 v74, v16, v17
    v_mfma_f32_16x16x32_bf16 a[152:155], v[188:191], v[44:47], a[152:155]
    s_waitcnt lgkmcnt(2)
    buffer_load_dwordx4 v4, s[4:7], s27 offen offset:2048 sc1 lds
    v_mfma_f32_16x16x32_bf16 a[12:15], v[160:163], v[24:27], a[12:15]
    ds_read_b128 v[40:43], v1 offset:5120
    v_cvt_f32_i32 v247, v247
    v_mfma_f32_16x16x32_bf16 a[12:15], v[176:179], v[28:31], a[12:15]
    s_add_u32 s27, s27, 24576
    v_exp_f32 v16, v76
    v_mfma_f32_16x16x32_bf16 a[60:63], v[164:167], v[24:27], a[60:63]
    v_add_f32 v7, v7, v18
    v_add_f32 v7, v7, v19
    v_mfma_f32_16x16x32_bf16 a[60:63], v[180:183], v[28:31], a[60:63]
    v_fma_f32 v243, v243, v48, v50
    v_fma_f32 v247, v247, v49, v51
    v_mfma_f32_16x16x32_bf16 a[108:111], v[168:171], v[24:27], a[108:111]
    ds_read_b128 v[44:47], v1 offset:17408
    v_lshlrev_b32 v48, 16, v61
    v_mfma_f32_16x16x32_bf16 a[108:111], v[184:187], v[28:31], a[108:111]
    v_exp_f32 v17, v77
    v_mfma_f32_16x16x32_bf16 a[156:159], v[172:175], v[24:27], a[156:159]
    s_add_u32 s29, s28, 49152
    v_cvt_pk_bf16_f32 v75, v18, v19
    v_and_b32 v49, s97, v61
    v_mfma_f32_16x16x32_bf16 a[156:159], v[188:191], v[28:31], a[156:159]
    s_waitcnt lgkmcnt(2)
    v_exp_f32 v18, v78
    v_mfma_f32_16x16x32_bf16 a[16:19], v[160:163], v[32:35], a[16:19]
    s_sub_u32 s3, s29, 147456
    ds_read_b128 v[24:27], v1 offset:6144
    v_add_f32 v8, v8, v16
    v_mfma_f32_16x16x32_bf16 a[16:19], v[176:179], v[36:39], a[16:19]
    s_add_u32 s56, s56, 12288
    v_add_f32 v8, v8, v17
    v_lshlrev_b32 v50, 16, v63
    v_mfma_f32_16x16x32_bf16 a[64:67], v[164:167], v[32:35], a[64:67]
    s_min_u32 s29, s29, s3
    v_exp_f32 v19, v79
    v_mfma_f32_16x16x32_bf16 a[64:67], v[180:183], v[36:39], a[64:67]
    s_mov_b32 m0, s56
    v_cvt_pk_bf16_f32 v76, v16, v17
    v_and_b32 v51, s97, v63
    v_mfma_f32_16x16x32_bf16 a[112:115], v[168:171], v[32:35], a[112:115]
    ds_read_b128 v[28:31], v1 offset:18432
    v_mul_f32_e64 v50, -v50, v48
    v_mfma_f32_16x16x32_bf16 a[112:115], v[184:187], v[36:39], a[112:115]
    v_exp_f32 v16, v108
    v_mfma_f32_16x16x32_bf16 a[160:163], v[172:175], v[32:35], a[160:163]
    v_add_f32 v8, v8, v18
    v_add_f32 v8, v8, v19
    v_mfma_f32_16x16x32_bf16 a[160:163], v[188:191], v[36:39], a[160:163]
    s_waitcnt lgkmcnt(2)
    v_exp_f32 v17, v109
    v_mfma_f32_16x16x32_bf16 a[20:23], v[160:163], v[40:43], a[20:23]
    s_sub_u32 s3, s29, s28
    ds_read_b128 v[32:35], v1 offset:7168
    v_cvt_pk_bf16_f32 v77, v18, v19
    v_mfma_f32_16x16x32_bf16 a[20:23], v[176:179], v[44:47], a[20:23]
    v_exp_f32 v18, v110
    v_mfma_f32_16x16x32_bf16 a[68:71], v[164:167], v[40:43], a[68:71]
    v_mul_f32_e64 v51, -v51, v49
    v_add_f32 v8, v8, v16
    v_mfma_f32_16x16x32_bf16 a[68:71], v[180:183], v[44:47], a[68:71]
    buffer_load_dwordx4 v4, s[4:7], s27 offen offset:0 sc1 lds
    v_mfma_f32_16x16x32_bf16 a[116:119], v[168:171], v[40:43], a[116:119]
    ds_read_b128 v[36:39], v1 offset:19456
    v_add_f32 v8, v8, v17
    v_mfma_f32_16x16x32_bf16 a[116:119], v[184:187], v[44:47], a[116:119]
    v_exp_f32 v19, v111
    v_mfma_f32_16x16x32_bf16 a[164:167], v[172:175], v[40:43], a[164:167]
    s_mov_b32 s28, s29
    v_cvt_f32_i32 v248, v248
    v_cvt_pk_bf16_f32 v78, v16, v17
    v_mfma_f32_16x16x32_bf16 a[164:167], v[188:191], v[44:47], a[164:167]
    s_waitcnt lgkmcnt(2)
    v_add_f32 v8, v8, v18
    v_cvt_f32_i32 v252, v252
    v_mfma_f32_16x16x32_bf16 a[24:27], v[160:163], v[24:27], a[24:27]
    ds_read_b128 v[40:43], v1 offset:8192
    v_add_f32 v8, v8, v19
    v_mfma_f32_16x16x32_bf16 a[24:27], v[176:179], v[28:31], a[24:27]
    v_cvt_pk_bf16_f32 v79, v18, v19
    v_fma_f32 v248, v248, v48, v50
    v_mfma_f32_16x16x32_bf16 a[72:75], v[164:167], v[24:27], a[72:75]
    v_exp_f32 v16, v80
    v_mfma_f32_16x16x32_bf16 a[72:75], v[180:183], v[28:31], a[72:75]
    buffer_load_dwordx4 v4, s[4:7], s27 offen offset:1024 sc1 lds
    v_mfma_f32_16x16x32_bf16 a[120:123], v[168:171], v[24:27], a[120:123]
    ds_read_b128 v[44:47], v1 offset:20480
    v_fma_f32 v252, v252, v49, v51
    v_mfma_f32_16x16x32_bf16 a[120:123], v[184:187], v[28:31], a[120:123]
    v_exp_f32 v17, v81
    v_mfma_f32_16x16x32_bf16 a[168:171], v[172:175], v[24:27], a[168:171]
    v_exp_f32 v18, v82
    v_mfma_f32_16x16x32_bf16 a[168:171], v[188:191], v[28:31], a[168:171]
    s_waitcnt lgkmcnt(2)
    v_cvt_f32_i32 v249, v249
    v_add_f32 v5, v5, v16
    v_mfma_f32_16x16x32_bf16 a[28:31], v[160:163], v[32:35], a[28:31]
    ds_read_b128 v[24:27], v1 offset:9216
    v_add_f32 v5, v5, v17
    v_mfma_f32_16x16x32_bf16 a[28:31], v[176:179], v[36:39], a[28:31]
    v_exp_f32 v19, v83
    v_mfma_f32_16x16x32_bf16 a[76:79], v[164:167], v[32:35], a[76:79]
    v_cvt_f32_i32 v253, v253
    v_cvt_pk_bf16_f32 v80, v16, v17
    v_mfma_f32_16x16x32_bf16 a[76:79], v[180:183], v[36:39], a[76:79]
    v_exp_f32 v16, v112
    v_mfma_f32_16x16x32_bf16 a[124:127], v[168:171], v[32:35], a[124:127]
    ds_read_b128 v[28:31], v1 offset:21504
    v_fma_f32 v249, v249, v48, v50
    v_mfma_f32_16x16x32_bf16 a[124:127], v[184:187], v[36:39], a[124:127]
    buffer_load_dwordx4 v4, s[4:7], s27 offen offset:2048 sc1 lds
    v_mfma_f32_16x16x32_bf16 a[172:175], v[172:175], v[32:35], a[172:175]
    v_add_f32 v5, v5, v18
    v_add_f32 v5, v5, v19
    v_mfma_f32_16x16x32_bf16 a[172:175], v[188:191], v[36:39], a[172:175]
    s_waitcnt lgkmcnt(2)
    v_exp_f32 v17, v113
    v_mfma_f32_16x16x32_bf16 a[32:35], v[160:163], v[40:43], a[32:35]
    ds_read_b128 v[32:35], v1 offset:10240
    v_fma_f32 v253, v253, v49, v51
    v_mfma_f32_16x16x32_bf16 a[32:35], v[176:179], v[44:47], a[32:35]
    v_cvt_pk_bf16_f32 v81, v18, v19
    v_cvt_f32_i32 v250, v250
    v_mfma_f32_16x16x32_bf16 a[80:83], v[164:167], v[40:43], a[80:83]
    v_exp_f32 v18, v114
    v_mfma_f32_16x16x32_bf16 a[80:83], v[180:183], v[44:47], a[80:83]
    v_cvt_f32_i32 v254, v254
    v_add_f32 v5, v5, v16
    v_mfma_f32_16x16x32_bf16 a[128:131], v[168:171], v[40:43], a[128:131]
    ds_read_b128 v[36:39], v1 offset:22528
    v_add_f32 v5, v5, v17
    v_mfma_f32_16x16x32_bf16 a[128:131], v[184:187], v[44:47], a[128:131]
    v_exp_f32 v19, v115
    v_mfma_f32_16x16x32_bf16 a[176:179], v[172:175], v[40:43], a[176:179]
    v_fma_f32 v250, v250, v48, v50
    v_cvt_pk_bf16_f32 v82, v16, v17
    v_mfma_f32_16x16x32_bf16 a[176:179], v[188:191], v[44:47], a[176:179]
    s_waitcnt lgkmcnt(2)
    v_exp_f32 v16, v84
    v_mfma_f32_16x16x32_bf16 a[36:39], v[160:163], v[24:27], a[36:39]
    ds_read_b128 v[40:43], v1 offset:11264
    v_fma_f32 v254, v254, v49, v51
    v_mfma_f32_16x16x32_bf16 a[36:39], v[176:179], v[28:31], a[36:39]
    v_add_u32 v2, s3, v2
    v_add_f32 v5, v5, v18
    v_mfma_f32_16x16x32_bf16 a[84:87], v[164:167], v[24:27], a[84:87]
    v_add_f32 v5, v5, v19
    v_cvt_f32_i32 v251, v251
    v_mfma_f32_16x16x32_bf16 a[84:87], v[180:183], v[28:31], a[84:87]
    s_add_u32 s27, s27, 24576
    v_exp_f32 v17, v85
    v_mfma_f32_16x16x32_bf16 a[132:135], v[168:171], v[24:27], a[132:135]
    s_add_u32 s56, s56, 36864
    ds_read_b128 v[44:47], v1 offset:23552
    v_add_u32 v3, s3, v3
    v_mfma_f32_16x16x32_bf16 a[132:135], v[184:187], v[28:31], a[132:135]
    s_sub_u32 s58, s56, 147456
    v_cvt_pk_bf16_f32 v83, v18, v19
    v_cvt_f32_i32 v255, v255
    v_mfma_f32_16x16x32_bf16 a[180:183], v[172:175], v[24:27], a[180:183]
    v_exp_f32 v18, v86
    v_mfma_f32_16x16x32_bf16 a[180:183], v[188:191], v[28:31], a[180:183]
    s_waitcnt lgkmcnt(2)
    v_fma_f32 v251, v251, v48, v50
    v_add_f32 v6, v6, v16
    v_mfma_f32_16x16x32_bf16 a[40:43], v[160:163], v[32:35], a[40:43]
    s_min_u32 s56, s56, s58
    ds_read_b128 v[24:27], v2 offset:0
    v_add_f32 v6, v6, v17
    v_mfma_f32_16x16x32_bf16 a[40:43], v[176:179], v[36:39], a[40:43]
    buffer_load_dword v15, v4, s[88:91], s93 offen
    v_mfma_f32_16x16x32_bf16 a[88:91], v[164:167], v[32:35], a[88:91]
    v_exp_f32 v19, v87
    v_mfma_f32_16x16x32_bf16 a[88:91], v[180:183], v[36:39], a[88:91]
    v_cvt_pk_bf16_f32 v84, v16, v17
    v_fma_f32 v255, v255, v49, v51
    v_mfma_f32_16x16x32_bf16 a[136:139], v[168:171], v[32:35], a[136:139]
    ds_read_b128 v[28:31], v3 offset:0
    v_cvt_pk_bf16_f32 v146, v240, v244
    v_mfma_f32_16x16x32_bf16 a[136:139], v[184:187], v[36:39], a[136:139]
    v_exp_f32 v16, v116
    v_mfma_f32_16x16x32_bf16 a[184:187], v[172:175], v[32:35], a[184:187]
    v_add_f32 v6, v6, v18
    v_add_f32 v6, v6, v19
    v_mfma_f32_16x16x32_bf16 a[184:187], v[188:191], v[36:39], a[184:187]
    s_waitcnt lgkmcnt(2)
    v_exp_f32 v17, v117
    v_mfma_f32_16x16x32_bf16 a[44:47], v[160:163], v[40:43], a[44:47]
    ds_read_b128 v[32:35], v2 offset:6144
    v_cvt_pk_bf16_f32 v150, v241, v245
    v_mfma_f32_16x16x32_bf16 a[44:47], v[176:179], v[44:47], a[44:47]
    v_cvt_pk_bf16_f32 v85, v18, v19
    v_cvt_pk_bf16_f32 v147, v248, v252
    v_mfma_f32_16x16x32_bf16 a[92:95], v[164:167], v[40:43], a[92:95]
    v_exp_f32 v18, v118
    v_mfma_f32_16x16x32_bf16 a[92:95], v[180:183], v[44:47], a[92:95]
    v_cvt_pk_bf16_f32 v151, v249, v253
    v_add_f32 v6, v6, v16
    v_mfma_f32_16x16x32_bf16 a[140:143], v[168:171], v[40:43], a[140:143]
    ds_read_b128 v[36:39], v3 offset:6144
    v_add_f32 v6, v6, v17
    v_mfma_f32_16x16x32_bf16 a[140:143], v[184:187], v[44:47], a[140:143]
    v_exp_f32 v19, v119
    v_mfma_f32_16x16x32_bf16 a[188:191], v[172:175], v[40:43], a[188:191]
    v_cvt_pk_bf16_f32 v154, v242, v246
    v_cvt_pk_bf16_f32 v86, v16, v17
    v_mfma_f32_16x16x32_bf16 a[188:191], v[188:191], v[44:47], a[188:191]
    s_waitcnt lgkmcnt(2)
    v_add_f32 v6, v6, v18
    v_cvt_pk_bf16_f32 v155, v250, v254
    v_add_f32 v6, v6, v19
    v_cvt_pk_bf16_f32 v158, v243, v247
    v_cvt_pk_bf16_f32 v87, v18, v19
    v_cvt_pk_bf16_f32 v159, v251, v255
L_join:
    v_mfma_f32_16x16x32_bf16 v[160:163], v[24:27], a[192:195], v[128:131]
    s_waitcnt vmcnt(7)
    ds_read_b128 v[40:43], v2 offset:128
    v_lshlrev_b32 v48, 16, v56
    v_mfma_f32_16x16x32_bf16 v[160:163], v[28:31], a[196:199], v[160:163]
    s_waitcnt vmcnt(5)
    v_subrev_u32 v52, s92, v52
    v_cmp_lt_u32 vcc, 15, v52
    v_mfma_f32_16x16x32_bf16 v[164:167], v[24:27], a[216:219], v[132:135]
    v_exp_f32 v16, v88
    v_mfma_f32_16x16x32_bf16 v[164:167], v[28:31], a[220:223], v[164:167]
    v_exp_f32 v17, v89
    v_mfma_f32_16x16x32_bf16 v[168:171], v[24:27], a[240:243], v[136:139]
    s_and_b32 s59, vcc_lo, 0xff
    ds_read_b128 v[44:47], v3 offset:128
    v_and_b32 v49, s97, v56
    v_mfma_f32_16x16x32_bf16 v[168:171], v[28:31], a[244:247], v[168:171]
    s_cbranch_scc1 L_pollslow1
L_pollok1:
    v_mfma_f32_16x16x32_bf16 v[172:175], v[24:27], v[200:203], v[140:143]
    s_add_u32 s92, s92, 1
    v_exp_f32 v18, v90
    v_mfma_f32_16x16x32_bf16 v[172:175], v[28:31], v[204:207], v[172:175]
    s_waitcnt lgkmcnt(2)
    v_add_f32 v7, v7, v16
    v_add_f32 v7, v7, v17
    v_mfma_f32_16x16x32_bf16 v[96:99], v[32:35], a[192:195], v[128:131]
    ds_read_b128 v[24:27], v2 offset:6272
    v_lshlrev_b32 v50, 16, v58
    v_mfma_f32_16x16x32_bf16 v[96:99], v[36:39], a[196:199], v[96:99]
    buffer_store_dwordx4 v[144:147], v20, s[4:7], s35 offen offset:0 sc1
    v_mfma_f32_16x16x32_bf16 v[100:103], v[32:35], a[216:219], v[132:135]
    v_exp_f32 v19, v91
    v_mfma_f32_16x16x32_bf16 v[100:103], v[36:39], a[220:223], v[100:103]
    v_cvt_pk_bf16_f32 v88, v16, v17
    v_mfma_f32_16x16x32_bf16 v[104:107], v[32:35], a[240:243], v[136:139]
    ds_read_b128 v[28:31], v3 offset:6272
    v_mfma_f32_16x16x32_bf16 v[104:107], v[36:39], a[244:247], v[104:107]
    v_exp_f32 v16, v120
    v_mfma_f32_16x16x32_bf16 v[108:111], v[32:35], v[200:203], v[140:143]
    v_add_f32 v7, v7, v18
    v_add_f32 v7, v7, v19
    v_mfma_f32_16x16x32_bf16 v[108:111], v[36:39], v[204:207], v[108:111]
    s_waitcnt lgkmcnt(2)
    v_exp_f32 v17, v121
    v_mfma_f32_16x16x32_bf16 v[160:163], v[40:43], a[200:203], v[160:163]
    ds_read_b128 v[32:35], v2 offset:256
    v_cvt_pk_bf16_f32 v89, v18, v19
    v_mfma_f32_16x16x32_bf16 v[160:163], v[44:47], a[204:207], v[160:163]
    buffer_store_dwordx4 v[148:151], v20, s[4:7], s35 offen offset:3072 sc1
    v_mfma_f32_16x16x32_bf16 v[164:167], v[40:43], a[224:227], v[164:167]
    v_exp_f32 v18, v122
    v_mfma_f32_16x16x32_bf16 v[164:167], v[44:47], a[228:231], v[164:167]
    v_add_f32 v7, v7, v16
    v_add_f32 v7, v7, v17
    v_mfma_f32_16x16x32_bf16 v[168:171], v[40:43], a[248:251], v[168:171]
    ds_read_b128 v[36:39], v3 offset:256
    v_and_b32 v51, s97, v58
    v_mfma_f32_16x16x32_bf16 v[168:171], v[44:47], a[252:255], v[168:171]
    v_exp_f32 v19, v123
    v_mfma_f32_16x16x32_bf16 v[172:175], v[40:43], v[208:211], v[172:175]
    v_cvt_pk_bf16_f32 v90, v16, v17
    v_mul_f32 v48, s38, v48
    v_mfma_f32_16x16x32_bf16 v[172:175], v[44:47], v[212:215], v[172:175]
    s_waitcnt lgkmcnt(2)
    v_exp_f32 v16, v92
    v_mfma_f32_16x16x32_bf16 v[96:99], v[24:27], a[200:203], v[96:99]
    ds_read_b128 v[40:43], v2 offset:6400
    v_add_f32 v7, v7, v18
    v_mfma_f32_16x16x32_bf16 v[96:99], v[28:31], a[204:207], v[96:99]
    buffer_store_dwordx4 v[152:155], v20, s[4:7], s17 offen offset:0 sc1
    v_mfma_f32_16x16x32_bf16 v[100:103], v[24:27], a[224:227], v[100:103]
    v_add_f32 v7, v7, v19
    v_mul_f32 v49, s38, v49
    v_mfma_f32_16x16x32_bf16 v[100:103], v[28:31], a[228:231], v[100:103]
    v_exp_f32 v17, v93
    v_mfma_f32_16x16x32_bf16 v[104:107], v[24:27], a[248:251], v[104:107]
    ds_read_b128 v[44:47], v3 offset:6400
    v_cvt_pk_bf16_f32 v91, v18, v19
    v_mfma_f32_16x16x32_bf16 v[104:107], v[28:31], a[252:255], v[104:107]
    v_exp_f32 v18, v94
    v_mfma_f32_16x16x32_bf16 v[108:111], v[24:27], v[208:211], v[108:111]
    s_add_u32 s29, s30, 49152
    v_add_f32 v8, v8, v16
    v_add_f32 v8, v8, v17
    v_mfma_f32_16x16x32_bf16 v[108:111], v[28:31], v[212:215], v[108:111]
    s_waitcnt lgkmcnt(2)
    v_exp_f32 v19, v95
    v_mfma_f32_16x16x32_bf16 v[160:163], v[32:35], a[208:211], v[160:163]
    s_sub_u32 s3, s29, 147456
    ds_read_b128 v[24:27], v2 offset:12288
    v_cvt_pk_bf16_f32 v92, v16, v17
    v_mfma_f32_16x16x32_bf16 v[160:163], v[36:39], a[212:215], v[160:163]
    buffer_store_dwordx4 v[156:159], v20, s[4:7], s17 offen offset:3072 sc1
    v_mfma_f32_16x16x32_bf16 v[164:167], v[32:35], a[232:235], v[164:167]
    s_min_u32 s29, s29, s3
    v_exp_f32 v16, v124
    v_mfma_f32_16x16x32_bf16 v[164:167], v[36:39], a[236:239], v[164:167]
    v_add_f32 v8, v8, v18
    v_add_f32 v8, v8, v19
    v_mfma_f32_16x16x32_bf16 v[168:171], v[32:35], v[192:195], v[168:171]
    ds_read_b128 v[28:31], v3 offset:12288
    v_mul_f32_e64 v50, -v50, v48
    v_mfma_f32_16x16x32_bf16 v[168:171], v[36:39], v[196:199], v[168:171]
    v_exp_f32 v17, v125
    v_mfma_f32_16x16x32_bf16 v[172:175], v[32:35], v[216:219], v[172:175]
    v_cvt_pk_bf16_f32 v93, v18, v19
    v_mul_f32_e64 v51, -v51, v49
    v_mfma_f32_16x16x32_bf16 v[172:175], v[36:39], v[220:223], v[172:175]
    s_waitcnt lgkmcnt(2)
    v_exp_f32 v18, v126
    v_mfma_f32_16x16x32_bf16 v[96:99], v[40:43], a[208:211], v[96:99]
    ds_read_b128 v[32:35], v2 offset:18432
    v_add_f32 v8, v8, v16
    v_mfma_f32_16x16x32_bf16 v[96:99], v[44:47], a[212:215], v[96:99]
    s_mov_b32 m0, s26
    v_add_f32 v8, v8, v17
    s_sub_u32 s3, s29, s30
    v_mfma_f32_16x16x32_bf16 v[100:103], v[40:43], a[232:235], v[100:103]
    v_exp_f32 v19, v127
    v_mfma_f32_16x16x32_bf16 v[100:103], v[44:47], a[236:239], v[100:103]
    buffer_load_dwordx4 v4, s[4:7], s32 offen offset:0 sc1 lds
    v_mfma_f32_16x16x32_bf16 v[104:107], v[40:43], v[192:195], v[104:107]
    ds_read_b128 v[36:39], v3 offset:18432
    v_cvt_pk_bf16_f32 v94, v16, v17
    v_mfma_f32_16x16x32_bf16 v[104:107], v[44:47], v[196:199], v[104:107]
    v_add_f32 v8, v8, v18
    v_add_f32 v8, v8, v19
    v_mfma_f32_16x16x32_bf16 v[108:111], v[40:43], v[216:219], v[108:111]
    v_cvt_pk_bf16_f32 v95, v18, v19
    v_cvt_f32_i32 v224, v224
    v_mfma_f32_16x16x32_bf16 v[108:111], v[44:47], v[220:223], v[108:111]
    s_waitcnt lgkmcnt(2)
    buffer_load_dwordx4 v4, s[4:7], s32 offen offset:1024 sc1 lds
    v_mfma_f32_16x16x32_bf16 v[176:179], v[24:27], a[192:195], v[128:131]
    ds_read_b128 v[40:43], v2 offset:12416
    v_cvt_f32_i32 v225, v225
    v_mfma_f32_16x16x32_bf16 v[176:179], v[28:31], a[196:199], v[176:179]
    s_mov_b32 s30, s29
    v_exp_f32 v16, v160
    v_mfma_f32_16x16x32_bf16 v[180:183], v[24:27], a[216:219], v[132:135]
    v_exp_f32 v17, v161
    v_mfma_f32_16x16x32_bf16 v[180:183], v[28:31], a[220:223], v[180:183]
    buffer_load_dwordx4 v4, s[4:7], s32 offen offset:2048 sc1 lds
    v_mfma_f32_16x16x32_bf16 v[184:187], v[24:27], a[240:243], v[136:139]
    s_add_u32 s32, s32, 24576
    ds_read_b128 v[44:47], v3 offset:12416
    v_mfma_f32_16x16x32_bf16 v[184:187], v[28:31], a[244:247], v[184:187]
    v_exp_f32 v18, v162
    v_mfma_f32_16x16x32_bf16 v[188:191], v[24:27], v[200:203], v[140:143]
    s_add_u32 s26, s26, 12288
    v_add_f32 v5, v5, v16
    v_add_f32 v5, v5, v17
    v_mfma_f32_16x16x32_bf16 v[188:191], v[28:31], v[204:207], v[188:191]
    s_waitcnt lgkmcnt(2)
    v_exp_f32 v19, v163
    v_mfma_f32_16x16x32_bf16 v[112:115], v[32:35], a[192:195], v[128:131]
    s_mov_b32 m0, s26
    ds_read_b128 v[24:27], v2 offset:18560
    v_cvt_pk_bf16_f32 v160, v16, v17
    v_mfma_f32_16x16x32_bf16 v[112:115], v[36:39], a[196:199], v[112:115]
    v_exp_f32 v16, v96
    v_mfma_f32_16x16x32_bf16 v[116:119], v[32:35], a[216:219], v[132:135]
    v_add_f32 v5, v5, v18
    v_fma_f32 v224, v224, v48, v50
    v_mfma_f32_16x16x32_bf16 v[116:119], v[36:39], a[220:223], v[116:119]
    v_add_f32 v5, v5, v19
    v_fma_f32 v225, v225, v49, v51
    v_mfma_f32_16x16x32_bf16 v[120:123], v[32:35], a[240:243], v[136:139]
    ds_read_b128 v[28:31], v3 offset:18560
    v_add_u32 v1, s3, v1
    v_mfma_f32_16x16x32_bf16 v[120:123], v[36:39], a[244:247], v[120:123]
    buffer_load_dwordx4 v4, s[4:7], s32 offen offset:0 sc1 lds
    v_mfma_f32_16x16x32_bf16 v[124:127], v[32:35], v[200:203], v[140:143]
    v_exp_f32 v17, v97
    v_mfma_f32_16x16x32_bf16 v[124:127], v[36:39], v[204:207], v[124:127]
    s_waitcnt lgkmcnt(2)
    v_cvt_pk_bf16_f32 v161, v18, v19
    v_mfma_f32_16x16x32_bf16 v[176:179], v[40:43], a[200:203], v[176:179]
    ds_read_b128 v[32:35], v2 offset:12544
    v_cvt_pk_bf16_f32 v224, v224, v225
    v_mfma_f32_16x16x32_bf16 v[176:179], v[44:47], a[204:207], v[176:179]
    buffer_load_dwordx4 v4, s[4:7], s32 offen offset:1024 sc1 lds
    v_mfma_f32_16x16x32_bf16 v[180:183], v[40:43], a[224:227], v[180:183]
    v_exp_f32 v18, v98
    v_mfma_f32_16x16x32_bf16 v[180:183], v[44:47], a[228:231], v[180:183]
    v_add_f32 v5, v5, v16
    v_add_f32 v5, v5, v17
    v_mfma_f32_16x16x32_bf16 v[184:187], v[40:43], a[248:251], v[184:187]
    ds_read_b128 v[36:39], v3 offset:12544
    v_mfma_f32_16x16x32_bf16 v[184:187], v[44:47], a[252:255], v[184:187]
    buffer_load_dwordx4 v4, s[4:7], s32 offen offset:2048 sc1 lds
    v_mfma_f32_16x16x32_bf16 v[188:191], v[40:43], v[208:211], v[188:191]
    v_exp_f32 v19, v99
    v_mfma_f32_16x16x32_bf16 v[188:191], v[44:47], v[212:215], v[188:191]
    s_waitcnt lgkmcnt(2)
    v_cvt_pk_bf16_f32 v162, v16, v17
    v_cvt_f32_i32 v228, v228
    v_mfma_f32_16x16x32_bf16 v[112:115], v[24:27], a[200:203], v[112:115]
    ds_read_b128 v[40:43], v2 offset:18688
    v_mfma_f32_16x16x32_bf16 v[112:115], v[28:31], a[204:207], v[112:115]
    v_exp_f32 v16, v164
    v_mfma_f32_16x16x32_bf16 v[116:119], v[24:27], a[224:227], v[116:119]
    v_add_f32 v5, v5, v18
    v_add_f32 v5, v5, v19
    v_mfma_f32_16x16x32_bf16 v[116:119], v[28:31], a[228:231], v[116:119]
    s_add_u32 s32, s32, 24576
    v_exp_f32 v17, v165
    v_mfma_f32_16x16x32_bf16 v[120:123], v[24:27], a[248:251], v[120:123]
    s_add_u32 s26, s26, 36864
    ds_read_b128 v[44:47], v3 offset:18688
    v_cvt_pk_bf16_f32 v163, v18, v19
    v_mfma_f32_16x16x32_bf16 v[120:123], v[28:31], a[252:255], v[120:123]
    s_waitcnt lgkmcnt(2)
    v_exp_f32 v18, v166
    v_mfma_f32_16x16x32_bf16 v[124:127], v[24:27], v[208:211], v[124:127]
    s_waitcnt vmcnt(6)
    v_add_f32 v6, v6, v16
    v_add_f32 v6, v6, v17
    v_mfma_f32_16x16x32_bf16 v[124:127], v[28:31], v[212:215], v[124:127]
    s_barrier
    s_sub_u32 s57, s26, 147456
    v_mfma_f32_16x16x32_bf16 v[176:179], v[32:35], a[208:211], v[176:179]
    s_min_u32 s26, s26, s57
    ds_read_b128 v[24:27], v1 offset:0
    v_add_u32 v0, 1, v0
    v_mfma_f32_16x16x32_bf16 v[176:179], v[36:39], a[212:215], v[176:179]
    buffer_store_dword v0, v13, s[20:23], 0 offen offset:32 sc1
    v_mfma_f32_16x16x32_bf16 v[180:183], v[32:35], a[232:235], v[180:183]
    v_exp_f32 v19, v167
    v_mfma_f32_16x16x32_bf16 v[180:183], v[36:39], a[236:239], v[180:183]
    v_cvt_pk_bf16_f32 v164, v16, v17
    v_cvt_f32_i32 v229, v229
    v_mfma_f32_16x16x32_bf16 v[184:187], v[32:35], v[192:195], v[184:187]
    ds_read_b128 v[28:31], v1 offset:12288
    v_fma_f32 v228, v228, v48, v50
    v_mfma_f32_16x16x32_bf16 v[184:187], v[36:39], v[196:199], v[184:187]
    v_exp_f32 v16, v100
    v_mfma_f32_16x16x32_bf16 v[188:191], v[32:35], v[216:219], v[188:191]
    v_add_f32 v6, v6, v18
    v_add_f32 v6, v6, v19
    v_mfma_f32_16x16x32_bf16 v[188:191], v[36:39], v[220:223], v[188:191]
    s_waitcnt lgkmcnt(2)
    v_exp_f32 v17, v101
    v_mfma_f32_16x16x32_bf16 v[112:115], v[40:43], a[208:211], v[112:115]
    ds_read_b128 v[32:35], v1 offset:1024
    v_cvt_pk_bf16_f32 v165, v18, v19
    v_mfma_f32_16x16x32_bf16 v[112:115], v[44:47], a[212:215], v[112:115]
    v_exp_f32 v18, v102
    v_mfma_f32_16x16x32_bf16 v[116:119], v[40:43], a[232:235], v[116:119]
    v_add_f32 v6, v6, v16
    v_add_f32 v6, v6, v17
    v_mfma_f32_16x16x32_bf16 v[116:119], v[44:47], a[236:239], v[116:119]
    v_exp_f32 v19, v103
    v_mfma_f32_16x16x32_bf16 v[120:123], v[40:43], v[192:195], v[120:123]
    ds_read_b128 v[36:39], v1 offset:13312
    v_cvt_pk_bf16_f32 v166, v16, v17
    v_mfma_f32_16x16x32_bf16 v[120:123], v[44:47], v[196:199], v[120:123]
    v_add_f32 v6, v6, v18
    v_add_f32 v6, v6, v19
    v_mfma_f32_16x16x32_bf16 v[124:127], v[40:43], v[216:219], v[124:127]
    v_cvt_pk_bf16_f32 v167, v18, v19
    v_mfma_f32_16x16x32_bf16 v[124:127], v[44:47], v[220:223], v[124:127]
    s_waitcnt lgkmcnt(2)
    v_mfma_f32_16x16x32_bf16 a[0:3], v[64:67], v[24:27], a[0:3]
    s_mov_b32 m0, s26
    ds_read_b128 v[40:43], v1 offset:2048
    v_fma_f32 v229, v229, v49, v51
    v_mfma_f32_16x16x32_bf16 a[0:3], v[80:83], v[28:31], a[0:3]
    buffer_load_dwordx2 v[60:61], v10, s[72:75], s36 offen offset:192
    v_mfma_f32_16x16x32_bf16 a[48:51], v[68:71], v[24:27], a[48:51]
    v_exp_f32 v16, v168
    v_mfma_f32_16x16x32_bf16 a[48:51], v[84:87], v[28:31], a[48:51]
    v_exp_f32 v17, v169
    v_mfma_f32_16x16x32_bf16 a[96:99], v[72:75], v[24:27], a[96:99]
    ds_read_b128 v[44:47], v1 offset:14336
    v_cvt_pk_bf16_f32 v228, v228, v229
    v_mfma_f32_16x16x32_bf16 a[96:99], v[88:91], v[28:31], a[96:99]
    buffer_load_dwordx4 v4, s[4:7], s32 offen offset:0 sc1 lds
    v_mfma_f32_16x16x32_bf16 a[144:147], v[76:79], v[24:27], a[144:147]
    v_exp_f32 v18, v170
    v_mfma_f32_16x16x32_bf16 a[144:147], v[92:95], v[28:31], a[144:147]
    s_waitcnt lgkmcnt(2)
    v_add_f32 v7, v7, v16
    v_add_f32 v7, v7, v17
    v_mfma_f32_16x16x32_bf16 a[4:7], v[64:67], v[32:35], a[4:7]
    ds_read_b128 v[24:27], v1 offset:3072
    v_cvt_f32_i32 v232, v232
    v_mfma_f32_16x16x32_bf16 a[4:7], v[80:83], v[36:39], a[4:7]
    buffer_load_dwordx2 v[62:63], v10, s[76:79], s36 offen offset:192
    v_mfma_f32_16x16x32_bf16 a[52:55], v[68:71], v[32:35], a[52:55]
    v_exp_f32 v19, v171
    v_mfma_f32_16x16x32_bf16 a[52:55], v[84:87], v[36:39], a[52:55]
    v_cvt_pk_bf16_f32 v168, v16, v17
    v_cvt_f32_i32 v233, v233
    v_mfma_f32_16x16x32_bf16 a[100:103], v[72:75], v[32:35], a[100:103]
    ds_read_b128 v[28:31], v1 offset:15360
    v_fma_f32 v232, v232, v48, v50
    v_mfma_f32_16x16x32_bf16 a[100:103], v[88:91], v[36:39], a[100:103]
    buffer_load_dwordx4 v[240:243], v9, s[64:67], s33 offen offset:384 nt
    v_mfma_f32_16x16x32_bf16 a[148:151], v[76:79], v[32:35], a[148:151]
    v_exp_f32 v16, v104
    v_mfma_f32_16x16x32_bf16 a[148:151], v[92:95], v[36:39], a[148:151]
    s_waitcnt lgkmcnt(2)
    v_add_f32 v7, v7, v18
    v_add_f32 v7, v7, v19
    v_mfma_f32_16x16x32_bf16 a[8:11], v[64:67], v[40:43], a[8:11]
    ds_read_b128 v[32:35], v1 offset:4096
    v_fma_f32 v233, v233, v49, v51
    v_mfma_f32_16x16x32_bf16 a[8:11], v[80:83], v[44:47], a[8:11]
    buffer_load_dwordx4 v4, s[4:7], s32 offen offset:1024 sc1 lds
    v_mfma_f32_16x16x32_bf16 a[56:59], v[68:71], v[40:43], a[56:59]
    v_exp_f32 v17, v105
    v_mfma_f32_16x16x32_bf16 a[56:59], v[84:87], v[44:47], a[56:59]
    v_cvt_pk_bf16_f32 v169, v18, v19
    v_cvt_pk_bf16_f32 v232, v232, v233
    v_mfma_f32_16x16x32_bf16 a[104:107], v[72:75], v[40:43], a[104:107]
    ds_read_b128 v[36:39], v1 offset:16384
    v_cvt_f32_i32 v236, v236
    v_mfma_f32_16x16x32_bf16 a[104:107], v[88:91], v[44:47], a[104:107]
    buffer_load_dwordx4 v[244:247], v9, s[64:67], s33 offen offset:1920 nt
    v_mfma_f32_16x16x32_bf16 a[152:155], v[76:79], v[40:43], a[152:155]
    v_exp_f32 v18, v106
    v_mfma_f32_16x16x32_bf16 a[152:155], v[92:95], v[44:47], a[152:155]
    s_waitcnt lgkmcnt(2)
    v_add_f32 v7, v7, v16
    v_add_f32 v7, v7, v17
    v_mfma_f32_16x16x32_bf16 a[12:15], v[64:67], v[24:27], a[12:15]
    ds_read_b128 v[40:43], v1 offset:5120
    v_cvt_f32_i32 v237, v237
    v_mfma_f32_16x16x32_bf16 a[12:15], v[80:83], v[28:31], a[12:15]
    buffer_load_dwordx4 v4, s[4:7], s32 offen offset:2048 sc1 lds
    v_mfma_f32_16x16x32_bf16 a[60:63], v[68:71], v[24:27], a[60:63]
    v_exp_f32 v19, v107
    v_mfma_f32_16x16x32_bf16 a[60:63], v[84:87], v[28:31], a[60:63]
    v_cvt_pk_bf16_f32 v170, v16, v17
    v_exp_f32 v16, v172
    v_mfma_f32_16x16x32_bf16 a[108:111], v[72:75], v[24:27], a[108:111]
    ds_read_b128 v[44:47], v1 offset:17408
    v_add_f32 v7, v7, v18
    v_mfma_f32_16x16x32_bf16 a[108:111], v[88:91], v[28:31], a[108:111]
    buffer_load_dwordx4 v[248:251], v9, s[64:67], s34 offen offset:384 nt
    v_add_f32 v7, v7, v19
    v_mfma_f32_16x16x32_bf16 a[156:159], v[76:79], v[24:27], a[156:159]
    s_add_u32 s29, s28, 49152
    v_exp_f32 v17, v173
    v_mfma_f32_16x16x32_bf16 a[156:159], v[92:95], v[28:31], a[156:159]
    s_waitcnt lgkmcnt(2)
    v_cvt_pk_bf16_f32 v171, v18, v19
    v_fma_f32 v236, v236, v48, v50
    v_mfma_f32_16x16x32_bf16 a[16:19], v[64:67], v[32:35], a[16:19]
    s_sub_u32 s3, s29, 147456
    ds_read_b128 v[24:27], v1 offset:6144
    v_fma_f32 v237, v237, v49, v51
    v_mfma_f32_16x16x32_bf16 a[16:19], v[80:83], v[36:39], a[16:19]
    s_add_u32 s32, s32, 24576
    buffer_load_dwordx4 v[252:255], v9, s[64:67], s34 offen offset:1920 nt
    v_mfma_f32_16x16x32_bf16 a[64:67], v[68:71], v[32:35], a[64:67]
    s_min_u32 s29, s29, s3
    v_exp_f32 v18, v174
    v_mfma_f32_16x16x32_bf16 a[64:67], v[84:87], v[36:39], a[64:67]
    v_add_f32 v8, v8, v16
    v_add_f32 v8, v8, v17
    v_mfma_f32_16x16x32_bf16 a[112:115], v[72:75], v[32:35], a[112:115]
    s_add_u32 s26, s26, 12288
    ds_read_b128 v[28:31], v1 offset:18432
    v_cvt_pk_bf16_f32 v236, v236, v237
    v_mfma_f32_16x16x32_bf16 a[112:115], v[88:91], v[36:39], a[112:115]
    v_exp_f32 v19, v175
    v_cvt_pk_bf16_f32 v172, v16, v17
    v_mfma_f32_16x16x32_bf16 a[160:163], v[76:79], v[32:35], a[160:163]
    v_exp_f32 v16, v108
    v_mfma_f32_16x16x32_bf16 a[160:163], v[92:95], v[36:39], a[160:163]
    s_waitcnt lgkmcnt(2)
    v_add_f32 v8, v8, v18
    v_add_f32 v8, v8, v19
    v_mfma_f32_16x16x32_bf16 a[20:23], v[64:67], v[40:43], a[20:23]
    s_sub_u32 s3, s29, s28
    ds_read_b128 v[32:35], v1 offset:7168
    v_lshlrev_b32 v48, 16, v57
    v_mfma_f32_16x16x32_bf16 a[20:23], v[80:83], v[44:47], a[20:23]
    v_exp_f32 v17, v109
    v_mfma_f32_16x16x32_bf16 a[68:71], v[68:71], v[40:43], a[68:71]
    s_mov_b32 m0, s26
    v_cvt_pk_bf16_f32 v173, v18, v19
    v_and_b32 v49, s97, v57
    v_mfma_f32_16x16x32_bf16 a[68:71], v[84:87], v[44:47], a[68:71]
    v_exp_f32 v18, v110
    v_mfma_f32_16x16x32_bf16 a[116:119], v[72:75], v[40:43], a[116:119]
    ds_read_b128 v[36:39], v1 offset:19456
    v_add_f32 v8, v8, v16
    v_mfma_f32_16x16x32_bf16 a[116:119], v[88:91], v[44:47], a[116:119]
    v_add_f32 v8, v8, v17
    v_mfma_f32_16x16x32_bf16 a[164:167], v[76:79], v[40:43], a[164:167]
    s_mov_b32 s28, s29
    v_exp_f32 v19, v111
    v_mfma_f32_16x16x32_bf16 a[164:167], v[92:95], v[44:47], a[164:167]
    s_waitcnt lgkmcnt(2)
    v_cvt_pk_bf16_f32 v174, v16, v17
    v_add_f32 v8, v8, v18
    v_mfma_f32_16x16x32_bf16 a[24:27], v[64:67], v[24:27], a[24:27]
    ds_read_b128 v[40:43], v1 offset:8192
    v_add_f32 v8, v8, v19
    v_mfma_f32_16x16x32_bf16 a[24:27], v[80:83], v[28:31], a[24:27]
    v_cvt_pk_bf16_f32 v175, v18, v19
    v_lshlrev_b32 v50, 16, v59
    v_mfma_f32_16x16x32_bf16 a[72:75], v[68:71], v[24:27], a[72:75]
    v_exp_f32 v16, v176
    v_mfma_f32_16x16x32_bf16 a[72:75], v[84:87], v[28:31], a[72:75]
    buffer_load_dwordx4 v4, s[4:7], s32 offen offset:0 sc1 lds
    v_mfma_f32_16x16x32_bf16 a[120:123], v[72:75], v[24:27], a[120:123]
    ds_read_b128 v[44:47], v1 offset:20480
    v_and_b32 v51, s97, v59
    v_mfma_f32_16x16x32_bf16 a[120:123], v[88:91], v[28:31], a[120:123]
    v_exp_f32 v17, v177
    v_mfma_f32_16x16x32_bf16 a[168:171], v[76:79], v[24:27], a[168:171]
    v_exp_f32 v18, v178
    v_mfma_f32_16x16x32_bf16 a[168:171], v[92:95], v[28:31], a[168:171]
    s_waitcnt lgkmcnt(2)
    v_add_f32 v5, v5, v16
    v_add_f32 v5, v5, v17
    v_mfma_f32_16x16x32_bf16 a[28:31], v[64:67], v[32:35], a[28:31]
    ds_read_b128 v[24:27], v1 offset:9216
    v_mul_f32 v48, s38, v48
    v_mfma_f32_16x16x32_bf16 a[28:31], v[80:83], v[36:39], a[28:31]
    v_exp_f32 v19, v179
    v_mfma_f32_16x16x32_bf16 a[76:79], v[68:71], v[32:35], a[76:79]
    v_cvt_pk_bf16_f32 v176, v16, v17
    v_add_u32 v2, s3, v2
    v_mfma_f32_16x16x32_bf16 a[76:79], v[84:87], v[36:39], a[76:79]
    v_exp_f32 v16, v112
    v_mfma_f32_16x16x32_bf16 a[124:127], v[72:75], v[32:35], a[124:127]
    ds_read_b128 v[28:31], v1 offset:21504
    v_add_f32 v5, v5, v18
    v_mfma_f32_16x16x32_bf16 a[124:127], v[88:91], v[36:39], a[124:127]
    v_add_f32 v5, v5, v19
    v_mul_f32 v49, s38, v49
    v_mfma_f32_16x16x32_bf16 a[172:175], v[76:79], v[32:35], a[172:175]
    v_exp_f32 v17, v113
    v_mfma_f32_16x16x32_bf16 a[172:175], v[92:95], v[36:39], a[172:175]
    s_waitcnt lgkmcnt(2)
    buffer_load_dwordx4 v4, s[4:7], s32 offen offset:1024 sc1 lds
    v_mfma_f32_16x16x32_bf16 a[32:35], v[64:67], v[40:43], a[32:35]
    ds_read_b128 v[32:35], v1 offset:10240
    v_cvt_pk_bf16_f32 v177, v18, v19
    v_mfma_f32_16x16x32_bf16 a[32:35], v[80:83], v[44:47], a[32:35]
    v_exp_f32 v18, v114
    v_mfma_f32_16x16x32_bf16 a[80:83], v[68:71], v[40:43], a[80:83]
    v_add_f32 v5, v5, v16
    v_add_f32 v5, v5, v17
    v_mfma_f32_16x16x32_bf16 a[80:83], v[84:87], v[44:47], a[80:83]
    v_exp_f32 v19, v115
    v_mfma_f32_16x16x32_bf16 a[128:131], v[72:75], v[40:43], a[128:131]
    ds_read_b128 v[36:39], v1 offset:22528
    v_mul_f32_e64 v50, -v50, v48
    v_mfma_f32_16x16x32_bf16 a[128:131], v[88:91], v[44:47], a[128:131]
    v_cvt_pk_bf16_f32 v178, v16, v17
    v_mul_f32_e64 v51, -v51, v49
    v_mfma_f32_16x16x32_bf16 a[176:179], v[76:79], v[40:43], a[176:179]
    v_exp_f32 v16, v180
    v_mfma_f32_16x16x32_bf16 a[176:179], v[92:95], v[44:47], a[176:179]
    s_waitcnt lgkmcnt(2)
    v_add_f32 v5, v5, v18
    v_add_u32 v3, s3, v3
    v_mfma_f32_16x16x32_bf16 a[36:39], v[64:67], v[24:27], a[36:39]
    ds_read_b128 v[40:43], v1 offset:11264
    v_add_f32 v5, v5, v19
    v_mfma_f32_16x16x32_bf16 a[36:39], v[80:83], v[28:31], a[36:39]
    buffer_load_dwordx4 v4, s[4:7], s32 offen offset:2048 sc1 lds
    v_mfma_f32_16x16x32_bf16 a[84:87], v[68:71], v[24:27], a[84:87]
    v_exp_f32 v17, v181
    v_mfma_f32_16x16x32_bf16 a[84:87], v[84:87], v[28:31], a[84:87]
    v_cvt_pk_bf16_f32 v179, v18, v19
    v_cvt_f32_i32 v226, v226
    v_mfma_f32_16x16x32_bf16 a[132:135], v[72:75], v[24:27], a[132:135]
    ds_read_b128 v[44:47], v1 offset:23552
    v_cvt_f32_i32 v227, v227
    v_mfma_f32_16x16x32_bf16 a[132:135], v[88:91], v[28:31], a[132:135]
    s_waitcnt lgkmcnt(2)
    v_exp_f32 v18, v182
    v_mfma_f32_16x16x32_bf16 a[180:183], v[76:79], v[24:27], a[180:183]
    s_waitcnt vmcnt(13)
    v_add_f32 v6, v6, v16
    v_add_f32 v6, v6, v17
    v_mfma_f32_16x16x32_bf16 a[180:183], v[92:95], v[28:31], a[180:183]
    s_barrier
    v_fma_f32 v226, v226, v48, v50
    v_mfma_f32_16x16x32_bf16 a[40:43], v[64:67], v[32:35], a[40:43]
    ds_read_b128 v[24:27], v2 offset:0
    v_fma_f32 v227, v227, v49, v51
    v_mfma_f32_16x16x32_bf16 a[40:43], v[80:83], v[36:39], a[40:43]
    v_exp_f32 v19, v183
    v_mfma_f32_16x16x32_bf16 a[88:91], v[68:71], v[32:35], a[88:91]
    v_cvt_pk_bf16_f32 v180, v16, v17
    v_mfma_f32_16x16x32_bf16 a[88:91], v[84:87], v[36:39], a[88:91]
    v_exp_f32 v16, v116
    v_mfma_f32_16x16x32_bf16 a[136:139], v[72:75], v[32:35], a[136:139]
    ds_read_b128 v[28:31], v3 offset:0
    v_add_f32 v6, v6, v18
    v_mfma_f32_16x16x32_bf16 a[136:139], v[88:91], v[36:39], a[136:139]
    v_add_f32 v6, v6, v19
    v_cvt_pk_bf16_f32 v225, v226, v227
    v_mfma_f32_16x16x32_bf16 a[184:187], v[76:79], v[32:35], a[184:187]
    v_exp_f32 v17, v117
    v_mfma_f32_16x16x32_bf16 a[184:187], v[92:95], v[36:39], a[184:187]
    s_waitcnt lgkmcnt(2)
    v_cvt_pk_bf16_f32 v181, v18, v19
    v_cvt_f32_i32 v230, v230
    v_mfma_f32_16x16x32_bf16 a[44:47], v[64:67], v[40:43], a[44:47]
    ds_read_b128 v[32:35], v2 offset:6144
    v_mfma_f32_16x16x32_bf16 a[44:47], v[80:83], v[44:47], a[44:47]
    v_exp_f32 v18, v118
    v_mfma_f32_16x16x32_bf16 a[92:95], v[68:71], v[40:43], a[92:95]
    v_add_f32 v6, v6, v16
    v_add_f32 v6, v6, v17
    v_mfma_f32_16x16x32_bf16 a[92:95], v[84:87], v[44:47], a[92:95]
    s_add_u32 s32, s32, 24576
    v_exp_f32 v19, v119
    v_mfma_f32_16x16x32_bf16 a[140:143], v[72:75], v[40:43], a[140:143]
    s_add_u32 s26, s26, 36864
    ds_read_b128 v[36:39], v3 offset:6144
    v_cvt_pk_bf16_f32 v182, v16, v17
    v_mfma_f32_16x16x32_bf16 a[140:143], v[88:91], v[44:47], a[140:143]
    s_sub_u32 s57, s26, 147456
    v_add_f32 v6, v6, v18
    v_add_f32 v6, v6, v19
    v_mfma_f32_16x16x32_bf16 a[188:191], v[76:79], v[40:43], a[188:191]
    s_min_u32 s26, s26, s57
    v_cvt_pk_bf16_f32 v183, v18, v19
    v_mfma_f32_16x16x32_bf16 a[188:191], v[92:95], v[44:47], a[188:191]
    s_waitcnt lgkmcnt(2)
    v_mfma_f32_16x16x32_bf16 v[64:67], v[24:27], a[192:195], v[128:131]
    ds_read_b128 v[40:43], v2 offset:128
    v_cvt_f32_i32 v231, v231
    v_mfma_f32_16x16x32_bf16 v[64:67], v[28:31], a[196:199], v[64:67]
    v_exp_f32 v16, v184
    v_mfma_f32_16x16x32_bf16 v[68:71], v[24:27], a[216:219], v[132:135]
    v_exp_f32 v17, v185
    v_mfma_f32_16x16x32_bf16 v[68:71], v[28:31], a[220:223], v[68:71]
    v_bfe_u32 v53, v4, 4, 6
    v_fma_f32 v230, v230, v48, v50
    v_mfma_f32_16x16x32_bf16 v[72:75], v[24:27], a[240:243], v[136:139]
    ds_read_b128 v[44:47], v3 offset:128
    v_lshlrev_b32 v53, 2, v53
    v_mfma_f32_16x16x32_bf16 v[72:75], v[28:31], a[244:247], v[72:75]
    buffer_load_dword v52, v53, s[20:23], s44 offen sc1
    v_mfma_f32_16x16x32_bf16 v[76:79], v[24:27], v[200:203], v[140:143]
    v_exp_f32 v18, v186
    v_mfma_f32_16x16x32_bf16 v[76:79], v[28:31], v[204:207], v[76:79]
    s_waitcnt lgkmcnt(2)
    v_add_f32 v7, v7, v16
    v_add_f32 v7, v7, v17
    v_mfma_f32_16x16x32_bf16 v[96:99], v[32:35], a[192:195], v[128:131]
    ds_read_b128 v[24:27], v2 offset:6272
    v_fma_f32 v231, v231, v49, v51
    v_mfma_f32_16x16x32_bf16 v[96:99], v[36:39], a[196:199], v[96:99]
    v_exp_f32 v19, v187
    v_mfma_f32_16x16x32_bf16 v[100:103], v[32:35], a[216:219], v[132:135]
    v_cvt_pk_bf16_f32 v184, v16, v17
    v_cvt_pk_bf16_f32 v229, v230, v231
    v_mfma_f32_16x16x32_bf16 v[100:103], v[36:39], a[220:223], v[100:103]
    s_add_u32 s35, s35, 196608
    v_exp_f32 v16, v120
    v_mfma_f32_16x16x32_bf16 v[104:107], v[32:35], a[240:243], v[136:139]
    s_mov_b32 m0, s26
    ds_read_b128 v[28:31], v3 offset:6272
    v_add_f32 v7, v7, v18
    v_mfma_f32_16x16x32_bf16 v[104:107], v[36:39], a[244:247], v[104:107]
    s_add_u32 s16, s16, 196608
    buffer_load_dwordx4 v4, s[4:7], s32 offen offset:0 sc1 lds
    v_mfma_f32_16x16x32_bf16 v[108:111], v[32:35], v[200:203], v[140:143]
    s_add_u32 s17, s17, 196608
    v_add_f32 v7, v7, v19
    v_cvt_f32_i32 v234, v234
    v_mfma_f32_16x16x32_bf16 v[108:111], v[36:39], v[204:207], v[108:111]
    s_waitcnt lgkmcnt(2)
    v_exp_f32 v17, v121
    v_mfma_f32_16x16x32_bf16 v[64:67], v[40:43], a[200:203], v[64:67]
    s_add_u32 s37, s37, 512
    ds_read_b128 v[32:35], v2 offset:256
    v_cvt_pk_bf16_f32 v185, v18, v19
    v_mfma_f32_16x16x32_bf16 v[64:67], v[44:47], a[204:207], v[64:67]
    v_exp_f32 v18, v122
    v_mfma_f32_16x16x32_bf16 v[68:71], v[40:43], a[224:227], v[68:71]
    v_add_f32 v7, v7, v16
    v_add_f32 v7, v7, v17
    v_mfma_f32_16x16x32_bf16 v[68:71], v[44:47], a[228:231], v[68:71]
    v_exp_f32 v19, v123
    v_mfma_f32_16x16x32_bf16 v[72:75], v[40:43], a[248:251], v[72:75]
    ds_read_b128 v[36:39], v3 offset:256
    v_cvt_pk_bf16_f32 v186, v16, v17
    v_mfma_f32_16x16x32_bf16 v[72:75], v[44:47], a[252:255], v[72:75]
    buffer_load_dwordx4 v4, s[4:7], s32 offen offset:1024 sc1 lds
    v_mfma_f32_16x16x32_bf16 v[76:79], v[40:43], v[208:211], v[76:79]
    v_exp_f32 v16, v188
    v_mfma_f32_16x16x32_bf16 v[76:79], v[44:47], v[212:215], v[76:79]
    s_waitcnt lgkmcnt(2)
    v_add_f32 v7, v7, v18
    v_cvt_f32_i32 v235, v235
    v_mfma_f32_16x16x32_bf16 v[96:99], v[24:27], a[200:203], v[96:99]
    ds_read_b128 v[40:43], v2 offset:6400
    v_add_f32 v7, v7, v19
    v_mfma_f32_16x16x32_bf16 v[96:99], v[28:31], a[204:207], v[96:99]
    buffer_load_dwordx2 v[56:57], off, s[80:83], s37 offset:0
    v_mfma_f32_16x16x32_bf16 v[100:103], v[24:27], a[224:227], v[100:103]
    v_exp_f32 v17, v189
    v_mfma_f32_16x16x32_bf16 v[100:103], v[28:31], a[228:231], v[100:103]
    v_cvt_pk_bf16_f32 v187, v18, v19
    v_fma_f32 v234, v234, v48, v50
    v_mfma_f32_16x16x32_bf16 v[104:107], v[24:27], a[248:251], v[104:107]
    ds_read_b128 v[44:47], v3 offset:6400
    v_fma_f32 v235, v235, v49, v51
    v_mfma_f32_16x16x32_bf16 v[104:107], v[28:31], a[252:255], v[104:107]
    buffer_load_dwordx2 v[58:59], off, s[84:87], s37 offset:0
    v_mfma_f32_16x16x32_bf16 v[108:111], v[24:27], v[208:211], v[108:111]
    s_add_u32 s29, s30, 49152
    v_exp_f32 v18, v190
    v_mfma_f32_16x16x32_bf16 v[108:111], v[28:31], v[212:215], v[108:111]
    s_waitcnt lgkmcnt(2)
    v_add_f32 v8, v8, v16
    v_add_f32 v8, v8, v17
    v_mfma_f32_16x16x32_bf16 v[64:67], v[32:35], a[208:211], v[64:67]
    s_sub_u32 s3, s29, 147456
    ds_read_b128 v[24:27], v2 offset:12288
    v_cvt_pk_bf16_f32 v233, v234, v235
    v_mfma_f32_16x16x32_bf16 v[64:67], v[36:39], a[212:215], v[64:67]
    s_min_u32 s29, s29, s3
    buffer_load_dwordx4 v4, s[4:7], s32 offen offset:2048 sc1 lds
    v_mfma_f32_16x16x32_bf16 v[68:71], v[32:35], a[232:235], v[68:71]
    v_exp_f32 v19, v191
    v_mfma_f32_16x16x32_bf16 v[68:71], v[36:39], a[236:239], v[68:71]
    v_cvt_pk_bf16_f32 v188, v16, v17
    v_cvt_f32_i32 v238, v238
    v_mfma_f32_16x16x32_bf16 v[72:75], v[32:35], v[192:195], v[72:75]
    ds_read_b128 v[28:31], v3 offset:12288
    v_mfma_f32_16x16x32_bf16 v[72:75], v[36:39], v[196:199], v[72:75]
    buffer_load_dwordx4 v[144:147], v12, s[68:71], s35 offen offset:0 nt
    v_mfma_f32_16x16x32_bf16 v[76:79], v[32:35], v[216:219], v[76:79]
    v_exp_f32 v16, v124
    v_mfma_f32_16x16x32_bf16 v[76:79], v[36:39], v[220:223], v[76:79]
    s_waitcnt lgkmcnt(2)
    v_add_f32 v8, v8, v18
    v_add_f32 v8, v8, v19
    v_mfma_f32_16x16x32_bf16 v[96:99], v[40:43], a[208:211], v[96:99]
    s_add_u32 s32, s32, 24576
    ds_read_b128 v[32:35], v2 offset:18432
    v_cvt_f32_i32 v239, v239
    v_mfma_f32_16x16x32_bf16 v[96:99], v[44:47], a[212:215], v[96:99]
    s_sub_u32 s3, s29, s30
    v_exp_f32 v17, v125
    v_mfma_f32_16x16x32_bf16 v[100:103], v[40:43], a[232:235], v[100:103]
    v_cvt_pk_bf16_f32 v189, v18, v19
    v_fma_f32 v238, v238, v48, v50
    v_mfma_f32_16x16x32_bf16 v[100:103], v[44:47], a[236:239], v[100:103]
    v_exp_f32 v18, v126
    v_mfma_f32_16x16x32_bf16 v[104:107], v[40:43], v[192:195], v[104:107]
    s_add_u32 s26, s26, 12288
    ds_read_b128 v[36:39], v3 offset:18432
    v_add_f32 v8, v8, v16
    v_mfma_f32_16x16x32_bf16 v[104:107], v[44:47], v[196:199], v[104:107]
    buffer_load_dwordx4 v[148:151], v12, s[68:71], s35 offen offset:768 nt
    v_mfma_f32_16x16x32_bf16 v[108:111], v[40:43], v[216:219], v[108:111]
    v_add_f32 v8, v8, v17
    v_fma_f32 v239, v239, v49, v51
    v_mfma_f32_16x16x32_bf16 v[108:111], v[44:47], v[220:223], v[108:111]
    s_waitcnt lgkmcnt(2)
    v_exp_f32 v19, v127
    v_mfma_f32_16x16x32_bf16 v[80:83], v[24:27], a[192:195], v[128:131]
    ds_read_b128 v[40:43], v2 offset:12416
    v_cvt_pk_bf16_f32 v190, v16, v17
    v_mfma_f32_16x16x32_bf16 v[80:83], v[28:31], a[196:199], v[80:83]
    s_mov_b32 m0, s26
    v_add_f32 v8, v8, v18
    v_add_f32 v8, v8, v19
    v_mfma_f32_16x16x32_bf16 v[84:87], v[24:27], a[216:219], v[132:135]
    s_mov_b32 s30, s29
    v_cvt_pk_bf16_f32 v191, v18, v19
    v_cvt_pk_bf16_f32 v237, v238, v239
    v_mfma_f32_16x16x32_bf16 v[84:87], v[28:31], a[220:223], v[84:87]
    v_exp_f32 v16, v64
    v_mfma_f32_16x16x32_bf16 v[88:91], v[24:27], a[240:243], v[136:139]
    ds_read_b128 v[44:47], v3 offset:12416
    v_mfma_f32_16x16x32_bf16 v[88:91], v[28:31], a[244:247], v[88:91]
    buffer_load_dwordx4 v[152:155], v12, s[68:71], s35 offen offset:1536 nt
    v_mfma_f32_16x16x32_bf16 v[92:95], v[24:27], v[200:203], v[140:143]
    v_exp_f32 v17, v65
    v_mfma_f32_16x16x32_bf16 v[92:95], v[28:31], v[204:207], v[92:95]
    s_waitcnt lgkmcnt(2)
    v_exp_f32 v18, v66
    v_mfma_f32_16x16x32_bf16 v[112:115], v[32:35], a[192:195], v[128:131]
    ds_read_b128 v[24:27], v2 offset:18560
    v_add_f32 v5, v5, v16
    v_mfma_f32_16x16x32_bf16 v[112:115], v[36:39], a[196:199], v[112:115]
    buffer_load_dwordx4 v4, s[4:7], s32 offen offset:0 sc1 lds
    v_mfma_f32_16x16x32_bf16 v[116:119], v[32:35], a[216:219], v[132:135]
    v_add_f32 v5, v5, v17
    v_add_u32 v1, s3, v1
    v_mfma_f32_16x16x32_bf16 v[116:119], v[36:39], a[220:223], v[116:119]
    v_exp_f32 v19, v67
    v_mfma_f32_16x16x32_bf16 v[120:123], v[32:35], a[240:243], v[136:139]
    ds_read_b128 v[28:31], v3 offset:18560
    v_cvt_pk_bf16_f32 v64, v16, v17
    v_mfma_f32_16x16x32_bf16 v[120:123], v[36:39], a[244:247], v[120:123]
    s_waitcnt vmcnt(13)
    buffer_load_dwordx4 v[156:159], v12, s[68:71], s35 offen offset:2304 nt
    v_mfma_f32_16x16x32_bf16 v[124:127], v[32:35], v[200:203], v[140:143]
    v_exp_f32 v16, v96
    v_mfma_f32_16x16x32_bf16 v[124:127], v[36:39], v[204:207], v[124:127]
    s_waitcnt lgkmcnt(2)
    v_add_f32 v5, v5, v18
    v_add_f32 v5, v5, v19
    v_mfma_f32_16x16x32_bf16 v[80:83], v[40:43], a[200:203], v[80:83]
    ds_read_b128 v[32:35], v2 offset:12544
    v_lshlrev_b32 v48, 16, v60
    v_mfma_f32_16x16x32_bf16 v[80:83], v[44:47], a[204:207], v[80:83]
    v_exp_f32 v17, v97
    v_mfma_f32_16x16x32_bf16 v[84:87], v[40:43], a[224:227], v[84:87]
    v_cvt_pk_bf16_f32 v65, v18, v19
    v_and_b32 v49, s97, v60
    v_mfma_f32_16x16x32_bf16 v[84:87], v[44:47], a[228:231], v[84:87]
    buffer_load_dwordx4 v4, s[4:7], s32 offen offset:1024 sc1 lds
    v_mfma_f32_16x16x32_bf16 v[88:91], v[40:43], a[248:251], v[88:91]
    ds_read_b128 v[36:39], v3 offset:12544
    v_lshlrev_b32 v50, 16, v62
    v_mfma_f32_16x16x32_bf16 v[88:91], v[44:47], a[252:255], v[88:91]
    v_exp_f32 v18, v98
    v_mfma_f32_16x16x32_bf16 v[92:95], v[40:43], v[208:211], v[92:95]
    v_add_f32 v5, v5, v16
    v_add_f32 v5, v5, v17
    v_mfma_f32_16x16x32_bf16 v[92:95], v[44:47], v[212:215], v[92:95]
    s_waitcnt lgkmcnt(2)
    v_exp_f32 v19, v99
    v_mfma_f32_16x16x32_bf16 v[112:115], v[24:27], a[200:203], v[112:115]
    ds_read_b128 v[40:43], v2 offset:18688
    v_cvt_pk_bf16_f32 v66, v16, v17
    v_mfma_f32_16x16x32_bf16 v[112:115], v[28:31], a[204:207], v[112:115]
    v_exp_f32 v16, v68
    v_mfma_f32_16x16x32_bf16 v[116:119], v[24:27], a[224:227], v[116:119]
    v_add_f32 v5, v5, v18
    v_add_f32 v5, v5, v19
    v_mfma_f32_16x16x32_bf16 v[116:119], v[28:31], a[228:231], v[116:119]
    v_exp_f32 v17, v69
    v_mfma_f32_16x16x32_bf16 v[120:123], v[24:27], a[248:251], v[120:123]
    ds_read_b128 v[44:47], v3 offset:18688
    v_cvt_pk_bf16_f32 v67, v18, v19
    v_mfma_f32_16x16x32_bf16 v[120:123], v[28:31], a[252:255], v[120:123]
    s_waitcnt lgkmcnt(2)
    buffer_load_dwordx4 v4, s[4:7], s32 offen offset:2048 sc1 lds
    v_mfma_f32_16x16x32_bf16 v[124:127], v[24:27], v[208:211], v[124:127]
    s_waitcnt vmcnt(13)
    v_exp_f32 v18, v70
    v_mfma_f32_16x16x32_bf16 v[124:127], v[28:31], v[212:215], v[124:127]
    s_barrier
    v_add_f32 v6, v6, v16
    v_mfma_f32_16x16x32_bf16 v[80:83], v[32:35], a[208:211], v[80:83]
    ds_read_b128 v[24:27], v1 offset:0
    v_add_f32 v6, v6, v17
    v_mfma_f32_16x16x32_bf16 v[80:83], v[36:39], a[212:215], v[80:83]
    v_exp_f32 v19, v71
    v_mfma_f32_16x16x32_bf16 v[84:87], v[32:35], a[232:235], v[84:87]
    v_cvt_pk_bf16_f32 v68, v16, v17
    v_and_b32 v51, s97, v62
    v_mfma_f32_16x16x32_bf16 v[84:87], v[36:39], a[236:239], v[84:87]
    v_exp_f32 v16, v100
    v_mfma_f32_16x16x32_bf16 v[88:91], v[32:35], v[192:195], v[88:91]
    ds_read_b128 v[28:31], v1 offset:12288
    v_add_f32 v6, v6, v18
    v_mfma_f32_16x16x32_bf16 v[88:91], v[36:39], v[196:199], v[88:91]
    v_add_f32 v6, v6, v19
    v_mul_f32 v48, s38, v48
    v_mfma_f32_16x16x32_bf16 v[92:95], v[32:35], v[216:219], v[92:95]
    v_exp_f32 v17, v101
    v_mfma_f32_16x16x32_bf16 v[92:95], v[36:39], v[220:223], v[92:95]
    s_waitcnt lgkmcnt(2)
    v_cvt_pk_bf16_f32 v69, v18, v19
    v_mul_f32 v49, s38, v49
    v_mfma_f32_16x16x32_bf16 v[112:115], v[40:43], a[208:211], v[112:115]
    ds_read_b128 v[32:35], v1 offset:1024
    v_mul_f32_e64 v50, -v50, v48
    v_mfma_f32_16x16x32_bf16 v[112:115], v[44:47], a[212:215], v[112:115]
    v_exp_f32 v18, v102
    v_mfma_f32_16x16x32_bf16 v[116:119], v[40:43], a[232:235], v[116:119]
    v_add_f32 v6, v6, v16
    v_add_f32 v6, v6, v17
    v_mfma_f32_16x16x32_bf16 v[116:119], v[44:47], a[236:239], v[116:119]
    v_exp_f32 v19, v103
    v_mfma_f32_16x16x32_bf16 v[120:123], v[40:43], v[192:195], v[120:123]
    ds_read_b128 v[36:39], v1 offset:13312
    v_cvt_pk_bf16_f32 v70, v16, v17
    v_mfma_f32_16x16x32_bf16 v[120:123], v[44:47], v[196:199], v[120:123]
    s_add_u32 s32, s32, 24576
    v_add_f32 v6, v6, v18
    v_mul_f32_e64 v51, -v51, v49
    v_mfma_f32_16x16x32_bf16 v[124:127], v[40:43], v[216:219], v[124:127]
    s_add_u32 s26, s26, 36864
    v_add_f32 v6, v6, v19
    s_sub_u32 s57, s26, 147456
    v_mfma_f32_16x16x32_bf16 v[124:127], v[44:47], v[220:223], v[124:127]
    s_waitcnt lgkmcnt(2)
    v_cvt_pk_bf16_f32 v71, v18, v19
    s_min_u32 s26, s26, s57
    v_mfma_f32_16x16x32_bf16 a[0:3], v[160:163], v[24:27], a[0:3]
    ds_read_b128 v[40:43], v1 offset:2048
    v_cvt_f32_i32 v240, v240
    v_mfma_f32_16x16x32_bf16 a[0:3], v[176:179], v[28:31], a[0:3]
    s_waitcnt vmcnt(12)
    v_subrev_u32 v52, s92, v52
    v_cmp_lt_u32 vcc, 15, v52
    v_mfma_f32_16x16x32_bf16 a[48:51], v[164:167], v[24:27], a[48:51]
    v_exp_f32 v16, v72
    v_mfma_f32_16x16x32_bf16 a[48:51], v[180:183], v[28:31], a[48:51]
    v_exp_f32 v17, v73
    v_mfma_f32_16x16x32_bf16 a[96:99], v[168:171], v[24:27], a[96:99]
    s_and_b32 s59, vcc_lo, 0xff
    ds_read_b128 v[44:47], v1 offset:14336
    v_cvt_f32_i32 v241, v241
    v_mfma_f32_16x16x32_bf16 a[96:99], v[184:187], v[28:31], a[96:99]
    s_cbranch_scc1 L_pollslow2
L_pollok2:
    v_mfma_f32_16x16x32_bf16 a[144:147], v[172:175], v[24:27], a[144:147]
    s_add_u32 s92, s92, 1
    v_exp_f32 v18, v74
    v_mfma_f32_16x16x32_bf16 a[144:147], v[188:191], v[28:31], a[144:147]
    s_waitcnt lgkmcnt(2)
    v_add_f32 v7, v7, v16
    v_add_f32 v7, v7, v17
    v_mfma_f32_16x16x32_bf16 a[4:7], v[160:163], v[32:35], a[4:7]
    s_mov_b32 m0, s56
    ds_read_b128 v[24:27], v1 offset:3072
    v_fma_f32 v240, v240, v48, v50
    v_mfma_f32_16x16x32_bf16 a[4:7], v[176:179], v[36:39], a[4:7]
    buffer_load_dwordx4 v4, s[4:7], s27 offen offset:0 sc1 lds
    v_mfma_f32_16x16x32_bf16 a[52:55], v[164:167], v[32:35], a[52:55]
    v_exp_f32 v19, v75
    v_mfma_f32_16x16x32_bf16 a[52:55], v[180:183], v[36:39], a[52:55]
    v_cvt_pk_bf16_f32 v72, v16, v17
    v_fma_f32 v241, v241, v49, v51
    v_mfma_f32_16x16x32_bf16 a[100:103], v[168:171], v[32:35], a[100:103]
    ds_read_b128 v[28:31], v1 offset:15360
    v_cvt_pk_bf16_f32 v226, v240, v241
    v_mfma_f32_16x16x32_bf16 a[100:103], v[184:187], v[36:39], a[100:103]
    v_exp_f32 v16, v104
    v_mfma_f32_16x16x32_bf16 a[148:151], v[172:175], v[32:35], a[148:151]
    v_add_f32 v7, v7, v18
    v_add_f32 v7, v7, v19
    v_mfma_f32_16x16x32_bf16 a[148:151], v[188:191], v[36:39], a[148:151]
    s_waitcnt lgkmcnt(2)
    v_exp_f32 v17, v105
    v_mfma_f32_16x16x32_bf16 a[8:11], v[160:163], v[40:43], a[8:11]
    ds_read_b128 v[32:35], v1 offset:4096
    v_cvt_pk_bf16_f32 v73, v18, v19
    v_mfma_f32_16x16x32_bf16 a[8:11], v[176:179], v[44:47], a[8:11]
    buffer_load_dwordx4 v4, s[4:7], s27 offen offset:1024 sc1 lds
    v_mfma_f32_16x16x32_bf16 a[56:59], v[164:167], v[40:43], a[56:59]
    v_exp_f32 v18, v106
    v_mfma_f32_16x16x32_bf16 a[56:59], v[180:183], v[44:47], a[56:59]
    v_add_f32 v7, v7, v16
    v_cvt_f32_i32 v244, v244
    v_mfma_f32_16x16x32_bf16 a[104:107], v[168:171], v[40:43], a[104:107]
    ds_read_b128 v[36:39], v1 offset:16384
    v_add_f32 v7, v7, v17
    v_mfma_f32_16x16x32_bf16 a[104:107], v[184:187], v[44:47], a[104:107]
    v_exp_f32 v19, v107
    v_mfma_f32_16x16x32_bf16 a[152:155], v[172:175], v[40:43], a[152:155]
    v_cvt_f32_i32 v245, v245
    v_cvt_pk_bf16_f32 v74, v16, v17
    v_mfma_f32_16x16x32_bf16 a[152:155], v[188:191], v[44:47], a[152:155]
    s_waitcnt lgkmcnt(2)
    v_exp_f32 v16, v76
    v_mfma_f32_16x16x32_bf16 a[12:15], v[160:163], v[24:27], a[12:15]
    ds_read_b128 v[40:43], v1 offset:5120
    v_fma_f32 v244, v244, v48, v50
    v_mfma_f32_16x16x32_bf16 a[12:15], v[176:179], v[28:31], a[12:15]
    buffer_load_dwordx4 v4, s[4:7], s27 offen offset:2048 sc1 lds
    v_mfma_f32_16x16x32_bf16 a[60:63], v[164:167], v[24:27], a[60:63]
    v_add_f32 v7, v7, v18
    v_add_f32 v7, v7, v19
    v_mfma_f32_16x16x32_bf16 a[60:63], v[180:183], v[28:31], a[60:63]
    v_exp_f32 v17, v77
    v_mfma_f32_16x16x32_bf16 a[108:111], v[168:171], v[24:27], a[108:111]
    ds_read_b128 v[44:47], v1 offset:17408
    v_fma_f32 v245, v245, v49, v51
    v_mfma_f32_16x16x32_bf16 a[108:111], v[184:187], v[28:31], a[108:111]
    v_cvt_pk_bf16_f32 v75, v18, v19
    v_cvt_pk_bf16_f32 v230, v244, v245
    v_mfma_f32_16x16x32_bf16 a[156:159], v[172:175], v[24:27], a[156:159]
    s_add_u32 s29, s28, 49152
    v_exp_f32 v18, v78
    v_mfma_f32_16x16x32_bf16 a[156:159], v[188:191], v[28:31], a[156:159]
    s_waitcnt lgkmcnt(2)
    v_add_f32 v8, v8, v16
    v_cvt_f32_i32 v248, v248
    v_mfma_f32_16x16x32_bf16 a[16:19], v[160:163], v[32:35], a[16:19]
    s_sub_u32 s3, s29, 147456
    ds_read_b128 v[24:27], v1 offset:6144
    v_add_f32 v8, v8, v17
    v_mfma_f32_16x16x32_bf16 a[16:19], v[176:179], v[36:39], a[16:19]
    s_add_u32 s27, s27, 24576
    v_exp_f32 v19, v79
    v_mfma_f32_16x16x32_bf16 a[64:67], v[164:167], v[32:35], a[64:67]
    s_min_u32 s29, s29, s3
    v_cvt_f32_i32 v249, v249
    v_cvt_pk_bf16_f32 v76, v16, v17
    v_mfma_f32_16x16x32_bf16 a[64:67], v[180:183], v[36:39], a[64:67]
    s_add_u32 s56, s56, 12288
    v_exp_f32 v16, v108
    v_mfma_f32_16x16x32_bf16 a[112:115], v[168:171], v[32:35], a[112:115]
    ds_read_b128 v[28:31], v1 offset:18432
    v_fma_f32 v248, v248, v48, v50
    v_mfma_f32_16x16x32_bf16 a[112:115], v[184:187], v[36:39], a[112:115]
    v_add_f32 v8, v8, v18
    v_fma_f32 v249, v249, v49, v51
    v_mfma_f32_16x16x32_bf16 a[160:163], v[172:175], v[32:35], a[160:163]
    v_add_f32 v8, v8, v19
    v_cvt_pk_bf16_f32 v234, v248, v249
    v_mfma_f32_16x16x32_bf16 a[160:163], v[188:191], v[36:39], a[160:163]
    s_waitcnt lgkmcnt(2)
    v_exp_f32 v17, v109
    v_mfma_f32_16x16x32_bf16 a[20:23], v[160:163], v[40:43], a[20:23]
    s_mov_b32 m0, s56
    ds_read_b128 v[32:35], v1 offset:7168
    v_cvt_pk_bf16_f32 v77, v18, v19
    v_mfma_f32_16x16x32_bf16 a[20:23], v[176:179], v[44:47], a[20:23]
    s_sub_u32 s3, s29, s28
    v_exp_f32 v18, v110
    v_mfma_f32_16x16x32_bf16 a[68:71], v[164:167], v[40:43], a[68:71]
    v_cvt_f32_i32 v252, v252
    v_add_f32 v8, v8, v16
    v_mfma_f32_16x16x32_bf16 a[68:71], v[180:183], v[44:47], a[68:71]
    v_add_f32 v8, v8, v17
    v_cvt_f32_i32 v253, v253
    v_mfma_f32_16x16x32_bf16 a[116:119], v[168:171], v[40:43], a[116:119]
    ds_read_b128 v[36:39], v1 offset:19456
    v_fma_f32 v252, v252, v48, v50
    v_mfma_f32_16x16x32_bf16 a[116:119], v[184:187], v[44:47], a[116:119]
    buffer_load_dwordx4 v4, s[4:7], s27 offen offset:0 sc1 lds
    v_mfma_f32_16x16x32_bf16 a[164:167], v[172:175], v[40:43], a[164:167]
    s_mov_b32 s28, s29
    v_exp_f32 v19, v111
    v_mfma_f32_16x16x32_bf16 a[164:167], v[188:191], v[44:47], a[164:167]
    s_waitcnt lgkmcnt(2)
    v_cvt_pk_bf16_f32 v78, v16, v17
    v_add_f32 v8, v8, v18
    v_mfma_f32_16x16x32_bf16 a[24:27], v[160:163], v[24:27], a[24:27]
    ds_read_b128 v[40:43], v1 offset:8192
    v_add_f32 v8, v8, v19
    v_mfma_f32_16x16x32_bf16 a[24:27], v[176:179], v[28:31], a[24:27]
    v_cvt_pk_bf16_f32 v79, v18, v19
    v_fma_f32 v253, v253, v49, v51
    v_mfma_f32_16x16x32_bf16 a[72:75], v[164:167], v[24:27], a[72:75]
    v_exp_f32 v16, v80
    v_mfma_f32_16x16x32_bf16 a[72:75], v[180:183], v[28:31], a[72:75]
    v_exp_f32 v17, v81
    v_mfma_f32_16x16x32_bf16 a[120:123], v[168:171], v[24:27], a[120:123]
    ds_read_b128 v[44:47], v1 offset:20480
    v_cvt_pk_bf16_f32 v238, v252, v253
    v_mfma_f32_16x16x32_bf16 a[120:123], v[184:187], v[28:31], a[120:123]
    v_exp_f32 v18, v82
    v_mfma_f32_16x16x32_bf16 a[168:171], v[172:175], v[24:27], a[168:171]
    v_lshlrev_b32 v48, 16, v61
    v_add_f32 v5, v5, v16
    v_mfma_f32_16x16x32_bf16 a[168:171], v[188:191], v[28:31], a[168:171]
    s_waitcnt lgkmcnt(2)
    buffer_load_dwordx4 v4, s[4:7], s27 offen offset:1024 sc1 lds
    v_mfma_f32_16x16x32_bf16 a[28:31], v[160:163], v[32:35], a[28:31]
    ds_read_b128 v[24:27], v1 offset:9216
    v_add_f32 v5, v5, v17
    v_mfma_f32_16x16x32_bf16 a[28:31], v[176:179], v[36:39], a[28:31]
    v_exp_f32 v19, v83
    v_mfma_f32_16x16x32_bf16 a[76:79], v[164:167], v[32:35], a[76:79]
    v_and_b32 v49, s97, v61
    v_cvt_pk_bf16_f32 v80, v16, v17
    v_mfma_f32_16x16x32_bf16 a[76:79], v[180:183], v[36:39], a[76:79]
    v_exp_f32 v16, v112
    v_mfma_f32_16x16x32_bf16 a[124:127], v[168:171], v[32:35], a[124:127]
    ds_read_b128 v[28:31], v1 offset:21504
    v_lshlrev_b32 v50, 16, v63
    v_mfma_f32_16x16x32_bf16 a[124:127], v[184:187], v[36:39], a[124:127]
    v_add_f32 v5, v5, v18
    v_and_b32 v51, s97, v63
    v_mfma_f32_16x16x32_bf16 a[172:175], v[172:175], v[32:35], a[172:175]
    v_add_f32 v5, v5, v19
    v_mul_f32 v48, s38, v48
    v_mfma_f32_16x16x32_bf16 a[172:175], v[188:191], v[36:39], a[172:175]
    s_waitcnt lgkmcnt(2)
    buffer_load_dwordx4 v4, s[4:7], s27 offen offset:2048 sc1 lds
    v_mfma_f32_16x16x32_bf16 a[32:35], v[160:163], v[40:43], a[32:35]
    ds_read_b128 v[32:35], v1 offset:10240
    v_mul_f32 v49, s38, v49
    v_mfma_f32_16x16x32_bf16 a[32:35], v[176:179], v[44:47], a[32:35]
    v_exp_f32 v17, v113
    v_mfma_f32_16x16x32_bf16 a[80:83], v[164:167], v[40:43], a[80:83]
    v_cvt_pk_bf16_f32 v81, v18, v19
    v_mul_f32_e64 v50, -v50, v48
    v_mfma_f32_16x16x32_bf16 a[80:83], v[180:183], v[44:47], a[80:83]
    v_exp_f32 v18, v114
    v_mfma_f32_16x16x32_bf16 a[128:131], v[168:171], v[40:43], a[128:131]
    ds_read_b128 v[36:39], v1 offset:22528
    v_add_f32 v5, v5, v16
    v_mfma_f32_16x16x32_bf16 a[128:131], v[184:187], v[44:47], a[128:131]
    v_add_f32 v5, v5, v17
    v_mul_f32_e64 v51, -v51, v49
    v_mfma_f32_16x16x32_bf16 a[176:179], v[172:175], v[40:43], a[176:179]
    v_exp_f32 v19, v115
    v_mfma_f32_16x16x32_bf16 a[176:179], v[188:191], v[44:47], a[176:179]
    s_waitcnt lgkmcnt(2)
    v_cvt_pk_bf16_f32 v82, v16, v17
    v_add_u32 v2, s3, v2
    v_mfma_f32_16x16x32_bf16 a[36:39], v[160:163], v[24:27], a[36:39]
    ds_read_b128 v[40:43], v1 offset:11264
    v_cvt_f32_i32 v242, v242
    v_mfma_f32_16x16x32_bf16 a[36:39], v[176:179], v[28:31], a[36:39]
    v_exp_f32 v16, v84
    v_mfma_f32_16x16x32_bf16 a[84:87], v[164:167], v[24:27], a[84:87]
    v_add_f32 v5, v5, v18
    v_add_f32 v5, v5, v19
    v_mfma_f32_16x16x32_bf16 a[84:87], v[180:183], v[28:31], a[84:87]
    s_add_u32 s27, s27, 24576
    v_exp_f32 v17, v85
    v_mfma_f32_16x16x32_bf16 a[132:135], v[168:171], v[24:27], a[132:135]
    s_add_u32 s56, s56, 36864
    ds_read_b128 v[44:47], v1 offset:23552
    v_add_u32 v3, s3, v3
    v_mfma_f32_16x16x32_bf16 a[132:135], v[184:187], v[28:31], a[132:135]
    s_sub_u32 s58, s56, 147456
    v_cvt_pk_bf16_f32 v83, v18, v19
    v_cvt_f32_i32 v243, v243
    v_mfma_f32_16x16x32_bf16 a[180:183], v[172:175], v[24:27], a[180:183]
    v_exp_f32 v18, v86
    v_mfma_f32_16x16x32_bf16 a[180:183], v[188:191], v[28:31], a[180:183]
    s_waitcnt lgkmcnt(2)
    v_add_f32 v6, v6, v16
    v_fma_f32 v242, v242, v48, v50
    v_mfma_f32_16x16x32_bf16 a[40:43], v[160:163], v[32:35], a[40:43]
    s_min_u32 s56, s56, s58
    ds_read_b128 v[24:27], v2 offset:0
    v_add_f32 v6, v6, v17
    v_mfma_f32_16x16x32_bf16 a[40:43], v[176:179], v[36:39], a[40:43]
    v_exp_f32 v19, v87
    v_mfma_f32_16x16x32_bf16 a[88:91], v[164:167], v[32:35], a[88:91]
    v_fma_f32 v243, v243, v49, v51
    v_cvt_pk_bf16_f32 v84, v16, v17
    v_mfma_f32_16x16x32_bf16 a[88:91], v[180:183], v[36:39], a[88:91]
    v_exp_f32 v16, v116
    v_mfma_f32_16x16x32_bf16 a[136:139], v[168:171], v[32:35], a[136:139]
    ds_read_b128 v[28:31], v3 offset:0
    v_cvt_pk_bf16_f32 v227, v242, v243
    v_mfma_f32_16x16x32_bf16 a[136:139], v[184:187], v[36:39], a[136:139]
    v_add_f32 v6, v6, v18
    v_add_f32 v6, v6, v19
    v_mfma_f32_16x16x32_bf16 a[184:187], v[172:175], v[32:35], a[184:187]
    v_cvt_f32_i32 v246, v246
    v_cvt_f32_i32 v247, v247
    v_mfma_f32_16x16x32_bf16 a[184:187], v[188:191], v[36:39], a[184:187]
    s_waitcnt lgkmcnt(2)
    v_exp_f32 v17, v117
    v_mfma_f32_16x16x32_bf16 a[44:47], v[160:163], v[40:43], a[44:47]
    ds_read_b128 v[32:35], v2 offset:6144
    v_cvt_pk_bf16_f32 v85, v18, v19
    v_mfma_f32_16x16x32_bf16 a[44:47], v[176:179], v[44:47], a[44:47]
    v_exp_f32 v18, v118
    v_mfma_f32_16x16x32_bf16 a[92:95], v[164:167], v[40:43], a[92:95]
    v_fma_f32 v246, v246, v48, v50
    v_add_f32 v6, v6, v16
    v_mfma_f32_16x16x32_bf16 a[92:95], v[180:183], v[44:47], a[92:95]
    v_add_f32 v6, v6, v17
    v_fma_f32 v247, v247, v49, v51
    v_mfma_f32_16x16x32_bf16 a[140:143], v[168:171], v[40:43], a[140:143]
    s_sub_u32 s31, s31, 1
    ds_read_b128 v[36:39], v3 offset:6144
    v_cvt_pk_bf16_f32 v231, v246, v247
    v_mfma_f32_16x16x32_bf16 a[140:143], v[184:187], v[44:47], a[140:143]
    v_exp_f32 v19, v119
    v_mfma_f32_16x16x32_bf16 a[188:191], v[172:175], v[40:43], a[188:191]
    s_waitcnt lgkmcnt(2)
    s_cmp_lg_u32 s31, 0
    v_cvt_pk_bf16_f32 v86, v16, v17
    v_add_f32 v6, v6, v18
    v_add_f32 v6, v6, v19
    v_cvt_f32_i32 v250, v250
    v_cvt_pk_bf16_f32 v87, v18, v19
    v_cvt_f32_i32 v251, v251
    v_mfma_f32_16x16x32_bf16 a[188:191], v[188:191], v[44:47], a[188:191]
    s_cbranch_scc1 L_loop
    v_mfma_f32_16x16x32_bf16 v[160:163], v[24:27], a[192:195], v[128:131]
    ds_read_b128 v[40:43], v2 offset:128
    v_mfma_f32_16x16x32_bf16 v[160:163], v[28:31], a[196:199], v[160:163]
    v_exp_f32 v16, v88
    v_mfma_f32_16x16x32_bf16 v[164:167], v[24:27], a[216:219], v[132:135]
    ds_read_b128 v[44:47], v3 offset:128
    v_mfma_f32_16x16x32_bf16 v[164:167], v[28:31], a[220:223], v[164:167]
    s_waitcnt lgkmcnt(2)
    v_exp_f32 v17, v89
    v_mfma_f32_16x16x32_bf16 v[96:99], v[32:35], a[192:195], v[128:131]
    ds_read_b128 v[24:27], v2 offset:6272
    v_mfma_f32_16x16x32_bf16 v[96:99], v[36:39], a[196:199], v[96:99]
    s_waitcnt vmcnt(6)
    v_exp_f32 v18, v90
    v_mfma_f32_16x16x32_bf16 v[100:103], v[32:35], a[216:219], v[132:135]
    ds_read_b128 v[28:31], v3 offset:6272
    v_add_f32 v7, v7, v16
    v_mfma_f32_16x16x32_bf16 v[100:103], v[36:39], a[220:223], v[100:103]
    s_waitcnt lgkmcnt(2)
    s_barrier
    v_mfma_f32_16x16x32_bf16 v[160:163], v[40:43], a[200:203], v[160:163]
    s_mov_b32 m0, s26
    ds_read_b128 v[32:35], v2 offset:256
    v_add_f32 v7, v7, v17
    v_mfma_f32_16x16x32_bf16 v[160:163], v[44:47], a[204:207], v[160:163]
    buffer_load_dwordx4 v4, s[4:7], s32 offen offset:0 sc1 lds
    v_mfma_f32_16x16x32_bf16 v[164:167], v[40:43], a[224:227], v[164:167]
    ds_read_b128 v[36:39], v3 offset:256
    v_mfma_f32_16x16x32_bf16 v[164:167], v[44:47], a[228:231], v[164:167]
    s_waitcnt lgkmcnt(2)
    v_exp_f32 v19, v91
    v_mfma_f32_16x16x32_bf16 v[96:99], v[24:27], a[200:203], v[96:99]
    ds_read_b128 v[40:43], v2 offset:6400
    v_cvt_pk_bf16_f32 v88, v16, v17
    v_mfma_f32_16x16x32_bf16 v[96:99], v[28:31], a[204:207], v[96:99]
    v_exp_f32 v16, v120
    v_mfma_f32_16x16x32_bf16 v[100:103], v[24:27], a[224:227], v[100:103]
    ds_read_b128 v[44:47], v3 offset:6400
    v_add_f32 v7, v7, v18
    v_mfma_f32_16x16x32_bf16 v[100:103], v[28:31], a[228:231], v[100:103]
    s_waitcnt lgkmcnt(2)
    buffer_load_dwordx4 v4, s[4:7], s32 offen offset:1024 sc1 lds
    v_mfma_f32_16x16x32_bf16 v[160:163], v[32:35], a[208:211], v[160:163]
    ds_read_b128 v[24:27], v2 offset:12288
    v_add_f32 v7, v7, v19
    v_mfma_f32_16x16x32_bf16 v[160:163], v[36:39], a[212:215], v[160:163]
    v_exp_f32 v17, v121
    v_mfma_f32_16x16x32_bf16 v[164:167], v[32:35], a[232:235], v[164:167]
    ds_read_b128 v[28:31], v3 offset:12288
    v_cvt_pk_bf16_f32 v89, v18, v19
    v_mfma_f32_16x16x32_bf16 v[164:167], v[36:39], a[236:239], v[164:167]
    s_waitcnt lgkmcnt(2)
    v_exp_f32 v18, v122
    v_mfma_f32_16x16x32_bf16 v[96:99], v[40:43], a[208:211], v[96:99]
    ds_read_b128 v[32:35], v2 offset:18432
    v_add_f32 v7, v7, v16
    v_mfma_f32_16x16x32_bf16 v[96:99], v[44:47], a[212:215], v[96:99]
    buffer_load_dwordx4 v4, s[4:7], s32 offen offset:2048 sc1 lds
    v_mfma_f32_16x16x32_bf16 v[100:103], v[40:43], a[232:235], v[100:103]
    ds_read_b128 v[36:39], v3 offset:18432
    v_add_f32 v7, v7, v17
    v_mfma_f32_16x16x32_bf16 v[100:103], v[44:47], a[236:239], v[100:103]
    s_waitcnt lgkmcnt(2)
    v_exp_f32 v19, v123
    v_mfma_f32_16x16x32_bf16 v[168:171], v[24:27], a[192:195], v[128:131]
    ds_read_b128 v[40:43], v2 offset:12416
    v_cvt_pk_bf16_f32 v90, v16, v17
    v_mfma_f32_16x16x32_bf16 v[168:171], v[28:31], a[196:199], v[168:171]
    v_exp_f32 v16, v92
    v_mfma_f32_16x16x32_bf16 v[172:175], v[24:27], a[216:219], v[132:135]
    s_add_u32 s32, s32, 24576
    ds_read_b128 v[44:47], v3 offset:12416
    v_add_f32 v7, v7, v18
    v_mfma_f32_16x16x32_bf16 v[172:175], v[28:31], a[220:223], v[172:175]
    s_waitcnt lgkmcnt(2)
    v_add_f32 v7, v7, v19
    v_mfma_f32_16x16x32_bf16 v[104:107], v[32:35], a[192:195], v[128:131]
    ds_read_b128 v[24:27], v2 offset:18560
    v_mfma_f32_16x16x32_bf16 v[104:107], v[36:39], a[196:199], v[104:107]
    s_add_u32 s26, s26, 12288
    v_exp_f32 v17, v93
    v_mfma_f32_16x16x32_bf16 v[108:111], v[32:35], a[216:219], v[132:135]
    s_add_u32 s29, s30, 49152
    ds_read_b128 v[28:31], v3 offset:18560
    v_cvt_pk_bf16_f32 v91, v18, v19
    v_mfma_f32_16x16x32_bf16 v[108:111], v[36:39], a[220:223], v[108:111]
    s_waitcnt lgkmcnt(2)
    v_exp_f32 v18, v94
    v_mfma_f32_16x16x32_bf16 v[168:171], v[40:43], a[200:203], v[168:171]
    s_sub_u32 s3, s29, 147456
    ds_read_b128 v[32:35], v2 offset:12544
    v_add_f32 v8, v8, v16
    v_mfma_f32_16x16x32_bf16 v[168:171], v[44:47], a[204:207], v[168:171]
    s_mov_b32 m0, s26
    v_add_f32 v8, v8, v17
    s_min_u32 s29, s29, s3
    v_mfma_f32_16x16x32_bf16 v[172:175], v[40:43], a[224:227], v[172:175]
    ds_read_b128 v[36:39], v3 offset:12544
    v_mfma_f32_16x16x32_bf16 v[172:175], v[44:47], a[228:231], v[172:175]
    s_waitcnt lgkmcnt(2)
    v_exp_f32 v19, v95
    v_mfma_f32_16x16x32_bf16 v[104:107], v[24:27], a[200:203], v[104:107]
    ds_read_b128 v[40:43], v2 offset:18688
    v_cvt_pk_bf16_f32 v92, v16, v17
    v_mfma_f32_16x16x32_bf16 v[104:107], v[28:31], a[204:207], v[104:107]
    buffer_load_dwordx4 v4, s[4:7], s32 offen offset:0 sc1 lds
    v_mfma_f32_16x16x32_bf16 v[108:111], v[24:27], a[224:227], v[108:111]
    ds_read_b128 v[44:47], v3 offset:18688
    v_mfma_f32_16x16x32_bf16 v[108:111], v[28:31], a[228:231], v[108:111]
    s_waitcnt lgkmcnt(2)
    v_subrev_u32 v2, 98304, v2
    v_subrev_u32 v3, 98304, v3
    v_mfma_f32_16x16x32_bf16 v[168:171], v[32:35], a[208:211], v[168:171]
    ds_read_b128 v[24:27], v2 offset:0
    v_mfma_f32_16x16x32_bf16 v[168:171], v[36:39], a[212:215], v[168:171]
    v_exp_f32 v16, v124
    v_add_f32 v8, v8, v18
    v_mfma_f32_16x16x32_bf16 v[172:175], v[32:35], a[232:235], v[172:175]
    s_sub_u32 s3, s29, s30
    ds_read_b128 v[28:31], v3 offset:0
    v_add_f32 v8, v8, v19
    v_mfma_f32_16x16x32_bf16 v[172:175], v[36:39], a[236:239], v[172:175]
    s_waitcnt lgkmcnt(2)
    v_exp_f32 v17, v125
    v_cvt_pk_bf16_f32 v93, v18, v19
    v_mfma_f32_16x16x32_bf16 v[104:107], v[40:43], a[208:211], v[104:107]
    ds_read_b128 v[32:35], v2 offset:6144
    v_mfma_f32_16x16x32_bf16 v[104:107], v[44:47], a[212:215], v[104:107]
    buffer_load_dwordx4 v4, s[4:7], s32 offen offset:1024 sc1 lds
    v_mfma_f32_16x16x32_bf16 v[108:111], v[40:43], a[232:235], v[108:111]
    ds_read_b128 v[36:39], v3 offset:6144
    v_mfma_f32_16x16x32_bf16 v[108:111], v[44:47], a[236:239], v[108:111]
    s_waitcnt lgkmcnt(2)
    v_exp_f32 v18, v126
    v_add_f32 v8, v8, v16
    v_mfma_f32_16x16x32_bf16 v[176:179], v[24:27], a[192:195], v[128:131]
    ds_read_b128 v[40:43], v2 offset:128
    v_add_f32 v8, v8, v17
    v_mfma_f32_16x16x32_bf16 v[176:179], v[28:31], a[196:199], v[176:179]
    v_exp_f32 v19, v127
    v_cvt_pk_bf16_f32 v94, v16, v17
    v_mfma_f32_16x16x32_bf16 v[180:183], v[24:27], a[216:219], v[132:135]
    ds_read_b128 v[44:47], v3 offset:128
    v_add_f32 v8, v8, v18
    v_add_f32 v8, v8, v19
    v_cvt_pk_bf16_f32 v95, v18, v19
    v_mfma_f32_16x16x32_bf16 v[180:183], v[28:31], a[220:223], v[180:183]
    s_waitcnt lgkmcnt(2)
    buffer_load_dwordx4 v4, s[4:7], s32 offen offset:2048 sc1 lds
    v_mfma_f32_16x16x32_bf16 v[112:115], v[32:35], a[192:195], v[128:131]
    s_mov_b32 s30, s29
    ds_read_b128 v[24:27], v2 offset:6272
    v_mfma_f32_16x16x32_bf16 v[112:115], v[36:39], a[196:199], v[112:115]
    v_exp_f32 v16, v160
    v_mfma_f32_16x16x32_bf16 v[116:119], v[32:35], a[216:219], v[132:135]
    ds_read_b128 v[28:31], v3 offset:6272
    v_mfma_f32_16x16x32_bf16 v[116:119], v[36:39], a[220:223], v[116:119]
    s_waitcnt lgkmcnt(2)
    v_exp_f32 v17, v161
    v_mfma_f32_16x16x32_bf16 v[176:179], v[40:43], a[200:203], v[176:179]
    ds_read_b128 v[32:35], v2 offset:256
    v_mfma_f32_16x16x32_bf16 v[176:179], v[44:47], a[204:207], v[176:179]
    v_exp_f32 v18, v162
    v_mfma_f32_16x16x32_bf16 v[180:183], v[40:43], a[224:227], v[180:183]
    ds_read_b128 v[36:39], v3 offset:256
    v_add_f32 v5, v5, v16
    v_mfma_f32_16x16x32_bf16 v[180:183], v[44:47], a[228:231], v[180:183]
    s_waitcnt lgkmcnt(2)
    v_add_f32 v5, v5, v17
    v_add_u32 v1, s3, v1
    v_mfma_f32_16x16x32_bf16 v[112:115], v[24:27], a[200:203], v[112:115]
    ds_read_b128 v[40:43], v2 offset:6400
    v_mfma_f32_16x16x32_bf16 v[112:115], v[28:31], a[204:207], v[112:115]
    v_exp_f32 v19, v163
    v_cvt_pk_bf16_f32 v160, v16, v17
    v_mfma_f32_16x16x32_bf16 v[116:119], v[24:27], a[224:227], v[116:119]
    s_add_u32 s32, s32, 24576
    ds_read_b128 v[44:47], v3 offset:6400
    s_add_u32 s26, s26, 36864
    v_mfma_f32_16x16x32_bf16 v[116:119], v[28:31], a[228:231], v[116:119]
    s_waitcnt lgkmcnt(2)
    v_exp_f32 v16, v96
    v_mfma_f32_16x16x32_bf16 v[176:179], v[32:35], a[208:211], v[176:179]
    s_sub_u32 s57, s26, 147456
    ds_read_b128 v[24:27], v2 offset:12288
    v_add_f32 v5, v5, v18
    v_mfma_f32_16x16x32_bf16 v[176:179], v[36:39], a[212:215], v[176:179]
    s_min_u32 s26, s26, s57
    v_add_f32 v5, v5, v19
    v_mfma_f32_16x16x32_bf16 v[180:183], v[32:35], a[232:235], v[180:183]
    ds_read_b128 v[28:31], v3 offset:12288
    v_mfma_f32_16x16x32_bf16 v[180:183], v[36:39], a[236:239], v[180:183]
    s_waitcnt lgkmcnt(2)
    v_exp_f32 v17, v97
    v_cvt_pk_bf16_f32 v161, v18, v19
    v_mfma_f32_16x16x32_bf16 v[112:115], v[40:43], a[208:211], v[112:115]
    ds_read_b128 v[32:35], v2 offset:18432
    v_mfma_f32_16x16x32_bf16 v[112:115], v[44:47], a[212:215], v[112:115]
    v_exp_f32 v18, v98
    v_mfma_f32_16x16x32_bf16 v[116:119], v[40:43], a[232:235], v[116:119]
    ds_read_b128 v[36:39], v3 offset:18432
    v_add_f32 v5, v5, v16
    v_mfma_f32_16x16x32_bf16 v[116:119], v[44:47], a[236:239], v[116:119]
    s_waitcnt lgkmcnt(2)
    v_add_f32 v5, v5, v17
    v_mfma_f32_16x16x32_bf16 v[184:187], v[24:27], a[192:195], v[128:131]
    ds_read_b128 v[40:43], v2 offset:12416
    v_mfma_f32_16x16x32_bf16 v[184:187], v[28:31], a[196:199], v[184:187]
    v_exp_f32 v19, v99
    v_cvt_pk_bf16_f32 v162, v16, v17
    v_mfma_f32_16x16x32_bf16 v[188:191], v[24:27], a[216:219], v[132:135]
    ds_read_b128 v[44:47], v3 offset:12416
    v_mfma_f32_16x16x32_bf16 v[188:191], v[28:31], a[220:223], v[188:191]
    s_waitcnt lgkmcnt(2)
    v_exp_f32 v16, v164
    v_mfma_f32_16x16x32_bf16 v[120:123], v[32:35], a[192:195], v[128:131]
    ds_read_b128 v[24:27], v2 offset:18560
    v_add_f32 v5, v5, v18
    v_mfma_f32_16x16x32_bf16 v[120:123], v[36:39], a[196:199], v[120:123]
    s_waitcnt vmcnt(6)
    v_add_f32 v5, v5, v19
    v_mfma_f32_16x16x32_bf16 v[124:127], v[32:35], a[216:219], v[132:135]
    ds_read_b128 v[28:31], v3 offset:18560
    v_mfma_f32_16x16x32_bf16 v[124:127], v[36:39], a[220:223], v[124:127]
    s_waitcnt lgkmcnt(2)
    s_barrier
    v_mfma_f32_16x16x32_bf16 v[184:187], v[40:43], a[200:203], v[184:187]
    ds_read_b128 v[32:35], v2 offset:12544
    v_mfma_f32_16x16x32_bf16 v[184:187], v[44:47], a[204:207], v[184:187]
    v_exp_f32 v17, v165
    v_cvt_pk_bf16_f32 v163, v18, v19
    v_mfma_f32_16x16x32_bf16 v[188:191], v[40:43], a[224:227], v[188:191]
    ds_read_b128 v[36:39], v3 offset:12544
    v_mfma_f32_16x16x32_bf16 v[188:191], v[44:47], a[228:231], v[188:191]
    s_waitcnt lgkmcnt(2)
    v_exp_f32 v18, v166
    v_add_f32 v6, v6, v16
    v_mfma_f32_16x16x32_bf16 v[120:123], v[24:27], a[200:203], v[120:123]
    ds_read_b128 v[40:43], v2 offset:18688
    v_add_f32 v6, v6, v17
    v_mfma_f32_16x16x32_bf16 v[120:123], v[28:31], a[204:207], v[120:123]
    v_exp_f32 v19, v167
    v_cvt_pk_bf16_f32 v164, v16, v17
    v_mfma_f32_16x16x32_bf16 v[124:127], v[24:27], a[224:227], v[124:127]
    ds_read_b128 v[44:47], v3 offset:18688
    v_mfma_f32_16x16x32_bf16 v[124:127], v[28:31], a[228:231], v[124:127]
    s_waitcnt lgkmcnt(2)
    v_exp_f32 v16, v100
    v_mfma_f32_16x16x32_bf16 v[184:187], v[32:35], a[208:211], v[184:187]
    ds_read_b128 v[24:27], v1 offset:0
    v_add_f32 v6, v6, v18
    v_mfma_f32_16x16x32_bf16 v[184:187], v[36:39], a[212:215], v[184:187]
    v_add_f32 v6, v6, v19
    v_mfma_f32_16x16x32_bf16 v[188:191], v[32:35], a[232:235], v[188:191]
    ds_read_b128 v[28:31], v1 offset:12288
    v_mfma_f32_16x16x32_bf16 v[188:191], v[36:39], a[236:239], v[188:191]
    s_waitcnt lgkmcnt(2)
    v_exp_f32 v17, v101
    v_cvt_pk_bf16_f32 v165, v18, v19
    v_mfma_f32_16x16x32_bf16 v[120:123], v[40:43], a[208:211], v[120:123]
    ds_read_b128 v[32:35], v1 offset:1024
    v_mfma_f32_16x16x32_bf16 v[120:123], v[44:47], a[212:215], v[120:123]
    v_exp_f32 v18, v102
    v_mfma_f32_16x16x32_bf16 v[124:127], v[40:43], a[232:235], v[124:127]
    ds_read_b128 v[36:39], v1 offset:13312
    v_add_f32 v6, v6, v16
    v_mfma_f32_16x16x32_bf16 v[124:127], v[44:47], a[236:239], v[124:127]
    s_waitcnt lgkmcnt(2)
    v_add_f32 v6, v6, v17
    v_exp_f32 v19, v103
    v_cvt_pk_bf16_f32 v166, v16, v17
    v_add_f32 v6, v6, v18
    v_add_f32 v6, v6, v19
    v_cvt_pk_bf16_f32 v167, v18, v19
    v_mfma_f32_16x16x32_bf16 a[0:3], v[64:67], v[24:27], a[0:3]
    s_mov_b32 m0, s56
    ds_read_b128 v[40:43], v1 offset:2048
    v_bfe_u32 v57, v4, 8, 2
    v_mfma_f32_16x16x32_bf16 a[0:3], v[80:83], v[28:31], a[0:3]
    buffer_load_dwordx4 v4, s[4:7], s27 offen offset:0 sc1 lds
    v_mfma_f32_16x16x32_bf16 a[48:51], v[68:71], v[24:27], a[48:51]
    v_exp_f32 v16, v168
    v_mfma_f32_16x16x32_bf16 a[48:51], v[84:87], v[28:31], a[48:51]
    v_exp_f32 v17, v169
    v_mfma_f32_16x16x32_bf16 a[96:99], v[72:75], v[24:27], a[96:99]
    ds_read_b128 v[44:47], v1 offset:14336
    v_mul_u32_u24 v56, 1536, v57
    v_mfma_f32_16x16x32_bf16 a[96:99], v[88:91], v[28:31], a[96:99]
    buffer_load_dwordx4 v4, s[4:7], s27 offen offset:1024 sc1 lds
    v_mfma_f32_16x16x32_bf16 a[144:147], v[76:79], v[24:27], a[144:147]
    v_exp_f32 v18, v170
    v_mfma_f32_16x16x32_bf16 a[144:147], v[92:95], v[28:31], a[144:147]
    s_waitcnt lgkmcnt(2)
    v_add_f32 v5, v5, v16
    v_add_f32 v5, v5, v17
    v_mfma_f32_16x16x32_bf16 a[4:7], v[64:67], v[32:35], a[4:7]
    ds_read_b128 v[24:27], v1 offset:3072
    v_lshlrev_b32 v58, 4, v57
    v_mfma_f32_16x16x32_bf16 a[4:7], v[80:83], v[36:39], a[4:7]
    buffer_load_dwordx4 v4, s[4:7], s27 offen offset:2048 sc1 lds
    v_mfma_f32_16x16x32_bf16 a[52:55], v[68:71], v[32:35], a[52:55]
    v_exp_f32 v19, v171
    v_mfma_f32_16x16x32_bf16 a[52:55], v[84:87], v[36:39], a[52:55]
    s_add_u32 s27, s27, 24576
    v_cvt_pk_bf16_f32 v168, v16, v17
    v_bfe_u32 v57, v4, 4, 4
    v_mfma_f32_16x16x32_bf16 a[100:103], v[72:75], v[32:35], a[100:103]
    ds_read_b128 v[28:31], v1 offset:15360
    v_mfma_f32_16x16x32_bf16 a[100:103], v[88:91], v[36:39], a[100:103]
    s_add_u32 s56, s56, 12288
    v_exp_f32 v16, v104
    v_mfma_f32_16x16x32_bf16 a[148:151], v[76:79], v[32:35], a[148:151]
    v_add_f32 v5, v5, v18
    v_add_f32 v5, v5, v19
    v_mfma_f32_16x16x32_bf16 a[148:151], v[92:95], v[36:39], a[148:151]
    s_waitcnt lgkmcnt(2)
    v_exp_f32 v17, v105
    v_mfma_f32_16x16x32_bf16 a[8:11], v[64:67], v[40:43], a[8:11]
    s_mov_b32 m0, s56
    ds_read_b128 v[32:35], v1 offset:4096
    v_cvt_pk_bf16_f32 v169, v18, v19
    v_mfma_f32_16x16x32_bf16 a[8:11], v[80:83], v[44:47], a[8:11]
    v_exp_f32 v18, v106
    v_mfma_f32_16x16x32_bf16 a[56:59], v[68:71], v[40:43], a[56:59]
    v_add_f32 v5, v5, v16
    v_add_f32 v5, v5, v17
    v_mfma_f32_16x16x32_bf16 a[56:59], v[84:87], v[44:47], a[56:59]
    buffer_load_dwordx4 v4, s[4:7], s27 offen offset:0 sc1 lds
    v_mfma_f32_16x16x32_bf16 a[104:107], v[72:75], v[40:43], a[104:107]
    ds_read_b128 v[36:39], v1 offset:16384
    v_lshl_add_u32 v56, v57, 3, v56
    v_mfma_f32_16x16x32_bf16 a[104:107], v[88:91], v[44:47], a[104:107]
    v_exp_f32 v19, v107
    v_mfma_f32_16x16x32_bf16 a[152:155], v[76:79], v[40:43], a[152:155]
    v_cvt_pk_bf16_f32 v170, v16, v17
    v_mfma_f32_16x16x32_bf16 a[152:155], v[92:95], v[44:47], a[152:155]
    s_waitcnt lgkmcnt(2)
    buffer_load_dwordx4 v4, s[4:7], s27 offen offset:1024 sc1 lds
    v_mfma_f32_16x16x32_bf16 a[12:15], v[64:67], v[24:27], a[12:15]
    ds_read_b128 v[40:43], v1 offset:5120
    v_mfma_f32_16x16x32_bf16 a[12:15], v[80:83], v[28:31], a[12:15]
    v_exp_f32 v16, v172
    v_mfma_f32_16x16x32_bf16 a[60:63], v[68:71], v[24:27], a[60:63]
    v_add_f32 v5, v5, v18
    v_add_f32 v5, v5, v19
    v_mfma_f32_16x16x32_bf16 a[60:63], v[84:87], v[28:31], a[60:63]
    buffer_load_dwordx4 v4, s[4:7], s27 offen offset:2048 sc1 lds
    v_mfma_f32_16x16x32_bf16 a[108:111], v[72:75], v[24:27], a[108:111]
    ds_read_b128 v[44:47], v1 offset:17408
    v_mov_b32 v57, 1.0
    v_mfma_f32_16x16x32_bf16 a[108:111], v[88:91], v[28:31], a[108:111]
    v_exp_f32 v17, v173
    v_mfma_f32_16x16x32_bf16 a[156:159], v[76:79], v[24:27], a[156:159]
    s_add_u32 s27, s27, 24576
    v_cvt_pk_bf16_f32 v171, v18, v19
    v_mfma_f32_16x16x32_bf16 a[156:159], v[92:95], v[28:31], a[156:159]
    s_waitcnt lgkmcnt(2)
    v_exp_f32 v18, v174
    v_mfma_f32_16x16x32_bf16 a[16:19], v[64:67], v[32:35], a[16:19]
    s_add_u32 s56, s56, 36864
    ds_read_b128 v[24:27], v1 offset:6144
    v_add_f32 v6, v6, v16
    v_mfma_f32_16x16x32_bf16 a[16:19], v[80:83], v[36:39], a[16:19]
    v_add_f32 v6, v6, v17
    v_mfma_f32_16x16x32_bf16 a[64:67], v[68:71], v[32:35], a[64:67]
    s_sub_u32 s58, s56, 147456
    v_exp_f32 v19, v175
    v_mfma_f32_16x16x32_bf16 a[64:67], v[84:87], v[36:39], a[64:67]
    s_lshl_b32 s24, s95, 2
    v_cvt_pk_bf16_f32 v172, v16, v17
    v_mfma_f32_16x16x32_bf16 a[112:115], v[72:75], v[32:35], a[112:115]
    s_min_u32 s56, s56, s58
    ds_read_b128 v[28:31], v1 offset:18432
    v_mfma_f32_16x16x32_bf16 a[112:115], v[88:91], v[36:39], a[112:115]
    v_exp_f32 v16, v108
    v_mfma_f32_16x16x32_bf16 a[160:163], v[76:79], v[32:35], a[160:163]
    s_mov_b32 m0, s56
    v_add_f32 v6, v6, v18
    v_add_f32 v6, v6, v19
    v_mfma_f32_16x16x32_bf16 a[160:163], v[92:95], v[36:39], a[160:163]
    s_waitcnt lgkmcnt(2)
    v_exp_f32 v17, v109
    v_mfma_f32_16x16x32_bf16 a[20:23], v[64:67], v[40:43], a[20:23]
    ds_read_b128 v[32:35], v1 offset:7168
    v_cvt_pk_bf16_f32 v173, v18, v19
    v_mfma_f32_16x16x32_bf16 a[20:23], v[80:83], v[44:47], a[20:23]
    buffer_load_dwordx4 v4, s[4:7], s27 offen offset:0 sc1 lds
    v_mfma_f32_16x16x32_bf16 a[68:71], v[68:71], v[40:43], a[68:71]
    v_exp_f32 v18, v110
    v_mfma_f32_16x16x32_bf16 a[68:71], v[84:87], v[44:47], a[68:71]
    s_add_u32 s24, s24, s25
    v_add_f32 v6, v6, v16
    v_add_f32 v6, v6, v17
    v_mfma_f32_16x16x32_bf16 a[116:119], v[72:75], v[40:43], a[116:119]
    ds_read_b128 v[36:39], v1 offset:19456
    v_mfma_f32_16x16x32_bf16 a[116:119], v[88:91], v[44:47], a[116:119]
    buffer_load_dwordx4 v4, s[4:7], s27 offen offset:1024 sc1 lds
    v_mfma_f32_16x16x32_bf16 a[164:167], v[76:79], v[40:43], a[164:167]
    v_exp_f32 v19, v111
    v_mfma_f32_16x16x32_bf16 a[164:167], v[92:95], v[44:47], a[164:167]
    s_waitcnt lgkmcnt(2)
    v_cvt_pk_bf16_f32 v174, v16, v17
    v_add_f32 v6, v6, v18
    v_mfma_f32_16x16x32_bf16 a[24:27], v[64:67], v[24:27], a[24:27]
    ds_read_b128 v[40:43], v1 offset:8192
    v_add_f32 v6, v6, v19
    v_mfma_f32_16x16x32_bf16 a[24:27], v[80:83], v[28:31], a[24:27]
    buffer_load_dwordx4 v4, s[4:7], s27 offen offset:2048 sc1 lds
    v_mfma_f32_16x16x32_bf16 a[72:75], v[68:71], v[24:27], a[72:75]
    v_cvt_pk_bf16_f32 v175, v18, v19
    v_mfma_f32_16x16x32_bf16 a[72:75], v[84:87], v[28:31], a[72:75]
    s_mul_i32 s24, s24, 24576
    v_exp_f32 v16, v176
    v_mfma_f32_16x16x32_bf16 a[120:123], v[72:75], v[24:27], a[120:123]
    ds_read_b128 v[44:47], v1 offset:20480
    v_mfma_f32_16x16x32_bf16 a[120:123], v[88:91], v[28:31], a[120:123]
    s_add_u32 s27, s27, 24576
    v_exp_f32 v17, v177
    v_mfma_f32_16x16x32_bf16 a[168:171], v[76:79], v[24:27], a[168:171]
    v_exp_f32 v18, v178
    v_mfma_f32_16x16x32_bf16 a[168:171], v[92:95], v[28:31], a[168:171]
    s_waitcnt lgkmcnt(2)
    v_add_f32 v5, v5, v16
    v_add_f32 v5, v5, v17
    v_mfma_f32_16x16x32_bf16 a[28:31], v[64:67], v[32:35], a[28:31]
    s_add_u32 s56, s56, 12288
    ds_read_b128 v[24:27], v1 offset:9216
    v_mfma_f32_16x16x32_bf16 a[28:31], v[80:83], v[36:39], a[28:31]
    s_mov_b32 m0, s56
    v_exp_f32 v19, v179
    v_mfma_f32_16x16x32_bf16 a[76:79], v[68:71], v[32:35], a[76:79]
    v_cvt_pk_bf16_f32 v176, v16, v17
    v_mfma_f32_16x16x32_bf16 a[76:79], v[84:87], v[36:39], a[76:79]
    s_add_u32 s40, s24, 6144
    v_exp_f32 v16, v112
    v_mfma_f32_16x16x32_bf16 a[124:127], v[72:75], v[32:35], a[124:127]
    ds_read_b128 v[28:31], v1 offset:21504
    v_add_f32 v5, v5, v18
    v_mfma_f32_16x16x32_bf16 a[124:127], v[88:91], v[36:39], a[124:127]
    buffer_load_dwordx4 v4, s[4:7], s27 offen offset:0 sc1 lds
    v_mfma_f32_16x16x32_bf16 a[172:175], v[76:79], v[32:35], a[172:175]
    v_add_f32 v5, v5, v19
    v_mfma_f32_16x16x32_bf16 a[172:175], v[92:95], v[36:39], a[172:175]
    s_waitcnt lgkmcnt(2)
    v_exp_f32 v17, v113
    v_mfma_f32_16x16x32_bf16 a[32:35], v[64:67], v[40:43], a[32:35]
    ds_read_b128 v[32:35], v1 offset:10240
    v_cvt_pk_bf16_f32 v177, v18, v19
    v_mfma_f32_16x16x32_bf16 a[32:35], v[80:83], v[44:47], a[32:35]
    buffer_load_dwordx4 v4, s[4:7], s27 offen offset:1024 sc1 lds
    v_mfma_f32_16x16x32_bf16 a[80:83], v[68:71], v[40:43], a[80:83]
    v_exp_f32 v18, v114
    v_mfma_f32_16x16x32_bf16 a[80:83], v[84:87], v[44:47], a[80:83]
    s_add_u32 s41, s24, 12288
    v_add_f32 v5, v5, v16
    v_add_f32 v5, v5, v17
    v_mfma_f32_16x16x32_bf16 a[128:131], v[72:75], v[40:43], a[128:131]
    ds_read_b128 v[36:39], v1 offset:22528
    v_mfma_f32_16x16x32_bf16 a[128:131], v[88:91], v[44:47], a[128:131]
    buffer_load_dwordx4 v4, s[4:7], s27 offen offset:2048 sc1 lds
    v_mfma_f32_16x16x32_bf16 a[176:179], v[76:79], v[40:43], a[176:179]
    v_exp_f32 v19, v115
    v_mfma_f32_16x16x32_bf16 a[176:179], v[92:95], v[44:47], a[176:179]
    s_waitcnt lgkmcnt(2)
    v_cvt_pk_bf16_f32 v178, v16, v17
    v_mfma_f32_16x16x32_bf16 a[36:39], v[64:67], v[24:27], a[36:39]
    ds_read_b128 v[40:43], v1 offset:11264
    v_mfma_f32_16x16x32_bf16 a[36:39], v[80:83], v[28:31], a[36:39]
    v_exp_f32 v16, v180
    v_mfma_f32_16x16x32_bf16 a[84:87], v[68:71], v[24:27], a[84:87]
    v_add_f32 v5, v5, v18
    v_add_f32 v5, v5, v19
    v_mfma_f32_16x16x32_bf16 a[84:87], v[84:87], v[28:31], a[84:87]
    s_add_u32 s27, s27, 24576
    v_exp_f32 v17, v181
    v_mfma_f32_16x16x32_bf16 a[132:135], v[72:75], v[24:27], a[132:135]
    s_add_u32 s56, s56, 36864
    ds_read_b128 v[44:47], v1 offset:23552
    v_cvt_pk_bf16_f32 v179, v18, v19
    v_mfma_f32_16x16x32_bf16 a[132:135], v[88:91], v[28:31], a[132:135]
    s_waitcnt lgkmcnt(2)
    v_exp_f32 v18, v182
    v_mfma_f32_16x16x32_bf16 a[180:183], v[76:79], v[24:27], a[180:183]
    s_waitcnt vmcnt(12)
    v_add_f32 v6, v6, v16
    v_add_f32 v6, v6, v17
    v_mfma_f32_16x16x32_bf16 a[180:183], v[92:95], v[28:31], a[180:183]
    s_barrier
    v_add_u32 v2, 49152, v2
    v_add_u32 v3, 49152, v3
    v_mfma_f32_16x16x32_bf16 a[40:43], v[64:67], v[32:35], a[40:43]
    s_sub_u32 s58, s56, 147456
    ds_read_b128 v[24:27], v2 offset:0
    s_add_u32 s42, s24, 18432
    v_mfma_f32_16x16x32_bf16 a[40:43], v[80:83], v[36:39], a[40:43]
    s_min_u32 s56, s56, s58
    v_exp_f32 v19, v183
    v_mfma_f32_16x16x32_bf16 a[88:91], v[68:71], v[32:35], a[88:91]
    v_cvt_pk_bf16_f32 v180, v16, v17
    v_mfma_f32_16x16x32_bf16 a[88:91], v[84:87], v[36:39], a[88:91]
    v_exp_f32 v16, v116
    v_mfma_f32_16x16x32_bf16 a[136:139], v[72:75], v[32:35], a[136:139]
    ds_read_b128 v[28:31], v3 offset:0
    v_add_f32 v6, v6, v18
    v_mfma_f32_16x16x32_bf16 a[136:139], v[88:91], v[36:39], a[136:139]
    v_add_f32 v6, v6, v19
    v_mfma_f32_16x16x32_bf16 a[184:187], v[76:79], v[32:35], a[184:187]
    v_exp_f32 v17, v117
    v_mfma_f32_16x16x32_bf16 a[184:187], v[92:95], v[36:39], a[184:187]
    s_waitcnt lgkmcnt(2)
    v_cvt_pk_bf16_f32 v181, v18, v19
    v_mfma_f32_16x16x32_bf16 a[44:47], v[64:67], v[40:43], a[44:47]
    ds_read_b128 v[32:35], v2 offset:6144
    v_mfma_f32_16x16x32_bf16 a[44:47], v[80:83], v[44:47], a[44:47]
    v_exp_f32 v18, v118
    v_mfma_f32_16x16x32_bf16 a[92:95], v[68:71], v[40:43], a[92:95]
    v_add_f32 v6, v6, v16
    v_add_f32 v6, v6, v17
    v_mfma_f32_16x16x32_bf16 a[92:95], v[84:87], v[44:47], a[92:95]
    v_exp_f32 v19, v119
    v_mfma_f32_16x16x32_bf16 a[140:143], v[72:75], v[40:43], a[140:143]
    ds_read_b128 v[36:39], v3 offset:6144
    v_cvt_pk_bf16_f32 v182, v16, v17
    v_mfma_f32_16x16x32_bf16 a[140:143], v[88:91], v[44:47], a[140:143]
    v_add_f32 v6, v6, v18
    v_add_f32 v6, v6, v19
    v_mfma_f32_16x16x32_bf16 a[188:191], v[76:79], v[40:43], a[188:191]
    v_cvt_pk_bf16_f32 v183, v18, v19
    v_mfma_f32_16x16x32_bf16 a[188:191], v[92:95], v[44:47], a[188:191]
    s_waitcnt lgkmcnt(2)
    v_mfma_f32_16x16x32_bf16 v[64:67], v[24:27], a[192:195], v[128:131]
    ds_read_b128 v[40:43], v2 offset:128
    v_mfma_f32_16x16x32_bf16 v[64:67], v[28:31], a[196:199], v[64:67]
    v_exp_f32 v16, v184
    v_mfma_f32_16x16x32_bf16 v[68:71], v[24:27], a[216:219], v[132:135]
    ds_read_b128 v[44:47], v3 offset:128
    v_mfma_f32_16x16x32_bf16 v[68:71], v[28:31], a[220:223], v[68:71]
    s_waitcnt lgkmcnt(2)
    v_exp_f32 v17, v185
    v_mfma_f32_16x16x32_bf16 v[96:99], v[32:35], a[192:195], v[128:131]
    ds_read_b128 v[24:27], v2 offset:6272
    v_mfma_f32_16x16x32_bf16 v[96:99], v[36:39], a[196:199], v[96:99]
    v_exp_f32 v18, v186
    v_mfma_f32_16x16x32_bf16 v[100:103], v[32:35], a[216:219], v[132:135]
    ds_read_b128 v[28:31], v3 offset:6272
    v_add_f32 v5, v5, v16
    v_mfma_f32_16x16x32_bf16 v[100:103], v[36:39], a[220:223], v[100:103]
    s_waitcnt lgkmcnt(2)
    v_add_f32 v5, v5, v17
    v_mfma_f32_16x16x32_bf16 v[64:67], v[40:43], a[200:203], v[64:67]
    ds_read_b128 v[32:35], v2 offset:256
    v_mfma_f32_16x16x32_bf16 v[64:67], v[44:47], a[204:207], v[64:67]
    v_exp_f32 v19, v187
    v_mfma_f32_16x16x32_bf16 v[68:71], v[40:43], a[224:227], v[68:71]
    ds_read_b128 v[36:39], v3 offset:256
    v_cvt_pk_bf16_f32 v184, v16, v17
    v_mfma_f32_16x16x32_bf16 v[68:71], v[44:47], a[228:231], v[68:71]
    s_waitcnt lgkmcnt(2)
    v_exp_f32 v16, v120
    v_mfma_f32_16x16x32_bf16 v[96:99], v[24:27], a[200:203], v[96:99]
    ds_read_b128 v[40:43], v2 offset:6400
    v_add_f32 v5, v5, v18
    v_mfma_f32_16x16x32_bf16 v[96:99], v[28:31], a[204:207], v[96:99]
    s_waitcnt vmcnt(0)
    v_add_f32 v5, v5, v19
    v_mfma_f32_16x16x32_bf16 v[100:103], v[24:27], a[224:227], v[100:103]
    ds_read_b128 v[44:47], v3 offset:6400
    v_mfma_f32_16x16x32_bf16 v[100:103], v[28:31], a[228:231], v[100:103]
    s_waitcnt lgkmcnt(2)
    s_barrier
    v_mfma_f32_16x16x32_bf16 v[64:67], v[32:35], a[208:211], v[64:67]
    s_mov_b32 m0, s56
    ds_read_b128 v[24:27], v2 offset:12288
    v_mfma_f32_16x16x32_bf16 v[64:67], v[36:39], a[212:215], v[64:67]
    buffer_load_dwordx4 v4, s[4:7], s27 offen offset:0 sc1 lds
    v_mfma_f32_16x16x32_bf16 v[68:71], v[32:35], a[232:235], v[68:71]
    ds_read_b128 v[28:31], v3 offset:12288
    v_mfma_f32_16x16x32_bf16 v[68:71], v[36:39], a[236:239], v[68:71]
    s_waitcnt lgkmcnt(2)
    v_exp_f32 v17, v121
    v_cvt_pk_bf16_f32 v185, v18, v19
    v_mfma_f32_16x16x32_bf16 v[96:99], v[40:43], a[208:211], v[96:99]
    ds_read_b128 v[32:35], v2 offset:18432
    v_mfma_f32_16x16x32_bf16 v[96:99], v[44:47], a[212:215], v[96:99]
    buffer_load_dwordx4 v4, s[4:7], s27 offen offset:1024 sc1 lds
    v_mfma_f32_16x16x32_bf16 v[100:103], v[40:43], a[232:235], v[100:103]
    ds_read_b128 v[36:39], v3 offset:18432
    v_mfma_f32_16x16x32_bf16 v[100:103], v[44:47], a[236:239], v[100:103]
    s_waitcnt lgkmcnt(2)
    v_exp_f32 v18, v122
    v_add_f32 v5, v5, v16
    v_mfma_f32_16x16x32_bf16 v[72:75], v[24:27], a[192:195], v[128:131]
    ds_read_b128 v[40:43], v2 offset:12416
    v_add_f32 v5, v5, v17
    v_mfma_f32_16x16x32_bf16 v[72:75], v[28:31], a[196:199], v[72:75]
    v_exp_f32 v19, v123
    v_cvt_pk_bf16_f32 v186, v16, v17
    v_mfma_f32_16x16x32_bf16 v[76:79], v[24:27], a[216:219], v[132:135]
    ds_read_b128 v[44:47], v3 offset:12416
    v_mfma_f32_16x16x32_bf16 v[76:79], v[28:31], a[220:223], v[76:79]
    s_waitcnt lgkmcnt(2)
    buffer_load_dwordx4 v4, s[4:7], s27 offen offset:2048 sc1 lds
    v_mfma_f32_16x16x32_bf16 v[104:107], v[32:35], a[192:195], v[128:131]
    ds_read_b128 v[24:27], v2 offset:18560
    v_mfma_f32_16x16x32_bf16 v[104:107], v[36:39], a[196:199], v[104:107]
    v_exp_f32 v16, v188
    v_add_f32 v5, v5, v18
    v_mfma_f32_16x16x32_bf16 v[108:111], v[32:35], a[216:219], v[132:135]
    ds_read_b128 v[28:31], v3 offset:18560
    v_add_f32 v5, v5, v19
    v_mfma_f32_16x16x32_bf16 v[108:111], v[36:39], a[220:223], v[108:111]
    s_waitcnt lgkmcnt(2)
    v_exp_f32 v17, v189
    v_cvt_pk_bf16_f32 v187, v18, v19
    v_mfma_f32_16x16x32_bf16 v[72:75], v[40:43], a[200:203], v[72:75]
    s_add_u32 s27, s27, 24576
    ds_read_b128 v[32:35], v2 offset:12544
    v_mfma_f32_16x16x32_bf16 v[72:75], v[44:47], a[204:207], v[72:75]
    v_exp_f32 v18, v190
    v_mfma_f32_16x16x32_bf16 v[76:79], v[40:43], a[224:227], v[76:79]
    s_add_u32 s56, s56, 12288
    ds_read_b128 v[36:39], v3 offset:12544
    v_add_f32 v6, v6, v16
    v_mfma_f32_16x16x32_bf16 v[76:79], v[44:47], a[228:231], v[76:79]
    s_waitcnt lgkmcnt(2)
    v_add_f32 v6, v6, v17
    v_mfma_f32_16x16x32_bf16 v[104:107], v[24:27], a[200:203], v[104:107]
    ds_read_b128 v[40:43], v2 offset:18688
    v_mfma_f32_16x16x32_bf16 v[104:107], v[28:31], a[204:207], v[104:107]
    v_exp_f32 v19, v191
    v_cvt_pk_bf16_f32 v188, v16, v17
    v_mfma_f32_16x16x32_bf16 v[108:111], v[24:27], a[224:227], v[108:111]
    s_mov_b32 m0, s56
    ds_read_b128 v[44:47], v3 offset:18688
    v_mfma_f32_16x16x32_bf16 v[108:111], v[28:31], a[228:231], v[108:111]
    s_waitcnt lgkmcnt(2)
    v_add_u32 v2, 49152, v2
    v_add_u32 v3, 49152, v3
    v_mfma_f32_16x16x32_bf16 v[72:75], v[32:35], a[208:211], v[72:75]
    ds_read_b128 v[24:27], v2 offset:0
    v_mfma_f32_16x16x32_bf16 v[72:75], v[36:39], a[212:215], v[72:75]
    buffer_load_dwordx4 v4, s[4:7], s27 offen offset:0 sc1 lds
    v_mfma_f32_16x16x32_bf16 v[76:79], v[32:35], a[232:235], v[76:79]
    ds_read_b128 v[28:31], v3 offset:0
    v_mfma_f32_16x16x32_bf16 v[76:79], v[36:39], a[236:239], v[76:79]
    s_waitcnt lgkmcnt(2)
    v_exp_f32 v16, v124
    v_add_f32 v6, v6, v18
    v_mfma_f32_16x16x32_bf16 v[104:107], v[40:43], a[208:211], v[104:107]
    ds_read_b128 v[32:35], v2 offset:6144
    v_add_f32 v6, v6, v19
    v_mfma_f32_16x16x32_bf16 v[104:107], v[44:47], a[212:215], v[104:107]
    v_exp_f32 v17, v125
    v_cvt_pk_bf16_f32 v189, v18, v19
    v_mfma_f32_16x16x32_bf16 v[108:111], v[40:43], a[232:235], v[108:111]
    ds_read_b128 v[36:39], v3 offset:6144
    v_mfma_f32_16x16x32_bf16 v[108:111], v[44:47], a[236:239], v[108:111]
    s_waitcnt lgkmcnt(2)
    buffer_load_dwordx4 v4, s[4:7], s27 offen offset:1024 sc1 lds
    v_mfma_f32_16x16x32_bf16 v[80:83], v[24:27], a[240:243], v[136:139]
    ds_read_b128 v[40:43], v2 offset:128
    v_mfma_f32_16x16x32_bf16 v[80:83], v[28:31], a[244:247], v[80:83]
    v_exp_f32 v18, v126
    v_add_f32 v6, v6, v16
    v_mfma_f32_16x16x32_bf16 v[84:87], v[24:27], v[200:203], v[140:143]
    ds_read_b128 v[44:47], v3 offset:128
    v_add_f32 v6, v6, v17
    v_exp_f32 v19, v127
    v_cvt_pk_bf16_f32 v190, v16, v17
    v_add_f32 v6, v6, v18
    v_add_f32 v6, v6, v19
    v_cvt_pk_bf16_f32 v191, v18, v19
    v_mfma_f32_16x16x32_bf16 v[84:87], v[28:31], v[204:207], v[84:87]
    s_waitcnt lgkmcnt(2)
    v_exp_f32 v16, v64
    v_mfma_f32_16x16x32_bf16 v[112:115], v[32:35], a[240:243], v[136:139]
    ds_read_b128 v[24:27], v2 offset:6272
    v_mfma_f32_16x16x32_bf16 v[112:115], v[36:39], a[244:247], v[112:115]
    buffer_load_dwordx4 v4, s[4:7], s27 offen offset:2048 sc1 lds
    v_mfma_f32_16x16x32_bf16 v[116:119], v[32:35], v[200:203], v[140:143]
    ds_read_b128 v[28:31], v3 offset:6272
    v_mfma_f32_16x16x32_bf16 v[116:119], v[36:39], v[204:207], v[116:119]
    s_waitcnt lgkmcnt(2)
    v_exp_f32 v17, v65
    v_mfma_f32_16x16x32_bf16 v[80:83], v[40:43], a[248:251], v[80:83]
    ds_read_b128 v[32:35], v2 offset:256
    v_mfma_f32_16x16x32_bf16 v[80:83], v[44:47], a[252:255], v[80:83]
    v_exp_f32 v18, v66
    v_mfma_f32_16x16x32_bf16 v[84:87], v[40:43], v[208:211], v[84:87]
    ds_read_b128 v[36:39], v3 offset:256
    v_add_f32 v5, v5, v16
    v_mfma_f32_16x16x32_bf16 v[84:87], v[44:47], v[212:215], v[84:87]
    s_waitcnt lgkmcnt(2)
    v_add_f32 v5, v5, v17
    v_mfma_f32_16x16x32_bf16 v[112:115], v[24:27], a[248:251], v[112:115]
    ds_read_b128 v[40:43], v2 offset:6400
    v_mfma_f32_16x16x32_bf16 v[112:115], v[28:31], a[252:255], v[112:115]
    v_exp_f32 v19, v67
    v_cvt_pk_bf16_f32 v64, v16, v17
    v_mfma_f32_16x16x32_bf16 v[116:119], v[24:27], v[208:211], v[116:119]
    s_add_u32 s27, s27, 24576
    ds_read_b128 v[44:47], v3 offset:6400
    s_add_u32 s56, s56, 36864
    v_mfma_f32_16x16x32_bf16 v[116:119], v[28:31], v[212:215], v[116:119]
    s_waitcnt lgkmcnt(2)
    v_exp_f32 v16, v96
    v_mfma_f32_16x16x32_bf16 v[80:83], v[32:35], v[192:195], v[80:83]
    s_sub_u32 s58, s56, 147456
    ds_read_b128 v[24:27], v2 offset:12288
    v_add_f32 v5, v5, v18
    v_mfma_f32_16x16x32_bf16 v[80:83], v[36:39], v[196:199], v[80:83]
    s_min_u32 s56, s56, s58
    v_add_f32 v5, v5, v19
    v_mfma_f32_16x16x32_bf16 v[84:87], v[32:35], v[216:219], v[84:87]
    ds_read_b128 v[28:31], v3 offset:12288
    v_mfma_f32_16x16x32_bf16 v[84:87], v[36:39], v[220:223], v[84:87]
    s_waitcnt lgkmcnt(2)
    v_exp_f32 v17, v97
    v_cvt_pk_bf16_f32 v65, v18, v19
    v_mfma_f32_16x16x32_bf16 v[112:115], v[40:43], v[192:195], v[112:115]
    ds_read_b128 v[32:35], v2 offset:18432
    v_mfma_f32_16x16x32_bf16 v[112:115], v[44:47], v[196:199], v[112:115]
    v_exp_f32 v18, v98
    v_mfma_f32_16x16x32_bf16 v[116:119], v[40:43], v[216:219], v[116:119]
    ds_read_b128 v[36:39], v3 offset:18432
    v_add_f32 v5, v5, v16
    v_mfma_f32_16x16x32_bf16 v[116:119], v[44:47], v[220:223], v[116:119]
    s_waitcnt lgkmcnt(2)
    v_add_f32 v5, v5, v17
    v_mfma_f32_16x16x32_bf16 v[88:91], v[24:27], a[240:243], v[136:139]
    ds_read_b128 v[40:43], v2 offset:12416
    v_mfma_f32_16x16x32_bf16 v[88:91], v[28:31], a[244:247], v[88:91]
    v_exp_f32 v19, v99
    v_cvt_pk_bf16_f32 v66, v16, v17
    v_mfma_f32_16x16x32_bf16 v[92:95], v[24:27], v[200:203], v[140:143]
    ds_read_b128 v[44:47], v3 offset:12416
    v_mfma_f32_16x16x32_bf16 v[92:95], v[28:31], v[204:207], v[92:95]
    s_waitcnt lgkmcnt(2)
    v_exp_f32 v16, v68
    v_mfma_f32_16x16x32_bf16 v[120:123], v[32:35], a[240:243], v[136:139]
    ds_read_b128 v[24:27], v2 offset:18560
    v_add_f32 v5, v5, v18
    v_mfma_f32_16x16x32_bf16 v[120:123], v[36:39], a[244:247], v[120:123]
    v_add_f32 v5, v5, v19
    v_mfma_f32_16x16x32_bf16 v[124:127], v[32:35], v[200:203], v[140:143]
    ds_read_b128 v[28:31], v3 offset:18560
    v_mfma_f32_16x16x32_bf16 v[124:127], v[36:39], v[204:207], v[124:127]
    s_waitcnt lgkmcnt(2)
    v_exp_f32 v17, v69
    v_cvt_pk_bf16_f32 v67, v18, v19
    v_mfma_f32_16x16x32_bf16 v[88:91], v[40:43], a[248:251], v[88:91]
    ds_read_b128 v[32:35], v2 offset:12544
    v_mfma_f32_16x16x32_bf16 v[88:91], v[44:47], a[252:255], v[88:91]
    v_exp_f32 v18, v70
    v_mfma_f32_16x16x32_bf16 v[92:95], v[40:43], v[208:211], v[92:95]
    ds_read_b128 v[36:39], v3 offset:12544
    v_add_f32 v6, v6, v16
    v_mfma_f32_16x16x32_bf16 v[92:95], v[44:47], v[212:215], v[92:95]
    s_waitcnt lgkmcnt(2)
    v_add_f32 v6, v6, v17
    v_mfma_f32_16x16x32_bf16 v[120:123], v[24:27], a[248:251], v[120:123]
    ds_read_b128 v[40:43], v2 offset:18688
    v_mfma_f32_16x16x32_bf16 v[120:123], v[28:31], a[252:255], v[120:123]
    v_exp_f32 v19, v71
    v_cvt_pk_bf16_f32 v68, v16, v17
    v_mfma_f32_16x16x32_bf16 v[124:127], v[24:27], v[208:211], v[124:127]
    ds_read_b128 v[44:47], v3 offset:18688
    v_mfma_f32_16x16x32_bf16 v[124:127], v[28:31], v[212:215], v[124:127]
    s_waitcnt lgkmcnt(2)
    v_add_u32 v1, 49152, v1
    v_exp_f32 v16, v100
    v_mfma_f32_16x16x32_bf16 v[88:91], v[32:35], v[192:195], v[88:91]
    ds_read_b128 v[24:27], v1 offset:0
    v_add_f32 v6, v6, v18
    v_mfma_f32_16x16x32_bf16 v[88:91], v[36:39], v[196:199], v[88:91]
    v_add_f32 v6, v6, v19
    v_mfma_f32_16x16x32_bf16 v[92:95], v[32:35], v[216:219], v[92:95]
    ds_read_b128 v[28:31], v1 offset:12288
    v_mfma_f32_16x16x32_bf16 v[92:95], v[36:39], v[220:223], v[92:95]
    s_waitcnt lgkmcnt(2)
    v_exp_f32 v17, v101
    v_cvt_pk_bf16_f32 v69, v18, v19
    v_mfma_f32_16x16x32_bf16 v[120:123], v[40:43], v[192:195], v[120:123]
    ds_read_b128 v[32:35], v1 offset:1024
    v_mfma_f32_16x16x32_bf16 v[120:123], v[44:47], v[196:199], v[120:123]
    v_exp_f32 v18, v102
    v_mfma_f32_16x16x32_bf16 v[124:127], v[40:43], v[216:219], v[124:127]
    ds_read_b128 v[36:39], v1 offset:13312
    v_add_f32 v6, v6, v16
    v_mfma_f32_16x16x32_bf16 v[124:127], v[44:47], v[220:223], v[124:127]
    s_waitcnt lgkmcnt(2)
    v_add_f32 v6, v6, v17
    v_exp_f32 v19, v103
    v_cvt_pk_bf16_f32 v70, v16, v17
    v_add_f32 v6, v6, v18
    v_add_f32 v6, v6, v19
    v_cvt_pk_bf16_f32 v71, v18, v19
    v_mfma_f32_16x16x32_bf16 a[0:3], v[160:163], v[24:27], a[0:3]
    ds_read_b128 v[40:43], v1 offset:2048
    v_mfma_f32_16x16x32_bf16 a[0:3], v[168:171], v[28:31], a[0:3]
    v_exp_f32 v16, v72
    v_mfma_f32_16x16x32_bf16 a[48:51], v[164:167], v[24:27], a[48:51]
    ds_read_b128 v[44:47], v1 offset:14336
    v_mfma_f32_16x16x32_bf16 a[48:51], v[172:175], v[28:31], a[48:51]
    s_waitcnt lgkmcnt(2)
    v_exp_f32 v17, v73
    v_mfma_f32_16x16x32_bf16 a[4:7], v[160:163], v[32:35], a[4:7]
    ds_read_b128 v[24:27], v1 offset:3072
    v_mfma_f32_16x16x32_bf16 a[4:7], v[168:171], v[36:39], a[4:7]
    v_exp_f32 v18, v74
    v_mfma_f32_16x16x32_bf16 a[52:55], v[164:167], v[32:35], a[52:55]
    ds_read_b128 v[28:31], v1 offset:15360
    v_add_f32 v5, v5, v16
    v_mfma_f32_16x16x32_bf16 a[52:55], v[172:175], v[36:39], a[52:55]
    s_waitcnt lgkmcnt(2)
    v_add_f32 v5, v5, v17
    v_mfma_f32_16x16x32_bf16 a[8:11], v[160:163], v[40:43], a[8:11]
    ds_read_b128 v[32:35], v1 offset:4096
    v_mfma_f32_16x16x32_bf16 a[8:11], v[168:171], v[44:47], a[8:11]
    v_exp_f32 v19, v75
    v_mfma_f32_16x16x32_bf16 a[56:59], v[164:167], v[40:43], a[56:59]
    ds_read_b128 v[36:39], v1 offset:16384
    v_cvt_pk_bf16_f32 v72, v16, v17
    v_mfma_f32_16x16x32_bf16 a[56:59], v[172:175], v[44:47], a[56:59]
    s_waitcnt lgkmcnt(2)
    v_exp_f32 v16, v104
    v_mfma_f32_16x16x32_bf16 a[12:15], v[160:163], v[24:27], a[12:15]
    ds_read_b128 v[40:43], v1 offset:5120
    v_add_f32 v5, v5, v18
    v_mfma_f32_16x16x32_bf16 a[12:15], v[168:171], v[28:31], a[12:15]
    v_add_f32 v5, v5, v19
    v_mfma_f32_16x16x32_bf16 a[60:63], v[164:167], v[24:27], a[60:63]
    ds_read_b128 v[44:47], v1 offset:17408
    v_mfma_f32_16x16x32_bf16 a[60:63], v[172:175], v[28:31], a[60:63]
    s_waitcnt lgkmcnt(2)
    v_exp_f32 v17, v105
    v_mfma_f32_16x16x32_bf16 a[16:19], v[160:163], v[32:35], a[16:19]
    ds_read_b128 v[24:27], v1 offset:6144
    v_cvt_pk_bf16_f32 v73, v18, v19
    v_mfma_f32_16x16x32_bf16 a[16:19], v[168:171], v[36:39], a[16:19]
    v_exp_f32 v18, v106
    v_mfma_f32_16x16x32_bf16 a[64:67], v[164:167], v[32:35], a[64:67]
    ds_read_b128 v[28:31], v1 offset:18432
    v_add_f32 v5, v5, v16
    v_mfma_f32_16x16x32_bf16 a[64:67], v[172:175], v[36:39], a[64:67]
    s_waitcnt lgkmcnt(2)
    v_add_f32 v5, v5, v17
    v_mfma_f32_16x16x32_bf16 a[20:23], v[160:163], v[40:43], a[20:23]
    ds_read_b128 v[32:35], v1 offset:7168
    v_mfma_f32_16x16x32_bf16 a[20:23], v[168:171], v[44:47], a[20:23]
    v_exp_f32 v19, v107
    v_mfma_f32_16x16x32_bf16 a[68:71], v[164:167], v[40:43], a[68:71]
    ds_read_b128 v[36:39], v1 offset:19456
    v_cvt_pk_bf16_f32 v74, v16, v17
    v_mfma_f32_16x16x32_bf16 a[68:71], v[172:175], v[44:47], a[68:71]
    s_waitcnt lgkmcnt(2)
    v_exp_f32 v16, v76
    v_mfma_f32_16x16x32_bf16 a[24:27], v[160:163], v[24:27], a[24:27]
    ds_read_b128 v[40:43], v1 offset:8192
    v_add_f32 v5, v5, v18
    v_mfma_f32_16x16x32_bf16 a[24:27], v[168:171], v[28:31], a[24:27]
    v_add_f32 v5, v5, v19
    v_mfma_f32_16x16x32_bf16 a[72:75], v[164:167], v[24:27], a[72:75]
    ds_read_b128 v[44:47], v1 offset:20480
    v_mfma_f32_16x16x32_bf16 a[72:75], v[172:175], v[28:31], a[72:75]
    s_waitcnt lgkmcnt(2)
    v_exp_f32 v17, v77
    v_mfma_f32_16x16x32_bf16 a[28:31], v[160:163], v[32:35], a[28:31]
    ds_read_b128 v[24:27], v1 offset:9216
    v_cvt_pk_bf16_f32 v75, v18, v19
    v_mfma_f32_16x16x32_bf16 a[28:31], v[168:171], v[36:39], a[28:31]
    v_exp_f32 v18, v78
    v_mfma_f32_16x16x32_bf16 a[76:79], v[164:167], v[32:35], a[76:79]
    ds_read_b128 v[28:31], v1 offset:21504
    v_add_f32 v6, v6, v16
    v_mfma_f32_16x16x32_bf16 a[76:79], v[172:175], v[36:39], a[76:79]
    s_waitcnt lgkmcnt(2)
    v_add_f32 v6, v6, v17
    v_mfma_f32_16x16x32_bf16 a[32:35], v[160:163], v[40:43], a[32:35]
    ds_read_b128 v[32:35], v1 offset:10240
    v_mfma_f32_16x16x32_bf16 a[32:35], v[168:171], v[44:47], a[32:35]
    v_exp_f32 v19, v79
    v_mfma_f32_16x16x32_bf16 a[80:83], v[164:167], v[40:43], a[80:83]
    ds_read_b128 v[36:39], v1 offset:22528
    v_cvt_pk_bf16_f32 v76, v16, v17
    v_mfma_f32_16x16x32_bf16 a[80:83], v[172:175], v[44:47], a[80:83]
    s_waitcnt lgkmcnt(2)
    v_exp_f32 v16, v108
    v_mfma_f32_16x16x32_bf16 a[36:39], v[160:163], v[24:27], a[36:39]
    ds_read_b128 v[40:43], v1 offset:11264
    v_add_f32 v6, v6, v18
    v_mfma_f32_16x16x32_bf16 a[36:39], v[168:171], v[28:31], a[36:39]
    v_add_f32 v6, v6, v19
    v_mfma_f32_16x16x32_bf16 a[84:87], v[164:167], v[24:27], a[84:87]
    ds_read_b128 v[44:47], v1 offset:23552
    v_mfma_f32_16x16x32_bf16 a[84:87], v[172:175], v[28:31], a[84:87]
    s_waitcnt lgkmcnt(2)
    v_subrev_u32 v1, 98304, v1
    v_mfma_f32_16x16x32_bf16 a[40:43], v[160:163], v[32:35], a[40:43]
    ds_read_b128 v[24:27], v1 offset:0
    v_mfma_f32_16x16x32_bf16 a[40:43], v[168:171], v[36:39], a[40:43]
    v_exp_f32 v17, v109
    v_mfma_f32_16x16x32_bf16 a[88:91], v[164:167], v[32:35], a[88:91]
    ds_read_b128 v[28:31], v1 offset:12288
    v_cvt_pk_bf16_f32 v77, v18, v19
    v_mfma_f32_16x16x32_bf16 a[88:91], v[172:175], v[36:39], a[88:91]
    s_waitcnt lgkmcnt(2)
    v_exp_f32 v18, v110
    v_mfma_f32_16x16x32_bf16 a[44:47], v[160:163], v[40:43], a[44:47]
    ds_read_b128 v[32:35], v1 offset:1024
    v_add_f32 v6, v6, v16
    v_mfma_f32_16x16x32_bf16 a[44:47], v[168:171], v[44:47], a[44:47]
    v_add_f32 v6, v6, v17
    v_mfma_f32_16x16x32_bf16 a[92:95], v[164:167], v[40:43], a[92:95]
    ds_read_b128 v[36:39], v1 offset:13312
    v_mfma_f32_16x16x32_bf16 a[92:95], v[172:175], v[44:47], a[92:95]
    s_waitcnt lgkmcnt(2)
    v_exp_f32 v19, v111
    v_mfma_f32_16x16x32_bf16 a[0:3], v[176:179], v[24:27], a[0:3]
    ds_read_b128 v[40:43], v1 offset:2048
    v_cvt_pk_bf16_f32 v78, v16, v17
    v_mfma_f32_16x16x32_bf16 a[0:3], v[184:187], v[28:31], a[0:3]
    v_add_f32 v6, v6, v18
    v_add_f32 v6, v6, v19
    v_mfma_f32_16x16x32_bf16 a[48:51], v[180:183], v[24:27], a[48:51]
    ds_read_b128 v[44:47], v1 offset:14336
    v_cvt_pk_bf16_f32 v79, v18, v19
    v_mfma_f32_16x16x32_bf16 a[48:51], v[188:191], v[28:31], a[48:51]
    s_waitcnt lgkmcnt(2)
    v_exp_f32 v16, v80
    v_mfma_f32_16x16x32_bf16 a[4:7], v[176:179], v[32:35], a[4:7]
    ds_read_b128 v[24:27], v1 offset:3072
    v_mfma_f32_16x16x32_bf16 a[4:7], v[184:187], v[36:39], a[4:7]
    v_exp_f32 v17, v81
    v_mfma_f32_16x16x32_bf16 a[52:55], v[180:183], v[32:35], a[52:55]
    ds_read_b128 v[28:31], v1 offset:15360
    v_mfma_f32_16x16x32_bf16 a[52:55], v[188:191], v[36:39], a[52:55]
    s_waitcnt lgkmcnt(2)
    v_exp_f32 v18, v82
    v_mfma_f32_16x16x32_bf16 a[8:11], v[176:179], v[40:43], a[8:11]
    ds_read_b128 v[32:35], v1 offset:4096
    v_add_f32 v7, v7, v16
    v_mfma_f32_16x16x32_bf16 a[8:11], v[184:187], v[44:47], a[8:11]
    v_add_f32 v7, v7, v17
    v_mfma_f32_16x16x32_bf16 a[56:59], v[180:183], v[40:43], a[56:59]
    ds_read_b128 v[36:39], v1 offset:16384
    v_mfma_f32_16x16x32_bf16 a[56:59], v[188:191], v[44:47], a[56:59]
    s_waitcnt lgkmcnt(2)
    v_exp_f32 v19, v83
    v_mfma_f32_16x16x32_bf16 a[12:15], v[176:179], v[24:27], a[12:15]
    ds_read_b128 v[40:43], v1 offset:5120
    v_cvt_pk_bf16_f32 v80, v16, v17
    v_mfma_f32_16x16x32_bf16 a[12:15], v[184:187], v[28:31], a[12:15]
    v_exp_f32 v16, v112
    v_mfma_f32_16x16x32_bf16 a[60:63], v[180:183], v[24:27], a[60:63]
    ds_read_b128 v[44:47], v1 offset:17408
    v_add_f32 v7, v7, v18
    v_mfma_f32_16x16x32_bf16 a[60:63], v[188:191], v[28:31], a[60:63]
    s_waitcnt lgkmcnt(2)
    v_add_f32 v7, v7, v19
    v_mfma_f32_16x16x32_bf16 a[16:19], v[176:179], v[32:35], a[16:19]
    ds_read_b128 v[24:27], v1 offset:6144
    v_mfma_f32_16x16x32_bf16 a[16:19], v[184:187], v[36:39], a[16:19]
    v_exp_f32 v17, v113
    v_mfma_f32_16x16x32_bf16 a[64:67], v[180:183], v[32:35], a[64:67]
    ds_read_b128 v[28:31], v1 offset:18432
    v_cvt_pk_bf16_f32 v81, v18, v19
    v_mfma_f32_16x16x32_bf16 a[64:67], v[188:191], v[36:39], a[64:67]
    s_waitcnt lgkmcnt(2)
    v_exp_f32 v18, v114
    v_mfma_f32_16x16x32_bf16 a[20:23], v[176:179], v[40:43], a[20:23]
    ds_read_b128 v[32:35], v1 offset:7168
    v_add_f32 v7, v7, v16
    v_mfma_f32_16x16x32_bf16 a[20:23], v[184:187], v[44:47], a[20:23]
    v_add_f32 v7, v7, v17
    v_mfma_f32_16x16x32_bf16 a[68:71], v[180:183], v[40:43], a[68:71]
    ds_read_b128 v[36:39], v1 offset:19456
    v_mfma_f32_16x16x32_bf16 a[68:71], v[188:191], v[44:47], a[68:71]
    s_waitcnt lgkmcnt(2)
    v_exp_f32 v19, v115
    v_mfma_f32_16x16x32_bf16 a[24:27], v[176:179], v[24:27], a[24:27]
    ds_read_b128 v[40:43], v1 offset:8192
    v_cvt_pk_bf16_f32 v82, v16, v17
    v_mfma_f32_16x16x32_bf16 a[24:27], v[184:187], v[28:31], a[24:27]
    v_exp_f32 v16, v84
    v_mfma_f32_16x16x32_bf16 a[72:75], v[180:183], v[24:27], a[72:75]
    ds_read_b128 v[44:47], v1 offset:20480
    v_add_f32 v7, v7, v18
    v_mfma_f32_16x16x32_bf16 a[72:75], v[188:191], v[28:31], a[72:75]
    s_waitcnt lgkmcnt(2)
    v_add_f32 v7, v7, v19
    v_mfma_f32_16x16x32_bf16 a[28:31], v[176:179], v[32:35], a[28:31]
    ds_read_b128 v[24:27], v1 offset:9216
    v_mfma_f32_16x16x32_bf16 a[28:31], v[184:187], v[36:39], a[28:31]
    s_waitcnt vmcnt(0)
    v_exp_f32 v17, v85
    v_mfma_f32_16x16x32_bf16 a[76:79], v[180:183], v[32:35], a[76:79]
    ds_read_b128 v[28:31], v1 offset:21504
    v_cvt_pk_bf16_f32 v83, v18, v19
    v_mfma_f32_16x16x32_bf16 a[76:79], v[188:191], v[36:39], a[76:79]
    s_waitcnt lgkmcnt(2)
    s_barrier
    v_mfma_f32_16x16x32_bf16 a[32:35], v[176:179], v[40:43], a[32:35]
    ds_read_b128 v[32:35], v1 offset:10240
    v_mfma_f32_16x16x32_bf16 a[32:35], v[184:187], v[44:47], a[32:35]
    v_exp_f32 v18, v86
    v_mfma_f32_16x16x32_bf16 a[80:83], v[180:183], v[40:43], a[80:83]
    ds_read_b128 v[36:39], v1 offset:22528
    v_add_f32 v8, v8, v16
    v_mfma_f32_16x16x32_bf16 a[80:83], v[188:191], v[44:47], a[80:83]
    s_waitcnt lgkmcnt(2)
    v_add_f32 v8, v8, v17
    v_mfma_f32_16x16x32_bf16 a[36:39], v[176:179], v[24:27], a[36:39]
    ds_read_b128 v[40:43], v1 offset:11264
    v_mfma_f32_16x16x32_bf16 a[36:39], v[184:187], v[28:31], a[36:39]
    v_exp_f32 v19, v87
    v_cvt_pk_bf16_f32 v84, v16, v17
    v_mfma_f32_16x16x32_bf16 a[84:87], v[180:183], v[24:27], a[84:87]
    ds_read_b128 v[44:47], v1 offset:23552
    v_mfma_f32_16x16x32_bf16 a[84:87], v[188:191], v[28:31], a[84:87]
    s_waitcnt lgkmcnt(2)
    v_add_u32 v1, 49152, v1
    v_exp_f32 v16, v116
    v_mfma_f32_16x16x32_bf16 a[40:43], v[176:179], v[32:35], a[40:43]
    ds_read_b128 v[24:27], v1 offset:0
    v_add_f32 v8, v8, v18
    v_mfma_f32_16x16x32_bf16 a[40:43], v[184:187], v[36:39], a[40:43]
    v_add_f32 v8, v8, v19
    v_mfma_f32_16x16x32_bf16 a[88:91], v[180:183], v[32:35], a[88:91]
    ds_read_b128 v[28:31], v1 offset:12288
    v_mfma_f32_16x16x32_bf16 a[88:91], v[188:191], v[36:39], a[88:91]
    s_waitcnt lgkmcnt(2)
    v_exp_f32 v17, v117
    v_cvt_pk_bf16_f32 v85, v18, v19
    v_mfma_f32_16x16x32_bf16 a[44:47], v[176:179], v[40:43], a[44:47]
    ds_read_b128 v[32:35], v1 offset:1024
    v_mfma_f32_16x16x32_bf16 a[44:47], v[184:187], v[44:47], a[44:47]
    v_exp_f32 v18, v118
    v_mfma_f32_16x16x32_bf16 a[92:95], v[180:183], v[40:43], a[92:95]
    ds_read_b128 v[36:39], v1 offset:13312
    v_add_f32 v8, v8, v16
    v_mfma_f32_16x16x32_bf16 a[92:95], v[188:191], v[44:47], a[92:95]
    s_waitcnt lgkmcnt(2)
    v_add_f32 v8, v8, v17
    v_exp_f32 v19, v119
    v_cvt_pk_bf16_f32 v86, v16, v17
    v_add_f32 v8, v8, v18
    v_add_f32 v8, v8, v19
    v_cvt_pk_bf16_f32 v87, v18, v19
    v_mfma_f32_16x16x32_bf16 a[0:3], v[64:67], v[24:27], a[0:3]
    ds_read_b128 v[40:43], v1 offset:2048
    v_mfma_f32_16x16x32_bf16 a[0:3], v[72:75], v[28:31], a[0:3]
    v_exp_f32 v16, v88
    v_exp_f32 v17, v89
    v_exp_f32 v18, v90
    v_mfma_f32_16x16x4_f32 v[48:51], v5, v57, 0
    v_mfma_f32_16x16x32_bf16 a[48:51], v[68:71], v[24:27], a[48:51]
    ds_read_b128 v[44:47], v1 offset:14336
    v_add_f32 v7, v7, v16
    v_mfma_f32_16x16x32_bf16 a[48:51], v[76:79], v[28:31], a[48:51]
    s_waitcnt lgkmcnt(2)
    v_add_f32 v7, v7, v17
    v_exp_f32 v19, v91
    v_cvt_pk_bf16_f32 v88, v16, v17
    v_exp_f32 v16, v120
    v_mfma_f32_16x16x4_f32 v[52:55], v6, v57, 0
    v_mfma_f32_16x16x32_bf16 a[4:7], v[64:67], v[32:35], a[4:7]
    ds_read_b128 v[24:27], v1 offset:3072
    v_add_f32 v7, v7, v18
    v_mfma_f32_16x16x32_bf16 a[4:7], v[72:75], v[36:39], a[4:7]
    v_add_f32 v7, v7, v19
    v_exp_f32 v17, v121
    v_mfma_f32_16x16x32_bf16 a[52:55], v[68:71], v[32:35], a[52:55]
    ds_read_b128 v[28:31], v1 offset:15360
    v_cvt_pk_bf16_f32 v89, v18, v19
    v_mfma_f32_16x16x32_bf16 a[52:55], v[76:79], v[36:39], a[52:55]
    s_waitcnt lgkmcnt(2)
    v_exp_f32 v18, v122
    v_mfma_f32_16x16x32_bf16 a[8:11], v[64:67], v[40:43], a[8:11]
    ds_read_b128 v[32:35], v1 offset:4096
    v_add_f32 v7, v7, v16
    v_mfma_f32_16x16x32_bf16 a[8:11], v[72:75], v[44:47], a[8:11]
    v_add_f32 v7, v7, v17
    v_exp_f32 v19, v123
    v_mfma_f32_16x16x32_bf16 a[56:59], v[68:71], v[40:43], a[56:59]
    ds_read_b128 v[36:39], v1 offset:16384
    v_cvt_pk_bf16_f32 v90, v16, v17
    v_mfma_f32_16x16x32_bf16 a[56:59], v[76:79], v[44:47], a[56:59]
    s_waitcnt lgkmcnt(2)
    v_exp_f32 v16, v92
    v_mfma_f32_16x16x32_bf16 a[12:15], v[64:67], v[24:27], a[12:15]
    ds_read_b128 v[40:43], v1 offset:5120
    v_add_f32 v7, v7, v18
    v_mfma_f32_16x16x32_bf16 a[12:15], v[72:75], v[28:31], a[12:15]
    v_add_f32 v7, v7, v19
    v_exp_f32 v17, v93
    v_mfma_f32_16x16x32_bf16 a[60:63], v[68:71], v[24:27], a[60:63]
    ds_read_b128 v[44:47], v1 offset:17408
    v_cvt_pk_bf16_f32 v91, v18, v19
    v_mfma_f32_16x16x32_bf16 a[60:63], v[76:79], v[28:31], a[60:63]
    s_waitcnt lgkmcnt(2)
    v_exp_f32 v18, v94
    v_mfma_f32_16x16x32_bf16 a[16:19], v[64:67], v[32:35], a[16:19]
    ds_read_b128 v[24:27], v1 offset:6144
    v_add_f32 v8, v8, v16
    v_mfma_f32_16x16x32_bf16 a[16:19], v[72:75], v[36:39], a[16:19]
    v_add_f32 v8, v8, v17
    v_exp_f32 v19, v95
    v_mfma_f32_16x16x32_bf16 a[64:67], v[68:71], v[32:35], a[64:67]
    ds_read_b128 v[28:31], v1 offset:18432
    v_cvt_pk_bf16_f32 v92, v16, v17
    v_mfma_f32_16x16x32_bf16 a[64:67], v[76:79], v[36:39], a[64:67]
    s_waitcnt lgkmcnt(2)
    v_exp_f32 v16, v124
    v_mfma_f32_16x16x32_bf16 a[20:23], v[64:67], v[40:43], a[20:23]
    ds_read_b128 v[32:35], v1 offset:7168
    v_add_f32 v8, v8, v18
    v_mfma_f32_16x16x32_bf16 a[20:23], v[72:75], v[44:47], a[20:23]
    v_add_f32 v8, v8, v19
    v_exp_f32 v17, v125
    v_mfma_f32_16x16x32_bf16 a[68:71], v[68:71], v[40:43], a[68:71]
    ds_read_b128 v[36:39], v1 offset:19456
    v_cvt_pk_bf16_f32 v93, v18, v19
    v_mfma_f32_16x16x32_bf16 a[68:71], v[76:79], v[44:47], a[68:71]
    s_waitcnt lgkmcnt(2)
    v_exp_f32 v18, v126
    v_mfma_f32_16x16x32_bf16 a[24:27], v[64:67], v[24:27], a[24:27]
    ds_read_b128 v[40:43], v1 offset:8192
    v_add_f32 v8, v8, v16
    v_mfma_f32_16x16x32_bf16 a[24:27], v[72:75], v[28:31], a[24:27]
    v_add_f32 v8, v8, v17
    v_exp_f32 v19, v127
    v_mfma_f32_16x16x32_bf16 a[72:75], v[68:71], v[24:27], a[72:75]
    ds_read_b128 v[44:47], v1 offset:20480
    v_cvt_pk_bf16_f32 v94, v16, v17
    v_mfma_f32_16x16x32_bf16 a[72:75], v[76:79], v[28:31], a[72:75]
    s_waitcnt lgkmcnt(2)
    v_add_f32 v8, v8, v18
    v_add_f32 v8, v8, v19
    v_mfma_f32_16x16x32_bf16 a[28:31], v[64:67], v[32:35], a[28:31]
    ds_read_b128 v[24:27], v1 offset:9216
    v_cvt_pk_bf16_f32 v95, v18, v19
    v_mfma_f32_16x16x32_bf16 a[28:31], v[72:75], v[36:39], a[28:31]
    v_rcp_f32 v48, v48
    v_mfma_f32_16x16x32_bf16 a[76:79], v[68:71], v[32:35], a[76:79]
    ds_read_b128 v[28:31], v1 offset:21504
    v_mfma_f32_16x16x32_bf16 a[76:79], v[76:79], v[36:39], a[76:79]
    s_waitcnt lgkmcnt(2)
    v_rcp_f32 v49, v49
    v_mfma_f32_16x16x32_bf16 a[32:35], v[64:67], v[40:43], a[32:35]
    ds_read_b128 v[32:35], v1 offset:10240
    v_mfma_f32_16x16x32_bf16 a[32:35], v[72:75], v[44:47], a[32:35]
    v_rcp_f32 v50, v50
    v_mfma_f32_16x16x32_bf16 a[80:83], v[68:71], v[40:43], a[80:83]
    ds_read_b128 v[36:39], v1 offset:22528
    v_mfma_f32_16x16x32_bf16 a[80:83], v[76:79], v[44:47], a[80:83]
    s_waitcnt lgkmcnt(2)
    v_rcp_f32 v51, v51
    v_mfma_f32_16x16x32_bf16 a[36:39], v[64:67], v[24:27], a[36:39]
    ds_read_b128 v[40:43], v1 offset:11264
    v_mfma_f32_16x16x32_bf16 a[36:39], v[72:75], v[28:31], a[36:39]
    v_rcp_f32 v52, v52
    v_mfma_f32_16x16x32_bf16 a[84:87], v[68:71], v[24:27], a[84:87]
    ds_read_b128 v[44:47], v1 offset:23552
    v_mfma_f32_16x16x32_bf16 a[84:87], v[76:79], v[28:31], a[84:87]
    s_waitcnt lgkmcnt(2)
    v_subrev_u32 v2, 98304, v2
    v_subrev_u32 v3, 98304, v3
    v_mfma_f32_16x16x32_bf16 a[40:43], v[64:67], v[32:35], a[40:43]
    ds_read_b128 v[24:27], v2 offset:0
    v_mfma_f32_16x16x32_bf16 a[40:43], v[72:75], v[36:39], a[40:43]
    v_rcp_f32 v53, v53
    v_mfma_f32_16x16x32_bf16 a[88:91], v[68:71], v[32:35], a[88:91]
    ds_read_b128 v[28:31], v3 offset:0
    v_mfma_f32_16x16x32_bf16 a[88:91], v[76:79], v[36:39], a[88:91]
    s_waitcnt lgkmcnt(2)
    v_rcp_f32 v54, v54
    v_mfma_f32_16x16x32_bf16 a[44:47], v[64:67], v[40:43], a[44:47]
    ds_read_b128 v[32:35], v2 offset:6144
    v_mfma_f32_16x16x32_bf16 a[44:47], v[72:75], v[44:47], a[44:47]
    v_rcp_f32 v55, v55
    v_mfma_f32_16x16x32_bf16 a[92:95], v[68:71], v[40:43], a[92:95]
    ds_read_b128 v[36:39], v3 offset:6144
    v_mfma_f32_16x16x32_bf16 a[92:95], v[76:79], v[44:47], a[92:95]
    s_waitcnt lgkmcnt(2)
    v_mfma_f32_16x16x32_bf16 v[160:163], v[24:27], a[240:243], v[136:139]
    ds_read_b128 v[40:43], v2 offset:128
    v_mfma_f32_16x16x32_bf16 v[160:163], v[28:31], a[244:247], v[160:163]
    v_mfma_f32_16x16x32_bf16 v[164:167], v[24:27], v[200:203], v[140:143]
    ds_read_b128 v[44:47], v3 offset:128
    v_mfma_f32_16x16x32_bf16 v[164:167], v[28:31], v[204:207], v[164:167]
    s_waitcnt lgkmcnt(2)
    v_mfma_f32_16x16x32_bf16 v[96:99], v[32:35], a[240:243], v[136:139]
    ds_read_b128 v[24:27], v2 offset:6272
    v_accvgpr_read_b32 v224, a0
    v_mfma_f32_16x16x32_bf16 v[96:99], v[36:39], a[244:247], v[96:99]
    v_accvgpr_read_b32 v225, a12
    v_accvgpr_read_b32 v226, a24
    v_accvgpr_read_b32 v227, a36
    v_mul_f32 v224, v224, v48
    v_mul_f32 v225, v225, v48
    v_mfma_f32_16x16x32_bf16 v[100:103], v[32:35], v[200:203], v[140:143]
    ds_read_b128 v[28:31], v3 offset:6272
    v_mul_f32 v226, v226, v48
    v_mfma_f32_16x16x32_bf16 v[100:103], v[36:39], v[204:207], v[100:103]
    s_waitcnt lgkmcnt(2)
    v_mul_f32 v227, v227, v48
    v_cvt_pk_bf16_f32 v224, v224, v225
    v_cvt_pk_bf16_f32 v225, v226, v227
    v_accvgpr_read_b32 v228, a1
    v_accvgpr_read_b32 v229, a13
    v_accvgpr_read_b32 v230, a25
    v_mfma_f32_16x16x32_bf16 v[160:163], v[40:43], a[248:251], v[160:163]
    ds_read_b128 v[32:35], v2 offset:256
    v_accvgpr_read_b32 v231, a37
    v_mfma_f32_16x16x32_bf16 v[160:163], v[44:47], a[252:255], v[160:163]
    buffer_store_dwordx2 v[224:225], v56, s[12:15], s24 offen offset:0 sc0 sc1
    v_mul_f32 v228, v228, v49
    v_mul_f32 v229, v229, v49
    v_mul_f32 v230, v230, v49
    v_mfma_f32_16x16x32_bf16 v[164:167], v[40:43], v[208:211], v[164:167]
    ds_read_b128 v[36:39], v3 offset:256
    v_mul_f32 v231, v231, v49
    v_mfma_f32_16x16x32_bf16 v[164:167], v[44:47], v[212:215], v[164:167]
    s_waitcnt lgkmcnt(2)
    v_cvt_pk_bf16_f32 v228, v228, v229
    v_cvt_pk_bf16_f32 v229, v230, v231
    v_accvgpr_read_b32 v232, a2
    v_accvgpr_read_b32 v233, a14
    v_accvgpr_read_b32 v234, a26
    v_accvgpr_read_b32 v235, a38
    v_mfma_f32_16x16x32_bf16 v[96:99], v[24:27], a[248:251], v[96:99]
    ds_read_b128 v[40:43], v2 offset:6400
    v_mul_f32 v232, v232, v50
    v_mfma_f32_16x16x32_bf16 v[96:99], v[28:31], a[252:255], v[96:99]
    buffer_store_dwordx2 v[228:229], v56, s[12:15], s24 offen offset:384 sc0 sc1
    v_mul_f32 v233, v233, v50
    v_mul_f32 v234, v234, v50
    v_mul_f32 v235, v235, v50
    v_mfma_f32_16x16x32_bf16 v[100:103], v[24:27], v[208:211], v[100:103]
    ds_read_b128 v[44:47], v3 offset:6400
    v_cvt_pk_bf16_f32 v232, v232, v233
    v_mfma_f32_16x16x32_bf16 v[100:103], v[28:31], v[212:215], v[100:103]
    s_waitcnt lgkmcnt(2)
    v_cvt_pk_bf16_f32 v233, v234, v235
    v_accvgpr_read_b32 v236, a3
    v_accvgpr_read_b32 v237, a15
    v_accvgpr_read_b32 v238, a27
    v_accvgpr_read_b32 v239, a39
    v_mul_f32 v236, v236, v51
    v_mfma_f32_16x16x32_bf16 v[160:163], v[32:35], v[192:195], v[160:163]
    ds_read_b128 v[24:27], v2 offset:12288
    v_mul_f32 v237, v237, v51
    v_mfma_f32_16x16x32_bf16 v[160:163], v[36:39], v[196:199], v[160:163]
    buffer_store_dwordx2 v[232:233], v56, s[12:15], s24 offen offset:768 sc0 sc1
    v_mul_f32 v238, v238, v51
    v_mul_f32 v239, v239, v51
    v_cvt_pk_bf16_f32 v236, v236, v237
    v_mfma_f32_16x16x32_bf16 v[164:167], v[32:35], v[216:219], v[164:167]
    ds_read_b128 v[28:31], v3 offset:12288
    v_cvt_pk_bf16_f32 v237, v238, v239
    v_mfma_f32_16x16x32_bf16 v[164:167], v[36:39], v[220:223], v[164:167]
    s_waitcnt lgkmcnt(2)
    buffer_store_dwordx2 v[236:237], v56, s[12:15], s24 offen offset:1152 sc0 sc1
    v_accvgpr_read_b32 v240, a4
    v_accvgpr_read_b32 v241, a16
    v_accvgpr_read_b32 v242, a28
    v_mfma_f32_16x16x32_bf16 v[96:99], v[40:43], v[192:195], v[96:99]
    ds_read_b128 v[32:35], v2 offset:18432
    v_accvgpr_read_b32 v243, a40
    v_mfma_f32_16x16x32_bf16 v[96:99], v[44:47], v[196:199], v[96:99]
    v_mul_f32 v240, v240, v48
    v_mul_f32 v241, v241, v48
    v_mul_f32 v242, v242, v48
    v_mul_f32 v243, v243, v48
    v_cvt_pk_bf16_f32 v240, v240, v241
    v_cvt_pk_bf16_f32 v241, v242, v243
    v_mfma_f32_16x16x32_bf16 v[100:103], v[40:43], v[216:219], v[100:103]
    ds_read_b128 v[36:39], v3 offset:18432
    v_accvgpr_read_b32 v244, a5
    v_mfma_f32_16x16x32_bf16 v[100:103], v[44:47], v[220:223], v[100:103]
    s_waitcnt lgkmcnt(2)
    buffer_store_dwordx2 v[240:241], v56, s[12:15], s24 offen offset:128 sc0 sc1
    v_accvgpr_read_b32 v245, a17
    v_accvgpr_read_b32 v246, a29
    v_accvgpr_read_b32 v247, a41
    v_mfma_f32_16x16x32_bf16 v[168:171], v[24:27], a[240:243], v[136:139]
    ds_read_b128 v[40:43], v2 offset:12416
    v_mul_f32 v244, v244, v49
    v_mfma_f32_16x16x32_bf16 v[168:171], v[28:31], a[244:247], v[168:171]
    v_mul_f32 v245, v245, v49
    v_mul_f32 v246, v246, v49
    v_mul_f32 v247, v247, v49
    v_cvt_pk_bf16_f32 v244, v244, v245
    v_cvt_pk_bf16_f32 v245, v246, v247
    v_accvgpr_read_b32 v248, a6
    v_mfma_f32_16x16x32_bf16 v[172:175], v[24:27], v[200:203], v[140:143]
    ds_read_b128 v[44:47], v3 offset:12416
    v_accvgpr_read_b32 v249, a18
    v_mfma_f32_16x16x32_bf16 v[172:175], v[28:31], v[204:207], v[172:175]
    s_waitcnt lgkmcnt(2)
    buffer_store_dwordx2 v[244:245], v56, s[12:15], s24 offen offset:512 sc0 sc1
    v_accvgpr_read_b32 v250, a30
    v_accvgpr_read_b32 v251, a42
    v_mul_f32 v248, v248, v50
    v_mfma_f32_16x16x32_bf16 v[104:107], v[32:35], a[240:243], v[136:139]
    ds_read_b128 v[24:27], v2 offset:18560
    v_mul_f32 v249, v249, v50
    v_mfma_f32_16x16x32_bf16 v[104:107], v[36:39], a[244:247], v[104:107]
    v_mul_f32 v250, v250, v50
    v_mul_f32 v251, v251, v50
    v_cvt_pk_bf16_f32 v248, v248, v249
    v_exp_f32 v16, v160
    v_mfma_f32_16x16x32_bf16 v[108:111], v[32:35], v[200:203], v[140:143]
    ds_read_b128 v[28:31], v3 offset:18560
    v_cvt_pk_bf16_f32 v249, v250, v251
    v_mfma_f32_16x16x32_bf16 v[108:111], v[36:39], v[204:207], v[108:111]
    s_waitcnt lgkmcnt(2)
    buffer_store_dwordx2 v[248:249], v56, s[12:15], s24 offen offset:896 sc0 sc1
    v_accvgpr_read_b32 v252, a7
    v_exp_f32 v17, v161
    v_mfma_f32_16x16x32_bf16 v[168:171], v[40:43], a[248:251], v[168:171]
    ds_read_b128 v[32:35], v2 offset:12544
    v_accvgpr_read_b32 v253, a19
    v_mfma_f32_16x16x32_bf16 v[168:171], v[44:47], a[252:255], v[168:171]
    v_exp_f32 v18, v162
    v_accvgpr_read_b32 v254, a31
    v_accvgpr_read_b32 v255, a43
    v_mul_f32 v252, v252, v51
    v_add_f32 v7, v7, v16
    v_mfma_f32_16x16x32_bf16 v[172:175], v[40:43], v[208:211], v[172:175]
    ds_read_b128 v[36:39], v3 offset:12544
    v_mul_f32 v253, v253, v51
    v_mfma_f32_16x16x32_bf16 v[172:175], v[44:47], v[212:215], v[172:175]
    s_waitcnt lgkmcnt(2)
    v_add_f32 v7, v7, v17
    v_mul_f32 v254, v254, v51
    v_exp_f32 v19, v163
    v_mul_f32 v255, v255, v51
    v_cvt_pk_bf16_f32 v252, v252, v253
    v_mfma_f32_16x16x32_bf16 v[104:107], v[24:27], a[248:251], v[104:107]
    ds_read_b128 v[40:43], v2 offset:18688
    v_cvt_pk_bf16_f32 v160, v16, v17
    v_mfma_f32_16x16x32_bf16 v[104:107], v[28:31], a[252:255], v[104:107]
    v_cvt_pk_bf16_f32 v253, v254, v255
    v_exp_f32 v16, v96
    v_accvgpr_read_b32 v224, a8
    v_accvgpr_read_b32 v225, a20
    v_accvgpr_read_b32 v226, a32
    v_mfma_f32_16x16x32_bf16 v[108:111], v[24:27], v[208:211], v[108:111]
    ds_read_b128 v[44:47], v3 offset:18688
    v_add_f32 v7, v7, v18
    v_mfma_f32_16x16x32_bf16 v[108:111], v[28:31], v[212:215], v[108:111]
    s_waitcnt lgkmcnt(2)
    buffer_store_dwordx2 v[252:253], v56, s[12:15], s24 offen offset:1280 sc0 sc1
    v_add_u32 v2, 49152, v2
    v_add_u32 v3, 49152, v3
    v_add_f32 v7, v7, v19
    v_mfma_f32_16x16x32_bf16 v[168:171], v[32:35], v[192:195], v[168:171]
    ds_read_b128 v[24:27], v2 offset:0
    v_accvgpr_read_b32 v227, a44
    v_mfma_f32_16x16x32_bf16 v[168:171], v[36:39], v[196:199], v[168:171]
    v_exp_f32 v17, v97
    v_mul_f32 v224, v224, v48
    v_mul_f32 v225, v225, v48
    v_cvt_pk_bf16_f32 v161, v18, v19
    v_mul_f32 v226, v226, v48
    v_mfma_f32_16x16x32_bf16 v[172:175], v[32:35], v[216:219], v[172:175]
    ds_read_b128 v[28:31], v3 offset:0
    v_mul_f32 v227, v227, v48
    v_mfma_f32_16x16x32_bf16 v[172:175], v[36:39], v[220:223], v[172:175]
    s_waitcnt lgkmcnt(2)
    v_exp_f32 v18, v98
    v_cvt_pk_bf16_f32 v224, v224, v225
    v_add_f32 v7, v7, v16
    v_cvt_pk_bf16_f32 v225, v226, v227
    v_accvgpr_read_b32 v228, a9
    v_mfma_f32_16x16x32_bf16 v[104:107], v[40:43], v[192:195], v[104:107]
    ds_read_b128 v[32:35], v2 offset:6144
    v_add_f32 v7, v7, v17
    v_mfma_f32_16x16x32_bf16 v[104:107], v[44:47], v[196:199], v[104:107]
    buffer_store_dwordx2 v[224:225], v56, s[12:15], s24 offen offset:256 sc0 sc1
    v_exp_f32 v19, v99
    v_accvgpr_read_b32 v229, a21
    v_mfma_f32_16x16x32_bf16 v[108:111], v[40:43], v[216:219], v[108:111]
    ds_read_b128 v[36:39], v3 offset:6144
    v_accvgpr_read_b32 v230, a33
    v_mfma_f32_16x16x32_bf16 v[108:111], v[44:47], v[220:223], v[108:111]
    s_waitcnt lgkmcnt(2)
    v_cvt_pk_bf16_f32 v162, v16, v17
    v_accvgpr_read_b32 v231, a45
    v_exp_f32 v16, v164
    v_mul_f32 v228, v228, v49
    v_mul_f32 v229, v229, v49
    v_mfma_f32_16x16x32_bf16 v[176:179], v[24:27], a[240:243], v[136:139]
    ds_read_b128 v[40:43], v2 offset:128
    v_mul_f32 v230, v230, v49
    v_mfma_f32_16x16x32_bf16 v[176:179], v[28:31], a[244:247], v[176:179]
    v_add_f32 v7, v7, v18
    v_add_f32 v7, v7, v19
    v_mul_f32 v231, v231, v49
    v_cvt_pk_bf16_f32 v228, v228, v229
    v_exp_f32 v17, v165
    v_mfma_f32_16x16x32_bf16 v[180:183], v[24:27], v[200:203], v[140:143]
    ds_read_b128 v[44:47], v3 offset:128
    v_cvt_pk_bf16_f32 v229, v230, v231
    v_mfma_f32_16x16x32_bf16 v[180:183], v[28:31], v[204:207], v[180:183]
    s_waitcnt lgkmcnt(2)
    buffer_store_dwordx2 v[228:229], v56, s[12:15], s24 offen offset:640 sc0 sc1
    v_cvt_pk_bf16_f32 v163, v18, v19
    v_accvgpr_read_b32 v232, a10
    v_accvgpr_read_b32 v233, a22
    v_mfma_f32_16x16x32_bf16 v[112:115], v[32:35], a[240:243], v[136:139]
    ds_read_b128 v[24:27], v2 offset:6272
    v_accvgpr_read_b32 v234, a34
    v_mfma_f32_16x16x32_bf16 v[112:115], v[36:39], a[244:247], v[112:115]
    v_exp_f32 v18, v166
    v_accvgpr_read_b32 v235, a46
    v_add_f32 v8, v8, v16
    v_mul_f32 v232, v232, v50
    v_mfma_f32_16x16x32_bf16 v[116:119], v[32:35], v[200:203], v[140:143]
    ds_read_b128 v[28:31], v3 offset:6272
    v_add_f32 v8, v8, v17
    v_mfma_f32_16x16x32_bf16 v[116:119], v[36:39], v[204:207], v[116:119]
    s_waitcnt lgkmcnt(2)
    v_exp_f32 v19, v167
    v_mul_f32 v233, v233, v50
    v_mul_f32 v234, v234, v50
    v_mul_f32 v235, v235, v50
    v_cvt_pk_bf16_f32 v232, v232, v233
    v_mfma_f32_16x16x32_bf16 v[176:179], v[40:43], a[248:251], v[176:179]
    ds_read_b128 v[32:35], v2 offset:256
    v_cvt_pk_bf16_f32 v164, v16, v17
    v_mfma_f32_16x16x32_bf16 v[176:179], v[44:47], a[252:255], v[176:179]
    v_exp_f32 v16, v100
    v_cvt_pk_bf16_f32 v233, v234, v235
    v_accvgpr_read_b32 v236, a11
    v_accvgpr_read_b32 v237, a23
    v_add_f32 v8, v8, v18
    v_mfma_f32_16x16x32_bf16 v[180:183], v[40:43], v[208:211], v[180:183]
    ds_read_b128 v[36:39], v3 offset:256
    v_accvgpr_read_b32 v238, a35
    v_mfma_f32_16x16x32_bf16 v[180:183], v[44:47], v[212:215], v[180:183]
    s_waitcnt lgkmcnt(2)
    buffer_store_dwordx2 v[232:233], v56, s[12:15], s24 offen offset:1024 sc0 sc1
    v_add_f32 v8, v8, v19
    v_exp_f32 v17, v101
    v_mfma_f32_16x16x32_bf16 v[112:115], v[24:27], a[248:251], v[112:115]
    ds_read_b128 v[40:43], v2 offset:6400
    v_accvgpr_read_b32 v239, a47
    v_mfma_f32_16x16x32_bf16 v[112:115], v[28:31], a[252:255], v[112:115]
    v_mul_f32 v236, v236, v51
    v_cvt_pk_bf16_f32 v165, v18, v19
    v_mul_f32 v237, v237, v51
    v_mul_f32 v238, v238, v51
    v_exp_f32 v18, v102
    v_mfma_f32_16x16x32_bf16 v[116:119], v[24:27], v[208:211], v[116:119]
    ds_read_b128 v[44:47], v3 offset:6400
    v_mul_f32 v239, v239, v51
    v_mfma_f32_16x16x32_bf16 v[116:119], v[28:31], v[212:215], v[116:119]
    s_waitcnt lgkmcnt(2)
    v_add_f32 v8, v8, v16
    v_cvt_pk_bf16_f32 v236, v236, v237
    v_cvt_pk_bf16_f32 v237, v238, v239
    v_add_f32 v8, v8, v17
    v_accvgpr_read_b32 v240, a48
    v_accvgpr_read_b32 v241, a60
    v_mfma_f32_16x16x32_bf16 v[176:179], v[32:35], v[192:195], v[176:179]
    ds_read_b128 v[24:27], v2 offset:12288
    v_accvgpr_read_b32 v242, a72
    v_mfma_f32_16x16x32_bf16 v[176:179], v[36:39], v[196:199], v[176:179]
    buffer_store_dwordx2 v[236:237], v56, s[12:15], s24 offen offset:1408 sc0 sc1
    v_exp_f32 v19, v103
    v_cvt_pk_bf16_f32 v166, v16, v17
    v_mfma_f32_16x16x32_bf16 v[180:183], v[32:35], v[216:219], v[180:183]
    ds_read_b128 v[28:31], v3 offset:12288
    v_accvgpr_read_b32 v243, a84
    v_mfma_f32_16x16x32_bf16 v[180:183], v[36:39], v[220:223], v[180:183]
    s_waitcnt lgkmcnt(2)
    v_add_f32 v8, v8, v18
    v_add_f32 v8, v8, v19
    v_mul_f32 v240, v240, v52
    v_mul_f32 v241, v241, v52
    v_cvt_pk_bf16_f32 v167, v18, v19
    v_mul_f32 v242, v242, v52
    v_mfma_f32_16x16x32_bf16 v[112:115], v[40:43], v[192:195], v[112:115]
    ds_read_b128 v[32:35], v2 offset:18432
    v_mul_f32 v243, v243, v52
    v_mfma_f32_16x16x32_bf16 v[112:115], v[44:47], v[196:199], v[112:115]
    v_exp_f32 v16, v168
    v_cvt_pk_bf16_f32 v240, v240, v241
    v_cvt_pk_bf16_f32 v241, v242, v243
    v_exp_f32 v17, v169
    v_mfma_f32_16x16x32_bf16 v[116:119], v[40:43], v[216:219], v[116:119]
    ds_read_b128 v[36:39], v3 offset:18432
    v_accvgpr_read_b32 v244, a49
    v_mfma_f32_16x16x32_bf16 v[116:119], v[44:47], v[220:223], v[116:119]
    s_waitcnt lgkmcnt(2)
    buffer_store_dwordx2 v[240:241], v56, s[12:15], s40 offen offset:0 sc0 sc1
    v_exp_f32 v18, v170
    v_accvgpr_read_b32 v245, a61
    v_mfma_f32_16x16x32_bf16 v[184:187], v[24:27], a[240:243], v[136:139]
    ds_read_b128 v[40:43], v2 offset:12416
    v_accvgpr_read_b32 v246, a73
    v_mfma_f32_16x16x32_bf16 v[184:187], v[28:31], a[244:247], v[184:187]
    v_add_f32 v7, v7, v16
    v_accvgpr_read_b32 v247, a85
    v_mul_f32 v244, v244, v53
    v_add_f32 v7, v7, v17
    v_mul_f32 v245, v245, v53
    v_mul_f32 v246, v246, v53
    v_mfma_f32_16x16x32_bf16 v[188:191], v[24:27], v[200:203], v[140:143]
    ds_read_b128 v[44:47], v3 offset:12416
    v_mul_f32 v247, v247, v53
    v_mfma_f32_16x16x32_bf16 v[188:191], v[28:31], v[204:207], v[188:191]
    s_waitcnt lgkmcnt(2)
    v_exp_f32 v19, v171
    v_cvt_pk_bf16_f32 v168, v16, v17
    v_cvt_pk_bf16_f32 v244, v244, v245
    v_cvt_pk_bf16_f32 v245, v246, v247
    v_accvgpr_read_b32 v248, a50
    v_mfma_f32_16x16x32_bf16 v[120:123], v[32:35], a[240:243], v[136:139]
    ds_read_b128 v[24:27], v2 offset:18560
    v_accvgpr_read_b32 v249, a62
    v_mfma_f32_16x16x32_bf16 v[120:123], v[36:39], a[244:247], v[120:123]
    buffer_store_dwordx2 v[244:245], v56, s[12:15], s40 offen offset:384 sc0 sc1
    v_exp_f32 v16, v104
    v_mfma_f32_16x16x32_bf16 v[124:127], v[32:35], v[200:203], v[140:143]
    ds_read_b128 v[28:31], v3 offset:18560
    v_add_f32 v7, v7, v18
    v_mfma_f32_16x16x32_bf16 v[124:127], v[36:39], v[204:207], v[124:127]
    s_waitcnt lgkmcnt(2)
    v_add_f32 v7, v7, v19
    v_accvgpr_read_b32 v250, a74
    v_exp_f32 v17, v105
    v_accvgpr_read_b32 v251, a86
    v_mul_f32 v248, v248, v54
    v_mfma_f32_16x16x32_bf16 v[184:187], v[40:43], a[248:251], v[184:187]
    ds_read_b128 v[32:35], v2 offset:12544
    v_mul_f32 v249, v249, v54
    v_mfma_f32_16x16x32_bf16 v[184:187], v[44:47], a[252:255], v[184:187]
    v_cvt_pk_bf16_f32 v169, v18, v19
    v_exp_f32 v18, v106
    v_mul_f32 v250, v250, v54
    v_mul_f32 v251, v251, v54
    v_cvt_pk_bf16_f32 v248, v248, v249
    v_mfma_f32_16x16x32_bf16 v[188:191], v[40:43], v[208:211], v[188:191]
    ds_read_b128 v[36:39], v3 offset:12544
    v_add_f32 v7, v7, v16
    v_mfma_f32_16x16x32_bf16 v[188:191], v[44:47], v[212:215], v[188:191]
    s_waitcnt lgkmcnt(2)
    v_cvt_pk_bf16_f32 v249, v250, v251
    v_add_f32 v7, v7, v17
    v_accvgpr_read_b32 v252, a51
    v_accvgpr_read_b32 v253, a63
    v_exp_f32 v19, v107
    v_mfma_f32_16x16x32_bf16 v[120:123], v[24:27], a[248:251], v[120:123]
    ds_read_b128 v[40:43], v2 offset:18688
    v_accvgpr_read_b32 v254, a75
    v_mfma_f32_16x16x32_bf16 v[120:123], v[28:31], a[252:255], v[120:123]
    buffer_store_dwordx2 v[248:249], v56, s[12:15], s40 offen offset:768 sc0 sc1
    v_cvt_pk_bf16_f32 v170, v16, v17
    v_accvgpr_read_b32 v255, a87
    v_mul_f32 v252, v252, v55
    v_mfma_f32_16x16x32_bf16 v[124:127], v[24:27], v[208:211], v[124:127]
    ds_read_b128 v[44:47], v3 offset:18688
    v_mul_f32 v253, v253, v55
    v_mfma_f32_16x16x32_bf16 v[124:127], v[28:31], v[212:215], v[124:127]
    s_waitcnt lgkmcnt(2)
    v_add_u32 v22, 49152, v1
    v_mov_b32 v14, v1
    v_subrev_u32 v1, 49152, v1
    v_exp_f32 v16, v172
    v_mul_f32 v254, v254, v55
    v_mfma_f32_16x16x32_bf16 v[184:187], v[32:35], v[192:195], v[184:187]
    ds_read_b128 v[24:27], v22 offset:0
    v_add_f32 v7, v7, v18
    v_mfma_f32_16x16x32_bf16 v[184:187], v[36:39], v[196:199], v[184:187]
    v_add_f32 v7, v7, v19
    v_mul_f32 v255, v255, v55
    v_exp_f32 v17, v173
    v_cvt_pk_bf16_f32 v252, v252, v253
    v_cvt_pk_bf16_f32 v253, v254, v255
    v_mfma_f32_16x16x32_bf16 v[188:191], v[32:35], v[216:219], v[188:191]
    ds_read_b128 v[28:31], v22 offset:12288
    v_accvgpr_read_b32 v224, a52
    v_mfma_f32_16x16x32_bf16 v[188:191], v[36:39], v[220:223], v[188:191]
    s_waitcnt lgkmcnt(2)
    buffer_store_dwordx2 v[252:253], v56, s[12:15], s40 offen offset:1152 sc0 sc1
    v_cvt_pk_bf16_f32 v171, v18, v19
    v_accvgpr_read_b32 v225, a64
    v_accvgpr_read_b32 v226, a76
    v_mfma_f32_16x16x32_bf16 v[120:123], v[40:43], v[192:195], v[120:123]
    ds_read_b128 v[32:35], v22 offset:3072
    v_accvgpr_read_b32 v227, a88
    v_mfma_f32_16x16x32_bf16 v[120:123], v[44:47], v[196:199], v[120:123]
    v_exp_f32 v18, v174
    v_add_f32 v8, v8, v16
    v_mul_f32 v224, v224, v52
    v_mul_f32 v225, v225, v52
    v_add_f32 v8, v8, v17
    v_mfma_f32_16x16x32_bf16 v[124:127], v[40:43], v[216:219], v[124:127]
    ds_read_b128 v[36:39], v22 offset:15360
    v_mul_f32 v226, v226, v52
    v_mfma_f32_16x16x32_bf16 v[124:127], v[44:47], v[220:223], v[124:127]
    s_waitcnt lgkmcnt(2)
    v_exp_f32 v19, v175
    v_mul_f32 v227, v227, v52
    v_cvt_pk_bf16_f32 v224, v224, v225
    v_cvt_pk_bf16_f32 v225, v226, v227
    v_accvgpr_read_b32 v228, a53
    v_mfma_f32_16x16x32_bf16 a[96:99], v[80:83], v[24:27], a[96:99]
    ds_read_b128 v[40:43], v22 offset:6144
    v_cvt_pk_bf16_f32 v172, v16, v17
    v_mfma_f32_16x16x32_bf16 a[96:99], v[88:91], v[28:31], a[96:99]
    buffer_store_dwordx2 v[224:225], v56, s[12:15], s40 offen offset:128 sc0 sc1
    v_exp_f32 v16, v108
    v_accvgpr_read_b32 v229, a65
    v_mfma_f32_16x16x32_bf16 a[144:147], v[84:87], v[24:27], a[144:147]
    ds_read_b128 v[44:47], v22 offset:18432
    v_add_f32 v8, v8, v18
    v_mfma_f32_16x16x32_bf16 a[144:147], v[92:95], v[28:31], a[144:147]
    s_waitcnt lgkmcnt(2)
    v_add_f32 v8, v8, v19
    v_accvgpr_read_b32 v230, a77
    v_accvgpr_read_b32 v231, a89
    v_mul_f32 v228, v228, v53
    v_mul_f32 v229, v229, v53
    v_mul_f32 v230, v230, v53
    v_mfma_f32_16x16x32_bf16 a[108:111], v[80:83], v[32:35], a[108:111]
    ds_read_b128 v[24:27], v22 offset:9216
    v_mul_f32 v231, v231, v53
    v_mfma_f32_16x16x32_bf16 a[108:111], v[88:91], v[36:39], a[108:111]
    v_exp_f32 v17, v109
    v_cvt_pk_bf16_f32 v173, v18, v19
    v_cvt_pk_bf16_f32 v228, v228, v229
    v_cvt_pk_bf16_f32 v229, v230, v231
    v_accvgpr_read_b32 v232, a54
    v_mfma_f32_16x16x32_bf16 a[156:159], v[84:87], v[32:35], a[156:159]
    ds_read_b128 v[28:31], v22 offset:21504
    v_accvgpr_read_b32 v233, a66
    v_mfma_f32_16x16x32_bf16 a[156:159], v[92:95], v[36:39], a[156:159]
    s_waitcnt lgkmcnt(2)
    buffer_store_dwordx2 v[228:229], v56, s[12:15], s40 offen offset:512 sc0 sc1
    v_exp_f32 v18, v110
    v_mfma_f32_16x16x32_bf16 a[120:123], v[80:83], v[40:43], a[120:123]
    ds_read_b128 v[32:35], v1 offset:0
    v_add_f32 v8, v8, v16
    v_mfma_f32_16x16x32_bf16 a[120:123], v[88:91], v[44:47], a[120:123]
    v_add_f32 v8, v8, v17
    v_accvgpr_read_b32 v234, a78
    v_exp_f32 v19, v111
    v_accvgpr_read_b32 v235, a90
    v_mul_f32 v232, v232, v54
    v_mfma_f32_16x16x32_bf16 a[168:171], v[84:87], v[40:43], a[168:171]
    ds_read_b128 v[36:39], v1 offset:12288
    v_mul_f32 v233, v233, v54
    v_mfma_f32_16x16x32_bf16 a[168:171], v[92:95], v[44:47], a[168:171]
    s_waitcnt lgkmcnt(2)
    v_cvt_pk_bf16_f32 v174, v16, v17
    v_mul_f32 v234, v234, v54
    v_mul_f32 v235, v235, v54
    v_cvt_pk_bf16_f32 v232, v232, v233
    v_cvt_pk_bf16_f32 v233, v234, v235
    v_accvgpr_read_b32 v236, a55
    v_mfma_f32_16x16x32_bf16 a[132:135], v[80:83], v[24:27], a[132:135]
    ds_read_b128 v[40:43], v1 offset:3072
    v_add_f32 v8, v8, v18
    v_mfma_f32_16x16x32_bf16 a[132:135], v[88:91], v[28:31], a[132:135]
    buffer_store_dwordx2 v[232:233], v56, s[12:15], s40 offen offset:896 sc0 sc1
    v_add_f32 v8, v8, v19
    v_cvt_pk_bf16_f32 v175, v18, v19
    v_accvgpr_read_b32 v237, a67
    v_mfma_f32_16x16x32_bf16 a[180:183], v[84:87], v[24:27], a[180:183]
    ds_read_b128 v[44:47], v1 offset:15360
    v_accvgpr_read_b32 v238, a79
    v_mfma_f32_16x16x32_bf16 a[180:183], v[92:95], v[28:31], a[180:183]
    s_waitcnt lgkmcnt(2)
    v_exp_f32 v16, v176
    v_exp_f32 v17, v177
    v_exp_f32 v18, v178
    v_mfma_f32_16x16x32_bf16 a[96:99], v[160:163], v[32:35], a[96:99]
    ds_read_b128 v[24:27], v1 offset:6144
    v_add_f32 v7, v7, v16
    v_mfma_f32_16x16x32_bf16 a[96:99], v[168:171], v[36:39], a[96:99]
    v_add_f32 v7, v7, v17
    v_exp_f32 v19, v179
    v_cvt_pk_bf16_f32 v176, v16, v17
    v_exp_f32 v16, v112
    v_mfma_f32_16x16x32_bf16 a[144:147], v[164:167], v[32:35], a[144:147]
    ds_read_b128 v[28:31], v1 offset:18432
    v_add_f32 v7, v7, v18
    v_mfma_f32_16x16x32_bf16 a[144:147], v[172:175], v[36:39], a[144:147]
    s_waitcnt lgkmcnt(2)
    v_add_f32 v7, v7, v19
    v_exp_f32 v17, v113
    v_cvt_pk_bf16_f32 v177, v18, v19
    v_exp_f32 v18, v114
    v_mfma_f32_16x16x32_bf16 a[108:111], v[160:163], v[40:43], a[108:111]
    ds_read_b128 v[32:35], v1 offset:9216
    v_add_f32 v7, v7, v16
    v_mfma_f32_16x16x32_bf16 a[108:111], v[168:171], v[44:47], a[108:111]
    v_add_f32 v7, v7, v17
    v_exp_f32 v19, v115
    v_cvt_pk_bf16_f32 v178, v16, v17
    v_exp_f32 v16, v180
    v_mfma_f32_16x16x32_bf16 a[156:159], v[164:167], v[40:43], a[156:159]
    ds_read_b128 v[36:39], v1 offset:21504
    v_add_f32 v7, v7, v18
    v_mfma_f32_16x16x32_bf16 a[156:159], v[172:175], v[44:47], a[156:159]
    s_waitcnt lgkmcnt(2)
    v_add_f32 v7, v7, v19
    v_exp_f32 v17, v181
    v_cvt_pk_bf16_f32 v179, v18, v19
    v_exp_f32 v18, v182
    v_mfma_f32_16x16x32_bf16 a[120:123], v[160:163], v[24:27], a[120:123]
    ds_read_b128 v[40:43], v14 offset:0
    v_add_f32 v8, v8, v16
    v_mfma_f32_16x16x32_bf16 a[120:123], v[168:171], v[28:31], a[120:123]
    v_add_f32 v8, v8, v17
    v_exp_f32 v19, v183
    v_cvt_pk_bf16_f32 v180, v16, v17
    v_exp_f32 v16, v116
    v_mfma_f32_16x16x32_bf16 a[168:171], v[164:167], v[24:27], a[168:171]
    ds_read_b128 v[44:47], v14 offset:12288
    v_add_f32 v8, v8, v18
    v_mfma_f32_16x16x32_bf16 a[168:171], v[172:175], v[28:31], a[168:171]
    s_waitcnt lgkmcnt(2)
    v_add_f32 v8, v8, v19
    v_exp_f32 v17, v117
    v_cvt_pk_bf16_f32 v181, v18, v19
    v_exp_f32 v18, v118
    v_mfma_f32_16x16x32_bf16 a[132:135], v[160:163], v[32:35], a[132:135]
    ds_read_b128 v[24:27], v14 offset:3072
    v_add_f32 v8, v8, v16
    v_mfma_f32_16x16x32_bf16 a[132:135], v[168:171], v[36:39], a[132:135]
    v_add_f32 v8, v8, v17
    v_exp_f32 v19, v119
    v_cvt_pk_bf16_f32 v182, v16, v17
    v_add_f32 v8, v8, v18
    v_add_f32 v8, v8, v19
    v_cvt_pk_bf16_f32 v183, v18, v19
    v_exp_f32 v16, v184
    v_exp_f32 v17, v185
    v_exp_f32 v18, v186
    v_add_f32 v7, v7, v16
    v_add_f32 v7, v7, v17
    v_exp_f32 v19, v187
    v_cvt_pk_bf16_f32 v184, v16, v17
    v_exp_f32 v16, v120
    v_add_f32 v7, v7, v18
    v_add_f32 v7, v7, v19
    v_exp_f32 v17, v121
    v_cvt_pk_bf16_f32 v185, v18, v19
    v_exp_f32 v18, v122
    v_add_f32 v7, v7, v16
    v_add_f32 v7, v7, v17
    v_exp_f32 v19, v123
    v_cvt_pk_bf16_f32 v186, v16, v17
    v_exp_f32 v16, v188
    v_add_f32 v7, v7, v18
    v_add_f32 v7, v7, v19
    v_exp_f32 v17, v189
    v_cvt_pk_bf16_f32 v187, v18, v19
    v_exp_f32 v18, v190
    v_add_f32 v8, v8, v16
    v_add_f32 v8, v8, v17
    v_exp_f32 v19, v191
    v_cvt_pk_bf16_f32 v188, v16, v17
    v_exp_f32 v16, v124
    v_add_f32 v8, v8, v18
    v_add_f32 v8, v8, v19
    v_exp_f32 v17, v125
    v_cvt_pk_bf16_f32 v189, v18, v19
    v_exp_f32 v18, v126
    v_add_f32 v8, v8, v16
    v_add_f32 v8, v8, v17
    v_exp_f32 v19, v127
    v_cvt_pk_bf16_f32 v190, v16, v17
    v_add_f32 v8, v8, v18
    v_add_f32 v8, v8, v19
    v_cvt_pk_bf16_f32 v191, v18, v19
    v_mfma_f32_16x16x32_bf16 a[180:183], v[164:167], v[32:35], a[180:183]
    ds_read_b128 v[28:31], v14 offset:15360
    v_accvgpr_read_b32 v239, a91
    v_mfma_f32_16x16x32_bf16 a[180:183], v[172:175], v[36:39], a[180:183]
    s_waitcnt lgkmcnt(2)
    v_mul_f32 v236, v236, v55
    v_mul_f32 v237, v237, v55
    v_mul_f32 v238, v238, v55
    v_mul_f32 v239, v239, v55
    v_cvt_pk_bf16_f32 v236, v236, v237
    v_cvt_pk_bf16_f32 v237, v238, v239
    v_mfma_f32_16x16x4_f32 v[128:131], v7, v57, 0
    v_mfma_f32_16x16x32_bf16 a[96:99], v[176:179], v[40:43], a[96:99]
    ds_read_b128 v[32:35], v14 offset:6144
    v_accvgpr_read_b32 v240, a56
    v_mfma_f32_16x16x32_bf16 a[96:99], v[184:187], v[44:47], a[96:99]
    buffer_store_dwordx2 v[236:237], v56, s[12:15], s40 offen offset:1280 sc0 sc1
    v_accvgpr_read_b32 v241, a68
    v_accvgpr_read_b32 v242, a80
    v_accvgpr_read_b32 v243, a92
    v_mfma_f32_16x16x4_f32 v[132:135], v8, v57, 0
    v_mfma_f32_16x16x32_bf16 a[144:147], v[180:183], v[40:43], a[144:147]
    ds_read_b128 v[36:39], v14 offset:18432
    v_mul_f32 v240, v240, v52
    v_mfma_f32_16x16x32_bf16 a[144:147], v[188:191], v[44:47], a[144:147]
    s_waitcnt lgkmcnt(2)
    v_max3_f32 v18, v5, v6, v7
    v_mul_f32 v241, v241, v52
    v_max_f32 v18, v18, v8
    v_mul_f32 v242, v242, v52
    s_mov_b32 s29, 0x5f800000
    v_mfma_f32_16x16x32_bf16 a[108:111], v[176:179], v[24:27], a[108:111]
    ds_read_b128 v[40:43], v14 offset:9216
    v_mul_f32 v243, v243, v52
    v_mfma_f32_16x16x32_bf16 a[108:111], v[184:187], v[28:31], a[108:111]
    v_cmp_lt_f32 s[48:49], s29, v18
    v_cvt_pk_bf16_f32 v240, v240, v241
    v_cvt_pk_bf16_f32 v241, v242, v243
    v_accvgpr_read_b32 v244, a57
    v_accvgpr_read_b32 v245, a69
    v_accvgpr_read_b32 v246, a81
    v_mfma_f32_16x16x32_bf16 a[156:159], v[180:183], v[24:27], a[156:159]
    ds_read_b128 v[44:47], v14 offset:21504
    v_accvgpr_read_b32 v247, a93
    v_mfma_f32_16x16x32_bf16 a[156:159], v[188:191], v[28:31], a[156:159]
    s_waitcnt lgkmcnt(2)
    buffer_store_dwordx2 v[240:241], v56, s[12:15], s40 offen offset:256 sc0 sc1
    v_rcp_f32 v128, v128
    v_mul_f32 v244, v244, v53
    v_mfma_f32_16x16x32_bf16 a[120:123], v[176:179], v[32:35], a[120:123]
    ds_read_b128 v[24:27], v22 offset:1024
    v_mul_f32 v245, v245, v53
    v_mfma_f32_16x16x32_bf16 a[120:123], v[184:187], v[36:39], a[120:123]
    v_rcp_f32 v129, v129
    v_rcp_f32 v130, v130
    v_rcp_f32 v131, v131
    v_mfma_f32_16x16x32_bf16 a[168:171], v[180:183], v[32:35], a[168:171]
    ds_read_b128 v[28:31], v22 offset:13312
    v_mul_f32 v246, v246, v53
    v_mfma_f32_16x16x32_bf16 a[168:171], v[188:191], v[36:39], a[168:171]
    s_waitcnt lgkmcnt(2)
    v_rcp_f32 v132, v132
    v_mul_f32 v247, v247, v53
    v_cvt_pk_bf16_f32 v244, v244, v245
    v_rcp_f32 v133, v133
    v_mfma_f32_16x16x32_bf16 a[132:135], v[176:179], v[40:43], a[132:135]
    ds_read_b128 v[32:35], v22 offset:4096
    v_cvt_pk_bf16_f32 v245, v246, v247
    v_mfma_f32_16x16x32_bf16 a[132:135], v[184:187], v[44:47], a[132:135]
    buffer_store_dwordx2 v[244:245], v56, s[12:15], s40 offen offset:640 sc0 sc1
    v_rcp_f32 v134, v134
    v_accvgpr_read_b32 v248, a58
    v_mfma_f32_16x16x32_bf16 a[180:183], v[180:183], v[40:43], a[180:183]
    ds_read_b128 v[36:39], v22 offset:16384
    v_rcp_f32 v135, v135
    v_mfma_f32_16x16x32_bf16 a[180:183], v[188:191], v[44:47], a[180:183]
    s_waitcnt lgkmcnt(2)
    v_accvgpr_read_b32 v249, a70
    v_accvgpr_read_b32 v250, a82
    v_accvgpr_read_b32 v251, a94
    v_mul_f32 v248, v248, v54
    v_mul_f32 v249, v249, v54
    v_mfma_f32_16x16x32_bf16 a[100:103], v[80:83], v[24:27], a[100:103]
    ds_read_b128 v[40:43], v22 offset:7168
    v_mul_f32 v250, v250, v54
    v_mfma_f32_16x16x32_bf16 a[100:103], v[88:91], v[28:31], a[100:103]
    v_mul_f32 v251, v251, v54
    v_cvt_pk_bf16_f32 v248, v248, v249
    v_cvt_pk_bf16_f32 v249, v250, v251
    v_accvgpr_read_b32 v252, a59
    v_accvgpr_read_b32 v253, a71
    v_accvgpr_read_b32 v254, a83
    v_mfma_f32_16x16x32_bf16 a[148:151], v[84:87], v[24:27], a[148:151]
    ds_read_b128 v[44:47], v22 offset:19456
    v_accvgpr_read_b32 v255, a95
    v_mfma_f32_16x16x32_bf16 a[148:151], v[92:95], v[28:31], a[148:151]
    s_waitcnt lgkmcnt(2)
    s_cmp_lg_u64 s[48:49], 0
    s_cbranch_scc1 L_slow
    v_mul_f32 v252, v252, v55
    v_mul_f32 v253, v253, v55
    v_mfma_f32_16x16x32_bf16 a[112:115], v[80:83], v[32:35], a[112:115]
    ds_read_b128 v[24:27], v22 offset:10240
    v_mul_f32 v254, v254, v55
    v_mfma_f32_16x16x32_bf16 a[112:115], v[88:91], v[36:39], a[112:115]
    buffer_store_dwordx2 v[248:249], v56, s[12:15], s40 offen offset:1024 sc0 sc1
    v_mul_f32 v255, v255, v55
    v_cvt_pk_bf16_f32 v252, v252, v253
    v_cvt_pk_bf16_f32 v253, v254, v255
    v_mfma_f32_16x16x32_bf16 a[160:163], v[84:87], v[32:35], a[160:163]
    ds_read_b128 v[28:31], v22 offset:22528
    v_accvgpr_read_b32 v224, a96
    v_mfma_f32_16x16x32_bf16 a[160:163], v[92:95], v[36:39], a[160:163]
    s_waitcnt lgkmcnt(2)
    buffer_store_dwordx2 v[252:253], v56, s[12:15], s40 offen offset:1408 sc0 sc1
    v_accvgpr_read_b32 v225, a108
    v_accvgpr_read_b32 v226, a120
    v_accvgpr_read_b32 v227, a132
    v_mfma_f32_16x16x32_bf16 a[124:127], v[80:83], v[40:43], a[124:127]
    ds_read_b128 v[32:35], v1 offset:1024
    v_mul_f32 v224, v224, v128
    v_mfma_f32_16x16x32_bf16 a[124:127], v[88:91], v[44:47], a[124:127]
    v_mul_f32 v225, v225, v128
    v_mul_f32 v226, v226, v128
    v_mul_f32 v227, v227, v128
    v_cvt_pk_bf16_f32 v224, v224, v225
    v_cvt_pk_bf16_f32 v225, v226, v227
    v_accvgpr_read_b32 v228, a97
    v_mfma_f32_16x16x32_bf16 a[172:175], v[84:87], v[40:43], a[172:175]
    ds_read_b128 v[36:39], v1 offset:13312
    v_accvgpr_read_b32 v229, a109
    v_mfma_f32_16x16x32_bf16 a[172:175], v[92:95], v[44:47], a[172:175]
    s_waitcnt lgkmcnt(2)
    buffer_store_dwordx2 v[224:225], v56, s[12:15], s41 offen offset:0 sc0 sc1
    v_accvgpr_read_b32 v230, a121
    v_accvgpr_read_b32 v231, a133
    v_mul_f32 v228, v228, v129
    v_mfma_f32_16x16x32_bf16 a[136:139], v[80:83], v[24:27], a[136:139]
    ds_read_b128 v[40:43], v1 offset:4096
    v_mul_f32 v229, v229, v129
    v_mfma_f32_16x16x32_bf16 a[136:139], v[88:91], v[28:31], a[136:139]
    v_mul_f32 v230, v230, v129
    v_mul_f32 v231, v231, v129
    v_cvt_pk_bf16_f32 v228, v228, v229
    v_cvt_pk_bf16_f32 v229, v230, v231
    v_accvgpr_read_b32 v232, a98
    v_accvgpr_read_b32 v233, a110
    v_mfma_f32_16x16x32_bf16 a[184:187], v[84:87], v[24:27], a[184:187]
    ds_read_b128 v[44:47], v1 offset:16384
    v_accvgpr_read_b32 v234, a122
    v_mfma_f32_16x16x32_bf16 a[184:187], v[92:95], v[28:31], a[184:187]
    s_waitcnt lgkmcnt(2)
    buffer_store_dwordx2 v[228:229], v56, s[12:15], s41 offen offset:384 sc0 sc1
    v_accvgpr_read_b32 v235, a134
    v_mul_f32 v232, v232, v130
    v_mul_f32 v233, v233, v130
    v_mfma_f32_16x16x32_bf16 a[100:103], v[160:163], v[32:35], a[100:103]
    ds_read_b128 v[24:27], v1 offset:7168
    v_mul_f32 v234, v234, v130
    v_mfma_f32_16x16x32_bf16 a[100:103], v[168:171], v[36:39], a[100:103]
    v_mul_f32 v235, v235, v130
    v_cvt_pk_bf16_f32 v232, v232, v233
    v_cvt_pk_bf16_f32 v233, v234, v235
    v_accvgpr_read_b32 v236, a99
    v_accvgpr_read_b32 v237, a111
    v_accvgpr_read_b32 v238, a123
    v_mfma_f32_16x16x32_bf16 a[148:151], v[164:167], v[32:35], a[148:151]
    ds_read_b128 v[28:31], v1 offset:19456
    v_accvgpr_read_b32 v239, a135
    v_mfma_f32_16x16x32_bf16 a[148:151], v[172:175], v[36:39], a[148:151]
    s_waitcnt lgkmcnt(2)
    buffer_store_dwordx2 v[232:233], v56, s[12:15], s41 offen offset:768 sc0 sc1
    v_mul_f32 v236, v236, v131
    v_mul_f32 v237, v237, v131
    v_mul_f32 v238, v238, v131
    v_mfma_f32_16x16x32_bf16 a[112:115], v[160:163], v[40:43], a[112:115]
    ds_read_b128 v[32:35], v1 offset:10240
    v_mul_f32 v239, v239, v131
    v_mfma_f32_16x16x32_bf16 a[112:115], v[168:171], v[44:47], a[112:115]
    v_cvt_pk_bf16_f32 v236, v236, v237
    v_cvt_pk_bf16_f32 v237, v238, v239
    v_accvgpr_read_b32 v240, a144
    v_accvgpr_read_b32 v241, a156
    v_accvgpr_read_b32 v242, a168
    v_accvgpr_read_b32 v243, a180
    v_mfma_f32_16x16x32_bf16 a[160:163], v[164:167], v[40:43], a[160:163]
    ds_read_b128 v[36:39], v1 offset:22528
    v_mul_f32 v240, v240, v132
    v_mfma_f32_16x16x32_bf16 a[160:163], v[172:175], v[44:47], a[160:163]
    s_waitcnt lgkmcnt(2)
    buffer_store_dwordx2 v[236:237], v56, s[12:15], s41 offen offset:1152 sc0 sc1
    v_mul_f32 v241, v241, v132
    v_mul_f32 v242, v242, v132
    v_mul_f32 v243, v243, v132
    v_mfma_f32_16x16x32_bf16 a[124:127], v[160:163], v[24:27], a[124:127]
    ds_read_b128 v[40:43], v14 offset:1024
    v_cvt_pk_bf16_f32 v240, v240, v241
    v_mfma_f32_16x16x32_bf16 a[124:127], v[168:171], v[28:31], a[124:127]
    v_cvt_pk_bf16_f32 v241, v242, v243
    v_accvgpr_read_b32 v244, a145
    v_accvgpr_read_b32 v245, a157
    v_accvgpr_read_b32 v246, a169
    v_accvgpr_read_b32 v247, a181
    v_mfma_f32_16x16x32_bf16 a[172:175], v[164:167], v[24:27], a[172:175]
    ds_read_b128 v[44:47], v14 offset:13312
    v_mul_f32 v244, v244, v133
    v_mfma_f32_16x16x32_bf16 a[172:175], v[172:175], v[28:31], a[172:175]
    s_waitcnt lgkmcnt(2)
    buffer_store_dwordx2 v[240:241], v56, s[12:15], s42 offen offset:0 sc0 sc1
    v_mul_f32 v245, v245, v133
    v_mul_f32 v246, v246, v133
    v_mul_f32 v247, v247, v133
    v_mfma_f32_16x16x32_bf16 a[136:139], v[160:163], v[32:35], a[136:139]
    ds_read_b128 v[24:27], v14 offset:4096
    v_cvt_pk_bf16_f32 v244, v244, v245
    v_mfma_f32_16x16x32_bf16 a[136:139], v[168:171], v[36:39], a[136:139]
    v_cvt_pk_bf16_f32 v245, v246, v247
    v_accvgpr_read_b32 v248, a146
    v_accvgpr_read_b32 v249, a158
    v_accvgpr_read_b32 v250, a170
    v_accvgpr_read_b32 v251, a182
    v_mul_f32 v248, v248, v134
    v_mfma_f32_16x16x32_bf16 a[184:187], v[164:167], v[32:35], a[184:187]
    ds_read_b128 v[28:31], v14 offset:16384
    v_mul_f32 v249, v249, v134
    v_mfma_f32_16x16x32_bf16 a[184:187], v[172:175], v[36:39], a[184:187]
    s_waitcnt lgkmcnt(2)
    buffer_store_dwordx2 v[244:245], v56, s[12:15], s42 offen offset:384 sc0 sc1
    v_mul_f32 v250, v250, v134
    v_mul_f32 v251, v251, v134
    v_cvt_pk_bf16_f32 v248, v248, v249
    v_mfma_f32_16x16x32_bf16 a[100:103], v[176:179], v[40:43], a[100:103]
    ds_read_b128 v[32:35], v14 offset:7168
    v_cvt_pk_bf16_f32 v249, v250, v251
    v_mfma_f32_16x16x32_bf16 a[100:103], v[184:187], v[44:47], a[100:103]
    buffer_store_dwordx2 v[248:249], v56, s[12:15], s42 offen offset:768 sc0 sc1
    v_accvgpr_read_b32 v252, a147
    v_accvgpr_read_b32 v253, a159
    v_accvgpr_read_b32 v254, a171
    v_mfma_f32_16x16x32_bf16 a[148:151], v[180:183], v[40:43], a[148:151]
    ds_read_b128 v[36:39], v14 offset:19456
    v_accvgpr_read_b32 v255, a183
    v_mfma_f32_16x16x32_bf16 a[148:151], v[188:191], v[44:47], a[148:151]
    s_waitcnt lgkmcnt(2)
    v_mul_f32 v252, v252, v135
    v_mul_f32 v253, v253, v135
    v_mul_f32 v254, v254, v135
    v_mul_f32 v255, v255, v135
    v_cvt_pk_bf16_f32 v252, v252, v253
    v_cvt_pk_bf16_f32 v253, v254, v255
    v_mfma_f32_16x16x32_bf16 a[112:115], v[176:179], v[24:27], a[112:115]
    ds_read_b128 v[40:43], v14 offset:10240
    v_mfma_f32_16x16x32_bf16 a[112:115], v[184:187], v[28:31], a[112:115]
    buffer_store_dwordx2 v[252:253], v56, s[12:15], s42 offen offset:1152 sc0 sc1
    v_mfma_f32_16x16x32_bf16 a[160:163], v[180:183], v[24:27], a[160:163]
    ds_read_b128 v[44:47], v14 offset:22528
    v_mfma_f32_16x16x32_bf16 a[160:163], v[188:191], v[28:31], a[160:163]
    s_waitcnt lgkmcnt(2)
    v_mfma_f32_16x16x32_bf16 a[124:127], v[176:179], v[32:35], a[124:127]
    ds_read_b128 v[24:27], v22 offset:2048
    v_mfma_f32_16x16x32_bf16 a[124:127], v[184:187], v[36:39], a[124:127]
    v_mfma_f32_16x16x32_bf16 a[172:175], v[180:183], v[32:35], a[172:175]
    ds_read_b128 v[28:31], v22 offset:14336
    v_mfma_f32_16x16x32_bf16 a[172:175], v[188:191], v[36:39], a[172:175]
    s_waitcnt lgkmcnt(2)
    v_mfma_f32_16x16x32_bf16 a[136:139], v[176:179], v[40:43], a[136:139]
    ds_read_b128 v[32:35], v22 offset:5120
    v_mfma_f32_16x16x32_bf16 a[136:139], v[184:187], v[44:47], a[136:139]
    v_mfma_f32_16x16x32_bf16 a[184:187], v[180:183], v[40:43], a[184:187]
    ds_read_b128 v[36:39], v22 offset:17408
    v_mfma_f32_16x16x32_bf16 a[184:187], v[188:191], v[44:47], a[184:187]
    s_waitcnt lgkmcnt(2)
    v_mfma_f32_16x16x32_bf16 a[104:107], v[80:83], v[24:27], a[104:107]
    ds_read_b128 v[40:43], v22 offset:8192
    v_mfma_f32_16x16x32_bf16 a[104:107], v[88:91], v[28:31], a[104:107]
    v_mfma_f32_16x16x32_bf16 a[152:155], v[84:87], v[24:27], a[152:155]
    ds_read_b128 v[44:47], v22 offset:20480
    v_mfma_f32_16x16x32_bf16 a[152:155], v[92:95], v[28:31], a[152:155]
    s_waitcnt lgkmcnt(2)
    v_mfma_f32_16x16x32_bf16 a[116:119], v[80:83], v[32:35], a[116:119]
    ds_read_b128 v[24:27], v22 offset:11264
    v_accvgpr_read_b32 v224, a100
    v_mfma_f32_16x16x32_bf16 a[116:119], v[88:91], v[36:39], a[116:119]
    v_accvgpr_read_b32 v225, a112
    v_accvgpr_read_b32 v226, a124
    v_accvgpr_read_b32 v227, a136
    v_mul_f32 v224, v224, v128
    v_mul_f32 v225, v225, v128
    v_mul_f32 v226, v226, v128
    v_mul_f32 v227, v227, v128
    v_cvt_pk_bf16_f32 v224, v224, v225
    v_cvt_pk_bf16_f32 v225, v226, v227
    v_accvgpr_read_b32 v228, a101
    v_accvgpr_read_b32 v229, a113
    v_accvgpr_read_b32 v230, a125
    v_accvgpr_read_b32 v231, a137
    v_mul_f32 v228, v228, v129
    v_mul_f32 v229, v229, v129
    v_mul_f32 v230, v230, v129
    v_mul_f32 v231, v231, v129
    v_cvt_pk_bf16_f32 v228, v228, v229
    v_cvt_pk_bf16_f32 v229, v230, v231
    v_accvgpr_read_b32 v232, a102
    v_accvgpr_read_b32 v233, a114
    v_accvgpr_read_b32 v234, a126
    v_accvgpr_read_b32 v235, a138
    v_mul_f32 v232, v232, v130
    v_mul_f32 v233, v233, v130
    v_mul_f32 v234, v234, v130
    v_mul_f32 v235, v235, v130
    v_cvt_pk_bf16_f32 v232, v232, v233
    v_cvt_pk_bf16_f32 v233, v234, v235
    v_accvgpr_read_b32 v236, a103
    v_accvgpr_read_b32 v237, a115
    v_accvgpr_read_b32 v238, a127
    v_accvgpr_read_b32 v239, a139
    v_mul_f32 v236, v236, v131
    v_mul_f32 v237, v237, v131
    v_mul_f32 v238, v238, v131
    v_mfma_f32_16x16x32_bf16 a[164:167], v[84:87], v[32:35], a[164:167]
    ds_read_b128 v[28:31], v22 offset:23552
    v_mul_f32 v239, v239, v131
    v_mfma_f32_16x16x32_bf16 a[164:167], v[92:95], v[36:39], a[164:167]
    s_waitcnt lgkmcnt(2)
    buffer_store_dwordx2 v[224:225], v56, s[12:15], s41 offen offset:128 sc0 sc1
    v_cvt_pk_bf16_f32 v236, v236, v237
    v_cvt_pk_bf16_f32 v237, v238, v239
    v_accvgpr_read_b32 v240, a148
    v_mfma_f32_16x16x32_bf16 a[128:131], v[80:83], v[40:43], a[128:131]
    ds_read_b128 v[32:35], v1 offset:2048
    v_accvgpr_read_b32 v241, a160
    v_mfma_f32_16x16x32_bf16 a[128:131], v[88:91], v[44:47], a[128:131]
    buffer_store_dwordx2 v[228:229], v56, s[12:15], s41 offen offset:512 sc0 sc1
    v_accvgpr_read_b32 v242, a172
    v_accvgpr_read_b32 v243, a184
    v_mul_f32 v240, v240, v132
    v_mfma_f32_16x16x32_bf16 a[176:179], v[84:87], v[40:43], a[176:179]
    ds_read_b128 v[36:39], v1 offset:14336
    v_mul_f32 v241, v241, v132
    v_mfma_f32_16x16x32_bf16 a[176:179], v[92:95], v[44:47], a[176:179]
    s_waitcnt lgkmcnt(2)
    buffer_store_dwordx2 v[232:233], v56, s[12:15], s41 offen offset:896 sc0 sc1
    v_mul_f32 v242, v242, v132
    v_mul_f32 v243, v243, v132
    v_cvt_pk_bf16_f32 v240, v240, v241
    v_mfma_f32_16x16x32_bf16 a[140:143], v[80:83], v[24:27], a[140:143]
    ds_read_b128 v[40:43], v1 offset:5120
    v_cvt_pk_bf16_f32 v241, v242, v243
    v_mfma_f32_16x16x32_bf16 a[140:143], v[88:91], v[28:31], a[140:143]
    buffer_store_dwordx2 v[236:237], v56, s[12:15], s41 offen offset:1280 sc0 sc1
    v_accvgpr_read_b32 v244, a149
    v_accvgpr_read_b32 v245, a161
    v_accvgpr_read_b32 v246, a173
    v_mfma_f32_16x16x32_bf16 a[188:191], v[84:87], v[24:27], a[188:191]
    ds_read_b128 v[44:47], v1 offset:17408
    v_accvgpr_read_b32 v247, a185
    v_mfma_f32_16x16x32_bf16 a[188:191], v[92:95], v[28:31], a[188:191]
    s_waitcnt lgkmcnt(2)
    buffer_store_dwordx2 v[240:241], v56, s[12:15], s42 offen offset:128 sc0 sc1
    v_mul_f32 v244, v244, v133
    v_mul_f32 v245, v245, v133
    v_mul_f32 v246, v246, v133
    v_mfma_f32_16x16x32_bf16 a[104:107], v[160:163], v[32:35], a[104:107]
    ds_read_b128 v[24:27], v1 offset:8192
    v_mul_f32 v247, v247, v133
    v_mfma_f32_16x16x32_bf16 a[104:107], v[168:171], v[36:39], a[104:107]
    v_cvt_pk_bf16_f32 v244, v244, v245
    v_cvt_pk_bf16_f32 v245, v246, v247
    v_accvgpr_read_b32 v248, a150
    v_accvgpr_read_b32 v249, a162
    v_accvgpr_read_b32 v250, a174
    v_accvgpr_read_b32 v251, a186
    v_mfma_f32_16x16x32_bf16 a[152:155], v[164:167], v[32:35], a[152:155]
    ds_read_b128 v[28:31], v1 offset:20480
    v_mul_f32 v248, v248, v134
    v_mfma_f32_16x16x32_bf16 a[152:155], v[172:175], v[36:39], a[152:155]
    s_waitcnt lgkmcnt(2)
    buffer_store_dwordx2 v[244:245], v56, s[12:15], s42 offen offset:512 sc0 sc1
    v_mul_f32 v249, v249, v134
    v_mul_f32 v250, v250, v134
    v_mul_f32 v251, v251, v134
    v_mfma_f32_16x16x32_bf16 a[116:119], v[160:163], v[40:43], a[116:119]
    ds_read_b128 v[32:35], v1 offset:11264
    v_cvt_pk_bf16_f32 v248, v248, v249
    v_mfma_f32_16x16x32_bf16 a[116:119], v[168:171], v[44:47], a[116:119]
    v_cvt_pk_bf16_f32 v249, v250, v251
    v_accvgpr_read_b32 v252, a151
    v_accvgpr_read_b32 v253, a163
    v_accvgpr_read_b32 v254, a175
    v_accvgpr_read_b32 v255, a187
    v_mul_f32 v252, v252, v135
    v_mfma_f32_16x16x32_bf16 a[164:167], v[164:167], v[40:43], a[164:167]
    ds_read_b128 v[36:39], v1 offset:23552
    v_mul_f32 v253, v253, v135
    v_mfma_f32_16x16x32_bf16 a[164:167], v[172:175], v[44:47], a[164:167]
    s_waitcnt lgkmcnt(2)
    buffer_store_dwordx2 v[248:249], v56, s[12:15], s42 offen offset:896 sc0 sc1
    v_mul_f32 v254, v254, v135
    v_mul_f32 v255, v255, v135
    v_cvt_pk_bf16_f32 v252, v252, v253
    v_mfma_f32_16x16x32_bf16 a[128:131], v[160:163], v[24:27], a[128:131]
    ds_read_b128 v[40:43], v14 offset:2048
    v_cvt_pk_bf16_f32 v253, v254, v255
    v_mfma_f32_16x16x32_bf16 a[128:131], v[168:171], v[28:31], a[128:131]
    buffer_store_dwordx2 v[252:253], v56, s[12:15], s42 offen offset:1280 sc0 sc1
    v_mfma_f32_16x16x32_bf16 a[176:179], v[164:167], v[24:27], a[176:179]
    ds_read_b128 v[44:47], v14 offset:14336
    v_mfma_f32_16x16x32_bf16 a[176:179], v[172:175], v[28:31], a[176:179]
    s_waitcnt lgkmcnt(2)
    v_mfma_f32_16x16x32_bf16 a[140:143], v[160:163], v[32:35], a[140:143]
    ds_read_b128 v[24:27], v14 offset:5120
    v_mfma_f32_16x16x32_bf16 a[140:143], v[168:171], v[36:39], a[140:143]
    v_mfma_f32_16x16x32_bf16 a[188:191], v[164:167], v[32:35], a[188:191]
    ds_read_b128 v[28:31], v14 offset:17408
    v_mfma_f32_16x16x32_bf16 a[188:191], v[172:175], v[36:39], a[188:191]
    s_waitcnt lgkmcnt(2)
    v_mfma_f32_16x16x32_bf16 a[104:107], v[176:179], v[40:43], a[104:107]
    ds_read_b128 v[32:35], v14 offset:8192
    v_mfma_f32_16x16x32_bf16 a[104:107], v[184:187], v[44:47], a[104:107]
    v_mfma_f32_16x16x32_bf16 a[152:155], v[180:183], v[40:43], a[152:155]
    ds_read_b128 v[36:39], v14 offset:20480
    v_mfma_f32_16x16x32_bf16 a[152:155], v[188:191], v[44:47], a[152:155]
    s_waitcnt lgkmcnt(2)
    v_mfma_f32_16x16x32_bf16 a[116:119], v[176:179], v[24:27], a[116:119]
    ds_read_b128 v[40:43], v14 offset:11264
    v_mfma_f32_16x16x32_bf16 a[116:119], v[184:187], v[28:31], a[116:119]
    v_mfma_f32_16x16x32_bf16 a[164:167], v[180:183], v[24:27], a[164:167]
    ds_read_b128 v[44:47], v14 offset:23552
    v_mfma_f32_16x16x32_bf16 a[164:167], v[188:191], v[28:31], a[164:167]
    s_waitcnt lgkmcnt(2)
    v_mfma_f32_16x16x32_bf16 a[128:131], v[176:179], v[32:35], a[128:131]
    v_mfma_f32_16x16x32_bf16 a[128:131], v[184:187], v[36:39], a[128:131]
    v_mfma_f32_16x16x32_bf16 a[176:179], v[180:183], v[32:35], a[176:179]
    v_mfma_f32_16x16x32_bf16 a[176:179], v[188:191], v[36:39], a[176:179]
    s_waitcnt lgkmcnt(0)
    v_mfma_f32_16x16x32_bf16 a[140:143], v[176:179], v[40:43], a[140:143]
    v_mfma_f32_16x16x32_bf16 a[140:143], v[184:187], v[44:47], a[140:143]
    v_mfma_f32_16x16x32_bf16 a[188:191], v[180:183], v[40:43], a[188:191]
    v_mfma_f32_16x16x32_bf16 a[188:191], v[188:191], v[44:47], a[188:191]
    s_nop 7
    v_accvgpr_read_b32 v224, a104
    v_accvgpr_read_b32 v225, a116
    v_accvgpr_read_b32 v226, a128
    v_accvgpr_read_b32 v227, a140
    v_pk_mul_f32 v[224:225], v[224:225], v[128:129] op_sel_hi:[1,0]
    v_pk_mul_f32 v[226:227], v[226:227], v[128:129] op_sel_hi:[1,0]
    v_cvt_pk_bf16_f32 v224, v224, v225
    v_cvt_pk_bf16_f32 v225, v226, v227
    v_accvgpr_read_b32 v228, a105
    v_accvgpr_read_b32 v229, a117
    v_accvgpr_read_b32 v230, a129
    v_accvgpr_read_b32 v231, a141
    v_pk_mul_f32 v[228:229], v[228:229], v[128:129] op_sel:[0,1] op_sel_hi:[1,1]
    v_pk_mul_f32 v[230:231], v[230:231], v[128:129] op_sel:[0,1] op_sel_hi:[1,1]
    v_cvt_pk_bf16_f32 v228, v228, v229
    v_cvt_pk_bf16_f32 v229, v230, v231
    buffer_store_dwordx2 v[224:225], v56, s[12:15], s41 offen offset:256 sc0 sc1
    v_accvgpr_read_b32 v232, a106
    v_accvgpr_read_b32 v233, a118
    v_accvgpr_read_b32 v234, a130
    v_accvgpr_read_b32 v235, a142
    v_pk_mul_f32 v[232:233], v[232:233], v[130:131] op_sel_hi:[1,0]
    v_pk_mul_f32 v[234:235], v[234:235], v[130:131] op_sel_hi:[1,0]
    v_cvt_pk_bf16_f32 v232, v232, v233
    v_cvt_pk_bf16_f32 v233, v234, v235
    buffer_store_dwordx2 v[228:229], v56, s[12:15], s41 offen offset:640 sc0 sc1
    v_accvgpr_read_b32 v236, a107
    v_accvgpr_read_b32 v237, a119
    v_accvgpr_read_b32 v238, a131
    v_accvgpr_read_b32 v239, a143
    v_pk_mul_f32 v[236:237], v[236:237], v[130:131] op_sel:[0,1] op_sel_hi:[1,1]
    v_pk_mul_f32 v[238:239], v[238:239], v[130:131] op_sel:[0,1] op_sel_hi:[1,1]
    v_cvt_pk_bf16_f32 v236, v236, v237
    v_cvt_pk_bf16_f32 v237, v238, v239
    buffer_store_dwordx2 v[232:233], v56, s[12:15], s41 offen offset:1024 sc0 sc1
    buffer_store_dwordx2 v[236:237], v56, s[12:15], s41 offen offset:1408 sc0 sc1
    v_accvgpr_read_b32 v240, a152
    v_accvgpr_read_b32 v241, a164
    v_accvgpr_read_b32 v242, a176
    v_accvgpr_read_b32 v243, a188
    v_pk_mul_f32 v[240:241], v[240:241], v[132:133] op_sel_hi:[1,0]
    v_pk_mul_f32 v[242:243], v[242:243], v[132:133] op_sel_hi:[1,0]
    v_cvt_pk_bf16_f32 v240, v240, v241
    v_cvt_pk_bf16_f32 v241, v242, v243
    v_accvgpr_read_b32 v244, a153
    v_accvgpr_read_b32 v245, a165
    v_accvgpr_read_b32 v246, a177
    v_accvgpr_read_b32 v247, a189
    v_pk_mul_f32 v[244:245], v[244:245], v[132:133] op_sel:[0,1] op_sel_hi:[1,1]
    v_pk_mul_f32 v[246:247], v[246:247], v[132:133] op_sel:[0,1] op_sel_hi:[1,1]
    v_cvt_pk_bf16_f32 v244, v244, v245
    v_cvt_pk_bf16_f32 v245, v246, v247
    buffer_store_dwordx2 v[240:241], v56, s[12:15], s42 offen offset:256 sc0 sc1
    v_accvgpr_read_b32 v248, a154
    v_accvgpr_read_b32 v249, a166
    v_accvgpr_read_b32 v250, a178
    v_accvgpr_read_b32 v251, a190
    v_pk_mul_f32 v[248:249], v[248:249], v[134:135] op_sel_hi:[1,0]
    v_pk_mul_f32 v[250:251], v[250:251], v[134:135] op_sel_hi:[1,0]
    v_cvt_pk_bf16_f32 v248, v248, v249
    v_cvt_pk_bf16_f32 v249, v250, v251
    buffer_store_dwordx2 v[244:245], v56, s[12:15], s42 offen offset:640 sc0 sc1
    v_accvgpr_read_b32 v252, a155
    v_accvgpr_read_b32 v253, a167
    v_accvgpr_read_b32 v254, a179
    v_accvgpr_read_b32 v255, a191
    v_pk_mul_f32 v[252:253], v[252:253], v[134:135] op_sel:[0,1] op_sel_hi:[1,1]
    v_pk_mul_f32 v[254:255], v[254:255], v[134:135] op_sel:[0,1] op_sel_hi:[1,1]
    v_cvt_pk_bf16_f32 v252, v252, v253
    v_cvt_pk_bf16_f32 v253, v254, v255
    buffer_store_dwordx2 v[248:249], v56, s[12:15], s42 offen offset:1024 sc0 sc1
    buffer_store_dwordx2 v[252:253], v56, s[12:15], s42 offen offset:1408 sc0 sc1
L_fin:
L_done:
    s_endpgm
L_pollslow0:
    s_mov_b32 s59, 60
L_pollsm0:
    s_buffer_load_dwordx8 s[48:55], s[20:23], s44 glc
    s_waitcnt lgkmcnt(0)
    s_sub_u32 s48, s48, s92
    s_sub_u32 s49, s49, s92
    s_sub_u32 s50, s50, s92
    s_sub_u32 s51, s51, s92
    s_sub_u32 s52, s52, s92
    s_sub_u32 s53, s53, s92
    s_sub_u32 s54, s54, s92
    s_sub_u32 s55, s55, s92
    s_max_u32 s48, s48, s49
    s_max_u32 s48, s48, s50
    s_max_u32 s48, s48, s51
    s_max_u32 s48, s48, s52
    s_max_u32 s48, s48, s53
    s_max_u32 s48, s48, s54
    s_max_u32 s48, s48, s55
    s_cmp_lt_u32 s48, 16
    s_cbranch_scc1 L_pollok0
    s_sub_u32 s59, s59, 1
    s_cbranch_scc1 L_pollvec0
    s_sleep 1
    s_branch L_pollsm0
L_pollvec0:
    v_bfe_u32 v53, v4, 4, 6
    v_lshlrev_b32 v53, 2, v53
    s_sub_u32 s96, s96, 1
    s_cbranch_scc1 L_pollgiveup0
    s_sleep 2
    buffer_load_dword v52, v53, s[20:23], s44 offen sc1
    s_waitcnt vmcnt(0)
    s_cmp_lg_u32 s44, 0
    s_cbranch_scc1 L_nomix
    v_xor_b32 v53, s92, v52
    v_lshrrev_b32 v53, 5, v53
    v_add_u32 v53, -1, v53
    v_cmp_gt_u32 vcc, 31, v53
    s_nop 1
    s_and_b32 s59, vcc_lo, 0xff00
    s_cbranch_scc0 L_nomix
    buffer_store_dwordx4 v[224:227], v11, s[4:7], s33 offen offset:0 sc1
    v_xor_b32 v55, 16, v11
    buffer_store_dwordx4 v[228:231], v55, s[4:7], s33 offen offset:768 sc1
    v_xor_b32 v54, 32, v11
    buffer_store_dwordx4 v[232:235], v54, s[4:7], s33 offen offset:1536 sc1
    v_xor_b32 v55, 48, v11
    buffer_store_dwordx4 v[236:239], v55, s[4:7], s33 offen offset:2304 sc1
    buffer_store_dwordx4 v[112:115], v20, s[4:7], s35 offen offset:0 sc1
    buffer_store_dwordx4 v[116:119], v20, s[4:7], s35 offen offset:3072 sc1
    buffer_store_dwordx4 v[120:123], v20, s[4:7], s17 offen offset:0 sc1
    buffer_store_dwordx4 v[124:127], v20, s[4:7], s17 offen offset:3072 sc1
    s_waitcnt vmcnt(0)
    s_barrier
    s_and_b32 s92, s92, 0xfffffc00
    s_add_u32 s92, s92, 512
    v_mov_b32 v0, s92
    s_add_u32 s92, s92, 1
    s_mov_b32 s44, 32
    v_add_u32 v0, 1, v0
    buffer_store_dword v0, v13, s[20:23], 0 offen offset:32 sc1
    s_branch L_pollvec0
L_nomix:
    v_subrev_u32 v52, s92, v52
    v_cmp_lt_u32 vcc, 15, v52
    s_nop 0
    s_and_b32 s59, vcc_lo, 0xff
    s_cbranch_scc1 L_pollvec0
    s_branch L_pollok0
L_pollgiveup0:
    s_mov_b32 s96, 0
    s_branch L_pollok0
L_pollslow1:
    s_mov_b32 s59, 200
L_pollsm1:
    s_buffer_load_dwordx8 s[48:55], s[20:23], s44 glc
    s_waitcnt lgkmcnt(0)
    s_sub_u32 s48, s48, s92
    s_sub_u32 s49, s49, s92
    s_sub_u32 s50, s50, s92
    s_sub_u32 s51, s51, s92
    s_sub_u32 s52, s52, s92
    s_sub_u32 s53, s53, s92
    s_sub_u32 s54, s54, s92
    s_sub_u32 s55, s55, s92
    s_max_u32 s48, s48, s49
    s_max_u32 s48, s48, s50
    s_max_u32 s48, s48, s51
    s_max_u32 s48, s48, s52
    s_max_u32 s48, s48, s53
    s_max_u32 s48, s48, s54
    s_max_u32 s48, s48, s55
    s_cmp_lt_u32 s48, 16
    s_cbranch_scc1 L_pollok1
    s_sub_u32 s59, s59, 1
    s_cbranch_scc1 L_pollvec1
    s_sleep 1
    s_branch L_pollsm1
L_pollvec1:
    v_bfe_u32 v53, v4, 4, 6
    v_lshlrev_b32 v53, 2, v53
    s_sub_u32 s96, s96, 1
    s_cbranch_scc1 L_pollgiveup1
    s_sleep 2
    buffer_load_dword v52, v53, s[20:23], s44 offen sc1
    s_waitcnt vmcnt(0)
    v_subrev_u32 v52, s92, v52
    v_cmp_lt_u32 vcc, 15, v52
    s_nop 0
    s_and_b32 s59, vcc_lo, 0xff
    s_cbranch_scc1 L_pollvec1
    s_branch L_pollok1
L_pollgiveup1:
    s_mov_b32 s96, 0
    s_branch L_pollok1
L_pollslow2:
    s_mov_b32 s59, 200
L_pollsm2:
    s_buffer_load_dwordx8 s[48:55], s[20:23], s44 glc
    s_waitcnt lgkmcnt(0)
    s_sub_u32 s48, s48, s92
    s_sub_u32 s49, s49, s92
    s_sub_u32 s50, s50, s92
    s_sub_u32 s51, s51, s92
    s_sub_u32 s52, s52, s92
    s_sub_u32 s53, s53, s92
    s_sub_u32 s54, s54, s92
    s_sub_u32 s55, s55, s92
    s_max_u32 s48, s48, s49
    s_max_u32 s48, s48, s50
    s_max_u32 s48, s48, s51
    s_max_u32 s48, s48, s52
    s_max_u32 s48, s48, s53
    s_max_u32 s48, s48, s54
    s_max_u32 s48, s48, s55
    s_cmp_lt_u32 s48, 16
    s_cbranch_scc1 L_pollok2
    s_sub_u32 s59, s59, 1
    s_cbranch_scc1 L_pollvec2
    s_sleep 1
    s_branch L_pollsm2
L_pollvec2:
    v_bfe_u32 v53, v4, 4, 6
    v_lshlrev_b32 v53, 2, v53
    s_sub_u32 s96, s96, 1
    s_cbranch_scc1 L_pollgiveup2
    s_sleep 2
    buffer_load_dword v52, v53, s[20:23], s44 offen sc1
    s_waitcnt vmcnt(0)
    v_subrev_u32 v52, s92, v52
    v_cmp_lt_u32 vcc, 15, v52
    s_nop 0
    s_and_b32 s59, vcc_lo, 0xff
    s_cbranch_scc1 L_pollvec2
    s_branch L_pollok2
L_pollgiveup2:
    s_mov_b32 s96, 0
    s_branch L_pollok2
L_tagslow:
    s_sub_u32 s96, s96, 1
    s_cbranch_scc1 L_taggiveup
    s_sleep 2
    buffer_load_dword v0, off, s[88:91], s93 sc1
    s_waitcnt vmcnt(0)
    v_readfirstlane_b32 s42, v0
    s_nop 0
    s_cmp_eq_u32 s42, s46
    s_cbranch_scc1 L_tagslow
    s_cmp_eq_u32 s42, 0
    s_cbranch_scc1 L_tagslow
    s_branch L_tagok
L_taggiveup:
    s_mov_b32 s96, 0
    s_branch L_tagok
L_slow:
    s_waitcnt vmcnt(0) lgkmcnt(0)
    s_nop 15
    v_accvgpr_write_b32 a0, 0
    v_accvgpr_write_b32 a1, 0
    v_accvgpr_write_b32 a2, 0
    v_accvgpr_write_b32 a3, 0
    v_accvgpr_write_b32 a4, 0
    v_accvgpr_write_b32 a5, 0
    v_accvgpr_write_b32 a6, 0
    v_accvgpr_write_b32 a7, 0
    v_accvgpr_write_b32 a8, 0
    v_accvgpr_write_b32 a9, 0
    v_accvgpr_write_b32 a10, 0
    v_accvgpr_write_b32 a11, 0
    v_accvgpr_write_b32 a12, 0
    v_accvgpr_write_b32 a13, 0
    v_accvgpr_write_b32 a14, 0
    v_accvgpr_write_b32 a15, 0
    v_accvgpr_write_b32 a16, 0
    v_accvgpr_write_b32 a17, 0
    v_accvgpr_write_b32 a18, 0
    v_accvgpr_write_b32 a19, 0
    v_accvgpr_write_b32 a20, 0
    v_accvgpr_write_b32 a21, 0
    v_accvgpr_write_b32 a22, 0
    v_accvgpr_write_b32 a23, 0
    v_accvgpr_write_b32 a24, 0
    v_accvgpr_write_b32 a25, 0
    v_accvgpr_write_b32 a26, 0
    v_accvgpr_write_b32 a27, 0
    v_accvgpr_write_b32 a28, 0
    v_accvgpr_write_b32 a29, 0
    v_accvgpr_write_b32 a30, 0
    v_accvgpr_write_b32 a31, 0
    v_accvgpr_write_b32 a32, 0
    v_accvgpr_write_b32 a33, 0
    v_accvgpr_write_b32 a34, 0
    v_accvgpr_write_b32 a35, 0
    v_accvgpr_write_b32 a36, 0
    v_accvgpr_write_b32 a37, 0
    v_accvgpr_write_b32 a38, 0
    v_accvgpr_write_b32 a39, 0
    v_accvgpr_write_b32 a40, 0
    v_accvgpr_write_b32 a41, 0
    v_accvgpr_write_b32 a42, 0
    v_accvgpr_write_b32 a43, 0
    v_accvgpr_write_b32 a44, 0
    v_accvgpr_write_b32 a45, 0
    v_accvgpr_write_b32 a46, 0
    v_accvgpr_write_b32 a47, 0
    v_accvgpr_write_b32 a48, 0
    v_accvgpr_write_b32 a49, 0
    v_accvgpr_write_b32 a50, 0
    v_accvgpr_write_b32 a51, 0
    v_accvgpr_write_b32 a52, 0
    v_accvgpr_write_b32 a53, 0
    v_accvgpr_write_b32 a54, 0
    v_accvgpr_write_b32 a55, 0
    v_accvgpr_write_b32 a56, 0
    v_accvgpr_write_b32 a57, 0
    v_accvgpr_write_b32 a58, 0
    v_accvgpr_write_b32 a59, 0
    v_accvgpr_write_b32 a60, 0
    v_accvgpr_write_b32 a61, 0
    v_accvgpr_write_b32 a62, 0
    v_accvgpr_write_b32 a63, 0
    v_accvgpr_write_b32 a64, 0
    v_accvgpr_write_b32 a65, 0
    v_accvgpr_write_b32 a66, 0
    v_accvgpr_write_b32 a67, 0
    v_accvgpr_write_b32 a68, 0
    v_accvgpr_write_b32 a69, 0
    v_accvgpr_write_b32 a70, 0
    v_accvgpr_write_b32 a71, 0
    v_accvgpr_write_b32 a72, 0
    v_accvgpr_write_b32 a73, 0
    v_accvgpr_write_b32 a74, 0
    v_accvgpr_write_b32 a75, 0
    v_accvgpr_write_b32 a76, 0
    v_accvgpr_write_b32 a77, 0
    v_accvgpr_write_b32 a78, 0
    v_accvgpr_write_b32 a79, 0
    v_accvgpr_write_b32 a80, 0
    v_accvgpr_write_b32 a81, 0
    v_accvgpr_write_b32 a82, 0
    v_accvgpr_write_b32 a83, 0
    v_accvgpr_write_b32 a84, 0
    v_accvgpr_write_b32 a85, 0
    v_accvgpr_write_b32 a86, 0
    v_accvgpr_write_b32 a87, 0
    v_accvgpr_write_b32 a88, 0
    v_accvgpr_write_b32 a89, 0
    v_accvgpr_write_b32 a90, 0
    v_accvgpr_write_b32 a91, 0
    v_accvgpr_write_b32 a92, 0
    v_accvgpr_write_b32 a93, 0
    v_accvgpr_write_b32 a94, 0
    v_accvgpr_write_b32 a95, 0
    v_accvgpr_write_b32 a96, 0
    v_accvgpr_write_b32 a97, 0
    v_accvgpr_write_b32 a98, 0
    v_accvgpr_write_b32 a99, 0
    v_accvgpr_write_b32 a100, 0
    v_accvgpr_write_b32 a101, 0
    v_accvgpr_write_b32 a102, 0
    v_accvgpr_write_b32 a103, 0
    v_accvgpr_write_b32 a104, 0
    v_accvgpr_write_b32 a105, 0
    v_accvgpr_write_b32 a106, 0
    v_accvgpr_write_b32 a107, 0
    v_accvgpr_write_b32 a108, 0
    v_accvgpr_write_b32 a109, 0
    v_accvgpr_write_b32 a110, 0
    v_accvgpr_write_b32 a111, 0
    v_accvgpr_write_b32 a112, 0
    v_accvgpr_write_b32 a113, 0
    v_accvgpr_write_b32 a114, 0
    v_accvgpr_write_b32 a115, 0
    v_accvgpr_write_b32 a116, 0
    v_accvgpr_write_b32 a117, 0
    v_accvgpr_write_b32 a118, 0
    v_accvgpr_write_b32 a119, 0
    v_accvgpr_write_b32 a120, 0
    v_accvgpr_write_b32 a121, 0
    v_accvgpr_write_b32 a122, 0
    v_accvgpr_write_b32 a123, 0
    v_accvgpr_write_b32 a124, 0
    v_accvgpr_write_b32 a125, 0
    v_accvgpr_write_b32 a126, 0
    v_accvgpr_write_b32 a127, 0
    v_accvgpr_write_b32 a128, 0
    v_accvgpr_write_b32 a129, 0
    v_accvgpr_write_b32 a130, 0
    v_accvgpr_write_b32 a131, 0
    v_accvgpr_write_b32 a132, 0
    v_accvgpr_write_b32 a133, 0
    v_accvgpr_write_b32 a134, 0
    v_accvgpr_write_b32 a135, 0
    v_accvgpr_write_b32 a136, 0
    v_accvgpr_write_b32 a137, 0
    v_accvgpr_write_b32 a138, 0
    v_accvgpr_write_b32 a139, 0
    v_accvgpr_write_b32 a140, 0
    v_accvgpr_write_b32 a141, 0
    v_accvgpr_write_b32 a142, 0
    v_accvgpr_write_b32 a143, 0
    v_accvgpr_write_b32 a144, 0
    v_accvgpr_write_b32 a145, 0
    v_accvgpr_write_b32 a146, 0
    v_accvgpr_write_b32 a147, 0
    v_accvgpr_write_b32 a148, 0
    v_accvgpr_write_b32 a149, 0
    v_accvgpr_write_b32 a150, 0
    v_accvgpr_write_b32 a151, 0
    v_accvgpr_write_b32 a152, 0
    v_accvgpr_write_b32 a153, 0
    v_accvgpr_write_b32 a154, 0
    v_accvgpr_write_b32 a155, 0
    v_accvgpr_write_b32 a156, 0
    v_accvgpr_write_b32 a157, 0
    v_accvgpr_write_b32 a158, 0
    v_accvgpr_write_b32 a159, 0
    v_accvgpr_write_b32 a160, 0
    v_accvgpr_write_b32 a161, 0
    v_accvgpr_write_b32 a162, 0
    v_accvgpr_write_b32 a163, 0
    v_accvgpr_write_b32 a164, 0
    v_accvgpr_write_b32 a165, 0
    v_accvgpr_write_b32 a166, 0
    v_accvgpr_write_b32 a167, 0
    v_accvgpr_write_b32 a168, 0
    v_accvgpr_write_b32 a169, 0
    v_accvgpr_write_b32 a170, 0
    v_accvgpr_write_b32 a171, 0
    v_accvgpr_write_b32 a172, 0
    v_accvgpr_write_b32 a173, 0
    v_accvgpr_write_b32 a174, 0
    v_accvgpr_write_b32 a175, 0
    v_accvgpr_write_b32 a176, 0
    v_accvgpr_write_b32 a177, 0
    v_accvgpr_write_b32 a178, 0
    v_accvgpr_write_b32 a179, 0
    v_accvgpr_write_b32 a180, 0
    v_accvgpr_write_b32 a181, 0
    v_accvgpr_write_b32 a182, 0
    v_accvgpr_write_b32 a183, 0
    v_accvgpr_write_b32 a184, 0
    v_accvgpr_write_b32 a185, 0
    v_accvgpr_write_b32 a186, 0
    v_accvgpr_write_b32 a187, 0
    v_accvgpr_write_b32 a188, 0
    v_accvgpr_write_b32 a189, 0
    v_accvgpr_write_b32 a190, 0
    v_accvgpr_write_b32 a191, 0
    v_mov_b32 v5, 0
    v_mov_b32 v240, 0xff7fffff
    v_mov_b32 v6, 0
    v_mov_b32 v241, 0xff7fffff
    v_mov_b32 v7, 0
    v_mov_b32 v242, 0xff7fffff
    v_mov_b32 v8, 0
    v_mov_b32 v243, 0xff7fffff
    v_subrev_u32 v244, 49152, v2
    v_subrev_u32 v245, 49152, v3
    v_subrev_u32 v246, 24576, v1
    s_mov_b32 s48, 0
L_slowloop:
    s_add_u32 s49, s48, 6144
    s_add_u32 s50, s48, 12288
    s_add_u32 s51, s48, 16384
    s_add_u32 s52, s48, 20480
    buffer_load_dwordx4 v[64:67], v244, s[4:7], s48 offen offset:0 sc1
    buffer_load_dwordx4 v[68:71], v245, s[4:7], s48 offen offset:0 sc1
    buffer_load_dwordx4 v[72:75], v244, s[4:7], s49 offen offset:0 sc1
    buffer_load_dwordx4 v[76:79], v245, s[4:7], s49 offen offset:0 sc1
    buffer_load_dwordx4 v[80:83], v244, s[4:7], s48 offen offset:128 sc1
    buffer_load_dwordx4 v[84:87], v245, s[4:7], s48 offen offset:128 sc1
    buffer_load_dwordx4 v[88:91], v244, s[4:7], s49 offen offset:128 sc1
    buffer_load_dwordx4 v[92:95], v245, s[4:7], s49 offen offset:128 sc1
    buffer_load_dwordx4 v[96:99], v244, s[4:7], s48 offen offset:256 sc1
    buffer_load_dwordx4 v[100:103], v245, s[4:7], s48 offen offset:256 sc1
    buffer_load_dwordx4 v[104:107], v244, s[4:7], s49 offen offset:256 sc1
    buffer_load_dwordx4 v[108:111], v245, s[4:7], s49 offen offset:256 sc1
    buffer_load_dwordx4 v[112:115], v246, s[4:7], s50 offen offset:0 sc1
    buffer_load_dwordx4 v[116:119], v246, s[4:7], s50 offen offset:1024 sc1
    buffer_load_dwordx4 v[120:123], v246, s[4:7], s50 offen offset:2048 sc1
    buffer_load_dwordx4 v[124:127], v246, s[4:7], s50 offen offset:3072 sc1
    buffer_load_dwordx4 v[128:131], v246, s[4:7], s51 offen offset:0 sc1
    buffer_load_dwordx4 v[132:135], v246, s[4:7], s51 offen offset:1024 sc1
    buffer_load_dwordx4 v[136:139], v246, s[4:7], s51 offen offset:2048 sc1
    buffer_load_dwordx4 v[140:143], v246, s[4:7], s51 offen offset:3072 sc1
    buffer_load_dwordx4 v[144:147], v246, s[4:7], s52 offen offset:0 sc1
    buffer_load_dwordx4 v[148:151], v246, s[4:7], s52 offen offset:1024 sc1
    buffer_load_dwordx4 v[152:155], v246, s[4:7], s52 offen offset:2048 sc1
    buffer_load_dwordx4 v[156:159], v246, s[4:7], s52 offen offset:3072 sc1
    s_waitcnt vmcnt(12)
    v_mfma_f32_16x16x32_bf16 v[160:163], v[64:67], a[192:195], 0
    v_mfma_f32_16x16x32_bf16 v[168:171], v[64:67], a[216:219], 0
    v_mfma_f32_16x16x32_bf16 v[176:179], v[64:67], a[240:243], 0
    v_mfma_f32_16x16x32_bf16 v[184:187], v[64:67], v[200:203], 0
    v_mfma_f32_16x16x32_bf16 v[160:163], v[68:71], a[196:199], v[160:163]
    v_mfma_f32_16x16x32_bf16 v[168:171], v[68:71], a[220:223], v[168:171]
    v_mfma_f32_16x16x32_bf16 v[176:179], v[68:71], a[244:247], v[176:179]
    v_mfma_f32_16x16x32_bf16 v[184:187], v[68:71], v[204:207], v[184:187]
    v_mfma_f32_16x16x32_bf16 v[164:167], v[72:75], a[192:195], 0
    v_mfma_f32_16x16x32_bf16 v[172:175], v[72:75], a[216:219], 0
    v_mfma_f32_16x16x32_bf16 v[180:183], v[72:75], a[240:243], 0
    v_mfma_f32_16x16x32_bf16 v[188:191], v[72:75], v[200:203], 0
    v_mfma_f32_16x16x32_bf16 v[164:167], v[76:79], a[196:199], v[164:167]
    v_mfma_f32_16x16x32_bf16 v[172:175], v[76:79], a[220:223], v[172:175]
    v_mfma_f32_16x16x32_bf16 v[180:183], v[76:79], a[244:247], v[180:183]
    v_mfma_f32_16x16x32_bf16 v[188:191], v[76:79], v[204:207], v[188:191]
    v_mfma_f32_16x16x32_bf16 v[160:163], v[80:83], a[200:203], v[160:163]
    v_mfma_f32_16x16x32_bf16 v[168:171], v[80:83], a[224:227], v[168:171]
    v_mfma_f32_16x16x32_bf16 v[176:179], v[80:83], a[248:251], v[176:179]
    v_mfma_f32_16x16x32_bf16 v[184:187], v[80:83], v[208:211], v[184:187]
    v_mfma_f32_16x16x32_bf16 v[160:163], v[84:87], a[204:207], v[160:163]
    v_mfma_f32_16x16x32_bf16 v[168:171], v[84:87], a[228:231], v[168:171]
    v_mfma_f32_16x16x32_bf16 v[176:179], v[84:87], a[252:255], v[176:179]
    v_mfma_f32_16x16x32_bf16 v[184:187], v[84:87], v[212:215], v[184:187]
    v_mfma_f32_16x16x32_bf16 v[164:167], v[88:91], a[200:203], v[164:167]
    v_mfma_f32_16x16x32_bf16 v[172:175], v[88:91], a[224:227], v[172:175]
    v_mfma_f32_16x16x32_bf16 v[180:183], v[88:91], a[248:251], v[180:183]
    v_mfma_f32_16x16x32_bf16 v[188:191], v[88:91], v[208:211], v[188:191]
    v_mfma_f32_16x16x32_bf16 v[164:167], v[92:95], a[204:207], v[164:167]
    v_mfma_f32_16x16x32_bf16 v[172:175], v[92:95], a[228:231], v[172:175]
    v_mfma_f32_16x16x32_bf16 v[180:183], v[92:95], a[252:255], v[180:183]
    v_mfma_f32_16x16x32_bf16 v[188:191], v[92:95], v[212:215], v[188:191]
    v_mfma_f32_16x16x32_bf16 v[160:163], v[96:99], a[208:211], v[160:163]
    v_mfma_f32_16x16x32_bf16 v[168:171], v[96:99], a[232:235], v[168:171]
    v_mfma_f32_16x16x32_bf16 v[176:179], v[96:99], v[192:195], v[176:179]
    v_mfma_f32_16x16x32_bf16 v[184:187], v[96:99], v[216:219], v[184:187]
    v_mfma_f32_16x16x32_bf16 v[160:163], v[100:103], a[212:215], v[160:163]
    v_mfma_f32_16x16x32_bf16 v[168:171], v[100:103], a[236:239], v[168:171]
    v_mfma_f32_16x16x32_bf16 v[176:179], v[100:103], v[196:199], v[176:179]
    v_mfma_f32_16x16x32_bf16 v[184:187], v[100:103], v[220:223], v[184:187]
    v_mfma_f32_16x16x32_bf16 v[164:167], v[104:107], a[208:211], v[164:167]
    v_mfma_f32_16x16x32_bf16 v[172:175], v[104:107], a[232:235], v[172:175]
    v_mfma_f32_16x16x32_bf16 v[180:183], v[104:107], v[192:195], v[180:183]
    v_mfma_f32_16x16x32_bf16 v[188:191], v[104:107], v[216:219], v[188:191]
    v_mfma_f32_16x16x32_bf16 v[164:167], v[108:111], a[212:215], v[164:167]
    v_mfma_f32_16x16x32_bf16 v[172:175], v[108:111], a[236:239], v[172:175]
    v_mfma_f32_16x16x32_bf16 v[180:183], v[108:111], v[196:199], v[180:183]
    v_mfma_f32_16x16x32_bf16 v[188:191], v[108:111], v[220:223], v[188:191]
    s_nop 9
    v_max3_f32 v16, v160, v161, v162
    v_max3_f32 v16, v16, v163, v164
    v_max3_f32 v16, v16, v165, v166
    v_max3_f32 v16, v16, v167, v240
    v_mov_b32 v17, v16
    s_nop 1
    v_permlane16_swap_b32 v16, v17
    s_nop 1
    v_max_f32 v16, v16, v17
    v_mov_b32 v17, v16
    s_nop 1
    v_permlane32_swap_b32 v16, v17
    s_nop 1
    v_max_f32 v16, v16, v17
    v_sub_f32 v17, v240, v16
    v_exp_f32 v17, v17
    v_mov_b32 v240, v16
    v_sub_f32 v160, v160, v16
    v_sub_f32 v161, v161, v16
    v_sub_f32 v162, v162, v16
    v_sub_f32 v163, v163, v16
    v_sub_f32 v164, v164, v16
    v_sub_f32 v165, v165, v16
    v_sub_f32 v166, v166, v16
    v_sub_f32 v167, v167, v16
    v_exp_f32 v160, v160
    v_exp_f32 v161, v161
    v_exp_f32 v162, v162
    v_exp_f32 v163, v163
    v_exp_f32 v164, v164
    v_exp_f32 v165, v165
    v_exp_f32 v166, v166
    v_exp_f32 v167, v167
    v_mul_f32 v5, v5, v17
    v_add_f32 v5, v5, v160
    v_add_f32 v5, v5, v161
    v_add_f32 v5, v5, v162
    v_add_f32 v5, v5, v163
    v_add_f32 v5, v5, v164
    v_add_f32 v5, v5, v165
    v_add_f32 v5, v5, v166
    v_add_f32 v5, v5, v167
    v_cvt_pk_bf16_f32 v224, v160, v161
    v_cvt_pk_bf16_f32 v225, v162, v163
    v_cvt_pk_bf16_f32 v226, v164, v165
    v_cvt_pk_bf16_f32 v227, v166, v167
    ds_bpermute_b32 v248, v58, v17 offset:0
    ds_bpermute_b32 v249, v58, v17 offset:4
    ds_bpermute_b32 v250, v58, v17 offset:8
    ds_bpermute_b32 v251, v58, v17 offset:12
    s_waitcnt lgkmcnt(0)
    v_accvgpr_read_b32 v18, a0
    v_mul_f32 v18, v18, v248
    v_accvgpr_write_b32 a0, v18
    v_accvgpr_read_b32 v19, a1
    v_mul_f32 v19, v19, v249
    v_accvgpr_write_b32 a1, v19
    v_accvgpr_read_b32 v18, a2
    v_mul_f32 v18, v18, v250
    v_accvgpr_write_b32 a2, v18
    v_accvgpr_read_b32 v19, a3
    v_mul_f32 v19, v19, v251
    v_accvgpr_write_b32 a3, v19
    v_accvgpr_read_b32 v18, a4
    v_mul_f32 v18, v18, v248
    v_accvgpr_write_b32 a4, v18
    v_accvgpr_read_b32 v19, a5
    v_mul_f32 v19, v19, v249
    v_accvgpr_write_b32 a5, v19
    v_accvgpr_read_b32 v18, a6
    v_mul_f32 v18, v18, v250
    v_accvgpr_write_b32 a6, v18
    v_accvgpr_read_b32 v19, a7
    v_mul_f32 v19, v19, v251
    v_accvgpr_write_b32 a7, v19
    v_accvgpr_read_b32 v18, a8
    v_mul_f32 v18, v18, v248
    v_accvgpr_write_b32 a8, v18
    v_accvgpr_read_b32 v19, a9
    v_mul_f32 v19, v19, v249
    v_accvgpr_write_b32 a9, v19
    v_accvgpr_read_b32 v18, a10
    v_mul_f32 v18, v18, v250
    v_accvgpr_write_b32 a10, v18
    v_accvgpr_read_b32 v19, a11
    v_mul_f32 v19, v19, v251
    v_accvgpr_write_b32 a11, v19
    v_accvgpr_read_b32 v18, a12
    v_mul_f32 v18, v18, v248
    v_accvgpr_write_b32 a12, v18
    v_accvgpr_read_b32 v19, a13
    v_mul_f32 v19, v19, v249
    v_accvgpr_write_b32 a13, v19
    v_accvgpr_read_b32 v18, a14
    v_mul_f32 v18, v18, v250
    v_accvgpr_write_b32 a14, v18
    v_accvgpr_read_b32 v19, a15
    v_mul_f32 v19, v19, v251
    v_accvgpr_write_b32 a15, v19
    v_accvgpr_read_b32 v18, a16
    v_mul_f32 v18, v18, v248
    v_accvgpr_write_b32 a16, v18
    v_accvgpr_read_b32 v19, a17
    v_mul_f32 v19, v19, v249
    v_accvgpr_write_b32 a17, v19
    v_accvgpr_read_b32 v18, a18
    v_mul_f32 v18, v18, v250
    v_accvgpr_write_b32 a18, v18
    v_accvgpr_read_b32 v19, a19
    v_mul_f32 v19, v19, v251
    v_accvgpr_write_b32 a19, v19
    v_accvgpr_read_b32 v18, a20
    v_mul_f32 v18, v18, v248
    v_accvgpr_write_b32 a20, v18
    v_accvgpr_read_b32 v19, a21
    v_mul_f32 v19, v19, v249
    v_accvgpr_write_b32 a21, v19
    v_accvgpr_read_b32 v18, a22
    v_mul_f32 v18, v18, v250
    v_accvgpr_write_b32 a22, v18
    v_accvgpr_read_b32 v19, a23
    v_mul_f32 v19, v19, v251
    v_accvgpr_write_b32 a23, v19
    v_accvgpr_read_b32 v18, a24
    v_mul_f32 v18, v18, v248
    v_accvgpr_write_b32 a24, v18
    v_accvgpr_read_b32 v19, a25
    v_mul_f32 v19, v19, v249
    v_accvgpr_write_b32 a25, v19
    v_accvgpr_read_b32 v18, a26
    v_mul_f32 v18, v18, v250
    v_accvgpr_write_b32 a26, v18
    v_accvgpr_read_b32 v19, a27
    v_mul_f32 v19, v19, v251
    v_accvgpr_write_b32 a27, v19
    v_accvgpr_read_b32 v18, a28
    v_mul_f32 v18, v18, v248
    v_accvgpr_write_b32 a28, v18
    v_accvgpr_read_b32 v19, a29
    v_mul_f32 v19, v19, v249
    v_accvgpr_write_b32 a29, v19
    v_accvgpr_read_b32 v18, a30
    v_mul_f32 v18, v18, v250
    v_accvgpr_write_b32 a30, v18
    v_accvgpr_read_b32 v19, a31
    v_mul_f32 v19, v19, v251
    v_accvgpr_write_b32 a31, v19
    v_accvgpr_read_b32 v18, a32
    v_mul_f32 v18, v18, v248
    v_accvgpr_write_b32 a32, v18
    v_accvgpr_read_b32 v19, a33
    v_mul_f32 v19, v19, v249
    v_accvgpr_write_b32 a33, v19
    v_accvgpr_read_b32 v18, a34
    v_mul_f32 v18, v18, v250
    v_accvgpr_write_b32 a34, v18
    v_accvgpr_read_b32 v19, a35
    v_mul_f32 v19, v19, v251
    v_accvgpr_write_b32 a35, v19
    v_accvgpr_read_b32 v18, a36
    v_mul_f32 v18, v18, v248
    v_accvgpr_write_b32 a36, v18
    v_accvgpr_read_b32 v19, a37
    v_mul_f32 v19, v19, v249
    v_accvgpr_write_b32 a37, v19
    v_accvgpr_read_b32 v18, a38
    v_mul_f32 v18, v18, v250
    v_accvgpr_write_b32 a38, v18
    v_accvgpr_read_b32 v19, a39
    v_mul_f32 v19, v19, v251
    v_accvgpr_write_b32 a39, v19
    v_accvgpr_read_b32 v18, a40
    v_mul_f32 v18, v18, v248
    v_accvgpr_write_b32 a40, v18
    v_accvgpr_read_b32 v19, a41
    v_mul_f32 v19, v19, v249
    v_accvgpr_write_b32 a41, v19
    v_accvgpr_read_b32 v18, a42
    v_mul_f32 v18, v18, v250
    v_accvgpr_write_b32 a42, v18
    v_accvgpr_read_b32 v19, a43
    v_mul_f32 v19, v19, v251
    v_accvgpr_write_b32 a43, v19
    v_accvgpr_read_b32 v18, a44
    v_mul_f32 v18, v18, v248
    v_accvgpr_write_b32 a44, v18
    v_accvgpr_read_b32 v19, a45
    v_mul_f32 v19, v19, v249
    v_accvgpr_write_b32 a45, v19
    v_accvgpr_read_b32 v18, a46
    v_mul_f32 v18, v18, v250
    v_accvgpr_write_b32 a46, v18
    v_accvgpr_read_b32 v19, a47
    v_mul_f32 v19, v19, v251
    v_accvgpr_write_b32 a47, v19
    v_max3_f32 v16, v168, v169, v170
    v_max3_f32 v16, v16, v171, v172
    v_max3_f32 v16, v16, v173, v174
    v_max3_f32 v16, v16, v175, v241
    v_mov_b32 v17, v16
    s_nop 1
    v_permlane16_swap_b32 v16, v17
    s_nop 1
    v_max_f32 v16, v16, v17
    v_mov_b32 v17, v16
    s_nop 1
    v_permlane32_swap_b32 v16, v17
    s_nop 1
    v_max_f32 v16, v16, v17
    v_sub_f32 v17, v241, v16
    v_exp_f32 v17, v17
    v_mov_b32 v241, v16
    v_sub_f32 v168, v168, v16
    v_sub_f32 v169, v169, v16
    v_sub_f32 v170, v170, v16
    v_sub_f32 v171, v171, v16
    v_sub_f32 v172, v172, v16
    v_sub_f32 v173, v173, v16
    v_sub_f32 v174, v174, v16
    v_sub_f32 v175, v175, v16
    v_exp_f32 v168, v168
    v_exp_f32 v169, v169
    v_exp_f32 v170, v170
    v_exp_f32 v171, v171
    v_exp_f32 v172, v172
    v_exp_f32 v173, v173
    v_exp_f32 v174, v174
    v_exp_f32 v175, v175
    v_mul_f32 v6, v6, v17
    v_add_f32 v6, v6, v168
    v_add_f32 v6, v6, v169
    v_add_f32 v6, v6, v170
    v_add_f32 v6, v6, v171
    v_add_f32 v6, v6, v172
    v_add_f32 v6, v6, v173
    v_add_f32 v6, v6, v174
    v_add_f32 v6, v6, v175
    v_cvt_pk_bf16_f32 v228, v168, v169
    v_cvt_pk_bf16_f32 v229, v170, v171
    v_cvt_pk_bf16_f32 v230, v172, v173
    v_cvt_pk_bf16_f32 v231, v174, v175
    ds_bpermute_b32 v248, v58, v17 offset:0
    ds_bpermute_b32 v249, v58, v17 offset:4
    ds_bpermute_b32 v250, v58, v17 offset:8
    ds_bpermute_b32 v251, v58, v17 offset:12
    s_waitcnt lgkmcnt(0)
    v_accvgpr_read_b32 v18, a48
    v_mul_f32 v18, v18, v248
    v_accvgpr_write_b32 a48, v18
    v_accvgpr_read_b32 v19, a49
    v_mul_f32 v19, v19, v249
    v_accvgpr_write_b32 a49, v19
    v_accvgpr_read_b32 v18, a50
    v_mul_f32 v18, v18, v250
    v_accvgpr_write_b32 a50, v18
    v_accvgpr_read_b32 v19, a51
    v_mul_f32 v19, v19, v251
    v_accvgpr_write_b32 a51, v19
    v_accvgpr_read_b32 v18, a52
    v_mul_f32 v18, v18, v248
    v_accvgpr_write_b32 a52, v18
    v_accvgpr_read_b32 v19, a53
    v_mul_f32 v19, v19, v249
    v_accvgpr_write_b32 a53, v19
    v_accvgpr_read_b32 v18, a54
    v_mul_f32 v18, v18, v250
    v_accvgpr_write_b32 a54, v18
    v_accvgpr_read_b32 v19, a55
    v_mul_f32 v19, v19, v251
    v_accvgpr_write_b32 a55, v19
    v_accvgpr_read_b32 v18, a56
    v_mul_f32 v18, v18, v248
    v_accvgpr_write_b32 a56, v18
    v_accvgpr_read_b32 v19, a57
    v_mul_f32 v19, v19, v249
    v_accvgpr_write_b32 a57, v19
    v_accvgpr_read_b32 v18, a58
    v_mul_f32 v18, v18, v250
    v_accvgpr_write_b32 a58, v18
    v_accvgpr_read_b32 v19, a59
    v_mul_f32 v19, v19, v251
    v_accvgpr_write_b32 a59, v19
    v_accvgpr_read_b32 v18, a60
    v_mul_f32 v18, v18, v248
    v_accvgpr_write_b32 a60, v18
    v_accvgpr_read_b32 v19, a61
    v_mul_f32 v19, v19, v249
    v_accvgpr_write_b32 a61, v19
    v_accvgpr_read_b32 v18, a62
    v_mul_f32 v18, v18, v250
    v_accvgpr_write_b32 a62, v18
    v_accvgpr_read_b32 v19, a63
    v_mul_f32 v19, v19, v251
    v_accvgpr_write_b32 a63, v19
    v_accvgpr_read_b32 v18, a64
    v_mul_f32 v18, v18, v248
    v_accvgpr_write_b32 a64, v18
    v_accvgpr_read_b32 v19, a65
    v_mul_f32 v19, v19, v249
    v_accvgpr_write_b32 a65, v19
    v_accvgpr_read_b32 v18, a66
    v_mul_f32 v18, v18, v250
    v_accvgpr_write_b32 a66, v18
    v_accvgpr_read_b32 v19, a67
    v_mul_f32 v19, v19, v251
    v_accvgpr_write_b32 a67, v19
    v_accvgpr_read_b32 v18, a68
    v_mul_f32 v18, v18, v248
    v_accvgpr_write_b32 a68, v18
    v_accvgpr_read_b32 v19, a69
    v_mul_f32 v19, v19, v249
    v_accvgpr_write_b32 a69, v19
    v_accvgpr_read_b32 v18, a70
    v_mul_f32 v18, v18, v250
    v_accvgpr_write_b32 a70, v18
    v_accvgpr_read_b32 v19, a71
    v_mul_f32 v19, v19, v251
    v_accvgpr_write_b32 a71, v19
    v_accvgpr_read_b32 v18, a72
    v_mul_f32 v18, v18, v248
    v_accvgpr_write_b32 a72, v18
    v_accvgpr_read_b32 v19, a73
    v_mul_f32 v19, v19, v249
    v_accvgpr_write_b32 a73, v19
    v_accvgpr_read_b32 v18, a74
    v_mul_f32 v18, v18, v250
    v_accvgpr_write_b32 a74, v18
    v_accvgpr_read_b32 v19, a75
    v_mul_f32 v19, v19, v251
    v_accvgpr_write_b32 a75, v19
    v_accvgpr_read_b32 v18, a76
    v_mul_f32 v18, v18, v248
    v_accvgpr_write_b32 a76, v18
    v_accvgpr_read_b32 v19, a77
    v_mul_f32 v19, v19, v249
    v_accvgpr_write_b32 a77, v19
    v_accvgpr_read_b32 v18, a78
    v_mul_f32 v18, v18, v250
    v_accvgpr_write_b32 a78, v18
    v_accvgpr_read_b32 v19, a79
    v_mul_f32 v19, v19, v251
    v_accvgpr_write_b32 a79, v19
    v_accvgpr_read_b32 v18, a80
    v_mul_f32 v18, v18, v248
    v_accvgpr_write_b32 a80, v18
    v_accvgpr_read_b32 v19, a81
    v_mul_f32 v19, v19, v249
    v_accvgpr_write_b32 a81, v19
    v_accvgpr_read_b32 v18, a82
    v_mul_f32 v18, v18, v250
    v_accvgpr_write_b32 a82, v18
    v_accvgpr_read_b32 v19, a83
    v_mul_f32 v19, v19, v251
    v_accvgpr_write_b32 a83, v19
    v_accvgpr_read_b32 v18, a84
    v_mul_f32 v18, v18, v248
    v_accvgpr_write_b32 a84, v18
    v_accvgpr_read_b32 v19, a85
    v_mul_f32 v19, v19, v249
    v_accvgpr_write_b32 a85, v19
    v_accvgpr_read_b32 v18, a86
    v_mul_f32 v18, v18, v250
    v_accvgpr_write_b32 a86, v18
    v_accvgpr_read_b32 v19, a87
    v_mul_f32 v19, v19, v251
    v_accvgpr_write_b32 a87, v19
    v_accvgpr_read_b32 v18, a88
    v_mul_f32 v18, v18, v248
    v_accvgpr_write_b32 a88, v18
    v_accvgpr_read_b32 v19, a89
    v_mul_f32 v19, v19, v249
    v_accvgpr_write_b32 a89, v19
    v_accvgpr_read_b32 v18, a90
    v_mul_f32 v18, v18, v250
    v_accvgpr_write_b32 a90, v18
    v_accvgpr_read_b32 v19, a91
    v_mul_f32 v19, v19, v251
    v_accvgpr_write_b32 a91, v19
    v_accvgpr_read_b32 v18, a92
    v_mul_f32 v18, v18, v248
    v_accvgpr_write_b32 a92, v18
    v_accvgpr_read_b32 v19, a93
    v_mul_f32 v19, v19, v249
    v_accvgpr_write_b32 a93, v19
    v_accvgpr_read_b32 v18, a94
    v_mul_f32 v18, v18, v250
    v_accvgpr_write_b32 a94, v18
    v_accvgpr_read_b32 v19, a95
    v_mul_f32 v19, v19, v251
    v_accvgpr_write_b32 a95, v19
    v_max3_f32 v16, v176, v177, v178
    v_max3_f32 v16, v16, v179, v180
    v_max3_f32 v16, v16, v181, v182
    v_max3_f32 v16, v16, v183, v242
    v_mov_b32 v17, v16
    s_nop 1
    v_permlane16_swap_b32 v16, v17
    s_nop 1
    v_max_f32 v16, v16, v17
    v_mov_b32 v17, v16
    s_nop 1
    v_permlane32_swap_b32 v16, v17
    s_nop 1
    v_max_f32 v16, v16, v17
    v_sub_f32 v17, v242, v16
    v_exp_f32 v17, v17
    v_mov_b32 v242, v16
    v_sub_f32 v176, v176, v16
    v_sub_f32 v177, v177, v16
    v_sub_f32 v178, v178, v16
    v_sub_f32 v179, v179, v16
    v_sub_f32 v180, v180, v16
    v_sub_f32 v181, v181, v16
    v_sub_f32 v182, v182, v16
    v_sub_f32 v183, v183, v16
    v_exp_f32 v176, v176
    v_exp_f32 v177, v177
    v_exp_f32 v178, v178
    v_exp_f32 v179, v179
    v_exp_f32 v180, v180
    v_exp_f32 v181, v181
    v_exp_f32 v182, v182
    v_exp_f32 v183, v183
    v_mul_f32 v7, v7, v17
    v_add_f32 v7, v7, v176
    v_add_f32 v7, v7, v177
    v_add_f32 v7, v7, v178
    v_add_f32 v7, v7, v179
    v_add_f32 v7, v7, v180
    v_add_f32 v7, v7, v181
    v_add_f32 v7, v7, v182
    v_add_f32 v7, v7, v183
    v_cvt_pk_bf16_f32 v232, v176, v177
    v_cvt_pk_bf16_f32 v233, v178, v179
    v_cvt_pk_bf16_f32 v234, v180, v181
    v_cvt_pk_bf16_f32 v235, v182, v183
    ds_bpermute_b32 v248, v58, v17 offset:0
    ds_bpermute_b32 v249, v58, v17 offset:4
    ds_bpermute_b32 v250, v58, v17 offset:8
    ds_bpermute_b32 v251, v58, v17 offset:12
    s_waitcnt lgkmcnt(0)
    v_accvgpr_read_b32 v18, a96
    v_mul_f32 v18, v18, v248
    v_accvgpr_write_b32 a96, v18
    v_accvgpr_read_b32 v19, a97
    v_mul_f32 v19, v19, v249
    v_accvgpr_write_b32 a97, v19
    v_accvgpr_read_b32 v18, a98
    v_mul_f32 v18, v18, v250
    v_accvgpr_write_b32 a98, v18
    v_accvgpr_read_b32 v19, a99
    v_mul_f32 v19, v19, v251
    v_accvgpr_write_b32 a99, v19
    v_accvgpr_read_b32 v18, a100
    v_mul_f32 v18, v18, v248
    v_accvgpr_write_b32 a100, v18
    v_accvgpr_read_b32 v19, a101
    v_mul_f32 v19, v19, v249
    v_accvgpr_write_b32 a101, v19
    v_accvgpr_read_b32 v18, a102
    v_mul_f32 v18, v18, v250
    v_accvgpr_write_b32 a102, v18
    v_accvgpr_read_b32 v19, a103
    v_mul_f32 v19, v19, v251
    v_accvgpr_write_b32 a103, v19
    v_accvgpr_read_b32 v18, a104
    v_mul_f32 v18, v18, v248
    v_accvgpr_write_b32 a104, v18
    v_accvgpr_read_b32 v19, a105
    v_mul_f32 v19, v19, v249
    v_accvgpr_write_b32 a105, v19
    v_accvgpr_read_b32 v18, a106
    v_mul_f32 v18, v18, v250
    v_accvgpr_write_b32 a106, v18
    v_accvgpr_read_b32 v19, a107
    v_mul_f32 v19, v19, v251
    v_accvgpr_write_b32 a107, v19
    v_accvgpr_read_b32 v18, a108
    v_mul_f32 v18, v18, v248
    v_accvgpr_write_b32 a108, v18
    v_accvgpr_read_b32 v19, a109
    v_mul_f32 v19, v19, v249
    v_accvgpr_write_b32 a109, v19
    v_accvgpr_read_b32 v18, a110
    v_mul_f32 v18, v18, v250
    v_accvgpr_write_b32 a110, v18
    v_accvgpr_read_b32 v19, a111
    v_mul_f32 v19, v19, v251
    v_accvgpr_write_b32 a111, v19
    v_accvgpr_read_b32 v18, a112
    v_mul_f32 v18, v18, v248
    v_accvgpr_write_b32 a112, v18
    v_accvgpr_read_b32 v19, a113
    v_mul_f32 v19, v19, v249
    v_accvgpr_write_b32 a113, v19
    v_accvgpr_read_b32 v18, a114
    v_mul_f32 v18, v18, v250
    v_accvgpr_write_b32 a114, v18
    v_accvgpr_read_b32 v19, a115
    v_mul_f32 v19, v19, v251
    v_accvgpr_write_b32 a115, v19
    v_accvgpr_read_b32 v18, a116
    v_mul_f32 v18, v18, v248
    v_accvgpr_write_b32 a116, v18
    v_accvgpr_read_b32 v19, a117
    v_mul_f32 v19, v19, v249
    v_accvgpr_write_b32 a117, v19
    v_accvgpr_read_b32 v18, a118
    v_mul_f32 v18, v18, v250
    v_accvgpr_write_b32 a118, v18
    v_accvgpr_read_b32 v19, a119
    v_mul_f32 v19, v19, v251
    v_accvgpr_write_b32 a119, v19
    v_accvgpr_read_b32 v18, a120
    v_mul_f32 v18, v18, v248
    v_accvgpr_write_b32 a120, v18
    v_accvgpr_read_b32 v19, a121
    v_mul_f32 v19, v19, v249
    v_accvgpr_write_b32 a121, v19
    v_accvgpr_read_b32 v18, a122
    v_mul_f32 v18, v18, v250
    v_accvgpr_write_b32 a122, v18
    v_accvgpr_read_b32 v19, a123
    v_mul_f32 v19, v19, v251
    v_accvgpr_write_b32 a123, v19
    v_accvgpr_read_b32 v18, a124
    v_mul_f32 v18, v18, v248
    v_accvgpr_write_b32 a124, v18
    v_accvgpr_read_b32 v19, a125
    v_mul_f32 v19, v19, v249
    v_accvgpr_write_b32 a125, v19
    v_accvgpr_read_b32 v18, a126
    v_mul_f32 v18, v18, v250
    v_accvgpr_write_b32 a126, v18
    v_accvgpr_read_b32 v19, a127
    v_mul_f32 v19, v19, v251
    v_accvgpr_write_b32 a127, v19
    v_accvgpr_read_b32 v18, a128
    v_mul_f32 v18, v18, v248
    v_accvgpr_write_b32 a128, v18
    v_accvgpr_read_b32 v19, a129
    v_mul_f32 v19, v19, v249
    v_accvgpr_write_b32 a129, v19
    v_accvgpr_read_b32 v18, a130
    v_mul_f32 v18, v18, v250
    v_accvgpr_write_b32 a130, v18
    v_accvgpr_read_b32 v19, a131
    v_mul_f32 v19, v19, v251
    v_accvgpr_write_b32 a131, v19
    v_accvgpr_read_b32 v18, a132
    v_mul_f32 v18, v18, v248
    v_accvgpr_write_b32 a132, v18
    v_accvgpr_read_b32 v19, a133
    v_mul_f32 v19, v19, v249
    v_accvgpr_write_b32 a133, v19
    v_accvgpr_read_b32 v18, a134
    v_mul_f32 v18, v18, v250
    v_accvgpr_write_b32 a134, v18
    v_accvgpr_read_b32 v19, a135
    v_mul_f32 v19, v19, v251
    v_accvgpr_write_b32 a135, v19
    v_accvgpr_read_b32 v18, a136
    v_mul_f32 v18, v18, v248
    v_accvgpr_write_b32 a136, v18
    v_accvgpr_read_b32 v19, a137
    v_mul_f32 v19, v19, v249
    v_accvgpr_write_b32 a137, v19
    v_accvgpr_read_b32 v18, a138
    v_mul_f32 v18, v18, v250
    v_accvgpr_write_b32 a138, v18
    v_accvgpr_read_b32 v19, a139
    v_mul_f32 v19, v19, v251
    v_accvgpr_write_b32 a139, v19
    v_accvgpr_read_b32 v18, a140
    v_mul_f32 v18, v18, v248
    v_accvgpr_write_b32 a140, v18
    v_accvgpr_read_b32 v19, a141
    v_mul_f32 v19, v19, v249
    v_accvgpr_write_b32 a141, v19
    v_accvgpr_read_b32 v18, a142
    v_mul_f32 v18, v18, v250
    v_accvgpr_write_b32 a142, v18
    v_accvgpr_read_b32 v19, a143
    v_mul_f32 v19, v19, v251
    v_accvgpr_write_b32 a143, v19
    v_max3_f32 v16, v184, v185, v186
    v_max3_f32 v16, v16, v187, v188
    v_max3_f32 v16, v16, v189, v190
    v_max3_f32 v16, v16, v191, v243
    v_mov_b32 v17, v16
    s_nop 1
    v_permlane16_swap_b32 v16, v17
    s_nop 1
    v_max_f32 v16, v16, v17
    v_mov_b32 v17, v16
    s_nop 1
    v_permlane32_swap_b32 v16, v17
    s_nop 1
    v_max_f32 v16, v16, v17
    v_sub_f32 v17, v243, v16
    v_exp_f32 v17, v17
    v_mov_b32 v243, v16
    v_sub_f32 v184, v184, v16
    v_sub_f32 v185, v185, v16
    v_sub_f32 v186, v186, v16
    v_sub_f32 v187, v187, v16
    v_sub_f32 v188, v188, v16
    v_sub_f32 v189, v189, v16
    v_sub_f32 v190, v190, v16
    v_sub_f32 v191, v191, v16
    v_exp_f32 v184, v184
    v_exp_f32 v185, v185
    v_exp_f32 v186, v186
    v_exp_f32 v187, v187
    v_exp_f32 v188, v188
    v_exp_f32 v189, v189
    v_exp_f32 v190, v190
    v_exp_f32 v191, v191
    v_mul_f32 v8, v8, v17
    v_add_f32 v8, v8, v184
    v_add_f32 v8, v8, v185
    v_add_f32 v8, v8, v186
    v_add_f32 v8, v8, v187
    v_add_f32 v8, v8, v188
    v_add_f32 v8, v8, v189
    v_add_f32 v8, v8, v190
    v_add_f32 v8, v8, v191
    v_cvt_pk_bf16_f32 v236, v184, v185
    v_cvt_pk_bf16_f32 v237, v186, v187
    v_cvt_pk_bf16_f32 v238, v188, v189
    v_cvt_pk_bf16_f32 v239, v190, v191
    ds_bpermute_b32 v248, v58, v17 offset:0
    ds_bpermute_b32 v249, v58, v17 offset:4
    ds_bpermute_b32 v250, v58, v17 offset:8
    ds_bpermute_b32 v251, v58, v17 offset:12
    s_waitcnt lgkmcnt(0)
    v_accvgpr_read_b32 v18, a144
    v_mul_f32 v18, v18, v248
    v_accvgpr_write_b32 a144, v18
    v_accvgpr_read_b32 v19, a145
    v_mul_f32 v19, v19, v249
    v_accvgpr_write_b32 a145, v19
    v_accvgpr_read_b32 v18, a146
    v_mul_f32 v18, v18, v250
    v_accvgpr_write_b32 a146, v18
    v_accvgpr_read_b32 v19, a147
    v_mul_f32 v19, v19, v251
    v_accvgpr_write_b32 a147, v19
    v_accvgpr_read_b32 v18, a148
    v_mul_f32 v18, v18, v248
    v_accvgpr_write_b32 a148, v18
    v_accvgpr_read_b32 v19, a149
    v_mul_f32 v19, v19, v249
    v_accvgpr_write_b32 a149, v19
    v_accvgpr_read_b32 v18, a150
    v_mul_f32 v18, v18, v250
    v_accvgpr_write_b32 a150, v18
    v_accvgpr_read_b32 v19, a151
    v_mul_f32 v19, v19, v251
    v_accvgpr_write_b32 a151, v19
    v_accvgpr_read_b32 v18, a152
    v_mul_f32 v18, v18, v248
    v_accvgpr_write_b32 a152, v18
    v_accvgpr_read_b32 v19, a153
    v_mul_f32 v19, v19, v249
    v_accvgpr_write_b32 a153, v19
    v_accvgpr_read_b32 v18, a154
    v_mul_f32 v18, v18, v250
    v_accvgpr_write_b32 a154, v18
    v_accvgpr_read_b32 v19, a155
    v_mul_f32 v19, v19, v251
    v_accvgpr_write_b32 a155, v19
    v_accvgpr_read_b32 v18, a156
    v_mul_f32 v18, v18, v248
    v_accvgpr_write_b32 a156, v18
    v_accvgpr_read_b32 v19, a157
    v_mul_f32 v19, v19, v249
    v_accvgpr_write_b32 a157, v19
    v_accvgpr_read_b32 v18, a158
    v_mul_f32 v18, v18, v250
    v_accvgpr_write_b32 a158, v18
    v_accvgpr_read_b32 v19, a159
    v_mul_f32 v19, v19, v251
    v_accvgpr_write_b32 a159, v19
    v_accvgpr_read_b32 v18, a160
    v_mul_f32 v18, v18, v248
    v_accvgpr_write_b32 a160, v18
    v_accvgpr_read_b32 v19, a161
    v_mul_f32 v19, v19, v249
    v_accvgpr_write_b32 a161, v19
    v_accvgpr_read_b32 v18, a162
    v_mul_f32 v18, v18, v250
    v_accvgpr_write_b32 a162, v18
    v_accvgpr_read_b32 v19, a163
    v_mul_f32 v19, v19, v251
    v_accvgpr_write_b32 a163, v19
    v_accvgpr_read_b32 v18, a164
    v_mul_f32 v18, v18, v248
    v_accvgpr_write_b32 a164, v18
    v_accvgpr_read_b32 v19, a165
    v_mul_f32 v19, v19, v249
    v_accvgpr_write_b32 a165, v19
    v_accvgpr_read_b32 v18, a166
    v_mul_f32 v18, v18, v250
    v_accvgpr_write_b32 a166, v18
    v_accvgpr_read_b32 v19, a167
    v_mul_f32 v19, v19, v251
    v_accvgpr_write_b32 a167, v19
    v_accvgpr_read_b32 v18, a168
    v_mul_f32 v18, v18, v248
    v_accvgpr_write_b32 a168, v18
    v_accvgpr_read_b32 v19, a169
    v_mul_f32 v19, v19, v249
    v_accvgpr_write_b32 a169, v19
    v_accvgpr_read_b32 v18, a170
    v_mul_f32 v18, v18, v250
    v_accvgpr_write_b32 a170, v18
    v_accvgpr_read_b32 v19, a171
    v_mul_f32 v19, v19, v251
    v_accvgpr_write_b32 a171, v19
    v_accvgpr_read_b32 v18, a172
    v_mul_f32 v18, v18, v248
    v_accvgpr_write_b32 a172, v18
    v_accvgpr_read_b32 v19, a173
    v_mul_f32 v19, v19, v249
    v_accvgpr_write_b32 a173, v19
    v_accvgpr_read_b32 v18, a174
    v_mul_f32 v18, v18, v250
    v_accvgpr_write_b32 a174, v18
    v_accvgpr_read_b32 v19, a175
    v_mul_f32 v19, v19, v251
    v_accvgpr_write_b32 a175, v19
    v_accvgpr_read_b32 v18, a176
    v_mul_f32 v18, v18, v248
    v_accvgpr_write_b32 a176, v18
    v_accvgpr_read_b32 v19, a177
    v_mul_f32 v19, v19, v249
    v_accvgpr_write_b32 a177, v19
    v_accvgpr_read_b32 v18, a178
    v_mul_f32 v18, v18, v250
    v_accvgpr_write_b32 a178, v18
    v_accvgpr_read_b32 v19, a179
    v_mul_f32 v19, v19, v251
    v_accvgpr_write_b32 a179, v19
    v_accvgpr_read_b32 v18, a180
    v_mul_f32 v18, v18, v248
    v_accvgpr_write_b32 a180, v18
    v_accvgpr_read_b32 v19, a181
    v_mul_f32 v19, v19, v249
    v_accvgpr_write_b32 a181, v19
    v_accvgpr_read_b32 v18, a182
    v_mul_f32 v18, v18, v250
    v_accvgpr_write_b32 a182, v18
    v_accvgpr_read_b32 v19, a183
    v_mul_f32 v19, v19, v251
    v_accvgpr_write_b32 a183, v19
    v_accvgpr_read_b32 v18, a184
    v_mul_f32 v18, v18, v248
    v_accvgpr_write_b32 a184, v18
    v_accvgpr_read_b32 v19, a185
    v_mul_f32 v19, v19, v249
    v_accvgpr_write_b32 a185, v19
    v_accvgpr_read_b32 v18, a186
    v_mul_f32 v18, v18, v250
    v_accvgpr_write_b32 a186, v18
    v_accvgpr_read_b32 v19, a187
    v_mul_f32 v19, v19, v251
    v_accvgpr_write_b32 a187, v19
    v_accvgpr_read_b32 v18, a188
    v_mul_f32 v18, v18, v248
    v_accvgpr_write_b32 a188, v18
    v_accvgpr_read_b32 v19, a189
    v_mul_f32 v19, v19, v249
    v_accvgpr_write_b32 a189, v19
    v_accvgpr_read_b32 v18, a190
    v_mul_f32 v18, v18, v250
    v_accvgpr_write_b32 a190, v18
    v_accvgpr_read_b32 v19, a191
    v_mul_f32 v19, v19, v251
    v_accvgpr_write_b32 a191, v19
    s_waitcnt vmcnt(0)
    s_nop 1
    v_mfma_f32_16x16x32_bf16 a[0:3], v[224:227], v[112:115], a[0:3]
    v_mfma_f32_16x16x32_bf16 a[48:51], v[228:231], v[112:115], a[48:51]
    v_mfma_f32_16x16x32_bf16 a[96:99], v[232:235], v[112:115], a[96:99]
    v_mfma_f32_16x16x32_bf16 a[144:147], v[236:239], v[112:115], a[144:147]
    v_mfma_f32_16x16x32_bf16 a[4:7], v[224:227], v[116:119], a[4:7]
    v_mfma_f32_16x16x32_bf16 a[52:55], v[228:231], v[116:119], a[52:55]
    v_mfma_f32_16x16x32_bf16 a[100:103], v[232:235], v[116:119], a[100:103]
    v_mfma_f32_16x16x32_bf16 a[148:151], v[236:239], v[116:119], a[148:151]
    v_mfma_f32_16x16x32_bf16 a[8:11], v[224:227], v[120:123], a[8:11]
    v_mfma_f32_16x16x32_bf16 a[56:59], v[228:231], v[120:123], a[56:59]
    v_mfma_f32_16x16x32_bf16 a[104:107], v[232:235], v[120:123], a[104:107]
    v_mfma_f32_16x16x32_bf16 a[152:155], v[236:239], v[120:123], a[152:155]
    v_mfma_f32_16x16x32_bf16 a[12:15], v[224:227], v[124:127], a[12:15]
    v_mfma_f32_16x16x32_bf16 a[60:63], v[228:231], v[124:127], a[60:63]
    v_mfma_f32_16x16x32_bf16 a[108:111], v[232:235], v[124:127], a[108:111]
    v_mfma_f32_16x16x32_bf16 a[156:159], v[236:239], v[124:127], a[156:159]
    v_mfma_f32_16x16x32_bf16 a[16:19], v[224:227], v[128:131], a[16:19]
    v_mfma_f32_16x16x32_bf16 a[64:67], v[228:231], v[128:131], a[64:67]
    v_mfma_f32_16x16x32_bf16 a[112:115], v[232:235], v[128:131], a[112:115]
    v_mfma_f32_16x16x32_bf16 a[160:163], v[236:239], v[128:131], a[160:163]
    v_mfma_f32_16x16x32_bf16 a[20:23], v[224:227], v[132:135], a[20:23]
    v_mfma_f32_16x16x32_bf16 a[68:71], v[228:231], v[132:135], a[68:71]
    v_mfma_f32_16x16x32_bf16 a[116:119], v[232:235], v[132:135], a[116:119]
    v_mfma_f32_16x16x32_bf16 a[164:167], v[236:239], v[132:135], a[164:167]
    v_mfma_f32_16x16x32_bf16 a[24:27], v[224:227], v[136:139], a[24:27]
    v_mfma_f32_16x16x32_bf16 a[72:75], v[228:231], v[136:139], a[72:75]
    v_mfma_f32_16x16x32_bf16 a[120:123], v[232:235], v[136:139], a[120:123]
    v_mfma_f32_16x16x32_bf16 a[168:171], v[236:239], v[136:139], a[168:171]
    v_mfma_f32_16x16x32_bf16 a[28:31], v[224:227], v[140:143], a[28:31]
    v_mfma_f32_16x16x32_bf16 a[76:79], v[228:231], v[140:143], a[76:79]
    v_mfma_f32_16x16x32_bf16 a[124:127], v[232:235], v[140:143], a[124:127]
    v_mfma_f32_16x16x32_bf16 a[172:175], v[236:239], v[140:143], a[172:175]
    v_mfma_f32_16x16x32_bf16 a[32:35], v[224:227], v[144:147], a[32:35]
    v_mfma_f32_16x16x32_bf16 a[80:83], v[228:231], v[144:147], a[80:83]
    v_mfma_f32_16x16x32_bf16 a[128:131], v[232:235], v[144:147], a[128:131]
    v_mfma_f32_16x16x32_bf16 a[176:179], v[236:239], v[144:147], a[176:179]
    v_mfma_f32_16x16x32_bf16 a[36:39], v[224:227], v[148:151], a[36:39]
    v_mfma_f32_16x16x32_bf16 a[84:87], v[228:231], v[148:151], a[84:87]
    v_mfma_f32_16x16x32_bf16 a[132:135], v[232:235], v[148:151], a[132:135]
    v_mfma_f32_16x16x32_bf16 a[180:183], v[236:239], v[148:151], a[180:183]
    v_mfma_f32_16x16x32_bf16 a[40:43], v[224:227], v[152:155], a[40:43]
    v_mfma_f32_16x16x32_bf16 a[88:91], v[228:231], v[152:155], a[88:91]
    v_mfma_f32_16x16x32_bf16 a[136:139], v[232:235], v[152:155], a[136:139]
    v_mfma_f32_16x16x32_bf16 a[184:187], v[236:239], v[152:155], a[184:187]
    v_mfma_f32_16x16x32_bf16 a[44:47], v[224:227], v[156:159], a[44:47]
    v_mfma_f32_16x16x32_bf16 a[92:95], v[228:231], v[156:159], a[92:95]
    v_mfma_f32_16x16x32_bf16 a[140:143], v[232:235], v[156:159], a[140:143]
    v_mfma_f32_16x16x32_bf16 a[188:191], v[236:239], v[156:159], a[188:191]
    s_add_u32 s48, s48, 24576
    s_cmp_lt_u32 s48, 1572864
    s_nop 7
    s_cbranch_scc1 L_slowloop
    s_nop 1
    v_mfma_f32_16x16x4_f32 v[48:51], v5, v57, 0
    v_mfma_f32_16x16x4_f32 v[52:55], v6, v57, 0
    s_nop 7
    s_nop 1
    v_rcp_f32 v48, v48
    v_rcp_f32 v49, v49
    v_rcp_f32 v50, v50
    v_rcp_f32 v51, v51
    v_rcp_f32 v52, v52
    v_rcp_f32 v53, v53
    v_rcp_f32 v54, v54
    v_rcp_f32 v55, v55
    v_mfma_f32_16x16x4_f32 v[128:131], v7, v57, 0
    v_mfma_f32_16x16x4_f32 v[132:135], v8, v57, 0
    s_nop 7
    s_nop 1
    v_rcp_f32 v128, v128
    v_rcp_f32 v129, v129
    v_rcp_f32 v130, v130
    v_rcp_f32 v131, v131
    v_rcp_f32 v132, v132
    v_rcp_f32 v133, v133
    v_rcp_f32 v134, v134
    v_rcp_f32 v135, v135
    s_nop 0
    v_accvgpr_read_b32 v64, a0
    v_accvgpr_read_b32 v65, a12
    v_accvgpr_read_b32 v66, a24
    v_accvgpr_read_b32 v67, a36
    v_pk_mul_f32 v[64:65], v[64:65], v[48:49] op_sel_hi:[1,0]
    v_pk_mul_f32 v[66:67], v[66:67], v[48:49] op_sel_hi:[1,0]
    v_cvt_pk_bf16_f32 v64, v64, v65
    v_cvt_pk_bf16_f32 v65, v66, v67
    v_accvgpr_read_b32 v68, a1
    v_accvgpr_read_b32 v69, a13
    v_accvgpr_read_b32 v70, a25
    v_accvgpr_read_b32 v71, a37
    v_pk_mul_f32 v[68:69], v[68:69], v[48:49] op_sel:[0,1] op_sel_hi:[1,1]
    v_pk_mul_f32 v[70:71], v[70:71], v[48:49] op_sel:[0,1] op_sel_hi:[1,1]
    v_cvt_pk_bf16_f32 v68, v68, v69
    v_cvt_pk_bf16_f32 v69, v70, v71
    buffer_store_dwordx2 v[64:65], v56, s[12:15], s24 offen offset:0 sc0 sc1
    v_accvgpr_read_b32 v72, a2
    v_accvgpr_read_b32 v73, a14
    v_accvgpr_read_b32 v74, a26
    v_accvgpr_read_b32 v75, a38
    v_pk_mul_f32 v[72:73], v[72:73], v[50:51] op_sel_hi:[1,0]
    v_pk_mul_f32 v[74:75], v[74:75], v[50:51] op_sel_hi:[1,0]
    v_cvt_pk_bf16_f32 v72, v72, v73
    v_cvt_pk_bf16_f32 v73, v74, v75
    buffer_store_dwordx2 v[68:69], v56, s[12:15], s24 offen offset:384 sc0 sc1
    v_accvgpr_read_b32 v76, a3
    v_accvgpr_read_b32 v77, a15
    v_accvgpr_read_b32 v78, a27
    v_accvgpr_read_b32 v79, a39
    v_pk_mul_f32 v[76:77], v[76:77], v[50:51] op_sel:[0,1] op_sel_hi:[1,1]
    v_pk_mul_f32 v[78:79], v[78:79], v[50:51] op_sel:[0,1] op_sel_hi:[1,1]
    v_cvt_pk_bf16_f32 v76, v76, v77
    v_cvt_pk_bf16_f32 v77, v78, v79
    buffer_store_dwordx2 v[72:73], v56, s[12:15], s24 offen offset:768 sc0 sc1
    v_accvgpr_read_b32 v80, a4
    v_accvgpr_read_b32 v81, a16
    v_accvgpr_read_b32 v82, a28
    v_accvgpr_read_b32 v83, a40
    v_pk_mul_f32 v[80:81], v[80:81], v[48:49] op_sel_hi:[1,0]
    v_pk_mul_f32 v[82:83], v[82:83], v[48:49] op_sel_hi:[1,0]
    v_cvt_pk_bf16_f32 v80, v80, v81
    v_cvt_pk_bf16_f32 v81, v82, v83
    buffer_store_dwordx2 v[76:77], v56, s[12:15], s24 offen offset:1152 sc0 sc1
    v_accvgpr_read_b32 v84, a5
    v_accvgpr_read_b32 v85, a17
    v_accvgpr_read_b32 v86, a29
    v_accvgpr_read_b32 v87, a41
    v_pk_mul_f32 v[84:85], v[84:85], v[48:49] op_sel:[0,1] op_sel_hi:[1,1]
    v_pk_mul_f32 v[86:87], v[86:87], v[48:49] op_sel:[0,1] op_sel_hi:[1,1]
    v_cvt_pk_bf16_f32 v84, v84, v85
    v_cvt_pk_bf16_f32 v85, v86, v87
    buffer_store_dwordx2 v[80:81], v56, s[12:15], s24 offen offset:128 sc0 sc1
    v_accvgpr_read_b32 v88, a6
    v_accvgpr_read_b32 v89, a18
    v_accvgpr_read_b32 v90, a30
    v_accvgpr_read_b32 v91, a42
    v_pk_mul_f32 v[88:89], v[88:89], v[50:51] op_sel_hi:[1,0]
    v_pk_mul_f32 v[90:91], v[90:91], v[50:51] op_sel_hi:[1,0]
    v_cvt_pk_bf16_f32 v88, v88, v89
    v_cvt_pk_bf16_f32 v89, v90, v91
    buffer_store_dwordx2 v[84:85], v56, s[12:15], s24 offen offset:512 sc0 sc1
    v_accvgpr_read_b32 v92, a7
    v_accvgpr_read_b32 v93, a19
    v_accvgpr_read_b32 v94, a31
    v_accvgpr_read_b32 v95, a43
    v_pk_mul_f32 v[92:93], v[92:93], v[50:51] op_sel:[0,1] op_sel_hi:[1,1]
    v_pk_mul_f32 v[94:95], v[94:95], v[50:51] op_sel:[0,1] op_sel_hi:[1,1]
    v_cvt_pk_bf16_f32 v92, v92, v93
    v_cvt_pk_bf16_f32 v93, v94, v95
    buffer_store_dwordx2 v[88:89], v56, s[12:15], s24 offen offset:896 sc0 sc1
    v_accvgpr_read_b32 v96, a8
    v_accvgpr_read_b32 v97, a20
    v_accvgpr_read_b32 v98, a32
    v_accvgpr_read_b32 v99, a44
    v_pk_mul_f32 v[96:97], v[96:97], v[48:49] op_sel_hi:[1,0]
    v_pk_mul_f32 v[98:99], v[98:99], v[48:49] op_sel_hi:[1,0]
    v_cvt_pk_bf16_f32 v96, v96, v97
    v_cvt_pk_bf16_f32 v97, v98, v99
    buffer_store_dwordx2 v[92:93], v56, s[12:15], s24 offen offset:1280 sc0 sc1
    v_accvgpr_read_b32 v100, a9
    v_accvgpr_read_b32 v101, a21
    v_accvgpr_read_b32 v102, a33
    v_accvgpr_read_b32 v103, a45
    v_pk_mul_f32 v[100:101], v[100:101], v[48:49] op_sel:[0,1] op_sel_hi:[1,1]
    v_pk_mul_f32 v[102:103], v[102:103], v[48:49] op_sel:[0,1] op_sel_hi:[1,1]
    v_cvt_pk_bf16_f32 v100, v100, v101
    v_cvt_pk_bf16_f32 v101, v102, v103
    buffer_store_dwordx2 v[96:97], v56, s[12:15], s24 offen offset:256 sc0 sc1
    v_accvgpr_read_b32 v104, a10
    v_accvgpr_read_b32 v105, a22
    v_accvgpr_read_b32 v106, a34
    v_accvgpr_read_b32 v107, a46
    v_pk_mul_f32 v[104:105], v[104:105], v[50:51] op_sel_hi:[1,0]
    v_pk_mul_f32 v[106:107], v[106:107], v[50:51] op_sel_hi:[1,0]
    v_cvt_pk_bf16_f32 v104, v104, v105
    v_cvt_pk_bf16_f32 v105, v106, v107
    buffer_store_dwordx2 v[100:101], v56, s[12:15], s24 offen offset:640 sc0 sc1
    v_accvgpr_read_b32 v108, a11
    v_accvgpr_read_b32 v109, a23
    v_accvgpr_read_b32 v110, a35
    v_accvgpr_read_b32 v111, a47
    v_pk_mul_f32 v[108:109], v[108:109], v[50:51] op_sel:[0,1] op_sel_hi:[1,1]
    v_pk_mul_f32 v[110:111], v[110:111], v[50:51] op_sel:[0,1] op_sel_hi:[1,1]
    v_cvt_pk_bf16_f32 v108, v108, v109
    v_cvt_pk_bf16_f32 v109, v110, v111
    buffer_store_dwordx2 v[104:105], v56, s[12:15], s24 offen offset:1024 sc0 sc1
    v_accvgpr_read_b32 v112, a48
    v_accvgpr_read_b32 v113, a60
    v_accvgpr_read_b32 v114, a72
    v_accvgpr_read_b32 v115, a84
    v_pk_mul_f32 v[112:113], v[112:113], v[52:53] op_sel_hi:[1,0]
    v_pk_mul_f32 v[114:115], v[114:115], v[52:53] op_sel_hi:[1,0]
    v_cvt_pk_bf16_f32 v112, v112, v113
    v_cvt_pk_bf16_f32 v113, v114, v115
    buffer_store_dwordx2 v[108:109], v56, s[12:15], s24 offen offset:1408 sc0 sc1
    v_accvgpr_read_b32 v116, a49
    v_accvgpr_read_b32 v117, a61
    v_accvgpr_read_b32 v118, a73
    v_accvgpr_read_b32 v119, a85
    v_pk_mul_f32 v[116:117], v[116:117], v[52:53] op_sel:[0,1] op_sel_hi:[1,1]
    v_pk_mul_f32 v[118:119], v[118:119], v[52:53] op_sel:[0,1] op_sel_hi:[1,1]
    v_cvt_pk_bf16_f32 v116, v116, v117
    v_cvt_pk_bf16_f32 v117, v118, v119
    buffer_store_dwordx2 v[112:113], v56, s[12:15], s40 offen offset:0 sc0 sc1
    v_accvgpr_read_b32 v120, a50
    v_accvgpr_read_b32 v121, a62
    v_accvgpr_read_b32 v122, a74
    v_accvgpr_read_b32 v123, a86
    v_pk_mul_f32 v[120:121], v[120:121], v[54:55] op_sel_hi:[1,0]
    v_pk_mul_f32 v[122:123], v[122:123], v[54:55] op_sel_hi:[1,0]
    v_cvt_pk_bf16_f32 v120, v120, v121
    v_cvt_pk_bf16_f32 v121, v122, v123
    buffer_store_dwordx2 v[116:117], v56, s[12:15], s40 offen offset:384 sc0 sc1
    v_accvgpr_read_b32 v124, a51
    v_accvgpr_read_b32 v125, a63
    v_accvgpr_read_b32 v126, a75
    v_accvgpr_read_b32 v127, a87
    v_pk_mul_f32 v[124:125], v[124:125], v[54:55] op_sel:[0,1] op_sel_hi:[1,1]
    v_pk_mul_f32 v[126:127], v[126:127], v[54:55] op_sel:[0,1] op_sel_hi:[1,1]
    v_cvt_pk_bf16_f32 v124, v124, v125
    v_cvt_pk_bf16_f32 v125, v126, v127
    buffer_store_dwordx2 v[120:121], v56, s[12:15], s40 offen offset:768 sc0 sc1
    v_accvgpr_read_b32 v64, a52
    v_accvgpr_read_b32 v65, a64
    v_accvgpr_read_b32 v66, a76
    v_accvgpr_read_b32 v67, a88
    v_pk_mul_f32 v[64:65], v[64:65], v[52:53] op_sel_hi:[1,0]
    v_pk_mul_f32 v[66:67], v[66:67], v[52:53] op_sel_hi:[1,0]
    v_cvt_pk_bf16_f32 v64, v64, v65
    v_cvt_pk_bf16_f32 v65, v66, v67
    buffer_store_dwordx2 v[124:125], v56, s[12:15], s40 offen offset:1152 sc0 sc1
    v_accvgpr_read_b32 v68, a53
    v_accvgpr_read_b32 v69, a65
    v_accvgpr_read_b32 v70, a77
    v_accvgpr_read_b32 v71, a89
    v_pk_mul_f32 v[68:69], v[68:69], v[52:53] op_sel:[0,1] op_sel_hi:[1,1]
    v_pk_mul_f32 v[70:71], v[70:71], v[52:53] op_sel:[0,1] op_sel_hi:[1,1]
    v_cvt_pk_bf16_f32 v68, v68, v69
    v_cvt_pk_bf16_f32 v69, v70, v71
    buffer_store_dwordx2 v[64:65], v56, s[12:15], s40 offen offset:128 sc0 sc1
    v_accvgpr_read_b32 v72, a54
    v_accvgpr_read_b32 v73, a66
    v_accvgpr_read_b32 v74, a78
    v_accvgpr_read_b32 v75, a90
    v_pk_mul_f32 v[72:73], v[72:73], v[54:55] op_sel_hi:[1,0]
    v_pk_mul_f32 v[74:75], v[74:75], v[54:55] op_sel_hi:[1,0]
    v_cvt_pk_bf16_f32 v72, v72, v73
    v_cvt_pk_bf16_f32 v73, v74, v75
    buffer_store_dwordx2 v[68:69], v56, s[12:15], s40 offen offset:512 sc0 sc1
    v_accvgpr_read_b32 v76, a55
    v_accvgpr_read_b32 v77, a67
    v_accvgpr_read_b32 v78, a79
    v_accvgpr_read_b32 v79, a91
    v_pk_mul_f32 v[76:77], v[76:77], v[54:55] op_sel:[0,1] op_sel_hi:[1,1]
    v_pk_mul_f32 v[78:79], v[78:79], v[54:55] op_sel:[0,1] op_sel_hi:[1,1]
    v_cvt_pk_bf16_f32 v76, v76, v77
    v_cvt_pk_bf16_f32 v77, v78, v79
    buffer_store_dwordx2 v[72:73], v56, s[12:15], s40 offen offset:896 sc0 sc1
    v_accvgpr_read_b32 v80, a56
    v_accvgpr_read_b32 v81, a68
    v_accvgpr_read_b32 v82, a80
    v_accvgpr_read_b32 v83, a92
    v_pk_mul_f32 v[80:81], v[80:81], v[52:53] op_sel_hi:[1,0]
    v_pk_mul_f32 v[82:83], v[82:83], v[52:53] op_sel_hi:[1,0]
    v_cvt_pk_bf16_f32 v80, v80, v81
    v_cvt_pk_bf16_f32 v81, v82, v83
    buffer_store_dwordx2 v[76:77], v56, s[12:15], s40 offen offset:1280 sc0 sc1
    v_accvgpr_read_b32 v84, a57
    v_accvgpr_read_b32 v85, a69
    v_accvgpr_read_b32 v86, a81
    v_accvgpr_read_b32 v87, a93
    v_pk_mul_f32 v[84:85], v[84:85], v[52:53] op_sel:[0,1] op_sel_hi:[1,1]
    v_pk_mul_f32 v[86:87], v[86:87], v[52:53] op_sel:[0,1] op_sel_hi:[1,1]
    v_cvt_pk_bf16_f32 v84, v84, v85
    v_cvt_pk_bf16_f32 v85, v86, v87
    buffer_store_dwordx2 v[80:81], v56, s[12:15], s40 offen offset:256 sc0 sc1
    v_accvgpr_read_b32 v88, a58
    v_accvgpr_read_b32 v89, a70
    v_accvgpr_read_b32 v90, a82
    v_accvgpr_read_b32 v91, a94
    v_pk_mul_f32 v[88:89], v[88:89], v[54:55] op_sel_hi:[1,0]
    v_pk_mul_f32 v[90:91], v[90:91], v[54:55] op_sel_hi:[1,0]
    v_cvt_pk_bf16_f32 v88, v88, v89
    v_cvt_pk_bf16_f32 v89, v90, v91
    buffer_store_dwordx2 v[84:85], v56, s[12:15], s40 offen offset:640 sc0 sc1
    v_accvgpr_read_b32 v92, a59
    v_accvgpr_read_b32 v93, a71
    v_accvgpr_read_b32 v94, a83
    v_accvgpr_read_b32 v95, a95
    v_pk_mul_f32 v[92:93], v[92:93], v[54:55] op_sel:[0,1] op_sel_hi:[1,1]
    v_pk_mul_f32 v[94:95], v[94:95], v[54:55] op_sel:[0,1] op_sel_hi:[1,1]
    v_cvt_pk_bf16_f32 v92, v92, v93
    v_cvt_pk_bf16_f32 v93, v94, v95
    buffer_store_dwordx2 v[88:89], v56, s[12:15], s40 offen offset:1024 sc0 sc1
    v_accvgpr_read_b32 v96, a96
    v_accvgpr_read_b32 v97, a108
    v_accvgpr_read_b32 v98, a120
    v_accvgpr_read_b32 v99, a132
    v_pk_mul_f32 v[96:97], v[96:97], v[128:129] op_sel_hi:[1,0]
    v_pk_mul_f32 v[98:99], v[98:99], v[128:129] op_sel_hi:[1,0]
    v_cvt_pk_bf16_f32 v96, v96, v97
    v_cvt_pk_bf16_f32 v97, v98, v99
    buffer_store_dwordx2 v[92:93], v56, s[12:15], s40 offen offset:1408 sc0 sc1
    v_accvgpr_read_b32 v100, a97
    v_accvgpr_read_b32 v101, a109
    v_accvgpr_read_b32 v102, a121
    v_accvgpr_read_b32 v103, a133
    v_pk_mul_f32 v[100:101], v[100:101], v[128:129] op_sel:[0,1] op_sel_hi:[1,1]
    v_pk_mul_f32 v[102:103], v[102:103], v[128:129] op_sel:[0,1] op_sel_hi:[1,1]
    v_cvt_pk_bf16_f32 v100, v100, v101
    v_cvt_pk_bf16_f32 v101, v102, v103
    buffer_store_dwordx2 v[96:97], v56, s[12:15], s41 offen offset:0 sc0 sc1
    v_accvgpr_read_b32 v104, a98
    v_accvgpr_read_b32 v105, a110
    v_accvgpr_read_b32 v106, a122
    v_accvgpr_read_b32 v107, a134
    v_pk_mul_f32 v[104:105], v[104:105], v[130:131] op_sel_hi:[1,0]
    v_pk_mul_f32 v[106:107], v[106:107], v[130:131] op_sel_hi:[1,0]
    v_cvt_pk_bf16_f32 v104, v104, v105
    v_cvt_pk_bf16_f32 v105, v106, v107
    buffer_store_dwordx2 v[100:101], v56, s[12:15], s41 offen offset:384 sc0 sc1
    v_accvgpr_read_b32 v108, a99
    v_accvgpr_read_b32 v109, a111
    v_accvgpr_read_b32 v110, a123
    v_accvgpr_read_b32 v111, a135
    v_pk_mul_f32 v[108:109], v[108:109], v[130:131] op_sel:[0,1] op_sel_hi:[1,1]
    v_pk_mul_f32 v[110:111], v[110:111], v[130:131] op_sel:[0,1] op_sel_hi:[1,1]
    v_cvt_pk_bf16_f32 v108, v108, v109
    v_cvt_pk_bf16_f32 v109, v110, v111
    buffer_store_dwordx2 v[104:105], v56, s[12:15], s41 offen offset:768 sc0 sc1
    v_accvgpr_read_b32 v112, a100
    v_accvgpr_read_b32 v113, a112
    v_accvgpr_read_b32 v114, a124
    v_accvgpr_read_b32 v115, a136
    v_pk_mul_f32 v[112:113], v[112:113], v[128:129] op_sel_hi:[1,0]
    v_pk_mul_f32 v[114:115], v[114:115], v[128:129] op_sel_hi:[1,0]
    v_cvt_pk_bf16_f32 v112, v112, v113
    v_cvt_pk_bf16_f32 v113, v114, v115
    buffer_store_dwordx2 v[108:109], v56, s[12:15], s41 offen offset:1152 sc0 sc1
    v_accvgpr_read_b32 v116, a101
    v_accvgpr_read_b32 v117, a113
    v_accvgpr_read_b32 v118, a125
    v_accvgpr_read_b32 v119, a137
    v_pk_mul_f32 v[116:117], v[116:117], v[128:129] op_sel:[0,1] op_sel_hi:[1,1]
    v_pk_mul_f32 v[118:119], v[118:119], v[128:129] op_sel:[0,1] op_sel_hi:[1,1]
    v_cvt_pk_bf16_f32 v116, v116, v117
    v_cvt_pk_bf16_f32 v117, v118, v119
    buffer_store_dwordx2 v[112:113], v56, s[12:15], s41 offen offset:128 sc0 sc1
    v_accvgpr_read_b32 v120, a102
    v_accvgpr_read_b32 v121, a114
    v_accvgpr_read_b32 v122, a126
    v_accvgpr_read_b32 v123, a138
    v_pk_mul_f32 v[120:121], v[120:121], v[130:131] op_sel_hi:[1,0]
    v_pk_mul_f32 v[122:123], v[122:123], v[130:131] op_sel_hi:[1,0]
    v_cvt_pk_bf16_f32 v120, v120, v121
    v_cvt_pk_bf16_f32 v121, v122, v123
    buffer_store_dwordx2 v[116:117], v56, s[12:15], s41 offen offset:512 sc0 sc1
    v_accvgpr_read_b32 v124, a103
    v_accvgpr_read_b32 v125, a115
    v_accvgpr_read_b32 v126, a127
    v_accvgpr_read_b32 v127, a139
    v_pk_mul_f32 v[124:125], v[124:125], v[130:131] op_sel:[0,1] op_sel_hi:[1,1]
    v_pk_mul_f32 v[126:127], v[126:127], v[130:131] op_sel:[0,1] op_sel_hi:[1,1]
    v_cvt_pk_bf16_f32 v124, v124, v125
    v_cvt_pk_bf16_f32 v125, v126, v127
    buffer_store_dwordx2 v[120:121], v56, s[12:15], s41 offen offset:896 sc0 sc1
    v_accvgpr_read_b32 v64, a104
    v_accvgpr_read_b32 v65, a116
    v_accvgpr_read_b32 v66, a128
    v_accvgpr_read_b32 v67, a140
    v_pk_mul_f32 v[64:65], v[64:65], v[128:129] op_sel_hi:[1,0]
    v_pk_mul_f32 v[66:67], v[66:67], v[128:129] op_sel_hi:[1,0]
    v_cvt_pk_bf16_f32 v64, v64, v65
    v_cvt_pk_bf16_f32 v65, v66, v67
    buffer_store_dwordx2 v[124:125], v56, s[12:15], s41 offen offset:1280 sc0 sc1
    v_accvgpr_read_b32 v68, a105
    v_accvgpr_read_b32 v69, a117
    v_accvgpr_read_b32 v70, a129
    v_accvgpr_read_b32 v71, a141
    v_pk_mul_f32 v[68:69], v[68:69], v[128:129] op_sel:[0,1] op_sel_hi:[1,1]
    v_pk_mul_f32 v[70:71], v[70:71], v[128:129] op_sel:[0,1] op_sel_hi:[1,1]
    v_cvt_pk_bf16_f32 v68, v68, v69
    v_cvt_pk_bf16_f32 v69, v70, v71
    buffer_store_dwordx2 v[64:65], v56, s[12:15], s41 offen offset:256 sc0 sc1
    v_accvgpr_read_b32 v72, a106
    v_accvgpr_read_b32 v73, a118
    v_accvgpr_read_b32 v74, a130
    v_accvgpr_read_b32 v75, a142
    v_pk_mul_f32 v[72:73], v[72:73], v[130:131] op_sel_hi:[1,0]
    v_pk_mul_f32 v[74:75], v[74:75], v[130:131] op_sel_hi:[1,0]
    v_cvt_pk_bf16_f32 v72, v72, v73
    v_cvt_pk_bf16_f32 v73, v74, v75
    buffer_store_dwordx2 v[68:69], v56, s[12:15], s41 offen offset:640 sc0 sc1
    v_accvgpr_read_b32 v76, a107
    v_accvgpr_read_b32 v77, a119
    v_accvgpr_read_b32 v78, a131
    v_accvgpr_read_b32 v79, a143
    v_pk_mul_f32 v[76:77], v[76:77], v[130:131] op_sel:[0,1] op_sel_hi:[1,1]
    v_pk_mul_f32 v[78:79], v[78:79], v[130:131] op_sel:[0,1] op_sel_hi:[1,1]
    v_cvt_pk_bf16_f32 v76, v76, v77
    v_cvt_pk_bf16_f32 v77, v78, v79
    buffer_store_dwordx2 v[72:73], v56, s[12:15], s41 offen offset:1024 sc0 sc1
    v_accvgpr_read_b32 v80, a144
    v_accvgpr_read_b32 v81, a156
    v_accvgpr_read_b32 v82, a168
    v_accvgpr_read_b32 v83, a180
    v_pk_mul_f32 v[80:81], v[80:81], v[132:133] op_sel_hi:[1,0]
    v_pk_mul_f32 v[82:83], v[82:83], v[132:133] op_sel_hi:[1,0]
    v_cvt_pk_bf16_f32 v80, v80, v81
    v_cvt_pk_bf16_f32 v81, v82, v83
    buffer_store_dwordx2 v[76:77], v56, s[12:15], s41 offen offset:1408 sc0 sc1
    v_accvgpr_read_b32 v84, a145
    v_accvgpr_read_b32 v85, a157
    v_accvgpr_read_b32 v86, a169
    v_accvgpr_read_b32 v87, a181
    v_pk_mul_f32 v[84:85], v[84:85], v[132:133] op_sel:[0,1] op_sel_hi:[1,1]
    v_pk_mul_f32 v[86:87], v[86:87], v[132:133] op_sel:[0,1] op_sel_hi:[1,1]
    v_cvt_pk_bf16_f32 v84, v84, v85
    v_cvt_pk_bf16_f32 v85, v86, v87
    buffer_store_dwordx2 v[80:81], v56, s[12:15], s42 offen offset:0 sc0 sc1
    v_accvgpr_read_b32 v88, a146
    v_accvgpr_read_b32 v89, a158
    v_accvgpr_read_b32 v90, a170
    v_accvgpr_read_b32 v91, a182
    v_pk_mul_f32 v[88:89], v[88:89], v[134:135] op_sel_hi:[1,0]
    v_pk_mul_f32 v[90:91], v[90:91], v[134:135] op_sel_hi:[1,0]
    v_cvt_pk_bf16_f32 v88, v88, v89
    v_cvt_pk_bf16_f32 v89, v90, v91
    buffer_store_dwordx2 v[84:85], v56, s[12:15], s42 offen offset:384 sc0 sc1
    v_accvgpr_read_b32 v92, a147
    v_accvgpr_read_b32 v93, a159
    v_accvgpr_read_b32 v94, a171
    v_accvgpr_read_b32 v95, a183
    v_pk_mul_f32 v[92:93], v[92:93], v[134:135] op_sel:[0,1] op_sel_hi:[1,1]
    v_pk_mul_f32 v[94:95], v[94:95], v[134:135] op_sel:[0,1] op_sel_hi:[1,1]
    v_cvt_pk_bf16_f32 v92, v92, v93
    v_cvt_pk_bf16_f32 v93, v94, v95
    buffer_store_dwordx2 v[88:89], v56, s[12:15], s42 offen offset:768 sc0 sc1
    v_accvgpr_read_b32 v96, a148
    v_accvgpr_read_b32 v97, a160
    v_accvgpr_read_b32 v98, a172
    v_accvgpr_read_b32 v99, a184
    v_pk_mul_f32 v[96:97], v[96:97], v[132:133] op_sel_hi:[1,0]
    v_pk_mul_f32 v[98:99], v[98:99], v[132:133] op_sel_hi:[1,0]
    v_cvt_pk_bf16_f32 v96, v96, v97
    v_cvt_pk_bf16_f32 v97, v98, v99
    buffer_store_dwordx2 v[92:93], v56, s[12:15], s42 offen offset:1152 sc0 sc1
    v_accvgpr_read_b32 v100, a149
    v_accvgpr_read_b32 v101, a161
    v_accvgpr_read_b32 v102, a173
    v_accvgpr_read_b32 v103, a185
    v_pk_mul_f32 v[100:101], v[100:101], v[132:133] op_sel:[0,1] op_sel_hi:[1,1]
    v_pk_mul_f32 v[102:103], v[102:103], v[132:133] op_sel:[0,1] op_sel_hi:[1,1]
    v_cvt_pk_bf16_f32 v100, v100, v101
    v_cvt_pk_bf16_f32 v101, v102, v103
    buffer_store_dwordx2 v[96:97], v56, s[12:15], s42 offen offset:128 sc0 sc1
    v_accvgpr_read_b32 v104, a150
    v_accvgpr_read_b32 v105, a162
    v_accvgpr_read_b32 v106, a174
    v_accvgpr_read_b32 v107, a186
    v_pk_mul_f32 v[104:105], v[104:105], v[134:135] op_sel_hi:[1,0]
    v_pk_mul_f32 v[106:107], v[106:107], v[134:135] op_sel_hi:[1,0]
    v_cvt_pk_bf16_f32 v104, v104, v105
    v_cvt_pk_bf16_f32 v105, v106, v107
    buffer_store_dwordx2 v[100:101], v56, s[12:15], s42 offen offset:512 sc0 sc1
    v_accvgpr_read_b32 v108, a151
    v_accvgpr_read_b32 v109, a163
    v_accvgpr_read_b32 v110, a175
    v_accvgpr_read_b32 v111, a187
    v_pk_mul_f32 v[108:109], v[108:109], v[134:135] op_sel:[0,1] op_sel_hi:[1,1]
    v_pk_mul_f32 v[110:111], v[110:111], v[134:135] op_sel:[0,1] op_sel_hi:[1,1]
    v_cvt_pk_bf16_f32 v108, v108, v109
    v_cvt_pk_bf16_f32 v109, v110, v111
    buffer_store_dwordx2 v[104:105], v56, s[12:15], s42 offen offset:896 sc0 sc1
    v_accvgpr_read_b32 v112, a152
    v_accvgpr_read_b32 v113, a164
    v_accvgpr_read_b32 v114, a176
    v_accvgpr_read_b32 v115, a188
    v_pk_mul_f32 v[112:113], v[112:113], v[132:133] op_sel_hi:[1,0]
    v_pk_mul_f32 v[114:115], v[114:115], v[132:133] op_sel_hi:[1,0]
    v_cvt_pk_bf16_f32 v112, v112, v113
    v_cvt_pk_bf16_f32 v113, v114, v115
    buffer_store_dwordx2 v[108:109], v56, s[12:15], s42 offen offset:1280 sc0 sc1
    v_accvgpr_read_b32 v116, a153
    v_accvgpr_read_b32 v117, a165
    v_accvgpr_read_b32 v118, a177
    v_accvgpr_read_b32 v119, a189
    v_pk_mul_f32 v[116:117], v[116:117], v[132:133] op_sel:[0,1] op_sel_hi:[1,1]
    v_pk_mul_f32 v[118:119], v[118:119], v[132:133] op_sel:[0,1] op_sel_hi:[1,1]
    v_cvt_pk_bf16_f32 v116, v116, v117
    v_cvt_pk_bf16_f32 v117, v118, v119
    buffer_store_dwordx2 v[112:113], v56, s[12:15], s42 offen offset:256 sc0 sc1
    v_accvgpr_read_b32 v120, a154
    v_accvgpr_read_b32 v121, a166
    v_accvgpr_read_b32 v122, a178
    v_accvgpr_read_b32 v123, a190
    v_pk_mul_f32 v[120:121], v[120:121], v[134:135] op_sel_hi:[1,0]
    v_pk_mul_f32 v[122:123], v[122:123], v[134:135] op_sel_hi:[1,0]
    v_cvt_pk_bf16_f32 v120, v120, v121
    v_cvt_pk_bf16_f32 v121, v122, v123
    buffer_store_dwordx2 v[116:117], v56, s[12:15], s42 offen offset:640 sc0 sc1
    v_accvgpr_read_b32 v124, a155
    v_accvgpr_read_b32 v125, a167
    v_accvgpr_read_b32 v126, a179
    v_accvgpr_read_b32 v127, a191
    v_pk_mul_f32 v[124:125], v[124:125], v[134:135] op_sel:[0,1] op_sel_hi:[1,1]
    v_pk_mul_f32 v[126:127], v[126:127], v[134:135] op_sel:[0,1] op_sel_hi:[1,1]
    v_cvt_pk_bf16_f32 v124, v124, v125
    v_cvt_pk_bf16_f32 v125, v126, v127
    buffer_store_dwordx2 v[120:121], v56, s[12:15], s42 offen offset:1024 sc0 sc1
    buffer_store_dwordx2 v[124:125], v56, s[12:15], s42 offen offset:1408 sc0 sc1
    s_branch L_fin
.section .rodata,"a"
.p2align 6
.amdhsa_kernel standalone__kv_cache_quant_int4_int2_kv_with_per_channel_or_per_token_scales__prompt_kernel
  .amdhsa_next_free_vgpr 512
  .amdhsa_next_free_sgpr 102
  .amdhsa_accum_offset 256
  .amdhsa_group_segment_fixed_size 0
  .amdhsa_kernarg_size 80
  .amdhsa_user_sgpr_count 2
  .amdhsa_user_sgpr_kernarg_segment_ptr 1
  .amdhsa_system_sgpr_workgroup_id_x 1
.end_amdhsa_kernel
```

```asm
; @launch grid=(256,1,1) block=(256,1,1) lds=147584
.amdgcn_target "amdgcn-amd-amdhsa--gfx950"
.text
.globl standalone__kv_cache_quant_int4_int2_kv_with_per_channel_or_per_token_scales__prompt_kernel
.p2align 8
.type standalone__kv_cache_quant_int4_int2_kv_with_per_channel_or_per_token_scales__prompt_kernel,@function
standalone__kv_cache_quant_int4_int2_kv_with_per_channel_or_per_token_scales__prompt_kernel:
    s_cmp_ge_u32 s2, 256
    s_cbranch_scc1 L_done
    s_load_dwordx16 s[40:55], s[0:1], 0
    s_load_dwordx4 s[16:19], s[0:1], 64
    s_and_b32 s94, s2, 7
    s_lshr_b32 s95, s2, 3
    s_lshr_b32 s24, s95, 3
    s_lshl_b32 s94, s94, 2
    s_add_u32 s94, s94, s24
    s_and_b32 s95, s95, 7
    s_getpc_b64 s[60:61]
L_pc:
    s_sub_u32 s60, s60, L_pc-standalone__kv_cache_quant_int4_int2_kv_with_per_channel_or_per_token_scales__prompt_kernel
    s_subb_u32 s61, s61, 0
    s_mov_b32 s62, L_slow-standalone__kv_cache_quant_int4_int2_kv_with_per_channel_or_per_token_scales__prompt_kernel
    s_mov_b32 s63, 0x20000
    s_lshr_b32 s22, s2, 3
    s_lshl_b32 s22, s22, 12
    v_lshlrev_b32 v30, 4, v0
    buffer_load_dwordx4 v[128:131], v30, s[60:63], s22 offen
    v_lshrrev_b32 v24, 6, v0
    v_and_b32 v25, 63, v0
    v_readfirstlane_b32 s25, v24
    v_lshlrev_b32 v1, 4, v25
    v_mul_u32_u24 v26, 43, v25
    v_lshrrev_b32 v26, 10, v26
    v_mul_u32_u24 v27, 24, v26
    v_sub_u32 v27, v25, v27
    v_lshrrev_b32 v28, 1, v24
    v_and_b32 v29, 1, v24
    v_lshlrev_b32 v30, 4, v29
    v_lshl_add_u32 v30, v28, 2, v30
    v_add_u32 v30, v30, v26
    v_mul_u32_u24 v30, 768, v30
    v_lshrrev_b32 v48, 1, v26
    v_lshlrev_b32 v48, 30, v48
    v_lshl_add_u32 v30, v27, 4, v30
    v_or_b32 v9, v30, v48
    v_lshl_or_b32 v10, v27, 3, v48
    v_mul_u32_u24 v30, 6144, v24
    v_add3_u32 v12, v30, v1, v48
    s_mov_b32 s66, 1572864
    s_mov_b32 s67, 0x20000
    s_mov_b32 s70, 1572864
    s_mov_b32 s71, 0x20000
    s_mov_b32 s74, 12288
    s_mov_b32 s75, 0x20000
    s_mov_b32 s78, 12288
    s_mov_b32 s79, 0x20000
    s_mov_b32 s82, 4096
    s_mov_b32 s83, 0x20000
    s_mov_b32 s86, 4096
    s_mov_b32 s87, 0x20000
    s_mov_b32 s22, 64
    s_mov_b32 s23, 0x20000
    s_mul_i32 s33, s95, 24576
    s_add_u32 s34, s33, 6144
    s_mov_b32 s35, s33
    s_lshr_b32 s36, s95, 1
    s_mul_i32 s36, s36, 384
    s_lshl_b32 s37, s95, 6
    s_lshl_b32 s24, s25, 4
    s_add_u32 s37, s37, s24
    s_mul_i32 s24, s94, 1572864
    s_mul_i32 s56, s94, 12288
    s_lshl_b32 s57, s94, 12
    s_lshl_b32 s58, s94, 10
    s_add_u32 s58, s58, 51380320
    s_or_b32 s39, s95, s25
    s_waitcnt lgkmcnt(0)
    s_add_u32 s64, s42, s24
    s_addc_u32 s65, s43, 0
    s_add_u32 s72, s46, s56
    s_addc_u32 s73, s47, 0
    s_add_u32 s76, s48, s56
    s_addc_u32 s77, s49, 0
    buffer_load_dwordx4 v[224:227], v9, s[64:67], s33 offen offset:0 nt
    buffer_load_dwordx4 v[228:231], v9, s[64:67], s33 offen offset:1536 nt
    buffer_load_dwordx4 v[232:235], v9, s[64:67], s34 offen offset:0 nt
    buffer_load_dwordx4 v[236:239], v9, s[64:67], s34 offen offset:1536 nt
    buffer_load_dwordx2 v[32:33], v10, s[72:75], s36 offen offset:0
    buffer_load_dwordx2 v[34:35], v10, s[76:79], s36 offen offset:0
    buffer_load_dwordx2 v[36:37], v10, s[72:75], s36 offen offset:192
    buffer_load_dwordx2 v[38:39], v10, s[76:79], s36 offen offset:192
    s_add_u32 s20, s18, s58
    s_addc_u32 s21, s19, 0
    s_add_u32 s80, s50, s57
    s_addc_u32 s81, s51, 0
    s_add_u32 s84, s52, s57
    s_addc_u32 s85, s53, 0
    s_add_u32 s68, s44, s24
    s_addc_u32 s69, s45, 0
    s_mul_i32 s59, s94, 786432
    s_add_u32 s12, s54, s59
    s_addc_u32 s13, s55, 0
    s_add_u32 s8, s40, s59
    s_addc_u32 s9, s41, 0
    s_cmp_lg_u32 s39, 0
    s_cbranch_scc1 L_notleader0
    s_buffer_load_dwordx16 s[40:55], s[20:23], 0 glc
L_notleader0:
    buffer_load_dwordx4 v[240:243], v9, s[64:67], s33 offen offset:384 nt
    buffer_load_dwordx4 v[244:247], v9, s[64:67], s33 offen offset:1920 nt
    buffer_load_dwordx4 v[248:251], v9, s[64:67], s34 offen offset:384 nt
    buffer_load_dwordx4 v[252:255], v9, s[64:67], s34 offen offset:1920 nt
    s_add_u32 s4, s18, s24
    s_addc_u32 s5, s19, 0
    s_mov_b32 s6, 1572864
    s_mov_b32 s7, 0x20000
    s_mov_b32 s10, 786432
    s_mov_b32 s11, 0x20000
    s_mov_b32 s88, s16
    s_mov_b32 s89, s17
    s_add_u32 s16, s33, 3072
    s_add_u32 s17, s33, 6144
    s_mov_b32 s90, 256
    s_mov_b32 s91, 0x20000
    s_lshl_b32 s93, s94, 3
    s_cmp_lg_u32 s39, 0
    s_cbranch_scc1 L_notleader
    s_waitcnt lgkmcnt(0)
    s_mov_b32 s59, 1
    s_lshr_b32 s40, s40, 10
    s_min_u32 s40, s40, 31
    s_bitset1_b32 s59, s40
    s_lshr_b32 s41, s41, 10
    s_min_u32 s41, s41, 31
    s_bitset1_b32 s59, s41
    s_lshr_b32 s42, s42, 10
    s_min_u32 s42, s42, 31
    s_bitset1_b32 s59, s42
    s_lshr_b32 s43, s43, 10
    s_min_u32 s43, s43, 31
    s_bitset1_b32 s59, s43
    s_lshr_b32 s44, s44, 10
    s_min_u32 s44, s44, 31
    s_bitset1_b32 s59, s44
    s_lshr_b32 s45, s45, 10
    s_min_u32 s45, s45, 31
    s_bitset1_b32 s59, s45
    s_lshr_b32 s46, s46, 10
    s_min_u32 s46, s46, 31
    s_bitset1_b32 s59, s46
    s_lshr_b32 s47, s47, 10
    s_min_u32 s47, s47, 31
    s_bitset1_b32 s59, s47
    s_lshr_b32 s48, s48, 10
    s_min_u32 s48, s48, 31
    s_bitset1_b32 s59, s48
    s_lshr_b32 s49, s49, 10
    s_min_u32 s49, s49, 31
    s_bitset1_b32 s59, s49
    s_lshr_b32 s50, s50, 10
    s_min_u32 s50, s50, 31
    s_bitset1_b32 s59, s50
    s_lshr_b32 s51, s51, 10
    s_min_u32 s51, s51, 31
    s_bitset1_b32 s59, s51
    s_lshr_b32 s52, s52, 10
    s_min_u32 s52, s52, 31
    s_bitset1_b32 s59, s52
    s_lshr_b32 s53, s53, 10
    s_min_u32 s53, s53, 31
    s_bitset1_b32 s59, s53
    s_lshr_b32 s54, s54, 10
    s_min_u32 s54, s54, 31
    s_bitset1_b32 s59, s54
    s_lshr_b32 s55, s55, 10
    s_min_u32 s55, s55, 31
    s_bitset1_b32 s59, s55
    s_ff0_i32_b32 s59, s59
    s_lshl_b32 s59, s59, 10
    v_mov_b32 v52, s59
    s_mov_b64 exec, 1
    buffer_store_dword v52, off, s[88:91], s93 sc1
    s_mov_b64 exec, -1
L_notleader:
    s_lshl_b32 s24, s95, 2
    s_add_u32 s24, s24, 32
    s_buffer_load_dword s46, s[20:23], s24 glc
    s_getreg_b32 s45, hwreg(HW_REG_XCC_ID, 0, 4)
    s_lshl_b32 s45, s45, 5
    s_mov_b32 s44, 0
    buffer_load_dwordx4 v[112:115], v12, s[68:71], s35 offen offset:0 nt
    buffer_load_dwordx4 v[116:119], v12, s[68:71], s35 offen offset:768 nt
    buffer_load_dwordx4 v[120:123], v12, s[68:71], s35 offen offset:1536 nt
    buffer_load_dwordx4 v[124:127], v12, s[68:71], s35 offen offset:2304 nt
    buffer_load_dwordx2 v[40:41], off, s[80:83], s37 offset:0
    buffer_load_dwordx2 v[42:43], off, s[84:87], s37 offset:0
    buffer_load_dwordx2 v[44:45], off, s[80:83], s37 offset:8
    buffer_load_dwordx2 v[46:47], off, s[84:87], s37 offset:8
    s_mov_b32 s14, 786432
    s_mov_b32 s15, 0x20000
    s_lshl_b32 s24, s25, 8
    s_add_u32 s93, s93, s24
    v_mul_u32_u24 v30, 3072, v24
    v_add_u32 v4, v30, v1
    v_lshl_add_u32 v30, v24, 3, v26
    v_mul_u32_u24 v30, 384, v30
    v_lshlrev_b32 v31, 2, v29
    v_xor_b32 v31, v27, v31
    v_lshl_add_u32 v30, v31, 4, v30
    v_or_b32 v11, v30, v48
    v_lshlrev_b32 v30, 8, v24
    v_add_u32 v30, 12288, v30
    v_lshrrev_b32 v31, 4, v25
    v_lshl_add_u32 v30, v31, 10, v30
    v_and_b32 v31, 15, v25
    v_lshl_add_u32 v30, v31, 4, v30
    v_or_b32 v20, v30, v48
    s_lshl_b32 s24, s95, 2
    v_lshl_add_u32 v13, v0, 2, s24
    v_cmp_lt_u32 vcc, 0, v0
    v_mov_b32 v30, 0x40000000
    s_nop 0
    v_cndmask_b32 v13, v13, v30, vcc
    s_mul_i32 s26, s25, 3072
    s_add_u32 s26, s26, 12288
    s_add_u32 s56, s26, 24576
    s_add_u32 s24, s95, 1
    s_and_b32 s24, s24, 7
    s_mul_i32 s32, s24, 24576
    s_add_u32 s27, s32, 12288
    s_mov_b32 s28, 98304
    s_mov_b32 s30, 73728
    v_add_u32 v1, 24576, v1
    s_mov_b32 s38, 0x3dd53b95
    s_mov_b32 s97, 0xffff0000
    s_mov_b32 s96, 100000
    v_and_b32 v26, 15, v25
    v_lshrrev_b32 v27, 4, v25
    v_bfe_u32 v28, v25, 1, 3
    v_xor_b32 v29, v27, v28
    v_mul_u32_u24 v30, 384, v26
    v_lshl_add_u32 v2, v29, 4, v30
    v_xor_b32 v3, 64, v2
    s_mul_i32 s40, s25, 6144
    s_add_u32 s40, s40, 73728
    v_lshrrev_b32 v29, 1, v27
    v_xor_b32 v29, v29, v28
    v_lshl_add_u32 v31, v29, 4, v30
    v_and_b32 v29, 1, v27
    v_lshl_add_u32 v31, v29, 3, v31
    v_xor_b32 v22, 0, v31
    v_add_u32 v22, s40, v22
    v_xor_b32 v23, 32, v31
    v_add_u32 v23, s40, v23
    v_xor_b32 v142, 64, v31
    v_add_u32 v142, s40, v142
    v_xor_b32 v143, 96, v31
    v_add_u32 v143, s40, v143
    s_lshl_b32 s24, s95, 2
    s_add_u32 s24, s24, s25
    s_mul_i32 s24, s24, 24576
    v_add_u32 v26, 0, v25
    v_mul_u32_u24 v27, 2731, v26
    v_lshrrev_b32 v27, 17, v27
    v_and_b32 v27, 7, v27
    v_xor_b32 v26, v26, v27
    v_lshlrev_b32 v136, 4, v26
    v_add_u32 v136, s24, v136
    v_add_u32 v26, 64, v25
    v_mul_u32_u24 v27, 2731, v26
    v_lshrrev_b32 v27, 17, v27
    v_and_b32 v27, 7, v27
    v_xor_b32 v26, v26, v27
    v_lshlrev_b32 v137, 4, v26
    v_add_u32 v137, s24, v137
    v_add_u32 v26, 128, v25
    v_mul_u32_u24 v27, 2731, v26
    v_lshrrev_b32 v27, 17, v27
    v_and_b32 v27, 7, v27
    v_xor_b32 v26, v26, v27
    v_lshlrev_b32 v138, 4, v26
    v_add_u32 v138, s24, v138
    v_add_u32 v26, 192, v25
    v_mul_u32_u24 v27, 2731, v26
    v_lshrrev_b32 v27, 17, v27
    v_and_b32 v27, 7, v27
    v_xor_b32 v26, v26, v27
    v_lshlrev_b32 v139, 4, v26
    v_add_u32 v139, s24, v139
    v_add_u32 v26, 256, v25
    v_mul_u32_u24 v27, 2731, v26
    v_lshrrev_b32 v27, 17, v27
    v_and_b32 v27, 7, v27
    v_xor_b32 v26, v26, v27
    v_lshlrev_b32 v140, 4, v26
    v_add_u32 v140, s24, v140
    v_add_u32 v26, 320, v25
    v_mul_u32_u24 v27, 2731, v26
    v_lshrrev_b32 v27, 17, v27
    v_and_b32 v27, 7, v27
    v_xor_b32 v26, v26, v27
    v_lshlrev_b32 v141, 4, v26
    v_add_u32 v141, s24, v141
    v_mov_b32 v5, 0
    v_mov_b32 v6, 0
    v_mov_b32 v7, 0
    v_mov_b32 v8, 0
    s_mov_b32 s62, -1
    s_mov_b32 s63, 0xffff
    s_waitcnt vmcnt(12)
    buffer_load_dwordx4 v[80:83], v12, s[68:71], s16 offen offset:0 nt
    buffer_load_dwordx4 v[84:87], v12, s[68:71], s16 offen offset:768 nt
    buffer_load_dwordx4 v[88:91], v12, s[68:71], s16 offen offset:1536 nt
    buffer_load_dwordx4 v[92:95], v12, s[68:71], s16 offen offset:2304 nt
    v_lshlrev_b32 v48, 16, v32
    v_and_b32 v49, s97, v32
    v_lshlrev_b32 v50, 16, v34
    v_and_b32 v51, s97, v34
    v_mul_f32 v48, s38, v48
    v_mul_f32 v49, s38, v49
    v_mul_f32_e64 v50, -v50, v48
    v_mul_f32_e64 v51, -v51, v49
    v_cvt_f32_i32 v224, v224
    v_cvt_f32_i32 v225, v225
    v_fma_f32 v224, v224, v48, v50
    v_fma_f32 v225, v225, v49, v51
    v_cvt_pk_bf16_f32 v224, v224, v225
    v_cvt_f32_i32 v228, v228
    v_cvt_f32_i32 v229, v229
    v_fma_f32 v228, v228, v48, v50
    v_fma_f32 v229, v229, v49, v51
    v_cvt_pk_bf16_f32 v228, v228, v229
    v_cvt_f32_i32 v232, v232
    v_cvt_f32_i32 v233, v233
    v_fma_f32 v232, v232, v48, v50
    v_fma_f32 v233, v233, v49, v51
    v_cvt_pk_bf16_f32 v232, v232, v233
    v_cvt_f32_i32 v236, v236
    v_cvt_f32_i32 v237, v237
    v_fma_f32 v236, v236, v48, v50
    v_fma_f32 v237, v237, v49, v51
    v_cvt_pk_bf16_f32 v236, v236, v237
    v_lshlrev_b32 v48, 16, v33
    v_and_b32 v49, s97, v33
    v_lshlrev_b32 v50, 16, v35
    v_and_b32 v51, s97, v35
    v_mul_f32 v48, s38, v48
    v_mul_f32 v49, s38, v49
    v_mul_f32_e64 v50, -v50, v48
    v_mul_f32_e64 v51, -v51, v49
    v_cvt_f32_i32 v226, v226
    v_cvt_f32_i32 v227, v227
    v_fma_f32 v226, v226, v48, v50
    v_fma_f32 v227, v227, v49, v51
    v_cvt_pk_bf16_f32 v225, v226, v227
    v_cvt_f32_i32 v230, v230
    v_cvt_f32_i32 v231, v231
    v_fma_f32 v230, v230, v48, v50
    v_fma_f32 v231, v231, v49, v51
    v_cvt_pk_bf16_f32 v229, v230, v231
    v_cvt_f32_i32 v234, v234
    v_cvt_f32_i32 v235, v235
    v_fma_f32 v234, v234, v48, v50
    v_fma_f32 v235, v235, v49, v51
    v_cvt_pk_bf16_f32 v233, v234, v235
    v_cvt_f32_i32 v238, v238
    v_cvt_f32_i32 v239, v239
    v_fma_f32 v238, v238, v48, v50
    v_fma_f32 v239, v239, v49, v51
    v_cvt_pk_bf16_f32 v237, v238, v239
    s_waitcnt vmcnt(12)
    v_lshlrev_b32 v48, 16, v36
    v_and_b32 v49, s97, v36
    v_lshlrev_b32 v50, 16, v38
    v_and_b32 v51, s97, v38
    v_mul_f32 v48, s38, v48
    v_mul_f32 v49, s38, v49
    v_mul_f32_e64 v50, -v50, v48
    v_mul_f32_e64 v51, -v51, v49
    v_cvt_f32_i32 v240, v240
    v_cvt_f32_i32 v241, v241
    v_fma_f32 v240, v240, v48, v50
    v_fma_f32 v241, v241, v49, v51
    v_cvt_pk_bf16_f32 v226, v240, v241
    v_cvt_f32_i32 v244, v244
    v_cvt_f32_i32 v245, v245
    v_fma_f32 v244, v244, v48, v50
    v_fma_f32 v245, v245, v49, v51
    v_cvt_pk_bf16_f32 v230, v244, v245
    v_cvt_f32_i32 v248, v248
    v_cvt_f32_i32 v249, v249
    v_fma_f32 v248, v248, v48, v50
    v_fma_f32 v249, v249, v49, v51
    v_cvt_pk_bf16_f32 v234, v248, v249
    v_cvt_f32_i32 v252, v252
    v_cvt_f32_i32 v253, v253
    v_fma_f32 v252, v252, v48, v50
    v_fma_f32 v253, v253, v49, v51
    v_cvt_pk_bf16_f32 v238, v252, v253
    v_lshlrev_b32 v48, 16, v37
    v_and_b32 v49, s97, v37
    v_lshlrev_b32 v50, 16, v39
    v_and_b32 v51, s97, v39
    v_mul_f32 v48, s38, v48
    v_mul_f32 v49, s38, v49
    v_mul_f32_e64 v50, -v50, v48
    v_mul_f32_e64 v51, -v51, v49
    v_cvt_f32_i32 v242, v242
    v_cvt_f32_i32 v243, v243
    v_fma_f32 v242, v242, v48, v50
    v_fma_f32 v243, v243, v49, v51
    v_cvt_pk_bf16_f32 v227, v242, v243
    v_cvt_f32_i32 v246, v246
    v_cvt_f32_i32 v247, v247
    v_fma_f32 v246, v246, v48, v50
    v_fma_f32 v247, v247, v49, v51
    v_cvt_pk_bf16_f32 v231, v246, v247
    v_cvt_f32_i32 v250, v250
    v_cvt_f32_i32 v251, v251
    v_fma_f32 v250, v250, v48, v50
    v_fma_f32 v251, v251, v49, v51
    v_cvt_pk_bf16_f32 v235, v250, v251
    v_cvt_f32_i32 v254, v254
    v_cvt_f32_i32 v255, v255
    v_fma_f32 v254, v254, v48, v50
    v_fma_f32 v255, v255, v49, v51
    v_cvt_pk_bf16_f32 v239, v254, v255
    buffer_store_dwordx4 v[224:227], v11, s[4:7], s33 offen offset:0
    s_mov_b64 exec, s[62:63]
    ds_write_b128 v11, v[224:227] offset:0
    s_mov_b64 exec, -1
    v_xor_b32 v55, 16, v11
    buffer_store_dwordx4 v[228:231], v55, s[4:7], s33 offen offset:768
    s_mov_b64 exec, s[62:63]
    ds_write_b128 v55, v[228:231] offset:768
    s_mov_b64 exec, -1
    v_xor_b32 v54, 32, v11
    buffer_store_dwordx4 v[232:235], v54, s[4:7], s33 offen offset:1536
    s_mov_b64 exec, s[62:63]
    ds_write_b128 v54, v[232:235] offset:1536
    s_mov_b64 exec, -1
    v_xor_b32 v55, 48, v11
    buffer_store_dwordx4 v[236:239], v55, s[4:7], s33 offen offset:2304
    s_mov_b64 exec, s[62:63]
    ds_write_b128 v55, v[236:239] offset:2304
    s_mov_b64 exec, -1
    s_mov_b32 s41, 0
    s_add_u32 m0, s40, 24576
    s_nop 0
    buffer_load_dwordx4 v136, s[8:11], s41 offen nt lds
    s_add_u32 m0, s40, 25600
    s_nop 0
    buffer_load_dwordx4 v137, s[8:11], s41 offen nt lds
    s_add_u32 m0, s40, 26624
    s_nop 0
    buffer_load_dwordx4 v138, s[8:11], s41 offen nt lds
    s_add_u32 m0, s40, 27648
    s_nop 0
    buffer_load_dwordx4 v139, s[8:11], s41 offen nt lds
    s_add_u32 m0, s40, 28672
    s_nop 0
    buffer_load_dwordx4 v140, s[8:11], s41 offen nt lds
    s_add_u32 m0, s40, 29696
    s_waitcnt vmcnt(20)
    buffer_load_dwordx4 v141, s[8:11], s41 offen nt lds
    s_waitcnt vmcnt(14)
    v_lshlrev_b32 v48, 16, v40
    v_and_b32 v49, s97, v40
    v_lshlrev_b32 v50, 16, v42
    v_and_b32 v51, s97, v42
    v_mul_f32_e64 v50, -v50, v48
    v_mul_f32_e64 v51, -v51, v49
    v_cvt_f32_i32 v112, v112
    v_cvt_f32_i32 v116, v116
    v_fma_f32 v112, v112, v48, v50
    v_fma_f32 v116, v116, v49, v51
    v_cvt_f32_i32 v113, v113
    v_cvt_f32_i32 v117, v117
    v_fma_f32 v113, v113, v48, v50
    v_fma_f32 v117, v117, v49, v51
    v_cvt_f32_i32 v114, v114
    v_cvt_f32_i32 v118, v118
    v_fma_f32 v114, v114, v48, v50
    v_fma_f32 v118, v118, v49, v51
    v_cvt_f32_i32 v115, v115
    v_cvt_f32_i32 v119, v119
    v_fma_f32 v115, v115, v48, v50
    v_fma_f32 v119, v119, v49, v51
    v_lshlrev_b32 v48, 16, v41
    v_and_b32 v49, s97, v41
    v_lshlrev_b32 v50, 16, v43
    v_and_b32 v51, s97, v43
    v_mul_f32_e64 v50, -v50, v48
    v_mul_f32_e64 v51, -v51, v49
    v_cvt_f32_i32 v120, v120
    v_cvt_f32_i32 v124, v124
    v_fma_f32 v120, v120, v48, v50
    v_fma_f32 v124, v124, v49, v51
    v_cvt_f32_i32 v121, v121
    v_cvt_f32_i32 v125, v125
    v_fma_f32 v121, v121, v48, v50
    v_fma_f32 v125, v125, v49, v51
    v_cvt_f32_i32 v122, v122
    v_cvt_f32_i32 v126, v126
    v_fma_f32 v122, v122, v48, v50
    v_fma_f32 v126, v126, v49, v51
    v_cvt_f32_i32 v123, v123
    v_cvt_f32_i32 v127, v127
    v_fma_f32 v123, v123, v48, v50
    v_fma_f32 v127, v127, v49, v51
    v_cvt_pk_bf16_f32 v112, v112, v116
    v_cvt_pk_bf16_f32 v116, v113, v117
    v_cvt_pk_bf16_f32 v113, v120, v124
    v_cvt_pk_bf16_f32 v117, v121, v125
    v_cvt_pk_bf16_f32 v120, v114, v118
    v_cvt_pk_bf16_f32 v121, v122, v126
    v_cvt_pk_bf16_f32 v124, v115, v119
    v_cvt_pk_bf16_f32 v125, v123, v127
    s_waitcnt vmcnt(10)
    v_lshlrev_b32 v48, 16, v44
    v_and_b32 v49, s97, v44
    v_lshlrev_b32 v50, 16, v46
    v_and_b32 v51, s97, v46
    v_mul_f32_e64 v50, -v50, v48
    v_mul_f32_e64 v51, -v51, v49
    v_cvt_f32_i32 v80, v80
    v_cvt_f32_i32 v84, v84
    v_fma_f32 v80, v80, v48, v50
    v_fma_f32 v84, v84, v49, v51
    v_cvt_f32_i32 v81, v81
    v_cvt_f32_i32 v85, v85
    v_fma_f32 v81, v81, v48, v50
    v_fma_f32 v85, v85, v49, v51
    v_cvt_f32_i32 v82, v82
    v_cvt_f32_i32 v86, v86
    v_fma_f32 v82, v82, v48, v50
    v_fma_f32 v86, v86, v49, v51
    v_cvt_f32_i32 v83, v83
    v_cvt_f32_i32 v87, v87
    v_fma_f32 v83, v83, v48, v50
    v_fma_f32 v87, v87, v49, v51
    v_lshlrev_b32 v48, 16, v45
    v_and_b32 v49, s97, v45
    v_lshlrev_b32 v50, 16, v47
    v_and_b32 v51, s97, v47
    v_mul_f32_e64 v50, -v50, v48
    v_mul_f32_e64 v51, -v51, v49
    v_cvt_f32_i32 v88, v88
    v_cvt_f32_i32 v92, v92
    v_fma_f32 v88, v88, v48, v50
    v_fma_f32 v92, v92, v49, v51
    v_cvt_f32_i32 v89, v89
    v_cvt_f32_i32 v93, v93
    v_fma_f32 v89, v89, v48, v50
    v_fma_f32 v93, v93, v49, v51
    v_cvt_f32_i32 v90, v90
    v_cvt_f32_i32 v94, v94
    v_fma_f32 v90, v90, v48, v50
    v_fma_f32 v94, v94, v49, v51
    v_cvt_f32_i32 v91, v91
    v_cvt_f32_i32 v95, v95
    v_fma_f32 v91, v91, v48, v50
    v_fma_f32 v95, v95, v49, v51
    v_cvt_pk_bf16_f32 v114, v80, v84
    v_cvt_pk_bf16_f32 v118, v81, v85
    v_cvt_pk_bf16_f32 v115, v88, v92
    v_cvt_pk_bf16_f32 v119, v89, v93
    v_cvt_pk_bf16_f32 v122, v82, v86
    v_cvt_pk_bf16_f32 v123, v90, v94
    v_cvt_pk_bf16_f32 v126, v83, v87
    v_cvt_pk_bf16_f32 v127, v91, v95
    buffer_store_dwordx4 v[112:115], v20, s[4:7], s35 offen offset:0
    buffer_store_dwordx4 v[116:119], v20, s[4:7], s35 offen offset:3072
    buffer_store_dwordx4 v[120:123], v20, s[4:7], s17 offen offset:0
    buffer_store_dwordx4 v[124:127], v20, s[4:7], s17 offen offset:3072
    s_mov_b64 exec, s[62:63]
    ds_write_b128 v20, v[112:115] offset:12288
    ds_write_b128 v20, v[116:119] offset:15360
    ds_write_b128 v20, v[120:123] offset:18432
    ds_write_b128 v20, v[124:127] offset:21504
    s_mov_b64 exec, -1
    buffer_load_dword v0, off, s[88:91], s93 sc1
    s_mov_b32 s41, 6144
    s_add_u32 m0, s40, 0
    s_nop 0
    buffer_load_dwordx4 v136, s[8:11], s41 offen nt lds
    s_add_u32 m0, s40, 1024
    s_nop 0
    buffer_load_dwordx4 v137, s[8:11], s41 offen nt lds
    s_add_u32 m0, s40, 2048
    s_nop 0
    buffer_load_dwordx4 v138, s[8:11], s41 offen nt lds
    s_add_u32 m0, s40, 3072
    s_nop 0
    buffer_load_dwordx4 v139, s[8:11], s41 offen nt lds
    s_add_u32 m0, s40, 4096
    s_nop 0
    buffer_load_dwordx4 v140, s[8:11], s41 offen nt lds
    s_add_u32 m0, s40, 5120
    s_waitcnt vmcnt(15)
    buffer_load_dwordx4 v141, s[8:11], s41 offen nt lds
    s_waitcnt vmcnt(6)
    s_cmp_lg_u32 s25, 0
    s_cbranch_scc1 L_tagdone
    v_readfirstlane_b32 s42, v0
    s_mov_b32 s39, 100
    s_waitcnt lgkmcnt(0)
    s_and_b32 s46, s46, 0xfffffc00
L_tagretry:
    s_cmp_eq_u32 s42, s46
    s_cselect_b32 s42, 0, s42
    s_cmp_lg_u32 s42, 0
    s_cbranch_scc1 L_tagok
    s_sub_u32 s39, s39, 1
    s_cbranch_scc1 L_tagslow
    s_sleep 4
    s_buffer_load_dword s42, s[88:91], s93 glc
    s_waitcnt lgkmcnt(0)
    s_branch L_tagretry
L_tagok:
    s_add_u32 s42, s42, s45
    v_mov_b32 v0, s42
    v_mov_b32 v16, 147456
    ds_write_b32 v16, v0
L_tagdone:
    s_waitcnt lgkmcnt(0)
    s_barrier
    v_add_u32 v0, 1, v0
    buffer_store_dword v0, v13, s[20:23], 0 offen
    buffer_store_dword v0, v13, s[20:23], 0 offen offset:32 sc1
    v_mov_b32 v16, 147456
    ds_read_b32 v17, v16
    s_mov_b32 s88, s60
    s_mov_b32 s89, s61
    s_mov_b32 s90, L_slow-standalone__kv_cache_quant_int4_int2_kv_with_per_channel_or_per_token_scales__prompt_kernel
    s_lshr_b32 s24, s2, 3
    s_mul_i32 s93, s24, 43
    s_lshr_b32 s93, s93, 7
    s_mul_i32 s39, s93, 3
    s_sub_u32 s24, s24, s39
    s_lshl_b32 s24, s24, 10
    s_mul_i32 s93, s93, 12288
    s_add_u32 s93, s93, s24
    ds_read_b128 v[144:147], v2 offset:0
    ds_read_b128 v[148:151], v3 offset:0
    ds_read_b128 v[152:155], v2 offset:6144
    ds_read_b128 v[156:159], v3 offset:6144
    ds_read_b128 v[160:163], v2 offset:128
    ds_read_b128 v[164:167], v3 offset:128
    ds_read_b128 v[168:171], v2 offset:6272
    ds_read_b128 v[172:175], v3 offset:6272
    ds_read_b128 v[176:179], v2 offset:256
    ds_read_b128 v[180:183], v3 offset:256
    ds_read_b128 v[184:187], v2 offset:6400
    ds_read_b128 v[188:191], v3 offset:6400
    s_waitcnt vmcnt(13)
    ds_read_b64 a[192:193], v22 offset:24576
    ds_read_b64 a[194:195], v142 offset:24704
    ds_read_b64 a[196:197], v23 offset:24576
    ds_read_b64 a[198:199], v143 offset:24704
    ds_read_b64 a[200:201], v142 offset:24576
    ds_read_b64 a[202:203], v22 offset:24832
    ds_read_b64 a[204:205], v143 offset:24576
    ds_read_b64 a[206:207], v23 offset:24832
    ds_read_b64 a[208:209], v22 offset:24704
    ds_read_b64 a[210:211], v142 offset:24832
    ds_read_b64 a[212:213], v23 offset:24704
    ds_read_b64 a[214:215], v143 offset:24832
    s_waitcnt lgkmcnt(15)
    v_readfirstlane_b32 s92, v17
    s_add_u32 s92, s92, 1
    s_mov_b32 s41, 12288
    s_add_u32 m0, s40, 49152
    s_nop 0
    buffer_load_dwordx4 v136, s[8:11], s41 offen nt lds
    s_add_u32 m0, s40, 50176
    s_nop 0
    buffer_load_dwordx4 v137, s[8:11], s41 offen nt lds
    s_add_u32 m0, s40, 51200
    s_nop 0
    buffer_load_dwordx4 v138, s[8:11], s41 offen nt lds
    s_waitcnt lgkmcnt(0)
    v_mfma_f32_16x16x32_bf16 v[64:67], v[144:147], a[192:195], 0
    v_mfma_f32_16x16x32_bf16 v[64:67], v[148:151], a[196:199], v[64:67]
    v_mfma_f32_16x16x32_bf16 v[64:67], v[160:163], a[200:203], v[64:67]
    v_mfma_f32_16x16x32_bf16 v[64:67], v[164:167], a[204:207], v[64:67]
    v_mfma_f32_16x16x32_bf16 v[64:67], v[176:179], a[208:211], v[64:67]
    v_mfma_f32_16x16x32_bf16 v[64:67], v[180:183], a[212:215], v[64:67]
    v_mfma_f32_16x16x32_bf16 v[96:99], v[152:155], a[192:195], 0
    v_mfma_f32_16x16x32_bf16 v[96:99], v[156:159], a[196:199], v[96:99]
    v_mfma_f32_16x16x32_bf16 v[96:99], v[168:171], a[200:203], v[96:99]
    v_mfma_f32_16x16x32_bf16 v[96:99], v[172:175], a[204:207], v[96:99]
    v_mfma_f32_16x16x32_bf16 v[96:99], v[184:187], a[208:211], v[96:99]
    v_mfma_f32_16x16x32_bf16 v[96:99], v[188:191], a[212:215], v[96:99]
    s_nop 7
    v_max3_f32 v48, v64, v65, v66
    v_max3_f32 v50, v67, v96, v97
    v_max3_f32 v48, v48, v98, v99
    v_max_f32 v48, v48, v50
    v_mov_b32 v49, v48
    s_nop 1
    v_permlane16_swap_b32 v48, v49
    s_nop 1
    v_max_f32 v48, v48, v49
    v_mov_b32 v49, v48
    s_nop 1
    v_permlane32_swap_b32 v48, v49
    s_nop 1
    v_max_f32 v48, v48, v49
    v_sub_f32 v64, v64, v48
    v_sub_f32 v65, v65, v48
    v_sub_f32 v66, v66, v48
    v_sub_f32 v67, v67, v48
    v_sub_f32 v96, v96, v48
    v_sub_f32 v97, v97, v48
    v_sub_f32 v98, v98, v48
    v_sub_f32 v99, v99, v48
    v_exp_f32 v64, v64
    v_exp_f32 v65, v65
    v_exp_f32 v66, v66
    v_exp_f32 v67, v67
    v_exp_f32 v96, v96
    v_exp_f32 v97, v97
    v_exp_f32 v98, v98
    v_exp_f32 v99, v99
    v_sub_f32 v128, 0, v48
    v_sub_f32 v129, 0, v48
    v_sub_f32 v130, 0, v48
    v_sub_f32 v131, 0, v48
    v_add_f32 v5, v5, v64
    v_add_f32 v5, v5, v65
    v_add_f32 v5, v5, v66
    v_add_f32 v5, v5, v67
    v_add_f32 v5, v5, v96
    v_add_f32 v5, v5, v97
    v_add_f32 v5, v5, v98
    v_add_f32 v5, v5, v99
    v_cvt_pk_bf16_f32 v64, v64, v65
    v_cvt_pk_bf16_f32 v65, v66, v67
    v_cvt_pk_bf16_f32 v66, v96, v97
    v_cvt_pk_bf16_f32 v67, v98, v99
    s_waitcnt vmcnt(5)
    ds_read_b64 a[216:217], v22 offset:0
    ds_read_b64 a[218:219], v142 offset:128
    ds_read_b64 a[220:221], v23 offset:0
    ds_read_b64 a[222:223], v143 offset:128
    ds_read_b64 a[224:225], v142 offset:0
    ds_read_b64 a[226:227], v22 offset:256
    ds_read_b64 a[228:229], v143 offset:0
    ds_read_b64 a[230:231], v23 offset:256
    ds_read_b64 a[232:233], v22 offset:128
    ds_read_b64 a[234:235], v142 offset:256
    ds_read_b64 a[236:237], v23 offset:128
    ds_read_b64 a[238:239], v143 offset:256
    s_mov_b32 s41, 12288
    s_add_u32 m0, s40, 52224
    s_nop 0
    buffer_load_dwordx4 v139, s[8:11], s41 offen nt lds
    s_add_u32 m0, s40, 53248
    s_nop 0
    buffer_load_dwordx4 v140, s[8:11], s41 offen nt lds
    s_add_u32 m0, s40, 54272
    s_nop 0
    buffer_load_dwordx4 v141, s[8:11], s41 offen nt lds
    s_waitcnt lgkmcnt(0)
    v_mfma_f32_16x16x32_bf16 v[68:71], v[144:147], a[216:219], 0
    v_mfma_f32_16x16x32_bf16 v[68:71], v[148:151], a[220:223], v[68:71]
    v_mfma_f32_16x16x32_bf16 v[68:71], v[160:163], a[224:227], v[68:71]
    v_mfma_f32_16x16x32_bf16 v[68:71], v[164:167], a[228:231], v[68:71]
    v_mfma_f32_16x16x32_bf16 v[68:71], v[176:179], a[232:235], v[68:71]
    v_mfma_f32_16x16x32_bf16 v[68:71], v[180:183], a[236:239], v[68:71]
    v_mfma_f32_16x16x32_bf16 v[100:103], v[152:155], a[216:219], 0
    v_mfma_f32_16x16x32_bf16 v[100:103], v[156:159], a[220:223], v[100:103]
    v_mfma_f32_16x16x32_bf16 v[100:103], v[168:171], a[224:227], v[100:103]
    v_mfma_f32_16x16x32_bf16 v[100:103], v[172:175], a[228:231], v[100:103]
    v_mfma_f32_16x16x32_bf16 v[100:103], v[184:187], a[232:235], v[100:103]
    v_mfma_f32_16x16x32_bf16 v[100:103], v[188:191], a[236:239], v[100:103]
    s_nop 7
    ds_read_b128 v[24:27], v1 offset:0
    ds_read_b128 v[28:31], v1 offset:1024
    ds_read_b128 v[32:35], v1 offset:2048
    ds_read_b128 v[36:39], v1 offset:3072
    s_mov_b32 s41, 18432
    s_add_u32 m0, s40, 24576
    s_nop 0
    buffer_load_dwordx4 v136, s[8:11], s41 offen nt lds
    v_max3_f32 v48, v68, v69, v70
    v_max3_f32 v50, v71, v100, v101
    v_max3_f32 v48, v48, v102, v103
    v_max_f32 v48, v48, v50
    v_mov_b32 v49, v48
    s_nop 1
    v_permlane16_swap_b32 v48, v49
    s_nop 1
    v_max_f32 v48, v48, v49
    v_mov_b32 v49, v48
    s_nop 1
    v_permlane32_swap_b32 v48, v49
    s_nop 1
    v_max_f32 v48, v48, v49
    v_sub_f32 v68, v68, v48
    v_sub_f32 v69, v69, v48
    s_add_u32 m0, s40, 25600
    s_nop 0
    buffer_load_dwordx4 v137, s[8:11], s41 offen nt lds
    v_sub_f32 v70, v70, v48
    v_sub_f32 v71, v71, v48
    v_sub_f32 v100, v100, v48
    v_sub_f32 v101, v101, v48
    v_sub_f32 v102, v102, v48
    v_sub_f32 v103, v103, v48
    v_exp_f32 v68, v68
    v_exp_f32 v69, v69
    v_exp_f32 v70, v70
    v_exp_f32 v71, v71
    v_exp_f32 v100, v100
    v_exp_f32 v101, v101
    v_exp_f32 v102, v102
    v_exp_f32 v103, v103
    v_sub_f32 v132, 0, v48
    s_add_u32 m0, s40, 26624
    s_nop 0
    buffer_load_dwordx4 v138, s[8:11], s41 offen nt lds
    v_sub_f32 v133, 0, v48
    v_sub_f32 v134, 0, v48
    v_sub_f32 v135, 0, v48
    v_add_f32 v6, v6, v68
    v_add_f32 v6, v6, v69
    v_add_f32 v6, v6, v70
    v_add_f32 v6, v6, v71
    v_add_f32 v6, v6, v100
    v_add_f32 v6, v6, v101
    v_add_f32 v6, v6, v102
    v_add_f32 v6, v6, v103
    v_cvt_pk_bf16_f32 v68, v68, v69
    v_cvt_pk_bf16_f32 v69, v70, v71
    v_cvt_pk_bf16_f32 v70, v100, v101
    v_cvt_pk_bf16_f32 v71, v102, v103
    s_buffer_load_dwordx8 s[48:55], s[20:23], s44 glc
    s_waitcnt lgkmcnt(2)
    v_mfma_f32_16x16x32_bf16 a[0:3], v[64:67], v[24:27], 0
    ds_read_b128 v[40:43], v1 offset:4096
    v_mfma_f32_16x16x32_bf16 a[4:7], v[64:67], v[28:31], 0
    v_mfma_f32_16x16x32_bf16 a[48:51], v[68:71], v[24:27], 0
    ds_read_b128 v[44:47], v1 offset:5120
    v_mfma_f32_16x16x32_bf16 a[52:55], v[68:71], v[28:31], 0
    s_waitcnt lgkmcnt(2)
    v_mfma_f32_16x16x32_bf16 a[8:11], v[64:67], v[32:35], 0
    ds_read_b128 v[24:27], v1 offset:6144
    v_mfma_f32_16x16x32_bf16 a[12:15], v[64:67], v[36:39], 0
    v_mfma_f32_16x16x32_bf16 a[56:59], v[68:71], v[32:35], 0
    ds_read_b128 v[28:31], v1 offset:7168
    v_mfma_f32_16x16x32_bf16 a[60:63], v[68:71], v[36:39], 0
    s_waitcnt lgkmcnt(2)
    v_mfma_f32_16x16x32_bf16 a[16:19], v[64:67], v[40:43], 0
    ds_read_b128 v[32:35], v1 offset:8192
    v_mfma_f32_16x16x32_bf16 a[20:23], v[64:67], v[44:47], 0
    v_mfma_f32_16x16x32_bf16 a[64:67], v[68:71], v[40:43], 0
    ds_read_b128 v[36:39], v1 offset:9216
    v_mfma_f32_16x16x32_bf16 a[68:71], v[68:71], v[44:47], 0
    s_waitcnt lgkmcnt(2)
    v_mfma_f32_16x16x32_bf16 a[24:27], v[64:67], v[24:27], 0
    ds_read_b128 v[40:43], v1 offset:10240
    v_mfma_f32_16x16x32_bf16 a[28:31], v[64:67], v[28:31], 0
    v_mfma_f32_16x16x32_bf16 a[72:75], v[68:71], v[24:27], 0
    ds_read_b128 v[44:47], v1 offset:11264
    v_mfma_f32_16x16x32_bf16 a[76:79], v[68:71], v[28:31], 0
    s_waitcnt lgkmcnt(2)
    v_mfma_f32_16x16x32_bf16 a[32:35], v[64:67], v[32:35], 0
    v_mfma_f32_16x16x32_bf16 a[36:39], v[64:67], v[36:39], 0
    v_mfma_f32_16x16x32_bf16 a[80:83], v[68:71], v[32:35], 0
    v_mfma_f32_16x16x32_bf16 a[84:87], v[68:71], v[36:39], 0
    s_waitcnt lgkmcnt(0)
    v_mfma_f32_16x16x32_bf16 a[40:43], v[64:67], v[40:43], 0
    v_mfma_f32_16x16x32_bf16 a[44:47], v[64:67], v[44:47], 0
    v_mfma_f32_16x16x32_bf16 a[88:91], v[68:71], v[40:43], 0
    v_mfma_f32_16x16x32_bf16 a[92:95], v[68:71], v[44:47], 0
    s_waitcnt lgkmcnt(0)
    s_sub_u32 s48, s48, s92
    s_sub_u32 s49, s49, s92
    s_sub_u32 s50, s50, s92
    s_sub_u32 s51, s51, s92
    s_sub_u32 s52, s52, s92
    s_sub_u32 s53, s53, s92
    s_sub_u32 s54, s54, s92
    s_sub_u32 s55, s55, s92
    s_max_u32 s48, s48, s49
    s_max_u32 s48, s48, s50
    s_max_u32 s48, s48, s51
    s_max_u32 s48, s48, s52
    s_max_u32 s48, s48, s53
    s_max_u32 s48, s48, s54
    s_max_u32 s48, s48, s55
    s_cmp_ge_u32 s48, 16
    s_cbranch_scc1 L_pollslow0
L_pollok0:
    s_add_u32 s92, s92, 1
    s_mov_b32 s44, 32
    s_mov_b32 m0, s26
    s_nop 0
    buffer_load_dwordx4 v4, s[4:7], s32 offen offset:0 sc1 lds
    buffer_load_dwordx4 v4, s[4:7], s32 offen offset:1024 sc1 lds
    buffer_load_dwordx4 v4, s[4:7], s32 offen offset:2048 sc1 lds
    s_add_u32 s32, s32, 24576
    s_sub_u32 s57, s32, 196608
    s_min_u32 s32, s32, s57
    s_add_u32 s26, s26, 36864
    s_sub_u32 s57, s26, 147456
    s_min_u32 s26, s26, s57
    s_mov_b32 m0, s26
    s_waitcnt vmcnt(11)
    buffer_load_dwordx4 v4, s[4:7], s32 offen offset:0 sc1 lds
    s_waitcnt vmcnt(11)
    buffer_load_dwordx4 v4, s[4:7], s32 offen offset:1024 sc1 lds
    s_waitcnt vmcnt(11)
    buffer_load_dwordx4 v4, s[4:7], s32 offen offset:2048 sc1 lds
    s_add_u32 s32, s32, 24576
    s_sub_u32 s57, s32, 196608
    s_min_u32 s32, s32, s57
    s_add_u32 s26, s26, 12288
    s_mov_b32 m0, s26
    s_waitcnt vmcnt(11)
    buffer_load_dwordx4 v4, s[4:7], s32 offen offset:0 sc1 lds
    s_waitcnt vmcnt(11)
    buffer_load_dwordx4 v4, s[4:7], s32 offen offset:1024 sc1 lds
    s_waitcnt vmcnt(11)
    buffer_load_dwordx4 v4, s[4:7], s32 offen offset:2048 sc1 lds
    s_add_u32 s32, s32, 24576
    s_sub_u32 s57, s32, 196608
    s_min_u32 s32, s32, s57
    s_add_u32 s26, s26, 36864
    s_sub_u32 s57, s26, 147456
    s_min_u32 s26, s26, s57
    s_mov_b32 m0, s56
    s_waitcnt vmcnt(11)
    buffer_load_dwordx4 v4, s[4:7], s27 offen offset:0 sc1 lds
    s_waitcnt vmcnt(11)
    buffer_load_dwordx4 v4, s[4:7], s27 offen offset:1024 sc1 lds
    s_waitcnt vmcnt(11)
    buffer_load_dwordx4 v4, s[4:7], s27 offen offset:2048 sc1 lds
    s_add_u32 s27, s27, 24576
    s_sub_u32 s58, s27, 196608
    s_min_u32 s27, s27, s58
    s_add_u32 s56, s56, 36864
    s_sub_u32 s58, s56, 147456
    s_min_u32 s56, s56, s58
    s_add_u32 s33, s33, 196608
    s_add_u32 s34, s34, 196608
    s_add_u32 s36, s36, 1536
    s_add_u32 s35, s35, 196608
    s_add_u32 s16, s16, 196608
    s_add_u32 s17, s17, 196608
    s_add_u32 s37, s37, 512
    s_waitcnt vmcnt(9)
    s_barrier
    ds_read_b128 v[24:27], v2 offset:12288
    ds_read_b128 v[28:31], v3 offset:12288
    ds_read_b128 v[32:35], v2 offset:18432
    ds_read_b128 v[36:39], v3 offset:18432
    s_waitcnt lgkmcnt(2)
    v_mfma_f32_16x16x32_bf16 v[72:75], v[24:27], a[192:195], v[128:131]
    s_mov_b32 m0, s56
    ds_read_b128 v[40:43], v2 offset:12416
    v_mfma_f32_16x16x32_bf16 v[72:75], v[28:31], a[196:199], v[72:75]
    buffer_load_dwordx4 v4, s[4:7], s27 offen offset:0 sc1 lds
    v_mfma_f32_16x16x32_bf16 v[76:79], v[24:27], a[216:219], v[132:135]
    ds_read_b128 v[44:47], v3 offset:12416
    v_mfma_f32_16x16x32_bf16 v[76:79], v[28:31], a[220:223], v[76:79]
    s_waitcnt lgkmcnt(2)
    buffer_load_dwordx4 v4, s[4:7], s27 offen offset:1024 sc1 lds
    v_mfma_f32_16x16x32_bf16 v[104:107], v[32:35], a[192:195], v[128:131]
    ds_read_b128 v[24:27], v2 offset:18560
    v_mfma_f32_16x16x32_bf16 v[104:107], v[36:39], a[196:199], v[104:107]
    buffer_load_dwordx4 v4, s[4:7], s27 offen offset:2048 sc1 lds
    v_mfma_f32_16x16x32_bf16 v[108:111], v[32:35], a[216:219], v[132:135]
    s_add_u32 s27, s27, 24576
    ds_read_b128 v[28:31], v3 offset:18560
    v_mfma_f32_16x16x32_bf16 v[108:111], v[36:39], a[220:223], v[108:111]
    s_waitcnt lgkmcnt(2)
    s_sub_u32 s58, s27, 196608
    v_mfma_f32_16x16x32_bf16 v[72:75], v[40:43], a[200:203], v[72:75]
    ds_read_b128 v[32:35], v2 offset:12544
    v_mfma_f32_16x16x32_bf16 v[72:75], v[44:47], a[204:207], v[72:75]
    s_min_u32 s27, s27, s58
    v_mfma_f32_16x16x32_bf16 v[76:79], v[40:43], a[224:227], v[76:79]
    s_add_u32 s56, s56, 12288
    ds_read_b128 v[36:39], v3 offset:12544
    v_mfma_f32_16x16x32_bf16 v[76:79], v[44:47], a[228:231], v[76:79]
    s_waitcnt lgkmcnt(2)
    s_mov_b32 m0, s56
    v_mfma_f32_16x16x32_bf16 v[104:107], v[24:27], a[200:203], v[104:107]
    ds_read_b128 v[40:43], v2 offset:18688
    v_mfma_f32_16x16x32_bf16 v[104:107], v[28:31], a[204:207], v[104:107]
    s_waitcnt vmcnt(6)
    buffer_load_dwordx4 v4, s[4:7], s27 offen offset:0 sc1 lds
    v_mfma_f32_16x16x32_bf16 v[108:111], v[24:27], a[224:227], v[108:111]
    ds_read_b128 v[44:47], v3 offset:18688
    v_mfma_f32_16x16x32_bf16 v[108:111], v[28:31], a[228:231], v[108:111]
    s_waitcnt lgkmcnt(2)
    s_barrier
    v_add_u32 v2, 49152, v2
    v_add_u32 v3, 49152, v3
    v_mfma_f32_16x16x32_bf16 v[72:75], v[32:35], a[208:211], v[72:75]
    ds_read_b128 v[24:27], v2 offset:0
    v_mfma_f32_16x16x32_bf16 v[72:75], v[36:39], a[212:215], v[72:75]
    buffer_load_dwordx4 v4, s[4:7], s27 offen offset:1024 sc1 lds
    v_mfma_f32_16x16x32_bf16 v[76:79], v[32:35], a[232:235], v[76:79]
    ds_read_b128 v[28:31], v3 offset:0
    v_mfma_f32_16x16x32_bf16 v[76:79], v[36:39], a[236:239], v[76:79]
    s_waitcnt lgkmcnt(2)
    buffer_load_dwordx4 v4, s[4:7], s27 offen offset:2048 sc1 lds
    v_mfma_f32_16x16x32_bf16 v[104:107], v[40:43], a[208:211], v[104:107]
    ds_read_b128 v[32:35], v2 offset:6144
    v_mfma_f32_16x16x32_bf16 v[104:107], v[44:47], a[212:215], v[104:107]
    v_mfma_f32_16x16x32_bf16 v[108:111], v[40:43], a[232:235], v[108:111]
    s_add_u32 s27, s27, 24576
    ds_read_b128 v[36:39], v3 offset:6144
    s_sub_u32 s58, s27, 196608
    v_mfma_f32_16x16x32_bf16 v[108:111], v[44:47], a[236:239], v[108:111]
    s_waitcnt lgkmcnt(2)
    s_min_u32 s27, s27, s58
    s_add_u32 s56, s56, 36864
    s_sub_u32 s58, s56, 147456
    s_min_u32 s56, s56, s58
    v_mfma_f32_16x16x32_bf16 v[80:83], v[24:27], a[192:195], v[128:131]
    s_mov_b32 s41, 18432
    ds_read_b128 v[40:43], v2 offset:128
    s_add_u32 m0, s40, 27648
    v_mfma_f32_16x16x32_bf16 v[80:83], v[28:31], a[196:199], v[80:83]
    buffer_load_dwordx4 v139, s[8:11], s41 offen nt lds
    v_mfma_f32_16x16x32_bf16 v[84:87], v[24:27], a[216:219], v[132:135]
    s_add_u32 m0, s40, 28672
    ds_read_b128 v[44:47], v3 offset:128
    v_mfma_f32_16x16x32_bf16 v[84:87], v[28:31], a[220:223], v[84:87]
    s_waitcnt lgkmcnt(2)
    buffer_load_dwordx4 v140, s[8:11], s41 offen nt lds
    s_add_u32 m0, s40, 29696
    v_mfma_f32_16x16x32_bf16 v[112:115], v[32:35], a[192:195], v[128:131]
    ds_read_b128 v[24:27], v2 offset:6272
    v_mfma_f32_16x16x32_bf16 v[112:115], v[36:39], a[196:199], v[112:115]
    buffer_load_dwordx4 v141, s[8:11], s41 offen nt lds
    v_mfma_f32_16x16x32_bf16 v[116:119], v[32:35], a[216:219], v[132:135]
    ds_read_b128 v[28:31], v3 offset:6272
    v_mfma_f32_16x16x32_bf16 v[116:119], v[36:39], a[220:223], v[116:119]
    s_waitcnt lgkmcnt(2)
    v_exp_f32 v16, v72
    v_mfma_f32_16x16x32_bf16 v[80:83], v[40:43], a[200:203], v[80:83]
    ds_read_b128 v[32:35], v2 offset:256
    v_mfma_f32_16x16x32_bf16 v[80:83], v[44:47], a[204:207], v[80:83]
    v_exp_f32 v17, v73
    v_exp_f32 v18, v74
    v_mfma_f32_16x16x32_bf16 v[84:87], v[40:43], a[224:227], v[84:87]
    ds_read_b128 v[36:39], v3 offset:256
    v_add_f32 v5, v5, v16
    v_mfma_f32_16x16x32_bf16 v[84:87], v[44:47], a[228:231], v[84:87]
    s_waitcnt lgkmcnt(2)
    v_add_f32 v5, v5, v17
    v_exp_f32 v19, v75
    v_mfma_f32_16x16x32_bf16 v[112:115], v[24:27], a[200:203], v[112:115]
    ds_read_b128 v[40:43], v2 offset:6400
    v_cvt_pk_bf16_f32 v72, v16, v17
    v_mfma_f32_16x16x32_bf16 v[112:115], v[28:31], a[204:207], v[112:115]
    v_exp_f32 v16, v104
    v_mfma_f32_16x16x32_bf16 v[116:119], v[24:27], a[224:227], v[116:119]
    ds_read_b128 v[44:47], v3 offset:6400
    v_add_f32 v5, v5, v18
    v_mfma_f32_16x16x32_bf16 v[116:119], v[28:31], a[228:231], v[116:119]
    s_waitcnt lgkmcnt(2)
    v_add_f32 v5, v5, v19
    v_exp_f32 v17, v105
    v_mfma_f32_16x16x32_bf16 v[80:83], v[32:35], a[208:211], v[80:83]
    ds_read_b128 v[24:27], v2 offset:12288
    v_cvt_pk_bf16_f32 v73, v18, v19
    v_mfma_f32_16x16x32_bf16 v[80:83], v[36:39], a[212:215], v[80:83]
    v_exp_f32 v18, v106
    v_mfma_f32_16x16x32_bf16 v[84:87], v[32:35], a[232:235], v[84:87]
    ds_read_b128 v[28:31], v3 offset:12288
    v_add_f32 v5, v5, v16
    v_mfma_f32_16x16x32_bf16 v[84:87], v[36:39], a[236:239], v[84:87]
    s_waitcnt lgkmcnt(2)
    v_add_f32 v5, v5, v17
    v_exp_f32 v19, v107
    v_mfma_f32_16x16x32_bf16 v[112:115], v[40:43], a[208:211], v[112:115]
    ds_read_b128 v[32:35], v2 offset:18432
    v_cvt_pk_bf16_f32 v74, v16, v17
    v_mfma_f32_16x16x32_bf16 v[112:115], v[44:47], a[212:215], v[112:115]
    v_exp_f32 v16, v76
    v_add_f32 v5, v5, v18
    v_mfma_f32_16x16x32_bf16 v[116:119], v[40:43], a[232:235], v[116:119]
    ds_read_b128 v[36:39], v3 offset:18432
    v_add_f32 v5, v5, v19
    v_mfma_f32_16x16x32_bf16 v[116:119], v[44:47], a[236:239], v[116:119]
    s_waitcnt lgkmcnt(2)
    v_exp_f32 v17, v77
    v_mfma_f32_16x16x32_bf16 v[88:91], v[24:27], a[192:195], v[128:131]
    ds_read_b128 v[40:43], v2 offset:12416
    v_cvt_pk_bf16_f32 v75, v18, v19
    v_mfma_f32_16x16x32_bf16 v[88:91], v[28:31], a[196:199], v[88:91]
    s_waitcnt vmcnt(11)
    buffer_load_dwordx2 v[56:57], v10, s[72:75], s36 offen offset:0
    v_mfma_f32_16x16x32_bf16 v[92:95], v[24:27], a[216:219], v[132:135]
    ds_read_b128 v[44:47], v3 offset:12416
    v_mfma_f32_16x16x32_bf16 v[92:95], v[28:31], a[220:223], v[92:95]
    s_waitcnt lgkmcnt(2)
    buffer_load_dwordx2 v[58:59], v10, s[76:79], s36 offen offset:0
    v_exp_f32 v18, v78
    v_mfma_f32_16x16x32_bf16 v[120:123], v[32:35], a[192:195], v[128:131]
    ds_read_b128 v[24:27], v2 offset:18560
    v_add_f32 v6, v6, v16
    v_mfma_f32_16x16x32_bf16 v[120:123], v[36:39], a[196:199], v[120:123]
    s_waitcnt vmcnt(12)
    buffer_load_dwordx4 v[224:227], v9, s[64:67], s33 offen offset:0 nt
    v_mfma_f32_16x16x32_bf16 v[124:127], v[32:35], a[216:219], v[132:135]
    ds_read_b128 v[28:31], v3 offset:18560
    v_add_f32 v6, v6, v17
    v_mfma_f32_16x16x32_bf16 v[124:127], v[36:39], a[220:223], v[124:127]
    s_waitcnt lgkmcnt(2)
    s_waitcnt vmcnt(12)
    buffer_load_dwordx4 v[228:231], v9, s[64:67], s33 offen offset:1536 nt
    v_mfma_f32_16x16x32_bf16 v[88:91], v[40:43], a[200:203], v[88:91]
    ds_read_b128 v[32:35], v2 offset:12544
    v_mfma_f32_16x16x32_bf16 v[88:91], v[44:47], a[204:207], v[88:91]
    buffer_load_dwordx4 v[232:235], v9, s[64:67], s34 offen offset:0 nt
    v_mfma_f32_16x16x32_bf16 v[92:95], v[40:43], a[224:227], v[92:95]
    ds_read_b128 v[36:39], v3 offset:12544
    v_mfma_f32_16x16x32_bf16 v[92:95], v[44:47], a[228:231], v[92:95]
    s_waitcnt lgkmcnt(2)
    s_waitcnt vmcnt(13)
    buffer_load_dwordx4 v[236:239], v9, s[64:67], s34 offen offset:1536 nt
    v_exp_f32 v19, v79
    v_mfma_f32_16x16x32_bf16 v[120:123], v[24:27], a[200:203], v[120:123]
    ds_read_b128 v[40:43], v2 offset:18688
    v_cvt_pk_bf16_f32 v76, v16, v17
    v_mfma_f32_16x16x32_bf16 v[120:123], v[28:31], a[204:207], v[120:123]
    s_waitcnt vmcnt(9)
    v_exp_f32 v16, v108
    v_add_f32 v6, v6, v18
    v_mfma_f32_16x16x32_bf16 v[124:127], v[24:27], a[224:227], v[124:127]
    ds_read_b128 v[44:47], v3 offset:18688
    v_add_f32 v6, v6, v19
    v_mfma_f32_16x16x32_bf16 v[124:127], v[28:31], a[228:231], v[124:127]
    s_waitcnt lgkmcnt(2)
    s_barrier
    v_mfma_f32_16x16x32_bf16 v[88:91], v[32:35], a[208:211], v[88:91]
    ds_read_b128 v[24:27], v1 offset:12288
    v_mfma_f32_16x16x32_bf16 v[88:91], v[36:39], a[212:215], v[88:91]
    v_exp_f32 v17, v109
    v_cvt_pk_bf16_f32 v77, v18, v19
    v_mfma_f32_16x16x32_bf16 v[92:95], v[32:35], a[232:235], v[92:95]
    ds_read_b128 v[28:31], v1 offset:13312
    v_mfma_f32_16x16x32_bf16 v[92:95], v[36:39], a[236:239], v[92:95]
    s_waitcnt lgkmcnt(2)
    v_exp_f32 v18, v110
    v_add_f32 v6, v6, v16
    v_mfma_f32_16x16x32_bf16 v[120:123], v[40:43], a[208:211], v[120:123]
    ds_read_b128 v[32:35], v1 offset:14336
    v_add_f32 v6, v6, v17
    v_mfma_f32_16x16x32_bf16 v[120:123], v[44:47], a[212:215], v[120:123]
    v_exp_f32 v19, v111
    v_mfma_f32_16x16x32_bf16 v[124:127], v[40:43], a[232:235], v[124:127]
    ds_read_b128 v[36:39], v1 offset:15360
    v_cvt_pk_bf16_f32 v78, v16, v17
    v_mfma_f32_16x16x32_bf16 v[124:127], v[44:47], a[236:239], v[124:127]
    s_waitcnt lgkmcnt(2)
    v_add_f32 v6, v6, v18
    v_add_f32 v6, v6, v19
    v_cvt_pk_bf16_f32 v79, v18, v19
    v_mfma_f32_16x16x32_bf16 a[0:3], v[72:75], v[24:27], a[0:3]
    ds_read_b128 v[40:43], v1 offset:16384
    v_mfma_f32_16x16x32_bf16 a[4:7], v[72:75], v[28:31], a[4:7]
    buffer_load_dwordx2 v[60:61], v10, s[72:75], s36 offen offset:192
    v_exp_f32 v16, v80
    v_mfma_f32_16x16x32_bf16 a[48:51], v[76:79], v[24:27], a[48:51]
    ds_read_b128 v[44:47], v1 offset:17408
    v_mfma_f32_16x16x32_bf16 a[52:55], v[76:79], v[28:31], a[52:55]
    s_waitcnt lgkmcnt(2)
    buffer_load_dwordx2 v[62:63], v10, s[76:79], s36 offen offset:192
    v_exp_f32 v17, v81
    v_exp_f32 v18, v82
    v_mfma_f32_16x16x32_bf16 a[8:11], v[72:75], v[32:35], a[8:11]
    ds_read_b128 v[24:27], v1 offset:18432
    v_add_f32 v5, v5, v16
    v_mfma_f32_16x16x32_bf16 a[12:15], v[72:75], v[36:39], a[12:15]
    buffer_load_dwordx4 v[240:243], v9, s[64:67], s33 offen offset:384 nt
    v_add_f32 v5, v5, v17
    v_exp_f32 v19, v83
    v_mfma_f32_16x16x32_bf16 a[56:59], v[76:79], v[32:35], a[56:59]
    ds_read_b128 v[28:31], v1 offset:19456
    v_cvt_pk_bf16_f32 v80, v16, v17
    v_mfma_f32_16x16x32_bf16 a[60:63], v[76:79], v[36:39], a[60:63]
    s_waitcnt lgkmcnt(2)
    buffer_load_dwordx4 v[244:247], v9, s[64:67], s33 offen offset:1920 nt
    v_exp_f32 v16, v112
    v_add_f32 v5, v5, v18
    v_add_f32 v5, v5, v19
    v_mfma_f32_16x16x32_bf16 a[16:19], v[72:75], v[40:43], a[16:19]
    ds_read_b128 v[32:35], v1 offset:20480
    v_mfma_f32_16x16x32_bf16 a[20:23], v[72:75], v[44:47], a[20:23]
    buffer_load_dwordx4 v[248:251], v9, s[64:67], s34 offen offset:384 nt
    v_exp_f32 v17, v113
    v_cvt_pk_bf16_f32 v81, v18, v19
    v_mfma_f32_16x16x32_bf16 a[64:67], v[76:79], v[40:43], a[64:67]
    ds_read_b128 v[36:39], v1 offset:21504
    v_mfma_f32_16x16x32_bf16 a[68:71], v[76:79], v[44:47], a[68:71]
    s_waitcnt lgkmcnt(2)
    buffer_load_dwordx4 v[252:255], v9, s[64:67], s34 offen offset:1920 nt
    v_exp_f32 v18, v114
    v_add_f32 v5, v5, v16
    v_mfma_f32_16x16x32_bf16 a[24:27], v[72:75], v[24:27], a[24:27]
    ds_read_b128 v[40:43], v1 offset:22528
    v_add_f32 v5, v5, v17
    v_mfma_f32_16x16x32_bf16 a[28:31], v[72:75], v[28:31], a[28:31]
    v_exp_f32 v19, v115
    v_cvt_pk_bf16_f32 v82, v16, v17
    v_exp_f32 v16, v84
    v_mfma_f32_16x16x32_bf16 a[72:75], v[76:79], v[24:27], a[72:75]
    ds_read_b128 v[44:47], v1 offset:23552
    v_add_f32 v5, v5, v18
    v_mfma_f32_16x16x32_bf16 a[76:79], v[76:79], v[28:31], a[76:79]
    s_waitcnt lgkmcnt(2)
    v_add_u32 v1, 49152, v1
    v_add_f32 v5, v5, v19
    v_exp_f32 v17, v85
    v_cvt_pk_bf16_f32 v83, v18, v19
    v_mfma_f32_16x16x32_bf16 a[32:35], v[72:75], v[32:35], a[32:35]
    ds_read_b128 v[24:27], v1 offset:0
    v_mfma_f32_16x16x32_bf16 a[36:39], v[72:75], v[36:39], a[36:39]
    v_exp_f32 v18, v86
    v_add_f32 v6, v6, v16
    v_add_f32 v6, v6, v17
    v_exp_f32 v19, v87
    v_mfma_f32_16x16x32_bf16 a[80:83], v[76:79], v[32:35], a[80:83]
    ds_read_b128 v[28:31], v1 offset:1024
    v_cvt_pk_bf16_f32 v84, v16, v17
    v_mfma_f32_16x16x32_bf16 a[84:87], v[76:79], v[36:39], a[84:87]
    s_waitcnt lgkmcnt(2)
    v_exp_f32 v16, v116
    v_add_f32 v6, v6, v18
    v_add_f32 v6, v6, v19
    v_mfma_f32_16x16x32_bf16 a[40:43], v[72:75], v[40:43], a[40:43]
    ds_read_b128 v[32:35], v1 offset:2048
    v_mfma_f32_16x16x32_bf16 a[44:47], v[72:75], v[44:47], a[44:47]
    v_exp_f32 v17, v117
    v_cvt_pk_bf16_f32 v85, v18, v19
    v_exp_f32 v18, v118
    v_add_f32 v6, v6, v16
    v_mfma_f32_16x16x32_bf16 a[88:91], v[76:79], v[40:43], a[88:91]
    ds_read_b128 v[36:39], v1 offset:3072
    v_add_f32 v6, v6, v17
    v_mfma_f32_16x16x32_bf16 a[92:95], v[76:79], v[44:47], a[92:95]
    s_waitcnt lgkmcnt(2)
    v_exp_f32 v19, v119
    v_cvt_pk_bf16_f32 v86, v16, v17
    v_add_f32 v6, v6, v18
    v_add_f32 v6, v6, v19
    v_cvt_pk_bf16_f32 v87, v18, v19
    v_mfma_f32_16x16x32_bf16 a[0:3], v[80:83], v[24:27], a[0:3]
    ds_read_b128 v[40:43], v1 offset:4096
    v_mfma_f32_16x16x32_bf16 a[4:7], v[80:83], v[28:31], a[4:7]
    buffer_load_dwordx4 v[144:147], v12, s[68:71], s35 offen offset:0 nt
    v_exp_f32 v16, v88
    v_mfma_f32_16x16x32_bf16 a[48:51], v[84:87], v[24:27], a[48:51]
    ds_read_b128 v[44:47], v1 offset:5120
    v_mfma_f32_16x16x32_bf16 a[52:55], v[84:87], v[28:31], a[52:55]
    s_waitcnt lgkmcnt(2)
    buffer_load_dwordx4 v[148:151], v12, s[68:71], s35 offen offset:768 nt
    v_exp_f32 v17, v89
    v_mfma_f32_16x16x32_bf16 a[8:11], v[80:83], v[32:35], a[8:11]
    ds_read_b128 v[24:27], v1 offset:6144
    v_mfma_f32_16x16x32_bf16 a[12:15], v[80:83], v[36:39], a[12:15]
    s_waitcnt vmcnt(16)
    buffer_load_dwordx4 v[152:155], v12, s[68:71], s35 offen offset:1536 nt
    v_exp_f32 v18, v90
    v_mfma_f32_16x16x32_bf16 a[56:59], v[84:87], v[32:35], a[56:59]
    ds_read_b128 v[28:31], v1 offset:7168
    v_add_f32 v5, v5, v16
    v_mfma_f32_16x16x32_bf16 a[60:63], v[84:87], v[36:39], a[60:63]
    s_waitcnt lgkmcnt(2)
    s_waitcnt vmcnt(16)
    buffer_load_dwordx4 v[156:159], v12, s[68:71], s35 offen offset:2304 nt
    v_add_f32 v5, v5, v17
    v_mfma_f32_16x16x32_bf16 a[16:19], v[80:83], v[40:43], a[16:19]
    ds_read_b128 v[32:35], v1 offset:8192
    v_mfma_f32_16x16x32_bf16 a[20:23], v[80:83], v[44:47], a[20:23]
    v_exp_f32 v19, v91
    v_cvt_pk_bf16_f32 v88, v16, v17
    v_exp_f32 v16, v120
    v_mfma_f32_16x16x32_bf16 a[64:67], v[84:87], v[40:43], a[64:67]
    ds_read_b128 v[36:39], v1 offset:9216
    v_add_f32 v5, v5, v18
    v_mfma_f32_16x16x32_bf16 a[68:71], v[84:87], v[44:47], a[68:71]
    s_waitcnt lgkmcnt(2)
    v_add_f32 v5, v5, v19
    v_exp_f32 v17, v121
    v_cvt_pk_bf16_f32 v89, v18, v19
    v_mfma_f32_16x16x32_bf16 a[24:27], v[80:83], v[24:27], a[24:27]
    ds_read_b128 v[40:43], v1 offset:10240
    v_mfma_f32_16x16x32_bf16 a[28:31], v[80:83], v[28:31], a[28:31]
    v_exp_f32 v18, v122
    v_add_f32 v5, v5, v16
    v_add_f32 v5, v5, v17
    v_mfma_f32_16x16x32_bf16 a[72:75], v[84:87], v[24:27], a[72:75]
    ds_read_b128 v[44:47], v1 offset:11264
    v_mfma_f32_16x16x32_bf16 a[76:79], v[84:87], v[28:31], a[76:79]
    s_waitcnt lgkmcnt(2)
    v_exp_f32 v19, v123
    v_cvt_pk_bf16_f32 v90, v16, v17
    v_mfma_f32_16x16x32_bf16 a[32:35], v[80:83], v[32:35], a[32:35]
    s_waitcnt vmcnt(40)
    ds_read_b128 v[24:27], v1 offset:12288
    ds_read_b64 a[240:241], v22 offset:49152
    v_mfma_f32_16x16x32_bf16 a[36:39], v[80:83], v[36:39], a[36:39]
    ds_read_b64 a[242:243], v142 offset:49280
    ds_read_b64 a[244:245], v23 offset:49152
    ds_read_b64 a[246:247], v143 offset:49280
    ds_read_b64 a[248:249], v142 offset:49152
    ds_read_b64 a[250:251], v22 offset:49408
    v_mfma_f32_16x16x32_bf16 a[80:83], v[84:87], v[32:35], a[80:83]
    ds_read_b128 v[28:31], v1 offset:13312
    ds_read_b64 a[252:253], v143 offset:49152
    v_mfma_f32_16x16x32_bf16 a[84:87], v[84:87], v[36:39], a[84:87]
    s_waitcnt lgkmcnt(9)
    ds_read_b64 a[254:255], v23 offset:49408
    ds_read_b64 v[192:193], v22 offset:49280
    ds_read_b64 v[194:195], v142 offset:49408
    ds_read_b64 v[196:197], v23 offset:49280
    v_mfma_f32_16x16x32_bf16 a[40:43], v[80:83], v[40:43], a[40:43]
    ds_read_b128 v[32:35], v1 offset:14336
    ds_read_b64 v[198:199], v143 offset:49408
    v_mfma_f32_16x16x32_bf16 a[44:47], v[80:83], v[44:47], a[44:47]
    v_exp_f32 v16, v92
    v_add_f32 v5, v5, v18
    v_add_f32 v5, v5, v19
    v_exp_f32 v17, v93
    v_cvt_pk_bf16_f32 v91, v18, v19
    v_exp_f32 v18, v94
    v_add_f32 v6, v6, v16
    v_add_f32 v6, v6, v17
    v_exp_f32 v19, v95
    v_cvt_pk_bf16_f32 v92, v16, v17
    v_exp_f32 v16, v124
    v_add_f32 v6, v6, v18
    v_add_f32 v6, v6, v19
    v_exp_f32 v17, v125
    v_cvt_pk_bf16_f32 v93, v18, v19
    v_exp_f32 v18, v126
    v_add_f32 v6, v6, v16
    v_add_f32 v6, v6, v17
    v_exp_f32 v19, v127
    v_cvt_pk_bf16_f32 v94, v16, v17
    v_add_f32 v6, v6, v18
    v_add_f32 v6, v6, v19
    v_cvt_pk_bf16_f32 v95, v18, v19
    v_mfma_f32_16x16x32_bf16 a[88:91], v[84:87], v[40:43], a[88:91]
    s_waitcnt vmcnt(16)
    ds_read_b128 v[36:39], v1 offset:15360
    ds_read_b64 v[200:201], v22 offset:24576
    v_mfma_f32_16x16x32_bf16 a[92:95], v[84:87], v[44:47], a[92:95]
    s_waitcnt lgkmcnt(9)
    ds_read_b64 v[202:203], v142 offset:24704
    ds_read_b64 v[204:205], v23 offset:24576
    v_mfma_f32_16x16x32_bf16 a[0:3], v[88:91], v[24:27], a[0:3]
    ds_read_b128 v[40:43], v1 offset:16384
    ds_read_b64 v[206:207], v143 offset:24704
    v_mfma_f32_16x16x32_bf16 a[4:7], v[88:91], v[28:31], a[4:7]
    ds_read_b64 v[208:209], v142 offset:24576
    ds_read_b64 v[210:211], v22 offset:24832
    v_mfma_f32_16x16x32_bf16 a[48:51], v[92:95], v[24:27], a[48:51]
    ds_read_b128 v[44:47], v1 offset:17408
    ds_read_b64 v[212:213], v143 offset:24576
    v_mfma_f32_16x16x32_bf16 a[52:55], v[92:95], v[28:31], a[52:55]
    s_waitcnt lgkmcnt(9)
    ds_read_b64 v[214:215], v23 offset:24832
    ds_read_b64 v[216:217], v22 offset:24704
    v_mfma_f32_16x16x32_bf16 a[8:11], v[88:91], v[32:35], a[8:11]
    ds_read_b128 v[24:27], v1 offset:18432
    ds_read_b64 v[218:219], v142 offset:24832
    v_mfma_f32_16x16x32_bf16 a[12:15], v[88:91], v[36:39], a[12:15]
    ds_read_b64 v[220:221], v23 offset:24704
    ds_read_b64 v[222:223], v143 offset:24832
    v_mfma_f32_16x16x32_bf16 a[56:59], v[92:95], v[32:35], a[56:59]
    ds_read_b128 v[28:31], v1 offset:19456
    v_mfma_f32_16x16x32_bf16 a[60:63], v[92:95], v[36:39], a[60:63]
    s_waitcnt lgkmcnt(8)
    v_mfma_f32_16x16x32_bf16 a[16:19], v[88:91], v[40:43], a[16:19]
    ds_read_b128 v[32:35], v1 offset:20480
    v_mfma_f32_16x16x32_bf16 a[20:23], v[88:91], v[44:47], a[20:23]
    v_mfma_f32_16x16x32_bf16 a[64:67], v[92:95], v[40:43], a[64:67]
    ds_read_b128 v[36:39], v1 offset:21504
    v_mfma_f32_16x16x32_bf16 a[68:71], v[92:95], v[44:47], a[68:71]
    s_waitcnt lgkmcnt(2)
    v_mfma_f32_16x16x32_bf16 a[24:27], v[88:91], v[24:27], a[24:27]
    ds_read_b128 v[40:43], v1 offset:22528
    v_mfma_f32_16x16x32_bf16 a[28:31], v[88:91], v[28:31], a[28:31]
    v_mfma_f32_16x16x32_bf16 a[72:75], v[92:95], v[24:27], a[72:75]
    ds_read_b128 v[44:47], v1 offset:23552
    v_mfma_f32_16x16x32_bf16 a[76:79], v[92:95], v[28:31], a[76:79]
    s_waitcnt lgkmcnt(2)
    v_subrev_u32 v2, 49152, v2
    v_subrev_u32 v3, 49152, v3
    v_mfma_f32_16x16x32_bf16 a[32:35], v[88:91], v[32:35], a[32:35]
    ds_read_b128 v[24:27], v2 offset:0
    v_mfma_f32_16x16x32_bf16 a[36:39], v[88:91], v[36:39], a[36:39]
    v_mfma_f32_16x16x32_bf16 a[80:83], v[92:95], v[32:35], a[80:83]
    ds_read_b128 v[28:31], v3 offset:0
    v_mfma_f32_16x16x32_bf16 a[84:87], v[92:95], v[36:39], a[84:87]
    s_waitcnt lgkmcnt(2)
    v_mfma_f32_16x16x32_bf16 a[40:43], v[88:91], v[40:43], a[40:43]
    ds_read_b128 v[32:35], v2 offset:6144
    v_mfma_f32_16x16x32_bf16 a[44:47], v[88:91], v[44:47], a[44:47]
    v_mfma_f32_16x16x32_bf16 a[88:91], v[92:95], v[40:43], a[88:91]
    ds_read_b128 v[36:39], v3 offset:6144
    v_mfma_f32_16x16x32_bf16 a[92:95], v[92:95], v[44:47], a[92:95]
    s_waitcnt lgkmcnt(2)
    s_waitcnt lgkmcnt(0)
    s_barrier
    v_mfma_f32_16x16x32_bf16 v[160:163], v[24:27], a[240:243], 0
    s_waitcnt vmcnt(10)
    ds_read_b128 v[40:43], v2 offset:128
    v_lshlrev_b32 v48, 16, v56
    v_mfma_f32_16x16x32_bf16 v[160:163], v[28:31], a[244:247], v[160:163]
    s_mov_b32 m0, s26
    v_and_b32 v49, s97, v56
    v_lshlrev_b32 v50, 16, v58
    v_and_b32 v51, s97, v58
    v_mul_f32 v48, s38, v48
    v_mul_f32 v49, s38, v49
    v_mfma_f32_16x16x32_bf16 v[164:167], v[24:27], v[200:203], 0
    ds_read_b128 v[44:47], v3 offset:128
    v_mul_f32_e64 v50, -v50, v48
    v_mfma_f32_16x16x32_bf16 v[164:167], v[28:31], v[204:207], v[164:167]
    s_waitcnt lgkmcnt(2)
    buffer_load_dwordx4 v4, s[4:7], s32 offen offset:0 sc1 lds
    v_mul_f32_e64 v51, -v51, v49
    v_cvt_f32_i32 v224, v224
    v_cvt_f32_i32 v225, v225
    v_mfma_f32_16x16x32_bf16 v[96:99], v[32:35], a[240:243], 0
    ds_read_b128 v[24:27], v2 offset:6272
    v_fma_f32 v224, v224, v48, v50
    v_mfma_f32_16x16x32_bf16 v[96:99], v[36:39], a[244:247], v[96:99]
    buffer_load_dwordx4 v4, s[4:7], s32 offen offset:1024 sc1 lds
    v_fma_f32 v225, v225, v49, v51
    v_cvt_pk_bf16_f32 v224, v224, v225
    v_cvt_f32_i32 v228, v228
    v_mfma_f32_16x16x32_bf16 v[100:103], v[32:35], v[200:203], 0
    ds_read_b128 v[28:31], v3 offset:6272
    v_cvt_f32_i32 v229, v229
    v_mfma_f32_16x16x32_bf16 v[100:103], v[36:39], v[204:207], v[100:103]
    s_waitcnt lgkmcnt(2)
    buffer_load_dwordx4 v4, s[4:7], s32 offen offset:2048 sc1 lds
    v_fma_f32 v228, v228, v48, v50
    v_fma_f32 v229, v229, v49, v51
    v_cvt_pk_bf16_f32 v228, v228, v229
    v_mfma_f32_16x16x32_bf16 v[160:163], v[40:43], a[248:251], v[160:163]
    s_add_u32 s32, s32, 24576
    ds_read_b128 v[32:35], v2 offset:256
    v_cvt_f32_i32 v232, v232
    v_mfma_f32_16x16x32_bf16 v[160:163], v[44:47], a[252:255], v[160:163]
    s_sub_u32 s57, s32, 196608
    v_cvt_f32_i32 v233, v233
    v_fma_f32 v232, v232, v48, v50
    v_fma_f32 v233, v233, v49, v51
    v_cvt_pk_bf16_f32 v232, v232, v233
    v_cvt_f32_i32 v236, v236
    v_mfma_f32_16x16x32_bf16 v[164:167], v[40:43], v[208:211], v[164:167]
    s_min_u32 s32, s32, s57
    ds_read_b128 v[36:39], v3 offset:256
    v_cvt_f32_i32 v237, v237
    v_mfma_f32_16x16x32_bf16 v[164:167], v[44:47], v[212:215], v[164:167]
    s_waitcnt lgkmcnt(2)
    v_fma_f32 v236, v236, v48, v50
    v_fma_f32 v237, v237, v49, v51
    v_cvt_pk_bf16_f32 v236, v236, v237
    v_lshlrev_b32 v48, 16, v57
    v_and_b32 v49, s97, v57
    v_mfma_f32_16x16x32_bf16 v[96:99], v[24:27], a[248:251], v[96:99]
    s_add_u32 s26, s26, 12288
    ds_read_b128 v[40:43], v2 offset:6400
    v_lshlrev_b32 v50, 16, v59
    v_mfma_f32_16x16x32_bf16 v[96:99], v[28:31], a[252:255], v[96:99]
    s_mov_b32 m0, s26
    v_and_b32 v51, s97, v59
    v_mul_f32 v48, s38, v48
    v_mul_f32 v49, s38, v49
    v_mul_f32_e64 v50, -v50, v48
    v_mul_f32_e64 v51, -v51, v49
    v_mfma_f32_16x16x32_bf16 v[100:103], v[24:27], v[208:211], v[100:103]
    ds_read_b128 v[44:47], v3 offset:6400
    v_cvt_f32_i32 v226, v226
    v_mfma_f32_16x16x32_bf16 v[100:103], v[28:31], v[212:215], v[100:103]
    s_waitcnt lgkmcnt(2)
    buffer_load_dwordx4 v4, s[4:7], s32 offen offset:0 sc1 lds
    v_cvt_f32_i32 v227, v227
    v_fma_f32 v226, v226, v48, v50
    v_fma_f32 v227, v227, v49, v51
    v_mfma_f32_16x16x32_bf16 v[160:163], v[32:35], v[192:195], v[160:163]
    ds_read_b128 v[24:27], v2 offset:12288
    v_cvt_pk_bf16_f32 v225, v226, v227
    v_mfma_f32_16x16x32_bf16 v[160:163], v[36:39], v[196:199], v[160:163]
    buffer_load_dwordx4 v4, s[4:7], s32 offen offset:1024 sc1 lds
    v_cvt_f32_i32 v230, v230
    v_cvt_f32_i32 v231, v231
    v_fma_f32 v230, v230, v48, v50
    v_mfma_f32_16x16x32_bf16 v[164:167], v[32:35], v[216:219], v[164:167]
    ds_read_b128 v[28:31], v3 offset:12288
    v_fma_f32 v231, v231, v49, v51
    v_mfma_f32_16x16x32_bf16 v[164:167], v[36:39], v[220:223], v[164:167]
    s_waitcnt lgkmcnt(2)
    s_waitcnt vmcnt(13)
    buffer_load_dwordx4 v4, s[4:7], s32 offen offset:2048 sc1 lds
    v_cvt_pk_bf16_f32 v229, v230, v231
    v_cvt_f32_i32 v234, v234
    v_cvt_f32_i32 v235, v235
    v_mfma_f32_16x16x32_bf16 v[96:99], v[40:43], v[192:195], v[96:99]
    ds_read_b128 v[32:35], v2 offset:18432
    v_fma_f32 v234, v234, v48, v50
    v_mfma_f32_16x16x32_bf16 v[96:99], v[44:47], v[196:199], v[96:99]
    v_fma_f32 v235, v235, v49, v51
    v_cvt_pk_bf16_f32 v233, v234, v235
    v_cvt_f32_i32 v238, v238
    v_cvt_f32_i32 v239, v239
    v_fma_f32 v238, v238, v48, v50
    v_mfma_f32_16x16x32_bf16 v[100:103], v[40:43], v[216:219], v[100:103]
    ds_read_b128 v[36:39], v3 offset:18432
    v_fma_f32 v239, v239, v49, v51
    v_mfma_f32_16x16x32_bf16 v[100:103], v[44:47], v[220:223], v[100:103]
    s_waitcnt lgkmcnt(2)
    v_cvt_pk_bf16_f32 v237, v238, v239
    v_mfma_f32_16x16x32_bf16 v[168:171], v[24:27], a[240:243], 0
    ds_read_b128 v[40:43], v2 offset:12416
    v_mfma_f32_16x16x32_bf16 v[168:171], v[28:31], a[244:247], v[168:171]
    s_add_u32 s32, s32, 24576
    s_sub_u32 s57, s32, 196608
    s_min_u32 s32, s32, s57
    s_add_u32 s26, s26, 36864
    s_sub_u32 s57, s26, 147456
    s_min_u32 s26, s26, s57
    v_mfma_f32_16x16x32_bf16 v[172:175], v[24:27], v[200:203], 0
    ds_read_b128 v[44:47], v3 offset:12416
    v_mfma_f32_16x16x32_bf16 v[172:175], v[28:31], v[204:207], v[172:175]
    s_waitcnt lgkmcnt(2)
    v_max3_f32 v16, v160, v161, v162
    v_max3_f32 v18, v164, v165, v166
    v_max3_f32 v16, v16, v163, v96
    v_max3_f32 v18, v18, v167, v100
    v_max3_f32 v16, v16, v97, v98
    v_max3_f32 v18, v18, v101, v102
    v_max_f32 v16, v16, v99
    v_max_f32 v18, v18, v103
    v_mov_b32 v17, v16
    v_mfma_f32_16x16x32_bf16 v[104:107], v[32:35], a[240:243], 0
    ds_read_b128 v[24:27], v2 offset:18560
    v_mov_b32 v19, v18
    v_mfma_f32_16x16x32_bf16 v[104:107], v[36:39], a[244:247], v[104:107]
    s_nop 0
    v_permlane16_swap_b32 v16, v17
    v_permlane16_swap_b32 v18, v19
    s_nop 0
    v_max_f32 v16, v16, v17
    v_max_f32 v18, v18, v19
    v_mov_b32 v17, v16
    v_mov_b32 v19, v18
    v_mfma_f32_16x16x32_bf16 v[108:111], v[32:35], v[200:203], 0
    s_nop 0
    ds_read_b128 v[28:31], v3 offset:18560
    v_permlane32_swap_b32 v16, v17
    v_mfma_f32_16x16x32_bf16 v[108:111], v[36:39], v[204:207], v[108:111]
    s_waitcnt lgkmcnt(2)
    v_permlane32_swap_b32 v18, v19
    s_nop 0
    v_max_f32 v16, v16, v17
    v_max_f32 v18, v18, v19
    v_sub_f32 v136, 0, v16
    v_sub_f32 v137, 0, v16
    v_mfma_f32_16x16x32_bf16 v[168:171], v[40:43], a[248:251], v[168:171]
    ds_read_b128 v[32:35], v2 offset:12544
    v_sub_f32 v138, 0, v16
    v_mfma_f32_16x16x32_bf16 v[168:171], v[44:47], a[252:255], v[168:171]
    v_sub_f32 v139, 0, v16
    v_sub_f32 v140, 0, v18
    v_sub_f32 v141, 0, v18
    v_sub_f32 v142, 0, v18
    v_sub_f32 v143, 0, v18
    v_mfma_f32_16x16x32_bf16 v[172:175], v[40:43], v[208:211], v[172:175]
    ds_read_b128 v[36:39], v3 offset:12544
    v_mfma_f32_16x16x32_bf16 v[172:175], v[44:47], v[212:215], v[172:175]
    s_waitcnt lgkmcnt(2)
    s_waitcnt vmcnt(10)
    v_lshlrev_b32 v48, 16, v60
    v_and_b32 v49, s97, v60
    v_lshlrev_b32 v50, 16, v62
    v_and_b32 v51, s97, v62
    v_mul_f32 v48, s38, v48
    v_mul_f32 v49, s38, v49
    v_mul_f32_e64 v50, -v50, v48
    v_mfma_f32_16x16x32_bf16 v[104:107], v[24:27], a[248:251], v[104:107]
    ds_read_b128 v[40:43], v2 offset:18688
    v_mul_f32_e64 v51, -v51, v49
    v_mfma_f32_16x16x32_bf16 v[104:107], v[28:31], a[252:255], v[104:107]
    buffer_load_dwordx2 v[56:57], off, s[80:83], s37 offset:0
    v_cvt_f32_i32 v240, v240
    v_cvt_f32_i32 v241, v241
    v_fma_f32 v240, v240, v48, v50
    v_fma_f32 v241, v241, v49, v51
    v_cvt_pk_bf16_f32 v226, v240, v241
    v_mfma_f32_16x16x32_bf16 v[108:111], v[24:27], v[208:211], v[108:111]
    ds_read_b128 v[44:47], v3 offset:18688
    v_cvt_f32_i32 v244, v244
    v_mfma_f32_16x16x32_bf16 v[108:111], v[28:31], v[212:215], v[108:111]
    s_waitcnt lgkmcnt(2)
    buffer_load_dwordx2 v[58:59], off, s[84:87], s37 offset:0
    v_add_u32 v2, 49152, v2
    v_add_u32 v3, 49152, v3
    v_cvt_f32_i32 v245, v245
    v_fma_f32 v244, v244, v48, v50
    v_mfma_f32_16x16x32_bf16 v[168:171], v[32:35], v[192:195], v[168:171]
    ds_read_b128 v[24:27], v2 offset:0
    v_fma_f32 v245, v245, v49, v51
    v_mfma_f32_16x16x32_bf16 v[168:171], v[36:39], v[196:199], v[168:171]
    v_cvt_pk_bf16_f32 v230, v244, v245
    v_cvt_f32_i32 v248, v248
    v_cvt_f32_i32 v249, v249
    v_fma_f32 v248, v248, v48, v50
    v_fma_f32 v249, v249, v49, v51
    v_cvt_pk_bf16_f32 v234, v248, v249
    v_cvt_f32_i32 v252, v252
    v_mfma_f32_16x16x32_bf16 v[172:175], v[32:35], v[216:219], v[172:175]
    ds_read_b128 v[28:31], v3 offset:0
    v_cvt_f32_i32 v253, v253
    v_mfma_f32_16x16x32_bf16 v[172:175], v[36:39], v[220:223], v[172:175]
    s_waitcnt lgkmcnt(2)
    v_fma_f32 v252, v252, v48, v50
    v_fma_f32 v253, v253, v49, v51
    v_cvt_pk_bf16_f32 v238, v252, v253
    v_lshlrev_b32 v48, 16, v61
    v_and_b32 v49, s97, v61
    v_lshlrev_b32 v50, 16, v63
    v_and_b32 v51, s97, v63
    v_mfma_f32_16x16x32_bf16 v[104:107], v[40:43], v[192:195], v[104:107]
    ds_read_b128 v[32:35], v2 offset:6144
    v_mul_f32 v48, s38, v48
    v_mfma_f32_16x16x32_bf16 v[104:107], v[44:47], v[196:199], v[104:107]
    v_mul_f32 v49, s38, v49
    v_mul_f32_e64 v50, -v50, v48
    v_mul_f32_e64 v51, -v51, v49
    v_cvt_f32_i32 v242, v242
    v_cvt_f32_i32 v243, v243
    v_fma_f32 v242, v242, v48, v50
    v_mfma_f32_16x16x32_bf16 v[108:111], v[40:43], v[216:219], v[108:111]
    ds_read_b128 v[36:39], v3 offset:6144
    v_add_f32 v160, v160, v136
    v_mfma_f32_16x16x32_bf16 v[108:111], v[44:47], v[220:223], v[108:111]
    s_waitcnt lgkmcnt(2)
    v_add_f32 v161, v161, v136
    v_add_f32 v162, v162, v136
    v_add_f32 v163, v163, v136
    v_add_f32 v96, v96, v136
    v_add_f32 v97, v97, v136
    v_add_f32 v98, v98, v136
    v_add_f32 v99, v99, v136
    v_mfma_f32_16x16x32_bf16 v[176:179], v[24:27], a[240:243], v[136:139]
    ds_read_b128 v[40:43], v2 offset:128
    v_add_f32 v164, v164, v140
    v_mfma_f32_16x16x32_bf16 v[176:179], v[28:31], a[244:247], v[176:179]
    v_add_f32 v165, v165, v140
    v_add_f32 v166, v166, v140
    v_add_f32 v167, v167, v140
    v_add_f32 v100, v100, v140
    v_add_f32 v101, v101, v140
    v_add_f32 v102, v102, v140
    v_mfma_f32_16x16x32_bf16 v[180:183], v[24:27], v[200:203], v[140:143]
    ds_read_b128 v[44:47], v3 offset:128
    v_add_f32 v103, v103, v140
    v_mfma_f32_16x16x32_bf16 v[180:183], v[28:31], v[204:207], v[180:183]
    s_waitcnt lgkmcnt(2)
    v_exp_f32 v16, v160
    v_exp_f32 v17, v161
    v_exp_f32 v18, v162
    v_add_f32 v7, v7, v16
    v_mfma_f32_16x16x32_bf16 v[112:115], v[32:35], a[240:243], v[136:139]
    ds_read_b128 v[24:27], v2 offset:6272
    v_add_f32 v7, v7, v17
    v_mfma_f32_16x16x32_bf16 v[112:115], v[36:39], a[244:247], v[112:115]
    v_exp_f32 v19, v163
    v_cvt_pk_bf16_f32 v160, v16, v17
    v_exp_f32 v16, v96
    v_add_f32 v7, v7, v18
    v_add_f32 v7, v7, v19
    v_mfma_f32_16x16x32_bf16 v[116:119], v[32:35], v[200:203], v[140:143]
    ds_read_b128 v[28:31], v3 offset:6272
    v_fma_f32 v243, v243, v49, v51
    v_mfma_f32_16x16x32_bf16 v[116:119], v[36:39], v[204:207], v[116:119]
    s_waitcnt lgkmcnt(2)
    v_exp_f32 v17, v97
    v_cvt_pk_bf16_f32 v161, v18, v19
    v_exp_f32 v18, v98
    v_add_f32 v7, v7, v16
    v_mfma_f32_16x16x32_bf16 v[176:179], v[40:43], a[248:251], v[176:179]
    ds_read_b128 v[32:35], v2 offset:256
    v_add_f32 v7, v7, v17
    v_mfma_f32_16x16x32_bf16 v[176:179], v[44:47], a[252:255], v[176:179]
    v_exp_f32 v19, v99
    v_cvt_pk_bf16_f32 v162, v16, v17
    v_exp_f32 v16, v164
    v_add_f32 v7, v7, v18
    v_add_f32 v7, v7, v19
    v_mfma_f32_16x16x32_bf16 v[180:183], v[40:43], v[208:211], v[180:183]
    ds_read_b128 v[36:39], v3 offset:256
    v_cvt_pk_bf16_f32 v227, v242, v243
    v_mfma_f32_16x16x32_bf16 v[180:183], v[44:47], v[212:215], v[180:183]
    s_waitcnt lgkmcnt(2)
    v_exp_f32 v17, v165
    v_cvt_pk_bf16_f32 v163, v18, v19
    v_exp_f32 v18, v166
    v_add_f32 v8, v8, v16
    v_mfma_f32_16x16x32_bf16 v[112:115], v[24:27], a[248:251], v[112:115]
    ds_read_b128 v[40:43], v2 offset:6400
    v_add_f32 v8, v8, v17
    v_mfma_f32_16x16x32_bf16 v[112:115], v[28:31], a[252:255], v[112:115]
    v_exp_f32 v19, v167
    v_cvt_pk_bf16_f32 v164, v16, v17
    v_exp_f32 v16, v100
    v_add_f32 v8, v8, v18
    v_add_f32 v8, v8, v19
    v_mfma_f32_16x16x32_bf16 v[116:119], v[24:27], v[208:211], v[116:119]
    ds_read_b128 v[44:47], v3 offset:6400
    v_cvt_f32_i32 v246, v246
    v_mfma_f32_16x16x32_bf16 v[116:119], v[28:31], v[212:215], v[116:119]
    s_waitcnt lgkmcnt(2)
    v_exp_f32 v17, v101
    v_cvt_pk_bf16_f32 v165, v18, v19
    v_exp_f32 v18, v102
    v_add_f32 v8, v8, v16
    v_add_f32 v8, v8, v17
    v_mfma_f32_16x16x32_bf16 v[176:179], v[32:35], v[192:195], v[176:179]
    ds_read_b128 v[24:27], v2 offset:12288
    v_cvt_f32_i32 v247, v247
    v_mfma_f32_16x16x32_bf16 v[176:179], v[36:39], v[196:199], v[176:179]
    v_exp_f32 v19, v103
    v_cvt_pk_bf16_f32 v166, v16, v17
    v_add_f32 v8, v8, v18
    v_add_f32 v8, v8, v19
    v_cvt_pk_bf16_f32 v167, v18, v19
    v_mfma_f32_16x16x32_bf16 v[180:183], v[32:35], v[216:219], v[180:183]
    ds_read_b128 v[28:31], v3 offset:12288
    v_add_f32 v168, v168, v136
    v_mfma_f32_16x16x32_bf16 v[180:183], v[36:39], v[220:223], v[180:183]
    s_waitcnt lgkmcnt(2)
    v_add_f32 v169, v169, v136
    v_add_f32 v170, v170, v136
    v_add_f32 v171, v171, v136
    v_add_f32 v104, v104, v136
    v_add_f32 v105, v105, v136
    v_add_f32 v106, v106, v136
    v_add_f32 v107, v107, v136
    v_mfma_f32_16x16x32_bf16 v[112:115], v[40:43], v[192:195], v[112:115]
    ds_read_b128 v[32:35], v2 offset:18432
    v_fma_f32 v246, v246, v48, v50
    v_mfma_f32_16x16x32_bf16 v[112:115], v[44:47], v[196:199], v[112:115]
    v_fma_f32 v247, v247, v49, v51
    v_cvt_pk_bf16_f32 v231, v246, v247
    v_cvt_f32_i32 v250, v250
    v_add_f32 v172, v172, v140
    v_add_f32 v173, v173, v140
    v_add_f32 v174, v174, v140
    v_add_f32 v175, v175, v140
    v_mfma_f32_16x16x32_bf16 v[116:119], v[40:43], v[216:219], v[116:119]
    ds_read_b128 v[36:39], v3 offset:18432
    v_cvt_f32_i32 v251, v251
    v_mfma_f32_16x16x32_bf16 v[116:119], v[44:47], v[220:223], v[116:119]
    s_waitcnt lgkmcnt(2)
    v_fma_f32 v250, v250, v48, v50
    v_fma_f32 v251, v251, v49, v51
    v_cvt_pk_bf16_f32 v235, v250, v251
    v_cvt_f32_i32 v254, v254
    v_add_f32 v108, v108, v140
    v_add_f32 v109, v109, v140
    v_mfma_f32_16x16x32_bf16 v[184:187], v[24:27], a[240:243], v[136:139]
    ds_read_b128 v[40:43], v2 offset:12416
    v_cvt_f32_i32 v255, v255
    v_fma_f32 v254, v254, v48, v50
    v_fma_f32 v255, v255, v49, v51
    v_cvt_pk_bf16_f32 v239, v254, v255
    v_mfma_f32_16x16x32_bf16 v[184:187], v[28:31], a[244:247], v[184:187]
    buffer_store_dwordx4 v[224:227], v11, s[4:7], s33 offen offset:0 sc1
    v_add_f32 v110, v110, v140
    v_add_f32 v111, v111, v140
    v_xor_b32 v55, 16, v11
    v_mfma_f32_16x16x32_bf16 v[188:191], v[24:27], v[200:203], v[140:143]
    ds_read_b128 v[44:47], v3 offset:12416
    v_mfma_f32_16x16x32_bf16 v[188:191], v[28:31], v[204:207], v[188:191]
    s_waitcnt lgkmcnt(2)
    v_exp_f32 v16, v168
    v_exp_f32 v17, v169
    v_exp_f32 v18, v170
    v_mfma_f32_16x16x32_bf16 v[120:123], v[32:35], a[240:243], v[136:139]
    ds_read_b128 v[24:27], v2 offset:18560
    v_add_f32 v7, v7, v16
    v_mfma_f32_16x16x32_bf16 v[120:123], v[36:39], a[244:247], v[120:123]
    buffer_store_dwordx4 v[228:231], v55, s[4:7], s33 offen offset:768 sc1
    v_add_f32 v7, v7, v17
    v_exp_f32 v19, v171
    v_mfma_f32_16x16x32_bf16 v[124:127], v[32:35], v[200:203], v[140:143]
    ds_read_b128 v[28:31], v3 offset:18560
    v_cvt_pk_bf16_f32 v168, v16, v17
    v_mfma_f32_16x16x32_bf16 v[124:127], v[36:39], v[204:207], v[124:127]
    s_waitcnt lgkmcnt(2)
    v_exp_f32 v16, v104
    v_add_f32 v7, v7, v18
    v_add_f32 v7, v7, v19
    v_exp_f32 v17, v105
    v_cvt_pk_bf16_f32 v169, v18, v19
    v_mfma_f32_16x16x32_bf16 v[184:187], v[40:43], a[248:251], v[184:187]
    ds_read_b128 v[32:35], v2 offset:12544
    v_mfma_f32_16x16x32_bf16 v[184:187], v[44:47], a[252:255], v[184:187]
    v_exp_f32 v18, v106
    v_add_f32 v7, v7, v16
    v_add_f32 v7, v7, v17
    v_exp_f32 v19, v107
    v_mfma_f32_16x16x32_bf16 v[188:191], v[40:43], v[208:211], v[188:191]
    ds_read_b128 v[36:39], v3 offset:12544
    v_cvt_pk_bf16_f32 v170, v16, v17
    v_mfma_f32_16x16x32_bf16 v[188:191], v[44:47], v[212:215], v[188:191]
    s_waitcnt lgkmcnt(2)
    v_exp_f32 v16, v172
    v_add_f32 v7, v7, v18
    v_add_f32 v7, v7, v19
    v_exp_f32 v17, v173
    v_cvt_pk_bf16_f32 v171, v18, v19
    v_mfma_f32_16x16x32_bf16 v[120:123], v[24:27], a[248:251], v[120:123]
    ds_read_b128 v[40:43], v2 offset:18688
    v_xor_b32 v54, 32, v11
    v_mfma_f32_16x16x32_bf16 v[120:123], v[28:31], a[252:255], v[120:123]
    s_waitcnt vmcnt(4)
    v_exp_f32 v18, v174
    v_add_f32 v8, v8, v16
    v_add_f32 v8, v8, v17
    v_exp_f32 v19, v175
    v_cvt_pk_bf16_f32 v172, v16, v17
    v_mfma_f32_16x16x32_bf16 v[124:127], v[24:27], v[208:211], v[124:127]
    ds_read_b128 v[44:47], v3 offset:18688
    v_mfma_f32_16x16x32_bf16 v[124:127], v[28:31], v[212:215], v[124:127]
    s_waitcnt lgkmcnt(2)
    s_barrier
    v_add_u32 v2, 49152, v2
    v_add_u32 v3, 49152, v3
    v_exp_f32 v16, v108
    v_mfma_f32_16x16x32_bf16 v[184:187], v[32:35], v[192:195], v[184:187]
    ds_read_b128 v[24:27], v2 offset:0
    v_add_f32 v8, v8, v18
    v_mfma_f32_16x16x32_bf16 v[184:187], v[36:39], v[196:199], v[184:187]
    buffer_store_dwordx4 v[232:235], v54, s[4:7], s33 offen offset:1536 sc1
    v_add_f32 v8, v8, v19
    v_exp_f32 v17, v109
    v_mfma_f32_16x16x32_bf16 v[188:191], v[32:35], v[216:219], v[188:191]
    ds_read_b128 v[28:31], v3 offset:0
    v_cvt_pk_bf16_f32 v173, v18, v19
    v_mfma_f32_16x16x32_bf16 v[188:191], v[36:39], v[220:223], v[188:191]
    s_waitcnt lgkmcnt(2)
    v_exp_f32 v18, v110
    v_add_f32 v8, v8, v16
    v_add_f32 v8, v8, v17
    v_exp_f32 v19, v111
    v_cvt_pk_bf16_f32 v174, v16, v17
    v_mfma_f32_16x16x32_bf16 v[120:123], v[40:43], v[192:195], v[120:123]
    ds_read_b128 v[32:35], v2 offset:6144
    v_xor_b32 v55, 48, v11
    v_mfma_f32_16x16x32_bf16 v[120:123], v[44:47], v[196:199], v[120:123]
    buffer_store_dwordx4 v[236:239], v55, s[4:7], s33 offen offset:2304 sc1
    v_add_f32 v8, v8, v18
    v_add_f32 v8, v8, v19
    v_cvt_pk_bf16_f32 v175, v18, v19
    v_mfma_f32_16x16x32_bf16 v[124:127], v[40:43], v[216:219], v[124:127]
    ds_read_b128 v[36:39], v3 offset:6144
    v_mfma_f32_16x16x32_bf16 v[124:127], v[44:47], v[220:223], v[124:127]
    s_waitcnt lgkmcnt(2)
    v_mfma_f32_16x16x32_bf16 v[64:67], v[24:27], a[192:195], v[128:131]
    ds_read_b128 v[40:43], v2 offset:128
    v_mfma_f32_16x16x32_bf16 v[64:67], v[28:31], a[196:199], v[64:67]
    buffer_load_dwordx2 v[60:61], off, s[80:83], s37 offset:8
    v_mfma_f32_16x16x32_bf16 v[68:71], v[24:27], a[216:219], v[132:135]
    v_exp_f32 v16, v176
    v_mfma_f32_16x16x32_bf16 v[68:71], v[28:31], a[220:223], v[68:71]
    v_exp_f32 v17, v177
    v_mfma_f32_16x16x32_bf16 v[72:75], v[24:27], a[240:243], v[136:139]
    ds_read_b128 v[44:47], v3 offset:128
    v_mfma_f32_16x16x32_bf16 v[72:75], v[28:31], a[244:247], v[72:75]
    buffer_load_dwordx2 v[62:63], off, s[84:87], s37 offset:8
    v_mfma_f32_16x16x32_bf16 v[76:79], v[24:27], v[200:203], v[140:143]
    v_exp_f32 v18, v178
    v_mfma_f32_16x16x32_bf16 v[76:79], v[28:31], v[204:207], v[76:79]
    s_waitcnt lgkmcnt(2)
    v_add_f32 v7, v7, v16
    v_add_f32 v7, v7, v17
    v_mfma_f32_16x16x32_bf16 v[96:99], v[32:35], a[192:195], v[128:131]
    ds_read_b128 v[24:27], v2 offset:6272
    v_mfma_f32_16x16x32_bf16 v[96:99], v[36:39], a[196:199], v[96:99]
    buffer_load_dwordx4 v[240:243], v12, s[68:71], s16 offen offset:0 nt
    v_mfma_f32_16x16x32_bf16 v[100:103], v[32:35], a[216:219], v[132:135]
    s_waitcnt vmcnt(7)
    v_exp_f32 v19, v179
    v_mfma_f32_16x16x32_bf16 v[100:103], v[36:39], a[220:223], v[100:103]
    v_cvt_pk_bf16_f32 v176, v16, v17
    v_exp_f32 v16, v112
    v_mfma_f32_16x16x32_bf16 v[104:107], v[32:35], a[240:243], v[136:139]
    ds_read_b128 v[28:31], v3 offset:6272
    v_add_f32 v7, v7, v18
    v_mfma_f32_16x16x32_bf16 v[104:107], v[36:39], a[244:247], v[104:107]
    buffer_load_dwordx4 v[244:247], v12, s[68:71], s16 offen offset:768 nt
    v_add_f32 v7, v7, v19
    v_mfma_f32_16x16x32_bf16 v[108:111], v[32:35], v[200:203], v[140:143]
    v_exp_f32 v17, v113
    v_mfma_f32_16x16x32_bf16 v[108:111], v[36:39], v[204:207], v[108:111]
    s_waitcnt lgkmcnt(2)
    v_cvt_pk_bf16_f32 v177, v18, v19
    v_exp_f32 v18, v114
    v_mfma_f32_16x16x32_bf16 v[64:67], v[40:43], a[200:203], v[64:67]
    ds_read_b128 v[32:35], v2 offset:256
    v_add_f32 v7, v7, v16
    v_mfma_f32_16x16x32_bf16 v[64:67], v[44:47], a[204:207], v[64:67]
    buffer_load_dwordx4 v[248:251], v12, s[68:71], s16 offen offset:1536 nt
    v_add_f32 v7, v7, v17
    v_mfma_f32_16x16x32_bf16 v[68:71], v[40:43], a[224:227], v[68:71]
    v_exp_f32 v19, v115
    v_mfma_f32_16x16x32_bf16 v[68:71], v[44:47], a[228:231], v[68:71]
    v_cvt_pk_bf16_f32 v178, v16, v17
    v_exp_f32 v16, v180
    v_mfma_f32_16x16x32_bf16 v[72:75], v[40:43], a[248:251], v[72:75]
    ds_read_b128 v[36:39], v3 offset:256
    v_add_f32 v7, v7, v18
    v_mfma_f32_16x16x32_bf16 v[72:75], v[44:47], a[252:255], v[72:75]
    buffer_load_dwordx4 v[252:255], v12, s[68:71], s16 offen offset:2304 nt
    v_add_f32 v7, v7, v19
    v_mfma_f32_16x16x32_bf16 v[76:79], v[40:43], v[208:211], v[76:79]
    v_exp_f32 v17, v181
    v_mfma_f32_16x16x32_bf16 v[76:79], v[44:47], v[212:215], v[76:79]
    s_waitcnt lgkmcnt(2)
    v_cvt_pk_bf16_f32 v179, v18, v19
    v_exp_f32 v18, v182
    v_mfma_f32_16x16x32_bf16 v[96:99], v[24:27], a[200:203], v[96:99]
    s_mov_b32 m0, s26
    ds_read_b128 v[40:43], v2 offset:6400
    v_add_f32 v8, v8, v16
    v_mfma_f32_16x16x32_bf16 v[96:99], v[28:31], a[204:207], v[96:99]
    buffer_load_dwordx4 v4, s[4:7], s32 offen offset:0 sc1 lds
    v_add_f32 v8, v8, v17
    v_mfma_f32_16x16x32_bf16 v[100:103], v[24:27], a[224:227], v[100:103]
    v_exp_f32 v19, v183
    v_mfma_f32_16x16x32_bf16 v[100:103], v[28:31], a[228:231], v[100:103]
    v_cvt_pk_bf16_f32 v180, v16, v17
    v_exp_f32 v16, v116
    v_mfma_f32_16x16x32_bf16 v[104:107], v[24:27], a[248:251], v[104:107]
    ds_read_b128 v[44:47], v3 offset:6400
    v_add_f32 v8, v8, v18
    v_mfma_f32_16x16x32_bf16 v[104:107], v[28:31], a[252:255], v[104:107]
    buffer_load_dwordx4 v4, s[4:7], s32 offen offset:1024 sc1 lds
    v_add_f32 v8, v8, v19
    v_mfma_f32_16x16x32_bf16 v[108:111], v[24:27], v[208:211], v[108:111]
    v_exp_f32 v17, v117
    v_mfma_f32_16x16x32_bf16 v[108:111], v[28:31], v[212:215], v[108:111]
    s_waitcnt lgkmcnt(2)
    v_cvt_pk_bf16_f32 v181, v18, v19
    v_exp_f32 v18, v118
    v_mfma_f32_16x16x32_bf16 v[64:67], v[32:35], a[208:211], v[64:67]
    ds_read_b128 v[24:27], v2 offset:12288
    v_add_f32 v8, v8, v16
    v_mfma_f32_16x16x32_bf16 v[64:67], v[36:39], a[212:215], v[64:67]
    buffer_load_dwordx4 v4, s[4:7], s32 offen offset:2048 sc1 lds
    v_add_f32 v8, v8, v17
    v_mfma_f32_16x16x32_bf16 v[68:71], v[32:35], a[232:235], v[68:71]
    s_add_u32 s32, s32, 24576
    v_exp_f32 v19, v119
    v_mfma_f32_16x16x32_bf16 v[68:71], v[36:39], a[236:239], v[68:71]
    v_cvt_pk_bf16_f32 v182, v16, v17
    v_add_f32 v8, v8, v18
    v_add_f32 v8, v8, v19
    v_mfma_f32_16x16x32_bf16 v[72:75], v[32:35], v[192:195], v[72:75]
    s_sub_u32 s57, s32, 196608
    ds_read_b128 v[28:31], v3 offset:12288
    v_cvt_pk_bf16_f32 v183, v18, v19
    v_mfma_f32_16x16x32_bf16 v[72:75], v[36:39], v[196:199], v[72:75]
    s_waitcnt lgkmcnt(2)
    v_exp_f32 v16, v184
    v_lshlrev_b32 v48, 16, v56
    v_mfma_f32_16x16x32_bf16 v[76:79], v[32:35], v[216:219], v[76:79]
    s_waitcnt vmcnt(9)
    v_exp_f32 v17, v185
    v_mfma_f32_16x16x32_bf16 v[76:79], v[36:39], v[220:223], v[76:79]
    s_barrier
    v_exp_f32 v18, v186
    v_mfma_f32_16x16x32_bf16 v[96:99], v[40:43], a[208:211], v[96:99]
    s_min_u32 s32, s32, s57
    ds_read_b128 v[32:35], v2 offset:18432
    v_add_f32 v7, v7, v16
    v_mfma_f32_16x16x32_bf16 v[96:99], v[44:47], a[212:215], v[96:99]
    v_add_f32 v7, v7, v17
    v_exp_f32 v19, v187
    v_mfma_f32_16x16x32_bf16 v[100:103], v[40:43], a[232:235], v[100:103]
    s_add_u32 s26, s26, 12288
    v_cvt_pk_bf16_f32 v184, v16, v17
    v_and_b32 v49, s97, v56
    v_mfma_f32_16x16x32_bf16 v[100:103], v[44:47], a[236:239], v[100:103]
    v_exp_f32 v16, v120
    v_add_f32 v7, v7, v18
    v_mfma_f32_16x16x32_bf16 v[104:107], v[40:43], v[192:195], v[104:107]
    s_mov_b32 m0, s26
    ds_read_b128 v[36:39], v3 offset:18432
    v_add_f32 v7, v7, v19
    v_mfma_f32_16x16x32_bf16 v[104:107], v[44:47], v[196:199], v[104:107]
    buffer_load_dwordx4 v4, s[4:7], s32 offen offset:0 sc1 lds
    v_lshlrev_b32 v50, 16, v58
    v_mfma_f32_16x16x32_bf16 v[108:111], v[40:43], v[216:219], v[108:111]
    v_exp_f32 v17, v121
    v_mfma_f32_16x16x32_bf16 v[108:111], v[44:47], v[220:223], v[108:111]
    s_waitcnt lgkmcnt(2)
    v_cvt_pk_bf16_f32 v185, v18, v19
    v_exp_f32 v18, v122
    v_mfma_f32_16x16x32_bf16 v[80:83], v[24:27], a[192:195], v[128:131]
    ds_read_b128 v[40:43], v2 offset:12416
    v_add_f32 v7, v7, v16
    v_mfma_f32_16x16x32_bf16 v[80:83], v[28:31], a[196:199], v[80:83]
    buffer_load_dwordx4 v4, s[4:7], s32 offen offset:1024 sc1 lds
    v_add_f32 v7, v7, v17
    v_mfma_f32_16x16x32_bf16 v[84:87], v[24:27], a[216:219], v[132:135]
    v_exp_f32 v19, v123
    v_mfma_f32_16x16x32_bf16 v[84:87], v[28:31], a[220:223], v[84:87]
    v_cvt_pk_bf16_f32 v186, v16, v17
    v_exp_f32 v16, v188
    v_mfma_f32_16x16x32_bf16 v[88:91], v[24:27], a[240:243], v[136:139]
    ds_read_b128 v[44:47], v3 offset:12416
    v_add_f32 v7, v7, v18
    v_mfma_f32_16x16x32_bf16 v[88:91], v[28:31], a[244:247], v[88:91]
    v_add_u32 v0, 1, v0
    buffer_store_dword v0, v13, s[20:23], 0 offen offset:32 sc1
    v_mfma_f32_16x16x32_bf16 v[92:95], v[24:27], v[200:203], v[140:143]
    v_add_f32 v7, v7, v19
    v_exp_f32 v17, v189
    v_cvt_pk_bf16_f32 v187, v18, v19
    v_exp_f32 v18, v190
    v_add_f32 v8, v8, v16
    v_add_f32 v8, v8, v17
    v_exp_f32 v19, v191
    v_cvt_pk_bf16_f32 v188, v16, v17
    v_exp_f32 v16, v124
    v_add_f32 v8, v8, v18
    v_add_f32 v8, v8, v19
    v_exp_f32 v17, v125
    v_cvt_pk_bf16_f32 v189, v18, v19
    v_exp_f32 v18, v126
    v_add_f32 v8, v8, v16
    v_add_f32 v8, v8, v17
    v_exp_f32 v19, v127
    v_cvt_pk_bf16_f32 v190, v16, v17
    v_add_f32 v8, v8, v18
    v_add_f32 v8, v8, v19
    v_cvt_pk_bf16_f32 v191, v18, v19
    v_mfma_f32_16x16x32_bf16 v[92:95], v[28:31], v[204:207], v[92:95]
    s_waitcnt lgkmcnt(2)
    v_and_b32 v51, s97, v58
    v_mul_f32_e64 v50, -v50, v48
    v_mul_f32_e64 v51, -v51, v49
    v_mfma_f32_16x16x32_bf16 v[112:115], v[32:35], a[192:195], v[128:131]
    ds_read_b128 v[24:27], v2 offset:18560
    v_cvt_f32_i32 v144, v144
    v_mfma_f32_16x16x32_bf16 v[112:115], v[36:39], a[196:199], v[112:115]
    buffer_load_dwordx4 v4, s[4:7], s32 offen offset:2048 sc1 lds
    v_cvt_f32_i32 v148, v148
    v_mfma_f32_16x16x32_bf16 v[116:119], v[32:35], a[216:219], v[132:135]
    s_mov_b32 s32, 196608
    v_fma_f32 v144, v144, v48, v50
    v_fma_f32 v148, v148, v49, v51
    v_mfma_f32_16x16x32_bf16 v[116:119], v[36:39], a[220:223], v[116:119]
    v_cvt_f32_i32 v145, v145
    v_cvt_f32_i32 v149, v149
    v_fma_f32 v145, v145, v48, v50
    v_mfma_f32_16x16x32_bf16 v[120:123], v[32:35], a[240:243], v[136:139]
    s_add_u32 s26, s26, 36864
    ds_read_b128 v[28:31], v3 offset:18560
    v_fma_f32 v149, v149, v49, v51
    v_mfma_f32_16x16x32_bf16 v[120:123], v[36:39], a[244:247], v[120:123]
    v_cvt_f32_i32 v146, v146
    v_cvt_f32_i32 v150, v150
    v_fma_f32 v146, v146, v48, v50
    v_mfma_f32_16x16x32_bf16 v[124:127], v[32:35], v[200:203], v[140:143]
    s_sub_u32 s57, s26, 147456
    v_fma_f32 v150, v150, v49, v51
    v_cvt_f32_i32 v147, v147
    v_mfma_f32_16x16x32_bf16 v[124:127], v[36:39], v[204:207], v[124:127]
    s_waitcnt lgkmcnt(2)
    v_cvt_f32_i32 v151, v151
    v_exp_f32 v16, v64
    v_mfma_f32_16x16x32_bf16 v[80:83], v[40:43], a[200:203], v[80:83]
    s_min_u32 s26, s26, s57
    ds_read_b128 v[32:35], v2 offset:12544
    v_fma_f32 v147, v147, v48, v50
    v_mfma_f32_16x16x32_bf16 v[80:83], v[44:47], a[204:207], v[80:83]
    v_exp_f32 v17, v65
    v_fma_f32 v151, v151, v49, v51
    v_mfma_f32_16x16x32_bf16 v[84:87], v[40:43], a[224:227], v[84:87]
    s_mov_b32 m0, s56
    v_exp_f32 v18, v66
    v_mfma_f32_16x16x32_bf16 v[84:87], v[44:47], a[228:231], v[84:87]
    buffer_load_dwordx4 v4, s[4:7], s27 offen offset:0 sc1 lds
    v_lshlrev_b32 v48, 16, v57
    v_mfma_f32_16x16x32_bf16 v[88:91], v[40:43], a[248:251], v[88:91]
    ds_read_b128 v[36:39], v3 offset:12544
    v_add_f32 v5, v5, v16
    v_mfma_f32_16x16x32_bf16 v[88:91], v[44:47], a[252:255], v[88:91]
    v_add_f32 v5, v5, v17
    v_and_b32 v49, s97, v57
    v_lshlrev_b32 v50, 16, v59
    v_mfma_f32_16x16x32_bf16 v[92:95], v[40:43], v[208:211], v[92:95]
    v_exp_f32 v19, v67
    v_mfma_f32_16x16x32_bf16 v[92:95], v[44:47], v[212:215], v[92:95]
    s_waitcnt lgkmcnt(2)
    buffer_load_dwordx4 v4, s[4:7], s27 offen offset:1024 sc1 lds
    v_cvt_pk_bf16_f32 v64, v16, v17
    v_mfma_f32_16x16x32_bf16 v[112:115], v[24:27], a[200:203], v[112:115]
    ds_read_b128 v[40:43], v2 offset:18688
    v_and_b32 v51, s97, v59
    v_mfma_f32_16x16x32_bf16 v[112:115], v[28:31], a[204:207], v[112:115]
    v_exp_f32 v16, v96
    v_add_f32 v5, v5, v18
    v_mfma_f32_16x16x32_bf16 v[116:119], v[24:27], a[224:227], v[116:119]
    v_add_f32 v5, v5, v19
    v_mul_f32_e64 v50, -v50, v48
    v_mfma_f32_16x16x32_bf16 v[116:119], v[28:31], a[228:231], v[116:119]
    s_waitcnt vmcnt(13)
    buffer_load_dwordx4 v4, s[4:7], s27 offen offset:2048 sc1 lds
    v_mul_f32_e64 v51, -v51, v49
    v_mfma_f32_16x16x32_bf16 v[120:123], v[24:27], a[248:251], v[120:123]
    s_add_u32 s27, s27, 24576
    ds_read_b128 v[44:47], v3 offset:18688
    v_cvt_f32_i32 v152, v152
    v_mfma_f32_16x16x32_bf16 v[120:123], v[28:31], a[252:255], v[120:123]
    s_waitcnt lgkmcnt(2)
    v_exp_f32 v17, v97
    v_cvt_pk_bf16_f32 v65, v18, v19
    v_mfma_f32_16x16x32_bf16 v[124:127], v[24:27], v[208:211], v[124:127]
    s_sub_u32 s58, s27, 196608
    v_exp_f32 v18, v98
    v_mfma_f32_16x16x32_bf16 v[124:127], v[28:31], v[212:215], v[124:127]
    s_barrier
    v_subrev_u32 v1, 49152, v1
    v_add_f32 v5, v5, v16
    v_mfma_f32_16x16x32_bf16 v[80:83], v[32:35], a[208:211], v[80:83]
    s_min_u32 s27, s27, s58
    ds_read_b128 v[24:27], v1 offset:0
    v_add_f32 v5, v5, v17
    v_mfma_f32_16x16x32_bf16 v[80:83], v[36:39], a[212:215], v[80:83]
    v_exp_f32 v19, v99
    v_cvt_f32_i32 v156, v156
    v_mfma_f32_16x16x32_bf16 v[84:87], v[32:35], a[232:235], v[84:87]
    s_add_u32 s56, s56, 12288
    v_cvt_pk_bf16_f32 v66, v16, v17
    v_fma_f32 v152, v152, v48, v50
    v_mfma_f32_16x16x32_bf16 v[84:87], v[36:39], a[236:239], v[84:87]
    v_exp_f32 v16, v68
    v_fma_f32 v156, v156, v49, v51
    v_mfma_f32_16x16x32_bf16 v[88:91], v[32:35], v[192:195], v[88:91]
    s_mov_b32 m0, s56
    ds_read_b128 v[28:31], v1 offset:12288
    v_add_f32 v5, v5, v18
    v_mfma_f32_16x16x32_bf16 v[88:91], v[36:39], v[196:199], v[88:91]
    s_waitcnt vmcnt(12)
    buffer_load_dwordx4 v4, s[4:7], s27 offen offset:0 sc1 lds
    v_add_f32 v5, v5, v19
    v_mfma_f32_16x16x32_bf16 v[92:95], v[32:35], v[216:219], v[92:95]
    v_exp_f32 v17, v69
    v_mfma_f32_16x16x32_bf16 v[92:95], v[36:39], v[220:223], v[92:95]
    s_waitcnt lgkmcnt(2)
    v_cvt_f32_i32 v153, v153
    v_cvt_pk_bf16_f32 v67, v18, v19
    v_cvt_f32_i32 v157, v157
    v_mfma_f32_16x16x32_bf16 v[112:115], v[40:43], a[208:211], v[112:115]
    ds_read_b128 v[32:35], v1 offset:1024
    v_fma_f32 v153, v153, v48, v50
    v_mfma_f32_16x16x32_bf16 v[112:115], v[44:47], a[212:215], v[112:115]
    s_waitcnt vmcnt(12)
    buffer_load_dwordx4 v4, s[4:7], s27 offen offset:1024 sc1 lds
    v_fma_f32 v157, v157, v49, v51
    v_mfma_f32_16x16x32_bf16 v[116:119], v[40:43], a[232:235], v[116:119]
    s_waitcnt vmcnt(12)
    buffer_load_dwordx4 v4, s[4:7], s27 offen offset:2048 sc1 lds
    v_mfma_f32_16x16x32_bf16 v[116:119], v[44:47], a[236:239], v[116:119]
    v_exp_f32 v18, v70
    v_add_f32 v6, v6, v16
    v_mfma_f32_16x16x32_bf16 v[120:123], v[40:43], v[192:195], v[120:123]
    s_add_u32 s27, s27, 24576
    ds_read_b128 v[36:39], v1 offset:13312
    v_add_f32 v6, v6, v17
    v_mfma_f32_16x16x32_bf16 v[120:123], v[44:47], v[196:199], v[120:123]
    v_exp_f32 v19, v71
    v_cvt_pk_bf16_f32 v68, v16, v17
    v_mfma_f32_16x16x32_bf16 v[124:127], v[40:43], v[216:219], v[124:127]
    s_sub_u32 s58, s27, 196608
    v_exp_f32 v16, v100
    v_mfma_f32_16x16x32_bf16 v[124:127], v[44:47], v[220:223], v[124:127]
    s_waitcnt lgkmcnt(2)
    v_cvt_f32_i32 v154, v154
    v_add_f32 v6, v6, v18
    v_cvt_f32_i32 v158, v158
    v_add_f32 v6, v6, v19
    v_fma_f32 v154, v154, v48, v50
    v_exp_f32 v17, v101
    v_fma_f32 v158, v158, v49, v51
    v_cvt_f32_i32 v155, v155
    v_cvt_pk_bf16_f32 v69, v18, v19
    v_cvt_f32_i32 v159, v159
    v_exp_f32 v18, v102
    v_fma_f32 v155, v155, v48, v50
    v_fma_f32 v159, v159, v49, v51
    v_add_f32 v6, v6, v16
    v_cvt_pk_bf16_f32 v144, v144, v148
    v_add_f32 v6, v6, v17
    v_cvt_pk_bf16_f32 v148, v145, v149
    v_exp_f32 v19, v103
    v_cvt_pk_bf16_f32 v145, v152, v156
    v_cvt_pk_bf16_f32 v149, v153, v157
    v_cvt_pk_bf16_f32 v70, v16, v17
    s_min_u32 s27, s27, s58
    v_cvt_pk_bf16_f32 v152, v146, v150
    v_add_f32 v6, v6, v18
    s_add_u32 s56, s56, 36864
    v_cvt_pk_bf16_f32 v153, v154, v158
    v_add_f32 v6, v6, v19
    s_sub_u32 s58, s56, 147456
    v_cvt_pk_bf16_f32 v156, v147, v151
    v_cvt_pk_bf16_f32 v71, v18, v19
    s_min_u32 s56, s56, s58
    v_cvt_pk_bf16_f32 v157, v155, v159
    s_mov_b32 s31, 7
    v_mfma_f32_16x16x32_bf16 a[96:99], v[160:163], v[24:27], 0
    s_add_u32 s33, s33, 196608
    ds_read_b128 v[40:43], v1 offset:2048
    v_mfma_f32_16x16x32_bf16 a[96:99], v[168:171], v[28:31], a[96:99]
    s_add_u32 s34, s34, 196608
    v_exp_f32 v16, v72
    v_mfma_f32_16x16x32_bf16 a[144:147], v[164:167], v[24:27], 0
    s_add_u32 s36, s36, 1536
    ds_read_b128 v[44:47], v1 offset:14336
    v_mfma_f32_16x16x32_bf16 a[144:147], v[172:175], v[28:31], a[144:147]
    s_waitcnt lgkmcnt(2)
    v_exp_f32 v17, v73
    v_mfma_f32_16x16x32_bf16 a[100:103], v[160:163], v[32:35], 0
    ds_read_b128 v[24:27], v1 offset:3072
    v_mfma_f32_16x16x32_bf16 a[100:103], v[168:171], v[36:39], a[100:103]
    s_waitcnt vmcnt(12)
    buffer_load_dwordx2 v[56:57], v10, s[72:75], s36 offen offset:0
    v_mfma_f32_16x16x32_bf16 a[148:151], v[164:167], v[32:35], 0
    ds_read_b128 v[28:31], v1 offset:15360
    v_mfma_f32_16x16x32_bf16 a[148:151], v[172:175], v[36:39], a[148:151]
    s_waitcnt lgkmcnt(2)
    v_exp_f32 v18, v74
    v_mfma_f32_16x16x32_bf16 a[104:107], v[160:163], v[40:43], 0
    ds_read_b128 v[32:35], v1 offset:4096
    v_add_f32 v7, v7, v16
    v_mfma_f32_16x16x32_bf16 a[104:107], v[168:171], v[44:47], a[104:107]
    buffer_load_dwordx2 v[58:59], v10, s[76:79], s36 offen offset:0
    v_mfma_f32_16x16x32_bf16 a[152:155], v[164:167], v[40:43], 0
    ds_read_b128 v[36:39], v1 offset:16384
    v_add_f32 v7, v7, v17
    v_mfma_f32_16x16x32_bf16 a[152:155], v[172:175], v[44:47], a[152:155]
    s_waitcnt lgkmcnt(2)
    v_exp_f32 v19, v75
    v_mfma_f32_16x16x32_bf16 a[108:111], v[160:163], v[24:27], 0
    ds_read_b128 v[40:43], v1 offset:5120
    v_cvt_pk_bf16_f32 v72, v16, v17
    v_mfma_f32_16x16x32_bf16 a[108:111], v[168:171], v[28:31], a[108:111]
    s_waitcnt vmcnt(13)
    buffer_load_dwordx4 v[224:227], v9, s[64:67], s33 offen offset:0 nt
    v_mfma_f32_16x16x32_bf16 a[156:159], v[164:167], v[24:27], 0
    ds_read_b128 v[44:47], v1 offset:17408
    v_mfma_f32_16x16x32_bf16 a[156:159], v[172:175], v[28:31], a[156:159]
    s_waitcnt lgkmcnt(2)
    v_exp_f32 v16, v104
    v_mfma_f32_16x16x32_bf16 a[112:115], v[160:163], v[32:35], 0
    ds_read_b128 v[24:27], v1 offset:6144
    v_add_f32 v7, v7, v18
    v_mfma_f32_16x16x32_bf16 a[112:115], v[168:171], v[36:39], a[112:115]
    s_waitcnt vmcnt(13)
    buffer_load_dwordx4 v[228:231], v9, s[64:67], s33 offen offset:1536 nt
    v_add_f32 v7, v7, v19
    v_mfma_f32_16x16x32_bf16 a[160:163], v[164:167], v[32:35], 0
    ds_read_b128 v[28:31], v1 offset:18432
    v_mfma_f32_16x16x32_bf16 a[160:163], v[172:175], v[36:39], a[160:163]
    s_waitcnt lgkmcnt(2)
    v_exp_f32 v17, v105
    v_cvt_pk_bf16_f32 v73, v18, v19
    v_mfma_f32_16x16x32_bf16 a[116:119], v[160:163], v[40:43], 0
    ds_read_b128 v[32:35], v1 offset:7168
    v_mfma_f32_16x16x32_bf16 a[116:119], v[168:171], v[44:47], a[116:119]
    buffer_load_dwordx4 v[232:235], v9, s[64:67], s34 offen offset:0 nt
    v_mfma_f32_16x16x32_bf16 a[164:167], v[164:167], v[40:43], 0
    ds_read_b128 v[36:39], v1 offset:19456
    v_mfma_f32_16x16x32_bf16 a[164:167], v[172:175], v[44:47], a[164:167]
    s_waitcnt lgkmcnt(2)
    v_exp_f32 v18, v106
    v_add_f32 v7, v7, v16
    v_mfma_f32_16x16x32_bf16 a[120:123], v[160:163], v[24:27], 0
    ds_read_b128 v[40:43], v1 offset:8192
    v_add_f32 v7, v7, v17
    v_mfma_f32_16x16x32_bf16 a[120:123], v[168:171], v[28:31], a[120:123]
    s_waitcnt vmcnt(14)
    buffer_load_dwordx4 v[236:239], v9, s[64:67], s34 offen offset:1536 nt
    v_mfma_f32_16x16x32_bf16 a[168:171], v[164:167], v[24:27], 0
    ds_read_b128 v[44:47], v1 offset:20480
    v_mfma_f32_16x16x32_bf16 a[168:171], v[172:175], v[28:31], a[168:171]
    s_waitcnt lgkmcnt(2)
    v_exp_f32 v19, v107
    v_cvt_pk_bf16_f32 v74, v16, v17
    v_mfma_f32_16x16x32_bf16 a[124:127], v[160:163], v[32:35], 0
    ds_read_b128 v[24:27], v1 offset:9216
    v_mfma_f32_16x16x32_bf16 a[124:127], v[168:171], v[36:39], a[124:127]
    v_exp_f32 v16, v76
    v_add_f32 v7, v7, v18
    v_mfma_f32_16x16x32_bf16 a[172:175], v[164:167], v[32:35], 0
    s_waitcnt vmcnt(19)
    ds_read_b128 v[28:31], v1 offset:21504
    v_add_f32 v7, v7, v19
    v_mfma_f32_16x16x32_bf16 a[172:175], v[172:175], v[36:39], a[172:175]
    s_waitcnt lgkmcnt(2)
    v_exp_f32 v17, v77
    v_cvt_pk_bf16_f32 v75, v18, v19
    v_mfma_f32_16x16x32_bf16 a[128:131], v[160:163], v[40:43], 0
    s_add_u32 s29, s28, 49152
    ds_read_b128 v[32:35], v1 offset:10240
    v_lshlrev_b32 v48, 16, v60
    v_mfma_f32_16x16x32_bf16 a[128:131], v[168:171], v[44:47], a[128:131]
    v_exp_f32 v18, v78
    v_add_f32 v8, v8, v16
    v_mfma_f32_16x16x32_bf16 a[176:179], v[164:167], v[40:43], 0
    s_sub_u32 s3, s29, 147456
    ds_read_b128 v[36:39], v1 offset:22528
    v_add_f32 v8, v8, v17
    v_mfma_f32_16x16x32_bf16 a[176:179], v[172:175], v[44:47], a[176:179]
    s_waitcnt lgkmcnt(2)
    v_exp_f32 v19, v79
    v_mfma_f32_16x16x32_bf16 a[132:135], v[160:163], v[24:27], 0
    s_min_u32 s29, s29, s3
    ds_read_b128 v[40:43], v1 offset:11264
    v_cvt_pk_bf16_f32 v76, v16, v17
    v_mfma_f32_16x16x32_bf16 a[132:135], v[168:171], v[28:31], a[132:135]
    v_exp_f32 v16, v108
    v_mfma_f32_16x16x32_bf16 a[180:183], v[164:167], v[24:27], 0
    s_sub_u32 s3, s29, s28
    ds_read_b128 v[44:47], v1 offset:23552
    v_and_b32 v49, s97, v60
    v_mfma_f32_16x16x32_bf16 a[180:183], v[172:175], v[28:31], a[180:183]
    s_waitcnt lgkmcnt(2)
    v_add_u32 v1, 49152, v1
    v_add_f32 v8, v8, v18
    v_mfma_f32_16x16x32_bf16 a[136:139], v[160:163], v[32:35], 0
    ds_read_b128 v[24:27], v1 offset:0
    v_add_f32 v8, v8, v19
    v_mfma_f32_16x16x32_bf16 a[136:139], v[168:171], v[36:39], a[136:139]
    v_lshlrev_b32 v50, 16, v62
    v_exp_f32 v17, v109
    v_mfma_f32_16x16x32_bf16 a[184:187], v[164:167], v[32:35], 0
    ds_read_b128 v[28:31], v1 offset:12288
    v_and_b32 v51, s97, v62
    v_mfma_f32_16x16x32_bf16 a[184:187], v[172:175], v[36:39], a[184:187]
    s_waitcnt lgkmcnt(2)
    v_cvt_pk_bf16_f32 v77, v18, v19
    v_mul_f32_e64 v50, -v50, v48
    v_mfma_f32_16x16x32_bf16 a[140:143], v[160:163], v[40:43], 0
    s_mov_b32 s28, s29
    ds_read_b128 v[32:35], v1 offset:1024
    v_bfe_u32 v53, v4, 4, 6
    v_mfma_f32_16x16x32_bf16 a[140:143], v[168:171], v[44:47], a[140:143]
    v_exp_f32 v18, v110
    v_mul_f32_e64 v51, -v51, v49
    v_mfma_f32_16x16x32_bf16 a[188:191], v[164:167], v[40:43], 0
    ds_read_b128 v[36:39], v1 offset:13312
    v_lshlrev_b32 v53, 2, v53
    v_mfma_f32_16x16x32_bf16 a[188:191], v[172:175], v[44:47], a[188:191]
    s_waitcnt lgkmcnt(2)
    s_barrier
    v_add_f32 v8, v8, v16
    v_mfma_f32_16x16x32_bf16 a[96:99], v[176:179], v[24:27], a[96:99]
    ds_read_b128 v[40:43], v1 offset:2048
    buffer_load_dword v52, v53, s[20:23], s44 offen sc1
    v_mfma_f32_16x16x32_bf16 a[96:99], v[184:187], v[28:31], a[96:99]
    v_add_f32 v8, v8, v17
    v_cvt_f32_i32 v240, v240
    v_cvt_f32_i32 v244, v244
    v_mfma_f32_16x16x32_bf16 a[144:147], v[180:183], v[24:27], a[144:147]
    ds_read_b128 v[44:47], v1 offset:14336
    v_fma_f32 v240, v240, v48, v50
    v_mfma_f32_16x16x32_bf16 a[144:147], v[188:191], v[28:31], a[144:147]
    s_waitcnt lgkmcnt(2)
    v_exp_f32 v19, v111
    v_cvt_pk_bf16_f32 v78, v16, v17
    v_mfma_f32_16x16x32_bf16 a[100:103], v[176:179], v[32:35], a[100:103]
    s_mov_b32 m0, s56
    ds_read_b128 v[24:27], v1 offset:3072
    v_add_f32 v8, v8, v18
    v_mfma_f32_16x16x32_bf16 a[100:103], v[184:187], v[36:39], a[100:103]
    s_waitcnt vmcnt(15)
    buffer_load_dwordx4 v4, s[4:7], s27 offen offset:0 sc1 lds
    v_add_f32 v8, v8, v19
    v_mfma_f32_16x16x32_bf16 a[148:151], v[180:183], v[32:35], a[148:151]
    ds_read_b128 v[28:31], v1 offset:15360
    v_fma_f32 v244, v244, v49, v51
    v_mfma_f32_16x16x32_bf16 a[148:151], v[188:191], v[36:39], a[148:151]
    s_waitcnt lgkmcnt(2)
    v_cvt_pk_bf16_f32 v79, v18, v19
    v_cvt_f32_i32 v241, v241
    v_cvt_f32_i32 v245, v245
    v_mfma_f32_16x16x32_bf16 a[104:107], v[176:179], v[40:43], a[104:107]
    ds_read_b128 v[32:35], v1 offset:4096
    v_fma_f32 v241, v241, v48, v50
    v_mfma_f32_16x16x32_bf16 a[104:107], v[184:187], v[44:47], a[104:107]
    s_waitcnt vmcnt(14)
    buffer_load_dwordx4 v4, s[4:7], s27 offen offset:1024 sc1 lds
    v_fma_f32 v245, v245, v49, v51
    v_mfma_f32_16x16x32_bf16 a[152:155], v[180:183], v[40:43], a[152:155]
    ds_read_b128 v[36:39], v1 offset:16384
    v_cvt_f32_i32 v242, v242
    v_mfma_f32_16x16x32_bf16 a[152:155], v[188:191], v[44:47], a[152:155]
    s_waitcnt lgkmcnt(2)
    v_exp_f32 v16, v80
    v_cvt_f32_i32 v246, v246
    v_mfma_f32_16x16x32_bf16 a[108:111], v[176:179], v[24:27], a[108:111]
    ds_read_b128 v[40:43], v1 offset:5120
    v_fma_f32 v242, v242, v48, v50
    v_mfma_f32_16x16x32_bf16 a[108:111], v[184:187], v[28:31], a[108:111]
    s_waitcnt vmcnt(14)
    buffer_load_dwordx4 v4, s[4:7], s27 offen offset:2048 sc1 lds
    v_fma_f32 v246, v246, v49, v51
    v_mfma_f32_16x16x32_bf16 a[156:159], v[180:183], v[24:27], a[156:159]
    s_add_u32 s27, s27, 24576
    ds_read_b128 v[44:47], v1 offset:17408
    v_cvt_f32_i32 v243, v243
    v_mfma_f32_16x16x32_bf16 a[156:159], v[188:191], v[28:31], a[156:159]
    s_waitcnt lgkmcnt(2)
    v_exp_f32 v17, v81
    v_cvt_f32_i32 v247, v247
    v_mfma_f32_16x16x32_bf16 a[112:115], v[176:179], v[32:35], a[112:115]
    s_sub_u32 s58, s27, 196608
    ds_read_b128 v[24:27], v1 offset:6144
    v_fma_f32 v243, v243, v48, v50
    v_mfma_f32_16x16x32_bf16 a[112:115], v[184:187], v[36:39], a[112:115]
    v_exp_f32 v18, v82
    v_add_f32 v5, v5, v16
    v_mfma_f32_16x16x32_bf16 a[160:163], v[180:183], v[32:35], a[160:163]
    s_min_u32 s27, s27, s58
    ds_read_b128 v[28:31], v1 offset:18432
    v_add_f32 v5, v5, v17
    v_mfma_f32_16x16x32_bf16 a[160:163], v[188:191], v[36:39], a[160:163]
    s_waitcnt lgkmcnt(2)
    v_exp_f32 v19, v83
    v_cvt_pk_bf16_f32 v80, v16, v17
    v_mfma_f32_16x16x32_bf16 a[116:119], v[176:179], v[40:43], a[116:119]
    s_add_u32 s56, s56, 12288
    ds_read_b128 v[32:35], v1 offset:7168
    v_fma_f32 v247, v247, v49, v51
    v_mfma_f32_16x16x32_bf16 a[116:119], v[184:187], v[44:47], a[116:119]
    v_exp_f32 v16, v112
    v_add_f32 v5, v5, v18
    v_mfma_f32_16x16x32_bf16 a[164:167], v[180:183], v[40:43], a[164:167]
    ds_read_b128 v[36:39], v1 offset:19456
    v_add_u32 v2, s3, v2
    v_add_u32 v3, s3, v3
    v_mfma_f32_16x16x32_bf16 a[164:167], v[188:191], v[44:47], a[164:167]
    s_waitcnt lgkmcnt(2)
    v_add_f32 v5, v5, v19
    v_exp_f32 v17, v113
    v_mfma_f32_16x16x32_bf16 a[120:123], v[176:179], v[24:27], a[120:123]
    s_mov_b32 m0, s56
    ds_read_b128 v[40:43], v1 offset:8192
    v_cvt_pk_bf16_f32 v81, v18, v19
    v_mfma_f32_16x16x32_bf16 a[120:123], v[184:187], v[28:31], a[120:123]
    s_waitcnt vmcnt(14)
    buffer_load_dwordx4 v4, s[4:7], s27 offen offset:0 sc1 lds
    v_lshlrev_b32 v48, 16, v61
    v_mfma_f32_16x16x32_bf16 a[168:171], v[180:183], v[24:27], a[168:171]
    ds_read_b128 v[44:47], v1 offset:20480
    v_and_b32 v49, s97, v61
    v_mfma_f32_16x16x32_bf16 a[168:171], v[188:191], v[28:31], a[168:171]
    s_waitcnt lgkmcnt(2)
    v_exp_f32 v18, v114
    v_add_f32 v5, v5, v16
    v_mfma_f32_16x16x32_bf16 a[124:127], v[176:179], v[32:35], a[124:127]
    ds_read_b128 v[24:27], v1 offset:9216
    v_add_f32 v5, v5, v17
    v_mfma_f32_16x16x32_bf16 a[124:127], v[184:187], v[36:39], a[124:127]
    s_waitcnt vmcnt(14)
    buffer_load_dwordx4 v4, s[4:7], s27 offen offset:1024 sc1 lds
    v_lshlrev_b32 v50, 16, v63
    v_mfma_f32_16x16x32_bf16 a[172:175], v[180:183], v[32:35], a[172:175]
    ds_read_b128 v[28:31], v1 offset:21504
    v_and_b32 v51, s97, v63
    v_mfma_f32_16x16x32_bf16 a[172:175], v[188:191], v[36:39], a[172:175]
    s_waitcnt lgkmcnt(2)
    v_exp_f32 v19, v115
    v_cvt_pk_bf16_f32 v82, v16, v17
    v_mfma_f32_16x16x32_bf16 a[128:131], v[176:179], v[40:43], a[128:131]
    ds_read_b128 v[32:35], v1 offset:10240
    v_mul_f32_e64 v50, -v50, v48
    v_mfma_f32_16x16x32_bf16 a[128:131], v[184:187], v[44:47], a[128:131]
    s_waitcnt vmcnt(14)
    buffer_load_dwordx4 v4, s[4:7], s27 offen offset:2048 sc1 lds
    v_mul_f32_e64 v51, -v51, v49
    v_mfma_f32_16x16x32_bf16 a[176:179], v[180:183], v[40:43], a[176:179]
    ds_read_b128 v[36:39], v1 offset:22528
    v_cvt_f32_i32 v248, v248
    v_mfma_f32_16x16x32_bf16 a[176:179], v[188:191], v[44:47], a[176:179]
    s_waitcnt lgkmcnt(2)
    v_exp_f32 v16, v84
    v_add_f32 v5, v5, v18
    v_mfma_f32_16x16x32_bf16 a[132:135], v[176:179], v[24:27], a[132:135]
    ds_read_b128 v[40:43], v1 offset:11264
    v_add_f32 v5, v5, v19
    v_mfma_f32_16x16x32_bf16 a[132:135], v[184:187], v[28:31], a[132:135]
    s_waitcnt vmcnt(19)
    v_exp_f32 v17, v85
    v_cvt_f32_i32 v252, v252
    v_mfma_f32_16x16x32_bf16 a[180:183], v[180:183], v[24:27], a[180:183]
    s_mov_b32 s27, 208896
    ds_read_b128 v[44:47], v1 offset:23552
    v_cvt_pk_bf16_f32 v83, v18, v19
    v_mfma_f32_16x16x32_bf16 a[180:183], v[188:191], v[28:31], a[180:183]
    s_waitcnt lgkmcnt(2)
    s_barrier
    v_fma_f32 v248, v248, v48, v50
    v_mfma_f32_16x16x32_bf16 a[136:139], v[176:179], v[32:35], a[136:139]
    s_add_u32 s56, s56, 36864
    ds_read_b128 v[24:27], v2 offset:0
    v_fma_f32 v252, v252, v49, v51
    v_mfma_f32_16x16x32_bf16 a[136:139], v[184:187], v[36:39], a[136:139]
    v_exp_f32 v18, v86
    v_add_f32 v6, v6, v16
    v_mfma_f32_16x16x32_bf16 a[184:187], v[180:183], v[32:35], a[184:187]
    s_sub_u32 s58, s56, 147456
    ds_read_b128 v[28:31], v3 offset:0
    v_cvt_f32_i32 v249, v249
    v_mfma_f32_16x16x32_bf16 a[184:187], v[188:191], v[36:39], a[184:187]
    s_waitcnt lgkmcnt(2)
    v_add_f32 v6, v6, v17
    v_cvt_f32_i32 v253, v253
    v_fma_f32 v249, v249, v48, v50
    v_mfma_f32_16x16x32_bf16 a[140:143], v[176:179], v[40:43], a[140:143]
    s_nop 0
    ds_read_b128 v[32:35], v2 offset:6144
    v_fma_f32 v253, v253, v49, v51
    v_mfma_f32_16x16x32_bf16 a[140:143], v[184:187], v[44:47], a[140:143]
    s_min_u32 s56, s56, s58
    v_exp_f32 v19, v87
    v_cvt_pk_bf16_f32 v84, v16, v17
    v_mfma_f32_16x16x32_bf16 a[188:191], v[180:183], v[40:43], a[188:191]
    s_waitcnt lgkmcnt(1)
    ds_read_b128 v[36:39], v3 offset:6144
    v_exp_f32 v16, v116
    v_cvt_f32_i32 v250, v250
    v_add_f32 v6, v6, v18
    v_cvt_f32_i32 v254, v254
    v_add_f32 v6, v6, v19
    v_fma_f32 v250, v250, v48, v50
    v_exp_f32 v17, v117
    v_fma_f32 v254, v254, v49, v51
    v_cvt_f32_i32 v251, v251
    v_cvt_pk_bf16_f32 v85, v18, v19
    v_cvt_f32_i32 v255, v255
    v_exp_f32 v18, v118
    v_fma_f32 v251, v251, v48, v50
    v_fma_f32 v255, v255, v49, v51
    v_add_f32 v6, v6, v16
    v_cvt_pk_bf16_f32 v146, v240, v244
    v_add_f32 v6, v6, v17
    v_cvt_pk_bf16_f32 v150, v241, v245
    v_exp_f32 v19, v119
    v_cvt_pk_bf16_f32 v147, v248, v252
    v_cvt_pk_bf16_f32 v151, v249, v253
    v_cvt_pk_bf16_f32 v86, v16, v17
    v_cvt_pk_bf16_f32 v154, v242, v246
    v_add_f32 v6, v6, v18
    v_cvt_pk_bf16_f32 v155, v250, v254
    v_add_f32 v6, v6, v19
    v_cvt_pk_bf16_f32 v158, v243, v247
    v_cvt_pk_bf16_f32 v87, v18, v19
    v_cvt_pk_bf16_f32 v159, v251, v255
    v_mfma_f32_16x16x32_bf16 a[188:191], v[188:191], v[44:47], a[188:191]
    s_branch L_join
.p2align 6
L_loop:
    v_mfma_f32_16x16x32_bf16 v[160:163], v[24:27], a[192:195], v[128:131]
    s_mov_b32 m0, s56
    ds_read_b128 v[40:43], v2 offset:128
    v_fma_f32 v250, v250, v48, v50
    v_mfma_f32_16x16x32_bf16 v[160:163], v[28:31], a[196:199], v[160:163]
    buffer_load_dwordx4 v4, s[4:7], s27 offen offset:0 sc1 lds
    v_mfma_f32_16x16x32_bf16 v[164:167], v[24:27], a[216:219], v[132:135]
    v_exp_f32 v16, v88
    v_mfma_f32_16x16x32_bf16 v[164:167], v[28:31], a[220:223], v[164:167]
    v_exp_f32 v17, v89
    v_mfma_f32_16x16x32_bf16 v[168:171], v[24:27], a[240:243], v[136:139]
    ds_read_b128 v[44:47], v3 offset:128
    v_fma_f32 v251, v251, v49, v51
    v_mfma_f32_16x16x32_bf16 v[168:171], v[28:31], a[244:247], v[168:171]
    v_exp_f32 v18, v90
    v_mfma_f32_16x16x32_bf16 v[172:175], v[24:27], v[200:203], v[140:143]
    v_add_f32 v7, v7, v16
    v_add_f32 v7, v7, v17
    v_mfma_f32_16x16x32_bf16 v[172:175], v[28:31], v[204:207], v[172:175]
    s_waitcnt lgkmcnt(2)
    v_exp_f32 v19, v91
    v_mfma_f32_16x16x32_bf16 v[96:99], v[32:35], a[192:195], v[128:131]
    ds_read_b128 v[24:27], v2 offset:6272
    v_cvt_pk_bf16_f32 v235, v250, v251
    v_mfma_f32_16x16x32_bf16 v[96:99], v[36:39], a[196:199], v[96:99]
    buffer_load_dwordx4 v4, s[4:7], s27 offen offset:1024 sc1 lds
    v_mfma_f32_16x16x32_bf16 v[100:103], v[32:35], a[216:219], v[132:135]
    v_cvt_pk_bf16_f32 v88, v16, v17
    v_cvt_f32_i32 v254, v254
    v_mfma_f32_16x16x32_bf16 v[100:103], v[36:39], a[220:223], v[100:103]
    v_exp_f32 v16, v120
    v_mfma_f32_16x16x32_bf16 v[104:107], v[32:35], a[240:243], v[136:139]
    ds_read_b128 v[28:31], v3 offset:6272
    v_add_f32 v7, v7, v18
    v_mfma_f32_16x16x32_bf16 v[104:107], v[36:39], a[244:247], v[104:107]
    v_add_f32 v7, v7, v19
    v_cvt_f32_i32 v255, v255
    v_mfma_f32_16x16x32_bf16 v[108:111], v[32:35], v[200:203], v[140:143]
    v_exp_f32 v17, v121
    v_mfma_f32_16x16x32_bf16 v[108:111], v[36:39], v[204:207], v[108:111]
    s_waitcnt lgkmcnt(2)
    v_cvt_pk_bf16_f32 v89, v18, v19
    v_fma_f32 v254, v254, v48, v50
    v_mfma_f32_16x16x32_bf16 v[160:163], v[40:43], a[200:203], v[160:163]
    ds_read_b128 v[32:35], v2 offset:256
    v_mfma_f32_16x16x32_bf16 v[160:163], v[44:47], a[204:207], v[160:163]
    v_exp_f32 v18, v122
    v_mfma_f32_16x16x32_bf16 v[164:167], v[40:43], a[224:227], v[164:167]
    v_add_f32 v7, v7, v16
    v_add_f32 v7, v7, v17
    v_mfma_f32_16x16x32_bf16 v[164:167], v[44:47], a[228:231], v[164:167]
    buffer_load_dwordx4 v4, s[4:7], s27 offen offset:2048 sc1 lds
    v_mfma_f32_16x16x32_bf16 v[168:171], v[40:43], a[248:251], v[168:171]
    ds_read_b128 v[36:39], v3 offset:256
    v_fma_f32 v255, v255, v49, v51
    v_mfma_f32_16x16x32_bf16 v[168:171], v[44:47], a[252:255], v[168:171]
    v_exp_f32 v19, v123
    v_mfma_f32_16x16x32_bf16 v[172:175], v[40:43], v[208:211], v[172:175]
    v_cvt_pk_bf16_f32 v90, v16, v17
    v_cvt_pk_bf16_f32 v239, v254, v255
    v_mfma_f32_16x16x32_bf16 v[172:175], v[44:47], v[212:215], v[172:175]
    s_waitcnt lgkmcnt(2)
    v_exp_f32 v16, v92
    v_mfma_f32_16x16x32_bf16 v[96:99], v[24:27], a[200:203], v[96:99]
    ds_read_b128 v[40:43], v2 offset:6400
    v_add_f32 v7, v7, v18
    v_mfma_f32_16x16x32_bf16 v[96:99], v[28:31], a[204:207], v[96:99]
    s_add_u32 s27, s27, 24576
    v_add_f32 v7, v7, v19
    v_mfma_f32_16x16x32_bf16 v[100:103], v[24:27], a[224:227], v[100:103]
    v_exp_f32 v17, v93
    v_mfma_f32_16x16x32_bf16 v[100:103], v[28:31], a[228:231], v[100:103]
    v_cvt_pk_bf16_f32 v91, v18, v19
    v_mfma_f32_16x16x32_bf16 v[104:107], v[24:27], a[248:251], v[104:107]
    ds_read_b128 v[44:47], v3 offset:6400
    v_mfma_f32_16x16x32_bf16 v[104:107], v[28:31], a[252:255], v[104:107]
    v_exp_f32 v18, v94
    v_mfma_f32_16x16x32_bf16 v[108:111], v[24:27], v[208:211], v[108:111]
    s_add_u32 s29, s30, 49152
    v_add_f32 v8, v8, v16
    v_add_f32 v8, v8, v17
    v_mfma_f32_16x16x32_bf16 v[108:111], v[28:31], v[212:215], v[108:111]
    s_waitcnt lgkmcnt(2)
    v_exp_f32 v19, v95
    v_mfma_f32_16x16x32_bf16 v[160:163], v[32:35], a[208:211], v[160:163]
    s_waitcnt vmcnt(11)
    ds_read_b128 v[24:27], v2 offset:12288
    v_cvt_pk_bf16_f32 v92, v16, v17
    v_mfma_f32_16x16x32_bf16 v[160:163], v[36:39], a[212:215], v[160:163]
    s_sub_u32 s3, s29, 147456
    buffer_load_dwordx2 v[60:61], off, s[80:83], s37 offset:8
    v_mfma_f32_16x16x32_bf16 v[164:167], v[32:35], a[232:235], v[164:167]
    s_add_u32 s56, s56, 12288
    v_exp_f32 v16, v124
    v_mfma_f32_16x16x32_bf16 v[164:167], v[36:39], a[236:239], v[164:167]
    s_min_u32 s29, s29, s3
    v_add_f32 v8, v8, v18
    v_lshlrev_b32 v48, 16, v56
    v_mfma_f32_16x16x32_bf16 v[168:171], v[32:35], v[192:195], v[168:171]
    s_mov_b32 m0, s56
    ds_read_b128 v[28:31], v3 offset:12288
    v_add_f32 v8, v8, v19
    v_mfma_f32_16x16x32_bf16 v[168:171], v[36:39], v[196:199], v[168:171]
    buffer_load_dwordx2 v[62:63], off, s[84:87], s37 offset:8
    v_mfma_f32_16x16x32_bf16 v[172:175], v[32:35], v[216:219], v[172:175]
    v_exp_f32 v17, v125
    v_mfma_f32_16x16x32_bf16 v[172:175], v[36:39], v[220:223], v[172:175]
    s_waitcnt lgkmcnt(2)
    v_cvt_pk_bf16_f32 v93, v18, v19
    v_and_b32 v49, s97, v56
    v_mfma_f32_16x16x32_bf16 v[96:99], v[40:43], a[208:211], v[96:99]
    ds_read_b128 v[32:35], v2 offset:18432
    v_lshlrev_b32 v50, 16, v58
    v_mfma_f32_16x16x32_bf16 v[96:99], v[44:47], a[212:215], v[96:99]
    s_sub_u32 s3, s29, s30
    v_exp_f32 v18, v126
    v_mfma_f32_16x16x32_bf16 v[100:103], v[40:43], a[232:235], v[100:103]
    v_add_f32 v8, v8, v16
    v_add_f32 v8, v8, v17
    v_mfma_f32_16x16x32_bf16 v[100:103], v[44:47], a[236:239], v[100:103]
    buffer_load_dwordx4 v4, s[4:7], s27 offen offset:0 sc1 lds
    v_mfma_f32_16x16x32_bf16 v[104:107], v[40:43], v[192:195], v[104:107]
    ds_read_b128 v[36:39], v3 offset:18432
    v_and_b32 v51, s97, v58
    v_mfma_f32_16x16x32_bf16 v[104:107], v[44:47], v[196:199], v[104:107]
    v_exp_f32 v19, v127
    v_mfma_f32_16x16x32_bf16 v[108:111], v[40:43], v[216:219], v[108:111]
    v_cvt_pk_bf16_f32 v94, v16, v17
    v_add_f32 v8, v8, v18
    v_mfma_f32_16x16x32_bf16 v[108:111], v[44:47], v[220:223], v[108:111]
    s_waitcnt lgkmcnt(2)
    buffer_load_dwordx4 v[240:243], v12, s[68:71], s16 offen offset:0 nt
    v_mfma_f32_16x16x32_bf16 v[176:179], v[24:27], a[192:195], v[128:131]
    ds_read_b128 v[40:43], v2 offset:12416
    v_add_f32 v8, v8, v19
    v_mfma_f32_16x16x32_bf16 v[176:179], v[28:31], a[196:199], v[176:179]
    s_mov_b32 s30, s29
    v_cvt_pk_bf16_f32 v95, v18, v19
    v_mul_f32_e64 v50, -v50, v48
    v_mfma_f32_16x16x32_bf16 v[180:183], v[24:27], a[216:219], v[132:135]
    v_exp_f32 v16, v160
    v_mfma_f32_16x16x32_bf16 v[180:183], v[28:31], a[220:223], v[180:183]
    buffer_load_dwordx4 v4, s[4:7], s27 offen offset:1024 sc1 lds
    v_mfma_f32_16x16x32_bf16 v[184:187], v[24:27], a[240:243], v[136:139]
    ds_read_b128 v[44:47], v3 offset:12416
    v_mul_f32_e64 v51, -v51, v49
    v_mfma_f32_16x16x32_bf16 v[184:187], v[28:31], a[244:247], v[184:187]
    v_exp_f32 v17, v161
    v_mfma_f32_16x16x32_bf16 v[188:191], v[24:27], v[200:203], v[140:143]
    v_exp_f32 v18, v162
    v_mfma_f32_16x16x32_bf16 v[188:191], v[28:31], v[204:207], v[188:191]
    s_waitcnt lgkmcnt(2)
    buffer_load_dwordx4 v[244:247], v12, s[68:71], s16 offen offset:768 nt
    v_mfma_f32_16x16x32_bf16 v[112:115], v[32:35], a[192:195], v[128:131]
    ds_read_b128 v[24:27], v2 offset:18560
    v_add_f32 v5, v5, v16
    v_mfma_f32_16x16x32_bf16 v[112:115], v[36:39], a[196:199], v[112:115]
    v_add_f32 v5, v5, v17
    v_cvt_f32_i32 v144, v144
    v_mfma_f32_16x16x32_bf16 v[116:119], v[32:35], a[216:219], v[132:135]
    v_exp_f32 v19, v163
    v_mfma_f32_16x16x32_bf16 v[116:119], v[36:39], a[220:223], v[116:119]
    v_cvt_pk_bf16_f32 v160, v16, v17
    v_cvt_f32_i32 v148, v148
    v_mfma_f32_16x16x32_bf16 v[120:123], v[32:35], a[240:243], v[136:139]
    ds_read_b128 v[28:31], v3 offset:18560
    v_fma_f32 v144, v144, v48, v50
    v_mfma_f32_16x16x32_bf16 v[120:123], v[36:39], a[244:247], v[120:123]
    buffer_load_dwordx4 v[248:251], v12, s[68:71], s16 offen offset:1536 nt
    v_mfma_f32_16x16x32_bf16 v[124:127], v[32:35], v[200:203], v[140:143]
    v_exp_f32 v16, v96
    v_mfma_f32_16x16x32_bf16 v[124:127], v[36:39], v[204:207], v[124:127]
    s_waitcnt lgkmcnt(2)
    v_add_f32 v5, v5, v18
    v_add_f32 v5, v5, v19
    v_mfma_f32_16x16x32_bf16 v[176:179], v[40:43], a[200:203], v[176:179]
    ds_read_b128 v[32:35], v2 offset:12544
    v_fma_f32 v148, v148, v49, v51
    v_mfma_f32_16x16x32_bf16 v[176:179], v[44:47], a[204:207], v[176:179]
    buffer_load_dwordx4 v4, s[4:7], s27 offen offset:2048 sc1 lds
    v_mfma_f32_16x16x32_bf16 v[180:183], v[40:43], a[224:227], v[180:183]
    v_exp_f32 v17, v97
    v_mfma_f32_16x16x32_bf16 v[180:183], v[44:47], a[228:231], v[180:183]
    v_cvt_pk_bf16_f32 v161, v18, v19
    v_cvt_f32_i32 v145, v145
    v_mfma_f32_16x16x32_bf16 v[184:187], v[40:43], a[248:251], v[184:187]
    ds_read_b128 v[36:39], v3 offset:12544
    v_add_u32 v1, s3, v1
    v_mfma_f32_16x16x32_bf16 v[184:187], v[44:47], a[252:255], v[184:187]
    buffer_load_dwordx4 v[252:255], v12, s[68:71], s16 offen offset:2304 nt
    v_mfma_f32_16x16x32_bf16 v[188:191], v[40:43], v[208:211], v[188:191]
    v_exp_f32 v18, v98
    v_mfma_f32_16x16x32_bf16 v[188:191], v[44:47], v[212:215], v[188:191]
    s_waitcnt lgkmcnt(2)
    v_add_f32 v5, v5, v16
    v_add_f32 v5, v5, v17
    v_mfma_f32_16x16x32_bf16 v[112:115], v[24:27], a[200:203], v[112:115]
    ds_read_b128 v[40:43], v2 offset:18688
    v_cvt_f32_i32 v149, v149
    v_mfma_f32_16x16x32_bf16 v[112:115], v[28:31], a[204:207], v[112:115]
    v_exp_f32 v19, v99
    v_cvt_pk_bf16_f32 v162, v16, v17
    v_mfma_f32_16x16x32_bf16 v[116:119], v[24:27], a[224:227], v[116:119]
    v_exp_f32 v16, v164
    v_mfma_f32_16x16x32_bf16 v[116:119], v[28:31], a[228:231], v[116:119]
    s_add_u32 s27, s27, 24576
    v_add_f32 v5, v5, v18
    v_add_f32 v5, v5, v19
    v_mfma_f32_16x16x32_bf16 v[120:123], v[24:27], a[248:251], v[120:123]
    s_add_u32 s56, s56, 36864
    ds_read_b128 v[44:47], v3 offset:18688
    v_fma_f32 v145, v145, v48, v50
    v_mfma_f32_16x16x32_bf16 v[120:123], v[28:31], a[252:255], v[120:123]
    s_waitcnt lgkmcnt(2)
    v_exp_f32 v17, v165
    v_mfma_f32_16x16x32_bf16 v[124:127], v[24:27], v[208:211], v[124:127]
    s_waitcnt vmcnt(12)
    v_cvt_pk_bf16_f32 v163, v18, v19
    v_fma_f32 v149, v149, v49, v51
    v_mfma_f32_16x16x32_bf16 v[124:127], v[28:31], v[212:215], v[124:127]
    s_barrier
    s_sub_u32 s58, s56, 147456
    v_mfma_f32_16x16x32_bf16 v[176:179], v[32:35], a[208:211], v[176:179]
    s_min_u32 s56, s56, s58
    ds_read_b128 v[24:27], v1 offset:0
    v_cvt_f32_i32 v146, v146
    v_mfma_f32_16x16x32_bf16 v[176:179], v[36:39], a[212:215], v[176:179]
    v_exp_f32 v18, v166
    v_mfma_f32_16x16x32_bf16 v[180:183], v[32:35], a[232:235], v[180:183]
    v_add_f32 v6, v6, v16
    v_add_f32 v6, v6, v17
    v_mfma_f32_16x16x32_bf16 v[180:183], v[36:39], a[236:239], v[180:183]
    v_exp_f32 v19, v167
    v_mfma_f32_16x16x32_bf16 v[184:187], v[32:35], v[192:195], v[184:187]
    ds_read_b128 v[28:31], v1 offset:12288
    v_cvt_pk_bf16_f32 v164, v16, v17
    v_mfma_f32_16x16x32_bf16 v[184:187], v[36:39], v[196:199], v[184:187]
    v_exp_f32 v16, v100
    v_mfma_f32_16x16x32_bf16 v[188:191], v[32:35], v[216:219], v[188:191]
    v_add_f32 v6, v6, v18
    v_add_f32 v6, v6, v19
    v_mfma_f32_16x16x32_bf16 v[188:191], v[36:39], v[220:223], v[188:191]
    s_waitcnt lgkmcnt(2)
    v_exp_f32 v17, v101
    v_mfma_f32_16x16x32_bf16 v[112:115], v[40:43], a[208:211], v[112:115]
    ds_read_b128 v[32:35], v1 offset:1024
    v_cvt_pk_bf16_f32 v165, v18, v19
    v_mfma_f32_16x16x32_bf16 v[112:115], v[44:47], a[212:215], v[112:115]
    v_exp_f32 v18, v102
    v_mfma_f32_16x16x32_bf16 v[116:119], v[40:43], a[232:235], v[116:119]
    v_add_f32 v6, v6, v16
    v_cvt_f32_i32 v150, v150
    v_mfma_f32_16x16x32_bf16 v[116:119], v[44:47], a[236:239], v[116:119]
    v_add_f32 v6, v6, v17
    v_fma_f32 v146, v146, v48, v50
    v_mfma_f32_16x16x32_bf16 v[120:123], v[40:43], v[192:195], v[120:123]
    ds_read_b128 v[36:39], v1 offset:13312
    v_fma_f32 v150, v150, v49, v51
    v_mfma_f32_16x16x32_bf16 v[120:123], v[44:47], v[196:199], v[120:123]
    v_exp_f32 v19, v103
    v_mfma_f32_16x16x32_bf16 v[124:127], v[40:43], v[216:219], v[124:127]
    v_cvt_pk_bf16_f32 v166, v16, v17
    v_add_f32 v6, v6, v18
    v_mfma_f32_16x16x32_bf16 v[124:127], v[44:47], v[220:223], v[124:127]
    s_waitcnt lgkmcnt(2)
    v_add_f32 v6, v6, v19
    v_cvt_pk_bf16_f32 v167, v18, v19
    v_mfma_f32_16x16x32_bf16 a[0:3], v[64:67], v[24:27], a[0:3]
    ds_read_b128 v[40:43], v1 offset:2048
    v_cvt_f32_i32 v147, v147
    v_mfma_f32_16x16x32_bf16 a[0:3], v[80:83], v[28:31], a[0:3]
    buffer_store_dwordx4 v[224:227], v11, s[4:7], s33 offen offset:0 sc1
    v_mfma_f32_16x16x32_bf16 a[48:51], v[68:71], v[24:27], a[48:51]
    v_exp_f32 v16, v168
    v_mfma_f32_16x16x32_bf16 a[48:51], v[84:87], v[28:31], a[48:51]
    v_exp_f32 v17, v169
    v_mfma_f32_16x16x32_bf16 a[96:99], v[72:75], v[24:27], a[96:99]
    ds_read_b128 v[44:47], v1 offset:14336
    v_xor_b32 v55, 16, v11
    v_mfma_f32_16x16x32_bf16 a[96:99], v[88:91], v[28:31], a[96:99]
    v_exp_f32 v18, v170
    v_mfma_f32_16x16x32_bf16 a[144:147], v[76:79], v[24:27], a[144:147]
    v_add_f32 v7, v7, v16
    v_add_f32 v7, v7, v17
    v_mfma_f32_16x16x32_bf16 a[144:147], v[92:95], v[28:31], a[144:147]
    s_waitcnt lgkmcnt(2)
    v_exp_f32 v19, v171
    v_mfma_f32_16x16x32_bf16 a[4:7], v[64:67], v[32:35], a[4:7]
    ds_read_b128 v[24:27], v1 offset:3072
    v_cvt_f32_i32 v151, v151
    v_mfma_f32_16x16x32_bf16 a[4:7], v[80:83], v[36:39], a[4:7]
    buffer_store_dwordx4 v[228:231], v55, s[4:7], s33 offen offset:768 sc1
    v_mfma_f32_16x16x32_bf16 a[52:55], v[68:71], v[32:35], a[52:55]
    v_cvt_pk_bf16_f32 v168, v16, v17
    v_fma_f32 v147, v147, v48, v50
    v_mfma_f32_16x16x32_bf16 a[52:55], v[84:87], v[36:39], a[52:55]
    v_exp_f32 v16, v104
    v_mfma_f32_16x16x32_bf16 a[100:103], v[72:75], v[32:35], a[100:103]
    ds_read_b128 v[28:31], v1 offset:15360
    v_add_f32 v7, v7, v18
    v_mfma_f32_16x16x32_bf16 a[100:103], v[88:91], v[36:39], a[100:103]
    v_add_f32 v7, v7, v19
    v_xor_b32 v54, 32, v11
    v_mfma_f32_16x16x32_bf16 a[148:151], v[76:79], v[32:35], a[148:151]
    v_exp_f32 v17, v105
    v_mfma_f32_16x16x32_bf16 a[148:151], v[92:95], v[36:39], a[148:151]
    s_waitcnt lgkmcnt(2)
    v_cvt_pk_bf16_f32 v169, v18, v19
    v_fma_f32 v151, v151, v49, v51
    v_mfma_f32_16x16x32_bf16 a[8:11], v[64:67], v[40:43], a[8:11]
    ds_read_b128 v[32:35], v1 offset:4096
    v_lshlrev_b32 v48, 16, v57
    v_mfma_f32_16x16x32_bf16 a[8:11], v[80:83], v[44:47], a[8:11]
    buffer_store_dwordx4 v[232:235], v54, s[4:7], s33 offen offset:1536 sc1
    v_mfma_f32_16x16x32_bf16 a[56:59], v[68:71], v[40:43], a[56:59]
    v_exp_f32 v18, v106
    v_mfma_f32_16x16x32_bf16 a[56:59], v[84:87], v[44:47], a[56:59]
    v_add_f32 v7, v7, v16
    v_add_f32 v7, v7, v17
    v_mfma_f32_16x16x32_bf16 a[104:107], v[72:75], v[40:43], a[104:107]
    ds_read_b128 v[36:39], v1 offset:16384
    v_xor_b32 v55, 48, v11
    v_mfma_f32_16x16x32_bf16 a[104:107], v[88:91], v[44:47], a[104:107]
    v_exp_f32 v19, v107
    v_mfma_f32_16x16x32_bf16 a[152:155], v[76:79], v[40:43], a[152:155]
    v_cvt_pk_bf16_f32 v170, v16, v17
    v_and_b32 v49, s97, v57
    v_mfma_f32_16x16x32_bf16 a[152:155], v[92:95], v[44:47], a[152:155]
    s_waitcnt lgkmcnt(2)
    v_exp_f32 v16, v172
    v_mfma_f32_16x16x32_bf16 a[12:15], v[64:67], v[24:27], a[12:15]
    ds_read_b128 v[40:43], v1 offset:5120
    v_add_f32 v7, v7, v18
    v_mfma_f32_16x16x32_bf16 a[12:15], v[80:83], v[28:31], a[12:15]
    buffer_store_dwordx4 v[236:239], v55, s[4:7], s33 offen offset:2304 sc1
    v_mfma_f32_16x16x32_bf16 a[60:63], v[68:71], v[24:27], a[60:63]
    v_add_f32 v7, v7, v19
    v_lshlrev_b32 v50, 16, v59
    v_mfma_f32_16x16x32_bf16 a[60:63], v[84:87], v[28:31], a[60:63]
    v_exp_f32 v17, v173
    v_mfma_f32_16x16x32_bf16 a[108:111], v[72:75], v[24:27], a[108:111]
    ds_read_b128 v[44:47], v1 offset:17408
    v_cvt_pk_bf16_f32 v171, v18, v19
    v_mfma_f32_16x16x32_bf16 a[108:111], v[88:91], v[28:31], a[108:111]
    v_exp_f32 v18, v174
    v_mfma_f32_16x16x32_bf16 a[156:159], v[76:79], v[24:27], a[156:159]
    s_add_u32 s29, s28, 49152
    v_add_f32 v8, v8, v16
    v_add_f32 v8, v8, v17
    v_mfma_f32_16x16x32_bf16 a[156:159], v[92:95], v[28:31], a[156:159]
    s_waitcnt lgkmcnt(2)
    v_exp_f32 v19, v175
    v_mfma_f32_16x16x32_bf16 a[16:19], v[64:67], v[32:35], a[16:19]
    s_sub_u32 s3, s29, 147456
    ds_read_b128 v[24:27], v1 offset:6144
    v_cvt_pk_bf16_f32 v172, v16, v17
    v_mfma_f32_16x16x32_bf16 a[16:19], v[80:83], v[36:39], a[16:19]
    s_mov_b32 m0, s26
    v_exp_f32 v16, v108
    v_mfma_f32_16x16x32_bf16 a[64:67], v[68:71], v[32:35], a[64:67]
    s_min_u32 s29, s29, s3
    v_and_b32 v51, s97, v59
    v_add_f32 v8, v8, v18
    v_mfma_f32_16x16x32_bf16 a[64:67], v[84:87], v[36:39], a[64:67]
    buffer_load_dwordx4 v4, s[4:7], s32 offen offset:0 sc1 lds
    v_mfma_f32_16x16x32_bf16 a[112:115], v[72:75], v[32:35], a[112:115]
    ds_read_b128 v[28:31], v1 offset:18432
    v_add_f32 v8, v8, v19
    v_mfma_f32_16x16x32_bf16 a[112:115], v[88:91], v[36:39], a[112:115]
    v_exp_f32 v17, v109
    v_mfma_f32_16x16x32_bf16 a[160:163], v[76:79], v[32:35], a[160:163]
    v_cvt_pk_bf16_f32 v173, v18, v19
    v_mul_f32_e64 v50, -v50, v48
    v_mfma_f32_16x16x32_bf16 a[160:163], v[92:95], v[36:39], a[160:163]
    s_waitcnt lgkmcnt(2)
    buffer_load_dwordx4 v4, s[4:7], s32 offen offset:1024 sc1 lds
    v_mfma_f32_16x16x32_bf16 a[20:23], v[64:67], v[40:43], a[20:23]
    s_sub_u32 s3, s29, s28
    ds_read_b128 v[32:35], v1 offset:7168
    v_mul_f32_e64 v51, -v51, v49
    v_mfma_f32_16x16x32_bf16 a[20:23], v[80:83], v[44:47], a[20:23]
    v_exp_f32 v18, v110
    v_mfma_f32_16x16x32_bf16 a[68:71], v[68:71], v[40:43], a[68:71]
    v_add_f32 v8, v8, v16
    v_add_f32 v8, v8, v17
    v_mfma_f32_16x16x32_bf16 a[68:71], v[84:87], v[44:47], a[68:71]
    buffer_load_dwordx4 v4, s[4:7], s32 offen offset:2048 sc1 lds
    v_mfma_f32_16x16x32_bf16 a[116:119], v[72:75], v[40:43], a[116:119]
    ds_read_b128 v[36:39], v1 offset:19456
    v_cvt_f32_i32 v152, v152
    v_mfma_f32_16x16x32_bf16 a[116:119], v[88:91], v[44:47], a[116:119]
    v_exp_f32 v19, v111
    v_mfma_f32_16x16x32_bf16 a[164:167], v[76:79], v[40:43], a[164:167]
    s_mov_b32 s28, s29
    v_cvt_pk_bf16_f32 v174, v16, v17
    v_add_f32 v8, v8, v18
    v_mfma_f32_16x16x32_bf16 a[164:167], v[92:95], v[44:47], a[164:167]
    s_waitcnt lgkmcnt(2)
    v_add_f32 v8, v8, v19
    v_cvt_pk_bf16_f32 v175, v18, v19
    v_mfma_f32_16x16x32_bf16 a[24:27], v[64:67], v[24:27], a[24:27]
    s_add_u32 s32, s32, 24576
    ds_read_b128 v[40:43], v1 offset:8192
    v_cvt_f32_i32 v156, v156
    v_mfma_f32_16x16x32_bf16 a[24:27], v[80:83], v[28:31], a[24:27]
    v_exp_f32 v16, v176
    v_mfma_f32_16x16x32_bf16 a[72:75], v[68:71], v[24:27], a[72:75]
    s_add_u32 s26, s26, 12288
    v_exp_f32 v17, v177
    v_mfma_f32_16x16x32_bf16 a[72:75], v[84:87], v[28:31], a[72:75]
    v_exp_f32 v18, v178
    v_mfma_f32_16x16x32_bf16 a[120:123], v[72:75], v[24:27], a[120:123]
    s_mov_b32 m0, s26
    ds_read_b128 v[44:47], v1 offset:20480
    v_add_f32 v5, v5, v16
    v_mfma_f32_16x16x32_bf16 a[120:123], v[88:91], v[28:31], a[120:123]
    v_add_f32 v5, v5, v17
    v_fma_f32 v152, v152, v48, v50
    v_mfma_f32_16x16x32_bf16 a[168:171], v[76:79], v[24:27], a[168:171]
    v_exp_f32 v19, v179
    v_mfma_f32_16x16x32_bf16 a[168:171], v[92:95], v[28:31], a[168:171]
    s_waitcnt lgkmcnt(2)
    v_cvt_pk_bf16_f32 v176, v16, v17
    v_fma_f32 v156, v156, v49, v51
    v_mfma_f32_16x16x32_bf16 a[28:31], v[64:67], v[32:35], a[28:31]
    ds_read_b128 v[24:27], v1 offset:9216
    v_add_u32 v2, s3, v2
    v_mfma_f32_16x16x32_bf16 a[28:31], v[80:83], v[36:39], a[28:31]
    buffer_load_dwordx4 v4, s[4:7], s32 offen offset:0 sc1 lds
    v_mfma_f32_16x16x32_bf16 a[76:79], v[68:71], v[32:35], a[76:79]
    v_exp_f32 v16, v112
    v_mfma_f32_16x16x32_bf16 a[76:79], v[84:87], v[36:39], a[76:79]
    v_add_f32 v5, v5, v18
    v_add_f32 v5, v5, v19
    v_mfma_f32_16x16x32_bf16 a[124:127], v[72:75], v[32:35], a[124:127]
    ds_read_b128 v[28:31], v1 offset:21504
    v_cvt_f32_i32 v153, v153
    v_mfma_f32_16x16x32_bf16 a[124:127], v[88:91], v[36:39], a[124:127]
    buffer_load_dwordx4 v4, s[4:7], s32 offen offset:1024 sc1 lds
    v_mfma_f32_16x16x32_bf16 a[172:175], v[76:79], v[32:35], a[172:175]
    v_exp_f32 v17, v113
    v_mfma_f32_16x16x32_bf16 a[172:175], v[92:95], v[36:39], a[172:175]
    s_waitcnt lgkmcnt(2)
    v_cvt_pk_bf16_f32 v177, v18, v19
    v_add_u32 v3, s3, v3
    v_mfma_f32_16x16x32_bf16 a[32:35], v[64:67], v[40:43], a[32:35]
    ds_read_b128 v[32:35], v1 offset:10240
    v_cvt_f32_i32 v157, v157
    v_mfma_f32_16x16x32_bf16 a[32:35], v[80:83], v[44:47], a[32:35]
    v_exp_f32 v18, v114
    v_mfma_f32_16x16x32_bf16 a[80:83], v[68:71], v[40:43], a[80:83]
    v_add_f32 v5, v5, v16
    v_add_f32 v5, v5, v17
    v_mfma_f32_16x16x32_bf16 a[80:83], v[84:87], v[44:47], a[80:83]
    buffer_load_dwordx4 v4, s[4:7], s32 offen offset:2048 sc1 lds
    v_mfma_f32_16x16x32_bf16 a[128:131], v[72:75], v[40:43], a[128:131]
    ds_read_b128 v[36:39], v1 offset:22528
    v_mfma_f32_16x16x32_bf16 a[128:131], v[88:91], v[44:47], a[128:131]
    v_exp_f32 v19, v115
    v_mfma_f32_16x16x32_bf16 a[176:179], v[76:79], v[40:43], a[176:179]
    v_cvt_pk_bf16_f32 v178, v16, v17
    v_fma_f32 v153, v153, v48, v50
    v_mfma_f32_16x16x32_bf16 a[176:179], v[92:95], v[44:47], a[176:179]
    s_waitcnt lgkmcnt(2)
    v_exp_f32 v16, v180
    v_mfma_f32_16x16x32_bf16 a[36:39], v[64:67], v[24:27], a[36:39]
    ds_read_b128 v[40:43], v1 offset:11264
    v_add_f32 v5, v5, v18
    v_mfma_f32_16x16x32_bf16 a[36:39], v[80:83], v[28:31], a[36:39]
    v_add_f32 v5, v5, v19
    v_mfma_f32_16x16x32_bf16 a[84:87], v[68:71], v[24:27], a[84:87]
    v_exp_f32 v17, v181
    v_mfma_f32_16x16x32_bf16 a[84:87], v[84:87], v[28:31], a[84:87]
    s_add_u32 s32, s32, 24576
    v_cvt_pk_bf16_f32 v179, v18, v19
    s_add_u32 s26, s26, 36864
    v_mfma_f32_16x16x32_bf16 a[132:135], v[72:75], v[24:27], a[132:135]
    s_sub_u32 s57, s26, 147456
    ds_read_b128 v[44:47], v1 offset:23552
    v_fma_f32 v157, v157, v49, v51
    v_mfma_f32_16x16x32_bf16 a[132:135], v[88:91], v[28:31], a[132:135]
    s_waitcnt lgkmcnt(2)
    v_exp_f32 v18, v182
    v_mfma_f32_16x16x32_bf16 a[180:183], v[76:79], v[24:27], a[180:183]
    s_waitcnt vmcnt(6)
    v_add_f32 v6, v6, v16
    v_add_f32 v6, v6, v17
    v_mfma_f32_16x16x32_bf16 a[180:183], v[92:95], v[28:31], a[180:183]
    s_barrier
    v_cvt_f32_i32 v154, v154
    v_mfma_f32_16x16x32_bf16 a[40:43], v[64:67], v[32:35], a[40:43]
    s_min_u32 s26, s26, s57
    ds_read_b128 v[24:27], v2 offset:0
    v_add_u32 v0, 1, v0
    v_mfma_f32_16x16x32_bf16 a[40:43], v[80:83], v[36:39], a[40:43]
    buffer_store_dword v0, v13, s[20:23], 0 offen offset:32 sc1
    v_mfma_f32_16x16x32_bf16 a[88:91], v[68:71], v[32:35], a[88:91]
    v_exp_f32 v19, v183
    v_mfma_f32_16x16x32_bf16 a[88:91], v[84:87], v[36:39], a[88:91]
    v_cvt_pk_bf16_f32 v180, v16, v17
    v_cvt_f32_i32 v158, v158
    v_mfma_f32_16x16x32_bf16 a[136:139], v[72:75], v[32:35], a[136:139]
    ds_read_b128 v[28:31], v3 offset:0
    v_mfma_f32_16x16x32_bf16 a[136:139], v[88:91], v[36:39], a[136:139]
    v_exp_f32 v16, v116
    v_mfma_f32_16x16x32_bf16 a[184:187], v[76:79], v[32:35], a[184:187]
    v_add_f32 v6, v6, v18
    v_add_f32 v6, v6, v19
    v_mfma_f32_16x16x32_bf16 a[184:187], v[92:95], v[36:39], a[184:187]
    s_waitcnt lgkmcnt(2)
    v_exp_f32 v17, v117
    v_mfma_f32_16x16x32_bf16 a[44:47], v[64:67], v[40:43], a[44:47]
    ds_read_b128 v[32:35], v2 offset:6144
    v_cvt_pk_bf16_f32 v181, v18, v19
    v_mfma_f32_16x16x32_bf16 a[44:47], v[80:83], v[44:47], a[44:47]
    v_exp_f32 v18, v118
    v_mfma_f32_16x16x32_bf16 a[92:95], v[68:71], v[40:43], a[92:95]
    v_add_f32 v6, v6, v16
    v_add_f32 v6, v6, v17
    v_mfma_f32_16x16x32_bf16 a[92:95], v[84:87], v[44:47], a[92:95]
    v_exp_f32 v19, v119
    v_mfma_f32_16x16x32_bf16 a[140:143], v[72:75], v[40:43], a[140:143]
    ds_read_b128 v[36:39], v3 offset:6144
    v_cvt_pk_bf16_f32 v182, v16, v17
    v_mfma_f32_16x16x32_bf16 a[140:143], v[88:91], v[44:47], a[140:143]
    v_add_f32 v6, v6, v18
    v_add_f32 v6, v6, v19
    v_mfma_f32_16x16x32_bf16 a[188:191], v[76:79], v[40:43], a[188:191]
    v_cvt_pk_bf16_f32 v183, v18, v19
    v_mfma_f32_16x16x32_bf16 a[188:191], v[92:95], v[44:47], a[188:191]
    s_waitcnt lgkmcnt(2)
    v_mfma_f32_16x16x32_bf16 v[64:67], v[24:27], a[192:195], v[128:131]
    s_add_u32 s33, s33, 196608
    ds_read_b128 v[40:43], v2 offset:128
    v_fma_f32 v154, v154, v48, v50
    v_mfma_f32_16x16x32_bf16 v[64:67], v[28:31], a[196:199], v[64:67]
    s_mov_b32 m0, s56
    v_exp_f32 v16, v184
    v_mfma_f32_16x16x32_bf16 v[68:71], v[24:27], a[216:219], v[132:135]
    s_add_u32 s34, s34, 196608
    v_exp_f32 v17, v185
    v_mfma_f32_16x16x32_bf16 v[68:71], v[28:31], a[220:223], v[68:71]
    s_add_u32 s36, s36, 1536
    buffer_load_dwordx4 v4, s[4:7], s27 offen offset:0 sc1 lds
    v_mfma_f32_16x16x32_bf16 v[72:75], v[24:27], a[240:243], v[136:139]
    ds_read_b128 v[44:47], v3 offset:128
    v_fma_f32 v158, v158, v49, v51
    v_mfma_f32_16x16x32_bf16 v[72:75], v[28:31], a[244:247], v[72:75]
    v_exp_f32 v18, v186
    v_mfma_f32_16x16x32_bf16 v[76:79], v[24:27], v[200:203], v[140:143]
    v_add_f32 v7, v7, v16
    v_add_f32 v7, v7, v17
    v_mfma_f32_16x16x32_bf16 v[76:79], v[28:31], v[204:207], v[76:79]
    s_waitcnt lgkmcnt(2)
    buffer_load_dwordx2 v[56:57], v10, s[72:75], s36 offen offset:0
    v_mfma_f32_16x16x32_bf16 v[96:99], v[32:35], a[192:195], v[128:131]
    ds_read_b128 v[24:27], v2 offset:6272
    v_cvt_f32_i32 v155, v155
    v_mfma_f32_16x16x32_bf16 v[96:99], v[36:39], a[196:199], v[96:99]
    v_exp_f32 v19, v187
    v_mfma_f32_16x16x32_bf16 v[100:103], v[32:35], a[216:219], v[132:135]
    v_cvt_pk_bf16_f32 v184, v16, v17
    v_cvt_f32_i32 v159, v159
    v_mfma_f32_16x16x32_bf16 v[100:103], v[36:39], a[220:223], v[100:103]
    buffer_load_dwordx4 v4, s[4:7], s27 offen offset:1024 sc1 lds
    v_mfma_f32_16x16x32_bf16 v[104:107], v[32:35], a[240:243], v[136:139]
    ds_read_b128 v[28:31], v3 offset:6272
    v_fma_f32 v155, v155, v48, v50
    v_mfma_f32_16x16x32_bf16 v[104:107], v[36:39], a[244:247], v[104:107]
    v_exp_f32 v16, v120
    v_mfma_f32_16x16x32_bf16 v[108:111], v[32:35], v[200:203], v[140:143]
    v_add_f32 v7, v7, v18
    v_add_f32 v7, v7, v19
    v_mfma_f32_16x16x32_bf16 v[108:111], v[36:39], v[204:207], v[108:111]
    s_waitcnt lgkmcnt(2)
    buffer_load_dwordx2 v[58:59], v10, s[76:79], s36 offen offset:0
    v_mfma_f32_16x16x32_bf16 v[64:67], v[40:43], a[200:203], v[64:67]
    ds_read_b128 v[32:35], v2 offset:256
    v_fma_f32 v159, v159, v49, v51
    v_mfma_f32_16x16x32_bf16 v[64:67], v[44:47], a[204:207], v[64:67]
    v_exp_f32 v17, v121
    v_mfma_f32_16x16x32_bf16 v[68:71], v[40:43], a[224:227], v[68:71]
    v_cvt_pk_bf16_f32 v185, v18, v19
    v_cvt_pk_bf16_f32 v144, v144, v148
    v_mfma_f32_16x16x32_bf16 v[68:71], v[44:47], a[228:231], v[68:71]
    buffer_load_dwordx4 v[224:227], v9, s[64:67], s33 offen offset:0 nt
    v_mfma_f32_16x16x32_bf16 v[72:75], v[40:43], a[248:251], v[72:75]
    ds_read_b128 v[36:39], v3 offset:256
    v_cvt_pk_bf16_f32 v148, v145, v149
    v_mfma_f32_16x16x32_bf16 v[72:75], v[44:47], a[252:255], v[72:75]
    v_exp_f32 v18, v122
    v_mfma_f32_16x16x32_bf16 v[76:79], v[40:43], v[208:211], v[76:79]
    v_add_f32 v7, v7, v16
    v_add_f32 v7, v7, v17
    v_mfma_f32_16x16x32_bf16 v[76:79], v[44:47], v[212:215], v[76:79]
    s_waitcnt lgkmcnt(2)
    buffer_load_dwordx4 v4, s[4:7], s27 offen offset:2048 sc1 lds
    v_mfma_f32_16x16x32_bf16 v[96:99], v[24:27], a[200:203], v[96:99]
    ds_read_b128 v[40:43], v2 offset:6400
    v_cvt_pk_bf16_f32 v145, v152, v156
    v_mfma_f32_16x16x32_bf16 v[96:99], v[28:31], a[204:207], v[96:99]
    v_exp_f32 v19, v123
    v_cvt_pk_bf16_f32 v186, v16, v17
    v_mfma_f32_16x16x32_bf16 v[100:103], v[24:27], a[224:227], v[100:103]
    v_exp_f32 v16, v188
    v_mfma_f32_16x16x32_bf16 v[100:103], v[28:31], a[228:231], v[100:103]
    buffer_load_dwordx4 v[228:231], v9, s[64:67], s33 offen offset:1536 nt
    v_mfma_f32_16x16x32_bf16 v[104:107], v[24:27], a[248:251], v[104:107]
    ds_read_b128 v[44:47], v3 offset:6400
    v_add_f32 v7, v7, v18
    v_mfma_f32_16x16x32_bf16 v[104:107], v[28:31], a[252:255], v[104:107]
    v_add_f32 v7, v7, v19
    v_cvt_pk_bf16_f32 v149, v153, v157
    v_mfma_f32_16x16x32_bf16 v[108:111], v[24:27], v[208:211], v[108:111]
    s_add_u32 s29, s30, 49152
    v_exp_f32 v17, v189
    v_mfma_f32_16x16x32_bf16 v[108:111], v[28:31], v[212:215], v[108:111]
    s_waitcnt lgkmcnt(2)
    buffer_load_dwordx4 v[232:235], v9, s[64:67], s34 offen offset:0 nt
    v_cvt_pk_bf16_f32 v187, v18, v19
    v_mfma_f32_16x16x32_bf16 v[64:67], v[32:35], a[208:211], v[64:67]
    s_sub_u32 s3, s29, 147456
    ds_read_b128 v[24:27], v2 offset:12288
    s_add_u32 s27, s27, 24576
    v_mfma_f32_16x16x32_bf16 v[64:67], v[36:39], a[212:215], v[64:67]
    s_min_u32 s29, s29, s3
    v_exp_f32 v18, v190
    v_mfma_f32_16x16x32_bf16 v[68:71], v[32:35], a[232:235], v[68:71]
    v_add_f32 v8, v8, v16
    v_add_f32 v8, v8, v17
    v_mfma_f32_16x16x32_bf16 v[68:71], v[36:39], a[236:239], v[68:71]
    buffer_load_dwordx4 v[236:239], v9, s[64:67], s34 offen offset:1536 nt
    v_mfma_f32_16x16x32_bf16 v[72:75], v[32:35], v[192:195], v[72:75]
    s_add_u32 s56, s56, 12288
    ds_read_b128 v[28:31], v3 offset:12288
    v_cvt_pk_bf16_f32 v152, v146, v150
    v_mfma_f32_16x16x32_bf16 v[72:75], v[36:39], v[196:199], v[72:75]
    v_exp_f32 v19, v191
    v_cvt_pk_bf16_f32 v188, v16, v17
    v_mfma_f32_16x16x32_bf16 v[76:79], v[32:35], v[216:219], v[76:79]
    v_exp_f32 v16, v124
    v_mfma_f32_16x16x32_bf16 v[76:79], v[36:39], v[220:223], v[76:79]
    s_waitcnt lgkmcnt(2)
    v_add_f32 v8, v8, v18
    v_add_f32 v8, v8, v19
    v_mfma_f32_16x16x32_bf16 v[96:99], v[40:43], a[208:211], v[96:99]
    ds_read_b128 v[32:35], v2 offset:18432
    v_cvt_pk_bf16_f32 v153, v154, v158
    v_mfma_f32_16x16x32_bf16 v[96:99], v[44:47], a[212:215], v[96:99]
    s_sub_u32 s3, s29, s30
    v_exp_f32 v17, v125
    v_mfma_f32_16x16x32_bf16 v[100:103], v[40:43], a[232:235], v[100:103]
    s_mov_b32 m0, s56
    v_cvt_pk_bf16_f32 v189, v18, v19
    v_cvt_pk_bf16_f32 v156, v147, v151
    v_mfma_f32_16x16x32_bf16 v[100:103], v[44:47], a[236:239], v[100:103]
    v_exp_f32 v18, v126
    v_mfma_f32_16x16x32_bf16 v[104:107], v[40:43], v[192:195], v[104:107]
    ds_read_b128 v[36:39], v3 offset:18432
    v_add_f32 v8, v8, v16
    v_mfma_f32_16x16x32_bf16 v[104:107], v[44:47], v[196:199], v[104:107]
    v_add_f32 v8, v8, v17
    v_cvt_pk_bf16_f32 v157, v155, v159
    v_mfma_f32_16x16x32_bf16 v[108:111], v[40:43], v[216:219], v[108:111]
    v_exp_f32 v19, v127
    v_mfma_f32_16x16x32_bf16 v[108:111], v[44:47], v[220:223], v[108:111]
    s_waitcnt lgkmcnt(2)
    v_cvt_pk_bf16_f32 v190, v16, v17
    v_add_f32 v8, v8, v18
    v_mfma_f32_16x16x32_bf16 v[80:83], v[24:27], a[192:195], v[128:131]
    ds_read_b128 v[40:43], v2 offset:12416
    v_add_f32 v8, v8, v19
    v_mfma_f32_16x16x32_bf16 v[80:83], v[28:31], a[196:199], v[80:83]
    s_mov_b32 s30, s29
    v_cvt_pk_bf16_f32 v191, v18, v19
    v_mfma_f32_16x16x32_bf16 v[84:87], v[24:27], a[216:219], v[132:135]
    v_exp_f32 v16, v64
    v_mfma_f32_16x16x32_bf16 v[84:87], v[28:31], a[220:223], v[84:87]
    s_waitcnt vmcnt(20)
    buffer_load_dwordx4 v4, s[4:7], s27 offen offset:0 sc1 lds
    v_mfma_f32_16x16x32_bf16 v[88:91], v[24:27], a[240:243], v[136:139]
    ds_read_b128 v[44:47], v3 offset:12416
    v_lshlrev_b32 v48, 16, v60
    v_mfma_f32_16x16x32_bf16 v[88:91], v[28:31], a[244:247], v[88:91]
    v_exp_f32 v17, v65
    v_mfma_f32_16x16x32_bf16 v[92:95], v[24:27], v[200:203], v[140:143]
    v_exp_f32 v18, v66
    v_mfma_f32_16x16x32_bf16 v[92:95], v[28:31], v[204:207], v[92:95]
    s_waitcnt lgkmcnt(2)
    v_add_f32 v5, v5, v16
    v_add_f32 v5, v5, v17
    v_mfma_f32_16x16x32_bf16 v[112:115], v[32:35], a[192:195], v[128:131]
    ds_read_b128 v[24:27], v2 offset:18560
    v_and_b32 v49, s97, v60
    v_mfma_f32_16x16x32_bf16 v[112:115], v[36:39], a[196:199], v[112:115]
    v_exp_f32 v19, v67
    v_mfma_f32_16x16x32_bf16 v[116:119], v[32:35], a[216:219], v[132:135]
    v_cvt_pk_bf16_f32 v64, v16, v17
    v_lshlrev_b32 v50, 16, v62
    v_mfma_f32_16x16x32_bf16 v[116:119], v[36:39], a[220:223], v[116:119]
    v_exp_f32 v16, v96
    v_mfma_f32_16x16x32_bf16 v[120:123], v[32:35], a[240:243], v[136:139]
    ds_read_b128 v[28:31], v3 offset:18560
    v_add_f32 v5, v5, v18
    v_mfma_f32_16x16x32_bf16 v[120:123], v[36:39], a[244:247], v[120:123]
    v_add_f32 v5, v5, v19
    v_and_b32 v51, s97, v62
    v_mfma_f32_16x16x32_bf16 v[124:127], v[32:35], v[200:203], v[140:143]
    v_exp_f32 v17, v97
    v_mfma_f32_16x16x32_bf16 v[124:127], v[36:39], v[204:207], v[124:127]
    s_waitcnt lgkmcnt(2)
    buffer_load_dwordx4 v4, s[4:7], s27 offen offset:1024 sc1 lds
    v_mfma_f32_16x16x32_bf16 v[80:83], v[40:43], a[200:203], v[80:83]
    ds_read_b128 v[32:35], v2 offset:12544
    v_cvt_pk_bf16_f32 v65, v18, v19
    v_mfma_f32_16x16x32_bf16 v[80:83], v[44:47], a[204:207], v[80:83]
    v_exp_f32 v18, v98
    v_mfma_f32_16x16x32_bf16 v[84:87], v[40:43], a[224:227], v[84:87]
    v_add_f32 v5, v5, v16
    v_add_f32 v5, v5, v17
    v_mfma_f32_16x16x32_bf16 v[84:87], v[44:47], a[228:231], v[84:87]
    v_exp_f32 v19, v99
    v_mfma_f32_16x16x32_bf16 v[88:91], v[40:43], a[248:251], v[88:91]
    ds_read_b128 v[36:39], v3 offset:12544
    v_cvt_pk_bf16_f32 v66, v16, v17
    v_mfma_f32_16x16x32_bf16 v[88:91], v[44:47], a[252:255], v[88:91]
    v_exp_f32 v16, v68
    v_mfma_f32_16x16x32_bf16 v[92:95], v[40:43], v[208:211], v[92:95]
    v_mul_f32_e64 v50, -v50, v48
    v_add_u32 v1, s3, v1
    v_mfma_f32_16x16x32_bf16 v[92:95], v[44:47], v[212:215], v[92:95]
    s_waitcnt lgkmcnt(2)
    v_add_f32 v5, v5, v18
    v_mul_f32_e64 v51, -v51, v49
    v_mfma_f32_16x16x32_bf16 v[112:115], v[24:27], a[200:203], v[112:115]
    ds_read_b128 v[40:43], v2 offset:18688
    v_add_f32 v5, v5, v19
    v_mfma_f32_16x16x32_bf16 v[112:115], v[28:31], a[204:207], v[112:115]
    buffer_load_dwordx4 v4, s[4:7], s27 offen offset:2048 sc1 lds
    v_mfma_f32_16x16x32_bf16 v[116:119], v[24:27], a[224:227], v[116:119]
    v_exp_f32 v17, v69
    v_mfma_f32_16x16x32_bf16 v[116:119], v[28:31], a[228:231], v[116:119]
    v_cvt_pk_bf16_f32 v67, v18, v19
    v_cvt_f32_i32 v240, v240
    v_mfma_f32_16x16x32_bf16 v[120:123], v[24:27], a[248:251], v[120:123]
    ds_read_b128 v[44:47], v3 offset:18688
    v_cvt_f32_i32 v244, v244
    v_mfma_f32_16x16x32_bf16 v[120:123], v[28:31], a[252:255], v[120:123]
    s_waitcnt lgkmcnt(2)
    v_exp_f32 v18, v70
    v_mfma_f32_16x16x32_bf16 v[124:127], v[24:27], v[208:211], v[124:127]
    s_waitcnt vmcnt(13)
    v_add_f32 v6, v6, v16
    v_add_f32 v6, v6, v17
    v_mfma_f32_16x16x32_bf16 v[124:127], v[28:31], v[212:215], v[124:127]
    s_barrier
    v_fma_f32 v240, v240, v48, v50
    v_mfma_f32_16x16x32_bf16 v[80:83], v[32:35], a[208:211], v[80:83]
    ds_read_b128 v[24:27], v1 offset:0
    v_fma_f32 v244, v244, v49, v51
    v_mfma_f32_16x16x32_bf16 v[80:83], v[36:39], a[212:215], v[80:83]
    v_exp_f32 v19, v71
    v_mfma_f32_16x16x32_bf16 v[84:87], v[32:35], a[232:235], v[84:87]
    v_cvt_pk_bf16_f32 v68, v16, v17
    v_mfma_f32_16x16x32_bf16 v[84:87], v[36:39], a[236:239], v[84:87]
    v_exp_f32 v16, v100
    v_mfma_f32_16x16x32_bf16 v[88:91], v[32:35], v[192:195], v[88:91]
    ds_read_b128 v[28:31], v1 offset:12288
    v_add_f32 v6, v6, v18
    v_mfma_f32_16x16x32_bf16 v[88:91], v[36:39], v[196:199], v[88:91]
    v_add_f32 v6, v6, v19
    v_cvt_f32_i32 v241, v241
    v_mfma_f32_16x16x32_bf16 v[92:95], v[32:35], v[216:219], v[92:95]
    v_exp_f32 v17, v101
    v_mfma_f32_16x16x32_bf16 v[92:95], v[36:39], v[220:223], v[92:95]
    s_waitcnt lgkmcnt(2)
    v_cvt_pk_bf16_f32 v69, v18, v19
    v_cvt_f32_i32 v245, v245
    v_mfma_f32_16x16x32_bf16 v[112:115], v[40:43], a[208:211], v[112:115]
    ds_read_b128 v[32:35], v1 offset:1024
    v_mfma_f32_16x16x32_bf16 v[112:115], v[44:47], a[212:215], v[112:115]
    v_exp_f32 v18, v102
    v_mfma_f32_16x16x32_bf16 v[116:119], v[40:43], a[232:235], v[116:119]
    v_add_f32 v6, v6, v16
    v_add_f32 v6, v6, v17
    v_mfma_f32_16x16x32_bf16 v[116:119], v[44:47], a[236:239], v[116:119]
    s_add_u32 s27, s27, 24576
    v_exp_f32 v19, v103
    v_mfma_f32_16x16x32_bf16 v[120:123], v[40:43], v[192:195], v[120:123]
    s_add_u32 s56, s56, 36864
    ds_read_b128 v[36:39], v1 offset:13312
    v_cvt_pk_bf16_f32 v70, v16, v17
    v_mfma_f32_16x16x32_bf16 v[120:123], v[44:47], v[196:199], v[120:123]
    s_sub_u32 s58, s56, 147456
    v_add_f32 v6, v6, v18
    v_add_f32 v6, v6, v19
    v_mfma_f32_16x16x32_bf16 v[124:127], v[40:43], v[216:219], v[124:127]
    s_min_u32 s56, s56, s58
    v_cvt_pk_bf16_f32 v71, v18, v19
    v_mfma_f32_16x16x32_bf16 v[124:127], v[44:47], v[220:223], v[124:127]
    s_waitcnt lgkmcnt(2)
    v_mfma_f32_16x16x32_bf16 a[0:3], v[160:163], v[24:27], a[0:3]
    s_mov_b32 m0, s56
    ds_read_b128 v[40:43], v1 offset:2048
    v_fma_f32 v241, v241, v48, v50
    v_mfma_f32_16x16x32_bf16 a[0:3], v[176:179], v[28:31], a[0:3]
    buffer_load_dwordx4 v4, s[4:7], s27 offen offset:0 sc1 lds
    v_mfma_f32_16x16x32_bf16 a[48:51], v[164:167], v[24:27], a[48:51]
    v_exp_f32 v16, v72
    v_mfma_f32_16x16x32_bf16 a[48:51], v[180:183], v[28:31], a[48:51]
    v_exp_f32 v17, v73
    v_mfma_f32_16x16x32_bf16 a[96:99], v[168:171], v[24:27], a[96:99]
    ds_read_b128 v[44:47], v1 offset:14336
    v_fma_f32 v245, v245, v49, v51
    v_mfma_f32_16x16x32_bf16 a[96:99], v[184:187], v[28:31], a[96:99]
    v_exp_f32 v18, v74
    v_mfma_f32_16x16x32_bf16 a[144:147], v[172:175], v[24:27], a[144:147]
    v_add_f32 v7, v7, v16
    v_add_f32 v7, v7, v17
    v_mfma_f32_16x16x32_bf16 a[144:147], v[188:191], v[28:31], a[144:147]
    s_waitcnt lgkmcnt(2)
    v_exp_f32 v19, v75
    v_mfma_f32_16x16x32_bf16 a[4:7], v[160:163], v[32:35], a[4:7]
    ds_read_b128 v[24:27], v1 offset:3072
    v_cvt_f32_i32 v242, v242
    v_mfma_f32_16x16x32_bf16 a[4:7], v[176:179], v[36:39], a[4:7]
    buffer_load_dwordx4 v4, s[4:7], s27 offen offset:1024 sc1 lds
    v_mfma_f32_16x16x32_bf16 a[52:55], v[164:167], v[32:35], a[52:55]
    v_cvt_pk_bf16_f32 v72, v16, v17
    v_cvt_f32_i32 v246, v246
    v_mfma_f32_16x16x32_bf16 a[52:55], v[180:183], v[36:39], a[52:55]
    v_exp_f32 v16, v104
    v_mfma_f32_16x16x32_bf16 a[100:103], v[168:171], v[32:35], a[100:103]
    ds_read_b128 v[28:31], v1 offset:15360
    v_add_f32 v7, v7, v18
    v_mfma_f32_16x16x32_bf16 a[100:103], v[184:187], v[36:39], a[100:103]
    v_add_f32 v7, v7, v19
    v_bfe_u32 v53, v4, 4, 6
    v_mfma_f32_16x16x32_bf16 a[148:151], v[172:175], v[32:35], a[148:151]
    v_exp_f32 v17, v105
    v_mfma_f32_16x16x32_bf16 a[148:151], v[188:191], v[36:39], a[148:151]
    s_waitcnt lgkmcnt(2)
    v_fma_f32 v242, v242, v48, v50
    v_cvt_pk_bf16_f32 v73, v18, v19
    v_mfma_f32_16x16x32_bf16 a[8:11], v[160:163], v[40:43], a[8:11]
    ds_read_b128 v[32:35], v1 offset:4096
    v_fma_f32 v246, v246, v49, v51
    v_mfma_f32_16x16x32_bf16 a[8:11], v[176:179], v[44:47], a[8:11]
    v_exp_f32 v18, v106
    v_mfma_f32_16x16x32_bf16 a[56:59], v[164:167], v[40:43], a[56:59]
    v_lshlrev_b32 v53, 2, v53
    v_add_f32 v7, v7, v16
    v_mfma_f32_16x16x32_bf16 a[56:59], v[180:183], v[44:47], a[56:59]
    buffer_load_dword v52, v53, s[20:23], s44 offen sc1
    v_mfma_f32_16x16x32_bf16 a[104:107], v[168:171], v[40:43], a[104:107]
    ds_read_b128 v[36:39], v1 offset:16384
    v_add_f32 v7, v7, v17
    v_mfma_f32_16x16x32_bf16 a[104:107], v[184:187], v[44:47], a[104:107]
    v_exp_f32 v19, v107
    v_mfma_f32_16x16x32_bf16 a[152:155], v[172:175], v[40:43], a[152:155]
    v_cvt_f32_i32 v243, v243
    v_cvt_pk_bf16_f32 v74, v16, v17
    v_mfma_f32_16x16x32_bf16 a[152:155], v[188:191], v[44:47], a[152:155]
    s_waitcnt lgkmcnt(2)
    buffer_load_dwordx4 v4, s[4:7], s27 offen offset:2048 sc1 lds
    v_mfma_f32_16x16x32_bf16 a[12:15], v[160:163], v[24:27], a[12:15]
    ds_read_b128 v[40:43], v1 offset:5120
    v_cvt_f32_i32 v247, v247
    v_mfma_f32_16x16x32_bf16 a[12:15], v[176:179], v[28:31], a[12:15]
    s_add_u32 s27, s27, 24576
    v_exp_f32 v16, v76
    v_mfma_f32_16x16x32_bf16 a[60:63], v[164:167], v[24:27], a[60:63]
    v_add_f32 v7, v7, v18
    v_add_f32 v7, v7, v19
    v_mfma_f32_16x16x32_bf16 a[60:63], v[180:183], v[28:31], a[60:63]
    v_fma_f32 v243, v243, v48, v50
    v_fma_f32 v247, v247, v49, v51
    v_mfma_f32_16x16x32_bf16 a[108:111], v[168:171], v[24:27], a[108:111]
    ds_read_b128 v[44:47], v1 offset:17408
    v_lshlrev_b32 v48, 16, v61
    v_mfma_f32_16x16x32_bf16 a[108:111], v[184:187], v[28:31], a[108:111]
    v_exp_f32 v17, v77
    v_mfma_f32_16x16x32_bf16 a[156:159], v[172:175], v[24:27], a[156:159]
    s_add_u32 s29, s28, 49152
    v_cvt_pk_bf16_f32 v75, v18, v19
    v_and_b32 v49, s97, v61
    v_mfma_f32_16x16x32_bf16 a[156:159], v[188:191], v[28:31], a[156:159]
    s_waitcnt lgkmcnt(2)
    v_exp_f32 v18, v78
    v_mfma_f32_16x16x32_bf16 a[16:19], v[160:163], v[32:35], a[16:19]
    s_sub_u32 s3, s29, 147456
    ds_read_b128 v[24:27], v1 offset:6144
    v_add_f32 v8, v8, v16
    v_mfma_f32_16x16x32_bf16 a[16:19], v[176:179], v[36:39], a[16:19]
    s_add_u32 s56, s56, 12288
    v_add_f32 v8, v8, v17
    v_lshlrev_b32 v50, 16, v63
    v_mfma_f32_16x16x32_bf16 a[64:67], v[164:167], v[32:35], a[64:67]
    s_min_u32 s29, s29, s3
    v_exp_f32 v19, v79
    v_mfma_f32_16x16x32_bf16 a[64:67], v[180:183], v[36:39], a[64:67]
    s_mov_b32 m0, s56
    v_cvt_pk_bf16_f32 v76, v16, v17
    v_and_b32 v51, s97, v63
    v_mfma_f32_16x16x32_bf16 a[112:115], v[168:171], v[32:35], a[112:115]
    ds_read_b128 v[28:31], v1 offset:18432
    v_mul_f32_e64 v50, -v50, v48
    v_mfma_f32_16x16x32_bf16 a[112:115], v[184:187], v[36:39], a[112:115]
    v_exp_f32 v16, v108
    v_mfma_f32_16x16x32_bf16 a[160:163], v[172:175], v[32:35], a[160:163]
    v_add_f32 v8, v8, v18
    v_add_f32 v8, v8, v19
    v_mfma_f32_16x16x32_bf16 a[160:163], v[188:191], v[36:39], a[160:163]
    s_waitcnt lgkmcnt(2)
    v_exp_f32 v17, v109
    v_mfma_f32_16x16x32_bf16 a[20:23], v[160:163], v[40:43], a[20:23]
    s_sub_u32 s3, s29, s28
    ds_read_b128 v[32:35], v1 offset:7168
    v_cvt_pk_bf16_f32 v77, v18, v19
    v_mfma_f32_16x16x32_bf16 a[20:23], v[176:179], v[44:47], a[20:23]
    v_exp_f32 v18, v110
    v_mfma_f32_16x16x32_bf16 a[68:71], v[164:167], v[40:43], a[68:71]
    v_mul_f32_e64 v51, -v51, v49
    v_add_f32 v8, v8, v16
    v_mfma_f32_16x16x32_bf16 a[68:71], v[180:183], v[44:47], a[68:71]
    buffer_load_dwordx4 v4, s[4:7], s27 offen offset:0 sc1 lds
    v_mfma_f32_16x16x32_bf16 a[116:119], v[168:171], v[40:43], a[116:119]
    ds_read_b128 v[36:39], v1 offset:19456
    v_add_f32 v8, v8, v17
    v_mfma_f32_16x16x32_bf16 a[116:119], v[184:187], v[44:47], a[116:119]
    v_exp_f32 v19, v111
    v_mfma_f32_16x16x32_bf16 a[164:167], v[172:175], v[40:43], a[164:167]
    s_mov_b32 s28, s29
    v_cvt_f32_i32 v248, v248
    v_cvt_pk_bf16_f32 v78, v16, v17
    v_mfma_f32_16x16x32_bf16 a[164:167], v[188:191], v[44:47], a[164:167]
    s_waitcnt lgkmcnt(2)
    v_add_f32 v8, v8, v18
    v_cvt_f32_i32 v252, v252
    v_mfma_f32_16x16x32_bf16 a[24:27], v[160:163], v[24:27], a[24:27]
    ds_read_b128 v[40:43], v1 offset:8192
    v_add_f32 v8, v8, v19
    v_mfma_f32_16x16x32_bf16 a[24:27], v[176:179], v[28:31], a[24:27]
    v_cvt_pk_bf16_f32 v79, v18, v19
    v_fma_f32 v248, v248, v48, v50
    v_mfma_f32_16x16x32_bf16 a[72:75], v[164:167], v[24:27], a[72:75]
    v_exp_f32 v16, v80
    v_mfma_f32_16x16x32_bf16 a[72:75], v[180:183], v[28:31], a[72:75]
    buffer_load_dwordx4 v4, s[4:7], s27 offen offset:1024 sc1 lds
    v_mfma_f32_16x16x32_bf16 a[120:123], v[168:171], v[24:27], a[120:123]
    ds_read_b128 v[44:47], v1 offset:20480
    v_fma_f32 v252, v252, v49, v51
    v_mfma_f32_16x16x32_bf16 a[120:123], v[184:187], v[28:31], a[120:123]
    v_exp_f32 v17, v81
    v_mfma_f32_16x16x32_bf16 a[168:171], v[172:175], v[24:27], a[168:171]
    v_exp_f32 v18, v82
    v_mfma_f32_16x16x32_bf16 a[168:171], v[188:191], v[28:31], a[168:171]
    s_waitcnt lgkmcnt(2)
    v_cvt_f32_i32 v249, v249
    v_add_f32 v5, v5, v16
    v_mfma_f32_16x16x32_bf16 a[28:31], v[160:163], v[32:35], a[28:31]
    ds_read_b128 v[24:27], v1 offset:9216
    v_add_f32 v5, v5, v17
    v_mfma_f32_16x16x32_bf16 a[28:31], v[176:179], v[36:39], a[28:31]
    v_exp_f32 v19, v83
    v_mfma_f32_16x16x32_bf16 a[76:79], v[164:167], v[32:35], a[76:79]
    v_cvt_f32_i32 v253, v253
    v_cvt_pk_bf16_f32 v80, v16, v17
    v_mfma_f32_16x16x32_bf16 a[76:79], v[180:183], v[36:39], a[76:79]
    v_exp_f32 v16, v112
    v_mfma_f32_16x16x32_bf16 a[124:127], v[168:171], v[32:35], a[124:127]
    ds_read_b128 v[28:31], v1 offset:21504
    v_fma_f32 v249, v249, v48, v50
    v_mfma_f32_16x16x32_bf16 a[124:127], v[184:187], v[36:39], a[124:127]
    buffer_load_dwordx4 v4, s[4:7], s27 offen offset:2048 sc1 lds
    v_mfma_f32_16x16x32_bf16 a[172:175], v[172:175], v[32:35], a[172:175]
    v_add_f32 v5, v5, v18
    v_add_f32 v5, v5, v19
    v_mfma_f32_16x16x32_bf16 a[172:175], v[188:191], v[36:39], a[172:175]
    s_waitcnt lgkmcnt(2)
    v_exp_f32 v17, v113
    v_mfma_f32_16x16x32_bf16 a[32:35], v[160:163], v[40:43], a[32:35]
    ds_read_b128 v[32:35], v1 offset:10240
    v_fma_f32 v253, v253, v49, v51
    v_mfma_f32_16x16x32_bf16 a[32:35], v[176:179], v[44:47], a[32:35]
    v_cvt_pk_bf16_f32 v81, v18, v19
    v_cvt_f32_i32 v250, v250
    v_mfma_f32_16x16x32_bf16 a[80:83], v[164:167], v[40:43], a[80:83]
    v_exp_f32 v18, v114
    v_mfma_f32_16x16x32_bf16 a[80:83], v[180:183], v[44:47], a[80:83]
    v_cvt_f32_i32 v254, v254
    v_add_f32 v5, v5, v16
    v_mfma_f32_16x16x32_bf16 a[128:131], v[168:171], v[40:43], a[128:131]
    ds_read_b128 v[36:39], v1 offset:22528
    v_add_f32 v5, v5, v17
    v_mfma_f32_16x16x32_bf16 a[128:131], v[184:187], v[44:47], a[128:131]
    v_exp_f32 v19, v115
    v_mfma_f32_16x16x32_bf16 a[176:179], v[172:175], v[40:43], a[176:179]
    v_fma_f32 v250, v250, v48, v50
    v_cvt_pk_bf16_f32 v82, v16, v17
    v_mfma_f32_16x16x32_bf16 a[176:179], v[188:191], v[44:47], a[176:179]
    s_waitcnt lgkmcnt(2)
    v_exp_f32 v16, v84
    v_mfma_f32_16x16x32_bf16 a[36:39], v[160:163], v[24:27], a[36:39]
    ds_read_b128 v[40:43], v1 offset:11264
    v_fma_f32 v254, v254, v49, v51
    v_mfma_f32_16x16x32_bf16 a[36:39], v[176:179], v[28:31], a[36:39]
    v_add_u32 v2, s3, v2
    v_add_f32 v5, v5, v18
    v_mfma_f32_16x16x32_bf16 a[84:87], v[164:167], v[24:27], a[84:87]
    v_add_f32 v5, v5, v19
    v_cvt_f32_i32 v251, v251
    v_mfma_f32_16x16x32_bf16 a[84:87], v[180:183], v[28:31], a[84:87]
    s_add_u32 s27, s27, 24576
    v_exp_f32 v17, v85
    v_mfma_f32_16x16x32_bf16 a[132:135], v[168:171], v[24:27], a[132:135]
    s_add_u32 s56, s56, 36864
    ds_read_b128 v[44:47], v1 offset:23552
    v_add_u32 v3, s3, v3
    v_mfma_f32_16x16x32_bf16 a[132:135], v[184:187], v[28:31], a[132:135]
    s_sub_u32 s58, s56, 147456
    v_cvt_pk_bf16_f32 v83, v18, v19
    v_cvt_f32_i32 v255, v255
    v_mfma_f32_16x16x32_bf16 a[180:183], v[172:175], v[24:27], a[180:183]
    v_exp_f32 v18, v86
    v_mfma_f32_16x16x32_bf16 a[180:183], v[188:191], v[28:31], a[180:183]
    s_waitcnt lgkmcnt(2)
    v_fma_f32 v251, v251, v48, v50
    v_add_f32 v6, v6, v16
    v_mfma_f32_16x16x32_bf16 a[40:43], v[160:163], v[32:35], a[40:43]
    s_min_u32 s56, s56, s58
    ds_read_b128 v[24:27], v2 offset:0
    v_add_f32 v6, v6, v17
    v_mfma_f32_16x16x32_bf16 a[40:43], v[176:179], v[36:39], a[40:43]
    buffer_load_dword v15, v4, s[88:91], s93 offen
    v_mfma_f32_16x16x32_bf16 a[88:91], v[164:167], v[32:35], a[88:91]
    v_exp_f32 v19, v87
    v_mfma_f32_16x16x32_bf16 a[88:91], v[180:183], v[36:39], a[88:91]
    v_cvt_pk_bf16_f32 v84, v16, v17
    v_fma_f32 v255, v255, v49, v51
    v_mfma_f32_16x16x32_bf16 a[136:139], v[168:171], v[32:35], a[136:139]
    ds_read_b128 v[28:31], v3 offset:0
    v_cvt_pk_bf16_f32 v146, v240, v244
    v_mfma_f32_16x16x32_bf16 a[136:139], v[184:187], v[36:39], a[136:139]
    v_exp_f32 v16, v116
    v_mfma_f32_16x16x32_bf16 a[184:187], v[172:175], v[32:35], a[184:187]
    v_add_f32 v6, v6, v18
    v_add_f32 v6, v6, v19
    v_mfma_f32_16x16x32_bf16 a[184:187], v[188:191], v[36:39], a[184:187]
    s_waitcnt lgkmcnt(2)
    v_exp_f32 v17, v117
    v_mfma_f32_16x16x32_bf16 a[44:47], v[160:163], v[40:43], a[44:47]
    ds_read_b128 v[32:35], v2 offset:6144
    v_cvt_pk_bf16_f32 v150, v241, v245
    v_mfma_f32_16x16x32_bf16 a[44:47], v[176:179], v[44:47], a[44:47]
    v_cvt_pk_bf16_f32 v85, v18, v19
    v_cvt_pk_bf16_f32 v147, v248, v252
    v_mfma_f32_16x16x32_bf16 a[92:95], v[164:167], v[40:43], a[92:95]
    v_exp_f32 v18, v118
    v_mfma_f32_16x16x32_bf16 a[92:95], v[180:183], v[44:47], a[92:95]
    v_cvt_pk_bf16_f32 v151, v249, v253
    v_add_f32 v6, v6, v16
    v_mfma_f32_16x16x32_bf16 a[140:143], v[168:171], v[40:43], a[140:143]
    ds_read_b128 v[36:39], v3 offset:6144
    v_add_f32 v6, v6, v17
    v_mfma_f32_16x16x32_bf16 a[140:143], v[184:187], v[44:47], a[140:143]
    v_exp_f32 v19, v119
    v_mfma_f32_16x16x32_bf16 a[188:191], v[172:175], v[40:43], a[188:191]
    v_cvt_pk_bf16_f32 v154, v242, v246
    v_cvt_pk_bf16_f32 v86, v16, v17
    v_mfma_f32_16x16x32_bf16 a[188:191], v[188:191], v[44:47], a[188:191]
    s_waitcnt lgkmcnt(2)
    v_add_f32 v6, v6, v18
    v_cvt_pk_bf16_f32 v155, v250, v254
    v_add_f32 v6, v6, v19
    v_cvt_pk_bf16_f32 v158, v243, v247
    v_cvt_pk_bf16_f32 v87, v18, v19
    v_cvt_pk_bf16_f32 v159, v251, v255
L_join:
    v_mfma_f32_16x16x32_bf16 v[160:163], v[24:27], a[192:195], v[128:131]
    s_waitcnt vmcnt(7)
    ds_read_b128 v[40:43], v2 offset:128
    v_lshlrev_b32 v48, 16, v56
    v_mfma_f32_16x16x32_bf16 v[160:163], v[28:31], a[196:199], v[160:163]
    s_waitcnt vmcnt(5)
    v_subrev_u32 v52, s92, v52
    v_cmp_lt_u32 vcc, 15, v52
    v_mfma_f32_16x16x32_bf16 v[164:167], v[24:27], a[216:219], v[132:135]
    v_exp_f32 v16, v88
    v_mfma_f32_16x16x32_bf16 v[164:167], v[28:31], a[220:223], v[164:167]
    v_exp_f32 v17, v89
    v_mfma_f32_16x16x32_bf16 v[168:171], v[24:27], a[240:243], v[136:139]
    s_and_b32 s59, vcc_lo, 0xff
    ds_read_b128 v[44:47], v3 offset:128
    v_and_b32 v49, s97, v56
    v_mfma_f32_16x16x32_bf16 v[168:171], v[28:31], a[244:247], v[168:171]
    s_cbranch_scc1 L_pollslow1
L_pollok1:
    v_mfma_f32_16x16x32_bf16 v[172:175], v[24:27], v[200:203], v[140:143]
    s_add_u32 s92, s92, 1
    v_exp_f32 v18, v90
    v_mfma_f32_16x16x32_bf16 v[172:175], v[28:31], v[204:207], v[172:175]
    s_waitcnt lgkmcnt(2)
    v_add_f32 v7, v7, v16
    v_add_f32 v7, v7, v17
    v_mfma_f32_16x16x32_bf16 v[96:99], v[32:35], a[192:195], v[128:131]
    ds_read_b128 v[24:27], v2 offset:6272
    v_lshlrev_b32 v50, 16, v58
    v_mfma_f32_16x16x32_bf16 v[96:99], v[36:39], a[196:199], v[96:99]
    buffer_store_dwordx4 v[144:147], v20, s[4:7], s35 offen offset:0 sc1
    v_mfma_f32_16x16x32_bf16 v[100:103], v[32:35], a[216:219], v[132:135]
    v_exp_f32 v19, v91
    v_mfma_f32_16x16x32_bf16 v[100:103], v[36:39], a[220:223], v[100:103]
    v_cvt_pk_bf16_f32 v88, v16, v17
    v_mfma_f32_16x16x32_bf16 v[104:107], v[32:35], a[240:243], v[136:139]
    ds_read_b128 v[28:31], v3 offset:6272
    v_mfma_f32_16x16x32_bf16 v[104:107], v[36:39], a[244:247], v[104:107]
    v_exp_f32 v16, v120
    v_mfma_f32_16x16x32_bf16 v[108:111], v[32:35], v[200:203], v[140:143]
    v_add_f32 v7, v7, v18
    v_add_f32 v7, v7, v19
    v_mfma_f32_16x16x32_bf16 v[108:111], v[36:39], v[204:207], v[108:111]
    s_waitcnt lgkmcnt(2)
    v_exp_f32 v17, v121
    v_mfma_f32_16x16x32_bf16 v[160:163], v[40:43], a[200:203], v[160:163]
    ds_read_b128 v[32:35], v2 offset:256
    v_cvt_pk_bf16_f32 v89, v18, v19
    v_mfma_f32_16x16x32_bf16 v[160:163], v[44:47], a[204:207], v[160:163]
    buffer_store_dwordx4 v[148:151], v20, s[4:7], s35 offen offset:3072 sc1
    v_mfma_f32_16x16x32_bf16 v[164:167], v[40:43], a[224:227], v[164:167]
    v_exp_f32 v18, v122
    v_mfma_f32_16x16x32_bf16 v[164:167], v[44:47], a[228:231], v[164:167]
    v_add_f32 v7, v7, v16
    v_add_f32 v7, v7, v17
    v_mfma_f32_16x16x32_bf16 v[168:171], v[40:43], a[248:251], v[168:171]
    ds_read_b128 v[36:39], v3 offset:256
    v_and_b32 v51, s97, v58
    v_mfma_f32_16x16x32_bf16 v[168:171], v[44:47], a[252:255], v[168:171]
    v_exp_f32 v19, v123
    v_mfma_f32_16x16x32_bf16 v[172:175], v[40:43], v[208:211], v[172:175]
    v_cvt_pk_bf16_f32 v90, v16, v17
    v_mul_f32 v48, s38, v48
    v_mfma_f32_16x16x32_bf16 v[172:175], v[44:47], v[212:215], v[172:175]
    s_waitcnt lgkmcnt(2)
    v_exp_f32 v16, v92
    v_mfma_f32_16x16x32_bf16 v[96:99], v[24:27], a[200:203], v[96:99]
    ds_read_b128 v[40:43], v2 offset:6400
    v_add_f32 v7, v7, v18
    v_mfma_f32_16x16x32_bf16 v[96:99], v[28:31], a[204:207], v[96:99]
    buffer_store_dwordx4 v[152:155], v20, s[4:7], s17 offen offset:0 sc1
    v_mfma_f32_16x16x32_bf16 v[100:103], v[24:27], a[224:227], v[100:103]
    v_add_f32 v7, v7, v19
    v_mul_f32 v49, s38, v49
    v_mfma_f32_16x16x32_bf16 v[100:103], v[28:31], a[228:231], v[100:103]
    v_exp_f32 v17, v93
    v_mfma_f32_16x16x32_bf16 v[104:107], v[24:27], a[248:251], v[104:107]
    ds_read_b128 v[44:47], v3 offset:6400
    v_cvt_pk_bf16_f32 v91, v18, v19
    v_mfma_f32_16x16x32_bf16 v[104:107], v[28:31], a[252:255], v[104:107]
    v_exp_f32 v18, v94
    v_mfma_f32_16x16x32_bf16 v[108:111], v[24:27], v[208:211], v[108:111]
    s_add_u32 s29, s30, 49152
    v_add_f32 v8, v8, v16
    v_add_f32 v8, v8, v17
    v_mfma_f32_16x16x32_bf16 v[108:111], v[28:31], v[212:215], v[108:111]
    s_waitcnt lgkmcnt(2)
    v_exp_f32 v19, v95
    v_mfma_f32_16x16x32_bf16 v[160:163], v[32:35], a[208:211], v[160:163]
    s_sub_u32 s3, s29, 147456
    ds_read_b128 v[24:27], v2 offset:12288
    v_cvt_pk_bf16_f32 v92, v16, v17
    v_mfma_f32_16x16x32_bf16 v[160:163], v[36:39], a[212:215], v[160:163]
    buffer_store_dwordx4 v[156:159], v20, s[4:7], s17 offen offset:3072 sc1
    v_mfma_f32_16x16x32_bf16 v[164:167], v[32:35], a[232:235], v[164:167]
    s_min_u32 s29, s29, s3
    v_exp_f32 v16, v124
    v_mfma_f32_16x16x32_bf16 v[164:167], v[36:39], a[236:239], v[164:167]
    v_add_f32 v8, v8, v18
    v_add_f32 v8, v8, v19
    v_mfma_f32_16x16x32_bf16 v[168:171], v[32:35], v[192:195], v[168:171]
    ds_read_b128 v[28:31], v3 offset:12288
    v_mul_f32_e64 v50, -v50, v48
    v_mfma_f32_16x16x32_bf16 v[168:171], v[36:39], v[196:199], v[168:171]
    v_exp_f32 v17, v125
    v_mfma_f32_16x16x32_bf16 v[172:175], v[32:35], v[216:219], v[172:175]
    v_cvt_pk_bf16_f32 v93, v18, v19
    v_mul_f32_e64 v51, -v51, v49
    v_mfma_f32_16x16x32_bf16 v[172:175], v[36:39], v[220:223], v[172:175]
    s_waitcnt lgkmcnt(2)
    v_exp_f32 v18, v126
    v_mfma_f32_16x16x32_bf16 v[96:99], v[40:43], a[208:211], v[96:99]
    ds_read_b128 v[32:35], v2 offset:18432
    v_add_f32 v8, v8, v16
    v_mfma_f32_16x16x32_bf16 v[96:99], v[44:47], a[212:215], v[96:99]
    s_mov_b32 m0, s26
    v_add_f32 v8, v8, v17
    s_sub_u32 s3, s29, s30
    v_mfma_f32_16x16x32_bf16 v[100:103], v[40:43], a[232:235], v[100:103]
    v_exp_f32 v19, v127
    v_mfma_f32_16x16x32_bf16 v[100:103], v[44:47], a[236:239], v[100:103]
    buffer_load_dwordx4 v4, s[4:7], s32 offen offset:0 sc1 lds
    v_mfma_f32_16x16x32_bf16 v[104:107], v[40:43], v[192:195], v[104:107]
    ds_read_b128 v[36:39], v3 offset:18432
    v_cvt_pk_bf16_f32 v94, v16, v17
    v_mfma_f32_16x16x32_bf16 v[104:107], v[44:47], v[196:199], v[104:107]
    v_add_f32 v8, v8, v18
    v_add_f32 v8, v8, v19
    v_mfma_f32_16x16x32_bf16 v[108:111], v[40:43], v[216:219], v[108:111]
    v_cvt_pk_bf16_f32 v95, v18, v19
    v_cvt_f32_i32 v224, v224
    v_mfma_f32_16x16x32_bf16 v[108:111], v[44:47], v[220:223], v[108:111]
    s_waitcnt lgkmcnt(2)
    buffer_load_dwordx4 v4, s[4:7], s32 offen offset:1024 sc1 lds
    v_mfma_f32_16x16x32_bf16 v[176:179], v[24:27], a[192:195], v[128:131]
    ds_read_b128 v[40:43], v2 offset:12416
    v_cvt_f32_i32 v225, v225
    v_mfma_f32_16x16x32_bf16 v[176:179], v[28:31], a[196:199], v[176:179]
    s_mov_b32 s30, s29
    v_exp_f32 v16, v160
    v_mfma_f32_16x16x32_bf16 v[180:183], v[24:27], a[216:219], v[132:135]
    v_exp_f32 v17, v161
    v_mfma_f32_16x16x32_bf16 v[180:183], v[28:31], a[220:223], v[180:183]
    buffer_load_dwordx4 v4, s[4:7], s32 offen offset:2048 sc1 lds
    v_mfma_f32_16x16x32_bf16 v[184:187], v[24:27], a[240:243], v[136:139]
    s_add_u32 s32, s32, 24576
    ds_read_b128 v[44:47], v3 offset:12416
    v_mfma_f32_16x16x32_bf16 v[184:187], v[28:31], a[244:247], v[184:187]
    v_exp_f32 v18, v162
    v_mfma_f32_16x16x32_bf16 v[188:191], v[24:27], v[200:203], v[140:143]
    s_add_u32 s26, s26, 12288
    v_add_f32 v5, v5, v16
    v_add_f32 v5, v5, v17
    v_mfma_f32_16x16x32_bf16 v[188:191], v[28:31], v[204:207], v[188:191]
    s_waitcnt lgkmcnt(2)
    v_exp_f32 v19, v163
    v_mfma_f32_16x16x32_bf16 v[112:115], v[32:35], a[192:195], v[128:131]
    s_mov_b32 m0, s26
    ds_read_b128 v[24:27], v2 offset:18560
    v_cvt_pk_bf16_f32 v160, v16, v17
    v_mfma_f32_16x16x32_bf16 v[112:115], v[36:39], a[196:199], v[112:115]
    v_exp_f32 v16, v96
    v_mfma_f32_16x16x32_bf16 v[116:119], v[32:35], a[216:219], v[132:135]
    v_add_f32 v5, v5, v18
    v_fma_f32 v224, v224, v48, v50
    v_mfma_f32_16x16x32_bf16 v[116:119], v[36:39], a[220:223], v[116:119]
    v_add_f32 v5, v5, v19
    v_fma_f32 v225, v225, v49, v51
    v_mfma_f32_16x16x32_bf16 v[120:123], v[32:35], a[240:243], v[136:139]
    ds_read_b128 v[28:31], v3 offset:18560
    v_add_u32 v1, s3, v1
    v_mfma_f32_16x16x32_bf16 v[120:123], v[36:39], a[244:247], v[120:123]
    buffer_load_dwordx4 v4, s[4:7], s32 offen offset:0 sc1 lds
    v_mfma_f32_16x16x32_bf16 v[124:127], v[32:35], v[200:203], v[140:143]
    v_exp_f32 v17, v97
    v_mfma_f32_16x16x32_bf16 v[124:127], v[36:39], v[204:207], v[124:127]
    s_waitcnt lgkmcnt(2)
    v_cvt_pk_bf16_f32 v161, v18, v19
    v_mfma_f32_16x16x32_bf16 v[176:179], v[40:43], a[200:203], v[176:179]
    ds_read_b128 v[32:35], v2 offset:12544
    v_cvt_pk_bf16_f32 v224, v224, v225
    v_mfma_f32_16x16x32_bf16 v[176:179], v[44:47], a[204:207], v[176:179]
    buffer_load_dwordx4 v4, s[4:7], s32 offen offset:1024 sc1 lds
    v_mfma_f32_16x16x32_bf16 v[180:183], v[40:43], a[224:227], v[180:183]
    v_exp_f32 v18, v98
    v_mfma_f32_16x16x32_bf16 v[180:183], v[44:47], a[228:231], v[180:183]
    v_add_f32 v5, v5, v16
    v_add_f32 v5, v5, v17
    v_mfma_f32_16x16x32_bf16 v[184:187], v[40:43], a[248:251], v[184:187]
    ds_read_b128 v[36:39], v3 offset:12544
    v_mfma_f32_16x16x32_bf16 v[184:187], v[44:47], a[252:255], v[184:187]
    buffer_load_dwordx4 v4, s[4:7], s32 offen offset:2048 sc1 lds
    v_mfma_f32_16x16x32_bf16 v[188:191], v[40:43], v[208:211], v[188:191]
    v_exp_f32 v19, v99
    v_mfma_f32_16x16x32_bf16 v[188:191], v[44:47], v[212:215], v[188:191]
    s_waitcnt lgkmcnt(2)
    v_cvt_pk_bf16_f32 v162, v16, v17
    v_cvt_f32_i32 v228, v228
    v_mfma_f32_16x16x32_bf16 v[112:115], v[24:27], a[200:203], v[112:115]
    ds_read_b128 v[40:43], v2 offset:18688
    v_mfma_f32_16x16x32_bf16 v[112:115], v[28:31], a[204:207], v[112:115]
    v_exp_f32 v16, v164
    v_mfma_f32_16x16x32_bf16 v[116:119], v[24:27], a[224:227], v[116:119]
    v_add_f32 v5, v5, v18
    v_add_f32 v5, v5, v19
    v_mfma_f32_16x16x32_bf16 v[116:119], v[28:31], a[228:231], v[116:119]
    s_add_u32 s32, s32, 24576
    v_exp_f32 v17, v165
    v_mfma_f32_16x16x32_bf16 v[120:123], v[24:27], a[248:251], v[120:123]
    s_add_u32 s26, s26, 36864
    ds_read_b128 v[44:47], v3 offset:18688
    v_cvt_pk_bf16_f32 v163, v18, v19
    v_mfma_f32_16x16x32_bf16 v[120:123], v[28:31], a[252:255], v[120:123]
    s_waitcnt lgkmcnt(2)
    v_exp_f32 v18, v166
    v_mfma_f32_16x16x32_bf16 v[124:127], v[24:27], v[208:211], v[124:127]
    s_waitcnt vmcnt(6)
    v_add_f32 v6, v6, v16
    v_add_f32 v6, v6, v17
    v_mfma_f32_16x16x32_bf16 v[124:127], v[28:31], v[212:215], v[124:127]
    s_barrier
    s_sub_u32 s57, s26, 147456
    v_mfma_f32_16x16x32_bf16 v[176:179], v[32:35], a[208:211], v[176:179]
    s_min_u32 s26, s26, s57
    ds_read_b128 v[24:27], v1 offset:0
    v_add_u32 v0, 1, v0
    v_mfma_f32_16x16x32_bf16 v[176:179], v[36:39], a[212:215], v[176:179]
    buffer_store_dword v0, v13, s[20:23], 0 offen offset:32 sc1
    v_mfma_f32_16x16x32_bf16 v[180:183], v[32:35], a[232:235], v[180:183]
    v_exp_f32 v19, v167
    v_mfma_f32_16x16x32_bf16 v[180:183], v[36:39], a[236:239], v[180:183]
    v_cvt_pk_bf16_f32 v164, v16, v17
    v_cvt_f32_i32 v229, v229
    v_mfma_f32_16x16x32_bf16 v[184:187], v[32:35], v[192:195], v[184:187]
    ds_read_b128 v[28:31], v1 offset:12288
    v_fma_f32 v228, v228, v48, v50
    v_mfma_f32_16x16x32_bf16 v[184:187], v[36:39], v[196:199], v[184:187]
    v_exp_f32 v16, v100
    v_mfma_f32_16x16x32_bf16 v[188:191], v[32:35], v[216:219], v[188:191]
    v_add_f32 v6, v6, v18
    v_add_f32 v6, v6, v19
    v_mfma_f32_16x16x32_bf16 v[188:191], v[36:39], v[220:223], v[188:191]
    s_waitcnt lgkmcnt(2)
    v_exp_f32 v17, v101
    v_mfma_f32_16x16x32_bf16 v[112:115], v[40:43], a[208:211], v[112:115]
    ds_read_b128 v[32:35], v1 offset:1024
    v_cvt_pk_bf16_f32 v165, v18, v19
    v_mfma_f32_16x16x32_bf16 v[112:115], v[44:47], a[212:215], v[112:115]
    v_exp_f32 v18, v102
    v_mfma_f32_16x16x32_bf16 v[116:119], v[40:43], a[232:235], v[116:119]
    v_add_f32 v6, v6, v16
    v_add_f32 v6, v6, v17
    v_mfma_f32_16x16x32_bf16 v[116:119], v[44:47], a[236:239], v[116:119]
    v_exp_f32 v19, v103
    v_mfma_f32_16x16x32_bf16 v[120:123], v[40:43], v[192:195], v[120:123]
    ds_read_b128 v[36:39], v1 offset:13312
    v_cvt_pk_bf16_f32 v166, v16, v17
    v_mfma_f32_16x16x32_bf16 v[120:123], v[44:47], v[196:199], v[120:123]
    v_add_f32 v6, v6, v18
    v_add_f32 v6, v6, v19
    v_mfma_f32_16x16x32_bf16 v[124:127], v[40:43], v[216:219], v[124:127]
    v_cvt_pk_bf16_f32 v167, v18, v19
    v_mfma_f32_16x16x32_bf16 v[124:127], v[44:47], v[220:223], v[124:127]
    s_waitcnt lgkmcnt(2)
    v_mfma_f32_16x16x32_bf16 a[0:3], v[64:67], v[24:27], a[0:3]
    s_mov_b32 m0, s26
    ds_read_b128 v[40:43], v1 offset:2048
    v_fma_f32 v229, v229, v49, v51
    v_mfma_f32_16x16x32_bf16 a[0:3], v[80:83], v[28:31], a[0:3]
    buffer_load_dwordx2 v[60:61], v10, s[72:75], s36 offen offset:192
    v_mfma_f32_16x16x32_bf16 a[48:51], v[68:71], v[24:27], a[48:51]
    v_exp_f32 v16, v168
    v_mfma_f32_16x16x32_bf16 a[48:51], v[84:87], v[28:31], a[48:51]
    v_exp_f32 v17, v169
    v_mfma_f32_16x16x32_bf16 a[96:99], v[72:75], v[24:27], a[96:99]
    ds_read_b128 v[44:47], v1 offset:14336
    v_cvt_pk_bf16_f32 v228, v228, v229
    v_mfma_f32_16x16x32_bf16 a[96:99], v[88:91], v[28:31], a[96:99]
    buffer_load_dwordx4 v4, s[4:7], s32 offen offset:0 sc1 lds
    v_mfma_f32_16x16x32_bf16 a[144:147], v[76:79], v[24:27], a[144:147]
    v_exp_f32 v18, v170
    v_mfma_f32_16x16x32_bf16 a[144:147], v[92:95], v[28:31], a[144:147]
    s_waitcnt lgkmcnt(2)
    v_add_f32 v7, v7, v16
    v_add_f32 v7, v7, v17
    v_mfma_f32_16x16x32_bf16 a[4:7], v[64:67], v[32:35], a[4:7]
    ds_read_b128 v[24:27], v1 offset:3072
    v_cvt_f32_i32 v232, v232
    v_mfma_f32_16x16x32_bf16 a[4:7], v[80:83], v[36:39], a[4:7]
    buffer_load_dwordx2 v[62:63], v10, s[76:79], s36 offen offset:192
    v_mfma_f32_16x16x32_bf16 a[52:55], v[68:71], v[32:35], a[52:55]
    v_exp_f32 v19, v171
    v_mfma_f32_16x16x32_bf16 a[52:55], v[84:87], v[36:39], a[52:55]
    v_cvt_pk_bf16_f32 v168, v16, v17
    v_cvt_f32_i32 v233, v233
    v_mfma_f32_16x16x32_bf16 a[100:103], v[72:75], v[32:35], a[100:103]
    ds_read_b128 v[28:31], v1 offset:15360
    v_fma_f32 v232, v232, v48, v50
    v_mfma_f32_16x16x32_bf16 a[100:103], v[88:91], v[36:39], a[100:103]
    buffer_load_dwordx4 v[240:243], v9, s[64:67], s33 offen offset:384 nt
    v_mfma_f32_16x16x32_bf16 a[148:151], v[76:79], v[32:35], a[148:151]
    v_exp_f32 v16, v104
    v_mfma_f32_16x16x32_bf16 a[148:151], v[92:95], v[36:39], a[148:151]
    s_waitcnt lgkmcnt(2)
    v_add_f32 v7, v7, v18
    v_add_f32 v7, v7, v19
    v_mfma_f32_16x16x32_bf16 a[8:11], v[64:67], v[40:43], a[8:11]
    ds_read_b128 v[32:35], v1 offset:4096
    v_fma_f32 v233, v233, v49, v51
    v_mfma_f32_16x16x32_bf16 a[8:11], v[80:83], v[44:47], a[8:11]
    buffer_load_dwordx4 v4, s[4:7], s32 offen offset:1024 sc1 lds
    v_mfma_f32_16x16x32_bf16 a[56:59], v[68:71], v[40:43], a[56:59]
    v_exp_f32 v17, v105
    v_mfma_f32_16x16x32_bf16 a[56:59], v[84:87], v[44:47], a[56:59]
    v_cvt_pk_bf16_f32 v169, v18, v19
    v_cvt_pk_bf16_f32 v232, v232, v233
    v_mfma_f32_16x16x32_bf16 a[104:107], v[72:75], v[40:43], a[104:107]
    ds_read_b128 v[36:39], v1 offset:16384
    v_cvt_f32_i32 v236, v236
    v_mfma_f32_16x16x32_bf16 a[104:107], v[88:91], v[44:47], a[104:107]
    buffer_load_dwordx4 v[244:247], v9, s[64:67], s33 offen offset:1920 nt
    v_mfma_f32_16x16x32_bf16 a[152:155], v[76:79], v[40:43], a[152:155]
    v_exp_f32 v18, v106
    v_mfma_f32_16x16x32_bf16 a[152:155], v[92:95], v[44:47], a[152:155]
    s_waitcnt lgkmcnt(2)
    v_add_f32 v7, v7, v16
    v_add_f32 v7, v7, v17
    v_mfma_f32_16x16x32_bf16 a[12:15], v[64:67], v[24:27], a[12:15]
    ds_read_b128 v[40:43], v1 offset:5120
    v_cvt_f32_i32 v237, v237
    v_mfma_f32_16x16x32_bf16 a[12:15], v[80:83], v[28:31], a[12:15]
    buffer_load_dwordx4 v4, s[4:7], s32 offen offset:2048 sc1 lds
    v_mfma_f32_16x16x32_bf16 a[60:63], v[68:71], v[24:27], a[60:63]
    v_exp_f32 v19, v107
    v_mfma_f32_16x16x32_bf16 a[60:63], v[84:87], v[28:31], a[60:63]
    v_cvt_pk_bf16_f32 v170, v16, v17
    v_exp_f32 v16, v172
    v_mfma_f32_16x16x32_bf16 a[108:111], v[72:75], v[24:27], a[108:111]
    ds_read_b128 v[44:47], v1 offset:17408
    v_add_f32 v7, v7, v18
    v_mfma_f32_16x16x32_bf16 a[108:111], v[88:91], v[28:31], a[108:111]
    buffer_load_dwordx4 v[248:251], v9, s[64:67], s34 offen offset:384 nt
    v_add_f32 v7, v7, v19
    v_mfma_f32_16x16x32_bf16 a[156:159], v[76:79], v[24:27], a[156:159]
    s_add_u32 s29, s28, 49152
    v_exp_f32 v17, v173
    v_mfma_f32_16x16x32_bf16 a[156:159], v[92:95], v[28:31], a[156:159]
    s_waitcnt lgkmcnt(2)
    v_cvt_pk_bf16_f32 v171, v18, v19
    v_fma_f32 v236, v236, v48, v50
    v_mfma_f32_16x16x32_bf16 a[16:19], v[64:67], v[32:35], a[16:19]
    s_sub_u32 s3, s29, 147456
    ds_read_b128 v[24:27], v1 offset:6144
    v_fma_f32 v237, v237, v49, v51
    v_mfma_f32_16x16x32_bf16 a[16:19], v[80:83], v[36:39], a[16:19]
    s_add_u32 s32, s32, 24576
    buffer_load_dwordx4 v[252:255], v9, s[64:67], s34 offen offset:1920 nt
    v_mfma_f32_16x16x32_bf16 a[64:67], v[68:71], v[32:35], a[64:67]
    s_min_u32 s29, s29, s3
    v_exp_f32 v18, v174
    v_mfma_f32_16x16x32_bf16 a[64:67], v[84:87], v[36:39], a[64:67]
    v_add_f32 v8, v8, v16
    v_add_f32 v8, v8, v17
    v_mfma_f32_16x16x32_bf16 a[112:115], v[72:75], v[32:35], a[112:115]
    s_add_u32 s26, s26, 12288
    ds_read_b128 v[28:31], v1 offset:18432
    v_cvt_pk_bf16_f32 v236, v236, v237
    v_mfma_f32_16x16x32_bf16 a[112:115], v[88:91], v[36:39], a[112:115]
    v_exp_f32 v19, v175
    v_cvt_pk_bf16_f32 v172, v16, v17
    v_mfma_f32_16x16x32_bf16 a[160:163], v[76:79], v[32:35], a[160:163]
    v_exp_f32 v16, v108
    v_mfma_f32_16x16x32_bf16 a[160:163], v[92:95], v[36:39], a[160:163]
    s_waitcnt lgkmcnt(2)
    v_add_f32 v8, v8, v18
    v_add_f32 v8, v8, v19
    v_mfma_f32_16x16x32_bf16 a[20:23], v[64:67], v[40:43], a[20:23]
    s_sub_u32 s3, s29, s28
    ds_read_b128 v[32:35], v1 offset:7168
    v_lshlrev_b32 v48, 16, v57
    v_mfma_f32_16x16x32_bf16 a[20:23], v[80:83], v[44:47], a[20:23]
    v_exp_f32 v17, v109
    v_mfma_f32_16x16x32_bf16 a[68:71], v[68:71], v[40:43], a[68:71]
    s_mov_b32 m0, s26
    v_cvt_pk_bf16_f32 v173, v18, v19
    v_and_b32 v49, s97, v57
    v_mfma_f32_16x16x32_bf16 a[68:71], v[84:87], v[44:47], a[68:71]
    v_exp_f32 v18, v110
    v_mfma_f32_16x16x32_bf16 a[116:119], v[72:75], v[40:43], a[116:119]
    ds_read_b128 v[36:39], v1 offset:19456
    v_add_f32 v8, v8, v16
    v_mfma_f32_16x16x32_bf16 a[116:119], v[88:91], v[44:47], a[116:119]
    v_add_f32 v8, v8, v17
    v_mfma_f32_16x16x32_bf16 a[164:167], v[76:79], v[40:43], a[164:167]
    s_mov_b32 s28, s29
    v_exp_f32 v19, v111
    v_mfma_f32_16x16x32_bf16 a[164:167], v[92:95], v[44:47], a[164:167]
    s_waitcnt lgkmcnt(2)
    v_cvt_pk_bf16_f32 v174, v16, v17
    v_add_f32 v8, v8, v18
    v_mfma_f32_16x16x32_bf16 a[24:27], v[64:67], v[24:27], a[24:27]
    ds_read_b128 v[40:43], v1 offset:8192
    v_add_f32 v8, v8, v19
    v_mfma_f32_16x16x32_bf16 a[24:27], v[80:83], v[28:31], a[24:27]
    v_cvt_pk_bf16_f32 v175, v18, v19
    v_lshlrev_b32 v50, 16, v59
    v_mfma_f32_16x16x32_bf16 a[72:75], v[68:71], v[24:27], a[72:75]
    v_exp_f32 v16, v176
    v_mfma_f32_16x16x32_bf16 a[72:75], v[84:87], v[28:31], a[72:75]
    buffer_load_dwordx4 v4, s[4:7], s32 offen offset:0 sc1 lds
    v_mfma_f32_16x16x32_bf16 a[120:123], v[72:75], v[24:27], a[120:123]
    ds_read_b128 v[44:47], v1 offset:20480
    v_and_b32 v51, s97, v59
    v_mfma_f32_16x16x32_bf16 a[120:123], v[88:91], v[28:31], a[120:123]
    v_exp_f32 v17, v177
    v_mfma_f32_16x16x32_bf16 a[168:171], v[76:79], v[24:27], a[168:171]
    v_exp_f32 v18, v178
    v_mfma_f32_16x16x32_bf16 a[168:171], v[92:95], v[28:31], a[168:171]
    s_waitcnt lgkmcnt(2)
    v_add_f32 v5, v5, v16
    v_add_f32 v5, v5, v17
    v_mfma_f32_16x16x32_bf16 a[28:31], v[64:67], v[32:35], a[28:31]
    ds_read_b128 v[24:27], v1 offset:9216
    v_mul_f32 v48, s38, v48
    v_mfma_f32_16x16x32_bf16 a[28:31], v[80:83], v[36:39], a[28:31]
    v_exp_f32 v19, v179
    v_mfma_f32_16x16x32_bf16 a[76:79], v[68:71], v[32:35], a[76:79]
    v_cvt_pk_bf16_f32 v176, v16, v17
    v_add_u32 v2, s3, v2
    v_mfma_f32_16x16x32_bf16 a[76:79], v[84:87], v[36:39], a[76:79]
    v_exp_f32 v16, v112
    v_mfma_f32_16x16x32_bf16 a[124:127], v[72:75], v[32:35], a[124:127]
    ds_read_b128 v[28:31], v1 offset:21504
    v_add_f32 v5, v5, v18
    v_mfma_f32_16x16x32_bf16 a[124:127], v[88:91], v[36:39], a[124:127]
    v_add_f32 v5, v5, v19
    v_mul_f32 v49, s38, v49
    v_mfma_f32_16x16x32_bf16 a[172:175], v[76:79], v[32:35], a[172:175]
    v_exp_f32 v17, v113
    v_mfma_f32_16x16x32_bf16 a[172:175], v[92:95], v[36:39], a[172:175]
    s_waitcnt lgkmcnt(2)
    buffer_load_dwordx4 v4, s[4:7], s32 offen offset:1024 sc1 lds
    v_mfma_f32_16x16x32_bf16 a[32:35], v[64:67], v[40:43], a[32:35]
    ds_read_b128 v[32:35], v1 offset:10240
    v_cvt_pk_bf16_f32 v177, v18, v19
    v_mfma_f32_16x16x32_bf16 a[32:35], v[80:83], v[44:47], a[32:35]
    v_exp_f32 v18, v114
    v_mfma_f32_16x16x32_bf16 a[80:83], v[68:71], v[40:43], a[80:83]
    v_add_f32 v5, v5, v16
    v_add_f32 v5, v5, v17
    v_mfma_f32_16x16x32_bf16 a[80:83], v[84:87], v[44:47], a[80:83]
    v_exp_f32 v19, v115
    v_mfma_f32_16x16x32_bf16 a[128:131], v[72:75], v[40:43], a[128:131]
    ds_read_b128 v[36:39], v1 offset:22528
    v_mul_f32_e64 v50, -v50, v48
    v_mfma_f32_16x16x32_bf16 a[128:131], v[88:91], v[44:47], a[128:131]
    v_cvt_pk_bf16_f32 v178, v16, v17
    v_mul_f32_e64 v51, -v51, v49
    v_mfma_f32_16x16x32_bf16 a[176:179], v[76:79], v[40:43], a[176:179]
    v_exp_f32 v16, v180
    v_mfma_f32_16x16x32_bf16 a[176:179], v[92:95], v[44:47], a[176:179]
    s_waitcnt lgkmcnt(2)
    v_add_f32 v5, v5, v18
    v_add_u32 v3, s3, v3
    v_mfma_f32_16x16x32_bf16 a[36:39], v[64:67], v[24:27], a[36:39]
    ds_read_b128 v[40:43], v1 offset:11264
    v_add_f32 v5, v5, v19
    v_mfma_f32_16x16x32_bf16 a[36:39], v[80:83], v[28:31], a[36:39]
    buffer_load_dwordx4 v4, s[4:7], s32 offen offset:2048 sc1 lds
    v_mfma_f32_16x16x32_bf16 a[84:87], v[68:71], v[24:27], a[84:87]
    v_exp_f32 v17, v181
    v_mfma_f32_16x16x32_bf16 a[84:87], v[84:87], v[28:31], a[84:87]
    v_cvt_pk_bf16_f32 v179, v18, v19
    v_cvt_f32_i32 v226, v226
    v_mfma_f32_16x16x32_bf16 a[132:135], v[72:75], v[24:27], a[132:135]
    ds_read_b128 v[44:47], v1 offset:23552
    v_cvt_f32_i32 v227, v227
    v_mfma_f32_16x16x32_bf16 a[132:135], v[88:91], v[28:31], a[132:135]
    s_waitcnt lgkmcnt(2)
    v_exp_f32 v18, v182
    v_mfma_f32_16x16x32_bf16 a[180:183], v[76:79], v[24:27], a[180:183]
    s_waitcnt vmcnt(13)
    v_add_f32 v6, v6, v16
    v_add_f32 v6, v6, v17
    v_mfma_f32_16x16x32_bf16 a[180:183], v[92:95], v[28:31], a[180:183]
    s_barrier
    v_fma_f32 v226, v226, v48, v50
    v_mfma_f32_16x16x32_bf16 a[40:43], v[64:67], v[32:35], a[40:43]
    ds_read_b128 v[24:27], v2 offset:0
    v_fma_f32 v227, v227, v49, v51
    v_mfma_f32_16x16x32_bf16 a[40:43], v[80:83], v[36:39], a[40:43]
    v_exp_f32 v19, v183
    v_mfma_f32_16x16x32_bf16 a[88:91], v[68:71], v[32:35], a[88:91]
    v_cvt_pk_bf16_f32 v180, v16, v17
    v_mfma_f32_16x16x32_bf16 a[88:91], v[84:87], v[36:39], a[88:91]
    v_exp_f32 v16, v116
    v_mfma_f32_16x16x32_bf16 a[136:139], v[72:75], v[32:35], a[136:139]
    ds_read_b128 v[28:31], v3 offset:0
    v_add_f32 v6, v6, v18
    v_mfma_f32_16x16x32_bf16 a[136:139], v[88:91], v[36:39], a[136:139]
    v_add_f32 v6, v6, v19
    v_cvt_pk_bf16_f32 v225, v226, v227
    v_mfma_f32_16x16x32_bf16 a[184:187], v[76:79], v[32:35], a[184:187]
    v_exp_f32 v17, v117
    v_mfma_f32_16x16x32_bf16 a[184:187], v[92:95], v[36:39], a[184:187]
    s_waitcnt lgkmcnt(2)
    v_cvt_pk_bf16_f32 v181, v18, v19
    v_cvt_f32_i32 v230, v230
    v_mfma_f32_16x16x32_bf16 a[44:47], v[64:67], v[40:43], a[44:47]
    ds_read_b128 v[32:35], v2 offset:6144
    v_mfma_f32_16x16x32_bf16 a[44:47], v[80:83], v[44:47], a[44:47]
    v_exp_f32 v18, v118
    v_mfma_f32_16x16x32_bf16 a[92:95], v[68:71], v[40:43], a[92:95]
    v_add_f32 v6, v6, v16
    v_add_f32 v6, v6, v17
    v_mfma_f32_16x16x32_bf16 a[92:95], v[84:87], v[44:47], a[92:95]
    s_add_u32 s32, s32, 24576
    v_exp_f32 v19, v119
    v_mfma_f32_16x16x32_bf16 a[140:143], v[72:75], v[40:43], a[140:143]
    s_add_u32 s26, s26, 36864
    ds_read_b128 v[36:39], v3 offset:6144
    v_cvt_pk_bf16_f32 v182, v16, v17
    v_mfma_f32_16x16x32_bf16 a[140:143], v[88:91], v[44:47], a[140:143]
    s_sub_u32 s57, s26, 147456
    v_add_f32 v6, v6, v18
    v_add_f32 v6, v6, v19
    v_mfma_f32_16x16x32_bf16 a[188:191], v[76:79], v[40:43], a[188:191]
    s_min_u32 s26, s26, s57
    v_cvt_pk_bf16_f32 v183, v18, v19
    v_mfma_f32_16x16x32_bf16 a[188:191], v[92:95], v[44:47], a[188:191]
    s_waitcnt lgkmcnt(2)
    v_mfma_f32_16x16x32_bf16 v[64:67], v[24:27], a[192:195], v[128:131]
    ds_read_b128 v[40:43], v2 offset:128
    v_cvt_f32_i32 v231, v231
    v_mfma_f32_16x16x32_bf16 v[64:67], v[28:31], a[196:199], v[64:67]
    v_exp_f32 v16, v184
    v_mfma_f32_16x16x32_bf16 v[68:71], v[24:27], a[216:219], v[132:135]
    v_exp_f32 v17, v185
    v_mfma_f32_16x16x32_bf16 v[68:71], v[28:31], a[220:223], v[68:71]
    v_bfe_u32 v53, v4, 4, 6
    v_fma_f32 v230, v230, v48, v50
    v_mfma_f32_16x16x32_bf16 v[72:75], v[24:27], a[240:243], v[136:139]
    ds_read_b128 v[44:47], v3 offset:128
    v_lshlrev_b32 v53, 2, v53
    v_mfma_f32_16x16x32_bf16 v[72:75], v[28:31], a[244:247], v[72:75]
    buffer_load_dword v52, v53, s[20:23], s44 offen sc1
    v_mfma_f32_16x16x32_bf16 v[76:79], v[24:27], v[200:203], v[140:143]
    v_exp_f32 v18, v186
    v_mfma_f32_16x16x32_bf16 v[76:79], v[28:31], v[204:207], v[76:79]
    s_waitcnt lgkmcnt(2)
    v_add_f32 v7, v7, v16
    v_add_f32 v7, v7, v17
    v_mfma_f32_16x16x32_bf16 v[96:99], v[32:35], a[192:195], v[128:131]
    ds_read_b128 v[24:27], v2 offset:6272
    v_fma_f32 v231, v231, v49, v51
    v_mfma_f32_16x16x32_bf16 v[96:99], v[36:39], a[196:199], v[96:99]
    v_exp_f32 v19, v187
    v_mfma_f32_16x16x32_bf16 v[100:103], v[32:35], a[216:219], v[132:135]
    v_cvt_pk_bf16_f32 v184, v16, v17
    v_cvt_pk_bf16_f32 v229, v230, v231
    v_mfma_f32_16x16x32_bf16 v[100:103], v[36:39], a[220:223], v[100:103]
    s_add_u32 s35, s35, 196608
    v_exp_f32 v16, v120
    v_mfma_f32_16x16x32_bf16 v[104:107], v[32:35], a[240:243], v[136:139]
    s_mov_b32 m0, s26
    ds_read_b128 v[28:31], v3 offset:6272
    v_add_f32 v7, v7, v18
    v_mfma_f32_16x16x32_bf16 v[104:107], v[36:39], a[244:247], v[104:107]
    s_add_u32 s16, s16, 196608
    buffer_load_dwordx4 v4, s[4:7], s32 offen offset:0 sc1 lds
    v_mfma_f32_16x16x32_bf16 v[108:111], v[32:35], v[200:203], v[140:143]
    s_add_u32 s17, s17, 196608
    v_add_f32 v7, v7, v19
    v_cvt_f32_i32 v234, v234
    v_mfma_f32_16x16x32_bf16 v[108:111], v[36:39], v[204:207], v[108:111]
    s_waitcnt lgkmcnt(2)
    v_exp_f32 v17, v121
    v_mfma_f32_16x16x32_bf16 v[64:67], v[40:43], a[200:203], v[64:67]
    s_add_u32 s37, s37, 512
    ds_read_b128 v[32:35], v2 offset:256
    v_cvt_pk_bf16_f32 v185, v18, v19
    v_mfma_f32_16x16x32_bf16 v[64:67], v[44:47], a[204:207], v[64:67]
    v_exp_f32 v18, v122
    v_mfma_f32_16x16x32_bf16 v[68:71], v[40:43], a[224:227], v[68:71]
    v_add_f32 v7, v7, v16
    v_add_f32 v7, v7, v17
    v_mfma_f32_16x16x32_bf16 v[68:71], v[44:47], a[228:231], v[68:71]
    v_exp_f32 v19, v123
    v_mfma_f32_16x16x32_bf16 v[72:75], v[40:43], a[248:251], v[72:75]
    ds_read_b128 v[36:39], v3 offset:256
    v_cvt_pk_bf16_f32 v186, v16, v17
    v_mfma_f32_16x16x32_bf16 v[72:75], v[44:47], a[252:255], v[72:75]
    buffer_load_dwordx4 v4, s[4:7], s32 offen offset:1024 sc1 lds
    v_mfma_f32_16x16x32_bf16 v[76:79], v[40:43], v[208:211], v[76:79]
    v_exp_f32 v16, v188
    v_mfma_f32_16x16x32_bf16 v[76:79], v[44:47], v[212:215], v[76:79]
    s_waitcnt lgkmcnt(2)
    v_add_f32 v7, v7, v18
    v_cvt_f32_i32 v235, v235
    v_mfma_f32_16x16x32_bf16 v[96:99], v[24:27], a[200:203], v[96:99]
    ds_read_b128 v[40:43], v2 offset:6400
    v_add_f32 v7, v7, v19
    v_mfma_f32_16x16x32_bf16 v[96:99], v[28:31], a[204:207], v[96:99]
    buffer_load_dwordx2 v[56:57], off, s[80:83], s37 offset:0
    v_mfma_f32_16x16x32_bf16 v[100:103], v[24:27], a[224:227], v[100:103]
    v_exp_f32 v17, v189
    v_mfma_f32_16x16x32_bf16 v[100:103], v[28:31], a[228:231], v[100:103]
    v_cvt_pk_bf16_f32 v187, v18, v19
    v_fma_f32 v234, v234, v48, v50
    v_mfma_f32_16x16x32_bf16 v[104:107], v[24:27], a[248:251], v[104:107]
    ds_read_b128 v[44:47], v3 offset:6400
    v_fma_f32 v235, v235, v49, v51
    v_mfma_f32_16x16x32_bf16 v[104:107], v[28:31], a[252:255], v[104:107]
    buffer_load_dwordx2 v[58:59], off, s[84:87], s37 offset:0
    v_mfma_f32_16x16x32_bf16 v[108:111], v[24:27], v[208:211], v[108:111]
    s_add_u32 s29, s30, 49152
    v_exp_f32 v18, v190
    v_mfma_f32_16x16x32_bf16 v[108:111], v[28:31], v[212:215], v[108:111]
    s_waitcnt lgkmcnt(2)
    v_add_f32 v8, v8, v16
    v_add_f32 v8, v8, v17
    v_mfma_f32_16x16x32_bf16 v[64:67], v[32:35], a[208:211], v[64:67]
    s_sub_u32 s3, s29, 147456
    ds_read_b128 v[24:27], v2 offset:12288
    v_cvt_pk_bf16_f32 v233, v234, v235
    v_mfma_f32_16x16x32_bf16 v[64:67], v[36:39], a[212:215], v[64:67]
    s_min_u32 s29, s29, s3
    buffer_load_dwordx4 v4, s[4:7], s32 offen offset:2048 sc1 lds
    v_mfma_f32_16x16x32_bf16 v[68:71], v[32:35], a[232:235], v[68:71]
    v_exp_f32 v19, v191
    v_mfma_f32_16x16x32_bf16 v[68:71], v[36:39], a[236:239], v[68:71]
    v_cvt_pk_bf16_f32 v188, v16, v17
    v_cvt_f32_i32 v238, v238
    v_mfma_f32_16x16x32_bf16 v[72:75], v[32:35], v[192:195], v[72:75]
    ds_read_b128 v[28:31], v3 offset:12288
    v_mfma_f32_16x16x32_bf16 v[72:75], v[36:39], v[196:199], v[72:75]
    buffer_load_dwordx4 v[144:147], v12, s[68:71], s35 offen offset:0 nt
    v_mfma_f32_16x16x32_bf16 v[76:79], v[32:35], v[216:219], v[76:79]
    v_exp_f32 v16, v124
    v_mfma_f32_16x16x32_bf16 v[76:79], v[36:39], v[220:223], v[76:79]
    s_waitcnt lgkmcnt(2)
    v_add_f32 v8, v8, v18
    v_add_f32 v8, v8, v19
    v_mfma_f32_16x16x32_bf16 v[96:99], v[40:43], a[208:211], v[96:99]
    s_add_u32 s32, s32, 24576
    ds_read_b128 v[32:35], v2 offset:18432
    v_cvt_f32_i32 v239, v239
    v_mfma_f32_16x16x32_bf16 v[96:99], v[44:47], a[212:215], v[96:99]
    s_sub_u32 s3, s29, s30
    v_exp_f32 v17, v125
    v_mfma_f32_16x16x32_bf16 v[100:103], v[40:43], a[232:235], v[100:103]
    v_cvt_pk_bf16_f32 v189, v18, v19
    v_fma_f32 v238, v238, v48, v50
    v_mfma_f32_16x16x32_bf16 v[100:103], v[44:47], a[236:239], v[100:103]
    v_exp_f32 v18, v126
    v_mfma_f32_16x16x32_bf16 v[104:107], v[40:43], v[192:195], v[104:107]
    s_add_u32 s26, s26, 12288
    ds_read_b128 v[36:39], v3 offset:18432
    v_add_f32 v8, v8, v16
    v_mfma_f32_16x16x32_bf16 v[104:107], v[44:47], v[196:199], v[104:107]
    buffer_load_dwordx4 v[148:151], v12, s[68:71], s35 offen offset:768 nt
    v_mfma_f32_16x16x32_bf16 v[108:111], v[40:43], v[216:219], v[108:111]
    v_add_f32 v8, v8, v17
    v_fma_f32 v239, v239, v49, v51
    v_mfma_f32_16x16x32_bf16 v[108:111], v[44:47], v[220:223], v[108:111]
    s_waitcnt lgkmcnt(2)
    v_exp_f32 v19, v127
    v_mfma_f32_16x16x32_bf16 v[80:83], v[24:27], a[192:195], v[128:131]
    ds_read_b128 v[40:43], v2 offset:12416
    v_cvt_pk_bf16_f32 v190, v16, v17
    v_mfma_f32_16x16x32_bf16 v[80:83], v[28:31], a[196:199], v[80:83]
    s_mov_b32 m0, s26
    v_add_f32 v8, v8, v18
    v_add_f32 v8, v8, v19
    v_mfma_f32_16x16x32_bf16 v[84:87], v[24:27], a[216:219], v[132:135]
    s_mov_b32 s30, s29
    v_cvt_pk_bf16_f32 v191, v18, v19
    v_cvt_pk_bf16_f32 v237, v238, v239
    v_mfma_f32_16x16x32_bf16 v[84:87], v[28:31], a[220:223], v[84:87]
    v_exp_f32 v16, v64
    v_mfma_f32_16x16x32_bf16 v[88:91], v[24:27], a[240:243], v[136:139]
    ds_read_b128 v[44:47], v3 offset:12416
    v_mfma_f32_16x16x32_bf16 v[88:91], v[28:31], a[244:247], v[88:91]
    buffer_load_dwordx4 v[152:155], v12, s[68:71], s35 offen offset:1536 nt
    v_mfma_f32_16x16x32_bf16 v[92:95], v[24:27], v[200:203], v[140:143]
    v_exp_f32 v17, v65
    v_mfma_f32_16x16x32_bf16 v[92:95], v[28:31], v[204:207], v[92:95]
    s_waitcnt lgkmcnt(2)
    v_exp_f32 v18, v66
    v_mfma_f32_16x16x32_bf16 v[112:115], v[32:35], a[192:195], v[128:131]
    ds_read_b128 v[24:27], v2 offset:18560
    v_add_f32 v5, v5, v16
    v_mfma_f32_16x16x32_bf16 v[112:115], v[36:39], a[196:199], v[112:115]
    buffer_load_dwordx4 v4, s[4:7], s32 offen offset:0 sc1 lds
    v_mfma_f32_16x16x32_bf16 v[116:119], v[32:35], a[216:219], v[132:135]
    v_add_f32 v5, v5, v17
    v_add_u32 v1, s3, v1
    v_mfma_f32_16x16x32_bf16 v[116:119], v[36:39], a[220:223], v[116:119]
    v_exp_f32 v19, v67
    v_mfma_f32_16x16x32_bf16 v[120:123], v[32:35], a[240:243], v[136:139]
    ds_read_b128 v[28:31], v3 offset:18560
    v_cvt_pk_bf16_f32 v64, v16, v17
    v_mfma_f32_16x16x32_bf16 v[120:123], v[36:39], a[244:247], v[120:123]
    s_waitcnt vmcnt(13)
    buffer_load_dwordx4 v[156:159], v12, s[68:71], s35 offen offset:2304 nt
    v_mfma_f32_16x16x32_bf16 v[124:127], v[32:35], v[200:203], v[140:143]
    v_exp_f32 v16, v96
    v_mfma_f32_16x16x32_bf16 v[124:127], v[36:39], v[204:207], v[124:127]
    s_waitcnt lgkmcnt(2)
    v_add_f32 v5, v5, v18
    v_add_f32 v5, v5, v19
    v_mfma_f32_16x16x32_bf16 v[80:83], v[40:43], a[200:203], v[80:83]
    ds_read_b128 v[32:35], v2 offset:12544
    v_lshlrev_b32 v48, 16, v60
    v_mfma_f32_16x16x32_bf16 v[80:83], v[44:47], a[204:207], v[80:83]
    v_exp_f32 v17, v97
    v_mfma_f32_16x16x32_bf16 v[84:87], v[40:43], a[224:227], v[84:87]
    v_cvt_pk_bf16_f32 v65, v18, v19
    v_and_b32 v49, s97, v60
    v_mfma_f32_16x16x32_bf16 v[84:87], v[44:47], a[228:231], v[84:87]
    buffer_load_dwordx4 v4, s[4:7], s32 offen offset:1024 sc1 lds
    v_mfma_f32_16x16x32_bf16 v[88:91], v[40:43], a[248:251], v[88:91]
    ds_read_b128 v[36:39], v3 offset:12544
    v_lshlrev_b32 v50, 16, v62
    v_mfma_f32_16x16x32_bf16 v[88:91], v[44:47], a[252:255], v[88:91]
    v_exp_f32 v18, v98
    v_mfma_f32_16x16x32_bf16 v[92:95], v[40:43], v[208:211], v[92:95]
    v_add_f32 v5, v5, v16
    v_add_f32 v5, v5, v17
    v_mfma_f32_16x16x32_bf16 v[92:95], v[44:47], v[212:215], v[92:95]
    s_waitcnt lgkmcnt(2)
    v_exp_f32 v19, v99
    v_mfma_f32_16x16x32_bf16 v[112:115], v[24:27], a[200:203], v[112:115]
    ds_read_b128 v[40:43], v2 offset:18688
    v_cvt_pk_bf16_f32 v66, v16, v17
    v_mfma_f32_16x16x32_bf16 v[112:115], v[28:31], a[204:207], v[112:115]
    v_exp_f32 v16, v68
    v_mfma_f32_16x16x32_bf16 v[116:119], v[24:27], a[224:227], v[116:119]
    v_add_f32 v5, v5, v18
    v_add_f32 v5, v5, v19
    v_mfma_f32_16x16x32_bf16 v[116:119], v[28:31], a[228:231], v[116:119]
    v_exp_f32 v17, v69
    v_mfma_f32_16x16x32_bf16 v[120:123], v[24:27], a[248:251], v[120:123]
    ds_read_b128 v[44:47], v3 offset:18688
    v_cvt_pk_bf16_f32 v67, v18, v19
    v_mfma_f32_16x16x32_bf16 v[120:123], v[28:31], a[252:255], v[120:123]
    s_waitcnt lgkmcnt(2)
    buffer_load_dwordx4 v4, s[4:7], s32 offen offset:2048 sc1 lds
    v_mfma_f32_16x16x32_bf16 v[124:127], v[24:27], v[208:211], v[124:127]
    s_waitcnt vmcnt(13)
    v_exp_f32 v18, v70
    v_mfma_f32_16x16x32_bf16 v[124:127], v[28:31], v[212:215], v[124:127]
    s_barrier
    v_add_f32 v6, v6, v16
    v_mfma_f32_16x16x32_bf16 v[80:83], v[32:35], a[208:211], v[80:83]
    ds_read_b128 v[24:27], v1 offset:0
    v_add_f32 v6, v6, v17
    v_mfma_f32_16x16x32_bf16 v[80:83], v[36:39], a[212:215], v[80:83]
    v_exp_f32 v19, v71
    v_mfma_f32_16x16x32_bf16 v[84:87], v[32:35], a[232:235], v[84:87]
    v_cvt_pk_bf16_f32 v68, v16, v17
    v_and_b32 v51, s97, v62
    v_mfma_f32_16x16x32_bf16 v[84:87], v[36:39], a[236:239], v[84:87]
    v_exp_f32 v16, v100
    v_mfma_f32_16x16x32_bf16 v[88:91], v[32:35], v[192:195], v[88:91]
    ds_read_b128 v[28:31], v1 offset:12288
    v_add_f32 v6, v6, v18
    v_mfma_f32_16x16x32_bf16 v[88:91], v[36:39], v[196:199], v[88:91]
    v_add_f32 v6, v6, v19
    v_mul_f32 v48, s38, v48
    v_mfma_f32_16x16x32_bf16 v[92:95], v[32:35], v[216:219], v[92:95]
    v_exp_f32 v17, v101
    v_mfma_f32_16x16x32_bf16 v[92:95], v[36:39], v[220:223], v[92:95]
    s_waitcnt lgkmcnt(2)
    v_cvt_pk_bf16_f32 v69, v18, v19
    v_mul_f32 v49, s38, v49
    v_mfma_f32_16x16x32_bf16 v[112:115], v[40:43], a[208:211], v[112:115]
    ds_read_b128 v[32:35], v1 offset:1024
    v_mul_f32_e64 v50, -v50, v48
    v_mfma_f32_16x16x32_bf16 v[112:115], v[44:47], a[212:215], v[112:115]
    v_exp_f32 v18, v102
    v_mfma_f32_16x16x32_bf16 v[116:119], v[40:43], a[232:235], v[116:119]
    v_add_f32 v6, v6, v16
    v_add_f32 v6, v6, v17
    v_mfma_f32_16x16x32_bf16 v[116:119], v[44:47], a[236:239], v[116:119]
    v_exp_f32 v19, v103
    v_mfma_f32_16x16x32_bf16 v[120:123], v[40:43], v[192:195], v[120:123]
    ds_read_b128 v[36:39], v1 offset:13312
    v_cvt_pk_bf16_f32 v70, v16, v17
    v_mfma_f32_16x16x32_bf16 v[120:123], v[44:47], v[196:199], v[120:123]
    s_add_u32 s32, s32, 24576
    v_add_f32 v6, v6, v18
    v_mul_f32_e64 v51, -v51, v49
    v_mfma_f32_16x16x32_bf16 v[124:127], v[40:43], v[216:219], v[124:127]
    s_add_u32 s26, s26, 36864
    v_add_f32 v6, v6, v19
    s_sub_u32 s57, s26, 147456
    v_mfma_f32_16x16x32_bf16 v[124:127], v[44:47], v[220:223], v[124:127]
    s_waitcnt lgkmcnt(2)
    v_cvt_pk_bf16_f32 v71, v18, v19
    s_min_u32 s26, s26, s57
    v_mfma_f32_16x16x32_bf16 a[0:3], v[160:163], v[24:27], a[0:3]
    ds_read_b128 v[40:43], v1 offset:2048
    v_cvt_f32_i32 v240, v240
    v_mfma_f32_16x16x32_bf16 a[0:3], v[176:179], v[28:31], a[0:3]
    s_waitcnt vmcnt(12)
    v_subrev_u32 v52, s92, v52
    v_cmp_lt_u32 vcc, 15, v52
    v_mfma_f32_16x16x32_bf16 a[48:51], v[164:167], v[24:27], a[48:51]
    v_exp_f32 v16, v72
    v_mfma_f32_16x16x32_bf16 a[48:51], v[180:183], v[28:31], a[48:51]
    v_exp_f32 v17, v73
    v_mfma_f32_16x16x32_bf16 a[96:99], v[168:171], v[24:27], a[96:99]
    s_and_b32 s59, vcc_lo, 0xff
    ds_read_b128 v[44:47], v1 offset:14336
    v_cvt_f32_i32 v241, v241
    v_mfma_f32_16x16x32_bf16 a[96:99], v[184:187], v[28:31], a[96:99]
    s_cbranch_scc1 L_pollslow2
L_pollok2:
    v_mfma_f32_16x16x32_bf16 a[144:147], v[172:175], v[24:27], a[144:147]
    s_add_u32 s92, s92, 1
    v_exp_f32 v18, v74
    v_mfma_f32_16x16x32_bf16 a[144:147], v[188:191], v[28:31], a[144:147]
    s_waitcnt lgkmcnt(2)
    v_add_f32 v7, v7, v16
    v_add_f32 v7, v7, v17
    v_mfma_f32_16x16x32_bf16 a[4:7], v[160:163], v[32:35], a[4:7]
    s_mov_b32 m0, s56
    ds_read_b128 v[24:27], v1 offset:3072
    v_fma_f32 v240, v240, v48, v50
    v_mfma_f32_16x16x32_bf16 a[4:7], v[176:179], v[36:39], a[4:7]
    buffer_load_dwordx4 v4, s[4:7], s27 offen offset:0 sc1 lds
    v_mfma_f32_16x16x32_bf16 a[52:55], v[164:167], v[32:35], a[52:55]
    v_exp_f32 v19, v75
    v_mfma_f32_16x16x32_bf16 a[52:55], v[180:183], v[36:39], a[52:55]
    v_cvt_pk_bf16_f32 v72, v16, v17
    v_fma_f32 v241, v241, v49, v51
    v_mfma_f32_16x16x32_bf16 a[100:103], v[168:171], v[32:35], a[100:103]
    ds_read_b128 v[28:31], v1 offset:15360
    v_cvt_pk_bf16_f32 v226, v240, v241
    v_mfma_f32_16x16x32_bf16 a[100:103], v[184:187], v[36:39], a[100:103]
    v_exp_f32 v16, v104
    v_mfma_f32_16x16x32_bf16 a[148:151], v[172:175], v[32:35], a[148:151]
    v_add_f32 v7, v7, v18
    v_add_f32 v7, v7, v19
    v_mfma_f32_16x16x32_bf16 a[148:151], v[188:191], v[36:39], a[148:151]
    s_waitcnt lgkmcnt(2)
    v_exp_f32 v17, v105
    v_mfma_f32_16x16x32_bf16 a[8:11], v[160:163], v[40:43], a[8:11]
    ds_read_b128 v[32:35], v1 offset:4096
    v_cvt_pk_bf16_f32 v73, v18, v19
    v_mfma_f32_16x16x32_bf16 a[8:11], v[176:179], v[44:47], a[8:11]
    buffer_load_dwordx4 v4, s[4:7], s27 offen offset:1024 sc1 lds
    v_mfma_f32_16x16x32_bf16 a[56:59], v[164:167], v[40:43], a[56:59]
    v_exp_f32 v18, v106
    v_mfma_f32_16x16x32_bf16 a[56:59], v[180:183], v[44:47], a[56:59]
    v_add_f32 v7, v7, v16
    v_cvt_f32_i32 v244, v244
    v_mfma_f32_16x16x32_bf16 a[104:107], v[168:171], v[40:43], a[104:107]
    ds_read_b128 v[36:39], v1 offset:16384
    v_add_f32 v7, v7, v17
    v_mfma_f32_16x16x32_bf16 a[104:107], v[184:187], v[44:47], a[104:107]
    v_exp_f32 v19, v107
    v_mfma_f32_16x16x32_bf16 a[152:155], v[172:175], v[40:43], a[152:155]
    v_cvt_f32_i32 v245, v245
    v_cvt_pk_bf16_f32 v74, v16, v17
    v_mfma_f32_16x16x32_bf16 a[152:155], v[188:191], v[44:47], a[152:155]
    s_waitcnt lgkmcnt(2)
    v_exp_f32 v16, v76
    v_mfma_f32_16x16x32_bf16 a[12:15], v[160:163], v[24:27], a[12:15]
    ds_read_b128 v[40:43], v1 offset:5120
    v_fma_f32 v244, v244, v48, v50
    v_mfma_f32_16x16x32_bf16 a[12:15], v[176:179], v[28:31], a[12:15]
    buffer_load_dwordx4 v4, s[4:7], s27 offen offset:2048 sc1 lds
    v_mfma_f32_16x16x32_bf16 a[60:63], v[164:167], v[24:27], a[60:63]
    v_add_f32 v7, v7, v18
    v_add_f32 v7, v7, v19
    v_mfma_f32_16x16x32_bf16 a[60:63], v[180:183], v[28:31], a[60:63]
    v_exp_f32 v17, v77
    v_mfma_f32_16x16x32_bf16 a[108:111], v[168:171], v[24:27], a[108:111]
    ds_read_b128 v[44:47], v1 offset:17408
    v_fma_f32 v245, v245, v49, v51
    v_mfma_f32_16x16x32_bf16 a[108:111], v[184:187], v[28:31], a[108:111]
    v_cvt_pk_bf16_f32 v75, v18, v19
    v_cvt_pk_bf16_f32 v230, v244, v245
    v_mfma_f32_16x16x32_bf16 a[156:159], v[172:175], v[24:27], a[156:159]
    s_add_u32 s29, s28, 49152
    v_exp_f32 v18, v78
    v_mfma_f32_16x16x32_bf16 a[156:159], v[188:191], v[28:31], a[156:159]
    s_waitcnt lgkmcnt(2)
    v_add_f32 v8, v8, v16
    v_cvt_f32_i32 v248, v248
    v_mfma_f32_16x16x32_bf16 a[16:19], v[160:163], v[32:35], a[16:19]
    s_sub_u32 s3, s29, 147456
    ds_read_b128 v[24:27], v1 offset:6144
    v_add_f32 v8, v8, v17
    v_mfma_f32_16x16x32_bf16 a[16:19], v[176:179], v[36:39], a[16:19]
    s_add_u32 s27, s27, 24576
    v_exp_f32 v19, v79
    v_mfma_f32_16x16x32_bf16 a[64:67], v[164:167], v[32:35], a[64:67]
    s_min_u32 s29, s29, s3
    v_cvt_f32_i32 v249, v249
    v_cvt_pk_bf16_f32 v76, v16, v17
    v_mfma_f32_16x16x32_bf16 a[64:67], v[180:183], v[36:39], a[64:67]
    s_add_u32 s56, s56, 12288
    v_exp_f32 v16, v108
    v_mfma_f32_16x16x32_bf16 a[112:115], v[168:171], v[32:35], a[112:115]
    ds_read_b128 v[28:31], v1 offset:18432
    v_fma_f32 v248, v248, v48, v50
    v_mfma_f32_16x16x32_bf16 a[112:115], v[184:187], v[36:39], a[112:115]
    v_add_f32 v8, v8, v18
    v_fma_f32 v249, v249, v49, v51
    v_mfma_f32_16x16x32_bf16 a[160:163], v[172:175], v[32:35], a[160:163]
    v_add_f32 v8, v8, v19
    v_cvt_pk_bf16_f32 v234, v248, v249
    v_mfma_f32_16x16x32_bf16 a[160:163], v[188:191], v[36:39], a[160:163]
    s_waitcnt lgkmcnt(2)
    v_exp_f32 v17, v109
    v_mfma_f32_16x16x32_bf16 a[20:23], v[160:163], v[40:43], a[20:23]
    s_mov_b32 m0, s56
    ds_read_b128 v[32:35], v1 offset:7168
    v_cvt_pk_bf16_f32 v77, v18, v19
    v_mfma_f32_16x16x32_bf16 a[20:23], v[176:179], v[44:47], a[20:23]
    s_sub_u32 s3, s29, s28
    v_exp_f32 v18, v110
    v_mfma_f32_16x16x32_bf16 a[68:71], v[164:167], v[40:43], a[68:71]
    v_cvt_f32_i32 v252, v252
    v_add_f32 v8, v8, v16
    v_mfma_f32_16x16x32_bf16 a[68:71], v[180:183], v[44:47], a[68:71]
    v_add_f32 v8, v8, v17
    v_cvt_f32_i32 v253, v253
    v_mfma_f32_16x16x32_bf16 a[116:119], v[168:171], v[40:43], a[116:119]
    ds_read_b128 v[36:39], v1 offset:19456
    v_fma_f32 v252, v252, v48, v50
    v_mfma_f32_16x16x32_bf16 a[116:119], v[184:187], v[44:47], a[116:119]
    buffer_load_dwordx4 v4, s[4:7], s27 offen offset:0 sc1 lds
    v_mfma_f32_16x16x32_bf16 a[164:167], v[172:175], v[40:43], a[164:167]
    s_mov_b32 s28, s29
    v_exp_f32 v19, v111
    v_mfma_f32_16x16x32_bf16 a[164:167], v[188:191], v[44:47], a[164:167]
    s_waitcnt lgkmcnt(2)
    v_cvt_pk_bf16_f32 v78, v16, v17
    v_add_f32 v8, v8, v18
    v_mfma_f32_16x16x32_bf16 a[24:27], v[160:163], v[24:27], a[24:27]
    ds_read_b128 v[40:43], v1 offset:8192
    v_add_f32 v8, v8, v19
    v_mfma_f32_16x16x32_bf16 a[24:27], v[176:179], v[28:31], a[24:27]
    v_cvt_pk_bf16_f32 v79, v18, v19
    v_fma_f32 v253, v253, v49, v51
    v_mfma_f32_16x16x32_bf16 a[72:75], v[164:167], v[24:27], a[72:75]
    v_exp_f32 v16, v80
    v_mfma_f32_16x16x32_bf16 a[72:75], v[180:183], v[28:31], a[72:75]
    v_exp_f32 v17, v81
    v_mfma_f32_16x16x32_bf16 a[120:123], v[168:171], v[24:27], a[120:123]
    ds_read_b128 v[44:47], v1 offset:20480
    v_cvt_pk_bf16_f32 v238, v252, v253
    v_mfma_f32_16x16x32_bf16 a[120:123], v[184:187], v[28:31], a[120:123]
    v_exp_f32 v18, v82
    v_mfma_f32_16x16x32_bf16 a[168:171], v[172:175], v[24:27], a[168:171]
    v_lshlrev_b32 v48, 16, v61
    v_add_f32 v5, v5, v16
    v_mfma_f32_16x16x32_bf16 a[168:171], v[188:191], v[28:31], a[168:171]
    s_waitcnt lgkmcnt(2)
    buffer_load_dwordx4 v4, s[4:7], s27 offen offset:1024 sc1 lds
    v_mfma_f32_16x16x32_bf16 a[28:31], v[160:163], v[32:35], a[28:31]
    ds_read_b128 v[24:27], v1 offset:9216
    v_add_f32 v5, v5, v17
    v_mfma_f32_16x16x32_bf16 a[28:31], v[176:179], v[36:39], a[28:31]
    v_exp_f32 v19, v83
    v_mfma_f32_16x16x32_bf16 a[76:79], v[164:167], v[32:35], a[76:79]
    v_and_b32 v49, s97, v61
    v_cvt_pk_bf16_f32 v80, v16, v17
    v_mfma_f32_16x16x32_bf16 a[76:79], v[180:183], v[36:39], a[76:79]
    v_exp_f32 v16, v112
    v_mfma_f32_16x16x32_bf16 a[124:127], v[168:171], v[32:35], a[124:127]
    ds_read_b128 v[28:31], v1 offset:21504
    v_lshlrev_b32 v50, 16, v63
    v_mfma_f32_16x16x32_bf16 a[124:127], v[184:187], v[36:39], a[124:127]
    v_add_f32 v5, v5, v18
    v_and_b32 v51, s97, v63
    v_mfma_f32_16x16x32_bf16 a[172:175], v[172:175], v[32:35], a[172:175]
    v_add_f32 v5, v5, v19
    v_mul_f32 v48, s38, v48
    v_mfma_f32_16x16x32_bf16 a[172:175], v[188:191], v[36:39], a[172:175]
    s_waitcnt lgkmcnt(2)
    buffer_load_dwordx4 v4, s[4:7], s27 offen offset:2048 sc1 lds
    v_mfma_f32_16x16x32_bf16 a[32:35], v[160:163], v[40:43], a[32:35]
    ds_read_b128 v[32:35], v1 offset:10240
    v_mul_f32 v49, s38, v49
    v_mfma_f32_16x16x32_bf16 a[32:35], v[176:179], v[44:47], a[32:35]
    v_exp_f32 v17, v113
    v_mfma_f32_16x16x32_bf16 a[80:83], v[164:167], v[40:43], a[80:83]
    v_cvt_pk_bf16_f32 v81, v18, v19
    v_mul_f32_e64 v50, -v50, v48
    v_mfma_f32_16x16x32_bf16 a[80:83], v[180:183], v[44:47], a[80:83]
    v_exp_f32 v18, v114
    v_mfma_f32_16x16x32_bf16 a[128:131], v[168:171], v[40:43], a[128:131]
    ds_read_b128 v[36:39], v1 offset:22528
    v_add_f32 v5, v5, v16
    v_mfma_f32_16x16x32_bf16 a[128:131], v[184:187], v[44:47], a[128:131]
    v_add_f32 v5, v5, v17
    v_mul_f32_e64 v51, -v51, v49
    v_mfma_f32_16x16x32_bf16 a[176:179], v[172:175], v[40:43], a[176:179]
    v_exp_f32 v19, v115
    v_mfma_f32_16x16x32_bf16 a[176:179], v[188:191], v[44:47], a[176:179]
    s_waitcnt lgkmcnt(2)
    v_cvt_pk_bf16_f32 v82, v16, v17
    v_add_u32 v2, s3, v2
    v_mfma_f32_16x16x32_bf16 a[36:39], v[160:163], v[24:27], a[36:39]
    ds_read_b128 v[40:43], v1 offset:11264
    v_cvt_f32_i32 v242, v242
    v_mfma_f32_16x16x32_bf16 a[36:39], v[176:179], v[28:31], a[36:39]
    v_exp_f32 v16, v84
    v_mfma_f32_16x16x32_bf16 a[84:87], v[164:167], v[24:27], a[84:87]
    v_add_f32 v5, v5, v18
    v_add_f32 v5, v5, v19
    v_mfma_f32_16x16x32_bf16 a[84:87], v[180:183], v[28:31], a[84:87]
    s_add_u32 s27, s27, 24576
    v_exp_f32 v17, v85
    v_mfma_f32_16x16x32_bf16 a[132:135], v[168:171], v[24:27], a[132:135]
    s_add_u32 s56, s56, 36864
    ds_read_b128 v[44:47], v1 offset:23552
    v_add_u32 v3, s3, v3
    v_mfma_f32_16x16x32_bf16 a[132:135], v[184:187], v[28:31], a[132:135]
    s_sub_u32 s58, s56, 147456
    v_cvt_pk_bf16_f32 v83, v18, v19
    v_cvt_f32_i32 v243, v243
    v_mfma_f32_16x16x32_bf16 a[180:183], v[172:175], v[24:27], a[180:183]
    v_exp_f32 v18, v86
    v_mfma_f32_16x16x32_bf16 a[180:183], v[188:191], v[28:31], a[180:183]
    s_waitcnt lgkmcnt(2)
    v_add_f32 v6, v6, v16
    v_fma_f32 v242, v242, v48, v50
    v_mfma_f32_16x16x32_bf16 a[40:43], v[160:163], v[32:35], a[40:43]
    s_min_u32 s56, s56, s58
    ds_read_b128 v[24:27], v2 offset:0
    v_add_f32 v6, v6, v17
    v_mfma_f32_16x16x32_bf16 a[40:43], v[176:179], v[36:39], a[40:43]
    v_exp_f32 v19, v87
    v_mfma_f32_16x16x32_bf16 a[88:91], v[164:167], v[32:35], a[88:91]
    v_fma_f32 v243, v243, v49, v51
    v_cvt_pk_bf16_f32 v84, v16, v17
    v_mfma_f32_16x16x32_bf16 a[88:91], v[180:183], v[36:39], a[88:91]
    v_exp_f32 v16, v116
    v_mfma_f32_16x16x32_bf16 a[136:139], v[168:171], v[32:35], a[136:139]
    ds_read_b128 v[28:31], v3 offset:0
    v_cvt_pk_bf16_f32 v227, v242, v243
    v_mfma_f32_16x16x32_bf16 a[136:139], v[184:187], v[36:39], a[136:139]
    v_add_f32 v6, v6, v18
    v_add_f32 v6, v6, v19
    v_mfma_f32_16x16x32_bf16 a[184:187], v[172:175], v[32:35], a[184:187]
    v_cvt_f32_i32 v246, v246
    v_cvt_f32_i32 v247, v247
    v_mfma_f32_16x16x32_bf16 a[184:187], v[188:191], v[36:39], a[184:187]
    s_waitcnt lgkmcnt(2)
    v_exp_f32 v17, v117
    v_mfma_f32_16x16x32_bf16 a[44:47], v[160:163], v[40:43], a[44:47]
    ds_read_b128 v[32:35], v2 offset:6144
    v_cvt_pk_bf16_f32 v85, v18, v19
    v_mfma_f32_16x16x32_bf16 a[44:47], v[176:179], v[44:47], a[44:47]
    v_exp_f32 v18, v118
    v_mfma_f32_16x16x32_bf16 a[92:95], v[164:167], v[40:43], a[92:95]
    v_fma_f32 v246, v246, v48, v50
    v_add_f32 v6, v6, v16
    v_mfma_f32_16x16x32_bf16 a[92:95], v[180:183], v[44:47], a[92:95]
    v_add_f32 v6, v6, v17
    v_fma_f32 v247, v247, v49, v51
    v_mfma_f32_16x16x32_bf16 a[140:143], v[168:171], v[40:43], a[140:143]
    s_sub_u32 s31, s31, 1
    ds_read_b128 v[36:39], v3 offset:6144
    v_cvt_pk_bf16_f32 v231, v246, v247
    v_mfma_f32_16x16x32_bf16 a[140:143], v[184:187], v[44:47], a[140:143]
    v_exp_f32 v19, v119
    v_mfma_f32_16x16x32_bf16 a[188:191], v[172:175], v[40:43], a[188:191]
    s_waitcnt lgkmcnt(2)
    s_cmp_lg_u32 s31, 0
    v_cvt_pk_bf16_f32 v86, v16, v17
    v_add_f32 v6, v6, v18
    v_add_f32 v6, v6, v19
    v_cvt_f32_i32 v250, v250
    v_cvt_pk_bf16_f32 v87, v18, v19
    v_cvt_f32_i32 v251, v251
    v_mfma_f32_16x16x32_bf16 a[188:191], v[188:191], v[44:47], a[188:191]
    s_cbranch_scc1 L_loop
    v_mfma_f32_16x16x32_bf16 v[160:163], v[24:27], a[192:195], v[128:131]
    ds_read_b128 v[40:43], v2 offset:128
    v_mfma_f32_16x16x32_bf16 v[160:163], v[28:31], a[196:199], v[160:163]
    v_exp_f32 v16, v88
    v_mfma_f32_16x16x32_bf16 v[164:167], v[24:27], a[216:219], v[132:135]
    ds_read_b128 v[44:47], v3 offset:128
    v_mfma_f32_16x16x32_bf16 v[164:167], v[28:31], a[220:223], v[164:167]
    s_waitcnt lgkmcnt(2)
    v_exp_f32 v17, v89
    v_mfma_f32_16x16x32_bf16 v[96:99], v[32:35], a[192:195], v[128:131]
    ds_read_b128 v[24:27], v2 offset:6272
    v_mfma_f32_16x16x32_bf16 v[96:99], v[36:39], a[196:199], v[96:99]
    s_waitcnt vmcnt(6)
    v_exp_f32 v18, v90
    v_mfma_f32_16x16x32_bf16 v[100:103], v[32:35], a[216:219], v[132:135]
    ds_read_b128 v[28:31], v3 offset:6272
    v_add_f32 v7, v7, v16
    v_mfma_f32_16x16x32_bf16 v[100:103], v[36:39], a[220:223], v[100:103]
    s_waitcnt lgkmcnt(2)
    s_barrier
    v_mfma_f32_16x16x32_bf16 v[160:163], v[40:43], a[200:203], v[160:163]
    s_mov_b32 m0, s26
    ds_read_b128 v[32:35], v2 offset:256
    v_add_f32 v7, v7, v17
    v_mfma_f32_16x16x32_bf16 v[160:163], v[44:47], a[204:207], v[160:163]
    buffer_load_dwordx4 v4, s[4:7], s32 offen offset:0 sc1 lds
    v_mfma_f32_16x16x32_bf16 v[164:167], v[40:43], a[224:227], v[164:167]
    ds_read_b128 v[36:39], v3 offset:256
    v_mfma_f32_16x16x32_bf16 v[164:167], v[44:47], a[228:231], v[164:167]
    s_waitcnt lgkmcnt(2)
    v_exp_f32 v19, v91
    v_mfma_f32_16x16x32_bf16 v[96:99], v[24:27], a[200:203], v[96:99]
    ds_read_b128 v[40:43], v2 offset:6400
    v_cvt_pk_bf16_f32 v88, v16, v17
    v_mfma_f32_16x16x32_bf16 v[96:99], v[28:31], a[204:207], v[96:99]
    v_exp_f32 v16, v120
    v_mfma_f32_16x16x32_bf16 v[100:103], v[24:27], a[224:227], v[100:103]
    ds_read_b128 v[44:47], v3 offset:6400
    v_add_f32 v7, v7, v18
    v_mfma_f32_16x16x32_bf16 v[100:103], v[28:31], a[228:231], v[100:103]
    s_waitcnt lgkmcnt(2)
    buffer_load_dwordx4 v4, s[4:7], s32 offen offset:1024 sc1 lds
    v_mfma_f32_16x16x32_bf16 v[160:163], v[32:35], a[208:211], v[160:163]
    ds_read_b128 v[24:27], v2 offset:12288
    v_add_f32 v7, v7, v19
    v_mfma_f32_16x16x32_bf16 v[160:163], v[36:39], a[212:215], v[160:163]
    v_exp_f32 v17, v121
    v_mfma_f32_16x16x32_bf16 v[164:167], v[32:35], a[232:235], v[164:167]
    ds_read_b128 v[28:31], v3 offset:12288
    v_cvt_pk_bf16_f32 v89, v18, v19
    v_mfma_f32_16x16x32_bf16 v[164:167], v[36:39], a[236:239], v[164:167]
    s_waitcnt lgkmcnt(2)
    v_exp_f32 v18, v122
    v_mfma_f32_16x16x32_bf16 v[96:99], v[40:43], a[208:211], v[96:99]
    ds_read_b128 v[32:35], v2 offset:18432
    v_add_f32 v7, v7, v16
    v_mfma_f32_16x16x32_bf16 v[96:99], v[44:47], a[212:215], v[96:99]
    buffer_load_dwordx4 v4, s[4:7], s32 offen offset:2048 sc1 lds
    v_mfma_f32_16x16x32_bf16 v[100:103], v[40:43], a[232:235], v[100:103]
    ds_read_b128 v[36:39], v3 offset:18432
    v_add_f32 v7, v7, v17
    v_mfma_f32_16x16x32_bf16 v[100:103], v[44:47], a[236:239], v[100:103]
    s_waitcnt lgkmcnt(2)
    v_exp_f32 v19, v123
    v_mfma_f32_16x16x32_bf16 v[168:171], v[24:27], a[192:195], v[128:131]
    ds_read_b128 v[40:43], v2 offset:12416
    v_cvt_pk_bf16_f32 v90, v16, v17
    v_mfma_f32_16x16x32_bf16 v[168:171], v[28:31], a[196:199], v[168:171]
    v_exp_f32 v16, v92
    v_mfma_f32_16x16x32_bf16 v[172:175], v[24:27], a[216:219], v[132:135]
    s_add_u32 s32, s32, 24576
    ds_read_b128 v[44:47], v3 offset:12416
    v_add_f32 v7, v7, v18
    v_mfma_f32_16x16x32_bf16 v[172:175], v[28:31], a[220:223], v[172:175]
    s_waitcnt lgkmcnt(2)
    v_add_f32 v7, v7, v19
    v_mfma_f32_16x16x32_bf16 v[104:107], v[32:35], a[192:195], v[128:131]
    ds_read_b128 v[24:27], v2 offset:18560
    v_mfma_f32_16x16x32_bf16 v[104:107], v[36:39], a[196:199], v[104:107]
    s_add_u32 s26, s26, 12288
    v_exp_f32 v17, v93
    v_mfma_f32_16x16x32_bf16 v[108:111], v[32:35], a[216:219], v[132:135]
    s_add_u32 s29, s30, 49152
    ds_read_b128 v[28:31], v3 offset:18560
    v_cvt_pk_bf16_f32 v91, v18, v19
    v_mfma_f32_16x16x32_bf16 v[108:111], v[36:39], a[220:223], v[108:111]
    s_waitcnt lgkmcnt(2)
    v_exp_f32 v18, v94
    v_mfma_f32_16x16x32_bf16 v[168:171], v[40:43], a[200:203], v[168:171]
    s_sub_u32 s3, s29, 147456
    ds_read_b128 v[32:35], v2 offset:12544
    v_add_f32 v8, v8, v16
    v_mfma_f32_16x16x32_bf16 v[168:171], v[44:47], a[204:207], v[168:171]
    s_mov_b32 m0, s26
    v_add_f32 v8, v8, v17
    s_min_u32 s29, s29, s3
    v_mfma_f32_16x16x32_bf16 v[172:175], v[40:43], a[224:227], v[172:175]
    ds_read_b128 v[36:39], v3 offset:12544
    v_mfma_f32_16x16x32_bf16 v[172:175], v[44:47], a[228:231], v[172:175]
    s_waitcnt lgkmcnt(2)
    v_exp_f32 v19, v95
    v_mfma_f32_16x16x32_bf16 v[104:107], v[24:27], a[200:203], v[104:107]
    ds_read_b128 v[40:43], v2 offset:18688
    v_cvt_pk_bf16_f32 v92, v16, v17
    v_mfma_f32_16x16x32_bf16 v[104:107], v[28:31], a[204:207], v[104:107]
    buffer_load_dwordx4 v4, s[4:7], s32 offen offset:0 sc1 lds
    v_mfma_f32_16x16x32_bf16 v[108:111], v[24:27], a[224:227], v[108:111]
    ds_read_b128 v[44:47], v3 offset:18688
    v_mfma_f32_16x16x32_bf16 v[108:111], v[28:31], a[228:231], v[108:111]
    s_waitcnt lgkmcnt(2)
    v_subrev_u32 v2, 98304, v2
    v_subrev_u32 v3, 98304, v3
    v_mfma_f32_16x16x32_bf16 v[168:171], v[32:35], a[208:211], v[168:171]
    ds_read_b128 v[24:27], v2 offset:0
    v_mfma_f32_16x16x32_bf16 v[168:171], v[36:39], a[212:215], v[168:171]
    v_exp_f32 v16, v124
    v_add_f32 v8, v8, v18
    v_mfma_f32_16x16x32_bf16 v[172:175], v[32:35], a[232:235], v[172:175]
    s_sub_u32 s3, s29, s30
    ds_read_b128 v[28:31], v3 offset:0
    v_add_f32 v8, v8, v19
    v_mfma_f32_16x16x32_bf16 v[172:175], v[36:39], a[236:239], v[172:175]
    s_waitcnt lgkmcnt(2)
    v_exp_f32 v17, v125
    v_cvt_pk_bf16_f32 v93, v18, v19
    v_mfma_f32_16x16x32_bf16 v[104:107], v[40:43], a[208:211], v[104:107]
    ds_read_b128 v[32:35], v2 offset:6144
    v_mfma_f32_16x16x32_bf16 v[104:107], v[44:47], a[212:215], v[104:107]
    buffer_load_dwordx4 v4, s[4:7], s32 offen offset:1024 sc1 lds
    v_mfma_f32_16x16x32_bf16 v[108:111], v[40:43], a[232:235], v[108:111]
    ds_read_b128 v[36:39], v3 offset:6144
    v_mfma_f32_16x16x32_bf16 v[108:111], v[44:47], a[236:239], v[108:111]
    s_waitcnt lgkmcnt(2)
    v_exp_f32 v18, v126
    v_add_f32 v8, v8, v16
    v_mfma_f32_16x16x32_bf16 v[176:179], v[24:27], a[192:195], v[128:131]
    ds_read_b128 v[40:43], v2 offset:128
    v_add_f32 v8, v8, v17
    v_mfma_f32_16x16x32_bf16 v[176:179], v[28:31], a[196:199], v[176:179]
    v_exp_f32 v19, v127
    v_cvt_pk_bf16_f32 v94, v16, v17
    v_mfma_f32_16x16x32_bf16 v[180:183], v[24:27], a[216:219], v[132:135]
    ds_read_b128 v[44:47], v3 offset:128
    v_add_f32 v8, v8, v18
    v_add_f32 v8, v8, v19
    v_cvt_pk_bf16_f32 v95, v18, v19
    v_mfma_f32_16x16x32_bf16 v[180:183], v[28:31], a[220:223], v[180:183]
    s_waitcnt lgkmcnt(2)
    buffer_load_dwordx4 v4, s[4:7], s32 offen offset:2048 sc1 lds
    v_mfma_f32_16x16x32_bf16 v[112:115], v[32:35], a[192:195], v[128:131]
    s_mov_b32 s30, s29
    ds_read_b128 v[24:27], v2 offset:6272
    v_mfma_f32_16x16x32_bf16 v[112:115], v[36:39], a[196:199], v[112:115]
    v_exp_f32 v16, v160
    v_mfma_f32_16x16x32_bf16 v[116:119], v[32:35], a[216:219], v[132:135]
    ds_read_b128 v[28:31], v3 offset:6272
    v_mfma_f32_16x16x32_bf16 v[116:119], v[36:39], a[220:223], v[116:119]
    s_waitcnt lgkmcnt(2)
    v_exp_f32 v17, v161
    v_mfma_f32_16x16x32_bf16 v[176:179], v[40:43], a[200:203], v[176:179]
    ds_read_b128 v[32:35], v2 offset:256
    v_mfma_f32_16x16x32_bf16 v[176:179], v[44:47], a[204:207], v[176:179]
    v_exp_f32 v18, v162
    v_mfma_f32_16x16x32_bf16 v[180:183], v[40:43], a[224:227], v[180:183]
    ds_read_b128 v[36:39], v3 offset:256
    v_add_f32 v5, v5, v16
    v_mfma_f32_16x16x32_bf16 v[180:183], v[44:47], a[228:231], v[180:183]
    s_waitcnt lgkmcnt(2)
    v_add_f32 v5, v5, v17
    v_add_u32 v1, s3, v1
    v_mfma_f32_16x16x32_bf16 v[112:115], v[24:27], a[200:203], v[112:115]
    ds_read_b128 v[40:43], v2 offset:6400
    v_mfma_f32_16x16x32_bf16 v[112:115], v[28:31], a[204:207], v[112:115]
    v_exp_f32 v19, v163
    v_cvt_pk_bf16_f32 v160, v16, v17
    v_mfma_f32_16x16x32_bf16 v[116:119], v[24:27], a[224:227], v[116:119]
    s_add_u32 s32, s32, 24576
    ds_read_b128 v[44:47], v3 offset:6400
    s_add_u32 s26, s26, 36864
    v_mfma_f32_16x16x32_bf16 v[116:119], v[28:31], a[228:231], v[116:119]
    s_waitcnt lgkmcnt(2)
    v_exp_f32 v16, v96
    v_mfma_f32_16x16x32_bf16 v[176:179], v[32:35], a[208:211], v[176:179]
    s_sub_u32 s57, s26, 147456
    ds_read_b128 v[24:27], v2 offset:12288
    v_add_f32 v5, v5, v18
    v_mfma_f32_16x16x32_bf16 v[176:179], v[36:39], a[212:215], v[176:179]
    s_min_u32 s26, s26, s57
    v_add_f32 v5, v5, v19
    v_mfma_f32_16x16x32_bf16 v[180:183], v[32:35], a[232:235], v[180:183]
    ds_read_b128 v[28:31], v3 offset:12288
    v_mfma_f32_16x16x32_bf16 v[180:183], v[36:39], a[236:239], v[180:183]
    s_waitcnt lgkmcnt(2)
    v_exp_f32 v17, v97
    v_cvt_pk_bf16_f32 v161, v18, v19
    v_mfma_f32_16x16x32_bf16 v[112:115], v[40:43], a[208:211], v[112:115]
    ds_read_b128 v[32:35], v2 offset:18432
    v_mfma_f32_16x16x32_bf16 v[112:115], v[44:47], a[212:215], v[112:115]
    v_exp_f32 v18, v98
    v_mfma_f32_16x16x32_bf16 v[116:119], v[40:43], a[232:235], v[116:119]
    ds_read_b128 v[36:39], v3 offset:18432
    v_add_f32 v5, v5, v16
    v_mfma_f32_16x16x32_bf16 v[116:119], v[44:47], a[236:239], v[116:119]
    s_waitcnt lgkmcnt(2)
    v_add_f32 v5, v5, v17
    v_mfma_f32_16x16x32_bf16 v[184:187], v[24:27], a[192:195], v[128:131]
    ds_read_b128 v[40:43], v2 offset:12416
    v_mfma_f32_16x16x32_bf16 v[184:187], v[28:31], a[196:199], v[184:187]
    v_exp_f32 v19, v99
    v_cvt_pk_bf16_f32 v162, v16, v17
    v_mfma_f32_16x16x32_bf16 v[188:191], v[24:27], a[216:219], v[132:135]
    ds_read_b128 v[44:47], v3 offset:12416
    v_mfma_f32_16x16x32_bf16 v[188:191], v[28:31], a[220:223], v[188:191]
    s_waitcnt lgkmcnt(2)
    v_exp_f32 v16, v164
    v_mfma_f32_16x16x32_bf16 v[120:123], v[32:35], a[192:195], v[128:131]
    ds_read_b128 v[24:27], v2 offset:18560
    v_add_f32 v5, v5, v18
    v_mfma_f32_16x16x32_bf16 v[120:123], v[36:39], a[196:199], v[120:123]
    s_waitcnt vmcnt(6)
    v_add_f32 v5, v5, v19
    v_mfma_f32_16x16x32_bf16 v[124:127], v[32:35], a[216:219], v[132:135]
    ds_read_b128 v[28:31], v3 offset:18560
    v_mfma_f32_16x16x32_bf16 v[124:127], v[36:39], a[220:223], v[124:127]
    s_waitcnt lgkmcnt(2)
    s_barrier
    v_mfma_f32_16x16x32_bf16 v[184:187], v[40:43], a[200:203], v[184:187]
    ds_read_b128 v[32:35], v2 offset:12544
    v_mfma_f32_16x16x32_bf16 v[184:187], v[44:47], a[204:207], v[184:187]
    v_exp_f32 v17, v165
    v_cvt_pk_bf16_f32 v163, v18, v19
    v_mfma_f32_16x16x32_bf16 v[188:191], v[40:43], a[224:227], v[188:191]
    ds_read_b128 v[36:39], v3 offset:12544
    v_mfma_f32_16x16x32_bf16 v[188:191], v[44:47], a[228:231], v[188:191]
    s_waitcnt lgkmcnt(2)
    v_exp_f32 v18, v166
    v_add_f32 v6, v6, v16
    v_mfma_f32_16x16x32_bf16 v[120:123], v[24:27], a[200:203], v[120:123]
    ds_read_b128 v[40:43], v2 offset:18688
    v_add_f32 v6, v6, v17
    v_mfma_f32_16x16x32_bf16 v[120:123], v[28:31], a[204:207], v[120:123]
    v_exp_f32 v19, v167
    v_cvt_pk_bf16_f32 v164, v16, v17
    v_mfma_f32_16x16x32_bf16 v[124:127], v[24:27], a[224:227], v[124:127]
    ds_read_b128 v[44:47], v3 offset:18688
    v_mfma_f32_16x16x32_bf16 v[124:127], v[28:31], a[228:231], v[124:127]
    s_waitcnt lgkmcnt(2)
    v_exp_f32 v16, v100
    v_mfma_f32_16x16x32_bf16 v[184:187], v[32:35], a[208:211], v[184:187]
    ds_read_b128 v[24:27], v1 offset:0
    v_add_f32 v6, v6, v18
    v_mfma_f32_16x16x32_bf16 v[184:187], v[36:39], a[212:215], v[184:187]
    v_add_f32 v6, v6, v19
    v_mfma_f32_16x16x32_bf16 v[188:191], v[32:35], a[232:235], v[188:191]
    ds_read_b128 v[28:31], v1 offset:12288
    v_mfma_f32_16x16x32_bf16 v[188:191], v[36:39], a[236:239], v[188:191]
    s_waitcnt lgkmcnt(2)
    v_exp_f32 v17, v101
    v_cvt_pk_bf16_f32 v165, v18, v19
    v_mfma_f32_16x16x32_bf16 v[120:123], v[40:43], a[208:211], v[120:123]
    ds_read_b128 v[32:35], v1 offset:1024
    v_mfma_f32_16x16x32_bf16 v[120:123], v[44:47], a[212:215], v[120:123]
    v_exp_f32 v18, v102
    v_mfma_f32_16x16x32_bf16 v[124:127], v[40:43], a[232:235], v[124:127]
    ds_read_b128 v[36:39], v1 offset:13312
    v_add_f32 v6, v6, v16
    v_mfma_f32_16x16x32_bf16 v[124:127], v[44:47], a[236:239], v[124:127]
    s_waitcnt lgkmcnt(2)
    v_add_f32 v6, v6, v17
    v_exp_f32 v19, v103
    v_cvt_pk_bf16_f32 v166, v16, v17
    v_add_f32 v6, v6, v18
    v_add_f32 v6, v6, v19
    v_cvt_pk_bf16_f32 v167, v18, v19
    v_mfma_f32_16x16x32_bf16 a[0:3], v[64:67], v[24:27], a[0:3]
    s_mov_b32 m0, s56
    ds_read_b128 v[40:43], v1 offset:2048
    v_bfe_u32 v57, v4, 8, 2
    v_mfma_f32_16x16x32_bf16 a[0:3], v[80:83], v[28:31], a[0:3]
    buffer_load_dwordx4 v4, s[4:7], s27 offen offset:0 sc1 lds
    v_mfma_f32_16x16x32_bf16 a[48:51], v[68:71], v[24:27], a[48:51]
    v_exp_f32 v16, v168
    v_mfma_f32_16x16x32_bf16 a[48:51], v[84:87], v[28:31], a[48:51]
    v_exp_f32 v17, v169
    v_mfma_f32_16x16x32_bf16 a[96:99], v[72:75], v[24:27], a[96:99]
    ds_read_b128 v[44:47], v1 offset:14336
    v_mul_u32_u24 v56, 1536, v57
    v_mfma_f32_16x16x32_bf16 a[96:99], v[88:91], v[28:31], a[96:99]
    buffer_load_dwordx4 v4, s[4:7], s27 offen offset:1024 sc1 lds
    v_mfma_f32_16x16x32_bf16 a[144:147], v[76:79], v[24:27], a[144:147]
    v_exp_f32 v18, v170
    v_mfma_f32_16x16x32_bf16 a[144:147], v[92:95], v[28:31], a[144:147]
    s_waitcnt lgkmcnt(2)
    v_add_f32 v5, v5, v16
    v_add_f32 v5, v5, v17
    v_mfma_f32_16x16x32_bf16 a[4:7], v[64:67], v[32:35], a[4:7]
    ds_read_b128 v[24:27], v1 offset:3072
    v_lshlrev_b32 v58, 4, v57
    v_mfma_f32_16x16x32_bf16 a[4:7], v[80:83], v[36:39], a[4:7]
    buffer_load_dwordx4 v4, s[4:7], s27 offen offset:2048 sc1 lds
    v_mfma_f32_16x16x32_bf16 a[52:55], v[68:71], v[32:35], a[52:55]
    v_exp_f32 v19, v171
    v_mfma_f32_16x16x32_bf16 a[52:55], v[84:87], v[36:39], a[52:55]
    s_add_u32 s27, s27, 24576
    v_cvt_pk_bf16_f32 v168, v16, v17
    v_bfe_u32 v57, v4, 4, 4
    v_mfma_f32_16x16x32_bf16 a[100:103], v[72:75], v[32:35], a[100:103]
    ds_read_b128 v[28:31], v1 offset:15360
    v_mfma_f32_16x16x32_bf16 a[100:103], v[88:91], v[36:39], a[100:103]
    s_add_u32 s56, s56, 12288
    v_exp_f32 v16, v104
    v_mfma_f32_16x16x32_bf16 a[148:151], v[76:79], v[32:35], a[148:151]
    v_add_f32 v5, v5, v18
    v_add_f32 v5, v5, v19
    v_mfma_f32_16x16x32_bf16 a[148:151], v[92:95], v[36:39], a[148:151]
    s_waitcnt lgkmcnt(2)
    v_exp_f32 v17, v105
    v_mfma_f32_16x16x32_bf16 a[8:11], v[64:67], v[40:43], a[8:11]
    s_mov_b32 m0, s56
    ds_read_b128 v[32:35], v1 offset:4096
    v_cvt_pk_bf16_f32 v169, v18, v19
    v_mfma_f32_16x16x32_bf16 a[8:11], v[80:83], v[44:47], a[8:11]
    v_exp_f32 v18, v106
    v_mfma_f32_16x16x32_bf16 a[56:59], v[68:71], v[40:43], a[56:59]
    v_add_f32 v5, v5, v16
    v_add_f32 v5, v5, v17
    v_mfma_f32_16x16x32_bf16 a[56:59], v[84:87], v[44:47], a[56:59]
    buffer_load_dwordx4 v4, s[4:7], s27 offen offset:0 sc1 lds
    v_mfma_f32_16x16x32_bf16 a[104:107], v[72:75], v[40:43], a[104:107]
    ds_read_b128 v[36:39], v1 offset:16384
    v_lshl_add_u32 v56, v57, 3, v56
    v_mfma_f32_16x16x32_bf16 a[104:107], v[88:91], v[44:47], a[104:107]
    v_exp_f32 v19, v107
    v_mfma_f32_16x16x32_bf16 a[152:155], v[76:79], v[40:43], a[152:155]
    v_cvt_pk_bf16_f32 v170, v16, v17
    v_mfma_f32_16x16x32_bf16 a[152:155], v[92:95], v[44:47], a[152:155]
    s_waitcnt lgkmcnt(2)
    buffer_load_dwordx4 v4, s[4:7], s27 offen offset:1024 sc1 lds
    v_mfma_f32_16x16x32_bf16 a[12:15], v[64:67], v[24:27], a[12:15]
    ds_read_b128 v[40:43], v1 offset:5120
    v_mfma_f32_16x16x32_bf16 a[12:15], v[80:83], v[28:31], a[12:15]
    v_exp_f32 v16, v172
    v_mfma_f32_16x16x32_bf16 a[60:63], v[68:71], v[24:27], a[60:63]
    v_add_f32 v5, v5, v18
    v_add_f32 v5, v5, v19
    v_mfma_f32_16x16x32_bf16 a[60:63], v[84:87], v[28:31], a[60:63]
    buffer_load_dwordx4 v4, s[4:7], s27 offen offset:2048 sc1 lds
    v_mfma_f32_16x16x32_bf16 a[108:111], v[72:75], v[24:27], a[108:111]
    ds_read_b128 v[44:47], v1 offset:17408
    v_mov_b32 v57, 1.0
    v_mfma_f32_16x16x32_bf16 a[108:111], v[88:91], v[28:31], a[108:111]
    v_exp_f32 v17, v173
    v_mfma_f32_16x16x32_bf16 a[156:159], v[76:79], v[24:27], a[156:159]
    s_add_u32 s27, s27, 24576
    v_cvt_pk_bf16_f32 v171, v18, v19
    v_mfma_f32_16x16x32_bf16 a[156:159], v[92:95], v[28:31], a[156:159]
    s_waitcnt lgkmcnt(2)
    v_exp_f32 v18, v174
    v_mfma_f32_16x16x32_bf16 a[16:19], v[64:67], v[32:35], a[16:19]
    s_add_u32 s56, s56, 36864
    ds_read_b128 v[24:27], v1 offset:6144
    v_add_f32 v6, v6, v16
    v_mfma_f32_16x16x32_bf16 a[16:19], v[80:83], v[36:39], a[16:19]
    v_add_f32 v6, v6, v17
    v_mfma_f32_16x16x32_bf16 a[64:67], v[68:71], v[32:35], a[64:67]
    s_sub_u32 s58, s56, 147456
    v_exp_f32 v19, v175
    v_mfma_f32_16x16x32_bf16 a[64:67], v[84:87], v[36:39], a[64:67]
    s_lshl_b32 s24, s95, 2
    v_cvt_pk_bf16_f32 v172, v16, v17
    v_mfma_f32_16x16x32_bf16 a[112:115], v[72:75], v[32:35], a[112:115]
    s_min_u32 s56, s56, s58
    ds_read_b128 v[28:31], v1 offset:18432
    v_mfma_f32_16x16x32_bf16 a[112:115], v[88:91], v[36:39], a[112:115]
    v_exp_f32 v16, v108
    v_mfma_f32_16x16x32_bf16 a[160:163], v[76:79], v[32:35], a[160:163]
    s_mov_b32 m0, s56
    v_add_f32 v6, v6, v18
    v_add_f32 v6, v6, v19
    v_mfma_f32_16x16x32_bf16 a[160:163], v[92:95], v[36:39], a[160:163]
    s_waitcnt lgkmcnt(2)
    v_exp_f32 v17, v109
    v_mfma_f32_16x16x32_bf16 a[20:23], v[64:67], v[40:43], a[20:23]
    ds_read_b128 v[32:35], v1 offset:7168
    v_cvt_pk_bf16_f32 v173, v18, v19
    v_mfma_f32_16x16x32_bf16 a[20:23], v[80:83], v[44:47], a[20:23]
    buffer_load_dwordx4 v4, s[4:7], s27 offen offset:0 sc1 lds
    v_mfma_f32_16x16x32_bf16 a[68:71], v[68:71], v[40:43], a[68:71]
    v_exp_f32 v18, v110
    v_mfma_f32_16x16x32_bf16 a[68:71], v[84:87], v[44:47], a[68:71]
    s_add_u32 s24, s24, s25
    v_add_f32 v6, v6, v16
    v_add_f32 v6, v6, v17
    v_mfma_f32_16x16x32_bf16 a[116:119], v[72:75], v[40:43], a[116:119]
    ds_read_b128 v[36:39], v1 offset:19456
    v_mfma_f32_16x16x32_bf16 a[116:119], v[88:91], v[44:47], a[116:119]
    buffer_load_dwordx4 v4, s[4:7], s27 offen offset:1024 sc1 lds
    v_mfma_f32_16x16x32_bf16 a[164:167], v[76:79], v[40:43], a[164:167]
    v_exp_f32 v19, v111
    v_mfma_f32_16x16x32_bf16 a[164:167], v[92:95], v[44:47], a[164:167]
    s_waitcnt lgkmcnt(2)
    v_cvt_pk_bf16_f32 v174, v16, v17
    v_add_f32 v6, v6, v18
    v_mfma_f32_16x16x32_bf16 a[24:27], v[64:67], v[24:27], a[24:27]
    ds_read_b128 v[40:43], v1 offset:8192
    v_add_f32 v6, v6, v19
    v_mfma_f32_16x16x32_bf16 a[24:27], v[80:83], v[28:31], a[24:27]
    buffer_load_dwordx4 v4, s[4:7], s27 offen offset:2048 sc1 lds
    v_mfma_f32_16x16x32_bf16 a[72:75], v[68:71], v[24:27], a[72:75]
    v_cvt_pk_bf16_f32 v175, v18, v19
    v_mfma_f32_16x16x32_bf16 a[72:75], v[84:87], v[28:31], a[72:75]
    s_mul_i32 s24, s24, 24576
    v_exp_f32 v16, v176
    v_mfma_f32_16x16x32_bf16 a[120:123], v[72:75], v[24:27], a[120:123]
    ds_read_b128 v[44:47], v1 offset:20480
    v_mfma_f32_16x16x32_bf16 a[120:123], v[88:91], v[28:31], a[120:123]
    s_add_u32 s27, s27, 24576
    v_exp_f32 v17, v177
    v_mfma_f32_16x16x32_bf16 a[168:171], v[76:79], v[24:27], a[168:171]
    v_exp_f32 v18, v178
    v_mfma_f32_16x16x32_bf16 a[168:171], v[92:95], v[28:31], a[168:171]
    s_waitcnt lgkmcnt(2)
    v_add_f32 v5, v5, v16
    v_add_f32 v5, v5, v17
    v_mfma_f32_16x16x32_bf16 a[28:31], v[64:67], v[32:35], a[28:31]
    s_add_u32 s56, s56, 12288
    ds_read_b128 v[24:27], v1 offset:9216
    v_mfma_f32_16x16x32_bf16 a[28:31], v[80:83], v[36:39], a[28:31]
    s_mov_b32 m0, s56
    v_exp_f32 v19, v179
    v_mfma_f32_16x16x32_bf16 a[76:79], v[68:71], v[32:35], a[76:79]
    v_cvt_pk_bf16_f32 v176, v16, v17
    v_mfma_f32_16x16x32_bf16 a[76:79], v[84:87], v[36:39], a[76:79]
    s_add_u32 s40, s24, 6144
    v_exp_f32 v16, v112
    v_mfma_f32_16x16x32_bf16 a[124:127], v[72:75], v[32:35], a[124:127]
    ds_read_b128 v[28:31], v1 offset:21504
    v_add_f32 v5, v5, v18
    v_mfma_f32_16x16x32_bf16 a[124:127], v[88:91], v[36:39], a[124:127]
    buffer_load_dwordx4 v4, s[4:7], s27 offen offset:0 sc1 lds
    v_mfma_f32_16x16x32_bf16 a[172:175], v[76:79], v[32:35], a[172:175]
    v_add_f32 v5, v5, v19
    v_mfma_f32_16x16x32_bf16 a[172:175], v[92:95], v[36:39], a[172:175]
    s_waitcnt lgkmcnt(2)
    v_exp_f32 v17, v113
    v_mfma_f32_16x16x32_bf16 a[32:35], v[64:67], v[40:43], a[32:35]
    ds_read_b128 v[32:35], v1 offset:10240
    v_cvt_pk_bf16_f32 v177, v18, v19
    v_mfma_f32_16x16x32_bf16 a[32:35], v[80:83], v[44:47], a[32:35]
    buffer_load_dwordx4 v4, s[4:7], s27 offen offset:1024 sc1 lds
    v_mfma_f32_16x16x32_bf16 a[80:83], v[68:71], v[40:43], a[80:83]
    v_exp_f32 v18, v114
    v_mfma_f32_16x16x32_bf16 a[80:83], v[84:87], v[44:47], a[80:83]
    s_add_u32 s41, s24, 12288
    v_add_f32 v5, v5, v16
    v_add_f32 v5, v5, v17
    v_mfma_f32_16x16x32_bf16 a[128:131], v[72:75], v[40:43], a[128:131]
    ds_read_b128 v[36:39], v1 offset:22528
    v_mfma_f32_16x16x32_bf16 a[128:131], v[88:91], v[44:47], a[128:131]
    buffer_load_dwordx4 v4, s[4:7], s27 offen offset:2048 sc1 lds
    v_mfma_f32_16x16x32_bf16 a[176:179], v[76:79], v[40:43], a[176:179]
    v_exp_f32 v19, v115
    v_mfma_f32_16x16x32_bf16 a[176:179], v[92:95], v[44:47], a[176:179]
    s_waitcnt lgkmcnt(2)
    v_cvt_pk_bf16_f32 v178, v16, v17
    v_mfma_f32_16x16x32_bf16 a[36:39], v[64:67], v[24:27], a[36:39]
    ds_read_b128 v[40:43], v1 offset:11264
    v_mfma_f32_16x16x32_bf16 a[36:39], v[80:83], v[28:31], a[36:39]
    v_exp_f32 v16, v180
    v_mfma_f32_16x16x32_bf16 a[84:87], v[68:71], v[24:27], a[84:87]
    v_add_f32 v5, v5, v18
    v_add_f32 v5, v5, v19
    v_mfma_f32_16x16x32_bf16 a[84:87], v[84:87], v[28:31], a[84:87]
    s_add_u32 s27, s27, 24576
    v_exp_f32 v17, v181
    v_mfma_f32_16x16x32_bf16 a[132:135], v[72:75], v[24:27], a[132:135]
    s_add_u32 s56, s56, 36864
    ds_read_b128 v[44:47], v1 offset:23552
    v_cvt_pk_bf16_f32 v179, v18, v19
    v_mfma_f32_16x16x32_bf16 a[132:135], v[88:91], v[28:31], a[132:135]
    s_waitcnt lgkmcnt(2)
    v_exp_f32 v18, v182
    v_mfma_f32_16x16x32_bf16 a[180:183], v[76:79], v[24:27], a[180:183]
    s_waitcnt vmcnt(12)
    v_add_f32 v6, v6, v16
    v_add_f32 v6, v6, v17
    v_mfma_f32_16x16x32_bf16 a[180:183], v[92:95], v[28:31], a[180:183]
    s_barrier
    v_add_u32 v2, 49152, v2
    v_add_u32 v3, 49152, v3
    v_mfma_f32_16x16x32_bf16 a[40:43], v[64:67], v[32:35], a[40:43]
    s_sub_u32 s58, s56, 147456
    ds_read_b128 v[24:27], v2 offset:0
    s_add_u32 s42, s24, 18432
    v_mfma_f32_16x16x32_bf16 a[40:43], v[80:83], v[36:39], a[40:43]
    s_min_u32 s56, s56, s58
    v_exp_f32 v19, v183
    v_mfma_f32_16x16x32_bf16 a[88:91], v[68:71], v[32:35], a[88:91]
    v_cvt_pk_bf16_f32 v180, v16, v17
    v_mfma_f32_16x16x32_bf16 a[88:91], v[84:87], v[36:39], a[88:91]
    v_exp_f32 v16, v116
    v_mfma_f32_16x16x32_bf16 a[136:139], v[72:75], v[32:35], a[136:139]
    ds_read_b128 v[28:31], v3 offset:0
    v_add_f32 v6, v6, v18
    v_mfma_f32_16x16x32_bf16 a[136:139], v[88:91], v[36:39], a[136:139]
    v_add_f32 v6, v6, v19
    v_mfma_f32_16x16x32_bf16 a[184:187], v[76:79], v[32:35], a[184:187]
    v_exp_f32 v17, v117
    v_mfma_f32_16x16x32_bf16 a[184:187], v[92:95], v[36:39], a[184:187]
    s_waitcnt lgkmcnt(2)
    v_cvt_pk_bf16_f32 v181, v18, v19
    v_mfma_f32_16x16x32_bf16 a[44:47], v[64:67], v[40:43], a[44:47]
    ds_read_b128 v[32:35], v2 offset:6144
    v_mfma_f32_16x16x32_bf16 a[44:47], v[80:83], v[44:47], a[44:47]
    v_exp_f32 v18, v118
    v_mfma_f32_16x16x32_bf16 a[92:95], v[68:71], v[40:43], a[92:95]
    v_add_f32 v6, v6, v16
    v_add_f32 v6, v6, v17
    v_mfma_f32_16x16x32_bf16 a[92:95], v[84:87], v[44:47], a[92:95]
    v_exp_f32 v19, v119
    v_mfma_f32_16x16x32_bf16 a[140:143], v[72:75], v[40:43], a[140:143]
    ds_read_b128 v[36:39], v3 offset:6144
    v_cvt_pk_bf16_f32 v182, v16, v17
    v_mfma_f32_16x16x32_bf16 a[140:143], v[88:91], v[44:47], a[140:143]
    v_add_f32 v6, v6, v18
    v_add_f32 v6, v6, v19
    v_mfma_f32_16x16x32_bf16 a[188:191], v[76:79], v[40:43], a[188:191]
    v_cvt_pk_bf16_f32 v183, v18, v19
    v_mfma_f32_16x16x32_bf16 a[188:191], v[92:95], v[44:47], a[188:191]
    s_waitcnt lgkmcnt(2)
    v_mfma_f32_16x16x32_bf16 v[64:67], v[24:27], a[192:195], v[128:131]
    ds_read_b128 v[40:43], v2 offset:128
    v_mfma_f32_16x16x32_bf16 v[64:67], v[28:31], a[196:199], v[64:67]
    v_exp_f32 v16, v184
    v_mfma_f32_16x16x32_bf16 v[68:71], v[24:27], a[216:219], v[132:135]
    ds_read_b128 v[44:47], v3 offset:128
    v_mfma_f32_16x16x32_bf16 v[68:71], v[28:31], a[220:223], v[68:71]
    s_waitcnt lgkmcnt(2)
    v_exp_f32 v17, v185
    v_mfma_f32_16x16x32_bf16 v[96:99], v[32:35], a[192:195], v[128:131]
    ds_read_b128 v[24:27], v2 offset:6272
    v_mfma_f32_16x16x32_bf16 v[96:99], v[36:39], a[196:199], v[96:99]
    v_exp_f32 v18, v186
    v_mfma_f32_16x16x32_bf16 v[100:103], v[32:35], a[216:219], v[132:135]
    ds_read_b128 v[28:31], v3 offset:6272
    v_add_f32 v5, v5, v16
    v_mfma_f32_16x16x32_bf16 v[100:103], v[36:39], a[220:223], v[100:103]
    s_waitcnt lgkmcnt(2)
    v_add_f32 v5, v5, v17
    v_mfma_f32_16x16x32_bf16 v[64:67], v[40:43], a[200:203], v[64:67]
    ds_read_b128 v[32:35], v2 offset:256
    v_mfma_f32_16x16x32_bf16 v[64:67], v[44:47], a[204:207], v[64:67]
    v_exp_f32 v19, v187
    v_mfma_f32_16x16x32_bf16 v[68:71], v[40:43], a[224:227], v[68:71]
    ds_read_b128 v[36:39], v3 offset:256
    v_cvt_pk_bf16_f32 v184, v16, v17
    v_mfma_f32_16x16x32_bf16 v[68:71], v[44:47], a[228:231], v[68:71]
    s_waitcnt lgkmcnt(2)
    v_exp_f32 v16, v120
    v_mfma_f32_16x16x32_bf16 v[96:99], v[24:27], a[200:203], v[96:99]
    ds_read_b128 v[40:43], v2 offset:6400
    v_add_f32 v5, v5, v18
    v_mfma_f32_16x16x32_bf16 v[96:99], v[28:31], a[204:207], v[96:99]
    s_waitcnt vmcnt(0)
    v_add_f32 v5, v5, v19
    v_mfma_f32_16x16x32_bf16 v[100:103], v[24:27], a[224:227], v[100:103]
    ds_read_b128 v[44:47], v3 offset:6400
    v_mfma_f32_16x16x32_bf16 v[100:103], v[28:31], a[228:231], v[100:103]
    s_waitcnt lgkmcnt(2)
    s_barrier
    v_mfma_f32_16x16x32_bf16 v[64:67], v[32:35], a[208:211], v[64:67]
    s_mov_b32 m0, s56
    ds_read_b128 v[24:27], v2 offset:12288
    v_mfma_f32_16x16x32_bf16 v[64:67], v[36:39], a[212:215], v[64:67]
    buffer_load_dwordx4 v4, s[4:7], s27 offen offset:0 sc1 lds
    v_mfma_f32_16x16x32_bf16 v[68:71], v[32:35], a[232:235], v[68:71]
    ds_read_b128 v[28:31], v3 offset:12288
    v_mfma_f32_16x16x32_bf16 v[68:71], v[36:39], a[236:239], v[68:71]
    s_waitcnt lgkmcnt(2)
    v_exp_f32 v17, v121
    v_cvt_pk_bf16_f32 v185, v18, v19
    v_mfma_f32_16x16x32_bf16 v[96:99], v[40:43], a[208:211], v[96:99]
    ds_read_b128 v[32:35], v2 offset:18432
    v_mfma_f32_16x16x32_bf16 v[96:99], v[44:47], a[212:215], v[96:99]
    buffer_load_dwordx4 v4, s[4:7], s27 offen offset:1024 sc1 lds
    v_mfma_f32_16x16x32_bf16 v[100:103], v[40:43], a[232:235], v[100:103]
    ds_read_b128 v[36:39], v3 offset:18432
    v_mfma_f32_16x16x32_bf16 v[100:103], v[44:47], a[236:239], v[100:103]
    s_waitcnt lgkmcnt(2)
    v_exp_f32 v18, v122
    v_add_f32 v5, v5, v16
    v_mfma_f32_16x16x32_bf16 v[72:75], v[24:27], a[192:195], v[128:131]
    ds_read_b128 v[40:43], v2 offset:12416
    v_add_f32 v5, v5, v17
    v_mfma_f32_16x16x32_bf16 v[72:75], v[28:31], a[196:199], v[72:75]
    v_exp_f32 v19, v123
    v_cvt_pk_bf16_f32 v186, v16, v17
    v_mfma_f32_16x16x32_bf16 v[76:79], v[24:27], a[216:219], v[132:135]
    ds_read_b128 v[44:47], v3 offset:12416
    v_mfma_f32_16x16x32_bf16 v[76:79], v[28:31], a[220:223], v[76:79]
    s_waitcnt lgkmcnt(2)
    buffer_load_dwordx4 v4, s[4:7], s27 offen offset:2048 sc1 lds
    v_mfma_f32_16x16x32_bf16 v[104:107], v[32:35], a[192:195], v[128:131]
    ds_read_b128 v[24:27], v2 offset:18560
    v_mfma_f32_16x16x32_bf16 v[104:107], v[36:39], a[196:199], v[104:107]
    v_exp_f32 v16, v188
    v_add_f32 v5, v5, v18
    v_mfma_f32_16x16x32_bf16 v[108:111], v[32:35], a[216:219], v[132:135]
    ds_read_b128 v[28:31], v3 offset:18560
    v_add_f32 v5, v5, v19
    v_mfma_f32_16x16x32_bf16 v[108:111], v[36:39], a[220:223], v[108:111]
    s_waitcnt lgkmcnt(2)
    v_exp_f32 v17, v189
    v_cvt_pk_bf16_f32 v187, v18, v19
    v_mfma_f32_16x16x32_bf16 v[72:75], v[40:43], a[200:203], v[72:75]
    s_add_u32 s27, s27, 24576
    ds_read_b128 v[32:35], v2 offset:12544
    v_mfma_f32_16x16x32_bf16 v[72:75], v[44:47], a[204:207], v[72:75]
    v_exp_f32 v18, v190
    v_mfma_f32_16x16x32_bf16 v[76:79], v[40:43], a[224:227], v[76:79]
    s_add_u32 s56, s56, 12288
    ds_read_b128 v[36:39], v3 offset:12544
    v_add_f32 v6, v6, v16
    v_mfma_f32_16x16x32_bf16 v[76:79], v[44:47], a[228:231], v[76:79]
    s_waitcnt lgkmcnt(2)
    v_add_f32 v6, v6, v17
    v_mfma_f32_16x16x32_bf16 v[104:107], v[24:27], a[200:203], v[104:107]
    ds_read_b128 v[40:43], v2 offset:18688
    v_mfma_f32_16x16x32_bf16 v[104:107], v[28:31], a[204:207], v[104:107]
    v_exp_f32 v19, v191
    v_cvt_pk_bf16_f32 v188, v16, v17
    v_mfma_f32_16x16x32_bf16 v[108:111], v[24:27], a[224:227], v[108:111]
    s_mov_b32 m0, s56
    ds_read_b128 v[44:47], v3 offset:18688
    v_mfma_f32_16x16x32_bf16 v[108:111], v[28:31], a[228:231], v[108:111]
    s_waitcnt lgkmcnt(2)
    v_add_u32 v2, 49152, v2
    v_add_u32 v3, 49152, v3
    v_mfma_f32_16x16x32_bf16 v[72:75], v[32:35], a[208:211], v[72:75]
    ds_read_b128 v[24:27], v2 offset:0
    v_mfma_f32_16x16x32_bf16 v[72:75], v[36:39], a[212:215], v[72:75]
    buffer_load_dwordx4 v4, s[4:7], s27 offen offset:0 sc1 lds
    v_mfma_f32_16x16x32_bf16 v[76:79], v[32:35], a[232:235], v[76:79]
    ds_read_b128 v[28:31], v3 offset:0
    v_mfma_f32_16x16x32_bf16 v[76:79], v[36:39], a[236:239], v[76:79]
    s_waitcnt lgkmcnt(2)
    v_exp_f32 v16, v124
    v_add_f32 v6, v6, v18
    v_mfma_f32_16x16x32_bf16 v[104:107], v[40:43], a[208:211], v[104:107]
    ds_read_b128 v[32:35], v2 offset:6144
    v_add_f32 v6, v6, v19
    v_mfma_f32_16x16x32_bf16 v[104:107], v[44:47], a[212:215], v[104:107]
    v_exp_f32 v17, v125
    v_cvt_pk_bf16_f32 v189, v18, v19
    v_mfma_f32_16x16x32_bf16 v[108:111], v[40:43], a[232:235], v[108:111]
    ds_read_b128 v[36:39], v3 offset:6144
    v_mfma_f32_16x16x32_bf16 v[108:111], v[44:47], a[236:239], v[108:111]
    s_waitcnt lgkmcnt(2)
    buffer_load_dwordx4 v4, s[4:7], s27 offen offset:1024 sc1 lds
    v_mfma_f32_16x16x32_bf16 v[80:83], v[24:27], a[240:243], v[136:139]
    ds_read_b128 v[40:43], v2 offset:128
    v_mfma_f32_16x16x32_bf16 v[80:83], v[28:31], a[244:247], v[80:83]
    v_exp_f32 v18, v126
    v_add_f32 v6, v6, v16
    v_mfma_f32_16x16x32_bf16 v[84:87], v[24:27], v[200:203], v[140:143]
    ds_read_b128 v[44:47], v3 offset:128
    v_add_f32 v6, v6, v17
    v_exp_f32 v19, v127
    v_cvt_pk_bf16_f32 v190, v16, v17
    v_add_f32 v6, v6, v18
    v_add_f32 v6, v6, v19
    v_cvt_pk_bf16_f32 v191, v18, v19
    v_mfma_f32_16x16x32_bf16 v[84:87], v[28:31], v[204:207], v[84:87]
    s_waitcnt lgkmcnt(2)
    v_exp_f32 v16, v64
    v_mfma_f32_16x16x32_bf16 v[112:115], v[32:35], a[240:243], v[136:139]
    ds_read_b128 v[24:27], v2 offset:6272
    v_mfma_f32_16x16x32_bf16 v[112:115], v[36:39], a[244:247], v[112:115]
    buffer_load_dwordx4 v4, s[4:7], s27 offen offset:2048 sc1 lds
    v_mfma_f32_16x16x32_bf16 v[116:119], v[32:35], v[200:203], v[140:143]
    ds_read_b128 v[28:31], v3 offset:6272
    v_mfma_f32_16x16x32_bf16 v[116:119], v[36:39], v[204:207], v[116:119]
    s_waitcnt lgkmcnt(2)
    v_exp_f32 v17, v65
    v_mfma_f32_16x16x32_bf16 v[80:83], v[40:43], a[248:251], v[80:83]
    ds_read_b128 v[32:35], v2 offset:256
    v_mfma_f32_16x16x32_bf16 v[80:83], v[44:47], a[252:255], v[80:83]
    v_exp_f32 v18, v66
    v_mfma_f32_16x16x32_bf16 v[84:87], v[40:43], v[208:211], v[84:87]
    ds_read_b128 v[36:39], v3 offset:256
    v_add_f32 v5, v5, v16
    v_mfma_f32_16x16x32_bf16 v[84:87], v[44:47], v[212:215], v[84:87]
    s_waitcnt lgkmcnt(2)
    v_add_f32 v5, v5, v17
    v_mfma_f32_16x16x32_bf16 v[112:115], v[24:27], a[248:251], v[112:115]
    ds_read_b128 v[40:43], v2 offset:6400
    v_mfma_f32_16x16x32_bf16 v[112:115], v[28:31], a[252:255], v[112:115]
    v_exp_f32 v19, v67
    v_cvt_pk_bf16_f32 v64, v16, v17
    v_mfma_f32_16x16x32_bf16 v[116:119], v[24:27], v[208:211], v[116:119]
    s_add_u32 s27, s27, 24576
    ds_read_b128 v[44:47], v3 offset:6400
    s_add_u32 s56, s56, 36864
    v_mfma_f32_16x16x32_bf16 v[116:119], v[28:31], v[212:215], v[116:119]
    s_waitcnt lgkmcnt(2)
    v_exp_f32 v16, v96
    v_mfma_f32_16x16x32_bf16 v[80:83], v[32:35], v[192:195], v[80:83]
    s_sub_u32 s58, s56, 147456
    ds_read_b128 v[24:27], v2 offset:12288
    v_add_f32 v5, v5, v18
    v_mfma_f32_16x16x32_bf16 v[80:83], v[36:39], v[196:199], v[80:83]
    s_min_u32 s56, s56, s58
    v_add_f32 v5, v5, v19
    v_mfma_f32_16x16x32_bf16 v[84:87], v[32:35], v[216:219], v[84:87]
    ds_read_b128 v[28:31], v3 offset:12288
    v_mfma_f32_16x16x32_bf16 v[84:87], v[36:39], v[220:223], v[84:87]
    s_waitcnt lgkmcnt(2)
    v_exp_f32 v17, v97
    v_cvt_pk_bf16_f32 v65, v18, v19
    v_mfma_f32_16x16x32_bf16 v[112:115], v[40:43], v[192:195], v[112:115]
    ds_read_b128 v[32:35], v2 offset:18432
    v_mfma_f32_16x16x32_bf16 v[112:115], v[44:47], v[196:199], v[112:115]
    v_exp_f32 v18, v98
    v_mfma_f32_16x16x32_bf16 v[116:119], v[40:43], v[216:219], v[116:119]
    ds_read_b128 v[36:39], v3 offset:18432
    v_add_f32 v5, v5, v16
    v_mfma_f32_16x16x32_bf16 v[116:119], v[44:47], v[220:223], v[116:119]
    s_waitcnt lgkmcnt(2)
    v_add_f32 v5, v5, v17
    v_mfma_f32_16x16x32_bf16 v[88:91], v[24:27], a[240:243], v[136:139]
    ds_read_b128 v[40:43], v2 offset:12416
    v_mfma_f32_16x16x32_bf16 v[88:91], v[28:31], a[244:247], v[88:91]
    v_exp_f32 v19, v99
    v_cvt_pk_bf16_f32 v66, v16, v17
    v_mfma_f32_16x16x32_bf16 v[92:95], v[24:27], v[200:203], v[140:143]
    ds_read_b128 v[44:47], v3 offset:12416
    v_mfma_f32_16x16x32_bf16 v[92:95], v[28:31], v[204:207], v[92:95]
    s_waitcnt lgkmcnt(2)
    v_exp_f32 v16, v68
    v_mfma_f32_16x16x32_bf16 v[120:123], v[32:35], a[240:243], v[136:139]
    ds_read_b128 v[24:27], v2 offset:18560
    v_add_f32 v5, v5, v18
    v_mfma_f32_16x16x32_bf16 v[120:123], v[36:39], a[244:247], v[120:123]
    v_add_f32 v5, v5, v19
    v_mfma_f32_16x16x32_bf16 v[124:127], v[32:35], v[200:203], v[140:143]
    ds_read_b128 v[28:31], v3 offset:18560
    v_mfma_f32_16x16x32_bf16 v[124:127], v[36:39], v[204:207], v[124:127]
    s_waitcnt lgkmcnt(2)
    v_exp_f32 v17, v69
    v_cvt_pk_bf16_f32 v67, v18, v19
    v_mfma_f32_16x16x32_bf16 v[88:91], v[40:43], a[248:251], v[88:91]
    ds_read_b128 v[32:35], v2 offset:12544
    v_mfma_f32_16x16x32_bf16 v[88:91], v[44:47], a[252:255], v[88:91]
    v_exp_f32 v18, v70
    v_mfma_f32_16x16x32_bf16 v[92:95], v[40:43], v[208:211], v[92:95]
    ds_read_b128 v[36:39], v3 offset:12544
    v_add_f32 v6, v6, v16
    v_mfma_f32_16x16x32_bf16 v[92:95], v[44:47], v[212:215], v[92:95]
    s_waitcnt lgkmcnt(2)
    v_add_f32 v6, v6, v17
    v_mfma_f32_16x16x32_bf16 v[120:123], v[24:27], a[248:251], v[120:123]
    ds_read_b128 v[40:43], v2 offset:18688
    v_mfma_f32_16x16x32_bf16 v[120:123], v[28:31], a[252:255], v[120:123]
    v_exp_f32 v19, v71
    v_cvt_pk_bf16_f32 v68, v16, v17
    v_mfma_f32_16x16x32_bf16 v[124:127], v[24:27], v[208:211], v[124:127]
    ds_read_b128 v[44:47], v3 offset:18688
    v_mfma_f32_16x16x32_bf16 v[124:127], v[28:31], v[212:215], v[124:127]
    s_waitcnt lgkmcnt(2)
    v_add_u32 v1, 49152, v1
    v_exp_f32 v16, v100
    v_mfma_f32_16x16x32_bf16 v[88:91], v[32:35], v[192:195], v[88:91]
    ds_read_b128 v[24:27], v1 offset:0
    v_add_f32 v6, v6, v18
    v_mfma_f32_16x16x32_bf16 v[88:91], v[36:39], v[196:199], v[88:91]
    v_add_f32 v6, v6, v19
    v_mfma_f32_16x16x32_bf16 v[92:95], v[32:35], v[216:219], v[92:95]
    ds_read_b128 v[28:31], v1 offset:12288
    v_mfma_f32_16x16x32_bf16 v[92:95], v[36:39], v[220:223], v[92:95]
    s_waitcnt lgkmcnt(2)
    v_exp_f32 v17, v101
    v_cvt_pk_bf16_f32 v69, v18, v19
    v_mfma_f32_16x16x32_bf16 v[120:123], v[40:43], v[192:195], v[120:123]
    ds_read_b128 v[32:35], v1 offset:1024
    v_mfma_f32_16x16x32_bf16 v[120:123], v[44:47], v[196:199], v[120:123]
    v_exp_f32 v18, v102
    v_mfma_f32_16x16x32_bf16 v[124:127], v[40:43], v[216:219], v[124:127]
    ds_read_b128 v[36:39], v1 offset:13312
    v_add_f32 v6, v6, v16
    v_mfma_f32_16x16x32_bf16 v[124:127], v[44:47], v[220:223], v[124:127]
    s_waitcnt lgkmcnt(2)
    v_add_f32 v6, v6, v17
    v_exp_f32 v19, v103
    v_cvt_pk_bf16_f32 v70, v16, v17
    v_add_f32 v6, v6, v18
    v_add_f32 v6, v6, v19
    v_cvt_pk_bf16_f32 v71, v18, v19
    v_mfma_f32_16x16x32_bf16 a[0:3], v[160:163], v[24:27], a[0:3]
    ds_read_b128 v[40:43], v1 offset:2048
    v_mfma_f32_16x16x32_bf16 a[0:3], v[168:171], v[28:31], a[0:3]
    v_exp_f32 v16, v72
    v_mfma_f32_16x16x32_bf16 a[48:51], v[164:167], v[24:27], a[48:51]
    ds_read_b128 v[44:47], v1 offset:14336
    v_mfma_f32_16x16x32_bf16 a[48:51], v[172:175], v[28:31], a[48:51]
    s_waitcnt lgkmcnt(2)
    v_exp_f32 v17, v73
    v_mfma_f32_16x16x32_bf16 a[4:7], v[160:163], v[32:35], a[4:7]
    ds_read_b128 v[24:27], v1 offset:3072
    v_mfma_f32_16x16x32_bf16 a[4:7], v[168:171], v[36:39], a[4:7]
    v_exp_f32 v18, v74
    v_mfma_f32_16x16x32_bf16 a[52:55], v[164:167], v[32:35], a[52:55]
    ds_read_b128 v[28:31], v1 offset:15360
    v_add_f32 v5, v5, v16
    v_mfma_f32_16x16x32_bf16 a[52:55], v[172:175], v[36:39], a[52:55]
    s_waitcnt lgkmcnt(2)
    v_add_f32 v5, v5, v17
    v_mfma_f32_16x16x32_bf16 a[8:11], v[160:163], v[40:43], a[8:11]
    ds_read_b128 v[32:35], v1 offset:4096
    v_mfma_f32_16x16x32_bf16 a[8:11], v[168:171], v[44:47], a[8:11]
    v_exp_f32 v19, v75
    v_mfma_f32_16x16x32_bf16 a[56:59], v[164:167], v[40:43], a[56:59]
    ds_read_b128 v[36:39], v1 offset:16384
    v_cvt_pk_bf16_f32 v72, v16, v17
    v_mfma_f32_16x16x32_bf16 a[56:59], v[172:175], v[44:47], a[56:59]
    s_waitcnt lgkmcnt(2)
    v_exp_f32 v16, v104
    v_mfma_f32_16x16x32_bf16 a[12:15], v[160:163], v[24:27], a[12:15]
    ds_read_b128 v[40:43], v1 offset:5120
    v_add_f32 v5, v5, v18
    v_mfma_f32_16x16x32_bf16 a[12:15], v[168:171], v[28:31], a[12:15]
    v_add_f32 v5, v5, v19
    v_mfma_f32_16x16x32_bf16 a[60:63], v[164:167], v[24:27], a[60:63]
    ds_read_b128 v[44:47], v1 offset:17408
    v_mfma_f32_16x16x32_bf16 a[60:63], v[172:175], v[28:31], a[60:63]
    s_waitcnt lgkmcnt(2)
    v_exp_f32 v17, v105
    v_mfma_f32_16x16x32_bf16 a[16:19], v[160:163], v[32:35], a[16:19]
    ds_read_b128 v[24:27], v1 offset:6144
    v_cvt_pk_bf16_f32 v73, v18, v19
    v_mfma_f32_16x16x32_bf16 a[16:19], v[168:171], v[36:39], a[16:19]
    v_exp_f32 v18, v106
    v_mfma_f32_16x16x32_bf16 a[64:67], v[164:167], v[32:35], a[64:67]
    ds_read_b128 v[28:31], v1 offset:18432
    v_add_f32 v5, v5, v16
    v_mfma_f32_16x16x32_bf16 a[64:67], v[172:175], v[36:39], a[64:67]
    s_waitcnt lgkmcnt(2)
    v_add_f32 v5, v5, v17
    v_mfma_f32_16x16x32_bf16 a[20:23], v[160:163], v[40:43], a[20:23]
    ds_read_b128 v[32:35], v1 offset:7168
    v_mfma_f32_16x16x32_bf16 a[20:23], v[168:171], v[44:47], a[20:23]
    v_exp_f32 v19, v107
    v_mfma_f32_16x16x32_bf16 a[68:71], v[164:167], v[40:43], a[68:71]
    ds_read_b128 v[36:39], v1 offset:19456
    v_cvt_pk_bf16_f32 v74, v16, v17
    v_mfma_f32_16x16x32_bf16 a[68:71], v[172:175], v[44:47], a[68:71]
    s_waitcnt lgkmcnt(2)
    v_exp_f32 v16, v76
    v_mfma_f32_16x16x32_bf16 a[24:27], v[160:163], v[24:27], a[24:27]
    ds_read_b128 v[40:43], v1 offset:8192
    v_add_f32 v5, v5, v18
    v_mfma_f32_16x16x32_bf16 a[24:27], v[168:171], v[28:31], a[24:27]
    v_add_f32 v5, v5, v19
    v_mfma_f32_16x16x32_bf16 a[72:75], v[164:167], v[24:27], a[72:75]
    ds_read_b128 v[44:47], v1 offset:20480
    v_mfma_f32_16x16x32_bf16 a[72:75], v[172:175], v[28:31], a[72:75]
    s_waitcnt lgkmcnt(2)
    v_exp_f32 v17, v77
    v_mfma_f32_16x16x32_bf16 a[28:31], v[160:163], v[32:35], a[28:31]
    ds_read_b128 v[24:27], v1 offset:9216
    v_cvt_pk_bf16_f32 v75, v18, v19
    v_mfma_f32_16x16x32_bf16 a[28:31], v[168:171], v[36:39], a[28:31]
    v_exp_f32 v18, v78
    v_mfma_f32_16x16x32_bf16 a[76:79], v[164:167], v[32:35], a[76:79]
    ds_read_b128 v[28:31], v1 offset:21504
    v_add_f32 v6, v6, v16
    v_mfma_f32_16x16x32_bf16 a[76:79], v[172:175], v[36:39], a[76:79]
    s_waitcnt lgkmcnt(2)
    v_add_f32 v6, v6, v17
    v_mfma_f32_16x16x32_bf16 a[32:35], v[160:163], v[40:43], a[32:35]
    ds_read_b128 v[32:35], v1 offset:10240
    v_mfma_f32_16x16x32_bf16 a[32:35], v[168:171], v[44:47], a[32:35]
    v_exp_f32 v19, v79
    v_mfma_f32_16x16x32_bf16 a[80:83], v[164:167], v[40:43], a[80:83]
    ds_read_b128 v[36:39], v1 offset:22528
    v_cvt_pk_bf16_f32 v76, v16, v17
    v_mfma_f32_16x16x32_bf16 a[80:83], v[172:175], v[44:47], a[80:83]
    s_waitcnt lgkmcnt(2)
    v_exp_f32 v16, v108
    v_mfma_f32_16x16x32_bf16 a[36:39], v[160:163], v[24:27], a[36:39]
    ds_read_b128 v[40:43], v1 offset:11264
    v_add_f32 v6, v6, v18
    v_mfma_f32_16x16x32_bf16 a[36:39], v[168:171], v[28:31], a[36:39]
    v_add_f32 v6, v6, v19
    v_mfma_f32_16x16x32_bf16 a[84:87], v[164:167], v[24:27], a[84:87]
    ds_read_b128 v[44:47], v1 offset:23552
    v_mfma_f32_16x16x32_bf16 a[84:87], v[172:175], v[28:31], a[84:87]
    s_waitcnt lgkmcnt(2)
    v_subrev_u32 v1, 98304, v1
    v_mfma_f32_16x16x32_bf16 a[40:43], v[160:163], v[32:35], a[40:43]
    ds_read_b128 v[24:27], v1 offset:0
    v_mfma_f32_16x16x32_bf16 a[40:43], v[168:171], v[36:39], a[40:43]
    v_exp_f32 v17, v109
    v_mfma_f32_16x16x32_bf16 a[88:91], v[164:167], v[32:35], a[88:91]
    ds_read_b128 v[28:31], v1 offset:12288
    v_cvt_pk_bf16_f32 v77, v18, v19
    v_mfma_f32_16x16x32_bf16 a[88:91], v[172:175], v[36:39], a[88:91]
    s_waitcnt lgkmcnt(2)
    v_exp_f32 v18, v110
    v_mfma_f32_16x16x32_bf16 a[44:47], v[160:163], v[40:43], a[44:47]
    ds_read_b128 v[32:35], v1 offset:1024
    v_add_f32 v6, v6, v16
    v_mfma_f32_16x16x32_bf16 a[44:47], v[168:171], v[44:47], a[44:47]
    v_add_f32 v6, v6, v17
    v_mfma_f32_16x16x32_bf16 a[92:95], v[164:167], v[40:43], a[92:95]
    ds_read_b128 v[36:39], v1 offset:13312
    v_mfma_f32_16x16x32_bf16 a[92:95], v[172:175], v[44:47], a[92:95]
    s_waitcnt lgkmcnt(2)
    v_exp_f32 v19, v111
    v_mfma_f32_16x16x32_bf16 a[0:3], v[176:179], v[24:27], a[0:3]
    ds_read_b128 v[40:43], v1 offset:2048
    v_cvt_pk_bf16_f32 v78, v16, v17
    v_mfma_f32_16x16x32_bf16 a[0:3], v[184:187], v[28:31], a[0:3]
    v_add_f32 v6, v6, v18
    v_add_f32 v6, v6, v19
    v_mfma_f32_16x16x32_bf16 a[48:51], v[180:183], v[24:27], a[48:51]
    ds_read_b128 v[44:47], v1 offset:14336
    v_cvt_pk_bf16_f32 v79, v18, v19
    v_mfma_f32_16x16x32_bf16 a[48:51], v[188:191], v[28:31], a[48:51]
    s_waitcnt lgkmcnt(2)
    v_exp_f32 v16, v80
    v_mfma_f32_16x16x32_bf16 a[4:7], v[176:179], v[32:35], a[4:7]
    ds_read_b128 v[24:27], v1 offset:3072
    v_mfma_f32_16x16x32_bf16 a[4:7], v[184:187], v[36:39], a[4:7]
    v_exp_f32 v17, v81
    v_mfma_f32_16x16x32_bf16 a[52:55], v[180:183], v[32:35], a[52:55]
    ds_read_b128 v[28:31], v1 offset:15360
    v_mfma_f32_16x16x32_bf16 a[52:55], v[188:191], v[36:39], a[52:55]
    s_waitcnt lgkmcnt(2)
    v_exp_f32 v18, v82
    v_mfma_f32_16x16x32_bf16 a[8:11], v[176:179], v[40:43], a[8:11]
    ds_read_b128 v[32:35], v1 offset:4096
    v_add_f32 v7, v7, v16
    v_mfma_f32_16x16x32_bf16 a[8:11], v[184:187], v[44:47], a[8:11]
    v_add_f32 v7, v7, v17
    v_mfma_f32_16x16x32_bf16 a[56:59], v[180:183], v[40:43], a[56:59]
    ds_read_b128 v[36:39], v1 offset:16384
    v_mfma_f32_16x16x32_bf16 a[56:59], v[188:191], v[44:47], a[56:59]
    s_waitcnt lgkmcnt(2)
    v_exp_f32 v19, v83
    v_mfma_f32_16x16x32_bf16 a[12:15], v[176:179], v[24:27], a[12:15]
    ds_read_b128 v[40:43], v1 offset:5120
    v_cvt_pk_bf16_f32 v80, v16, v17
    v_mfma_f32_16x16x32_bf16 a[12:15], v[184:187], v[28:31], a[12:15]
    v_exp_f32 v16, v112
    v_mfma_f32_16x16x32_bf16 a[60:63], v[180:183], v[24:27], a[60:63]
    ds_read_b128 v[44:47], v1 offset:17408
    v_add_f32 v7, v7, v18
    v_mfma_f32_16x16x32_bf16 a[60:63], v[188:191], v[28:31], a[60:63]
    s_waitcnt lgkmcnt(2)
    v_add_f32 v7, v7, v19
    v_mfma_f32_16x16x32_bf16 a[16:19], v[176:179], v[32:35], a[16:19]
    ds_read_b128 v[24:27], v1 offset:6144
    v_mfma_f32_16x16x32_bf16 a[16:19], v[184:187], v[36:39], a[16:19]
    v_exp_f32 v17, v113
    v_mfma_f32_16x16x32_bf16 a[64:67], v[180:183], v[32:35], a[64:67]
    ds_read_b128 v[28:31], v1 offset:18432
    v_cvt_pk_bf16_f32 v81, v18, v19
    v_mfma_f32_16x16x32_bf16 a[64:67], v[188:191], v[36:39], a[64:67]
    s_waitcnt lgkmcnt(2)
    v_exp_f32 v18, v114
    v_mfma_f32_16x16x32_bf16 a[20:23], v[176:179], v[40:43], a[20:23]
    ds_read_b128 v[32:35], v1 offset:7168
    v_add_f32 v7, v7, v16
    v_mfma_f32_16x16x32_bf16 a[20:23], v[184:187], v[44:47], a[20:23]
    v_add_f32 v7, v7, v17
    v_mfma_f32_16x16x32_bf16 a[68:71], v[180:183], v[40:43], a[68:71]
    ds_read_b128 v[36:39], v1 offset:19456
    v_mfma_f32_16x16x32_bf16 a[68:71], v[188:191], v[44:47], a[68:71]
    s_waitcnt lgkmcnt(2)
    v_exp_f32 v19, v115
    v_mfma_f32_16x16x32_bf16 a[24:27], v[176:179], v[24:27], a[24:27]
    ds_read_b128 v[40:43], v1 offset:8192
    v_cvt_pk_bf16_f32 v82, v16, v17
    v_mfma_f32_16x16x32_bf16 a[24:27], v[184:187], v[28:31], a[24:27]
    v_exp_f32 v16, v84
    v_mfma_f32_16x16x32_bf16 a[72:75], v[180:183], v[24:27], a[72:75]
    ds_read_b128 v[44:47], v1 offset:20480
    v_add_f32 v7, v7, v18
    v_mfma_f32_16x16x32_bf16 a[72:75], v[188:191], v[28:31], a[72:75]
    s_waitcnt lgkmcnt(2)
    v_add_f32 v7, v7, v19
    v_mfma_f32_16x16x32_bf16 a[28:31], v[176:179], v[32:35], a[28:31]
    ds_read_b128 v[24:27], v1 offset:9216
    v_mfma_f32_16x16x32_bf16 a[28:31], v[184:187], v[36:39], a[28:31]
    s_waitcnt vmcnt(0)
    v_exp_f32 v17, v85
    v_mfma_f32_16x16x32_bf16 a[76:79], v[180:183], v[32:35], a[76:79]
    ds_read_b128 v[28:31], v1 offset:21504
    v_cvt_pk_bf16_f32 v83, v18, v19
    v_mfma_f32_16x16x32_bf16 a[76:79], v[188:191], v[36:39], a[76:79]
    s_waitcnt lgkmcnt(2)
    s_barrier
    v_mfma_f32_16x16x32_bf16 a[32:35], v[176:179], v[40:43], a[32:35]
    ds_read_b128 v[32:35], v1 offset:10240
    v_mfma_f32_16x16x32_bf16 a[32:35], v[184:187], v[44:47], a[32:35]
    v_exp_f32 v18, v86
    v_mfma_f32_16x16x32_bf16 a[80:83], v[180:183], v[40:43], a[80:83]
    ds_read_b128 v[36:39], v1 offset:22528
    v_add_f32 v8, v8, v16
    v_mfma_f32_16x16x32_bf16 a[80:83], v[188:191], v[44:47], a[80:83]
    s_waitcnt lgkmcnt(2)
    v_add_f32 v8, v8, v17
    v_mfma_f32_16x16x32_bf16 a[36:39], v[176:179], v[24:27], a[36:39]
    ds_read_b128 v[40:43], v1 offset:11264
    v_mfma_f32_16x16x32_bf16 a[36:39], v[184:187], v[28:31], a[36:39]
    v_exp_f32 v19, v87
    v_cvt_pk_bf16_f32 v84, v16, v17
    v_mfma_f32_16x16x32_bf16 a[84:87], v[180:183], v[24:27], a[84:87]
    ds_read_b128 v[44:47], v1 offset:23552
    v_mfma_f32_16x16x32_bf16 a[84:87], v[188:191], v[28:31], a[84:87]
    s_waitcnt lgkmcnt(2)
    v_add_u32 v1, 49152, v1
    v_exp_f32 v16, v116
    v_mfma_f32_16x16x32_bf16 a[40:43], v[176:179], v[32:35], a[40:43]
    ds_read_b128 v[24:27], v1 offset:0
    v_add_f32 v8, v8, v18
    v_mfma_f32_16x16x32_bf16 a[40:43], v[184:187], v[36:39], a[40:43]
    v_add_f32 v8, v8, v19
    v_mfma_f32_16x16x32_bf16 a[88:91], v[180:183], v[32:35], a[88:91]
    ds_read_b128 v[28:31], v1 offset:12288
    v_mfma_f32_16x16x32_bf16 a[88:91], v[188:191], v[36:39], a[88:91]
    s_waitcnt lgkmcnt(2)
    v_exp_f32 v17, v117
    v_cvt_pk_bf16_f32 v85, v18, v19
    v_mfma_f32_16x16x32_bf16 a[44:47], v[176:179], v[40:43], a[44:47]
    ds_read_b128 v[32:35], v1 offset:1024
    v_mfma_f32_16x16x32_bf16 a[44:47], v[184:187], v[44:47], a[44:47]
    v_exp_f32 v18, v118
    v_mfma_f32_16x16x32_bf16 a[92:95], v[180:183], v[40:43], a[92:95]
    ds_read_b128 v[36:39], v1 offset:13312
    v_add_f32 v8, v8, v16
    v_mfma_f32_16x16x32_bf16 a[92:95], v[188:191], v[44:47], a[92:95]
    s_waitcnt lgkmcnt(2)
    v_add_f32 v8, v8, v17
    v_exp_f32 v19, v119
    v_cvt_pk_bf16_f32 v86, v16, v17
    v_add_f32 v8, v8, v18
    v_add_f32 v8, v8, v19
    v_cvt_pk_bf16_f32 v87, v18, v19
    v_mfma_f32_16x16x32_bf16 a[0:3], v[64:67], v[24:27], a[0:3]
    ds_read_b128 v[40:43], v1 offset:2048
    v_mfma_f32_16x16x32_bf16 a[0:3], v[72:75], v[28:31], a[0:3]
    v_exp_f32 v16, v88
    v_exp_f32 v17, v89
    v_exp_f32 v18, v90
    v_mfma_f32_16x16x4_f32 v[48:51], v5, v57, 0
    v_mfma_f32_16x16x32_bf16 a[48:51], v[68:71], v[24:27], a[48:51]
    ds_read_b128 v[44:47], v1 offset:14336
    v_add_f32 v7, v7, v16
    v_mfma_f32_16x16x32_bf16 a[48:51], v[76:79], v[28:31], a[48:51]
    s_waitcnt lgkmcnt(2)
    v_add_f32 v7, v7, v17
    v_exp_f32 v19, v91
    v_cvt_pk_bf16_f32 v88, v16, v17
    v_exp_f32 v16, v120
    v_mfma_f32_16x16x4_f32 v[52:55], v6, v57, 0
    v_mfma_f32_16x16x32_bf16 a[4:7], v[64:67], v[32:35], a[4:7]
    ds_read_b128 v[24:27], v1 offset:3072
    v_add_f32 v7, v7, v18
    v_mfma_f32_16x16x32_bf16 a[4:7], v[72:75], v[36:39], a[4:7]
    v_add_f32 v7, v7, v19
    v_exp_f32 v17, v121
    v_mfma_f32_16x16x32_bf16 a[52:55], v[68:71], v[32:35], a[52:55]
    ds_read_b128 v[28:31], v1 offset:15360
    v_cvt_pk_bf16_f32 v89, v18, v19
    v_mfma_f32_16x16x32_bf16 a[52:55], v[76:79], v[36:39], a[52:55]
    s_waitcnt lgkmcnt(2)
    v_exp_f32 v18, v122
    v_mfma_f32_16x16x32_bf16 a[8:11], v[64:67], v[40:43], a[8:11]
    ds_read_b128 v[32:35], v1 offset:4096
    v_add_f32 v7, v7, v16
    v_mfma_f32_16x16x32_bf16 a[8:11], v[72:75], v[44:47], a[8:11]
    v_add_f32 v7, v7, v17
    v_exp_f32 v19, v123
    v_mfma_f32_16x16x32_bf16 a[56:59], v[68:71], v[40:43], a[56:59]
    ds_read_b128 v[36:39], v1 offset:16384
    v_cvt_pk_bf16_f32 v90, v16, v17
    v_mfma_f32_16x16x32_bf16 a[56:59], v[76:79], v[44:47], a[56:59]
    s_waitcnt lgkmcnt(2)
    v_exp_f32 v16, v92
    v_mfma_f32_16x16x32_bf16 a[12:15], v[64:67], v[24:27], a[12:15]
    ds_read_b128 v[40:43], v1 offset:5120
    v_add_f32 v7, v7, v18
    v_mfma_f32_16x16x32_bf16 a[12:15], v[72:75], v[28:31], a[12:15]
    v_add_f32 v7, v7, v19
    v_exp_f32 v17, v93
    v_mfma_f32_16x16x32_bf16 a[60:63], v[68:71], v[24:27], a[60:63]
    ds_read_b128 v[44:47], v1 offset:17408
    v_cvt_pk_bf16_f32 v91, v18, v19
    v_mfma_f32_16x16x32_bf16 a[60:63], v[76:79], v[28:31], a[60:63]
    s_waitcnt lgkmcnt(2)
    v_exp_f32 v18, v94
    v_mfma_f32_16x16x32_bf16 a[16:19], v[64:67], v[32:35], a[16:19]
    ds_read_b128 v[24:27], v1 offset:6144
    v_add_f32 v8, v8, v16
    v_mfma_f32_16x16x32_bf16 a[16:19], v[72:75], v[36:39], a[16:19]
    v_add_f32 v8, v8, v17
    v_exp_f32 v19, v95
    v_mfma_f32_16x16x32_bf16 a[64:67], v[68:71], v[32:35], a[64:67]
    ds_read_b128 v[28:31], v1 offset:18432
    v_cvt_pk_bf16_f32 v92, v16, v17
    v_mfma_f32_16x16x32_bf16 a[64:67], v[76:79], v[36:39], a[64:67]
    s_waitcnt lgkmcnt(2)
    v_exp_f32 v16, v124
    v_mfma_f32_16x16x32_bf16 a[20:23], v[64:67], v[40:43], a[20:23]
    ds_read_b128 v[32:35], v1 offset:7168
    v_add_f32 v8, v8, v18
    v_mfma_f32_16x16x32_bf16 a[20:23], v[72:75], v[44:47], a[20:23]
    v_add_f32 v8, v8, v19
    v_exp_f32 v17, v125
    v_mfma_f32_16x16x32_bf16 a[68:71], v[68:71], v[40:43], a[68:71]
    ds_read_b128 v[36:39], v1 offset:19456
    v_cvt_pk_bf16_f32 v93, v18, v19
    v_mfma_f32_16x16x32_bf16 a[68:71], v[76:79], v[44:47], a[68:71]
    s_waitcnt lgkmcnt(2)
    v_exp_f32 v18, v126
    v_mfma_f32_16x16x32_bf16 a[24:27], v[64:67], v[24:27], a[24:27]
    ds_read_b128 v[40:43], v1 offset:8192
    v_add_f32 v8, v8, v16
    v_mfma_f32_16x16x32_bf16 a[24:27], v[72:75], v[28:31], a[24:27]
    v_add_f32 v8, v8, v17
    v_exp_f32 v19, v127
    v_mfma_f32_16x16x32_bf16 a[72:75], v[68:71], v[24:27], a[72:75]
    ds_read_b128 v[44:47], v1 offset:20480
    v_cvt_pk_bf16_f32 v94, v16, v17
    v_mfma_f32_16x16x32_bf16 a[72:75], v[76:79], v[28:31], a[72:75]
    s_waitcnt lgkmcnt(2)
    v_add_f32 v8, v8, v18
    v_add_f32 v8, v8, v19
    v_mfma_f32_16x16x32_bf16 a[28:31], v[64:67], v[32:35], a[28:31]
    ds_read_b128 v[24:27], v1 offset:9216
    v_cvt_pk_bf16_f32 v95, v18, v19
    v_mfma_f32_16x16x32_bf16 a[28:31], v[72:75], v[36:39], a[28:31]
    v_rcp_f32 v48, v48
    v_mfma_f32_16x16x32_bf16 a[76:79], v[68:71], v[32:35], a[76:79]
    ds_read_b128 v[28:31], v1 offset:21504
    v_mfma_f32_16x16x32_bf16 a[76:79], v[76:79], v[36:39], a[76:79]
    s_waitcnt lgkmcnt(2)
    v_rcp_f32 v49, v49
    v_mfma_f32_16x16x32_bf16 a[32:35], v[64:67], v[40:43], a[32:35]
    ds_read_b128 v[32:35], v1 offset:10240
    v_mfma_f32_16x16x32_bf16 a[32:35], v[72:75], v[44:47], a[32:35]
    v_rcp_f32 v50, v50
    v_mfma_f32_16x16x32_bf16 a[80:83], v[68:71], v[40:43], a[80:83]
    ds_read_b128 v[36:39], v1 offset:22528
    v_mfma_f32_16x16x32_bf16 a[80:83], v[76:79], v[44:47], a[80:83]
    s_waitcnt lgkmcnt(2)
    v_rcp_f32 v51, v51
    v_mfma_f32_16x16x32_bf16 a[36:39], v[64:67], v[24:27], a[36:39]
    ds_read_b128 v[40:43], v1 offset:11264
    v_mfma_f32_16x16x32_bf16 a[36:39], v[72:75], v[28:31], a[36:39]
    v_rcp_f32 v52, v52
    v_mfma_f32_16x16x32_bf16 a[84:87], v[68:71], v[24:27], a[84:87]
    ds_read_b128 v[44:47], v1 offset:23552
    v_mfma_f32_16x16x32_bf16 a[84:87], v[76:79], v[28:31], a[84:87]
    s_waitcnt lgkmcnt(2)
    v_subrev_u32 v2, 98304, v2
    v_subrev_u32 v3, 98304, v3
    v_mfma_f32_16x16x32_bf16 a[40:43], v[64:67], v[32:35], a[40:43]
    ds_read_b128 v[24:27], v2 offset:0
    v_mfma_f32_16x16x32_bf16 a[40:43], v[72:75], v[36:39], a[40:43]
    v_rcp_f32 v53, v53
    v_mfma_f32_16x16x32_bf16 a[88:91], v[68:71], v[32:35], a[88:91]
    ds_read_b128 v[28:31], v3 offset:0
    v_mfma_f32_16x16x32_bf16 a[88:91], v[76:79], v[36:39], a[88:91]
    s_waitcnt lgkmcnt(2)
    v_rcp_f32 v54, v54
    v_mfma_f32_16x16x32_bf16 a[44:47], v[64:67], v[40:43], a[44:47]
    ds_read_b128 v[32:35], v2 offset:6144
    v_mfma_f32_16x16x32_bf16 a[44:47], v[72:75], v[44:47], a[44:47]
    v_rcp_f32 v55, v55
    v_mfma_f32_16x16x32_bf16 a[92:95], v[68:71], v[40:43], a[92:95]
    ds_read_b128 v[36:39], v3 offset:6144
    v_mfma_f32_16x16x32_bf16 a[92:95], v[76:79], v[44:47], a[92:95]
    s_waitcnt lgkmcnt(2)
    v_mfma_f32_16x16x32_bf16 v[160:163], v[24:27], a[240:243], v[136:139]
    ds_read_b128 v[40:43], v2 offset:128
    v_mfma_f32_16x16x32_bf16 v[160:163], v[28:31], a[244:247], v[160:163]
    v_mfma_f32_16x16x32_bf16 v[164:167], v[24:27], v[200:203], v[140:143]
    ds_read_b128 v[44:47], v3 offset:128
    v_mfma_f32_16x16x32_bf16 v[164:167], v[28:31], v[204:207], v[164:167]
    s_waitcnt lgkmcnt(2)
    v_mfma_f32_16x16x32_bf16 v[96:99], v[32:35], a[240:243], v[136:139]
    ds_read_b128 v[24:27], v2 offset:6272
    v_accvgpr_read_b32 v224, a0
    v_mfma_f32_16x16x32_bf16 v[96:99], v[36:39], a[244:247], v[96:99]
    v_accvgpr_read_b32 v225, a12
    v_accvgpr_read_b32 v226, a24
    v_accvgpr_read_b32 v227, a36
    v_mul_f32 v224, v224, v48
    v_mul_f32 v225, v225, v48
    v_mfma_f32_16x16x32_bf16 v[100:103], v[32:35], v[200:203], v[140:143]
    ds_read_b128 v[28:31], v3 offset:6272
    v_mul_f32 v226, v226, v48
    v_mfma_f32_16x16x32_bf16 v[100:103], v[36:39], v[204:207], v[100:103]
    s_waitcnt lgkmcnt(2)
    v_mul_f32 v227, v227, v48
    v_cvt_pk_bf16_f32 v224, v224, v225
    v_cvt_pk_bf16_f32 v225, v226, v227
    v_accvgpr_read_b32 v228, a1
    v_accvgpr_read_b32 v229, a13
    v_accvgpr_read_b32 v230, a25
    v_mfma_f32_16x16x32_bf16 v[160:163], v[40:43], a[248:251], v[160:163]
    ds_read_b128 v[32:35], v2 offset:256
    v_accvgpr_read_b32 v231, a37
    v_mfma_f32_16x16x32_bf16 v[160:163], v[44:47], a[252:255], v[160:163]
    buffer_store_dwordx2 v[224:225], v56, s[12:15], s24 offen offset:0 sc0 sc1
    v_mul_f32 v228, v228, v49
    v_mul_f32 v229, v229, v49
    v_mul_f32 v230, v230, v49
    v_mfma_f32_16x16x32_bf16 v[164:167], v[40:43], v[208:211], v[164:167]
    ds_read_b128 v[36:39], v3 offset:256
    v_mul_f32 v231, v231, v49
    v_mfma_f32_16x16x32_bf16 v[164:167], v[44:47], v[212:215], v[164:167]
    s_waitcnt lgkmcnt(2)
    v_cvt_pk_bf16_f32 v228, v228, v229
    v_cvt_pk_bf16_f32 v229, v230, v231
    v_accvgpr_read_b32 v232, a2
    v_accvgpr_read_b32 v233, a14
    v_accvgpr_read_b32 v234, a26
    v_accvgpr_read_b32 v235, a38
    v_mfma_f32_16x16x32_bf16 v[96:99], v[24:27], a[248:251], v[96:99]
    ds_read_b128 v[40:43], v2 offset:6400
    v_mul_f32 v232, v232, v50
    v_mfma_f32_16x16x32_bf16 v[96:99], v[28:31], a[252:255], v[96:99]
    buffer_store_dwordx2 v[228:229], v56, s[12:15], s24 offen offset:384 sc0 sc1
    v_mul_f32 v233, v233, v50
    v_mul_f32 v234, v234, v50
    v_mul_f32 v235, v235, v50
    v_mfma_f32_16x16x32_bf16 v[100:103], v[24:27], v[208:211], v[100:103]
    ds_read_b128 v[44:47], v3 offset:6400
    v_cvt_pk_bf16_f32 v232, v232, v233
    v_mfma_f32_16x16x32_bf16 v[100:103], v[28:31], v[212:215], v[100:103]
    s_waitcnt lgkmcnt(2)
    v_cvt_pk_bf16_f32 v233, v234, v235
    v_accvgpr_read_b32 v236, a3
    v_accvgpr_read_b32 v237, a15
    v_accvgpr_read_b32 v238, a27
    v_accvgpr_read_b32 v239, a39
    v_mul_f32 v236, v236, v51
    v_mfma_f32_16x16x32_bf16 v[160:163], v[32:35], v[192:195], v[160:163]
    ds_read_b128 v[24:27], v2 offset:12288
    v_mul_f32 v237, v237, v51
    v_mfma_f32_16x16x32_bf16 v[160:163], v[36:39], v[196:199], v[160:163]
    buffer_store_dwordx2 v[232:233], v56, s[12:15], s24 offen offset:768 sc0 sc1
    v_mul_f32 v238, v238, v51
    v_mul_f32 v239, v239, v51
    v_cvt_pk_bf16_f32 v236, v236, v237
    v_mfma_f32_16x16x32_bf16 v[164:167], v[32:35], v[216:219], v[164:167]
    ds_read_b128 v[28:31], v3 offset:12288
    v_cvt_pk_bf16_f32 v237, v238, v239
    v_mfma_f32_16x16x32_bf16 v[164:167], v[36:39], v[220:223], v[164:167]
    s_waitcnt lgkmcnt(2)
    buffer_store_dwordx2 v[236:237], v56, s[12:15], s24 offen offset:1152 sc0 sc1
    v_accvgpr_read_b32 v240, a4
    v_accvgpr_read_b32 v241, a16
    v_accvgpr_read_b32 v242, a28
    v_mfma_f32_16x16x32_bf16 v[96:99], v[40:43], v[192:195], v[96:99]
    ds_read_b128 v[32:35], v2 offset:18432
    v_accvgpr_read_b32 v243, a40
    v_mfma_f32_16x16x32_bf16 v[96:99], v[44:47], v[196:199], v[96:99]
    v_mul_f32 v240, v240, v48
    v_mul_f32 v241, v241, v48
    v_mul_f32 v242, v242, v48
    v_mul_f32 v243, v243, v48
    v_cvt_pk_bf16_f32 v240, v240, v241
    v_cvt_pk_bf16_f32 v241, v242, v243
    v_mfma_f32_16x16x32_bf16 v[100:103], v[40:43], v[216:219], v[100:103]
    ds_read_b128 v[36:39], v3 offset:18432
    v_accvgpr_read_b32 v244, a5
    v_mfma_f32_16x16x32_bf16 v[100:103], v[44:47], v[220:223], v[100:103]
    s_waitcnt lgkmcnt(2)
    buffer_store_dwordx2 v[240:241], v56, s[12:15], s24 offen offset:128 sc0 sc1
    v_accvgpr_read_b32 v245, a17
    v_accvgpr_read_b32 v246, a29
    v_accvgpr_read_b32 v247, a41
    v_mfma_f32_16x16x32_bf16 v[168:171], v[24:27], a[240:243], v[136:139]
    ds_read_b128 v[40:43], v2 offset:12416
    v_mul_f32 v244, v244, v49
    v_mfma_f32_16x16x32_bf16 v[168:171], v[28:31], a[244:247], v[168:171]
    v_mul_f32 v245, v245, v49
    v_mul_f32 v246, v246, v49
    v_mul_f32 v247, v247, v49
    v_cvt_pk_bf16_f32 v244, v244, v245
    v_cvt_pk_bf16_f32 v245, v246, v247
    v_accvgpr_read_b32 v248, a6
    v_mfma_f32_16x16x32_bf16 v[172:175], v[24:27], v[200:203], v[140:143]
    ds_read_b128 v[44:47], v3 offset:12416
    v_accvgpr_read_b32 v249, a18
    v_mfma_f32_16x16x32_bf16 v[172:175], v[28:31], v[204:207], v[172:175]
    s_waitcnt lgkmcnt(2)
    buffer_store_dwordx2 v[244:245], v56, s[12:15], s24 offen offset:512 sc0 sc1
    v_accvgpr_read_b32 v250, a30
    v_accvgpr_read_b32 v251, a42
    v_mul_f32 v248, v248, v50
    v_mfma_f32_16x16x32_bf16 v[104:107], v[32:35], a[240:243], v[136:139]
    ds_read_b128 v[24:27], v2 offset:18560
    v_mul_f32 v249, v249, v50
    v_mfma_f32_16x16x32_bf16 v[104:107], v[36:39], a[244:247], v[104:107]
    v_mul_f32 v250, v250, v50
    v_mul_f32 v251, v251, v50
    v_cvt_pk_bf16_f32 v248, v248, v249
    v_exp_f32 v16, v160
    v_mfma_f32_16x16x32_bf16 v[108:111], v[32:35], v[200:203], v[140:143]
    ds_read_b128 v[28:31], v3 offset:18560
    v_cvt_pk_bf16_f32 v249, v250, v251
    v_mfma_f32_16x16x32_bf16 v[108:111], v[36:39], v[204:207], v[108:111]
    s_waitcnt lgkmcnt(2)
    buffer_store_dwordx2 v[248:249], v56, s[12:15], s24 offen offset:896 sc0 sc1
    v_accvgpr_read_b32 v252, a7
    v_exp_f32 v17, v161
    v_mfma_f32_16x16x32_bf16 v[168:171], v[40:43], a[248:251], v[168:171]
    ds_read_b128 v[32:35], v2 offset:12544
    v_accvgpr_read_b32 v253, a19
    v_mfma_f32_16x16x32_bf16 v[168:171], v[44:47], a[252:255], v[168:171]
    v_exp_f32 v18, v162
    v_accvgpr_read_b32 v254, a31
    v_accvgpr_read_b32 v255, a43
    v_mul_f32 v252, v252, v51
    v_add_f32 v7, v7, v16
    v_mfma_f32_16x16x32_bf16 v[172:175], v[40:43], v[208:211], v[172:175]
    ds_read_b128 v[36:39], v3 offset:12544
    v_mul_f32 v253, v253, v51
    v_mfma_f32_16x16x32_bf16 v[172:175], v[44:47], v[212:215], v[172:175]
    s_waitcnt lgkmcnt(2)
    v_add_f32 v7, v7, v17
    v_mul_f32 v254, v254, v51
    v_exp_f32 v19, v163
    v_mul_f32 v255, v255, v51
    v_cvt_pk_bf16_f32 v252, v252, v253
    v_mfma_f32_16x16x32_bf16 v[104:107], v[24:27], a[248:251], v[104:107]
    ds_read_b128 v[40:43], v2 offset:18688
    v_cvt_pk_bf16_f32 v160, v16, v17
    v_mfma_f32_16x16x32_bf16 v[104:107], v[28:31], a[252:255], v[104:107]
    v_cvt_pk_bf16_f32 v253, v254, v255
    v_exp_f32 v16, v96
    v_accvgpr_read_b32 v224, a8
    v_accvgpr_read_b32 v225, a20
    v_accvgpr_read_b32 v226, a32
    v_mfma_f32_16x16x32_bf16 v[108:111], v[24:27], v[208:211], v[108:111]
    ds_read_b128 v[44:47], v3 offset:18688
    v_add_f32 v7, v7, v18
    v_mfma_f32_16x16x32_bf16 v[108:111], v[28:31], v[212:215], v[108:111]
    s_waitcnt lgkmcnt(2)
    buffer_store_dwordx2 v[252:253], v56, s[12:15], s24 offen offset:1280 sc0 sc1
    v_add_u32 v2, 49152, v2
    v_add_u32 v3, 49152, v3
    v_add_f32 v7, v7, v19
    v_mfma_f32_16x16x32_bf16 v[168:171], v[32:35], v[192:195], v[168:171]
    ds_read_b128 v[24:27], v2 offset:0
    v_accvgpr_read_b32 v227, a44
    v_mfma_f32_16x16x32_bf16 v[168:171], v[36:39], v[196:199], v[168:171]
    v_exp_f32 v17, v97
    v_mul_f32 v224, v224, v48
    v_mul_f32 v225, v225, v48
    v_cvt_pk_bf16_f32 v161, v18, v19
    v_mul_f32 v226, v226, v48
    v_mfma_f32_16x16x32_bf16 v[172:175], v[32:35], v[216:219], v[172:175]
    ds_read_b128 v[28:31], v3 offset:0
    v_mul_f32 v227, v227, v48
    v_mfma_f32_16x16x32_bf16 v[172:175], v[36:39], v[220:223], v[172:175]
    s_waitcnt lgkmcnt(2)
    v_exp_f32 v18, v98
    v_cvt_pk_bf16_f32 v224, v224, v225
    v_add_f32 v7, v7, v16
    v_cvt_pk_bf16_f32 v225, v226, v227
    v_accvgpr_read_b32 v228, a9
    v_mfma_f32_16x16x32_bf16 v[104:107], v[40:43], v[192:195], v[104:107]
    ds_read_b128 v[32:35], v2 offset:6144
    v_add_f32 v7, v7, v17
    v_mfma_f32_16x16x32_bf16 v[104:107], v[44:47], v[196:199], v[104:107]
    buffer_store_dwordx2 v[224:225], v56, s[12:15], s24 offen offset:256 sc0 sc1
    v_exp_f32 v19, v99
    v_accvgpr_read_b32 v229, a21
    v_mfma_f32_16x16x32_bf16 v[108:111], v[40:43], v[216:219], v[108:111]
    ds_read_b128 v[36:39], v3 offset:6144
    v_accvgpr_read_b32 v230, a33
    v_mfma_f32_16x16x32_bf16 v[108:111], v[44:47], v[220:223], v[108:111]
    s_waitcnt lgkmcnt(2)
    v_cvt_pk_bf16_f32 v162, v16, v17
    v_accvgpr_read_b32 v231, a45
    v_exp_f32 v16, v164
    v_mul_f32 v228, v228, v49
    v_mul_f32 v229, v229, v49
    v_mfma_f32_16x16x32_bf16 v[176:179], v[24:27], a[240:243], v[136:139]
    ds_read_b128 v[40:43], v2 offset:128
    v_mul_f32 v230, v230, v49
    v_mfma_f32_16x16x32_bf16 v[176:179], v[28:31], a[244:247], v[176:179]
    v_add_f32 v7, v7, v18
    v_add_f32 v7, v7, v19
    v_mul_f32 v231, v231, v49
    v_cvt_pk_bf16_f32 v228, v228, v229
    v_exp_f32 v17, v165
    v_mfma_f32_16x16x32_bf16 v[180:183], v[24:27], v[200:203], v[140:143]
    ds_read_b128 v[44:47], v3 offset:128
    v_cvt_pk_bf16_f32 v229, v230, v231
    v_mfma_f32_16x16x32_bf16 v[180:183], v[28:31], v[204:207], v[180:183]
    s_waitcnt lgkmcnt(2)
    buffer_store_dwordx2 v[228:229], v56, s[12:15], s24 offen offset:640 sc0 sc1
    v_cvt_pk_bf16_f32 v163, v18, v19
    v_accvgpr_read_b32 v232, a10
    v_accvgpr_read_b32 v233, a22
    v_mfma_f32_16x16x32_bf16 v[112:115], v[32:35], a[240:243], v[136:139]
    ds_read_b128 v[24:27], v2 offset:6272
    v_accvgpr_read_b32 v234, a34
    v_mfma_f32_16x16x32_bf16 v[112:115], v[36:39], a[244:247], v[112:115]
    v_exp_f32 v18, v166
    v_accvgpr_read_b32 v235, a46
    v_add_f32 v8, v8, v16
    v_mul_f32 v232, v232, v50
    v_mfma_f32_16x16x32_bf16 v[116:119], v[32:35], v[200:203], v[140:143]
    ds_read_b128 v[28:31], v3 offset:6272
    v_add_f32 v8, v8, v17
    v_mfma_f32_16x16x32_bf16 v[116:119], v[36:39], v[204:207], v[116:119]
    s_waitcnt lgkmcnt(2)
    v_exp_f32 v19, v167
    v_mul_f32 v233, v233, v50
    v_mul_f32 v234, v234, v50
    v_mul_f32 v235, v235, v50
    v_cvt_pk_bf16_f32 v232, v232, v233
    v_mfma_f32_16x16x32_bf16 v[176:179], v[40:43], a[248:251], v[176:179]
    ds_read_b128 v[32:35], v2 offset:256
    v_cvt_pk_bf16_f32 v164, v16, v17
    v_mfma_f32_16x16x32_bf16 v[176:179], v[44:47], a[252:255], v[176:179]
    v_exp_f32 v16, v100
    v_cvt_pk_bf16_f32 v233, v234, v235
    v_accvgpr_read_b32 v236, a11
    v_accvgpr_read_b32 v237, a23
    v_add_f32 v8, v8, v18
    v_mfma_f32_16x16x32_bf16 v[180:183], v[40:43], v[208:211], v[180:183]
    ds_read_b128 v[36:39], v3 offset:256
    v_accvgpr_read_b32 v238, a35
    v_mfma_f32_16x16x32_bf16 v[180:183], v[44:47], v[212:215], v[180:183]
    s_waitcnt lgkmcnt(2)
    buffer_store_dwordx2 v[232:233], v56, s[12:15], s24 offen offset:1024 sc0 sc1
    v_add_f32 v8, v8, v19
    v_exp_f32 v17, v101
    v_mfma_f32_16x16x32_bf16 v[112:115], v[24:27], a[248:251], v[112:115]
    ds_read_b128 v[40:43], v2 offset:6400
    v_accvgpr_read_b32 v239, a47
    v_mfma_f32_16x16x32_bf16 v[112:115], v[28:31], a[252:255], v[112:115]
    v_mul_f32 v236, v236, v51
    v_cvt_pk_bf16_f32 v165, v18, v19
    v_mul_f32 v237, v237, v51
    v_mul_f32 v238, v238, v51
    v_exp_f32 v18, v102
    v_mfma_f32_16x16x32_bf16 v[116:119], v[24:27], v[208:211], v[116:119]
    ds_read_b128 v[44:47], v3 offset:6400
    v_mul_f32 v239, v239, v51
    v_mfma_f32_16x16x32_bf16 v[116:119], v[28:31], v[212:215], v[116:119]
    s_waitcnt lgkmcnt(2)
    v_add_f32 v8, v8, v16
    v_cvt_pk_bf16_f32 v236, v236, v237
    v_cvt_pk_bf16_f32 v237, v238, v239
    v_add_f32 v8, v8, v17
    v_accvgpr_read_b32 v240, a48
    v_accvgpr_read_b32 v241, a60
    v_mfma_f32_16x16x32_bf16 v[176:179], v[32:35], v[192:195], v[176:179]
    ds_read_b128 v[24:27], v2 offset:12288
    v_accvgpr_read_b32 v242, a72
    v_mfma_f32_16x16x32_bf16 v[176:179], v[36:39], v[196:199], v[176:179]
    buffer_store_dwordx2 v[236:237], v56, s[12:15], s24 offen offset:1408 sc0 sc1
    v_exp_f32 v19, v103
    v_cvt_pk_bf16_f32 v166, v16, v17
    v_mfma_f32_16x16x32_bf16 v[180:183], v[32:35], v[216:219], v[180:183]
    ds_read_b128 v[28:31], v3 offset:12288
    v_accvgpr_read_b32 v243, a84
    v_mfma_f32_16x16x32_bf16 v[180:183], v[36:39], v[220:223], v[180:183]
    s_waitcnt lgkmcnt(2)
    v_add_f32 v8, v8, v18
    v_add_f32 v8, v8, v19
    v_mul_f32 v240, v240, v52
    v_mul_f32 v241, v241, v52
    v_cvt_pk_bf16_f32 v167, v18, v19
    v_mul_f32 v242, v242, v52
    v_mfma_f32_16x16x32_bf16 v[112:115], v[40:43], v[192:195], v[112:115]
    ds_read_b128 v[32:35], v2 offset:18432
    v_mul_f32 v243, v243, v52
    v_mfma_f32_16x16x32_bf16 v[112:115], v[44:47], v[196:199], v[112:115]
    v_exp_f32 v16, v168
    v_cvt_pk_bf16_f32 v240, v240, v241
    v_cvt_pk_bf16_f32 v241, v242, v243
    v_exp_f32 v17, v169
    v_mfma_f32_16x16x32_bf16 v[116:119], v[40:43], v[216:219], v[116:119]
    ds_read_b128 v[36:39], v3 offset:18432
    v_accvgpr_read_b32 v244, a49
    v_mfma_f32_16x16x32_bf16 v[116:119], v[44:47], v[220:223], v[116:119]
    s_waitcnt lgkmcnt(2)
    buffer_store_dwordx2 v[240:241], v56, s[12:15], s40 offen offset:0 sc0 sc1
    v_exp_f32 v18, v170
    v_accvgpr_read_b32 v245, a61
    v_mfma_f32_16x16x32_bf16 v[184:187], v[24:27], a[240:243], v[136:139]
    ds_read_b128 v[40:43], v2 offset:12416
    v_accvgpr_read_b32 v246, a73
    v_mfma_f32_16x16x32_bf16 v[184:187], v[28:31], a[244:247], v[184:187]
    v_add_f32 v7, v7, v16
    v_accvgpr_read_b32 v247, a85
    v_mul_f32 v244, v244, v53
    v_add_f32 v7, v7, v17
    v_mul_f32 v245, v245, v53
    v_mul_f32 v246, v246, v53
    v_mfma_f32_16x16x32_bf16 v[188:191], v[24:27], v[200:203], v[140:143]
    ds_read_b128 v[44:47], v3 offset:12416
    v_mul_f32 v247, v247, v53
    v_mfma_f32_16x16x32_bf16 v[188:191], v[28:31], v[204:207], v[188:191]
    s_waitcnt lgkmcnt(2)
    v_exp_f32 v19, v171
    v_cvt_pk_bf16_f32 v168, v16, v17
    v_cvt_pk_bf16_f32 v244, v244, v245
    v_cvt_pk_bf16_f32 v245, v246, v247
    v_accvgpr_read_b32 v248, a50
    v_mfma_f32_16x16x32_bf16 v[120:123], v[32:35], a[240:243], v[136:139]
    ds_read_b128 v[24:27], v2 offset:18560
    v_accvgpr_read_b32 v249, a62
    v_mfma_f32_16x16x32_bf16 v[120:123], v[36:39], a[244:247], v[120:123]
    buffer_store_dwordx2 v[244:245], v56, s[12:15], s40 offen offset:384 sc0 sc1
    v_exp_f32 v16, v104
    v_mfma_f32_16x16x32_bf16 v[124:127], v[32:35], v[200:203], v[140:143]
    ds_read_b128 v[28:31], v3 offset:18560
    v_add_f32 v7, v7, v18
    v_mfma_f32_16x16x32_bf16 v[124:127], v[36:39], v[204:207], v[124:127]
    s_waitcnt lgkmcnt(2)
    v_add_f32 v7, v7, v19
    v_accvgpr_read_b32 v250, a74
    v_exp_f32 v17, v105
    v_accvgpr_read_b32 v251, a86
    v_mul_f32 v248, v248, v54
    v_mfma_f32_16x16x32_bf16 v[184:187], v[40:43], a[248:251], v[184:187]
    ds_read_b128 v[32:35], v2 offset:12544
    v_mul_f32 v249, v249, v54
    v_mfma_f32_16x16x32_bf16 v[184:187], v[44:47], a[252:255], v[184:187]
    v_cvt_pk_bf16_f32 v169, v18, v19
    v_exp_f32 v18, v106
    v_mul_f32 v250, v250, v54
    v_mul_f32 v251, v251, v54
    v_cvt_pk_bf16_f32 v248, v248, v249
    v_mfma_f32_16x16x32_bf16 v[188:191], v[40:43], v[208:211], v[188:191]
    ds_read_b128 v[36:39], v3 offset:12544
    v_add_f32 v7, v7, v16
    v_mfma_f32_16x16x32_bf16 v[188:191], v[44:47], v[212:215], v[188:191]
    s_waitcnt lgkmcnt(2)
    v_cvt_pk_bf16_f32 v249, v250, v251
    v_add_f32 v7, v7, v17
    v_accvgpr_read_b32 v252, a51
    v_accvgpr_read_b32 v253, a63
    v_exp_f32 v19, v107
    v_mfma_f32_16x16x32_bf16 v[120:123], v[24:27], a[248:251], v[120:123]
    ds_read_b128 v[40:43], v2 offset:18688
    v_accvgpr_read_b32 v254, a75
    v_mfma_f32_16x16x32_bf16 v[120:123], v[28:31], a[252:255], v[120:123]
    buffer_store_dwordx2 v[248:249], v56, s[12:15], s40 offen offset:768 sc0 sc1
    v_cvt_pk_bf16_f32 v170, v16, v17
    v_accvgpr_read_b32 v255, a87
    v_mul_f32 v252, v252, v55
    v_mfma_f32_16x16x32_bf16 v[124:127], v[24:27], v[208:211], v[124:127]
    ds_read_b128 v[44:47], v3 offset:18688
    v_mul_f32 v253, v253, v55
    v_mfma_f32_16x16x32_bf16 v[124:127], v[28:31], v[212:215], v[124:127]
    s_waitcnt lgkmcnt(2)
    v_add_u32 v22, 49152, v1
    v_mov_b32 v14, v1
    v_subrev_u32 v1, 49152, v1
    v_exp_f32 v16, v172
    v_mul_f32 v254, v254, v55
    v_mfma_f32_16x16x32_bf16 v[184:187], v[32:35], v[192:195], v[184:187]
    ds_read_b128 v[24:27], v22 offset:0
    v_add_f32 v7, v7, v18
    v_mfma_f32_16x16x32_bf16 v[184:187], v[36:39], v[196:199], v[184:187]
    v_add_f32 v7, v7, v19
    v_mul_f32 v255, v255, v55
    v_exp_f32 v17, v173
    v_cvt_pk_bf16_f32 v252, v252, v253
    v_cvt_pk_bf16_f32 v253, v254, v255
    v_mfma_f32_16x16x32_bf16 v[188:191], v[32:35], v[216:219], v[188:191]
    ds_read_b128 v[28:31], v22 offset:12288
    v_accvgpr_read_b32 v224, a52
    v_mfma_f32_16x16x32_bf16 v[188:191], v[36:39], v[220:223], v[188:191]
    s_waitcnt lgkmcnt(2)
    buffer_store_dwordx2 v[252:253], v56, s[12:15], s40 offen offset:1152 sc0 sc1
    v_cvt_pk_bf16_f32 v171, v18, v19
    v_accvgpr_read_b32 v225, a64
    v_accvgpr_read_b32 v226, a76
    v_mfma_f32_16x16x32_bf16 v[120:123], v[40:43], v[192:195], v[120:123]
    ds_read_b128 v[32:35], v22 offset:3072
    v_accvgpr_read_b32 v227, a88
    v_mfma_f32_16x16x32_bf16 v[120:123], v[44:47], v[196:199], v[120:123]
    v_exp_f32 v18, v174
    v_add_f32 v8, v8, v16
    v_mul_f32 v224, v224, v52
    v_mul_f32 v225, v225, v52
    v_add_f32 v8, v8, v17
    v_mfma_f32_16x16x32_bf16 v[124:127], v[40:43], v[216:219], v[124:127]
    ds_read_b128 v[36:39], v22 offset:15360
    v_mul_f32 v226, v226, v52
    v_mfma_f32_16x16x32_bf16 v[124:127], v[44:47], v[220:223], v[124:127]
    s_waitcnt lgkmcnt(2)
    v_exp_f32 v19, v175
    v_mul_f32 v227, v227, v52
    v_cvt_pk_bf16_f32 v224, v224, v225
    v_cvt_pk_bf16_f32 v225, v226, v227
    v_accvgpr_read_b32 v228, a53
    v_mfma_f32_16x16x32_bf16 a[96:99], v[80:83], v[24:27], a[96:99]
    ds_read_b128 v[40:43], v22 offset:6144
    v_cvt_pk_bf16_f32 v172, v16, v17
    v_mfma_f32_16x16x32_bf16 a[96:99], v[88:91], v[28:31], a[96:99]
    buffer_store_dwordx2 v[224:225], v56, s[12:15], s40 offen offset:128 sc0 sc1
    v_exp_f32 v16, v108
    v_accvgpr_read_b32 v229, a65
    v_mfma_f32_16x16x32_bf16 a[144:147], v[84:87], v[24:27], a[144:147]
    ds_read_b128 v[44:47], v22 offset:18432
    v_add_f32 v8, v8, v18
    v_mfma_f32_16x16x32_bf16 a[144:147], v[92:95], v[28:31], a[144:147]
    s_waitcnt lgkmcnt(2)
    v_add_f32 v8, v8, v19
    v_accvgpr_read_b32 v230, a77
    v_accvgpr_read_b32 v231, a89
    v_mul_f32 v228, v228, v53
    v_mul_f32 v229, v229, v53
    v_mul_f32 v230, v230, v53
    v_mfma_f32_16x16x32_bf16 a[108:111], v[80:83], v[32:35], a[108:111]
    ds_read_b128 v[24:27], v22 offset:9216
    v_mul_f32 v231, v231, v53
    v_mfma_f32_16x16x32_bf16 a[108:111], v[88:91], v[36:39], a[108:111]
    v_exp_f32 v17, v109
    v_cvt_pk_bf16_f32 v173, v18, v19
    v_cvt_pk_bf16_f32 v228, v228, v229
    v_cvt_pk_bf16_f32 v229, v230, v231
    v_accvgpr_read_b32 v232, a54
    v_mfma_f32_16x16x32_bf16 a[156:159], v[84:87], v[32:35], a[156:159]
    ds_read_b128 v[28:31], v22 offset:21504
    v_accvgpr_read_b32 v233, a66
    v_mfma_f32_16x16x32_bf16 a[156:159], v[92:95], v[36:39], a[156:159]
    s_waitcnt lgkmcnt(2)
    buffer_store_dwordx2 v[228:229], v56, s[12:15], s40 offen offset:512 sc0 sc1
    v_exp_f32 v18, v110
    v_mfma_f32_16x16x32_bf16 a[120:123], v[80:83], v[40:43], a[120:123]
    ds_read_b128 v[32:35], v1 offset:0
    v_add_f32 v8, v8, v16
    v_mfma_f32_16x16x32_bf16 a[120:123], v[88:91], v[44:47], a[120:123]
    v_add_f32 v8, v8, v17
    v_accvgpr_read_b32 v234, a78
    v_exp_f32 v19, v111
    v_accvgpr_read_b32 v235, a90
    v_mul_f32 v232, v232, v54
    v_mfma_f32_16x16x32_bf16 a[168:171], v[84:87], v[40:43], a[168:171]
    ds_read_b128 v[36:39], v1 offset:12288
    v_mul_f32 v233, v233, v54
    v_mfma_f32_16x16x32_bf16 a[168:171], v[92:95], v[44:47], a[168:171]
    s_waitcnt lgkmcnt(2)
    v_cvt_pk_bf16_f32 v174, v16, v17
    v_mul_f32 v234, v234, v54
    v_mul_f32 v235, v235, v54
    v_cvt_pk_bf16_f32 v232, v232, v233
    v_cvt_pk_bf16_f32 v233, v234, v235
    v_accvgpr_read_b32 v236, a55
    v_mfma_f32_16x16x32_bf16 a[132:135], v[80:83], v[24:27], a[132:135]
    ds_read_b128 v[40:43], v1 offset:3072
    v_add_f32 v8, v8, v18
    v_mfma_f32_16x16x32_bf16 a[132:135], v[88:91], v[28:31], a[132:135]
    buffer_store_dwordx2 v[232:233], v56, s[12:15], s40 offen offset:896 sc0 sc1
    v_add_f32 v8, v8, v19
    v_cvt_pk_bf16_f32 v175, v18, v19
    v_accvgpr_read_b32 v237, a67
    v_mfma_f32_16x16x32_bf16 a[180:183], v[84:87], v[24:27], a[180:183]
    ds_read_b128 v[44:47], v1 offset:15360
    v_accvgpr_read_b32 v238, a79
    v_mfma_f32_16x16x32_bf16 a[180:183], v[92:95], v[28:31], a[180:183]
    s_waitcnt lgkmcnt(2)
    v_exp_f32 v16, v176
    v_exp_f32 v17, v177
    v_exp_f32 v18, v178
    v_mfma_f32_16x16x32_bf16 a[96:99], v[160:163], v[32:35], a[96:99]
    ds_read_b128 v[24:27], v1 offset:6144
    v_add_f32 v7, v7, v16
    v_mfma_f32_16x16x32_bf16 a[96:99], v[168:171], v[36:39], a[96:99]
    v_add_f32 v7, v7, v17
    v_exp_f32 v19, v179
    v_cvt_pk_bf16_f32 v176, v16, v17
    v_exp_f32 v16, v112
    v_mfma_f32_16x16x32_bf16 a[144:147], v[164:167], v[32:35], a[144:147]
    ds_read_b128 v[28:31], v1 offset:18432
    v_add_f32 v7, v7, v18
    v_mfma_f32_16x16x32_bf16 a[144:147], v[172:175], v[36:39], a[144:147]
    s_waitcnt lgkmcnt(2)
    v_add_f32 v7, v7, v19
    v_exp_f32 v17, v113
    v_cvt_pk_bf16_f32 v177, v18, v19
    v_exp_f32 v18, v114
    v_mfma_f32_16x16x32_bf16 a[108:111], v[160:163], v[40:43], a[108:111]
    ds_read_b128 v[32:35], v1 offset:9216
    v_add_f32 v7, v7, v16
    v_mfma_f32_16x16x32_bf16 a[108:111], v[168:171], v[44:47], a[108:111]
    v_add_f32 v7, v7, v17
    v_exp_f32 v19, v115
    v_cvt_pk_bf16_f32 v178, v16, v17
    v_exp_f32 v16, v180
    v_mfma_f32_16x16x32_bf16 a[156:159], v[164:167], v[40:43], a[156:159]
    ds_read_b128 v[36:39], v1 offset:21504
    v_add_f32 v7, v7, v18
    v_mfma_f32_16x16x32_bf16 a[156:159], v[172:175], v[44:47], a[156:159]
    s_waitcnt lgkmcnt(2)
    v_add_f32 v7, v7, v19
    v_exp_f32 v17, v181
    v_cvt_pk_bf16_f32 v179, v18, v19
    v_exp_f32 v18, v182
    v_mfma_f32_16x16x32_bf16 a[120:123], v[160:163], v[24:27], a[120:123]
    ds_read_b128 v[40:43], v14 offset:0
    v_add_f32 v8, v8, v16
    v_mfma_f32_16x16x32_bf16 a[120:123], v[168:171], v[28:31], a[120:123]
    v_add_f32 v8, v8, v17
    v_exp_f32 v19, v183
    v_cvt_pk_bf16_f32 v180, v16, v17
    v_exp_f32 v16, v116
    v_mfma_f32_16x16x32_bf16 a[168:171], v[164:167], v[24:27], a[168:171]
    ds_read_b128 v[44:47], v14 offset:12288
    v_add_f32 v8, v8, v18
    v_mfma_f32_16x16x32_bf16 a[168:171], v[172:175], v[28:31], a[168:171]
    s_waitcnt lgkmcnt(2)
    v_add_f32 v8, v8, v19
    v_exp_f32 v17, v117
    v_cvt_pk_bf16_f32 v181, v18, v19
    v_exp_f32 v18, v118
    v_mfma_f32_16x16x32_bf16 a[132:135], v[160:163], v[32:35], a[132:135]
    ds_read_b128 v[24:27], v14 offset:3072
    v_add_f32 v8, v8, v16
    v_mfma_f32_16x16x32_bf16 a[132:135], v[168:171], v[36:39], a[132:135]
    v_add_f32 v8, v8, v17
    v_exp_f32 v19, v119
    v_cvt_pk_bf16_f32 v182, v16, v17
    v_add_f32 v8, v8, v18
    v_add_f32 v8, v8, v19
    v_cvt_pk_bf16_f32 v183, v18, v19
    v_exp_f32 v16, v184
    v_exp_f32 v17, v185
    v_exp_f32 v18, v186
    v_add_f32 v7, v7, v16
    v_add_f32 v7, v7, v17
    v_exp_f32 v19, v187
    v_cvt_pk_bf16_f32 v184, v16, v17
    v_exp_f32 v16, v120
    v_add_f32 v7, v7, v18
    v_add_f32 v7, v7, v19
    v_exp_f32 v17, v121
    v_cvt_pk_bf16_f32 v185, v18, v19
    v_exp_f32 v18, v122
    v_add_f32 v7, v7, v16
    v_add_f32 v7, v7, v17
    v_exp_f32 v19, v123
    v_cvt_pk_bf16_f32 v186, v16, v17
    v_exp_f32 v16, v188
    v_add_f32 v7, v7, v18
    v_add_f32 v7, v7, v19
    v_exp_f32 v17, v189
    v_cvt_pk_bf16_f32 v187, v18, v19
    v_exp_f32 v18, v190
    v_add_f32 v8, v8, v16
    v_add_f32 v8, v8, v17
    v_exp_f32 v19, v191
    v_cvt_pk_bf16_f32 v188, v16, v17
    v_exp_f32 v16, v124
    v_add_f32 v8, v8, v18
    v_add_f32 v8, v8, v19
    v_exp_f32 v17, v125
    v_cvt_pk_bf16_f32 v189, v18, v19
    v_exp_f32 v18, v126
    v_add_f32 v8, v8, v16
    v_add_f32 v8, v8, v17
    v_exp_f32 v19, v127
    v_cvt_pk_bf16_f32 v190, v16, v17
    v_add_f32 v8, v8, v18
    v_add_f32 v8, v8, v19
    v_cvt_pk_bf16_f32 v191, v18, v19
    v_mfma_f32_16x16x32_bf16 a[180:183], v[164:167], v[32:35], a[180:183]
    ds_read_b128 v[28:31], v14 offset:15360
    v_accvgpr_read_b32 v239, a91
    v_mfma_f32_16x16x32_bf16 a[180:183], v[172:175], v[36:39], a[180:183]
    s_waitcnt lgkmcnt(2)
    v_mul_f32 v236, v236, v55
    v_mul_f32 v237, v237, v55
    v_mul_f32 v238, v238, v55
    v_mul_f32 v239, v239, v55
    v_cvt_pk_bf16_f32 v236, v236, v237
    v_cvt_pk_bf16_f32 v237, v238, v239
    v_mfma_f32_16x16x4_f32 v[128:131], v7, v57, 0
    v_mfma_f32_16x16x32_bf16 a[96:99], v[176:179], v[40:43], a[96:99]
    ds_read_b128 v[32:35], v14 offset:6144
    v_accvgpr_read_b32 v240, a56
    v_mfma_f32_16x16x32_bf16 a[96:99], v[184:187], v[44:47], a[96:99]
    buffer_store_dwordx2 v[236:237], v56, s[12:15], s40 offen offset:1280 sc0 sc1
    v_accvgpr_read_b32 v241, a68
    v_accvgpr_read_b32 v242, a80
    v_accvgpr_read_b32 v243, a92
    v_mfma_f32_16x16x4_f32 v[132:135], v8, v57, 0
    v_mfma_f32_16x16x32_bf16 a[144:147], v[180:183], v[40:43], a[144:147]
    ds_read_b128 v[36:39], v14 offset:18432
    v_mul_f32 v240, v240, v52
    v_mfma_f32_16x16x32_bf16 a[144:147], v[188:191], v[44:47], a[144:147]
    s_waitcnt lgkmcnt(2)
    v_max3_f32 v18, v5, v6, v7
    v_mul_f32 v241, v241, v52
    v_max_f32 v18, v18, v8
    v_mul_f32 v242, v242, v52
    s_mov_b32 s29, 0x5f800000
    v_mfma_f32_16x16x32_bf16 a[108:111], v[176:179], v[24:27], a[108:111]
    ds_read_b128 v[40:43], v14 offset:9216
    v_mul_f32 v243, v243, v52
    v_mfma_f32_16x16x32_bf16 a[108:111], v[184:187], v[28:31], a[108:111]
    v_cmp_lt_f32 s[48:49], s29, v18
    v_cvt_pk_bf16_f32 v240, v240, v241
    v_cvt_pk_bf16_f32 v241, v242, v243
    v_accvgpr_read_b32 v244, a57
    v_accvgpr_read_b32 v245, a69
    v_accvgpr_read_b32 v246, a81
    v_mfma_f32_16x16x32_bf16 a[156:159], v[180:183], v[24:27], a[156:159]
    ds_read_b128 v[44:47], v14 offset:21504
    v_accvgpr_read_b32 v247, a93
    v_mfma_f32_16x16x32_bf16 a[156:159], v[188:191], v[28:31], a[156:159]
    s_waitcnt lgkmcnt(2)
    buffer_store_dwordx2 v[240:241], v56, s[12:15], s40 offen offset:256 sc0 sc1
    v_rcp_f32 v128, v128
    v_mul_f32 v244, v244, v53
    v_mfma_f32_16x16x32_bf16 a[120:123], v[176:179], v[32:35], a[120:123]
    ds_read_b128 v[24:27], v22 offset:1024
    v_mul_f32 v245, v245, v53
    v_mfma_f32_16x16x32_bf16 a[120:123], v[184:187], v[36:39], a[120:123]
    v_rcp_f32 v129, v129
    v_rcp_f32 v130, v130
    v_rcp_f32 v131, v131
    v_mfma_f32_16x16x32_bf16 a[168:171], v[180:183], v[32:35], a[168:171]
    ds_read_b128 v[28:31], v22 offset:13312
    v_mul_f32 v246, v246, v53
    v_mfma_f32_16x16x32_bf16 a[168:171], v[188:191], v[36:39], a[168:171]
    s_waitcnt lgkmcnt(2)
    v_rcp_f32 v132, v132
    v_mul_f32 v247, v247, v53
    v_cvt_pk_bf16_f32 v244, v244, v245
    v_rcp_f32 v133, v133
    v_mfma_f32_16x16x32_bf16 a[132:135], v[176:179], v[40:43], a[132:135]
    ds_read_b128 v[32:35], v22 offset:4096
    v_cvt_pk_bf16_f32 v245, v246, v247
    v_mfma_f32_16x16x32_bf16 a[132:135], v[184:187], v[44:47], a[132:135]
    buffer_store_dwordx2 v[244:245], v56, s[12:15], s40 offen offset:640 sc0 sc1
    v_rcp_f32 v134, v134
    v_accvgpr_read_b32 v248, a58
    v_mfma_f32_16x16x32_bf16 a[180:183], v[180:183], v[40:43], a[180:183]
    ds_read_b128 v[36:39], v22 offset:16384
    v_rcp_f32 v135, v135
    v_mfma_f32_16x16x32_bf16 a[180:183], v[188:191], v[44:47], a[180:183]
    s_waitcnt lgkmcnt(2)
    v_accvgpr_read_b32 v249, a70
    v_accvgpr_read_b32 v250, a82
    v_accvgpr_read_b32 v251, a94
    v_mul_f32 v248, v248, v54
    v_mul_f32 v249, v249, v54
    v_mfma_f32_16x16x32_bf16 a[100:103], v[80:83], v[24:27], a[100:103]
    ds_read_b128 v[40:43], v22 offset:7168
    v_mul_f32 v250, v250, v54
    v_mfma_f32_16x16x32_bf16 a[100:103], v[88:91], v[28:31], a[100:103]
    v_mul_f32 v251, v251, v54
    v_cvt_pk_bf16_f32 v248, v248, v249
    v_cvt_pk_bf16_f32 v249, v250, v251
    v_accvgpr_read_b32 v252, a59
    v_accvgpr_read_b32 v253, a71
    v_accvgpr_read_b32 v254, a83
    v_mfma_f32_16x16x32_bf16 a[148:151], v[84:87], v[24:27], a[148:151]
    ds_read_b128 v[44:47], v22 offset:19456
    v_accvgpr_read_b32 v255, a95
    v_mfma_f32_16x16x32_bf16 a[148:151], v[92:95], v[28:31], a[148:151]
    s_waitcnt lgkmcnt(2)
    s_cmp_lg_u64 s[48:49], 0
    s_cbranch_scc1 L_slow
    v_mul_f32 v252, v252, v55
    v_mul_f32 v253, v253, v55
    v_mfma_f32_16x16x32_bf16 a[112:115], v[80:83], v[32:35], a[112:115]
    ds_read_b128 v[24:27], v22 offset:10240
    v_mul_f32 v254, v254, v55
    v_mfma_f32_16x16x32_bf16 a[112:115], v[88:91], v[36:39], a[112:115]
    buffer_store_dwordx2 v[248:249], v56, s[12:15], s40 offen offset:1024 sc0 sc1
    v_mul_f32 v255, v255, v55
    v_cvt_pk_bf16_f32 v252, v252, v253
    v_cvt_pk_bf16_f32 v253, v254, v255
    v_mfma_f32_16x16x32_bf16 a[160:163], v[84:87], v[32:35], a[160:163]
    ds_read_b128 v[28:31], v22 offset:22528
    v_accvgpr_read_b32 v224, a96
    v_mfma_f32_16x16x32_bf16 a[160:163], v[92:95], v[36:39], a[160:163]
    s_waitcnt lgkmcnt(2)
    buffer_store_dwordx2 v[252:253], v56, s[12:15], s40 offen offset:1408 sc0 sc1
    v_accvgpr_read_b32 v225, a108
    v_accvgpr_read_b32 v226, a120
    v_accvgpr_read_b32 v227, a132
    v_mfma_f32_16x16x32_bf16 a[124:127], v[80:83], v[40:43], a[124:127]
    ds_read_b128 v[32:35], v1 offset:1024
    v_mul_f32 v224, v224, v128
    v_mfma_f32_16x16x32_bf16 a[124:127], v[88:91], v[44:47], a[124:127]
    v_mul_f32 v225, v225, v128
    v_mul_f32 v226, v226, v128
    v_mul_f32 v227, v227, v128
    v_cvt_pk_bf16_f32 v224, v224, v225
    v_cvt_pk_bf16_f32 v225, v226, v227
    v_accvgpr_read_b32 v228, a97
    v_mfma_f32_16x16x32_bf16 a[172:175], v[84:87], v[40:43], a[172:175]
    ds_read_b128 v[36:39], v1 offset:13312
    v_accvgpr_read_b32 v229, a109
    v_mfma_f32_16x16x32_bf16 a[172:175], v[92:95], v[44:47], a[172:175]
    s_waitcnt lgkmcnt(2)
    buffer_store_dwordx2 v[224:225], v56, s[12:15], s41 offen offset:0 sc0 sc1
    v_accvgpr_read_b32 v230, a121
    v_accvgpr_read_b32 v231, a133
    v_mul_f32 v228, v228, v129
    v_mfma_f32_16x16x32_bf16 a[136:139], v[80:83], v[24:27], a[136:139]
    ds_read_b128 v[40:43], v1 offset:4096
    v_mul_f32 v229, v229, v129
    v_mfma_f32_16x16x32_bf16 a[136:139], v[88:91], v[28:31], a[136:139]
    v_mul_f32 v230, v230, v129
    v_mul_f32 v231, v231, v129
    v_cvt_pk_bf16_f32 v228, v228, v229
    v_cvt_pk_bf16_f32 v229, v230, v231
    v_accvgpr_read_b32 v232, a98
    v_accvgpr_read_b32 v233, a110
    v_mfma_f32_16x16x32_bf16 a[184:187], v[84:87], v[24:27], a[184:187]
    ds_read_b128 v[44:47], v1 offset:16384
    v_accvgpr_read_b32 v234, a122
    v_mfma_f32_16x16x32_bf16 a[184:187], v[92:95], v[28:31], a[184:187]
    s_waitcnt lgkmcnt(2)
    buffer_store_dwordx2 v[228:229], v56, s[12:15], s41 offen offset:384 sc0 sc1
    v_accvgpr_read_b32 v235, a134
    v_mul_f32 v232, v232, v130
    v_mul_f32 v233, v233, v130
    v_mfma_f32_16x16x32_bf16 a[100:103], v[160:163], v[32:35], a[100:103]
    ds_read_b128 v[24:27], v1 offset:7168
    v_mul_f32 v234, v234, v130
    v_mfma_f32_16x16x32_bf16 a[100:103], v[168:171], v[36:39], a[100:103]
    v_mul_f32 v235, v235, v130
    v_cvt_pk_bf16_f32 v232, v232, v233
    v_cvt_pk_bf16_f32 v233, v234, v235
    v_accvgpr_read_b32 v236, a99
    v_accvgpr_read_b32 v237, a111
    v_accvgpr_read_b32 v238, a123
    v_mfma_f32_16x16x32_bf16 a[148:151], v[164:167], v[32:35], a[148:151]
    ds_read_b128 v[28:31], v1 offset:19456
    v_accvgpr_read_b32 v239, a135
    v_mfma_f32_16x16x32_bf16 a[148:151], v[172:175], v[36:39], a[148:151]
    s_waitcnt lgkmcnt(2)
    buffer_store_dwordx2 v[232:233], v56, s[12:15], s41 offen offset:768 sc0 sc1
    v_mul_f32 v236, v236, v131
    v_mul_f32 v237, v237, v131
    v_mul_f32 v238, v238, v131
    v_mfma_f32_16x16x32_bf16 a[112:115], v[160:163], v[40:43], a[112:115]
    ds_read_b128 v[32:35], v1 offset:10240
    v_mul_f32 v239, v239, v131
    v_mfma_f32_16x16x32_bf16 a[112:115], v[168:171], v[44:47], a[112:115]
    v_cvt_pk_bf16_f32 v236, v236, v237
    v_cvt_pk_bf16_f32 v237, v238, v239
    v_accvgpr_read_b32 v240, a144
    v_accvgpr_read_b32 v241, a156
    v_accvgpr_read_b32 v242, a168
    v_accvgpr_read_b32 v243, a180
    v_mfma_f32_16x16x32_bf16 a[160:163], v[164:167], v[40:43], a[160:163]
    ds_read_b128 v[36:39], v1 offset:22528
    v_mul_f32 v240, v240, v132
    v_mfma_f32_16x16x32_bf16 a[160:163], v[172:175], v[44:47], a[160:163]
    s_waitcnt lgkmcnt(2)
    buffer_store_dwordx2 v[236:237], v56, s[12:15], s41 offen offset:1152 sc0 sc1
    v_mul_f32 v241, v241, v132
    v_mul_f32 v242, v242, v132
    v_mul_f32 v243, v243, v132
    v_mfma_f32_16x16x32_bf16 a[124:127], v[160:163], v[24:27], a[124:127]
    ds_read_b128 v[40:43], v14 offset:1024
    v_cvt_pk_bf16_f32 v240, v240, v241
    v_mfma_f32_16x16x32_bf16 a[124:127], v[168:171], v[28:31], a[124:127]
    v_cvt_pk_bf16_f32 v241, v242, v243
    v_accvgpr_read_b32 v244, a145
    v_accvgpr_read_b32 v245, a157
    v_accvgpr_read_b32 v246, a169
    v_accvgpr_read_b32 v247, a181
    v_mfma_f32_16x16x32_bf16 a[172:175], v[164:167], v[24:27], a[172:175]
    ds_read_b128 v[44:47], v14 offset:13312
    v_mul_f32 v244, v244, v133
    v_mfma_f32_16x16x32_bf16 a[172:175], v[172:175], v[28:31], a[172:175]
    s_waitcnt lgkmcnt(2)
    buffer_store_dwordx2 v[240:241], v56, s[12:15], s42 offen offset:0 sc0 sc1
    v_mul_f32 v245, v245, v133
    v_mul_f32 v246, v246, v133
    v_mul_f32 v247, v247, v133
    v_mfma_f32_16x16x32_bf16 a[136:139], v[160:163], v[32:35], a[136:139]
    ds_read_b128 v[24:27], v14 offset:4096
    v_cvt_pk_bf16_f32 v244, v244, v245
    v_mfma_f32_16x16x32_bf16 a[136:139], v[168:171], v[36:39], a[136:139]
    v_cvt_pk_bf16_f32 v245, v246, v247
    v_accvgpr_read_b32 v248, a146
    v_accvgpr_read_b32 v249, a158
    v_accvgpr_read_b32 v250, a170
    v_accvgpr_read_b32 v251, a182
    v_mul_f32 v248, v248, v134
    v_mfma_f32_16x16x32_bf16 a[184:187], v[164:167], v[32:35], a[184:187]
    ds_read_b128 v[28:31], v14 offset:16384
    v_mul_f32 v249, v249, v134
    v_mfma_f32_16x16x32_bf16 a[184:187], v[172:175], v[36:39], a[184:187]
    s_waitcnt lgkmcnt(2)
    buffer_store_dwordx2 v[244:245], v56, s[12:15], s42 offen offset:384 sc0 sc1
    v_mul_f32 v250, v250, v134
    v_mul_f32 v251, v251, v134
    v_cvt_pk_bf16_f32 v248, v248, v249
    v_mfma_f32_16x16x32_bf16 a[100:103], v[176:179], v[40:43], a[100:103]
    ds_read_b128 v[32:35], v14 offset:7168
    v_cvt_pk_bf16_f32 v249, v250, v251
    v_mfma_f32_16x16x32_bf16 a[100:103], v[184:187], v[44:47], a[100:103]
    buffer_store_dwordx2 v[248:249], v56, s[12:15], s42 offen offset:768 sc0 sc1
    v_accvgpr_read_b32 v252, a147
    v_accvgpr_read_b32 v253, a159
    v_accvgpr_read_b32 v254, a171
    v_mfma_f32_16x16x32_bf16 a[148:151], v[180:183], v[40:43], a[148:151]
    ds_read_b128 v[36:39], v14 offset:19456
    v_accvgpr_read_b32 v255, a183
    v_mfma_f32_16x16x32_bf16 a[148:151], v[188:191], v[44:47], a[148:151]
    s_waitcnt lgkmcnt(2)
    v_mul_f32 v252, v252, v135
    v_mul_f32 v253, v253, v135
    v_mul_f32 v254, v254, v135
    v_mul_f32 v255, v255, v135
    v_cvt_pk_bf16_f32 v252, v252, v253
    v_cvt_pk_bf16_f32 v253, v254, v255
    v_mfma_f32_16x16x32_bf16 a[112:115], v[176:179], v[24:27], a[112:115]
    ds_read_b128 v[40:43], v14 offset:10240
    v_mfma_f32_16x16x32_bf16 a[112:115], v[184:187], v[28:31], a[112:115]
    buffer_store_dwordx2 v[252:253], v56, s[12:15], s42 offen offset:1152 sc0 sc1
    v_mfma_f32_16x16x32_bf16 a[160:163], v[180:183], v[24:27], a[160:163]
    ds_read_b128 v[44:47], v14 offset:22528
    v_mfma_f32_16x16x32_bf16 a[160:163], v[188:191], v[28:31], a[160:163]
    s_waitcnt lgkmcnt(2)
    v_mfma_f32_16x16x32_bf16 a[124:127], v[176:179], v[32:35], a[124:127]
    ds_read_b128 v[24:27], v22 offset:2048
    v_mfma_f32_16x16x32_bf16 a[124:127], v[184:187], v[36:39], a[124:127]
    v_mfma_f32_16x16x32_bf16 a[172:175], v[180:183], v[32:35], a[172:175]
    ds_read_b128 v[28:31], v22 offset:14336
    v_mfma_f32_16x16x32_bf16 a[172:175], v[188:191], v[36:39], a[172:175]
    s_waitcnt lgkmcnt(2)
    v_mfma_f32_16x16x32_bf16 a[136:139], v[176:179], v[40:43], a[136:139]
    ds_read_b128 v[32:35], v22 offset:5120
    v_mfma_f32_16x16x32_bf16 a[136:139], v[184:187], v[44:47], a[136:139]
    v_mfma_f32_16x16x32_bf16 a[184:187], v[180:183], v[40:43], a[184:187]
    ds_read_b128 v[36:39], v22 offset:17408
    v_mfma_f32_16x16x32_bf16 a[184:187], v[188:191], v[44:47], a[184:187]
    s_waitcnt lgkmcnt(2)
    v_mfma_f32_16x16x32_bf16 a[104:107], v[80:83], v[24:27], a[104:107]
    ds_read_b128 v[40:43], v22 offset:8192
    v_mfma_f32_16x16x32_bf16 a[104:107], v[88:91], v[28:31], a[104:107]
    v_mfma_f32_16x16x32_bf16 a[152:155], v[84:87], v[24:27], a[152:155]
    ds_read_b128 v[44:47], v22 offset:20480
    v_mfma_f32_16x16x32_bf16 a[152:155], v[92:95], v[28:31], a[152:155]
    s_waitcnt lgkmcnt(2)
    v_mfma_f32_16x16x32_bf16 a[116:119], v[80:83], v[32:35], a[116:119]
    ds_read_b128 v[24:27], v22 offset:11264
    v_accvgpr_read_b32 v224, a100
    v_mfma_f32_16x16x32_bf16 a[116:119], v[88:91], v[36:39], a[116:119]
    v_accvgpr_read_b32 v225, a112
    v_accvgpr_read_b32 v226, a124
    v_accvgpr_read_b32 v227, a136
    v_mul_f32 v224, v224, v128
    v_mul_f32 v225, v225, v128
    v_mul_f32 v226, v226, v128
    v_mul_f32 v227, v227, v128
    v_cvt_pk_bf16_f32 v224, v224, v225
    v_cvt_pk_bf16_f32 v225, v226, v227
    v_accvgpr_read_b32 v228, a101
    v_accvgpr_read_b32 v229, a113
    v_accvgpr_read_b32 v230, a125
    v_accvgpr_read_b32 v231, a137
    v_mul_f32 v228, v228, v129
    v_mul_f32 v229, v229, v129
    v_mul_f32 v230, v230, v129
    v_mul_f32 v231, v231, v129
    v_cvt_pk_bf16_f32 v228, v228, v229
    v_cvt_pk_bf16_f32 v229, v230, v231
    v_accvgpr_read_b32 v232, a102
    v_accvgpr_read_b32 v233, a114
    v_accvgpr_read_b32 v234, a126
    v_accvgpr_read_b32 v235, a138
    v_mul_f32 v232, v232, v130
    v_mul_f32 v233, v233, v130
    v_mul_f32 v234, v234, v130
    v_mul_f32 v235, v235, v130
    v_cvt_pk_bf16_f32 v232, v232, v233
    v_cvt_pk_bf16_f32 v233, v234, v235
    v_accvgpr_read_b32 v236, a103
    v_accvgpr_read_b32 v237, a115
    v_accvgpr_read_b32 v238, a127
    v_accvgpr_read_b32 v239, a139
    v_mul_f32 v236, v236, v131
    v_mul_f32 v237, v237, v131
    v_mul_f32 v238, v238, v131
    v_mfma_f32_16x16x32_bf16 a[164:167], v[84:87], v[32:35], a[164:167]
    ds_read_b128 v[28:31], v22 offset:23552
    v_mul_f32 v239, v239, v131
    v_mfma_f32_16x16x32_bf16 a[164:167], v[92:95], v[36:39], a[164:167]
    s_waitcnt lgkmcnt(2)
    buffer_store_dwordx2 v[224:225], v56, s[12:15], s41 offen offset:128 sc0 sc1
    v_cvt_pk_bf16_f32 v236, v236, v237
    v_cvt_pk_bf16_f32 v237, v238, v239
    v_accvgpr_read_b32 v240, a148
    v_mfma_f32_16x16x32_bf16 a[128:131], v[80:83], v[40:43], a[128:131]
    ds_read_b128 v[32:35], v1 offset:2048
    v_accvgpr_read_b32 v241, a160
    v_mfma_f32_16x16x32_bf16 a[128:131], v[88:91], v[44:47], a[128:131]
    buffer_store_dwordx2 v[228:229], v56, s[12:15], s41 offen offset:512 sc0 sc1
    v_accvgpr_read_b32 v242, a172
    v_accvgpr_read_b32 v243, a184
    v_mul_f32 v240, v240, v132
    v_mfma_f32_16x16x32_bf16 a[176:179], v[84:87], v[40:43], a[176:179]
    ds_read_b128 v[36:39], v1 offset:14336
    v_mul_f32 v241, v241, v132
    v_mfma_f32_16x16x32_bf16 a[176:179], v[92:95], v[44:47], a[176:179]
    s_waitcnt lgkmcnt(2)
    buffer_store_dwordx2 v[232:233], v56, s[12:15], s41 offen offset:896 sc0 sc1
    v_mul_f32 v242, v242, v132
    v_mul_f32 v243, v243, v132
    v_cvt_pk_bf16_f32 v240, v240, v241
    v_mfma_f32_16x16x32_bf16 a[140:143], v[80:83], v[24:27], a[140:143]
    ds_read_b128 v[40:43], v1 offset:5120
    v_cvt_pk_bf16_f32 v241, v242, v243
    v_mfma_f32_16x16x32_bf16 a[140:143], v[88:91], v[28:31], a[140:143]
    buffer_store_dwordx2 v[236:237], v56, s[12:15], s41 offen offset:1280 sc0 sc1
    v_accvgpr_read_b32 v244, a149
    v_accvgpr_read_b32 v245, a161
    v_accvgpr_read_b32 v246, a173
    v_mfma_f32_16x16x32_bf16 a[188:191], v[84:87], v[24:27], a[188:191]
    ds_read_b128 v[44:47], v1 offset:17408
    v_accvgpr_read_b32 v247, a185
    v_mfma_f32_16x16x32_bf16 a[188:191], v[92:95], v[28:31], a[188:191]
    s_waitcnt lgkmcnt(2)
    buffer_store_dwordx2 v[240:241], v56, s[12:15], s42 offen offset:128 sc0 sc1
    v_mul_f32 v244, v244, v133
    v_mul_f32 v245, v245, v133
    v_mul_f32 v246, v246, v133
    v_mfma_f32_16x16x32_bf16 a[104:107], v[160:163], v[32:35], a[104:107]
    ds_read_b128 v[24:27], v1 offset:8192
    v_mul_f32 v247, v247, v133
    v_mfma_f32_16x16x32_bf16 a[104:107], v[168:171], v[36:39], a[104:107]
    v_cvt_pk_bf16_f32 v244, v244, v245
    v_cvt_pk_bf16_f32 v245, v246, v247
    v_accvgpr_read_b32 v248, a150
    v_accvgpr_read_b32 v249, a162
    v_accvgpr_read_b32 v250, a174
    v_accvgpr_read_b32 v251, a186
    v_mfma_f32_16x16x32_bf16 a[152:155], v[164:167], v[32:35], a[152:155]
    ds_read_b128 v[28:31], v1 offset:20480
    v_mul_f32 v248, v248, v134
    v_mfma_f32_16x16x32_bf16 a[152:155], v[172:175], v[36:39], a[152:155]
    s_waitcnt lgkmcnt(2)
    buffer_store_dwordx2 v[244:245], v56, s[12:15], s42 offen offset:512 sc0 sc1
    v_mul_f32 v249, v249, v134
    v_mul_f32 v250, v250, v134
    v_mul_f32 v251, v251, v134
    v_mfma_f32_16x16x32_bf16 a[116:119], v[160:163], v[40:43], a[116:119]
    ds_read_b128 v[32:35], v1 offset:11264
    v_cvt_pk_bf16_f32 v248, v248, v249
    v_mfma_f32_16x16x32_bf16 a[116:119], v[168:171], v[44:47], a[116:119]
    v_cvt_pk_bf16_f32 v249, v250, v251
    v_accvgpr_read_b32 v252, a151
    v_accvgpr_read_b32 v253, a163
    v_accvgpr_read_b32 v254, a175
    v_accvgpr_read_b32 v255, a187
    v_mul_f32 v252, v252, v135
    v_mfma_f32_16x16x32_bf16 a[164:167], v[164:167], v[40:43], a[164:167]
    ds_read_b128 v[36:39], v1 offset:23552
    v_mul_f32 v253, v253, v135
    v_mfma_f32_16x16x32_bf16 a[164:167], v[172:175], v[44:47], a[164:167]
    s_waitcnt lgkmcnt(2)
    buffer_store_dwordx2 v[248:249], v56, s[12:15], s42 offen offset:896 sc0 sc1
    v_mul_f32 v254, v254, v135
    v_mul_f32 v255, v255, v135
    v_cvt_pk_bf16_f32 v252, v252, v253
    v_mfma_f32_16x16x32_bf16 a[128:131], v[160:163], v[24:27], a[128:131]
    ds_read_b128 v[40:43], v14 offset:2048
    v_cvt_pk_bf16_f32 v253, v254, v255
    v_mfma_f32_16x16x32_bf16 a[128:131], v[168:171], v[28:31], a[128:131]
    buffer_store_dwordx2 v[252:253], v56, s[12:15], s42 offen offset:1280 sc0 sc1
    v_mfma_f32_16x16x32_bf16 a[176:179], v[164:167], v[24:27], a[176:179]
    ds_read_b128 v[44:47], v14 offset:14336
    v_mfma_f32_16x16x32_bf16 a[176:179], v[172:175], v[28:31], a[176:179]
    s_waitcnt lgkmcnt(2)
    v_mfma_f32_16x16x32_bf16 a[140:143], v[160:163], v[32:35], a[140:143]
    ds_read_b128 v[24:27], v14 offset:5120
    v_mfma_f32_16x16x32_bf16 a[140:143], v[168:171], v[36:39], a[140:143]
    v_mfma_f32_16x16x32_bf16 a[188:191], v[164:167], v[32:35], a[188:191]
    ds_read_b128 v[28:31], v14 offset:17408
    v_mfma_f32_16x16x32_bf16 a[188:191], v[172:175], v[36:39], a[188:191]
    s_waitcnt lgkmcnt(2)
    v_mfma_f32_16x16x32_bf16 a[104:107], v[176:179], v[40:43], a[104:107]
    ds_read_b128 v[32:35], v14 offset:8192
    v_mfma_f32_16x16x32_bf16 a[104:107], v[184:187], v[44:47], a[104:107]
    v_mfma_f32_16x16x32_bf16 a[152:155], v[180:183], v[40:43], a[152:155]
    ds_read_b128 v[36:39], v14 offset:20480
    v_mfma_f32_16x16x32_bf16 a[152:155], v[188:191], v[44:47], a[152:155]
    s_waitcnt lgkmcnt(2)
    v_mfma_f32_16x16x32_bf16 a[116:119], v[176:179], v[24:27], a[116:119]
    ds_read_b128 v[40:43], v14 offset:11264
    v_mfma_f32_16x16x32_bf16 a[116:119], v[184:187], v[28:31], a[116:119]
    v_mfma_f32_16x16x32_bf16 a[164:167], v[180:183], v[24:27], a[164:167]
    ds_read_b128 v[44:47], v14 offset:23552
    v_mfma_f32_16x16x32_bf16 a[164:167], v[188:191], v[28:31], a[164:167]
    s_waitcnt lgkmcnt(2)
    v_mfma_f32_16x16x32_bf16 a[128:131], v[176:179], v[32:35], a[128:131]
    v_mfma_f32_16x16x32_bf16 a[128:131], v[184:187], v[36:39], a[128:131]
    v_mfma_f32_16x16x32_bf16 a[176:179], v[180:183], v[32:35], a[176:179]
    v_mfma_f32_16x16x32_bf16 a[176:179], v[188:191], v[36:39], a[176:179]
    s_waitcnt lgkmcnt(0)
    v_mfma_f32_16x16x32_bf16 a[140:143], v[176:179], v[40:43], a[140:143]
    v_mfma_f32_16x16x32_bf16 a[140:143], v[184:187], v[44:47], a[140:143]
    v_mfma_f32_16x16x32_bf16 a[188:191], v[180:183], v[40:43], a[188:191]
    v_mfma_f32_16x16x32_bf16 a[188:191], v[188:191], v[44:47], a[188:191]
    s_nop 7
    v_accvgpr_read_b32 v224, a104
    v_accvgpr_read_b32 v225, a116
    v_accvgpr_read_b32 v226, a128
    v_accvgpr_read_b32 v227, a140
    v_pk_mul_f32 v[224:225], v[224:225], v[128:129] op_sel_hi:[1,0]
    v_pk_mul_f32 v[226:227], v[226:227], v[128:129] op_sel_hi:[1,0]
    v_cvt_pk_bf16_f32 v224, v224, v225
    v_cvt_pk_bf16_f32 v225, v226, v227
    v_accvgpr_read_b32 v228, a105
    v_accvgpr_read_b32 v229, a117
    v_accvgpr_read_b32 v230, a129
    v_accvgpr_read_b32 v231, a141
    v_pk_mul_f32 v[228:229], v[228:229], v[128:129] op_sel:[0,1] op_sel_hi:[1,1]
    v_pk_mul_f32 v[230:231], v[230:231], v[128:129] op_sel:[0,1] op_sel_hi:[1,1]
    v_cvt_pk_bf16_f32 v228, v228, v229
    v_cvt_pk_bf16_f32 v229, v230, v231
    buffer_store_dwordx2 v[224:225], v56, s[12:15], s41 offen offset:256 sc0 sc1
    v_accvgpr_read_b32 v232, a106
    v_accvgpr_read_b32 v233, a118
    v_accvgpr_read_b32 v234, a130
    v_accvgpr_read_b32 v235, a142
    v_pk_mul_f32 v[232:233], v[232:233], v[130:131] op_sel_hi:[1,0]
    v_pk_mul_f32 v[234:235], v[234:235], v[130:131] op_sel_hi:[1,0]
    v_cvt_pk_bf16_f32 v232, v232, v233
    v_cvt_pk_bf16_f32 v233, v234, v235
    buffer_store_dwordx2 v[228:229], v56, s[12:15], s41 offen offset:640 sc0 sc1
    v_accvgpr_read_b32 v236, a107
    v_accvgpr_read_b32 v237, a119
    v_accvgpr_read_b32 v238, a131
    v_accvgpr_read_b32 v239, a143
    v_pk_mul_f32 v[236:237], v[236:237], v[130:131] op_sel:[0,1] op_sel_hi:[1,1]
    v_pk_mul_f32 v[238:239], v[238:239], v[130:131] op_sel:[0,1] op_sel_hi:[1,1]
    v_cvt_pk_bf16_f32 v236, v236, v237
    v_cvt_pk_bf16_f32 v237, v238, v239
    buffer_store_dwordx2 v[232:233], v56, s[12:15], s41 offen offset:1024 sc0 sc1
    buffer_store_dwordx2 v[236:237], v56, s[12:15], s41 offen offset:1408 sc0 sc1
    v_accvgpr_read_b32 v240, a152
    v_accvgpr_read_b32 v241, a164
    v_accvgpr_read_b32 v242, a176
    v_accvgpr_read_b32 v243, a188
    v_pk_mul_f32 v[240:241], v[240:241], v[132:133] op_sel_hi:[1,0]
    v_pk_mul_f32 v[242:243], v[242:243], v[132:133] op_sel_hi:[1,0]
    v_cvt_pk_bf16_f32 v240, v240, v241
    v_cvt_pk_bf16_f32 v241, v242, v243
    v_accvgpr_read_b32 v244, a153
    v_accvgpr_read_b32 v245, a165
    v_accvgpr_read_b32 v246, a177
    v_accvgpr_read_b32 v247, a189
    v_pk_mul_f32 v[244:245], v[244:245], v[132:133] op_sel:[0,1] op_sel_hi:[1,1]
    v_pk_mul_f32 v[246:247], v[246:247], v[132:133] op_sel:[0,1] op_sel_hi:[1,1]
    v_cvt_pk_bf16_f32 v244, v244, v245
    v_cvt_pk_bf16_f32 v245, v246, v247
    buffer_store_dwordx2 v[240:241], v56, s[12:15], s42 offen offset:256 sc0 sc1
    v_accvgpr_read_b32 v248, a154
    v_accvgpr_read_b32 v249, a166
    v_accvgpr_read_b32 v250, a178
    v_accvgpr_read_b32 v251, a190
    v_pk_mul_f32 v[248:249], v[248:249], v[134:135] op_sel_hi:[1,0]
    v_pk_mul_f32 v[250:251], v[250:251], v[134:135] op_sel_hi:[1,0]
    v_cvt_pk_bf16_f32 v248, v248, v249
    v_cvt_pk_bf16_f32 v249, v250, v251
    buffer_store_dwordx2 v[244:245], v56, s[12:15], s42 offen offset:640 sc0 sc1
    v_accvgpr_read_b32 v252, a155
    v_accvgpr_read_b32 v253, a167
    v_accvgpr_read_b32 v254, a179
    v_accvgpr_read_b32 v255, a191
    v_pk_mul_f32 v[252:253], v[252:253], v[134:135] op_sel:[0,1] op_sel_hi:[1,1]
    v_pk_mul_f32 v[254:255], v[254:255], v[134:135] op_sel:[0,1] op_sel_hi:[1,1]
    v_cvt_pk_bf16_f32 v252, v252, v253
    v_cvt_pk_bf16_f32 v253, v254, v255
    buffer_store_dwordx2 v[248:249], v56, s[12:15], s42 offen offset:1024 sc0 sc1
    buffer_store_dwordx2 v[252:253], v56, s[12:15], s42 offen offset:1408 sc0 sc1
L_fin:
L_done:
    s_endpgm
L_pollslow0:
    s_mov_b32 s59, 60
L_pollsm0:
    s_buffer_load_dwordx8 s[48:55], s[20:23], s44 glc
    s_waitcnt lgkmcnt(0)
    s_sub_u32 s48, s48, s92
    s_sub_u32 s49, s49, s92
    s_sub_u32 s50, s50, s92
    s_sub_u32 s51, s51, s92
    s_sub_u32 s52, s52, s92
    s_sub_u32 s53, s53, s92
    s_sub_u32 s54, s54, s92
    s_sub_u32 s55, s55, s92
    s_max_u32 s48, s48, s49
    s_max_u32 s48, s48, s50
    s_max_u32 s48, s48, s51
    s_max_u32 s48, s48, s52
    s_max_u32 s48, s48, s53
    s_max_u32 s48, s48, s54
    s_max_u32 s48, s48, s55
    s_cmp_lt_u32 s48, 16
    s_cbranch_scc1 L_pollok0
    s_sub_u32 s59, s59, 1
    s_cbranch_scc1 L_pollvec0
    s_sleep 1
    s_branch L_pollsm0
L_pollvec0:
    v_bfe_u32 v53, v4, 4, 6
    v_lshlrev_b32 v53, 2, v53
    s_sub_u32 s96, s96, 1
    s_cbranch_scc1 L_pollgiveup0
    s_sleep 2
    buffer_load_dword v52, v53, s[20:23], s44 offen sc1
    s_waitcnt vmcnt(0)
    s_cmp_lg_u32 s44, 0
    s_cbranch_scc1 L_nomix
    v_xor_b32 v53, s92, v52
    v_lshrrev_b32 v53, 5, v53
    v_add_u32 v53, -1, v53
    v_cmp_gt_u32 vcc, 31, v53
    s_nop 1
    s_and_b32 s59, vcc_lo, 0xff00
    s_cbranch_scc0 L_nomix
    buffer_store_dwordx4 v[224:227], v11, s[4:7], s33 offen offset:0 sc1
    v_xor_b32 v55, 16, v11
    buffer_store_dwordx4 v[228:231], v55, s[4:7], s33 offen offset:768 sc1
    v_xor_b32 v54, 32, v11
    buffer_store_dwordx4 v[232:235], v54, s[4:7], s33 offen offset:1536 sc1
    v_xor_b32 v55, 48, v11
    buffer_store_dwordx4 v[236:239], v55, s[4:7], s33 offen offset:2304 sc1
    buffer_store_dwordx4 v[112:115], v20, s[4:7], s35 offen offset:0 sc1
    buffer_store_dwordx4 v[116:119], v20, s[4:7], s35 offen offset:3072 sc1
    buffer_store_dwordx4 v[120:123], v20, s[4:7], s17 offen offset:0 sc1
    buffer_store_dwordx4 v[124:127], v20, s[4:7], s17 offen offset:3072 sc1
    s_waitcnt vmcnt(0)
    s_barrier
    s_and_b32 s92, s92, 0xfffffc00
    s_add_u32 s92, s92, 512
    v_mov_b32 v0, s92
    s_add_u32 s92, s92, 1
    s_mov_b32 s44, 32
    v_add_u32 v0, 1, v0
    buffer_store_dword v0, v13, s[20:23], 0 offen offset:32 sc1
    s_branch L_pollvec0
L_nomix:
    v_subrev_u32 v52, s92, v52
    v_cmp_lt_u32 vcc, 15, v52
    s_nop 0
    s_and_b32 s59, vcc_lo, 0xff
    s_cbranch_scc1 L_pollvec0
    s_branch L_pollok0
L_pollgiveup0:
    s_mov_b32 s96, 0
    s_branch L_pollok0
L_pollslow1:
    s_mov_b32 s59, 200
L_pollsm1:
    s_buffer_load_dwordx8 s[48:55], s[20:23], s44 glc
    s_waitcnt lgkmcnt(0)
    s_sub_u32 s48, s48, s92
    s_sub_u32 s49, s49, s92
    s_sub_u32 s50, s50, s92
    s_sub_u32 s51, s51, s92
    s_sub_u32 s52, s52, s92
    s_sub_u32 s53, s53, s92
    s_sub_u32 s54, s54, s92
    s_sub_u32 s55, s55, s92
    s_max_u32 s48, s48, s49
    s_max_u32 s48, s48, s50
    s_max_u32 s48, s48, s51
    s_max_u32 s48, s48, s52
    s_max_u32 s48, s48, s53
    s_max_u32 s48, s48, s54
    s_max_u32 s48, s48, s55
    s_cmp_lt_u32 s48, 16
    s_cbranch_scc1 L_pollok1
    s_sub_u32 s59, s59, 1
    s_cbranch_scc1 L_pollvec1
    s_sleep 1
    s_branch L_pollsm1
L_pollvec1:
    v_bfe_u32 v53, v4, 4, 6
    v_lshlrev_b32 v53, 2, v53
    s_sub_u32 s96, s96, 1
    s_cbranch_scc1 L_pollgiveup1
    s_sleep 2
    buffer_load_dword v52, v53, s[20:23], s44 offen sc1
    s_waitcnt vmcnt(0)
    v_subrev_u32 v52, s92, v52
    v_cmp_lt_u32 vcc, 15, v52
    s_nop 0
    s_and_b32 s59, vcc_lo, 0xff
    s_cbranch_scc1 L_pollvec1
    s_branch L_pollok1
L_pollgiveup1:
    s_mov_b32 s96, 0
    s_branch L_pollok1
L_pollslow2:
    s_mov_b32 s59, 200
L_pollsm2:
    s_buffer_load_dwordx8 s[48:55], s[20:23], s44 glc
    s_waitcnt lgkmcnt(0)
    s_sub_u32 s48, s48, s92
    s_sub_u32 s49, s49, s92
    s_sub_u32 s50, s50, s92
    s_sub_u32 s51, s51, s92
    s_sub_u32 s52, s52, s92
    s_sub_u32 s53, s53, s92
    s_sub_u32 s54, s54, s92
    s_sub_u32 s55, s55, s92
    s_max_u32 s48, s48, s49
    s_max_u32 s48, s48, s50
    s_max_u32 s48, s48, s51
    s_max_u32 s48, s48, s52
    s_max_u32 s48, s48, s53
    s_max_u32 s48, s48, s54
    s_max_u32 s48, s48, s55
    s_cmp_lt_u32 s48, 16
    s_cbranch_scc1 L_pollok2
    s_sub_u32 s59, s59, 1
    s_cbranch_scc1 L_pollvec2
    s_sleep 1
    s_branch L_pollsm2
L_pollvec2:
    v_bfe_u32 v53, v4, 4, 6
    v_lshlrev_b32 v53, 2, v53
    s_sub_u32 s96, s96, 1
    s_cbranch_scc1 L_pollgiveup2
    s_sleep 2
    buffer_load_dword v52, v53, s[20:23], s44 offen sc1
    s_waitcnt vmcnt(0)
    v_subrev_u32 v52, s92, v52
    v_cmp_lt_u32 vcc, 15, v52
    s_nop 0
    s_and_b32 s59, vcc_lo, 0xff
    s_cbranch_scc1 L_pollvec2
    s_branch L_pollok2
L_pollgiveup2:
    s_mov_b32 s96, 0
    s_branch L_pollok2
L_tagslow:
    s_sub_u32 s96, s96, 1
    s_cbranch_scc1 L_taggiveup
    s_sleep 2
    buffer_load_dword v0, off, s[88:91], s93 sc1
    s_waitcnt vmcnt(0)
    v_readfirstlane_b32 s42, v0
    s_nop 0
    s_cmp_eq_u32 s42, s46
    s_cbranch_scc1 L_tagslow
    s_cmp_eq_u32 s42, 0
    s_cbranch_scc1 L_tagslow
    s_branch L_tagok
L_taggiveup:
    s_mov_b32 s96, 0
    s_branch L_tagok
L_slow:
    s_waitcnt vmcnt(0) lgkmcnt(0)
    s_nop 15
    v_accvgpr_write_b32 a0, 0
    v_accvgpr_write_b32 a1, 0
    v_accvgpr_write_b32 a2, 0
    v_accvgpr_write_b32 a3, 0
    v_accvgpr_write_b32 a4, 0
    v_accvgpr_write_b32 a5, 0
    v_accvgpr_write_b32 a6, 0
    v_accvgpr_write_b32 a7, 0
    v_accvgpr_write_b32 a8, 0
    v_accvgpr_write_b32 a9, 0
    v_accvgpr_write_b32 a10, 0
    v_accvgpr_write_b32 a11, 0
    v_accvgpr_write_b32 a12, 0
    v_accvgpr_write_b32 a13, 0
    v_accvgpr_write_b32 a14, 0
    v_accvgpr_write_b32 a15, 0
    v_accvgpr_write_b32 a16, 0
    v_accvgpr_write_b32 a17, 0
    v_accvgpr_write_b32 a18, 0
    v_accvgpr_write_b32 a19, 0
    v_accvgpr_write_b32 a20, 0
    v_accvgpr_write_b32 a21, 0
    v_accvgpr_write_b32 a22, 0
    v_accvgpr_write_b32 a23, 0
    v_accvgpr_write_b32 a24, 0
    v_accvgpr_write_b32 a25, 0
    v_accvgpr_write_b32 a26, 0
    v_accvgpr_write_b32 a27, 0
    v_accvgpr_write_b32 a28, 0
    v_accvgpr_write_b32 a29, 0
    v_accvgpr_write_b32 a30, 0
    v_accvgpr_write_b32 a31, 0
    v_accvgpr_write_b32 a32, 0
    v_accvgpr_write_b32 a33, 0
    v_accvgpr_write_b32 a34, 0
    v_accvgpr_write_b32 a35, 0
    v_accvgpr_write_b32 a36, 0
    v_accvgpr_write_b32 a37, 0
    v_accvgpr_write_b32 a38, 0
    v_accvgpr_write_b32 a39, 0
    v_accvgpr_write_b32 a40, 0
    v_accvgpr_write_b32 a41, 0
    v_accvgpr_write_b32 a42, 0
    v_accvgpr_write_b32 a43, 0
    v_accvgpr_write_b32 a44, 0
    v_accvgpr_write_b32 a45, 0
    v_accvgpr_write_b32 a46, 0
    v_accvgpr_write_b32 a47, 0
    v_accvgpr_write_b32 a48, 0
    v_accvgpr_write_b32 a49, 0
    v_accvgpr_write_b32 a50, 0
    v_accvgpr_write_b32 a51, 0
    v_accvgpr_write_b32 a52, 0
    v_accvgpr_write_b32 a53, 0
    v_accvgpr_write_b32 a54, 0
    v_accvgpr_write_b32 a55, 0
    v_accvgpr_write_b32 a56, 0
    v_accvgpr_write_b32 a57, 0
    v_accvgpr_write_b32 a58, 0
    v_accvgpr_write_b32 a59, 0
    v_accvgpr_write_b32 a60, 0
    v_accvgpr_write_b32 a61, 0
    v_accvgpr_write_b32 a62, 0
    v_accvgpr_write_b32 a63, 0
    v_accvgpr_write_b32 a64, 0
    v_accvgpr_write_b32 a65, 0
    v_accvgpr_write_b32 a66, 0
    v_accvgpr_write_b32 a67, 0
    v_accvgpr_write_b32 a68, 0
    v_accvgpr_write_b32 a69, 0
    v_accvgpr_write_b32 a70, 0
    v_accvgpr_write_b32 a71, 0
    v_accvgpr_write_b32 a72, 0
    v_accvgpr_write_b32 a73, 0
    v_accvgpr_write_b32 a74, 0
    v_accvgpr_write_b32 a75, 0
    v_accvgpr_write_b32 a76, 0
    v_accvgpr_write_b32 a77, 0
    v_accvgpr_write_b32 a78, 0
    v_accvgpr_write_b32 a79, 0
    v_accvgpr_write_b32 a80, 0
    v_accvgpr_write_b32 a81, 0
    v_accvgpr_write_b32 a82, 0
    v_accvgpr_write_b32 a83, 0
    v_accvgpr_write_b32 a84, 0
    v_accvgpr_write_b32 a85, 0
    v_accvgpr_write_b32 a86, 0
    v_accvgpr_write_b32 a87, 0
    v_accvgpr_write_b32 a88, 0
    v_accvgpr_write_b32 a89, 0
    v_accvgpr_write_b32 a90, 0
    v_accvgpr_write_b32 a91, 0
    v_accvgpr_write_b32 a92, 0
    v_accvgpr_write_b32 a93, 0
    v_accvgpr_write_b32 a94, 0
    v_accvgpr_write_b32 a95, 0
    v_accvgpr_write_b32 a96, 0
    v_accvgpr_write_b32 a97, 0
    v_accvgpr_write_b32 a98, 0
    v_accvgpr_write_b32 a99, 0
    v_accvgpr_write_b32 a100, 0
    v_accvgpr_write_b32 a101, 0
    v_accvgpr_write_b32 a102, 0
    v_accvgpr_write_b32 a103, 0
    v_accvgpr_write_b32 a104, 0
    v_accvgpr_write_b32 a105, 0
    v_accvgpr_write_b32 a106, 0
    v_accvgpr_write_b32 a107, 0
    v_accvgpr_write_b32 a108, 0
    v_accvgpr_write_b32 a109, 0
    v_accvgpr_write_b32 a110, 0
    v_accvgpr_write_b32 a111, 0
    v_accvgpr_write_b32 a112, 0
    v_accvgpr_write_b32 a113, 0
    v_accvgpr_write_b32 a114, 0
    v_accvgpr_write_b32 a115, 0
    v_accvgpr_write_b32 a116, 0
    v_accvgpr_write_b32 a117, 0
    v_accvgpr_write_b32 a118, 0
    v_accvgpr_write_b32 a119, 0
    v_accvgpr_write_b32 a120, 0
    v_accvgpr_write_b32 a121, 0
    v_accvgpr_write_b32 a122, 0
    v_accvgpr_write_b32 a123, 0
    v_accvgpr_write_b32 a124, 0
    v_accvgpr_write_b32 a125, 0
    v_accvgpr_write_b32 a126, 0
    v_accvgpr_write_b32 a127, 0
    v_accvgpr_write_b32 a128, 0
    v_accvgpr_write_b32 a129, 0
    v_accvgpr_write_b32 a130, 0
    v_accvgpr_write_b32 a131, 0
    v_accvgpr_write_b32 a132, 0
    v_accvgpr_write_b32 a133, 0
    v_accvgpr_write_b32 a134, 0
    v_accvgpr_write_b32 a135, 0
    v_accvgpr_write_b32 a136, 0
    v_accvgpr_write_b32 a137, 0
    v_accvgpr_write_b32 a138, 0
    v_accvgpr_write_b32 a139, 0
    v_accvgpr_write_b32 a140, 0
    v_accvgpr_write_b32 a141, 0
    v_accvgpr_write_b32 a142, 0
    v_accvgpr_write_b32 a143, 0
    v_accvgpr_write_b32 a144, 0
    v_accvgpr_write_b32 a145, 0
    v_accvgpr_write_b32 a146, 0
    v_accvgpr_write_b32 a147, 0
    v_accvgpr_write_b32 a148, 0
    v_accvgpr_write_b32 a149, 0
    v_accvgpr_write_b32 a150, 0
    v_accvgpr_write_b32 a151, 0
    v_accvgpr_write_b32 a152, 0
    v_accvgpr_write_b32 a153, 0
    v_accvgpr_write_b32 a154, 0
    v_accvgpr_write_b32 a155, 0
    v_accvgpr_write_b32 a156, 0
    v_accvgpr_write_b32 a157, 0
    v_accvgpr_write_b32 a158, 0
    v_accvgpr_write_b32 a159, 0
    v_accvgpr_write_b32 a160, 0
    v_accvgpr_write_b32 a161, 0
    v_accvgpr_write_b32 a162, 0
    v_accvgpr_write_b32 a163, 0
    v_accvgpr_write_b32 a164, 0
    v_accvgpr_write_b32 a165, 0
    v_accvgpr_write_b32 a166, 0
    v_accvgpr_write_b32 a167, 0
    v_accvgpr_write_b32 a168, 0
    v_accvgpr_write_b32 a169, 0
    v_accvgpr_write_b32 a170, 0
    v_accvgpr_write_b32 a171, 0
    v_accvgpr_write_b32 a172, 0
    v_accvgpr_write_b32 a173, 0
    v_accvgpr_write_b32 a174, 0
    v_accvgpr_write_b32 a175, 0
    v_accvgpr_write_b32 a176, 0
    v_accvgpr_write_b32 a177, 0
    v_accvgpr_write_b32 a178, 0
    v_accvgpr_write_b32 a179, 0
    v_accvgpr_write_b32 a180, 0
    v_accvgpr_write_b32 a181, 0
    v_accvgpr_write_b32 a182, 0
    v_accvgpr_write_b32 a183, 0
    v_accvgpr_write_b32 a184, 0
    v_accvgpr_write_b32 a185, 0
    v_accvgpr_write_b32 a186, 0
    v_accvgpr_write_b32 a187, 0
    v_accvgpr_write_b32 a188, 0
    v_accvgpr_write_b32 a189, 0
    v_accvgpr_write_b32 a190, 0
    v_accvgpr_write_b32 a191, 0
    v_mov_b32 v5, 0
    v_mov_b32 v240, 0xff7fffff
    v_mov_b32 v6, 0
    v_mov_b32 v241, 0xff7fffff
    v_mov_b32 v7, 0
    v_mov_b32 v242, 0xff7fffff
    v_mov_b32 v8, 0
    v_mov_b32 v243, 0xff7fffff
    v_subrev_u32 v244, 49152, v2
    v_subrev_u32 v245, 49152, v3
    v_subrev_u32 v246, 24576, v1
    s_mov_b32 s48, 0
L_slowloop:
    s_add_u32 s49, s48, 6144
    s_add_u32 s50, s48, 12288
    s_add_u32 s51, s48, 16384
    s_add_u32 s52, s48, 20480
    buffer_load_dwordx4 v[64:67], v244, s[4:7], s48 offen offset:0 sc1
    buffer_load_dwordx4 v[68:71], v245, s[4:7], s48 offen offset:0 sc1
    buffer_load_dwordx4 v[72:75], v244, s[4:7], s49 offen offset:0 sc1
    buffer_load_dwordx4 v[76:79], v245, s[4:7], s49 offen offset:0 sc1
    buffer_load_dwordx4 v[80:83], v244, s[4:7], s48 offen offset:128 sc1
    buffer_load_dwordx4 v[84:87], v245, s[4:7], s48 offen offset:128 sc1
    buffer_load_dwordx4 v[88:91], v244, s[4:7], s49 offen offset:128 sc1
    buffer_load_dwordx4 v[92:95], v245, s[4:7], s49 offen offset:128 sc1
    buffer_load_dwordx4 v[96:99], v244, s[4:7], s48 offen offset:256 sc1
    buffer_load_dwordx4 v[100:103], v245, s[4:7], s48 offen offset:256 sc1
    buffer_load_dwordx4 v[104:107], v244, s[4:7], s49 offen offset:256 sc1
    buffer_load_dwordx4 v[108:111], v245, s[4:7], s49 offen offset:256 sc1
    buffer_load_dwordx4 v[112:115], v246, s[4:7], s50 offen offset:0 sc1
    buffer_load_dwordx4 v[116:119], v246, s[4:7], s50 offen offset:1024 sc1
    buffer_load_dwordx4 v[120:123], v246, s[4:7], s50 offen offset:2048 sc1
    buffer_load_dwordx4 v[124:127], v246, s[4:7], s50 offen offset:3072 sc1
    buffer_load_dwordx4 v[128:131], v246, s[4:7], s51 offen offset:0 sc1
    buffer_load_dwordx4 v[132:135], v246, s[4:7], s51 offen offset:1024 sc1
    buffer_load_dwordx4 v[136:139], v246, s[4:7], s51 offen offset:2048 sc1
    buffer_load_dwordx4 v[140:143], v246, s[4:7], s51 offen offset:3072 sc1
    buffer_load_dwordx4 v[144:147], v246, s[4:7], s52 offen offset:0 sc1
    buffer_load_dwordx4 v[148:151], v246, s[4:7], s52 offen offset:1024 sc1
    buffer_load_dwordx4 v[152:155], v246, s[4:7], s52 offen offset:2048 sc1
    buffer_load_dwordx4 v[156:159], v246, s[4:7], s52 offen offset:3072 sc1
    s_waitcnt vmcnt(12)
    v_mfma_f32_16x16x32_bf16 v[160:163], v[64:67], a[192:195], 0
    v_mfma_f32_16x16x32_bf16 v[168:171], v[64:67], a[216:219], 0
    v_mfma_f32_16x16x32_bf16 v[176:179], v[64:67], a[240:243], 0
    v_mfma_f32_16x16x32_bf16 v[184:187], v[64:67], v[200:203], 0
    v_mfma_f32_16x16x32_bf16 v[160:163], v[68:71], a[196:199], v[160:163]
    v_mfma_f32_16x16x32_bf16 v[168:171], v[68:71], a[220:223], v[168:171]
    v_mfma_f32_16x16x32_bf16 v[176:179], v[68:71], a[244:247], v[176:179]
    v_mfma_f32_16x16x32_bf16 v[184:187], v[68:71], v[204:207], v[184:187]
    v_mfma_f32_16x16x32_bf16 v[164:167], v[72:75], a[192:195], 0
    v_mfma_f32_16x16x32_bf16 v[172:175], v[72:75], a[216:219], 0
    v_mfma_f32_16x16x32_bf16 v[180:183], v[72:75], a[240:243], 0
    v_mfma_f32_16x16x32_bf16 v[188:191], v[72:75], v[200:203], 0
    v_mfma_f32_16x16x32_bf16 v[164:167], v[76:79], a[196:199], v[164:167]
    v_mfma_f32_16x16x32_bf16 v[172:175], v[76:79], a[220:223], v[172:175]
    v_mfma_f32_16x16x32_bf16 v[180:183], v[76:79], a[244:247], v[180:183]
    v_mfma_f32_16x16x32_bf16 v[188:191], v[76:79], v[204:207], v[188:191]
    v_mfma_f32_16x16x32_bf16 v[160:163], v[80:83], a[200:203], v[160:163]
    v_mfma_f32_16x16x32_bf16 v[168:171], v[80:83], a[224:227], v[168:171]
    v_mfma_f32_16x16x32_bf16 v[176:179], v[80:83], a[248:251], v[176:179]
    v_mfma_f32_16x16x32_bf16 v[184:187], v[80:83], v[208:211], v[184:187]
    v_mfma_f32_16x16x32_bf16 v[160:163], v[84:87], a[204:207], v[160:163]
    v_mfma_f32_16x16x32_bf16 v[168:171], v[84:87], a[228:231], v[168:171]
    v_mfma_f32_16x16x32_bf16 v[176:179], v[84:87], a[252:255], v[176:179]
    v_mfma_f32_16x16x32_bf16 v[184:187], v[84:87], v[212:215], v[184:187]
    v_mfma_f32_16x16x32_bf16 v[164:167], v[88:91], a[200:203], v[164:167]
    v_mfma_f32_16x16x32_bf16 v[172:175], v[88:91], a[224:227], v[172:175]
    v_mfma_f32_16x16x32_bf16 v[180:183], v[88:91], a[248:251], v[180:183]
    v_mfma_f32_16x16x32_bf16 v[188:191], v[88:91], v[208:211], v[188:191]
    v_mfma_f32_16x16x32_bf16 v[164:167], v[92:95], a[204:207], v[164:167]
    v_mfma_f32_16x16x32_bf16 v[172:175], v[92:95], a[228:231], v[172:175]
    v_mfma_f32_16x16x32_bf16 v[180:183], v[92:95], a[252:255], v[180:183]
    v_mfma_f32_16x16x32_bf16 v[188:191], v[92:95], v[212:215], v[188:191]
    v_mfma_f32_16x16x32_bf16 v[160:163], v[96:99], a[208:211], v[160:163]
    v_mfma_f32_16x16x32_bf16 v[168:171], v[96:99], a[232:235], v[168:171]
    v_mfma_f32_16x16x32_bf16 v[176:179], v[96:99], v[192:195], v[176:179]
    v_mfma_f32_16x16x32_bf16 v[184:187], v[96:99], v[216:219], v[184:187]
    v_mfma_f32_16x16x32_bf16 v[160:163], v[100:103], a[212:215], v[160:163]
    v_mfma_f32_16x16x32_bf16 v[168:171], v[100:103], a[236:239], v[168:171]
    v_mfma_f32_16x16x32_bf16 v[176:179], v[100:103], v[196:199], v[176:179]
    v_mfma_f32_16x16x32_bf16 v[184:187], v[100:103], v[220:223], v[184:187]
    v_mfma_f32_16x16x32_bf16 v[164:167], v[104:107], a[208:211], v[164:167]
    v_mfma_f32_16x16x32_bf16 v[172:175], v[104:107], a[232:235], v[172:175]
    v_mfma_f32_16x16x32_bf16 v[180:183], v[104:107], v[192:195], v[180:183]
    v_mfma_f32_16x16x32_bf16 v[188:191], v[104:107], v[216:219], v[188:191]
    v_mfma_f32_16x16x32_bf16 v[164:167], v[108:111], a[212:215], v[164:167]
    v_mfma_f32_16x16x32_bf16 v[172:175], v[108:111], a[236:239], v[172:175]
    v_mfma_f32_16x16x32_bf16 v[180:183], v[108:111], v[196:199], v[180:183]
    v_mfma_f32_16x16x32_bf16 v[188:191], v[108:111], v[220:223], v[188:191]
    s_nop 9
    v_max3_f32 v16, v160, v161, v162
    v_max3_f32 v16, v16, v163, v164
    v_max3_f32 v16, v16, v165, v166
    v_max3_f32 v16, v16, v167, v240
    v_mov_b32 v17, v16
    s_nop 1
    v_permlane16_swap_b32 v16, v17
    s_nop 1
    v_max_f32 v16, v16, v17
    v_mov_b32 v17, v16
    s_nop 1
    v_permlane32_swap_b32 v16, v17
    s_nop 1
    v_max_f32 v16, v16, v17
    v_sub_f32 v17, v240, v16
    v_exp_f32 v17, v17
    v_mov_b32 v240, v16
    v_sub_f32 v160, v160, v16
    v_sub_f32 v161, v161, v16
    v_sub_f32 v162, v162, v16
    v_sub_f32 v163, v163, v16
    v_sub_f32 v164, v164, v16
    v_sub_f32 v165, v165, v16
    v_sub_f32 v166, v166, v16
    v_sub_f32 v167, v167, v16
    v_exp_f32 v160, v160
    v_exp_f32 v161, v161
    v_exp_f32 v162, v162
    v_exp_f32 v163, v163
    v_exp_f32 v164, v164
    v_exp_f32 v165, v165
    v_exp_f32 v166, v166
    v_exp_f32 v167, v167
    v_mul_f32 v5, v5, v17
    v_add_f32 v5, v5, v160
    v_add_f32 v5, v5, v161
    v_add_f32 v5, v5, v162
    v_add_f32 v5, v5, v163
    v_add_f32 v5, v5, v164
    v_add_f32 v5, v5, v165
    v_add_f32 v5, v5, v166
    v_add_f32 v5, v5, v167
    v_cvt_pk_bf16_f32 v224, v160, v161
    v_cvt_pk_bf16_f32 v225, v162, v163
    v_cvt_pk_bf16_f32 v226, v164, v165
    v_cvt_pk_bf16_f32 v227, v166, v167
    ds_bpermute_b32 v248, v58, v17 offset:0
    ds_bpermute_b32 v249, v58, v17 offset:4
    ds_bpermute_b32 v250, v58, v17 offset:8
    ds_bpermute_b32 v251, v58, v17 offset:12
    s_waitcnt lgkmcnt(0)
    v_accvgpr_read_b32 v18, a0
    v_mul_f32 v18, v18, v248
    v_accvgpr_write_b32 a0, v18
    v_accvgpr_read_b32 v19, a1
    v_mul_f32 v19, v19, v249
    v_accvgpr_write_b32 a1, v19
    v_accvgpr_read_b32 v18, a2
    v_mul_f32 v18, v18, v250
    v_accvgpr_write_b32 a2, v18
    v_accvgpr_read_b32 v19, a3
    v_mul_f32 v19, v19, v251
    v_accvgpr_write_b32 a3, v19
    v_accvgpr_read_b32 v18, a4
    v_mul_f32 v18, v18, v248
    v_accvgpr_write_b32 a4, v18
    v_accvgpr_read_b32 v19, a5
    v_mul_f32 v19, v19, v249
    v_accvgpr_write_b32 a5, v19
    v_accvgpr_read_b32 v18, a6
    v_mul_f32 v18, v18, v250
    v_accvgpr_write_b32 a6, v18
    v_accvgpr_read_b32 v19, a7
    v_mul_f32 v19, v19, v251
    v_accvgpr_write_b32 a7, v19
    v_accvgpr_read_b32 v18, a8
    v_mul_f32 v18, v18, v248
    v_accvgpr_write_b32 a8, v18
    v_accvgpr_read_b32 v19, a9
    v_mul_f32 v19, v19, v249
    v_accvgpr_write_b32 a9, v19
    v_accvgpr_read_b32 v18, a10
    v_mul_f32 v18, v18, v250
    v_accvgpr_write_b32 a10, v18
    v_accvgpr_read_b32 v19, a11
    v_mul_f32 v19, v19, v251
    v_accvgpr_write_b32 a11, v19
    v_accvgpr_read_b32 v18, a12
    v_mul_f32 v18, v18, v248
    v_accvgpr_write_b32 a12, v18
    v_accvgpr_read_b32 v19, a13
    v_mul_f32 v19, v19, v249
    v_accvgpr_write_b32 a13, v19
    v_accvgpr_read_b32 v18, a14
    v_mul_f32 v18, v18, v250
    v_accvgpr_write_b32 a14, v18
    v_accvgpr_read_b32 v19, a15
    v_mul_f32 v19, v19, v251
    v_accvgpr_write_b32 a15, v19
    v_accvgpr_read_b32 v18, a16
    v_mul_f32 v18, v18, v248
    v_accvgpr_write_b32 a16, v18
    v_accvgpr_read_b32 v19, a17
    v_mul_f32 v19, v19, v249
    v_accvgpr_write_b32 a17, v19
    v_accvgpr_read_b32 v18, a18
    v_mul_f32 v18, v18, v250
    v_accvgpr_write_b32 a18, v18
    v_accvgpr_read_b32 v19, a19
    v_mul_f32 v19, v19, v251
    v_accvgpr_write_b32 a19, v19
    v_accvgpr_read_b32 v18, a20
    v_mul_f32 v18, v18, v248
    v_accvgpr_write_b32 a20, v18
    v_accvgpr_read_b32 v19, a21
    v_mul_f32 v19, v19, v249
    v_accvgpr_write_b32 a21, v19
    v_accvgpr_read_b32 v18, a22
    v_mul_f32 v18, v18, v250
    v_accvgpr_write_b32 a22, v18
    v_accvgpr_read_b32 v19, a23
    v_mul_f32 v19, v19, v251
    v_accvgpr_write_b32 a23, v19
    v_accvgpr_read_b32 v18, a24
    v_mul_f32 v18, v18, v248
    v_accvgpr_write_b32 a24, v18
    v_accvgpr_read_b32 v19, a25
    v_mul_f32 v19, v19, v249
    v_accvgpr_write_b32 a25, v19
    v_accvgpr_read_b32 v18, a26
    v_mul_f32 v18, v18, v250
    v_accvgpr_write_b32 a26, v18
    v_accvgpr_read_b32 v19, a27
    v_mul_f32 v19, v19, v251
    v_accvgpr_write_b32 a27, v19
    v_accvgpr_read_b32 v18, a28
    v_mul_f32 v18, v18, v248
    v_accvgpr_write_b32 a28, v18
    v_accvgpr_read_b32 v19, a29
    v_mul_f32 v19, v19, v249
    v_accvgpr_write_b32 a29, v19
    v_accvgpr_read_b32 v18, a30
    v_mul_f32 v18, v18, v250
    v_accvgpr_write_b32 a30, v18
    v_accvgpr_read_b32 v19, a31
    v_mul_f32 v19, v19, v251
    v_accvgpr_write_b32 a31, v19
    v_accvgpr_read_b32 v18, a32
    v_mul_f32 v18, v18, v248
    v_accvgpr_write_b32 a32, v18
    v_accvgpr_read_b32 v19, a33
    v_mul_f32 v19, v19, v249
    v_accvgpr_write_b32 a33, v19
    v_accvgpr_read_b32 v18, a34
    v_mul_f32 v18, v18, v250
    v_accvgpr_write_b32 a34, v18
    v_accvgpr_read_b32 v19, a35
    v_mul_f32 v19, v19, v251
    v_accvgpr_write_b32 a35, v19
    v_accvgpr_read_b32 v18, a36
    v_mul_f32 v18, v18, v248
    v_accvgpr_write_b32 a36, v18
    v_accvgpr_read_b32 v19, a37
    v_mul_f32 v19, v19, v249
    v_accvgpr_write_b32 a37, v19
    v_accvgpr_read_b32 v18, a38
    v_mul_f32 v18, v18, v250
    v_accvgpr_write_b32 a38, v18
    v_accvgpr_read_b32 v19, a39
    v_mul_f32 v19, v19, v251
    v_accvgpr_write_b32 a39, v19
    v_accvgpr_read_b32 v18, a40
    v_mul_f32 v18, v18, v248
    v_accvgpr_write_b32 a40, v18
    v_accvgpr_read_b32 v19, a41
    v_mul_f32 v19, v19, v249
    v_accvgpr_write_b32 a41, v19
    v_accvgpr_read_b32 v18, a42
    v_mul_f32 v18, v18, v250
    v_accvgpr_write_b32 a42, v18
    v_accvgpr_read_b32 v19, a43
    v_mul_f32 v19, v19, v251
    v_accvgpr_write_b32 a43, v19
    v_accvgpr_read_b32 v18, a44
    v_mul_f32 v18, v18, v248
    v_accvgpr_write_b32 a44, v18
    v_accvgpr_read_b32 v19, a45
    v_mul_f32 v19, v19, v249
    v_accvgpr_write_b32 a45, v19
    v_accvgpr_read_b32 v18, a46
    v_mul_f32 v18, v18, v250
    v_accvgpr_write_b32 a46, v18
    v_accvgpr_read_b32 v19, a47
    v_mul_f32 v19, v19, v251
    v_accvgpr_write_b32 a47, v19
    v_max3_f32 v16, v168, v169, v170
    v_max3_f32 v16, v16, v171, v172
    v_max3_f32 v16, v16, v173, v174
    v_max3_f32 v16, v16, v175, v241
    v_mov_b32 v17, v16
    s_nop 1
    v_permlane16_swap_b32 v16, v17
    s_nop 1
    v_max_f32 v16, v16, v17
    v_mov_b32 v17, v16
    s_nop 1
    v_permlane32_swap_b32 v16, v17
    s_nop 1
    v_max_f32 v16, v16, v17
    v_sub_f32 v17, v241, v16
    v_exp_f32 v17, v17
    v_mov_b32 v241, v16
    v_sub_f32 v168, v168, v16
    v_sub_f32 v169, v169, v16
    v_sub_f32 v170, v170, v16
    v_sub_f32 v171, v171, v16
    v_sub_f32 v172, v172, v16
    v_sub_f32 v173, v173, v16
    v_sub_f32 v174, v174, v16
    v_sub_f32 v175, v175, v16
    v_exp_f32 v168, v168
    v_exp_f32 v169, v169
    v_exp_f32 v170, v170
    v_exp_f32 v171, v171
    v_exp_f32 v172, v172
    v_exp_f32 v173, v173
    v_exp_f32 v174, v174
    v_exp_f32 v175, v175
    v_mul_f32 v6, v6, v17
    v_add_f32 v6, v6, v168
    v_add_f32 v6, v6, v169
    v_add_f32 v6, v6, v170
    v_add_f32 v6, v6, v171
    v_add_f32 v6, v6, v172
    v_add_f32 v6, v6, v173
    v_add_f32 v6, v6, v174
    v_add_f32 v6, v6, v175
    v_cvt_pk_bf16_f32 v228, v168, v169
    v_cvt_pk_bf16_f32 v229, v170, v171
    v_cvt_pk_bf16_f32 v230, v172, v173
    v_cvt_pk_bf16_f32 v231, v174, v175
    ds_bpermute_b32 v248, v58, v17 offset:0
    ds_bpermute_b32 v249, v58, v17 offset:4
    ds_bpermute_b32 v250, v58, v17 offset:8
    ds_bpermute_b32 v251, v58, v17 offset:12
    s_waitcnt lgkmcnt(0)
    v_accvgpr_read_b32 v18, a48
    v_mul_f32 v18, v18, v248
    v_accvgpr_write_b32 a48, v18
    v_accvgpr_read_b32 v19, a49
    v_mul_f32 v19, v19, v249
    v_accvgpr_write_b32 a49, v19
    v_accvgpr_read_b32 v18, a50
    v_mul_f32 v18, v18, v250
    v_accvgpr_write_b32 a50, v18
    v_accvgpr_read_b32 v19, a51
    v_mul_f32 v19, v19, v251
    v_accvgpr_write_b32 a51, v19
    v_accvgpr_read_b32 v18, a52
    v_mul_f32 v18, v18, v248
    v_accvgpr_write_b32 a52, v18
    v_accvgpr_read_b32 v19, a53
    v_mul_f32 v19, v19, v249
    v_accvgpr_write_b32 a53, v19
    v_accvgpr_read_b32 v18, a54
    v_mul_f32 v18, v18, v250
    v_accvgpr_write_b32 a54, v18
    v_accvgpr_read_b32 v19, a55
    v_mul_f32 v19, v19, v251
    v_accvgpr_write_b32 a55, v19
    v_accvgpr_read_b32 v18, a56
    v_mul_f32 v18, v18, v248
    v_accvgpr_write_b32 a56, v18
    v_accvgpr_read_b32 v19, a57
    v_mul_f32 v19, v19, v249
    v_accvgpr_write_b32 a57, v19
    v_accvgpr_read_b32 v18, a58
    v_mul_f32 v18, v18, v250
    v_accvgpr_write_b32 a58, v18
    v_accvgpr_read_b32 v19, a59
    v_mul_f32 v19, v19, v251
    v_accvgpr_write_b32 a59, v19
    v_accvgpr_read_b32 v18, a60
    v_mul_f32 v18, v18, v248
    v_accvgpr_write_b32 a60, v18
    v_accvgpr_read_b32 v19, a61
    v_mul_f32 v19, v19, v249
    v_accvgpr_write_b32 a61, v19
    v_accvgpr_read_b32 v18, a62
    v_mul_f32 v18, v18, v250
    v_accvgpr_write_b32 a62, v18
    v_accvgpr_read_b32 v19, a63
    v_mul_f32 v19, v19, v251
    v_accvgpr_write_b32 a63, v19
    v_accvgpr_read_b32 v18, a64
    v_mul_f32 v18, v18, v248
    v_accvgpr_write_b32 a64, v18
    v_accvgpr_read_b32 v19, a65
    v_mul_f32 v19, v19, v249
    v_accvgpr_write_b32 a65, v19
    v_accvgpr_read_b32 v18, a66
    v_mul_f32 v18, v18, v250
    v_accvgpr_write_b32 a66, v18
    v_accvgpr_read_b32 v19, a67
    v_mul_f32 v19, v19, v251
    v_accvgpr_write_b32 a67, v19
    v_accvgpr_read_b32 v18, a68
    v_mul_f32 v18, v18, v248
    v_accvgpr_write_b32 a68, v18
    v_accvgpr_read_b32 v19, a69
    v_mul_f32 v19, v19, v249
    v_accvgpr_write_b32 a69, v19
    v_accvgpr_read_b32 v18, a70
    v_mul_f32 v18, v18, v250
    v_accvgpr_write_b32 a70, v18
    v_accvgpr_read_b32 v19, a71
    v_mul_f32 v19, v19, v251
    v_accvgpr_write_b32 a71, v19
    v_accvgpr_read_b32 v18, a72
    v_mul_f32 v18, v18, v248
    v_accvgpr_write_b32 a72, v18
    v_accvgpr_read_b32 v19, a73
    v_mul_f32 v19, v19, v249
    v_accvgpr_write_b32 a73, v19
    v_accvgpr_read_b32 v18, a74
    v_mul_f32 v18, v18, v250
    v_accvgpr_write_b32 a74, v18
    v_accvgpr_read_b32 v19, a75
    v_mul_f32 v19, v19, v251
    v_accvgpr_write_b32 a75, v19
    v_accvgpr_read_b32 v18, a76
    v_mul_f32 v18, v18, v248
    v_accvgpr_write_b32 a76, v18
    v_accvgpr_read_b32 v19, a77
    v_mul_f32 v19, v19, v249
    v_accvgpr_write_b32 a77, v19
    v_accvgpr_read_b32 v18, a78
    v_mul_f32 v18, v18, v250
    v_accvgpr_write_b32 a78, v18
    v_accvgpr_read_b32 v19, a79
    v_mul_f32 v19, v19, v251
    v_accvgpr_write_b32 a79, v19
    v_accvgpr_read_b32 v18, a80
    v_mul_f32 v18, v18, v248
    v_accvgpr_write_b32 a80, v18
    v_accvgpr_read_b32 v19, a81
    v_mul_f32 v19, v19, v249
    v_accvgpr_write_b32 a81, v19
    v_accvgpr_read_b32 v18, a82
    v_mul_f32 v18, v18, v250
    v_accvgpr_write_b32 a82, v18
    v_accvgpr_read_b32 v19, a83
    v_mul_f32 v19, v19, v251
    v_accvgpr_write_b32 a83, v19
    v_accvgpr_read_b32 v18, a84
    v_mul_f32 v18, v18, v248
    v_accvgpr_write_b32 a84, v18
    v_accvgpr_read_b32 v19, a85
    v_mul_f32 v19, v19, v249
    v_accvgpr_write_b32 a85, v19
    v_accvgpr_read_b32 v18, a86
    v_mul_f32 v18, v18, v250
    v_accvgpr_write_b32 a86, v18
    v_accvgpr_read_b32 v19, a87
    v_mul_f32 v19, v19, v251
    v_accvgpr_write_b32 a87, v19
    v_accvgpr_read_b32 v18, a88
    v_mul_f32 v18, v18, v248
    v_accvgpr_write_b32 a88, v18
    v_accvgpr_read_b32 v19, a89
    v_mul_f32 v19, v19, v249
    v_accvgpr_write_b32 a89, v19
    v_accvgpr_read_b32 v18, a90
    v_mul_f32 v18, v18, v250
    v_accvgpr_write_b32 a90, v18
    v_accvgpr_read_b32 v19, a91
    v_mul_f32 v19, v19, v251
    v_accvgpr_write_b32 a91, v19
    v_accvgpr_read_b32 v18, a92
    v_mul_f32 v18, v18, v248
    v_accvgpr_write_b32 a92, v18
    v_accvgpr_read_b32 v19, a93
    v_mul_f32 v19, v19, v249
    v_accvgpr_write_b32 a93, v19
    v_accvgpr_read_b32 v18, a94
    v_mul_f32 v18, v18, v250
    v_accvgpr_write_b32 a94, v18
    v_accvgpr_read_b32 v19, a95
    v_mul_f32 v19, v19, v251
    v_accvgpr_write_b32 a95, v19
    v_max3_f32 v16, v176, v177, v178
    v_max3_f32 v16, v16, v179, v180
    v_max3_f32 v16, v16, v181, v182
    v_max3_f32 v16, v16, v183, v242
    v_mov_b32 v17, v16
    s_nop 1
    v_permlane16_swap_b32 v16, v17
    s_nop 1
    v_max_f32 v16, v16, v17
    v_mov_b32 v17, v16
    s_nop 1
    v_permlane32_swap_b32 v16, v17
    s_nop 1
    v_max_f32 v16, v16, v17
    v_sub_f32 v17, v242, v16
    v_exp_f32 v17, v17
    v_mov_b32 v242, v16
    v_sub_f32 v176, v176, v16
    v_sub_f32 v177, v177, v16
    v_sub_f32 v178, v178, v16
    v_sub_f32 v179, v179, v16
    v_sub_f32 v180, v180, v16
    v_sub_f32 v181, v181, v16
    v_sub_f32 v182, v182, v16
    v_sub_f32 v183, v183, v16
    v_exp_f32 v176, v176
    v_exp_f32 v177, v177
    v_exp_f32 v178, v178
    v_exp_f32 v179, v179
    v_exp_f32 v180, v180
    v_exp_f32 v181, v181
    v_exp_f32 v182, v182
    v_exp_f32 v183, v183
    v_mul_f32 v7, v7, v17
    v_add_f32 v7, v7, v176
    v_add_f32 v7, v7, v177
    v_add_f32 v7, v7, v178
    v_add_f32 v7, v7, v179
    v_add_f32 v7, v7, v180
    v_add_f32 v7, v7, v181
    v_add_f32 v7, v7, v182
    v_add_f32 v7, v7, v183
    v_cvt_pk_bf16_f32 v232, v176, v177
    v_cvt_pk_bf16_f32 v233, v178, v179
    v_cvt_pk_bf16_f32 v234, v180, v181
    v_cvt_pk_bf16_f32 v235, v182, v183
    ds_bpermute_b32 v248, v58, v17 offset:0
    ds_bpermute_b32 v249, v58, v17 offset:4
    ds_bpermute_b32 v250, v58, v17 offset:8
    ds_bpermute_b32 v251, v58, v17 offset:12
    s_waitcnt lgkmcnt(0)
    v_accvgpr_read_b32 v18, a96
    v_mul_f32 v18, v18, v248
    v_accvgpr_write_b32 a96, v18
    v_accvgpr_read_b32 v19, a97
    v_mul_f32 v19, v19, v249
    v_accvgpr_write_b32 a97, v19
    v_accvgpr_read_b32 v18, a98
    v_mul_f32 v18, v18, v250
    v_accvgpr_write_b32 a98, v18
    v_accvgpr_read_b32 v19, a99
    v_mul_f32 v19, v19, v251
    v_accvgpr_write_b32 a99, v19
    v_accvgpr_read_b32 v18, a100
    v_mul_f32 v18, v18, v248
    v_accvgpr_write_b32 a100, v18
    v_accvgpr_read_b32 v19, a101
    v_mul_f32 v19, v19, v249
    v_accvgpr_write_b32 a101, v19
    v_accvgpr_read_b32 v18, a102
    v_mul_f32 v18, v18, v250
    v_accvgpr_write_b32 a102, v18
    v_accvgpr_read_b32 v19, a103
    v_mul_f32 v19, v19, v251
    v_accvgpr_write_b32 a103, v19
    v_accvgpr_read_b32 v18, a104
    v_mul_f32 v18, v18, v248
    v_accvgpr_write_b32 a104, v18
    v_accvgpr_read_b32 v19, a105
    v_mul_f32 v19, v19, v249
    v_accvgpr_write_b32 a105, v19
    v_accvgpr_read_b32 v18, a106
    v_mul_f32 v18, v18, v250
    v_accvgpr_write_b32 a106, v18
    v_accvgpr_read_b32 v19, a107
    v_mul_f32 v19, v19, v251
    v_accvgpr_write_b32 a107, v19
    v_accvgpr_read_b32 v18, a108
    v_mul_f32 v18, v18, v248
    v_accvgpr_write_b32 a108, v18
    v_accvgpr_read_b32 v19, a109
    v_mul_f32 v19, v19, v249
    v_accvgpr_write_b32 a109, v19
    v_accvgpr_read_b32 v18, a110
    v_mul_f32 v18, v18, v250
    v_accvgpr_write_b32 a110, v18
    v_accvgpr_read_b32 v19, a111
    v_mul_f32 v19, v19, v251
    v_accvgpr_write_b32 a111, v19
    v_accvgpr_read_b32 v18, a112
    v_mul_f32 v18, v18, v248
    v_accvgpr_write_b32 a112, v18
    v_accvgpr_read_b32 v19, a113
    v_mul_f32 v19, v19, v249
    v_accvgpr_write_b32 a113, v19
    v_accvgpr_read_b32 v18, a114
    v_mul_f32 v18, v18, v250
    v_accvgpr_write_b32 a114, v18
    v_accvgpr_read_b32 v19, a115
    v_mul_f32 v19, v19, v251
    v_accvgpr_write_b32 a115, v19
    v_accvgpr_read_b32 v18, a116
    v_mul_f32 v18, v18, v248
    v_accvgpr_write_b32 a116, v18
    v_accvgpr_read_b32 v19, a117
    v_mul_f32 v19, v19, v249
    v_accvgpr_write_b32 a117, v19
    v_accvgpr_read_b32 v18, a118
    v_mul_f32 v18, v18, v250
    v_accvgpr_write_b32 a118, v18
    v_accvgpr_read_b32 v19, a119
    v_mul_f32 v19, v19, v251
    v_accvgpr_write_b32 a119, v19
    v_accvgpr_read_b32 v18, a120
    v_mul_f32 v18, v18, v248
    v_accvgpr_write_b32 a120, v18
    v_accvgpr_read_b32 v19, a121
    v_mul_f32 v19, v19, v249
    v_accvgpr_write_b32 a121, v19
    v_accvgpr_read_b32 v18, a122
    v_mul_f32 v18, v18, v250
    v_accvgpr_write_b32 a122, v18
    v_accvgpr_read_b32 v19, a123
    v_mul_f32 v19, v19, v251
    v_accvgpr_write_b32 a123, v19
    v_accvgpr_read_b32 v18, a124
    v_mul_f32 v18, v18, v248
    v_accvgpr_write_b32 a124, v18
    v_accvgpr_read_b32 v19, a125
    v_mul_f32 v19, v19, v249
    v_accvgpr_write_b32 a125, v19
    v_accvgpr_read_b32 v18, a126
    v_mul_f32 v18, v18, v250
    v_accvgpr_write_b32 a126, v18
    v_accvgpr_read_b32 v19, a127
    v_mul_f32 v19, v19, v251
    v_accvgpr_write_b32 a127, v19
    v_accvgpr_read_b32 v18, a128
    v_mul_f32 v18, v18, v248
    v_accvgpr_write_b32 a128, v18
    v_accvgpr_read_b32 v19, a129
    v_mul_f32 v19, v19, v249
    v_accvgpr_write_b32 a129, v19
    v_accvgpr_read_b32 v18, a130
    v_mul_f32 v18, v18, v250
    v_accvgpr_write_b32 a130, v18
    v_accvgpr_read_b32 v19, a131
    v_mul_f32 v19, v19, v251
    v_accvgpr_write_b32 a131, v19
    v_accvgpr_read_b32 v18, a132
    v_mul_f32 v18, v18, v248
    v_accvgpr_write_b32 a132, v18
    v_accvgpr_read_b32 v19, a133
    v_mul_f32 v19, v19, v249
    v_accvgpr_write_b32 a133, v19
    v_accvgpr_read_b32 v18, a134
    v_mul_f32 v18, v18, v250
    v_accvgpr_write_b32 a134, v18
    v_accvgpr_read_b32 v19, a135
    v_mul_f32 v19, v19, v251
    v_accvgpr_write_b32 a135, v19
    v_accvgpr_read_b32 v18, a136
    v_mul_f32 v18, v18, v248
    v_accvgpr_write_b32 a136, v18
    v_accvgpr_read_b32 v19, a137
    v_mul_f32 v19, v19, v249
    v_accvgpr_write_b32 a137, v19
    v_accvgpr_read_b32 v18, a138
    v_mul_f32 v18, v18, v250
    v_accvgpr_write_b32 a138, v18
    v_accvgpr_read_b32 v19, a139
    v_mul_f32 v19, v19, v251
    v_accvgpr_write_b32 a139, v19
    v_accvgpr_read_b32 v18, a140
    v_mul_f32 v18, v18, v248
    v_accvgpr_write_b32 a140, v18
    v_accvgpr_read_b32 v19, a141
    v_mul_f32 v19, v19, v249
    v_accvgpr_write_b32 a141, v19
    v_accvgpr_read_b32 v18, a142
    v_mul_f32 v18, v18, v250
    v_accvgpr_write_b32 a142, v18
    v_accvgpr_read_b32 v19, a143
    v_mul_f32 v19, v19, v251
    v_accvgpr_write_b32 a143, v19
    v_max3_f32 v16, v184, v185, v186
    v_max3_f32 v16, v16, v187, v188
    v_max3_f32 v16, v16, v189, v190
    v_max3_f32 v16, v16, v191, v243
    v_mov_b32 v17, v16
    s_nop 1
    v_permlane16_swap_b32 v16, v17
    s_nop 1
    v_max_f32 v16, v16, v17
    v_mov_b32 v17, v16
    s_nop 1
    v_permlane32_swap_b32 v16, v17
    s_nop 1
    v_max_f32 v16, v16, v17
    v_sub_f32 v17, v243, v16
    v_exp_f32 v17, v17
    v_mov_b32 v243, v16
    v_sub_f32 v184, v184, v16
    v_sub_f32 v185, v185, v16
    v_sub_f32 v186, v186, v16
    v_sub_f32 v187, v187, v16
    v_sub_f32 v188, v188, v16
    v_sub_f32 v189, v189, v16
    v_sub_f32 v190, v190, v16
    v_sub_f32 v191, v191, v16
    v_exp_f32 v184, v184
    v_exp_f32 v185, v185
    v_exp_f32 v186, v186
    v_exp_f32 v187, v187
    v_exp_f32 v188, v188
    v_exp_f32 v189, v189
    v_exp_f32 v190, v190
    v_exp_f32 v191, v191
    v_mul_f32 v8, v8, v17
    v_add_f32 v8, v8, v184
    v_add_f32 v8, v8, v185
    v_add_f32 v8, v8, v186
    v_add_f32 v8, v8, v187
    v_add_f32 v8, v8, v188
    v_add_f32 v8, v8, v189
    v_add_f32 v8, v8, v190
    v_add_f32 v8, v8, v191
    v_cvt_pk_bf16_f32 v236, v184, v185
    v_cvt_pk_bf16_f32 v237, v186, v187
    v_cvt_pk_bf16_f32 v238, v188, v189
    v_cvt_pk_bf16_f32 v239, v190, v191
    ds_bpermute_b32 v248, v58, v17 offset:0
    ds_bpermute_b32 v249, v58, v17 offset:4
    ds_bpermute_b32 v250, v58, v17 offset:8
    ds_bpermute_b32 v251, v58, v17 offset:12
    s_waitcnt lgkmcnt(0)
    v_accvgpr_read_b32 v18, a144
    v_mul_f32 v18, v18, v248
    v_accvgpr_write_b32 a144, v18
    v_accvgpr_read_b32 v19, a145
    v_mul_f32 v19, v19, v249
    v_accvgpr_write_b32 a145, v19
    v_accvgpr_read_b32 v18, a146
    v_mul_f32 v18, v18, v250
    v_accvgpr_write_b32 a146, v18
    v_accvgpr_read_b32 v19, a147
    v_mul_f32 v19, v19, v251
    v_accvgpr_write_b32 a147, v19
    v_accvgpr_read_b32 v18, a148
    v_mul_f32 v18, v18, v248
    v_accvgpr_write_b32 a148, v18
    v_accvgpr_read_b32 v19, a149
    v_mul_f32 v19, v19, v249
    v_accvgpr_write_b32 a149, v19
    v_accvgpr_read_b32 v18, a150
    v_mul_f32 v18, v18, v250
    v_accvgpr_write_b32 a150, v18
    v_accvgpr_read_b32 v19, a151
    v_mul_f32 v19, v19, v251
    v_accvgpr_write_b32 a151, v19
    v_accvgpr_read_b32 v18, a152
    v_mul_f32 v18, v18, v248
    v_accvgpr_write_b32 a152, v18
    v_accvgpr_read_b32 v19, a153
    v_mul_f32 v19, v19, v249
    v_accvgpr_write_b32 a153, v19
    v_accvgpr_read_b32 v18, a154
    v_mul_f32 v18, v18, v250
    v_accvgpr_write_b32 a154, v18
    v_accvgpr_read_b32 v19, a155
    v_mul_f32 v19, v19, v251
    v_accvgpr_write_b32 a155, v19
    v_accvgpr_read_b32 v18, a156
    v_mul_f32 v18, v18, v248
    v_accvgpr_write_b32 a156, v18
    v_accvgpr_read_b32 v19, a157
    v_mul_f32 v19, v19, v249
    v_accvgpr_write_b32 a157, v19
    v_accvgpr_read_b32 v18, a158
    v_mul_f32 v18, v18, v250
    v_accvgpr_write_b32 a158, v18
    v_accvgpr_read_b32 v19, a159
    v_mul_f32 v19, v19, v251
    v_accvgpr_write_b32 a159, v19
    v_accvgpr_read_b32 v18, a160
    v_mul_f32 v18, v18, v248
    v_accvgpr_write_b32 a160, v18
    v_accvgpr_read_b32 v19, a161
    v_mul_f32 v19, v19, v249
    v_accvgpr_write_b32 a161, v19
    v_accvgpr_read_b32 v18, a162
    v_mul_f32 v18, v18, v250
    v_accvgpr_write_b32 a162, v18
    v_accvgpr_read_b32 v19, a163
    v_mul_f32 v19, v19, v251
    v_accvgpr_write_b32 a163, v19
    v_accvgpr_read_b32 v18, a164
    v_mul_f32 v18, v18, v248
    v_accvgpr_write_b32 a164, v18
    v_accvgpr_read_b32 v19, a165
    v_mul_f32 v19, v19, v249
    v_accvgpr_write_b32 a165, v19
    v_accvgpr_read_b32 v18, a166
    v_mul_f32 v18, v18, v250
    v_accvgpr_write_b32 a166, v18
    v_accvgpr_read_b32 v19, a167
    v_mul_f32 v19, v19, v251
    v_accvgpr_write_b32 a167, v19
    v_accvgpr_read_b32 v18, a168
    v_mul_f32 v18, v18, v248
    v_accvgpr_write_b32 a168, v18
    v_accvgpr_read_b32 v19, a169
    v_mul_f32 v19, v19, v249
    v_accvgpr_write_b32 a169, v19
    v_accvgpr_read_b32 v18, a170
    v_mul_f32 v18, v18, v250
    v_accvgpr_write_b32 a170, v18
    v_accvgpr_read_b32 v19, a171
    v_mul_f32 v19, v19, v251
    v_accvgpr_write_b32 a171, v19
    v_accvgpr_read_b32 v18, a172
    v_mul_f32 v18, v18, v248
    v_accvgpr_write_b32 a172, v18
    v_accvgpr_read_b32 v19, a173
    v_mul_f32 v19, v19, v249
    v_accvgpr_write_b32 a173, v19
    v_accvgpr_read_b32 v18, a174
    v_mul_f32 v18, v18, v250
    v_accvgpr_write_b32 a174, v18
    v_accvgpr_read_b32 v19, a175
    v_mul_f32 v19, v19, v251
    v_accvgpr_write_b32 a175, v19
    v_accvgpr_read_b32 v18, a176
    v_mul_f32 v18, v18, v248
    v_accvgpr_write_b32 a176, v18
    v_accvgpr_read_b32 v19, a177
    v_mul_f32 v19, v19, v249
    v_accvgpr_write_b32 a177, v19
    v_accvgpr_read_b32 v18, a178
    v_mul_f32 v18, v18, v250
    v_accvgpr_write_b32 a178, v18
    v_accvgpr_read_b32 v19, a179
    v_mul_f32 v19, v19, v251
    v_accvgpr_write_b32 a179, v19
    v_accvgpr_read_b32 v18, a180
    v_mul_f32 v18, v18, v248
    v_accvgpr_write_b32 a180, v18
    v_accvgpr_read_b32 v19, a181
    v_mul_f32 v19, v19, v249
    v_accvgpr_write_b32 a181, v19
    v_accvgpr_read_b32 v18, a182
    v_mul_f32 v18, v18, v250
    v_accvgpr_write_b32 a182, v18
    v_accvgpr_read_b32 v19, a183
    v_mul_f32 v19, v19, v251
    v_accvgpr_write_b32 a183, v19
    v_accvgpr_read_b32 v18, a184
    v_mul_f32 v18, v18, v248
    v_accvgpr_write_b32 a184, v18
    v_accvgpr_read_b32 v19, a185
    v_mul_f32 v19, v19, v249
    v_accvgpr_write_b32 a185, v19
    v_accvgpr_read_b32 v18, a186
    v_mul_f32 v18, v18, v250
    v_accvgpr_write_b32 a186, v18
    v_accvgpr_read_b32 v19, a187
    v_mul_f32 v19, v19, v251
    v_accvgpr_write_b32 a187, v19
    v_accvgpr_read_b32 v18, a188
    v_mul_f32 v18, v18, v248
    v_accvgpr_write_b32 a188, v18
    v_accvgpr_read_b32 v19, a189
    v_mul_f32 v19, v19, v249
    v_accvgpr_write_b32 a189, v19
    v_accvgpr_read_b32 v18, a190
    v_mul_f32 v18, v18, v250
    v_accvgpr_write_b32 a190, v18
    v_accvgpr_read_b32 v19, a191
    v_mul_f32 v19, v19, v251
    v_accvgpr_write_b32 a191, v19
    s_waitcnt vmcnt(0)
    s_nop 1
    v_mfma_f32_16x16x32_bf16 a[0:3], v[224:227], v[112:115], a[0:3]
    v_mfma_f32_16x16x32_bf16 a[48:51], v[228:231], v[112:115], a[48:51]
    v_mfma_f32_16x16x32_bf16 a[96:99], v[232:235], v[112:115], a[96:99]
    v_mfma_f32_16x16x32_bf16 a[144:147], v[236:239], v[112:115], a[144:147]
    v_mfma_f32_16x16x32_bf16 a[4:7], v[224:227], v[116:119], a[4:7]
    v_mfma_f32_16x16x32_bf16 a[52:55], v[228:231], v[116:119], a[52:55]
    v_mfma_f32_16x16x32_bf16 a[100:103], v[232:235], v[116:119], a[100:103]
    v_mfma_f32_16x16x32_bf16 a[148:151], v[236:239], v[116:119], a[148:151]
    v_mfma_f32_16x16x32_bf16 a[8:11], v[224:227], v[120:123], a[8:11]
    v_mfma_f32_16x16x32_bf16 a[56:59], v[228:231], v[120:123], a[56:59]
    v_mfma_f32_16x16x32_bf16 a[104:107], v[232:235], v[120:123], a[104:107]
    v_mfma_f32_16x16x32_bf16 a[152:155], v[236:239], v[120:123], a[152:155]
    v_mfma_f32_16x16x32_bf16 a[12:15], v[224:227], v[124:127], a[12:15]
    v_mfma_f32_16x16x32_bf16 a[60:63], v[228:231], v[124:127], a[60:63]
    v_mfma_f32_16x16x32_bf16 a[108:111], v[232:235], v[124:127], a[108:111]
    v_mfma_f32_16x16x32_bf16 a[156:159], v[236:239], v[124:127], a[156:159]
    v_mfma_f32_16x16x32_bf16 a[16:19], v[224:227], v[128:131], a[16:19]
    v_mfma_f32_16x16x32_bf16 a[64:67], v[228:231], v[128:131], a[64:67]
    v_mfma_f32_16x16x32_bf16 a[112:115], v[232:235], v[128:131], a[112:115]
    v_mfma_f32_16x16x32_bf16 a[160:163], v[236:239], v[128:131], a[160:163]
    v_mfma_f32_16x16x32_bf16 a[20:23], v[224:227], v[132:135], a[20:23]
    v_mfma_f32_16x16x32_bf16 a[68:71], v[228:231], v[132:135], a[68:71]
    v_mfma_f32_16x16x32_bf16 a[116:119], v[232:235], v[132:135], a[116:119]
    v_mfma_f32_16x16x32_bf16 a[164:167], v[236:239], v[132:135], a[164:167]
    v_mfma_f32_16x16x32_bf16 a[24:27], v[224:227], v[136:139], a[24:27]
    v_mfma_f32_16x16x32_bf16 a[72:75], v[228:231], v[136:139], a[72:75]
    v_mfma_f32_16x16x32_bf16 a[120:123], v[232:235], v[136:139], a[120:123]
    v_mfma_f32_16x16x32_bf16 a[168:171], v[236:239], v[136:139], a[168:171]
    v_mfma_f32_16x16x32_bf16 a[28:31], v[224:227], v[140:143], a[28:31]
    v_mfma_f32_16x16x32_bf16 a[76:79], v[228:231], v[140:143], a[76:79]
    v_mfma_f32_16x16x32_bf16 a[124:127], v[232:235], v[140:143], a[124:127]
    v_mfma_f32_16x16x32_bf16 a[172:175], v[236:239], v[140:143], a[172:175]
    v_mfma_f32_16x16x32_bf16 a[32:35], v[224:227], v[144:147], a[32:35]
    v_mfma_f32_16x16x32_bf16 a[80:83], v[228:231], v[144:147], a[80:83]
    v_mfma_f32_16x16x32_bf16 a[128:131], v[232:235], v[144:147], a[128:131]
    v_mfma_f32_16x16x32_bf16 a[176:179], v[236:239], v[144:147], a[176:179]
    v_mfma_f32_16x16x32_bf16 a[36:39], v[224:227], v[148:151], a[36:39]
    v_mfma_f32_16x16x32_bf16 a[84:87], v[228:231], v[148:151], a[84:87]
    v_mfma_f32_16x16x32_bf16 a[132:135], v[232:235], v[148:151], a[132:135]
    v_mfma_f32_16x16x32_bf16 a[180:183], v[236:239], v[148:151], a[180:183]
    v_mfma_f32_16x16x32_bf16 a[40:43], v[224:227], v[152:155], a[40:43]
    v_mfma_f32_16x16x32_bf16 a[88:91], v[228:231], v[152:155], a[88:91]
    v_mfma_f32_16x16x32_bf16 a[136:139], v[232:235], v[152:155], a[136:139]
    v_mfma_f32_16x16x32_bf16 a[184:187], v[236:239], v[152:155], a[184:187]
    v_mfma_f32_16x16x32_bf16 a[44:47], v[224:227], v[156:159], a[44:47]
    v_mfma_f32_16x16x32_bf16 a[92:95], v[228:231], v[156:159], a[92:95]
    v_mfma_f32_16x16x32_bf16 a[140:143], v[232:235], v[156:159], a[140:143]
    v_mfma_f32_16x16x32_bf16 a[188:191], v[236:239], v[156:159], a[188:191]
    s_add_u32 s48, s48, 24576
    s_cmp_lt_u32 s48, 1572864
    s_nop 7
    s_cbranch_scc1 L_slowloop
    s_nop 1
    v_mfma_f32_16x16x4_f32 v[48:51], v5, v57, 0
    v_mfma_f32_16x16x4_f32 v[52:55], v6, v57, 0
    s_nop 7
    s_nop 1
    v_rcp_f32 v48, v48
    v_rcp_f32 v49, v49
    v_rcp_f32 v50, v50
    v_rcp_f32 v51, v51
    v_rcp_f32 v52, v52
    v_rcp_f32 v53, v53
    v_rcp_f32 v54, v54
    v_rcp_f32 v55, v55
    v_mfma_f32_16x16x4_f32 v[128:131], v7, v57, 0
    v_mfma_f32_16x16x4_f32 v[132:135], v8, v57, 0
    s_nop 7
    s_nop 1
    v_rcp_f32 v128, v128
    v_rcp_f32 v129, v129
    v_rcp_f32 v130, v130
    v_rcp_f32 v131, v131
    v_rcp_f32 v132, v132
    v_rcp_f32 v133, v133
    v_rcp_f32 v134, v134
    v_rcp_f32 v135, v135
    s_nop 0
    v_accvgpr_read_b32 v64, a0
    v_accvgpr_read_b32 v65, a12
    v_accvgpr_read_b32 v66, a24
    v_accvgpr_read_b32 v67, a36
    v_pk_mul_f32 v[64:65], v[64:65], v[48:49] op_sel_hi:[1,0]
    v_pk_mul_f32 v[66:67], v[66:67], v[48:49] op_sel_hi:[1,0]
    v_cvt_pk_bf16_f32 v64, v64, v65
    v_cvt_pk_bf16_f32 v65, v66, v67
    v_accvgpr_read_b32 v68, a1
    v_accvgpr_read_b32 v69, a13
    v_accvgpr_read_b32 v70, a25
    v_accvgpr_read_b32 v71, a37
    v_pk_mul_f32 v[68:69], v[68:69], v[48:49] op_sel:[0,1] op_sel_hi:[1,1]
    v_pk_mul_f32 v[70:71], v[70:71], v[48:49] op_sel:[0,1] op_sel_hi:[1,1]
    v_cvt_pk_bf16_f32 v68, v68, v69
    v_cvt_pk_bf16_f32 v69, v70, v71
    buffer_store_dwordx2 v[64:65], v56, s[12:15], s24 offen offset:0 sc0 sc1
    v_accvgpr_read_b32 v72, a2
    v_accvgpr_read_b32 v73, a14
    v_accvgpr_read_b32 v74, a26
    v_accvgpr_read_b32 v75, a38
    v_pk_mul_f32 v[72:73], v[72:73], v[50:51] op_sel_hi:[1,0]
    v_pk_mul_f32 v[74:75], v[74:75], v[50:51] op_sel_hi:[1,0]
    v_cvt_pk_bf16_f32 v72, v72, v73
    v_cvt_pk_bf16_f32 v73, v74, v75
    buffer_store_dwordx2 v[68:69], v56, s[12:15], s24 offen offset:384 sc0 sc1
    v_accvgpr_read_b32 v76, a3
    v_accvgpr_read_b32 v77, a15
    v_accvgpr_read_b32 v78, a27
    v_accvgpr_read_b32 v79, a39
    v_pk_mul_f32 v[76:77], v[76:77], v[50:51] op_sel:[0,1] op_sel_hi:[1,1]
    v_pk_mul_f32 v[78:79], v[78:79], v[50:51] op_sel:[0,1] op_sel_hi:[1,1]
    v_cvt_pk_bf16_f32 v76, v76, v77
    v_cvt_pk_bf16_f32 v77, v78, v79
    buffer_store_dwordx2 v[72:73], v56, s[12:15], s24 offen offset:768 sc0 sc1
    v_accvgpr_read_b32 v80, a4
    v_accvgpr_read_b32 v81, a16
    v_accvgpr_read_b32 v82, a28
    v_accvgpr_read_b32 v83, a40
    v_pk_mul_f32 v[80:81], v[80:81], v[48:49] op_sel_hi:[1,0]
    v_pk_mul_f32 v[82:83], v[82:83], v[48:49] op_sel_hi:[1,0]
    v_cvt_pk_bf16_f32 v80, v80, v81
    v_cvt_pk_bf16_f32 v81, v82, v83
    buffer_store_dwordx2 v[76:77], v56, s[12:15], s24 offen offset:1152 sc0 sc1
    v_accvgpr_read_b32 v84, a5
    v_accvgpr_read_b32 v85, a17
    v_accvgpr_read_b32 v86, a29
    v_accvgpr_read_b32 v87, a41
    v_pk_mul_f32 v[84:85], v[84:85], v[48:49] op_sel:[0,1] op_sel_hi:[1,1]
    v_pk_mul_f32 v[86:87], v[86:87], v[48:49] op_sel:[0,1] op_sel_hi:[1,1]
    v_cvt_pk_bf16_f32 v84, v84, v85
    v_cvt_pk_bf16_f32 v85, v86, v87
    buffer_store_dwordx2 v[80:81], v56, s[12:15], s24 offen offset:128 sc0 sc1
    v_accvgpr_read_b32 v88, a6
    v_accvgpr_read_b32 v89, a18
    v_accvgpr_read_b32 v90, a30
    v_accvgpr_read_b32 v91, a42
    v_pk_mul_f32 v[88:89], v[88:89], v[50:51] op_sel_hi:[1,0]
    v_pk_mul_f32 v[90:91], v[90:91], v[50:51] op_sel_hi:[1,0]
    v_cvt_pk_bf16_f32 v88, v88, v89
    v_cvt_pk_bf16_f32 v89, v90, v91
    buffer_store_dwordx2 v[84:85], v56, s[12:15], s24 offen offset:512 sc0 sc1
    v_accvgpr_read_b32 v92, a7
    v_accvgpr_read_b32 v93, a19
    v_accvgpr_read_b32 v94, a31
    v_accvgpr_read_b32 v95, a43
    v_pk_mul_f32 v[92:93], v[92:93], v[50:51] op_sel:[0,1] op_sel_hi:[1,1]
    v_pk_mul_f32 v[94:95], v[94:95], v[50:51] op_sel:[0,1] op_sel_hi:[1,1]
    v_cvt_pk_bf16_f32 v92, v92, v93
    v_cvt_pk_bf16_f32 v93, v94, v95
    buffer_store_dwordx2 v[88:89], v56, s[12:15], s24 offen offset:896 sc0 sc1
    v_accvgpr_read_b32 v96, a8
    v_accvgpr_read_b32 v97, a20
    v_accvgpr_read_b32 v98, a32
    v_accvgpr_read_b32 v99, a44
    v_pk_mul_f32 v[96:97], v[96:97], v[48:49] op_sel_hi:[1,0]
    v_pk_mul_f32 v[98:99], v[98:99], v[48:49] op_sel_hi:[1,0]
    v_cvt_pk_bf16_f32 v96, v96, v97
    v_cvt_pk_bf16_f32 v97, v98, v99
    buffer_store_dwordx2 v[92:93], v56, s[12:15], s24 offen offset:1280 sc0 sc1
    v_accvgpr_read_b32 v100, a9
    v_accvgpr_read_b32 v101, a21
    v_accvgpr_read_b32 v102, a33
    v_accvgpr_read_b32 v103, a45
    v_pk_mul_f32 v[100:101], v[100:101], v[48:49] op_sel:[0,1] op_sel_hi:[1,1]
    v_pk_mul_f32 v[102:103], v[102:103], v[48:49] op_sel:[0,1] op_sel_hi:[1,1]
    v_cvt_pk_bf16_f32 v100, v100, v101
    v_cvt_pk_bf16_f32 v101, v102, v103
    buffer_store_dwordx2 v[96:97], v56, s[12:15], s24 offen offset:256 sc0 sc1
    v_accvgpr_read_b32 v104, a10
    v_accvgpr_read_b32 v105, a22
    v_accvgpr_read_b32 v106, a34
    v_accvgpr_read_b32 v107, a46
    v_pk_mul_f32 v[104:105], v[104:105], v[50:51] op_sel_hi:[1,0]
    v_pk_mul_f32 v[106:107], v[106:107], v[50:51] op_sel_hi:[1,0]
    v_cvt_pk_bf16_f32 v104, v104, v105
    v_cvt_pk_bf16_f32 v105, v106, v107
    buffer_store_dwordx2 v[100:101], v56, s[12:15], s24 offen offset:640 sc0 sc1
    v_accvgpr_read_b32 v108, a11
    v_accvgpr_read_b32 v109, a23
    v_accvgpr_read_b32 v110, a35
    v_accvgpr_read_b32 v111, a47
    v_pk_mul_f32 v[108:109], v[108:109], v[50:51] op_sel:[0,1] op_sel_hi:[1,1]
    v_pk_mul_f32 v[110:111], v[110:111], v[50:51] op_sel:[0,1] op_sel_hi:[1,1]
    v_cvt_pk_bf16_f32 v108, v108, v109
    v_cvt_pk_bf16_f32 v109, v110, v111
    buffer_store_dwordx2 v[104:105], v56, s[12:15], s24 offen offset:1024 sc0 sc1
    v_accvgpr_read_b32 v112, a48
    v_accvgpr_read_b32 v113, a60
    v_accvgpr_read_b32 v114, a72
    v_accvgpr_read_b32 v115, a84
    v_pk_mul_f32 v[112:113], v[112:113], v[52:53] op_sel_hi:[1,0]
    v_pk_mul_f32 v[114:115], v[114:115], v[52:53] op_sel_hi:[1,0]
    v_cvt_pk_bf16_f32 v112, v112, v113
    v_cvt_pk_bf16_f32 v113, v114, v115
    buffer_store_dwordx2 v[108:109], v56, s[12:15], s24 offen offset:1408 sc0 sc1
    v_accvgpr_read_b32 v116, a49
    v_accvgpr_read_b32 v117, a61
    v_accvgpr_read_b32 v118, a73
    v_accvgpr_read_b32 v119, a85
    v_pk_mul_f32 v[116:117], v[116:117], v[52:53] op_sel:[0,1] op_sel_hi:[1,1]
    v_pk_mul_f32 v[118:119], v[118:119], v[52:53] op_sel:[0,1] op_sel_hi:[1,1]
    v_cvt_pk_bf16_f32 v116, v116, v117
    v_cvt_pk_bf16_f32 v117, v118, v119
    buffer_store_dwordx2 v[112:113], v56, s[12:15], s40 offen offset:0 sc0 sc1
    v_accvgpr_read_b32 v120, a50
    v_accvgpr_read_b32 v121, a62
    v_accvgpr_read_b32 v122, a74
    v_accvgpr_read_b32 v123, a86
    v_pk_mul_f32 v[120:121], v[120:121], v[54:55] op_sel_hi:[1,0]
    v_pk_mul_f32 v[122:123], v[122:123], v[54:55] op_sel_hi:[1,0]
    v_cvt_pk_bf16_f32 v120, v120, v121
    v_cvt_pk_bf16_f32 v121, v122, v123
    buffer_store_dwordx2 v[116:117], v56, s[12:15], s40 offen offset:384 sc0 sc1
    v_accvgpr_read_b32 v124, a51
    v_accvgpr_read_b32 v125, a63
    v_accvgpr_read_b32 v126, a75
    v_accvgpr_read_b32 v127, a87
    v_pk_mul_f32 v[124:125], v[124:125], v[54:55] op_sel:[0,1] op_sel_hi:[1,1]
    v_pk_mul_f32 v[126:127], v[126:127], v[54:55] op_sel:[0,1] op_sel_hi:[1,1]
    v_cvt_pk_bf16_f32 v124, v124, v125
    v_cvt_pk_bf16_f32 v125, v126, v127
    buffer_store_dwordx2 v[120:121], v56, s[12:15], s40 offen offset:768 sc0 sc1
    v_accvgpr_read_b32 v64, a52
    v_accvgpr_read_b32 v65, a64
    v_accvgpr_read_b32 v66, a76
    v_accvgpr_read_b32 v67, a88
    v_pk_mul_f32 v[64:65], v[64:65], v[52:53] op_sel_hi:[1,0]
    v_pk_mul_f32 v[66:67], v[66:67], v[52:53] op_sel_hi:[1,0]
    v_cvt_pk_bf16_f32 v64, v64, v65
    v_cvt_pk_bf16_f32 v65, v66, v67
    buffer_store_dwordx2 v[124:125], v56, s[12:15], s40 offen offset:1152 sc0 sc1
    v_accvgpr_read_b32 v68, a53
    v_accvgpr_read_b32 v69, a65
    v_accvgpr_read_b32 v70, a77
    v_accvgpr_read_b32 v71, a89
    v_pk_mul_f32 v[68:69], v[68:69], v[52:53] op_sel:[0,1] op_sel_hi:[1,1]
    v_pk_mul_f32 v[70:71], v[70:71], v[52:53] op_sel:[0,1] op_sel_hi:[1,1]
    v_cvt_pk_bf16_f32 v68, v68, v69
    v_cvt_pk_bf16_f32 v69, v70, v71
    buffer_store_dwordx2 v[64:65], v56, s[12:15], s40 offen offset:128 sc0 sc1
    v_accvgpr_read_b32 v72, a54
    v_accvgpr_read_b32 v73, a66
    v_accvgpr_read_b32 v74, a78
    v_accvgpr_read_b32 v75, a90
    v_pk_mul_f32 v[72:73], v[72:73], v[54:55] op_sel_hi:[1,0]
    v_pk_mul_f32 v[74:75], v[74:75], v[54:55] op_sel_hi:[1,0]
    v_cvt_pk_bf16_f32 v72, v72, v73
    v_cvt_pk_bf16_f32 v73, v74, v75
    buffer_store_dwordx2 v[68:69], v56, s[12:15], s40 offen offset:512 sc0 sc1
    v_accvgpr_read_b32 v76, a55
    v_accvgpr_read_b32 v77, a67
    v_accvgpr_read_b32 v78, a79
    v_accvgpr_read_b32 v79, a91
    v_pk_mul_f32 v[76:77], v[76:77], v[54:55] op_sel:[0,1] op_sel_hi:[1,1]
    v_pk_mul_f32 v[78:79], v[78:79], v[54:55] op_sel:[0,1] op_sel_hi:[1,1]
    v_cvt_pk_bf16_f32 v76, v76, v77
    v_cvt_pk_bf16_f32 v77, v78, v79
    buffer_store_dwordx2 v[72:73], v56, s[12:15], s40 offen offset:896 sc0 sc1
    v_accvgpr_read_b32 v80, a56
    v_accvgpr_read_b32 v81, a68
    v_accvgpr_read_b32 v82, a80
    v_accvgpr_read_b32 v83, a92
    v_pk_mul_f32 v[80:81], v[80:81], v[52:53] op_sel_hi:[1,0]
    v_pk_mul_f32 v[82:83], v[82:83], v[52:53] op_sel_hi:[1,0]
    v_cvt_pk_bf16_f32 v80, v80, v81
    v_cvt_pk_bf16_f32 v81, v82, v83
    buffer_store_dwordx2 v[76:77], v56, s[12:15], s40 offen offset:1280 sc0 sc1
    v_accvgpr_read_b32 v84, a57
    v_accvgpr_read_b32 v85, a69
    v_accvgpr_read_b32 v86, a81
    v_accvgpr_read_b32 v87, a93
    v_pk_mul_f32 v[84:85], v[84:85], v[52:53] op_sel:[0,1] op_sel_hi:[1,1]
    v_pk_mul_f32 v[86:87], v[86:87], v[52:53] op_sel:[0,1] op_sel_hi:[1,1]
    v_cvt_pk_bf16_f32 v84, v84, v85
    v_cvt_pk_bf16_f32 v85, v86, v87
    buffer_store_dwordx2 v[80:81], v56, s[12:15], s40 offen offset:256 sc0 sc1
    v_accvgpr_read_b32 v88, a58
    v_accvgpr_read_b32 v89, a70
    v_accvgpr_read_b32 v90, a82
    v_accvgpr_read_b32 v91, a94
    v_pk_mul_f32 v[88:89], v[88:89], v[54:55] op_sel_hi:[1,0]
    v_pk_mul_f32 v[90:91], v[90:91], v[54:55] op_sel_hi:[1,0]
    v_cvt_pk_bf16_f32 v88, v88, v89
    v_cvt_pk_bf16_f32 v89, v90, v91
    buffer_store_dwordx2 v[84:85], v56, s[12:15], s40 offen offset:640 sc0 sc1
    v_accvgpr_read_b32 v92, a59
    v_accvgpr_read_b32 v93, a71
    v_accvgpr_read_b32 v94, a83
    v_accvgpr_read_b32 v95, a95
    v_pk_mul_f32 v[92:93], v[92:93], v[54:55] op_sel:[0,1] op_sel_hi:[1,1]
    v_pk_mul_f32 v[94:95], v[94:95], v[54:55] op_sel:[0,1] op_sel_hi:[1,1]
    v_cvt_pk_bf16_f32 v92, v92, v93
    v_cvt_pk_bf16_f32 v93, v94, v95
    buffer_store_dwordx2 v[88:89], v56, s[12:15], s40 offen offset:1024 sc0 sc1
    v_accvgpr_read_b32 v96, a96
    v_accvgpr_read_b32 v97, a108
    v_accvgpr_read_b32 v98, a120
    v_accvgpr_read_b32 v99, a132
    v_pk_mul_f32 v[96:97], v[96:97], v[128:129] op_sel_hi:[1,0]
    v_pk_mul_f32 v[98:99], v[98:99], v[128:129] op_sel_hi:[1,0]
    v_cvt_pk_bf16_f32 v96, v96, v97
    v_cvt_pk_bf16_f32 v97, v98, v99
    buffer_store_dwordx2 v[92:93], v56, s[12:15], s40 offen offset:1408 sc0 sc1
    v_accvgpr_read_b32 v100, a97
    v_accvgpr_read_b32 v101, a109
    v_accvgpr_read_b32 v102, a121
    v_accvgpr_read_b32 v103, a133
    v_pk_mul_f32 v[100:101], v[100:101], v[128:129] op_sel:[0,1] op_sel_hi:[1,1]
    v_pk_mul_f32 v[102:103], v[102:103], v[128:129] op_sel:[0,1] op_sel_hi:[1,1]
    v_cvt_pk_bf16_f32 v100, v100, v101
    v_cvt_pk_bf16_f32 v101, v102, v103
    buffer_store_dwordx2 v[96:97], v56, s[12:15], s41 offen offset:0 sc0 sc1
    v_accvgpr_read_b32 v104, a98
    v_accvgpr_read_b32 v105, a110
    v_accvgpr_read_b32 v106, a122
    v_accvgpr_read_b32 v107, a134
    v_pk_mul_f32 v[104:105], v[104:105], v[130:131] op_sel_hi:[1,0]
    v_pk_mul_f32 v[106:107], v[106:107], v[130:131] op_sel_hi:[1,0]
    v_cvt_pk_bf16_f32 v104, v104, v105
    v_cvt_pk_bf16_f32 v105, v106, v107
    buffer_store_dwordx2 v[100:101], v56, s[12:15], s41 offen offset:384 sc0 sc1
    v_accvgpr_read_b32 v108, a99
    v_accvgpr_read_b32 v109, a111
    v_accvgpr_read_b32 v110, a123
    v_accvgpr_read_b32 v111, a135
    v_pk_mul_f32 v[108:109], v[108:109], v[130:131] op_sel:[0,1] op_sel_hi:[1,1]
    v_pk_mul_f32 v[110:111], v[110:111], v[130:131] op_sel:[0,1] op_sel_hi:[1,1]
    v_cvt_pk_bf16_f32 v108, v108, v109
    v_cvt_pk_bf16_f32 v109, v110, v111
    buffer_store_dwordx2 v[104:105], v56, s[12:15], s41 offen offset:768 sc0 sc1
    v_accvgpr_read_b32 v112, a100
    v_accvgpr_read_b32 v113, a112
    v_accvgpr_read_b32 v114, a124
    v_accvgpr_read_b32 v115, a136
    v_pk_mul_f32 v[112:113], v[112:113], v[128:129] op_sel_hi:[1,0]
    v_pk_mul_f32 v[114:115], v[114:115], v[128:129] op_sel_hi:[1,0]
    v_cvt_pk_bf16_f32 v112, v112, v113
    v_cvt_pk_bf16_f32 v113, v114, v115
    buffer_store_dwordx2 v[108:109], v56, s[12:15], s41 offen offset:1152 sc0 sc1
    v_accvgpr_read_b32 v116, a101
    v_accvgpr_read_b32 v117, a113
    v_accvgpr_read_b32 v118, a125
    v_accvgpr_read_b32 v119, a137
    v_pk_mul_f32 v[116:117], v[116:117], v[128:129] op_sel:[0,1] op_sel_hi:[1,1]
    v_pk_mul_f32 v[118:119], v[118:119], v[128:129] op_sel:[0,1] op_sel_hi:[1,1]
    v_cvt_pk_bf16_f32 v116, v116, v117
    v_cvt_pk_bf16_f32 v117, v118, v119
    buffer_store_dwordx2 v[112:113], v56, s[12:15], s41 offen offset:128 sc0 sc1
    v_accvgpr_read_b32 v120, a102
    v_accvgpr_read_b32 v121, a114
    v_accvgpr_read_b32 v122, a126
    v_accvgpr_read_b32 v123, a138
    v_pk_mul_f32 v[120:121], v[120:121], v[130:131] op_sel_hi:[1,0]
    v_pk_mul_f32 v[122:123], v[122:123], v[130:131] op_sel_hi:[1,0]
    v_cvt_pk_bf16_f32 v120, v120, v121
    v_cvt_pk_bf16_f32 v121, v122, v123
    buffer_store_dwordx2 v[116:117], v56, s[12:15], s41 offen offset:512 sc0 sc1
    v_accvgpr_read_b32 v124, a103
    v_accvgpr_read_b32 v125, a115
    v_accvgpr_read_b32 v126, a127
    v_accvgpr_read_b32 v127, a139
    v_pk_mul_f32 v[124:125], v[124:125], v[130:131] op_sel:[0,1] op_sel_hi:[1,1]
    v_pk_mul_f32 v[126:127], v[126:127], v[130:131] op_sel:[0,1] op_sel_hi:[1,1]
    v_cvt_pk_bf16_f32 v124, v124, v125
    v_cvt_pk_bf16_f32 v125, v126, v127
    buffer_store_dwordx2 v[120:121], v56, s[12:15], s41 offen offset:896 sc0 sc1
    v_accvgpr_read_b32 v64, a104
    v_accvgpr_read_b32 v65, a116
    v_accvgpr_read_b32 v66, a128
    v_accvgpr_read_b32 v67, a140
    v_pk_mul_f32 v[64:65], v[64:65], v[128:129] op_sel_hi:[1,0]
    v_pk_mul_f32 v[66:67], v[66:67], v[128:129] op_sel_hi:[1,0]
    v_cvt_pk_bf16_f32 v64, v64, v65
    v_cvt_pk_bf16_f32 v65, v66, v67
    buffer_store_dwordx2 v[124:125], v56, s[12:15], s41 offen offset:1280 sc0 sc1
    v_accvgpr_read_b32 v68, a105
    v_accvgpr_read_b32 v69, a117
    v_accvgpr_read_b32 v70, a129
    v_accvgpr_read_b32 v71, a141
    v_pk_mul_f32 v[68:69], v[68:69], v[128:129] op_sel:[0,1] op_sel_hi:[1,1]
    v_pk_mul_f32 v[70:71], v[70:71], v[128:129] op_sel:[0,1] op_sel_hi:[1,1]
    v_cvt_pk_bf16_f32 v68, v68, v69
    v_cvt_pk_bf16_f32 v69, v70, v71
    buffer_store_dwordx2 v[64:65], v56, s[12:15], s41 offen offset:256 sc0 sc1
    v_accvgpr_read_b32 v72, a106
    v_accvgpr_read_b32 v73, a118
    v_accvgpr_read_b32 v74, a130
    v_accvgpr_read_b32 v75, a142
    v_pk_mul_f32 v[72:73], v[72:73], v[130:131] op_sel_hi:[1,0]
    v_pk_mul_f32 v[74:75], v[74:75], v[130:131] op_sel_hi:[1,0]
    v_cvt_pk_bf16_f32 v72, v72, v73
    v_cvt_pk_bf16_f32 v73, v74, v75
    buffer_store_dwordx2 v[68:69], v56, s[12:15], s41 offen offset:640 sc0 sc1
    v_accvgpr_read_b32 v76, a107
    v_accvgpr_read_b32 v77, a119
    v_accvgpr_read_b32 v78, a131
    v_accvgpr_read_b32 v79, a143
    v_pk_mul_f32 v[76:77], v[76:77], v[130:131] op_sel:[0,1] op_sel_hi:[1,1]
    v_pk_mul_f32 v[78:79], v[78:79], v[130:131] op_sel:[0,1] op_sel_hi:[1,1]
    v_cvt_pk_bf16_f32 v76, v76, v77
    v_cvt_pk_bf16_f32 v77, v78, v79
    buffer_store_dwordx2 v[72:73], v56, s[12:15], s41 offen offset:1024 sc0 sc1
    v_accvgpr_read_b32 v80, a144
    v_accvgpr_read_b32 v81, a156
    v_accvgpr_read_b32 v82, a168
    v_accvgpr_read_b32 v83, a180
    v_pk_mul_f32 v[80:81], v[80:81], v[132:133] op_sel_hi:[1,0]
    v_pk_mul_f32 v[82:83], v[82:83], v[132:133] op_sel_hi:[1,0]
    v_cvt_pk_bf16_f32 v80, v80, v81
    v_cvt_pk_bf16_f32 v81, v82, v83
    buffer_store_dwordx2 v[76:77], v56, s[12:15], s41 offen offset:1408 sc0 sc1
    v_accvgpr_read_b32 v84, a145
    v_accvgpr_read_b32 v85, a157
    v_accvgpr_read_b32 v86, a169
    v_accvgpr_read_b32 v87, a181
    v_pk_mul_f32 v[84:85], v[84:85], v[132:133] op_sel:[0,1] op_sel_hi:[1,1]
    v_pk_mul_f32 v[86:87], v[86:87], v[132:133] op_sel:[0,1] op_sel_hi:[1,1]
    v_cvt_pk_bf16_f32 v84, v84, v85
    v_cvt_pk_bf16_f32 v85, v86, v87
    buffer_store_dwordx2 v[80:81], v56, s[12:15], s42 offen offset:0 sc0 sc1
    v_accvgpr_read_b32 v88, a146
    v_accvgpr_read_b32 v89, a158
    v_accvgpr_read_b32 v90, a170
    v_accvgpr_read_b32 v91, a182
    v_pk_mul_f32 v[88:89], v[88:89], v[134:135] op_sel_hi:[1,0]
    v_pk_mul_f32 v[90:91], v[90:91], v[134:135] op_sel_hi:[1,0]
    v_cvt_pk_bf16_f32 v88, v88, v89
    v_cvt_pk_bf16_f32 v89, v90, v91
    buffer_store_dwordx2 v[84:85], v56, s[12:15], s42 offen offset:384 sc0 sc1
    v_accvgpr_read_b32 v92, a147
    v_accvgpr_read_b32 v93, a159
    v_accvgpr_read_b32 v94, a171
    v_accvgpr_read_b32 v95, a183
    v_pk_mul_f32 v[92:93], v[92:93], v[134:135] op_sel:[0,1] op_sel_hi:[1,1]
    v_pk_mul_f32 v[94:95], v[94:95], v[134:135] op_sel:[0,1] op_sel_hi:[1,1]
    v_cvt_pk_bf16_f32 v92, v92, v93
    v_cvt_pk_bf16_f32 v93, v94, v95
    buffer_store_dwordx2 v[88:89], v56, s[12:15], s42 offen offset:768 sc0 sc1
    v_accvgpr_read_b32 v96, a148
    v_accvgpr_read_b32 v97, a160
    v_accvgpr_read_b32 v98, a172
    v_accvgpr_read_b32 v99, a184
    v_pk_mul_f32 v[96:97], v[96:97], v[132:133] op_sel_hi:[1,0]
    v_pk_mul_f32 v[98:99], v[98:99], v[132:133] op_sel_hi:[1,0]
    v_cvt_pk_bf16_f32 v96, v96, v97
    v_cvt_pk_bf16_f32 v97, v98, v99
    buffer_store_dwordx2 v[92:93], v56, s[12:15], s42 offen offset:1152 sc0 sc1
    v_accvgpr_read_b32 v100, a149
    v_accvgpr_read_b32 v101, a161
    v_accvgpr_read_b32 v102, a173
    v_accvgpr_read_b32 v103, a185
    v_pk_mul_f32 v[100:101], v[100:101], v[132:133] op_sel:[0,1] op_sel_hi:[1,1]
    v_pk_mul_f32 v[102:103], v[102:103], v[132:133] op_sel:[0,1] op_sel_hi:[1,1]
    v_cvt_pk_bf16_f32 v100, v100, v101
    v_cvt_pk_bf16_f32 v101, v102, v103
    buffer_store_dwordx2 v[96:97], v56, s[12:15], s42 offen offset:128 sc0 sc1
    v_accvgpr_read_b32 v104, a150
    v_accvgpr_read_b32 v105, a162
    v_accvgpr_read_b32 v106, a174
    v_accvgpr_read_b32 v107, a186
    v_pk_mul_f32 v[104:105], v[104:105], v[134:135] op_sel_hi:[1,0]
    v_pk_mul_f32 v[106:107], v[106:107], v[134:135] op_sel_hi:[1,0]
    v_cvt_pk_bf16_f32 v104, v104, v105
    v_cvt_pk_bf16_f32 v105, v106, v107
    buffer_store_dwordx2 v[100:101], v56, s[12:15], s42 offen offset:512 sc0 sc1
    v_accvgpr_read_b32 v108, a151
    v_accvgpr_read_b32 v109, a163
    v_accvgpr_read_b32 v110, a175
    v_accvgpr_read_b32 v111, a187
    v_pk_mul_f32 v[108:109], v[108:109], v[134:135] op_sel:[0,1] op_sel_hi:[1,1]
    v_pk_mul_f32 v[110:111], v[110:111], v[134:135] op_sel:[0,1] op_sel_hi:[1,1]
    v_cvt_pk_bf16_f32 v108, v108, v109
    v_cvt_pk_bf16_f32 v109, v110, v111
    buffer_store_dwordx2 v[104:105], v56, s[12:15], s42 offen offset:896 sc0 sc1
    v_accvgpr_read_b32 v112, a152
    v_accvgpr_read_b32 v113, a164
    v_accvgpr_read_b32 v114, a176
    v_accvgpr_read_b32 v115, a188
    v_pk_mul_f32 v[112:113], v[112:113], v[132:133] op_sel_hi:[1,0]
    v_pk_mul_f32 v[114:115], v[114:115], v[132:133] op_sel_hi:[1,0]
    v_cvt_pk_bf16_f32 v112, v112, v113
    v_cvt_pk_bf16_f32 v113, v114, v115
    buffer_store_dwordx2 v[108:109], v56, s[12:15], s42 offen offset:1280 sc0 sc1
    v_accvgpr_read_b32 v116, a153
    v_accvgpr_read_b32 v117, a165
    v_accvgpr_read_b32 v118, a177
    v_accvgpr_read_b32 v119, a189
    v_pk_mul_f32 v[116:117], v[116:117], v[132:133] op_sel:[0,1] op_sel_hi:[1,1]
    v_pk_mul_f32 v[118:119], v[118:119], v[132:133] op_sel:[0,1] op_sel_hi:[1,1]
    v_cvt_pk_bf16_f32 v116, v116, v117
    v_cvt_pk_bf16_f32 v117, v118, v119
    buffer_store_dwordx2 v[112:113], v56, s[12:15], s42 offen offset:256 sc0 sc1
    v_accvgpr_read_b32 v120, a154
    v_accvgpr_read_b32 v121, a166
    v_accvgpr_read_b32 v122, a178
    v_accvgpr_read_b32 v123, a190
    v_pk_mul_f32 v[120:121], v[120:121], v[134:135] op_sel_hi:[1,0]
    v_pk_mul_f32 v[122:123], v[122:123], v[134:135] op_sel_hi:[1,0]
    v_cvt_pk_bf16_f32 v120, v120, v121
    v_cvt_pk_bf16_f32 v121, v122, v123
    buffer_store_dwordx2 v[116:117], v56, s[12:15], s42 offen offset:640 sc0 sc1
    v_accvgpr_read_b32 v124, a155
    v_accvgpr_read_b32 v125, a167
    v_accvgpr_read_b32 v126, a179
    v_accvgpr_read_b32 v127, a191
    v_pk_mul_f32 v[124:125], v[124:125], v[134:135] op_sel:[0,1] op_sel_hi:[1,1]
    v_pk_mul_f32 v[126:127], v[126:127], v[134:135] op_sel:[0,1] op_sel_hi:[1,1]
    v_cvt_pk_bf16_f32 v124, v124, v125
    v_cvt_pk_bf16_f32 v125, v126, v127
    buffer_store_dwordx2 v[120:121], v56, s[12:15], s42 offen offset:1024 sc0 sc1
    buffer_store_dwordx2 v[124:125], v56, s[12:15], s42 offen offset:1408 sc0 sc1
    s_branch L_fin
.section .rodata,"a"
.p2align 6
.amdhsa_kernel standalone__kv_cache_quant_int4_int2_kv_with_per_channel_or_per_token_scales__prompt_kernel
  .amdhsa_next_free_vgpr 512
  .amdhsa_next_free_sgpr 102
  .amdhsa_accum_offset 256
  .amdhsa_group_segment_fixed_size 0
  .amdhsa_kernarg_size 80
  .amdhsa_user_sgpr_count 2
  .amdhsa_user_sgpr_kernarg_segment_ptr 1
  .amdhsa_system_sgpr_workgroup_id_x 1
.end_amdhsa_kernel
```

```asm
; @launch grid=(256,1,1) block=(256,1,1) lds=147584
.amdgcn_target "amdgcn-amd-amdhsa--gfx950"
.text
.globl standalone__kv_cache_quant_int4_int2_kv_with_per_channel_or_per_token_scales__prompt_kernel
.p2align 8
.type standalone__kv_cache_quant_int4_int2_kv_with_per_channel_or_per_token_scales__prompt_kernel,@function
standalone__kv_cache_quant_int4_int2_kv_with_per_channel_or_per_token_scales__prompt_kernel:
    s_cmp_ge_u32 s2, 256
    s_cbranch_scc1 L_done
    s_load_dwordx16 s[40:55], s[0:1], 0
    s_load_dwordx4 s[16:19], s[0:1], 64
    s_and_b32 s94, s2, 7
    s_lshr_b32 s95, s2, 3
    s_lshr_b32 s24, s95, 3
    s_lshl_b32 s94, s94, 2
    s_add_u32 s94, s94, s24
    s_and_b32 s95, s95, 7
    s_getpc_b64 s[60:61]
L_pc:
    s_sub_u32 s60, s60, L_pc-standalone__kv_cache_quant_int4_int2_kv_with_per_channel_or_per_token_scales__prompt_kernel
    s_subb_u32 s61, s61, 0
    s_mov_b32 s62, L_slow-standalone__kv_cache_quant_int4_int2_kv_with_per_channel_or_per_token_scales__prompt_kernel
    s_mov_b32 s63, 0x20000
    s_lshr_b32 s22, s2, 3
    s_lshl_b32 s22, s22, 12
    v_lshlrev_b32 v30, 4, v0
    buffer_load_dwordx4 v[128:131], v30, s[60:63], s22 offen
    v_lshrrev_b32 v24, 6, v0
    v_and_b32 v25, 63, v0
    v_readfirstlane_b32 s25, v24
    v_lshlrev_b32 v1, 4, v25
    v_mul_u32_u24 v26, 43, v25
    v_lshrrev_b32 v26, 10, v26
    v_mul_u32_u24 v27, 24, v26
    v_sub_u32 v27, v25, v27
    v_lshrrev_b32 v28, 1, v24
    v_and_b32 v29, 1, v24
    v_lshlrev_b32 v30, 4, v29
    v_lshl_add_u32 v30, v28, 2, v30
    v_add_u32 v30, v30, v26
    v_mul_u32_u24 v30, 768, v30
    v_lshrrev_b32 v48, 1, v26
    v_lshlrev_b32 v48, 30, v48
    v_lshl_add_u32 v30, v27, 4, v30
    v_or_b32 v9, v30, v48
    v_lshl_or_b32 v10, v27, 3, v48
    v_mul_u32_u24 v30, 6144, v24
    v_add3_u32 v12, v30, v1, v48
    s_mov_b32 s66, 1572864
    s_mov_b32 s67, 0x20000
    s_mov_b32 s70, 1572864
    s_mov_b32 s71, 0x20000
    s_mov_b32 s74, 12288
    s_mov_b32 s75, 0x20000
    s_mov_b32 s78, 12288
    s_mov_b32 s79, 0x20000
    s_mov_b32 s82, 4096
    s_mov_b32 s83, 0x20000
    s_mov_b32 s86, 4096
    s_mov_b32 s87, 0x20000
    s_mov_b32 s22, 64
    s_mov_b32 s23, 0x20000
    s_mul_i32 s33, s95, 24576
    s_add_u32 s34, s33, 6144
    s_mov_b32 s35, s33
    s_lshr_b32 s36, s95, 1
    s_mul_i32 s36, s36, 384
    s_lshl_b32 s37, s95, 6
    s_lshl_b32 s24, s25, 4
    s_add_u32 s37, s37, s24
    s_mul_i32 s24, s94, 1572864
    s_mul_i32 s56, s94, 12288
    s_lshl_b32 s57, s94, 12
    s_lshl_b32 s58, s94, 10
    s_add_u32 s58, s58, 51380320
    s_or_b32 s39, s95, s25
    s_waitcnt lgkmcnt(0)
    s_add_u32 s64, s42, s24
    s_addc_u32 s65, s43, 0
    s_add_u32 s72, s46, s56
    s_addc_u32 s73, s47, 0
    s_add_u32 s76, s48, s56
    s_addc_u32 s77, s49, 0
    buffer_load_dwordx4 v[224:227], v9, s[64:67], s33 offen offset:0 nt
    buffer_load_dwordx4 v[228:231], v9, s[64:67], s33 offen offset:1536 nt
    buffer_load_dwordx4 v[232:235], v9, s[64:67], s34 offen offset:0 nt
    buffer_load_dwordx4 v[236:239], v9, s[64:67], s34 offen offset:1536 nt
    buffer_load_dwordx2 v[32:33], v10, s[72:75], s36 offen offset:0
    buffer_load_dwordx2 v[34:35], v10, s[76:79], s36 offen offset:0
    buffer_load_dwordx2 v[36:37], v10, s[72:75], s36 offen offset:192
    buffer_load_dwordx2 v[38:39], v10, s[76:79], s36 offen offset:192
    s_add_u32 s20, s18, s58
    s_addc_u32 s21, s19, 0
    s_add_u32 s80, s50, s57
    s_addc_u32 s81, s51, 0
    s_add_u32 s84, s52, s57
    s_addc_u32 s85, s53, 0
    s_add_u32 s68, s44, s24
    s_addc_u32 s69, s45, 0
    s_mul_i32 s59, s94, 786432
    s_add_u32 s12, s54, s59
    s_addc_u32 s13, s55, 0
    s_add_u32 s8, s40, s59
    s_addc_u32 s9, s41, 0
    s_cmp_lg_u32 s39, 0
    s_cbranch_scc1 L_notleader0
    s_buffer_load_dwordx16 s[40:55], s[20:23], 0 glc
L_notleader0:
    buffer_load_dwordx4 v[240:243], v9, s[64:67], s33 offen offset:384 nt
    buffer_load_dwordx4 v[244:247], v9, s[64:67], s33 offen offset:1920 nt
    buffer_load_dwordx4 v[248:251], v9, s[64:67], s34 offen offset:384 nt
    buffer_load_dwordx4 v[252:255], v9, s[64:67], s34 offen offset:1920 nt
    s_add_u32 s4, s18, s24
    s_addc_u32 s5, s19, 0
    s_mov_b32 s6, 1572864
    s_mov_b32 s7, 0x20000
    s_mov_b32 s10, 786432
    s_mov_b32 s11, 0x20000
    s_mov_b32 s88, s16
    s_mov_b32 s89, s17
    s_add_u32 s16, s33, 3072
    s_add_u32 s17, s33, 6144
    s_mov_b32 s90, 256
    s_mov_b32 s91, 0x20000
    s_lshl_b32 s93, s94, 3
    s_cmp_lg_u32 s39, 0
    s_cbranch_scc1 L_notleader
    s_waitcnt lgkmcnt(0)
    s_mov_b32 s59, 1
    s_lshr_b32 s40, s40, 10
    s_min_u32 s40, s40, 31
    s_bitset1_b32 s59, s40
    s_lshr_b32 s41, s41, 10
    s_min_u32 s41, s41, 31
    s_bitset1_b32 s59, s41
    s_lshr_b32 s42, s42, 10
    s_min_u32 s42, s42, 31
    s_bitset1_b32 s59, s42
    s_lshr_b32 s43, s43, 10
    s_min_u32 s43, s43, 31
    s_bitset1_b32 s59, s43
    s_lshr_b32 s44, s44, 10
    s_min_u32 s44, s44, 31
    s_bitset1_b32 s59, s44
    s_lshr_b32 s45, s45, 10
    s_min_u32 s45, s45, 31
    s_bitset1_b32 s59, s45
    s_lshr_b32 s46, s46, 10
    s_min_u32 s46, s46, 31
    s_bitset1_b32 s59, s46
    s_lshr_b32 s47, s47, 10
    s_min_u32 s47, s47, 31
    s_bitset1_b32 s59, s47
    s_lshr_b32 s48, s48, 10
    s_min_u32 s48, s48, 31
    s_bitset1_b32 s59, s48
    s_lshr_b32 s49, s49, 10
    s_min_u32 s49, s49, 31
    s_bitset1_b32 s59, s49
    s_lshr_b32 s50, s50, 10
    s_min_u32 s50, s50, 31
    s_bitset1_b32 s59, s50
    s_lshr_b32 s51, s51, 10
    s_min_u32 s51, s51, 31
    s_bitset1_b32 s59, s51
    s_lshr_b32 s52, s52, 10
    s_min_u32 s52, s52, 31
    s_bitset1_b32 s59, s52
    s_lshr_b32 s53, s53, 10
    s_min_u32 s53, s53, 31
    s_bitset1_b32 s59, s53
    s_lshr_b32 s54, s54, 10
    s_min_u32 s54, s54, 31
    s_bitset1_b32 s59, s54
    s_lshr_b32 s55, s55, 10
    s_min_u32 s55, s55, 31
    s_bitset1_b32 s59, s55
    s_ff0_i32_b32 s59, s59
    s_lshl_b32 s59, s59, 10
    v_mov_b32 v52, s59
    s_mov_b64 exec, 1
    buffer_store_dword v52, off, s[88:91], s93 sc1
    s_mov_b64 exec, -1
L_notleader:
    s_lshl_b32 s24, s95, 2
    s_add_u32 s24, s24, 32
    s_buffer_load_dword s46, s[20:23], s24 glc
    s_getreg_b32 s45, hwreg(HW_REG_XCC_ID, 0, 4)
    s_lshl_b32 s45, s45, 5
    s_mov_b32 s44, 32
    buffer_load_dwordx4 v[112:115], v12, s[68:71], s35 offen offset:0 nt
    buffer_load_dwordx4 v[116:119], v12, s[68:71], s35 offen offset:768 nt
    buffer_load_dwordx4 v[120:123], v12, s[68:71], s35 offen offset:1536 nt
    buffer_load_dwordx4 v[124:127], v12, s[68:71], s35 offen offset:2304 nt
    buffer_load_dwordx2 v[40:41], off, s[80:83], s37 offset:0
    buffer_load_dwordx2 v[42:43], off, s[84:87], s37 offset:0
    buffer_load_dwordx2 v[44:45], off, s[80:83], s37 offset:8
    buffer_load_dwordx2 v[46:47], off, s[84:87], s37 offset:8
    s_mov_b32 s14, 786432
    s_mov_b32 s15, 0x20000
    s_lshl_b32 s24, s25, 8
    s_add_u32 s93, s93, s24
    v_mul_u32_u24 v30, 3072, v24
    v_add_u32 v4, v30, v1
    v_lshl_add_u32 v30, v24, 3, v26
    v_mul_u32_u24 v30, 384, v30
    v_lshlrev_b32 v31, 2, v29
    v_xor_b32 v31, v27, v31
    v_lshl_add_u32 v30, v31, 4, v30
    v_or_b32 v11, v30, v48
    v_lshlrev_b32 v30, 8, v24
    v_add_u32 v30, 12288, v30
    v_lshrrev_b32 v31, 4, v25
    v_lshl_add_u32 v30, v31, 10, v30
    v_and_b32 v31, 15, v25
    v_lshl_add_u32 v30, v31, 4, v30
    v_or_b32 v15, v30, v48
    s_lshl_b32 s24, s95, 2
    v_lshl_add_u32 v13, v0, 2, s24
    v_cmp_lt_u32 vcc, 0, v0
    v_mov_b32 v30, 0x40000000
    s_nop 0
    v_cndmask_b32 v13, v13, v30, vcc
    s_mul_i32 s26, s25, 3072
    s_add_u32 s26, s26, 12288
    s_add_u32 s56, s26, 24576
    s_add_u32 s24, s95, 1
    s_and_b32 s24, s24, 7
    s_mul_i32 s32, s24, 24576
    s_add_u32 s27, s32, 12288
    s_mov_b32 s28, 98304
    s_mov_b32 s30, 73728
    v_add_u32 v1, 24576, v1
    s_mov_b32 s38, 0x3dd53b95
    s_mov_b32 s97, 0xffff0000
    s_mov_b32 s96, 100000
    v_and_b32 v26, 15, v25
    v_lshrrev_b32 v27, 4, v25
    v_bfe_u32 v28, v25, 1, 3
    v_xor_b32 v29, v27, v28
    v_mul_u32_u24 v30, 384, v26
    v_lshl_add_u32 v2, v29, 4, v30
    v_xor_b32 v3, 64, v2
    s_mul_i32 s40, s25, 6144
    s_add_u32 s40, s40, 73728
    v_lshrrev_b32 v29, 1, v27
    v_xor_b32 v29, v29, v28
    v_lshl_add_u32 v31, v29, 4, v30
    v_and_b32 v29, 1, v27
    v_lshl_add_u32 v31, v29, 3, v31
    v_xor_b32 v22, 0, v31
    v_add_u32 v22, s40, v22
    v_xor_b32 v23, 32, v31
    v_add_u32 v23, s40, v23
    v_xor_b32 v142, 64, v31
    v_add_u32 v142, s40, v142
    v_xor_b32 v143, 96, v31
    v_add_u32 v143, s40, v143
    s_lshl_b32 s24, s95, 2
    s_add_u32 s24, s24, s25
    s_mul_i32 s24, s24, 24576
    v_add_u32 v26, 0, v25
    v_mul_u32_u24 v27, 2731, v26
    v_lshrrev_b32 v27, 17, v27
    v_and_b32 v27, 7, v27
    v_xor_b32 v26, v26, v27
    v_lshlrev_b32 v136, 4, v26
    v_add_u32 v136, s24, v136
    v_add_u32 v26, 64, v25
    v_mul_u32_u24 v27, 2731, v26
    v_lshrrev_b32 v27, 17, v27
    v_and_b32 v27, 7, v27
    v_xor_b32 v26, v26, v27
    v_lshlrev_b32 v137, 4, v26
    v_add_u32 v137, s24, v137
    v_add_u32 v26, 128, v25
    v_mul_u32_u24 v27, 2731, v26
    v_lshrrev_b32 v27, 17, v27
    v_and_b32 v27, 7, v27
    v_xor_b32 v26, v26, v27
    v_lshlrev_b32 v138, 4, v26
    v_add_u32 v138, s24, v138
    v_add_u32 v26, 192, v25
    v_mul_u32_u24 v27, 2731, v26
    v_lshrrev_b32 v27, 17, v27
    v_and_b32 v27, 7, v27
    v_xor_b32 v26, v26, v27
    v_lshlrev_b32 v139, 4, v26
    v_add_u32 v139, s24, v139
    v_add_u32 v26, 256, v25
    v_mul_u32_u24 v27, 2731, v26
    v_lshrrev_b32 v27, 17, v27
    v_and_b32 v27, 7, v27
    v_xor_b32 v26, v26, v27
    v_lshlrev_b32 v140, 4, v26
    v_add_u32 v140, s24, v140
    v_add_u32 v26, 320, v25
    v_mul_u32_u24 v27, 2731, v26
    v_lshrrev_b32 v27, 17, v27
    v_and_b32 v27, 7, v27
    v_xor_b32 v26, v26, v27
    v_lshlrev_b32 v141, 4, v26
    v_add_u32 v141, s24, v141
    v_mov_b32 v5, 0
    v_mov_b32 v6, 0
    v_mov_b32 v7, 0
    v_mov_b32 v8, 0
    s_mov_b32 s62, -1
    s_mov_b32 s63, 0xffff
    s_waitcnt vmcnt(12)
    buffer_load_dwordx4 v[80:83], v12, s[68:71], s16 offen offset:0 nt
    buffer_load_dwordx4 v[84:87], v12, s[68:71], s16 offen offset:768 nt
    buffer_load_dwordx4 v[88:91], v12, s[68:71], s16 offen offset:1536 nt
    buffer_load_dwordx4 v[92:95], v12, s[68:71], s16 offen offset:2304 nt
    v_lshlrev_b32 v48, 16, v32
    v_and_b32 v49, s97, v32
    v_lshlrev_b32 v50, 16, v34
    v_and_b32 v51, s97, v34
    v_mul_f32 v48, s38, v48
    v_mul_f32 v49, s38, v49
    v_mul_f32_e64 v50, -v50, v48
    v_mul_f32_e64 v51, -v51, v49
    v_cvt_f32_i32 v224, v224
    v_cvt_f32_i32 v225, v225
    v_fma_f32 v224, v224, v48, v50
    v_fma_f32 v225, v225, v49, v51
    v_cvt_pk_bf16_f32 v224, v224, v225
    v_cvt_f32_i32 v228, v228
    v_cvt_f32_i32 v229, v229
    v_fma_f32 v228, v228, v48, v50
    v_fma_f32 v229, v229, v49, v51
    v_cvt_pk_bf16_f32 v228, v228, v229
    v_cvt_f32_i32 v232, v232
    v_cvt_f32_i32 v233, v233
    v_fma_f32 v232, v232, v48, v50
    v_fma_f32 v233, v233, v49, v51
    v_cvt_pk_bf16_f32 v232, v232, v233
    v_cvt_f32_i32 v236, v236
    v_cvt_f32_i32 v237, v237
    v_fma_f32 v236, v236, v48, v50
    v_fma_f32 v237, v237, v49, v51
    v_cvt_pk_bf16_f32 v236, v236, v237
    v_lshlrev_b32 v48, 16, v33
    v_and_b32 v49, s97, v33
    v_lshlrev_b32 v50, 16, v35
    v_and_b32 v51, s97, v35
    v_mul_f32 v48, s38, v48
    v_mul_f32 v49, s38, v49
    v_mul_f32_e64 v50, -v50, v48
    v_mul_f32_e64 v51, -v51, v49
    v_cvt_f32_i32 v226, v226
    v_cvt_f32_i32 v227, v227
    v_fma_f32 v226, v226, v48, v50
    v_fma_f32 v227, v227, v49, v51
    v_cvt_pk_bf16_f32 v225, v226, v227
    v_cvt_f32_i32 v230, v230
    v_cvt_f32_i32 v231, v231
    v_fma_f32 v230, v230, v48, v50
    v_fma_f32 v231, v231, v49, v51
    v_cvt_pk_bf16_f32 v229, v230, v231
    v_cvt_f32_i32 v234, v234
    v_cvt_f32_i32 v235, v235
    v_fma_f32 v234, v234, v48, v50
    v_fma_f32 v235, v235, v49, v51
    v_cvt_pk_bf16_f32 v233, v234, v235
    v_cvt_f32_i32 v238, v238
    v_cvt_f32_i32 v239, v239
    v_fma_f32 v238, v238, v48, v50
    v_fma_f32 v239, v239, v49, v51
    v_cvt_pk_bf16_f32 v237, v238, v239
    s_waitcnt vmcnt(12)
    v_lshlrev_b32 v48, 16, v36
    v_and_b32 v49, s97, v36
    v_lshlrev_b32 v50, 16, v38
    v_and_b32 v51, s97, v38
    v_mul_f32 v48, s38, v48
    v_mul_f32 v49, s38, v49
    v_mul_f32_e64 v50, -v50, v48
    v_mul_f32_e64 v51, -v51, v49
    v_cvt_f32_i32 v240, v240
    v_cvt_f32_i32 v241, v241
    v_fma_f32 v240, v240, v48, v50
    v_fma_f32 v241, v241, v49, v51
    v_cvt_pk_bf16_f32 v226, v240, v241
    v_cvt_f32_i32 v244, v244
    v_cvt_f32_i32 v245, v245
    v_fma_f32 v244, v244, v48, v50
    v_fma_f32 v245, v245, v49, v51
    v_cvt_pk_bf16_f32 v230, v244, v245
    v_cvt_f32_i32 v248, v248
    v_cvt_f32_i32 v249, v249
    v_fma_f32 v248, v248, v48, v50
    v_fma_f32 v249, v249, v49, v51
    v_cvt_pk_bf16_f32 v234, v248, v249
    v_cvt_f32_i32 v252, v252
    v_cvt_f32_i32 v253, v253
    v_fma_f32 v252, v252, v48, v50
    v_fma_f32 v253, v253, v49, v51
    v_cvt_pk_bf16_f32 v238, v252, v253
    v_lshlrev_b32 v48, 16, v37
    v_and_b32 v49, s97, v37
    v_lshlrev_b32 v50, 16, v39
    v_and_b32 v51, s97, v39
    v_mul_f32 v48, s38, v48
    v_mul_f32 v49, s38, v49
    v_mul_f32_e64 v50, -v50, v48
    v_mul_f32_e64 v51, -v51, v49
    v_cvt_f32_i32 v242, v242
    v_cvt_f32_i32 v243, v243
    v_fma_f32 v242, v242, v48, v50
    v_fma_f32 v243, v243, v49, v51
    v_cvt_pk_bf16_f32 v227, v242, v243
    v_cvt_f32_i32 v246, v246
    v_cvt_f32_i32 v247, v247
    v_fma_f32 v246, v246, v48, v50
    v_fma_f32 v247, v247, v49, v51
    v_cvt_pk_bf16_f32 v231, v246, v247
    v_cvt_f32_i32 v250, v250
    v_cvt_f32_i32 v251, v251
    v_fma_f32 v250, v250, v48, v50
    v_fma_f32 v251, v251, v49, v51
    v_cvt_pk_bf16_f32 v235, v250, v251
    v_cvt_f32_i32 v254, v254
    v_cvt_f32_i32 v255, v255
    v_fma_f32 v254, v254, v48, v50
    v_fma_f32 v255, v255, v49, v51
    v_cvt_pk_bf16_f32 v239, v254, v255
    buffer_store_dwordx4 v[224:227], v11, s[4:7], s33 offen offset:0
    s_mov_b64 exec, s[62:63]
    ds_write_b128 v11, v[224:227] offset:0
    s_mov_b64 exec, -1
    v_xor_b32 v55, 16, v11
    buffer_store_dwordx4 v[228:231], v55, s[4:7], s33 offen offset:768
    s_mov_b64 exec, s[62:63]
    ds_write_b128 v55, v[228:231] offset:768
    s_mov_b64 exec, -1
    v_xor_b32 v54, 32, v11
    buffer_store_dwordx4 v[232:235], v54, s[4:7], s33 offen offset:1536
    s_mov_b64 exec, s[62:63]
    ds_write_b128 v54, v[232:235] offset:1536
    s_mov_b64 exec, -1
    v_xor_b32 v55, 48, v11
    buffer_store_dwordx4 v[236:239], v55, s[4:7], s33 offen offset:2304
    s_mov_b64 exec, s[62:63]
    ds_write_b128 v55, v[236:239] offset:2304
    s_mov_b64 exec, -1
    s_mov_b32 s41, 0
    s_add_u32 m0, s40, 24576
    s_nop 0
    buffer_load_dwordx4 v136, s[8:11], s41 offen nt lds
    s_add_u32 m0, s40, 25600
    s_nop 0
    buffer_load_dwordx4 v137, s[8:11], s41 offen nt lds
    s_add_u32 m0, s40, 26624
    s_nop 0
    buffer_load_dwordx4 v138, s[8:11], s41 offen nt lds
    s_add_u32 m0, s40, 27648
    s_nop 0
    buffer_load_dwordx4 v139, s[8:11], s41 offen nt lds
    s_add_u32 m0, s40, 28672
    s_nop 0
    buffer_load_dwordx4 v140, s[8:11], s41 offen nt lds
    s_add_u32 m0, s40, 29696
    s_waitcnt vmcnt(20)
    buffer_load_dwordx4 v141, s[8:11], s41 offen nt lds
    s_waitcnt vmcnt(14)
    v_lshlrev_b32 v48, 16, v40
    v_and_b32 v49, s97, v40
    v_lshlrev_b32 v50, 16, v42
    v_and_b32 v51, s97, v42
    v_mul_f32_e64 v50, -v50, v48
    v_mul_f32_e64 v51, -v51, v49
    v_cvt_f32_i32 v112, v112
    v_cvt_f32_i32 v116, v116
    v_fma_f32 v112, v112, v48, v50
    v_fma_f32 v116, v116, v49, v51
    v_cvt_f32_i32 v113, v113
    v_cvt_f32_i32 v117, v117
    v_fma_f32 v113, v113, v48, v50
    v_fma_f32 v117, v117, v49, v51
    v_cvt_f32_i32 v114, v114
    v_cvt_f32_i32 v118, v118
    v_fma_f32 v114, v114, v48, v50
    v_fma_f32 v118, v118, v49, v51
    v_cvt_f32_i32 v115, v115
    v_cvt_f32_i32 v119, v119
    v_fma_f32 v115, v115, v48, v50
    v_fma_f32 v119, v119, v49, v51
    v_lshlrev_b32 v48, 16, v41
    v_and_b32 v49, s97, v41
    v_lshlrev_b32 v50, 16, v43
    v_and_b32 v51, s97, v43
    v_mul_f32_e64 v50, -v50, v48
    v_mul_f32_e64 v51, -v51, v49
    v_cvt_f32_i32 v120, v120
    v_cvt_f32_i32 v124, v124
    v_fma_f32 v120, v120, v48, v50
    v_fma_f32 v124, v124, v49, v51
    v_cvt_f32_i32 v121, v121
    v_cvt_f32_i32 v125, v125
    v_fma_f32 v121, v121, v48, v50
    v_fma_f32 v125, v125, v49, v51
    v_cvt_f32_i32 v122, v122
    v_cvt_f32_i32 v126, v126
    v_fma_f32 v122, v122, v48, v50
    v_fma_f32 v126, v126, v49, v51
    v_cvt_f32_i32 v123, v123
    v_cvt_f32_i32 v127, v127
    v_fma_f32 v123, v123, v48, v50
    v_fma_f32 v127, v127, v49, v51
    v_cvt_pk_bf16_f32 v112, v112, v116
    v_cvt_pk_bf16_f32 v116, v113, v117
    v_cvt_pk_bf16_f32 v113, v120, v124
    v_cvt_pk_bf16_f32 v117, v121, v125
    v_cvt_pk_bf16_f32 v120, v114, v118
    v_cvt_pk_bf16_f32 v121, v122, v126
    v_cvt_pk_bf16_f32 v124, v115, v119
    v_cvt_pk_bf16_f32 v125, v123, v127
    s_waitcnt vmcnt(10)
    v_lshlrev_b32 v48, 16, v44
    v_and_b32 v49, s97, v44
    v_lshlrev_b32 v50, 16, v46
    v_and_b32 v51, s97, v46
    v_mul_f32_e64 v50, -v50, v48
    v_mul_f32_e64 v51, -v51, v49
    v_cvt_f32_i32 v80, v80
    v_cvt_f32_i32 v84, v84
    v_fma_f32 v80, v80, v48, v50
    v_fma_f32 v84, v84, v49, v51
    v_cvt_f32_i32 v81, v81
    v_cvt_f32_i32 v85, v85
    v_fma_f32 v81, v81, v48, v50
    v_fma_f32 v85, v85, v49, v51
    v_cvt_f32_i32 v82, v82
    v_cvt_f32_i32 v86, v86
    v_fma_f32 v82, v82, v48, v50
    v_fma_f32 v86, v86, v49, v51
    v_cvt_f32_i32 v83, v83
    v_cvt_f32_i32 v87, v87
    v_fma_f32 v83, v83, v48, v50
    v_fma_f32 v87, v87, v49, v51
    v_lshlrev_b32 v48, 16, v45
    v_and_b32 v49, s97, v45
    v_lshlrev_b32 v50, 16, v47
    v_and_b32 v51, s97, v47
    v_mul_f32_e64 v50, -v50, v48
    v_mul_f32_e64 v51, -v51, v49
    v_cvt_f32_i32 v88, v88
    v_cvt_f32_i32 v92, v92
    v_fma_f32 v88, v88, v48, v50
    v_fma_f32 v92, v92, v49, v51
    v_cvt_f32_i32 v89, v89
    v_cvt_f32_i32 v93, v93
    v_fma_f32 v89, v89, v48, v50
    v_fma_f32 v93, v93, v49, v51
    v_cvt_f32_i32 v90, v90
    v_cvt_f32_i32 v94, v94
    v_fma_f32 v90, v90, v48, v50
    v_fma_f32 v94, v94, v49, v51
    v_cvt_f32_i32 v91, v91
    v_cvt_f32_i32 v95, v95
    v_fma_f32 v91, v91, v48, v50
    v_fma_f32 v95, v95, v49, v51
    v_cvt_pk_bf16_f32 v114, v80, v84
    v_cvt_pk_bf16_f32 v118, v81, v85
    v_cvt_pk_bf16_f32 v115, v88, v92
    v_cvt_pk_bf16_f32 v119, v89, v93
    v_cvt_pk_bf16_f32 v122, v82, v86
    v_cvt_pk_bf16_f32 v123, v90, v94
    v_cvt_pk_bf16_f32 v126, v83, v87
    v_cvt_pk_bf16_f32 v127, v91, v95
    buffer_store_dwordx4 v[112:115], v15, s[4:7], s35 offen offset:0
    buffer_store_dwordx4 v[116:119], v15, s[4:7], s35 offen offset:3072
    buffer_store_dwordx4 v[120:123], v15, s[4:7], s17 offen offset:0
    buffer_store_dwordx4 v[124:127], v15, s[4:7], s17 offen offset:3072
    s_mov_b64 exec, s[62:63]
    ds_write_b128 v15, v[112:115] offset:12288
    ds_write_b128 v15, v[116:119] offset:15360
    ds_write_b128 v15, v[120:123] offset:18432
    ds_write_b128 v15, v[124:127] offset:21504
    s_mov_b64 exec, -1
    buffer_load_dword v0, off, s[88:91], s93 sc1
    s_mov_b32 s41, 6144
    s_add_u32 m0, s40, 0
    s_nop 0
    buffer_load_dwordx4 v136, s[8:11], s41 offen nt lds
    s_add_u32 m0, s40, 1024
    s_nop 0
    buffer_load_dwordx4 v137, s[8:11], s41 offen nt lds
    s_add_u32 m0, s40, 2048
    s_nop 0
    buffer_load_dwordx4 v138, s[8:11], s41 offen nt lds
    s_add_u32 m0, s40, 3072
    s_nop 0
    buffer_load_dwordx4 v139, s[8:11], s41 offen nt lds
    s_add_u32 m0, s40, 4096
    s_nop 0
    buffer_load_dwordx4 v140, s[8:11], s41 offen nt lds
    s_add_u32 m0, s40, 5120
    s_waitcnt vmcnt(15)
    buffer_load_dwordx4 v141, s[8:11], s41 offen nt lds
    s_waitcnt vmcnt(6)
    s_cmp_lg_u32 s25, 0
    s_cbranch_scc1 L_tagdone
    v_readfirstlane_b32 s42, v0
    s_mov_b32 s39, 100
    s_waitcnt lgkmcnt(0)
    s_and_b32 s46, s46, 0xfffffc00
L_tagretry:
    s_cmp_eq_u32 s42, s46
    s_cselect_b32 s42, 0, s42
    s_cmp_lg_u32 s42, 0
    s_cbranch_scc1 L_tagok
    s_sub_u32 s39, s39, 1
    s_cbranch_scc1 L_tagslow
    s_sleep 4
    s_buffer_load_dword s42, s[88:91], s93 glc
    s_waitcnt lgkmcnt(0)
    s_branch L_tagretry
L_tagok:
    s_add_u32 s42, s42, s45
    v_mov_b32 v0, s42
    v_mov_b32 v16, 147456
    ds_write_b32 v16, v0
L_tagdone:
    s_waitcnt lgkmcnt(0)
    s_barrier
    v_add_u32 v0, 1, v0
    buffer_store_dword v0, v13, s[20:23], 0 offen offset:32 sc1
    v_mov_b32 v16, 147456
    ds_read_b32 v17, v16
    s_mov_b32 s88, s60
    s_mov_b32 s89, s61
    s_mov_b32 s90, L_slow-standalone__kv_cache_quant_int4_int2_kv_with_per_channel_or_per_token_scales__prompt_kernel
    s_lshr_b32 s24, s2, 3
    s_mul_i32 s93, s24, 43
    s_lshr_b32 s93, s93, 7
    s_mul_i32 s39, s93, 3
    s_sub_u32 s24, s24, s39
    s_lshl_b32 s24, s24, 10
    s_mul_i32 s93, s93, 12288
    s_add_u32 s93, s93, s24
    ds_read_b128 v[144:147], v2 offset:0
    ds_read_b128 v[148:151], v3 offset:0
    ds_read_b128 v[152:155], v2 offset:6144
    ds_read_b128 v[156:159], v3 offset:6144
    ds_read_b128 v[160:163], v2 offset:128
    ds_read_b128 v[164:167], v3 offset:128
    ds_read_b128 v[168:171], v2 offset:6272
    ds_read_b128 v[172:175], v3 offset:6272
    ds_read_b128 v[176:179], v2 offset:256
    ds_read_b128 v[180:183], v3 offset:256
    ds_read_b128 v[184:187], v2 offset:6400
    ds_read_b128 v[188:191], v3 offset:6400
    s_waitcnt vmcnt(12)
    ds_read_b64 a[192:193], v22 offset:24576
    ds_read_b64 a[194:195], v142 offset:24704
    ds_read_b64 a[196:197], v23 offset:24576
    ds_read_b64 a[198:199], v143 offset:24704
    ds_read_b64 a[200:201], v142 offset:24576
    ds_read_b64 a[202:203], v22 offset:24832
    ds_read_b64 a[204:205], v143 offset:24576
    ds_read_b64 a[206:207], v23 offset:24832
    ds_read_b64 a[208:209], v22 offset:24704
    ds_read_b64 a[210:211], v142 offset:24832
    ds_read_b64 a[212:213], v23 offset:24704
    ds_read_b64 a[214:215], v143 offset:24832
    s_waitcnt lgkmcnt(15)
    v_readfirstlane_b32 s92, v17
    s_add_u32 s92, s92, 1
    s_mov_b32 s41, 12288
    s_add_u32 m0, s40, 49152
    s_nop 0
    buffer_load_dwordx4 v136, s[8:11], s41 offen nt lds
    s_add_u32 m0, s40, 50176
    s_nop 0
    buffer_load_dwordx4 v137, s[8:11], s41 offen nt lds
    s_add_u32 m0, s40, 51200
    s_nop 0
    buffer_load_dwordx4 v138, s[8:11], s41 offen nt lds
    s_waitcnt lgkmcnt(0)
    v_mfma_f32_16x16x32_bf16 v[64:67], v[144:147], a[192:195], 0
    v_mfma_f32_16x16x32_bf16 v[64:67], v[148:151], a[196:199], v[64:67]
    v_mfma_f32_16x16x32_bf16 v[64:67], v[160:163], a[200:203], v[64:67]
    v_mfma_f32_16x16x32_bf16 v[64:67], v[164:167], a[204:207], v[64:67]
    v_mfma_f32_16x16x32_bf16 v[64:67], v[176:179], a[208:211], v[64:67]
    v_mfma_f32_16x16x32_bf16 v[64:67], v[180:183], a[212:215], v[64:67]
    v_mfma_f32_16x16x32_bf16 v[96:99], v[152:155], a[192:195], 0
    v_mfma_f32_16x16x32_bf16 v[96:99], v[156:159], a[196:199], v[96:99]
    v_mfma_f32_16x16x32_bf16 v[96:99], v[168:171], a[200:203], v[96:99]
    v_mfma_f32_16x16x32_bf16 v[96:99], v[172:175], a[204:207], v[96:99]
    v_mfma_f32_16x16x32_bf16 v[96:99], v[184:187], a[208:211], v[96:99]
    v_mfma_f32_16x16x32_bf16 v[96:99], v[188:191], a[212:215], v[96:99]
    s_nop 7
    v_max3_f32 v48, v64, v65, v66
    v_max3_f32 v50, v67, v96, v97
    v_max3_f32 v48, v48, v98, v99
    v_max_f32 v48, v48, v50
    v_mov_b32 v49, v48
    s_nop 1
    v_permlane16_swap_b32 v48, v49
    s_nop 1
    v_max_f32 v48, v48, v49
    v_mov_b32 v49, v48
    s_nop 1
    v_permlane32_swap_b32 v48, v49
    s_nop 1
    v_max_f32 v48, v48, v49
    v_sub_f32 v64, v64, v48
    v_sub_f32 v65, v65, v48
    v_sub_f32 v66, v66, v48
    v_sub_f32 v67, v67, v48
    v_sub_f32 v96, v96, v48
    v_sub_f32 v97, v97, v48
    v_sub_f32 v98, v98, v48
    v_sub_f32 v99, v99, v48
    v_exp_f32 v64, v64
    v_exp_f32 v65, v65
    v_exp_f32 v66, v66
    v_exp_f32 v67, v67
    v_exp_f32 v96, v96
    v_exp_f32 v97, v97
    v_exp_f32 v98, v98
    v_exp_f32 v99, v99
    v_sub_f32 v128, 0, v48
    v_sub_f32 v129, 0, v48
    v_sub_f32 v130, 0, v48
    v_sub_f32 v131, 0, v48
    v_add_f32 v5, v5, v64
    v_add_f32 v5, v5, v65
    v_add_f32 v5, v5, v66
    v_add_f32 v5, v5, v67
    v_add_f32 v5, v5, v96
    v_add_f32 v5, v5, v97
    v_add_f32 v5, v5, v98
    v_add_f32 v5, v5, v99
    v_cvt_pk_bf16_f32 v64, v64, v65
    v_cvt_pk_bf16_f32 v65, v66, v67
    v_cvt_pk_bf16_f32 v66, v96, v97
    v_cvt_pk_bf16_f32 v67, v98, v99
    s_waitcnt vmcnt(4)
    ds_read_b64 a[216:217], v22 offset:0
    ds_read_b64 a[218:219], v142 offset:128
    ds_read_b64 a[220:221], v23 offset:0
    ds_read_b64 a[222:223], v143 offset:128
    ds_read_b64 a[224:225], v142 offset:0
    ds_read_b64 a[226:227], v22 offset:256
    ds_read_b64 a[228:229], v143 offset:0
    ds_read_b64 a[230:231], v23 offset:256
    ds_read_b64 a[232:233], v22 offset:128
    ds_read_b64 a[234:235], v142 offset:256
    ds_read_b64 a[236:237], v23 offset:128
    ds_read_b64 a[238:239], v143 offset:256
    s_mov_b32 s41, 12288
    s_add_u32 m0, s40, 52224
    s_nop 0
    buffer_load_dwordx4 v139, s[8:11], s41 offen nt lds
    s_add_u32 m0, s40, 53248
    s_nop 0
    buffer_load_dwordx4 v140, s[8:11], s41 offen nt lds
    s_add_u32 m0, s40, 54272
    s_nop 0
    buffer_load_dwordx4 v141, s[8:11], s41 offen nt lds
    s_waitcnt lgkmcnt(0)
    v_mfma_f32_16x16x32_bf16 v[68:71], v[144:147], a[216:219], 0
    v_mfma_f32_16x16x32_bf16 v[68:71], v[148:151], a[220:223], v[68:71]
    v_mfma_f32_16x16x32_bf16 v[68:71], v[160:163], a[224:227], v[68:71]
    v_mfma_f32_16x16x32_bf16 v[68:71], v[164:167], a[228:231], v[68:71]
    v_mfma_f32_16x16x32_bf16 v[68:71], v[176:179], a[232:235], v[68:71]
    v_mfma_f32_16x16x32_bf16 v[68:71], v[180:183], a[236:239], v[68:71]
    v_mfma_f32_16x16x32_bf16 v[100:103], v[152:155], a[216:219], 0
    v_mfma_f32_16x16x32_bf16 v[100:103], v[156:159], a[220:223], v[100:103]
    v_mfma_f32_16x16x32_bf16 v[100:103], v[168:171], a[224:227], v[100:103]
    v_mfma_f32_16x16x32_bf16 v[100:103], v[172:175], a[228:231], v[100:103]
    v_mfma_f32_16x16x32_bf16 v[100:103], v[184:187], a[232:235], v[100:103]
    v_mfma_f32_16x16x32_bf16 v[100:103], v[188:191], a[236:239], v[100:103]
    s_nop 7
    ds_read_b128 v[24:27], v1 offset:0
    ds_read_b128 v[28:31], v1 offset:1024
    ds_read_b128 v[32:35], v1 offset:2048
    ds_read_b128 v[36:39], v1 offset:3072
    s_mov_b32 s41, 18432
    s_add_u32 m0, s40, 24576
    s_nop 0
    buffer_load_dwordx4 v136, s[8:11], s41 offen nt lds
    v_max3_f32 v48, v68, v69, v70
    v_max3_f32 v50, v71, v100, v101
    v_max3_f32 v48, v48, v102, v103
    v_max_f32 v48, v48, v50
    v_mov_b32 v49, v48
    s_nop 1
    v_permlane16_swap_b32 v48, v49
    s_nop 1
    v_max_f32 v48, v48, v49
    v_mov_b32 v49, v48
    s_nop 1
    v_permlane32_swap_b32 v48, v49
    s_nop 1
    v_max_f32 v48, v48, v49
    v_sub_f32 v68, v68, v48
    v_sub_f32 v69, v69, v48
    s_add_u32 m0, s40, 25600
    s_nop 0
    buffer_load_dwordx4 v137, s[8:11], s41 offen nt lds
    v_sub_f32 v70, v70, v48
    v_sub_f32 v71, v71, v48
    v_sub_f32 v100, v100, v48
    v_sub_f32 v101, v101, v48
    v_sub_f32 v102, v102, v48
    v_sub_f32 v103, v103, v48
    v_exp_f32 v68, v68
    v_exp_f32 v69, v69
    v_exp_f32 v70, v70
    v_exp_f32 v71, v71
    v_exp_f32 v100, v100
    v_exp_f32 v101, v101
    v_exp_f32 v102, v102
    v_exp_f32 v103, v103
    v_sub_f32 v132, 0, v48
    s_add_u32 m0, s40, 26624
    s_nop 0
    buffer_load_dwordx4 v138, s[8:11], s41 offen nt lds
    v_sub_f32 v133, 0, v48
    v_sub_f32 v134, 0, v48
    v_sub_f32 v135, 0, v48
    v_add_f32 v6, v6, v68
    v_add_f32 v6, v6, v69
    v_add_f32 v6, v6, v70
    v_add_f32 v6, v6, v71
    v_add_f32 v6, v6, v100
    v_add_f32 v6, v6, v101
    v_add_f32 v6, v6, v102
    v_add_f32 v6, v6, v103
    v_cvt_pk_bf16_f32 v68, v68, v69
    v_cvt_pk_bf16_f32 v69, v70, v71
    v_cvt_pk_bf16_f32 v70, v100, v101
    v_cvt_pk_bf16_f32 v71, v102, v103
    s_buffer_load_dwordx8 s[48:55], s[20:23], s44 glc
    s_waitcnt lgkmcnt(2)
    v_mfma_f32_16x16x32_bf16 a[0:3], v[64:67], v[24:27], 0
    ds_read_b128 v[40:43], v1 offset:4096
    v_mfma_f32_16x16x32_bf16 a[4:7], v[64:67], v[28:31], 0
    v_mfma_f32_16x16x32_bf16 a[48:51], v[68:71], v[24:27], 0
    ds_read_b128 v[44:47], v1 offset:5120
    v_mfma_f32_16x16x32_bf16 a[52:55], v[68:71], v[28:31], 0
    s_waitcnt lgkmcnt(2)
    v_mfma_f32_16x16x32_bf16 a[8:11], v[64:67], v[32:35], 0
    ds_read_b128 v[24:27], v1 offset:6144
    v_mfma_f32_16x16x32_bf16 a[12:15], v[64:67], v[36:39], 0
    v_mfma_f32_16x16x32_bf16 a[56:59], v[68:71], v[32:35], 0
    ds_read_b128 v[28:31], v1 offset:7168
    v_mfma_f32_16x16x32_bf16 a[60:63], v[68:71], v[36:39], 0
    s_waitcnt lgkmcnt(2)
    v_mfma_f32_16x16x32_bf16 a[16:19], v[64:67], v[40:43], 0
    ds_read_b128 v[32:35], v1 offset:8192
    v_mfma_f32_16x16x32_bf16 a[20:23], v[64:67], v[44:47], 0
    v_mfma_f32_16x16x32_bf16 a[64:67], v[68:71], v[40:43], 0
    ds_read_b128 v[36:39], v1 offset:9216
    v_mfma_f32_16x16x32_bf16 a[68:71], v[68:71], v[44:47], 0
    s_waitcnt lgkmcnt(2)
    v_mfma_f32_16x16x32_bf16 a[24:27], v[64:67], v[24:27], 0
    ds_read_b128 v[40:43], v1 offset:10240
    v_mfma_f32_16x16x32_bf16 a[28:31], v[64:67], v[28:31], 0
    v_mfma_f32_16x16x32_bf16 a[72:75], v[68:71], v[24:27], 0
    ds_read_b128 v[44:47], v1 offset:11264
    v_mfma_f32_16x16x32_bf16 a[76:79], v[68:71], v[28:31], 0
    s_waitcnt lgkmcnt(2)
    v_mfma_f32_16x16x32_bf16 a[32:35], v[64:67], v[32:35], 0
    v_mfma_f32_16x16x32_bf16 a[36:39], v[64:67], v[36:39], 0
    v_mfma_f32_16x16x32_bf16 a[80:83], v[68:71], v[32:35], 0
    v_mfma_f32_16x16x32_bf16 a[84:87], v[68:71], v[36:39], 0
    s_waitcnt lgkmcnt(0)
    v_mfma_f32_16x16x32_bf16 a[40:43], v[64:67], v[40:43], 0
    v_mfma_f32_16x16x32_bf16 a[44:47], v[64:67], v[44:47], 0
    v_mfma_f32_16x16x32_bf16 a[88:91], v[68:71], v[40:43], 0
    v_mfma_f32_16x16x32_bf16 a[92:95], v[68:71], v[44:47], 0
    s_waitcnt lgkmcnt(0)
    s_sub_u32 s48, s48, s92
    s_sub_u32 s49, s49, s92
    s_sub_u32 s50, s50, s92
    s_sub_u32 s51, s51, s92
    s_sub_u32 s52, s52, s92
    s_sub_u32 s53, s53, s92
    s_sub_u32 s54, s54, s92
    s_sub_u32 s55, s55, s92
    s_max_u32 s48, s48, s49
    s_max_u32 s48, s48, s50
    s_max_u32 s48, s48, s51
    s_max_u32 s48, s48, s52
    s_max_u32 s48, s48, s53
    s_max_u32 s48, s48, s54
    s_max_u32 s48, s48, s55
    s_cmp_ge_u32 s48, 16
    s_cbranch_scc1 L_pollslow0
L_pollok0:
    s_add_u32 s92, s92, 1
    s_mov_b32 m0, s26
    s_nop 0
    buffer_load_dwordx4 v4, s[4:7], s32 offen offset:0 sc1 lds
    buffer_load_dwordx4 v4, s[4:7], s32 offen offset:1024 sc1 lds
    buffer_load_dwordx4 v4, s[4:7], s32 offen offset:2048 sc1 lds
    s_add_u32 s32, s32, 24576
    s_sub_u32 s57, s32, 196608
    s_min_u32 s32, s32, s57
    s_add_u32 s26, s26, 36864
    s_sub_u32 s57, s26, 147456
    s_min_u32 s26, s26, s57
    s_mov_b32 m0, s26
    s_waitcnt vmcnt(11)
    buffer_load_dwordx4 v4, s[4:7], s32 offen offset:0 sc1 lds
    s_waitcnt vmcnt(11)
    buffer_load_dwordx4 v4, s[4:7], s32 offen offset:1024 sc1 lds
    s_waitcnt vmcnt(11)
    buffer_load_dwordx4 v4, s[4:7], s32 offen offset:2048 sc1 lds
    s_add_u32 s32, s32, 24576
    s_sub_u32 s57, s32, 196608
    s_min_u32 s32, s32, s57
    s_add_u32 s26, s26, 12288
    s_mov_b32 m0, s26
    s_waitcnt vmcnt(11)
    buffer_load_dwordx4 v4, s[4:7], s32 offen offset:0 sc1 lds
    s_waitcnt vmcnt(11)
    buffer_load_dwordx4 v4, s[4:7], s32 offen offset:1024 sc1 lds
    s_waitcnt vmcnt(11)
    buffer_load_dwordx4 v4, s[4:7], s32 offen offset:2048 sc1 lds
    s_add_u32 s32, s32, 24576
    s_sub_u32 s57, s32, 196608
    s_min_u32 s32, s32, s57
    s_add_u32 s26, s26, 36864
    s_sub_u32 s57, s26, 147456
    s_min_u32 s26, s26, s57
    s_mov_b32 m0, s56
    s_waitcnt vmcnt(11)
    buffer_load_dwordx4 v4, s[4:7], s27 offen offset:0 sc1 lds
    s_waitcnt vmcnt(11)
    buffer_load_dwordx4 v4, s[4:7], s27 offen offset:1024 sc1 lds
    s_waitcnt vmcnt(11)
    buffer_load_dwordx4 v4, s[4:7], s27 offen offset:2048 sc1 lds
    s_add_u32 s27, s27, 24576
    s_sub_u32 s58, s27, 196608
    s_min_u32 s27, s27, s58
    s_add_u32 s56, s56, 36864
    s_sub_u32 s58, s56, 147456
    s_min_u32 s56, s56, s58
    s_add_u32 s33, s33, 196608
    s_add_u32 s34, s34, 196608
    s_add_u32 s36, s36, 1536
    s_add_u32 s35, s35, 196608
    s_add_u32 s16, s16, 196608
    s_add_u32 s17, s17, 196608
    s_add_u32 s37, s37, 512
    s_waitcnt vmcnt(9)
    s_barrier
    ds_read_b128 v[24:27], v2 offset:12288
    ds_read_b128 v[28:31], v3 offset:12288
    ds_read_b128 v[32:35], v2 offset:18432
    ds_read_b128 v[36:39], v3 offset:18432
    s_waitcnt lgkmcnt(2)
    v_mfma_f32_16x16x32_bf16 v[72:75], v[24:27], a[192:195], v[128:131]
    s_mov_b32 m0, s56
    ds_read_b128 v[40:43], v2 offset:12416
    v_mfma_f32_16x16x32_bf16 v[72:75], v[28:31], a[196:199], v[72:75]
    buffer_load_dwordx4 v4, s[4:7], s27 offen offset:0 sc1 lds
    v_mfma_f32_16x16x32_bf16 v[76:79], v[24:27], a[216:219], v[132:135]
    ds_read_b128 v[44:47], v3 offset:12416
    v_mfma_f32_16x16x32_bf16 v[76:79], v[28:31], a[220:223], v[76:79]
    s_waitcnt lgkmcnt(2)
    buffer_load_dwordx4 v4, s[4:7], s27 offen offset:1024 sc1 lds
    v_mfma_f32_16x16x32_bf16 v[104:107], v[32:35], a[192:195], v[128:131]
    ds_read_b128 v[24:27], v2 offset:18560
    v_mfma_f32_16x16x32_bf16 v[104:107], v[36:39], a[196:199], v[104:107]
    buffer_load_dwordx4 v4, s[4:7], s27 offen offset:2048 sc1 lds
    v_mfma_f32_16x16x32_bf16 v[108:111], v[32:35], a[216:219], v[132:135]
    s_add_u32 s27, s27, 24576
    ds_read_b128 v[28:31], v3 offset:18560
    v_mfma_f32_16x16x32_bf16 v[108:111], v[36:39], a[220:223], v[108:111]
    s_waitcnt lgkmcnt(2)
    s_sub_u32 s58, s27, 196608
    v_mfma_f32_16x16x32_bf16 v[72:75], v[40:43], a[200:203], v[72:75]
    ds_read_b128 v[32:35], v2 offset:12544
    v_mfma_f32_16x16x32_bf16 v[72:75], v[44:47], a[204:207], v[72:75]
    s_min_u32 s27, s27, s58
    v_mfma_f32_16x16x32_bf16 v[76:79], v[40:43], a[224:227], v[76:79]
    s_add_u32 s56, s56, 12288
    ds_read_b128 v[36:39], v3 offset:12544
    v_mfma_f32_16x16x32_bf16 v[76:79], v[44:47], a[228:231], v[76:79]
    s_waitcnt lgkmcnt(2)
    s_mov_b32 m0, s56
    v_mfma_f32_16x16x32_bf16 v[104:107], v[24:27], a[200:203], v[104:107]
    ds_read_b128 v[40:43], v2 offset:18688
    v_mfma_f32_16x16x32_bf16 v[104:107], v[28:31], a[204:207], v[104:107]
    s_waitcnt vmcnt(6)
    buffer_load_dwordx4 v4, s[4:7], s27 offen offset:0 sc1 lds
    v_mfma_f32_16x16x32_bf16 v[108:111], v[24:27], a[224:227], v[108:111]
    ds_read_b128 v[44:47], v3 offset:18688
    v_mfma_f32_16x16x32_bf16 v[108:111], v[28:31], a[228:231], v[108:111]
    s_waitcnt lgkmcnt(2)
    s_barrier
    v_add_u32 v2, 49152, v2
    v_add_u32 v3, 49152, v3
    v_mfma_f32_16x16x32_bf16 v[72:75], v[32:35], a[208:211], v[72:75]
    ds_read_b128 v[24:27], v2 offset:0
    v_mfma_f32_16x16x32_bf16 v[72:75], v[36:39], a[212:215], v[72:75]
    buffer_load_dwordx4 v4, s[4:7], s27 offen offset:1024 sc1 lds
    v_mfma_f32_16x16x32_bf16 v[76:79], v[32:35], a[232:235], v[76:79]
    ds_read_b128 v[28:31], v3 offset:0
    v_mfma_f32_16x16x32_bf16 v[76:79], v[36:39], a[236:239], v[76:79]
    s_waitcnt lgkmcnt(2)
    buffer_load_dwordx4 v4, s[4:7], s27 offen offset:2048 sc1 lds
    v_mfma_f32_16x16x32_bf16 v[104:107], v[40:43], a[208:211], v[104:107]
    ds_read_b128 v[32:35], v2 offset:6144
    v_mfma_f32_16x16x32_bf16 v[104:107], v[44:47], a[212:215], v[104:107]
    v_mfma_f32_16x16x32_bf16 v[108:111], v[40:43], a[232:235], v[108:111]
    s_add_u32 s27, s27, 24576
    ds_read_b128 v[36:39], v3 offset:6144
    s_sub_u32 s58, s27, 196608
    v_mfma_f32_16x16x32_bf16 v[108:111], v[44:47], a[236:239], v[108:111]
    s_waitcnt lgkmcnt(2)
    s_min_u32 s27, s27, s58
    s_add_u32 s56, s56, 36864
    s_sub_u32 s58, s56, 147456
    s_min_u32 s56, s56, s58
    v_mfma_f32_16x16x32_bf16 v[80:83], v[24:27], a[192:195], v[128:131]
    s_mov_b32 s41, 18432
    ds_read_b128 v[40:43], v2 offset:128
    s_add_u32 m0, s40, 27648
    v_mfma_f32_16x16x32_bf16 v[80:83], v[28:31], a[196:199], v[80:83]
    buffer_load_dwordx4 v139, s[8:11], s41 offen nt lds
    v_mfma_f32_16x16x32_bf16 v[84:87], v[24:27], a[216:219], v[132:135]
    s_add_u32 m0, s40, 28672
    ds_read_b128 v[44:47], v3 offset:128
    v_mfma_f32_16x16x32_bf16 v[84:87], v[28:31], a[220:223], v[84:87]
    s_waitcnt lgkmcnt(2)
    buffer_load_dwordx4 v140, s[8:11], s41 offen nt lds
    s_add_u32 m0, s40, 29696
    v_mfma_f32_16x16x32_bf16 v[112:115], v[32:35], a[192:195], v[128:131]
    ds_read_b128 v[24:27], v2 offset:6272
    v_mfma_f32_16x16x32_bf16 v[112:115], v[36:39], a[196:199], v[112:115]
    buffer_load_dwordx4 v141, s[8:11], s41 offen nt lds
    v_mfma_f32_16x16x32_bf16 v[116:119], v[32:35], a[216:219], v[132:135]
    ds_read_b128 v[28:31], v3 offset:6272
    v_mfma_f32_16x16x32_bf16 v[116:119], v[36:39], a[220:223], v[116:119]
    s_waitcnt lgkmcnt(2)
    v_exp_f32 v16, v72
    v_mfma_f32_16x16x32_bf16 v[80:83], v[40:43], a[200:203], v[80:83]
    ds_read_b128 v[32:35], v2 offset:256
    v_mfma_f32_16x16x32_bf16 v[80:83], v[44:47], a[204:207], v[80:83]
    v_exp_f32 v17, v73
    v_exp_f32 v18, v74
    v_mfma_f32_16x16x32_bf16 v[84:87], v[40:43], a[224:227], v[84:87]
    ds_read_b128 v[36:39], v3 offset:256
    v_add_f32 v5, v5, v16
    v_mfma_f32_16x16x32_bf16 v[84:87], v[44:47], a[228:231], v[84:87]
    s_waitcnt lgkmcnt(2)
    v_add_f32 v5, v5, v17
    v_exp_f32 v19, v75
    v_mfma_f32_16x16x32_bf16 v[112:115], v[24:27], a[200:203], v[112:115]
    ds_read_b128 v[40:43], v2 offset:6400
    v_cvt_pk_bf16_f32 v72, v16, v17
    v_mfma_f32_16x16x32_bf16 v[112:115], v[28:31], a[204:207], v[112:115]
    v_exp_f32 v16, v104
    v_mfma_f32_16x16x32_bf16 v[116:119], v[24:27], a[224:227], v[116:119]
    ds_read_b128 v[44:47], v3 offset:6400
    v_add_f32 v5, v5, v18
    v_mfma_f32_16x16x32_bf16 v[116:119], v[28:31], a[228:231], v[116:119]
    s_waitcnt lgkmcnt(2)
    v_add_f32 v5, v5, v19
    v_exp_f32 v17, v105
    v_mfma_f32_16x16x32_bf16 v[80:83], v[32:35], a[208:211], v[80:83]
    ds_read_b128 v[24:27], v2 offset:12288
    v_cvt_pk_bf16_f32 v73, v18, v19
    v_mfma_f32_16x16x32_bf16 v[80:83], v[36:39], a[212:215], v[80:83]
    v_exp_f32 v18, v106
    v_mfma_f32_16x16x32_bf16 v[84:87], v[32:35], a[232:235], v[84:87]
    ds_read_b128 v[28:31], v3 offset:12288
    v_add_f32 v5, v5, v16
    v_mfma_f32_16x16x32_bf16 v[84:87], v[36:39], a[236:239], v[84:87]
    s_waitcnt lgkmcnt(2)
    v_add_f32 v5, v5, v17
    v_exp_f32 v19, v107
    v_mfma_f32_16x16x32_bf16 v[112:115], v[40:43], a[208:211], v[112:115]
    ds_read_b128 v[32:35], v2 offset:18432
    v_cvt_pk_bf16_f32 v74, v16, v17
    v_mfma_f32_16x16x32_bf16 v[112:115], v[44:47], a[212:215], v[112:115]
    v_exp_f32 v16, v76
    v_add_f32 v5, v5, v18
    v_mfma_f32_16x16x32_bf16 v[116:119], v[40:43], a[232:235], v[116:119]
    ds_read_b128 v[36:39], v3 offset:18432
    v_add_f32 v5, v5, v19
    v_mfma_f32_16x16x32_bf16 v[116:119], v[44:47], a[236:239], v[116:119]
    s_waitcnt lgkmcnt(2)
    v_exp_f32 v17, v77
    v_mfma_f32_16x16x32_bf16 v[88:91], v[24:27], a[192:195], v[128:131]
    ds_read_b128 v[40:43], v2 offset:12416
    v_cvt_pk_bf16_f32 v75, v18, v19
    v_mfma_f32_16x16x32_bf16 v[88:91], v[28:31], a[196:199], v[88:91]
    s_waitcnt vmcnt(11)
    buffer_load_dwordx2 v[56:57], v10, s[72:75], s36 offen offset:0
    v_mfma_f32_16x16x32_bf16 v[92:95], v[24:27], a[216:219], v[132:135]
    ds_read_b128 v[44:47], v3 offset:12416
    v_mfma_f32_16x16x32_bf16 v[92:95], v[28:31], a[220:223], v[92:95]
    s_waitcnt lgkmcnt(2)
    buffer_load_dwordx2 v[58:59], v10, s[76:79], s36 offen offset:0
    v_exp_f32 v18, v78
    v_mfma_f32_16x16x32_bf16 v[120:123], v[32:35], a[192:195], v[128:131]
    ds_read_b128 v[24:27], v2 offset:18560
    v_add_f32 v6, v6, v16
    v_mfma_f32_16x16x32_bf16 v[120:123], v[36:39], a[196:199], v[120:123]
    s_waitcnt vmcnt(12)
    buffer_load_dwordx4 v[224:227], v9, s[64:67], s33 offen offset:0 nt
    v_mfma_f32_16x16x32_bf16 v[124:127], v[32:35], a[216:219], v[132:135]
    ds_read_b128 v[28:31], v3 offset:18560
    v_add_f32 v6, v6, v17
    v_mfma_f32_16x16x32_bf16 v[124:127], v[36:39], a[220:223], v[124:127]
    s_waitcnt lgkmcnt(2)
    s_waitcnt vmcnt(12)
    buffer_load_dwordx4 v[228:231], v9, s[64:67], s33 offen offset:1536 nt
    v_mfma_f32_16x16x32_bf16 v[88:91], v[40:43], a[200:203], v[88:91]
    ds_read_b128 v[32:35], v2 offset:12544
    v_mfma_f32_16x16x32_bf16 v[88:91], v[44:47], a[204:207], v[88:91]
    buffer_load_dwordx4 v[232:235], v9, s[64:67], s34 offen offset:0 nt
    v_mfma_f32_16x16x32_bf16 v[92:95], v[40:43], a[224:227], v[92:95]
    ds_read_b128 v[36:39], v3 offset:12544
    v_mfma_f32_16x16x32_bf16 v[92:95], v[44:47], a[228:231], v[92:95]
    s_waitcnt lgkmcnt(2)
    s_waitcnt vmcnt(13)
    buffer_load_dwordx4 v[236:239], v9, s[64:67], s34 offen offset:1536 nt
    v_exp_f32 v19, v79
    v_mfma_f32_16x16x32_bf16 v[120:123], v[24:27], a[200:203], v[120:123]
    ds_read_b128 v[40:43], v2 offset:18688
    v_cvt_pk_bf16_f32 v76, v16, v17
    v_mfma_f32_16x16x32_bf16 v[120:123], v[28:31], a[204:207], v[120:123]
    s_waitcnt vmcnt(9)
    v_exp_f32 v16, v108
    v_add_f32 v6, v6, v18
    v_mfma_f32_16x16x32_bf16 v[124:127], v[24:27], a[224:227], v[124:127]
    ds_read_b128 v[44:47], v3 offset:18688
    v_add_f32 v6, v6, v19
    v_mfma_f32_16x16x32_bf16 v[124:127], v[28:31], a[228:231], v[124:127]
    s_waitcnt lgkmcnt(2)
    s_barrier
    v_mfma_f32_16x16x32_bf16 v[88:91], v[32:35], a[208:211], v[88:91]
    ds_read_b128 v[24:27], v1 offset:12288
    v_mfma_f32_16x16x32_bf16 v[88:91], v[36:39], a[212:215], v[88:91]
    v_exp_f32 v17, v109
    v_cvt_pk_bf16_f32 v77, v18, v19
    v_mfma_f32_16x16x32_bf16 v[92:95], v[32:35], a[232:235], v[92:95]
    ds_read_b128 v[28:31], v1 offset:13312
    v_mfma_f32_16x16x32_bf16 v[92:95], v[36:39], a[236:239], v[92:95]
    s_waitcnt lgkmcnt(2)
    v_exp_f32 v18, v110
    v_add_f32 v6, v6, v16
    v_mfma_f32_16x16x32_bf16 v[120:123], v[40:43], a[208:211], v[120:123]
    ds_read_b128 v[32:35], v1 offset:14336
    v_add_f32 v6, v6, v17
    v_mfma_f32_16x16x32_bf16 v[120:123], v[44:47], a[212:215], v[120:123]
    v_exp_f32 v19, v111
    v_mfma_f32_16x16x32_bf16 v[124:127], v[40:43], a[232:235], v[124:127]
    ds_read_b128 v[36:39], v1 offset:15360
    v_cvt_pk_bf16_f32 v78, v16, v17
    v_mfma_f32_16x16x32_bf16 v[124:127], v[44:47], a[236:239], v[124:127]
    s_waitcnt lgkmcnt(2)
    v_add_f32 v6, v6, v18
    v_add_f32 v6, v6, v19
    v_cvt_pk_bf16_f32 v79, v18, v19
    v_mfma_f32_16x16x32_bf16 a[0:3], v[72:75], v[24:27], a[0:3]
    ds_read_b128 v[40:43], v1 offset:16384
    v_mfma_f32_16x16x32_bf16 a[4:7], v[72:75], v[28:31], a[4:7]
    buffer_load_dwordx2 v[60:61], v10, s[72:75], s36 offen offset:192
    v_exp_f32 v16, v80
    v_mfma_f32_16x16x32_bf16 a[48:51], v[76:79], v[24:27], a[48:51]
    ds_read_b128 v[44:47], v1 offset:17408
    v_mfma_f32_16x16x32_bf16 a[52:55], v[76:79], v[28:31], a[52:55]
    s_waitcnt lgkmcnt(2)
    buffer_load_dwordx2 v[62:63], v10, s[76:79], s36 offen offset:192
    v_exp_f32 v17, v81
    v_exp_f32 v18, v82
    v_mfma_f32_16x16x32_bf16 a[8:11], v[72:75], v[32:35], a[8:11]
    ds_read_b128 v[24:27], v1 offset:18432
    v_add_f32 v5, v5, v16
    v_mfma_f32_16x16x32_bf16 a[12:15], v[72:75], v[36:39], a[12:15]
    buffer_load_dwordx4 v[240:243], v9, s[64:67], s33 offen offset:384 nt
    v_add_f32 v5, v5, v17
    v_exp_f32 v19, v83
    v_mfma_f32_16x16x32_bf16 a[56:59], v[76:79], v[32:35], a[56:59]
    ds_read_b128 v[28:31], v1 offset:19456
    v_cvt_pk_bf16_f32 v80, v16, v17
    v_mfma_f32_16x16x32_bf16 a[60:63], v[76:79], v[36:39], a[60:63]
    s_waitcnt lgkmcnt(2)
    buffer_load_dwordx4 v[244:247], v9, s[64:67], s33 offen offset:1920 nt
    v_exp_f32 v16, v112
    v_add_f32 v5, v5, v18
    v_add_f32 v5, v5, v19
    v_mfma_f32_16x16x32_bf16 a[16:19], v[72:75], v[40:43], a[16:19]
    ds_read_b128 v[32:35], v1 offset:20480
    v_mfma_f32_16x16x32_bf16 a[20:23], v[72:75], v[44:47], a[20:23]
    buffer_load_dwordx4 v[248:251], v9, s[64:67], s34 offen offset:384 nt
    v_exp_f32 v17, v113
    v_cvt_pk_bf16_f32 v81, v18, v19
    v_mfma_f32_16x16x32_bf16 a[64:67], v[76:79], v[40:43], a[64:67]
    ds_read_b128 v[36:39], v1 offset:21504
    v_mfma_f32_16x16x32_bf16 a[68:71], v[76:79], v[44:47], a[68:71]
    s_waitcnt lgkmcnt(2)
    buffer_load_dwordx4 v[252:255], v9, s[64:67], s34 offen offset:1920 nt
    v_exp_f32 v18, v114
    v_add_f32 v5, v5, v16
    v_mfma_f32_16x16x32_bf16 a[24:27], v[72:75], v[24:27], a[24:27]
    ds_read_b128 v[40:43], v1 offset:22528
    v_add_f32 v5, v5, v17
    v_mfma_f32_16x16x32_bf16 a[28:31], v[72:75], v[28:31], a[28:31]
    v_exp_f32 v19, v115
    v_cvt_pk_bf16_f32 v82, v16, v17
    v_exp_f32 v16, v84
    v_mfma_f32_16x16x32_bf16 a[72:75], v[76:79], v[24:27], a[72:75]
    ds_read_b128 v[44:47], v1 offset:23552
    v_add_f32 v5, v5, v18
    v_mfma_f32_16x16x32_bf16 a[76:79], v[76:79], v[28:31], a[76:79]
    s_waitcnt lgkmcnt(2)
    v_add_u32 v1, 49152, v1
    v_add_f32 v5, v5, v19
    v_exp_f32 v17, v85
    v_cvt_pk_bf16_f32 v83, v18, v19
    v_mfma_f32_16x16x32_bf16 a[32:35], v[72:75], v[32:35], a[32:35]
    ds_read_b128 v[24:27], v1 offset:0
    v_mfma_f32_16x16x32_bf16 a[36:39], v[72:75], v[36:39], a[36:39]
    v_exp_f32 v18, v86
    v_add_f32 v6, v6, v16
    v_add_f32 v6, v6, v17
    v_exp_f32 v19, v87
    v_mfma_f32_16x16x32_bf16 a[80:83], v[76:79], v[32:35], a[80:83]
    ds_read_b128 v[28:31], v1 offset:1024
    v_cvt_pk_bf16_f32 v84, v16, v17
    v_mfma_f32_16x16x32_bf16 a[84:87], v[76:79], v[36:39], a[84:87]
    s_waitcnt lgkmcnt(2)
    v_exp_f32 v16, v116
    v_add_f32 v6, v6, v18
    v_add_f32 v6, v6, v19
    v_mfma_f32_16x16x32_bf16 a[40:43], v[72:75], v[40:43], a[40:43]
    ds_read_b128 v[32:35], v1 offset:2048
    v_mfma_f32_16x16x32_bf16 a[44:47], v[72:75], v[44:47], a[44:47]
    v_exp_f32 v17, v117
    v_cvt_pk_bf16_f32 v85, v18, v19
    v_exp_f32 v18, v118
    v_add_f32 v6, v6, v16
    v_mfma_f32_16x16x32_bf16 a[88:91], v[76:79], v[40:43], a[88:91]
    ds_read_b128 v[36:39], v1 offset:3072
    v_add_f32 v6, v6, v17
    v_mfma_f32_16x16x32_bf16 a[92:95], v[76:79], v[44:47], a[92:95]
    s_waitcnt lgkmcnt(2)
    v_exp_f32 v19, v119
    v_cvt_pk_bf16_f32 v86, v16, v17
    v_add_f32 v6, v6, v18
    v_add_f32 v6, v6, v19
    v_cvt_pk_bf16_f32 v87, v18, v19
    v_mfma_f32_16x16x32_bf16 a[0:3], v[80:83], v[24:27], a[0:3]
    ds_read_b128 v[40:43], v1 offset:4096
    v_mfma_f32_16x16x32_bf16 a[4:7], v[80:83], v[28:31], a[4:7]
    buffer_load_dwordx4 v[144:147], v12, s[68:71], s35 offen offset:0 nt
    v_exp_f32 v16, v88
    v_mfma_f32_16x16x32_bf16 a[48:51], v[84:87], v[24:27], a[48:51]
    ds_read_b128 v[44:47], v1 offset:5120
    v_mfma_f32_16x16x32_bf16 a[52:55], v[84:87], v[28:31], a[52:55]
    s_waitcnt lgkmcnt(2)
    buffer_load_dwordx4 v[148:151], v12, s[68:71], s35 offen offset:768 nt
    v_exp_f32 v17, v89
    v_mfma_f32_16x16x32_bf16 a[8:11], v[80:83], v[32:35], a[8:11]
    ds_read_b128 v[24:27], v1 offset:6144
    v_mfma_f32_16x16x32_bf16 a[12:15], v[80:83], v[36:39], a[12:15]
    s_waitcnt vmcnt(16)
    buffer_load_dwordx4 v[152:155], v12, s[68:71], s35 offen offset:1536 nt
    v_exp_f32 v18, v90
    v_mfma_f32_16x16x32_bf16 a[56:59], v[84:87], v[32:35], a[56:59]
    ds_read_b128 v[28:31], v1 offset:7168
    v_add_f32 v5, v5, v16
    v_mfma_f32_16x16x32_bf16 a[60:63], v[84:87], v[36:39], a[60:63]
    s_waitcnt lgkmcnt(2)
    s_waitcnt vmcnt(16)
    buffer_load_dwordx4 v[156:159], v12, s[68:71], s35 offen offset:2304 nt
    v_add_f32 v5, v5, v17
    v_mfma_f32_16x16x32_bf16 a[16:19], v[80:83], v[40:43], a[16:19]
    ds_read_b128 v[32:35], v1 offset:8192
    v_mfma_f32_16x16x32_bf16 a[20:23], v[80:83], v[44:47], a[20:23]
    v_exp_f32 v19, v91
    v_cvt_pk_bf16_f32 v88, v16, v17
    v_exp_f32 v16, v120
    v_mfma_f32_16x16x32_bf16 a[64:67], v[84:87], v[40:43], a[64:67]
    ds_read_b128 v[36:39], v1 offset:9216
    v_add_f32 v5, v5, v18
    v_mfma_f32_16x16x32_bf16 a[68:71], v[84:87], v[44:47], a[68:71]
    s_waitcnt lgkmcnt(2)
    v_add_f32 v5, v5, v19
    v_exp_f32 v17, v121
    v_cvt_pk_bf16_f32 v89, v18, v19
    v_mfma_f32_16x16x32_bf16 a[24:27], v[80:83], v[24:27], a[24:27]
    ds_read_b128 v[40:43], v1 offset:10240
    v_mfma_f32_16x16x32_bf16 a[28:31], v[80:83], v[28:31], a[28:31]
    v_exp_f32 v18, v122
    v_add_f32 v5, v5, v16
    v_add_f32 v5, v5, v17
    v_mfma_f32_16x16x32_bf16 a[72:75], v[84:87], v[24:27], a[72:75]
    ds_read_b128 v[44:47], v1 offset:11264
    v_mfma_f32_16x16x32_bf16 a[76:79], v[84:87], v[28:31], a[76:79]
    s_waitcnt lgkmcnt(2)
    v_exp_f32 v19, v123
    v_cvt_pk_bf16_f32 v90, v16, v17
    v_mfma_f32_16x16x32_bf16 a[32:35], v[80:83], v[32:35], a[32:35]
    s_waitcnt vmcnt(40)
    ds_read_b128 v[24:27], v1 offset:12288
    ds_read_b64 a[240:241], v22 offset:49152
    v_mfma_f32_16x16x32_bf16 a[36:39], v[80:83], v[36:39], a[36:39]
    ds_read_b64 a[242:243], v142 offset:49280
    ds_read_b64 a[244:245], v23 offset:49152
    ds_read_b64 a[246:247], v143 offset:49280
    ds_read_b64 a[248:249], v142 offset:49152
    ds_read_b64 a[250:251], v22 offset:49408
    v_mfma_f32_16x16x32_bf16 a[80:83], v[84:87], v[32:35], a[80:83]
    ds_read_b128 v[28:31], v1 offset:13312
    ds_read_b64 a[252:253], v143 offset:49152
    v_mfma_f32_16x16x32_bf16 a[84:87], v[84:87], v[36:39], a[84:87]
    s_waitcnt lgkmcnt(9)
    ds_read_b64 a[254:255], v23 offset:49408
    ds_read_b64 v[192:193], v22 offset:49280
    ds_read_b64 v[194:195], v142 offset:49408
    ds_read_b64 v[196:197], v23 offset:49280
    v_mfma_f32_16x16x32_bf16 a[40:43], v[80:83], v[40:43], a[40:43]
    ds_read_b128 v[32:35], v1 offset:14336
    ds_read_b64 v[198:199], v143 offset:49408
    v_mfma_f32_16x16x32_bf16 a[44:47], v[80:83], v[44:47], a[44:47]
    v_exp_f32 v16, v92
    v_add_f32 v5, v5, v18
    v_add_f32 v5, v5, v19
    v_exp_f32 v17, v93
    v_cvt_pk_bf16_f32 v91, v18, v19
    v_exp_f32 v18, v94
    v_add_f32 v6, v6, v16
    v_add_f32 v6, v6, v17
    v_exp_f32 v19, v95
    v_cvt_pk_bf16_f32 v92, v16, v17
    v_exp_f32 v16, v124
    v_add_f32 v6, v6, v18
    v_add_f32 v6, v6, v19
    v_exp_f32 v17, v125
    v_cvt_pk_bf16_f32 v93, v18, v19
    v_exp_f32 v18, v126
    v_add_f32 v6, v6, v16
    v_add_f32 v6, v6, v17
    v_exp_f32 v19, v127
    v_cvt_pk_bf16_f32 v94, v16, v17
    v_add_f32 v6, v6, v18
    v_add_f32 v6, v6, v19
    v_cvt_pk_bf16_f32 v95, v18, v19
    v_mfma_f32_16x16x32_bf16 a[88:91], v[84:87], v[40:43], a[88:91]
    s_waitcnt vmcnt(16)
    ds_read_b128 v[36:39], v1 offset:15360
    ds_read_b64 v[200:201], v22 offset:24576
    v_mfma_f32_16x16x32_bf16 a[92:95], v[84:87], v[44:47], a[92:95]
    s_waitcnt lgkmcnt(9)
    ds_read_b64 v[202:203], v142 offset:24704
    ds_read_b64 v[204:205], v23 offset:24576
    v_mfma_f32_16x16x32_bf16 a[0:3], v[88:91], v[24:27], a[0:3]
    ds_read_b128 v[40:43], v1 offset:16384
    ds_read_b64 v[206:207], v143 offset:24704
    v_mfma_f32_16x16x32_bf16 a[4:7], v[88:91], v[28:31], a[4:7]
    ds_read_b64 v[208:209], v142 offset:24576
    ds_read_b64 v[210:211], v22 offset:24832
    v_mfma_f32_16x16x32_bf16 a[48:51], v[92:95], v[24:27], a[48:51]
    ds_read_b128 v[44:47], v1 offset:17408
    ds_read_b64 v[212:213], v143 offset:24576
    v_mfma_f32_16x16x32_bf16 a[52:55], v[92:95], v[28:31], a[52:55]
    s_waitcnt lgkmcnt(9)
    ds_read_b64 v[214:215], v23 offset:24832
    ds_read_b64 v[216:217], v22 offset:24704
    v_mfma_f32_16x16x32_bf16 a[8:11], v[88:91], v[32:35], a[8:11]
    ds_read_b128 v[24:27], v1 offset:18432
    ds_read_b64 v[218:219], v142 offset:24832
    v_mfma_f32_16x16x32_bf16 a[12:15], v[88:91], v[36:39], a[12:15]
    ds_read_b64 v[220:221], v23 offset:24704
    ds_read_b64 v[222:223], v143 offset:24832
    v_mfma_f32_16x16x32_bf16 a[56:59], v[92:95], v[32:35], a[56:59]
    ds_read_b128 v[28:31], v1 offset:19456
    v_mfma_f32_16x16x32_bf16 a[60:63], v[92:95], v[36:39], a[60:63]
    s_waitcnt lgkmcnt(8)
    v_mfma_f32_16x16x32_bf16 a[16:19], v[88:91], v[40:43], a[16:19]
    ds_read_b128 v[32:35], v1 offset:20480
    v_mfma_f32_16x16x32_bf16 a[20:23], v[88:91], v[44:47], a[20:23]
    v_mfma_f32_16x16x32_bf16 a[64:67], v[92:95], v[40:43], a[64:67]
    ds_read_b128 v[36:39], v1 offset:21504
    v_mfma_f32_16x16x32_bf16 a[68:71], v[92:95], v[44:47], a[68:71]
    s_waitcnt lgkmcnt(2)
    v_mfma_f32_16x16x32_bf16 a[24:27], v[88:91], v[24:27], a[24:27]
    ds_read_b128 v[40:43], v1 offset:22528
    v_mfma_f32_16x16x32_bf16 a[28:31], v[88:91], v[28:31], a[28:31]
    v_mfma_f32_16x16x32_bf16 a[72:75], v[92:95], v[24:27], a[72:75]
    ds_read_b128 v[44:47], v1 offset:23552
    v_mfma_f32_16x16x32_bf16 a[76:79], v[92:95], v[28:31], a[76:79]
    s_waitcnt lgkmcnt(2)
    v_subrev_u32 v2, 49152, v2
    v_subrev_u32 v3, 49152, v3
    v_mfma_f32_16x16x32_bf16 a[32:35], v[88:91], v[32:35], a[32:35]
    ds_read_b128 v[24:27], v2 offset:0
    v_mfma_f32_16x16x32_bf16 a[36:39], v[88:91], v[36:39], a[36:39]
    v_mfma_f32_16x16x32_bf16 a[80:83], v[92:95], v[32:35], a[80:83]
    ds_read_b128 v[28:31], v3 offset:0
    v_mfma_f32_16x16x32_bf16 a[84:87], v[92:95], v[36:39], a[84:87]
    s_waitcnt lgkmcnt(2)
    v_mfma_f32_16x16x32_bf16 a[40:43], v[88:91], v[40:43], a[40:43]
    ds_read_b128 v[32:35], v2 offset:6144
    v_mfma_f32_16x16x32_bf16 a[44:47], v[88:91], v[44:47], a[44:47]
    v_mfma_f32_16x16x32_bf16 a[88:91], v[92:95], v[40:43], a[88:91]
    ds_read_b128 v[36:39], v3 offset:6144
    v_mfma_f32_16x16x32_bf16 a[92:95], v[92:95], v[44:47], a[92:95]
    s_waitcnt lgkmcnt(2)
    s_waitcnt lgkmcnt(0)
    s_barrier
    v_mfma_f32_16x16x32_bf16 v[160:163], v[24:27], a[240:243], 0
    s_waitcnt vmcnt(10)
    ds_read_b128 v[40:43], v2 offset:128
    v_lshlrev_b32 v48, 16, v56
    v_mfma_f32_16x16x32_bf16 v[160:163], v[28:31], a[244:247], v[160:163]
    s_mov_b32 m0, s26
    v_and_b32 v49, s97, v56
    v_lshlrev_b32 v50, 16, v58
    v_and_b32 v51, s97, v58
    v_mul_f32 v48, s38, v48
    v_mul_f32 v49, s38, v49
    v_mfma_f32_16x16x32_bf16 v[164:167], v[24:27], v[200:203], 0
    ds_read_b128 v[44:47], v3 offset:128
    v_mul_f32_e64 v50, -v50, v48
    v_mfma_f32_16x16x32_bf16 v[164:167], v[28:31], v[204:207], v[164:167]
    s_waitcnt lgkmcnt(2)
    buffer_load_dwordx4 v4, s[4:7], s32 offen offset:0 sc1 lds
    v_mul_f32_e64 v51, -v51, v49
    v_cvt_f32_i32 v224, v224
    v_cvt_f32_i32 v225, v225
    v_mfma_f32_16x16x32_bf16 v[96:99], v[32:35], a[240:243], 0
    ds_read_b128 v[24:27], v2 offset:6272
    v_fma_f32 v224, v224, v48, v50
    v_mfma_f32_16x16x32_bf16 v[96:99], v[36:39], a[244:247], v[96:99]
    buffer_load_dwordx4 v4, s[4:7], s32 offen offset:1024 sc1 lds
    v_fma_f32 v225, v225, v49, v51
    v_cvt_pk_bf16_f32 v224, v224, v225
    v_cvt_f32_i32 v228, v228
    v_mfma_f32_16x16x32_bf16 v[100:103], v[32:35], v[200:203], 0
    ds_read_b128 v[28:31], v3 offset:6272
    v_cvt_f32_i32 v229, v229
    v_mfma_f32_16x16x32_bf16 v[100:103], v[36:39], v[204:207], v[100:103]
    s_waitcnt lgkmcnt(2)
    buffer_load_dwordx4 v4, s[4:7], s32 offen offset:2048 sc1 lds
    v_fma_f32 v228, v228, v48, v50
    v_fma_f32 v229, v229, v49, v51
    v_cvt_pk_bf16_f32 v228, v228, v229
    v_mfma_f32_16x16x32_bf16 v[160:163], v[40:43], a[248:251], v[160:163]
    s_add_u32 s32, s32, 24576
    ds_read_b128 v[32:35], v2 offset:256
    v_cvt_f32_i32 v232, v232
    v_mfma_f32_16x16x32_bf16 v[160:163], v[44:47], a[252:255], v[160:163]
    s_sub_u32 s57, s32, 196608
    v_cvt_f32_i32 v233, v233
    v_fma_f32 v232, v232, v48, v50
    v_fma_f32 v233, v233, v49, v51
    v_cvt_pk_bf16_f32 v232, v232, v233
    v_cvt_f32_i32 v236, v236
    v_mfma_f32_16x16x32_bf16 v[164:167], v[40:43], v[208:211], v[164:167]
    s_min_u32 s32, s32, s57
    ds_read_b128 v[36:39], v3 offset:256
    v_cvt_f32_i32 v237, v237
    v_mfma_f32_16x16x32_bf16 v[164:167], v[44:47], v[212:215], v[164:167]
    s_waitcnt lgkmcnt(2)
    v_fma_f32 v236, v236, v48, v50
    v_fma_f32 v237, v237, v49, v51
    v_cvt_pk_bf16_f32 v236, v236, v237
    v_lshlrev_b32 v48, 16, v57
    v_and_b32 v49, s97, v57
    v_mfma_f32_16x16x32_bf16 v[96:99], v[24:27], a[248:251], v[96:99]
    s_add_u32 s26, s26, 12288
    ds_read_b128 v[40:43], v2 offset:6400
    v_lshlrev_b32 v50, 16, v59
    v_mfma_f32_16x16x32_bf16 v[96:99], v[28:31], a[252:255], v[96:99]
    s_mov_b32 m0, s26
    v_and_b32 v51, s97, v59
    v_mul_f32 v48, s38, v48
    v_mul_f32 v49, s38, v49
    v_mul_f32_e64 v50, -v50, v48
    v_mul_f32_e64 v51, -v51, v49
    v_mfma_f32_16x16x32_bf16 v[100:103], v[24:27], v[208:211], v[100:103]
    ds_read_b128 v[44:47], v3 offset:6400
    v_cvt_f32_i32 v226, v226
    v_mfma_f32_16x16x32_bf16 v[100:103], v[28:31], v[212:215], v[100:103]
    s_waitcnt lgkmcnt(2)
    buffer_load_dwordx4 v4, s[4:7], s32 offen offset:0 sc1 lds
    v_cvt_f32_i32 v227, v227
    v_fma_f32 v226, v226, v48, v50
    v_fma_f32 v227, v227, v49, v51
    v_mfma_f32_16x16x32_bf16 v[160:163], v[32:35], v[192:195], v[160:163]
    ds_read_b128 v[24:27], v2 offset:12288
    v_cvt_pk_bf16_f32 v225, v226, v227
    v_mfma_f32_16x16x32_bf16 v[160:163], v[36:39], v[196:199], v[160:163]
    buffer_load_dwordx4 v4, s[4:7], s32 offen offset:1024 sc1 lds
    v_cvt_f32_i32 v230, v230
    v_cvt_f32_i32 v231, v231
    v_fma_f32 v230, v230, v48, v50
    v_mfma_f32_16x16x32_bf16 v[164:167], v[32:35], v[216:219], v[164:167]
    ds_read_b128 v[28:31], v3 offset:12288
    v_fma_f32 v231, v231, v49, v51
    v_mfma_f32_16x16x32_bf16 v[164:167], v[36:39], v[220:223], v[164:167]
    s_waitcnt lgkmcnt(2)
    s_waitcnt vmcnt(13)
    buffer_load_dwordx4 v4, s[4:7], s32 offen offset:2048 sc1 lds
    v_cvt_pk_bf16_f32 v229, v230, v231
    v_cvt_f32_i32 v234, v234
    v_cvt_f32_i32 v235, v235
    v_mfma_f32_16x16x32_bf16 v[96:99], v[40:43], v[192:195], v[96:99]
    ds_read_b128 v[32:35], v2 offset:18432
    v_fma_f32 v234, v234, v48, v50
    v_mfma_f32_16x16x32_bf16 v[96:99], v[44:47], v[196:199], v[96:99]
    v_fma_f32 v235, v235, v49, v51
    v_cvt_pk_bf16_f32 v233, v234, v235
    v_cvt_f32_i32 v238, v238
    v_cvt_f32_i32 v239, v239
    v_fma_f32 v238, v238, v48, v50
    v_mfma_f32_16x16x32_bf16 v[100:103], v[40:43], v[216:219], v[100:103]
    ds_read_b128 v[36:39], v3 offset:18432
    v_fma_f32 v239, v239, v49, v51
    v_mfma_f32_16x16x32_bf16 v[100:103], v[44:47], v[220:223], v[100:103]
    s_waitcnt lgkmcnt(2)
    v_cvt_pk_bf16_f32 v237, v238, v239
    v_mfma_f32_16x16x32_bf16 v[168:171], v[24:27], a[240:243], 0
    ds_read_b128 v[40:43], v2 offset:12416
    v_mfma_f32_16x16x32_bf16 v[168:171], v[28:31], a[244:247], v[168:171]
    s_add_u32 s32, s32, 24576
    s_sub_u32 s57, s32, 196608
    s_min_u32 s32, s32, s57
    s_add_u32 s26, s26, 36864
    s_sub_u32 s57, s26, 147456
    s_min_u32 s26, s26, s57
    v_mfma_f32_16x16x32_bf16 v[172:175], v[24:27], v[200:203], 0
    ds_read_b128 v[44:47], v3 offset:12416
    v_mfma_f32_16x16x32_bf16 v[172:175], v[28:31], v[204:207], v[172:175]
    s_waitcnt lgkmcnt(2)
    v_max3_f32 v16, v160, v161, v162
    v_max3_f32 v18, v164, v165, v166
    v_max3_f32 v16, v16, v163, v96
    v_max3_f32 v18, v18, v167, v100
    v_max3_f32 v16, v16, v97, v98
    v_max3_f32 v18, v18, v101, v102
    v_max_f32 v16, v16, v99
    v_max_f32 v18, v18, v103
    v_mov_b32 v17, v16
    v_mfma_f32_16x16x32_bf16 v[104:107], v[32:35], a[240:243], 0
    ds_read_b128 v[24:27], v2 offset:18560
    v_mov_b32 v19, v18
    v_mfma_f32_16x16x32_bf16 v[104:107], v[36:39], a[244:247], v[104:107]
    s_nop 0
    v_permlane16_swap_b32 v16, v17
    v_permlane16_swap_b32 v18, v19
    s_nop 0
    v_max_f32 v16, v16, v17
    v_max_f32 v18, v18, v19
    v_mov_b32 v17, v16
    v_mov_b32 v19, v18
    v_mfma_f32_16x16x32_bf16 v[108:111], v[32:35], v[200:203], 0
    s_nop 0
    ds_read_b128 v[28:31], v3 offset:18560
    v_permlane32_swap_b32 v16, v17
    v_mfma_f32_16x16x32_bf16 v[108:111], v[36:39], v[204:207], v[108:111]
    s_waitcnt lgkmcnt(2)
    v_permlane32_swap_b32 v18, v19
    s_nop 0
    v_max_f32 v16, v16, v17
    v_max_f32 v18, v18, v19
    v_sub_f32 v136, 0, v16
    v_sub_f32 v137, 0, v16
    v_mfma_f32_16x16x32_bf16 v[168:171], v[40:43], a[248:251], v[168:171]
    ds_read_b128 v[32:35], v2 offset:12544
    v_sub_f32 v138, 0, v16
    v_mfma_f32_16x16x32_bf16 v[168:171], v[44:47], a[252:255], v[168:171]
    v_sub_f32 v139, 0, v16
    v_sub_f32 v140, 0, v18
    v_sub_f32 v141, 0, v18
    v_sub_f32 v142, 0, v18
    v_sub_f32 v143, 0, v18
    v_mfma_f32_16x16x32_bf16 v[172:175], v[40:43], v[208:211], v[172:175]
    ds_read_b128 v[36:39], v3 offset:12544
    v_mfma_f32_16x16x32_bf16 v[172:175], v[44:47], v[212:215], v[172:175]
    s_waitcnt lgkmcnt(2)
    s_waitcnt vmcnt(10)
    v_lshlrev_b32 v48, 16, v60
    v_and_b32 v49, s97, v60
    v_lshlrev_b32 v50, 16, v62
    v_and_b32 v51, s97, v62
    v_mul_f32 v48, s38, v48
    v_mul_f32 v49, s38, v49
    v_mul_f32_e64 v50, -v50, v48
    v_mfma_f32_16x16x32_bf16 v[104:107], v[24:27], a[248:251], v[104:107]
    ds_read_b128 v[40:43], v2 offset:18688
    v_mul_f32_e64 v51, -v51, v49
    v_mfma_f32_16x16x32_bf16 v[104:107], v[28:31], a[252:255], v[104:107]
    buffer_load_dwordx2 v[56:57], off, s[80:83], s37 offset:0
    v_cvt_f32_i32 v240, v240
    v_cvt_f32_i32 v241, v241
    v_fma_f32 v240, v240, v48, v50
    v_fma_f32 v241, v241, v49, v51
    v_cvt_pk_bf16_f32 v226, v240, v241
    v_mfma_f32_16x16x32_bf16 v[108:111], v[24:27], v[208:211], v[108:111]
    ds_read_b128 v[44:47], v3 offset:18688
    v_cvt_f32_i32 v244, v244
    v_mfma_f32_16x16x32_bf16 v[108:111], v[28:31], v[212:215], v[108:111]
    s_waitcnt lgkmcnt(2)
    buffer_load_dwordx2 v[58:59], off, s[84:87], s37 offset:0
    v_add_u32 v2, 49152, v2
    v_add_u32 v3, 49152, v3
    v_cvt_f32_i32 v245, v245
    v_fma_f32 v244, v244, v48, v50
    v_mfma_f32_16x16x32_bf16 v[168:171], v[32:35], v[192:195], v[168:171]
    ds_read_b128 v[24:27], v2 offset:0
    v_fma_f32 v245, v245, v49, v51
    v_mfma_f32_16x16x32_bf16 v[168:171], v[36:39], v[196:199], v[168:171]
    v_cvt_pk_bf16_f32 v230, v244, v245
    v_cvt_f32_i32 v248, v248
    v_cvt_f32_i32 v249, v249
    v_fma_f32 v248, v248, v48, v50
    v_fma_f32 v249, v249, v49, v51
    v_cvt_pk_bf16_f32 v234, v248, v249
    v_cvt_f32_i32 v252, v252
    v_mfma_f32_16x16x32_bf16 v[172:175], v[32:35], v[216:219], v[172:175]
    ds_read_b128 v[28:31], v3 offset:0
    v_cvt_f32_i32 v253, v253
    v_mfma_f32_16x16x32_bf16 v[172:175], v[36:39], v[220:223], v[172:175]
    s_waitcnt lgkmcnt(2)
    v_fma_f32 v252, v252, v48, v50
    v_fma_f32 v253, v253, v49, v51
    v_cvt_pk_bf16_f32 v238, v252, v253
    v_lshlrev_b32 v48, 16, v61
    v_and_b32 v49, s97, v61
    v_lshlrev_b32 v50, 16, v63
    v_and_b32 v51, s97, v63
    v_mfma_f32_16x16x32_bf16 v[104:107], v[40:43], v[192:195], v[104:107]
    ds_read_b128 v[32:35], v2 offset:6144
    v_mul_f32 v48, s38, v48
    v_mfma_f32_16x16x32_bf16 v[104:107], v[44:47], v[196:199], v[104:107]
    v_mul_f32 v49, s38, v49
    v_mul_f32_e64 v50, -v50, v48
    v_mul_f32_e64 v51, -v51, v49
    v_cvt_f32_i32 v242, v242
    v_cvt_f32_i32 v243, v243
    v_fma_f32 v242, v242, v48, v50
    v_mfma_f32_16x16x32_bf16 v[108:111], v[40:43], v[216:219], v[108:111]
    ds_read_b128 v[36:39], v3 offset:6144
    v_add_f32 v160, v160, v136
    v_mfma_f32_16x16x32_bf16 v[108:111], v[44:47], v[220:223], v[108:111]
    s_waitcnt lgkmcnt(2)
    v_add_f32 v161, v161, v136
    v_add_f32 v162, v162, v136
    v_add_f32 v163, v163, v136
    v_add_f32 v96, v96, v136
    v_add_f32 v97, v97, v136
    v_add_f32 v98, v98, v136
    v_add_f32 v99, v99, v136
    v_mfma_f32_16x16x32_bf16 v[176:179], v[24:27], a[240:243], v[136:139]
    ds_read_b128 v[40:43], v2 offset:128
    v_add_f32 v164, v164, v140
    v_mfma_f32_16x16x32_bf16 v[176:179], v[28:31], a[244:247], v[176:179]
    v_add_f32 v165, v165, v140
    v_add_f32 v166, v166, v140
    v_add_f32 v167, v167, v140
    v_add_f32 v100, v100, v140
    v_add_f32 v101, v101, v140
    v_add_f32 v102, v102, v140
    v_mfma_f32_16x16x32_bf16 v[180:183], v[24:27], v[200:203], v[140:143]
    ds_read_b128 v[44:47], v3 offset:128
    v_add_f32 v103, v103, v140
    v_mfma_f32_16x16x32_bf16 v[180:183], v[28:31], v[204:207], v[180:183]
    s_waitcnt lgkmcnt(2)
    v_exp_f32 v16, v160
    v_exp_f32 v17, v161
    v_exp_f32 v18, v162
    v_add_f32 v7, v7, v16
    v_mfma_f32_16x16x32_bf16 v[112:115], v[32:35], a[240:243], v[136:139]
    ds_read_b128 v[24:27], v2 offset:6272
    v_add_f32 v7, v7, v17
    v_mfma_f32_16x16x32_bf16 v[112:115], v[36:39], a[244:247], v[112:115]
    v_exp_f32 v19, v163
    v_cvt_pk_bf16_f32 v160, v16, v17
    v_exp_f32 v16, v96
    v_add_f32 v7, v7, v18
    v_add_f32 v7, v7, v19
    v_mfma_f32_16x16x32_bf16 v[116:119], v[32:35], v[200:203], v[140:143]
    ds_read_b128 v[28:31], v3 offset:6272
    v_fma_f32 v243, v243, v49, v51
    v_mfma_f32_16x16x32_bf16 v[116:119], v[36:39], v[204:207], v[116:119]
    s_waitcnt lgkmcnt(2)
    v_exp_f32 v17, v97
    v_cvt_pk_bf16_f32 v161, v18, v19
    v_exp_f32 v18, v98
    v_add_f32 v7, v7, v16
    v_mfma_f32_16x16x32_bf16 v[176:179], v[40:43], a[248:251], v[176:179]
    ds_read_b128 v[32:35], v2 offset:256
    v_add_f32 v7, v7, v17
    v_mfma_f32_16x16x32_bf16 v[176:179], v[44:47], a[252:255], v[176:179]
    v_exp_f32 v19, v99
    v_cvt_pk_bf16_f32 v162, v16, v17
    v_exp_f32 v16, v164
    v_add_f32 v7, v7, v18
    v_add_f32 v7, v7, v19
    v_mfma_f32_16x16x32_bf16 v[180:183], v[40:43], v[208:211], v[180:183]
    ds_read_b128 v[36:39], v3 offset:256
    v_cvt_pk_bf16_f32 v227, v242, v243
    v_mfma_f32_16x16x32_bf16 v[180:183], v[44:47], v[212:215], v[180:183]
    s_waitcnt lgkmcnt(2)
    v_exp_f32 v17, v165
    v_cvt_pk_bf16_f32 v163, v18, v19
    v_exp_f32 v18, v166
    v_add_f32 v8, v8, v16
    v_mfma_f32_16x16x32_bf16 v[112:115], v[24:27], a[248:251], v[112:115]
    ds_read_b128 v[40:43], v2 offset:6400
    v_add_f32 v8, v8, v17
    v_mfma_f32_16x16x32_bf16 v[112:115], v[28:31], a[252:255], v[112:115]
    v_exp_f32 v19, v167
    v_cvt_pk_bf16_f32 v164, v16, v17
    v_exp_f32 v16, v100
    v_add_f32 v8, v8, v18
    v_add_f32 v8, v8, v19
    v_mfma_f32_16x16x32_bf16 v[116:119], v[24:27], v[208:211], v[116:119]
    ds_read_b128 v[44:47], v3 offset:6400
    v_cvt_f32_i32 v246, v246
    v_mfma_f32_16x16x32_bf16 v[116:119], v[28:31], v[212:215], v[116:119]
    s_waitcnt lgkmcnt(2)
    v_exp_f32 v17, v101
    v_cvt_pk_bf16_f32 v165, v18, v19
    v_exp_f32 v18, v102
    v_add_f32 v8, v8, v16
    v_add_f32 v8, v8, v17
    v_mfma_f32_16x16x32_bf16 v[176:179], v[32:35], v[192:195], v[176:179]
    ds_read_b128 v[24:27], v2 offset:12288
    v_cvt_f32_i32 v247, v247
    v_mfma_f32_16x16x32_bf16 v[176:179], v[36:39], v[196:199], v[176:179]
    v_exp_f32 v19, v103
    v_cvt_pk_bf16_f32 v166, v16, v17
    v_add_f32 v8, v8, v18
    v_add_f32 v8, v8, v19
    v_cvt_pk_bf16_f32 v167, v18, v19
    v_mfma_f32_16x16x32_bf16 v[180:183], v[32:35], v[216:219], v[180:183]
    ds_read_b128 v[28:31], v3 offset:12288
    v_add_f32 v168, v168, v136
    v_mfma_f32_16x16x32_bf16 v[180:183], v[36:39], v[220:223], v[180:183]
    s_waitcnt lgkmcnt(2)
    v_add_f32 v169, v169, v136
    v_add_f32 v170, v170, v136
    v_add_f32 v171, v171, v136
    v_add_f32 v104, v104, v136
    v_add_f32 v105, v105, v136
    v_add_f32 v106, v106, v136
    v_add_f32 v107, v107, v136
    v_mfma_f32_16x16x32_bf16 v[112:115], v[40:43], v[192:195], v[112:115]
    ds_read_b128 v[32:35], v2 offset:18432
    v_fma_f32 v246, v246, v48, v50
    v_mfma_f32_16x16x32_bf16 v[112:115], v[44:47], v[196:199], v[112:115]
    v_fma_f32 v247, v247, v49, v51
    v_cvt_pk_bf16_f32 v231, v246, v247
    v_cvt_f32_i32 v250, v250
    v_add_f32 v172, v172, v140
    v_add_f32 v173, v173, v140
    v_add_f32 v174, v174, v140
    v_add_f32 v175, v175, v140
    v_mfma_f32_16x16x32_bf16 v[116:119], v[40:43], v[216:219], v[116:119]
    ds_read_b128 v[36:39], v3 offset:18432
    v_cvt_f32_i32 v251, v251
    v_mfma_f32_16x16x32_bf16 v[116:119], v[44:47], v[220:223], v[116:119]
    s_waitcnt lgkmcnt(2)
    v_fma_f32 v250, v250, v48, v50
    v_fma_f32 v251, v251, v49, v51
    v_cvt_pk_bf16_f32 v235, v250, v251
    v_cvt_f32_i32 v254, v254
    v_add_f32 v108, v108, v140
    v_add_f32 v109, v109, v140
    v_mfma_f32_16x16x32_bf16 v[184:187], v[24:27], a[240:243], v[136:139]
    ds_read_b128 v[40:43], v2 offset:12416
    v_cvt_f32_i32 v255, v255
    v_fma_f32 v254, v254, v48, v50
    v_fma_f32 v255, v255, v49, v51
    v_cvt_pk_bf16_f32 v239, v254, v255
    v_mfma_f32_16x16x32_bf16 v[184:187], v[28:31], a[244:247], v[184:187]
    buffer_store_dwordx4 v[224:227], v11, s[4:7], s33 offen offset:0 sc1
    v_add_f32 v110, v110, v140
    v_add_f32 v111, v111, v140
    v_xor_b32 v55, 16, v11
    v_mfma_f32_16x16x32_bf16 v[188:191], v[24:27], v[200:203], v[140:143]
    ds_read_b128 v[44:47], v3 offset:12416
    v_mfma_f32_16x16x32_bf16 v[188:191], v[28:31], v[204:207], v[188:191]
    s_waitcnt lgkmcnt(2)
    v_exp_f32 v16, v168
    v_exp_f32 v17, v169
    v_exp_f32 v18, v170
    v_mfma_f32_16x16x32_bf16 v[120:123], v[32:35], a[240:243], v[136:139]
    ds_read_b128 v[24:27], v2 offset:18560
    v_add_f32 v7, v7, v16
    v_mfma_f32_16x16x32_bf16 v[120:123], v[36:39], a[244:247], v[120:123]
    buffer_store_dwordx4 v[228:231], v55, s[4:7], s33 offen offset:768 sc1
    v_add_f32 v7, v7, v17
    v_exp_f32 v19, v171
    v_mfma_f32_16x16x32_bf16 v[124:127], v[32:35], v[200:203], v[140:143]
    ds_read_b128 v[28:31], v3 offset:18560
    v_cvt_pk_bf16_f32 v168, v16, v17
    v_mfma_f32_16x16x32_bf16 v[124:127], v[36:39], v[204:207], v[124:127]
    s_waitcnt lgkmcnt(2)
    v_exp_f32 v16, v104
    v_add_f32 v7, v7, v18
    v_add_f32 v7, v7, v19
    v_exp_f32 v17, v105
    v_cvt_pk_bf16_f32 v169, v18, v19
    v_mfma_f32_16x16x32_bf16 v[184:187], v[40:43], a[248:251], v[184:187]
    ds_read_b128 v[32:35], v2 offset:12544
    v_mfma_f32_16x16x32_bf16 v[184:187], v[44:47], a[252:255], v[184:187]
    v_exp_f32 v18, v106
    v_add_f32 v7, v7, v16
    v_add_f32 v7, v7, v17
    v_exp_f32 v19, v107
    v_mfma_f32_16x16x32_bf16 v[188:191], v[40:43], v[208:211], v[188:191]
    ds_read_b128 v[36:39], v3 offset:12544
    v_cvt_pk_bf16_f32 v170, v16, v17
    v_mfma_f32_16x16x32_bf16 v[188:191], v[44:47], v[212:215], v[188:191]
    s_waitcnt lgkmcnt(2)
    v_exp_f32 v16, v172
    v_add_f32 v7, v7, v18
    v_add_f32 v7, v7, v19
    v_exp_f32 v17, v173
    v_cvt_pk_bf16_f32 v171, v18, v19
    v_mfma_f32_16x16x32_bf16 v[120:123], v[24:27], a[248:251], v[120:123]
    ds_read_b128 v[40:43], v2 offset:18688
    v_xor_b32 v54, 32, v11
    v_mfma_f32_16x16x32_bf16 v[120:123], v[28:31], a[252:255], v[120:123]
    s_waitcnt vmcnt(4)
    v_exp_f32 v18, v174
    v_add_f32 v8, v8, v16
    v_add_f32 v8, v8, v17
    v_exp_f32 v19, v175
    v_cvt_pk_bf16_f32 v172, v16, v17
    v_mfma_f32_16x16x32_bf16 v[124:127], v[24:27], v[208:211], v[124:127]
    ds_read_b128 v[44:47], v3 offset:18688
    v_mfma_f32_16x16x32_bf16 v[124:127], v[28:31], v[212:215], v[124:127]
    s_waitcnt lgkmcnt(2)
    s_barrier
    v_add_u32 v2, 49152, v2
    v_add_u32 v3, 49152, v3
    v_exp_f32 v16, v108
    v_mfma_f32_16x16x32_bf16 v[184:187], v[32:35], v[192:195], v[184:187]
    ds_read_b128 v[24:27], v2 offset:0
    v_add_f32 v8, v8, v18
    v_mfma_f32_16x16x32_bf16 v[184:187], v[36:39], v[196:199], v[184:187]
    buffer_store_dwordx4 v[232:235], v54, s[4:7], s33 offen offset:1536 sc1
    v_add_f32 v8, v8, v19
    v_exp_f32 v17, v109
    v_mfma_f32_16x16x32_bf16 v[188:191], v[32:35], v[216:219], v[188:191]
    ds_read_b128 v[28:31], v3 offset:0
    v_cvt_pk_bf16_f32 v173, v18, v19
    v_mfma_f32_16x16x32_bf16 v[188:191], v[36:39], v[220:223], v[188:191]
    s_waitcnt lgkmcnt(2)
    v_exp_f32 v18, v110
    v_add_f32 v8, v8, v16
    v_add_f32 v8, v8, v17
    v_exp_f32 v19, v111
    v_cvt_pk_bf16_f32 v174, v16, v17
    v_mfma_f32_16x16x32_bf16 v[120:123], v[40:43], v[192:195], v[120:123]
    ds_read_b128 v[32:35], v2 offset:6144
    v_xor_b32 v55, 48, v11
    v_mfma_f32_16x16x32_bf16 v[120:123], v[44:47], v[196:199], v[120:123]
    buffer_store_dwordx4 v[236:239], v55, s[4:7], s33 offen offset:2304 sc1
    v_add_f32 v8, v8, v18
    v_add_f32 v8, v8, v19
    v_cvt_pk_bf16_f32 v175, v18, v19
    v_mfma_f32_16x16x32_bf16 v[124:127], v[40:43], v[216:219], v[124:127]
    ds_read_b128 v[36:39], v3 offset:6144
    v_mfma_f32_16x16x32_bf16 v[124:127], v[44:47], v[220:223], v[124:127]
    s_waitcnt lgkmcnt(2)
    v_mfma_f32_16x16x32_bf16 v[64:67], v[24:27], a[192:195], v[128:131]
    ds_read_b128 v[40:43], v2 offset:128
    v_mfma_f32_16x16x32_bf16 v[64:67], v[28:31], a[196:199], v[64:67]
    buffer_load_dwordx2 v[60:61], off, s[80:83], s37 offset:8
    v_mfma_f32_16x16x32_bf16 v[68:71], v[24:27], a[216:219], v[132:135]
    v_exp_f32 v16, v176
    v_mfma_f32_16x16x32_bf16 v[68:71], v[28:31], a[220:223], v[68:71]
    v_exp_f32 v17, v177
    v_mfma_f32_16x16x32_bf16 v[72:75], v[24:27], a[240:243], v[136:139]
    ds_read_b128 v[44:47], v3 offset:128
    v_mfma_f32_16x16x32_bf16 v[72:75], v[28:31], a[244:247], v[72:75]
    buffer_load_dwordx2 v[62:63], off, s[84:87], s37 offset:8
    v_mfma_f32_16x16x32_bf16 v[76:79], v[24:27], v[200:203], v[140:143]
    v_exp_f32 v18, v178
    v_mfma_f32_16x16x32_bf16 v[76:79], v[28:31], v[204:207], v[76:79]
    s_waitcnt lgkmcnt(2)
    v_add_f32 v7, v7, v16
    v_add_f32 v7, v7, v17
    v_mfma_f32_16x16x32_bf16 v[96:99], v[32:35], a[192:195], v[128:131]
    ds_read_b128 v[24:27], v2 offset:6272
    v_mfma_f32_16x16x32_bf16 v[96:99], v[36:39], a[196:199], v[96:99]
    buffer_load_dwordx4 v[240:243], v12, s[68:71], s16 offen offset:0 nt
    v_mfma_f32_16x16x32_bf16 v[100:103], v[32:35], a[216:219], v[132:135]
    s_waitcnt vmcnt(7)
    v_exp_f32 v19, v179
    v_mfma_f32_16x16x32_bf16 v[100:103], v[36:39], a[220:223], v[100:103]
    v_cvt_pk_bf16_f32 v176, v16, v17
    v_exp_f32 v16, v112
    v_mfma_f32_16x16x32_bf16 v[104:107], v[32:35], a[240:243], v[136:139]
    ds_read_b128 v[28:31], v3 offset:6272
    v_add_f32 v7, v7, v18
    v_mfma_f32_16x16x32_bf16 v[104:107], v[36:39], a[244:247], v[104:107]
    buffer_load_dwordx4 v[244:247], v12, s[68:71], s16 offen offset:768 nt
    v_add_f32 v7, v7, v19
    v_mfma_f32_16x16x32_bf16 v[108:111], v[32:35], v[200:203], v[140:143]
    v_exp_f32 v17, v113
    v_mfma_f32_16x16x32_bf16 v[108:111], v[36:39], v[204:207], v[108:111]
    s_waitcnt lgkmcnt(2)
    v_cvt_pk_bf16_f32 v177, v18, v19
    v_exp_f32 v18, v114
    v_mfma_f32_16x16x32_bf16 v[64:67], v[40:43], a[200:203], v[64:67]
    ds_read_b128 v[32:35], v2 offset:256
    v_add_f32 v7, v7, v16
    v_mfma_f32_16x16x32_bf16 v[64:67], v[44:47], a[204:207], v[64:67]
    buffer_load_dwordx4 v[248:251], v12, s[68:71], s16 offen offset:1536 nt
    v_add_f32 v7, v7, v17
    v_mfma_f32_16x16x32_bf16 v[68:71], v[40:43], a[224:227], v[68:71]
    v_exp_f32 v19, v115
    v_mfma_f32_16x16x32_bf16 v[68:71], v[44:47], a[228:231], v[68:71]
    v_cvt_pk_bf16_f32 v178, v16, v17
    v_exp_f32 v16, v180
    v_mfma_f32_16x16x32_bf16 v[72:75], v[40:43], a[248:251], v[72:75]
    ds_read_b128 v[36:39], v3 offset:256
    v_add_f32 v7, v7, v18
    v_mfma_f32_16x16x32_bf16 v[72:75], v[44:47], a[252:255], v[72:75]
    buffer_load_dwordx4 v[252:255], v12, s[68:71], s16 offen offset:2304 nt
    v_add_f32 v7, v7, v19
    v_mfma_f32_16x16x32_bf16 v[76:79], v[40:43], v[208:211], v[76:79]
    v_exp_f32 v17, v181
    v_mfma_f32_16x16x32_bf16 v[76:79], v[44:47], v[212:215], v[76:79]
    s_waitcnt lgkmcnt(2)
    v_cvt_pk_bf16_f32 v179, v18, v19
    v_exp_f32 v18, v182
    v_mfma_f32_16x16x32_bf16 v[96:99], v[24:27], a[200:203], v[96:99]
    s_mov_b32 m0, s26
    ds_read_b128 v[40:43], v2 offset:6400
    v_add_f32 v8, v8, v16
    v_mfma_f32_16x16x32_bf16 v[96:99], v[28:31], a[204:207], v[96:99]
    buffer_load_dwordx4 v4, s[4:7], s32 offen offset:0 sc1 lds
    v_add_f32 v8, v8, v17
    v_mfma_f32_16x16x32_bf16 v[100:103], v[24:27], a[224:227], v[100:103]
    v_exp_f32 v19, v183
    v_mfma_f32_16x16x32_bf16 v[100:103], v[28:31], a[228:231], v[100:103]
    v_cvt_pk_bf16_f32 v180, v16, v17
    v_exp_f32 v16, v116
    v_mfma_f32_16x16x32_bf16 v[104:107], v[24:27], a[248:251], v[104:107]
    ds_read_b128 v[44:47], v3 offset:6400
    v_add_f32 v8, v8, v18
    v_mfma_f32_16x16x32_bf16 v[104:107], v[28:31], a[252:255], v[104:107]
    buffer_load_dwordx4 v4, s[4:7], s32 offen offset:1024 sc1 lds
    v_add_f32 v8, v8, v19
    v_mfma_f32_16x16x32_bf16 v[108:111], v[24:27], v[208:211], v[108:111]
    v_exp_f32 v17, v117
    v_mfma_f32_16x16x32_bf16 v[108:111], v[28:31], v[212:215], v[108:111]
    s_waitcnt lgkmcnt(2)
    v_cvt_pk_bf16_f32 v181, v18, v19
    v_exp_f32 v18, v118
    v_mfma_f32_16x16x32_bf16 v[64:67], v[32:35], a[208:211], v[64:67]
    ds_read_b128 v[24:27], v2 offset:12288
    v_add_f32 v8, v8, v16
    v_mfma_f32_16x16x32_bf16 v[64:67], v[36:39], a[212:215], v[64:67]
    buffer_load_dwordx4 v4, s[4:7], s32 offen offset:2048 sc1 lds
    v_add_f32 v8, v8, v17
    v_mfma_f32_16x16x32_bf16 v[68:71], v[32:35], a[232:235], v[68:71]
    s_add_u32 s32, s32, 24576
    v_exp_f32 v19, v119
    v_mfma_f32_16x16x32_bf16 v[68:71], v[36:39], a[236:239], v[68:71]
    v_cvt_pk_bf16_f32 v182, v16, v17
    v_add_f32 v8, v8, v18
    v_add_f32 v8, v8, v19
    v_mfma_f32_16x16x32_bf16 v[72:75], v[32:35], v[192:195], v[72:75]
    s_sub_u32 s57, s32, 196608
    ds_read_b128 v[28:31], v3 offset:12288
    v_cvt_pk_bf16_f32 v183, v18, v19
    v_mfma_f32_16x16x32_bf16 v[72:75], v[36:39], v[196:199], v[72:75]
    s_waitcnt lgkmcnt(2)
    v_exp_f32 v16, v184
    v_lshlrev_b32 v48, 16, v56
    v_mfma_f32_16x16x32_bf16 v[76:79], v[32:35], v[216:219], v[76:79]
    s_waitcnt vmcnt(9)
    v_exp_f32 v17, v185
    v_mfma_f32_16x16x32_bf16 v[76:79], v[36:39], v[220:223], v[76:79]
    s_barrier
    v_exp_f32 v18, v186
    v_mfma_f32_16x16x32_bf16 v[96:99], v[40:43], a[208:211], v[96:99]
    s_min_u32 s32, s32, s57
    ds_read_b128 v[32:35], v2 offset:18432
    v_add_f32 v7, v7, v16
    v_mfma_f32_16x16x32_bf16 v[96:99], v[44:47], a[212:215], v[96:99]
    v_add_f32 v7, v7, v17
    v_exp_f32 v19, v187
    v_mfma_f32_16x16x32_bf16 v[100:103], v[40:43], a[232:235], v[100:103]
    s_add_u32 s26, s26, 12288
    v_cvt_pk_bf16_f32 v184, v16, v17
    v_and_b32 v49, s97, v56
    v_mfma_f32_16x16x32_bf16 v[100:103], v[44:47], a[236:239], v[100:103]
    v_exp_f32 v16, v120
    v_add_f32 v7, v7, v18
    v_mfma_f32_16x16x32_bf16 v[104:107], v[40:43], v[192:195], v[104:107]
    s_mov_b32 m0, s26
    ds_read_b128 v[36:39], v3 offset:18432
    v_add_f32 v7, v7, v19
    v_mfma_f32_16x16x32_bf16 v[104:107], v[44:47], v[196:199], v[104:107]
    buffer_load_dwordx4 v4, s[4:7], s32 offen offset:0 sc1 lds
    v_lshlrev_b32 v50, 16, v58
    v_mfma_f32_16x16x32_bf16 v[108:111], v[40:43], v[216:219], v[108:111]
    v_exp_f32 v17, v121
    v_mfma_f32_16x16x32_bf16 v[108:111], v[44:47], v[220:223], v[108:111]
    s_waitcnt lgkmcnt(2)
    v_cvt_pk_bf16_f32 v185, v18, v19
    v_exp_f32 v18, v122
    v_mfma_f32_16x16x32_bf16 v[80:83], v[24:27], a[192:195], v[128:131]
    ds_read_b128 v[40:43], v2 offset:12416
    v_add_f32 v7, v7, v16
    v_mfma_f32_16x16x32_bf16 v[80:83], v[28:31], a[196:199], v[80:83]
    buffer_load_dwordx4 v4, s[4:7], s32 offen offset:1024 sc1 lds
    v_add_f32 v7, v7, v17
    v_mfma_f32_16x16x32_bf16 v[84:87], v[24:27], a[216:219], v[132:135]
    v_exp_f32 v19, v123
    v_mfma_f32_16x16x32_bf16 v[84:87], v[28:31], a[220:223], v[84:87]
    v_cvt_pk_bf16_f32 v186, v16, v17
    v_exp_f32 v16, v188
    v_mfma_f32_16x16x32_bf16 v[88:91], v[24:27], a[240:243], v[136:139]
    ds_read_b128 v[44:47], v3 offset:12416
    v_add_f32 v7, v7, v18
    v_mfma_f32_16x16x32_bf16 v[88:91], v[28:31], a[244:247], v[88:91]
    v_add_u32 v0, 1, v0
    buffer_store_dword v0, v13, s[20:23], 0 offen offset:32 sc1
    v_mfma_f32_16x16x32_bf16 v[92:95], v[24:27], v[200:203], v[140:143]
    v_add_f32 v7, v7, v19
    v_exp_f32 v17, v189
    v_cvt_pk_bf16_f32 v187, v18, v19
    v_exp_f32 v18, v190
    v_add_f32 v8, v8, v16
    v_add_f32 v8, v8, v17
    v_exp_f32 v19, v191
    v_cvt_pk_bf16_f32 v188, v16, v17
    v_exp_f32 v16, v124
    v_add_f32 v8, v8, v18
    v_add_f32 v8, v8, v19
    v_exp_f32 v17, v125
    v_cvt_pk_bf16_f32 v189, v18, v19
    v_exp_f32 v18, v126
    v_add_f32 v8, v8, v16
    v_add_f32 v8, v8, v17
    v_exp_f32 v19, v127
    v_cvt_pk_bf16_f32 v190, v16, v17
    v_add_f32 v8, v8, v18
    v_add_f32 v8, v8, v19
    v_cvt_pk_bf16_f32 v191, v18, v19
    v_mfma_f32_16x16x32_bf16 v[92:95], v[28:31], v[204:207], v[92:95]
    s_waitcnt lgkmcnt(2)
    v_and_b32 v51, s97, v58
    v_mul_f32_e64 v50, -v50, v48
    v_mul_f32_e64 v51, -v51, v49
    v_mfma_f32_16x16x32_bf16 v[112:115], v[32:35], a[192:195], v[128:131]
    ds_read_b128 v[24:27], v2 offset:18560
    v_cvt_f32_i32 v144, v144
    v_mfma_f32_16x16x32_bf16 v[112:115], v[36:39], a[196:199], v[112:115]
    buffer_load_dwordx4 v4, s[4:7], s32 offen offset:2048 sc1 lds
    v_cvt_f32_i32 v148, v148
    v_mfma_f32_16x16x32_bf16 v[116:119], v[32:35], a[216:219], v[132:135]
    s_mov_b32 s32, 196608
    v_fma_f32 v144, v144, v48, v50
    v_fma_f32 v148, v148, v49, v51
    v_mfma_f32_16x16x32_bf16 v[116:119], v[36:39], a[220:223], v[116:119]
    v_cvt_f32_i32 v145, v145
    v_cvt_f32_i32 v149, v149
    v_fma_f32 v145, v145, v48, v50
    v_mfma_f32_16x16x32_bf16 v[120:123], v[32:35], a[240:243], v[136:139]
    s_add_u32 s26, s26, 36864
    ds_read_b128 v[28:31], v3 offset:18560
    v_fma_f32 v149, v149, v49, v51
    v_mfma_f32_16x16x32_bf16 v[120:123], v[36:39], a[244:247], v[120:123]
    v_cvt_f32_i32 v146, v146
    v_cvt_f32_i32 v150, v150
    v_fma_f32 v146, v146, v48, v50
    v_mfma_f32_16x16x32_bf16 v[124:127], v[32:35], v[200:203], v[140:143]
    s_sub_u32 s57, s26, 147456
    v_fma_f32 v150, v150, v49, v51
    v_cvt_f32_i32 v147, v147
    v_mfma_f32_16x16x32_bf16 v[124:127], v[36:39], v[204:207], v[124:127]
    s_waitcnt lgkmcnt(2)
    v_cvt_f32_i32 v151, v151
    v_exp_f32 v16, v64
    v_mfma_f32_16x16x32_bf16 v[80:83], v[40:43], a[200:203], v[80:83]
    s_min_u32 s26, s26, s57
    ds_read_b128 v[32:35], v2 offset:12544
    v_fma_f32 v147, v147, v48, v50
    v_mfma_f32_16x16x32_bf16 v[80:83], v[44:47], a[204:207], v[80:83]
    v_exp_f32 v17, v65
    v_fma_f32 v151, v151, v49, v51
    v_mfma_f32_16x16x32_bf16 v[84:87], v[40:43], a[224:227], v[84:87]
    s_mov_b32 m0, s56
    v_exp_f32 v18, v66
    v_mfma_f32_16x16x32_bf16 v[84:87], v[44:47], a[228:231], v[84:87]
    buffer_load_dwordx4 v4, s[4:7], s27 offen offset:0 sc1 lds
    v_lshlrev_b32 v48, 16, v57
    v_mfma_f32_16x16x32_bf16 v[88:91], v[40:43], a[248:251], v[88:91]
    ds_read_b128 v[36:39], v3 offset:12544
    v_add_f32 v5, v5, v16
    v_mfma_f32_16x16x32_bf16 v[88:91], v[44:47], a[252:255], v[88:91]
    v_add_f32 v5, v5, v17
    v_and_b32 v49, s97, v57
    v_lshlrev_b32 v50, 16, v59
    v_mfma_f32_16x16x32_bf16 v[92:95], v[40:43], v[208:211], v[92:95]
    v_exp_f32 v19, v67
    v_mfma_f32_16x16x32_bf16 v[92:95], v[44:47], v[212:215], v[92:95]
    s_waitcnt lgkmcnt(2)
    buffer_load_dwordx4 v4, s[4:7], s27 offen offset:1024 sc1 lds
    v_cvt_pk_bf16_f32 v64, v16, v17
    v_mfma_f32_16x16x32_bf16 v[112:115], v[24:27], a[200:203], v[112:115]
    ds_read_b128 v[40:43], v2 offset:18688
    v_and_b32 v51, s97, v59
    v_mfma_f32_16x16x32_bf16 v[112:115], v[28:31], a[204:207], v[112:115]
    v_exp_f32 v16, v96
    v_add_f32 v5, v5, v18
    v_mfma_f32_16x16x32_bf16 v[116:119], v[24:27], a[224:227], v[116:119]
    v_add_f32 v5, v5, v19
    v_mul_f32_e64 v50, -v50, v48
    v_mfma_f32_16x16x32_bf16 v[116:119], v[28:31], a[228:231], v[116:119]
    s_waitcnt vmcnt(13)
    buffer_load_dwordx4 v4, s[4:7], s27 offen offset:2048 sc1 lds
    v_mul_f32_e64 v51, -v51, v49
    v_mfma_f32_16x16x32_bf16 v[120:123], v[24:27], a[248:251], v[120:123]
    s_add_u32 s27, s27, 24576
    ds_read_b128 v[44:47], v3 offset:18688
    v_cvt_f32_i32 v152, v152
    v_mfma_f32_16x16x32_bf16 v[120:123], v[28:31], a[252:255], v[120:123]
    s_waitcnt lgkmcnt(2)
    v_exp_f32 v17, v97
    v_cvt_pk_bf16_f32 v65, v18, v19
    v_mfma_f32_16x16x32_bf16 v[124:127], v[24:27], v[208:211], v[124:127]
    s_sub_u32 s58, s27, 196608
    v_exp_f32 v18, v98
    v_mfma_f32_16x16x32_bf16 v[124:127], v[28:31], v[212:215], v[124:127]
    s_barrier
    v_subrev_u32 v1, 49152, v1
    v_add_f32 v5, v5, v16
    v_mfma_f32_16x16x32_bf16 v[80:83], v[32:35], a[208:211], v[80:83]
    s_min_u32 s27, s27, s58
    ds_read_b128 v[24:27], v1 offset:0
    v_add_f32 v5, v5, v17
    v_mfma_f32_16x16x32_bf16 v[80:83], v[36:39], a[212:215], v[80:83]
    v_exp_f32 v19, v99
    v_cvt_f32_i32 v156, v156
    v_mfma_f32_16x16x32_bf16 v[84:87], v[32:35], a[232:235], v[84:87]
    s_add_u32 s56, s56, 12288
    v_cvt_pk_bf16_f32 v66, v16, v17
    v_fma_f32 v152, v152, v48, v50
    v_mfma_f32_16x16x32_bf16 v[84:87], v[36:39], a[236:239], v[84:87]
    v_exp_f32 v16, v68
    v_fma_f32 v156, v156, v49, v51
    v_mfma_f32_16x16x32_bf16 v[88:91], v[32:35], v[192:195], v[88:91]
    s_mov_b32 m0, s56
    ds_read_b128 v[28:31], v1 offset:12288
    v_add_f32 v5, v5, v18
    v_mfma_f32_16x16x32_bf16 v[88:91], v[36:39], v[196:199], v[88:91]
    s_waitcnt vmcnt(12)
    buffer_load_dwordx4 v4, s[4:7], s27 offen offset:0 sc1 lds
    v_add_f32 v5, v5, v19
    v_mfma_f32_16x16x32_bf16 v[92:95], v[32:35], v[216:219], v[92:95]
    v_exp_f32 v17, v69
    v_mfma_f32_16x16x32_bf16 v[92:95], v[36:39], v[220:223], v[92:95]
    s_waitcnt lgkmcnt(2)
    v_cvt_f32_i32 v153, v153
    v_cvt_pk_bf16_f32 v67, v18, v19
    v_cvt_f32_i32 v157, v157
    v_mfma_f32_16x16x32_bf16 v[112:115], v[40:43], a[208:211], v[112:115]
    ds_read_b128 v[32:35], v1 offset:1024
    v_fma_f32 v153, v153, v48, v50
    v_mfma_f32_16x16x32_bf16 v[112:115], v[44:47], a[212:215], v[112:115]
    s_waitcnt vmcnt(12)
    buffer_load_dwordx4 v4, s[4:7], s27 offen offset:1024 sc1 lds
    v_fma_f32 v157, v157, v49, v51
    v_mfma_f32_16x16x32_bf16 v[116:119], v[40:43], a[232:235], v[116:119]
    s_waitcnt vmcnt(12)
    buffer_load_dwordx4 v4, s[4:7], s27 offen offset:2048 sc1 lds
    v_mfma_f32_16x16x32_bf16 v[116:119], v[44:47], a[236:239], v[116:119]
    v_exp_f32 v18, v70
    v_add_f32 v6, v6, v16
    v_mfma_f32_16x16x32_bf16 v[120:123], v[40:43], v[192:195], v[120:123]
    s_add_u32 s27, s27, 24576
    ds_read_b128 v[36:39], v1 offset:13312
    v_add_f32 v6, v6, v17
    v_mfma_f32_16x16x32_bf16 v[120:123], v[44:47], v[196:199], v[120:123]
    v_exp_f32 v19, v71
    v_cvt_pk_bf16_f32 v68, v16, v17
    v_mfma_f32_16x16x32_bf16 v[124:127], v[40:43], v[216:219], v[124:127]
    s_sub_u32 s58, s27, 196608
    v_exp_f32 v16, v100
    v_mfma_f32_16x16x32_bf16 v[124:127], v[44:47], v[220:223], v[124:127]
    s_waitcnt lgkmcnt(2)
    v_cvt_f32_i32 v154, v154
    v_add_f32 v6, v6, v18
    v_cvt_f32_i32 v158, v158
    v_add_f32 v6, v6, v19
    v_fma_f32 v154, v154, v48, v50
    v_exp_f32 v17, v101
    v_fma_f32 v158, v158, v49, v51
    v_cvt_f32_i32 v155, v155
    v_cvt_pk_bf16_f32 v69, v18, v19
    v_cvt_f32_i32 v159, v159
    v_exp_f32 v18, v102
    v_fma_f32 v155, v155, v48, v50
    v_fma_f32 v159, v159, v49, v51
    v_add_f32 v6, v6, v16
    v_cvt_pk_bf16_f32 v144, v144, v148
    v_add_f32 v6, v6, v17
    v_cvt_pk_bf16_f32 v148, v145, v149
    v_exp_f32 v19, v103
    v_cvt_pk_bf16_f32 v145, v152, v156
    v_cvt_pk_bf16_f32 v149, v153, v157
    v_cvt_pk_bf16_f32 v70, v16, v17
    s_min_u32 s27, s27, s58
    v_cvt_pk_bf16_f32 v152, v146, v150
    v_add_f32 v6, v6, v18
    s_add_u32 s56, s56, 36864
    v_cvt_pk_bf16_f32 v153, v154, v158
    v_add_f32 v6, v6, v19
    s_sub_u32 s58, s56, 147456
    v_cvt_pk_bf16_f32 v156, v147, v151
    v_cvt_pk_bf16_f32 v71, v18, v19
    s_min_u32 s56, s56, s58
    v_cvt_pk_bf16_f32 v157, v155, v159
    s_mov_b32 s31, 7
    s_mul_i32 s46, s95, 24576
    s_mov_b32 s47, 12288
    v_mfma_f32_16x16x32_bf16 a[96:99], v[160:163], v[24:27], 0
    s_add_u32 s33, s33, 196608
    ds_read_b128 v[40:43], v1 offset:2048
    v_mfma_f32_16x16x32_bf16 a[96:99], v[168:171], v[28:31], a[96:99]
    s_add_u32 s34, s34, 196608
    v_exp_f32 v16, v72
    v_mfma_f32_16x16x32_bf16 a[144:147], v[164:167], v[24:27], 0
    s_add_u32 s36, s36, 1536
    ds_read_b128 v[44:47], v1 offset:14336
    v_mfma_f32_16x16x32_bf16 a[144:147], v[172:175], v[28:31], a[144:147]
    s_waitcnt lgkmcnt(2)
    v_exp_f32 v17, v73
    v_mfma_f32_16x16x32_bf16 a[100:103], v[160:163], v[32:35], 0
    ds_read_b128 v[24:27], v1 offset:3072
    v_mfma_f32_16x16x32_bf16 a[100:103], v[168:171], v[36:39], a[100:103]
    s_waitcnt vmcnt(12)
    buffer_load_dwordx2 v[56:57], v10, s[72:75], s36 offen offset:0
    v_mfma_f32_16x16x32_bf16 a[148:151], v[164:167], v[32:35], 0
    ds_read_b128 v[28:31], v1 offset:15360
    v_mfma_f32_16x16x32_bf16 a[148:151], v[172:175], v[36:39], a[148:151]
    s_waitcnt lgkmcnt(2)
    v_exp_f32 v18, v74
    v_mfma_f32_16x16x32_bf16 a[104:107], v[160:163], v[40:43], 0
    ds_read_b128 v[32:35], v1 offset:4096
    v_add_f32 v7, v7, v16
    v_mfma_f32_16x16x32_bf16 a[104:107], v[168:171], v[44:47], a[104:107]
    buffer_load_dwordx2 v[58:59], v10, s[76:79], s36 offen offset:0
    v_mfma_f32_16x16x32_bf16 a[152:155], v[164:167], v[40:43], 0
    ds_read_b128 v[36:39], v1 offset:16384
    v_add_f32 v7, v7, v17
    v_mfma_f32_16x16x32_bf16 a[152:155], v[172:175], v[44:47], a[152:155]
    s_waitcnt lgkmcnt(2)
    v_exp_f32 v19, v75
    v_mfma_f32_16x16x32_bf16 a[108:111], v[160:163], v[24:27], 0
    ds_read_b128 v[40:43], v1 offset:5120
    v_cvt_pk_bf16_f32 v72, v16, v17
    v_mfma_f32_16x16x32_bf16 a[108:111], v[168:171], v[28:31], a[108:111]
    s_waitcnt vmcnt(13)
    buffer_load_dwordx4 v[224:227], v9, s[64:67], s33 offen offset:0 nt
    v_mfma_f32_16x16x32_bf16 a[156:159], v[164:167], v[24:27], 0
    ds_read_b128 v[44:47], v1 offset:17408
    v_mfma_f32_16x16x32_bf16 a[156:159], v[172:175], v[28:31], a[156:159]
    s_waitcnt lgkmcnt(2)
    v_exp_f32 v16, v104
    v_mfma_f32_16x16x32_bf16 a[112:115], v[160:163], v[32:35], 0
    ds_read_b128 v[24:27], v1 offset:6144
    v_add_f32 v7, v7, v18
    v_mfma_f32_16x16x32_bf16 a[112:115], v[168:171], v[36:39], a[112:115]
    s_waitcnt vmcnt(13)
    buffer_load_dwordx4 v[228:231], v9, s[64:67], s33 offen offset:1536 nt
    v_add_f32 v7, v7, v19
    v_mfma_f32_16x16x32_bf16 a[160:163], v[164:167], v[32:35], 0
    ds_read_b128 v[28:31], v1 offset:18432
    v_mfma_f32_16x16x32_bf16 a[160:163], v[172:175], v[36:39], a[160:163]
    s_waitcnt lgkmcnt(2)
    v_exp_f32 v17, v105
    v_cvt_pk_bf16_f32 v73, v18, v19
    v_mfma_f32_16x16x32_bf16 a[116:119], v[160:163], v[40:43], 0
    ds_read_b128 v[32:35], v1 offset:7168
    v_mfma_f32_16x16x32_bf16 a[116:119], v[168:171], v[44:47], a[116:119]
    buffer_load_dwordx4 v[232:235], v9, s[64:67], s34 offen offset:0 nt
    v_mfma_f32_16x16x32_bf16 a[164:167], v[164:167], v[40:43], 0
    ds_read_b128 v[36:39], v1 offset:19456
    v_mfma_f32_16x16x32_bf16 a[164:167], v[172:175], v[44:47], a[164:167]
    s_waitcnt lgkmcnt(2)
    v_exp_f32 v18, v106
    v_add_f32 v7, v7, v16
    v_mfma_f32_16x16x32_bf16 a[120:123], v[160:163], v[24:27], 0
    ds_read_b128 v[40:43], v1 offset:8192
    v_add_f32 v7, v7, v17
    v_mfma_f32_16x16x32_bf16 a[120:123], v[168:171], v[28:31], a[120:123]
    s_waitcnt vmcnt(14)
    buffer_load_dwordx4 v[236:239], v9, s[64:67], s34 offen offset:1536 nt
    v_mfma_f32_16x16x32_bf16 a[168:171], v[164:167], v[24:27], 0
    ds_read_b128 v[44:47], v1 offset:20480
    v_mfma_f32_16x16x32_bf16 a[168:171], v[172:175], v[28:31], a[168:171]
    s_waitcnt lgkmcnt(2)
    v_exp_f32 v19, v107
    v_cvt_pk_bf16_f32 v74, v16, v17
    v_mfma_f32_16x16x32_bf16 a[124:127], v[160:163], v[32:35], 0
    ds_read_b128 v[24:27], v1 offset:9216
    v_mfma_f32_16x16x32_bf16 a[124:127], v[168:171], v[36:39], a[124:127]
    v_exp_f32 v16, v76
    v_add_f32 v7, v7, v18
    v_mfma_f32_16x16x32_bf16 a[172:175], v[164:167], v[32:35], 0
    s_waitcnt vmcnt(19)
    ds_read_b128 v[28:31], v1 offset:21504
    v_add_f32 v7, v7, v19
    v_mfma_f32_16x16x32_bf16 a[172:175], v[172:175], v[36:39], a[172:175]
    s_waitcnt lgkmcnt(2)
    v_exp_f32 v17, v77
    v_cvt_pk_bf16_f32 v75, v18, v19
    v_mfma_f32_16x16x32_bf16 a[128:131], v[160:163], v[40:43], 0
    s_add_u32 s29, s28, 49152
    ds_read_b128 v[32:35], v1 offset:10240
    v_lshlrev_b32 v48, 16, v60
    v_mfma_f32_16x16x32_bf16 a[128:131], v[168:171], v[44:47], a[128:131]
    v_exp_f32 v18, v78
    v_add_f32 v8, v8, v16
    v_mfma_f32_16x16x32_bf16 a[176:179], v[164:167], v[40:43], 0
    s_sub_u32 s3, s29, 147456
    ds_read_b128 v[36:39], v1 offset:22528
    v_add_f32 v8, v8, v17
    v_mfma_f32_16x16x32_bf16 a[176:179], v[172:175], v[44:47], a[176:179]
    s_waitcnt lgkmcnt(2)
    v_exp_f32 v19, v79
    v_mfma_f32_16x16x32_bf16 a[132:135], v[160:163], v[24:27], 0
    s_min_u32 s29, s29, s3
    ds_read_b128 v[40:43], v1 offset:11264
    v_cvt_pk_bf16_f32 v76, v16, v17
    v_mfma_f32_16x16x32_bf16 a[132:135], v[168:171], v[28:31], a[132:135]
    v_exp_f32 v16, v108
    v_mfma_f32_16x16x32_bf16 a[180:183], v[164:167], v[24:27], 0
    s_sub_u32 s3, s29, s28
    ds_read_b128 v[44:47], v1 offset:23552
    v_and_b32 v49, s97, v60
    v_mfma_f32_16x16x32_bf16 a[180:183], v[172:175], v[28:31], a[180:183]
    s_waitcnt lgkmcnt(2)
    v_add_u32 v1, 49152, v1
    v_add_f32 v8, v8, v18
    v_mfma_f32_16x16x32_bf16 a[136:139], v[160:163], v[32:35], 0
    ds_read_b128 v[24:27], v1 offset:0
    v_add_f32 v8, v8, v19
    v_mfma_f32_16x16x32_bf16 a[136:139], v[168:171], v[36:39], a[136:139]
    v_lshlrev_b32 v50, 16, v62
    v_exp_f32 v17, v109
    v_mfma_f32_16x16x32_bf16 a[184:187], v[164:167], v[32:35], 0
    ds_read_b128 v[28:31], v1 offset:12288
    v_and_b32 v51, s97, v62
    v_mfma_f32_16x16x32_bf16 a[184:187], v[172:175], v[36:39], a[184:187]
    s_waitcnt lgkmcnt(2)
    v_cvt_pk_bf16_f32 v77, v18, v19
    v_mul_f32_e64 v50, -v50, v48
    v_mfma_f32_16x16x32_bf16 a[140:143], v[160:163], v[40:43], 0
    s_mov_b32 s28, s29
    ds_read_b128 v[32:35], v1 offset:1024
    v_bfe_u32 v53, v4, 4, 6
    v_mfma_f32_16x16x32_bf16 a[140:143], v[168:171], v[44:47], a[140:143]
    v_exp_f32 v18, v110
    v_mul_f32_e64 v51, -v51, v49
    v_mfma_f32_16x16x32_bf16 a[188:191], v[164:167], v[40:43], 0
    ds_read_b128 v[36:39], v1 offset:13312
    v_lshlrev_b32 v53, 2, v53
    v_mfma_f32_16x16x32_bf16 a[188:191], v[172:175], v[44:47], a[188:191]
    s_waitcnt lgkmcnt(2)
    s_barrier
    v_add_f32 v8, v8, v16
    v_mfma_f32_16x16x32_bf16 a[96:99], v[176:179], v[24:27], a[96:99]
    ds_read_b128 v[40:43], v1 offset:2048
    buffer_load_dword v52, v53, s[20:23], s44 offen sc1
    v_mfma_f32_16x16x32_bf16 a[96:99], v[184:187], v[28:31], a[96:99]
    v_add_f32 v8, v8, v17
    v_cvt_f32_i32 v240, v240
    v_cvt_f32_i32 v244, v244
    v_mfma_f32_16x16x32_bf16 a[144:147], v[180:183], v[24:27], a[144:147]
    ds_read_b128 v[44:47], v1 offset:14336
    v_fma_f32 v240, v240, v48, v50
    v_mfma_f32_16x16x32_bf16 a[144:147], v[188:191], v[28:31], a[144:147]
    s_waitcnt lgkmcnt(2)
    v_exp_f32 v19, v111
    v_cvt_pk_bf16_f32 v78, v16, v17
    v_mfma_f32_16x16x32_bf16 a[100:103], v[176:179], v[32:35], a[100:103]
    s_mov_b32 m0, s56
    ds_read_b128 v[24:27], v1 offset:3072
    v_add_f32 v8, v8, v18
    v_mfma_f32_16x16x32_bf16 a[100:103], v[184:187], v[36:39], a[100:103]
    s_waitcnt vmcnt(15)
    buffer_load_dwordx4 v4, s[4:7], s27 offen offset:0 sc1 lds
    v_add_f32 v8, v8, v19
    v_mfma_f32_16x16x32_bf16 a[148:151], v[180:183], v[32:35], a[148:151]
    ds_read_b128 v[28:31], v1 offset:15360
    v_fma_f32 v244, v244, v49, v51
    v_mfma_f32_16x16x32_bf16 a[148:151], v[188:191], v[36:39], a[148:151]
    s_waitcnt lgkmcnt(2)
    v_cvt_pk_bf16_f32 v79, v18, v19
    v_cvt_f32_i32 v241, v241
    v_cvt_f32_i32 v245, v245
    v_mfma_f32_16x16x32_bf16 a[104:107], v[176:179], v[40:43], a[104:107]
    ds_read_b128 v[32:35], v1 offset:4096
    v_fma_f32 v241, v241, v48, v50
    v_mfma_f32_16x16x32_bf16 a[104:107], v[184:187], v[44:47], a[104:107]
    s_waitcnt vmcnt(14)
    buffer_load_dwordx4 v4, s[4:7], s27 offen offset:1024 sc1 lds
    v_fma_f32 v245, v245, v49, v51
    v_mfma_f32_16x16x32_bf16 a[152:155], v[180:183], v[40:43], a[152:155]
    ds_read_b128 v[36:39], v1 offset:16384
    v_cvt_f32_i32 v242, v242
    v_mfma_f32_16x16x32_bf16 a[152:155], v[188:191], v[44:47], a[152:155]
    s_waitcnt lgkmcnt(2)
    v_exp_f32 v16, v80
    v_cvt_f32_i32 v246, v246
    v_mfma_f32_16x16x32_bf16 a[108:111], v[176:179], v[24:27], a[108:111]
    ds_read_b128 v[40:43], v1 offset:5120
    v_fma_f32 v242, v242, v48, v50
    v_mfma_f32_16x16x32_bf16 a[108:111], v[184:187], v[28:31], a[108:111]
    s_waitcnt vmcnt(14)
    buffer_load_dwordx4 v4, s[4:7], s27 offen offset:2048 sc1 lds
    v_fma_f32 v246, v246, v49, v51
    v_mfma_f32_16x16x32_bf16 a[156:159], v[180:183], v[24:27], a[156:159]
    s_add_u32 s27, s27, 24576
    ds_read_b128 v[44:47], v1 offset:17408
    v_cvt_f32_i32 v243, v243
    v_mfma_f32_16x16x32_bf16 a[156:159], v[188:191], v[28:31], a[156:159]
    s_waitcnt lgkmcnt(2)
    v_exp_f32 v17, v81
    v_cvt_f32_i32 v247, v247
    v_mfma_f32_16x16x32_bf16 a[112:115], v[176:179], v[32:35], a[112:115]
    s_sub_u32 s58, s27, 196608
    ds_read_b128 v[24:27], v1 offset:6144
    v_fma_f32 v243, v243, v48, v50
    v_mfma_f32_16x16x32_bf16 a[112:115], v[184:187], v[36:39], a[112:115]
    v_exp_f32 v18, v82
    v_add_f32 v5, v5, v16
    v_mfma_f32_16x16x32_bf16 a[160:163], v[180:183], v[32:35], a[160:163]
    s_min_u32 s27, s27, s58
    ds_read_b128 v[28:31], v1 offset:18432
    v_add_f32 v5, v5, v17
    v_mfma_f32_16x16x32_bf16 a[160:163], v[188:191], v[36:39], a[160:163]
    s_waitcnt lgkmcnt(2)
    v_exp_f32 v19, v83
    v_cvt_pk_bf16_f32 v80, v16, v17
    v_mfma_f32_16x16x32_bf16 a[116:119], v[176:179], v[40:43], a[116:119]
    s_add_u32 s56, s56, 12288
    ds_read_b128 v[32:35], v1 offset:7168
    v_fma_f32 v247, v247, v49, v51
    v_mfma_f32_16x16x32_bf16 a[116:119], v[184:187], v[44:47], a[116:119]
    v_exp_f32 v16, v112
    v_add_f32 v5, v5, v18
    v_mfma_f32_16x16x32_bf16 a[164:167], v[180:183], v[40:43], a[164:167]
    ds_read_b128 v[36:39], v1 offset:19456
    v_add_u32 v2, s3, v2
    v_add_u32 v3, s3, v3
    v_mfma_f32_16x16x32_bf16 a[164:167], v[188:191], v[44:47], a[164:167]
    s_waitcnt lgkmcnt(2)
    v_add_f32 v5, v5, v19
    v_exp_f32 v17, v113
    v_mfma_f32_16x16x32_bf16 a[120:123], v[176:179], v[24:27], a[120:123]
    s_mov_b32 m0, s56
    ds_read_b128 v[40:43], v1 offset:8192
    v_cvt_pk_bf16_f32 v81, v18, v19
    v_mfma_f32_16x16x32_bf16 a[120:123], v[184:187], v[28:31], a[120:123]
    s_waitcnt vmcnt(14)
    buffer_load_dwordx4 v4, s[4:7], s27 offen offset:0 sc1 lds
    v_lshlrev_b32 v48, 16, v61
    v_mfma_f32_16x16x32_bf16 a[168:171], v[180:183], v[24:27], a[168:171]
    ds_read_b128 v[44:47], v1 offset:20480
    v_and_b32 v49, s97, v61
    v_mfma_f32_16x16x32_bf16 a[168:171], v[188:191], v[28:31], a[168:171]
    s_waitcnt lgkmcnt(2)
    v_exp_f32 v18, v114
    v_add_f32 v5, v5, v16
    v_mfma_f32_16x16x32_bf16 a[124:127], v[176:179], v[32:35], a[124:127]
    ds_read_b128 v[24:27], v1 offset:9216
    v_add_f32 v5, v5, v17
    v_mfma_f32_16x16x32_bf16 a[124:127], v[184:187], v[36:39], a[124:127]
    s_waitcnt vmcnt(14)
    buffer_load_dwordx4 v4, s[4:7], s27 offen offset:1024 sc1 lds
    v_lshlrev_b32 v50, 16, v63
    v_mfma_f32_16x16x32_bf16 a[172:175], v[180:183], v[32:35], a[172:175]
    ds_read_b128 v[28:31], v1 offset:21504
    v_and_b32 v51, s97, v63
    v_mfma_f32_16x16x32_bf16 a[172:175], v[188:191], v[36:39], a[172:175]
    s_waitcnt lgkmcnt(2)
    v_exp_f32 v19, v115
    v_cvt_pk_bf16_f32 v82, v16, v17
    v_mfma_f32_16x16x32_bf16 a[128:131], v[176:179], v[40:43], a[128:131]
    ds_read_b128 v[32:35], v1 offset:10240
    v_mul_f32_e64 v50, -v50, v48
    v_mfma_f32_16x16x32_bf16 a[128:131], v[184:187], v[44:47], a[128:131]
    s_waitcnt vmcnt(14)
    buffer_load_dwordx4 v4, s[4:7], s27 offen offset:2048 sc1 lds
    v_mul_f32_e64 v51, -v51, v49
    v_mfma_f32_16x16x32_bf16 a[176:179], v[180:183], v[40:43], a[176:179]
    ds_read_b128 v[36:39], v1 offset:22528
    v_cvt_f32_i32 v248, v248
    v_mfma_f32_16x16x32_bf16 a[176:179], v[188:191], v[44:47], a[176:179]
    s_waitcnt lgkmcnt(2)
    v_exp_f32 v16, v84
    v_add_f32 v5, v5, v18
    v_mfma_f32_16x16x32_bf16 a[132:135], v[176:179], v[24:27], a[132:135]
    ds_read_b128 v[40:43], v1 offset:11264
    v_add_f32 v5, v5, v19
    v_mfma_f32_16x16x32_bf16 a[132:135], v[184:187], v[28:31], a[132:135]
    s_waitcnt vmcnt(19)
    v_exp_f32 v17, v85
    v_cvt_f32_i32 v252, v252
    v_mfma_f32_16x16x32_bf16 a[180:183], v[180:183], v[24:27], a[180:183]
    s_mov_b32 s27, 208896
    ds_read_b128 v[44:47], v1 offset:23552
    v_cvt_pk_bf16_f32 v83, v18, v19
    v_mfma_f32_16x16x32_bf16 a[180:183], v[188:191], v[28:31], a[180:183]
    s_waitcnt lgkmcnt(2)
    s_barrier
    v_fma_f32 v248, v248, v48, v50
    v_mfma_f32_16x16x32_bf16 a[136:139], v[176:179], v[32:35], a[136:139]
    s_add_u32 s56, s56, 36864
    ds_read_b128 v[24:27], v2 offset:0
    v_fma_f32 v252, v252, v49, v51
    v_mfma_f32_16x16x32_bf16 a[136:139], v[184:187], v[36:39], a[136:139]
    v_exp_f32 v18, v86
    v_add_f32 v6, v6, v16
    v_mfma_f32_16x16x32_bf16 a[184:187], v[180:183], v[32:35], a[184:187]
    s_sub_u32 s58, s56, 147456
    ds_read_b128 v[28:31], v3 offset:0
    v_cvt_f32_i32 v249, v249
    v_mfma_f32_16x16x32_bf16 a[184:187], v[188:191], v[36:39], a[184:187]
    s_waitcnt lgkmcnt(2)
    v_add_f32 v6, v6, v17
    v_cvt_f32_i32 v253, v253
    v_fma_f32 v249, v249, v48, v50
    v_mfma_f32_16x16x32_bf16 a[140:143], v[176:179], v[40:43], a[140:143]
    s_nop 0
    ds_read_b128 v[32:35], v2 offset:6144
    v_fma_f32 v253, v253, v49, v51
    v_mfma_f32_16x16x32_bf16 a[140:143], v[184:187], v[44:47], a[140:143]
    s_min_u32 s56, s56, s58
    v_exp_f32 v19, v87
    v_cvt_pk_bf16_f32 v84, v16, v17
    v_mfma_f32_16x16x32_bf16 a[188:191], v[180:183], v[40:43], a[188:191]
    s_waitcnt lgkmcnt(1)
    ds_read_b128 v[36:39], v3 offset:6144
    v_exp_f32 v16, v116
    v_cvt_f32_i32 v250, v250
    v_add_f32 v6, v6, v18
    v_cvt_f32_i32 v254, v254
    v_add_f32 v6, v6, v19
    v_fma_f32 v250, v250, v48, v50
    v_exp_f32 v17, v117
    v_fma_f32 v254, v254, v49, v51
    v_cvt_f32_i32 v251, v251
    v_cvt_pk_bf16_f32 v85, v18, v19
    v_cvt_f32_i32 v255, v255
    v_exp_f32 v18, v118
    v_fma_f32 v251, v251, v48, v50
    v_fma_f32 v255, v255, v49, v51
    v_add_f32 v6, v6, v16
    v_cvt_pk_bf16_f32 v146, v240, v244
    v_add_f32 v6, v6, v17
    v_cvt_pk_bf16_f32 v150, v241, v245
    v_exp_f32 v19, v119
    v_cvt_pk_bf16_f32 v147, v248, v252
    v_cvt_pk_bf16_f32 v151, v249, v253
    v_cvt_pk_bf16_f32 v86, v16, v17
    v_cvt_pk_bf16_f32 v154, v242, v246
    v_add_f32 v6, v6, v18
    v_cvt_pk_bf16_f32 v155, v250, v254
    v_add_f32 v6, v6, v19
    v_cvt_pk_bf16_f32 v158, v243, v247
    v_cvt_pk_bf16_f32 v87, v18, v19
    v_cvt_pk_bf16_f32 v159, v251, v255
    v_mfma_f32_16x16x32_bf16 a[188:191], v[188:191], v[44:47], a[188:191]
    s_branch L_join
.p2align 6
L_loop:
    v_mfma_f32_16x16x32_bf16 v[160:163], v[24:27], a[192:195], v[128:131]
    s_mov_b32 m0, s56
    ds_read_b128 v[40:43], v2 offset:128
    v_fma_f32 v250, v250, v48, v50
    v_mfma_f32_16x16x32_bf16 v[160:163], v[28:31], a[196:199], v[160:163]
    buffer_load_dwordx4 v4, s[4:7], s27 offen offset:0 sc1 lds
    v_mfma_f32_16x16x32_bf16 v[164:167], v[24:27], a[216:219], v[132:135]
    v_exp_f32 v16, v88
    v_mfma_f32_16x16x32_bf16 v[164:167], v[28:31], a[220:223], v[164:167]
    v_exp_f32 v17, v89
    v_mfma_f32_16x16x32_bf16 v[168:171], v[24:27], a[240:243], v[136:139]
    ds_read_b128 v[44:47], v3 offset:128
    v_fma_f32 v251, v251, v49, v51
    v_mfma_f32_16x16x32_bf16 v[168:171], v[28:31], a[244:247], v[168:171]
    v_exp_f32 v18, v90
    v_mfma_f32_16x16x32_bf16 v[172:175], v[24:27], v[200:203], v[140:143]
    v_add_f32 v7, v7, v16
    v_add_f32 v7, v7, v17
    v_mfma_f32_16x16x32_bf16 v[172:175], v[28:31], v[204:207], v[172:175]
    s_waitcnt lgkmcnt(2)
    v_exp_f32 v19, v91
    v_mfma_f32_16x16x32_bf16 v[96:99], v[32:35], a[192:195], v[128:131]
    ds_read_b128 v[24:27], v2 offset:6272
    v_cvt_pk_bf16_f32 v235, v250, v251
    v_mfma_f32_16x16x32_bf16 v[96:99], v[36:39], a[196:199], v[96:99]
    buffer_load_dwordx4 v4, s[4:7], s27 offen offset:1024 sc1 lds
    v_mfma_f32_16x16x32_bf16 v[100:103], v[32:35], a[216:219], v[132:135]
    v_cvt_pk_bf16_f32 v88, v16, v17
    v_cvt_f32_i32 v254, v254
    v_mfma_f32_16x16x32_bf16 v[100:103], v[36:39], a[220:223], v[100:103]
    v_exp_f32 v16, v120
    v_mfma_f32_16x16x32_bf16 v[104:107], v[32:35], a[240:243], v[136:139]
    ds_read_b128 v[28:31], v3 offset:6272
    v_add_f32 v7, v7, v18
    v_mfma_f32_16x16x32_bf16 v[104:107], v[36:39], a[244:247], v[104:107]
    v_add_f32 v7, v7, v19
    v_cvt_f32_i32 v255, v255
    v_mfma_f32_16x16x32_bf16 v[108:111], v[32:35], v[200:203], v[140:143]
    v_exp_f32 v17, v121
    v_mfma_f32_16x16x32_bf16 v[108:111], v[36:39], v[204:207], v[108:111]
    s_waitcnt lgkmcnt(2)
    v_cvt_pk_bf16_f32 v89, v18, v19
    v_fma_f32 v254, v254, v48, v50
    v_mfma_f32_16x16x32_bf16 v[160:163], v[40:43], a[200:203], v[160:163]
    ds_read_b128 v[32:35], v2 offset:256
    v_mfma_f32_16x16x32_bf16 v[160:163], v[44:47], a[204:207], v[160:163]
    v_exp_f32 v18, v122
    v_mfma_f32_16x16x32_bf16 v[164:167], v[40:43], a[224:227], v[164:167]
    v_add_f32 v7, v7, v16
    v_add_f32 v7, v7, v17
    v_mfma_f32_16x16x32_bf16 v[164:167], v[44:47], a[228:231], v[164:167]
    buffer_load_dwordx4 v4, s[4:7], s27 offen offset:2048 sc1 lds
    v_mfma_f32_16x16x32_bf16 v[168:171], v[40:43], a[248:251], v[168:171]
    ds_read_b128 v[36:39], v3 offset:256
    v_fma_f32 v255, v255, v49, v51
    v_mfma_f32_16x16x32_bf16 v[168:171], v[44:47], a[252:255], v[168:171]
    v_exp_f32 v19, v123
    v_mfma_f32_16x16x32_bf16 v[172:175], v[40:43], v[208:211], v[172:175]
    v_cvt_pk_bf16_f32 v90, v16, v17
    v_cvt_pk_bf16_f32 v239, v254, v255
    v_mfma_f32_16x16x32_bf16 v[172:175], v[44:47], v[212:215], v[172:175]
    s_waitcnt lgkmcnt(2)
    v_exp_f32 v16, v92
    v_mfma_f32_16x16x32_bf16 v[96:99], v[24:27], a[200:203], v[96:99]
    ds_read_b128 v[40:43], v2 offset:6400
    v_add_f32 v7, v7, v18
    v_mfma_f32_16x16x32_bf16 v[96:99], v[28:31], a[204:207], v[96:99]
    s_add_u32 s27, s27, 24576
    v_add_f32 v7, v7, v19
    v_mfma_f32_16x16x32_bf16 v[100:103], v[24:27], a[224:227], v[100:103]
    v_exp_f32 v17, v93
    v_mfma_f32_16x16x32_bf16 v[100:103], v[28:31], a[228:231], v[100:103]
    v_cvt_pk_bf16_f32 v91, v18, v19
    v_mfma_f32_16x16x32_bf16 v[104:107], v[24:27], a[248:251], v[104:107]
    ds_read_b128 v[44:47], v3 offset:6400
    v_mfma_f32_16x16x32_bf16 v[104:107], v[28:31], a[252:255], v[104:107]
    v_exp_f32 v18, v94
    v_mfma_f32_16x16x32_bf16 v[108:111], v[24:27], v[208:211], v[108:111]
    s_add_u32 s29, s30, 49152
    v_add_f32 v8, v8, v16
    v_add_f32 v8, v8, v17
    v_mfma_f32_16x16x32_bf16 v[108:111], v[28:31], v[212:215], v[108:111]
    s_waitcnt lgkmcnt(2)
    v_exp_f32 v19, v95
    v_mfma_f32_16x16x32_bf16 v[160:163], v[32:35], a[208:211], v[160:163]
    s_waitcnt vmcnt(11)
    ds_read_b128 v[24:27], v2 offset:12288
    v_cvt_pk_bf16_f32 v92, v16, v17
    v_mfma_f32_16x16x32_bf16 v[160:163], v[36:39], a[212:215], v[160:163]
    s_sub_u32 s3, s29, 147456
    buffer_load_dwordx2 v[60:61], off, s[80:83], s37 offset:8
    v_mfma_f32_16x16x32_bf16 v[164:167], v[32:35], a[232:235], v[164:167]
    s_add_u32 s56, s56, 12288
    v_exp_f32 v16, v124
    v_mfma_f32_16x16x32_bf16 v[164:167], v[36:39], a[236:239], v[164:167]
    s_min_u32 s29, s29, s3
    v_add_f32 v8, v8, v18
    v_lshlrev_b32 v48, 16, v56
    v_mfma_f32_16x16x32_bf16 v[168:171], v[32:35], v[192:195], v[168:171]
    s_mov_b32 m0, s56
    ds_read_b128 v[28:31], v3 offset:12288
    v_add_f32 v8, v8, v19
    v_mfma_f32_16x16x32_bf16 v[168:171], v[36:39], v[196:199], v[168:171]
    buffer_load_dwordx2 v[62:63], off, s[84:87], s37 offset:8
    v_mfma_f32_16x16x32_bf16 v[172:175], v[32:35], v[216:219], v[172:175]
    v_exp_f32 v17, v125
    v_mfma_f32_16x16x32_bf16 v[172:175], v[36:39], v[220:223], v[172:175]
    s_waitcnt lgkmcnt(2)
    v_cvt_pk_bf16_f32 v93, v18, v19
    v_and_b32 v49, s97, v56
    v_mfma_f32_16x16x32_bf16 v[96:99], v[40:43], a[208:211], v[96:99]
    ds_read_b128 v[32:35], v2 offset:18432
    v_lshlrev_b32 v50, 16, v58
    v_mfma_f32_16x16x32_bf16 v[96:99], v[44:47], a[212:215], v[96:99]
    s_sub_u32 s3, s29, s30
    v_exp_f32 v18, v126
    v_mfma_f32_16x16x32_bf16 v[100:103], v[40:43], a[232:235], v[100:103]
    v_add_f32 v8, v8, v16
    v_add_f32 v8, v8, v17
    v_mfma_f32_16x16x32_bf16 v[100:103], v[44:47], a[236:239], v[100:103]
    buffer_load_dwordx4 v4, s[4:7], s27 offen offset:0 sc1 lds
    v_mfma_f32_16x16x32_bf16 v[104:107], v[40:43], v[192:195], v[104:107]
    ds_read_b128 v[36:39], v3 offset:18432
    v_and_b32 v51, s97, v58
    v_mfma_f32_16x16x32_bf16 v[104:107], v[44:47], v[196:199], v[104:107]
    v_exp_f32 v19, v127
    v_mfma_f32_16x16x32_bf16 v[108:111], v[40:43], v[216:219], v[108:111]
    v_cvt_pk_bf16_f32 v94, v16, v17
    v_add_f32 v8, v8, v18
    v_mfma_f32_16x16x32_bf16 v[108:111], v[44:47], v[220:223], v[108:111]
    s_waitcnt lgkmcnt(2)
    buffer_load_dwordx4 v[240:243], v12, s[68:71], s16 offen offset:0 nt
    v_mfma_f32_16x16x32_bf16 v[176:179], v[24:27], a[192:195], v[128:131]
    ds_read_b128 v[40:43], v2 offset:12416
    v_add_f32 v8, v8, v19
    v_mfma_f32_16x16x32_bf16 v[176:179], v[28:31], a[196:199], v[176:179]
    s_mov_b32 s30, s29
    v_cvt_pk_bf16_f32 v95, v18, v19
    v_mul_f32_e64 v50, -v50, v48
    v_mfma_f32_16x16x32_bf16 v[180:183], v[24:27], a[216:219], v[132:135]
    v_exp_f32 v16, v160
    v_mfma_f32_16x16x32_bf16 v[180:183], v[28:31], a[220:223], v[180:183]
    buffer_load_dwordx4 v4, s[4:7], s27 offen offset:1024 sc1 lds
    v_mfma_f32_16x16x32_bf16 v[184:187], v[24:27], a[240:243], v[136:139]
    ds_read_b128 v[44:47], v3 offset:12416
    v_mul_f32_e64 v51, -v51, v49
    v_mfma_f32_16x16x32_bf16 v[184:187], v[28:31], a[244:247], v[184:187]
    v_exp_f32 v17, v161
    v_mfma_f32_16x16x32_bf16 v[188:191], v[24:27], v[200:203], v[140:143]
    v_exp_f32 v18, v162
    v_mfma_f32_16x16x32_bf16 v[188:191], v[28:31], v[204:207], v[188:191]
    s_waitcnt lgkmcnt(2)
    buffer_load_dwordx4 v[244:247], v12, s[68:71], s16 offen offset:768 nt
    v_mfma_f32_16x16x32_bf16 v[112:115], v[32:35], a[192:195], v[128:131]
    ds_read_b128 v[24:27], v2 offset:18560
    v_add_f32 v5, v5, v16
    v_mfma_f32_16x16x32_bf16 v[112:115], v[36:39], a[196:199], v[112:115]
    v_add_f32 v5, v5, v17
    v_cvt_f32_i32 v144, v144
    v_mfma_f32_16x16x32_bf16 v[116:119], v[32:35], a[216:219], v[132:135]
    v_exp_f32 v19, v163
    v_mfma_f32_16x16x32_bf16 v[116:119], v[36:39], a[220:223], v[116:119]
    v_cvt_pk_bf16_f32 v160, v16, v17
    v_cvt_f32_i32 v148, v148
    v_mfma_f32_16x16x32_bf16 v[120:123], v[32:35], a[240:243], v[136:139]
    ds_read_b128 v[28:31], v3 offset:18560
    v_fma_f32 v144, v144, v48, v50
    v_mfma_f32_16x16x32_bf16 v[120:123], v[36:39], a[244:247], v[120:123]
    buffer_load_dwordx4 v[248:251], v12, s[68:71], s16 offen offset:1536 nt
    v_mfma_f32_16x16x32_bf16 v[124:127], v[32:35], v[200:203], v[140:143]
    v_exp_f32 v16, v96
    v_mfma_f32_16x16x32_bf16 v[124:127], v[36:39], v[204:207], v[124:127]
    s_waitcnt lgkmcnt(2)
    v_add_f32 v5, v5, v18
    v_add_f32 v5, v5, v19
    v_mfma_f32_16x16x32_bf16 v[176:179], v[40:43], a[200:203], v[176:179]
    ds_read_b128 v[32:35], v2 offset:12544
    v_fma_f32 v148, v148, v49, v51
    v_mfma_f32_16x16x32_bf16 v[176:179], v[44:47], a[204:207], v[176:179]
    buffer_load_dwordx4 v4, s[4:7], s27 offen offset:2048 sc1 lds
    v_mfma_f32_16x16x32_bf16 v[180:183], v[40:43], a[224:227], v[180:183]
    v_exp_f32 v17, v97
    v_mfma_f32_16x16x32_bf16 v[180:183], v[44:47], a[228:231], v[180:183]
    v_cvt_pk_bf16_f32 v161, v18, v19
    v_cvt_f32_i32 v145, v145
    v_mfma_f32_16x16x32_bf16 v[184:187], v[40:43], a[248:251], v[184:187]
    ds_read_b128 v[36:39], v3 offset:12544
    v_add_u32 v1, s3, v1
    v_mfma_f32_16x16x32_bf16 v[184:187], v[44:47], a[252:255], v[184:187]
    buffer_load_dwordx4 v[252:255], v12, s[68:71], s16 offen offset:2304 nt
    v_mfma_f32_16x16x32_bf16 v[188:191], v[40:43], v[208:211], v[188:191]
    v_exp_f32 v18, v98
    v_mfma_f32_16x16x32_bf16 v[188:191], v[44:47], v[212:215], v[188:191]
    s_waitcnt lgkmcnt(2)
    v_add_f32 v5, v5, v16
    v_add_f32 v5, v5, v17
    v_mfma_f32_16x16x32_bf16 v[112:115], v[24:27], a[200:203], v[112:115]
    ds_read_b128 v[40:43], v2 offset:18688
    v_cvt_f32_i32 v149, v149
    v_mfma_f32_16x16x32_bf16 v[112:115], v[28:31], a[204:207], v[112:115]
    v_exp_f32 v19, v99
    v_cvt_pk_bf16_f32 v162, v16, v17
    v_mfma_f32_16x16x32_bf16 v[116:119], v[24:27], a[224:227], v[116:119]
    v_exp_f32 v16, v164
    v_mfma_f32_16x16x32_bf16 v[116:119], v[28:31], a[228:231], v[116:119]
    s_add_u32 s27, s27, 24576
    v_add_f32 v5, v5, v18
    v_add_f32 v5, v5, v19
    v_mfma_f32_16x16x32_bf16 v[120:123], v[24:27], a[248:251], v[120:123]
    s_add_u32 s56, s56, 36864
    ds_read_b128 v[44:47], v3 offset:18688
    v_fma_f32 v145, v145, v48, v50
    v_mfma_f32_16x16x32_bf16 v[120:123], v[28:31], a[252:255], v[120:123]
    s_waitcnt lgkmcnt(2)
    v_exp_f32 v17, v165
    v_mfma_f32_16x16x32_bf16 v[124:127], v[24:27], v[208:211], v[124:127]
    s_waitcnt vmcnt(12)
    v_cvt_pk_bf16_f32 v163, v18, v19
    v_fma_f32 v149, v149, v49, v51
    v_mfma_f32_16x16x32_bf16 v[124:127], v[28:31], v[212:215], v[124:127]
    s_barrier
    s_sub_u32 s58, s56, 147456
    v_mfma_f32_16x16x32_bf16 v[176:179], v[32:35], a[208:211], v[176:179]
    s_min_u32 s56, s56, s58
    ds_read_b128 v[24:27], v1 offset:0
    v_cvt_f32_i32 v146, v146
    v_mfma_f32_16x16x32_bf16 v[176:179], v[36:39], a[212:215], v[176:179]
    v_exp_f32 v18, v166
    v_mfma_f32_16x16x32_bf16 v[180:183], v[32:35], a[232:235], v[180:183]
    v_add_f32 v6, v6, v16
    v_add_f32 v6, v6, v17
    v_mfma_f32_16x16x32_bf16 v[180:183], v[36:39], a[236:239], v[180:183]
    v_exp_f32 v19, v167
    v_mfma_f32_16x16x32_bf16 v[184:187], v[32:35], v[192:195], v[184:187]
    ds_read_b128 v[28:31], v1 offset:12288
    v_cvt_pk_bf16_f32 v164, v16, v17
    v_mfma_f32_16x16x32_bf16 v[184:187], v[36:39], v[196:199], v[184:187]
    v_exp_f32 v16, v100
    v_mfma_f32_16x16x32_bf16 v[188:191], v[32:35], v[216:219], v[188:191]
    v_add_f32 v6, v6, v18
    v_add_f32 v6, v6, v19
    v_mfma_f32_16x16x32_bf16 v[188:191], v[36:39], v[220:223], v[188:191]
    s_waitcnt lgkmcnt(2)
    v_exp_f32 v17, v101
    v_mfma_f32_16x16x32_bf16 v[112:115], v[40:43], a[208:211], v[112:115]
    ds_read_b128 v[32:35], v1 offset:1024
    v_cvt_pk_bf16_f32 v165, v18, v19
    v_mfma_f32_16x16x32_bf16 v[112:115], v[44:47], a[212:215], v[112:115]
    v_exp_f32 v18, v102
    v_mfma_f32_16x16x32_bf16 v[116:119], v[40:43], a[232:235], v[116:119]
    v_add_f32 v6, v6, v16
    v_cvt_f32_i32 v150, v150
    v_mfma_f32_16x16x32_bf16 v[116:119], v[44:47], a[236:239], v[116:119]
    v_add_f32 v6, v6, v17
    v_fma_f32 v146, v146, v48, v50
    v_mfma_f32_16x16x32_bf16 v[120:123], v[40:43], v[192:195], v[120:123]
    ds_read_b128 v[36:39], v1 offset:13312
    v_fma_f32 v150, v150, v49, v51
    v_mfma_f32_16x16x32_bf16 v[120:123], v[44:47], v[196:199], v[120:123]
    v_exp_f32 v19, v103
    v_mfma_f32_16x16x32_bf16 v[124:127], v[40:43], v[216:219], v[124:127]
    v_cvt_pk_bf16_f32 v166, v16, v17
    v_add_f32 v6, v6, v18
    v_mfma_f32_16x16x32_bf16 v[124:127], v[44:47], v[220:223], v[124:127]
    s_waitcnt lgkmcnt(2)
    v_add_f32 v6, v6, v19
    v_cvt_pk_bf16_f32 v167, v18, v19
    v_mfma_f32_16x16x32_bf16 a[0:3], v[64:67], v[24:27], a[0:3]
    ds_read_b128 v[40:43], v1 offset:2048
    v_cvt_f32_i32 v147, v147
    v_mfma_f32_16x16x32_bf16 a[0:3], v[80:83], v[28:31], a[0:3]
    buffer_store_dwordx4 v[224:227], v11, s[4:7], s33 offen offset:0 sc1
    v_mfma_f32_16x16x32_bf16 a[48:51], v[68:71], v[24:27], a[48:51]
    v_exp_f32 v16, v168
    v_mfma_f32_16x16x32_bf16 a[48:51], v[84:87], v[28:31], a[48:51]
    v_exp_f32 v17, v169
    v_mfma_f32_16x16x32_bf16 a[96:99], v[72:75], v[24:27], a[96:99]
    ds_read_b128 v[44:47], v1 offset:14336
    v_xor_b32 v55, 16, v11
    v_mfma_f32_16x16x32_bf16 a[96:99], v[88:91], v[28:31], a[96:99]
    v_exp_f32 v18, v170
    v_mfma_f32_16x16x32_bf16 a[144:147], v[76:79], v[24:27], a[144:147]
    v_add_f32 v7, v7, v16
    v_add_f32 v7, v7, v17
    v_mfma_f32_16x16x32_bf16 a[144:147], v[92:95], v[28:31], a[144:147]
    s_waitcnt lgkmcnt(2)
    v_exp_f32 v19, v171
    v_mfma_f32_16x16x32_bf16 a[4:7], v[64:67], v[32:35], a[4:7]
    ds_read_b128 v[24:27], v1 offset:3072
    v_cvt_f32_i32 v151, v151
    v_mfma_f32_16x16x32_bf16 a[4:7], v[80:83], v[36:39], a[4:7]
    buffer_store_dwordx4 v[228:231], v55, s[4:7], s33 offen offset:768 sc1
    v_mfma_f32_16x16x32_bf16 a[52:55], v[68:71], v[32:35], a[52:55]
    v_cvt_pk_bf16_f32 v168, v16, v17
    v_fma_f32 v147, v147, v48, v50
    v_mfma_f32_16x16x32_bf16 a[52:55], v[84:87], v[36:39], a[52:55]
    v_exp_f32 v16, v104
    v_mfma_f32_16x16x32_bf16 a[100:103], v[72:75], v[32:35], a[100:103]
    ds_read_b128 v[28:31], v1 offset:15360
    v_add_f32 v7, v7, v18
    v_mfma_f32_16x16x32_bf16 a[100:103], v[88:91], v[36:39], a[100:103]
    v_add_f32 v7, v7, v19
    v_xor_b32 v54, 32, v11
    v_mfma_f32_16x16x32_bf16 a[148:151], v[76:79], v[32:35], a[148:151]
    v_exp_f32 v17, v105
    v_mfma_f32_16x16x32_bf16 a[148:151], v[92:95], v[36:39], a[148:151]
    s_waitcnt lgkmcnt(2)
    v_cvt_pk_bf16_f32 v169, v18, v19
    v_fma_f32 v151, v151, v49, v51
    v_mfma_f32_16x16x32_bf16 a[8:11], v[64:67], v[40:43], a[8:11]
    ds_read_b128 v[32:35], v1 offset:4096
    v_lshlrev_b32 v48, 16, v57
    v_mfma_f32_16x16x32_bf16 a[8:11], v[80:83], v[44:47], a[8:11]
    buffer_store_dwordx4 v[232:235], v54, s[4:7], s33 offen offset:1536 sc1
    v_mfma_f32_16x16x32_bf16 a[56:59], v[68:71], v[40:43], a[56:59]
    v_exp_f32 v18, v106
    v_mfma_f32_16x16x32_bf16 a[56:59], v[84:87], v[44:47], a[56:59]
    v_add_f32 v7, v7, v16
    v_add_f32 v7, v7, v17
    v_mfma_f32_16x16x32_bf16 a[104:107], v[72:75], v[40:43], a[104:107]
    ds_read_b128 v[36:39], v1 offset:16384
    v_xor_b32 v55, 48, v11
    v_mfma_f32_16x16x32_bf16 a[104:107], v[88:91], v[44:47], a[104:107]
    v_exp_f32 v19, v107
    v_mfma_f32_16x16x32_bf16 a[152:155], v[76:79], v[40:43], a[152:155]
    v_cvt_pk_bf16_f32 v170, v16, v17
    v_and_b32 v49, s97, v57
    v_mfma_f32_16x16x32_bf16 a[152:155], v[92:95], v[44:47], a[152:155]
    s_waitcnt lgkmcnt(2)
    v_exp_f32 v16, v172
    v_mfma_f32_16x16x32_bf16 a[12:15], v[64:67], v[24:27], a[12:15]
    ds_read_b128 v[40:43], v1 offset:5120
    v_add_f32 v7, v7, v18
    v_mfma_f32_16x16x32_bf16 a[12:15], v[80:83], v[28:31], a[12:15]
    buffer_store_dwordx4 v[236:239], v55, s[4:7], s33 offen offset:2304 sc1
    v_mfma_f32_16x16x32_bf16 a[60:63], v[68:71], v[24:27], a[60:63]
    v_add_f32 v7, v7, v19
    v_lshlrev_b32 v50, 16, v59
    v_mfma_f32_16x16x32_bf16 a[60:63], v[84:87], v[28:31], a[60:63]
    v_exp_f32 v17, v173
    v_mfma_f32_16x16x32_bf16 a[108:111], v[72:75], v[24:27], a[108:111]
    ds_read_b128 v[44:47], v1 offset:17408
    v_cvt_pk_bf16_f32 v171, v18, v19
    v_mfma_f32_16x16x32_bf16 a[108:111], v[88:91], v[28:31], a[108:111]
    v_exp_f32 v18, v174
    v_mfma_f32_16x16x32_bf16 a[156:159], v[76:79], v[24:27], a[156:159]
    s_add_u32 s29, s28, 49152
    v_add_f32 v8, v8, v16
    v_add_f32 v8, v8, v17
    v_mfma_f32_16x16x32_bf16 a[156:159], v[92:95], v[28:31], a[156:159]
    s_waitcnt lgkmcnt(2)
    v_exp_f32 v19, v175
    v_mfma_f32_16x16x32_bf16 a[16:19], v[64:67], v[32:35], a[16:19]
    s_sub_u32 s3, s29, 147456
    ds_read_b128 v[24:27], v1 offset:6144
    v_cvt_pk_bf16_f32 v172, v16, v17
    v_mfma_f32_16x16x32_bf16 a[16:19], v[80:83], v[36:39], a[16:19]
    s_mov_b32 m0, s26
    v_exp_f32 v16, v108
    v_mfma_f32_16x16x32_bf16 a[64:67], v[68:71], v[32:35], a[64:67]
    s_min_u32 s29, s29, s3
    v_and_b32 v51, s97, v59
    v_add_f32 v8, v8, v18
    v_mfma_f32_16x16x32_bf16 a[64:67], v[84:87], v[36:39], a[64:67]
    buffer_load_dwordx4 v4, s[4:7], s32 offen offset:0 sc1 lds
    v_mfma_f32_16x16x32_bf16 a[112:115], v[72:75], v[32:35], a[112:115]
    ds_read_b128 v[28:31], v1 offset:18432
    v_add_f32 v8, v8, v19
    v_mfma_f32_16x16x32_bf16 a[112:115], v[88:91], v[36:39], a[112:115]
    v_exp_f32 v17, v109
    v_mfma_f32_16x16x32_bf16 a[160:163], v[76:79], v[32:35], a[160:163]
    v_cvt_pk_bf16_f32 v173, v18, v19
    v_mul_f32_e64 v50, -v50, v48
    v_mfma_f32_16x16x32_bf16 a[160:163], v[92:95], v[36:39], a[160:163]
    s_waitcnt lgkmcnt(2)
    buffer_load_dwordx4 v4, s[4:7], s32 offen offset:1024 sc1 lds
    v_mfma_f32_16x16x32_bf16 a[20:23], v[64:67], v[40:43], a[20:23]
    s_sub_u32 s3, s29, s28
    ds_read_b128 v[32:35], v1 offset:7168
    v_mul_f32_e64 v51, -v51, v49
    v_mfma_f32_16x16x32_bf16 a[20:23], v[80:83], v[44:47], a[20:23]
    v_exp_f32 v18, v110
    v_mfma_f32_16x16x32_bf16 a[68:71], v[68:71], v[40:43], a[68:71]
    v_add_f32 v8, v8, v16
    v_add_f32 v8, v8, v17
    v_mfma_f32_16x16x32_bf16 a[68:71], v[84:87], v[44:47], a[68:71]
    buffer_load_dwordx4 v4, s[4:7], s32 offen offset:2048 sc1 lds
    v_mfma_f32_16x16x32_bf16 a[116:119], v[72:75], v[40:43], a[116:119]
    ds_read_b128 v[36:39], v1 offset:19456
    v_cvt_f32_i32 v152, v152
    v_mfma_f32_16x16x32_bf16 a[116:119], v[88:91], v[44:47], a[116:119]
    v_exp_f32 v19, v111
    v_mfma_f32_16x16x32_bf16 a[164:167], v[76:79], v[40:43], a[164:167]
    s_mov_b32 s28, s29
    v_cvt_pk_bf16_f32 v174, v16, v17
    v_add_f32 v8, v8, v18
    v_mfma_f32_16x16x32_bf16 a[164:167], v[92:95], v[44:47], a[164:167]
    s_waitcnt lgkmcnt(2)
    v_add_f32 v8, v8, v19
    v_cvt_pk_bf16_f32 v175, v18, v19
    v_mfma_f32_16x16x32_bf16 a[24:27], v[64:67], v[24:27], a[24:27]
    s_add_u32 s32, s32, 24576
    ds_read_b128 v[40:43], v1 offset:8192
    v_cvt_f32_i32 v156, v156
    v_mfma_f32_16x16x32_bf16 a[24:27], v[80:83], v[28:31], a[24:27]
    v_exp_f32 v16, v176
    v_mfma_f32_16x16x32_bf16 a[72:75], v[68:71], v[24:27], a[72:75]
    s_add_u32 s26, s26, 12288
    v_exp_f32 v17, v177
    v_mfma_f32_16x16x32_bf16 a[72:75], v[84:87], v[28:31], a[72:75]
    v_exp_f32 v18, v178
    v_mfma_f32_16x16x32_bf16 a[120:123], v[72:75], v[24:27], a[120:123]
    s_mov_b32 m0, s26
    ds_read_b128 v[44:47], v1 offset:20480
    v_add_f32 v5, v5, v16
    v_mfma_f32_16x16x32_bf16 a[120:123], v[88:91], v[28:31], a[120:123]
    v_add_f32 v5, v5, v17
    v_fma_f32 v152, v152, v48, v50
    v_mfma_f32_16x16x32_bf16 a[168:171], v[76:79], v[24:27], a[168:171]
    v_exp_f32 v19, v179
    v_mfma_f32_16x16x32_bf16 a[168:171], v[92:95], v[28:31], a[168:171]
    s_waitcnt lgkmcnt(2)
    v_cvt_pk_bf16_f32 v176, v16, v17
    v_fma_f32 v156, v156, v49, v51
    v_mfma_f32_16x16x32_bf16 a[28:31], v[64:67], v[32:35], a[28:31]
    ds_read_b128 v[24:27], v1 offset:9216
    v_add_u32 v2, s3, v2
    v_mfma_f32_16x16x32_bf16 a[28:31], v[80:83], v[36:39], a[28:31]
    buffer_load_dwordx4 v4, s[4:7], s32 offen offset:0 sc1 lds
    v_mfma_f32_16x16x32_bf16 a[76:79], v[68:71], v[32:35], a[76:79]
    v_exp_f32 v16, v112
    v_mfma_f32_16x16x32_bf16 a[76:79], v[84:87], v[36:39], a[76:79]
    v_add_f32 v5, v5, v18
    v_add_f32 v5, v5, v19
    v_mfma_f32_16x16x32_bf16 a[124:127], v[72:75], v[32:35], a[124:127]
    ds_read_b128 v[28:31], v1 offset:21504
    v_cvt_f32_i32 v153, v153
    v_mfma_f32_16x16x32_bf16 a[124:127], v[88:91], v[36:39], a[124:127]
    buffer_load_dwordx4 v4, s[4:7], s32 offen offset:1024 sc1 lds
    v_mfma_f32_16x16x32_bf16 a[172:175], v[76:79], v[32:35], a[172:175]
    v_exp_f32 v17, v113
    v_mfma_f32_16x16x32_bf16 a[172:175], v[92:95], v[36:39], a[172:175]
    s_waitcnt lgkmcnt(2)
    v_cvt_pk_bf16_f32 v177, v18, v19
    v_add_u32 v3, s3, v3
    v_mfma_f32_16x16x32_bf16 a[32:35], v[64:67], v[40:43], a[32:35]
    ds_read_b128 v[32:35], v1 offset:10240
    v_cvt_f32_i32 v157, v157
    v_mfma_f32_16x16x32_bf16 a[32:35], v[80:83], v[44:47], a[32:35]
    v_exp_f32 v18, v114
    v_mfma_f32_16x16x32_bf16 a[80:83], v[68:71], v[40:43], a[80:83]
    v_add_f32 v5, v5, v16
    v_add_f32 v5, v5, v17
    v_mfma_f32_16x16x32_bf16 a[80:83], v[84:87], v[44:47], a[80:83]
    buffer_load_dwordx4 v4, s[4:7], s32 offen offset:2048 sc1 lds
    v_mfma_f32_16x16x32_bf16 a[128:131], v[72:75], v[40:43], a[128:131]
    ds_read_b128 v[36:39], v1 offset:22528
    v_mfma_f32_16x16x32_bf16 a[128:131], v[88:91], v[44:47], a[128:131]
    v_exp_f32 v19, v115
    v_mfma_f32_16x16x32_bf16 a[176:179], v[76:79], v[40:43], a[176:179]
    v_cvt_pk_bf16_f32 v178, v16, v17
    v_fma_f32 v153, v153, v48, v50
    v_mfma_f32_16x16x32_bf16 a[176:179], v[92:95], v[44:47], a[176:179]
    s_waitcnt lgkmcnt(2)
    v_exp_f32 v16, v180
    v_mfma_f32_16x16x32_bf16 a[36:39], v[64:67], v[24:27], a[36:39]
    ds_read_b128 v[40:43], v1 offset:11264
    v_add_f32 v5, v5, v18
    v_mfma_f32_16x16x32_bf16 a[36:39], v[80:83], v[28:31], a[36:39]
    v_add_f32 v5, v5, v19
    v_mfma_f32_16x16x32_bf16 a[84:87], v[68:71], v[24:27], a[84:87]
    v_exp_f32 v17, v181
    v_mfma_f32_16x16x32_bf16 a[84:87], v[84:87], v[28:31], a[84:87]
    s_add_u32 s32, s32, 24576
    v_cvt_pk_bf16_f32 v179, v18, v19
    s_add_u32 s26, s26, 36864
    v_mfma_f32_16x16x32_bf16 a[132:135], v[72:75], v[24:27], a[132:135]
    s_sub_u32 s57, s26, 147456
    ds_read_b128 v[44:47], v1 offset:23552
    v_fma_f32 v157, v157, v49, v51
    v_mfma_f32_16x16x32_bf16 a[132:135], v[88:91], v[28:31], a[132:135]
    s_waitcnt lgkmcnt(2)
    v_exp_f32 v18, v182
    v_mfma_f32_16x16x32_bf16 a[180:183], v[76:79], v[24:27], a[180:183]
    s_waitcnt vmcnt(6)
    v_add_f32 v6, v6, v16
    v_add_f32 v6, v6, v17
    v_mfma_f32_16x16x32_bf16 a[180:183], v[92:95], v[28:31], a[180:183]
    s_barrier
    v_cvt_f32_i32 v154, v154
    v_mfma_f32_16x16x32_bf16 a[40:43], v[64:67], v[32:35], a[40:43]
    s_min_u32 s26, s26, s57
    ds_read_b128 v[24:27], v2 offset:0
    v_add_u32 v0, 1, v0
    v_mfma_f32_16x16x32_bf16 a[40:43], v[80:83], v[36:39], a[40:43]
    buffer_store_dword v0, v13, s[20:23], 0 offen offset:32 sc1
    v_mfma_f32_16x16x32_bf16 a[88:91], v[68:71], v[32:35], a[88:91]
    v_exp_f32 v19, v183
    v_mfma_f32_16x16x32_bf16 a[88:91], v[84:87], v[36:39], a[88:91]
    v_cvt_pk_bf16_f32 v180, v16, v17
    v_cvt_f32_i32 v158, v158
    v_mfma_f32_16x16x32_bf16 a[136:139], v[72:75], v[32:35], a[136:139]
    ds_read_b128 v[28:31], v3 offset:0
    v_mfma_f32_16x16x32_bf16 a[136:139], v[88:91], v[36:39], a[136:139]
    v_exp_f32 v16, v116
    v_mfma_f32_16x16x32_bf16 a[184:187], v[76:79], v[32:35], a[184:187]
    v_add_f32 v6, v6, v18
    v_add_f32 v6, v6, v19
    v_mfma_f32_16x16x32_bf16 a[184:187], v[92:95], v[36:39], a[184:187]
    s_waitcnt lgkmcnt(2)
    v_exp_f32 v17, v117
    v_mfma_f32_16x16x32_bf16 a[44:47], v[64:67], v[40:43], a[44:47]
    ds_read_b128 v[32:35], v2 offset:6144
    v_cvt_pk_bf16_f32 v181, v18, v19
    v_mfma_f32_16x16x32_bf16 a[44:47], v[80:83], v[44:47], a[44:47]
    v_exp_f32 v18, v118
    v_mfma_f32_16x16x32_bf16 a[92:95], v[68:71], v[40:43], a[92:95]
    v_add_f32 v6, v6, v16
    v_add_f32 v6, v6, v17
    v_mfma_f32_16x16x32_bf16 a[92:95], v[84:87], v[44:47], a[92:95]
    v_exp_f32 v19, v119
    v_mfma_f32_16x16x32_bf16 a[140:143], v[72:75], v[40:43], a[140:143]
    ds_read_b128 v[36:39], v3 offset:6144
    v_cvt_pk_bf16_f32 v182, v16, v17
    v_mfma_f32_16x16x32_bf16 a[140:143], v[88:91], v[44:47], a[140:143]
    v_add_f32 v6, v6, v18
    v_add_f32 v6, v6, v19
    v_mfma_f32_16x16x32_bf16 a[188:191], v[76:79], v[40:43], a[188:191]
    v_cvt_pk_bf16_f32 v183, v18, v19
    v_mfma_f32_16x16x32_bf16 a[188:191], v[92:95], v[44:47], a[188:191]
    s_waitcnt lgkmcnt(2)
    v_mfma_f32_16x16x32_bf16 v[64:67], v[24:27], a[192:195], v[128:131]
    s_add_u32 s33, s33, 196608
    ds_read_b128 v[40:43], v2 offset:128
    v_fma_f32 v154, v154, v48, v50
    v_mfma_f32_16x16x32_bf16 v[64:67], v[28:31], a[196:199], v[64:67]
    s_mov_b32 m0, s56
    v_exp_f32 v16, v184
    v_mfma_f32_16x16x32_bf16 v[68:71], v[24:27], a[216:219], v[132:135]
    s_add_u32 s34, s34, 196608
    v_exp_f32 v17, v185
    v_mfma_f32_16x16x32_bf16 v[68:71], v[28:31], a[220:223], v[68:71]
    s_add_u32 s36, s36, 1536
    buffer_load_dwordx4 v4, s[4:7], s27 offen offset:0 sc1 lds
    v_mfma_f32_16x16x32_bf16 v[72:75], v[24:27], a[240:243], v[136:139]
    ds_read_b128 v[44:47], v3 offset:128
    v_fma_f32 v158, v158, v49, v51
    v_mfma_f32_16x16x32_bf16 v[72:75], v[28:31], a[244:247], v[72:75]
    v_exp_f32 v18, v186
    v_mfma_f32_16x16x32_bf16 v[76:79], v[24:27], v[200:203], v[140:143]
    v_add_f32 v7, v7, v16
    v_add_f32 v7, v7, v17
    v_mfma_f32_16x16x32_bf16 v[76:79], v[28:31], v[204:207], v[76:79]
    s_waitcnt lgkmcnt(2)
    buffer_load_dwordx2 v[56:57], v10, s[72:75], s36 offen offset:0
    v_mfma_f32_16x16x32_bf16 v[96:99], v[32:35], a[192:195], v[128:131]
    ds_read_b128 v[24:27], v2 offset:6272
    v_cvt_f32_i32 v155, v155
    v_mfma_f32_16x16x32_bf16 v[96:99], v[36:39], a[196:199], v[96:99]
    v_exp_f32 v19, v187
    v_mfma_f32_16x16x32_bf16 v[100:103], v[32:35], a[216:219], v[132:135]
    v_cvt_pk_bf16_f32 v184, v16, v17
    v_cvt_f32_i32 v159, v159
    v_mfma_f32_16x16x32_bf16 v[100:103], v[36:39], a[220:223], v[100:103]
    buffer_load_dwordx4 v4, s[4:7], s27 offen offset:1024 sc1 lds
    v_mfma_f32_16x16x32_bf16 v[104:107], v[32:35], a[240:243], v[136:139]
    ds_read_b128 v[28:31], v3 offset:6272
    v_fma_f32 v155, v155, v48, v50
    v_mfma_f32_16x16x32_bf16 v[104:107], v[36:39], a[244:247], v[104:107]
    v_exp_f32 v16, v120
    v_mfma_f32_16x16x32_bf16 v[108:111], v[32:35], v[200:203], v[140:143]
    v_add_f32 v7, v7, v18
    v_add_f32 v7, v7, v19
    v_mfma_f32_16x16x32_bf16 v[108:111], v[36:39], v[204:207], v[108:111]
    s_waitcnt lgkmcnt(2)
    buffer_load_dwordx2 v[58:59], v10, s[76:79], s36 offen offset:0
    v_mfma_f32_16x16x32_bf16 v[64:67], v[40:43], a[200:203], v[64:67]
    ds_read_b128 v[32:35], v2 offset:256
    v_fma_f32 v159, v159, v49, v51
    v_mfma_f32_16x16x32_bf16 v[64:67], v[44:47], a[204:207], v[64:67]
    v_exp_f32 v17, v121
    v_mfma_f32_16x16x32_bf16 v[68:71], v[40:43], a[224:227], v[68:71]
    v_cvt_pk_bf16_f32 v185, v18, v19
    v_cvt_pk_bf16_f32 v144, v144, v148
    v_mfma_f32_16x16x32_bf16 v[68:71], v[44:47], a[228:231], v[68:71]
    buffer_load_dwordx4 v[224:227], v9, s[64:67], s33 offen offset:0 nt
    v_mfma_f32_16x16x32_bf16 v[72:75], v[40:43], a[248:251], v[72:75]
    ds_read_b128 v[36:39], v3 offset:256
    v_cvt_pk_bf16_f32 v148, v145, v149
    v_mfma_f32_16x16x32_bf16 v[72:75], v[44:47], a[252:255], v[72:75]
    v_exp_f32 v18, v122
    v_mfma_f32_16x16x32_bf16 v[76:79], v[40:43], v[208:211], v[76:79]
    v_add_f32 v7, v7, v16
    v_add_f32 v7, v7, v17
    v_mfma_f32_16x16x32_bf16 v[76:79], v[44:47], v[212:215], v[76:79]
    s_waitcnt lgkmcnt(2)
    buffer_load_dwordx4 v4, s[4:7], s27 offen offset:2048 sc1 lds
    v_mfma_f32_16x16x32_bf16 v[96:99], v[24:27], a[200:203], v[96:99]
    ds_read_b128 v[40:43], v2 offset:6400
    v_cvt_pk_bf16_f32 v145, v152, v156
    v_mfma_f32_16x16x32_bf16 v[96:99], v[28:31], a[204:207], v[96:99]
    v_exp_f32 v19, v123
    v_cvt_pk_bf16_f32 v186, v16, v17
    v_mfma_f32_16x16x32_bf16 v[100:103], v[24:27], a[224:227], v[100:103]
    v_exp_f32 v16, v188
    v_mfma_f32_16x16x32_bf16 v[100:103], v[28:31], a[228:231], v[100:103]
    buffer_load_dwordx4 v[228:231], v9, s[64:67], s33 offen offset:1536 nt
    v_mfma_f32_16x16x32_bf16 v[104:107], v[24:27], a[248:251], v[104:107]
    ds_read_b128 v[44:47], v3 offset:6400
    v_add_f32 v7, v7, v18
    v_mfma_f32_16x16x32_bf16 v[104:107], v[28:31], a[252:255], v[104:107]
    v_add_f32 v7, v7, v19
    v_cvt_pk_bf16_f32 v149, v153, v157
    v_mfma_f32_16x16x32_bf16 v[108:111], v[24:27], v[208:211], v[108:111]
    s_add_u32 s29, s30, 49152
    v_exp_f32 v17, v189
    v_mfma_f32_16x16x32_bf16 v[108:111], v[28:31], v[212:215], v[108:111]
    s_waitcnt lgkmcnt(2)
    buffer_load_dwordx4 v[232:235], v9, s[64:67], s34 offen offset:0 nt
    v_cvt_pk_bf16_f32 v187, v18, v19
    v_mfma_f32_16x16x32_bf16 v[64:67], v[32:35], a[208:211], v[64:67]
    s_sub_u32 s3, s29, 147456
    ds_read_b128 v[24:27], v2 offset:12288
    s_add_u32 s27, s27, 24576
    v_mfma_f32_16x16x32_bf16 v[64:67], v[36:39], a[212:215], v[64:67]
    s_min_u32 s29, s29, s3
    v_exp_f32 v18, v190
    v_mfma_f32_16x16x32_bf16 v[68:71], v[32:35], a[232:235], v[68:71]
    v_add_f32 v8, v8, v16
    v_add_f32 v8, v8, v17
    v_mfma_f32_16x16x32_bf16 v[68:71], v[36:39], a[236:239], v[68:71]
    buffer_load_dwordx4 v[236:239], v9, s[64:67], s34 offen offset:1536 nt
    v_mfma_f32_16x16x32_bf16 v[72:75], v[32:35], v[192:195], v[72:75]
    s_add_u32 s56, s56, 12288
    ds_read_b128 v[28:31], v3 offset:12288
    v_cvt_pk_bf16_f32 v152, v146, v150
    v_mfma_f32_16x16x32_bf16 v[72:75], v[36:39], v[196:199], v[72:75]
    v_exp_f32 v19, v191
    v_cvt_pk_bf16_f32 v188, v16, v17
    v_mfma_f32_16x16x32_bf16 v[76:79], v[32:35], v[216:219], v[76:79]
    v_exp_f32 v16, v124
    v_mfma_f32_16x16x32_bf16 v[76:79], v[36:39], v[220:223], v[76:79]
    s_waitcnt lgkmcnt(2)
    v_add_f32 v8, v8, v18
    v_add_f32 v8, v8, v19
    v_mfma_f32_16x16x32_bf16 v[96:99], v[40:43], a[208:211], v[96:99]
    ds_read_b128 v[32:35], v2 offset:18432
    v_cvt_pk_bf16_f32 v153, v154, v158
    v_mfma_f32_16x16x32_bf16 v[96:99], v[44:47], a[212:215], v[96:99]
    s_sub_u32 s3, s29, s30
    v_exp_f32 v17, v125
    v_mfma_f32_16x16x32_bf16 v[100:103], v[40:43], a[232:235], v[100:103]
    s_mov_b32 m0, s56
    v_cvt_pk_bf16_f32 v189, v18, v19
    v_cvt_pk_bf16_f32 v156, v147, v151
    v_mfma_f32_16x16x32_bf16 v[100:103], v[44:47], a[236:239], v[100:103]
    v_exp_f32 v18, v126
    v_mfma_f32_16x16x32_bf16 v[104:107], v[40:43], v[192:195], v[104:107]
    ds_read_b128 v[36:39], v3 offset:18432
    v_add_f32 v8, v8, v16
    v_mfma_f32_16x16x32_bf16 v[104:107], v[44:47], v[196:199], v[104:107]
    v_add_f32 v8, v8, v17
    v_cvt_pk_bf16_f32 v157, v155, v159
    v_mfma_f32_16x16x32_bf16 v[108:111], v[40:43], v[216:219], v[108:111]
    v_exp_f32 v19, v127
    v_mfma_f32_16x16x32_bf16 v[108:111], v[44:47], v[220:223], v[108:111]
    s_waitcnt lgkmcnt(2)
    v_cvt_pk_bf16_f32 v190, v16, v17
    v_add_f32 v8, v8, v18
    v_mfma_f32_16x16x32_bf16 v[80:83], v[24:27], a[192:195], v[128:131]
    ds_read_b128 v[40:43], v2 offset:12416
    v_add_f32 v8, v8, v19
    v_mfma_f32_16x16x32_bf16 v[80:83], v[28:31], a[196:199], v[80:83]
    s_mov_b32 s30, s29
    v_cvt_pk_bf16_f32 v191, v18, v19
    v_mfma_f32_16x16x32_bf16 v[84:87], v[24:27], a[216:219], v[132:135]
    v_exp_f32 v16, v64
    v_mfma_f32_16x16x32_bf16 v[84:87], v[28:31], a[220:223], v[84:87]
    s_waitcnt vmcnt(20)
    buffer_load_dwordx4 v4, s[4:7], s27 offen offset:0 sc1 lds
    v_mfma_f32_16x16x32_bf16 v[88:91], v[24:27], a[240:243], v[136:139]
    ds_read_b128 v[44:47], v3 offset:12416
    v_lshlrev_b32 v48, 16, v60
    v_mfma_f32_16x16x32_bf16 v[88:91], v[28:31], a[244:247], v[88:91]
    v_exp_f32 v17, v65
    v_mfma_f32_16x16x32_bf16 v[92:95], v[24:27], v[200:203], v[140:143]
    v_exp_f32 v18, v66
    v_mfma_f32_16x16x32_bf16 v[92:95], v[28:31], v[204:207], v[92:95]
    s_waitcnt lgkmcnt(2)
    v_add_f32 v5, v5, v16
    v_add_f32 v5, v5, v17
    v_mfma_f32_16x16x32_bf16 v[112:115], v[32:35], a[192:195], v[128:131]
    ds_read_b128 v[24:27], v2 offset:18560
    v_and_b32 v49, s97, v60
    v_mfma_f32_16x16x32_bf16 v[112:115], v[36:39], a[196:199], v[112:115]
    v_exp_f32 v19, v67
    v_mfma_f32_16x16x32_bf16 v[116:119], v[32:35], a[216:219], v[132:135]
    v_cvt_pk_bf16_f32 v64, v16, v17
    v_lshlrev_b32 v50, 16, v62
    v_mfma_f32_16x16x32_bf16 v[116:119], v[36:39], a[220:223], v[116:119]
    v_exp_f32 v16, v96
    v_mfma_f32_16x16x32_bf16 v[120:123], v[32:35], a[240:243], v[136:139]
    ds_read_b128 v[28:31], v3 offset:18560
    v_add_f32 v5, v5, v18
    v_mfma_f32_16x16x32_bf16 v[120:123], v[36:39], a[244:247], v[120:123]
    v_add_f32 v5, v5, v19
    v_and_b32 v51, s97, v62
    v_mfma_f32_16x16x32_bf16 v[124:127], v[32:35], v[200:203], v[140:143]
    v_exp_f32 v17, v97
    v_mfma_f32_16x16x32_bf16 v[124:127], v[36:39], v[204:207], v[124:127]
    s_waitcnt lgkmcnt(2)
    buffer_load_dwordx4 v4, s[4:7], s27 offen offset:1024 sc1 lds
    v_mfma_f32_16x16x32_bf16 v[80:83], v[40:43], a[200:203], v[80:83]
    ds_read_b128 v[32:35], v2 offset:12544
    v_cvt_pk_bf16_f32 v65, v18, v19
    v_mfma_f32_16x16x32_bf16 v[80:83], v[44:47], a[204:207], v[80:83]
    v_exp_f32 v18, v98
    v_mfma_f32_16x16x32_bf16 v[84:87], v[40:43], a[224:227], v[84:87]
    v_add_f32 v5, v5, v16
    v_add_f32 v5, v5, v17
    v_mfma_f32_16x16x32_bf16 v[84:87], v[44:47], a[228:231], v[84:87]
    v_exp_f32 v19, v99
    v_mfma_f32_16x16x32_bf16 v[88:91], v[40:43], a[248:251], v[88:91]
    ds_read_b128 v[36:39], v3 offset:12544
    v_cvt_pk_bf16_f32 v66, v16, v17
    v_mfma_f32_16x16x32_bf16 v[88:91], v[44:47], a[252:255], v[88:91]
    v_exp_f32 v16, v68
    v_mfma_f32_16x16x32_bf16 v[92:95], v[40:43], v[208:211], v[92:95]
    v_mul_f32_e64 v50, -v50, v48
    v_add_u32 v1, s3, v1
    v_mfma_f32_16x16x32_bf16 v[92:95], v[44:47], v[212:215], v[92:95]
    s_waitcnt lgkmcnt(2)
    v_add_f32 v5, v5, v18
    v_mul_f32_e64 v51, -v51, v49
    v_mfma_f32_16x16x32_bf16 v[112:115], v[24:27], a[200:203], v[112:115]
    ds_read_b128 v[40:43], v2 offset:18688
    v_add_f32 v5, v5, v19
    v_mfma_f32_16x16x32_bf16 v[112:115], v[28:31], a[204:207], v[112:115]
    buffer_load_dwordx4 v4, s[4:7], s27 offen offset:2048 sc1 lds
    v_mfma_f32_16x16x32_bf16 v[116:119], v[24:27], a[224:227], v[116:119]
    v_exp_f32 v17, v69
    v_mfma_f32_16x16x32_bf16 v[116:119], v[28:31], a[228:231], v[116:119]
    v_cvt_pk_bf16_f32 v67, v18, v19
    v_cvt_f32_i32 v240, v240
    v_mfma_f32_16x16x32_bf16 v[120:123], v[24:27], a[248:251], v[120:123]
    ds_read_b128 v[44:47], v3 offset:18688
    v_cvt_f32_i32 v244, v244
    v_mfma_f32_16x16x32_bf16 v[120:123], v[28:31], a[252:255], v[120:123]
    s_waitcnt lgkmcnt(2)
    v_exp_f32 v18, v70
    v_mfma_f32_16x16x32_bf16 v[124:127], v[24:27], v[208:211], v[124:127]
    s_waitcnt vmcnt(13)
    v_add_f32 v6, v6, v16
    v_add_f32 v6, v6, v17
    v_mfma_f32_16x16x32_bf16 v[124:127], v[28:31], v[212:215], v[124:127]
    s_barrier
    v_fma_f32 v240, v240, v48, v50
    v_mfma_f32_16x16x32_bf16 v[80:83], v[32:35], a[208:211], v[80:83]
    ds_read_b128 v[24:27], v1 offset:0
    v_fma_f32 v244, v244, v49, v51
    v_mfma_f32_16x16x32_bf16 v[80:83], v[36:39], a[212:215], v[80:83]
    v_exp_f32 v19, v71
    v_mfma_f32_16x16x32_bf16 v[84:87], v[32:35], a[232:235], v[84:87]
    v_cvt_pk_bf16_f32 v68, v16, v17
    v_mfma_f32_16x16x32_bf16 v[84:87], v[36:39], a[236:239], v[84:87]
    v_exp_f32 v16, v100
    v_mfma_f32_16x16x32_bf16 v[88:91], v[32:35], v[192:195], v[88:91]
    ds_read_b128 v[28:31], v1 offset:12288
    v_add_f32 v6, v6, v18
    v_mfma_f32_16x16x32_bf16 v[88:91], v[36:39], v[196:199], v[88:91]
    v_add_f32 v6, v6, v19
    v_cvt_f32_i32 v241, v241
    v_mfma_f32_16x16x32_bf16 v[92:95], v[32:35], v[216:219], v[92:95]
    v_exp_f32 v17, v101
    v_mfma_f32_16x16x32_bf16 v[92:95], v[36:39], v[220:223], v[92:95]
    s_waitcnt lgkmcnt(2)
    v_cvt_pk_bf16_f32 v69, v18, v19
    v_cvt_f32_i32 v245, v245
    v_mfma_f32_16x16x32_bf16 v[112:115], v[40:43], a[208:211], v[112:115]
    ds_read_b128 v[32:35], v1 offset:1024
    v_mfma_f32_16x16x32_bf16 v[112:115], v[44:47], a[212:215], v[112:115]
    v_exp_f32 v18, v102
    v_mfma_f32_16x16x32_bf16 v[116:119], v[40:43], a[232:235], v[116:119]
    v_add_f32 v6, v6, v16
    v_add_f32 v6, v6, v17
    v_mfma_f32_16x16x32_bf16 v[116:119], v[44:47], a[236:239], v[116:119]
    s_add_u32 s27, s27, 24576
    v_exp_f32 v19, v103
    v_mfma_f32_16x16x32_bf16 v[120:123], v[40:43], v[192:195], v[120:123]
    s_add_u32 s56, s56, 36864
    ds_read_b128 v[36:39], v1 offset:13312
    v_cvt_pk_bf16_f32 v70, v16, v17
    v_mfma_f32_16x16x32_bf16 v[120:123], v[44:47], v[196:199], v[120:123]
    s_sub_u32 s58, s56, 147456
    v_add_f32 v6, v6, v18
    v_add_f32 v6, v6, v19
    v_mfma_f32_16x16x32_bf16 v[124:127], v[40:43], v[216:219], v[124:127]
    s_min_u32 s56, s56, s58
    v_cvt_pk_bf16_f32 v71, v18, v19
    v_mfma_f32_16x16x32_bf16 v[124:127], v[44:47], v[220:223], v[124:127]
    s_waitcnt lgkmcnt(2)
    v_mfma_f32_16x16x32_bf16 a[0:3], v[160:163], v[24:27], a[0:3]
    s_mov_b32 m0, s56
    ds_read_b128 v[40:43], v1 offset:2048
    v_fma_f32 v241, v241, v48, v50
    v_mfma_f32_16x16x32_bf16 a[0:3], v[176:179], v[28:31], a[0:3]
    buffer_load_dwordx4 v4, s[4:7], s27 offen offset:0 sc1 lds
    v_mfma_f32_16x16x32_bf16 a[48:51], v[164:167], v[24:27], a[48:51]
    v_exp_f32 v16, v72
    v_mfma_f32_16x16x32_bf16 a[48:51], v[180:183], v[28:31], a[48:51]
    v_exp_f32 v17, v73
    v_mfma_f32_16x16x32_bf16 a[96:99], v[168:171], v[24:27], a[96:99]
    ds_read_b128 v[44:47], v1 offset:14336
    v_fma_f32 v245, v245, v49, v51
    v_mfma_f32_16x16x32_bf16 a[96:99], v[184:187], v[28:31], a[96:99]
    v_exp_f32 v18, v74
    v_mfma_f32_16x16x32_bf16 a[144:147], v[172:175], v[24:27], a[144:147]
    v_add_f32 v7, v7, v16
    v_add_f32 v7, v7, v17
    v_mfma_f32_16x16x32_bf16 a[144:147], v[188:191], v[28:31], a[144:147]
    s_waitcnt lgkmcnt(2)
    v_exp_f32 v19, v75
    v_mfma_f32_16x16x32_bf16 a[4:7], v[160:163], v[32:35], a[4:7]
    ds_read_b128 v[24:27], v1 offset:3072
    v_cvt_f32_i32 v242, v242
    v_mfma_f32_16x16x32_bf16 a[4:7], v[176:179], v[36:39], a[4:7]
    buffer_load_dwordx4 v4, s[4:7], s27 offen offset:1024 sc1 lds
    v_mfma_f32_16x16x32_bf16 a[52:55], v[164:167], v[32:35], a[52:55]
    v_cvt_pk_bf16_f32 v72, v16, v17
    v_cvt_f32_i32 v246, v246
    v_mfma_f32_16x16x32_bf16 a[52:55], v[180:183], v[36:39], a[52:55]
    v_exp_f32 v16, v104
    v_mfma_f32_16x16x32_bf16 a[100:103], v[168:171], v[32:35], a[100:103]
    ds_read_b128 v[28:31], v1 offset:15360
    v_add_f32 v7, v7, v18
    v_mfma_f32_16x16x32_bf16 a[100:103], v[184:187], v[36:39], a[100:103]
    v_add_f32 v7, v7, v19
    v_bfe_u32 v53, v4, 4, 6
    v_mfma_f32_16x16x32_bf16 a[148:151], v[172:175], v[32:35], a[148:151]
    v_exp_f32 v17, v105
    v_mfma_f32_16x16x32_bf16 a[148:151], v[188:191], v[36:39], a[148:151]
    s_waitcnt lgkmcnt(2)
    v_fma_f32 v242, v242, v48, v50
    v_cvt_pk_bf16_f32 v73, v18, v19
    v_mfma_f32_16x16x32_bf16 a[8:11], v[160:163], v[40:43], a[8:11]
    ds_read_b128 v[32:35], v1 offset:4096
    v_fma_f32 v246, v246, v49, v51
    v_mfma_f32_16x16x32_bf16 a[8:11], v[176:179], v[44:47], a[8:11]
    v_exp_f32 v18, v106
    v_mfma_f32_16x16x32_bf16 a[56:59], v[164:167], v[40:43], a[56:59]
    v_lshlrev_b32 v53, 2, v53
    v_add_f32 v7, v7, v16
    v_mfma_f32_16x16x32_bf16 a[56:59], v[180:183], v[44:47], a[56:59]
    buffer_load_dword v52, v53, s[20:23], s44 offen sc1
    v_mfma_f32_16x16x32_bf16 a[104:107], v[168:171], v[40:43], a[104:107]
    ds_read_b128 v[36:39], v1 offset:16384
    v_add_f32 v7, v7, v17
    v_mfma_f32_16x16x32_bf16 a[104:107], v[184:187], v[44:47], a[104:107]
    v_exp_f32 v19, v107
    v_mfma_f32_16x16x32_bf16 a[152:155], v[172:175], v[40:43], a[152:155]
    v_cvt_f32_i32 v243, v243
    v_cvt_pk_bf16_f32 v74, v16, v17
    v_mfma_f32_16x16x32_bf16 a[152:155], v[188:191], v[44:47], a[152:155]
    s_waitcnt lgkmcnt(2)
    buffer_load_dwordx4 v4, s[4:7], s27 offen offset:2048 sc1 lds
    v_mfma_f32_16x16x32_bf16 a[12:15], v[160:163], v[24:27], a[12:15]
    ds_read_b128 v[40:43], v1 offset:5120
    v_cvt_f32_i32 v247, v247
    v_mfma_f32_16x16x32_bf16 a[12:15], v[176:179], v[28:31], a[12:15]
    s_add_u32 s27, s27, 24576
    v_exp_f32 v16, v76
    v_mfma_f32_16x16x32_bf16 a[60:63], v[164:167], v[24:27], a[60:63]
    v_add_f32 v7, v7, v18
    v_add_f32 v7, v7, v19
    v_mfma_f32_16x16x32_bf16 a[60:63], v[180:183], v[28:31], a[60:63]
    v_fma_f32 v243, v243, v48, v50
    v_fma_f32 v247, v247, v49, v51
    v_mfma_f32_16x16x32_bf16 a[108:111], v[168:171], v[24:27], a[108:111]
    ds_read_b128 v[44:47], v1 offset:17408
    v_lshlrev_b32 v48, 16, v61
    v_mfma_f32_16x16x32_bf16 a[108:111], v[184:187], v[28:31], a[108:111]
    v_exp_f32 v17, v77
    v_mfma_f32_16x16x32_bf16 a[156:159], v[172:175], v[24:27], a[156:159]
    s_add_u32 s29, s28, 49152
    v_cvt_pk_bf16_f32 v75, v18, v19
    v_and_b32 v49, s97, v61
    v_mfma_f32_16x16x32_bf16 a[156:159], v[188:191], v[28:31], a[156:159]
    s_waitcnt lgkmcnt(2)
    v_exp_f32 v18, v78
    v_mfma_f32_16x16x32_bf16 a[16:19], v[160:163], v[32:35], a[16:19]
    s_sub_u32 s3, s29, 147456
    ds_read_b128 v[24:27], v1 offset:6144
    v_add_f32 v8, v8, v16
    v_mfma_f32_16x16x32_bf16 a[16:19], v[176:179], v[36:39], a[16:19]
    s_add_u32 s56, s56, 12288
    v_add_f32 v8, v8, v17
    v_lshlrev_b32 v50, 16, v63
    v_mfma_f32_16x16x32_bf16 a[64:67], v[164:167], v[32:35], a[64:67]
    s_min_u32 s29, s29, s3
    v_exp_f32 v19, v79
    v_mfma_f32_16x16x32_bf16 a[64:67], v[180:183], v[36:39], a[64:67]
    s_mov_b32 m0, s56
    v_cvt_pk_bf16_f32 v76, v16, v17
    v_and_b32 v51, s97, v63
    v_mfma_f32_16x16x32_bf16 a[112:115], v[168:171], v[32:35], a[112:115]
    ds_read_b128 v[28:31], v1 offset:18432
    v_mul_f32_e64 v50, -v50, v48
    v_mfma_f32_16x16x32_bf16 a[112:115], v[184:187], v[36:39], a[112:115]
    v_exp_f32 v16, v108
    v_mfma_f32_16x16x32_bf16 a[160:163], v[172:175], v[32:35], a[160:163]
    v_add_f32 v8, v8, v18
    v_add_f32 v8, v8, v19
    v_mfma_f32_16x16x32_bf16 a[160:163], v[188:191], v[36:39], a[160:163]
    s_waitcnt lgkmcnt(2)
    v_exp_f32 v17, v109
    v_mfma_f32_16x16x32_bf16 a[20:23], v[160:163], v[40:43], a[20:23]
    s_sub_u32 s3, s29, s28
    ds_read_b128 v[32:35], v1 offset:7168
    v_cvt_pk_bf16_f32 v77, v18, v19
    v_mfma_f32_16x16x32_bf16 a[20:23], v[176:179], v[44:47], a[20:23]
    v_exp_f32 v18, v110
    v_mfma_f32_16x16x32_bf16 a[68:71], v[164:167], v[40:43], a[68:71]
    v_mul_f32_e64 v51, -v51, v49
    v_add_f32 v8, v8, v16
    v_mfma_f32_16x16x32_bf16 a[68:71], v[180:183], v[44:47], a[68:71]
    buffer_load_dwordx4 v4, s[4:7], s27 offen offset:0 sc1 lds
    v_mfma_f32_16x16x32_bf16 a[116:119], v[168:171], v[40:43], a[116:119]
    ds_read_b128 v[36:39], v1 offset:19456
    v_add_f32 v8, v8, v17
    v_mfma_f32_16x16x32_bf16 a[116:119], v[184:187], v[44:47], a[116:119]
    v_exp_f32 v19, v111
    v_mfma_f32_16x16x32_bf16 a[164:167], v[172:175], v[40:43], a[164:167]
    s_mov_b32 s28, s29
    v_cvt_f32_i32 v248, v248
    v_cvt_pk_bf16_f32 v78, v16, v17
    v_mfma_f32_16x16x32_bf16 a[164:167], v[188:191], v[44:47], a[164:167]
    s_waitcnt lgkmcnt(2)
    v_add_f32 v8, v8, v18
    v_cvt_f32_i32 v252, v252
    v_mfma_f32_16x16x32_bf16 a[24:27], v[160:163], v[24:27], a[24:27]
    ds_read_b128 v[40:43], v1 offset:8192
    v_add_f32 v8, v8, v19
    v_mfma_f32_16x16x32_bf16 a[24:27], v[176:179], v[28:31], a[24:27]
    v_cvt_pk_bf16_f32 v79, v18, v19
    v_fma_f32 v248, v248, v48, v50
    v_mfma_f32_16x16x32_bf16 a[72:75], v[164:167], v[24:27], a[72:75]
    v_exp_f32 v16, v80
    v_mfma_f32_16x16x32_bf16 a[72:75], v[180:183], v[28:31], a[72:75]
    buffer_load_dwordx4 v4, s[4:7], s27 offen offset:1024 sc1 lds
    v_mfma_f32_16x16x32_bf16 a[120:123], v[168:171], v[24:27], a[120:123]
    ds_read_b128 v[44:47], v1 offset:20480
    v_fma_f32 v252, v252, v49, v51
    v_mfma_f32_16x16x32_bf16 a[120:123], v[184:187], v[28:31], a[120:123]
    v_exp_f32 v17, v81
    v_mfma_f32_16x16x32_bf16 a[168:171], v[172:175], v[24:27], a[168:171]
    v_exp_f32 v18, v82
    v_mfma_f32_16x16x32_bf16 a[168:171], v[188:191], v[28:31], a[168:171]
    s_waitcnt lgkmcnt(2)
    v_cvt_f32_i32 v249, v249
    v_add_f32 v5, v5, v16
    v_mfma_f32_16x16x32_bf16 a[28:31], v[160:163], v[32:35], a[28:31]
    ds_read_b128 v[24:27], v1 offset:9216
    v_add_f32 v5, v5, v17
    v_mfma_f32_16x16x32_bf16 a[28:31], v[176:179], v[36:39], a[28:31]
    v_exp_f32 v19, v83
    v_mfma_f32_16x16x32_bf16 a[76:79], v[164:167], v[32:35], a[76:79]
    v_cvt_f32_i32 v253, v253
    v_cvt_pk_bf16_f32 v80, v16, v17
    v_mfma_f32_16x16x32_bf16 a[76:79], v[180:183], v[36:39], a[76:79]
    v_exp_f32 v16, v112
    v_mfma_f32_16x16x32_bf16 a[124:127], v[168:171], v[32:35], a[124:127]
    ds_read_b128 v[28:31], v1 offset:21504
    v_fma_f32 v249, v249, v48, v50
    v_mfma_f32_16x16x32_bf16 a[124:127], v[184:187], v[36:39], a[124:127]
    buffer_load_dwordx4 v4, s[4:7], s27 offen offset:2048 sc1 lds
    v_mfma_f32_16x16x32_bf16 a[172:175], v[172:175], v[32:35], a[172:175]
    v_add_f32 v5, v5, v18
    v_add_f32 v5, v5, v19
    v_mfma_f32_16x16x32_bf16 a[172:175], v[188:191], v[36:39], a[172:175]
    s_waitcnt lgkmcnt(2)
    v_exp_f32 v17, v113
    v_mfma_f32_16x16x32_bf16 a[32:35], v[160:163], v[40:43], a[32:35]
    ds_read_b128 v[32:35], v1 offset:10240
    v_fma_f32 v253, v253, v49, v51
    v_mfma_f32_16x16x32_bf16 a[32:35], v[176:179], v[44:47], a[32:35]
    v_cvt_pk_bf16_f32 v81, v18, v19
    v_cvt_f32_i32 v250, v250
    v_mfma_f32_16x16x32_bf16 a[80:83], v[164:167], v[40:43], a[80:83]
    v_exp_f32 v18, v114
    v_mfma_f32_16x16x32_bf16 a[80:83], v[180:183], v[44:47], a[80:83]
    v_cvt_f32_i32 v254, v254
    v_add_f32 v5, v5, v16
    v_mfma_f32_16x16x32_bf16 a[128:131], v[168:171], v[40:43], a[128:131]
    ds_read_b128 v[36:39], v1 offset:22528
    v_add_f32 v5, v5, v17
    v_mfma_f32_16x16x32_bf16 a[128:131], v[184:187], v[44:47], a[128:131]
    v_exp_f32 v19, v115
    v_mfma_f32_16x16x32_bf16 a[176:179], v[172:175], v[40:43], a[176:179]
    v_fma_f32 v250, v250, v48, v50
    v_cvt_pk_bf16_f32 v82, v16, v17
    v_mfma_f32_16x16x32_bf16 a[176:179], v[188:191], v[44:47], a[176:179]
    s_waitcnt lgkmcnt(2)
    v_exp_f32 v16, v84
    v_mfma_f32_16x16x32_bf16 a[36:39], v[160:163], v[24:27], a[36:39]
    ds_read_b128 v[40:43], v1 offset:11264
    v_fma_f32 v254, v254, v49, v51
    v_mfma_f32_16x16x32_bf16 a[36:39], v[176:179], v[28:31], a[36:39]
    v_add_u32 v2, s3, v2
    v_add_f32 v5, v5, v18
    v_mfma_f32_16x16x32_bf16 a[84:87], v[164:167], v[24:27], a[84:87]
    v_add_f32 v5, v5, v19
    v_cvt_f32_i32 v251, v251
    v_mfma_f32_16x16x32_bf16 a[84:87], v[180:183], v[28:31], a[84:87]
    s_add_u32 s27, s27, 24576
    v_exp_f32 v17, v85
    v_mfma_f32_16x16x32_bf16 a[132:135], v[168:171], v[24:27], a[132:135]
    s_add_u32 s56, s56, 36864
    ds_read_b128 v[44:47], v1 offset:23552
    v_add_u32 v3, s3, v3
    v_mfma_f32_16x16x32_bf16 a[132:135], v[184:187], v[28:31], a[132:135]
    s_sub_u32 s58, s56, 147456
    v_cvt_pk_bf16_f32 v83, v18, v19
    v_cvt_f32_i32 v255, v255
    v_mfma_f32_16x16x32_bf16 a[180:183], v[172:175], v[24:27], a[180:183]
    v_exp_f32 v18, v86
    v_mfma_f32_16x16x32_bf16 a[180:183], v[188:191], v[28:31], a[180:183]
    s_waitcnt lgkmcnt(2)
    v_fma_f32 v251, v251, v48, v50
    v_add_f32 v6, v6, v16
    v_mfma_f32_16x16x32_bf16 a[40:43], v[160:163], v[32:35], a[40:43]
    s_min_u32 s56, s56, s58
    ds_read_b128 v[24:27], v2 offset:0
    v_add_f32 v6, v6, v17
    v_mfma_f32_16x16x32_bf16 a[40:43], v[176:179], v[36:39], a[40:43]
    buffer_load_dword v20, v4, s[88:91], s93 offen
    v_mfma_f32_16x16x32_bf16 a[88:91], v[164:167], v[32:35], a[88:91]
    v_exp_f32 v19, v87
    v_mfma_f32_16x16x32_bf16 a[88:91], v[180:183], v[36:39], a[88:91]
    v_cvt_pk_bf16_f32 v84, v16, v17
    v_fma_f32 v255, v255, v49, v51
    v_mfma_f32_16x16x32_bf16 a[136:139], v[168:171], v[32:35], a[136:139]
    ds_read_b128 v[28:31], v3 offset:0
    v_cvt_pk_bf16_f32 v146, v240, v244
    v_mfma_f32_16x16x32_bf16 a[136:139], v[184:187], v[36:39], a[136:139]
    v_exp_f32 v16, v116
    v_mfma_f32_16x16x32_bf16 a[184:187], v[172:175], v[32:35], a[184:187]
    v_add_f32 v6, v6, v18
    v_add_f32 v6, v6, v19
    v_mfma_f32_16x16x32_bf16 a[184:187], v[188:191], v[36:39], a[184:187]
    s_waitcnt lgkmcnt(2)
    v_exp_f32 v17, v117
    v_mfma_f32_16x16x32_bf16 a[44:47], v[160:163], v[40:43], a[44:47]
    ds_read_b128 v[32:35], v2 offset:6144
    v_cvt_pk_bf16_f32 v150, v241, v245
    v_mfma_f32_16x16x32_bf16 a[44:47], v[176:179], v[44:47], a[44:47]
    v_cvt_pk_bf16_f32 v85, v18, v19
    v_cvt_pk_bf16_f32 v147, v248, v252
    v_mfma_f32_16x16x32_bf16 a[92:95], v[164:167], v[40:43], a[92:95]
    v_exp_f32 v18, v118
    v_mfma_f32_16x16x32_bf16 a[92:95], v[180:183], v[44:47], a[92:95]
    v_cvt_pk_bf16_f32 v151, v249, v253
    v_add_f32 v6, v6, v16
    v_mfma_f32_16x16x32_bf16 a[140:143], v[168:171], v[40:43], a[140:143]
    ds_read_b128 v[36:39], v3 offset:6144
    v_add_f32 v6, v6, v17
    v_mfma_f32_16x16x32_bf16 a[140:143], v[184:187], v[44:47], a[140:143]
    v_exp_f32 v19, v119
    v_mfma_f32_16x16x32_bf16 a[188:191], v[172:175], v[40:43], a[188:191]
    v_cvt_pk_bf16_f32 v154, v242, v246
    v_cvt_pk_bf16_f32 v86, v16, v17
    v_mfma_f32_16x16x32_bf16 a[188:191], v[188:191], v[44:47], a[188:191]
    s_waitcnt lgkmcnt(2)
    v_add_f32 v6, v6, v18
    v_cvt_pk_bf16_f32 v155, v250, v254
    v_add_f32 v6, v6, v19
    v_cvt_pk_bf16_f32 v158, v243, v247
    v_cvt_pk_bf16_f32 v87, v18, v19
    v_cvt_pk_bf16_f32 v159, v251, v255
L_join:
    v_mfma_f32_16x16x32_bf16 v[160:163], v[24:27], a[192:195], v[128:131]
    s_waitcnt vmcnt(7)
    ds_read_b128 v[40:43], v2 offset:128
    v_lshlrev_b32 v48, 16, v56
    v_mfma_f32_16x16x32_bf16 v[160:163], v[28:31], a[196:199], v[160:163]
    s_waitcnt vmcnt(5)
    v_subrev_u32 v52, s92, v52
    v_cmp_lt_u32 vcc, 15, v52
    v_mfma_f32_16x16x32_bf16 v[164:167], v[24:27], a[216:219], v[132:135]
    v_exp_f32 v16, v88
    v_mfma_f32_16x16x32_bf16 v[164:167], v[28:31], a[220:223], v[164:167]
    v_exp_f32 v17, v89
    v_mfma_f32_16x16x32_bf16 v[168:171], v[24:27], a[240:243], v[136:139]
    s_and_b32 s59, vcc_lo, 0xff
    ds_read_b128 v[44:47], v3 offset:128
    v_and_b32 v49, s97, v56
    v_mfma_f32_16x16x32_bf16 v[168:171], v[28:31], a[244:247], v[168:171]
    s_cbranch_scc1 L_pollslow1
L_pollok1:
    v_mfma_f32_16x16x32_bf16 v[172:175], v[24:27], v[200:203], v[140:143]
    s_add_u32 s92, s92, 1
    v_exp_f32 v18, v90
    v_mfma_f32_16x16x32_bf16 v[172:175], v[28:31], v[204:207], v[172:175]
    s_waitcnt lgkmcnt(2)
    v_add_f32 v7, v7, v16
    v_add_f32 v7, v7, v17
    v_mfma_f32_16x16x32_bf16 v[96:99], v[32:35], a[192:195], v[128:131]
    ds_read_b128 v[24:27], v2 offset:6272
    v_lshlrev_b32 v50, 16, v58
    v_mfma_f32_16x16x32_bf16 v[96:99], v[36:39], a[196:199], v[96:99]
    buffer_store_dwordx4 v[144:147], v15, s[4:7], s35 offen offset:0 sc1
    v_mfma_f32_16x16x32_bf16 v[100:103], v[32:35], a[216:219], v[132:135]
    v_exp_f32 v19, v91
    v_mfma_f32_16x16x32_bf16 v[100:103], v[36:39], a[220:223], v[100:103]
    v_cvt_pk_bf16_f32 v88, v16, v17
    v_mfma_f32_16x16x32_bf16 v[104:107], v[32:35], a[240:243], v[136:139]
    ds_read_b128 v[28:31], v3 offset:6272
    v_mfma_f32_16x16x32_bf16 v[104:107], v[36:39], a[244:247], v[104:107]
    v_exp_f32 v16, v120
    v_mfma_f32_16x16x32_bf16 v[108:111], v[32:35], v[200:203], v[140:143]
    v_add_f32 v7, v7, v18
    v_add_f32 v7, v7, v19
    v_mfma_f32_16x16x32_bf16 v[108:111], v[36:39], v[204:207], v[108:111]
    s_waitcnt lgkmcnt(2)
    v_exp_f32 v17, v121
    v_mfma_f32_16x16x32_bf16 v[160:163], v[40:43], a[200:203], v[160:163]
    ds_read_b128 v[32:35], v2 offset:256
    v_cvt_pk_bf16_f32 v89, v18, v19
    v_mfma_f32_16x16x32_bf16 v[160:163], v[44:47], a[204:207], v[160:163]
    buffer_store_dwordx4 v[148:151], v15, s[4:7], s35 offen offset:3072 sc1
    v_mfma_f32_16x16x32_bf16 v[164:167], v[40:43], a[224:227], v[164:167]
    v_exp_f32 v18, v122
    v_mfma_f32_16x16x32_bf16 v[164:167], v[44:47], a[228:231], v[164:167]
    v_add_f32 v7, v7, v16
    v_add_f32 v7, v7, v17
    v_mfma_f32_16x16x32_bf16 v[168:171], v[40:43], a[248:251], v[168:171]
    ds_read_b128 v[36:39], v3 offset:256
    v_and_b32 v51, s97, v58
    v_mfma_f32_16x16x32_bf16 v[168:171], v[44:47], a[252:255], v[168:171]
    v_exp_f32 v19, v123
    v_mfma_f32_16x16x32_bf16 v[172:175], v[40:43], v[208:211], v[172:175]
    v_cvt_pk_bf16_f32 v90, v16, v17
    v_mul_f32 v48, s38, v48
    v_mfma_f32_16x16x32_bf16 v[172:175], v[44:47], v[212:215], v[172:175]
    s_waitcnt lgkmcnt(2)
    v_exp_f32 v16, v92
    v_mfma_f32_16x16x32_bf16 v[96:99], v[24:27], a[200:203], v[96:99]
    ds_read_b128 v[40:43], v2 offset:6400
    v_add_f32 v7, v7, v18
    v_mfma_f32_16x16x32_bf16 v[96:99], v[28:31], a[204:207], v[96:99]
    buffer_store_dwordx4 v[152:155], v15, s[4:7], s17 offen offset:0 sc1
    v_mfma_f32_16x16x32_bf16 v[100:103], v[24:27], a[224:227], v[100:103]
    v_add_f32 v7, v7, v19
    v_mul_f32 v49, s38, v49
    v_mfma_f32_16x16x32_bf16 v[100:103], v[28:31], a[228:231], v[100:103]
    v_exp_f32 v17, v93
    v_mfma_f32_16x16x32_bf16 v[104:107], v[24:27], a[248:251], v[104:107]
    ds_read_b128 v[44:47], v3 offset:6400
    v_cvt_pk_bf16_f32 v91, v18, v19
    v_mfma_f32_16x16x32_bf16 v[104:107], v[28:31], a[252:255], v[104:107]
    v_exp_f32 v18, v94
    v_mfma_f32_16x16x32_bf16 v[108:111], v[24:27], v[208:211], v[108:111]
    s_add_u32 s29, s30, 49152
    v_add_f32 v8, v8, v16
    v_add_f32 v8, v8, v17
    v_mfma_f32_16x16x32_bf16 v[108:111], v[28:31], v[212:215], v[108:111]
    s_waitcnt lgkmcnt(2)
    v_exp_f32 v19, v95
    v_mfma_f32_16x16x32_bf16 v[160:163], v[32:35], a[208:211], v[160:163]
    s_sub_u32 s3, s29, 147456
    ds_read_b128 v[24:27], v2 offset:12288
    v_cvt_pk_bf16_f32 v92, v16, v17
    v_mfma_f32_16x16x32_bf16 v[160:163], v[36:39], a[212:215], v[160:163]
    buffer_store_dwordx4 v[156:159], v15, s[4:7], s17 offen offset:3072 sc1
    v_mfma_f32_16x16x32_bf16 v[164:167], v[32:35], a[232:235], v[164:167]
    s_min_u32 s29, s29, s3
    v_exp_f32 v16, v124
    v_mfma_f32_16x16x32_bf16 v[164:167], v[36:39], a[236:239], v[164:167]
    v_add_f32 v8, v8, v18
    v_add_f32 v8, v8, v19
    v_mfma_f32_16x16x32_bf16 v[168:171], v[32:35], v[192:195], v[168:171]
    ds_read_b128 v[28:31], v3 offset:12288
    v_mul_f32_e64 v50, -v50, v48
    v_mfma_f32_16x16x32_bf16 v[168:171], v[36:39], v[196:199], v[168:171]
    v_exp_f32 v17, v125
    v_mfma_f32_16x16x32_bf16 v[172:175], v[32:35], v[216:219], v[172:175]
    v_cvt_pk_bf16_f32 v93, v18, v19
    v_mul_f32_e64 v51, -v51, v49
    v_mfma_f32_16x16x32_bf16 v[172:175], v[36:39], v[220:223], v[172:175]
    s_waitcnt lgkmcnt(2)
    v_exp_f32 v18, v126
    v_mfma_f32_16x16x32_bf16 v[96:99], v[40:43], a[208:211], v[96:99]
    ds_read_b128 v[32:35], v2 offset:18432
    v_add_f32 v8, v8, v16
    v_mfma_f32_16x16x32_bf16 v[96:99], v[44:47], a[212:215], v[96:99]
    s_mov_b32 m0, s26
    v_add_f32 v8, v8, v17
    s_sub_u32 s3, s29, s30
    v_mfma_f32_16x16x32_bf16 v[100:103], v[40:43], a[232:235], v[100:103]
    v_exp_f32 v19, v127
    v_mfma_f32_16x16x32_bf16 v[100:103], v[44:47], a[236:239], v[100:103]
    buffer_load_dwordx4 v4, s[4:7], s32 offen offset:0 sc1 lds
    v_mfma_f32_16x16x32_bf16 v[104:107], v[40:43], v[192:195], v[104:107]
    ds_read_b128 v[36:39], v3 offset:18432
    v_cvt_pk_bf16_f32 v94, v16, v17
    v_mfma_f32_16x16x32_bf16 v[104:107], v[44:47], v[196:199], v[104:107]
    v_add_f32 v8, v8, v18
    v_add_f32 v8, v8, v19
    v_mfma_f32_16x16x32_bf16 v[108:111], v[40:43], v[216:219], v[108:111]
    v_cvt_pk_bf16_f32 v95, v18, v19
    v_cvt_f32_i32 v224, v224
    v_mfma_f32_16x16x32_bf16 v[108:111], v[44:47], v[220:223], v[108:111]
    s_waitcnt lgkmcnt(2)
    buffer_load_dwordx4 v4, s[4:7], s32 offen offset:1024 sc1 lds
    v_mfma_f32_16x16x32_bf16 v[176:179], v[24:27], a[192:195], v[128:131]
    ds_read_b128 v[40:43], v2 offset:12416
    v_cvt_f32_i32 v225, v225
    v_mfma_f32_16x16x32_bf16 v[176:179], v[28:31], a[196:199], v[176:179]
    s_mov_b32 s30, s29
    v_exp_f32 v16, v160
    v_mfma_f32_16x16x32_bf16 v[180:183], v[24:27], a[216:219], v[132:135]
    v_exp_f32 v17, v161
    v_mfma_f32_16x16x32_bf16 v[180:183], v[28:31], a[220:223], v[180:183]
    buffer_load_dwordx4 v4, s[4:7], s32 offen offset:2048 sc1 lds
    v_mfma_f32_16x16x32_bf16 v[184:187], v[24:27], a[240:243], v[136:139]
    s_add_u32 s32, s32, 24576
    ds_read_b128 v[44:47], v3 offset:12416
    v_mfma_f32_16x16x32_bf16 v[184:187], v[28:31], a[244:247], v[184:187]
    v_exp_f32 v18, v162
    v_mfma_f32_16x16x32_bf16 v[188:191], v[24:27], v[200:203], v[140:143]
    s_add_u32 s26, s26, 12288
    v_add_f32 v5, v5, v16
    v_add_f32 v5, v5, v17
    v_mfma_f32_16x16x32_bf16 v[188:191], v[28:31], v[204:207], v[188:191]
    s_waitcnt lgkmcnt(2)
    v_exp_f32 v19, v163
    v_mfma_f32_16x16x32_bf16 v[112:115], v[32:35], a[192:195], v[128:131]
    s_mov_b32 m0, s26
    ds_read_b128 v[24:27], v2 offset:18560
    v_cvt_pk_bf16_f32 v160, v16, v17
    v_mfma_f32_16x16x32_bf16 v[112:115], v[36:39], a[196:199], v[112:115]
    v_exp_f32 v16, v96
    v_mfma_f32_16x16x32_bf16 v[116:119], v[32:35], a[216:219], v[132:135]
    v_add_f32 v5, v5, v18
    v_fma_f32 v224, v224, v48, v50
    v_mfma_f32_16x16x32_bf16 v[116:119], v[36:39], a[220:223], v[116:119]
    v_add_f32 v5, v5, v19
    v_fma_f32 v225, v225, v49, v51
    v_mfma_f32_16x16x32_bf16 v[120:123], v[32:35], a[240:243], v[136:139]
    ds_read_b128 v[28:31], v3 offset:18560
    v_add_u32 v1, s3, v1
    v_mfma_f32_16x16x32_bf16 v[120:123], v[36:39], a[244:247], v[120:123]
    buffer_load_dwordx4 v4, s[4:7], s32 offen offset:0 sc1 lds
    v_mfma_f32_16x16x32_bf16 v[124:127], v[32:35], v[200:203], v[140:143]
    v_exp_f32 v17, v97
    v_mfma_f32_16x16x32_bf16 v[124:127], v[36:39], v[204:207], v[124:127]
    s_waitcnt lgkmcnt(2)
    v_cvt_pk_bf16_f32 v161, v18, v19
    v_mfma_f32_16x16x32_bf16 v[176:179], v[40:43], a[200:203], v[176:179]
    ds_read_b128 v[32:35], v2 offset:12544
    v_cvt_pk_bf16_f32 v224, v224, v225
    v_mfma_f32_16x16x32_bf16 v[176:179], v[44:47], a[204:207], v[176:179]
    buffer_load_dwordx4 v4, s[4:7], s32 offen offset:1024 sc1 lds
    v_mfma_f32_16x16x32_bf16 v[180:183], v[40:43], a[224:227], v[180:183]
    v_exp_f32 v18, v98
    v_mfma_f32_16x16x32_bf16 v[180:183], v[44:47], a[228:231], v[180:183]
    v_add_f32 v5, v5, v16
    v_add_f32 v5, v5, v17
    v_mfma_f32_16x16x32_bf16 v[184:187], v[40:43], a[248:251], v[184:187]
    ds_read_b128 v[36:39], v3 offset:12544
    v_mfma_f32_16x16x32_bf16 v[184:187], v[44:47], a[252:255], v[184:187]
    buffer_load_dwordx4 v4, s[4:7], s32 offen offset:2048 sc1 lds
    v_mfma_f32_16x16x32_bf16 v[188:191], v[40:43], v[208:211], v[188:191]
    v_exp_f32 v19, v99
    v_mfma_f32_16x16x32_bf16 v[188:191], v[44:47], v[212:215], v[188:191]
    s_waitcnt lgkmcnt(2)
    v_cvt_pk_bf16_f32 v162, v16, v17
    v_cvt_f32_i32 v228, v228
    v_mfma_f32_16x16x32_bf16 v[112:115], v[24:27], a[200:203], v[112:115]
    ds_read_b128 v[40:43], v2 offset:18688
    v_mfma_f32_16x16x32_bf16 v[112:115], v[28:31], a[204:207], v[112:115]
    v_exp_f32 v16, v164
    v_mfma_f32_16x16x32_bf16 v[116:119], v[24:27], a[224:227], v[116:119]
    v_add_f32 v5, v5, v18
    v_add_f32 v5, v5, v19
    v_mfma_f32_16x16x32_bf16 v[116:119], v[28:31], a[228:231], v[116:119]
    s_add_u32 s32, s32, 24576
    v_exp_f32 v17, v165
    v_mfma_f32_16x16x32_bf16 v[120:123], v[24:27], a[248:251], v[120:123]
    s_add_u32 s26, s26, 36864
    ds_read_b128 v[44:47], v3 offset:18688
    v_cvt_pk_bf16_f32 v163, v18, v19
    v_mfma_f32_16x16x32_bf16 v[120:123], v[28:31], a[252:255], v[120:123]
    s_waitcnt lgkmcnt(2)
    v_exp_f32 v18, v166
    v_mfma_f32_16x16x32_bf16 v[124:127], v[24:27], v[208:211], v[124:127]
    s_waitcnt vmcnt(6)
    v_add_f32 v6, v6, v16
    v_add_f32 v6, v6, v17
    v_mfma_f32_16x16x32_bf16 v[124:127], v[28:31], v[212:215], v[124:127]
    s_barrier
    s_sub_u32 s57, s26, 147456
    v_mfma_f32_16x16x32_bf16 v[176:179], v[32:35], a[208:211], v[176:179]
    s_min_u32 s26, s26, s57
    ds_read_b128 v[24:27], v1 offset:0
    v_add_u32 v0, 1, v0
    v_mfma_f32_16x16x32_bf16 v[176:179], v[36:39], a[212:215], v[176:179]
    buffer_store_dword v0, v13, s[20:23], 0 offen offset:32 sc1
    v_mfma_f32_16x16x32_bf16 v[180:183], v[32:35], a[232:235], v[180:183]
    v_exp_f32 v19, v167
    v_mfma_f32_16x16x32_bf16 v[180:183], v[36:39], a[236:239], v[180:183]
    v_cvt_pk_bf16_f32 v164, v16, v17
    v_cvt_f32_i32 v229, v229
    v_mfma_f32_16x16x32_bf16 v[184:187], v[32:35], v[192:195], v[184:187]
    ds_read_b128 v[28:31], v1 offset:12288
    v_fma_f32 v228, v228, v48, v50
    v_mfma_f32_16x16x32_bf16 v[184:187], v[36:39], v[196:199], v[184:187]
    v_exp_f32 v16, v100
    v_mfma_f32_16x16x32_bf16 v[188:191], v[32:35], v[216:219], v[188:191]
    v_add_f32 v6, v6, v18
    v_add_f32 v6, v6, v19
    v_mfma_f32_16x16x32_bf16 v[188:191], v[36:39], v[220:223], v[188:191]
    s_waitcnt lgkmcnt(2)
    v_exp_f32 v17, v101
    v_mfma_f32_16x16x32_bf16 v[112:115], v[40:43], a[208:211], v[112:115]
    ds_read_b128 v[32:35], v1 offset:1024
    v_cvt_pk_bf16_f32 v165, v18, v19
    v_mfma_f32_16x16x32_bf16 v[112:115], v[44:47], a[212:215], v[112:115]
    v_exp_f32 v18, v102
    v_mfma_f32_16x16x32_bf16 v[116:119], v[40:43], a[232:235], v[116:119]
    v_add_f32 v6, v6, v16
    v_add_f32 v6, v6, v17
    v_mfma_f32_16x16x32_bf16 v[116:119], v[44:47], a[236:239], v[116:119]
    v_exp_f32 v19, v103
    v_mfma_f32_16x16x32_bf16 v[120:123], v[40:43], v[192:195], v[120:123]
    ds_read_b128 v[36:39], v1 offset:13312
    v_cvt_pk_bf16_f32 v166, v16, v17
    v_mfma_f32_16x16x32_bf16 v[120:123], v[44:47], v[196:199], v[120:123]
    v_add_f32 v6, v6, v18
    v_add_f32 v6, v6, v19
    v_mfma_f32_16x16x32_bf16 v[124:127], v[40:43], v[216:219], v[124:127]
    v_cvt_pk_bf16_f32 v167, v18, v19
    v_mfma_f32_16x16x32_bf16 v[124:127], v[44:47], v[220:223], v[124:127]
    s_waitcnt lgkmcnt(2)
    v_mfma_f32_16x16x32_bf16 a[0:3], v[64:67], v[24:27], a[0:3]
    s_mov_b32 m0, s26
    ds_read_b128 v[40:43], v1 offset:2048
    v_fma_f32 v229, v229, v49, v51
    v_mfma_f32_16x16x32_bf16 a[0:3], v[80:83], v[28:31], a[0:3]
    buffer_load_dwordx2 v[60:61], v10, s[72:75], s36 offen offset:192
    v_mfma_f32_16x16x32_bf16 a[48:51], v[68:71], v[24:27], a[48:51]
    v_exp_f32 v16, v168
    v_mfma_f32_16x16x32_bf16 a[48:51], v[84:87], v[28:31], a[48:51]
    v_exp_f32 v17, v169
    v_mfma_f32_16x16x32_bf16 a[96:99], v[72:75], v[24:27], a[96:99]
    ds_read_b128 v[44:47], v1 offset:14336
    v_cvt_pk_bf16_f32 v228, v228, v229
    v_mfma_f32_16x16x32_bf16 a[96:99], v[88:91], v[28:31], a[96:99]
    buffer_load_dwordx4 v4, s[4:7], s32 offen offset:0 sc1 lds
    v_mfma_f32_16x16x32_bf16 a[144:147], v[76:79], v[24:27], a[144:147]
    v_exp_f32 v18, v170
    v_mfma_f32_16x16x32_bf16 a[144:147], v[92:95], v[28:31], a[144:147]
    s_waitcnt lgkmcnt(2)
    v_add_f32 v7, v7, v16
    v_add_f32 v7, v7, v17
    v_mfma_f32_16x16x32_bf16 a[4:7], v[64:67], v[32:35], a[4:7]
    ds_read_b128 v[24:27], v1 offset:3072
    v_cvt_f32_i32 v232, v232
    v_mfma_f32_16x16x32_bf16 a[4:7], v[80:83], v[36:39], a[4:7]
    buffer_load_dwordx2 v[62:63], v10, s[76:79], s36 offen offset:192
    v_mfma_f32_16x16x32_bf16 a[52:55], v[68:71], v[32:35], a[52:55]
    v_exp_f32 v19, v171
    v_mfma_f32_16x16x32_bf16 a[52:55], v[84:87], v[36:39], a[52:55]
    v_cvt_pk_bf16_f32 v168, v16, v17
    v_cvt_f32_i32 v233, v233
    v_mfma_f32_16x16x32_bf16 a[100:103], v[72:75], v[32:35], a[100:103]
    ds_read_b128 v[28:31], v1 offset:15360
    v_fma_f32 v232, v232, v48, v50
    v_mfma_f32_16x16x32_bf16 a[100:103], v[88:91], v[36:39], a[100:103]
    buffer_load_dwordx4 v[240:243], v9, s[64:67], s33 offen offset:384 nt
    v_mfma_f32_16x16x32_bf16 a[148:151], v[76:79], v[32:35], a[148:151]
    v_exp_f32 v16, v104
    v_mfma_f32_16x16x32_bf16 a[148:151], v[92:95], v[36:39], a[148:151]
    s_waitcnt lgkmcnt(2)
    v_add_f32 v7, v7, v18
    v_add_f32 v7, v7, v19
    v_mfma_f32_16x16x32_bf16 a[8:11], v[64:67], v[40:43], a[8:11]
    ds_read_b128 v[32:35], v1 offset:4096
    v_fma_f32 v233, v233, v49, v51
    v_mfma_f32_16x16x32_bf16 a[8:11], v[80:83], v[44:47], a[8:11]
    buffer_load_dwordx4 v4, s[4:7], s32 offen offset:1024 sc1 lds
    v_mfma_f32_16x16x32_bf16 a[56:59], v[68:71], v[40:43], a[56:59]
    v_exp_f32 v17, v105
    v_mfma_f32_16x16x32_bf16 a[56:59], v[84:87], v[44:47], a[56:59]
    v_cvt_pk_bf16_f32 v169, v18, v19
    v_cvt_pk_bf16_f32 v232, v232, v233
    v_mfma_f32_16x16x32_bf16 a[104:107], v[72:75], v[40:43], a[104:107]
    ds_read_b128 v[36:39], v1 offset:16384
    v_cvt_f32_i32 v236, v236
    v_mfma_f32_16x16x32_bf16 a[104:107], v[88:91], v[44:47], a[104:107]
    buffer_load_dwordx4 v[244:247], v9, s[64:67], s33 offen offset:1920 nt
    v_mfma_f32_16x16x32_bf16 a[152:155], v[76:79], v[40:43], a[152:155]
    v_exp_f32 v18, v106
    v_mfma_f32_16x16x32_bf16 a[152:155], v[92:95], v[44:47], a[152:155]
    s_waitcnt lgkmcnt(2)
    v_add_f32 v7, v7, v16
    v_add_f32 v7, v7, v17
    v_mfma_f32_16x16x32_bf16 a[12:15], v[64:67], v[24:27], a[12:15]
    ds_read_b128 v[40:43], v1 offset:5120
    v_cvt_f32_i32 v237, v237
    v_mfma_f32_16x16x32_bf16 a[12:15], v[80:83], v[28:31], a[12:15]
    buffer_load_dwordx4 v4, s[4:7], s32 offen offset:2048 sc1 lds
    v_mfma_f32_16x16x32_bf16 a[60:63], v[68:71], v[24:27], a[60:63]
    v_exp_f32 v19, v107
    v_mfma_f32_16x16x32_bf16 a[60:63], v[84:87], v[28:31], a[60:63]
    v_cvt_pk_bf16_f32 v170, v16, v17
    v_exp_f32 v16, v172
    v_mfma_f32_16x16x32_bf16 a[108:111], v[72:75], v[24:27], a[108:111]
    ds_read_b128 v[44:47], v1 offset:17408
    v_add_f32 v7, v7, v18
    v_mfma_f32_16x16x32_bf16 a[108:111], v[88:91], v[28:31], a[108:111]
    buffer_load_dwordx4 v[248:251], v9, s[64:67], s34 offen offset:384 nt
    v_add_f32 v7, v7, v19
    v_mfma_f32_16x16x32_bf16 a[156:159], v[76:79], v[24:27], a[156:159]
    s_add_u32 s29, s28, 49152
    v_exp_f32 v17, v173
    v_mfma_f32_16x16x32_bf16 a[156:159], v[92:95], v[28:31], a[156:159]
    s_waitcnt lgkmcnt(2)
    v_cvt_pk_bf16_f32 v171, v18, v19
    v_fma_f32 v236, v236, v48, v50
    v_mfma_f32_16x16x32_bf16 a[16:19], v[64:67], v[32:35], a[16:19]
    s_sub_u32 s3, s29, 147456
    ds_read_b128 v[24:27], v1 offset:6144
    v_fma_f32 v237, v237, v49, v51
    v_mfma_f32_16x16x32_bf16 a[16:19], v[80:83], v[36:39], a[16:19]
    s_add_u32 s32, s32, 24576
    buffer_load_dwordx4 v[252:255], v9, s[64:67], s34 offen offset:1920 nt
    v_mfma_f32_16x16x32_bf16 a[64:67], v[68:71], v[32:35], a[64:67]
    s_min_u32 s29, s29, s3
    v_exp_f32 v18, v174
    v_mfma_f32_16x16x32_bf16 a[64:67], v[84:87], v[36:39], a[64:67]
    v_add_f32 v8, v8, v16
    v_add_f32 v8, v8, v17
    v_mfma_f32_16x16x32_bf16 a[112:115], v[72:75], v[32:35], a[112:115]
    s_add_u32 s26, s26, 12288
    ds_read_b128 v[28:31], v1 offset:18432
    v_cvt_pk_bf16_f32 v236, v236, v237
    v_mfma_f32_16x16x32_bf16 a[112:115], v[88:91], v[36:39], a[112:115]
    v_exp_f32 v19, v175
    v_cvt_pk_bf16_f32 v172, v16, v17
    v_mfma_f32_16x16x32_bf16 a[160:163], v[76:79], v[32:35], a[160:163]
    v_exp_f32 v16, v108
    v_mfma_f32_16x16x32_bf16 a[160:163], v[92:95], v[36:39], a[160:163]
    s_waitcnt lgkmcnt(2)
    v_add_f32 v8, v8, v18
    v_add_f32 v8, v8, v19
    v_mfma_f32_16x16x32_bf16 a[20:23], v[64:67], v[40:43], a[20:23]
    s_sub_u32 s3, s29, s28
    ds_read_b128 v[32:35], v1 offset:7168
    v_lshlrev_b32 v48, 16, v57
    v_mfma_f32_16x16x32_bf16 a[20:23], v[80:83], v[44:47], a[20:23]
    v_exp_f32 v17, v109
    v_mfma_f32_16x16x32_bf16 a[68:71], v[68:71], v[40:43], a[68:71]
    s_mov_b32 m0, s26
    v_cvt_pk_bf16_f32 v173, v18, v19
    v_and_b32 v49, s97, v57
    v_mfma_f32_16x16x32_bf16 a[68:71], v[84:87], v[44:47], a[68:71]
    v_exp_f32 v18, v110
    v_mfma_f32_16x16x32_bf16 a[116:119], v[72:75], v[40:43], a[116:119]
    ds_read_b128 v[36:39], v1 offset:19456
    v_add_f32 v8, v8, v16
    v_mfma_f32_16x16x32_bf16 a[116:119], v[88:91], v[44:47], a[116:119]
    v_add_f32 v8, v8, v17
    v_mfma_f32_16x16x32_bf16 a[164:167], v[76:79], v[40:43], a[164:167]
    s_mov_b32 s28, s29
    v_exp_f32 v19, v111
    v_mfma_f32_16x16x32_bf16 a[164:167], v[92:95], v[44:47], a[164:167]
    s_waitcnt lgkmcnt(2)
    v_cvt_pk_bf16_f32 v174, v16, v17
    v_add_f32 v8, v8, v18
    v_mfma_f32_16x16x32_bf16 a[24:27], v[64:67], v[24:27], a[24:27]
    ds_read_b128 v[40:43], v1 offset:8192
    v_add_f32 v8, v8, v19
    v_mfma_f32_16x16x32_bf16 a[24:27], v[80:83], v[28:31], a[24:27]
    v_cvt_pk_bf16_f32 v175, v18, v19
    v_lshlrev_b32 v50, 16, v59
    v_mfma_f32_16x16x32_bf16 a[72:75], v[68:71], v[24:27], a[72:75]
    v_exp_f32 v16, v176
    v_mfma_f32_16x16x32_bf16 a[72:75], v[84:87], v[28:31], a[72:75]
    buffer_load_dwordx4 v4, s[4:7], s32 offen offset:0 sc1 lds
    v_mfma_f32_16x16x32_bf16 a[120:123], v[72:75], v[24:27], a[120:123]
    ds_read_b128 v[44:47], v1 offset:20480
    v_and_b32 v51, s97, v59
    v_mfma_f32_16x16x32_bf16 a[120:123], v[88:91], v[28:31], a[120:123]
    v_exp_f32 v17, v177
    v_mfma_f32_16x16x32_bf16 a[168:171], v[76:79], v[24:27], a[168:171]
    v_exp_f32 v18, v178
    v_mfma_f32_16x16x32_bf16 a[168:171], v[92:95], v[28:31], a[168:171]
    s_waitcnt lgkmcnt(2)
    v_add_f32 v5, v5, v16
    v_add_f32 v5, v5, v17
    v_mfma_f32_16x16x32_bf16 a[28:31], v[64:67], v[32:35], a[28:31]
    ds_read_b128 v[24:27], v1 offset:9216
    v_mul_f32 v48, s38, v48
    v_mfma_f32_16x16x32_bf16 a[28:31], v[80:83], v[36:39], a[28:31]
    v_exp_f32 v19, v179
    v_mfma_f32_16x16x32_bf16 a[76:79], v[68:71], v[32:35], a[76:79]
    v_cvt_pk_bf16_f32 v176, v16, v17
    v_add_u32 v2, s3, v2
    v_mfma_f32_16x16x32_bf16 a[76:79], v[84:87], v[36:39], a[76:79]
    v_exp_f32 v16, v112
    v_mfma_f32_16x16x32_bf16 a[124:127], v[72:75], v[32:35], a[124:127]
    ds_read_b128 v[28:31], v1 offset:21504
    v_add_f32 v5, v5, v18
    v_mfma_f32_16x16x32_bf16 a[124:127], v[88:91], v[36:39], a[124:127]
    v_add_f32 v5, v5, v19
    v_mul_f32 v49, s38, v49
    v_mfma_f32_16x16x32_bf16 a[172:175], v[76:79], v[32:35], a[172:175]
    v_exp_f32 v17, v113
    v_mfma_f32_16x16x32_bf16 a[172:175], v[92:95], v[36:39], a[172:175]
    s_waitcnt lgkmcnt(2)
    buffer_load_dwordx4 v4, s[4:7], s32 offen offset:1024 sc1 lds
    v_mfma_f32_16x16x32_bf16 a[32:35], v[64:67], v[40:43], a[32:35]
    ds_read_b128 v[32:35], v1 offset:10240
    v_cvt_pk_bf16_f32 v177, v18, v19
    v_mfma_f32_16x16x32_bf16 a[32:35], v[80:83], v[44:47], a[32:35]
    v_exp_f32 v18, v114
    v_mfma_f32_16x16x32_bf16 a[80:83], v[68:71], v[40:43], a[80:83]
    v_add_f32 v5, v5, v16
    v_add_f32 v5, v5, v17
    v_mfma_f32_16x16x32_bf16 a[80:83], v[84:87], v[44:47], a[80:83]
    v_exp_f32 v19, v115
    v_mfma_f32_16x16x32_bf16 a[128:131], v[72:75], v[40:43], a[128:131]
    ds_read_b128 v[36:39], v1 offset:22528
    v_mul_f32_e64 v50, -v50, v48
    v_mfma_f32_16x16x32_bf16 a[128:131], v[88:91], v[44:47], a[128:131]
    v_cvt_pk_bf16_f32 v178, v16, v17
    v_mul_f32_e64 v51, -v51, v49
    v_mfma_f32_16x16x32_bf16 a[176:179], v[76:79], v[40:43], a[176:179]
    v_exp_f32 v16, v180
    v_mfma_f32_16x16x32_bf16 a[176:179], v[92:95], v[44:47], a[176:179]
    s_waitcnt lgkmcnt(2)
    v_add_f32 v5, v5, v18
    v_add_u32 v3, s3, v3
    v_mfma_f32_16x16x32_bf16 a[36:39], v[64:67], v[24:27], a[36:39]
    ds_read_b128 v[40:43], v1 offset:11264
    v_add_f32 v5, v5, v19
    v_mfma_f32_16x16x32_bf16 a[36:39], v[80:83], v[28:31], a[36:39]
    buffer_load_dwordx4 v4, s[4:7], s32 offen offset:2048 sc1 lds
    v_mfma_f32_16x16x32_bf16 a[84:87], v[68:71], v[24:27], a[84:87]
    v_exp_f32 v17, v181
    v_mfma_f32_16x16x32_bf16 a[84:87], v[84:87], v[28:31], a[84:87]
    v_cvt_pk_bf16_f32 v179, v18, v19
    v_cvt_f32_i32 v226, v226
    v_mfma_f32_16x16x32_bf16 a[132:135], v[72:75], v[24:27], a[132:135]
    ds_read_b128 v[44:47], v1 offset:23552
    v_cvt_f32_i32 v227, v227
    v_mfma_f32_16x16x32_bf16 a[132:135], v[88:91], v[28:31], a[132:135]
    s_waitcnt lgkmcnt(2)
    v_exp_f32 v18, v182
    v_mfma_f32_16x16x32_bf16 a[180:183], v[76:79], v[24:27], a[180:183]
    s_waitcnt vmcnt(13)
    v_add_f32 v6, v6, v16
    v_add_f32 v6, v6, v17
    v_mfma_f32_16x16x32_bf16 a[180:183], v[92:95], v[28:31], a[180:183]
    s_barrier
    v_fma_f32 v226, v226, v48, v50
    v_mfma_f32_16x16x32_bf16 a[40:43], v[64:67], v[32:35], a[40:43]
    ds_read_b128 v[24:27], v2 offset:0
    v_fma_f32 v227, v227, v49, v51
    v_mfma_f32_16x16x32_bf16 a[40:43], v[80:83], v[36:39], a[40:43]
    v_exp_f32 v19, v183
    v_mfma_f32_16x16x32_bf16 a[88:91], v[68:71], v[32:35], a[88:91]
    v_cvt_pk_bf16_f32 v180, v16, v17
    v_mfma_f32_16x16x32_bf16 a[88:91], v[84:87], v[36:39], a[88:91]
    v_exp_f32 v16, v116
    v_mfma_f32_16x16x32_bf16 a[136:139], v[72:75], v[32:35], a[136:139]
    ds_read_b128 v[28:31], v3 offset:0
    v_add_f32 v6, v6, v18
    v_mfma_f32_16x16x32_bf16 a[136:139], v[88:91], v[36:39], a[136:139]
    v_add_f32 v6, v6, v19
    v_cvt_pk_bf16_f32 v225, v226, v227
    v_mfma_f32_16x16x32_bf16 a[184:187], v[76:79], v[32:35], a[184:187]
    v_exp_f32 v17, v117
    v_mfma_f32_16x16x32_bf16 a[184:187], v[92:95], v[36:39], a[184:187]
    s_waitcnt lgkmcnt(2)
    v_cvt_pk_bf16_f32 v181, v18, v19
    v_cvt_f32_i32 v230, v230
    v_mfma_f32_16x16x32_bf16 a[44:47], v[64:67], v[40:43], a[44:47]
    ds_read_b128 v[32:35], v2 offset:6144
    v_mfma_f32_16x16x32_bf16 a[44:47], v[80:83], v[44:47], a[44:47]
    v_exp_f32 v18, v118
    v_mfma_f32_16x16x32_bf16 a[92:95], v[68:71], v[40:43], a[92:95]
    v_add_f32 v6, v6, v16
    v_add_f32 v6, v6, v17
    v_mfma_f32_16x16x32_bf16 a[92:95], v[84:87], v[44:47], a[92:95]
    s_add_u32 s32, s32, 24576
    v_exp_f32 v19, v119
    v_mfma_f32_16x16x32_bf16 a[140:143], v[72:75], v[40:43], a[140:143]
    s_add_u32 s26, s26, 36864
    ds_read_b128 v[36:39], v3 offset:6144
    v_cvt_pk_bf16_f32 v182, v16, v17
    v_mfma_f32_16x16x32_bf16 a[140:143], v[88:91], v[44:47], a[140:143]
    s_sub_u32 s57, s26, 147456
    v_add_f32 v6, v6, v18
    v_add_f32 v6, v6, v19
    v_mfma_f32_16x16x32_bf16 a[188:191], v[76:79], v[40:43], a[188:191]
    s_min_u32 s26, s26, s57
    v_cvt_pk_bf16_f32 v183, v18, v19
    v_mfma_f32_16x16x32_bf16 a[188:191], v[92:95], v[44:47], a[188:191]
    s_waitcnt lgkmcnt(2)
    v_mfma_f32_16x16x32_bf16 v[64:67], v[24:27], a[192:195], v[128:131]
    ds_read_b128 v[40:43], v2 offset:128
    v_cvt_f32_i32 v231, v231
    v_mfma_f32_16x16x32_bf16 v[64:67], v[28:31], a[196:199], v[64:67]
    v_exp_f32 v16, v184
    v_mfma_f32_16x16x32_bf16 v[68:71], v[24:27], a[216:219], v[132:135]
    v_exp_f32 v17, v185
    v_mfma_f32_16x16x32_bf16 v[68:71], v[28:31], a[220:223], v[68:71]
    v_bfe_u32 v53, v4, 4, 6
    v_fma_f32 v230, v230, v48, v50
    v_mfma_f32_16x16x32_bf16 v[72:75], v[24:27], a[240:243], v[136:139]
    ds_read_b128 v[44:47], v3 offset:128
    v_lshlrev_b32 v53, 2, v53
    v_mfma_f32_16x16x32_bf16 v[72:75], v[28:31], a[244:247], v[72:75]
    buffer_load_dword v52, v53, s[20:23], s44 offen sc1
    v_mfma_f32_16x16x32_bf16 v[76:79], v[24:27], v[200:203], v[140:143]
    v_exp_f32 v18, v186
    v_mfma_f32_16x16x32_bf16 v[76:79], v[28:31], v[204:207], v[76:79]
    s_waitcnt lgkmcnt(2)
    v_add_f32 v7, v7, v16
    v_add_f32 v7, v7, v17
    v_mfma_f32_16x16x32_bf16 v[96:99], v[32:35], a[192:195], v[128:131]
    ds_read_b128 v[24:27], v2 offset:6272
    v_fma_f32 v231, v231, v49, v51
    v_mfma_f32_16x16x32_bf16 v[96:99], v[36:39], a[196:199], v[96:99]
    v_exp_f32 v19, v187
    v_mfma_f32_16x16x32_bf16 v[100:103], v[32:35], a[216:219], v[132:135]
    v_cvt_pk_bf16_f32 v184, v16, v17
    v_cvt_pk_bf16_f32 v229, v230, v231
    v_mfma_f32_16x16x32_bf16 v[100:103], v[36:39], a[220:223], v[100:103]
    s_add_u32 s35, s35, 196608
    v_exp_f32 v16, v120
    v_mfma_f32_16x16x32_bf16 v[104:107], v[32:35], a[240:243], v[136:139]
    s_mov_b32 m0, s26
    ds_read_b128 v[28:31], v3 offset:6272
    v_add_f32 v7, v7, v18
    v_mfma_f32_16x16x32_bf16 v[104:107], v[36:39], a[244:247], v[104:107]
    s_add_u32 s16, s16, 196608
    buffer_load_dwordx4 v4, s[4:7], s32 offen offset:0 sc1 lds
    v_mfma_f32_16x16x32_bf16 v[108:111], v[32:35], v[200:203], v[140:143]
    s_add_u32 s17, s17, 196608
    v_add_f32 v7, v7, v19
    v_cvt_f32_i32 v234, v234
    v_mfma_f32_16x16x32_bf16 v[108:111], v[36:39], v[204:207], v[108:111]
    s_waitcnt lgkmcnt(2)
    v_exp_f32 v17, v121
    v_mfma_f32_16x16x32_bf16 v[64:67], v[40:43], a[200:203], v[64:67]
    s_add_u32 s37, s37, 512
    ds_read_b128 v[32:35], v2 offset:256
    v_cvt_pk_bf16_f32 v185, v18, v19
    v_mfma_f32_16x16x32_bf16 v[64:67], v[44:47], a[204:207], v[64:67]
    v_exp_f32 v18, v122
    v_mfma_f32_16x16x32_bf16 v[68:71], v[40:43], a[224:227], v[68:71]
    v_add_f32 v7, v7, v16
    v_add_f32 v7, v7, v17
    v_mfma_f32_16x16x32_bf16 v[68:71], v[44:47], a[228:231], v[68:71]
    v_exp_f32 v19, v123
    v_mfma_f32_16x16x32_bf16 v[72:75], v[40:43], a[248:251], v[72:75]
    ds_read_b128 v[36:39], v3 offset:256
    v_cvt_pk_bf16_f32 v186, v16, v17
    v_mfma_f32_16x16x32_bf16 v[72:75], v[44:47], a[252:255], v[72:75]
    buffer_load_dwordx4 v4, s[4:7], s32 offen offset:1024 sc1 lds
    v_mfma_f32_16x16x32_bf16 v[76:79], v[40:43], v[208:211], v[76:79]
    v_exp_f32 v16, v188
    v_mfma_f32_16x16x32_bf16 v[76:79], v[44:47], v[212:215], v[76:79]
    s_waitcnt lgkmcnt(2)
    v_add_f32 v7, v7, v18
    v_cvt_f32_i32 v235, v235
    v_mfma_f32_16x16x32_bf16 v[96:99], v[24:27], a[200:203], v[96:99]
    ds_read_b128 v[40:43], v2 offset:6400
    v_add_f32 v7, v7, v19
    v_mfma_f32_16x16x32_bf16 v[96:99], v[28:31], a[204:207], v[96:99]
    buffer_load_dwordx2 v[56:57], off, s[80:83], s37 offset:0
    v_mfma_f32_16x16x32_bf16 v[100:103], v[24:27], a[224:227], v[100:103]
    v_exp_f32 v17, v189
    v_mfma_f32_16x16x32_bf16 v[100:103], v[28:31], a[228:231], v[100:103]
    v_cvt_pk_bf16_f32 v187, v18, v19
    v_fma_f32 v234, v234, v48, v50
    v_mfma_f32_16x16x32_bf16 v[104:107], v[24:27], a[248:251], v[104:107]
    ds_read_b128 v[44:47], v3 offset:6400
    v_fma_f32 v235, v235, v49, v51
    v_mfma_f32_16x16x32_bf16 v[104:107], v[28:31], a[252:255], v[104:107]
    buffer_load_dwordx2 v[58:59], off, s[84:87], s37 offset:0
    v_mfma_f32_16x16x32_bf16 v[108:111], v[24:27], v[208:211], v[108:111]
    s_add_u32 s29, s30, 49152
    v_exp_f32 v18, v190
    v_mfma_f32_16x16x32_bf16 v[108:111], v[28:31], v[212:215], v[108:111]
    s_waitcnt lgkmcnt(2)
    v_add_f32 v8, v8, v16
    v_add_f32 v8, v8, v17
    v_mfma_f32_16x16x32_bf16 v[64:67], v[32:35], a[208:211], v[64:67]
    s_sub_u32 s3, s29, 147456
    ds_read_b128 v[24:27], v2 offset:12288
    v_cvt_pk_bf16_f32 v233, v234, v235
    v_mfma_f32_16x16x32_bf16 v[64:67], v[36:39], a[212:215], v[64:67]
    s_min_u32 s29, s29, s3
    buffer_load_dwordx4 v4, s[4:7], s32 offen offset:2048 sc1 lds
    v_mfma_f32_16x16x32_bf16 v[68:71], v[32:35], a[232:235], v[68:71]
    v_exp_f32 v19, v191
    v_mfma_f32_16x16x32_bf16 v[68:71], v[36:39], a[236:239], v[68:71]
    v_cvt_pk_bf16_f32 v188, v16, v17
    v_cvt_f32_i32 v238, v238
    v_mfma_f32_16x16x32_bf16 v[72:75], v[32:35], v[192:195], v[72:75]
    ds_read_b128 v[28:31], v3 offset:12288
    v_mfma_f32_16x16x32_bf16 v[72:75], v[36:39], v[196:199], v[72:75]
    buffer_load_dwordx4 v[144:147], v12, s[68:71], s35 offen offset:0 nt
    v_mfma_f32_16x16x32_bf16 v[76:79], v[32:35], v[216:219], v[76:79]
    v_exp_f32 v16, v124
    v_mfma_f32_16x16x32_bf16 v[76:79], v[36:39], v[220:223], v[76:79]
    s_waitcnt lgkmcnt(2)
    v_add_f32 v8, v8, v18
    v_add_f32 v8, v8, v19
    v_mfma_f32_16x16x32_bf16 v[96:99], v[40:43], a[208:211], v[96:99]
    s_add_u32 s32, s32, 24576
    ds_read_b128 v[32:35], v2 offset:18432
    v_cvt_f32_i32 v239, v239
    v_mfma_f32_16x16x32_bf16 v[96:99], v[44:47], a[212:215], v[96:99]
    s_sub_u32 s3, s29, s30
    v_exp_f32 v17, v125
    v_mfma_f32_16x16x32_bf16 v[100:103], v[40:43], a[232:235], v[100:103]
    v_cvt_pk_bf16_f32 v189, v18, v19
    v_fma_f32 v238, v238, v48, v50
    v_mfma_f32_16x16x32_bf16 v[100:103], v[44:47], a[236:239], v[100:103]
    v_exp_f32 v18, v126
    v_mfma_f32_16x16x32_bf16 v[104:107], v[40:43], v[192:195], v[104:107]
    s_add_u32 s26, s26, 12288
    ds_read_b128 v[36:39], v3 offset:18432
    v_add_f32 v8, v8, v16
    v_mfma_f32_16x16x32_bf16 v[104:107], v[44:47], v[196:199], v[104:107]
    buffer_load_dwordx4 v[148:151], v12, s[68:71], s35 offen offset:768 nt
    v_mfma_f32_16x16x32_bf16 v[108:111], v[40:43], v[216:219], v[108:111]
    v_add_f32 v8, v8, v17
    v_fma_f32 v239, v239, v49, v51
    v_mfma_f32_16x16x32_bf16 v[108:111], v[44:47], v[220:223], v[108:111]
    s_waitcnt lgkmcnt(2)
    v_exp_f32 v19, v127
    v_mfma_f32_16x16x32_bf16 v[80:83], v[24:27], a[192:195], v[128:131]
    ds_read_b128 v[40:43], v2 offset:12416
    v_cvt_pk_bf16_f32 v190, v16, v17
    v_mfma_f32_16x16x32_bf16 v[80:83], v[28:31], a[196:199], v[80:83]
    s_mov_b32 m0, s26
    v_add_f32 v8, v8, v18
    v_add_f32 v8, v8, v19
    v_mfma_f32_16x16x32_bf16 v[84:87], v[24:27], a[216:219], v[132:135]
    s_mov_b32 s30, s29
    v_cvt_pk_bf16_f32 v191, v18, v19
    v_cvt_pk_bf16_f32 v237, v238, v239
    v_mfma_f32_16x16x32_bf16 v[84:87], v[28:31], a[220:223], v[84:87]
    v_exp_f32 v16, v64
    v_mfma_f32_16x16x32_bf16 v[88:91], v[24:27], a[240:243], v[136:139]
    ds_read_b128 v[44:47], v3 offset:12416
    v_mfma_f32_16x16x32_bf16 v[88:91], v[28:31], a[244:247], v[88:91]
    buffer_load_dwordx4 v[152:155], v12, s[68:71], s35 offen offset:1536 nt
    v_mfma_f32_16x16x32_bf16 v[92:95], v[24:27], v[200:203], v[140:143]
    v_exp_f32 v17, v65
    v_mfma_f32_16x16x32_bf16 v[92:95], v[28:31], v[204:207], v[92:95]
    s_waitcnt lgkmcnt(2)
    v_exp_f32 v18, v66
    v_mfma_f32_16x16x32_bf16 v[112:115], v[32:35], a[192:195], v[128:131]
    ds_read_b128 v[24:27], v2 offset:18560
    v_add_f32 v5, v5, v16
    v_mfma_f32_16x16x32_bf16 v[112:115], v[36:39], a[196:199], v[112:115]
    buffer_load_dwordx4 v4, s[4:7], s32 offen offset:0 sc1 lds
    v_mfma_f32_16x16x32_bf16 v[116:119], v[32:35], a[216:219], v[132:135]
    v_add_f32 v5, v5, v17
    v_add_u32 v1, s3, v1
    v_mfma_f32_16x16x32_bf16 v[116:119], v[36:39], a[220:223], v[116:119]
    v_exp_f32 v19, v67
    v_mfma_f32_16x16x32_bf16 v[120:123], v[32:35], a[240:243], v[136:139]
    ds_read_b128 v[28:31], v3 offset:18560
    v_cvt_pk_bf16_f32 v64, v16, v17
    v_mfma_f32_16x16x32_bf16 v[120:123], v[36:39], a[244:247], v[120:123]
    s_waitcnt vmcnt(13)
    buffer_load_dwordx4 v[156:159], v12, s[68:71], s35 offen offset:2304 nt
    v_mfma_f32_16x16x32_bf16 v[124:127], v[32:35], v[200:203], v[140:143]
    v_exp_f32 v16, v96
    v_mfma_f32_16x16x32_bf16 v[124:127], v[36:39], v[204:207], v[124:127]
    s_waitcnt lgkmcnt(2)
    v_add_f32 v5, v5, v18
    v_add_f32 v5, v5, v19
    v_mfma_f32_16x16x32_bf16 v[80:83], v[40:43], a[200:203], v[80:83]
    ds_read_b128 v[32:35], v2 offset:12544
    v_lshlrev_b32 v48, 16, v60
    v_mfma_f32_16x16x32_bf16 v[80:83], v[44:47], a[204:207], v[80:83]
    v_exp_f32 v17, v97
    v_mfma_f32_16x16x32_bf16 v[84:87], v[40:43], a[224:227], v[84:87]
    v_cvt_pk_bf16_f32 v65, v18, v19
    v_and_b32 v49, s97, v60
    v_mfma_f32_16x16x32_bf16 v[84:87], v[44:47], a[228:231], v[84:87]
    buffer_load_dwordx4 v4, s[4:7], s32 offen offset:1024 sc1 lds
    v_mfma_f32_16x16x32_bf16 v[88:91], v[40:43], a[248:251], v[88:91]
    ds_read_b128 v[36:39], v3 offset:12544
    v_lshlrev_b32 v50, 16, v62
    v_mfma_f32_16x16x32_bf16 v[88:91], v[44:47], a[252:255], v[88:91]
    v_exp_f32 v18, v98
    v_mfma_f32_16x16x32_bf16 v[92:95], v[40:43], v[208:211], v[92:95]
    v_add_f32 v5, v5, v16
    v_add_f32 v5, v5, v17
    v_mfma_f32_16x16x32_bf16 v[92:95], v[44:47], v[212:215], v[92:95]
    s_waitcnt lgkmcnt(2)
    v_exp_f32 v19, v99
    v_mfma_f32_16x16x32_bf16 v[112:115], v[24:27], a[200:203], v[112:115]
    ds_read_b128 v[40:43], v2 offset:18688
    v_cvt_pk_bf16_f32 v66, v16, v17
    v_mfma_f32_16x16x32_bf16 v[112:115], v[28:31], a[204:207], v[112:115]
    v_exp_f32 v16, v68
    v_mfma_f32_16x16x32_bf16 v[116:119], v[24:27], a[224:227], v[116:119]
    v_add_f32 v5, v5, v18
    v_add_f32 v5, v5, v19
    v_mfma_f32_16x16x32_bf16 v[116:119], v[28:31], a[228:231], v[116:119]
    v_exp_f32 v17, v69
    v_mfma_f32_16x16x32_bf16 v[120:123], v[24:27], a[248:251], v[120:123]
    ds_read_b128 v[44:47], v3 offset:18688
    v_cvt_pk_bf16_f32 v67, v18, v19
    v_mfma_f32_16x16x32_bf16 v[120:123], v[28:31], a[252:255], v[120:123]
    s_waitcnt lgkmcnt(2)
    buffer_load_dwordx4 v4, s[4:7], s32 offen offset:2048 sc1 lds
    v_mfma_f32_16x16x32_bf16 v[124:127], v[24:27], v[208:211], v[124:127]
    s_waitcnt vmcnt(13)
    v_exp_f32 v18, v70
    v_mfma_f32_16x16x32_bf16 v[124:127], v[28:31], v[212:215], v[124:127]
    s_barrier
    v_add_f32 v6, v6, v16
    v_mfma_f32_16x16x32_bf16 v[80:83], v[32:35], a[208:211], v[80:83]
    ds_read_b128 v[24:27], v1 offset:0
    v_add_f32 v6, v6, v17
    v_mfma_f32_16x16x32_bf16 v[80:83], v[36:39], a[212:215], v[80:83]
    v_exp_f32 v19, v71
    v_mfma_f32_16x16x32_bf16 v[84:87], v[32:35], a[232:235], v[84:87]
    v_cvt_pk_bf16_f32 v68, v16, v17
    v_and_b32 v51, s97, v62
    v_mfma_f32_16x16x32_bf16 v[84:87], v[36:39], a[236:239], v[84:87]
    v_exp_f32 v16, v100
    v_mfma_f32_16x16x32_bf16 v[88:91], v[32:35], v[192:195], v[88:91]
    ds_read_b128 v[28:31], v1 offset:12288
    v_add_f32 v6, v6, v18
    v_mfma_f32_16x16x32_bf16 v[88:91], v[36:39], v[196:199], v[88:91]
    v_add_f32 v6, v6, v19
    v_mul_f32 v48, s38, v48
    v_mfma_f32_16x16x32_bf16 v[92:95], v[32:35], v[216:219], v[92:95]
    v_exp_f32 v17, v101
    v_mfma_f32_16x16x32_bf16 v[92:95], v[36:39], v[220:223], v[92:95]
    s_waitcnt lgkmcnt(2)
    v_cvt_pk_bf16_f32 v69, v18, v19
    v_mul_f32 v49, s38, v49
    v_mfma_f32_16x16x32_bf16 v[112:115], v[40:43], a[208:211], v[112:115]
    ds_read_b128 v[32:35], v1 offset:1024
    v_mul_f32_e64 v50, -v50, v48
    v_mfma_f32_16x16x32_bf16 v[112:115], v[44:47], a[212:215], v[112:115]
    v_exp_f32 v18, v102
    v_mfma_f32_16x16x32_bf16 v[116:119], v[40:43], a[232:235], v[116:119]
    v_add_f32 v6, v6, v16
    v_add_f32 v6, v6, v17
    v_mfma_f32_16x16x32_bf16 v[116:119], v[44:47], a[236:239], v[116:119]
    v_exp_f32 v19, v103
    v_mfma_f32_16x16x32_bf16 v[120:123], v[40:43], v[192:195], v[120:123]
    ds_read_b128 v[36:39], v1 offset:13312
    v_cvt_pk_bf16_f32 v70, v16, v17
    v_mfma_f32_16x16x32_bf16 v[120:123], v[44:47], v[196:199], v[120:123]
    s_add_u32 s32, s32, 24576
    v_add_f32 v6, v6, v18
    v_mul_f32_e64 v51, -v51, v49
    v_mfma_f32_16x16x32_bf16 v[124:127], v[40:43], v[216:219], v[124:127]
    s_add_u32 s26, s26, 36864
    v_add_f32 v6, v6, v19
    s_sub_u32 s57, s26, 147456
    v_mfma_f32_16x16x32_bf16 v[124:127], v[44:47], v[220:223], v[124:127]
    s_waitcnt lgkmcnt(2)
    v_cvt_pk_bf16_f32 v71, v18, v19
    s_min_u32 s26, s26, s57
    v_mfma_f32_16x16x32_bf16 a[0:3], v[160:163], v[24:27], a[0:3]
    ds_read_b128 v[40:43], v1 offset:2048
    v_cvt_f32_i32 v240, v240
    v_mfma_f32_16x16x32_bf16 a[0:3], v[176:179], v[28:31], a[0:3]
    s_waitcnt vmcnt(12)
    v_subrev_u32 v52, s92, v52
    v_cmp_lt_u32 vcc, 15, v52
    v_mfma_f32_16x16x32_bf16 a[48:51], v[164:167], v[24:27], a[48:51]
    v_exp_f32 v16, v72
    v_mfma_f32_16x16x32_bf16 a[48:51], v[180:183], v[28:31], a[48:51]
    v_exp_f32 v17, v73
    v_mfma_f32_16x16x32_bf16 a[96:99], v[168:171], v[24:27], a[96:99]
    s_and_b32 s59, vcc_lo, 0xff
    ds_read_b128 v[44:47], v1 offset:14336
    v_cvt_f32_i32 v241, v241
    v_mfma_f32_16x16x32_bf16 a[96:99], v[184:187], v[28:31], a[96:99]
    s_cbranch_scc1 L_pollslow2
L_pollok2:
    v_mfma_f32_16x16x32_bf16 a[144:147], v[172:175], v[24:27], a[144:147]
    s_add_u32 s92, s92, 1
    v_exp_f32 v18, v74
    v_mfma_f32_16x16x32_bf16 a[144:147], v[188:191], v[28:31], a[144:147]
    s_waitcnt lgkmcnt(2)
    v_add_f32 v7, v7, v16
    v_add_f32 v7, v7, v17
    v_mfma_f32_16x16x32_bf16 a[4:7], v[160:163], v[32:35], a[4:7]
    s_mov_b32 m0, s56
    ds_read_b128 v[24:27], v1 offset:3072
    v_fma_f32 v240, v240, v48, v50
    v_mfma_f32_16x16x32_bf16 a[4:7], v[176:179], v[36:39], a[4:7]
    buffer_load_dwordx4 v4, s[4:7], s27 offen offset:0 sc1 lds
    v_mfma_f32_16x16x32_bf16 a[52:55], v[164:167], v[32:35], a[52:55]
    v_exp_f32 v19, v75
    v_mfma_f32_16x16x32_bf16 a[52:55], v[180:183], v[36:39], a[52:55]
    v_cvt_pk_bf16_f32 v72, v16, v17
    v_fma_f32 v241, v241, v49, v51
    v_mfma_f32_16x16x32_bf16 a[100:103], v[168:171], v[32:35], a[100:103]
    ds_read_b128 v[28:31], v1 offset:15360
    v_cvt_pk_bf16_f32 v226, v240, v241
    v_mfma_f32_16x16x32_bf16 a[100:103], v[184:187], v[36:39], a[100:103]
    v_exp_f32 v16, v104
    v_mfma_f32_16x16x32_bf16 a[148:151], v[172:175], v[32:35], a[148:151]
    v_add_f32 v7, v7, v18
    v_add_f32 v7, v7, v19
    v_mfma_f32_16x16x32_bf16 a[148:151], v[188:191], v[36:39], a[148:151]
    s_waitcnt lgkmcnt(2)
    v_exp_f32 v17, v105
    v_mfma_f32_16x16x32_bf16 a[8:11], v[160:163], v[40:43], a[8:11]
    ds_read_b128 v[32:35], v1 offset:4096
    v_cvt_pk_bf16_f32 v73, v18, v19
    v_mfma_f32_16x16x32_bf16 a[8:11], v[176:179], v[44:47], a[8:11]
    buffer_load_dwordx4 v4, s[4:7], s27 offen offset:1024 sc1 lds
    v_mfma_f32_16x16x32_bf16 a[56:59], v[164:167], v[40:43], a[56:59]
    v_exp_f32 v18, v106
    v_mfma_f32_16x16x32_bf16 a[56:59], v[180:183], v[44:47], a[56:59]
    v_add_f32 v7, v7, v16
    v_cvt_f32_i32 v244, v244
    v_mfma_f32_16x16x32_bf16 a[104:107], v[168:171], v[40:43], a[104:107]
    ds_read_b128 v[36:39], v1 offset:16384
    v_add_f32 v7, v7, v17
    v_mfma_f32_16x16x32_bf16 a[104:107], v[184:187], v[44:47], a[104:107]
    v_exp_f32 v19, v107
    v_mfma_f32_16x16x32_bf16 a[152:155], v[172:175], v[40:43], a[152:155]
    v_cvt_f32_i32 v245, v245
    v_cvt_pk_bf16_f32 v74, v16, v17
    v_mfma_f32_16x16x32_bf16 a[152:155], v[188:191], v[44:47], a[152:155]
    s_waitcnt lgkmcnt(2)
    v_exp_f32 v16, v76
    v_mfma_f32_16x16x32_bf16 a[12:15], v[160:163], v[24:27], a[12:15]
    ds_read_b128 v[40:43], v1 offset:5120
    v_fma_f32 v244, v244, v48, v50
    v_mfma_f32_16x16x32_bf16 a[12:15], v[176:179], v[28:31], a[12:15]
    buffer_load_dwordx4 v4, s[4:7], s27 offen offset:2048 sc1 lds
    v_mfma_f32_16x16x32_bf16 a[60:63], v[164:167], v[24:27], a[60:63]
    v_add_f32 v7, v7, v18
    v_add_f32 v7, v7, v19
    v_mfma_f32_16x16x32_bf16 a[60:63], v[180:183], v[28:31], a[60:63]
    v_exp_f32 v17, v77
    v_mfma_f32_16x16x32_bf16 a[108:111], v[168:171], v[24:27], a[108:111]
    ds_read_b128 v[44:47], v1 offset:17408
    v_fma_f32 v245, v245, v49, v51
    v_mfma_f32_16x16x32_bf16 a[108:111], v[184:187], v[28:31], a[108:111]
    v_cvt_pk_bf16_f32 v75, v18, v19
    v_cvt_pk_bf16_f32 v230, v244, v245
    v_mfma_f32_16x16x32_bf16 a[156:159], v[172:175], v[24:27], a[156:159]
    s_add_u32 s29, s28, 49152
    v_exp_f32 v18, v78
    v_mfma_f32_16x16x32_bf16 a[156:159], v[188:191], v[28:31], a[156:159]
    s_waitcnt lgkmcnt(2)
    v_add_f32 v8, v8, v16
    v_cvt_f32_i32 v248, v248
    v_mfma_f32_16x16x32_bf16 a[16:19], v[160:163], v[32:35], a[16:19]
    s_sub_u32 s3, s29, 147456
    ds_read_b128 v[24:27], v1 offset:6144
    v_add_f32 v8, v8, v17
    v_mfma_f32_16x16x32_bf16 a[16:19], v[176:179], v[36:39], a[16:19]
    s_add_u32 s27, s27, 24576
    v_exp_f32 v19, v79
    v_mfma_f32_16x16x32_bf16 a[64:67], v[164:167], v[32:35], a[64:67]
    s_min_u32 s29, s29, s3
    v_cvt_f32_i32 v249, v249
    v_cvt_pk_bf16_f32 v76, v16, v17
    v_mfma_f32_16x16x32_bf16 a[64:67], v[180:183], v[36:39], a[64:67]
    s_add_u32 s56, s56, 12288
    v_exp_f32 v16, v108
    v_mfma_f32_16x16x32_bf16 a[112:115], v[168:171], v[32:35], a[112:115]
    ds_read_b128 v[28:31], v1 offset:18432
    v_fma_f32 v248, v248, v48, v50
    v_mfma_f32_16x16x32_bf16 a[112:115], v[184:187], v[36:39], a[112:115]
    v_add_f32 v8, v8, v18
    v_fma_f32 v249, v249, v49, v51
    v_mfma_f32_16x16x32_bf16 a[160:163], v[172:175], v[32:35], a[160:163]
    v_add_f32 v8, v8, v19
    v_cvt_pk_bf16_f32 v234, v248, v249
    v_mfma_f32_16x16x32_bf16 a[160:163], v[188:191], v[36:39], a[160:163]
    s_waitcnt lgkmcnt(2)
    v_exp_f32 v17, v109
    v_mfma_f32_16x16x32_bf16 a[20:23], v[160:163], v[40:43], a[20:23]
    s_mov_b32 m0, s56
    ds_read_b128 v[32:35], v1 offset:7168
    v_cvt_pk_bf16_f32 v77, v18, v19
    v_mfma_f32_16x16x32_bf16 a[20:23], v[176:179], v[44:47], a[20:23]
    s_sub_u32 s3, s29, s28
    v_exp_f32 v18, v110
    v_mfma_f32_16x16x32_bf16 a[68:71], v[164:167], v[40:43], a[68:71]
    v_cvt_f32_i32 v252, v252
    v_add_f32 v8, v8, v16
    v_mfma_f32_16x16x32_bf16 a[68:71], v[180:183], v[44:47], a[68:71]
    v_add_f32 v8, v8, v17
    v_cvt_f32_i32 v253, v253
    v_mfma_f32_16x16x32_bf16 a[116:119], v[168:171], v[40:43], a[116:119]
    ds_read_b128 v[36:39], v1 offset:19456
    v_fma_f32 v252, v252, v48, v50
    v_mfma_f32_16x16x32_bf16 a[116:119], v[184:187], v[44:47], a[116:119]
    buffer_load_dwordx4 v4, s[4:7], s27 offen offset:0 sc1 lds
    v_mfma_f32_16x16x32_bf16 a[164:167], v[172:175], v[40:43], a[164:167]
    s_mov_b32 s28, s29
    v_exp_f32 v19, v111
    v_mfma_f32_16x16x32_bf16 a[164:167], v[188:191], v[44:47], a[164:167]
    s_waitcnt lgkmcnt(2)
    v_cvt_pk_bf16_f32 v78, v16, v17
    v_add_f32 v8, v8, v18
    v_mfma_f32_16x16x32_bf16 a[24:27], v[160:163], v[24:27], a[24:27]
    ds_read_b128 v[40:43], v1 offset:8192
    v_add_f32 v8, v8, v19
    v_mfma_f32_16x16x32_bf16 a[24:27], v[176:179], v[28:31], a[24:27]
    v_cvt_pk_bf16_f32 v79, v18, v19
    v_fma_f32 v253, v253, v49, v51
    v_mfma_f32_16x16x32_bf16 a[72:75], v[164:167], v[24:27], a[72:75]
    v_exp_f32 v16, v80
    v_mfma_f32_16x16x32_bf16 a[72:75], v[180:183], v[28:31], a[72:75]
    v_exp_f32 v17, v81
    v_mfma_f32_16x16x32_bf16 a[120:123], v[168:171], v[24:27], a[120:123]
    ds_read_b128 v[44:47], v1 offset:20480
    v_cvt_pk_bf16_f32 v238, v252, v253
    v_mfma_f32_16x16x32_bf16 a[120:123], v[184:187], v[28:31], a[120:123]
    v_exp_f32 v18, v82
    v_mfma_f32_16x16x32_bf16 a[168:171], v[172:175], v[24:27], a[168:171]
    v_lshlrev_b32 v48, 16, v61
    v_add_f32 v5, v5, v16
    v_mfma_f32_16x16x32_bf16 a[168:171], v[188:191], v[28:31], a[168:171]
    s_waitcnt lgkmcnt(2)
    buffer_load_dwordx4 v4, s[4:7], s27 offen offset:1024 sc1 lds
    v_mfma_f32_16x16x32_bf16 a[28:31], v[160:163], v[32:35], a[28:31]
    ds_read_b128 v[24:27], v1 offset:9216
    v_add_f32 v5, v5, v17
    v_mfma_f32_16x16x32_bf16 a[28:31], v[176:179], v[36:39], a[28:31]
    v_exp_f32 v19, v83
    v_mfma_f32_16x16x32_bf16 a[76:79], v[164:167], v[32:35], a[76:79]
    v_and_b32 v49, s97, v61
    v_cvt_pk_bf16_f32 v80, v16, v17
    v_mfma_f32_16x16x32_bf16 a[76:79], v[180:183], v[36:39], a[76:79]
    v_exp_f32 v16, v112
    v_mfma_f32_16x16x32_bf16 a[124:127], v[168:171], v[32:35], a[124:127]
    ds_read_b128 v[28:31], v1 offset:21504
    v_lshlrev_b32 v50, 16, v63
    v_mfma_f32_16x16x32_bf16 a[124:127], v[184:187], v[36:39], a[124:127]
    v_add_f32 v5, v5, v18
    v_and_b32 v51, s97, v63
    v_mfma_f32_16x16x32_bf16 a[172:175], v[172:175], v[32:35], a[172:175]
    v_add_f32 v5, v5, v19
    v_mul_f32 v48, s38, v48
    v_mfma_f32_16x16x32_bf16 a[172:175], v[188:191], v[36:39], a[172:175]
    s_waitcnt lgkmcnt(2)
    buffer_load_dwordx4 v4, s[4:7], s27 offen offset:2048 sc1 lds
    v_mfma_f32_16x16x32_bf16 a[32:35], v[160:163], v[40:43], a[32:35]
    ds_read_b128 v[32:35], v1 offset:10240
    v_mul_f32 v49, s38, v49
    v_mfma_f32_16x16x32_bf16 a[32:35], v[176:179], v[44:47], a[32:35]
    v_exp_f32 v17, v113
    v_mfma_f32_16x16x32_bf16 a[80:83], v[164:167], v[40:43], a[80:83]
    v_cvt_pk_bf16_f32 v81, v18, v19
    v_mul_f32_e64 v50, -v50, v48
    v_mfma_f32_16x16x32_bf16 a[80:83], v[180:183], v[44:47], a[80:83]
    v_exp_f32 v18, v114
    v_mfma_f32_16x16x32_bf16 a[128:131], v[168:171], v[40:43], a[128:131]
    ds_read_b128 v[36:39], v1 offset:22528
    v_add_f32 v5, v5, v16
    v_mfma_f32_16x16x32_bf16 a[128:131], v[184:187], v[44:47], a[128:131]
    v_add_f32 v5, v5, v17
    v_mul_f32_e64 v51, -v51, v49
    v_mfma_f32_16x16x32_bf16 a[176:179], v[172:175], v[40:43], a[176:179]
    v_exp_f32 v19, v115
    v_mfma_f32_16x16x32_bf16 a[176:179], v[188:191], v[44:47], a[176:179]
    s_waitcnt lgkmcnt(2)
    v_cvt_pk_bf16_f32 v82, v16, v17
    v_add_u32 v2, s3, v2
    v_mfma_f32_16x16x32_bf16 a[36:39], v[160:163], v[24:27], a[36:39]
    ds_read_b128 v[40:43], v1 offset:11264
    v_cvt_f32_i32 v242, v242
    v_mfma_f32_16x16x32_bf16 a[36:39], v[176:179], v[28:31], a[36:39]
    v_exp_f32 v16, v84
    v_mfma_f32_16x16x32_bf16 a[84:87], v[164:167], v[24:27], a[84:87]
    v_add_f32 v5, v5, v18
    v_add_f32 v5, v5, v19
    v_mfma_f32_16x16x32_bf16 a[84:87], v[180:183], v[28:31], a[84:87]
    s_add_u32 s27, s27, 24576
    v_exp_f32 v17, v85
    v_mfma_f32_16x16x32_bf16 a[132:135], v[168:171], v[24:27], a[132:135]
    s_add_u32 s56, s56, 36864
    ds_read_b128 v[44:47], v1 offset:23552
    v_add_u32 v3, s3, v3
    v_mfma_f32_16x16x32_bf16 a[132:135], v[184:187], v[28:31], a[132:135]
    s_sub_u32 s58, s56, 147456
    v_cvt_pk_bf16_f32 v83, v18, v19
    v_cvt_f32_i32 v243, v243
    v_mfma_f32_16x16x32_bf16 a[180:183], v[172:175], v[24:27], a[180:183]
    v_exp_f32 v18, v86
    v_mfma_f32_16x16x32_bf16 a[180:183], v[188:191], v[28:31], a[180:183]
    s_waitcnt lgkmcnt(2)
    v_add_f32 v6, v6, v16
    v_fma_f32 v242, v242, v48, v50
    v_mfma_f32_16x16x32_bf16 a[40:43], v[160:163], v[32:35], a[40:43]
    s_min_u32 s56, s56, s58
    ds_read_b128 v[24:27], v2 offset:0
    v_add_f32 v6, v6, v17
    v_mfma_f32_16x16x32_bf16 a[40:43], v[176:179], v[36:39], a[40:43]
    v_exp_f32 v19, v87
    v_mfma_f32_16x16x32_bf16 a[88:91], v[164:167], v[32:35], a[88:91]
    v_fma_f32 v243, v243, v49, v51
    v_cvt_pk_bf16_f32 v84, v16, v17
    v_mfma_f32_16x16x32_bf16 a[88:91], v[180:183], v[36:39], a[88:91]
    v_exp_f32 v16, v116
    v_mfma_f32_16x16x32_bf16 a[136:139], v[168:171], v[32:35], a[136:139]
    ds_read_b128 v[28:31], v3 offset:0
    v_cvt_pk_bf16_f32 v227, v242, v243
    v_mfma_f32_16x16x32_bf16 a[136:139], v[184:187], v[36:39], a[136:139]
    v_add_f32 v6, v6, v18
    v_add_f32 v6, v6, v19
    v_mfma_f32_16x16x32_bf16 a[184:187], v[172:175], v[32:35], a[184:187]
    v_cvt_f32_i32 v246, v246
    v_cvt_f32_i32 v247, v247
    v_mfma_f32_16x16x32_bf16 a[184:187], v[188:191], v[36:39], a[184:187]
    s_waitcnt lgkmcnt(2)
    v_exp_f32 v17, v117
    v_mfma_f32_16x16x32_bf16 a[44:47], v[160:163], v[40:43], a[44:47]
    ds_read_b128 v[32:35], v2 offset:6144
    v_cvt_pk_bf16_f32 v85, v18, v19
    v_mfma_f32_16x16x32_bf16 a[44:47], v[176:179], v[44:47], a[44:47]
    v_exp_f32 v18, v118
    v_mfma_f32_16x16x32_bf16 a[92:95], v[164:167], v[40:43], a[92:95]
    v_fma_f32 v246, v246, v48, v50
    v_add_f32 v6, v6, v16
    v_mfma_f32_16x16x32_bf16 a[92:95], v[180:183], v[44:47], a[92:95]
    v_add_f32 v6, v6, v17
    v_fma_f32 v247, v247, v49, v51
    v_mfma_f32_16x16x32_bf16 a[140:143], v[168:171], v[40:43], a[140:143]
    s_sub_u32 s31, s31, 1
    ds_read_b128 v[36:39], v3 offset:6144
    v_cvt_pk_bf16_f32 v231, v246, v247
    v_mfma_f32_16x16x32_bf16 a[140:143], v[184:187], v[44:47], a[140:143]
    v_exp_f32 v19, v119
    v_mfma_f32_16x16x32_bf16 a[188:191], v[172:175], v[40:43], a[188:191]
    s_waitcnt lgkmcnt(2)
    s_cmp_lg_u32 s31, 0
    v_cvt_pk_bf16_f32 v86, v16, v17
    v_add_f32 v6, v6, v18
    v_add_f32 v6, v6, v19
    v_cvt_f32_i32 v250, v250
    v_cvt_pk_bf16_f32 v87, v18, v19
    v_cvt_f32_i32 v251, v251
    v_mfma_f32_16x16x32_bf16 a[188:191], v[188:191], v[44:47], a[188:191]
    s_cbranch_scc1 L_loop
    v_mfma_f32_16x16x32_bf16 v[160:163], v[24:27], a[192:195], v[128:131]
    ds_read_b128 v[40:43], v2 offset:128
    v_mfma_f32_16x16x32_bf16 v[160:163], v[28:31], a[196:199], v[160:163]
    v_exp_f32 v16, v88
    v_mfma_f32_16x16x32_bf16 v[164:167], v[24:27], a[216:219], v[132:135]
    ds_read_b128 v[44:47], v3 offset:128
    v_mfma_f32_16x16x32_bf16 v[164:167], v[28:31], a[220:223], v[164:167]
    s_waitcnt lgkmcnt(2)
    v_exp_f32 v17, v89
    v_mfma_f32_16x16x32_bf16 v[96:99], v[32:35], a[192:195], v[128:131]
    ds_read_b128 v[24:27], v2 offset:6272
    v_mfma_f32_16x16x32_bf16 v[96:99], v[36:39], a[196:199], v[96:99]
    s_waitcnt vmcnt(6)
    v_exp_f32 v18, v90
    v_mfma_f32_16x16x32_bf16 v[100:103], v[32:35], a[216:219], v[132:135]
    ds_read_b128 v[28:31], v3 offset:6272
    v_add_f32 v7, v7, v16
    v_mfma_f32_16x16x32_bf16 v[100:103], v[36:39], a[220:223], v[100:103]
    s_waitcnt lgkmcnt(2)
    s_barrier
    v_mfma_f32_16x16x32_bf16 v[160:163], v[40:43], a[200:203], v[160:163]
    s_mov_b32 m0, s26
    ds_read_b128 v[32:35], v2 offset:256
    v_add_f32 v7, v7, v17
    v_mfma_f32_16x16x32_bf16 v[160:163], v[44:47], a[204:207], v[160:163]
    buffer_load_dwordx4 v4, s[4:7], s32 offen offset:0 sc1 lds
    v_mfma_f32_16x16x32_bf16 v[164:167], v[40:43], a[224:227], v[164:167]
    ds_read_b128 v[36:39], v3 offset:256
    v_mfma_f32_16x16x32_bf16 v[164:167], v[44:47], a[228:231], v[164:167]
    s_waitcnt lgkmcnt(2)
    v_exp_f32 v19, v91
    v_mfma_f32_16x16x32_bf16 v[96:99], v[24:27], a[200:203], v[96:99]
    ds_read_b128 v[40:43], v2 offset:6400
    v_cvt_pk_bf16_f32 v88, v16, v17
    v_mfma_f32_16x16x32_bf16 v[96:99], v[28:31], a[204:207], v[96:99]
    v_exp_f32 v16, v120
    v_mfma_f32_16x16x32_bf16 v[100:103], v[24:27], a[224:227], v[100:103]
    ds_read_b128 v[44:47], v3 offset:6400
    v_add_f32 v7, v7, v18
    v_mfma_f32_16x16x32_bf16 v[100:103], v[28:31], a[228:231], v[100:103]
    s_waitcnt lgkmcnt(2)
    buffer_load_dwordx4 v4, s[4:7], s32 offen offset:1024 sc1 lds
    v_mfma_f32_16x16x32_bf16 v[160:163], v[32:35], a[208:211], v[160:163]
    ds_read_b128 v[24:27], v2 offset:12288
    v_add_f32 v7, v7, v19
    v_mfma_f32_16x16x32_bf16 v[160:163], v[36:39], a[212:215], v[160:163]
    v_exp_f32 v17, v121
    v_mfma_f32_16x16x32_bf16 v[164:167], v[32:35], a[232:235], v[164:167]
    ds_read_b128 v[28:31], v3 offset:12288
    v_cvt_pk_bf16_f32 v89, v18, v19
    v_mfma_f32_16x16x32_bf16 v[164:167], v[36:39], a[236:239], v[164:167]
    s_waitcnt lgkmcnt(2)
    v_exp_f32 v18, v122
    v_mfma_f32_16x16x32_bf16 v[96:99], v[40:43], a[208:211], v[96:99]
    ds_read_b128 v[32:35], v2 offset:18432
    v_add_f32 v7, v7, v16
    v_mfma_f32_16x16x32_bf16 v[96:99], v[44:47], a[212:215], v[96:99]
    buffer_load_dwordx4 v4, s[4:7], s32 offen offset:2048 sc1 lds
    v_mfma_f32_16x16x32_bf16 v[100:103], v[40:43], a[232:235], v[100:103]
    ds_read_b128 v[36:39], v3 offset:18432
    v_add_f32 v7, v7, v17
    v_mfma_f32_16x16x32_bf16 v[100:103], v[44:47], a[236:239], v[100:103]
    s_waitcnt lgkmcnt(2)
    v_exp_f32 v19, v123
    v_mfma_f32_16x16x32_bf16 v[168:171], v[24:27], a[192:195], v[128:131]
    ds_read_b128 v[40:43], v2 offset:12416
    v_cvt_pk_bf16_f32 v90, v16, v17
    v_mfma_f32_16x16x32_bf16 v[168:171], v[28:31], a[196:199], v[168:171]
    v_exp_f32 v16, v92
    v_mfma_f32_16x16x32_bf16 v[172:175], v[24:27], a[216:219], v[132:135]
    s_add_u32 s32, s32, 24576
    ds_read_b128 v[44:47], v3 offset:12416
    v_add_f32 v7, v7, v18
    v_mfma_f32_16x16x32_bf16 v[172:175], v[28:31], a[220:223], v[172:175]
    s_waitcnt lgkmcnt(2)
    v_add_f32 v7, v7, v19
    v_mfma_f32_16x16x32_bf16 v[104:107], v[32:35], a[192:195], v[128:131]
    ds_read_b128 v[24:27], v2 offset:18560
    v_mfma_f32_16x16x32_bf16 v[104:107], v[36:39], a[196:199], v[104:107]
    s_add_u32 s26, s26, 12288
    v_exp_f32 v17, v93
    v_mfma_f32_16x16x32_bf16 v[108:111], v[32:35], a[216:219], v[132:135]
    s_add_u32 s29, s30, 49152
    ds_read_b128 v[28:31], v3 offset:18560
    v_cvt_pk_bf16_f32 v91, v18, v19
    v_mfma_f32_16x16x32_bf16 v[108:111], v[36:39], a[220:223], v[108:111]
    s_waitcnt lgkmcnt(2)
    v_exp_f32 v18, v94
    v_mfma_f32_16x16x32_bf16 v[168:171], v[40:43], a[200:203], v[168:171]
    s_sub_u32 s3, s29, 147456
    ds_read_b128 v[32:35], v2 offset:12544
    v_add_f32 v8, v8, v16
    v_mfma_f32_16x16x32_bf16 v[168:171], v[44:47], a[204:207], v[168:171]
    s_mov_b32 m0, s26
    v_add_f32 v8, v8, v17
    s_min_u32 s29, s29, s3
    v_mfma_f32_16x16x32_bf16 v[172:175], v[40:43], a[224:227], v[172:175]
    ds_read_b128 v[36:39], v3 offset:12544
    v_mfma_f32_16x16x32_bf16 v[172:175], v[44:47], a[228:231], v[172:175]
    s_waitcnt lgkmcnt(2)
    v_exp_f32 v19, v95
    v_mfma_f32_16x16x32_bf16 v[104:107], v[24:27], a[200:203], v[104:107]
    ds_read_b128 v[40:43], v2 offset:18688
    v_cvt_pk_bf16_f32 v92, v16, v17
    v_mfma_f32_16x16x32_bf16 v[104:107], v[28:31], a[204:207], v[104:107]
    buffer_load_dwordx4 v4, s[4:7], s32 offen offset:0 sc1 lds
    v_mfma_f32_16x16x32_bf16 v[108:111], v[24:27], a[224:227], v[108:111]
    ds_read_b128 v[44:47], v3 offset:18688
    v_mfma_f32_16x16x32_bf16 v[108:111], v[28:31], a[228:231], v[108:111]
    s_waitcnt lgkmcnt(2)
    v_subrev_u32 v2, 98304, v2
    v_subrev_u32 v3, 98304, v3
    v_mfma_f32_16x16x32_bf16 v[168:171], v[32:35], a[208:211], v[168:171]
    ds_read_b128 v[24:27], v2 offset:0
    v_mfma_f32_16x16x32_bf16 v[168:171], v[36:39], a[212:215], v[168:171]
    v_exp_f32 v16, v124
    v_add_f32 v8, v8, v18
    v_mfma_f32_16x16x32_bf16 v[172:175], v[32:35], a[232:235], v[172:175]
    s_sub_u32 s3, s29, s30
    ds_read_b128 v[28:31], v3 offset:0
    v_add_f32 v8, v8, v19
    v_mfma_f32_16x16x32_bf16 v[172:175], v[36:39], a[236:239], v[172:175]
    s_waitcnt lgkmcnt(2)
    v_exp_f32 v17, v125
    v_cvt_pk_bf16_f32 v93, v18, v19
    v_mfma_f32_16x16x32_bf16 v[104:107], v[40:43], a[208:211], v[104:107]
    ds_read_b128 v[32:35], v2 offset:6144
    v_mfma_f32_16x16x32_bf16 v[104:107], v[44:47], a[212:215], v[104:107]
    buffer_load_dwordx4 v4, s[4:7], s32 offen offset:1024 sc1 lds
    v_mfma_f32_16x16x32_bf16 v[108:111], v[40:43], a[232:235], v[108:111]
    ds_read_b128 v[36:39], v3 offset:6144
    v_mfma_f32_16x16x32_bf16 v[108:111], v[44:47], a[236:239], v[108:111]
    s_waitcnt lgkmcnt(2)
    v_exp_f32 v18, v126
    v_add_f32 v8, v8, v16
    v_mfma_f32_16x16x32_bf16 v[176:179], v[24:27], a[192:195], v[128:131]
    ds_read_b128 v[40:43], v2 offset:128
    v_add_f32 v8, v8, v17
    v_mfma_f32_16x16x32_bf16 v[176:179], v[28:31], a[196:199], v[176:179]
    v_exp_f32 v19, v127
    v_cvt_pk_bf16_f32 v94, v16, v17
    v_mfma_f32_16x16x32_bf16 v[180:183], v[24:27], a[216:219], v[132:135]
    ds_read_b128 v[44:47], v3 offset:128
    v_add_f32 v8, v8, v18
    v_add_f32 v8, v8, v19
    v_cvt_pk_bf16_f32 v95, v18, v19
    v_mfma_f32_16x16x32_bf16 v[180:183], v[28:31], a[220:223], v[180:183]
    s_waitcnt lgkmcnt(2)
    buffer_load_dwordx4 v4, s[4:7], s32 offen offset:2048 sc1 lds
    v_mfma_f32_16x16x32_bf16 v[112:115], v[32:35], a[192:195], v[128:131]
    s_mov_b32 s30, s29
    ds_read_b128 v[24:27], v2 offset:6272
    v_mfma_f32_16x16x32_bf16 v[112:115], v[36:39], a[196:199], v[112:115]
    v_exp_f32 v16, v160
    v_mfma_f32_16x16x32_bf16 v[116:119], v[32:35], a[216:219], v[132:135]
    ds_read_b128 v[28:31], v3 offset:6272
    v_mfma_f32_16x16x32_bf16 v[116:119], v[36:39], a[220:223], v[116:119]
    s_waitcnt lgkmcnt(2)
    v_exp_f32 v17, v161
    v_mfma_f32_16x16x32_bf16 v[176:179], v[40:43], a[200:203], v[176:179]
    ds_read_b128 v[32:35], v2 offset:256
    v_mfma_f32_16x16x32_bf16 v[176:179], v[44:47], a[204:207], v[176:179]
    v_exp_f32 v18, v162
    v_mfma_f32_16x16x32_bf16 v[180:183], v[40:43], a[224:227], v[180:183]
    ds_read_b128 v[36:39], v3 offset:256
    v_add_f32 v5, v5, v16
    v_mfma_f32_16x16x32_bf16 v[180:183], v[44:47], a[228:231], v[180:183]
    s_waitcnt lgkmcnt(2)
    v_add_f32 v5, v5, v17
    v_add_u32 v1, s3, v1
    v_mfma_f32_16x16x32_bf16 v[112:115], v[24:27], a[200:203], v[112:115]
    ds_read_b128 v[40:43], v2 offset:6400
    v_mfma_f32_16x16x32_bf16 v[112:115], v[28:31], a[204:207], v[112:115]
    v_exp_f32 v19, v163
    v_cvt_pk_bf16_f32 v160, v16, v17
    v_mfma_f32_16x16x32_bf16 v[116:119], v[24:27], a[224:227], v[116:119]
    s_add_u32 s32, s32, 24576
    ds_read_b128 v[44:47], v3 offset:6400
    s_add_u32 s26, s26, 36864
    v_mfma_f32_16x16x32_bf16 v[116:119], v[28:31], a[228:231], v[116:119]
    s_waitcnt lgkmcnt(2)
    v_exp_f32 v16, v96
    v_mfma_f32_16x16x32_bf16 v[176:179], v[32:35], a[208:211], v[176:179]
    s_sub_u32 s57, s26, 147456
    ds_read_b128 v[24:27], v2 offset:12288
    v_add_f32 v5, v5, v18
    v_mfma_f32_16x16x32_bf16 v[176:179], v[36:39], a[212:215], v[176:179]
    s_min_u32 s26, s26, s57
    v_add_f32 v5, v5, v19
    v_mfma_f32_16x16x32_bf16 v[180:183], v[32:35], a[232:235], v[180:183]
    ds_read_b128 v[28:31], v3 offset:12288
    v_mfma_f32_16x16x32_bf16 v[180:183], v[36:39], a[236:239], v[180:183]
    s_waitcnt lgkmcnt(2)
    v_exp_f32 v17, v97
    v_cvt_pk_bf16_f32 v161, v18, v19
    v_mfma_f32_16x16x32_bf16 v[112:115], v[40:43], a[208:211], v[112:115]
    ds_read_b128 v[32:35], v2 offset:18432
    v_mfma_f32_16x16x32_bf16 v[112:115], v[44:47], a[212:215], v[112:115]
    v_exp_f32 v18, v98
    v_mfma_f32_16x16x32_bf16 v[116:119], v[40:43], a[232:235], v[116:119]
    ds_read_b128 v[36:39], v3 offset:18432
    v_add_f32 v5, v5, v16
    v_mfma_f32_16x16x32_bf16 v[116:119], v[44:47], a[236:239], v[116:119]
    s_waitcnt lgkmcnt(2)
    v_add_f32 v5, v5, v17
    v_mfma_f32_16x16x32_bf16 v[184:187], v[24:27], a[192:195], v[128:131]
    ds_read_b128 v[40:43], v2 offset:12416
    v_mfma_f32_16x16x32_bf16 v[184:187], v[28:31], a[196:199], v[184:187]
    v_exp_f32 v19, v99
    v_cvt_pk_bf16_f32 v162, v16, v17
    v_mfma_f32_16x16x32_bf16 v[188:191], v[24:27], a[216:219], v[132:135]
    ds_read_b128 v[44:47], v3 offset:12416
    v_mfma_f32_16x16x32_bf16 v[188:191], v[28:31], a[220:223], v[188:191]
    s_waitcnt lgkmcnt(2)
    v_exp_f32 v16, v164
    v_mfma_f32_16x16x32_bf16 v[120:123], v[32:35], a[192:195], v[128:131]
    ds_read_b128 v[24:27], v2 offset:18560
    v_add_f32 v5, v5, v18
    v_mfma_f32_16x16x32_bf16 v[120:123], v[36:39], a[196:199], v[120:123]
    s_waitcnt vmcnt(6)
    v_add_f32 v5, v5, v19
    v_mfma_f32_16x16x32_bf16 v[124:127], v[32:35], a[216:219], v[132:135]
    ds_read_b128 v[28:31], v3 offset:18560
    v_mfma_f32_16x16x32_bf16 v[124:127], v[36:39], a[220:223], v[124:127]
    s_waitcnt lgkmcnt(2)
    s_barrier
    v_mfma_f32_16x16x32_bf16 v[184:187], v[40:43], a[200:203], v[184:187]
    ds_read_b128 v[32:35], v2 offset:12544
    v_mfma_f32_16x16x32_bf16 v[184:187], v[44:47], a[204:207], v[184:187]
    v_exp_f32 v17, v165
    v_cvt_pk_bf16_f32 v163, v18, v19
    v_mfma_f32_16x16x32_bf16 v[188:191], v[40:43], a[224:227], v[188:191]
    ds_read_b128 v[36:39], v3 offset:12544
    v_mfma_f32_16x16x32_bf16 v[188:191], v[44:47], a[228:231], v[188:191]
    s_waitcnt lgkmcnt(2)
    v_exp_f32 v18, v166
    v_add_f32 v6, v6, v16
    v_mfma_f32_16x16x32_bf16 v[120:123], v[24:27], a[200:203], v[120:123]
    ds_read_b128 v[40:43], v2 offset:18688
    v_add_f32 v6, v6, v17
    v_mfma_f32_16x16x32_bf16 v[120:123], v[28:31], a[204:207], v[120:123]
    v_exp_f32 v19, v167
    v_cvt_pk_bf16_f32 v164, v16, v17
    v_mfma_f32_16x16x32_bf16 v[124:127], v[24:27], a[224:227], v[124:127]
    ds_read_b128 v[44:47], v3 offset:18688
    v_mfma_f32_16x16x32_bf16 v[124:127], v[28:31], a[228:231], v[124:127]
    s_waitcnt lgkmcnt(2)
    v_exp_f32 v16, v100
    v_mfma_f32_16x16x32_bf16 v[184:187], v[32:35], a[208:211], v[184:187]
    ds_read_b128 v[24:27], v1 offset:0
    v_add_f32 v6, v6, v18
    v_mfma_f32_16x16x32_bf16 v[184:187], v[36:39], a[212:215], v[184:187]
    v_add_f32 v6, v6, v19
    v_mfma_f32_16x16x32_bf16 v[188:191], v[32:35], a[232:235], v[188:191]
    ds_read_b128 v[28:31], v1 offset:12288
    v_mfma_f32_16x16x32_bf16 v[188:191], v[36:39], a[236:239], v[188:191]
    s_waitcnt lgkmcnt(2)
    v_exp_f32 v17, v101
    v_cvt_pk_bf16_f32 v165, v18, v19
    v_mfma_f32_16x16x32_bf16 v[120:123], v[40:43], a[208:211], v[120:123]
    ds_read_b128 v[32:35], v1 offset:1024
    v_mfma_f32_16x16x32_bf16 v[120:123], v[44:47], a[212:215], v[120:123]
    v_exp_f32 v18, v102
    v_mfma_f32_16x16x32_bf16 v[124:127], v[40:43], a[232:235], v[124:127]
    ds_read_b128 v[36:39], v1 offset:13312
    v_add_f32 v6, v6, v16
    v_mfma_f32_16x16x32_bf16 v[124:127], v[44:47], a[236:239], v[124:127]
    s_waitcnt lgkmcnt(2)
    v_add_f32 v6, v6, v17
    v_exp_f32 v19, v103
    v_cvt_pk_bf16_f32 v166, v16, v17
    v_add_f32 v6, v6, v18
    v_add_f32 v6, v6, v19
    v_cvt_pk_bf16_f32 v167, v18, v19
    v_mfma_f32_16x16x32_bf16 a[0:3], v[64:67], v[24:27], a[0:3]
    s_mov_b32 m0, s56
    ds_read_b128 v[40:43], v1 offset:2048
    v_bfe_u32 v57, v4, 8, 2
    v_mfma_f32_16x16x32_bf16 a[0:3], v[80:83], v[28:31], a[0:3]
    buffer_load_dwordx4 v4, s[4:7], s27 offen offset:0 sc1 lds
    v_mfma_f32_16x16x32_bf16 a[48:51], v[68:71], v[24:27], a[48:51]
    v_exp_f32 v16, v168
    v_mfma_f32_16x16x32_bf16 a[48:51], v[84:87], v[28:31], a[48:51]
    v_exp_f32 v17, v169
    v_mfma_f32_16x16x32_bf16 a[96:99], v[72:75], v[24:27], a[96:99]
    ds_read_b128 v[44:47], v1 offset:14336
    v_mul_u32_u24 v56, 1536, v57
    v_mfma_f32_16x16x32_bf16 a[96:99], v[88:91], v[28:31], a[96:99]
    buffer_load_dwordx4 v4, s[4:7], s27 offen offset:1024 sc1 lds
    v_mfma_f32_16x16x32_bf16 a[144:147], v[76:79], v[24:27], a[144:147]
    v_exp_f32 v18, v170
    v_mfma_f32_16x16x32_bf16 a[144:147], v[92:95], v[28:31], a[144:147]
    s_waitcnt lgkmcnt(2)
    v_add_f32 v5, v5, v16
    v_add_f32 v5, v5, v17
    v_mfma_f32_16x16x32_bf16 a[4:7], v[64:67], v[32:35], a[4:7]
    ds_read_b128 v[24:27], v1 offset:3072
    v_lshlrev_b32 v58, 4, v57
    v_mfma_f32_16x16x32_bf16 a[4:7], v[80:83], v[36:39], a[4:7]
    buffer_load_dwordx4 v4, s[4:7], s27 offen offset:2048 sc1 lds
    v_mfma_f32_16x16x32_bf16 a[52:55], v[68:71], v[32:35], a[52:55]
    v_exp_f32 v19, v171
    v_mfma_f32_16x16x32_bf16 a[52:55], v[84:87], v[36:39], a[52:55]
    s_add_u32 s27, s27, 24576
    v_cvt_pk_bf16_f32 v168, v16, v17
    v_bfe_u32 v57, v4, 4, 4
    v_mfma_f32_16x16x32_bf16 a[100:103], v[72:75], v[32:35], a[100:103]
    ds_read_b128 v[28:31], v1 offset:15360
    v_mfma_f32_16x16x32_bf16 a[100:103], v[88:91], v[36:39], a[100:103]
    s_add_u32 s56, s56, 12288
    v_exp_f32 v16, v104
    v_mfma_f32_16x16x32_bf16 a[148:151], v[76:79], v[32:35], a[148:151]
    v_add_f32 v5, v5, v18
    v_add_f32 v5, v5, v19
    v_mfma_f32_16x16x32_bf16 a[148:151], v[92:95], v[36:39], a[148:151]
    s_waitcnt lgkmcnt(2)
    v_exp_f32 v17, v105
    v_mfma_f32_16x16x32_bf16 a[8:11], v[64:67], v[40:43], a[8:11]
    s_mov_b32 m0, s56
    ds_read_b128 v[32:35], v1 offset:4096
    v_cvt_pk_bf16_f32 v169, v18, v19
    v_mfma_f32_16x16x32_bf16 a[8:11], v[80:83], v[44:47], a[8:11]
    v_exp_f32 v18, v106
    v_mfma_f32_16x16x32_bf16 a[56:59], v[68:71], v[40:43], a[56:59]
    v_add_f32 v5, v5, v16
    v_add_f32 v5, v5, v17
    v_mfma_f32_16x16x32_bf16 a[56:59], v[84:87], v[44:47], a[56:59]
    buffer_load_dwordx4 v4, s[4:7], s27 offen offset:0 sc1 lds
    v_mfma_f32_16x16x32_bf16 a[104:107], v[72:75], v[40:43], a[104:107]
    ds_read_b128 v[36:39], v1 offset:16384
    v_lshl_add_u32 v56, v57, 3, v56
    v_mfma_f32_16x16x32_bf16 a[104:107], v[88:91], v[44:47], a[104:107]
    v_exp_f32 v19, v107
    v_mfma_f32_16x16x32_bf16 a[152:155], v[76:79], v[40:43], a[152:155]
    v_cvt_pk_bf16_f32 v170, v16, v17
    v_mfma_f32_16x16x32_bf16 a[152:155], v[92:95], v[44:47], a[152:155]
    s_waitcnt lgkmcnt(2)
    buffer_load_dwordx4 v4, s[4:7], s27 offen offset:1024 sc1 lds
    v_mfma_f32_16x16x32_bf16 a[12:15], v[64:67], v[24:27], a[12:15]
    ds_read_b128 v[40:43], v1 offset:5120
    v_mfma_f32_16x16x32_bf16 a[12:15], v[80:83], v[28:31], a[12:15]
    v_exp_f32 v16, v172
    v_mfma_f32_16x16x32_bf16 a[60:63], v[68:71], v[24:27], a[60:63]
    v_add_f32 v5, v5, v18
    v_add_f32 v5, v5, v19
    v_mfma_f32_16x16x32_bf16 a[60:63], v[84:87], v[28:31], a[60:63]
    buffer_load_dwordx4 v4, s[4:7], s27 offen offset:2048 sc1 lds
    v_mfma_f32_16x16x32_bf16 a[108:111], v[72:75], v[24:27], a[108:111]
    ds_read_b128 v[44:47], v1 offset:17408
    v_mov_b32 v57, 1.0
    v_mfma_f32_16x16x32_bf16 a[108:111], v[88:91], v[28:31], a[108:111]
    v_exp_f32 v17, v173
    v_mfma_f32_16x16x32_bf16 a[156:159], v[76:79], v[24:27], a[156:159]
    s_add_u32 s27, s27, 24576
    v_cvt_pk_bf16_f32 v171, v18, v19
    v_mfma_f32_16x16x32_bf16 a[156:159], v[92:95], v[28:31], a[156:159]
    s_waitcnt lgkmcnt(2)
    v_exp_f32 v18, v174
    v_mfma_f32_16x16x32_bf16 a[16:19], v[64:67], v[32:35], a[16:19]
    s_add_u32 s56, s56, 36864
    ds_read_b128 v[24:27], v1 offset:6144
    v_add_f32 v6, v6, v16
    v_mfma_f32_16x16x32_bf16 a[16:19], v[80:83], v[36:39], a[16:19]
    v_add_f32 v6, v6, v17
    v_mfma_f32_16x16x32_bf16 a[64:67], v[68:71], v[32:35], a[64:67]
    s_sub_u32 s58, s56, 147456
    v_exp_f32 v19, v175
    v_mfma_f32_16x16x32_bf16 a[64:67], v[84:87], v[36:39], a[64:67]
    s_lshl_b32 s24, s95, 2
    v_cvt_pk_bf16_f32 v172, v16, v17
    v_mfma_f32_16x16x32_bf16 a[112:115], v[72:75], v[32:35], a[112:115]
    s_min_u32 s56, s56, s58
    ds_read_b128 v[28:31], v1 offset:18432
    v_mfma_f32_16x16x32_bf16 a[112:115], v[88:91], v[36:39], a[112:115]
    v_exp_f32 v16, v108
    v_mfma_f32_16x16x32_bf16 a[160:163], v[76:79], v[32:35], a[160:163]
    s_mov_b32 m0, s56
    v_add_f32 v6, v6, v18
    v_add_f32 v6, v6, v19
    v_mfma_f32_16x16x32_bf16 a[160:163], v[92:95], v[36:39], a[160:163]
    s_waitcnt lgkmcnt(2)
    v_exp_f32 v17, v109
    v_mfma_f32_16x16x32_bf16 a[20:23], v[64:67], v[40:43], a[20:23]
    ds_read_b128 v[32:35], v1 offset:7168
    v_cvt_pk_bf16_f32 v173, v18, v19
    v_mfma_f32_16x16x32_bf16 a[20:23], v[80:83], v[44:47], a[20:23]
    buffer_load_dwordx4 v4, s[4:7], s27 offen offset:0 sc1 lds
    v_mfma_f32_16x16x32_bf16 a[68:71], v[68:71], v[40:43], a[68:71]
    v_exp_f32 v18, v110
    v_mfma_f32_16x16x32_bf16 a[68:71], v[84:87], v[44:47], a[68:71]
    s_add_u32 s24, s24, s25
    v_add_f32 v6, v6, v16
    v_add_f32 v6, v6, v17
    v_mfma_f32_16x16x32_bf16 a[116:119], v[72:75], v[40:43], a[116:119]
    ds_read_b128 v[36:39], v1 offset:19456
    v_mfma_f32_16x16x32_bf16 a[116:119], v[88:91], v[44:47], a[116:119]
    buffer_load_dwordx4 v4, s[4:7], s27 offen offset:1024 sc1 lds
    v_mfma_f32_16x16x32_bf16 a[164:167], v[76:79], v[40:43], a[164:167]
    v_exp_f32 v19, v111
    v_mfma_f32_16x16x32_bf16 a[164:167], v[92:95], v[44:47], a[164:167]
    s_waitcnt lgkmcnt(2)
    v_cvt_pk_bf16_f32 v174, v16, v17
    v_add_f32 v6, v6, v18
    v_mfma_f32_16x16x32_bf16 a[24:27], v[64:67], v[24:27], a[24:27]
    ds_read_b128 v[40:43], v1 offset:8192
    v_add_f32 v6, v6, v19
    v_mfma_f32_16x16x32_bf16 a[24:27], v[80:83], v[28:31], a[24:27]
    buffer_load_dwordx4 v4, s[4:7], s27 offen offset:2048 sc1 lds
    v_mfma_f32_16x16x32_bf16 a[72:75], v[68:71], v[24:27], a[72:75]
    v_cvt_pk_bf16_f32 v175, v18, v19
    v_mfma_f32_16x16x32_bf16 a[72:75], v[84:87], v[28:31], a[72:75]
    s_mul_i32 s24, s24, 24576
    v_exp_f32 v16, v176
    v_mfma_f32_16x16x32_bf16 a[120:123], v[72:75], v[24:27], a[120:123]
    ds_read_b128 v[44:47], v1 offset:20480
    v_mfma_f32_16x16x32_bf16 a[120:123], v[88:91], v[28:31], a[120:123]
    s_add_u32 s27, s27, 24576
    v_exp_f32 v17, v177
    v_mfma_f32_16x16x32_bf16 a[168:171], v[76:79], v[24:27], a[168:171]
    v_exp_f32 v18, v178
    v_mfma_f32_16x16x32_bf16 a[168:171], v[92:95], v[28:31], a[168:171]
    s_waitcnt lgkmcnt(2)
    v_add_f32 v5, v5, v16
    v_add_f32 v5, v5, v17
    v_mfma_f32_16x16x32_bf16 a[28:31], v[64:67], v[32:35], a[28:31]
    s_add_u32 s56, s56, 12288
    ds_read_b128 v[24:27], v1 offset:9216
    v_mfma_f32_16x16x32_bf16 a[28:31], v[80:83], v[36:39], a[28:31]
    s_mov_b32 m0, s56
    v_exp_f32 v19, v179
    v_mfma_f32_16x16x32_bf16 a[76:79], v[68:71], v[32:35], a[76:79]
    v_cvt_pk_bf16_f32 v176, v16, v17
    v_mfma_f32_16x16x32_bf16 a[76:79], v[84:87], v[36:39], a[76:79]
    s_add_u32 s40, s24, 6144
    v_exp_f32 v16, v112
    v_mfma_f32_16x16x32_bf16 a[124:127], v[72:75], v[32:35], a[124:127]
    ds_read_b128 v[28:31], v1 offset:21504
    v_add_f32 v5, v5, v18
    v_mfma_f32_16x16x32_bf16 a[124:127], v[88:91], v[36:39], a[124:127]
    buffer_load_dwordx4 v4, s[4:7], s27 offen offset:0 sc1 lds
    v_mfma_f32_16x16x32_bf16 a[172:175], v[76:79], v[32:35], a[172:175]
    v_add_f32 v5, v5, v19
    v_mfma_f32_16x16x32_bf16 a[172:175], v[92:95], v[36:39], a[172:175]
    s_waitcnt lgkmcnt(2)
    v_exp_f32 v17, v113
    v_mfma_f32_16x16x32_bf16 a[32:35], v[64:67], v[40:43], a[32:35]
    ds_read_b128 v[32:35], v1 offset:10240
    v_cvt_pk_bf16_f32 v177, v18, v19
    v_mfma_f32_16x16x32_bf16 a[32:35], v[80:83], v[44:47], a[32:35]
    buffer_load_dwordx4 v4, s[4:7], s27 offen offset:1024 sc1 lds
    v_mfma_f32_16x16x32_bf16 a[80:83], v[68:71], v[40:43], a[80:83]
    v_exp_f32 v18, v114
    v_mfma_f32_16x16x32_bf16 a[80:83], v[84:87], v[44:47], a[80:83]
    s_add_u32 s41, s24, 12288
    v_add_f32 v5, v5, v16
    v_add_f32 v5, v5, v17
    v_mfma_f32_16x16x32_bf16 a[128:131], v[72:75], v[40:43], a[128:131]
    ds_read_b128 v[36:39], v1 offset:22528
    v_mfma_f32_16x16x32_bf16 a[128:131], v[88:91], v[44:47], a[128:131]
    buffer_load_dwordx4 v4, s[4:7], s27 offen offset:2048 sc1 lds
    v_mfma_f32_16x16x32_bf16 a[176:179], v[76:79], v[40:43], a[176:179]
    v_exp_f32 v19, v115
    v_mfma_f32_16x16x32_bf16 a[176:179], v[92:95], v[44:47], a[176:179]
    s_waitcnt lgkmcnt(2)
    v_cvt_pk_bf16_f32 v178, v16, v17
    v_mfma_f32_16x16x32_bf16 a[36:39], v[64:67], v[24:27], a[36:39]
    ds_read_b128 v[40:43], v1 offset:11264
    v_mfma_f32_16x16x32_bf16 a[36:39], v[80:83], v[28:31], a[36:39]
    v_exp_f32 v16, v180
    v_mfma_f32_16x16x32_bf16 a[84:87], v[68:71], v[24:27], a[84:87]
    v_add_f32 v5, v5, v18
    v_add_f32 v5, v5, v19
    v_mfma_f32_16x16x32_bf16 a[84:87], v[84:87], v[28:31], a[84:87]
    s_add_u32 s27, s27, 24576
    v_exp_f32 v17, v181
    v_mfma_f32_16x16x32_bf16 a[132:135], v[72:75], v[24:27], a[132:135]
    s_add_u32 s56, s56, 36864
    ds_read_b128 v[44:47], v1 offset:23552
    v_cvt_pk_bf16_f32 v179, v18, v19
    v_mfma_f32_16x16x32_bf16 a[132:135], v[88:91], v[28:31], a[132:135]
    s_waitcnt lgkmcnt(2)
    v_exp_f32 v18, v182
    v_mfma_f32_16x16x32_bf16 a[180:183], v[76:79], v[24:27], a[180:183]
    s_waitcnt vmcnt(12)
    v_add_f32 v6, v6, v16
    v_add_f32 v6, v6, v17
    v_mfma_f32_16x16x32_bf16 a[180:183], v[92:95], v[28:31], a[180:183]
    s_barrier
    v_add_u32 v2, 49152, v2
    v_add_u32 v3, 49152, v3
    v_mfma_f32_16x16x32_bf16 a[40:43], v[64:67], v[32:35], a[40:43]
    s_sub_u32 s58, s56, 147456
    ds_read_b128 v[24:27], v2 offset:0
    s_add_u32 s42, s24, 18432
    v_mfma_f32_16x16x32_bf16 a[40:43], v[80:83], v[36:39], a[40:43]
    s_min_u32 s56, s56, s58
    v_exp_f32 v19, v183
    v_mfma_f32_16x16x32_bf16 a[88:91], v[68:71], v[32:35], a[88:91]
    v_cvt_pk_bf16_f32 v180, v16, v17
    v_mfma_f32_16x16x32_bf16 a[88:91], v[84:87], v[36:39], a[88:91]
    v_exp_f32 v16, v116
    v_mfma_f32_16x16x32_bf16 a[136:139], v[72:75], v[32:35], a[136:139]
    ds_read_b128 v[28:31], v3 offset:0
    v_add_f32 v6, v6, v18
    v_mfma_f32_16x16x32_bf16 a[136:139], v[88:91], v[36:39], a[136:139]
    v_add_f32 v6, v6, v19
    v_mfma_f32_16x16x32_bf16 a[184:187], v[76:79], v[32:35], a[184:187]
    v_exp_f32 v17, v117
    v_mfma_f32_16x16x32_bf16 a[184:187], v[92:95], v[36:39], a[184:187]
    s_waitcnt lgkmcnt(2)
    v_cvt_pk_bf16_f32 v181, v18, v19
    v_mfma_f32_16x16x32_bf16 a[44:47], v[64:67], v[40:43], a[44:47]
    ds_read_b128 v[32:35], v2 offset:6144
    v_mfma_f32_16x16x32_bf16 a[44:47], v[80:83], v[44:47], a[44:47]
    v_exp_f32 v18, v118
    v_mfma_f32_16x16x32_bf16 a[92:95], v[68:71], v[40:43], a[92:95]
    v_add_f32 v6, v6, v16
    v_add_f32 v6, v6, v17
    v_mfma_f32_16x16x32_bf16 a[92:95], v[84:87], v[44:47], a[92:95]
    v_exp_f32 v19, v119
    v_mfma_f32_16x16x32_bf16 a[140:143], v[72:75], v[40:43], a[140:143]
    ds_read_b128 v[36:39], v3 offset:6144
    v_cvt_pk_bf16_f32 v182, v16, v17
    v_mfma_f32_16x16x32_bf16 a[140:143], v[88:91], v[44:47], a[140:143]
    v_add_f32 v6, v6, v18
    v_add_f32 v6, v6, v19
    v_mfma_f32_16x16x32_bf16 a[188:191], v[76:79], v[40:43], a[188:191]
    v_cvt_pk_bf16_f32 v183, v18, v19
    v_mfma_f32_16x16x32_bf16 a[188:191], v[92:95], v[44:47], a[188:191]
    s_waitcnt lgkmcnt(2)
    v_mfma_f32_16x16x32_bf16 v[64:67], v[24:27], a[192:195], v[128:131]
    ds_read_b128 v[40:43], v2 offset:128
    v_mfma_f32_16x16x32_bf16 v[64:67], v[28:31], a[196:199], v[64:67]
    v_exp_f32 v16, v184
    v_mfma_f32_16x16x32_bf16 v[68:71], v[24:27], a[216:219], v[132:135]
    ds_read_b128 v[44:47], v3 offset:128
    v_mfma_f32_16x16x32_bf16 v[68:71], v[28:31], a[220:223], v[68:71]
    s_waitcnt lgkmcnt(2)
    v_exp_f32 v17, v185
    v_mfma_f32_16x16x32_bf16 v[96:99], v[32:35], a[192:195], v[128:131]
    ds_read_b128 v[24:27], v2 offset:6272
    v_mfma_f32_16x16x32_bf16 v[96:99], v[36:39], a[196:199], v[96:99]
    v_exp_f32 v18, v186
    v_mfma_f32_16x16x32_bf16 v[100:103], v[32:35], a[216:219], v[132:135]
    ds_read_b128 v[28:31], v3 offset:6272
    v_add_f32 v5, v5, v16
    v_mfma_f32_16x16x32_bf16 v[100:103], v[36:39], a[220:223], v[100:103]
    s_waitcnt lgkmcnt(2)
    v_add_f32 v5, v5, v17
    v_mfma_f32_16x16x32_bf16 v[64:67], v[40:43], a[200:203], v[64:67]
    ds_read_b128 v[32:35], v2 offset:256
    v_mfma_f32_16x16x32_bf16 v[64:67], v[44:47], a[204:207], v[64:67]
    v_exp_f32 v19, v187
    v_mfma_f32_16x16x32_bf16 v[68:71], v[40:43], a[224:227], v[68:71]
    ds_read_b128 v[36:39], v3 offset:256
    v_cvt_pk_bf16_f32 v184, v16, v17
    v_mfma_f32_16x16x32_bf16 v[68:71], v[44:47], a[228:231], v[68:71]
    s_waitcnt lgkmcnt(2)
    v_exp_f32 v16, v120
    v_mfma_f32_16x16x32_bf16 v[96:99], v[24:27], a[200:203], v[96:99]
    ds_read_b128 v[40:43], v2 offset:6400
    v_add_f32 v5, v5, v18
    v_mfma_f32_16x16x32_bf16 v[96:99], v[28:31], a[204:207], v[96:99]
    s_waitcnt vmcnt(0)
    v_add_f32 v5, v5, v19
    v_mfma_f32_16x16x32_bf16 v[100:103], v[24:27], a[224:227], v[100:103]
    ds_read_b128 v[44:47], v3 offset:6400
    v_mfma_f32_16x16x32_bf16 v[100:103], v[28:31], a[228:231], v[100:103]
    s_waitcnt lgkmcnt(2)
    s_barrier
    v_mfma_f32_16x16x32_bf16 v[64:67], v[32:35], a[208:211], v[64:67]
    s_mov_b32 m0, s56
    ds_read_b128 v[24:27], v2 offset:12288
    v_mfma_f32_16x16x32_bf16 v[64:67], v[36:39], a[212:215], v[64:67]
    buffer_load_dwordx4 v4, s[4:7], s27 offen offset:0 sc1 lds
    v_mfma_f32_16x16x32_bf16 v[68:71], v[32:35], a[232:235], v[68:71]
    ds_read_b128 v[28:31], v3 offset:12288
    v_mfma_f32_16x16x32_bf16 v[68:71], v[36:39], a[236:239], v[68:71]
    s_waitcnt lgkmcnt(2)
    v_exp_f32 v17, v121
    v_cvt_pk_bf16_f32 v185, v18, v19
    v_mfma_f32_16x16x32_bf16 v[96:99], v[40:43], a[208:211], v[96:99]
    ds_read_b128 v[32:35], v2 offset:18432
    v_mfma_f32_16x16x32_bf16 v[96:99], v[44:47], a[212:215], v[96:99]
    buffer_load_dwordx4 v4, s[4:7], s27 offen offset:1024 sc1 lds
    v_mfma_f32_16x16x32_bf16 v[100:103], v[40:43], a[232:235], v[100:103]
    ds_read_b128 v[36:39], v3 offset:18432
    v_mfma_f32_16x16x32_bf16 v[100:103], v[44:47], a[236:239], v[100:103]
    s_waitcnt lgkmcnt(2)
    v_exp_f32 v18, v122
    v_add_f32 v5, v5, v16
    v_mfma_f32_16x16x32_bf16 v[72:75], v[24:27], a[192:195], v[128:131]
    ds_read_b128 v[40:43], v2 offset:12416
    v_add_f32 v5, v5, v17
    v_mfma_f32_16x16x32_bf16 v[72:75], v[28:31], a[196:199], v[72:75]
    v_exp_f32 v19, v123
    v_cvt_pk_bf16_f32 v186, v16, v17
    v_mfma_f32_16x16x32_bf16 v[76:79], v[24:27], a[216:219], v[132:135]
    ds_read_b128 v[44:47], v3 offset:12416
    v_mfma_f32_16x16x32_bf16 v[76:79], v[28:31], a[220:223], v[76:79]
    s_waitcnt lgkmcnt(2)
    buffer_load_dwordx4 v4, s[4:7], s27 offen offset:2048 sc1 lds
    v_mfma_f32_16x16x32_bf16 v[104:107], v[32:35], a[192:195], v[128:131]
    ds_read_b128 v[24:27], v2 offset:18560
    v_mfma_f32_16x16x32_bf16 v[104:107], v[36:39], a[196:199], v[104:107]
    v_exp_f32 v16, v188
    v_add_f32 v5, v5, v18
    v_mfma_f32_16x16x32_bf16 v[108:111], v[32:35], a[216:219], v[132:135]
    ds_read_b128 v[28:31], v3 offset:18560
    v_add_f32 v5, v5, v19
    v_mfma_f32_16x16x32_bf16 v[108:111], v[36:39], a[220:223], v[108:111]
    s_waitcnt lgkmcnt(2)
    v_exp_f32 v17, v189
    v_cvt_pk_bf16_f32 v187, v18, v19
    v_mfma_f32_16x16x32_bf16 v[72:75], v[40:43], a[200:203], v[72:75]
    s_add_u32 s27, s27, 24576
    ds_read_b128 v[32:35], v2 offset:12544
    v_mfma_f32_16x16x32_bf16 v[72:75], v[44:47], a[204:207], v[72:75]
    v_exp_f32 v18, v190
    v_mfma_f32_16x16x32_bf16 v[76:79], v[40:43], a[224:227], v[76:79]
    s_add_u32 s56, s56, 12288
    ds_read_b128 v[36:39], v3 offset:12544
    v_add_f32 v6, v6, v16
    v_mfma_f32_16x16x32_bf16 v[76:79], v[44:47], a[228:231], v[76:79]
    s_waitcnt lgkmcnt(2)
    v_add_f32 v6, v6, v17
    v_mfma_f32_16x16x32_bf16 v[104:107], v[24:27], a[200:203], v[104:107]
    ds_read_b128 v[40:43], v2 offset:18688
    v_mfma_f32_16x16x32_bf16 v[104:107], v[28:31], a[204:207], v[104:107]
    v_exp_f32 v19, v191
    v_cvt_pk_bf16_f32 v188, v16, v17
    v_mfma_f32_16x16x32_bf16 v[108:111], v[24:27], a[224:227], v[108:111]
    s_mov_b32 m0, s56
    ds_read_b128 v[44:47], v3 offset:18688
    v_mfma_f32_16x16x32_bf16 v[108:111], v[28:31], a[228:231], v[108:111]
    s_waitcnt lgkmcnt(2)
    v_add_u32 v2, 49152, v2
    v_add_u32 v3, 49152, v3
    v_mfma_f32_16x16x32_bf16 v[72:75], v[32:35], a[208:211], v[72:75]
    ds_read_b128 v[24:27], v2 offset:0
    v_mfma_f32_16x16x32_bf16 v[72:75], v[36:39], a[212:215], v[72:75]
    buffer_load_dwordx4 v4, s[4:7], s27 offen offset:0 sc1 lds
    v_mfma_f32_16x16x32_bf16 v[76:79], v[32:35], a[232:235], v[76:79]
    ds_read_b128 v[28:31], v3 offset:0
    v_mfma_f32_16x16x32_bf16 v[76:79], v[36:39], a[236:239], v[76:79]
    s_waitcnt lgkmcnt(2)
    v_exp_f32 v16, v124
    v_add_f32 v6, v6, v18
    v_mfma_f32_16x16x32_bf16 v[104:107], v[40:43], a[208:211], v[104:107]
    ds_read_b128 v[32:35], v2 offset:6144
    v_add_f32 v6, v6, v19
    v_mfma_f32_16x16x32_bf16 v[104:107], v[44:47], a[212:215], v[104:107]
    v_exp_f32 v17, v125
    v_cvt_pk_bf16_f32 v189, v18, v19
    v_mfma_f32_16x16x32_bf16 v[108:111], v[40:43], a[232:235], v[108:111]
    ds_read_b128 v[36:39], v3 offset:6144
    v_mfma_f32_16x16x32_bf16 v[108:111], v[44:47], a[236:239], v[108:111]
    s_waitcnt lgkmcnt(2)
    buffer_load_dwordx4 v4, s[4:7], s27 offen offset:1024 sc1 lds
    v_mfma_f32_16x16x32_bf16 v[80:83], v[24:27], a[240:243], v[136:139]
    ds_read_b128 v[40:43], v2 offset:128
    v_mfma_f32_16x16x32_bf16 v[80:83], v[28:31], a[244:247], v[80:83]
    v_exp_f32 v18, v126
    v_add_f32 v6, v6, v16
    v_mfma_f32_16x16x32_bf16 v[84:87], v[24:27], v[200:203], v[140:143]
    ds_read_b128 v[44:47], v3 offset:128
    v_add_f32 v6, v6, v17
    v_exp_f32 v19, v127
    v_cvt_pk_bf16_f32 v190, v16, v17
    v_add_f32 v6, v6, v18
    v_add_f32 v6, v6, v19
    v_cvt_pk_bf16_f32 v191, v18, v19
    v_mfma_f32_16x16x32_bf16 v[84:87], v[28:31], v[204:207], v[84:87]
    s_waitcnt lgkmcnt(2)
    v_exp_f32 v16, v64
    v_mfma_f32_16x16x32_bf16 v[112:115], v[32:35], a[240:243], v[136:139]
    ds_read_b128 v[24:27], v2 offset:6272
    v_mfma_f32_16x16x32_bf16 v[112:115], v[36:39], a[244:247], v[112:115]
    buffer_load_dwordx4 v4, s[4:7], s27 offen offset:2048 sc1 lds
    v_mfma_f32_16x16x32_bf16 v[116:119], v[32:35], v[200:203], v[140:143]
    ds_read_b128 v[28:31], v3 offset:6272
    v_mfma_f32_16x16x32_bf16 v[116:119], v[36:39], v[204:207], v[116:119]
    s_waitcnt lgkmcnt(2)
    v_exp_f32 v17, v65
    v_mfma_f32_16x16x32_bf16 v[80:83], v[40:43], a[248:251], v[80:83]
    ds_read_b128 v[32:35], v2 offset:256
    v_mfma_f32_16x16x32_bf16 v[80:83], v[44:47], a[252:255], v[80:83]
    v_exp_f32 v18, v66
    v_mfma_f32_16x16x32_bf16 v[84:87], v[40:43], v[208:211], v[84:87]
    ds_read_b128 v[36:39], v3 offset:256
    v_add_f32 v5, v5, v16
    v_mfma_f32_16x16x32_bf16 v[84:87], v[44:47], v[212:215], v[84:87]
    s_waitcnt lgkmcnt(2)
    v_add_f32 v5, v5, v17
    v_mfma_f32_16x16x32_bf16 v[112:115], v[24:27], a[248:251], v[112:115]
    ds_read_b128 v[40:43], v2 offset:6400
    v_mfma_f32_16x16x32_bf16 v[112:115], v[28:31], a[252:255], v[112:115]
    v_exp_f32 v19, v67
    v_cvt_pk_bf16_f32 v64, v16, v17
    v_mfma_f32_16x16x32_bf16 v[116:119], v[24:27], v[208:211], v[116:119]
    s_add_u32 s27, s27, 24576
    ds_read_b128 v[44:47], v3 offset:6400
    s_add_u32 s56, s56, 36864
    v_mfma_f32_16x16x32_bf16 v[116:119], v[28:31], v[212:215], v[116:119]
    s_waitcnt lgkmcnt(2)
    v_exp_f32 v16, v96
    v_mfma_f32_16x16x32_bf16 v[80:83], v[32:35], v[192:195], v[80:83]
    s_sub_u32 s58, s56, 147456
    ds_read_b128 v[24:27], v2 offset:12288
    v_add_f32 v5, v5, v18
    v_mfma_f32_16x16x32_bf16 v[80:83], v[36:39], v[196:199], v[80:83]
    s_min_u32 s56, s56, s58
    v_add_f32 v5, v5, v19
    v_mfma_f32_16x16x32_bf16 v[84:87], v[32:35], v[216:219], v[84:87]
    ds_read_b128 v[28:31], v3 offset:12288
    v_mfma_f32_16x16x32_bf16 v[84:87], v[36:39], v[220:223], v[84:87]
    s_waitcnt lgkmcnt(2)
    v_exp_f32 v17, v97
    v_cvt_pk_bf16_f32 v65, v18, v19
    v_mfma_f32_16x16x32_bf16 v[112:115], v[40:43], v[192:195], v[112:115]
    ds_read_b128 v[32:35], v2 offset:18432
    v_mfma_f32_16x16x32_bf16 v[112:115], v[44:47], v[196:199], v[112:115]
    v_exp_f32 v18, v98
    v_mfma_f32_16x16x32_bf16 v[116:119], v[40:43], v[216:219], v[116:119]
    ds_read_b128 v[36:39], v3 offset:18432
    v_add_f32 v5, v5, v16
    v_mfma_f32_16x16x32_bf16 v[116:119], v[44:47], v[220:223], v[116:119]
    s_waitcnt lgkmcnt(2)
    v_add_f32 v5, v5, v17
    v_mfma_f32_16x16x32_bf16 v[88:91], v[24:27], a[240:243], v[136:139]
    ds_read_b128 v[40:43], v2 offset:12416
    v_mfma_f32_16x16x32_bf16 v[88:91], v[28:31], a[244:247], v[88:91]
    v_exp_f32 v19, v99
    v_cvt_pk_bf16_f32 v66, v16, v17
    v_mfma_f32_16x16x32_bf16 v[92:95], v[24:27], v[200:203], v[140:143]
    ds_read_b128 v[44:47], v3 offset:12416
    v_mfma_f32_16x16x32_bf16 v[92:95], v[28:31], v[204:207], v[92:95]
    s_waitcnt lgkmcnt(2)
    v_exp_f32 v16, v68
    v_mfma_f32_16x16x32_bf16 v[120:123], v[32:35], a[240:243], v[136:139]
    ds_read_b128 v[24:27], v2 offset:18560
    v_add_f32 v5, v5, v18
    v_mfma_f32_16x16x32_bf16 v[120:123], v[36:39], a[244:247], v[120:123]
    v_add_f32 v5, v5, v19
    v_mfma_f32_16x16x32_bf16 v[124:127], v[32:35], v[200:203], v[140:143]
    ds_read_b128 v[28:31], v3 offset:18560
    v_mfma_f32_16x16x32_bf16 v[124:127], v[36:39], v[204:207], v[124:127]
    s_waitcnt lgkmcnt(2)
    v_exp_f32 v17, v69
    v_cvt_pk_bf16_f32 v67, v18, v19
    v_mfma_f32_16x16x32_bf16 v[88:91], v[40:43], a[248:251], v[88:91]
    ds_read_b128 v[32:35], v2 offset:12544
    v_mfma_f32_16x16x32_bf16 v[88:91], v[44:47], a[252:255], v[88:91]
    v_exp_f32 v18, v70
    v_mfma_f32_16x16x32_bf16 v[92:95], v[40:43], v[208:211], v[92:95]
    ds_read_b128 v[36:39], v3 offset:12544
    v_add_f32 v6, v6, v16
    v_mfma_f32_16x16x32_bf16 v[92:95], v[44:47], v[212:215], v[92:95]
    s_waitcnt lgkmcnt(2)
    v_add_f32 v6, v6, v17
    v_mfma_f32_16x16x32_bf16 v[120:123], v[24:27], a[248:251], v[120:123]
    ds_read_b128 v[40:43], v2 offset:18688
    v_mfma_f32_16x16x32_bf16 v[120:123], v[28:31], a[252:255], v[120:123]
    v_exp_f32 v19, v71
    v_cvt_pk_bf16_f32 v68, v16, v17
    v_mfma_f32_16x16x32_bf16 v[124:127], v[24:27], v[208:211], v[124:127]
    ds_read_b128 v[44:47], v3 offset:18688
    v_mfma_f32_16x16x32_bf16 v[124:127], v[28:31], v[212:215], v[124:127]
    s_waitcnt lgkmcnt(2)
    v_add_u32 v1, 49152, v1
    v_exp_f32 v16, v100
    v_mfma_f32_16x16x32_bf16 v[88:91], v[32:35], v[192:195], v[88:91]
    ds_read_b128 v[24:27], v1 offset:0
    v_add_f32 v6, v6, v18
    v_mfma_f32_16x16x32_bf16 v[88:91], v[36:39], v[196:199], v[88:91]
    v_add_f32 v6, v6, v19
    v_mfma_f32_16x16x32_bf16 v[92:95], v[32:35], v[216:219], v[92:95]
    ds_read_b128 v[28:31], v1 offset:12288
    v_mfma_f32_16x16x32_bf16 v[92:95], v[36:39], v[220:223], v[92:95]
    s_waitcnt lgkmcnt(2)
    v_exp_f32 v17, v101
    v_cvt_pk_bf16_f32 v69, v18, v19
    v_mfma_f32_16x16x32_bf16 v[120:123], v[40:43], v[192:195], v[120:123]
    ds_read_b128 v[32:35], v1 offset:1024
    v_mfma_f32_16x16x32_bf16 v[120:123], v[44:47], v[196:199], v[120:123]
    v_exp_f32 v18, v102
    v_mfma_f32_16x16x32_bf16 v[124:127], v[40:43], v[216:219], v[124:127]
    ds_read_b128 v[36:39], v1 offset:13312
    v_add_f32 v6, v6, v16
    v_mfma_f32_16x16x32_bf16 v[124:127], v[44:47], v[220:223], v[124:127]
    s_waitcnt lgkmcnt(2)
    v_add_f32 v6, v6, v17
    v_exp_f32 v19, v103
    v_cvt_pk_bf16_f32 v70, v16, v17
    v_add_f32 v6, v6, v18
    v_add_f32 v6, v6, v19
    v_cvt_pk_bf16_f32 v71, v18, v19
    v_mfma_f32_16x16x32_bf16 a[0:3], v[160:163], v[24:27], a[0:3]
    ds_read_b128 v[40:43], v1 offset:2048
    v_mfma_f32_16x16x32_bf16 a[0:3], v[168:171], v[28:31], a[0:3]
    v_exp_f32 v16, v72
    v_mfma_f32_16x16x32_bf16 a[48:51], v[164:167], v[24:27], a[48:51]
    ds_read_b128 v[44:47], v1 offset:14336
    v_mfma_f32_16x16x32_bf16 a[48:51], v[172:175], v[28:31], a[48:51]
    s_waitcnt lgkmcnt(2)
    v_exp_f32 v17, v73
    v_mfma_f32_16x16x32_bf16 a[4:7], v[160:163], v[32:35], a[4:7]
    ds_read_b128 v[24:27], v1 offset:3072
    v_mfma_f32_16x16x32_bf16 a[4:7], v[168:171], v[36:39], a[4:7]
    v_exp_f32 v18, v74
    v_mfma_f32_16x16x32_bf16 a[52:55], v[164:167], v[32:35], a[52:55]
    ds_read_b128 v[28:31], v1 offset:15360
    v_add_f32 v5, v5, v16
    v_mfma_f32_16x16x32_bf16 a[52:55], v[172:175], v[36:39], a[52:55]
    s_waitcnt lgkmcnt(2)
    v_add_f32 v5, v5, v17
    v_mfma_f32_16x16x32_bf16 a[8:11], v[160:163], v[40:43], a[8:11]
    ds_read_b128 v[32:35], v1 offset:4096
    v_mfma_f32_16x16x32_bf16 a[8:11], v[168:171], v[44:47], a[8:11]
    v_exp_f32 v19, v75
    v_mfma_f32_16x16x32_bf16 a[56:59], v[164:167], v[40:43], a[56:59]
    ds_read_b128 v[36:39], v1 offset:16384
    v_cvt_pk_bf16_f32 v72, v16, v17
    v_mfma_f32_16x16x32_bf16 a[56:59], v[172:175], v[44:47], a[56:59]
    s_waitcnt lgkmcnt(2)
    v_exp_f32 v16, v104
    v_mfma_f32_16x16x32_bf16 a[12:15], v[160:163], v[24:27], a[12:15]
    ds_read_b128 v[40:43], v1 offset:5120
    v_add_f32 v5, v5, v18
    v_mfma_f32_16x16x32_bf16 a[12:15], v[168:171], v[28:31], a[12:15]
    v_add_f32 v5, v5, v19
    v_mfma_f32_16x16x32_bf16 a[60:63], v[164:167], v[24:27], a[60:63]
    ds_read_b128 v[44:47], v1 offset:17408
    v_mfma_f32_16x16x32_bf16 a[60:63], v[172:175], v[28:31], a[60:63]
    s_waitcnt lgkmcnt(2)
    v_exp_f32 v17, v105
    v_mfma_f32_16x16x32_bf16 a[16:19], v[160:163], v[32:35], a[16:19]
    ds_read_b128 v[24:27], v1 offset:6144
    v_cvt_pk_bf16_f32 v73, v18, v19
    v_mfma_f32_16x16x32_bf16 a[16:19], v[168:171], v[36:39], a[16:19]
    v_exp_f32 v18, v106
    v_mfma_f32_16x16x32_bf16 a[64:67], v[164:167], v[32:35], a[64:67]
    ds_read_b128 v[28:31], v1 offset:18432
    v_add_f32 v5, v5, v16
    v_mfma_f32_16x16x32_bf16 a[64:67], v[172:175], v[36:39], a[64:67]
    s_waitcnt lgkmcnt(2)
    v_add_f32 v5, v5, v17
    v_mfma_f32_16x16x32_bf16 a[20:23], v[160:163], v[40:43], a[20:23]
    ds_read_b128 v[32:35], v1 offset:7168
    v_mfma_f32_16x16x32_bf16 a[20:23], v[168:171], v[44:47], a[20:23]
    v_exp_f32 v19, v107
    v_mfma_f32_16x16x32_bf16 a[68:71], v[164:167], v[40:43], a[68:71]
    ds_read_b128 v[36:39], v1 offset:19456
    v_cvt_pk_bf16_f32 v74, v16, v17
    v_mfma_f32_16x16x32_bf16 a[68:71], v[172:175], v[44:47], a[68:71]
    s_waitcnt lgkmcnt(2)
    v_exp_f32 v16, v76
    v_mfma_f32_16x16x32_bf16 a[24:27], v[160:163], v[24:27], a[24:27]
    ds_read_b128 v[40:43], v1 offset:8192
    v_add_f32 v5, v5, v18
    v_mfma_f32_16x16x32_bf16 a[24:27], v[168:171], v[28:31], a[24:27]
    v_add_f32 v5, v5, v19
    v_mfma_f32_16x16x32_bf16 a[72:75], v[164:167], v[24:27], a[72:75]
    ds_read_b128 v[44:47], v1 offset:20480
    v_mfma_f32_16x16x32_bf16 a[72:75], v[172:175], v[28:31], a[72:75]
    s_waitcnt lgkmcnt(2)
    v_exp_f32 v17, v77
    v_mfma_f32_16x16x32_bf16 a[28:31], v[160:163], v[32:35], a[28:31]
    ds_read_b128 v[24:27], v1 offset:9216
    v_cvt_pk_bf16_f32 v75, v18, v19
    v_mfma_f32_16x16x32_bf16 a[28:31], v[168:171], v[36:39], a[28:31]
    v_exp_f32 v18, v78
    v_mfma_f32_16x16x32_bf16 a[76:79], v[164:167], v[32:35], a[76:79]
    ds_read_b128 v[28:31], v1 offset:21504
    v_add_f32 v6, v6, v16
    v_mfma_f32_16x16x32_bf16 a[76:79], v[172:175], v[36:39], a[76:79]
    s_waitcnt lgkmcnt(2)
    v_add_f32 v6, v6, v17
    v_mfma_f32_16x16x32_bf16 a[32:35], v[160:163], v[40:43], a[32:35]
    ds_read_b128 v[32:35], v1 offset:10240
    v_mfma_f32_16x16x32_bf16 a[32:35], v[168:171], v[44:47], a[32:35]
    v_exp_f32 v19, v79
    v_mfma_f32_16x16x32_bf16 a[80:83], v[164:167], v[40:43], a[80:83]
    ds_read_b128 v[36:39], v1 offset:22528
    v_cvt_pk_bf16_f32 v76, v16, v17
    v_mfma_f32_16x16x32_bf16 a[80:83], v[172:175], v[44:47], a[80:83]
    s_waitcnt lgkmcnt(2)
    v_exp_f32 v16, v108
    v_mfma_f32_16x16x32_bf16 a[36:39], v[160:163], v[24:27], a[36:39]
    ds_read_b128 v[40:43], v1 offset:11264
    v_add_f32 v6, v6, v18
    v_mfma_f32_16x16x32_bf16 a[36:39], v[168:171], v[28:31], a[36:39]
    v_add_f32 v6, v6, v19
    v_mfma_f32_16x16x32_bf16 a[84:87], v[164:167], v[24:27], a[84:87]
    ds_read_b128 v[44:47], v1 offset:23552
    v_mfma_f32_16x16x32_bf16 a[84:87], v[172:175], v[28:31], a[84:87]
    s_waitcnt lgkmcnt(2)
    v_subrev_u32 v1, 98304, v1
    v_mfma_f32_16x16x32_bf16 a[40:43], v[160:163], v[32:35], a[40:43]
    ds_read_b128 v[24:27], v1 offset:0
    v_mfma_f32_16x16x32_bf16 a[40:43], v[168:171], v[36:39], a[40:43]
    v_exp_f32 v17, v109
    v_mfma_f32_16x16x32_bf16 a[88:91], v[164:167], v[32:35], a[88:91]
    ds_read_b128 v[28:31], v1 offset:12288
    v_cvt_pk_bf16_f32 v77, v18, v19
    v_mfma_f32_16x16x32_bf16 a[88:91], v[172:175], v[36:39], a[88:91]
    s_waitcnt lgkmcnt(2)
    v_exp_f32 v18, v110
    v_mfma_f32_16x16x32_bf16 a[44:47], v[160:163], v[40:43], a[44:47]
    ds_read_b128 v[32:35], v1 offset:1024
    v_add_f32 v6, v6, v16
    v_mfma_f32_16x16x32_bf16 a[44:47], v[168:171], v[44:47], a[44:47]
    v_add_f32 v6, v6, v17
    v_mfma_f32_16x16x32_bf16 a[92:95], v[164:167], v[40:43], a[92:95]
    ds_read_b128 v[36:39], v1 offset:13312
    v_mfma_f32_16x16x32_bf16 a[92:95], v[172:175], v[44:47], a[92:95]
    s_waitcnt lgkmcnt(2)
    v_exp_f32 v19, v111
    v_mfma_f32_16x16x32_bf16 a[0:3], v[176:179], v[24:27], a[0:3]
    ds_read_b128 v[40:43], v1 offset:2048
    v_cvt_pk_bf16_f32 v78, v16, v17
    v_mfma_f32_16x16x32_bf16 a[0:3], v[184:187], v[28:31], a[0:3]
    v_add_f32 v6, v6, v18
    v_add_f32 v6, v6, v19
    v_mfma_f32_16x16x32_bf16 a[48:51], v[180:183], v[24:27], a[48:51]
    ds_read_b128 v[44:47], v1 offset:14336
    v_cvt_pk_bf16_f32 v79, v18, v19
    v_mfma_f32_16x16x32_bf16 a[48:51], v[188:191], v[28:31], a[48:51]
    s_waitcnt lgkmcnt(2)
    v_exp_f32 v16, v80
    v_mfma_f32_16x16x32_bf16 a[4:7], v[176:179], v[32:35], a[4:7]
    ds_read_b128 v[24:27], v1 offset:3072
    v_mfma_f32_16x16x32_bf16 a[4:7], v[184:187], v[36:39], a[4:7]
    v_exp_f32 v17, v81
    v_mfma_f32_16x16x32_bf16 a[52:55], v[180:183], v[32:35], a[52:55]
    ds_read_b128 v[28:31], v1 offset:15360
    v_mfma_f32_16x16x32_bf16 a[52:55], v[188:191], v[36:39], a[52:55]
    s_waitcnt lgkmcnt(2)
    v_exp_f32 v18, v82
    v_mfma_f32_16x16x32_bf16 a[8:11], v[176:179], v[40:43], a[8:11]
    ds_read_b128 v[32:35], v1 offset:4096
    v_add_f32 v7, v7, v16
    v_mfma_f32_16x16x32_bf16 a[8:11], v[184:187], v[44:47], a[8:11]
    v_add_f32 v7, v7, v17
    v_mfma_f32_16x16x32_bf16 a[56:59], v[180:183], v[40:43], a[56:59]
    ds_read_b128 v[36:39], v1 offset:16384
    v_mfma_f32_16x16x32_bf16 a[56:59], v[188:191], v[44:47], a[56:59]
    s_waitcnt lgkmcnt(2)
    v_exp_f32 v19, v83
    v_mfma_f32_16x16x32_bf16 a[12:15], v[176:179], v[24:27], a[12:15]
    ds_read_b128 v[40:43], v1 offset:5120
    v_cvt_pk_bf16_f32 v80, v16, v17
    v_mfma_f32_16x16x32_bf16 a[12:15], v[184:187], v[28:31], a[12:15]
    v_exp_f32 v16, v112
    v_mfma_f32_16x16x32_bf16 a[60:63], v[180:183], v[24:27], a[60:63]
    ds_read_b128 v[44:47], v1 offset:17408
    v_add_f32 v7, v7, v18
    v_mfma_f32_16x16x32_bf16 a[60:63], v[188:191], v[28:31], a[60:63]
    s_waitcnt lgkmcnt(2)
    v_add_f32 v7, v7, v19
    v_mfma_f32_16x16x32_bf16 a[16:19], v[176:179], v[32:35], a[16:19]
    ds_read_b128 v[24:27], v1 offset:6144
    v_mfma_f32_16x16x32_bf16 a[16:19], v[184:187], v[36:39], a[16:19]
    v_exp_f32 v17, v113
    v_mfma_f32_16x16x32_bf16 a[64:67], v[180:183], v[32:35], a[64:67]
    ds_read_b128 v[28:31], v1 offset:18432
    v_cvt_pk_bf16_f32 v81, v18, v19
    v_mfma_f32_16x16x32_bf16 a[64:67], v[188:191], v[36:39], a[64:67]
    s_waitcnt lgkmcnt(2)
    v_exp_f32 v18, v114
    v_mfma_f32_16x16x32_bf16 a[20:23], v[176:179], v[40:43], a[20:23]
    ds_read_b128 v[32:35], v1 offset:7168
    v_add_f32 v7, v7, v16
    v_mfma_f32_16x16x32_bf16 a[20:23], v[184:187], v[44:47], a[20:23]
    v_add_f32 v7, v7, v17
    v_mfma_f32_16x16x32_bf16 a[68:71], v[180:183], v[40:43], a[68:71]
    ds_read_b128 v[36:39], v1 offset:19456
    v_mfma_f32_16x16x32_bf16 a[68:71], v[188:191], v[44:47], a[68:71]
    s_waitcnt lgkmcnt(2)
    v_exp_f32 v19, v115
    v_mfma_f32_16x16x32_bf16 a[24:27], v[176:179], v[24:27], a[24:27]
    ds_read_b128 v[40:43], v1 offset:8192
    v_cvt_pk_bf16_f32 v82, v16, v17
    v_mfma_f32_16x16x32_bf16 a[24:27], v[184:187], v[28:31], a[24:27]
    v_exp_f32 v16, v84
    v_mfma_f32_16x16x32_bf16 a[72:75], v[180:183], v[24:27], a[72:75]
    ds_read_b128 v[44:47], v1 offset:20480
    v_add_f32 v7, v7, v18
    v_mfma_f32_16x16x32_bf16 a[72:75], v[188:191], v[28:31], a[72:75]
    s_waitcnt lgkmcnt(2)
    v_add_f32 v7, v7, v19
    v_mfma_f32_16x16x32_bf16 a[28:31], v[176:179], v[32:35], a[28:31]
    ds_read_b128 v[24:27], v1 offset:9216
    v_mfma_f32_16x16x32_bf16 a[28:31], v[184:187], v[36:39], a[28:31]
    s_waitcnt vmcnt(0)
    v_exp_f32 v17, v85
    v_mfma_f32_16x16x32_bf16 a[76:79], v[180:183], v[32:35], a[76:79]
    ds_read_b128 v[28:31], v1 offset:21504
    v_cvt_pk_bf16_f32 v83, v18, v19
    v_mfma_f32_16x16x32_bf16 a[76:79], v[188:191], v[36:39], a[76:79]
    s_waitcnt lgkmcnt(2)
    s_barrier
    v_mfma_f32_16x16x32_bf16 a[32:35], v[176:179], v[40:43], a[32:35]
    ds_read_b128 v[32:35], v1 offset:10240
    v_mfma_f32_16x16x32_bf16 a[32:35], v[184:187], v[44:47], a[32:35]
    v_exp_f32 v18, v86
    v_mfma_f32_16x16x32_bf16 a[80:83], v[180:183], v[40:43], a[80:83]
    ds_read_b128 v[36:39], v1 offset:22528
    v_add_f32 v8, v8, v16
    v_mfma_f32_16x16x32_bf16 a[80:83], v[188:191], v[44:47], a[80:83]
    s_waitcnt lgkmcnt(2)
    v_add_f32 v8, v8, v17
    v_mfma_f32_16x16x32_bf16 a[36:39], v[176:179], v[24:27], a[36:39]
    ds_read_b128 v[40:43], v1 offset:11264
    v_mfma_f32_16x16x32_bf16 a[36:39], v[184:187], v[28:31], a[36:39]
    v_exp_f32 v19, v87
    v_cvt_pk_bf16_f32 v84, v16, v17
    v_mfma_f32_16x16x32_bf16 a[84:87], v[180:183], v[24:27], a[84:87]
    ds_read_b128 v[44:47], v1 offset:23552
    v_mfma_f32_16x16x32_bf16 a[84:87], v[188:191], v[28:31], a[84:87]
    s_waitcnt lgkmcnt(2)
    v_add_u32 v1, 49152, v1
    v_exp_f32 v16, v116
    v_mfma_f32_16x16x32_bf16 a[40:43], v[176:179], v[32:35], a[40:43]
    ds_read_b128 v[24:27], v1 offset:0
    v_add_f32 v8, v8, v18
    v_mfma_f32_16x16x32_bf16 a[40:43], v[184:187], v[36:39], a[40:43]
    v_add_f32 v8, v8, v19
    v_mfma_f32_16x16x32_bf16 a[88:91], v[180:183], v[32:35], a[88:91]
    ds_read_b128 v[28:31], v1 offset:12288
    v_mfma_f32_16x16x32_bf16 a[88:91], v[188:191], v[36:39], a[88:91]
    s_waitcnt lgkmcnt(2)
    v_exp_f32 v17, v117
    v_cvt_pk_bf16_f32 v85, v18, v19
    v_mfma_f32_16x16x32_bf16 a[44:47], v[176:179], v[40:43], a[44:47]
    ds_read_b128 v[32:35], v1 offset:1024
    v_mfma_f32_16x16x32_bf16 a[44:47], v[184:187], v[44:47], a[44:47]
    v_exp_f32 v18, v118
    v_mfma_f32_16x16x32_bf16 a[92:95], v[180:183], v[40:43], a[92:95]
    ds_read_b128 v[36:39], v1 offset:13312
    v_add_f32 v8, v8, v16
    v_mfma_f32_16x16x32_bf16 a[92:95], v[188:191], v[44:47], a[92:95]
    s_waitcnt lgkmcnt(2)
    v_add_f32 v8, v8, v17
    v_exp_f32 v19, v119
    v_cvt_pk_bf16_f32 v86, v16, v17
    v_add_f32 v8, v8, v18
    v_add_f32 v8, v8, v19
    v_cvt_pk_bf16_f32 v87, v18, v19
    v_mfma_f32_16x16x32_bf16 a[0:3], v[64:67], v[24:27], a[0:3]
    ds_read_b128 v[40:43], v1 offset:2048
    v_mfma_f32_16x16x32_bf16 a[0:3], v[72:75], v[28:31], a[0:3]
    v_exp_f32 v16, v88
    v_exp_f32 v17, v89
    v_exp_f32 v18, v90
    v_mfma_f32_16x16x4_f32 v[48:51], v5, v57, 0
    v_mfma_f32_16x16x32_bf16 a[48:51], v[68:71], v[24:27], a[48:51]
    ds_read_b128 v[44:47], v1 offset:14336
    v_add_f32 v7, v7, v16
    v_mfma_f32_16x16x32_bf16 a[48:51], v[76:79], v[28:31], a[48:51]
    s_waitcnt lgkmcnt(2)
    v_add_f32 v7, v7, v17
    v_exp_f32 v19, v91
    v_cvt_pk_bf16_f32 v88, v16, v17
    v_exp_f32 v16, v120
    v_mfma_f32_16x16x4_f32 v[52:55], v6, v57, 0
    v_mfma_f32_16x16x32_bf16 a[4:7], v[64:67], v[32:35], a[4:7]
    ds_read_b128 v[24:27], v1 offset:3072
    v_add_f32 v7, v7, v18
    v_mfma_f32_16x16x32_bf16 a[4:7], v[72:75], v[36:39], a[4:7]
    v_add_f32 v7, v7, v19
    v_exp_f32 v17, v121
    v_mfma_f32_16x16x32_bf16 a[52:55], v[68:71], v[32:35], a[52:55]
    ds_read_b128 v[28:31], v1 offset:15360
    v_cvt_pk_bf16_f32 v89, v18, v19
    v_mfma_f32_16x16x32_bf16 a[52:55], v[76:79], v[36:39], a[52:55]
    s_waitcnt lgkmcnt(2)
    v_exp_f32 v18, v122
    v_mfma_f32_16x16x32_bf16 a[8:11], v[64:67], v[40:43], a[8:11]
    ds_read_b128 v[32:35], v1 offset:4096
    v_add_f32 v7, v7, v16
    v_mfma_f32_16x16x32_bf16 a[8:11], v[72:75], v[44:47], a[8:11]
    v_add_f32 v7, v7, v17
    v_exp_f32 v19, v123
    v_mfma_f32_16x16x32_bf16 a[56:59], v[68:71], v[40:43], a[56:59]
    ds_read_b128 v[36:39], v1 offset:16384
    v_cvt_pk_bf16_f32 v90, v16, v17
    v_mfma_f32_16x16x32_bf16 a[56:59], v[76:79], v[44:47], a[56:59]
    s_waitcnt lgkmcnt(2)
    v_exp_f32 v16, v92
    v_mfma_f32_16x16x32_bf16 a[12:15], v[64:67], v[24:27], a[12:15]
    ds_read_b128 v[40:43], v1 offset:5120
    v_add_f32 v7, v7, v18
    v_mfma_f32_16x16x32_bf16 a[12:15], v[72:75], v[28:31], a[12:15]
    v_add_f32 v7, v7, v19
    v_exp_f32 v17, v93
    v_mfma_f32_16x16x32_bf16 a[60:63], v[68:71], v[24:27], a[60:63]
    ds_read_b128 v[44:47], v1 offset:17408
    v_cvt_pk_bf16_f32 v91, v18, v19
    v_mfma_f32_16x16x32_bf16 a[60:63], v[76:79], v[28:31], a[60:63]
    s_waitcnt lgkmcnt(2)
    v_exp_f32 v18, v94
    v_mfma_f32_16x16x32_bf16 a[16:19], v[64:67], v[32:35], a[16:19]
    ds_read_b128 v[24:27], v1 offset:6144
    v_add_f32 v8, v8, v16
    v_mfma_f32_16x16x32_bf16 a[16:19], v[72:75], v[36:39], a[16:19]
    v_add_f32 v8, v8, v17
    v_exp_f32 v19, v95
    v_mfma_f32_16x16x32_bf16 a[64:67], v[68:71], v[32:35], a[64:67]
    ds_read_b128 v[28:31], v1 offset:18432
    v_cvt_pk_bf16_f32 v92, v16, v17
    v_mfma_f32_16x16x32_bf16 a[64:67], v[76:79], v[36:39], a[64:67]
    s_waitcnt lgkmcnt(2)
    v_exp_f32 v16, v124
    v_mfma_f32_16x16x32_bf16 a[20:23], v[64:67], v[40:43], a[20:23]
    ds_read_b128 v[32:35], v1 offset:7168
    v_add_f32 v8, v8, v18
    v_mfma_f32_16x16x32_bf16 a[20:23], v[72:75], v[44:47], a[20:23]
    v_add_f32 v8, v8, v19
    v_exp_f32 v17, v125
    v_mfma_f32_16x16x32_bf16 a[68:71], v[68:71], v[40:43], a[68:71]
    ds_read_b128 v[36:39], v1 offset:19456
    v_cvt_pk_bf16_f32 v93, v18, v19
    v_mfma_f32_16x16x32_bf16 a[68:71], v[76:79], v[44:47], a[68:71]
    s_waitcnt lgkmcnt(2)
    v_exp_f32 v18, v126
    v_mfma_f32_16x16x32_bf16 a[24:27], v[64:67], v[24:27], a[24:27]
    ds_read_b128 v[40:43], v1 offset:8192
    v_add_f32 v8, v8, v16
    v_mfma_f32_16x16x32_bf16 a[24:27], v[72:75], v[28:31], a[24:27]
    v_add_f32 v8, v8, v17
    v_exp_f32 v19, v127
    v_mfma_f32_16x16x32_bf16 a[72:75], v[68:71], v[24:27], a[72:75]
    ds_read_b128 v[44:47], v1 offset:20480
    v_cvt_pk_bf16_f32 v94, v16, v17
    v_mfma_f32_16x16x32_bf16 a[72:75], v[76:79], v[28:31], a[72:75]
    s_waitcnt lgkmcnt(2)
    v_add_f32 v8, v8, v18
    v_add_f32 v8, v8, v19
    v_mfma_f32_16x16x32_bf16 a[28:31], v[64:67], v[32:35], a[28:31]
    ds_read_b128 v[24:27], v1 offset:9216
    v_cvt_pk_bf16_f32 v95, v18, v19
    v_mfma_f32_16x16x32_bf16 a[28:31], v[72:75], v[36:39], a[28:31]
    v_rcp_f32 v48, v48
    v_mfma_f32_16x16x32_bf16 a[76:79], v[68:71], v[32:35], a[76:79]
    ds_read_b128 v[28:31], v1 offset:21504
    v_mfma_f32_16x16x32_bf16 a[76:79], v[76:79], v[36:39], a[76:79]
    s_waitcnt lgkmcnt(2)
    v_rcp_f32 v49, v49
    v_mfma_f32_16x16x32_bf16 a[32:35], v[64:67], v[40:43], a[32:35]
    ds_read_b128 v[32:35], v1 offset:10240
    v_mfma_f32_16x16x32_bf16 a[32:35], v[72:75], v[44:47], a[32:35]
    v_rcp_f32 v50, v50
    v_mfma_f32_16x16x32_bf16 a[80:83], v[68:71], v[40:43], a[80:83]
    ds_read_b128 v[36:39], v1 offset:22528
    v_mfma_f32_16x16x32_bf16 a[80:83], v[76:79], v[44:47], a[80:83]
    s_waitcnt lgkmcnt(2)
    v_rcp_f32 v51, v51
    v_mfma_f32_16x16x32_bf16 a[36:39], v[64:67], v[24:27], a[36:39]
    ds_read_b128 v[40:43], v1 offset:11264
    v_mfma_f32_16x16x32_bf16 a[36:39], v[72:75], v[28:31], a[36:39]
    v_rcp_f32 v52, v52
    v_mfma_f32_16x16x32_bf16 a[84:87], v[68:71], v[24:27], a[84:87]
    ds_read_b128 v[44:47], v1 offset:23552
    v_mfma_f32_16x16x32_bf16 a[84:87], v[76:79], v[28:31], a[84:87]
    s_waitcnt lgkmcnt(2)
    v_subrev_u32 v2, 98304, v2
    v_subrev_u32 v3, 98304, v3
    v_mfma_f32_16x16x32_bf16 a[40:43], v[64:67], v[32:35], a[40:43]
    ds_read_b128 v[24:27], v2 offset:0
    v_mfma_f32_16x16x32_bf16 a[40:43], v[72:75], v[36:39], a[40:43]
    v_rcp_f32 v53, v53
    v_mfma_f32_16x16x32_bf16 a[88:91], v[68:71], v[32:35], a[88:91]
    ds_read_b128 v[28:31], v3 offset:0
    v_mfma_f32_16x16x32_bf16 a[88:91], v[76:79], v[36:39], a[88:91]
    s_waitcnt lgkmcnt(2)
    v_rcp_f32 v54, v54
    v_mfma_f32_16x16x32_bf16 a[44:47], v[64:67], v[40:43], a[44:47]
    ds_read_b128 v[32:35], v2 offset:6144
    v_mfma_f32_16x16x32_bf16 a[44:47], v[72:75], v[44:47], a[44:47]
    v_rcp_f32 v55, v55
    v_mfma_f32_16x16x32_bf16 a[92:95], v[68:71], v[40:43], a[92:95]
    ds_read_b128 v[36:39], v3 offset:6144
    v_mfma_f32_16x16x32_bf16 a[92:95], v[76:79], v[44:47], a[92:95]
    s_waitcnt lgkmcnt(2)
    v_mfma_f32_16x16x32_bf16 v[160:163], v[24:27], a[240:243], v[136:139]
    ds_read_b128 v[40:43], v2 offset:128
    v_mfma_f32_16x16x32_bf16 v[160:163], v[28:31], a[244:247], v[160:163]
    v_mfma_f32_16x16x32_bf16 v[164:167], v[24:27], v[200:203], v[140:143]
    ds_read_b128 v[44:47], v3 offset:128
    v_mfma_f32_16x16x32_bf16 v[164:167], v[28:31], v[204:207], v[164:167]
    s_waitcnt lgkmcnt(2)
    v_mfma_f32_16x16x32_bf16 v[96:99], v[32:35], a[240:243], v[136:139]
    ds_read_b128 v[24:27], v2 offset:6272
    v_accvgpr_read_b32 v224, a0
    v_mfma_f32_16x16x32_bf16 v[96:99], v[36:39], a[244:247], v[96:99]
    v_accvgpr_read_b32 v225, a12
    v_accvgpr_read_b32 v226, a24
    v_accvgpr_read_b32 v227, a36
    v_mul_f32 v224, v224, v48
    v_mul_f32 v225, v225, v48
    v_mfma_f32_16x16x32_bf16 v[100:103], v[32:35], v[200:203], v[140:143]
    ds_read_b128 v[28:31], v3 offset:6272
    v_mul_f32 v226, v226, v48
    v_mfma_f32_16x16x32_bf16 v[100:103], v[36:39], v[204:207], v[100:103]
    s_waitcnt lgkmcnt(2)
    v_mul_f32 v227, v227, v48
    v_cvt_pk_bf16_f32 v224, v224, v225
    v_cvt_pk_bf16_f32 v225, v226, v227
    v_accvgpr_read_b32 v228, a1
    v_accvgpr_read_b32 v229, a13
    v_accvgpr_read_b32 v230, a25
    v_mfma_f32_16x16x32_bf16 v[160:163], v[40:43], a[248:251], v[160:163]
    ds_read_b128 v[32:35], v2 offset:256
    v_accvgpr_read_b32 v231, a37
    v_mfma_f32_16x16x32_bf16 v[160:163], v[44:47], a[252:255], v[160:163]
    buffer_store_dwordx2 v[224:225], v56, s[12:15], s24 offen offset:0 sc0 sc1
    v_mul_f32 v228, v228, v49
    v_mul_f32 v229, v229, v49
    v_mul_f32 v230, v230, v49
    v_mfma_f32_16x16x32_bf16 v[164:167], v[40:43], v[208:211], v[164:167]
    ds_read_b128 v[36:39], v3 offset:256
    v_mul_f32 v231, v231, v49
    v_mfma_f32_16x16x32_bf16 v[164:167], v[44:47], v[212:215], v[164:167]
    s_waitcnt lgkmcnt(2)
    v_cvt_pk_bf16_f32 v228, v228, v229
    v_cvt_pk_bf16_f32 v229, v230, v231
    v_accvgpr_read_b32 v232, a2
    v_accvgpr_read_b32 v233, a14
    v_accvgpr_read_b32 v234, a26
    v_accvgpr_read_b32 v235, a38
    v_mfma_f32_16x16x32_bf16 v[96:99], v[24:27], a[248:251], v[96:99]
    ds_read_b128 v[40:43], v2 offset:6400
    v_mul_f32 v232, v232, v50
    v_mfma_f32_16x16x32_bf16 v[96:99], v[28:31], a[252:255], v[96:99]
    buffer_store_dwordx2 v[228:229], v56, s[12:15], s24 offen offset:384 sc0 sc1
    v_mul_f32 v233, v233, v50
    v_mul_f32 v234, v234, v50
    v_mul_f32 v235, v235, v50
    v_mfma_f32_16x16x32_bf16 v[100:103], v[24:27], v[208:211], v[100:103]
    ds_read_b128 v[44:47], v3 offset:6400
    v_cvt_pk_bf16_f32 v232, v232, v233
    v_mfma_f32_16x16x32_bf16 v[100:103], v[28:31], v[212:215], v[100:103]
    s_waitcnt lgkmcnt(2)
    v_cvt_pk_bf16_f32 v233, v234, v235
    v_accvgpr_read_b32 v236, a3
    v_accvgpr_read_b32 v237, a15
    v_accvgpr_read_b32 v238, a27
    v_accvgpr_read_b32 v239, a39
    v_mul_f32 v236, v236, v51
    v_mfma_f32_16x16x32_bf16 v[160:163], v[32:35], v[192:195], v[160:163]
    ds_read_b128 v[24:27], v2 offset:12288
    v_mul_f32 v237, v237, v51
    v_mfma_f32_16x16x32_bf16 v[160:163], v[36:39], v[196:199], v[160:163]
    buffer_store_dwordx2 v[232:233], v56, s[12:15], s24 offen offset:768 sc0 sc1
    v_mul_f32 v238, v238, v51
    v_mul_f32 v239, v239, v51
    v_cvt_pk_bf16_f32 v236, v236, v237
    v_mfma_f32_16x16x32_bf16 v[164:167], v[32:35], v[216:219], v[164:167]
    ds_read_b128 v[28:31], v3 offset:12288
    v_cvt_pk_bf16_f32 v237, v238, v239
    v_mfma_f32_16x16x32_bf16 v[164:167], v[36:39], v[220:223], v[164:167]
    s_waitcnt lgkmcnt(2)
    buffer_store_dwordx2 v[236:237], v56, s[12:15], s24 offen offset:1152 sc0 sc1
    v_accvgpr_read_b32 v240, a4
    v_accvgpr_read_b32 v241, a16
    v_accvgpr_read_b32 v242, a28
    v_mfma_f32_16x16x32_bf16 v[96:99], v[40:43], v[192:195], v[96:99]
    ds_read_b128 v[32:35], v2 offset:18432
    v_accvgpr_read_b32 v243, a40
    v_mfma_f32_16x16x32_bf16 v[96:99], v[44:47], v[196:199], v[96:99]
    v_mul_f32 v240, v240, v48
    v_mul_f32 v241, v241, v48
    v_mul_f32 v242, v242, v48
    v_mul_f32 v243, v243, v48
    v_cvt_pk_bf16_f32 v240, v240, v241
    v_cvt_pk_bf16_f32 v241, v242, v243
    v_mfma_f32_16x16x32_bf16 v[100:103], v[40:43], v[216:219], v[100:103]
    ds_read_b128 v[36:39], v3 offset:18432
    v_accvgpr_read_b32 v244, a5
    v_mfma_f32_16x16x32_bf16 v[100:103], v[44:47], v[220:223], v[100:103]
    s_waitcnt lgkmcnt(2)
    buffer_store_dwordx2 v[240:241], v56, s[12:15], s24 offen offset:128 sc0 sc1
    v_accvgpr_read_b32 v245, a17
    v_accvgpr_read_b32 v246, a29
    v_accvgpr_read_b32 v247, a41
    v_mfma_f32_16x16x32_bf16 v[168:171], v[24:27], a[240:243], v[136:139]
    ds_read_b128 v[40:43], v2 offset:12416
    v_mul_f32 v244, v244, v49
    v_mfma_f32_16x16x32_bf16 v[168:171], v[28:31], a[244:247], v[168:171]
    v_mul_f32 v245, v245, v49
    v_mul_f32 v246, v246, v49
    v_mul_f32 v247, v247, v49
    v_cvt_pk_bf16_f32 v244, v244, v245
    v_cvt_pk_bf16_f32 v245, v246, v247
    v_accvgpr_read_b32 v248, a6
    v_mfma_f32_16x16x32_bf16 v[172:175], v[24:27], v[200:203], v[140:143]
    ds_read_b128 v[44:47], v3 offset:12416
    v_accvgpr_read_b32 v249, a18
    v_mfma_f32_16x16x32_bf16 v[172:175], v[28:31], v[204:207], v[172:175]
    s_waitcnt lgkmcnt(2)
    buffer_store_dwordx2 v[244:245], v56, s[12:15], s24 offen offset:512 sc0 sc1
    v_accvgpr_read_b32 v250, a30
    v_accvgpr_read_b32 v251, a42
    v_mul_f32 v248, v248, v50
    v_mfma_f32_16x16x32_bf16 v[104:107], v[32:35], a[240:243], v[136:139]
    ds_read_b128 v[24:27], v2 offset:18560
    v_mul_f32 v249, v249, v50
    v_mfma_f32_16x16x32_bf16 v[104:107], v[36:39], a[244:247], v[104:107]
    v_mul_f32 v250, v250, v50
    v_mul_f32 v251, v251, v50
    v_cvt_pk_bf16_f32 v248, v248, v249
    v_exp_f32 v16, v160
    v_mfma_f32_16x16x32_bf16 v[108:111], v[32:35], v[200:203], v[140:143]
    ds_read_b128 v[28:31], v3 offset:18560
    v_cvt_pk_bf16_f32 v249, v250, v251
    v_mfma_f32_16x16x32_bf16 v[108:111], v[36:39], v[204:207], v[108:111]
    s_waitcnt lgkmcnt(2)
    buffer_store_dwordx2 v[248:249], v56, s[12:15], s24 offen offset:896 sc0 sc1
    v_accvgpr_read_b32 v252, a7
    v_exp_f32 v17, v161
    v_mfma_f32_16x16x32_bf16 v[168:171], v[40:43], a[248:251], v[168:171]
    ds_read_b128 v[32:35], v2 offset:12544
    v_accvgpr_read_b32 v253, a19
    v_mfma_f32_16x16x32_bf16 v[168:171], v[44:47], a[252:255], v[168:171]
    v_exp_f32 v18, v162
    v_accvgpr_read_b32 v254, a31
    v_accvgpr_read_b32 v255, a43
    v_mul_f32 v252, v252, v51
    v_add_f32 v7, v7, v16
    v_mfma_f32_16x16x32_bf16 v[172:175], v[40:43], v[208:211], v[172:175]
    ds_read_b128 v[36:39], v3 offset:12544
    v_mul_f32 v253, v253, v51
    v_mfma_f32_16x16x32_bf16 v[172:175], v[44:47], v[212:215], v[172:175]
    s_waitcnt lgkmcnt(2)
    v_add_f32 v7, v7, v17
    v_mul_f32 v254, v254, v51
    v_exp_f32 v19, v163
    v_mul_f32 v255, v255, v51
    v_cvt_pk_bf16_f32 v252, v252, v253
    v_mfma_f32_16x16x32_bf16 v[104:107], v[24:27], a[248:251], v[104:107]
    ds_read_b128 v[40:43], v2 offset:18688
    v_cvt_pk_bf16_f32 v160, v16, v17
    v_mfma_f32_16x16x32_bf16 v[104:107], v[28:31], a[252:255], v[104:107]
    v_cvt_pk_bf16_f32 v253, v254, v255
    v_exp_f32 v16, v96
    v_accvgpr_read_b32 v224, a8
    v_accvgpr_read_b32 v225, a20
    v_accvgpr_read_b32 v226, a32
    v_mfma_f32_16x16x32_bf16 v[108:111], v[24:27], v[208:211], v[108:111]
    ds_read_b128 v[44:47], v3 offset:18688
    v_add_f32 v7, v7, v18
    v_mfma_f32_16x16x32_bf16 v[108:111], v[28:31], v[212:215], v[108:111]
    s_waitcnt lgkmcnt(2)
    buffer_store_dwordx2 v[252:253], v56, s[12:15], s24 offen offset:1280 sc0 sc1
    v_add_u32 v2, 49152, v2
    v_add_u32 v3, 49152, v3
    v_add_f32 v7, v7, v19
    v_mfma_f32_16x16x32_bf16 v[168:171], v[32:35], v[192:195], v[168:171]
    ds_read_b128 v[24:27], v2 offset:0
    v_accvgpr_read_b32 v227, a44
    v_mfma_f32_16x16x32_bf16 v[168:171], v[36:39], v[196:199], v[168:171]
    v_exp_f32 v17, v97
    v_mul_f32 v224, v224, v48
    v_mul_f32 v225, v225, v48
    v_cvt_pk_bf16_f32 v161, v18, v19
    v_mul_f32 v226, v226, v48
    v_mfma_f32_16x16x32_bf16 v[172:175], v[32:35], v[216:219], v[172:175]
    ds_read_b128 v[28:31], v3 offset:0
    v_mul_f32 v227, v227, v48
    v_mfma_f32_16x16x32_bf16 v[172:175], v[36:39], v[220:223], v[172:175]
    s_waitcnt lgkmcnt(2)
    v_exp_f32 v18, v98
    v_cvt_pk_bf16_f32 v224, v224, v225
    v_add_f32 v7, v7, v16
    v_cvt_pk_bf16_f32 v225, v226, v227
    v_accvgpr_read_b32 v228, a9
    v_mfma_f32_16x16x32_bf16 v[104:107], v[40:43], v[192:195], v[104:107]
    ds_read_b128 v[32:35], v2 offset:6144
    v_add_f32 v7, v7, v17
    v_mfma_f32_16x16x32_bf16 v[104:107], v[44:47], v[196:199], v[104:107]
    buffer_store_dwordx2 v[224:225], v56, s[12:15], s24 offen offset:256 sc0 sc1
    v_exp_f32 v19, v99
    v_accvgpr_read_b32 v229, a21
    v_mfma_f32_16x16x32_bf16 v[108:111], v[40:43], v[216:219], v[108:111]
    ds_read_b128 v[36:39], v3 offset:6144
    v_accvgpr_read_b32 v230, a33
    v_mfma_f32_16x16x32_bf16 v[108:111], v[44:47], v[220:223], v[108:111]
    s_waitcnt lgkmcnt(2)
    v_cvt_pk_bf16_f32 v162, v16, v17
    v_accvgpr_read_b32 v231, a45
    v_exp_f32 v16, v164
    v_mul_f32 v228, v228, v49
    v_mul_f32 v229, v229, v49
    v_mfma_f32_16x16x32_bf16 v[176:179], v[24:27], a[240:243], v[136:139]
    ds_read_b128 v[40:43], v2 offset:128
    v_mul_f32 v230, v230, v49
    v_mfma_f32_16x16x32_bf16 v[176:179], v[28:31], a[244:247], v[176:179]
    v_add_f32 v7, v7, v18
    v_add_f32 v7, v7, v19
    v_mul_f32 v231, v231, v49
    v_cvt_pk_bf16_f32 v228, v228, v229
    v_exp_f32 v17, v165
    v_mfma_f32_16x16x32_bf16 v[180:183], v[24:27], v[200:203], v[140:143]
    ds_read_b128 v[44:47], v3 offset:128
    v_cvt_pk_bf16_f32 v229, v230, v231
    v_mfma_f32_16x16x32_bf16 v[180:183], v[28:31], v[204:207], v[180:183]
    s_waitcnt lgkmcnt(2)
    buffer_store_dwordx2 v[228:229], v56, s[12:15], s24 offen offset:640 sc0 sc1
    v_cvt_pk_bf16_f32 v163, v18, v19
    v_accvgpr_read_b32 v232, a10
    v_accvgpr_read_b32 v233, a22
    v_mfma_f32_16x16x32_bf16 v[112:115], v[32:35], a[240:243], v[136:139]
    ds_read_b128 v[24:27], v2 offset:6272
    v_accvgpr_read_b32 v234, a34
    v_mfma_f32_16x16x32_bf16 v[112:115], v[36:39], a[244:247], v[112:115]
    v_exp_f32 v18, v166
    v_accvgpr_read_b32 v235, a46
    v_add_f32 v8, v8, v16
    v_mul_f32 v232, v232, v50
    v_mfma_f32_16x16x32_bf16 v[116:119], v[32:35], v[200:203], v[140:143]
    ds_read_b128 v[28:31], v3 offset:6272
    v_add_f32 v8, v8, v17
    v_mfma_f32_16x16x32_bf16 v[116:119], v[36:39], v[204:207], v[116:119]
    s_waitcnt lgkmcnt(2)
    v_exp_f32 v19, v167
    v_mul_f32 v233, v233, v50
    v_mul_f32 v234, v234, v50
    v_mul_f32 v235, v235, v50
    v_cvt_pk_bf16_f32 v232, v232, v233
    v_mfma_f32_16x16x32_bf16 v[176:179], v[40:43], a[248:251], v[176:179]
    ds_read_b128 v[32:35], v2 offset:256
    v_cvt_pk_bf16_f32 v164, v16, v17
    v_mfma_f32_16x16x32_bf16 v[176:179], v[44:47], a[252:255], v[176:179]
    v_exp_f32 v16, v100
    v_cvt_pk_bf16_f32 v233, v234, v235
    v_accvgpr_read_b32 v236, a11
    v_accvgpr_read_b32 v237, a23
    v_add_f32 v8, v8, v18
    v_mfma_f32_16x16x32_bf16 v[180:183], v[40:43], v[208:211], v[180:183]
    ds_read_b128 v[36:39], v3 offset:256
    v_accvgpr_read_b32 v238, a35
    v_mfma_f32_16x16x32_bf16 v[180:183], v[44:47], v[212:215], v[180:183]
    s_waitcnt lgkmcnt(2)
    buffer_store_dwordx2 v[232:233], v56, s[12:15], s24 offen offset:1024 sc0 sc1
    v_add_f32 v8, v8, v19
    v_exp_f32 v17, v101
    v_mfma_f32_16x16x32_bf16 v[112:115], v[24:27], a[248:251], v[112:115]
    ds_read_b128 v[40:43], v2 offset:6400
    v_accvgpr_read_b32 v239, a47
    v_mfma_f32_16x16x32_bf16 v[112:115], v[28:31], a[252:255], v[112:115]
    v_mul_f32 v236, v236, v51
    v_cvt_pk_bf16_f32 v165, v18, v19
    v_mul_f32 v237, v237, v51
    v_mul_f32 v238, v238, v51
    v_exp_f32 v18, v102
    v_mfma_f32_16x16x32_bf16 v[116:119], v[24:27], v[208:211], v[116:119]
    ds_read_b128 v[44:47], v3 offset:6400
    v_mul_f32 v239, v239, v51
    v_mfma_f32_16x16x32_bf16 v[116:119], v[28:31], v[212:215], v[116:119]
    s_waitcnt lgkmcnt(2)
    v_add_f32 v8, v8, v16
    v_cvt_pk_bf16_f32 v236, v236, v237
    v_cvt_pk_bf16_f32 v237, v238, v239
    v_add_f32 v8, v8, v17
    v_accvgpr_read_b32 v240, a48
    v_accvgpr_read_b32 v241, a60
    v_mfma_f32_16x16x32_bf16 v[176:179], v[32:35], v[192:195], v[176:179]
    ds_read_b128 v[24:27], v2 offset:12288
    v_accvgpr_read_b32 v242, a72
    v_mfma_f32_16x16x32_bf16 v[176:179], v[36:39], v[196:199], v[176:179]
    buffer_store_dwordx2 v[236:237], v56, s[12:15], s24 offen offset:1408 sc0 sc1
    v_exp_f32 v19, v103
    v_cvt_pk_bf16_f32 v166, v16, v17
    v_mfma_f32_16x16x32_bf16 v[180:183], v[32:35], v[216:219], v[180:183]
    ds_read_b128 v[28:31], v3 offset:12288
    v_accvgpr_read_b32 v243, a84
    v_mfma_f32_16x16x32_bf16 v[180:183], v[36:39], v[220:223], v[180:183]
    s_waitcnt lgkmcnt(2)
    v_add_f32 v8, v8, v18
    v_add_f32 v8, v8, v19
    v_mul_f32 v240, v240, v52
    v_mul_f32 v241, v241, v52
    v_cvt_pk_bf16_f32 v167, v18, v19
    v_mul_f32 v242, v242, v52
    v_mfma_f32_16x16x32_bf16 v[112:115], v[40:43], v[192:195], v[112:115]
    ds_read_b128 v[32:35], v2 offset:18432
    v_mul_f32 v243, v243, v52
    v_mfma_f32_16x16x32_bf16 v[112:115], v[44:47], v[196:199], v[112:115]
    v_exp_f32 v16, v168
    v_cvt_pk_bf16_f32 v240, v240, v241
    v_cvt_pk_bf16_f32 v241, v242, v243
    v_exp_f32 v17, v169
    v_mfma_f32_16x16x32_bf16 v[116:119], v[40:43], v[216:219], v[116:119]
    ds_read_b128 v[36:39], v3 offset:18432
    v_accvgpr_read_b32 v244, a49
    v_mfma_f32_16x16x32_bf16 v[116:119], v[44:47], v[220:223], v[116:119]
    s_waitcnt lgkmcnt(2)
    buffer_store_dwordx2 v[240:241], v56, s[12:15], s40 offen offset:0 sc0 sc1
    v_exp_f32 v18, v170
    v_accvgpr_read_b32 v245, a61
    v_mfma_f32_16x16x32_bf16 v[184:187], v[24:27], a[240:243], v[136:139]
    ds_read_b128 v[40:43], v2 offset:12416
    v_accvgpr_read_b32 v246, a73
    v_mfma_f32_16x16x32_bf16 v[184:187], v[28:31], a[244:247], v[184:187]
    v_add_f32 v7, v7, v16
    v_accvgpr_read_b32 v247, a85
    v_mul_f32 v244, v244, v53
    v_add_f32 v7, v7, v17
    v_mul_f32 v245, v245, v53
    v_mul_f32 v246, v246, v53
    v_mfma_f32_16x16x32_bf16 v[188:191], v[24:27], v[200:203], v[140:143]
    ds_read_b128 v[44:47], v3 offset:12416
    v_mul_f32 v247, v247, v53
    v_mfma_f32_16x16x32_bf16 v[188:191], v[28:31], v[204:207], v[188:191]
    s_waitcnt lgkmcnt(2)
    v_exp_f32 v19, v171
    v_cvt_pk_bf16_f32 v168, v16, v17
    v_cvt_pk_bf16_f32 v244, v244, v245
    v_cvt_pk_bf16_f32 v245, v246, v247
    v_accvgpr_read_b32 v248, a50
    v_mfma_f32_16x16x32_bf16 v[120:123], v[32:35], a[240:243], v[136:139]
    ds_read_b128 v[24:27], v2 offset:18560
    v_accvgpr_read_b32 v249, a62
    v_mfma_f32_16x16x32_bf16 v[120:123], v[36:39], a[244:247], v[120:123]
    buffer_store_dwordx2 v[244:245], v56, s[12:15], s40 offen offset:384 sc0 sc1
    v_exp_f32 v16, v104
    v_mfma_f32_16x16x32_bf16 v[124:127], v[32:35], v[200:203], v[140:143]
    ds_read_b128 v[28:31], v3 offset:18560
    v_add_f32 v7, v7, v18
    v_mfma_f32_16x16x32_bf16 v[124:127], v[36:39], v[204:207], v[124:127]
    s_waitcnt lgkmcnt(2)
    v_add_f32 v7, v7, v19
    v_accvgpr_read_b32 v250, a74
    v_exp_f32 v17, v105
    v_accvgpr_read_b32 v251, a86
    v_mul_f32 v248, v248, v54
    v_mfma_f32_16x16x32_bf16 v[184:187], v[40:43], a[248:251], v[184:187]
    ds_read_b128 v[32:35], v2 offset:12544
    v_mul_f32 v249, v249, v54
    v_mfma_f32_16x16x32_bf16 v[184:187], v[44:47], a[252:255], v[184:187]
    v_cvt_pk_bf16_f32 v169, v18, v19
    v_exp_f32 v18, v106
    v_mul_f32 v250, v250, v54
    v_mul_f32 v251, v251, v54
    v_cvt_pk_bf16_f32 v248, v248, v249
    v_mfma_f32_16x16x32_bf16 v[188:191], v[40:43], v[208:211], v[188:191]
    ds_read_b128 v[36:39], v3 offset:12544
    v_add_f32 v7, v7, v16
    v_mfma_f32_16x16x32_bf16 v[188:191], v[44:47], v[212:215], v[188:191]
    s_waitcnt lgkmcnt(2)
    v_cvt_pk_bf16_f32 v249, v250, v251
    v_add_f32 v7, v7, v17
    v_accvgpr_read_b32 v252, a51
    v_accvgpr_read_b32 v253, a63
    v_exp_f32 v19, v107
    v_mfma_f32_16x16x32_bf16 v[120:123], v[24:27], a[248:251], v[120:123]
    ds_read_b128 v[40:43], v2 offset:18688
    v_accvgpr_read_b32 v254, a75
    v_mfma_f32_16x16x32_bf16 v[120:123], v[28:31], a[252:255], v[120:123]
    buffer_store_dwordx2 v[248:249], v56, s[12:15], s40 offen offset:768 sc0 sc1
    v_cvt_pk_bf16_f32 v170, v16, v17
    v_accvgpr_read_b32 v255, a87
    v_mul_f32 v252, v252, v55
    v_mfma_f32_16x16x32_bf16 v[124:127], v[24:27], v[208:211], v[124:127]
    ds_read_b128 v[44:47], v3 offset:18688
    v_mul_f32 v253, v253, v55
    v_mfma_f32_16x16x32_bf16 v[124:127], v[28:31], v[212:215], v[124:127]
    s_waitcnt lgkmcnt(2)
    v_add_u32 v22, 49152, v1
    v_mov_b32 v23, v1
    v_subrev_u32 v1, 49152, v1
    v_exp_f32 v16, v172
    v_mul_f32 v254, v254, v55
    v_mfma_f32_16x16x32_bf16 v[184:187], v[32:35], v[192:195], v[184:187]
    ds_read_b128 v[24:27], v22 offset:0
    v_add_f32 v7, v7, v18
    v_mfma_f32_16x16x32_bf16 v[184:187], v[36:39], v[196:199], v[184:187]
    v_add_f32 v7, v7, v19
    v_mul_f32 v255, v255, v55
    v_exp_f32 v17, v173
    v_cvt_pk_bf16_f32 v252, v252, v253
    v_cvt_pk_bf16_f32 v253, v254, v255
    v_mfma_f32_16x16x32_bf16 v[188:191], v[32:35], v[216:219], v[188:191]
    ds_read_b128 v[28:31], v22 offset:12288
    v_accvgpr_read_b32 v224, a52
    v_mfma_f32_16x16x32_bf16 v[188:191], v[36:39], v[220:223], v[188:191]
    s_waitcnt lgkmcnt(2)
    buffer_store_dwordx2 v[252:253], v56, s[12:15], s40 offen offset:1152 sc0 sc1
    v_cvt_pk_bf16_f32 v171, v18, v19
    v_accvgpr_read_b32 v225, a64
    v_accvgpr_read_b32 v226, a76
    v_mfma_f32_16x16x32_bf16 v[120:123], v[40:43], v[192:195], v[120:123]
    ds_read_b128 v[32:35], v22 offset:3072
    v_accvgpr_read_b32 v227, a88
    v_mfma_f32_16x16x32_bf16 v[120:123], v[44:47], v[196:199], v[120:123]
    v_exp_f32 v18, v174
    v_add_f32 v8, v8, v16
    v_mul_f32 v224, v224, v52
    v_mul_f32 v225, v225, v52
    v_add_f32 v8, v8, v17
    v_mfma_f32_16x16x32_bf16 v[124:127], v[40:43], v[216:219], v[124:127]
    ds_read_b128 v[36:39], v22 offset:15360
    v_mul_f32 v226, v226, v52
    v_mfma_f32_16x16x32_bf16 v[124:127], v[44:47], v[220:223], v[124:127]
    s_waitcnt lgkmcnt(2)
    v_exp_f32 v19, v175
    v_mul_f32 v227, v227, v52
    v_cvt_pk_bf16_f32 v224, v224, v225
    v_cvt_pk_bf16_f32 v225, v226, v227
    v_accvgpr_read_b32 v228, a53
    v_mfma_f32_16x16x32_bf16 a[96:99], v[80:83], v[24:27], a[96:99]
    ds_read_b128 v[40:43], v22 offset:6144
    v_cvt_pk_bf16_f32 v172, v16, v17
    v_mfma_f32_16x16x32_bf16 a[96:99], v[88:91], v[28:31], a[96:99]
    buffer_store_dwordx2 v[224:225], v56, s[12:15], s40 offen offset:128 sc0 sc1
    v_exp_f32 v16, v108
    v_accvgpr_read_b32 v229, a65
    v_mfma_f32_16x16x32_bf16 a[144:147], v[84:87], v[24:27], a[144:147]
    ds_read_b128 v[44:47], v22 offset:18432
    v_add_f32 v8, v8, v18
    v_mfma_f32_16x16x32_bf16 a[144:147], v[92:95], v[28:31], a[144:147]
    s_waitcnt lgkmcnt(2)
    v_add_f32 v8, v8, v19
    v_accvgpr_read_b32 v230, a77
    v_accvgpr_read_b32 v231, a89
    v_mul_f32 v228, v228, v53
    v_mul_f32 v229, v229, v53
    v_mul_f32 v230, v230, v53
    v_mfma_f32_16x16x32_bf16 a[108:111], v[80:83], v[32:35], a[108:111]
    ds_read_b128 v[24:27], v22 offset:9216
    v_mul_f32 v231, v231, v53
    v_mfma_f32_16x16x32_bf16 a[108:111], v[88:91], v[36:39], a[108:111]
    v_exp_f32 v17, v109
    v_cvt_pk_bf16_f32 v173, v18, v19
    v_cvt_pk_bf16_f32 v228, v228, v229
    v_cvt_pk_bf16_f32 v229, v230, v231
    v_accvgpr_read_b32 v232, a54
    v_mfma_f32_16x16x32_bf16 a[156:159], v[84:87], v[32:35], a[156:159]
    ds_read_b128 v[28:31], v22 offset:21504
    v_accvgpr_read_b32 v233, a66
    v_mfma_f32_16x16x32_bf16 a[156:159], v[92:95], v[36:39], a[156:159]
    s_waitcnt lgkmcnt(2)
    buffer_store_dwordx2 v[228:229], v56, s[12:15], s40 offen offset:512 sc0 sc1
    v_exp_f32 v18, v110
    v_mfma_f32_16x16x32_bf16 a[120:123], v[80:83], v[40:43], a[120:123]
    ds_read_b128 v[32:35], v1 offset:0
    v_add_f32 v8, v8, v16
    v_mfma_f32_16x16x32_bf16 a[120:123], v[88:91], v[44:47], a[120:123]
    v_add_f32 v8, v8, v17
    v_accvgpr_read_b32 v234, a78
    v_exp_f32 v19, v111
    v_accvgpr_read_b32 v235, a90
    v_mul_f32 v232, v232, v54
    v_mfma_f32_16x16x32_bf16 a[168:171], v[84:87], v[40:43], a[168:171]
    ds_read_b128 v[36:39], v1 offset:12288
    v_mul_f32 v233, v233, v54
    v_mfma_f32_16x16x32_bf16 a[168:171], v[92:95], v[44:47], a[168:171]
    s_waitcnt lgkmcnt(2)
    v_cvt_pk_bf16_f32 v174, v16, v17
    v_mul_f32 v234, v234, v54
    v_mul_f32 v235, v235, v54
    v_cvt_pk_bf16_f32 v232, v232, v233
    v_cvt_pk_bf16_f32 v233, v234, v235
    v_accvgpr_read_b32 v236, a55
    v_mfma_f32_16x16x32_bf16 a[132:135], v[80:83], v[24:27], a[132:135]
    ds_read_b128 v[40:43], v1 offset:3072
    v_add_f32 v8, v8, v18
    v_mfma_f32_16x16x32_bf16 a[132:135], v[88:91], v[28:31], a[132:135]
    buffer_store_dwordx2 v[232:233], v56, s[12:15], s40 offen offset:896 sc0 sc1
    v_add_f32 v8, v8, v19
    v_cvt_pk_bf16_f32 v175, v18, v19
    v_accvgpr_read_b32 v237, a67
    v_mfma_f32_16x16x32_bf16 a[180:183], v[84:87], v[24:27], a[180:183]
    ds_read_b128 v[44:47], v1 offset:15360
    v_accvgpr_read_b32 v238, a79
    v_mfma_f32_16x16x32_bf16 a[180:183], v[92:95], v[28:31], a[180:183]
    s_waitcnt lgkmcnt(2)
    v_exp_f32 v16, v176
    v_exp_f32 v17, v177
    v_exp_f32 v18, v178
    v_mfma_f32_16x16x32_bf16 a[96:99], v[160:163], v[32:35], a[96:99]
    ds_read_b128 v[24:27], v1 offset:6144
    v_add_f32 v7, v7, v16
    v_mfma_f32_16x16x32_bf16 a[96:99], v[168:171], v[36:39], a[96:99]
    v_add_f32 v7, v7, v17
    v_exp_f32 v19, v179
    v_cvt_pk_bf16_f32 v176, v16, v17
    v_exp_f32 v16, v112
    v_mfma_f32_16x16x32_bf16 a[144:147], v[164:167], v[32:35], a[144:147]
    ds_read_b128 v[28:31], v1 offset:18432
    v_add_f32 v7, v7, v18
    v_mfma_f32_16x16x32_bf16 a[144:147], v[172:175], v[36:39], a[144:147]
    s_waitcnt lgkmcnt(2)
    v_add_f32 v7, v7, v19
    v_exp_f32 v17, v113
    v_cvt_pk_bf16_f32 v177, v18, v19
    v_exp_f32 v18, v114
    v_mfma_f32_16x16x32_bf16 a[108:111], v[160:163], v[40:43], a[108:111]
    ds_read_b128 v[32:35], v1 offset:9216
    v_add_f32 v7, v7, v16
    v_mfma_f32_16x16x32_bf16 a[108:111], v[168:171], v[44:47], a[108:111]
    v_add_f32 v7, v7, v17
    v_exp_f32 v19, v115
    v_cvt_pk_bf16_f32 v178, v16, v17
    v_exp_f32 v16, v180
    v_mfma_f32_16x16x32_bf16 a[156:159], v[164:167], v[40:43], a[156:159]
    ds_read_b128 v[36:39], v1 offset:21504
    v_add_f32 v7, v7, v18
    v_mfma_f32_16x16x32_bf16 a[156:159], v[172:175], v[44:47], a[156:159]
    s_waitcnt lgkmcnt(2)
    v_add_f32 v7, v7, v19
    v_exp_f32 v17, v181
    v_cvt_pk_bf16_f32 v179, v18, v19
    v_exp_f32 v18, v182
    v_mfma_f32_16x16x32_bf16 a[120:123], v[160:163], v[24:27], a[120:123]
    ds_read_b128 v[40:43], v23 offset:0
    v_add_f32 v8, v8, v16
    v_mfma_f32_16x16x32_bf16 a[120:123], v[168:171], v[28:31], a[120:123]
    v_add_f32 v8, v8, v17
    v_exp_f32 v19, v183
    v_cvt_pk_bf16_f32 v180, v16, v17
    v_exp_f32 v16, v116
    v_mfma_f32_16x16x32_bf16 a[168:171], v[164:167], v[24:27], a[168:171]
    ds_read_b128 v[44:47], v23 offset:12288
    v_add_f32 v8, v8, v18
    v_mfma_f32_16x16x32_bf16 a[168:171], v[172:175], v[28:31], a[168:171]
    s_waitcnt lgkmcnt(2)
    v_add_f32 v8, v8, v19
    v_exp_f32 v17, v117
    v_cvt_pk_bf16_f32 v181, v18, v19
    v_exp_f32 v18, v118
    v_mfma_f32_16x16x32_bf16 a[132:135], v[160:163], v[32:35], a[132:135]
    ds_read_b128 v[24:27], v23 offset:3072
    v_add_f32 v8, v8, v16
    v_mfma_f32_16x16x32_bf16 a[132:135], v[168:171], v[36:39], a[132:135]
    v_add_f32 v8, v8, v17
    v_exp_f32 v19, v119
    v_cvt_pk_bf16_f32 v182, v16, v17
    v_add_f32 v8, v8, v18
    v_add_f32 v8, v8, v19
    v_cvt_pk_bf16_f32 v183, v18, v19
    v_exp_f32 v16, v184
    v_exp_f32 v17, v185
    v_exp_f32 v18, v186
    v_add_f32 v7, v7, v16
    v_add_f32 v7, v7, v17
    v_exp_f32 v19, v187
    v_cvt_pk_bf16_f32 v184, v16, v17
    v_exp_f32 v16, v120
    v_add_f32 v7, v7, v18
    v_add_f32 v7, v7, v19
    v_exp_f32 v17, v121
    v_cvt_pk_bf16_f32 v185, v18, v19
    v_exp_f32 v18, v122
    v_add_f32 v7, v7, v16
    v_add_f32 v7, v7, v17
    v_exp_f32 v19, v123
    v_cvt_pk_bf16_f32 v186, v16, v17
    v_exp_f32 v16, v188
    v_add_f32 v7, v7, v18
    v_add_f32 v7, v7, v19
    v_exp_f32 v17, v189
    v_cvt_pk_bf16_f32 v187, v18, v19
    v_exp_f32 v18, v190
    v_add_f32 v8, v8, v16
    v_add_f32 v8, v8, v17
    v_exp_f32 v19, v191
    v_cvt_pk_bf16_f32 v188, v16, v17
    v_exp_f32 v16, v124
    v_add_f32 v8, v8, v18
    v_add_f32 v8, v8, v19
    v_exp_f32 v17, v125
    v_cvt_pk_bf16_f32 v189, v18, v19
    v_exp_f32 v18, v126
    v_add_f32 v8, v8, v16
    v_add_f32 v8, v8, v17
    v_exp_f32 v19, v127
    v_cvt_pk_bf16_f32 v190, v16, v17
    v_add_f32 v8, v8, v18
    v_add_f32 v8, v8, v19
    v_cvt_pk_bf16_f32 v191, v18, v19
    v_mfma_f32_16x16x32_bf16 a[180:183], v[164:167], v[32:35], a[180:183]
    ds_read_b128 v[28:31], v23 offset:15360
    v_accvgpr_read_b32 v239, a91
    v_mfma_f32_16x16x32_bf16 a[180:183], v[172:175], v[36:39], a[180:183]
    s_waitcnt lgkmcnt(2)
    v_mul_f32 v236, v236, v55
    v_mul_f32 v237, v237, v55
    v_mul_f32 v238, v238, v55
    v_mul_f32 v239, v239, v55
    v_cvt_pk_bf16_f32 v236, v236, v237
    v_cvt_pk_bf16_f32 v237, v238, v239
    v_mfma_f32_16x16x4_f32 v[128:131], v7, v57, 0
    v_mfma_f32_16x16x32_bf16 a[96:99], v[176:179], v[40:43], a[96:99]
    ds_read_b128 v[32:35], v23 offset:6144
    v_accvgpr_read_b32 v240, a56
    v_mfma_f32_16x16x32_bf16 a[96:99], v[184:187], v[44:47], a[96:99]
    buffer_store_dwordx2 v[236:237], v56, s[12:15], s40 offen offset:1280 sc0 sc1
    v_accvgpr_read_b32 v241, a68
    v_accvgpr_read_b32 v242, a80
    v_accvgpr_read_b32 v243, a92
    v_mfma_f32_16x16x4_f32 v[132:135], v8, v57, 0
    v_mfma_f32_16x16x32_bf16 a[144:147], v[180:183], v[40:43], a[144:147]
    ds_read_b128 v[36:39], v23 offset:18432
    v_mul_f32 v240, v240, v52
    v_mfma_f32_16x16x32_bf16 a[144:147], v[188:191], v[44:47], a[144:147]
    s_waitcnt lgkmcnt(2)
    v_max3_f32 v18, v5, v6, v7
    v_mul_f32 v241, v241, v52
    v_max_f32 v18, v18, v8
    v_mul_f32 v242, v242, v52
    s_mov_b32 s29, 0x5f800000
    v_mfma_f32_16x16x32_bf16 a[108:111], v[176:179], v[24:27], a[108:111]
    ds_read_b128 v[40:43], v23 offset:9216
    v_mul_f32 v243, v243, v52
    v_mfma_f32_16x16x32_bf16 a[108:111], v[184:187], v[28:31], a[108:111]
    v_cmp_lt_f32 s[48:49], s29, v18
    v_cvt_pk_bf16_f32 v240, v240, v241
    v_cvt_pk_bf16_f32 v241, v242, v243
    v_accvgpr_read_b32 v244, a57
    v_accvgpr_read_b32 v245, a69
    v_accvgpr_read_b32 v246, a81
    v_mfma_f32_16x16x32_bf16 a[156:159], v[180:183], v[24:27], a[156:159]
    ds_read_b128 v[44:47], v23 offset:21504
    v_accvgpr_read_b32 v247, a93
    v_mfma_f32_16x16x32_bf16 a[156:159], v[188:191], v[28:31], a[156:159]
    s_waitcnt lgkmcnt(2)
    buffer_store_dwordx2 v[240:241], v56, s[12:15], s40 offen offset:256 sc0 sc1
    v_rcp_f32 v128, v128
    v_mul_f32 v244, v244, v53
    v_mfma_f32_16x16x32_bf16 a[120:123], v[176:179], v[32:35], a[120:123]
    ds_read_b128 v[24:27], v22 offset:1024
    v_mul_f32 v245, v245, v53
    v_mfma_f32_16x16x32_bf16 a[120:123], v[184:187], v[36:39], a[120:123]
    v_rcp_f32 v129, v129
    v_rcp_f32 v130, v130
    v_rcp_f32 v131, v131
    v_mfma_f32_16x16x32_bf16 a[168:171], v[180:183], v[32:35], a[168:171]
    ds_read_b128 v[28:31], v22 offset:13312
    v_mul_f32 v246, v246, v53
    v_mfma_f32_16x16x32_bf16 a[168:171], v[188:191], v[36:39], a[168:171]
    s_waitcnt lgkmcnt(2)
    v_rcp_f32 v132, v132
    v_mul_f32 v247, v247, v53
    v_cvt_pk_bf16_f32 v244, v244, v245
    v_rcp_f32 v133, v133
    v_mfma_f32_16x16x32_bf16 a[132:135], v[176:179], v[40:43], a[132:135]
    ds_read_b128 v[32:35], v22 offset:4096
    v_cvt_pk_bf16_f32 v245, v246, v247
    v_mfma_f32_16x16x32_bf16 a[132:135], v[184:187], v[44:47], a[132:135]
    buffer_store_dwordx2 v[244:245], v56, s[12:15], s40 offen offset:640 sc0 sc1
    v_rcp_f32 v134, v134
    v_accvgpr_read_b32 v248, a58
    v_mfma_f32_16x16x32_bf16 a[180:183], v[180:183], v[40:43], a[180:183]
    ds_read_b128 v[36:39], v22 offset:16384
    v_rcp_f32 v135, v135
    v_mfma_f32_16x16x32_bf16 a[180:183], v[188:191], v[44:47], a[180:183]
    s_waitcnt lgkmcnt(2)
    v_accvgpr_read_b32 v249, a70
    v_accvgpr_read_b32 v250, a82
    v_accvgpr_read_b32 v251, a94
    v_mul_f32 v248, v248, v54
    v_mul_f32 v249, v249, v54
    v_mfma_f32_16x16x32_bf16 a[100:103], v[80:83], v[24:27], a[100:103]
    ds_read_b128 v[40:43], v22 offset:7168
    v_mul_f32 v250, v250, v54
    v_mfma_f32_16x16x32_bf16 a[100:103], v[88:91], v[28:31], a[100:103]
    v_mul_f32 v251, v251, v54
    v_cvt_pk_bf16_f32 v248, v248, v249
    v_cvt_pk_bf16_f32 v249, v250, v251
    v_accvgpr_read_b32 v252, a59
    v_accvgpr_read_b32 v253, a71
    v_accvgpr_read_b32 v254, a83
    v_mfma_f32_16x16x32_bf16 a[148:151], v[84:87], v[24:27], a[148:151]
    ds_read_b128 v[44:47], v22 offset:19456
    v_accvgpr_read_b32 v255, a95
    v_mfma_f32_16x16x32_bf16 a[148:151], v[92:95], v[28:31], a[148:151]
    s_waitcnt lgkmcnt(2)
    s_cmp_lg_u64 s[48:49], 0
    s_cbranch_scc1 L_slow
    v_mul_f32 v252, v252, v55
    v_mul_f32 v253, v253, v55
    v_mfma_f32_16x16x32_bf16 a[112:115], v[80:83], v[32:35], a[112:115]
    ds_read_b128 v[24:27], v22 offset:10240
    v_mul_f32 v254, v254, v55
    v_mfma_f32_16x16x32_bf16 a[112:115], v[88:91], v[36:39], a[112:115]
    buffer_store_dwordx2 v[248:249], v56, s[12:15], s40 offen offset:1024 sc0 sc1
    v_mul_f32 v255, v255, v55
    v_cvt_pk_bf16_f32 v252, v252, v253
    v_cvt_pk_bf16_f32 v253, v254, v255
    v_mfma_f32_16x16x32_bf16 a[160:163], v[84:87], v[32:35], a[160:163]
    ds_read_b128 v[28:31], v22 offset:22528
    v_accvgpr_read_b32 v224, a96
    v_mfma_f32_16x16x32_bf16 a[160:163], v[92:95], v[36:39], a[160:163]
    s_waitcnt lgkmcnt(2)
    buffer_store_dwordx2 v[252:253], v56, s[12:15], s40 offen offset:1408 sc0 sc1
    v_accvgpr_read_b32 v225, a108
    v_accvgpr_read_b32 v226, a120
    v_accvgpr_read_b32 v227, a132
    v_mfma_f32_16x16x32_bf16 a[124:127], v[80:83], v[40:43], a[124:127]
    ds_read_b128 v[32:35], v1 offset:1024
    v_mul_f32 v224, v224, v128
    v_mfma_f32_16x16x32_bf16 a[124:127], v[88:91], v[44:47], a[124:127]
    v_mul_f32 v225, v225, v128
    v_mul_f32 v226, v226, v128
    v_mul_f32 v227, v227, v128
    v_cvt_pk_bf16_f32 v224, v224, v225
    v_cvt_pk_bf16_f32 v225, v226, v227
    v_accvgpr_read_b32 v228, a97
    v_mfma_f32_16x16x32_bf16 a[172:175], v[84:87], v[40:43], a[172:175]
    ds_read_b128 v[36:39], v1 offset:13312
    v_accvgpr_read_b32 v229, a109
    v_mfma_f32_16x16x32_bf16 a[172:175], v[92:95], v[44:47], a[172:175]
    s_waitcnt lgkmcnt(2)
    buffer_store_dwordx2 v[224:225], v56, s[12:15], s41 offen offset:0 sc0 sc1
    v_accvgpr_read_b32 v230, a121
    v_accvgpr_read_b32 v231, a133
    v_mul_f32 v228, v228, v129
    v_mfma_f32_16x16x32_bf16 a[136:139], v[80:83], v[24:27], a[136:139]
    ds_read_b128 v[40:43], v1 offset:4096
    v_mul_f32 v229, v229, v129
    v_mfma_f32_16x16x32_bf16 a[136:139], v[88:91], v[28:31], a[136:139]
    v_mul_f32 v230, v230, v129
    v_mul_f32 v231, v231, v129
    v_cvt_pk_bf16_f32 v228, v228, v229
    v_cvt_pk_bf16_f32 v229, v230, v231
    v_accvgpr_read_b32 v232, a98
    v_accvgpr_read_b32 v233, a110
    v_mfma_f32_16x16x32_bf16 a[184:187], v[84:87], v[24:27], a[184:187]
    ds_read_b128 v[44:47], v1 offset:16384
    v_accvgpr_read_b32 v234, a122
    v_mfma_f32_16x16x32_bf16 a[184:187], v[92:95], v[28:31], a[184:187]
    s_waitcnt lgkmcnt(2)
    buffer_store_dwordx2 v[228:229], v56, s[12:15], s41 offen offset:384 sc0 sc1
    v_accvgpr_read_b32 v235, a134
    v_mul_f32 v232, v232, v130
    v_mul_f32 v233, v233, v130
    v_mfma_f32_16x16x32_bf16 a[100:103], v[160:163], v[32:35], a[100:103]
    ds_read_b128 v[24:27], v1 offset:7168
    v_mul_f32 v234, v234, v130
    v_mfma_f32_16x16x32_bf16 a[100:103], v[168:171], v[36:39], a[100:103]
    v_mul_f32 v235, v235, v130
    v_cvt_pk_bf16_f32 v232, v232, v233
    v_cvt_pk_bf16_f32 v233, v234, v235
    v_accvgpr_read_b32 v236, a99
    v_accvgpr_read_b32 v237, a111
    v_accvgpr_read_b32 v238, a123
    v_mfma_f32_16x16x32_bf16 a[148:151], v[164:167], v[32:35], a[148:151]
    ds_read_b128 v[28:31], v1 offset:19456
    v_accvgpr_read_b32 v239, a135
    v_mfma_f32_16x16x32_bf16 a[148:151], v[172:175], v[36:39], a[148:151]
    s_waitcnt lgkmcnt(2)
    buffer_store_dwordx2 v[232:233], v56, s[12:15], s41 offen offset:768 sc0 sc1
    v_mul_f32 v236, v236, v131
    v_mul_f32 v237, v237, v131
    v_mul_f32 v238, v238, v131
    v_mfma_f32_16x16x32_bf16 a[112:115], v[160:163], v[40:43], a[112:115]
    ds_read_b128 v[32:35], v1 offset:10240
    v_mul_f32 v239, v239, v131
    v_mfma_f32_16x16x32_bf16 a[112:115], v[168:171], v[44:47], a[112:115]
    v_cvt_pk_bf16_f32 v236, v236, v237
    v_cvt_pk_bf16_f32 v237, v238, v239
    v_accvgpr_read_b32 v240, a144
    v_accvgpr_read_b32 v241, a156
    v_accvgpr_read_b32 v242, a168
    v_accvgpr_read_b32 v243, a180
    v_mfma_f32_16x16x32_bf16 a[160:163], v[164:167], v[40:43], a[160:163]
    ds_read_b128 v[36:39], v1 offset:22528
    v_mul_f32 v240, v240, v132
    v_mfma_f32_16x16x32_bf16 a[160:163], v[172:175], v[44:47], a[160:163]
    s_waitcnt lgkmcnt(2)
    buffer_store_dwordx2 v[236:237], v56, s[12:15], s41 offen offset:1152 sc0 sc1
    v_mul_f32 v241, v241, v132
    v_mul_f32 v242, v242, v132
    v_mul_f32 v243, v243, v132
    v_mfma_f32_16x16x32_bf16 a[124:127], v[160:163], v[24:27], a[124:127]
    ds_read_b128 v[40:43], v23 offset:1024
    v_cvt_pk_bf16_f32 v240, v240, v241
    v_mfma_f32_16x16x32_bf16 a[124:127], v[168:171], v[28:31], a[124:127]
    v_cvt_pk_bf16_f32 v241, v242, v243
    v_accvgpr_read_b32 v244, a145
    v_accvgpr_read_b32 v245, a157
    v_accvgpr_read_b32 v246, a169
    v_accvgpr_read_b32 v247, a181
    v_mfma_f32_16x16x32_bf16 a[172:175], v[164:167], v[24:27], a[172:175]
    ds_read_b128 v[44:47], v23 offset:13312
    v_mul_f32 v244, v244, v133
    v_mfma_f32_16x16x32_bf16 a[172:175], v[172:175], v[28:31], a[172:175]
    s_waitcnt lgkmcnt(2)
    buffer_store_dwordx2 v[240:241], v56, s[12:15], s42 offen offset:0 sc0 sc1
    v_mul_f32 v245, v245, v133
    v_mul_f32 v246, v246, v133
    v_mul_f32 v247, v247, v133
    v_mfma_f32_16x16x32_bf16 a[136:139], v[160:163], v[32:35], a[136:139]
    ds_read_b128 v[24:27], v23 offset:4096
    v_cvt_pk_bf16_f32 v244, v244, v245
    v_mfma_f32_16x16x32_bf16 a[136:139], v[168:171], v[36:39], a[136:139]
    v_cvt_pk_bf16_f32 v245, v246, v247
    v_accvgpr_read_b32 v248, a146
    v_accvgpr_read_b32 v249, a158
    v_accvgpr_read_b32 v250, a170
    v_accvgpr_read_b32 v251, a182
    v_mul_f32 v248, v248, v134
    v_mfma_f32_16x16x32_bf16 a[184:187], v[164:167], v[32:35], a[184:187]
    ds_read_b128 v[28:31], v23 offset:16384
    v_mul_f32 v249, v249, v134
    v_mfma_f32_16x16x32_bf16 a[184:187], v[172:175], v[36:39], a[184:187]
    s_waitcnt lgkmcnt(2)
    buffer_store_dwordx2 v[244:245], v56, s[12:15], s42 offen offset:384 sc0 sc1
    v_mul_f32 v250, v250, v134
    v_mul_f32 v251, v251, v134
    v_cvt_pk_bf16_f32 v248, v248, v249
    v_mfma_f32_16x16x32_bf16 a[100:103], v[176:179], v[40:43], a[100:103]
    ds_read_b128 v[32:35], v23 offset:7168
    v_cvt_pk_bf16_f32 v249, v250, v251
    v_mfma_f32_16x16x32_bf16 a[100:103], v[184:187], v[44:47], a[100:103]
    buffer_store_dwordx2 v[248:249], v56, s[12:15], s42 offen offset:768 sc0 sc1
    v_accvgpr_read_b32 v252, a147
    v_accvgpr_read_b32 v253, a159
    v_accvgpr_read_b32 v254, a171
    v_mfma_f32_16x16x32_bf16 a[148:151], v[180:183], v[40:43], a[148:151]
    ds_read_b128 v[36:39], v23 offset:19456
    v_accvgpr_read_b32 v255, a183
    v_mfma_f32_16x16x32_bf16 a[148:151], v[188:191], v[44:47], a[148:151]
    s_waitcnt lgkmcnt(2)
    v_mul_f32 v252, v252, v135
    v_mul_f32 v253, v253, v135
    v_mul_f32 v254, v254, v135
    v_mul_f32 v255, v255, v135
    v_cvt_pk_bf16_f32 v252, v252, v253
    v_cvt_pk_bf16_f32 v253, v254, v255
    v_mfma_f32_16x16x32_bf16 a[112:115], v[176:179], v[24:27], a[112:115]
    ds_read_b128 v[40:43], v23 offset:10240
    v_mfma_f32_16x16x32_bf16 a[112:115], v[184:187], v[28:31], a[112:115]
    buffer_store_dwordx2 v[252:253], v56, s[12:15], s42 offen offset:1152 sc0 sc1
    v_mfma_f32_16x16x32_bf16 a[160:163], v[180:183], v[24:27], a[160:163]
    ds_read_b128 v[44:47], v23 offset:22528
    v_mfma_f32_16x16x32_bf16 a[160:163], v[188:191], v[28:31], a[160:163]
    s_waitcnt lgkmcnt(2)
    v_mfma_f32_16x16x32_bf16 a[124:127], v[176:179], v[32:35], a[124:127]
    ds_read_b128 v[24:27], v22 offset:2048
    v_mfma_f32_16x16x32_bf16 a[124:127], v[184:187], v[36:39], a[124:127]
    v_mfma_f32_16x16x32_bf16 a[172:175], v[180:183], v[32:35], a[172:175]
    ds_read_b128 v[28:31], v22 offset:14336
    v_mfma_f32_16x16x32_bf16 a[172:175], v[188:191], v[36:39], a[172:175]
    s_waitcnt lgkmcnt(2)
    v_mfma_f32_16x16x32_bf16 a[136:139], v[176:179], v[40:43], a[136:139]
    ds_read_b128 v[32:35], v22 offset:5120
    v_mfma_f32_16x16x32_bf16 a[136:139], v[184:187], v[44:47], a[136:139]
    v_mfma_f32_16x16x32_bf16 a[184:187], v[180:183], v[40:43], a[184:187]
    ds_read_b128 v[36:39], v22 offset:17408
    v_mfma_f32_16x16x32_bf16 a[184:187], v[188:191], v[44:47], a[184:187]
    s_waitcnt lgkmcnt(2)
    v_mfma_f32_16x16x32_bf16 a[104:107], v[80:83], v[24:27], a[104:107]
    ds_read_b128 v[40:43], v22 offset:8192
    v_mfma_f32_16x16x32_bf16 a[104:107], v[88:91], v[28:31], a[104:107]
    v_mfma_f32_16x16x32_bf16 a[152:155], v[84:87], v[24:27], a[152:155]
    ds_read_b128 v[44:47], v22 offset:20480
    v_mfma_f32_16x16x32_bf16 a[152:155], v[92:95], v[28:31], a[152:155]
    s_waitcnt lgkmcnt(2)
    v_mfma_f32_16x16x32_bf16 a[116:119], v[80:83], v[32:35], a[116:119]
    ds_read_b128 v[24:27], v22 offset:11264
    v_accvgpr_read_b32 v224, a100
    v_mfma_f32_16x16x32_bf16 a[116:119], v[88:91], v[36:39], a[116:119]
    v_accvgpr_read_b32 v225, a112
    v_accvgpr_read_b32 v226, a124
    v_accvgpr_read_b32 v227, a136
    v_mul_f32 v224, v224, v128
    v_mul_f32 v225, v225, v128
    v_mul_f32 v226, v226, v128
    v_mul_f32 v227, v227, v128
    v_cvt_pk_bf16_f32 v224, v224, v225
    v_cvt_pk_bf16_f32 v225, v226, v227
    v_accvgpr_read_b32 v228, a101
    v_accvgpr_read_b32 v229, a113
    v_accvgpr_read_b32 v230, a125
    v_accvgpr_read_b32 v231, a137
    v_mul_f32 v228, v228, v129
    v_mul_f32 v229, v229, v129
    v_mul_f32 v230, v230, v129
    v_mul_f32 v231, v231, v129
    v_cvt_pk_bf16_f32 v228, v228, v229
    v_cvt_pk_bf16_f32 v229, v230, v231
    v_accvgpr_read_b32 v232, a102
    v_accvgpr_read_b32 v233, a114
    v_accvgpr_read_b32 v234, a126
    v_accvgpr_read_b32 v235, a138
    v_mul_f32 v232, v232, v130
    v_mul_f32 v233, v233, v130
    v_mul_f32 v234, v234, v130
    v_mul_f32 v235, v235, v130
    v_cvt_pk_bf16_f32 v232, v232, v233
    v_cvt_pk_bf16_f32 v233, v234, v235
    v_accvgpr_read_b32 v236, a103
    v_accvgpr_read_b32 v237, a115
    v_accvgpr_read_b32 v238, a127
    v_accvgpr_read_b32 v239, a139
    v_mul_f32 v236, v236, v131
    v_mul_f32 v237, v237, v131
    v_mul_f32 v238, v238, v131
    v_mfma_f32_16x16x32_bf16 a[164:167], v[84:87], v[32:35], a[164:167]
    ds_read_b128 v[28:31], v22 offset:23552
    v_mul_f32 v239, v239, v131
    v_mfma_f32_16x16x32_bf16 a[164:167], v[92:95], v[36:39], a[164:167]
    s_waitcnt lgkmcnt(2)
    buffer_store_dwordx2 v[224:225], v56, s[12:15], s41 offen offset:128 sc0 sc1
    v_cvt_pk_bf16_f32 v236, v236, v237
    v_cvt_pk_bf16_f32 v237, v238, v239
    v_accvgpr_read_b32 v240, a148
    v_mfma_f32_16x16x32_bf16 a[128:131], v[80:83], v[40:43], a[128:131]
    ds_read_b128 v[32:35], v1 offset:2048
    v_accvgpr_read_b32 v241, a160
    v_mfma_f32_16x16x32_bf16 a[128:131], v[88:91], v[44:47], a[128:131]
    buffer_store_dwordx2 v[228:229], v56, s[12:15], s41 offen offset:512 sc0 sc1
    v_accvgpr_read_b32 v242, a172
    v_accvgpr_read_b32 v243, a184
    v_mul_f32 v240, v240, v132
    v_mfma_f32_16x16x32_bf16 a[176:179], v[84:87], v[40:43], a[176:179]
    ds_read_b128 v[36:39], v1 offset:14336
    v_mul_f32 v241, v241, v132
    v_mfma_f32_16x16x32_bf16 a[176:179], v[92:95], v[44:47], a[176:179]
    s_waitcnt lgkmcnt(2)
    buffer_store_dwordx2 v[232:233], v56, s[12:15], s41 offen offset:896 sc0 sc1
    v_mul_f32 v242, v242, v132
    v_mul_f32 v243, v243, v132
    v_cvt_pk_bf16_f32 v240, v240, v241
    v_mfma_f32_16x16x32_bf16 a[140:143], v[80:83], v[24:27], a[140:143]
    ds_read_b128 v[40:43], v1 offset:5120
    v_cvt_pk_bf16_f32 v241, v242, v243
    v_mfma_f32_16x16x32_bf16 a[140:143], v[88:91], v[28:31], a[140:143]
    buffer_store_dwordx2 v[236:237], v56, s[12:15], s41 offen offset:1280 sc0 sc1
    v_accvgpr_read_b32 v244, a149
    v_accvgpr_read_b32 v245, a161
    v_accvgpr_read_b32 v246, a173
    v_mfma_f32_16x16x32_bf16 a[188:191], v[84:87], v[24:27], a[188:191]
    ds_read_b128 v[44:47], v1 offset:17408
    v_accvgpr_read_b32 v247, a185
    v_mfma_f32_16x16x32_bf16 a[188:191], v[92:95], v[28:31], a[188:191]
    s_waitcnt lgkmcnt(2)
    buffer_store_dwordx2 v[240:241], v56, s[12:15], s42 offen offset:128 sc0 sc1
    v_mul_f32 v244, v244, v133
    v_mul_f32 v245, v245, v133
    v_mul_f32 v246, v246, v133
    v_mfma_f32_16x16x32_bf16 a[104:107], v[160:163], v[32:35], a[104:107]
    ds_read_b128 v[24:27], v1 offset:8192
    v_mul_f32 v247, v247, v133
    v_mfma_f32_16x16x32_bf16 a[104:107], v[168:171], v[36:39], a[104:107]
    v_cvt_pk_bf16_f32 v244, v244, v245
    v_cvt_pk_bf16_f32 v245, v246, v247
    v_accvgpr_read_b32 v248, a150
    v_accvgpr_read_b32 v249, a162
    v_accvgpr_read_b32 v250, a174
    v_accvgpr_read_b32 v251, a186
    v_mfma_f32_16x16x32_bf16 a[152:155], v[164:167], v[32:35], a[152:155]
    ds_read_b128 v[28:31], v1 offset:20480
    v_mul_f32 v248, v248, v134
    v_mfma_f32_16x16x32_bf16 a[152:155], v[172:175], v[36:39], a[152:155]
    s_waitcnt lgkmcnt(2)
    buffer_store_dwordx2 v[244:245], v56, s[12:15], s42 offen offset:512 sc0 sc1
    v_mul_f32 v249, v249, v134
    v_mul_f32 v250, v250, v134
    v_mul_f32 v251, v251, v134
    v_mfma_f32_16x16x32_bf16 a[116:119], v[160:163], v[40:43], a[116:119]
    ds_read_b128 v[32:35], v1 offset:11264
    v_cvt_pk_bf16_f32 v248, v248, v249
    v_mfma_f32_16x16x32_bf16 a[116:119], v[168:171], v[44:47], a[116:119]
    v_cvt_pk_bf16_f32 v249, v250, v251
    v_accvgpr_read_b32 v252, a151
    v_accvgpr_read_b32 v253, a163
    v_accvgpr_read_b32 v254, a175
    v_accvgpr_read_b32 v255, a187
    v_mul_f32 v252, v252, v135
    v_mfma_f32_16x16x32_bf16 a[164:167], v[164:167], v[40:43], a[164:167]
    ds_read_b128 v[36:39], v1 offset:23552
    v_mul_f32 v253, v253, v135
    v_mfma_f32_16x16x32_bf16 a[164:167], v[172:175], v[44:47], a[164:167]
    s_waitcnt lgkmcnt(2)
    buffer_store_dwordx2 v[248:249], v56, s[12:15], s42 offen offset:896 sc0 sc1
    v_mul_f32 v254, v254, v135
    v_mul_f32 v255, v255, v135
    v_cvt_pk_bf16_f32 v252, v252, v253
    v_mfma_f32_16x16x32_bf16 a[128:131], v[160:163], v[24:27], a[128:131]
    ds_read_b128 v[40:43], v23 offset:2048
    v_cvt_pk_bf16_f32 v253, v254, v255
    v_mfma_f32_16x16x32_bf16 a[128:131], v[168:171], v[28:31], a[128:131]
    buffer_store_dwordx2 v[252:253], v56, s[12:15], s42 offen offset:1280 sc0 sc1
    v_mfma_f32_16x16x32_bf16 a[176:179], v[164:167], v[24:27], a[176:179]
    ds_read_b128 v[44:47], v23 offset:14336
    v_mfma_f32_16x16x32_bf16 a[176:179], v[172:175], v[28:31], a[176:179]
    s_waitcnt lgkmcnt(2)
    v_mfma_f32_16x16x32_bf16 a[140:143], v[160:163], v[32:35], a[140:143]
    ds_read_b128 v[24:27], v23 offset:5120
    v_mfma_f32_16x16x32_bf16 a[140:143], v[168:171], v[36:39], a[140:143]
    v_mfma_f32_16x16x32_bf16 a[188:191], v[164:167], v[32:35], a[188:191]
    ds_read_b128 v[28:31], v23 offset:17408
    v_mfma_f32_16x16x32_bf16 a[188:191], v[172:175], v[36:39], a[188:191]
    s_waitcnt lgkmcnt(2)
    v_mfma_f32_16x16x32_bf16 a[104:107], v[176:179], v[40:43], a[104:107]
    ds_read_b128 v[32:35], v23 offset:8192
    v_mfma_f32_16x16x32_bf16 a[104:107], v[184:187], v[44:47], a[104:107]
    v_mfma_f32_16x16x32_bf16 a[152:155], v[180:183], v[40:43], a[152:155]
    ds_read_b128 v[36:39], v23 offset:20480
    v_mfma_f32_16x16x32_bf16 a[152:155], v[188:191], v[44:47], a[152:155]
    s_waitcnt lgkmcnt(2)
    v_mfma_f32_16x16x32_bf16 a[116:119], v[176:179], v[24:27], a[116:119]
    ds_read_b128 v[40:43], v23 offset:11264
    v_mfma_f32_16x16x32_bf16 a[116:119], v[184:187], v[28:31], a[116:119]
    v_mfma_f32_16x16x32_bf16 a[164:167], v[180:183], v[24:27], a[164:167]
    ds_read_b128 v[44:47], v23 offset:23552
    v_mfma_f32_16x16x32_bf16 a[164:167], v[188:191], v[28:31], a[164:167]
    s_waitcnt lgkmcnt(2)
    v_mfma_f32_16x16x32_bf16 a[128:131], v[176:179], v[32:35], a[128:131]
    v_mfma_f32_16x16x32_bf16 a[128:131], v[184:187], v[36:39], a[128:131]
    v_mfma_f32_16x16x32_bf16 a[176:179], v[180:183], v[32:35], a[176:179]
    v_mfma_f32_16x16x32_bf16 a[176:179], v[188:191], v[36:39], a[176:179]
    s_waitcnt lgkmcnt(0)
    v_mfma_f32_16x16x32_bf16 a[140:143], v[176:179], v[40:43], a[140:143]
    v_mfma_f32_16x16x32_bf16 a[140:143], v[184:187], v[44:47], a[140:143]
    v_mfma_f32_16x16x32_bf16 a[188:191], v[180:183], v[40:43], a[188:191]
    v_mfma_f32_16x16x32_bf16 a[188:191], v[188:191], v[44:47], a[188:191]
    s_nop 7
    v_accvgpr_read_b32 v224, a104
    v_accvgpr_read_b32 v225, a116
    v_accvgpr_read_b32 v226, a128
    v_accvgpr_read_b32 v227, a140
    v_pk_mul_f32 v[224:225], v[224:225], v[128:129] op_sel_hi:[1,0]
    v_pk_mul_f32 v[226:227], v[226:227], v[128:129] op_sel_hi:[1,0]
    v_cvt_pk_bf16_f32 v224, v224, v225
    v_cvt_pk_bf16_f32 v225, v226, v227
    v_accvgpr_read_b32 v228, a105
    v_accvgpr_read_b32 v229, a117
    v_accvgpr_read_b32 v230, a129
    v_accvgpr_read_b32 v231, a141
    v_pk_mul_f32 v[228:229], v[228:229], v[128:129] op_sel:[0,1] op_sel_hi:[1,1]
    v_pk_mul_f32 v[230:231], v[230:231], v[128:129] op_sel:[0,1] op_sel_hi:[1,1]
    v_cvt_pk_bf16_f32 v228, v228, v229
    v_cvt_pk_bf16_f32 v229, v230, v231
    buffer_store_dwordx2 v[224:225], v56, s[12:15], s41 offen offset:256 sc0 sc1
    v_accvgpr_read_b32 v232, a106
    v_accvgpr_read_b32 v233, a118
    v_accvgpr_read_b32 v234, a130
    v_accvgpr_read_b32 v235, a142
    v_pk_mul_f32 v[232:233], v[232:233], v[130:131] op_sel_hi:[1,0]
    v_pk_mul_f32 v[234:235], v[234:235], v[130:131] op_sel_hi:[1,0]
    v_cvt_pk_bf16_f32 v232, v232, v233
    v_cvt_pk_bf16_f32 v233, v234, v235
    buffer_store_dwordx2 v[228:229], v56, s[12:15], s41 offen offset:640 sc0 sc1
    v_accvgpr_read_b32 v236, a107
    v_accvgpr_read_b32 v237, a119
    v_accvgpr_read_b32 v238, a131
    v_accvgpr_read_b32 v239, a143
    v_pk_mul_f32 v[236:237], v[236:237], v[130:131] op_sel:[0,1] op_sel_hi:[1,1]
    v_pk_mul_f32 v[238:239], v[238:239], v[130:131] op_sel:[0,1] op_sel_hi:[1,1]
    v_cvt_pk_bf16_f32 v236, v236, v237
    v_cvt_pk_bf16_f32 v237, v238, v239
    buffer_store_dwordx2 v[232:233], v56, s[12:15], s41 offen offset:1024 sc0 sc1
    buffer_store_dwordx2 v[236:237], v56, s[12:15], s41 offen offset:1408 sc0 sc1
    v_accvgpr_read_b32 v240, a152
    v_accvgpr_read_b32 v241, a164
    v_accvgpr_read_b32 v242, a176
    v_accvgpr_read_b32 v243, a188
    v_pk_mul_f32 v[240:241], v[240:241], v[132:133] op_sel_hi:[1,0]
    v_pk_mul_f32 v[242:243], v[242:243], v[132:133] op_sel_hi:[1,0]
    v_cvt_pk_bf16_f32 v240, v240, v241
    v_cvt_pk_bf16_f32 v241, v242, v243
    v_accvgpr_read_b32 v244, a153
    v_accvgpr_read_b32 v245, a165
    v_accvgpr_read_b32 v246, a177
    v_accvgpr_read_b32 v247, a189
    v_pk_mul_f32 v[244:245], v[244:245], v[132:133] op_sel:[0,1] op_sel_hi:[1,1]
    v_pk_mul_f32 v[246:247], v[246:247], v[132:133] op_sel:[0,1] op_sel_hi:[1,1]
    v_cvt_pk_bf16_f32 v244, v244, v245
    v_cvt_pk_bf16_f32 v245, v246, v247
    buffer_store_dwordx2 v[240:241], v56, s[12:15], s42 offen offset:256 sc0 sc1
    v_accvgpr_read_b32 v248, a154
    v_accvgpr_read_b32 v249, a166
    v_accvgpr_read_b32 v250, a178
    v_accvgpr_read_b32 v251, a190
    v_pk_mul_f32 v[248:249], v[248:249], v[134:135] op_sel_hi:[1,0]
    v_pk_mul_f32 v[250:251], v[250:251], v[134:135] op_sel_hi:[1,0]
    v_cvt_pk_bf16_f32 v248, v248, v249
    v_cvt_pk_bf16_f32 v249, v250, v251
    buffer_store_dwordx2 v[244:245], v56, s[12:15], s42 offen offset:640 sc0 sc1
    v_accvgpr_read_b32 v252, a155
    v_accvgpr_read_b32 v253, a167
    v_accvgpr_read_b32 v254, a179
    v_accvgpr_read_b32 v255, a191
    v_pk_mul_f32 v[252:253], v[252:253], v[134:135] op_sel:[0,1] op_sel_hi:[1,1]
    v_pk_mul_f32 v[254:255], v[254:255], v[134:135] op_sel:[0,1] op_sel_hi:[1,1]
    v_cvt_pk_bf16_f32 v252, v252, v253
    v_cvt_pk_bf16_f32 v253, v254, v255
    buffer_store_dwordx2 v[248:249], v56, s[12:15], s42 offen offset:1024 sc0 sc1
    buffer_store_dwordx2 v[252:253], v56, s[12:15], s42 offen offset:1408 sc0 sc1
L_fin:
L_done:
    s_endpgm
L_pollslow0:
    s_mov_b32 s59, 60
L_pollsm0:
    s_buffer_load_dwordx8 s[48:55], s[20:23], s44 glc
    s_waitcnt lgkmcnt(0)
    s_sub_u32 s48, s48, s92
    s_sub_u32 s49, s49, s92
    s_sub_u32 s50, s50, s92
    s_sub_u32 s51, s51, s92
    s_sub_u32 s52, s52, s92
    s_sub_u32 s53, s53, s92
    s_sub_u32 s54, s54, s92
    s_sub_u32 s55, s55, s92
    s_max_u32 s48, s48, s49
    s_max_u32 s48, s48, s50
    s_max_u32 s48, s48, s51
    s_max_u32 s48, s48, s52
    s_max_u32 s48, s48, s53
    s_max_u32 s48, s48, s54
    s_max_u32 s48, s48, s55
    s_cmp_lt_u32 s48, 16
    s_cbranch_scc1 L_pollok0
    s_sub_u32 s59, s59, 1
    s_cbranch_scc1 L_pollvec0
    s_sleep 1
    s_branch L_pollsm0
L_pollvec0:
    v_bfe_u32 v53, v4, 4, 6
    v_lshlrev_b32 v53, 2, v53
    s_sub_u32 s96, s96, 1
    s_cbranch_scc1 L_pollgiveup0
    s_sleep 2
    buffer_load_dword v52, v53, s[20:23], s44 offen sc1
    s_waitcnt vmcnt(0)
    s_bitcmp1_b32 s92, 9
    s_cbranch_scc1 L_nomix
    v_xor_b32 v53, s92, v52
    v_lshrrev_b32 v53, 5, v53
    v_add_u32 v53, -1, v53
    v_cmp_gt_u32 vcc, 31, v53
    s_nop 1
    s_and_b32 s59, vcc_lo, 0xff
    s_cbranch_scc0 L_nomix
    buffer_store_dwordx4 v[224:227], v11, s[4:7], s33 offen offset:0 sc1
    v_xor_b32 v55, 16, v11
    buffer_store_dwordx4 v[228:231], v55, s[4:7], s33 offen offset:768 sc1
    v_xor_b32 v54, 32, v11
    buffer_store_dwordx4 v[232:235], v54, s[4:7], s33 offen offset:1536 sc1
    v_xor_b32 v55, 48, v11
    buffer_store_dwordx4 v[236:239], v55, s[4:7], s33 offen offset:2304 sc1
    buffer_store_dwordx4 v[112:115], v15, s[4:7], s35 offen offset:0 sc1
    buffer_store_dwordx4 v[116:119], v15, s[4:7], s35 offen offset:3072 sc1
    buffer_store_dwordx4 v[120:123], v15, s[4:7], s17 offen offset:0 sc1
    buffer_store_dwordx4 v[124:127], v15, s[4:7], s17 offen offset:3072 sc1
    s_waitcnt vmcnt(0)
    s_barrier
    s_and_b32 s92, s92, 0xfffffc00
    s_add_u32 s92, s92, 512
    v_mov_b32 v0, s92
    s_add_u32 s92, s92, 1
    s_mov_b32 s44, 32
    v_add_u32 v0, 1, v0
    buffer_store_dword v0, v13, s[20:23], 0 offen offset:32 sc1
    s_branch L_pollvec0
L_nomix:
    v_subrev_u32 v52, s92, v52
    v_cmp_lt_u32 vcc, 15, v52
    s_nop 0
    s_and_b32 s59, vcc_lo, 0xff
    s_cbranch_scc1 L_pollvec0
    s_branch L_pollok0
L_pollgiveup0:
    s_mov_b32 s96, 0
    s_branch L_pollok0
L_pollslow1:
    s_mov_b32 s59, 200
L_pollsm1:
    s_buffer_load_dwordx8 s[48:55], s[20:23], s44 glc
    s_waitcnt lgkmcnt(0)
    s_sub_u32 s48, s48, s92
    s_sub_u32 s49, s49, s92
    s_sub_u32 s50, s50, s92
    s_sub_u32 s51, s51, s92
    s_sub_u32 s52, s52, s92
    s_sub_u32 s53, s53, s92
    s_sub_u32 s54, s54, s92
    s_sub_u32 s55, s55, s92
    s_max_u32 s48, s48, s49
    s_max_u32 s48, s48, s50
    s_max_u32 s48, s48, s51
    s_max_u32 s48, s48, s52
    s_max_u32 s48, s48, s53
    s_max_u32 s48, s48, s54
    s_max_u32 s48, s48, s55
    s_cmp_lt_u32 s48, 16
    s_cbranch_scc1 L_pollok1
    s_sub_u32 s59, s59, 1
    s_cbranch_scc1 L_pollvec1
    s_sleep 1
    s_branch L_pollsm1
L_pollvec1:
    v_bfe_u32 v53, v4, 4, 6
    v_lshlrev_b32 v53, 2, v53
    s_sub_u32 s96, s96, 1
    s_cbranch_scc1 L_pollgiveup1
    s_sleep 2
    buffer_load_dword v52, v53, s[20:23], s44 offen sc1
    s_waitcnt vmcnt(0)
    v_subrev_u32 v52, s92, v52
    v_cmp_lt_u32 vcc, 15, v52
    s_nop 0
    s_and_b32 s59, vcc_lo, 0xff
    s_cbranch_scc1 L_pollvec1
    s_branch L_pollok1
L_pollgiveup1:
    s_mov_b32 s96, 0
    s_branch L_pollok1
L_pollslow2:
    s_mov_b32 s59, 200
L_pollsm2:
    s_buffer_load_dwordx8 s[48:55], s[20:23], s44 glc
    s_waitcnt lgkmcnt(0)
    s_sub_u32 s48, s48, s92
    s_sub_u32 s49, s49, s92
    s_sub_u32 s50, s50, s92
    s_sub_u32 s51, s51, s92
    s_sub_u32 s52, s52, s92
    s_sub_u32 s53, s53, s92
    s_sub_u32 s54, s54, s92
    s_sub_u32 s55, s55, s92
    s_max_u32 s48, s48, s49
    s_max_u32 s48, s48, s50
    s_max_u32 s48, s48, s51
    s_max_u32 s48, s48, s52
    s_max_u32 s48, s48, s53
    s_max_u32 s48, s48, s54
    s_max_u32 s48, s48, s55
    s_cmp_lt_u32 s48, 16
    s_cbranch_scc1 L_pollok2
    s_sub_u32 s59, s59, 1
    s_cbranch_scc1 L_pollvec2
    s_sleep 1
    s_branch L_pollsm2
L_pollvec2:
    v_bfe_u32 v53, v4, 4, 6
    v_lshlrev_b32 v53, 2, v53
    s_sub_u32 s96, s96, 1
    s_cbranch_scc1 L_pollgiveup2
    s_sleep 2
    buffer_load_dword v52, v53, s[20:23], s44 offen sc1
    s_waitcnt vmcnt(0)
    v_subrev_u32 v52, s92, v52
    v_cmp_lt_u32 vcc, 15, v52
    s_nop 0
    s_and_b32 s59, vcc_lo, 0xff
    s_cbranch_scc1 L_pollvec2
    s_branch L_pollok2
L_pollgiveup2:
    s_mov_b32 s96, 0
    s_branch L_pollok2
L_tagslow:
    s_sub_u32 s96, s96, 1
    s_cbranch_scc1 L_taggiveup
    s_sleep 2
    buffer_load_dword v0, off, s[88:91], s93 sc1
    s_waitcnt vmcnt(0)
    v_readfirstlane_b32 s42, v0
    s_nop 0
    s_cmp_eq_u32 s42, s46
    s_cbranch_scc1 L_tagslow
    s_cmp_eq_u32 s42, 0
    s_cbranch_scc1 L_tagslow
    s_branch L_tagok
L_taggiveup:
    s_mov_b32 s96, 0
    s_branch L_tagok
L_slow:
    s_waitcnt vmcnt(0) lgkmcnt(0)
    s_nop 15
    v_accvgpr_write_b32 a0, 0
    v_accvgpr_write_b32 a1, 0
    v_accvgpr_write_b32 a2, 0
    v_accvgpr_write_b32 a3, 0
    v_accvgpr_write_b32 a4, 0
    v_accvgpr_write_b32 a5, 0
    v_accvgpr_write_b32 a6, 0
    v_accvgpr_write_b32 a7, 0
    v_accvgpr_write_b32 a8, 0
    v_accvgpr_write_b32 a9, 0
    v_accvgpr_write_b32 a10, 0
    v_accvgpr_write_b32 a11, 0
    v_accvgpr_write_b32 a12, 0
    v_accvgpr_write_b32 a13, 0
    v_accvgpr_write_b32 a14, 0
    v_accvgpr_write_b32 a15, 0
    v_accvgpr_write_b32 a16, 0
    v_accvgpr_write_b32 a17, 0
    v_accvgpr_write_b32 a18, 0
    v_accvgpr_write_b32 a19, 0
    v_accvgpr_write_b32 a20, 0
    v_accvgpr_write_b32 a21, 0
    v_accvgpr_write_b32 a22, 0
    v_accvgpr_write_b32 a23, 0
    v_accvgpr_write_b32 a24, 0
    v_accvgpr_write_b32 a25, 0
    v_accvgpr_write_b32 a26, 0
    v_accvgpr_write_b32 a27, 0
    v_accvgpr_write_b32 a28, 0
    v_accvgpr_write_b32 a29, 0
    v_accvgpr_write_b32 a30, 0
    v_accvgpr_write_b32 a31, 0
    v_accvgpr_write_b32 a32, 0
    v_accvgpr_write_b32 a33, 0
    v_accvgpr_write_b32 a34, 0
    v_accvgpr_write_b32 a35, 0
    v_accvgpr_write_b32 a36, 0
    v_accvgpr_write_b32 a37, 0
    v_accvgpr_write_b32 a38, 0
    v_accvgpr_write_b32 a39, 0
    v_accvgpr_write_b32 a40, 0
    v_accvgpr_write_b32 a41, 0
    v_accvgpr_write_b32 a42, 0
    v_accvgpr_write_b32 a43, 0
    v_accvgpr_write_b32 a44, 0
    v_accvgpr_write_b32 a45, 0
    v_accvgpr_write_b32 a46, 0
    v_accvgpr_write_b32 a47, 0
    v_accvgpr_write_b32 a48, 0
    v_accvgpr_write_b32 a49, 0
    v_accvgpr_write_b32 a50, 0
    v_accvgpr_write_b32 a51, 0
    v_accvgpr_write_b32 a52, 0
    v_accvgpr_write_b32 a53, 0
    v_accvgpr_write_b32 a54, 0
    v_accvgpr_write_b32 a55, 0
    v_accvgpr_write_b32 a56, 0
    v_accvgpr_write_b32 a57, 0
    v_accvgpr_write_b32 a58, 0
    v_accvgpr_write_b32 a59, 0
    v_accvgpr_write_b32 a60, 0
    v_accvgpr_write_b32 a61, 0
    v_accvgpr_write_b32 a62, 0
    v_accvgpr_write_b32 a63, 0
    v_accvgpr_write_b32 a64, 0
    v_accvgpr_write_b32 a65, 0
    v_accvgpr_write_b32 a66, 0
    v_accvgpr_write_b32 a67, 0
    v_accvgpr_write_b32 a68, 0
    v_accvgpr_write_b32 a69, 0
    v_accvgpr_write_b32 a70, 0
    v_accvgpr_write_b32 a71, 0
    v_accvgpr_write_b32 a72, 0
    v_accvgpr_write_b32 a73, 0
    v_accvgpr_write_b32 a74, 0
    v_accvgpr_write_b32 a75, 0
    v_accvgpr_write_b32 a76, 0
    v_accvgpr_write_b32 a77, 0
    v_accvgpr_write_b32 a78, 0
    v_accvgpr_write_b32 a79, 0
    v_accvgpr_write_b32 a80, 0
    v_accvgpr_write_b32 a81, 0
    v_accvgpr_write_b32 a82, 0
    v_accvgpr_write_b32 a83, 0
    v_accvgpr_write_b32 a84, 0
    v_accvgpr_write_b32 a85, 0
    v_accvgpr_write_b32 a86, 0
    v_accvgpr_write_b32 a87, 0
    v_accvgpr_write_b32 a88, 0
    v_accvgpr_write_b32 a89, 0
    v_accvgpr_write_b32 a90, 0
    v_accvgpr_write_b32 a91, 0
    v_accvgpr_write_b32 a92, 0
    v_accvgpr_write_b32 a93, 0
    v_accvgpr_write_b32 a94, 0
    v_accvgpr_write_b32 a95, 0
    v_accvgpr_write_b32 a96, 0
    v_accvgpr_write_b32 a97, 0
    v_accvgpr_write_b32 a98, 0
    v_accvgpr_write_b32 a99, 0
    v_accvgpr_write_b32 a100, 0
    v_accvgpr_write_b32 a101, 0
    v_accvgpr_write_b32 a102, 0
    v_accvgpr_write_b32 a103, 0
    v_accvgpr_write_b32 a104, 0
    v_accvgpr_write_b32 a105, 0
    v_accvgpr_write_b32 a106, 0
    v_accvgpr_write_b32 a107, 0
    v_accvgpr_write_b32 a108, 0
    v_accvgpr_write_b32 a109, 0
    v_accvgpr_write_b32 a110, 0
    v_accvgpr_write_b32 a111, 0
    v_accvgpr_write_b32 a112, 0
    v_accvgpr_write_b32 a113, 0
    v_accvgpr_write_b32 a114, 0
    v_accvgpr_write_b32 a115, 0
    v_accvgpr_write_b32 a116, 0
    v_accvgpr_write_b32 a117, 0
    v_accvgpr_write_b32 a118, 0
    v_accvgpr_write_b32 a119, 0
    v_accvgpr_write_b32 a120, 0
    v_accvgpr_write_b32 a121, 0
    v_accvgpr_write_b32 a122, 0
    v_accvgpr_write_b32 a123, 0
    v_accvgpr_write_b32 a124, 0
    v_accvgpr_write_b32 a125, 0
    v_accvgpr_write_b32 a126, 0
    v_accvgpr_write_b32 a127, 0
    v_accvgpr_write_b32 a128, 0
    v_accvgpr_write_b32 a129, 0
    v_accvgpr_write_b32 a130, 0
    v_accvgpr_write_b32 a131, 0
    v_accvgpr_write_b32 a132, 0
    v_accvgpr_write_b32 a133, 0
    v_accvgpr_write_b32 a134, 0
    v_accvgpr_write_b32 a135, 0
    v_accvgpr_write_b32 a136, 0
    v_accvgpr_write_b32 a137, 0
    v_accvgpr_write_b32 a138, 0
    v_accvgpr_write_b32 a139, 0
    v_accvgpr_write_b32 a140, 0
    v_accvgpr_write_b32 a141, 0
    v_accvgpr_write_b32 a142, 0
    v_accvgpr_write_b32 a143, 0
    v_accvgpr_write_b32 a144, 0
    v_accvgpr_write_b32 a145, 0
    v_accvgpr_write_b32 a146, 0
    v_accvgpr_write_b32 a147, 0
    v_accvgpr_write_b32 a148, 0
    v_accvgpr_write_b32 a149, 0
    v_accvgpr_write_b32 a150, 0
    v_accvgpr_write_b32 a151, 0
    v_accvgpr_write_b32 a152, 0
    v_accvgpr_write_b32 a153, 0
    v_accvgpr_write_b32 a154, 0
    v_accvgpr_write_b32 a155, 0
    v_accvgpr_write_b32 a156, 0
    v_accvgpr_write_b32 a157, 0
    v_accvgpr_write_b32 a158, 0
    v_accvgpr_write_b32 a159, 0
    v_accvgpr_write_b32 a160, 0
    v_accvgpr_write_b32 a161, 0
    v_accvgpr_write_b32 a162, 0
    v_accvgpr_write_b32 a163, 0
    v_accvgpr_write_b32 a164, 0
    v_accvgpr_write_b32 a165, 0
    v_accvgpr_write_b32 a166, 0
    v_accvgpr_write_b32 a167, 0
    v_accvgpr_write_b32 a168, 0
    v_accvgpr_write_b32 a169, 0
    v_accvgpr_write_b32 a170, 0
    v_accvgpr_write_b32 a171, 0
    v_accvgpr_write_b32 a172, 0
    v_accvgpr_write_b32 a173, 0
    v_accvgpr_write_b32 a174, 0
    v_accvgpr_write_b32 a175, 0
    v_accvgpr_write_b32 a176, 0
    v_accvgpr_write_b32 a177, 0
    v_accvgpr_write_b32 a178, 0
    v_accvgpr_write_b32 a179, 0
    v_accvgpr_write_b32 a180, 0
    v_accvgpr_write_b32 a181, 0
    v_accvgpr_write_b32 a182, 0
    v_accvgpr_write_b32 a183, 0
    v_accvgpr_write_b32 a184, 0
    v_accvgpr_write_b32 a185, 0
    v_accvgpr_write_b32 a186, 0
    v_accvgpr_write_b32 a187, 0
    v_accvgpr_write_b32 a188, 0
    v_accvgpr_write_b32 a189, 0
    v_accvgpr_write_b32 a190, 0
    v_accvgpr_write_b32 a191, 0
    v_mov_b32 v5, 0
    v_mov_b32 v240, 0xff7fffff
    v_mov_b32 v6, 0
    v_mov_b32 v241, 0xff7fffff
    v_mov_b32 v7, 0
    v_mov_b32 v242, 0xff7fffff
    v_mov_b32 v8, 0
    v_mov_b32 v243, 0xff7fffff
    v_subrev_u32 v244, 49152, v2
    v_subrev_u32 v245, 49152, v3
    v_subrev_u32 v246, 24576, v1
    s_mov_b32 s48, 0
L_slowloop:
    s_add_u32 s49, s48, 6144
    s_add_u32 s50, s48, 12288
    s_add_u32 s51, s48, 16384
    s_add_u32 s52, s48, 20480
    buffer_load_dwordx4 v[64:67], v244, s[4:7], s48 offen offset:0 sc1
    buffer_load_dwordx4 v[68:71], v245, s[4:7], s48 offen offset:0 sc1
    buffer_load_dwordx4 v[72:75], v244, s[4:7], s49 offen offset:0 sc1
    buffer_load_dwordx4 v[76:79], v245, s[4:7], s49 offen offset:0 sc1
    buffer_load_dwordx4 v[80:83], v244, s[4:7], s48 offen offset:128 sc1
    buffer_load_dwordx4 v[84:87], v245, s[4:7], s48 offen offset:128 sc1
    buffer_load_dwordx4 v[88:91], v244, s[4:7], s49 offen offset:128 sc1
    buffer_load_dwordx4 v[92:95], v245, s[4:7], s49 offen offset:128 sc1
    buffer_load_dwordx4 v[96:99], v244, s[4:7], s48 offen offset:256 sc1
    buffer_load_dwordx4 v[100:103], v245, s[4:7], s48 offen offset:256 sc1
    buffer_load_dwordx4 v[104:107], v244, s[4:7], s49 offen offset:256 sc1
    buffer_load_dwordx4 v[108:111], v245, s[4:7], s49 offen offset:256 sc1
    buffer_load_dwordx4 v[112:115], v246, s[4:7], s50 offen offset:0 sc1
    buffer_load_dwordx4 v[116:119], v246, s[4:7], s50 offen offset:1024 sc1
    buffer_load_dwordx4 v[120:123], v246, s[4:7], s50 offen offset:2048 sc1
    buffer_load_dwordx4 v[124:127], v246, s[4:7], s50 offen offset:3072 sc1
    buffer_load_dwordx4 v[128:131], v246, s[4:7], s51 offen offset:0 sc1
    buffer_load_dwordx4 v[132:135], v246, s[4:7], s51 offen offset:1024 sc1
    buffer_load_dwordx4 v[136:139], v246, s[4:7], s51 offen offset:2048 sc1
    buffer_load_dwordx4 v[140:143], v246, s[4:7], s51 offen offset:3072 sc1
    buffer_load_dwordx4 v[144:147], v246, s[4:7], s52 offen offset:0 sc1
    buffer_load_dwordx4 v[148:151], v246, s[4:7], s52 offen offset:1024 sc1
    buffer_load_dwordx4 v[152:155], v246, s[4:7], s52 offen offset:2048 sc1
    buffer_load_dwordx4 v[156:159], v246, s[4:7], s52 offen offset:3072 sc1
    s_waitcnt vmcnt(12)
    v_mfma_f32_16x16x32_bf16 v[160:163], v[64:67], a[192:195], 0
    v_mfma_f32_16x16x32_bf16 v[168:171], v[64:67], a[216:219], 0
    v_mfma_f32_16x16x32_bf16 v[176:179], v[64:67], a[240:243], 0
    v_mfma_f32_16x16x32_bf16 v[184:187], v[64:67], v[200:203], 0
    v_mfma_f32_16x16x32_bf16 v[160:163], v[68:71], a[196:199], v[160:163]
    v_mfma_f32_16x16x32_bf16 v[168:171], v[68:71], a[220:223], v[168:171]
    v_mfma_f32_16x16x32_bf16 v[176:179], v[68:71], a[244:247], v[176:179]
    v_mfma_f32_16x16x32_bf16 v[184:187], v[68:71], v[204:207], v[184:187]
    v_mfma_f32_16x16x32_bf16 v[164:167], v[72:75], a[192:195], 0
    v_mfma_f32_16x16x32_bf16 v[172:175], v[72:75], a[216:219], 0
    v_mfma_f32_16x16x32_bf16 v[180:183], v[72:75], a[240:243], 0
    v_mfma_f32_16x16x32_bf16 v[188:191], v[72:75], v[200:203], 0
    v_mfma_f32_16x16x32_bf16 v[164:167], v[76:79], a[196:199], v[164:167]
    v_mfma_f32_16x16x32_bf16 v[172:175], v[76:79], a[220:223], v[172:175]
    v_mfma_f32_16x16x32_bf16 v[180:183], v[76:79], a[244:247], v[180:183]
    v_mfma_f32_16x16x32_bf16 v[188:191], v[76:79], v[204:207], v[188:191]
    v_mfma_f32_16x16x32_bf16 v[160:163], v[80:83], a[200:203], v[160:163]
    v_mfma_f32_16x16x32_bf16 v[168:171], v[80:83], a[224:227], v[168:171]
    v_mfma_f32_16x16x32_bf16 v[176:179], v[80:83], a[248:251], v[176:179]
    v_mfma_f32_16x16x32_bf16 v[184:187], v[80:83], v[208:211], v[184:187]
    v_mfma_f32_16x16x32_bf16 v[160:163], v[84:87], a[204:207], v[160:163]
    v_mfma_f32_16x16x32_bf16 v[168:171], v[84:87], a[228:231], v[168:171]
    v_mfma_f32_16x16x32_bf16 v[176:179], v[84:87], a[252:255], v[176:179]
    v_mfma_f32_16x16x32_bf16 v[184:187], v[84:87], v[212:215], v[184:187]
    v_mfma_f32_16x16x32_bf16 v[164:167], v[88:91], a[200:203], v[164:167]
    v_mfma_f32_16x16x32_bf16 v[172:175], v[88:91], a[224:227], v[172:175]
    v_mfma_f32_16x16x32_bf16 v[180:183], v[88:91], a[248:251], v[180:183]
    v_mfma_f32_16x16x32_bf16 v[188:191], v[88:91], v[208:211], v[188:191]
    v_mfma_f32_16x16x32_bf16 v[164:167], v[92:95], a[204:207], v[164:167]
    v_mfma_f32_16x16x32_bf16 v[172:175], v[92:95], a[228:231], v[172:175]
    v_mfma_f32_16x16x32_bf16 v[180:183], v[92:95], a[252:255], v[180:183]
    v_mfma_f32_16x16x32_bf16 v[188:191], v[92:95], v[212:215], v[188:191]
    v_mfma_f32_16x16x32_bf16 v[160:163], v[96:99], a[208:211], v[160:163]
    v_mfma_f32_16x16x32_bf16 v[168:171], v[96:99], a[232:235], v[168:171]
    v_mfma_f32_16x16x32_bf16 v[176:179], v[96:99], v[192:195], v[176:179]
    v_mfma_f32_16x16x32_bf16 v[184:187], v[96:99], v[216:219], v[184:187]
    v_mfma_f32_16x16x32_bf16 v[160:163], v[100:103], a[212:215], v[160:163]
    v_mfma_f32_16x16x32_bf16 v[168:171], v[100:103], a[236:239], v[168:171]
    v_mfma_f32_16x16x32_bf16 v[176:179], v[100:103], v[196:199], v[176:179]
    v_mfma_f32_16x16x32_bf16 v[184:187], v[100:103], v[220:223], v[184:187]
    v_mfma_f32_16x16x32_bf16 v[164:167], v[104:107], a[208:211], v[164:167]
    v_mfma_f32_16x16x32_bf16 v[172:175], v[104:107], a[232:235], v[172:175]
    v_mfma_f32_16x16x32_bf16 v[180:183], v[104:107], v[192:195], v[180:183]
    v_mfma_f32_16x16x32_bf16 v[188:191], v[104:107], v[216:219], v[188:191]
    v_mfma_f32_16x16x32_bf16 v[164:167], v[108:111], a[212:215], v[164:167]
    v_mfma_f32_16x16x32_bf16 v[172:175], v[108:111], a[236:239], v[172:175]
    v_mfma_f32_16x16x32_bf16 v[180:183], v[108:111], v[196:199], v[180:183]
    v_mfma_f32_16x16x32_bf16 v[188:191], v[108:111], v[220:223], v[188:191]
    s_nop 9
    v_max3_f32 v16, v160, v161, v162
    v_max3_f32 v16, v16, v163, v164
    v_max3_f32 v16, v16, v165, v166
    v_max3_f32 v16, v16, v167, v240
    v_mov_b32 v17, v16
    s_nop 1
    v_permlane16_swap_b32 v16, v17
    s_nop 1
    v_max_f32 v16, v16, v17
    v_mov_b32 v17, v16
    s_nop 1
    v_permlane32_swap_b32 v16, v17
    s_nop 1
    v_max_f32 v16, v16, v17
    v_sub_f32 v17, v240, v16
    v_exp_f32 v17, v17
    v_mov_b32 v240, v16
    v_sub_f32 v160, v160, v16
    v_sub_f32 v161, v161, v16
    v_sub_f32 v162, v162, v16
    v_sub_f32 v163, v163, v16
    v_sub_f32 v164, v164, v16
    v_sub_f32 v165, v165, v16
    v_sub_f32 v166, v166, v16
    v_sub_f32 v167, v167, v16
    v_exp_f32 v160, v160
    v_exp_f32 v161, v161
    v_exp_f32 v162, v162
    v_exp_f32 v163, v163
    v_exp_f32 v164, v164
    v_exp_f32 v165, v165
    v_exp_f32 v166, v166
    v_exp_f32 v167, v167
    v_mul_f32 v5, v5, v17
    v_add_f32 v5, v5, v160
    v_add_f32 v5, v5, v161
    v_add_f32 v5, v5, v162
    v_add_f32 v5, v5, v163
    v_add_f32 v5, v5, v164
    v_add_f32 v5, v5, v165
    v_add_f32 v5, v5, v166
    v_add_f32 v5, v5, v167
    v_cvt_pk_bf16_f32 v224, v160, v161
    v_cvt_pk_bf16_f32 v225, v162, v163
    v_cvt_pk_bf16_f32 v226, v164, v165
    v_cvt_pk_bf16_f32 v227, v166, v167
    ds_bpermute_b32 v248, v58, v17 offset:0
    ds_bpermute_b32 v249, v58, v17 offset:4
    ds_bpermute_b32 v250, v58, v17 offset:8
    ds_bpermute_b32 v251, v58, v17 offset:12
    s_waitcnt lgkmcnt(0)
    v_accvgpr_read_b32 v18, a0
    v_mul_f32 v18, v18, v248
    v_accvgpr_write_b32 a0, v18
    v_accvgpr_read_b32 v19, a1
    v_mul_f32 v19, v19, v249
    v_accvgpr_write_b32 a1, v19
    v_accvgpr_read_b32 v18, a2
    v_mul_f32 v18, v18, v250
    v_accvgpr_write_b32 a2, v18
    v_accvgpr_read_b32 v19, a3
    v_mul_f32 v19, v19, v251
    v_accvgpr_write_b32 a3, v19
    v_accvgpr_read_b32 v18, a4
    v_mul_f32 v18, v18, v248
    v_accvgpr_write_b32 a4, v18
    v_accvgpr_read_b32 v19, a5
    v_mul_f32 v19, v19, v249
    v_accvgpr_write_b32 a5, v19
    v_accvgpr_read_b32 v18, a6
    v_mul_f32 v18, v18, v250
    v_accvgpr_write_b32 a6, v18
    v_accvgpr_read_b32 v19, a7
    v_mul_f32 v19, v19, v251
    v_accvgpr_write_b32 a7, v19
    v_accvgpr_read_b32 v18, a8
    v_mul_f32 v18, v18, v248
    v_accvgpr_write_b32 a8, v18
    v_accvgpr_read_b32 v19, a9
    v_mul_f32 v19, v19, v249
    v_accvgpr_write_b32 a9, v19
    v_accvgpr_read_b32 v18, a10
    v_mul_f32 v18, v18, v250
    v_accvgpr_write_b32 a10, v18
    v_accvgpr_read_b32 v19, a11
    v_mul_f32 v19, v19, v251
    v_accvgpr_write_b32 a11, v19
    v_accvgpr_read_b32 v18, a12
    v_mul_f32 v18, v18, v248
    v_accvgpr_write_b32 a12, v18
    v_accvgpr_read_b32 v19, a13
    v_mul_f32 v19, v19, v249
    v_accvgpr_write_b32 a13, v19
    v_accvgpr_read_b32 v18, a14
    v_mul_f32 v18, v18, v250
    v_accvgpr_write_b32 a14, v18
    v_accvgpr_read_b32 v19, a15
    v_mul_f32 v19, v19, v251
    v_accvgpr_write_b32 a15, v19
    v_accvgpr_read_b32 v18, a16
    v_mul_f32 v18, v18, v248
    v_accvgpr_write_b32 a16, v18
    v_accvgpr_read_b32 v19, a17
    v_mul_f32 v19, v19, v249
    v_accvgpr_write_b32 a17, v19
    v_accvgpr_read_b32 v18, a18
    v_mul_f32 v18, v18, v250
    v_accvgpr_write_b32 a18, v18
    v_accvgpr_read_b32 v19, a19
    v_mul_f32 v19, v19, v251
    v_accvgpr_write_b32 a19, v19
    v_accvgpr_read_b32 v18, a20
    v_mul_f32 v18, v18, v248
    v_accvgpr_write_b32 a20, v18
    v_accvgpr_read_b32 v19, a21
    v_mul_f32 v19, v19, v249
    v_accvgpr_write_b32 a21, v19
    v_accvgpr_read_b32 v18, a22
    v_mul_f32 v18, v18, v250
    v_accvgpr_write_b32 a22, v18
    v_accvgpr_read_b32 v19, a23
    v_mul_f32 v19, v19, v251
    v_accvgpr_write_b32 a23, v19
    v_accvgpr_read_b32 v18, a24
    v_mul_f32 v18, v18, v248
    v_accvgpr_write_b32 a24, v18
    v_accvgpr_read_b32 v19, a25
    v_mul_f32 v19, v19, v249
    v_accvgpr_write_b32 a25, v19
    v_accvgpr_read_b32 v18, a26
    v_mul_f32 v18, v18, v250
    v_accvgpr_write_b32 a26, v18
    v_accvgpr_read_b32 v19, a27
    v_mul_f32 v19, v19, v251
    v_accvgpr_write_b32 a27, v19
    v_accvgpr_read_b32 v18, a28
    v_mul_f32 v18, v18, v248
    v_accvgpr_write_b32 a28, v18
    v_accvgpr_read_b32 v19, a29
    v_mul_f32 v19, v19, v249
    v_accvgpr_write_b32 a29, v19
    v_accvgpr_read_b32 v18, a30
    v_mul_f32 v18, v18, v250
    v_accvgpr_write_b32 a30, v18
    v_accvgpr_read_b32 v19, a31
    v_mul_f32 v19, v19, v251
    v_accvgpr_write_b32 a31, v19
    v_accvgpr_read_b32 v18, a32
    v_mul_f32 v18, v18, v248
    v_accvgpr_write_b32 a32, v18
    v_accvgpr_read_b32 v19, a33
    v_mul_f32 v19, v19, v249
    v_accvgpr_write_b32 a33, v19
    v_accvgpr_read_b32 v18, a34
    v_mul_f32 v18, v18, v250
    v_accvgpr_write_b32 a34, v18
    v_accvgpr_read_b32 v19, a35
    v_mul_f32 v19, v19, v251
    v_accvgpr_write_b32 a35, v19
    v_accvgpr_read_b32 v18, a36
    v_mul_f32 v18, v18, v248
    v_accvgpr_write_b32 a36, v18
    v_accvgpr_read_b32 v19, a37
    v_mul_f32 v19, v19, v249
    v_accvgpr_write_b32 a37, v19
    v_accvgpr_read_b32 v18, a38
    v_mul_f32 v18, v18, v250
    v_accvgpr_write_b32 a38, v18
    v_accvgpr_read_b32 v19, a39
    v_mul_f32 v19, v19, v251
    v_accvgpr_write_b32 a39, v19
    v_accvgpr_read_b32 v18, a40
    v_mul_f32 v18, v18, v248
    v_accvgpr_write_b32 a40, v18
    v_accvgpr_read_b32 v19, a41
    v_mul_f32 v19, v19, v249
    v_accvgpr_write_b32 a41, v19
    v_accvgpr_read_b32 v18, a42
    v_mul_f32 v18, v18, v250
    v_accvgpr_write_b32 a42, v18
    v_accvgpr_read_b32 v19, a43
    v_mul_f32 v19, v19, v251
    v_accvgpr_write_b32 a43, v19
    v_accvgpr_read_b32 v18, a44
    v_mul_f32 v18, v18, v248
    v_accvgpr_write_b32 a44, v18
    v_accvgpr_read_b32 v19, a45
    v_mul_f32 v19, v19, v249
    v_accvgpr_write_b32 a45, v19
    v_accvgpr_read_b32 v18, a46
    v_mul_f32 v18, v18, v250
    v_accvgpr_write_b32 a46, v18
    v_accvgpr_read_b32 v19, a47
    v_mul_f32 v19, v19, v251
    v_accvgpr_write_b32 a47, v19
    v_max3_f32 v16, v168, v169, v170
    v_max3_f32 v16, v16, v171, v172
    v_max3_f32 v16, v16, v173, v174
    v_max3_f32 v16, v16, v175, v241
    v_mov_b32 v17, v16
    s_nop 1
    v_permlane16_swap_b32 v16, v17
    s_nop 1
    v_max_f32 v16, v16, v17
    v_mov_b32 v17, v16
    s_nop 1
    v_permlane32_swap_b32 v16, v17
    s_nop 1
    v_max_f32 v16, v16, v17
    v_sub_f32 v17, v241, v16
    v_exp_f32 v17, v17
    v_mov_b32 v241, v16
    v_sub_f32 v168, v168, v16
    v_sub_f32 v169, v169, v16
    v_sub_f32 v170, v170, v16
    v_sub_f32 v171, v171, v16
    v_sub_f32 v172, v172, v16
    v_sub_f32 v173, v173, v16
    v_sub_f32 v174, v174, v16
    v_sub_f32 v175, v175, v16
    v_exp_f32 v168, v168
    v_exp_f32 v169, v169
    v_exp_f32 v170, v170
    v_exp_f32 v171, v171
    v_exp_f32 v172, v172
    v_exp_f32 v173, v173
    v_exp_f32 v174, v174
    v_exp_f32 v175, v175
    v_mul_f32 v6, v6, v17
    v_add_f32 v6, v6, v168
    v_add_f32 v6, v6, v169
    v_add_f32 v6, v6, v170
    v_add_f32 v6, v6, v171
    v_add_f32 v6, v6, v172
    v_add_f32 v6, v6, v173
    v_add_f32 v6, v6, v174
    v_add_f32 v6, v6, v175
    v_cvt_pk_bf16_f32 v228, v168, v169
    v_cvt_pk_bf16_f32 v229, v170, v171
    v_cvt_pk_bf16_f32 v230, v172, v173
    v_cvt_pk_bf16_f32 v231, v174, v175
    ds_bpermute_b32 v248, v58, v17 offset:0
    ds_bpermute_b32 v249, v58, v17 offset:4
    ds_bpermute_b32 v250, v58, v17 offset:8
    ds_bpermute_b32 v251, v58, v17 offset:12
    s_waitcnt lgkmcnt(0)
    v_accvgpr_read_b32 v18, a48
    v_mul_f32 v18, v18, v248
    v_accvgpr_write_b32 a48, v18
    v_accvgpr_read_b32 v19, a49
    v_mul_f32 v19, v19, v249
    v_accvgpr_write_b32 a49, v19
    v_accvgpr_read_b32 v18, a50
    v_mul_f32 v18, v18, v250
    v_accvgpr_write_b32 a50, v18
    v_accvgpr_read_b32 v19, a51
    v_mul_f32 v19, v19, v251
    v_accvgpr_write_b32 a51, v19
    v_accvgpr_read_b32 v18, a52
    v_mul_f32 v18, v18, v248
    v_accvgpr_write_b32 a52, v18
    v_accvgpr_read_b32 v19, a53
    v_mul_f32 v19, v19, v249
    v_accvgpr_write_b32 a53, v19
    v_accvgpr_read_b32 v18, a54
    v_mul_f32 v18, v18, v250
    v_accvgpr_write_b32 a54, v18
    v_accvgpr_read_b32 v19, a55
    v_mul_f32 v19, v19, v251
    v_accvgpr_write_b32 a55, v19
    v_accvgpr_read_b32 v18, a56
    v_mul_f32 v18, v18, v248
    v_accvgpr_write_b32 a56, v18
    v_accvgpr_read_b32 v19, a57
    v_mul_f32 v19, v19, v249
    v_accvgpr_write_b32 a57, v19
    v_accvgpr_read_b32 v18, a58
    v_mul_f32 v18, v18, v250
    v_accvgpr_write_b32 a58, v18
    v_accvgpr_read_b32 v19, a59
    v_mul_f32 v19, v19, v251
    v_accvgpr_write_b32 a59, v19
    v_accvgpr_read_b32 v18, a60
    v_mul_f32 v18, v18, v248
    v_accvgpr_write_b32 a60, v18
    v_accvgpr_read_b32 v19, a61
    v_mul_f32 v19, v19, v249
    v_accvgpr_write_b32 a61, v19
    v_accvgpr_read_b32 v18, a62
    v_mul_f32 v18, v18, v250
    v_accvgpr_write_b32 a62, v18
    v_accvgpr_read_b32 v19, a63
    v_mul_f32 v19, v19, v251
    v_accvgpr_write_b32 a63, v19
    v_accvgpr_read_b32 v18, a64
    v_mul_f32 v18, v18, v248
    v_accvgpr_write_b32 a64, v18
    v_accvgpr_read_b32 v19, a65
    v_mul_f32 v19, v19, v249
    v_accvgpr_write_b32 a65, v19
    v_accvgpr_read_b32 v18, a66
    v_mul_f32 v18, v18, v250
    v_accvgpr_write_b32 a66, v18
    v_accvgpr_read_b32 v19, a67
    v_mul_f32 v19, v19, v251
    v_accvgpr_write_b32 a67, v19
    v_accvgpr_read_b32 v18, a68
    v_mul_f32 v18, v18, v248
    v_accvgpr_write_b32 a68, v18
    v_accvgpr_read_b32 v19, a69
    v_mul_f32 v19, v19, v249
    v_accvgpr_write_b32 a69, v19
    v_accvgpr_read_b32 v18, a70
    v_mul_f32 v18, v18, v250
    v_accvgpr_write_b32 a70, v18
    v_accvgpr_read_b32 v19, a71
    v_mul_f32 v19, v19, v251
    v_accvgpr_write_b32 a71, v19
    v_accvgpr_read_b32 v18, a72
    v_mul_f32 v18, v18, v248
    v_accvgpr_write_b32 a72, v18
    v_accvgpr_read_b32 v19, a73
    v_mul_f32 v19, v19, v249
    v_accvgpr_write_b32 a73, v19
    v_accvgpr_read_b32 v18, a74
    v_mul_f32 v18, v18, v250
    v_accvgpr_write_b32 a74, v18
    v_accvgpr_read_b32 v19, a75
    v_mul_f32 v19, v19, v251
    v_accvgpr_write_b32 a75, v19
    v_accvgpr_read_b32 v18, a76
    v_mul_f32 v18, v18, v248
    v_accvgpr_write_b32 a76, v18
    v_accvgpr_read_b32 v19, a77
    v_mul_f32 v19, v19, v249
    v_accvgpr_write_b32 a77, v19
    v_accvgpr_read_b32 v18, a78
    v_mul_f32 v18, v18, v250
    v_accvgpr_write_b32 a78, v18
    v_accvgpr_read_b32 v19, a79
    v_mul_f32 v19, v19, v251
    v_accvgpr_write_b32 a79, v19
    v_accvgpr_read_b32 v18, a80
    v_mul_f32 v18, v18, v248
    v_accvgpr_write_b32 a80, v18
    v_accvgpr_read_b32 v19, a81
    v_mul_f32 v19, v19, v249
    v_accvgpr_write_b32 a81, v19
    v_accvgpr_read_b32 v18, a82
    v_mul_f32 v18, v18, v250
    v_accvgpr_write_b32 a82, v18
    v_accvgpr_read_b32 v19, a83
    v_mul_f32 v19, v19, v251
    v_accvgpr_write_b32 a83, v19
    v_accvgpr_read_b32 v18, a84
    v_mul_f32 v18, v18, v248
    v_accvgpr_write_b32 a84, v18
    v_accvgpr_read_b32 v19, a85
    v_mul_f32 v19, v19, v249
    v_accvgpr_write_b32 a85, v19
    v_accvgpr_read_b32 v18, a86
    v_mul_f32 v18, v18, v250
    v_accvgpr_write_b32 a86, v18
    v_accvgpr_read_b32 v19, a87
    v_mul_f32 v19, v19, v251
    v_accvgpr_write_b32 a87, v19
    v_accvgpr_read_b32 v18, a88
    v_mul_f32 v18, v18, v248
    v_accvgpr_write_b32 a88, v18
    v_accvgpr_read_b32 v19, a89
    v_mul_f32 v19, v19, v249
    v_accvgpr_write_b32 a89, v19
    v_accvgpr_read_b32 v18, a90
    v_mul_f32 v18, v18, v250
    v_accvgpr_write_b32 a90, v18
    v_accvgpr_read_b32 v19, a91
    v_mul_f32 v19, v19, v251
    v_accvgpr_write_b32 a91, v19
    v_accvgpr_read_b32 v18, a92
    v_mul_f32 v18, v18, v248
    v_accvgpr_write_b32 a92, v18
    v_accvgpr_read_b32 v19, a93
    v_mul_f32 v19, v19, v249
    v_accvgpr_write_b32 a93, v19
    v_accvgpr_read_b32 v18, a94
    v_mul_f32 v18, v18, v250
    v_accvgpr_write_b32 a94, v18
    v_accvgpr_read_b32 v19, a95
    v_mul_f32 v19, v19, v251
    v_accvgpr_write_b32 a95, v19
    v_max3_f32 v16, v176, v177, v178
    v_max3_f32 v16, v16, v179, v180
    v_max3_f32 v16, v16, v181, v182
    v_max3_f32 v16, v16, v183, v242
    v_mov_b32 v17, v16
    s_nop 1
    v_permlane16_swap_b32 v16, v17
    s_nop 1
    v_max_f32 v16, v16, v17
    v_mov_b32 v17, v16
    s_nop 1
    v_permlane32_swap_b32 v16, v17
    s_nop 1
    v_max_f32 v16, v16, v17
    v_sub_f32 v17, v242, v16
    v_exp_f32 v17, v17
    v_mov_b32 v242, v16
    v_sub_f32 v176, v176, v16
    v_sub_f32 v177, v177, v16
    v_sub_f32 v178, v178, v16
    v_sub_f32 v179, v179, v16
    v_sub_f32 v180, v180, v16
    v_sub_f32 v181, v181, v16
    v_sub_f32 v182, v182, v16
    v_sub_f32 v183, v183, v16
    v_exp_f32 v176, v176
    v_exp_f32 v177, v177
    v_exp_f32 v178, v178
    v_exp_f32 v179, v179
    v_exp_f32 v180, v180
    v_exp_f32 v181, v181
    v_exp_f32 v182, v182
    v_exp_f32 v183, v183
    v_mul_f32 v7, v7, v17
    v_add_f32 v7, v7, v176
    v_add_f32 v7, v7, v177
    v_add_f32 v7, v7, v178
    v_add_f32 v7, v7, v179
    v_add_f32 v7, v7, v180
    v_add_f32 v7, v7, v181
    v_add_f32 v7, v7, v182
    v_add_f32 v7, v7, v183
    v_cvt_pk_bf16_f32 v232, v176, v177
    v_cvt_pk_bf16_f32 v233, v178, v179
    v_cvt_pk_bf16_f32 v234, v180, v181
    v_cvt_pk_bf16_f32 v235, v182, v183
    ds_bpermute_b32 v248, v58, v17 offset:0
    ds_bpermute_b32 v249, v58, v17 offset:4
    ds_bpermute_b32 v250, v58, v17 offset:8
    ds_bpermute_b32 v251, v58, v17 offset:12
    s_waitcnt lgkmcnt(0)
    v_accvgpr_read_b32 v18, a96
    v_mul_f32 v18, v18, v248
    v_accvgpr_write_b32 a96, v18
    v_accvgpr_read_b32 v19, a97
    v_mul_f32 v19, v19, v249
    v_accvgpr_write_b32 a97, v19
    v_accvgpr_read_b32 v18, a98
    v_mul_f32 v18, v18, v250
    v_accvgpr_write_b32 a98, v18
    v_accvgpr_read_b32 v19, a99
    v_mul_f32 v19, v19, v251
    v_accvgpr_write_b32 a99, v19
    v_accvgpr_read_b32 v18, a100
    v_mul_f32 v18, v18, v248
    v_accvgpr_write_b32 a100, v18
    v_accvgpr_read_b32 v19, a101
    v_mul_f32 v19, v19, v249
    v_accvgpr_write_b32 a101, v19
    v_accvgpr_read_b32 v18, a102
    v_mul_f32 v18, v18, v250
    v_accvgpr_write_b32 a102, v18
    v_accvgpr_read_b32 v19, a103
    v_mul_f32 v19, v19, v251
    v_accvgpr_write_b32 a103, v19
    v_accvgpr_read_b32 v18, a104
    v_mul_f32 v18, v18, v248
    v_accvgpr_write_b32 a104, v18
    v_accvgpr_read_b32 v19, a105
    v_mul_f32 v19, v19, v249
    v_accvgpr_write_b32 a105, v19
    v_accvgpr_read_b32 v18, a106
    v_mul_f32 v18, v18, v250
    v_accvgpr_write_b32 a106, v18
    v_accvgpr_read_b32 v19, a107
    v_mul_f32 v19, v19, v251
    v_accvgpr_write_b32 a107, v19
    v_accvgpr_read_b32 v18, a108
    v_mul_f32 v18, v18, v248
    v_accvgpr_write_b32 a108, v18
    v_accvgpr_read_b32 v19, a109
    v_mul_f32 v19, v19, v249
    v_accvgpr_write_b32 a109, v19
    v_accvgpr_read_b32 v18, a110
    v_mul_f32 v18, v18, v250
    v_accvgpr_write_b32 a110, v18
    v_accvgpr_read_b32 v19, a111
    v_mul_f32 v19, v19, v251
    v_accvgpr_write_b32 a111, v19
    v_accvgpr_read_b32 v18, a112
    v_mul_f32 v18, v18, v248
    v_accvgpr_write_b32 a112, v18
    v_accvgpr_read_b32 v19, a113
    v_mul_f32 v19, v19, v249
    v_accvgpr_write_b32 a113, v19
    v_accvgpr_read_b32 v18, a114
    v_mul_f32 v18, v18, v250
    v_accvgpr_write_b32 a114, v18
    v_accvgpr_read_b32 v19, a115
    v_mul_f32 v19, v19, v251
    v_accvgpr_write_b32 a115, v19
    v_accvgpr_read_b32 v18, a116
    v_mul_f32 v18, v18, v248
    v_accvgpr_write_b32 a116, v18
    v_accvgpr_read_b32 v19, a117
    v_mul_f32 v19, v19, v249
    v_accvgpr_write_b32 a117, v19
    v_accvgpr_read_b32 v18, a118
    v_mul_f32 v18, v18, v250
    v_accvgpr_write_b32 a118, v18
    v_accvgpr_read_b32 v19, a119
    v_mul_f32 v19, v19, v251
    v_accvgpr_write_b32 a119, v19
    v_accvgpr_read_b32 v18, a120
    v_mul_f32 v18, v18, v248
    v_accvgpr_write_b32 a120, v18
    v_accvgpr_read_b32 v19, a121
    v_mul_f32 v19, v19, v249
    v_accvgpr_write_b32 a121, v19
    v_accvgpr_read_b32 v18, a122
    v_mul_f32 v18, v18, v250
    v_accvgpr_write_b32 a122, v18
    v_accvgpr_read_b32 v19, a123
    v_mul_f32 v19, v19, v251
    v_accvgpr_write_b32 a123, v19
    v_accvgpr_read_b32 v18, a124
    v_mul_f32 v18, v18, v248
    v_accvgpr_write_b32 a124, v18
    v_accvgpr_read_b32 v19, a125
    v_mul_f32 v19, v19, v249
    v_accvgpr_write_b32 a125, v19
    v_accvgpr_read_b32 v18, a126
    v_mul_f32 v18, v18, v250
    v_accvgpr_write_b32 a126, v18
    v_accvgpr_read_b32 v19, a127
    v_mul_f32 v19, v19, v251
    v_accvgpr_write_b32 a127, v19
    v_accvgpr_read_b32 v18, a128
    v_mul_f32 v18, v18, v248
    v_accvgpr_write_b32 a128, v18
    v_accvgpr_read_b32 v19, a129
    v_mul_f32 v19, v19, v249
    v_accvgpr_write_b32 a129, v19
    v_accvgpr_read_b32 v18, a130
    v_mul_f32 v18, v18, v250
    v_accvgpr_write_b32 a130, v18
    v_accvgpr_read_b32 v19, a131
    v_mul_f32 v19, v19, v251
    v_accvgpr_write_b32 a131, v19
    v_accvgpr_read_b32 v18, a132
    v_mul_f32 v18, v18, v248
    v_accvgpr_write_b32 a132, v18
    v_accvgpr_read_b32 v19, a133
    v_mul_f32 v19, v19, v249
    v_accvgpr_write_b32 a133, v19
    v_accvgpr_read_b32 v18, a134
    v_mul_f32 v18, v18, v250
    v_accvgpr_write_b32 a134, v18
    v_accvgpr_read_b32 v19, a135
    v_mul_f32 v19, v19, v251
    v_accvgpr_write_b32 a135, v19
    v_accvgpr_read_b32 v18, a136
    v_mul_f32 v18, v18, v248
    v_accvgpr_write_b32 a136, v18
    v_accvgpr_read_b32 v19, a137
    v_mul_f32 v19, v19, v249
    v_accvgpr_write_b32 a137, v19
    v_accvgpr_read_b32 v18, a138
    v_mul_f32 v18, v18, v250
    v_accvgpr_write_b32 a138, v18
    v_accvgpr_read_b32 v19, a139
    v_mul_f32 v19, v19, v251
    v_accvgpr_write_b32 a139, v19
    v_accvgpr_read_b32 v18, a140
    v_mul_f32 v18, v18, v248
    v_accvgpr_write_b32 a140, v18
    v_accvgpr_read_b32 v19, a141
    v_mul_f32 v19, v19, v249
    v_accvgpr_write_b32 a141, v19
    v_accvgpr_read_b32 v18, a142
    v_mul_f32 v18, v18, v250
    v_accvgpr_write_b32 a142, v18
    v_accvgpr_read_b32 v19, a143
    v_mul_f32 v19, v19, v251
    v_accvgpr_write_b32 a143, v19
    v_max3_f32 v16, v184, v185, v186
    v_max3_f32 v16, v16, v187, v188
    v_max3_f32 v16, v16, v189, v190
    v_max3_f32 v16, v16, v191, v243
    v_mov_b32 v17, v16
    s_nop 1
    v_permlane16_swap_b32 v16, v17
    s_nop 1
    v_max_f32 v16, v16, v17
    v_mov_b32 v17, v16
    s_nop 1
    v_permlane32_swap_b32 v16, v17
    s_nop 1
    v_max_f32 v16, v16, v17
    v_sub_f32 v17, v243, v16
    v_exp_f32 v17, v17
    v_mov_b32 v243, v16
    v_sub_f32 v184, v184, v16
    v_sub_f32 v185, v185, v16
    v_sub_f32 v186, v186, v16
    v_sub_f32 v187, v187, v16
    v_sub_f32 v188, v188, v16
    v_sub_f32 v189, v189, v16
    v_sub_f32 v190, v190, v16
    v_sub_f32 v191, v191, v16
    v_exp_f32 v184, v184
    v_exp_f32 v185, v185
    v_exp_f32 v186, v186
    v_exp_f32 v187, v187
    v_exp_f32 v188, v188
    v_exp_f32 v189, v189
    v_exp_f32 v190, v190
    v_exp_f32 v191, v191
    v_mul_f32 v8, v8, v17
    v_add_f32 v8, v8, v184
    v_add_f32 v8, v8, v185
    v_add_f32 v8, v8, v186
    v_add_f32 v8, v8, v187
    v_add_f32 v8, v8, v188
    v_add_f32 v8, v8, v189
    v_add_f32 v8, v8, v190
    v_add_f32 v8, v8, v191
    v_cvt_pk_bf16_f32 v236, v184, v185
    v_cvt_pk_bf16_f32 v237, v186, v187
    v_cvt_pk_bf16_f32 v238, v188, v189
    v_cvt_pk_bf16_f32 v239, v190, v191
    ds_bpermute_b32 v248, v58, v17 offset:0
    ds_bpermute_b32 v249, v58, v17 offset:4
    ds_bpermute_b32 v250, v58, v17 offset:8
    ds_bpermute_b32 v251, v58, v17 offset:12
    s_waitcnt lgkmcnt(0)
    v_accvgpr_read_b32 v18, a144
    v_mul_f32 v18, v18, v248
    v_accvgpr_write_b32 a144, v18
    v_accvgpr_read_b32 v19, a145
    v_mul_f32 v19, v19, v249
    v_accvgpr_write_b32 a145, v19
    v_accvgpr_read_b32 v18, a146
    v_mul_f32 v18, v18, v250
    v_accvgpr_write_b32 a146, v18
    v_accvgpr_read_b32 v19, a147
    v_mul_f32 v19, v19, v251
    v_accvgpr_write_b32 a147, v19
    v_accvgpr_read_b32 v18, a148
    v_mul_f32 v18, v18, v248
    v_accvgpr_write_b32 a148, v18
    v_accvgpr_read_b32 v19, a149
    v_mul_f32 v19, v19, v249
    v_accvgpr_write_b32 a149, v19
    v_accvgpr_read_b32 v18, a150
    v_mul_f32 v18, v18, v250
    v_accvgpr_write_b32 a150, v18
    v_accvgpr_read_b32 v19, a151
    v_mul_f32 v19, v19, v251
    v_accvgpr_write_b32 a151, v19
    v_accvgpr_read_b32 v18, a152
    v_mul_f32 v18, v18, v248
    v_accvgpr_write_b32 a152, v18
    v_accvgpr_read_b32 v19, a153
    v_mul_f32 v19, v19, v249
    v_accvgpr_write_b32 a153, v19
    v_accvgpr_read_b32 v18, a154
    v_mul_f32 v18, v18, v250
    v_accvgpr_write_b32 a154, v18
    v_accvgpr_read_b32 v19, a155
    v_mul_f32 v19, v19, v251
    v_accvgpr_write_b32 a155, v19
    v_accvgpr_read_b32 v18, a156
    v_mul_f32 v18, v18, v248
    v_accvgpr_write_b32 a156, v18
    v_accvgpr_read_b32 v19, a157
    v_mul_f32 v19, v19, v249
    v_accvgpr_write_b32 a157, v19
    v_accvgpr_read_b32 v18, a158
    v_mul_f32 v18, v18, v250
    v_accvgpr_write_b32 a158, v18
    v_accvgpr_read_b32 v19, a159
    v_mul_f32 v19, v19, v251
    v_accvgpr_write_b32 a159, v19
    v_accvgpr_read_b32 v18, a160
    v_mul_f32 v18, v18, v248
    v_accvgpr_write_b32 a160, v18
    v_accvgpr_read_b32 v19, a161
    v_mul_f32 v19, v19, v249
    v_accvgpr_write_b32 a161, v19
    v_accvgpr_read_b32 v18, a162
    v_mul_f32 v18, v18, v250
    v_accvgpr_write_b32 a162, v18
    v_accvgpr_read_b32 v19, a163
    v_mul_f32 v19, v19, v251
    v_accvgpr_write_b32 a163, v19
    v_accvgpr_read_b32 v18, a164
    v_mul_f32 v18, v18, v248
    v_accvgpr_write_b32 a164, v18
    v_accvgpr_read_b32 v19, a165
    v_mul_f32 v19, v19, v249
    v_accvgpr_write_b32 a165, v19
    v_accvgpr_read_b32 v18, a166
    v_mul_f32 v18, v18, v250
    v_accvgpr_write_b32 a166, v18
    v_accvgpr_read_b32 v19, a167
    v_mul_f32 v19, v19, v251
    v_accvgpr_write_b32 a167, v19
    v_accvgpr_read_b32 v18, a168
    v_mul_f32 v18, v18, v248
    v_accvgpr_write_b32 a168, v18
    v_accvgpr_read_b32 v19, a169
    v_mul_f32 v19, v19, v249
    v_accvgpr_write_b32 a169, v19
    v_accvgpr_read_b32 v18, a170
    v_mul_f32 v18, v18, v250
    v_accvgpr_write_b32 a170, v18
    v_accvgpr_read_b32 v19, a171
    v_mul_f32 v19, v19, v251
    v_accvgpr_write_b32 a171, v19
    v_accvgpr_read_b32 v18, a172
    v_mul_f32 v18, v18, v248
    v_accvgpr_write_b32 a172, v18
    v_accvgpr_read_b32 v19, a173
    v_mul_f32 v19, v19, v249
    v_accvgpr_write_b32 a173, v19
    v_accvgpr_read_b32 v18, a174
    v_mul_f32 v18, v18, v250
    v_accvgpr_write_b32 a174, v18
    v_accvgpr_read_b32 v19, a175
    v_mul_f32 v19, v19, v251
    v_accvgpr_write_b32 a175, v19
    v_accvgpr_read_b32 v18, a176
    v_mul_f32 v18, v18, v248
    v_accvgpr_write_b32 a176, v18
    v_accvgpr_read_b32 v19, a177
    v_mul_f32 v19, v19, v249
    v_accvgpr_write_b32 a177, v19
    v_accvgpr_read_b32 v18, a178
    v_mul_f32 v18, v18, v250
    v_accvgpr_write_b32 a178, v18
    v_accvgpr_read_b32 v19, a179
    v_mul_f32 v19, v19, v251
    v_accvgpr_write_b32 a179, v19
    v_accvgpr_read_b32 v18, a180
    v_mul_f32 v18, v18, v248
    v_accvgpr_write_b32 a180, v18
    v_accvgpr_read_b32 v19, a181
    v_mul_f32 v19, v19, v249
    v_accvgpr_write_b32 a181, v19
    v_accvgpr_read_b32 v18, a182
    v_mul_f32 v18, v18, v250
    v_accvgpr_write_b32 a182, v18
    v_accvgpr_read_b32 v19, a183
    v_mul_f32 v19, v19, v251
    v_accvgpr_write_b32 a183, v19
    v_accvgpr_read_b32 v18, a184
    v_mul_f32 v18, v18, v248
    v_accvgpr_write_b32 a184, v18
    v_accvgpr_read_b32 v19, a185
    v_mul_f32 v19, v19, v249
    v_accvgpr_write_b32 a185, v19
    v_accvgpr_read_b32 v18, a186
    v_mul_f32 v18, v18, v250
    v_accvgpr_write_b32 a186, v18
    v_accvgpr_read_b32 v19, a187
    v_mul_f32 v19, v19, v251
    v_accvgpr_write_b32 a187, v19
    v_accvgpr_read_b32 v18, a188
    v_mul_f32 v18, v18, v248
    v_accvgpr_write_b32 a188, v18
    v_accvgpr_read_b32 v19, a189
    v_mul_f32 v19, v19, v249
    v_accvgpr_write_b32 a189, v19
    v_accvgpr_read_b32 v18, a190
    v_mul_f32 v18, v18, v250
    v_accvgpr_write_b32 a190, v18
    v_accvgpr_read_b32 v19, a191
    v_mul_f32 v19, v19, v251
    v_accvgpr_write_b32 a191, v19
    s_waitcnt vmcnt(0)
    s_nop 1
    v_mfma_f32_16x16x32_bf16 a[0:3], v[224:227], v[112:115], a[0:3]
    v_mfma_f32_16x16x32_bf16 a[48:51], v[228:231], v[112:115], a[48:51]
    v_mfma_f32_16x16x32_bf16 a[96:99], v[232:235], v[112:115], a[96:99]
    v_mfma_f32_16x16x32_bf16 a[144:147], v[236:239], v[112:115], a[144:147]
    v_mfma_f32_16x16x32_bf16 a[4:7], v[224:227], v[116:119], a[4:7]
    v_mfma_f32_16x16x32_bf16 a[52:55], v[228:231], v[116:119], a[52:55]
    v_mfma_f32_16x16x32_bf16 a[100:103], v[232:235], v[116:119], a[100:103]
    v_mfma_f32_16x16x32_bf16 a[148:151], v[236:239], v[116:119], a[148:151]
    v_mfma_f32_16x16x32_bf16 a[8:11], v[224:227], v[120:123], a[8:11]
    v_mfma_f32_16x16x32_bf16 a[56:59], v[228:231], v[120:123], a[56:59]
    v_mfma_f32_16x16x32_bf16 a[104:107], v[232:235], v[120:123], a[104:107]
    v_mfma_f32_16x16x32_bf16 a[152:155], v[236:239], v[120:123], a[152:155]
    v_mfma_f32_16x16x32_bf16 a[12:15], v[224:227], v[124:127], a[12:15]
    v_mfma_f32_16x16x32_bf16 a[60:63], v[228:231], v[124:127], a[60:63]
    v_mfma_f32_16x16x32_bf16 a[108:111], v[232:235], v[124:127], a[108:111]
    v_mfma_f32_16x16x32_bf16 a[156:159], v[236:239], v[124:127], a[156:159]
    v_mfma_f32_16x16x32_bf16 a[16:19], v[224:227], v[128:131], a[16:19]
    v_mfma_f32_16x16x32_bf16 a[64:67], v[228:231], v[128:131], a[64:67]
    v_mfma_f32_16x16x32_bf16 a[112:115], v[232:235], v[128:131], a[112:115]
    v_mfma_f32_16x16x32_bf16 a[160:163], v[236:239], v[128:131], a[160:163]
    v_mfma_f32_16x16x32_bf16 a[20:23], v[224:227], v[132:135], a[20:23]
    v_mfma_f32_16x16x32_bf16 a[68:71], v[228:231], v[132:135], a[68:71]
    v_mfma_f32_16x16x32_bf16 a[116:119], v[232:235], v[132:135], a[116:119]
    v_mfma_f32_16x16x32_bf16 a[164:167], v[236:239], v[132:135], a[164:167]
    v_mfma_f32_16x16x32_bf16 a[24:27], v[224:227], v[136:139], a[24:27]
    v_mfma_f32_16x16x32_bf16 a[72:75], v[228:231], v[136:139], a[72:75]
    v_mfma_f32_16x16x32_bf16 a[120:123], v[232:235], v[136:139], a[120:123]
    v_mfma_f32_16x16x32_bf16 a[168:171], v[236:239], v[136:139], a[168:171]
    v_mfma_f32_16x16x32_bf16 a[28:31], v[224:227], v[140:143], a[28:31]
    v_mfma_f32_16x16x32_bf16 a[76:79], v[228:231], v[140:143], a[76:79]
    v_mfma_f32_16x16x32_bf16 a[124:127], v[232:235], v[140:143], a[124:127]
    v_mfma_f32_16x16x32_bf16 a[172:175], v[236:239], v[140:143], a[172:175]
    v_mfma_f32_16x16x32_bf16 a[32:35], v[224:227], v[144:147], a[32:35]
    v_mfma_f32_16x16x32_bf16 a[80:83], v[228:231], v[144:147], a[80:83]
    v_mfma_f32_16x16x32_bf16 a[128:131], v[232:235], v[144:147], a[128:131]
    v_mfma_f32_16x16x32_bf16 a[176:179], v[236:239], v[144:147], a[176:179]
    v_mfma_f32_16x16x32_bf16 a[36:39], v[224:227], v[148:151], a[36:39]
    v_mfma_f32_16x16x32_bf16 a[84:87], v[228:231], v[148:151], a[84:87]
    v_mfma_f32_16x16x32_bf16 a[132:135], v[232:235], v[148:151], a[132:135]
    v_mfma_f32_16x16x32_bf16 a[180:183], v[236:239], v[148:151], a[180:183]
    v_mfma_f32_16x16x32_bf16 a[40:43], v[224:227], v[152:155], a[40:43]
    v_mfma_f32_16x16x32_bf16 a[88:91], v[228:231], v[152:155], a[88:91]
    v_mfma_f32_16x16x32_bf16 a[136:139], v[232:235], v[152:155], a[136:139]
    v_mfma_f32_16x16x32_bf16 a[184:187], v[236:239], v[152:155], a[184:187]
    v_mfma_f32_16x16x32_bf16 a[44:47], v[224:227], v[156:159], a[44:47]
    v_mfma_f32_16x16x32_bf16 a[92:95], v[228:231], v[156:159], a[92:95]
    v_mfma_f32_16x16x32_bf16 a[140:143], v[232:235], v[156:159], a[140:143]
    v_mfma_f32_16x16x32_bf16 a[188:191], v[236:239], v[156:159], a[188:191]
    s_add_u32 s48, s48, 24576
    s_cmp_lt_u32 s48, 1572864
    s_nop 7
    s_cbranch_scc1 L_slowloop
    s_nop 1
    v_mfma_f32_16x16x4_f32 v[48:51], v5, v57, 0
    v_mfma_f32_16x16x4_f32 v[52:55], v6, v57, 0
    s_nop 7
    s_nop 1
    v_rcp_f32 v48, v48
    v_rcp_f32 v49, v49
    v_rcp_f32 v50, v50
    v_rcp_f32 v51, v51
    v_rcp_f32 v52, v52
    v_rcp_f32 v53, v53
    v_rcp_f32 v54, v54
    v_rcp_f32 v55, v55
    v_mfma_f32_16x16x4_f32 v[128:131], v7, v57, 0
    v_mfma_f32_16x16x4_f32 v[132:135], v8, v57, 0
    s_nop 7
    s_nop 1
    v_rcp_f32 v128, v128
    v_rcp_f32 v129, v129
    v_rcp_f32 v130, v130
    v_rcp_f32 v131, v131
    v_rcp_f32 v132, v132
    v_rcp_f32 v133, v133
    v_rcp_f32 v134, v134
    v_rcp_f32 v135, v135
    s_nop 0
    v_accvgpr_read_b32 v64, a0
    v_accvgpr_read_b32 v65, a12
    v_accvgpr_read_b32 v66, a24
    v_accvgpr_read_b32 v67, a36
    v_pk_mul_f32 v[64:65], v[64:65], v[48:49] op_sel_hi:[1,0]
    v_pk_mul_f32 v[66:67], v[66:67], v[48:49] op_sel_hi:[1,0]
    v_cvt_pk_bf16_f32 v64, v64, v65
    v_cvt_pk_bf16_f32 v65, v66, v67
    v_accvgpr_read_b32 v68, a1
    v_accvgpr_read_b32 v69, a13
    v_accvgpr_read_b32 v70, a25
    v_accvgpr_read_b32 v71, a37
    v_pk_mul_f32 v[68:69], v[68:69], v[48:49] op_sel:[0,1] op_sel_hi:[1,1]
    v_pk_mul_f32 v[70:71], v[70:71], v[48:49] op_sel:[0,1] op_sel_hi:[1,1]
    v_cvt_pk_bf16_f32 v68, v68, v69
    v_cvt_pk_bf16_f32 v69, v70, v71
    buffer_store_dwordx2 v[64:65], v56, s[12:15], s24 offen offset:0 sc0 sc1
    v_accvgpr_read_b32 v72, a2
    v_accvgpr_read_b32 v73, a14
    v_accvgpr_read_b32 v74, a26
    v_accvgpr_read_b32 v75, a38
    v_pk_mul_f32 v[72:73], v[72:73], v[50:51] op_sel_hi:[1,0]
    v_pk_mul_f32 v[74:75], v[74:75], v[50:51] op_sel_hi:[1,0]
    v_cvt_pk_bf16_f32 v72, v72, v73
    v_cvt_pk_bf16_f32 v73, v74, v75
    buffer_store_dwordx2 v[68:69], v56, s[12:15], s24 offen offset:384 sc0 sc1
    v_accvgpr_read_b32 v76, a3
    v_accvgpr_read_b32 v77, a15
    v_accvgpr_read_b32 v78, a27
    v_accvgpr_read_b32 v79, a39
    v_pk_mul_f32 v[76:77], v[76:77], v[50:51] op_sel:[0,1] op_sel_hi:[1,1]
    v_pk_mul_f32 v[78:79], v[78:79], v[50:51] op_sel:[0,1] op_sel_hi:[1,1]
    v_cvt_pk_bf16_f32 v76, v76, v77
    v_cvt_pk_bf16_f32 v77, v78, v79
    buffer_store_dwordx2 v[72:73], v56, s[12:15], s24 offen offset:768 sc0 sc1
    v_accvgpr_read_b32 v80, a4
    v_accvgpr_read_b32 v81, a16
    v_accvgpr_read_b32 v82, a28
    v_accvgpr_read_b32 v83, a40
    v_pk_mul_f32 v[80:81], v[80:81], v[48:49] op_sel_hi:[1,0]
    v_pk_mul_f32 v[82:83], v[82:83], v[48:49] op_sel_hi:[1,0]
    v_cvt_pk_bf16_f32 v80, v80, v81
    v_cvt_pk_bf16_f32 v81, v82, v83
    buffer_store_dwordx2 v[76:77], v56, s[12:15], s24 offen offset:1152 sc0 sc1
    v_accvgpr_read_b32 v84, a5
    v_accvgpr_read_b32 v85, a17
    v_accvgpr_read_b32 v86, a29
    v_accvgpr_read_b32 v87, a41
    v_pk_mul_f32 v[84:85], v[84:85], v[48:49] op_sel:[0,1] op_sel_hi:[1,1]
    v_pk_mul_f32 v[86:87], v[86:87], v[48:49] op_sel:[0,1] op_sel_hi:[1,1]
    v_cvt_pk_bf16_f32 v84, v84, v85
    v_cvt_pk_bf16_f32 v85, v86, v87
    buffer_store_dwordx2 v[80:81], v56, s[12:15], s24 offen offset:128 sc0 sc1
    v_accvgpr_read_b32 v88, a6
    v_accvgpr_read_b32 v89, a18
    v_accvgpr_read_b32 v90, a30
    v_accvgpr_read_b32 v91, a42
    v_pk_mul_f32 v[88:89], v[88:89], v[50:51] op_sel_hi:[1,0]
    v_pk_mul_f32 v[90:91], v[90:91], v[50:51] op_sel_hi:[1,0]
    v_cvt_pk_bf16_f32 v88, v88, v89
    v_cvt_pk_bf16_f32 v89, v90, v91
    buffer_store_dwordx2 v[84:85], v56, s[12:15], s24 offen offset:512 sc0 sc1
    v_accvgpr_read_b32 v92, a7
    v_accvgpr_read_b32 v93, a19
    v_accvgpr_read_b32 v94, a31
    v_accvgpr_read_b32 v95, a43
    v_pk_mul_f32 v[92:93], v[92:93], v[50:51] op_sel:[0,1] op_sel_hi:[1,1]
    v_pk_mul_f32 v[94:95], v[94:95], v[50:51] op_sel:[0,1] op_sel_hi:[1,1]
    v_cvt_pk_bf16_f32 v92, v92, v93
    v_cvt_pk_bf16_f32 v93, v94, v95
    buffer_store_dwordx2 v[88:89], v56, s[12:15], s24 offen offset:896 sc0 sc1
    v_accvgpr_read_b32 v96, a8
    v_accvgpr_read_b32 v97, a20
    v_accvgpr_read_b32 v98, a32
    v_accvgpr_read_b32 v99, a44
    v_pk_mul_f32 v[96:97], v[96:97], v[48:49] op_sel_hi:[1,0]
    v_pk_mul_f32 v[98:99], v[98:99], v[48:49] op_sel_hi:[1,0]
    v_cvt_pk_bf16_f32 v96, v96, v97
    v_cvt_pk_bf16_f32 v97, v98, v99
    buffer_store_dwordx2 v[92:93], v56, s[12:15], s24 offen offset:1280 sc0 sc1
    v_accvgpr_read_b32 v100, a9
    v_accvgpr_read_b32 v101, a21
    v_accvgpr_read_b32 v102, a33
    v_accvgpr_read_b32 v103, a45
    v_pk_mul_f32 v[100:101], v[100:101], v[48:49] op_sel:[0,1] op_sel_hi:[1,1]
    v_pk_mul_f32 v[102:103], v[102:103], v[48:49] op_sel:[0,1] op_sel_hi:[1,1]
    v_cvt_pk_bf16_f32 v100, v100, v101
    v_cvt_pk_bf16_f32 v101, v102, v103
    buffer_store_dwordx2 v[96:97], v56, s[12:15], s24 offen offset:256 sc0 sc1
    v_accvgpr_read_b32 v104, a10
    v_accvgpr_read_b32 v105, a22
    v_accvgpr_read_b32 v106, a34
    v_accvgpr_read_b32 v107, a46
    v_pk_mul_f32 v[104:105], v[104:105], v[50:51] op_sel_hi:[1,0]
    v_pk_mul_f32 v[106:107], v[106:107], v[50:51] op_sel_hi:[1,0]
    v_cvt_pk_bf16_f32 v104, v104, v105
    v_cvt_pk_bf16_f32 v105, v106, v107
    buffer_store_dwordx2 v[100:101], v56, s[12:15], s24 offen offset:640 sc0 sc1
    v_accvgpr_read_b32 v108, a11
    v_accvgpr_read_b32 v109, a23
    v_accvgpr_read_b32 v110, a35
    v_accvgpr_read_b32 v111, a47
    v_pk_mul_f32 v[108:109], v[108:109], v[50:51] op_sel:[0,1] op_sel_hi:[1,1]
    v_pk_mul_f32 v[110:111], v[110:111], v[50:51] op_sel:[0,1] op_sel_hi:[1,1]
    v_cvt_pk_bf16_f32 v108, v108, v109
    v_cvt_pk_bf16_f32 v109, v110, v111
    buffer_store_dwordx2 v[104:105], v56, s[12:15], s24 offen offset:1024 sc0 sc1
    v_accvgpr_read_b32 v112, a48
    v_accvgpr_read_b32 v113, a60
    v_accvgpr_read_b32 v114, a72
    v_accvgpr_read_b32 v115, a84
    v_pk_mul_f32 v[112:113], v[112:113], v[52:53] op_sel_hi:[1,0]
    v_pk_mul_f32 v[114:115], v[114:115], v[52:53] op_sel_hi:[1,0]
    v_cvt_pk_bf16_f32 v112, v112, v113
    v_cvt_pk_bf16_f32 v113, v114, v115
    buffer_store_dwordx2 v[108:109], v56, s[12:15], s24 offen offset:1408 sc0 sc1
    v_accvgpr_read_b32 v116, a49
    v_accvgpr_read_b32 v117, a61
    v_accvgpr_read_b32 v118, a73
    v_accvgpr_read_b32 v119, a85
    v_pk_mul_f32 v[116:117], v[116:117], v[52:53] op_sel:[0,1] op_sel_hi:[1,1]
    v_pk_mul_f32 v[118:119], v[118:119], v[52:53] op_sel:[0,1] op_sel_hi:[1,1]
    v_cvt_pk_bf16_f32 v116, v116, v117
    v_cvt_pk_bf16_f32 v117, v118, v119
    buffer_store_dwordx2 v[112:113], v56, s[12:15], s40 offen offset:0 sc0 sc1
    v_accvgpr_read_b32 v120, a50
    v_accvgpr_read_b32 v121, a62
    v_accvgpr_read_b32 v122, a74
    v_accvgpr_read_b32 v123, a86
    v_pk_mul_f32 v[120:121], v[120:121], v[54:55] op_sel_hi:[1,0]
    v_pk_mul_f32 v[122:123], v[122:123], v[54:55] op_sel_hi:[1,0]
    v_cvt_pk_bf16_f32 v120, v120, v121
    v_cvt_pk_bf16_f32 v121, v122, v123
    buffer_store_dwordx2 v[116:117], v56, s[12:15], s40 offen offset:384 sc0 sc1
    v_accvgpr_read_b32 v124, a51
    v_accvgpr_read_b32 v125, a63
    v_accvgpr_read_b32 v126, a75
    v_accvgpr_read_b32 v127, a87
    v_pk_mul_f32 v[124:125], v[124:125], v[54:55] op_sel:[0,1] op_sel_hi:[1,1]
    v_pk_mul_f32 v[126:127], v[126:127], v[54:55] op_sel:[0,1] op_sel_hi:[1,1]
    v_cvt_pk_bf16_f32 v124, v124, v125
    v_cvt_pk_bf16_f32 v125, v126, v127
    buffer_store_dwordx2 v[120:121], v56, s[12:15], s40 offen offset:768 sc0 sc1
    v_accvgpr_read_b32 v64, a52
    v_accvgpr_read_b32 v65, a64
    v_accvgpr_read_b32 v66, a76
    v_accvgpr_read_b32 v67, a88
    v_pk_mul_f32 v[64:65], v[64:65], v[52:53] op_sel_hi:[1,0]
    v_pk_mul_f32 v[66:67], v[66:67], v[52:53] op_sel_hi:[1,0]
    v_cvt_pk_bf16_f32 v64, v64, v65
    v_cvt_pk_bf16_f32 v65, v66, v67
    buffer_store_dwordx2 v[124:125], v56, s[12:15], s40 offen offset:1152 sc0 sc1
    v_accvgpr_read_b32 v68, a53
    v_accvgpr_read_b32 v69, a65
    v_accvgpr_read_b32 v70, a77
    v_accvgpr_read_b32 v71, a89
    v_pk_mul_f32 v[68:69], v[68:69], v[52:53] op_sel:[0,1] op_sel_hi:[1,1]
    v_pk_mul_f32 v[70:71], v[70:71], v[52:53] op_sel:[0,1] op_sel_hi:[1,1]
    v_cvt_pk_bf16_f32 v68, v68, v69
    v_cvt_pk_bf16_f32 v69, v70, v71
    buffer_store_dwordx2 v[64:65], v56, s[12:15], s40 offen offset:128 sc0 sc1
    v_accvgpr_read_b32 v72, a54
    v_accvgpr_read_b32 v73, a66
    v_accvgpr_read_b32 v74, a78
    v_accvgpr_read_b32 v75, a90
    v_pk_mul_f32 v[72:73], v[72:73], v[54:55] op_sel_hi:[1,0]
    v_pk_mul_f32 v[74:75], v[74:75], v[54:55] op_sel_hi:[1,0]
    v_cvt_pk_bf16_f32 v72, v72, v73
    v_cvt_pk_bf16_f32 v73, v74, v75
    buffer_store_dwordx2 v[68:69], v56, s[12:15], s40 offen offset:512 sc0 sc1
    v_accvgpr_read_b32 v76, a55
    v_accvgpr_read_b32 v77, a67
    v_accvgpr_read_b32 v78, a79
    v_accvgpr_read_b32 v79, a91
    v_pk_mul_f32 v[76:77], v[76:77], v[54:55] op_sel:[0,1] op_sel_hi:[1,1]
    v_pk_mul_f32 v[78:79], v[78:79], v[54:55] op_sel:[0,1] op_sel_hi:[1,1]
    v_cvt_pk_bf16_f32 v76, v76, v77
    v_cvt_pk_bf16_f32 v77, v78, v79
    buffer_store_dwordx2 v[72:73], v56, s[12:15], s40 offen offset:896 sc0 sc1
    v_accvgpr_read_b32 v80, a56
    v_accvgpr_read_b32 v81, a68
    v_accvgpr_read_b32 v82, a80
    v_accvgpr_read_b32 v83, a92
    v_pk_mul_f32 v[80:81], v[80:81], v[52:53] op_sel_hi:[1,0]
    v_pk_mul_f32 v[82:83], v[82:83], v[52:53] op_sel_hi:[1,0]
    v_cvt_pk_bf16_f32 v80, v80, v81
    v_cvt_pk_bf16_f32 v81, v82, v83
    buffer_store_dwordx2 v[76:77], v56, s[12:15], s40 offen offset:1280 sc0 sc1
    v_accvgpr_read_b32 v84, a57
    v_accvgpr_read_b32 v85, a69
    v_accvgpr_read_b32 v86, a81
    v_accvgpr_read_b32 v87, a93
    v_pk_mul_f32 v[84:85], v[84:85], v[52:53] op_sel:[0,1] op_sel_hi:[1,1]
    v_pk_mul_f32 v[86:87], v[86:87], v[52:53] op_sel:[0,1] op_sel_hi:[1,1]
    v_cvt_pk_bf16_f32 v84, v84, v85
    v_cvt_pk_bf16_f32 v85, v86, v87
    buffer_store_dwordx2 v[80:81], v56, s[12:15], s40 offen offset:256 sc0 sc1
    v_accvgpr_read_b32 v88, a58
    v_accvgpr_read_b32 v89, a70
    v_accvgpr_read_b32 v90, a82
    v_accvgpr_read_b32 v91, a94
    v_pk_mul_f32 v[88:89], v[88:89], v[54:55] op_sel_hi:[1,0]
    v_pk_mul_f32 v[90:91], v[90:91], v[54:55] op_sel_hi:[1,0]
    v_cvt_pk_bf16_f32 v88, v88, v89
    v_cvt_pk_bf16_f32 v89, v90, v91
    buffer_store_dwordx2 v[84:85], v56, s[12:15], s40 offen offset:640 sc0 sc1
    v_accvgpr_read_b32 v92, a59
    v_accvgpr_read_b32 v93, a71
    v_accvgpr_read_b32 v94, a83
    v_accvgpr_read_b32 v95, a95
    v_pk_mul_f32 v[92:93], v[92:93], v[54:55] op_sel:[0,1] op_sel_hi:[1,1]
    v_pk_mul_f32 v[94:95], v[94:95], v[54:55] op_sel:[0,1] op_sel_hi:[1,1]
    v_cvt_pk_bf16_f32 v92, v92, v93
    v_cvt_pk_bf16_f32 v93, v94, v95
    buffer_store_dwordx2 v[88:89], v56, s[12:15], s40 offen offset:1024 sc0 sc1
    v_accvgpr_read_b32 v96, a96
    v_accvgpr_read_b32 v97, a108
    v_accvgpr_read_b32 v98, a120
    v_accvgpr_read_b32 v99, a132
    v_pk_mul_f32 v[96:97], v[96:97], v[128:129] op_sel_hi:[1,0]
    v_pk_mul_f32 v[98:99], v[98:99], v[128:129] op_sel_hi:[1,0]
    v_cvt_pk_bf16_f32 v96, v96, v97
    v_cvt_pk_bf16_f32 v97, v98, v99
    buffer_store_dwordx2 v[92:93], v56, s[12:15], s40 offen offset:1408 sc0 sc1
    v_accvgpr_read_b32 v100, a97
    v_accvgpr_read_b32 v101, a109
    v_accvgpr_read_b32 v102, a121
    v_accvgpr_read_b32 v103, a133
    v_pk_mul_f32 v[100:101], v[100:101], v[128:129] op_sel:[0,1] op_sel_hi:[1,1]
    v_pk_mul_f32 v[102:103], v[102:103], v[128:129] op_sel:[0,1] op_sel_hi:[1,1]
    v_cvt_pk_bf16_f32 v100, v100, v101
    v_cvt_pk_bf16_f32 v101, v102, v103
    buffer_store_dwordx2 v[96:97], v56, s[12:15], s41 offen offset:0 sc0 sc1
    v_accvgpr_read_b32 v104, a98
    v_accvgpr_read_b32 v105, a110
    v_accvgpr_read_b32 v106, a122
    v_accvgpr_read_b32 v107, a134
    v_pk_mul_f32 v[104:105], v[104:105], v[130:131] op_sel_hi:[1,0]
    v_pk_mul_f32 v[106:107], v[106:107], v[130:131] op_sel_hi:[1,0]
    v_cvt_pk_bf16_f32 v104, v104, v105
    v_cvt_pk_bf16_f32 v105, v106, v107
    buffer_store_dwordx2 v[100:101], v56, s[12:15], s41 offen offset:384 sc0 sc1
    v_accvgpr_read_b32 v108, a99
    v_accvgpr_read_b32 v109, a111
    v_accvgpr_read_b32 v110, a123
    v_accvgpr_read_b32 v111, a135
    v_pk_mul_f32 v[108:109], v[108:109], v[130:131] op_sel:[0,1] op_sel_hi:[1,1]
    v_pk_mul_f32 v[110:111], v[110:111], v[130:131] op_sel:[0,1] op_sel_hi:[1,1]
    v_cvt_pk_bf16_f32 v108, v108, v109
    v_cvt_pk_bf16_f32 v109, v110, v111
    buffer_store_dwordx2 v[104:105], v56, s[12:15], s41 offen offset:768 sc0 sc1
    v_accvgpr_read_b32 v112, a100
    v_accvgpr_read_b32 v113, a112
    v_accvgpr_read_b32 v114, a124
    v_accvgpr_read_b32 v115, a136
    v_pk_mul_f32 v[112:113], v[112:113], v[128:129] op_sel_hi:[1,0]
    v_pk_mul_f32 v[114:115], v[114:115], v[128:129] op_sel_hi:[1,0]
    v_cvt_pk_bf16_f32 v112, v112, v113
    v_cvt_pk_bf16_f32 v113, v114, v115
    buffer_store_dwordx2 v[108:109], v56, s[12:15], s41 offen offset:1152 sc0 sc1
    v_accvgpr_read_b32 v116, a101
    v_accvgpr_read_b32 v117, a113
    v_accvgpr_read_b32 v118, a125
    v_accvgpr_read_b32 v119, a137
    v_pk_mul_f32 v[116:117], v[116:117], v[128:129] op_sel:[0,1] op_sel_hi:[1,1]
    v_pk_mul_f32 v[118:119], v[118:119], v[128:129] op_sel:[0,1] op_sel_hi:[1,1]
    v_cvt_pk_bf16_f32 v116, v116, v117
    v_cvt_pk_bf16_f32 v117, v118, v119
    buffer_store_dwordx2 v[112:113], v56, s[12:15], s41 offen offset:128 sc0 sc1
    v_accvgpr_read_b32 v120, a102
    v_accvgpr_read_b32 v121, a114
    v_accvgpr_read_b32 v122, a126
    v_accvgpr_read_b32 v123, a138
    v_pk_mul_f32 v[120:121], v[120:121], v[130:131] op_sel_hi:[1,0]
    v_pk_mul_f32 v[122:123], v[122:123], v[130:131] op_sel_hi:[1,0]
    v_cvt_pk_bf16_f32 v120, v120, v121
    v_cvt_pk_bf16_f32 v121, v122, v123
    buffer_store_dwordx2 v[116:117], v56, s[12:15], s41 offen offset:512 sc0 sc1
    v_accvgpr_read_b32 v124, a103
    v_accvgpr_read_b32 v125, a115
    v_accvgpr_read_b32 v126, a127
    v_accvgpr_read_b32 v127, a139
    v_pk_mul_f32 v[124:125], v[124:125], v[130:131] op_sel:[0,1] op_sel_hi:[1,1]
    v_pk_mul_f32 v[126:127], v[126:127], v[130:131] op_sel:[0,1] op_sel_hi:[1,1]
    v_cvt_pk_bf16_f32 v124, v124, v125
    v_cvt_pk_bf16_f32 v125, v126, v127
    buffer_store_dwordx2 v[120:121], v56, s[12:15], s41 offen offset:896 sc0 sc1
    v_accvgpr_read_b32 v64, a104
    v_accvgpr_read_b32 v65, a116
    v_accvgpr_read_b32 v66, a128
    v_accvgpr_read_b32 v67, a140
    v_pk_mul_f32 v[64:65], v[64:65], v[128:129] op_sel_hi:[1,0]
    v_pk_mul_f32 v[66:67], v[66:67], v[128:129] op_sel_hi:[1,0]
    v_cvt_pk_bf16_f32 v64, v64, v65
    v_cvt_pk_bf16_f32 v65, v66, v67
    buffer_store_dwordx2 v[124:125], v56, s[12:15], s41 offen offset:1280 sc0 sc1
    v_accvgpr_read_b32 v68, a105
    v_accvgpr_read_b32 v69, a117
    v_accvgpr_read_b32 v70, a129
    v_accvgpr_read_b32 v71, a141
    v_pk_mul_f32 v[68:69], v[68:69], v[128:129] op_sel:[0,1] op_sel_hi:[1,1]
    v_pk_mul_f32 v[70:71], v[70:71], v[128:129] op_sel:[0,1] op_sel_hi:[1,1]
    v_cvt_pk_bf16_f32 v68, v68, v69
    v_cvt_pk_bf16_f32 v69, v70, v71
    buffer_store_dwordx2 v[64:65], v56, s[12:15], s41 offen offset:256 sc0 sc1
    v_accvgpr_read_b32 v72, a106
    v_accvgpr_read_b32 v73, a118
    v_accvgpr_read_b32 v74, a130
    v_accvgpr_read_b32 v75, a142
    v_pk_mul_f32 v[72:73], v[72:73], v[130:131] op_sel_hi:[1,0]
    v_pk_mul_f32 v[74:75], v[74:75], v[130:131] op_sel_hi:[1,0]
    v_cvt_pk_bf16_f32 v72, v72, v73
    v_cvt_pk_bf16_f32 v73, v74, v75
    buffer_store_dwordx2 v[68:69], v56, s[12:15], s41 offen offset:640 sc0 sc1
    v_accvgpr_read_b32 v76, a107
    v_accvgpr_read_b32 v77, a119
    v_accvgpr_read_b32 v78, a131
    v_accvgpr_read_b32 v79, a143
    v_pk_mul_f32 v[76:77], v[76:77], v[130:131] op_sel:[0,1] op_sel_hi:[1,1]
    v_pk_mul_f32 v[78:79], v[78:79], v[130:131] op_sel:[0,1] op_sel_hi:[1,1]
    v_cvt_pk_bf16_f32 v76, v76, v77
    v_cvt_pk_bf16_f32 v77, v78, v79
    buffer_store_dwordx2 v[72:73], v56, s[12:15], s41 offen offset:1024 sc0 sc1
    v_accvgpr_read_b32 v80, a144
    v_accvgpr_read_b32 v81, a156
    v_accvgpr_read_b32 v82, a168
    v_accvgpr_read_b32 v83, a180
    v_pk_mul_f32 v[80:81], v[80:81], v[132:133] op_sel_hi:[1,0]
    v_pk_mul_f32 v[82:83], v[82:83], v[132:133] op_sel_hi:[1,0]
    v_cvt_pk_bf16_f32 v80, v80, v81
    v_cvt_pk_bf16_f32 v81, v82, v83
    buffer_store_dwordx2 v[76:77], v56, s[12:15], s41 offen offset:1408 sc0 sc1
    v_accvgpr_read_b32 v84, a145
    v_accvgpr_read_b32 v85, a157
    v_accvgpr_read_b32 v86, a169
    v_accvgpr_read_b32 v87, a181
    v_pk_mul_f32 v[84:85], v[84:85], v[132:133] op_sel:[0,1] op_sel_hi:[1,1]
    v_pk_mul_f32 v[86:87], v[86:87], v[132:133] op_sel:[0,1] op_sel_hi:[1,1]
    v_cvt_pk_bf16_f32 v84, v84, v85
    v_cvt_pk_bf16_f32 v85, v86, v87
    buffer_store_dwordx2 v[80:81], v56, s[12:15], s42 offen offset:0 sc0 sc1
    v_accvgpr_read_b32 v88, a146
    v_accvgpr_read_b32 v89, a158
    v_accvgpr_read_b32 v90, a170
    v_accvgpr_read_b32 v91, a182
    v_pk_mul_f32 v[88:89], v[88:89], v[134:135] op_sel_hi:[1,0]
    v_pk_mul_f32 v[90:91], v[90:91], v[134:135] op_sel_hi:[1,0]
    v_cvt_pk_bf16_f32 v88, v88, v89
    v_cvt_pk_bf16_f32 v89, v90, v91
    buffer_store_dwordx2 v[84:85], v56, s[12:15], s42 offen offset:384 sc0 sc1
    v_accvgpr_read_b32 v92, a147
    v_accvgpr_read_b32 v93, a159
    v_accvgpr_read_b32 v94, a171
    v_accvgpr_read_b32 v95, a183
    v_pk_mul_f32 v[92:93], v[92:93], v[134:135] op_sel:[0,1] op_sel_hi:[1,1]
    v_pk_mul_f32 v[94:95], v[94:95], v[134:135] op_sel:[0,1] op_sel_hi:[1,1]
    v_cvt_pk_bf16_f32 v92, v92, v93
    v_cvt_pk_bf16_f32 v93, v94, v95
    buffer_store_dwordx2 v[88:89], v56, s[12:15], s42 offen offset:768 sc0 sc1
    v_accvgpr_read_b32 v96, a148
    v_accvgpr_read_b32 v97, a160
    v_accvgpr_read_b32 v98, a172
    v_accvgpr_read_b32 v99, a184
    v_pk_mul_f32 v[96:97], v[96:97], v[132:133] op_sel_hi:[1,0]
    v_pk_mul_f32 v[98:99], v[98:99], v[132:133] op_sel_hi:[1,0]
    v_cvt_pk_bf16_f32 v96, v96, v97
    v_cvt_pk_bf16_f32 v97, v98, v99
    buffer_store_dwordx2 v[92:93], v56, s[12:15], s42 offen offset:1152 sc0 sc1
    v_accvgpr_read_b32 v100, a149
    v_accvgpr_read_b32 v101, a161
    v_accvgpr_read_b32 v102, a173
    v_accvgpr_read_b32 v103, a185
    v_pk_mul_f32 v[100:101], v[100:101], v[132:133] op_sel:[0,1] op_sel_hi:[1,1]
    v_pk_mul_f32 v[102:103], v[102:103], v[132:133] op_sel:[0,1] op_sel_hi:[1,1]
    v_cvt_pk_bf16_f32 v100, v100, v101
    v_cvt_pk_bf16_f32 v101, v102, v103
    buffer_store_dwordx2 v[96:97], v56, s[12:15], s42 offen offset:128 sc0 sc1
    v_accvgpr_read_b32 v104, a150
    v_accvgpr_read_b32 v105, a162
    v_accvgpr_read_b32 v106, a174
    v_accvgpr_read_b32 v107, a186
    v_pk_mul_f32 v[104:105], v[104:105], v[134:135] op_sel_hi:[1,0]
    v_pk_mul_f32 v[106:107], v[106:107], v[134:135] op_sel_hi:[1,0]
    v_cvt_pk_bf16_f32 v104, v104, v105
    v_cvt_pk_bf16_f32 v105, v106, v107
    buffer_store_dwordx2 v[100:101], v56, s[12:15], s42 offen offset:512 sc0 sc1
    v_accvgpr_read_b32 v108, a151
    v_accvgpr_read_b32 v109, a163
    v_accvgpr_read_b32 v110, a175
    v_accvgpr_read_b32 v111, a187
    v_pk_mul_f32 v[108:109], v[108:109], v[134:135] op_sel:[0,1] op_sel_hi:[1,1]
    v_pk_mul_f32 v[110:111], v[110:111], v[134:135] op_sel:[0,1] op_sel_hi:[1,1]
    v_cvt_pk_bf16_f32 v108, v108, v109
    v_cvt_pk_bf16_f32 v109, v110, v111
    buffer_store_dwordx2 v[104:105], v56, s[12:15], s42 offen offset:896 sc0 sc1
    v_accvgpr_read_b32 v112, a152
    v_accvgpr_read_b32 v113, a164
    v_accvgpr_read_b32 v114, a176
    v_accvgpr_read_b32 v115, a188
    v_pk_mul_f32 v[112:113], v[112:113], v[132:133] op_sel_hi:[1,0]
    v_pk_mul_f32 v[114:115], v[114:115], v[132:133] op_sel_hi:[1,0]
    v_cvt_pk_bf16_f32 v112, v112, v113
    v_cvt_pk_bf16_f32 v113, v114, v115
    buffer_store_dwordx2 v[108:109], v56, s[12:15], s42 offen offset:1280 sc0 sc1
    v_accvgpr_read_b32 v116, a153
    v_accvgpr_read_b32 v117, a165
    v_accvgpr_read_b32 v118, a177
    v_accvgpr_read_b32 v119, a189
    v_pk_mul_f32 v[116:117], v[116:117], v[132:133] op_sel:[0,1] op_sel_hi:[1,1]
    v_pk_mul_f32 v[118:119], v[118:119], v[132:133] op_sel:[0,1] op_sel_hi:[1,1]
    v_cvt_pk_bf16_f32 v116, v116, v117
    v_cvt_pk_bf16_f32 v117, v118, v119
    buffer_store_dwordx2 v[112:113], v56, s[12:15], s42 offen offset:256 sc0 sc1
    v_accvgpr_read_b32 v120, a154
    v_accvgpr_read_b32 v121, a166
    v_accvgpr_read_b32 v122, a178
    v_accvgpr_read_b32 v123, a190
    v_pk_mul_f32 v[120:121], v[120:121], v[134:135] op_sel_hi:[1,0]
    v_pk_mul_f32 v[122:123], v[122:123], v[134:135] op_sel_hi:[1,0]
    v_cvt_pk_bf16_f32 v120, v120, v121
    v_cvt_pk_bf16_f32 v121, v122, v123
    buffer_store_dwordx2 v[116:117], v56, s[12:15], s42 offen offset:640 sc0 sc1
    v_accvgpr_read_b32 v124, a155
    v_accvgpr_read_b32 v125, a167
    v_accvgpr_read_b32 v126, a179
    v_accvgpr_read_b32 v127, a191
    v_pk_mul_f32 v[124:125], v[124:125], v[134:135] op_sel:[0,1] op_sel_hi:[1,1]
    v_pk_mul_f32 v[126:127], v[126:127], v[134:135] op_sel:[0,1] op_sel_hi:[1,1]
    v_cvt_pk_bf16_f32 v124, v124, v125
    v_cvt_pk_bf16_f32 v125, v126, v127
    buffer_store_dwordx2 v[120:121], v56, s[12:15], s42 offen offset:1024 sc0 sc1
    buffer_store_dwordx2 v[124:125], v56, s[12:15], s42 offen offset:1408 sc0 sc1
    s_branch L_fin
.section .rodata,"a"
.p2align 6
.amdhsa_kernel standalone__kv_cache_quant_int4_int2_kv_with_per_channel_or_per_token_scales__prompt_kernel
  .amdhsa_next_free_vgpr 512
  .amdhsa_next_free_sgpr 102
  .amdhsa_accum_offset 256
  .amdhsa_group_segment_fixed_size 0
  .amdhsa_kernarg_size 80
  .amdhsa_user_sgpr_count 2
  .amdhsa_user_sgpr_kernarg_segment_ptr 1
  .amdhsa_system_sgpr_workgroup_id_x 1
.end_amdhsa_kernel
```

```asm
; @launch grid=(256,1,1) block=(256,1,1) lds=147584
.amdgcn_target "amdgcn-amd-amdhsa--gfx950"
.text
.globl standalone__kv_cache_quant_int4_int2_kv_with_per_channel_or_per_token_scales__prompt_kernel
.p2align 8
.type standalone__kv_cache_quant_int4_int2_kv_with_per_channel_or_per_token_scales__prompt_kernel,@function
standalone__kv_cache_quant_int4_int2_kv_with_per_channel_or_per_token_scales__prompt_kernel:
    s_cmp_ge_u32 s2, 256
    s_cbranch_scc1 L_done
    s_load_dwordx16 s[40:55], s[0:1], 0
    s_load_dwordx4 s[16:19], s[0:1], 64
    s_and_b32 s94, s2, 7
    s_lshr_b32 s95, s2, 3
    s_lshr_b32 s24, s95, 3
    s_lshl_b32 s94, s94, 2
    s_add_u32 s94, s94, s24
    s_and_b32 s95, s95, 7
    s_getpc_b64 s[60:61]
L_pc:
    s_sub_u32 s60, s60, L_pc-standalone__kv_cache_quant_int4_int2_kv_with_per_channel_or_per_token_scales__prompt_kernel
    s_subb_u32 s61, s61, 0
    s_mov_b32 s62, L_slow-standalone__kv_cache_quant_int4_int2_kv_with_per_channel_or_per_token_scales__prompt_kernel
    s_mov_b32 s63, 0x20000
    s_lshr_b32 s22, s2, 3
    s_lshl_b32 s22, s22, 12
    v_lshlrev_b32 v30, 4, v0
    buffer_load_dwordx4 v[128:131], v30, s[60:63], s22 offen
    v_lshrrev_b32 v24, 6, v0
    v_and_b32 v25, 63, v0
    v_readfirstlane_b32 s25, v24
    v_lshlrev_b32 v1, 4, v25
    v_mul_u32_u24 v26, 43, v25
    v_lshrrev_b32 v26, 10, v26
    v_mul_u32_u24 v27, 24, v26
    v_sub_u32 v27, v25, v27
    v_lshrrev_b32 v28, 1, v24
    v_and_b32 v29, 1, v24
    v_lshlrev_b32 v30, 4, v29
    v_lshl_add_u32 v30, v28, 2, v30
    v_add_u32 v30, v30, v26
    v_mul_u32_u24 v30, 768, v30
    v_lshrrev_b32 v48, 1, v26
    v_lshlrev_b32 v48, 30, v48
    v_lshl_add_u32 v30, v27, 4, v30
    v_or_b32 v9, v30, v48
    v_lshl_or_b32 v10, v27, 3, v48
    v_mul_u32_u24 v30, 6144, v24
    v_add3_u32 v12, v30, v1, v48
    s_mov_b32 s66, 1572864
    s_mov_b32 s67, 0x20000
    s_mov_b32 s70, 1572864
    s_mov_b32 s71, 0x20000
    s_mov_b32 s74, 12288
    s_mov_b32 s75, 0x20000
    s_mov_b32 s78, 12288
    s_mov_b32 s79, 0x20000
    s_mov_b32 s82, 4096
    s_mov_b32 s83, 0x20000
    s_mov_b32 s86, 4096
    s_mov_b32 s87, 0x20000
    s_mov_b32 s22, 64
    s_mov_b32 s23, 0x20000
    s_mul_i32 s33, s95, 24576
    s_add_u32 s34, s33, 6144
    s_mov_b32 s35, s33
    s_lshr_b32 s36, s95, 1
    s_mul_i32 s36, s36, 384
    s_lshl_b32 s37, s95, 6
    s_lshl_b32 s24, s25, 4
    s_add_u32 s37, s37, s24
    s_mul_i32 s24, s94, 1572864
    s_mul_i32 s56, s94, 12288
    s_lshl_b32 s57, s94, 12
    s_lshl_b32 s58, s94, 10
    s_add_u32 s58, s58, 51380320
    s_or_b32 s39, s95, s25
    s_waitcnt lgkmcnt(0)
    s_add_u32 s64, s42, s24
    s_addc_u32 s65, s43, 0
    s_add_u32 s72, s46, s56
    s_addc_u32 s73, s47, 0
    s_add_u32 s76, s48, s56
    s_addc_u32 s77, s49, 0
    buffer_load_dwordx4 v[224:227], v9, s[64:67], s33 offen offset:0 nt
    buffer_load_dwordx4 v[228:231], v9, s[64:67], s33 offen offset:1536 nt
    buffer_load_dwordx4 v[232:235], v9, s[64:67], s34 offen offset:0 nt
    buffer_load_dwordx4 v[236:239], v9, s[64:67], s34 offen offset:1536 nt
    buffer_load_dwordx2 v[32:33], v10, s[72:75], s36 offen offset:0
    buffer_load_dwordx2 v[34:35], v10, s[76:79], s36 offen offset:0
    buffer_load_dwordx2 v[36:37], v10, s[72:75], s36 offen offset:192
    buffer_load_dwordx2 v[38:39], v10, s[76:79], s36 offen offset:192
    s_add_u32 s20, s18, s58
    s_addc_u32 s21, s19, 0
    s_add_u32 s80, s50, s57
    s_addc_u32 s81, s51, 0
    s_add_u32 s84, s52, s57
    s_addc_u32 s85, s53, 0
    s_add_u32 s68, s44, s24
    s_addc_u32 s69, s45, 0
    s_mul_i32 s59, s94, 786432
    s_add_u32 s12, s54, s59
    s_addc_u32 s13, s55, 0
    s_add_u32 s8, s40, s59
    s_addc_u32 s9, s41, 0
    s_cmp_lg_u32 s39, 0
    s_cbranch_scc1 L_notleader0
    s_buffer_load_dwordx16 s[40:55], s[20:23], 0 glc
L_notleader0:
    buffer_load_dwordx4 v[240:243], v9, s[64:67], s33 offen offset:384 nt
    buffer_load_dwordx4 v[244:247], v9, s[64:67], s33 offen offset:1920 nt
    buffer_load_dwordx4 v[248:251], v9, s[64:67], s34 offen offset:384 nt
    buffer_load_dwordx4 v[252:255], v9, s[64:67], s34 offen offset:1920 nt
    s_add_u32 s4, s18, s24
    s_addc_u32 s5, s19, 0
    s_mov_b32 s6, 1572864
    s_mov_b32 s7, 0x20000
    s_mov_b32 s10, 786432
    s_mov_b32 s11, 0x20000
    s_mov_b32 s88, s16
    s_mov_b32 s89, s17
    s_add_u32 s16, s33, 3072
    s_add_u32 s17, s33, 6144
    s_mov_b32 s90, 256
    s_mov_b32 s91, 0x20000
    s_lshl_b32 s93, s94, 3
    s_cmp_lg_u32 s39, 0
    s_cbranch_scc1 L_notleader
    s_waitcnt lgkmcnt(0)
    s_mov_b32 s59, 1
    s_lshr_b32 s40, s40, 10
    s_min_u32 s40, s40, 31
    s_bitset1_b32 s59, s40
    s_lshr_b32 s41, s41, 10
    s_min_u32 s41, s41, 31
    s_bitset1_b32 s59, s41
    s_lshr_b32 s42, s42, 10
    s_min_u32 s42, s42, 31
    s_bitset1_b32 s59, s42
    s_lshr_b32 s43, s43, 10
    s_min_u32 s43, s43, 31
    s_bitset1_b32 s59, s43
    s_lshr_b32 s44, s44, 10
    s_min_u32 s44, s44, 31
    s_bitset1_b32 s59, s44
    s_lshr_b32 s45, s45, 10
    s_min_u32 s45, s45, 31
    s_bitset1_b32 s59, s45
    s_lshr_b32 s46, s46, 10
    s_min_u32 s46, s46, 31
    s_bitset1_b32 s59, s46
    s_lshr_b32 s47, s47, 10
    s_min_u32 s47, s47, 31
    s_bitset1_b32 s59, s47
    s_lshr_b32 s48, s48, 10
    s_min_u32 s48, s48, 31
    s_bitset1_b32 s59, s48
    s_lshr_b32 s49, s49, 10
    s_min_u32 s49, s49, 31
    s_bitset1_b32 s59, s49
    s_lshr_b32 s50, s50, 10
    s_min_u32 s50, s50, 31
    s_bitset1_b32 s59, s50
    s_lshr_b32 s51, s51, 10
    s_min_u32 s51, s51, 31
    s_bitset1_b32 s59, s51
    s_lshr_b32 s52, s52, 10
    s_min_u32 s52, s52, 31
    s_bitset1_b32 s59, s52
    s_lshr_b32 s53, s53, 10
    s_min_u32 s53, s53, 31
    s_bitset1_b32 s59, s53
    s_lshr_b32 s54, s54, 10
    s_min_u32 s54, s54, 31
    s_bitset1_b32 s59, s54
    s_lshr_b32 s55, s55, 10
    s_min_u32 s55, s55, 31
    s_bitset1_b32 s59, s55
    s_ff0_i32_b32 s59, s59
    s_lshl_b32 s59, s59, 10
    v_mov_b32 v52, s59
    s_mov_b64 exec, 1
    buffer_store_dword v52, off, s[88:91], s93 sc1
    s_mov_b64 exec, -1
L_notleader:
    s_lshl_b32 s24, s95, 2
    s_add_u32 s24, s24, 32
    s_buffer_load_dword s46, s[20:23], s24 glc
    s_getreg_b32 s45, hwreg(HW_REG_XCC_ID, 0, 4)
    s_lshl_b32 s45, s45, 5
    s_mov_b32 s44, 32
    buffer_load_dwordx4 v[112:115], v12, s[68:71], s35 offen offset:0 nt
    buffer_load_dwordx4 v[116:119], v12, s[68:71], s35 offen offset:768 nt
    buffer_load_dwordx4 v[120:123], v12, s[68:71], s35 offen offset:1536 nt
    buffer_load_dwordx4 v[124:127], v12, s[68:71], s35 offen offset:2304 nt
    buffer_load_dwordx2 v[40:41], off, s[80:83], s37 offset:0
    buffer_load_dwordx2 v[42:43], off, s[84:87], s37 offset:0
    buffer_load_dwordx2 v[44:45], off, s[80:83], s37 offset:8
    buffer_load_dwordx2 v[46:47], off, s[84:87], s37 offset:8
    s_mov_b32 s14, 786432
    s_mov_b32 s15, 0x20000
    s_lshl_b32 s24, s25, 8
    s_add_u32 s93, s93, s24
    v_mul_u32_u24 v30, 3072, v24
    v_add_u32 v4, v30, v1
    v_lshl_add_u32 v30, v24, 3, v26
    v_mul_u32_u24 v30, 384, v30
    v_lshlrev_b32 v31, 2, v29
    v_xor_b32 v31, v27, v31
    v_lshl_add_u32 v30, v31, 4, v30
    v_or_b32 v11, v30, v48
    v_lshlrev_b32 v30, 8, v24
    v_add_u32 v30, 12288, v30
    v_lshrrev_b32 v31, 4, v25
    v_lshl_add_u32 v30, v31, 10, v30
    v_and_b32 v31, 15, v25
    v_lshl_add_u32 v30, v31, 4, v30
    v_or_b32 v15, v30, v48
    s_lshl_b32 s24, s95, 2
    v_lshl_add_u32 v13, v0, 2, s24
    v_cmp_lt_u32 vcc, 0, v0
    v_mov_b32 v30, 0x40000000
    s_nop 0
    v_cndmask_b32 v13, v13, v30, vcc
    s_mul_i32 s26, s25, 3072
    s_add_u32 s26, s26, 12288
    s_add_u32 s56, s26, 24576
    s_add_u32 s24, s95, 1
    s_and_b32 s24, s24, 7
    s_mul_i32 s32, s24, 24576
    s_add_u32 s27, s32, 12288
    s_mov_b32 s28, 98304
    s_mov_b32 s30, 73728
    v_add_u32 v1, 24576, v1
    s_mov_b32 s38, 0x3dd53b95
    s_mov_b32 s97, 0xffff0000
    s_mov_b32 s96, 100000
    v_and_b32 v26, 15, v25
    v_lshrrev_b32 v27, 4, v25
    v_bfe_u32 v28, v25, 1, 3
    v_xor_b32 v29, v27, v28
    v_mul_u32_u24 v30, 384, v26
    v_lshl_add_u32 v2, v29, 4, v30
    v_xor_b32 v3, 64, v2
    s_mul_i32 s40, s25, 6144
    s_add_u32 s40, s40, 73728
    v_lshrrev_b32 v29, 1, v27
    v_xor_b32 v29, v29, v28
    v_lshl_add_u32 v31, v29, 4, v30
    v_and_b32 v29, 1, v27
    v_lshl_add_u32 v31, v29, 3, v31
    v_xor_b32 v22, 0, v31
    v_add_u32 v22, s40, v22
    v_xor_b32 v23, 32, v31
    v_add_u32 v23, s40, v23
    v_xor_b32 v142, 64, v31
    v_add_u32 v142, s40, v142
    v_xor_b32 v143, 96, v31
    v_add_u32 v143, s40, v143
    s_lshl_b32 s24, s95, 2
    s_add_u32 s24, s24, s25
    s_mul_i32 s24, s24, 24576
    v_add_u32 v26, 0, v25
    v_mul_u32_u24 v27, 2731, v26
    v_lshrrev_b32 v27, 17, v27
    v_and_b32 v27, 7, v27
    v_xor_b32 v26, v26, v27
    v_lshlrev_b32 v136, 4, v26
    v_add_u32 v136, s24, v136
    v_add_u32 v26, 64, v25
    v_mul_u32_u24 v27, 2731, v26
    v_lshrrev_b32 v27, 17, v27
    v_and_b32 v27, 7, v27
    v_xor_b32 v26, v26, v27
    v_lshlrev_b32 v137, 4, v26
    v_add_u32 v137, s24, v137
    v_add_u32 v26, 128, v25
    v_mul_u32_u24 v27, 2731, v26
    v_lshrrev_b32 v27, 17, v27
    v_and_b32 v27, 7, v27
    v_xor_b32 v26, v26, v27
    v_lshlrev_b32 v138, 4, v26
    v_add_u32 v138, s24, v138
    v_add_u32 v26, 192, v25
    v_mul_u32_u24 v27, 2731, v26
    v_lshrrev_b32 v27, 17, v27
    v_and_b32 v27, 7, v27
    v_xor_b32 v26, v26, v27
    v_lshlrev_b32 v139, 4, v26
    v_add_u32 v139, s24, v139
    v_add_u32 v26, 256, v25
    v_mul_u32_u24 v27, 2731, v26
    v_lshrrev_b32 v27, 17, v27
    v_and_b32 v27, 7, v27
    v_xor_b32 v26, v26, v27
    v_lshlrev_b32 v140, 4, v26
    v_add_u32 v140, s24, v140
    v_add_u32 v26, 320, v25
    v_mul_u32_u24 v27, 2731, v26
    v_lshrrev_b32 v27, 17, v27
    v_and_b32 v27, 7, v27
    v_xor_b32 v26, v26, v27
    v_lshlrev_b32 v141, 4, v26
    v_add_u32 v141, s24, v141
    v_mov_b32 v5, 0
    v_mov_b32 v6, 0
    v_mov_b32 v7, 0
    v_mov_b32 v8, 0
    s_mov_b32 s62, -1
    s_mov_b32 s63, 0xffff
    s_waitcnt vmcnt(12)
    buffer_load_dwordx4 v[80:83], v12, s[68:71], s16 offen offset:0 nt
    buffer_load_dwordx4 v[84:87], v12, s[68:71], s16 offen offset:768 nt
    buffer_load_dwordx4 v[88:91], v12, s[68:71], s16 offen offset:1536 nt
    buffer_load_dwordx4 v[92:95], v12, s[68:71], s16 offen offset:2304 nt
    v_lshlrev_b32 v48, 16, v32
    v_and_b32 v49, s97, v32
    v_lshlrev_b32 v50, 16, v34
    v_and_b32 v51, s97, v34
    v_mul_f32 v48, s38, v48
    v_mul_f32 v49, s38, v49
    v_mul_f32_e64 v50, -v50, v48
    v_mul_f32_e64 v51, -v51, v49
    v_cvt_f32_i32 v224, v224
    v_cvt_f32_i32 v225, v225
    v_fma_f32 v224, v224, v48, v50
    v_fma_f32 v225, v225, v49, v51
    v_cvt_pk_bf16_f32 v224, v224, v225
    v_cvt_f32_i32 v228, v228
    v_cvt_f32_i32 v229, v229
    v_fma_f32 v228, v228, v48, v50
    v_fma_f32 v229, v229, v49, v51
    v_cvt_pk_bf16_f32 v228, v228, v229
    v_cvt_f32_i32 v232, v232
    v_cvt_f32_i32 v233, v233
    v_fma_f32 v232, v232, v48, v50
    v_fma_f32 v233, v233, v49, v51
    v_cvt_pk_bf16_f32 v232, v232, v233
    v_cvt_f32_i32 v236, v236
    v_cvt_f32_i32 v237, v237
    v_fma_f32 v236, v236, v48, v50
    v_fma_f32 v237, v237, v49, v51
    v_cvt_pk_bf16_f32 v236, v236, v237
    v_lshlrev_b32 v48, 16, v33
    v_and_b32 v49, s97, v33
    v_lshlrev_b32 v50, 16, v35
    v_and_b32 v51, s97, v35
    v_mul_f32 v48, s38, v48
    v_mul_f32 v49, s38, v49
    v_mul_f32_e64 v50, -v50, v48
    v_mul_f32_e64 v51, -v51, v49
    v_cvt_f32_i32 v226, v226
    v_cvt_f32_i32 v227, v227
    v_fma_f32 v226, v226, v48, v50
    v_fma_f32 v227, v227, v49, v51
    v_cvt_pk_bf16_f32 v225, v226, v227
    v_cvt_f32_i32 v230, v230
    v_cvt_f32_i32 v231, v231
    v_fma_f32 v230, v230, v48, v50
    v_fma_f32 v231, v231, v49, v51
    v_cvt_pk_bf16_f32 v229, v230, v231
    v_cvt_f32_i32 v234, v234
    v_cvt_f32_i32 v235, v235
    v_fma_f32 v234, v234, v48, v50
    v_fma_f32 v235, v235, v49, v51
    v_cvt_pk_bf16_f32 v233, v234, v235
    v_cvt_f32_i32 v238, v238
    v_cvt_f32_i32 v239, v239
    v_fma_f32 v238, v238, v48, v50
    v_fma_f32 v239, v239, v49, v51
    v_cvt_pk_bf16_f32 v237, v238, v239
    s_waitcnt vmcnt(12)
    v_lshlrev_b32 v48, 16, v36
    v_and_b32 v49, s97, v36
    v_lshlrev_b32 v50, 16, v38
    v_and_b32 v51, s97, v38
    v_mul_f32 v48, s38, v48
    v_mul_f32 v49, s38, v49
    v_mul_f32_e64 v50, -v50, v48
    v_mul_f32_e64 v51, -v51, v49
    v_cvt_f32_i32 v240, v240
    v_cvt_f32_i32 v241, v241
    v_fma_f32 v240, v240, v48, v50
    v_fma_f32 v241, v241, v49, v51
    v_cvt_pk_bf16_f32 v226, v240, v241
    v_cvt_f32_i32 v244, v244
    v_cvt_f32_i32 v245, v245
    v_fma_f32 v244, v244, v48, v50
    v_fma_f32 v245, v245, v49, v51
    v_cvt_pk_bf16_f32 v230, v244, v245
    v_cvt_f32_i32 v248, v248
    v_cvt_f32_i32 v249, v249
    v_fma_f32 v248, v248, v48, v50
    v_fma_f32 v249, v249, v49, v51
    v_cvt_pk_bf16_f32 v234, v248, v249
    v_cvt_f32_i32 v252, v252
    v_cvt_f32_i32 v253, v253
    v_fma_f32 v252, v252, v48, v50
    v_fma_f32 v253, v253, v49, v51
    v_cvt_pk_bf16_f32 v238, v252, v253
    v_lshlrev_b32 v48, 16, v37
    v_and_b32 v49, s97, v37
    v_lshlrev_b32 v50, 16, v39
    v_and_b32 v51, s97, v39
    v_mul_f32 v48, s38, v48
    v_mul_f32 v49, s38, v49
    v_mul_f32_e64 v50, -v50, v48
    v_mul_f32_e64 v51, -v51, v49
    v_cvt_f32_i32 v242, v242
    v_cvt_f32_i32 v243, v243
    v_fma_f32 v242, v242, v48, v50
    v_fma_f32 v243, v243, v49, v51
    v_cvt_pk_bf16_f32 v227, v242, v243
    v_cvt_f32_i32 v246, v246
    v_cvt_f32_i32 v247, v247
    v_fma_f32 v246, v246, v48, v50
    v_fma_f32 v247, v247, v49, v51
    v_cvt_pk_bf16_f32 v231, v246, v247
    v_cvt_f32_i32 v250, v250
    v_cvt_f32_i32 v251, v251
    v_fma_f32 v250, v250, v48, v50
    v_fma_f32 v251, v251, v49, v51
    v_cvt_pk_bf16_f32 v235, v250, v251
    v_cvt_f32_i32 v254, v254
    v_cvt_f32_i32 v255, v255
    v_fma_f32 v254, v254, v48, v50
    v_fma_f32 v255, v255, v49, v51
    v_cvt_pk_bf16_f32 v239, v254, v255
    buffer_store_dwordx4 v[224:227], v11, s[4:7], s33 offen offset:0
    s_mov_b64 exec, s[62:63]
    ds_write_b128 v11, v[224:227] offset:0
    s_mov_b64 exec, -1
    v_xor_b32 v55, 16, v11
    buffer_store_dwordx4 v[228:231], v55, s[4:7], s33 offen offset:768
    s_mov_b64 exec, s[62:63]
    ds_write_b128 v55, v[228:231] offset:768
    s_mov_b64 exec, -1
    v_xor_b32 v54, 32, v11
    buffer_store_dwordx4 v[232:235], v54, s[4:7], s33 offen offset:1536
    s_mov_b64 exec, s[62:63]
    ds_write_b128 v54, v[232:235] offset:1536
    s_mov_b64 exec, -1
    v_xor_b32 v55, 48, v11
    buffer_store_dwordx4 v[236:239], v55, s[4:7], s33 offen offset:2304
    s_mov_b64 exec, s[62:63]
    ds_write_b128 v55, v[236:239] offset:2304
    s_mov_b64 exec, -1
    s_mov_b32 s41, 0
    s_add_u32 m0, s40, 24576
    s_nop 0
    buffer_load_dwordx4 v136, s[8:11], s41 offen nt lds
    s_add_u32 m0, s40, 25600
    s_nop 0
    buffer_load_dwordx4 v137, s[8:11], s41 offen nt lds
    s_add_u32 m0, s40, 26624
    s_nop 0
    buffer_load_dwordx4 v138, s[8:11], s41 offen nt lds
    s_add_u32 m0, s40, 27648
    s_nop 0
    buffer_load_dwordx4 v139, s[8:11], s41 offen nt lds
    s_add_u32 m0, s40, 28672
    s_nop 0
    buffer_load_dwordx4 v140, s[8:11], s41 offen nt lds
    s_add_u32 m0, s40, 29696
    s_waitcnt vmcnt(20)
    buffer_load_dwordx4 v141, s[8:11], s41 offen nt lds
    s_waitcnt vmcnt(14)
    v_lshlrev_b32 v48, 16, v40
    v_and_b32 v49, s97, v40
    v_lshlrev_b32 v50, 16, v42
    v_and_b32 v51, s97, v42
    v_mul_f32_e64 v50, -v50, v48
    v_mul_f32_e64 v51, -v51, v49
    v_cvt_f32_i32 v112, v112
    v_cvt_f32_i32 v116, v116
    v_fma_f32 v112, v112, v48, v50
    v_fma_f32 v116, v116, v49, v51
    v_cvt_f32_i32 v113, v113
    v_cvt_f32_i32 v117, v117
    v_fma_f32 v113, v113, v48, v50
    v_fma_f32 v117, v117, v49, v51
    v_cvt_f32_i32 v114, v114
    v_cvt_f32_i32 v118, v118
    v_fma_f32 v114, v114, v48, v50
    v_fma_f32 v118, v118, v49, v51
    v_cvt_f32_i32 v115, v115
    v_cvt_f32_i32 v119, v119
    v_fma_f32 v115, v115, v48, v50
    v_fma_f32 v119, v119, v49, v51
    v_lshlrev_b32 v48, 16, v41
    v_and_b32 v49, s97, v41
    v_lshlrev_b32 v50, 16, v43
    v_and_b32 v51, s97, v43
    v_mul_f32_e64 v50, -v50, v48
    v_mul_f32_e64 v51, -v51, v49
    v_cvt_f32_i32 v120, v120
    v_cvt_f32_i32 v124, v124
    v_fma_f32 v120, v120, v48, v50
    v_fma_f32 v124, v124, v49, v51
    v_cvt_f32_i32 v121, v121
    v_cvt_f32_i32 v125, v125
    v_fma_f32 v121, v121, v48, v50
    v_fma_f32 v125, v125, v49, v51
    v_cvt_f32_i32 v122, v122
    v_cvt_f32_i32 v126, v126
    v_fma_f32 v122, v122, v48, v50
    v_fma_f32 v126, v126, v49, v51
    v_cvt_f32_i32 v123, v123
    v_cvt_f32_i32 v127, v127
    v_fma_f32 v123, v123, v48, v50
    v_fma_f32 v127, v127, v49, v51
    v_cvt_pk_bf16_f32 v112, v112, v116
    v_cvt_pk_bf16_f32 v116, v113, v117
    v_cvt_pk_bf16_f32 v113, v120, v124
    v_cvt_pk_bf16_f32 v117, v121, v125
    v_cvt_pk_bf16_f32 v120, v114, v118
    v_cvt_pk_bf16_f32 v121, v122, v126
    v_cvt_pk_bf16_f32 v124, v115, v119
    v_cvt_pk_bf16_f32 v125, v123, v127
    s_waitcnt vmcnt(10)
    v_lshlrev_b32 v48, 16, v44
    v_and_b32 v49, s97, v44
    v_lshlrev_b32 v50, 16, v46
    v_and_b32 v51, s97, v46
    v_mul_f32_e64 v50, -v50, v48
    v_mul_f32_e64 v51, -v51, v49
    v_cvt_f32_i32 v80, v80
    v_cvt_f32_i32 v84, v84
    v_fma_f32 v80, v80, v48, v50
    v_fma_f32 v84, v84, v49, v51
    v_cvt_f32_i32 v81, v81
    v_cvt_f32_i32 v85, v85
    v_fma_f32 v81, v81, v48, v50
    v_fma_f32 v85, v85, v49, v51
    v_cvt_f32_i32 v82, v82
    v_cvt_f32_i32 v86, v86
    v_fma_f32 v82, v82, v48, v50
    v_fma_f32 v86, v86, v49, v51
    v_cvt_f32_i32 v83, v83
    v_cvt_f32_i32 v87, v87
    v_fma_f32 v83, v83, v48, v50
    v_fma_f32 v87, v87, v49, v51
    v_lshlrev_b32 v48, 16, v45
    v_and_b32 v49, s97, v45
    v_lshlrev_b32 v50, 16, v47
    v_and_b32 v51, s97, v47
    v_mul_f32_e64 v50, -v50, v48
    v_mul_f32_e64 v51, -v51, v49
    v_cvt_f32_i32 v88, v88
    v_cvt_f32_i32 v92, v92
    v_fma_f32 v88, v88, v48, v50
    v_fma_f32 v92, v92, v49, v51
    v_cvt_f32_i32 v89, v89
    v_cvt_f32_i32 v93, v93
    v_fma_f32 v89, v89, v48, v50
    v_fma_f32 v93, v93, v49, v51
    v_cvt_f32_i32 v90, v90
    v_cvt_f32_i32 v94, v94
    v_fma_f32 v90, v90, v48, v50
    v_fma_f32 v94, v94, v49, v51
    v_cvt_f32_i32 v91, v91
    v_cvt_f32_i32 v95, v95
    v_fma_f32 v91, v91, v48, v50
    v_fma_f32 v95, v95, v49, v51
    v_cvt_pk_bf16_f32 v114, v80, v84
    v_cvt_pk_bf16_f32 v118, v81, v85
    v_cvt_pk_bf16_f32 v115, v88, v92
    v_cvt_pk_bf16_f32 v119, v89, v93
    v_cvt_pk_bf16_f32 v122, v82, v86
    v_cvt_pk_bf16_f32 v123, v90, v94
    v_cvt_pk_bf16_f32 v126, v83, v87
    v_cvt_pk_bf16_f32 v127, v91, v95
    buffer_store_dwordx4 v[112:115], v15, s[4:7], s35 offen offset:0
    buffer_store_dwordx4 v[116:119], v15, s[4:7], s35 offen offset:3072
    buffer_store_dwordx4 v[120:123], v15, s[4:7], s17 offen offset:0
    buffer_store_dwordx4 v[124:127], v15, s[4:7], s17 offen offset:3072
    s_mov_b64 exec, s[62:63]
    ds_write_b128 v15, v[112:115] offset:12288
    ds_write_b128 v15, v[116:119] offset:15360
    ds_write_b128 v15, v[120:123] offset:18432
    ds_write_b128 v15, v[124:127] offset:21504
    s_mov_b64 exec, -1
    buffer_load_dword v0, off, s[88:91], s93 sc1
    s_mov_b32 s41, 6144
    s_add_u32 m0, s40, 0
    s_nop 0
    buffer_load_dwordx4 v136, s[8:11], s41 offen nt lds
    s_add_u32 m0, s40, 1024
    s_nop 0
    buffer_load_dwordx4 v137, s[8:11], s41 offen nt lds
    s_add_u32 m0, s40, 2048
    s_nop 0
    buffer_load_dwordx4 v138, s[8:11], s41 offen nt lds
    s_add_u32 m0, s40, 3072
    s_nop 0
    buffer_load_dwordx4 v139, s[8:11], s41 offen nt lds
    s_add_u32 m0, s40, 4096
    s_nop 0
    buffer_load_dwordx4 v140, s[8:11], s41 offen nt lds
    s_add_u32 m0, s40, 5120
    s_waitcnt vmcnt(15)
    buffer_load_dwordx4 v141, s[8:11], s41 offen nt lds
    s_mov_b64 exec, 0
    s_cmp_eq_u32 s25, 0
    s_cbranch_scc1 L_iw0
    s_cmp_eq_u32 s25, 1
    s_cbranch_scc1 L_iw1
    s_cmp_eq_u32 s25, 2
    s_cbranch_scc1 L_iw2
    s_branch L_iw3
L_iwret:
    s_mov_b64 exec, -1
    s_waitcnt vmcnt(6)
    s_cmp_lg_u32 s25, 0
    s_cbranch_scc1 L_tagdone
    v_readfirstlane_b32 s42, v0
    s_mov_b32 s39, 100
    s_waitcnt lgkmcnt(0)
    s_and_b32 s46, s46, 0xfffffc00
L_tagretry:
    s_cmp_eq_u32 s42, s46
    s_cselect_b32 s42, 0, s42
    s_cmp_lg_u32 s42, 0
    s_cbranch_scc1 L_tagok
    s_sub_u32 s39, s39, 1
    s_cbranch_scc1 L_tagslow
    s_sleep 4
    s_buffer_load_dword s42, s[88:91], s93 glc
    s_waitcnt lgkmcnt(0)
    s_branch L_tagretry
L_tagok:
    s_add_u32 s42, s42, s45
    v_mov_b32 v0, s42
    v_mov_b32 v16, 147456
    ds_write_b32 v16, v0
L_tagdone:
    s_waitcnt lgkmcnt(0)
    s_barrier
    v_add_u32 v0, 1, v0
    buffer_store_dword v0, v13, s[20:23], 0 offen offset:32 sc1
    v_mov_b32 v16, 147456
    ds_read_b32 v17, v16
    s_mov_b32 s88, s60
    s_mov_b32 s89, s61
    s_mov_b32 s90, L_slow-standalone__kv_cache_quant_int4_int2_kv_with_per_channel_or_per_token_scales__prompt_kernel
    s_lshr_b32 s24, s2, 3
    s_mul_i32 s93, s24, 43
    s_lshr_b32 s93, s93, 7
    s_mul_i32 s39, s93, 3
    s_sub_u32 s24, s24, s39
    s_lshl_b32 s24, s24, 10
    s_mul_i32 s93, s93, 12288
    s_add_u32 s93, s93, s24
    ds_read_b128 v[144:147], v2 offset:0
    ds_read_b128 v[148:151], v3 offset:0
    ds_read_b128 v[152:155], v2 offset:6144
    ds_read_b128 v[156:159], v3 offset:6144
    ds_read_b128 v[160:163], v2 offset:128
    ds_read_b128 v[164:167], v3 offset:128
    ds_read_b128 v[168:171], v2 offset:6272
    ds_read_b128 v[172:175], v3 offset:6272
    ds_read_b128 v[176:179], v2 offset:256
    ds_read_b128 v[180:183], v3 offset:256
    ds_read_b128 v[184:187], v2 offset:6400
    ds_read_b128 v[188:191], v3 offset:6400
    s_waitcnt vmcnt(12)
    ds_read_b64 a[192:193], v22 offset:24576
    ds_read_b64 a[194:195], v142 offset:24704
    ds_read_b64 a[196:197], v23 offset:24576
    ds_read_b64 a[198:199], v143 offset:24704
    ds_read_b64 a[200:201], v142 offset:24576
    ds_read_b64 a[202:203], v22 offset:24832
    ds_read_b64 a[204:205], v143 offset:24576
    ds_read_b64 a[206:207], v23 offset:24832
    ds_read_b64 a[208:209], v22 offset:24704
    ds_read_b64 a[210:211], v142 offset:24832
    ds_read_b64 a[212:213], v23 offset:24704
    ds_read_b64 a[214:215], v143 offset:24832
    s_waitcnt lgkmcnt(15)
    v_readfirstlane_b32 s92, v17
    s_add_u32 s92, s92, 1
    s_mov_b32 s41, 12288
    s_add_u32 m0, s40, 49152
    s_nop 0
    buffer_load_dwordx4 v136, s[8:11], s41 offen nt lds
    s_add_u32 m0, s40, 50176
    s_nop 0
    buffer_load_dwordx4 v137, s[8:11], s41 offen nt lds
    s_add_u32 m0, s40, 51200
    s_nop 0
    buffer_load_dwordx4 v138, s[8:11], s41 offen nt lds
    s_waitcnt lgkmcnt(0)
    v_mfma_f32_16x16x32_bf16 v[64:67], v[144:147], a[192:195], 0
    v_mfma_f32_16x16x32_bf16 v[64:67], v[148:151], a[196:199], v[64:67]
    v_mfma_f32_16x16x32_bf16 v[64:67], v[160:163], a[200:203], v[64:67]
    v_mfma_f32_16x16x32_bf16 v[64:67], v[164:167], a[204:207], v[64:67]
    v_mfma_f32_16x16x32_bf16 v[64:67], v[176:179], a[208:211], v[64:67]
    v_mfma_f32_16x16x32_bf16 v[64:67], v[180:183], a[212:215], v[64:67]
    v_mfma_f32_16x16x32_bf16 v[96:99], v[152:155], a[192:195], 0
    v_mfma_f32_16x16x32_bf16 v[96:99], v[156:159], a[196:199], v[96:99]
    v_mfma_f32_16x16x32_bf16 v[96:99], v[168:171], a[200:203], v[96:99]
    v_mfma_f32_16x16x32_bf16 v[96:99], v[172:175], a[204:207], v[96:99]
    v_mfma_f32_16x16x32_bf16 v[96:99], v[184:187], a[208:211], v[96:99]
    v_mfma_f32_16x16x32_bf16 v[96:99], v[188:191], a[212:215], v[96:99]
    s_nop 7
    v_max3_f32 v48, v64, v65, v66
    v_max3_f32 v50, v67, v96, v97
    v_max3_f32 v48, v48, v98, v99
    v_max_f32 v48, v48, v50
    v_mov_b32 v49, v48
    s_nop 1
    v_permlane16_swap_b32 v48, v49
    s_nop 1
    v_max_f32 v48, v48, v49
    v_mov_b32 v49, v48
    s_nop 1
    v_permlane32_swap_b32 v48, v49
    s_nop 1
    v_max_f32 v48, v48, v49
    v_sub_f32 v64, v64, v48
L_iw0:
L_pg0:
    s_cbranch_execz L_pg4
    v_sub_f32 v65, v65, v48
    v_sub_f32 v66, v66, v48
    v_sub_f32 v67, v67, v48
    v_sub_f32 v96, v96, v48
    v_sub_f32 v97, v97, v48
    v_sub_f32 v98, v98, v48
    v_sub_f32 v99, v99, v48
    v_exp_f32 v64, v64
    v_exp_f32 v65, v65
    v_exp_f32 v66, v66
    v_exp_f32 v67, v67
    v_exp_f32 v96, v96
    v_exp_f32 v97, v97
    v_exp_f32 v98, v98
    v_exp_f32 v99, v99
    v_sub_f32 v128, 0, v48
    v_sub_f32 v129, 0, v48
    v_sub_f32 v130, 0, v48
    v_sub_f32 v131, 0, v48
    v_add_f32 v5, v5, v64
    v_add_f32 v5, v5, v65
    v_add_f32 v5, v5, v66
    v_add_f32 v5, v5, v67
    v_add_f32 v5, v5, v96
    v_add_f32 v5, v5, v97
    v_add_f32 v5, v5, v98
    v_add_f32 v5, v5, v99
    v_cvt_pk_bf16_f32 v64, v64, v65
    v_cvt_pk_bf16_f32 v65, v66, v67
    v_cvt_pk_bf16_f32 v66, v96, v97
    v_cvt_pk_bf16_f32 v67, v98, v99
    s_waitcnt vmcnt(4)
    ds_read_b64 a[216:217], v22 offset:0
    ds_read_b64 a[218:219], v142 offset:128
    ds_read_b64 a[220:221], v23 offset:0
    ds_read_b64 a[222:223], v143 offset:128
    ds_read_b64 a[224:225], v142 offset:0
    ds_read_b64 a[226:227], v22 offset:256
    ds_read_b64 a[228:229], v143 offset:0
    ds_read_b64 a[230:231], v23 offset:256
    ds_read_b64 a[232:233], v22 offset:128
    ds_read_b64 a[234:235], v142 offset:256
    ds_read_b64 a[236:237], v23 offset:128
    ds_read_b64 a[238:239], v143 offset:256
    s_mov_b32 s41, 12288
    s_add_u32 m0, s40, 52224
    s_nop 0
    buffer_load_dwordx4 v139, s[8:11], s41 offen nt lds
    s_add_u32 m0, s40, 53248
    s_nop 0
    buffer_load_dwordx4 v140, s[8:11], s41 offen nt lds
    s_add_u32 m0, s40, 54272
    s_nop 0
    buffer_load_dwordx4 v141, s[8:11], s41 offen nt lds
    s_waitcnt lgkmcnt(0)
    v_mfma_f32_16x16x32_bf16 v[68:71], v[144:147], a[216:219], 0
    v_mfma_f32_16x16x32_bf16 v[68:71], v[148:151], a[220:223], v[68:71]
    v_mfma_f32_16x16x32_bf16 v[68:71], v[160:163], a[224:227], v[68:71]
    v_mfma_f32_16x16x32_bf16 v[68:71], v[164:167], a[228:231], v[68:71]
    v_mfma_f32_16x16x32_bf16 v[68:71], v[176:179], a[232:235], v[68:71]
    v_mfma_f32_16x16x32_bf16 v[68:71], v[180:183], a[236:239], v[68:71]
    v_mfma_f32_16x16x32_bf16 v[100:103], v[152:155], a[216:219], 0
    v_mfma_f32_16x16x32_bf16 v[100:103], v[156:159], a[220:223], v[100:103]
    v_mfma_f32_16x16x32_bf16 v[100:103], v[168:171], a[224:227], v[100:103]
    v_mfma_f32_16x16x32_bf16 v[100:103], v[172:175], a[228:231], v[100:103]
    v_mfma_f32_16x16x32_bf16 v[100:103], v[184:187], a[232:235], v[100:103]
    v_mfma_f32_16x16x32_bf16 v[100:103], v[188:191], a[236:239], v[100:103]
    s_nop 7
    ds_read_b128 v[24:27], v1 offset:0
    ds_read_b128 v[28:31], v1 offset:1024
    ds_read_b128 v[32:35], v1 offset:2048
    ds_read_b128 v[36:39], v1 offset:3072
    s_mov_b32 s41, 18432
    s_add_u32 m0, s40, 24576
    s_nop 0
    buffer_load_dwordx4 v136, s[8:11], s41 offen nt lds
    v_max3_f32 v48, v68, v69, v70
    v_max3_f32 v50, v71, v100, v101
    v_max3_f32 v48, v48, v102, v103
    v_max_f32 v48, v48, v50
    v_mov_b32 v49, v48
    s_nop 1
    v_permlane16_swap_b32 v48, v49
    s_nop 1
    v_max_f32 v48, v48, v49
    v_mov_b32 v49, v48
    s_nop 1
    v_permlane32_swap_b32 v48, v49
    s_nop 1
    v_max_f32 v48, v48, v49
    v_sub_f32 v68, v68, v48
    v_sub_f32 v69, v69, v48
    s_add_u32 m0, s40, 25600
    s_nop 0
    buffer_load_dwordx4 v137, s[8:11], s41 offen nt lds
    v_sub_f32 v70, v70, v48
    v_sub_f32 v71, v71, v48
    v_sub_f32 v100, v100, v48
    v_sub_f32 v101, v101, v48
    v_sub_f32 v102, v102, v48
    v_sub_f32 v103, v103, v48
    v_exp_f32 v68, v68
    v_exp_f32 v69, v69
    v_exp_f32 v70, v70
    v_exp_f32 v71, v71
    v_exp_f32 v100, v100
    v_exp_f32 v101, v101
    v_exp_f32 v102, v102
    v_exp_f32 v103, v103
    v_sub_f32 v132, 0, v48
    s_add_u32 m0, s40, 26624
    s_nop 0
    buffer_load_dwordx4 v138, s[8:11], s41 offen nt lds
    v_sub_f32 v133, 0, v48
    v_sub_f32 v134, 0, v48
    v_sub_f32 v135, 0, v48
    v_add_f32 v6, v6, v68
    v_add_f32 v6, v6, v69
    v_add_f32 v6, v6, v70
    v_add_f32 v6, v6, v71
    v_add_f32 v6, v6, v100
    v_add_f32 v6, v6, v101
    v_add_f32 v6, v6, v102
    v_add_f32 v6, v6, v103
    v_cvt_pk_bf16_f32 v68, v68, v69
    v_cvt_pk_bf16_f32 v69, v70, v71
    v_cvt_pk_bf16_f32 v70, v100, v101
    v_cvt_pk_bf16_f32 v71, v102, v103
    s_buffer_load_dwordx8 s[48:55], s[20:23], s44 glc
    s_waitcnt lgkmcnt(2)
    v_mfma_f32_16x16x32_bf16 a[0:3], v[64:67], v[24:27], 0
    ds_read_b128 v[40:43], v1 offset:4096
    v_mfma_f32_16x16x32_bf16 a[4:7], v[64:67], v[28:31], 0
    v_mfma_f32_16x16x32_bf16 a[48:51], v[68:71], v[24:27], 0
    ds_read_b128 v[44:47], v1 offset:5120
    v_mfma_f32_16x16x32_bf16 a[52:55], v[68:71], v[28:31], 0
    s_waitcnt lgkmcnt(2)
    v_mfma_f32_16x16x32_bf16 a[8:11], v[64:67], v[32:35], 0
    ds_read_b128 v[24:27], v1 offset:6144
    v_mfma_f32_16x16x32_bf16 a[12:15], v[64:67], v[36:39], 0
    v_mfma_f32_16x16x32_bf16 a[56:59], v[68:71], v[32:35], 0
    ds_read_b128 v[28:31], v1 offset:7168
    v_mfma_f32_16x16x32_bf16 a[60:63], v[68:71], v[36:39], 0
    s_waitcnt lgkmcnt(2)
    v_mfma_f32_16x16x32_bf16 a[16:19], v[64:67], v[40:43], 0
    ds_read_b128 v[32:35], v1 offset:8192
    v_mfma_f32_16x16x32_bf16 a[20:23], v[64:67], v[44:47], 0
    v_mfma_f32_16x16x32_bf16 a[64:67], v[68:71], v[40:43], 0
    ds_read_b128 v[36:39], v1 offset:9216
    v_mfma_f32_16x16x32_bf16 a[68:71], v[68:71], v[44:47], 0
    s_waitcnt lgkmcnt(2)
    v_mfma_f32_16x16x32_bf16 a[24:27], v[64:67], v[24:27], 0
    ds_read_b128 v[40:43], v1 offset:10240
    v_mfma_f32_16x16x32_bf16 a[28:31], v[64:67], v[28:31], 0
    v_mfma_f32_16x16x32_bf16 a[72:75], v[68:71], v[24:27], 0
    ds_read_b128 v[44:47], v1 offset:11264
    v_mfma_f32_16x16x32_bf16 a[76:79], v[68:71], v[28:31], 0
    s_waitcnt lgkmcnt(2)
    v_mfma_f32_16x16x32_bf16 a[32:35], v[64:67], v[32:35], 0
    v_mfma_f32_16x16x32_bf16 a[36:39], v[64:67], v[36:39], 0
    v_mfma_f32_16x16x32_bf16 a[80:83], v[68:71], v[32:35], 0
    v_mfma_f32_16x16x32_bf16 a[84:87], v[68:71], v[36:39], 0
    s_waitcnt lgkmcnt(0)
    v_mfma_f32_16x16x32_bf16 a[40:43], v[64:67], v[40:43], 0
    v_mfma_f32_16x16x32_bf16 a[44:47], v[64:67], v[44:47], 0
    v_mfma_f32_16x16x32_bf16 a[88:91], v[68:71], v[40:43], 0
    v_mfma_f32_16x16x32_bf16 a[92:95], v[68:71], v[44:47], 0
    s_waitcnt lgkmcnt(0)
    s_sub_u32 s48, s48, s92
    s_sub_u32 s49, s49, s92
    s_sub_u32 s50, s50, s92
    s_sub_u32 s51, s51, s92
    s_sub_u32 s52, s52, s92
    s_sub_u32 s53, s53, s92
    s_sub_u32 s54, s54, s92
    s_sub_u32 s55, s55, s92
    s_max_u32 s48, s48, s49
    s_max_u32 s48, s48, s50
    s_max_u32 s48, s48, s51
    s_max_u32 s48, s48, s52
    s_max_u32 s48, s48, s53
    s_max_u32 s48, s48, s54
    s_max_u32 s48, s48, s55
    s_cmp_ge_u32 s48, 16
    s_cbranch_scc1 L_pollslow0
L_pollok0:
    s_add_u32 s92, s92, 1
    s_mov_b32 m0, s26
    s_nop 0
    buffer_load_dwordx4 v4, s[4:7], s32 offen offset:0 sc1 lds
    buffer_load_dwordx4 v4, s[4:7], s32 offen offset:1024 sc1 lds
    buffer_load_dwordx4 v4, s[4:7], s32 offen offset:2048 sc1 lds
    s_add_u32 s32, s32, 24576
    s_sub_u32 s57, s32, 196608
    s_min_u32 s32, s32, s57
    s_add_u32 s26, s26, 36864
    s_sub_u32 s57, s26, 147456
    s_min_u32 s26, s26, s57
    s_mov_b32 m0, s26
    s_waitcnt vmcnt(11)
    buffer_load_dwordx4 v4, s[4:7], s32 offen offset:0 sc1 lds
    s_waitcnt vmcnt(11)
    buffer_load_dwordx4 v4, s[4:7], s32 offen offset:1024 sc1 lds
    s_waitcnt vmcnt(11)
    buffer_load_dwordx4 v4, s[4:7], s32 offen offset:2048 sc1 lds
    s_add_u32 s32, s32, 24576
    s_sub_u32 s57, s32, 196608
    s_min_u32 s32, s32, s57
    s_add_u32 s26, s26, 12288
    s_mov_b32 m0, s26
    s_waitcnt vmcnt(11)
    buffer_load_dwordx4 v4, s[4:7], s32 offen offset:0 sc1 lds
    s_waitcnt vmcnt(11)
    buffer_load_dwordx4 v4, s[4:7], s32 offen offset:1024 sc1 lds
    s_waitcnt vmcnt(11)
    buffer_load_dwordx4 v4, s[4:7], s32 offen offset:2048 sc1 lds
    s_add_u32 s32, s32, 24576
    s_sub_u32 s57, s32, 196608
    s_min_u32 s32, s32, s57
    s_add_u32 s26, s26, 36864
    s_sub_u32 s57, s26, 147456
    s_min_u32 s26, s26, s57
    s_mov_b32 m0, s56
    s_waitcnt vmcnt(11)
    buffer_load_dwordx4 v4, s[4:7], s27 offen offset:0 sc1 lds
    s_waitcnt vmcnt(11)
    buffer_load_dwordx4 v4, s[4:7], s27 offen offset:1024 sc1 lds
    s_waitcnt vmcnt(11)
    buffer_load_dwordx4 v4, s[4:7], s27 offen offset:2048 sc1 lds
    s_add_u32 s27, s27, 24576
    s_sub_u32 s58, s27, 196608
    s_min_u32 s27, s27, s58
    s_add_u32 s56, s56, 36864
    s_sub_u32 s58, s56, 147456
    s_min_u32 s56, s56, s58
    s_add_u32 s33, s33, 196608
    s_add_u32 s34, s34, 196608
    s_add_u32 s36, s36, 1536
    s_add_u32 s35, s35, 196608
    s_add_u32 s16, s16, 196608
    s_add_u32 s17, s17, 196608
    s_add_u32 s37, s37, 512
    s_waitcnt vmcnt(9)
    s_barrier
    ds_read_b128 v[24:27], v2 offset:12288
    ds_read_b128 v[28:31], v3 offset:12288
    ds_read_b128 v[32:35], v2 offset:18432
    ds_read_b128 v[36:39], v3 offset:18432
    s_waitcnt lgkmcnt(2)
    v_mfma_f32_16x16x32_bf16 v[72:75], v[24:27], a[192:195], v[128:131]
    s_mov_b32 m0, s56
    ds_read_b128 v[40:43], v2 offset:12416
    v_mfma_f32_16x16x32_bf16 v[72:75], v[28:31], a[196:199], v[72:75]
    buffer_load_dwordx4 v4, s[4:7], s27 offen offset:0 sc1 lds
    v_mfma_f32_16x16x32_bf16 v[76:79], v[24:27], a[216:219], v[132:135]
    ds_read_b128 v[44:47], v3 offset:12416
    v_mfma_f32_16x16x32_bf16 v[76:79], v[28:31], a[220:223], v[76:79]
    s_waitcnt lgkmcnt(2)
    buffer_load_dwordx4 v4, s[4:7], s27 offen offset:1024 sc1 lds
    v_mfma_f32_16x16x32_bf16 v[104:107], v[32:35], a[192:195], v[128:131]
    ds_read_b128 v[24:27], v2 offset:18560
    v_mfma_f32_16x16x32_bf16 v[104:107], v[36:39], a[196:199], v[104:107]
    buffer_load_dwordx4 v4, s[4:7], s27 offen offset:2048 sc1 lds
    v_mfma_f32_16x16x32_bf16 v[108:111], v[32:35], a[216:219], v[132:135]
    s_add_u32 s27, s27, 24576
    ds_read_b128 v[28:31], v3 offset:18560
    v_mfma_f32_16x16x32_bf16 v[108:111], v[36:39], a[220:223], v[108:111]
    s_waitcnt lgkmcnt(2)
    s_sub_u32 s58, s27, 196608
    v_mfma_f32_16x16x32_bf16 v[72:75], v[40:43], a[200:203], v[72:75]
    ds_read_b128 v[32:35], v2 offset:12544
    v_mfma_f32_16x16x32_bf16 v[72:75], v[44:47], a[204:207], v[72:75]
    s_min_u32 s27, s27, s58
    v_mfma_f32_16x16x32_bf16 v[76:79], v[40:43], a[224:227], v[76:79]
    s_add_u32 s56, s56, 12288
    ds_read_b128 v[36:39], v3 offset:12544
    v_mfma_f32_16x16x32_bf16 v[76:79], v[44:47], a[228:231], v[76:79]
    s_waitcnt lgkmcnt(2)
    s_mov_b32 m0, s56
    v_mfma_f32_16x16x32_bf16 v[104:107], v[24:27], a[200:203], v[104:107]
    ds_read_b128 v[40:43], v2 offset:18688
    v_mfma_f32_16x16x32_bf16 v[104:107], v[28:31], a[204:207], v[104:107]
    s_waitcnt vmcnt(6)
    buffer_load_dwordx4 v4, s[4:7], s27 offen offset:0 sc1 lds
    v_mfma_f32_16x16x32_bf16 v[108:111], v[24:27], a[224:227], v[108:111]
    ds_read_b128 v[44:47], v3 offset:18688
    v_mfma_f32_16x16x32_bf16 v[108:111], v[28:31], a[228:231], v[108:111]
    s_waitcnt lgkmcnt(2)
    s_barrier
    v_add_u32 v2, 49152, v2
    v_add_u32 v3, 49152, v3
    v_mfma_f32_16x16x32_bf16 v[72:75], v[32:35], a[208:211], v[72:75]
    ds_read_b128 v[24:27], v2 offset:0
    v_mfma_f32_16x16x32_bf16 v[72:75], v[36:39], a[212:215], v[72:75]
    buffer_load_dwordx4 v4, s[4:7], s27 offen offset:1024 sc1 lds
    v_mfma_f32_16x16x32_bf16 v[76:79], v[32:35], a[232:235], v[76:79]
    ds_read_b128 v[28:31], v3 offset:0
    v_mfma_f32_16x16x32_bf16 v[76:79], v[36:39], a[236:239], v[76:79]
    s_waitcnt lgkmcnt(2)
    buffer_load_dwordx4 v4, s[4:7], s27 offen offset:2048 sc1 lds
    v_mfma_f32_16x16x32_bf16 v[104:107], v[40:43], a[208:211], v[104:107]
    ds_read_b128 v[32:35], v2 offset:6144
    v_mfma_f32_16x16x32_bf16 v[104:107], v[44:47], a[212:215], v[104:107]
    v_mfma_f32_16x16x32_bf16 v[108:111], v[40:43], a[232:235], v[108:111]
    s_add_u32 s27, s27, 24576
    ds_read_b128 v[36:39], v3 offset:6144
    s_sub_u32 s58, s27, 196608
    v_mfma_f32_16x16x32_bf16 v[108:111], v[44:47], a[236:239], v[108:111]
    s_waitcnt lgkmcnt(2)
    s_min_u32 s27, s27, s58
    s_add_u32 s56, s56, 36864
    s_sub_u32 s58, s56, 147456
    s_min_u32 s56, s56, s58
    v_mfma_f32_16x16x32_bf16 v[80:83], v[24:27], a[192:195], v[128:131]
    s_mov_b32 s41, 18432
    ds_read_b128 v[40:43], v2 offset:128
    s_add_u32 m0, s40, 27648
    v_mfma_f32_16x16x32_bf16 v[80:83], v[28:31], a[196:199], v[80:83]
    buffer_load_dwordx4 v139, s[8:11], s41 offen nt lds
    v_mfma_f32_16x16x32_bf16 v[84:87], v[24:27], a[216:219], v[132:135]
    s_add_u32 m0, s40, 28672
    ds_read_b128 v[44:47], v3 offset:128
    v_mfma_f32_16x16x32_bf16 v[84:87], v[28:31], a[220:223], v[84:87]
    s_waitcnt lgkmcnt(2)
    buffer_load_dwordx4 v140, s[8:11], s41 offen nt lds
    s_add_u32 m0, s40, 29696
    v_mfma_f32_16x16x32_bf16 v[112:115], v[32:35], a[192:195], v[128:131]
    ds_read_b128 v[24:27], v2 offset:6272
    v_mfma_f32_16x16x32_bf16 v[112:115], v[36:39], a[196:199], v[112:115]
    buffer_load_dwordx4 v141, s[8:11], s41 offen nt lds
    v_mfma_f32_16x16x32_bf16 v[116:119], v[32:35], a[216:219], v[132:135]
    ds_read_b128 v[28:31], v3 offset:6272
    v_mfma_f32_16x16x32_bf16 v[116:119], v[36:39], a[220:223], v[116:119]
    s_waitcnt lgkmcnt(2)
    v_exp_f32 v16, v72
    v_mfma_f32_16x16x32_bf16 v[80:83], v[40:43], a[200:203], v[80:83]
    ds_read_b128 v[32:35], v2 offset:256
    v_mfma_f32_16x16x32_bf16 v[80:83], v[44:47], a[204:207], v[80:83]
    v_exp_f32 v17, v73
    v_exp_f32 v18, v74
    v_mfma_f32_16x16x32_bf16 v[84:87], v[40:43], a[224:227], v[84:87]
    ds_read_b128 v[36:39], v3 offset:256
    v_add_f32 v5, v5, v16
    v_mfma_f32_16x16x32_bf16 v[84:87], v[44:47], a[228:231], v[84:87]
    s_waitcnt lgkmcnt(2)
    v_add_f32 v5, v5, v17
    v_exp_f32 v19, v75
    v_mfma_f32_16x16x32_bf16 v[112:115], v[24:27], a[200:203], v[112:115]
    ds_read_b128 v[40:43], v2 offset:6400
    v_cvt_pk_bf16_f32 v72, v16, v17
    v_mfma_f32_16x16x32_bf16 v[112:115], v[28:31], a[204:207], v[112:115]
    v_exp_f32 v16, v104
    v_mfma_f32_16x16x32_bf16 v[116:119], v[24:27], a[224:227], v[116:119]
    ds_read_b128 v[44:47], v3 offset:6400
    v_add_f32 v5, v5, v18
    v_mfma_f32_16x16x32_bf16 v[116:119], v[28:31], a[228:231], v[116:119]
    s_waitcnt lgkmcnt(2)
    v_add_f32 v5, v5, v19
    v_exp_f32 v17, v105
    v_mfma_f32_16x16x32_bf16 v[80:83], v[32:35], a[208:211], v[80:83]
    ds_read_b128 v[24:27], v2 offset:12288
    v_cvt_pk_bf16_f32 v73, v18, v19
    v_mfma_f32_16x16x32_bf16 v[80:83], v[36:39], a[212:215], v[80:83]
    v_exp_f32 v18, v106
    v_mfma_f32_16x16x32_bf16 v[84:87], v[32:35], a[232:235], v[84:87]
    ds_read_b128 v[28:31], v3 offset:12288
    v_add_f32 v5, v5, v16
    v_mfma_f32_16x16x32_bf16 v[84:87], v[36:39], a[236:239], v[84:87]
    s_waitcnt lgkmcnt(2)
    v_add_f32 v5, v5, v17
    v_exp_f32 v19, v107
    v_mfma_f32_16x16x32_bf16 v[112:115], v[40:43], a[208:211], v[112:115]
    ds_read_b128 v[32:35], v2 offset:18432
    v_cvt_pk_bf16_f32 v74, v16, v17
    v_mfma_f32_16x16x32_bf16 v[112:115], v[44:47], a[212:215], v[112:115]
    v_exp_f32 v16, v76
    v_add_f32 v5, v5, v18
    v_mfma_f32_16x16x32_bf16 v[116:119], v[40:43], a[232:235], v[116:119]
    ds_read_b128 v[36:39], v3 offset:18432
    v_add_f32 v5, v5, v19
    v_mfma_f32_16x16x32_bf16 v[116:119], v[44:47], a[236:239], v[116:119]
    s_waitcnt lgkmcnt(2)
    v_exp_f32 v17, v77
    v_mfma_f32_16x16x32_bf16 v[88:91], v[24:27], a[192:195], v[128:131]
    ds_read_b128 v[40:43], v2 offset:12416
    v_cvt_pk_bf16_f32 v75, v18, v19
    v_mfma_f32_16x16x32_bf16 v[88:91], v[28:31], a[196:199], v[88:91]
    s_waitcnt vmcnt(11)
    buffer_load_dwordx2 v[56:57], v10, s[72:75], s36 offen offset:0
    v_mfma_f32_16x16x32_bf16 v[92:95], v[24:27], a[216:219], v[132:135]
    ds_read_b128 v[44:47], v3 offset:12416
    v_mfma_f32_16x16x32_bf16 v[92:95], v[28:31], a[220:223], v[92:95]
    s_waitcnt lgkmcnt(2)
    buffer_load_dwordx2 v[58:59], v10, s[76:79], s36 offen offset:0
    v_exp_f32 v18, v78
    v_mfma_f32_16x16x32_bf16 v[120:123], v[32:35], a[192:195], v[128:131]
    ds_read_b128 v[24:27], v2 offset:18560
    v_add_f32 v6, v6, v16
    v_mfma_f32_16x16x32_bf16 v[120:123], v[36:39], a[196:199], v[120:123]
    s_waitcnt vmcnt(12)
    buffer_load_dwordx4 v[224:227], v9, s[64:67], s33 offen offset:0 nt
    v_mfma_f32_16x16x32_bf16 v[124:127], v[32:35], a[216:219], v[132:135]
    ds_read_b128 v[28:31], v3 offset:18560
    v_add_f32 v6, v6, v17
    v_mfma_f32_16x16x32_bf16 v[124:127], v[36:39], a[220:223], v[124:127]
    s_waitcnt lgkmcnt(2)
    s_waitcnt vmcnt(12)
    buffer_load_dwordx4 v[228:231], v9, s[64:67], s33 offen offset:1536 nt
    v_mfma_f32_16x16x32_bf16 v[88:91], v[40:43], a[200:203], v[88:91]
    ds_read_b128 v[32:35], v2 offset:12544
    v_mfma_f32_16x16x32_bf16 v[88:91], v[44:47], a[204:207], v[88:91]
    buffer_load_dwordx4 v[232:235], v9, s[64:67], s34 offen offset:0 nt
    v_mfma_f32_16x16x32_bf16 v[92:95], v[40:43], a[224:227], v[92:95]
    ds_read_b128 v[36:39], v3 offset:12544
    v_mfma_f32_16x16x32_bf16 v[92:95], v[44:47], a[228:231], v[92:95]
    s_waitcnt lgkmcnt(2)
    s_waitcnt vmcnt(13)
    buffer_load_dwordx4 v[236:239], v9, s[64:67], s34 offen offset:1536 nt
    v_exp_f32 v19, v79
    v_mfma_f32_16x16x32_bf16 v[120:123], v[24:27], a[200:203], v[120:123]
    ds_read_b128 v[40:43], v2 offset:18688
    v_cvt_pk_bf16_f32 v76, v16, v17
    v_mfma_f32_16x16x32_bf16 v[120:123], v[28:31], a[204:207], v[120:123]
    s_waitcnt vmcnt(9)
    v_exp_f32 v16, v108
    v_add_f32 v6, v6, v18
    v_mfma_f32_16x16x32_bf16 v[124:127], v[24:27], a[224:227], v[124:127]
    ds_read_b128 v[44:47], v3 offset:18688
    v_add_f32 v6, v6, v19
    v_mfma_f32_16x16x32_bf16 v[124:127], v[28:31], a[228:231], v[124:127]
    s_waitcnt lgkmcnt(2)
    s_barrier
    v_mfma_f32_16x16x32_bf16 v[88:91], v[32:35], a[208:211], v[88:91]
    ds_read_b128 v[24:27], v1 offset:12288
    v_mfma_f32_16x16x32_bf16 v[88:91], v[36:39], a[212:215], v[88:91]
    v_exp_f32 v17, v109
    v_cvt_pk_bf16_f32 v77, v18, v19
    v_mfma_f32_16x16x32_bf16 v[92:95], v[32:35], a[232:235], v[92:95]
    ds_read_b128 v[28:31], v1 offset:13312
    v_mfma_f32_16x16x32_bf16 v[92:95], v[36:39], a[236:239], v[92:95]
    s_waitcnt lgkmcnt(2)
    v_exp_f32 v18, v110
    v_add_f32 v6, v6, v16
    v_mfma_f32_16x16x32_bf16 v[120:123], v[40:43], a[208:211], v[120:123]
    ds_read_b128 v[32:35], v1 offset:14336
    v_add_f32 v6, v6, v17
    v_mfma_f32_16x16x32_bf16 v[120:123], v[44:47], a[212:215], v[120:123]
    v_exp_f32 v19, v111
    v_mfma_f32_16x16x32_bf16 v[124:127], v[40:43], a[232:235], v[124:127]
    ds_read_b128 v[36:39], v1 offset:15360
    v_cvt_pk_bf16_f32 v78, v16, v17
    v_mfma_f32_16x16x32_bf16 v[124:127], v[44:47], a[236:239], v[124:127]
    s_waitcnt lgkmcnt(2)
    v_add_f32 v6, v6, v18
    v_add_f32 v6, v6, v19
    v_cvt_pk_bf16_f32 v79, v18, v19
    v_mfma_f32_16x16x32_bf16 a[0:3], v[72:75], v[24:27], a[0:3]
    ds_read_b128 v[40:43], v1 offset:16384
    v_mfma_f32_16x16x32_bf16 a[4:7], v[72:75], v[28:31], a[4:7]
    buffer_load_dwordx2 v[60:61], v10, s[72:75], s36 offen offset:192
    v_exp_f32 v16, v80
    v_mfma_f32_16x16x32_bf16 a[48:51], v[76:79], v[24:27], a[48:51]
    ds_read_b128 v[44:47], v1 offset:17408
    v_mfma_f32_16x16x32_bf16 a[52:55], v[76:79], v[28:31], a[52:55]
    s_waitcnt lgkmcnt(2)
    buffer_load_dwordx2 v[62:63], v10, s[76:79], s36 offen offset:192
    v_exp_f32 v17, v81
    v_exp_f32 v18, v82
    v_mfma_f32_16x16x32_bf16 a[8:11], v[72:75], v[32:35], a[8:11]
    ds_read_b128 v[24:27], v1 offset:18432
    v_add_f32 v5, v5, v16
    v_mfma_f32_16x16x32_bf16 a[12:15], v[72:75], v[36:39], a[12:15]
    buffer_load_dwordx4 v[240:243], v9, s[64:67], s33 offen offset:384 nt
    v_add_f32 v5, v5, v17
    v_exp_f32 v19, v83
    v_mfma_f32_16x16x32_bf16 a[56:59], v[76:79], v[32:35], a[56:59]
    ds_read_b128 v[28:31], v1 offset:19456
    v_cvt_pk_bf16_f32 v80, v16, v17
    v_mfma_f32_16x16x32_bf16 a[60:63], v[76:79], v[36:39], a[60:63]
    s_waitcnt lgkmcnt(2)
    buffer_load_dwordx4 v[244:247], v9, s[64:67], s33 offen offset:1920 nt
    v_exp_f32 v16, v112
    v_add_f32 v5, v5, v18
    v_add_f32 v5, v5, v19
    v_mfma_f32_16x16x32_bf16 a[16:19], v[72:75], v[40:43], a[16:19]
    ds_read_b128 v[32:35], v1 offset:20480
    v_mfma_f32_16x16x32_bf16 a[20:23], v[72:75], v[44:47], a[20:23]
    buffer_load_dwordx4 v[248:251], v9, s[64:67], s34 offen offset:384 nt
    v_exp_f32 v17, v113
    v_cvt_pk_bf16_f32 v81, v18, v19
    v_mfma_f32_16x16x32_bf16 a[64:67], v[76:79], v[40:43], a[64:67]
    ds_read_b128 v[36:39], v1 offset:21504
    v_mfma_f32_16x16x32_bf16 a[68:71], v[76:79], v[44:47], a[68:71]
    s_waitcnt lgkmcnt(2)
    buffer_load_dwordx4 v[252:255], v9, s[64:67], s34 offen offset:1920 nt
    v_exp_f32 v18, v114
    v_add_f32 v5, v5, v16
    v_mfma_f32_16x16x32_bf16 a[24:27], v[72:75], v[24:27], a[24:27]
    ds_read_b128 v[40:43], v1 offset:22528
    v_add_f32 v5, v5, v17
    v_mfma_f32_16x16x32_bf16 a[28:31], v[72:75], v[28:31], a[28:31]
    v_exp_f32 v19, v115
    v_cvt_pk_bf16_f32 v82, v16, v17
    v_exp_f32 v16, v84
    v_mfma_f32_16x16x32_bf16 a[72:75], v[76:79], v[24:27], a[72:75]
    ds_read_b128 v[44:47], v1 offset:23552
    v_add_f32 v5, v5, v18
    v_mfma_f32_16x16x32_bf16 a[76:79], v[76:79], v[28:31], a[76:79]
    s_waitcnt lgkmcnt(2)
    v_add_u32 v1, 49152, v1
    v_add_f32 v5, v5, v19
    v_exp_f32 v17, v85
    v_cvt_pk_bf16_f32 v83, v18, v19
    v_mfma_f32_16x16x32_bf16 a[32:35], v[72:75], v[32:35], a[32:35]
    ds_read_b128 v[24:27], v1 offset:0
    v_mfma_f32_16x16x32_bf16 a[36:39], v[72:75], v[36:39], a[36:39]
    v_exp_f32 v18, v86
    v_add_f32 v6, v6, v16
    v_add_f32 v6, v6, v17
    v_exp_f32 v19, v87
    v_mfma_f32_16x16x32_bf16 a[80:83], v[76:79], v[32:35], a[80:83]
    ds_read_b128 v[28:31], v1 offset:1024
    v_cvt_pk_bf16_f32 v84, v16, v17
    v_mfma_f32_16x16x32_bf16 a[84:87], v[76:79], v[36:39], a[84:87]
    s_waitcnt lgkmcnt(2)
    v_exp_f32 v16, v116
    v_add_f32 v6, v6, v18
    v_add_f32 v6, v6, v19
    v_mfma_f32_16x16x32_bf16 a[40:43], v[72:75], v[40:43], a[40:43]
    ds_read_b128 v[32:35], v1 offset:2048
    v_mfma_f32_16x16x32_bf16 a[44:47], v[72:75], v[44:47], a[44:47]
    v_exp_f32 v17, v117
    v_cvt_pk_bf16_f32 v85, v18, v19
    v_exp_f32 v18, v118
    v_add_f32 v6, v6, v16
    v_mfma_f32_16x16x32_bf16 a[88:91], v[76:79], v[40:43], a[88:91]
    ds_read_b128 v[36:39], v1 offset:3072
    v_add_f32 v6, v6, v17
    v_mfma_f32_16x16x32_bf16 a[92:95], v[76:79], v[44:47], a[92:95]
    s_waitcnt lgkmcnt(2)
    v_exp_f32 v19, v119
    v_cvt_pk_bf16_f32 v86, v16, v17
    v_add_f32 v6, v6, v18
    v_add_f32 v6, v6, v19
    v_cvt_pk_bf16_f32 v87, v18, v19
    v_mfma_f32_16x16x32_bf16 a[0:3], v[80:83], v[24:27], a[0:3]
    ds_read_b128 v[40:43], v1 offset:4096
    v_mfma_f32_16x16x32_bf16 a[4:7], v[80:83], v[28:31], a[4:7]
    buffer_load_dwordx4 v[144:147], v12, s[68:71], s35 offen offset:0 nt
    v_exp_f32 v16, v88
    v_mfma_f32_16x16x32_bf16 a[48:51], v[84:87], v[24:27], a[48:51]
    ds_read_b128 v[44:47], v1 offset:5120
    v_mfma_f32_16x16x32_bf16 a[52:55], v[84:87], v[28:31], a[52:55]
    s_waitcnt lgkmcnt(2)
    buffer_load_dwordx4 v[148:151], v12, s[68:71], s35 offen offset:768 nt
    v_exp_f32 v17, v89
    v_mfma_f32_16x16x32_bf16 a[8:11], v[80:83], v[32:35], a[8:11]
    ds_read_b128 v[24:27], v1 offset:6144
    v_mfma_f32_16x16x32_bf16 a[12:15], v[80:83], v[36:39], a[12:15]
    s_waitcnt vmcnt(16)
    buffer_load_dwordx4 v[152:155], v12, s[68:71], s35 offen offset:1536 nt
    v_exp_f32 v18, v90
    v_mfma_f32_16x16x32_bf16 a[56:59], v[84:87], v[32:35], a[56:59]
    ds_read_b128 v[28:31], v1 offset:7168
    v_add_f32 v5, v5, v16
    v_mfma_f32_16x16x32_bf16 a[60:63], v[84:87], v[36:39], a[60:63]
    s_waitcnt lgkmcnt(2)
    s_waitcnt vmcnt(16)
    buffer_load_dwordx4 v[156:159], v12, s[68:71], s35 offen offset:2304 nt
    v_add_f32 v5, v5, v17
    v_mfma_f32_16x16x32_bf16 a[16:19], v[80:83], v[40:43], a[16:19]
    ds_read_b128 v[32:35], v1 offset:8192
    v_mfma_f32_16x16x32_bf16 a[20:23], v[80:83], v[44:47], a[20:23]
    v_exp_f32 v19, v91
    v_cvt_pk_bf16_f32 v88, v16, v17
    v_exp_f32 v16, v120
    v_mfma_f32_16x16x32_bf16 a[64:67], v[84:87], v[40:43], a[64:67]
    ds_read_b128 v[36:39], v1 offset:9216
    v_add_f32 v5, v5, v18
    v_mfma_f32_16x16x32_bf16 a[68:71], v[84:87], v[44:47], a[68:71]
    s_waitcnt lgkmcnt(2)
    v_add_f32 v5, v5, v19
    v_exp_f32 v17, v121
    v_cvt_pk_bf16_f32 v89, v18, v19
    v_mfma_f32_16x16x32_bf16 a[24:27], v[80:83], v[24:27], a[24:27]
    ds_read_b128 v[40:43], v1 offset:10240
    v_mfma_f32_16x16x32_bf16 a[28:31], v[80:83], v[28:31], a[28:31]
    v_exp_f32 v18, v122
    v_add_f32 v5, v5, v16
    v_add_f32 v5, v5, v17
    v_mfma_f32_16x16x32_bf16 a[72:75], v[84:87], v[24:27], a[72:75]
    ds_read_b128 v[44:47], v1 offset:11264
    v_mfma_f32_16x16x32_bf16 a[76:79], v[84:87], v[28:31], a[76:79]
    s_waitcnt lgkmcnt(2)
    v_exp_f32 v19, v123
    v_cvt_pk_bf16_f32 v90, v16, v17
    v_mfma_f32_16x16x32_bf16 a[32:35], v[80:83], v[32:35], a[32:35]
    s_waitcnt vmcnt(40)
    ds_read_b128 v[24:27], v1 offset:12288
    ds_read_b64 a[240:241], v22 offset:49152
    v_mfma_f32_16x16x32_bf16 a[36:39], v[80:83], v[36:39], a[36:39]
    ds_read_b64 a[242:243], v142 offset:49280
    ds_read_b64 a[244:245], v23 offset:49152
    ds_read_b64 a[246:247], v143 offset:49280
    ds_read_b64 a[248:249], v142 offset:49152
    ds_read_b64 a[250:251], v22 offset:49408
    v_mfma_f32_16x16x32_bf16 a[80:83], v[84:87], v[32:35], a[80:83]
    ds_read_b128 v[28:31], v1 offset:13312
    ds_read_b64 a[252:253], v143 offset:49152
    v_mfma_f32_16x16x32_bf16 a[84:87], v[84:87], v[36:39], a[84:87]
    s_waitcnt lgkmcnt(9)
    ds_read_b64 a[254:255], v23 offset:49408
    ds_read_b64 v[192:193], v22 offset:49280
    ds_read_b64 v[194:195], v142 offset:49408
    ds_read_b64 v[196:197], v23 offset:49280
    v_mfma_f32_16x16x32_bf16 a[40:43], v[80:83], v[40:43], a[40:43]
    ds_read_b128 v[32:35], v1 offset:14336
    ds_read_b64 v[198:199], v143 offset:49408
    v_mfma_f32_16x16x32_bf16 a[44:47], v[80:83], v[44:47], a[44:47]
    v_exp_f32 v16, v92
    v_add_f32 v5, v5, v18
    v_add_f32 v5, v5, v19
    v_exp_f32 v17, v93
    v_cvt_pk_bf16_f32 v91, v18, v19
    v_exp_f32 v18, v94
    v_add_f32 v6, v6, v16
    v_add_f32 v6, v6, v17
    v_exp_f32 v19, v95
    v_cvt_pk_bf16_f32 v92, v16, v17
    v_exp_f32 v16, v124
    v_add_f32 v6, v6, v18
    v_add_f32 v6, v6, v19
    v_exp_f32 v17, v125
    v_cvt_pk_bf16_f32 v93, v18, v19
    v_exp_f32 v18, v126
    v_add_f32 v6, v6, v16
    v_add_f32 v6, v6, v17
    v_exp_f32 v19, v127
    v_cvt_pk_bf16_f32 v94, v16, v17
    v_add_f32 v6, v6, v18
    v_add_f32 v6, v6, v19
    v_cvt_pk_bf16_f32 v95, v18, v19
    v_mfma_f32_16x16x32_bf16 a[88:91], v[84:87], v[40:43], a[88:91]
    s_waitcnt vmcnt(16)
    ds_read_b128 v[36:39], v1 offset:15360
    ds_read_b64 v[200:201], v22 offset:24576
    v_mfma_f32_16x16x32_bf16 a[92:95], v[84:87], v[44:47], a[92:95]
L_iw1:
L_pg1:
    s_cbranch_execz L_pg5
    s_waitcnt lgkmcnt(9)
    ds_read_b64 v[202:203], v142 offset:24704
    ds_read_b64 v[204:205], v23 offset:24576
    v_mfma_f32_16x16x32_bf16 a[0:3], v[88:91], v[24:27], a[0:3]
    ds_read_b128 v[40:43], v1 offset:16384
    ds_read_b64 v[206:207], v143 offset:24704
    v_mfma_f32_16x16x32_bf16 a[4:7], v[88:91], v[28:31], a[4:7]
    ds_read_b64 v[208:209], v142 offset:24576
    ds_read_b64 v[210:211], v22 offset:24832
    v_mfma_f32_16x16x32_bf16 a[48:51], v[92:95], v[24:27], a[48:51]
    ds_read_b128 v[44:47], v1 offset:17408
    ds_read_b64 v[212:213], v143 offset:24576
    v_mfma_f32_16x16x32_bf16 a[52:55], v[92:95], v[28:31], a[52:55]
    s_waitcnt lgkmcnt(9)
    ds_read_b64 v[214:215], v23 offset:24832
    ds_read_b64 v[216:217], v22 offset:24704
    v_mfma_f32_16x16x32_bf16 a[8:11], v[88:91], v[32:35], a[8:11]
    ds_read_b128 v[24:27], v1 offset:18432
    ds_read_b64 v[218:219], v142 offset:24832
    v_mfma_f32_16x16x32_bf16 a[12:15], v[88:91], v[36:39], a[12:15]
    ds_read_b64 v[220:221], v23 offset:24704
    ds_read_b64 v[222:223], v143 offset:24832
    v_mfma_f32_16x16x32_bf16 a[56:59], v[92:95], v[32:35], a[56:59]
    ds_read_b128 v[28:31], v1 offset:19456
    v_mfma_f32_16x16x32_bf16 a[60:63], v[92:95], v[36:39], a[60:63]
    s_waitcnt lgkmcnt(8)
    v_mfma_f32_16x16x32_bf16 a[16:19], v[88:91], v[40:43], a[16:19]
    ds_read_b128 v[32:35], v1 offset:20480
    v_mfma_f32_16x16x32_bf16 a[20:23], v[88:91], v[44:47], a[20:23]
    v_mfma_f32_16x16x32_bf16 a[64:67], v[92:95], v[40:43], a[64:67]
    ds_read_b128 v[36:39], v1 offset:21504
    v_mfma_f32_16x16x32_bf16 a[68:71], v[92:95], v[44:47], a[68:71]
    s_waitcnt lgkmcnt(2)
    v_mfma_f32_16x16x32_bf16 a[24:27], v[88:91], v[24:27], a[24:27]
    ds_read_b128 v[40:43], v1 offset:22528
    v_mfma_f32_16x16x32_bf16 a[28:31], v[88:91], v[28:31], a[28:31]
    v_mfma_f32_16x16x32_bf16 a[72:75], v[92:95], v[24:27], a[72:75]
    ds_read_b128 v[44:47], v1 offset:23552
    v_mfma_f32_16x16x32_bf16 a[76:79], v[92:95], v[28:31], a[76:79]
    s_waitcnt lgkmcnt(2)
    v_subrev_u32 v2, 49152, v2
    v_subrev_u32 v3, 49152, v3
    v_mfma_f32_16x16x32_bf16 a[32:35], v[88:91], v[32:35], a[32:35]
    ds_read_b128 v[24:27], v2 offset:0
    v_mfma_f32_16x16x32_bf16 a[36:39], v[88:91], v[36:39], a[36:39]
    v_mfma_f32_16x16x32_bf16 a[80:83], v[92:95], v[32:35], a[80:83]
    ds_read_b128 v[28:31], v3 offset:0
    v_mfma_f32_16x16x32_bf16 a[84:87], v[92:95], v[36:39], a[84:87]
    s_waitcnt lgkmcnt(2)
    v_mfma_f32_16x16x32_bf16 a[40:43], v[88:91], v[40:43], a[40:43]
    ds_read_b128 v[32:35], v2 offset:6144
    v_mfma_f32_16x16x32_bf16 a[44:47], v[88:91], v[44:47], a[44:47]
    v_mfma_f32_16x16x32_bf16 a[88:91], v[92:95], v[40:43], a[88:91]
    ds_read_b128 v[36:39], v3 offset:6144
    v_mfma_f32_16x16x32_bf16 a[92:95], v[92:95], v[44:47], a[92:95]
    s_waitcnt lgkmcnt(2)
    s_waitcnt lgkmcnt(0)
    s_barrier
    v_mfma_f32_16x16x32_bf16 v[160:163], v[24:27], a[240:243], 0
    s_waitcnt vmcnt(10)
    ds_read_b128 v[40:43], v2 offset:128
    v_lshlrev_b32 v48, 16, v56
    v_mfma_f32_16x16x32_bf16 v[160:163], v[28:31], a[244:247], v[160:163]
    s_mov_b32 m0, s26
    v_and_b32 v49, s97, v56
    v_lshlrev_b32 v50, 16, v58
    v_and_b32 v51, s97, v58
    v_mul_f32 v48, s38, v48
    v_mul_f32 v49, s38, v49
    v_mfma_f32_16x16x32_bf16 v[164:167], v[24:27], v[200:203], 0
    ds_read_b128 v[44:47], v3 offset:128
    v_mul_f32_e64 v50, -v50, v48
    v_mfma_f32_16x16x32_bf16 v[164:167], v[28:31], v[204:207], v[164:167]
    s_waitcnt lgkmcnt(2)
    buffer_load_dwordx4 v4, s[4:7], s32 offen offset:0 sc1 lds
    v_mul_f32_e64 v51, -v51, v49
    v_cvt_f32_i32 v224, v224
    v_cvt_f32_i32 v225, v225
    v_mfma_f32_16x16x32_bf16 v[96:99], v[32:35], a[240:243], 0
    ds_read_b128 v[24:27], v2 offset:6272
    v_fma_f32 v224, v224, v48, v50
    v_mfma_f32_16x16x32_bf16 v[96:99], v[36:39], a[244:247], v[96:99]
    buffer_load_dwordx4 v4, s[4:7], s32 offen offset:1024 sc1 lds
    v_fma_f32 v225, v225, v49, v51
    v_cvt_pk_bf16_f32 v224, v224, v225
    v_cvt_f32_i32 v228, v228
    v_mfma_f32_16x16x32_bf16 v[100:103], v[32:35], v[200:203], 0
    ds_read_b128 v[28:31], v3 offset:6272
    v_cvt_f32_i32 v229, v229
    v_mfma_f32_16x16x32_bf16 v[100:103], v[36:39], v[204:207], v[100:103]
    s_waitcnt lgkmcnt(2)
    buffer_load_dwordx4 v4, s[4:7], s32 offen offset:2048 sc1 lds
    v_fma_f32 v228, v228, v48, v50
    v_fma_f32 v229, v229, v49, v51
    v_cvt_pk_bf16_f32 v228, v228, v229
    v_mfma_f32_16x16x32_bf16 v[160:163], v[40:43], a[248:251], v[160:163]
    s_add_u32 s32, s32, 24576
    ds_read_b128 v[32:35], v2 offset:256
    v_cvt_f32_i32 v232, v232
    v_mfma_f32_16x16x32_bf16 v[160:163], v[44:47], a[252:255], v[160:163]
    s_sub_u32 s57, s32, 196608
    v_cvt_f32_i32 v233, v233
    v_fma_f32 v232, v232, v48, v50
    v_fma_f32 v233, v233, v49, v51
    v_cvt_pk_bf16_f32 v232, v232, v233
    v_cvt_f32_i32 v236, v236
    v_mfma_f32_16x16x32_bf16 v[164:167], v[40:43], v[208:211], v[164:167]
    s_min_u32 s32, s32, s57
    ds_read_b128 v[36:39], v3 offset:256
    v_cvt_f32_i32 v237, v237
    v_mfma_f32_16x16x32_bf16 v[164:167], v[44:47], v[212:215], v[164:167]
    s_waitcnt lgkmcnt(2)
    v_fma_f32 v236, v236, v48, v50
    v_fma_f32 v237, v237, v49, v51
    v_cvt_pk_bf16_f32 v236, v236, v237
    v_lshlrev_b32 v48, 16, v57
    v_and_b32 v49, s97, v57
    v_mfma_f32_16x16x32_bf16 v[96:99], v[24:27], a[248:251], v[96:99]
    s_add_u32 s26, s26, 12288
    ds_read_b128 v[40:43], v2 offset:6400
    v_lshlrev_b32 v50, 16, v59
    v_mfma_f32_16x16x32_bf16 v[96:99], v[28:31], a[252:255], v[96:99]
    s_mov_b32 m0, s26
    v_and_b32 v51, s97, v59
    v_mul_f32 v48, s38, v48
    v_mul_f32 v49, s38, v49
    v_mul_f32_e64 v50, -v50, v48
    v_mul_f32_e64 v51, -v51, v49
    v_mfma_f32_16x16x32_bf16 v[100:103], v[24:27], v[208:211], v[100:103]
    ds_read_b128 v[44:47], v3 offset:6400
    v_cvt_f32_i32 v226, v226
    v_mfma_f32_16x16x32_bf16 v[100:103], v[28:31], v[212:215], v[100:103]
    s_waitcnt lgkmcnt(2)
    buffer_load_dwordx4 v4, s[4:7], s32 offen offset:0 sc1 lds
    v_cvt_f32_i32 v227, v227
    v_fma_f32 v226, v226, v48, v50
    v_fma_f32 v227, v227, v49, v51
    v_mfma_f32_16x16x32_bf16 v[160:163], v[32:35], v[192:195], v[160:163]
    ds_read_b128 v[24:27], v2 offset:12288
    v_cvt_pk_bf16_f32 v225, v226, v227
    v_mfma_f32_16x16x32_bf16 v[160:163], v[36:39], v[196:199], v[160:163]
    buffer_load_dwordx4 v4, s[4:7], s32 offen offset:1024 sc1 lds
    v_cvt_f32_i32 v230, v230
    v_cvt_f32_i32 v231, v231
    v_fma_f32 v230, v230, v48, v50
    v_mfma_f32_16x16x32_bf16 v[164:167], v[32:35], v[216:219], v[164:167]
    ds_read_b128 v[28:31], v3 offset:12288
    v_fma_f32 v231, v231, v49, v51
    v_mfma_f32_16x16x32_bf16 v[164:167], v[36:39], v[220:223], v[164:167]
    s_waitcnt lgkmcnt(2)
    s_waitcnt vmcnt(13)
    buffer_load_dwordx4 v4, s[4:7], s32 offen offset:2048 sc1 lds
    v_cvt_pk_bf16_f32 v229, v230, v231
    v_cvt_f32_i32 v234, v234
    v_cvt_f32_i32 v235, v235
    v_mfma_f32_16x16x32_bf16 v[96:99], v[40:43], v[192:195], v[96:99]
    ds_read_b128 v[32:35], v2 offset:18432
    v_fma_f32 v234, v234, v48, v50
    v_mfma_f32_16x16x32_bf16 v[96:99], v[44:47], v[196:199], v[96:99]
    v_fma_f32 v235, v235, v49, v51
    v_cvt_pk_bf16_f32 v233, v234, v235
    v_cvt_f32_i32 v238, v238
    v_cvt_f32_i32 v239, v239
    v_fma_f32 v238, v238, v48, v50
    v_mfma_f32_16x16x32_bf16 v[100:103], v[40:43], v[216:219], v[100:103]
    ds_read_b128 v[36:39], v3 offset:18432
    v_fma_f32 v239, v239, v49, v51
    v_mfma_f32_16x16x32_bf16 v[100:103], v[44:47], v[220:223], v[100:103]
    s_waitcnt lgkmcnt(2)
    v_cvt_pk_bf16_f32 v237, v238, v239
    v_mfma_f32_16x16x32_bf16 v[168:171], v[24:27], a[240:243], 0
    ds_read_b128 v[40:43], v2 offset:12416
    v_mfma_f32_16x16x32_bf16 v[168:171], v[28:31], a[244:247], v[168:171]
    s_add_u32 s32, s32, 24576
    s_sub_u32 s57, s32, 196608
    s_min_u32 s32, s32, s57
    s_add_u32 s26, s26, 36864
    s_sub_u32 s57, s26, 147456
    s_min_u32 s26, s26, s57
    v_mfma_f32_16x16x32_bf16 v[172:175], v[24:27], v[200:203], 0
    ds_read_b128 v[44:47], v3 offset:12416
    v_mfma_f32_16x16x32_bf16 v[172:175], v[28:31], v[204:207], v[172:175]
    s_waitcnt lgkmcnt(2)
    v_max3_f32 v16, v160, v161, v162
    v_max3_f32 v18, v164, v165, v166
    v_max3_f32 v16, v16, v163, v96
    v_max3_f32 v18, v18, v167, v100
    v_max3_f32 v16, v16, v97, v98
    v_max3_f32 v18, v18, v101, v102
    v_max_f32 v16, v16, v99
    v_max_f32 v18, v18, v103
    v_mov_b32 v17, v16
    v_mfma_f32_16x16x32_bf16 v[104:107], v[32:35], a[240:243], 0
    ds_read_b128 v[24:27], v2 offset:18560
    v_mov_b32 v19, v18
    v_mfma_f32_16x16x32_bf16 v[104:107], v[36:39], a[244:247], v[104:107]
    s_nop 0
    v_permlane16_swap_b32 v16, v17
    v_permlane16_swap_b32 v18, v19
    s_nop 0
    v_max_f32 v16, v16, v17
    v_max_f32 v18, v18, v19
    v_mov_b32 v17, v16
    v_mov_b32 v19, v18
    v_mfma_f32_16x16x32_bf16 v[108:111], v[32:35], v[200:203], 0
    s_nop 0
    ds_read_b128 v[28:31], v3 offset:18560
    v_permlane32_swap_b32 v16, v17
    v_mfma_f32_16x16x32_bf16 v[108:111], v[36:39], v[204:207], v[108:111]
    s_waitcnt lgkmcnt(2)
    v_permlane32_swap_b32 v18, v19
    s_nop 0
    v_max_f32 v16, v16, v17
    v_max_f32 v18, v18, v19
    v_sub_f32 v136, 0, v16
    v_sub_f32 v137, 0, v16
    v_mfma_f32_16x16x32_bf16 v[168:171], v[40:43], a[248:251], v[168:171]
    ds_read_b128 v[32:35], v2 offset:12544
    v_sub_f32 v138, 0, v16
    v_mfma_f32_16x16x32_bf16 v[168:171], v[44:47], a[252:255], v[168:171]
    v_sub_f32 v139, 0, v16
    v_sub_f32 v140, 0, v18
    v_sub_f32 v141, 0, v18
    v_sub_f32 v142, 0, v18
    v_sub_f32 v143, 0, v18
    v_mfma_f32_16x16x32_bf16 v[172:175], v[40:43], v[208:211], v[172:175]
    ds_read_b128 v[36:39], v3 offset:12544
    v_mfma_f32_16x16x32_bf16 v[172:175], v[44:47], v[212:215], v[172:175]
    s_waitcnt lgkmcnt(2)
    s_waitcnt vmcnt(10)
    v_lshlrev_b32 v48, 16, v60
    v_and_b32 v49, s97, v60
    v_lshlrev_b32 v50, 16, v62
    v_and_b32 v51, s97, v62
    v_mul_f32 v48, s38, v48
    v_mul_f32 v49, s38, v49
    v_mul_f32_e64 v50, -v50, v48
    v_mfma_f32_16x16x32_bf16 v[104:107], v[24:27], a[248:251], v[104:107]
    ds_read_b128 v[40:43], v2 offset:18688
    v_mul_f32_e64 v51, -v51, v49
    v_mfma_f32_16x16x32_bf16 v[104:107], v[28:31], a[252:255], v[104:107]
    buffer_load_dwordx2 v[56:57], off, s[80:83], s37 offset:0
    v_cvt_f32_i32 v240, v240
    v_cvt_f32_i32 v241, v241
    v_fma_f32 v240, v240, v48, v50
    v_fma_f32 v241, v241, v49, v51
    v_cvt_pk_bf16_f32 v226, v240, v241
    v_mfma_f32_16x16x32_bf16 v[108:111], v[24:27], v[208:211], v[108:111]
    ds_read_b128 v[44:47], v3 offset:18688
    v_cvt_f32_i32 v244, v244
    v_mfma_f32_16x16x32_bf16 v[108:111], v[28:31], v[212:215], v[108:111]
    s_waitcnt lgkmcnt(2)
    buffer_load_dwordx2 v[58:59], off, s[84:87], s37 offset:0
    v_add_u32 v2, 49152, v2
    v_add_u32 v3, 49152, v3
    v_cvt_f32_i32 v245, v245
    v_fma_f32 v244, v244, v48, v50
    v_mfma_f32_16x16x32_bf16 v[168:171], v[32:35], v[192:195], v[168:171]
    ds_read_b128 v[24:27], v2 offset:0
    v_fma_f32 v245, v245, v49, v51
    v_mfma_f32_16x16x32_bf16 v[168:171], v[36:39], v[196:199], v[168:171]
    v_cvt_pk_bf16_f32 v230, v244, v245
    v_cvt_f32_i32 v248, v248
    v_cvt_f32_i32 v249, v249
    v_fma_f32 v248, v248, v48, v50
    v_fma_f32 v249, v249, v49, v51
    v_cvt_pk_bf16_f32 v234, v248, v249
    v_cvt_f32_i32 v252, v252
    v_mfma_f32_16x16x32_bf16 v[172:175], v[32:35], v[216:219], v[172:175]
    ds_read_b128 v[28:31], v3 offset:0
    v_cvt_f32_i32 v253, v253
    v_mfma_f32_16x16x32_bf16 v[172:175], v[36:39], v[220:223], v[172:175]
    s_waitcnt lgkmcnt(2)
    v_fma_f32 v252, v252, v48, v50
    v_fma_f32 v253, v253, v49, v51
    v_cvt_pk_bf16_f32 v238, v252, v253
    v_lshlrev_b32 v48, 16, v61
    v_and_b32 v49, s97, v61
    v_lshlrev_b32 v50, 16, v63
    v_and_b32 v51, s97, v63
    v_mfma_f32_16x16x32_bf16 v[104:107], v[40:43], v[192:195], v[104:107]
    ds_read_b128 v[32:35], v2 offset:6144
    v_mul_f32 v48, s38, v48
    v_mfma_f32_16x16x32_bf16 v[104:107], v[44:47], v[196:199], v[104:107]
    v_mul_f32 v49, s38, v49
    v_mul_f32_e64 v50, -v50, v48
    v_mul_f32_e64 v51, -v51, v49
    v_cvt_f32_i32 v242, v242
    v_cvt_f32_i32 v243, v243
    v_fma_f32 v242, v242, v48, v50
    v_mfma_f32_16x16x32_bf16 v[108:111], v[40:43], v[216:219], v[108:111]
    ds_read_b128 v[36:39], v3 offset:6144
    v_add_f32 v160, v160, v136
    v_mfma_f32_16x16x32_bf16 v[108:111], v[44:47], v[220:223], v[108:111]
    s_waitcnt lgkmcnt(2)
    v_add_f32 v161, v161, v136
    v_add_f32 v162, v162, v136
    v_add_f32 v163, v163, v136
    v_add_f32 v96, v96, v136
    v_add_f32 v97, v97, v136
    v_add_f32 v98, v98, v136
    v_add_f32 v99, v99, v136
    v_mfma_f32_16x16x32_bf16 v[176:179], v[24:27], a[240:243], v[136:139]
    ds_read_b128 v[40:43], v2 offset:128
    v_add_f32 v164, v164, v140
    v_mfma_f32_16x16x32_bf16 v[176:179], v[28:31], a[244:247], v[176:179]
    v_add_f32 v165, v165, v140
    v_add_f32 v166, v166, v140
    v_add_f32 v167, v167, v140
    v_add_f32 v100, v100, v140
    v_add_f32 v101, v101, v140
    v_add_f32 v102, v102, v140
    v_mfma_f32_16x16x32_bf16 v[180:183], v[24:27], v[200:203], v[140:143]
    ds_read_b128 v[44:47], v3 offset:128
    v_add_f32 v103, v103, v140
    v_mfma_f32_16x16x32_bf16 v[180:183], v[28:31], v[204:207], v[180:183]
    s_waitcnt lgkmcnt(2)
    v_exp_f32 v16, v160
    v_exp_f32 v17, v161
    v_exp_f32 v18, v162
    v_add_f32 v7, v7, v16
    v_mfma_f32_16x16x32_bf16 v[112:115], v[32:35], a[240:243], v[136:139]
    ds_read_b128 v[24:27], v2 offset:6272
    v_add_f32 v7, v7, v17
    v_mfma_f32_16x16x32_bf16 v[112:115], v[36:39], a[244:247], v[112:115]
    v_exp_f32 v19, v163
    v_cvt_pk_bf16_f32 v160, v16, v17
    v_exp_f32 v16, v96
    v_add_f32 v7, v7, v18
    v_add_f32 v7, v7, v19
    v_mfma_f32_16x16x32_bf16 v[116:119], v[32:35], v[200:203], v[140:143]
    ds_read_b128 v[28:31], v3 offset:6272
    v_fma_f32 v243, v243, v49, v51
    v_mfma_f32_16x16x32_bf16 v[116:119], v[36:39], v[204:207], v[116:119]
    s_waitcnt lgkmcnt(2)
    v_exp_f32 v17, v97
    v_cvt_pk_bf16_f32 v161, v18, v19
    v_exp_f32 v18, v98
    v_add_f32 v7, v7, v16
    v_mfma_f32_16x16x32_bf16 v[176:179], v[40:43], a[248:251], v[176:179]
    ds_read_b128 v[32:35], v2 offset:256
    v_add_f32 v7, v7, v17
    v_mfma_f32_16x16x32_bf16 v[176:179], v[44:47], a[252:255], v[176:179]
    v_exp_f32 v19, v99
    v_cvt_pk_bf16_f32 v162, v16, v17
    v_exp_f32 v16, v164
    v_add_f32 v7, v7, v18
    v_add_f32 v7, v7, v19
    v_mfma_f32_16x16x32_bf16 v[180:183], v[40:43], v[208:211], v[180:183]
    ds_read_b128 v[36:39], v3 offset:256
    v_cvt_pk_bf16_f32 v227, v242, v243
    v_mfma_f32_16x16x32_bf16 v[180:183], v[44:47], v[212:215], v[180:183]
    s_waitcnt lgkmcnt(2)
    v_exp_f32 v17, v165
    v_cvt_pk_bf16_f32 v163, v18, v19
    v_exp_f32 v18, v166
    v_add_f32 v8, v8, v16
    v_mfma_f32_16x16x32_bf16 v[112:115], v[24:27], a[248:251], v[112:115]
    ds_read_b128 v[40:43], v2 offset:6400
    v_add_f32 v8, v8, v17
    v_mfma_f32_16x16x32_bf16 v[112:115], v[28:31], a[252:255], v[112:115]
    v_exp_f32 v19, v167
    v_cvt_pk_bf16_f32 v164, v16, v17
    v_exp_f32 v16, v100
    v_add_f32 v8, v8, v18
    v_add_f32 v8, v8, v19
    v_mfma_f32_16x16x32_bf16 v[116:119], v[24:27], v[208:211], v[116:119]
    ds_read_b128 v[44:47], v3 offset:6400
    v_cvt_f32_i32 v246, v246
    v_mfma_f32_16x16x32_bf16 v[116:119], v[28:31], v[212:215], v[116:119]
    s_waitcnt lgkmcnt(2)
    v_exp_f32 v17, v101
    v_cvt_pk_bf16_f32 v165, v18, v19
    v_exp_f32 v18, v102
    v_add_f32 v8, v8, v16
    v_add_f32 v8, v8, v17
    v_mfma_f32_16x16x32_bf16 v[176:179], v[32:35], v[192:195], v[176:179]
    ds_read_b128 v[24:27], v2 offset:12288
    v_cvt_f32_i32 v247, v247
    v_mfma_f32_16x16x32_bf16 v[176:179], v[36:39], v[196:199], v[176:179]
    v_exp_f32 v19, v103
    v_cvt_pk_bf16_f32 v166, v16, v17
    v_add_f32 v8, v8, v18
    v_add_f32 v8, v8, v19
    v_cvt_pk_bf16_f32 v167, v18, v19
    v_mfma_f32_16x16x32_bf16 v[180:183], v[32:35], v[216:219], v[180:183]
    ds_read_b128 v[28:31], v3 offset:12288
    v_add_f32 v168, v168, v136
    v_mfma_f32_16x16x32_bf16 v[180:183], v[36:39], v[220:223], v[180:183]
    s_waitcnt lgkmcnt(2)
    v_add_f32 v169, v169, v136
    v_add_f32 v170, v170, v136
    v_add_f32 v171, v171, v136
    v_add_f32 v104, v104, v136
    v_add_f32 v105, v105, v136
    v_add_f32 v106, v106, v136
    v_add_f32 v107, v107, v136
    v_mfma_f32_16x16x32_bf16 v[112:115], v[40:43], v[192:195], v[112:115]
    ds_read_b128 v[32:35], v2 offset:18432
    v_fma_f32 v246, v246, v48, v50
    v_mfma_f32_16x16x32_bf16 v[112:115], v[44:47], v[196:199], v[112:115]
    v_fma_f32 v247, v247, v49, v51
    v_cvt_pk_bf16_f32 v231, v246, v247
    v_cvt_f32_i32 v250, v250
    v_add_f32 v172, v172, v140
    v_add_f32 v173, v173, v140
    v_add_f32 v174, v174, v140
    v_add_f32 v175, v175, v140
    v_mfma_f32_16x16x32_bf16 v[116:119], v[40:43], v[216:219], v[116:119]
    ds_read_b128 v[36:39], v3 offset:18432
    v_cvt_f32_i32 v251, v251
    v_mfma_f32_16x16x32_bf16 v[116:119], v[44:47], v[220:223], v[116:119]
    s_waitcnt lgkmcnt(2)
    v_fma_f32 v250, v250, v48, v50
    v_fma_f32 v251, v251, v49, v51
    v_cvt_pk_bf16_f32 v235, v250, v251
    v_cvt_f32_i32 v254, v254
    v_add_f32 v108, v108, v140
    v_add_f32 v109, v109, v140
    v_mfma_f32_16x16x32_bf16 v[184:187], v[24:27], a[240:243], v[136:139]
    ds_read_b128 v[40:43], v2 offset:12416
    v_cvt_f32_i32 v255, v255
    v_fma_f32 v254, v254, v48, v50
    v_fma_f32 v255, v255, v49, v51
    v_cvt_pk_bf16_f32 v239, v254, v255
    v_mfma_f32_16x16x32_bf16 v[184:187], v[28:31], a[244:247], v[184:187]
    buffer_store_dwordx4 v[224:227], v11, s[4:7], s33 offen offset:0 sc1
    v_add_f32 v110, v110, v140
    v_add_f32 v111, v111, v140
    v_xor_b32 v55, 16, v11
    v_mfma_f32_16x16x32_bf16 v[188:191], v[24:27], v[200:203], v[140:143]
    ds_read_b128 v[44:47], v3 offset:12416
    v_mfma_f32_16x16x32_bf16 v[188:191], v[28:31], v[204:207], v[188:191]
    s_waitcnt lgkmcnt(2)
    v_exp_f32 v16, v168
    v_exp_f32 v17, v169
    v_exp_f32 v18, v170
    v_mfma_f32_16x16x32_bf16 v[120:123], v[32:35], a[240:243], v[136:139]
    ds_read_b128 v[24:27], v2 offset:18560
    v_add_f32 v7, v7, v16
    v_mfma_f32_16x16x32_bf16 v[120:123], v[36:39], a[244:247], v[120:123]
    buffer_store_dwordx4 v[228:231], v55, s[4:7], s33 offen offset:768 sc1
    v_add_f32 v7, v7, v17
    v_exp_f32 v19, v171
    v_mfma_f32_16x16x32_bf16 v[124:127], v[32:35], v[200:203], v[140:143]
    ds_read_b128 v[28:31], v3 offset:18560
    v_cvt_pk_bf16_f32 v168, v16, v17
    v_mfma_f32_16x16x32_bf16 v[124:127], v[36:39], v[204:207], v[124:127]
    s_waitcnt lgkmcnt(2)
    v_exp_f32 v16, v104
    v_add_f32 v7, v7, v18
    v_add_f32 v7, v7, v19
    v_exp_f32 v17, v105
    v_cvt_pk_bf16_f32 v169, v18, v19
    v_mfma_f32_16x16x32_bf16 v[184:187], v[40:43], a[248:251], v[184:187]
    ds_read_b128 v[32:35], v2 offset:12544
    v_mfma_f32_16x16x32_bf16 v[184:187], v[44:47], a[252:255], v[184:187]
    v_exp_f32 v18, v106
    v_add_f32 v7, v7, v16
    v_add_f32 v7, v7, v17
    v_exp_f32 v19, v107
    v_mfma_f32_16x16x32_bf16 v[188:191], v[40:43], v[208:211], v[188:191]
    ds_read_b128 v[36:39], v3 offset:12544
    v_cvt_pk_bf16_f32 v170, v16, v17
    v_mfma_f32_16x16x32_bf16 v[188:191], v[44:47], v[212:215], v[188:191]
    s_waitcnt lgkmcnt(2)
    v_exp_f32 v16, v172
    v_add_f32 v7, v7, v18
    v_add_f32 v7, v7, v19
    v_exp_f32 v17, v173
    v_cvt_pk_bf16_f32 v171, v18, v19
    v_mfma_f32_16x16x32_bf16 v[120:123], v[24:27], a[248:251], v[120:123]
    ds_read_b128 v[40:43], v2 offset:18688
    v_xor_b32 v54, 32, v11
    v_mfma_f32_16x16x32_bf16 v[120:123], v[28:31], a[252:255], v[120:123]
    s_waitcnt vmcnt(4)
    v_exp_f32 v18, v174
    v_add_f32 v8, v8, v16
    v_add_f32 v8, v8, v17
    v_exp_f32 v19, v175
    v_cvt_pk_bf16_f32 v172, v16, v17
    v_mfma_f32_16x16x32_bf16 v[124:127], v[24:27], v[208:211], v[124:127]
    ds_read_b128 v[44:47], v3 offset:18688
    v_mfma_f32_16x16x32_bf16 v[124:127], v[28:31], v[212:215], v[124:127]
    s_waitcnt lgkmcnt(2)
    s_barrier
    v_add_u32 v2, 49152, v2
    v_add_u32 v3, 49152, v3
    v_exp_f32 v16, v108
    v_mfma_f32_16x16x32_bf16 v[184:187], v[32:35], v[192:195], v[184:187]
    ds_read_b128 v[24:27], v2 offset:0
    v_add_f32 v8, v8, v18
    v_mfma_f32_16x16x32_bf16 v[184:187], v[36:39], v[196:199], v[184:187]
    buffer_store_dwordx4 v[232:235], v54, s[4:7], s33 offen offset:1536 sc1
    v_add_f32 v8, v8, v19
    v_exp_f32 v17, v109
    v_mfma_f32_16x16x32_bf16 v[188:191], v[32:35], v[216:219], v[188:191]
    ds_read_b128 v[28:31], v3 offset:0
    v_cvt_pk_bf16_f32 v173, v18, v19
    v_mfma_f32_16x16x32_bf16 v[188:191], v[36:39], v[220:223], v[188:191]
    s_waitcnt lgkmcnt(2)
    v_exp_f32 v18, v110
    v_add_f32 v8, v8, v16
    v_add_f32 v8, v8, v17
    v_exp_f32 v19, v111
    v_cvt_pk_bf16_f32 v174, v16, v17
    v_mfma_f32_16x16x32_bf16 v[120:123], v[40:43], v[192:195], v[120:123]
    ds_read_b128 v[32:35], v2 offset:6144
    v_xor_b32 v55, 48, v11
    v_mfma_f32_16x16x32_bf16 v[120:123], v[44:47], v[196:199], v[120:123]
    buffer_store_dwordx4 v[236:239], v55, s[4:7], s33 offen offset:2304 sc1
    v_add_f32 v8, v8, v18
    v_add_f32 v8, v8, v19
    v_cvt_pk_bf16_f32 v175, v18, v19
    v_mfma_f32_16x16x32_bf16 v[124:127], v[40:43], v[216:219], v[124:127]
    ds_read_b128 v[36:39], v3 offset:6144
    v_mfma_f32_16x16x32_bf16 v[124:127], v[44:47], v[220:223], v[124:127]
    s_waitcnt lgkmcnt(2)
    v_mfma_f32_16x16x32_bf16 v[64:67], v[24:27], a[192:195], v[128:131]
    ds_read_b128 v[40:43], v2 offset:128
    v_mfma_f32_16x16x32_bf16 v[64:67], v[28:31], a[196:199], v[64:67]
    buffer_load_dwordx2 v[60:61], off, s[80:83], s37 offset:8
    v_mfma_f32_16x16x32_bf16 v[68:71], v[24:27], a[216:219], v[132:135]
    v_exp_f32 v16, v176
    v_mfma_f32_16x16x32_bf16 v[68:71], v[28:31], a[220:223], v[68:71]
    v_exp_f32 v17, v177
    v_mfma_f32_16x16x32_bf16 v[72:75], v[24:27], a[240:243], v[136:139]
    ds_read_b128 v[44:47], v3 offset:128
    v_mfma_f32_16x16x32_bf16 v[72:75], v[28:31], a[244:247], v[72:75]
    buffer_load_dwordx2 v[62:63], off, s[84:87], s37 offset:8
    v_mfma_f32_16x16x32_bf16 v[76:79], v[24:27], v[200:203], v[140:143]
    v_exp_f32 v18, v178
    v_mfma_f32_16x16x32_bf16 v[76:79], v[28:31], v[204:207], v[76:79]
    s_waitcnt lgkmcnt(2)
    v_add_f32 v7, v7, v16
    v_add_f32 v7, v7, v17
    v_mfma_f32_16x16x32_bf16 v[96:99], v[32:35], a[192:195], v[128:131]
    ds_read_b128 v[24:27], v2 offset:6272
    v_mfma_f32_16x16x32_bf16 v[96:99], v[36:39], a[196:199], v[96:99]
    buffer_load_dwordx4 v[240:243], v12, s[68:71], s16 offen offset:0 nt
    v_mfma_f32_16x16x32_bf16 v[100:103], v[32:35], a[216:219], v[132:135]
    s_waitcnt vmcnt(7)
    v_exp_f32 v19, v179
    v_mfma_f32_16x16x32_bf16 v[100:103], v[36:39], a[220:223], v[100:103]
    v_cvt_pk_bf16_f32 v176, v16, v17
    v_exp_f32 v16, v112
    v_mfma_f32_16x16x32_bf16 v[104:107], v[32:35], a[240:243], v[136:139]
    ds_read_b128 v[28:31], v3 offset:6272
    v_add_f32 v7, v7, v18
    v_mfma_f32_16x16x32_bf16 v[104:107], v[36:39], a[244:247], v[104:107]
    buffer_load_dwordx4 v[244:247], v12, s[68:71], s16 offen offset:768 nt
    v_add_f32 v7, v7, v19
    v_mfma_f32_16x16x32_bf16 v[108:111], v[32:35], v[200:203], v[140:143]
    v_exp_f32 v17, v113
    v_mfma_f32_16x16x32_bf16 v[108:111], v[36:39], v[204:207], v[108:111]
    s_waitcnt lgkmcnt(2)
    v_cvt_pk_bf16_f32 v177, v18, v19
    v_exp_f32 v18, v114
    v_mfma_f32_16x16x32_bf16 v[64:67], v[40:43], a[200:203], v[64:67]
    ds_read_b128 v[32:35], v2 offset:256
    v_add_f32 v7, v7, v16
    v_mfma_f32_16x16x32_bf16 v[64:67], v[44:47], a[204:207], v[64:67]
    buffer_load_dwordx4 v[248:251], v12, s[68:71], s16 offen offset:1536 nt
    v_add_f32 v7, v7, v17
    v_mfma_f32_16x16x32_bf16 v[68:71], v[40:43], a[224:227], v[68:71]
    v_exp_f32 v19, v115
    v_mfma_f32_16x16x32_bf16 v[68:71], v[44:47], a[228:231], v[68:71]
    v_cvt_pk_bf16_f32 v178, v16, v17
    v_exp_f32 v16, v180
    v_mfma_f32_16x16x32_bf16 v[72:75], v[40:43], a[248:251], v[72:75]
    ds_read_b128 v[36:39], v3 offset:256
    v_add_f32 v7, v7, v18
    v_mfma_f32_16x16x32_bf16 v[72:75], v[44:47], a[252:255], v[72:75]
    buffer_load_dwordx4 v[252:255], v12, s[68:71], s16 offen offset:2304 nt
    v_add_f32 v7, v7, v19
    v_mfma_f32_16x16x32_bf16 v[76:79], v[40:43], v[208:211], v[76:79]
    v_exp_f32 v17, v181
    v_mfma_f32_16x16x32_bf16 v[76:79], v[44:47], v[212:215], v[76:79]
    s_waitcnt lgkmcnt(2)
    v_cvt_pk_bf16_f32 v179, v18, v19
    v_exp_f32 v18, v182
    v_mfma_f32_16x16x32_bf16 v[96:99], v[24:27], a[200:203], v[96:99]
    s_mov_b32 m0, s26
    ds_read_b128 v[40:43], v2 offset:6400
    v_add_f32 v8, v8, v16
    v_mfma_f32_16x16x32_bf16 v[96:99], v[28:31], a[204:207], v[96:99]
    buffer_load_dwordx4 v4, s[4:7], s32 offen offset:0 sc1 lds
    v_add_f32 v8, v8, v17
    v_mfma_f32_16x16x32_bf16 v[100:103], v[24:27], a[224:227], v[100:103]
    v_exp_f32 v19, v183
    v_mfma_f32_16x16x32_bf16 v[100:103], v[28:31], a[228:231], v[100:103]
    v_cvt_pk_bf16_f32 v180, v16, v17
    v_exp_f32 v16, v116
    v_mfma_f32_16x16x32_bf16 v[104:107], v[24:27], a[248:251], v[104:107]
    ds_read_b128 v[44:47], v3 offset:6400
    v_add_f32 v8, v8, v18
    v_mfma_f32_16x16x32_bf16 v[104:107], v[28:31], a[252:255], v[104:107]
    buffer_load_dwordx4 v4, s[4:7], s32 offen offset:1024 sc1 lds
    v_add_f32 v8, v8, v19
    v_mfma_f32_16x16x32_bf16 v[108:111], v[24:27], v[208:211], v[108:111]
    v_exp_f32 v17, v117
    v_mfma_f32_16x16x32_bf16 v[108:111], v[28:31], v[212:215], v[108:111]
    s_waitcnt lgkmcnt(2)
    v_cvt_pk_bf16_f32 v181, v18, v19
    v_exp_f32 v18, v118
    v_mfma_f32_16x16x32_bf16 v[64:67], v[32:35], a[208:211], v[64:67]
    ds_read_b128 v[24:27], v2 offset:12288
    v_add_f32 v8, v8, v16
    v_mfma_f32_16x16x32_bf16 v[64:67], v[36:39], a[212:215], v[64:67]
    buffer_load_dwordx4 v4, s[4:7], s32 offen offset:2048 sc1 lds
    v_add_f32 v8, v8, v17
    v_mfma_f32_16x16x32_bf16 v[68:71], v[32:35], a[232:235], v[68:71]
    s_add_u32 s32, s32, 24576
    v_exp_f32 v19, v119
    v_mfma_f32_16x16x32_bf16 v[68:71], v[36:39], a[236:239], v[68:71]
    v_cvt_pk_bf16_f32 v182, v16, v17
    v_add_f32 v8, v8, v18
    v_add_f32 v8, v8, v19
    v_mfma_f32_16x16x32_bf16 v[72:75], v[32:35], v[192:195], v[72:75]
    s_sub_u32 s57, s32, 196608
    ds_read_b128 v[28:31], v3 offset:12288
    v_cvt_pk_bf16_f32 v183, v18, v19
    v_mfma_f32_16x16x32_bf16 v[72:75], v[36:39], v[196:199], v[72:75]
    s_waitcnt lgkmcnt(2)
    v_exp_f32 v16, v184
    v_lshlrev_b32 v48, 16, v56
    v_mfma_f32_16x16x32_bf16 v[76:79], v[32:35], v[216:219], v[76:79]
    s_waitcnt vmcnt(9)
    v_exp_f32 v17, v185
    v_mfma_f32_16x16x32_bf16 v[76:79], v[36:39], v[220:223], v[76:79]
    s_barrier
    v_exp_f32 v18, v186
    v_mfma_f32_16x16x32_bf16 v[96:99], v[40:43], a[208:211], v[96:99]
    s_min_u32 s32, s32, s57
    ds_read_b128 v[32:35], v2 offset:18432
    v_add_f32 v7, v7, v16
    v_mfma_f32_16x16x32_bf16 v[96:99], v[44:47], a[212:215], v[96:99]
    v_add_f32 v7, v7, v17
    v_exp_f32 v19, v187
    v_mfma_f32_16x16x32_bf16 v[100:103], v[40:43], a[232:235], v[100:103]
    s_add_u32 s26, s26, 12288
    v_cvt_pk_bf16_f32 v184, v16, v17
    v_and_b32 v49, s97, v56
    v_mfma_f32_16x16x32_bf16 v[100:103], v[44:47], a[236:239], v[100:103]
    v_exp_f32 v16, v120
    v_add_f32 v7, v7, v18
    v_mfma_f32_16x16x32_bf16 v[104:107], v[40:43], v[192:195], v[104:107]
    s_mov_b32 m0, s26
    ds_read_b128 v[36:39], v3 offset:18432
    v_add_f32 v7, v7, v19
    v_mfma_f32_16x16x32_bf16 v[104:107], v[44:47], v[196:199], v[104:107]
L_iw2:
L_pg2:
    s_cbranch_execz L_pg6
    buffer_load_dwordx4 v4, s[4:7], s32 offen offset:0 sc1 lds
    v_lshlrev_b32 v50, 16, v58
    v_mfma_f32_16x16x32_bf16 v[108:111], v[40:43], v[216:219], v[108:111]
    v_exp_f32 v17, v121
    v_mfma_f32_16x16x32_bf16 v[108:111], v[44:47], v[220:223], v[108:111]
    s_waitcnt lgkmcnt(2)
    v_cvt_pk_bf16_f32 v185, v18, v19
    v_exp_f32 v18, v122
    v_mfma_f32_16x16x32_bf16 v[80:83], v[24:27], a[192:195], v[128:131]
    ds_read_b128 v[40:43], v2 offset:12416
    v_add_f32 v7, v7, v16
    v_mfma_f32_16x16x32_bf16 v[80:83], v[28:31], a[196:199], v[80:83]
    buffer_load_dwordx4 v4, s[4:7], s32 offen offset:1024 sc1 lds
    v_add_f32 v7, v7, v17
    v_mfma_f32_16x16x32_bf16 v[84:87], v[24:27], a[216:219], v[132:135]
    v_exp_f32 v19, v123
    v_mfma_f32_16x16x32_bf16 v[84:87], v[28:31], a[220:223], v[84:87]
    v_cvt_pk_bf16_f32 v186, v16, v17
    v_exp_f32 v16, v188
    v_mfma_f32_16x16x32_bf16 v[88:91], v[24:27], a[240:243], v[136:139]
    ds_read_b128 v[44:47], v3 offset:12416
    v_add_f32 v7, v7, v18
    v_mfma_f32_16x16x32_bf16 v[88:91], v[28:31], a[244:247], v[88:91]
    v_add_u32 v0, 1, v0
    buffer_store_dword v0, v13, s[20:23], 0 offen offset:32 sc1
    v_mfma_f32_16x16x32_bf16 v[92:95], v[24:27], v[200:203], v[140:143]
    v_add_f32 v7, v7, v19
    v_exp_f32 v17, v189
    v_cvt_pk_bf16_f32 v187, v18, v19
    v_exp_f32 v18, v190
    v_add_f32 v8, v8, v16
    v_add_f32 v8, v8, v17
    v_exp_f32 v19, v191
    v_cvt_pk_bf16_f32 v188, v16, v17
    v_exp_f32 v16, v124
    v_add_f32 v8, v8, v18
    v_add_f32 v8, v8, v19
    v_exp_f32 v17, v125
    v_cvt_pk_bf16_f32 v189, v18, v19
    v_exp_f32 v18, v126
    v_add_f32 v8, v8, v16
    v_add_f32 v8, v8, v17
    v_exp_f32 v19, v127
    v_cvt_pk_bf16_f32 v190, v16, v17
    v_add_f32 v8, v8, v18
    v_add_f32 v8, v8, v19
    v_cvt_pk_bf16_f32 v191, v18, v19
    v_mfma_f32_16x16x32_bf16 v[92:95], v[28:31], v[204:207], v[92:95]
    s_waitcnt lgkmcnt(2)
    v_and_b32 v51, s97, v58
    v_mul_f32_e64 v50, -v50, v48
    v_mul_f32_e64 v51, -v51, v49
    v_mfma_f32_16x16x32_bf16 v[112:115], v[32:35], a[192:195], v[128:131]
    ds_read_b128 v[24:27], v2 offset:18560
    v_cvt_f32_i32 v144, v144
    v_mfma_f32_16x16x32_bf16 v[112:115], v[36:39], a[196:199], v[112:115]
    buffer_load_dwordx4 v4, s[4:7], s32 offen offset:2048 sc1 lds
    v_cvt_f32_i32 v148, v148
    v_mfma_f32_16x16x32_bf16 v[116:119], v[32:35], a[216:219], v[132:135]
    s_mov_b32 s32, 196608
    v_fma_f32 v144, v144, v48, v50
    v_fma_f32 v148, v148, v49, v51
    v_mfma_f32_16x16x32_bf16 v[116:119], v[36:39], a[220:223], v[116:119]
    v_cvt_f32_i32 v145, v145
    v_cvt_f32_i32 v149, v149
    v_fma_f32 v145, v145, v48, v50
    v_mfma_f32_16x16x32_bf16 v[120:123], v[32:35], a[240:243], v[136:139]
    s_add_u32 s26, s26, 36864
    ds_read_b128 v[28:31], v3 offset:18560
    v_fma_f32 v149, v149, v49, v51
    v_mfma_f32_16x16x32_bf16 v[120:123], v[36:39], a[244:247], v[120:123]
    v_cvt_f32_i32 v146, v146
    v_cvt_f32_i32 v150, v150
    v_fma_f32 v146, v146, v48, v50
    v_mfma_f32_16x16x32_bf16 v[124:127], v[32:35], v[200:203], v[140:143]
    s_sub_u32 s57, s26, 147456
    v_fma_f32 v150, v150, v49, v51
    v_cvt_f32_i32 v147, v147
    v_mfma_f32_16x16x32_bf16 v[124:127], v[36:39], v[204:207], v[124:127]
    s_waitcnt lgkmcnt(2)
    v_cvt_f32_i32 v151, v151
    v_exp_f32 v16, v64
    v_mfma_f32_16x16x32_bf16 v[80:83], v[40:43], a[200:203], v[80:83]
    s_min_u32 s26, s26, s57
    ds_read_b128 v[32:35], v2 offset:12544
    v_fma_f32 v147, v147, v48, v50
    v_mfma_f32_16x16x32_bf16 v[80:83], v[44:47], a[204:207], v[80:83]
    v_exp_f32 v17, v65
    v_fma_f32 v151, v151, v49, v51
    v_mfma_f32_16x16x32_bf16 v[84:87], v[40:43], a[224:227], v[84:87]
    s_mov_b32 m0, s56
    v_exp_f32 v18, v66
    v_mfma_f32_16x16x32_bf16 v[84:87], v[44:47], a[228:231], v[84:87]
    buffer_load_dwordx4 v4, s[4:7], s27 offen offset:0 sc1 lds
    v_lshlrev_b32 v48, 16, v57
    v_mfma_f32_16x16x32_bf16 v[88:91], v[40:43], a[248:251], v[88:91]
    ds_read_b128 v[36:39], v3 offset:12544
    v_add_f32 v5, v5, v16
    v_mfma_f32_16x16x32_bf16 v[88:91], v[44:47], a[252:255], v[88:91]
    v_add_f32 v5, v5, v17
    v_and_b32 v49, s97, v57
    v_lshlrev_b32 v50, 16, v59
    v_mfma_f32_16x16x32_bf16 v[92:95], v[40:43], v[208:211], v[92:95]
    v_exp_f32 v19, v67
    v_mfma_f32_16x16x32_bf16 v[92:95], v[44:47], v[212:215], v[92:95]
    s_waitcnt lgkmcnt(2)
    buffer_load_dwordx4 v4, s[4:7], s27 offen offset:1024 sc1 lds
    v_cvt_pk_bf16_f32 v64, v16, v17
    v_mfma_f32_16x16x32_bf16 v[112:115], v[24:27], a[200:203], v[112:115]
    ds_read_b128 v[40:43], v2 offset:18688
    v_and_b32 v51, s97, v59
    v_mfma_f32_16x16x32_bf16 v[112:115], v[28:31], a[204:207], v[112:115]
    v_exp_f32 v16, v96
    v_add_f32 v5, v5, v18
    v_mfma_f32_16x16x32_bf16 v[116:119], v[24:27], a[224:227], v[116:119]
    v_add_f32 v5, v5, v19
    v_mul_f32_e64 v50, -v50, v48
    v_mfma_f32_16x16x32_bf16 v[116:119], v[28:31], a[228:231], v[116:119]
    s_waitcnt vmcnt(13)
    buffer_load_dwordx4 v4, s[4:7], s27 offen offset:2048 sc1 lds
    v_mul_f32_e64 v51, -v51, v49
    v_mfma_f32_16x16x32_bf16 v[120:123], v[24:27], a[248:251], v[120:123]
    s_add_u32 s27, s27, 24576
    ds_read_b128 v[44:47], v3 offset:18688
    v_cvt_f32_i32 v152, v152
    v_mfma_f32_16x16x32_bf16 v[120:123], v[28:31], a[252:255], v[120:123]
    s_waitcnt lgkmcnt(2)
    v_exp_f32 v17, v97
    v_cvt_pk_bf16_f32 v65, v18, v19
    v_mfma_f32_16x16x32_bf16 v[124:127], v[24:27], v[208:211], v[124:127]
    s_sub_u32 s58, s27, 196608
    v_exp_f32 v18, v98
    v_mfma_f32_16x16x32_bf16 v[124:127], v[28:31], v[212:215], v[124:127]
    s_barrier
    v_subrev_u32 v1, 49152, v1
    v_add_f32 v5, v5, v16
    v_mfma_f32_16x16x32_bf16 v[80:83], v[32:35], a[208:211], v[80:83]
    s_min_u32 s27, s27, s58
    ds_read_b128 v[24:27], v1 offset:0
    v_add_f32 v5, v5, v17
    v_mfma_f32_16x16x32_bf16 v[80:83], v[36:39], a[212:215], v[80:83]
    v_exp_f32 v19, v99
    v_cvt_f32_i32 v156, v156
    v_mfma_f32_16x16x32_bf16 v[84:87], v[32:35], a[232:235], v[84:87]
    s_add_u32 s56, s56, 12288
    v_cvt_pk_bf16_f32 v66, v16, v17
    v_fma_f32 v152, v152, v48, v50
    v_mfma_f32_16x16x32_bf16 v[84:87], v[36:39], a[236:239], v[84:87]
    v_exp_f32 v16, v68
    v_fma_f32 v156, v156, v49, v51
    v_mfma_f32_16x16x32_bf16 v[88:91], v[32:35], v[192:195], v[88:91]
    s_mov_b32 m0, s56
    ds_read_b128 v[28:31], v1 offset:12288
    v_add_f32 v5, v5, v18
    v_mfma_f32_16x16x32_bf16 v[88:91], v[36:39], v[196:199], v[88:91]
    s_waitcnt vmcnt(12)
    buffer_load_dwordx4 v4, s[4:7], s27 offen offset:0 sc1 lds
    v_add_f32 v5, v5, v19
    v_mfma_f32_16x16x32_bf16 v[92:95], v[32:35], v[216:219], v[92:95]
    v_exp_f32 v17, v69
    v_mfma_f32_16x16x32_bf16 v[92:95], v[36:39], v[220:223], v[92:95]
    s_waitcnt lgkmcnt(2)
    v_cvt_f32_i32 v153, v153
    v_cvt_pk_bf16_f32 v67, v18, v19
    v_cvt_f32_i32 v157, v157
    v_mfma_f32_16x16x32_bf16 v[112:115], v[40:43], a[208:211], v[112:115]
    ds_read_b128 v[32:35], v1 offset:1024
    v_fma_f32 v153, v153, v48, v50
    v_mfma_f32_16x16x32_bf16 v[112:115], v[44:47], a[212:215], v[112:115]
    s_waitcnt vmcnt(12)
    buffer_load_dwordx4 v4, s[4:7], s27 offen offset:1024 sc1 lds
    v_fma_f32 v157, v157, v49, v51
    v_mfma_f32_16x16x32_bf16 v[116:119], v[40:43], a[232:235], v[116:119]
    s_waitcnt vmcnt(12)
    buffer_load_dwordx4 v4, s[4:7], s27 offen offset:2048 sc1 lds
    v_mfma_f32_16x16x32_bf16 v[116:119], v[44:47], a[236:239], v[116:119]
    v_exp_f32 v18, v70
    v_add_f32 v6, v6, v16
    v_mfma_f32_16x16x32_bf16 v[120:123], v[40:43], v[192:195], v[120:123]
    s_add_u32 s27, s27, 24576
    ds_read_b128 v[36:39], v1 offset:13312
    v_add_f32 v6, v6, v17
    v_mfma_f32_16x16x32_bf16 v[120:123], v[44:47], v[196:199], v[120:123]
    v_exp_f32 v19, v71
    v_cvt_pk_bf16_f32 v68, v16, v17
    v_mfma_f32_16x16x32_bf16 v[124:127], v[40:43], v[216:219], v[124:127]
    s_sub_u32 s58, s27, 196608
    v_exp_f32 v16, v100
    v_mfma_f32_16x16x32_bf16 v[124:127], v[44:47], v[220:223], v[124:127]
    s_waitcnt lgkmcnt(2)
    v_cvt_f32_i32 v154, v154
    v_add_f32 v6, v6, v18
    v_cvt_f32_i32 v158, v158
    v_add_f32 v6, v6, v19
    v_fma_f32 v154, v154, v48, v50
    v_exp_f32 v17, v101
    v_fma_f32 v158, v158, v49, v51
    v_cvt_f32_i32 v155, v155
    v_cvt_pk_bf16_f32 v69, v18, v19
    v_cvt_f32_i32 v159, v159
    v_exp_f32 v18, v102
    v_fma_f32 v155, v155, v48, v50
    v_fma_f32 v159, v159, v49, v51
    v_add_f32 v6, v6, v16
    v_cvt_pk_bf16_f32 v144, v144, v148
    v_add_f32 v6, v6, v17
    v_cvt_pk_bf16_f32 v148, v145, v149
    v_exp_f32 v19, v103
    v_cvt_pk_bf16_f32 v145, v152, v156
    v_cvt_pk_bf16_f32 v149, v153, v157
    v_cvt_pk_bf16_f32 v70, v16, v17
    s_min_u32 s27, s27, s58
    v_cvt_pk_bf16_f32 v152, v146, v150
    v_add_f32 v6, v6, v18
    s_add_u32 s56, s56, 36864
    v_cvt_pk_bf16_f32 v153, v154, v158
    v_add_f32 v6, v6, v19
    s_sub_u32 s58, s56, 147456
    v_cvt_pk_bf16_f32 v156, v147, v151
    v_cvt_pk_bf16_f32 v71, v18, v19
    s_min_u32 s56, s56, s58
    v_cvt_pk_bf16_f32 v157, v155, v159
    s_mov_b32 s31, 7
    s_mul_i32 s46, s95, 24576
    s_mov_b32 s47, 12288
    v_mfma_f32_16x16x32_bf16 a[96:99], v[160:163], v[24:27], 0
    s_add_u32 s33, s33, 196608
    ds_read_b128 v[40:43], v1 offset:2048
    v_mfma_f32_16x16x32_bf16 a[96:99], v[168:171], v[28:31], a[96:99]
    s_add_u32 s34, s34, 196608
    v_exp_f32 v16, v72
    v_mfma_f32_16x16x32_bf16 a[144:147], v[164:167], v[24:27], 0
    s_add_u32 s36, s36, 1536
    ds_read_b128 v[44:47], v1 offset:14336
    v_mfma_f32_16x16x32_bf16 a[144:147], v[172:175], v[28:31], a[144:147]
    s_waitcnt lgkmcnt(2)
    v_exp_f32 v17, v73
    v_mfma_f32_16x16x32_bf16 a[100:103], v[160:163], v[32:35], 0
    ds_read_b128 v[24:27], v1 offset:3072
    v_mfma_f32_16x16x32_bf16 a[100:103], v[168:171], v[36:39], a[100:103]
    s_waitcnt vmcnt(12)
    buffer_load_dwordx2 v[56:57], v10, s[72:75], s36 offen offset:0
    v_mfma_f32_16x16x32_bf16 a[148:151], v[164:167], v[32:35], 0
    ds_read_b128 v[28:31], v1 offset:15360
    v_mfma_f32_16x16x32_bf16 a[148:151], v[172:175], v[36:39], a[148:151]
    s_waitcnt lgkmcnt(2)
    v_exp_f32 v18, v74
    v_mfma_f32_16x16x32_bf16 a[104:107], v[160:163], v[40:43], 0
    ds_read_b128 v[32:35], v1 offset:4096
    v_add_f32 v7, v7, v16
    v_mfma_f32_16x16x32_bf16 a[104:107], v[168:171], v[44:47], a[104:107]
    buffer_load_dwordx2 v[58:59], v10, s[76:79], s36 offen offset:0
    v_mfma_f32_16x16x32_bf16 a[152:155], v[164:167], v[40:43], 0
    ds_read_b128 v[36:39], v1 offset:16384
    v_add_f32 v7, v7, v17
    v_mfma_f32_16x16x32_bf16 a[152:155], v[172:175], v[44:47], a[152:155]
    s_waitcnt lgkmcnt(2)
    v_exp_f32 v19, v75
    v_mfma_f32_16x16x32_bf16 a[108:111], v[160:163], v[24:27], 0
    ds_read_b128 v[40:43], v1 offset:5120
    v_cvt_pk_bf16_f32 v72, v16, v17
    v_mfma_f32_16x16x32_bf16 a[108:111], v[168:171], v[28:31], a[108:111]
    s_waitcnt vmcnt(13)
    buffer_load_dwordx4 v[224:227], v9, s[64:67], s33 offen offset:0 nt
    v_mfma_f32_16x16x32_bf16 a[156:159], v[164:167], v[24:27], 0
    ds_read_b128 v[44:47], v1 offset:17408
    v_mfma_f32_16x16x32_bf16 a[156:159], v[172:175], v[28:31], a[156:159]
    s_waitcnt lgkmcnt(2)
    v_exp_f32 v16, v104
    v_mfma_f32_16x16x32_bf16 a[112:115], v[160:163], v[32:35], 0
    ds_read_b128 v[24:27], v1 offset:6144
    v_add_f32 v7, v7, v18
    v_mfma_f32_16x16x32_bf16 a[112:115], v[168:171], v[36:39], a[112:115]
    s_waitcnt vmcnt(13)
    buffer_load_dwordx4 v[228:231], v9, s[64:67], s33 offen offset:1536 nt
    v_add_f32 v7, v7, v19
    v_mfma_f32_16x16x32_bf16 a[160:163], v[164:167], v[32:35], 0
    ds_read_b128 v[28:31], v1 offset:18432
    v_mfma_f32_16x16x32_bf16 a[160:163], v[172:175], v[36:39], a[160:163]
    s_waitcnt lgkmcnt(2)
    v_exp_f32 v17, v105
    v_cvt_pk_bf16_f32 v73, v18, v19
    v_mfma_f32_16x16x32_bf16 a[116:119], v[160:163], v[40:43], 0
    ds_read_b128 v[32:35], v1 offset:7168
    v_mfma_f32_16x16x32_bf16 a[116:119], v[168:171], v[44:47], a[116:119]
    buffer_load_dwordx4 v[232:235], v9, s[64:67], s34 offen offset:0 nt
    v_mfma_f32_16x16x32_bf16 a[164:167], v[164:167], v[40:43], 0
    ds_read_b128 v[36:39], v1 offset:19456
    v_mfma_f32_16x16x32_bf16 a[164:167], v[172:175], v[44:47], a[164:167]
    s_waitcnt lgkmcnt(2)
    v_exp_f32 v18, v106
    v_add_f32 v7, v7, v16
    v_mfma_f32_16x16x32_bf16 a[120:123], v[160:163], v[24:27], 0
    ds_read_b128 v[40:43], v1 offset:8192
    v_add_f32 v7, v7, v17
    v_mfma_f32_16x16x32_bf16 a[120:123], v[168:171], v[28:31], a[120:123]
    s_waitcnt vmcnt(14)
    buffer_load_dwordx4 v[236:239], v9, s[64:67], s34 offen offset:1536 nt
    v_mfma_f32_16x16x32_bf16 a[168:171], v[164:167], v[24:27], 0
    ds_read_b128 v[44:47], v1 offset:20480
    v_mfma_f32_16x16x32_bf16 a[168:171], v[172:175], v[28:31], a[168:171]
    s_waitcnt lgkmcnt(2)
    v_exp_f32 v19, v107
    v_cvt_pk_bf16_f32 v74, v16, v17
    v_mfma_f32_16x16x32_bf16 a[124:127], v[160:163], v[32:35], 0
    ds_read_b128 v[24:27], v1 offset:9216
    v_mfma_f32_16x16x32_bf16 a[124:127], v[168:171], v[36:39], a[124:127]
    v_exp_f32 v16, v76
    v_add_f32 v7, v7, v18
    v_mfma_f32_16x16x32_bf16 a[172:175], v[164:167], v[32:35], 0
    s_waitcnt vmcnt(19)
    ds_read_b128 v[28:31], v1 offset:21504
    v_add_f32 v7, v7, v19
    v_mfma_f32_16x16x32_bf16 a[172:175], v[172:175], v[36:39], a[172:175]
    s_waitcnt lgkmcnt(2)
    v_exp_f32 v17, v77
    v_cvt_pk_bf16_f32 v75, v18, v19
    v_mfma_f32_16x16x32_bf16 a[128:131], v[160:163], v[40:43], 0
    s_add_u32 s29, s28, 49152
    ds_read_b128 v[32:35], v1 offset:10240
    v_lshlrev_b32 v48, 16, v60
    v_mfma_f32_16x16x32_bf16 a[128:131], v[168:171], v[44:47], a[128:131]
    v_exp_f32 v18, v78
    v_add_f32 v8, v8, v16
    v_mfma_f32_16x16x32_bf16 a[176:179], v[164:167], v[40:43], 0
    s_sub_u32 s3, s29, 147456
    ds_read_b128 v[36:39], v1 offset:22528
    v_add_f32 v8, v8, v17
    v_mfma_f32_16x16x32_bf16 a[176:179], v[172:175], v[44:47], a[176:179]
    s_waitcnt lgkmcnt(2)
    v_exp_f32 v19, v79
    v_mfma_f32_16x16x32_bf16 a[132:135], v[160:163], v[24:27], 0
    s_min_u32 s29, s29, s3
    ds_read_b128 v[40:43], v1 offset:11264
    v_cvt_pk_bf16_f32 v76, v16, v17
    v_mfma_f32_16x16x32_bf16 a[132:135], v[168:171], v[28:31], a[132:135]
    v_exp_f32 v16, v108
    v_mfma_f32_16x16x32_bf16 a[180:183], v[164:167], v[24:27], 0
    s_sub_u32 s3, s29, s28
    ds_read_b128 v[44:47], v1 offset:23552
    v_and_b32 v49, s97, v60
    v_mfma_f32_16x16x32_bf16 a[180:183], v[172:175], v[28:31], a[180:183]
    s_waitcnt lgkmcnt(2)
    v_add_u32 v1, 49152, v1
    v_add_f32 v8, v8, v18
    v_mfma_f32_16x16x32_bf16 a[136:139], v[160:163], v[32:35], 0
    ds_read_b128 v[24:27], v1 offset:0
    v_add_f32 v8, v8, v19
    v_mfma_f32_16x16x32_bf16 a[136:139], v[168:171], v[36:39], a[136:139]
    v_lshlrev_b32 v50, 16, v62
    v_exp_f32 v17, v109
    v_mfma_f32_16x16x32_bf16 a[184:187], v[164:167], v[32:35], 0
    ds_read_b128 v[28:31], v1 offset:12288
    v_and_b32 v51, s97, v62
    v_mfma_f32_16x16x32_bf16 a[184:187], v[172:175], v[36:39], a[184:187]
    s_waitcnt lgkmcnt(2)
    v_cvt_pk_bf16_f32 v77, v18, v19
    v_mul_f32_e64 v50, -v50, v48
    v_mfma_f32_16x16x32_bf16 a[140:143], v[160:163], v[40:43], 0
    s_mov_b32 s28, s29
    ds_read_b128 v[32:35], v1 offset:1024
    v_bfe_u32 v53, v4, 4, 6
    v_mfma_f32_16x16x32_bf16 a[140:143], v[168:171], v[44:47], a[140:143]
    v_exp_f32 v18, v110
    v_mul_f32_e64 v51, -v51, v49
    v_mfma_f32_16x16x32_bf16 a[188:191], v[164:167], v[40:43], 0
    ds_read_b128 v[36:39], v1 offset:13312
    v_lshlrev_b32 v53, 2, v53
    v_mfma_f32_16x16x32_bf16 a[188:191], v[172:175], v[44:47], a[188:191]
    s_waitcnt lgkmcnt(2)
    s_barrier
    v_add_f32 v8, v8, v16
    v_mfma_f32_16x16x32_bf16 a[96:99], v[176:179], v[24:27], a[96:99]
    ds_read_b128 v[40:43], v1 offset:2048
    buffer_load_dword v52, v53, s[20:23], s44 offen sc1
    v_mfma_f32_16x16x32_bf16 a[96:99], v[184:187], v[28:31], a[96:99]
    v_add_f32 v8, v8, v17
    v_cvt_f32_i32 v240, v240
    v_cvt_f32_i32 v244, v244
    v_mfma_f32_16x16x32_bf16 a[144:147], v[180:183], v[24:27], a[144:147]
    ds_read_b128 v[44:47], v1 offset:14336
    v_fma_f32 v240, v240, v48, v50
    v_mfma_f32_16x16x32_bf16 a[144:147], v[188:191], v[28:31], a[144:147]
    s_waitcnt lgkmcnt(2)
    v_exp_f32 v19, v111
    v_cvt_pk_bf16_f32 v78, v16, v17
    v_mfma_f32_16x16x32_bf16 a[100:103], v[176:179], v[32:35], a[100:103]
    s_mov_b32 m0, s56
    ds_read_b128 v[24:27], v1 offset:3072
    v_add_f32 v8, v8, v18
    v_mfma_f32_16x16x32_bf16 a[100:103], v[184:187], v[36:39], a[100:103]
    s_waitcnt vmcnt(15)
    buffer_load_dwordx4 v4, s[4:7], s27 offen offset:0 sc1 lds
    v_add_f32 v8, v8, v19
    v_mfma_f32_16x16x32_bf16 a[148:151], v[180:183], v[32:35], a[148:151]
    ds_read_b128 v[28:31], v1 offset:15360
    v_fma_f32 v244, v244, v49, v51
    v_mfma_f32_16x16x32_bf16 a[148:151], v[188:191], v[36:39], a[148:151]
    s_waitcnt lgkmcnt(2)
    v_cvt_pk_bf16_f32 v79, v18, v19
    v_cvt_f32_i32 v241, v241
    v_cvt_f32_i32 v245, v245
    v_mfma_f32_16x16x32_bf16 a[104:107], v[176:179], v[40:43], a[104:107]
    ds_read_b128 v[32:35], v1 offset:4096
    v_fma_f32 v241, v241, v48, v50
    v_mfma_f32_16x16x32_bf16 a[104:107], v[184:187], v[44:47], a[104:107]
    s_waitcnt vmcnt(14)
    buffer_load_dwordx4 v4, s[4:7], s27 offen offset:1024 sc1 lds
    v_fma_f32 v245, v245, v49, v51
    v_mfma_f32_16x16x32_bf16 a[152:155], v[180:183], v[40:43], a[152:155]
    ds_read_b128 v[36:39], v1 offset:16384
    v_cvt_f32_i32 v242, v242
    v_mfma_f32_16x16x32_bf16 a[152:155], v[188:191], v[44:47], a[152:155]
    s_waitcnt lgkmcnt(2)
    v_exp_f32 v16, v80
    v_cvt_f32_i32 v246, v246
    v_mfma_f32_16x16x32_bf16 a[108:111], v[176:179], v[24:27], a[108:111]
    ds_read_b128 v[40:43], v1 offset:5120
    v_fma_f32 v242, v242, v48, v50
    v_mfma_f32_16x16x32_bf16 a[108:111], v[184:187], v[28:31], a[108:111]
    s_waitcnt vmcnt(14)
    buffer_load_dwordx4 v4, s[4:7], s27 offen offset:2048 sc1 lds
    v_fma_f32 v246, v246, v49, v51
    v_mfma_f32_16x16x32_bf16 a[156:159], v[180:183], v[24:27], a[156:159]
    s_add_u32 s27, s27, 24576
    ds_read_b128 v[44:47], v1 offset:17408
    v_cvt_f32_i32 v243, v243
    v_mfma_f32_16x16x32_bf16 a[156:159], v[188:191], v[28:31], a[156:159]
    s_waitcnt lgkmcnt(2)
    v_exp_f32 v17, v81
    v_cvt_f32_i32 v247, v247
    v_mfma_f32_16x16x32_bf16 a[112:115], v[176:179], v[32:35], a[112:115]
    s_sub_u32 s58, s27, 196608
    ds_read_b128 v[24:27], v1 offset:6144
    v_fma_f32 v243, v243, v48, v50
    v_mfma_f32_16x16x32_bf16 a[112:115], v[184:187], v[36:39], a[112:115]
    v_exp_f32 v18, v82
    v_add_f32 v5, v5, v16
    v_mfma_f32_16x16x32_bf16 a[160:163], v[180:183], v[32:35], a[160:163]
    s_min_u32 s27, s27, s58
    ds_read_b128 v[28:31], v1 offset:18432
    v_add_f32 v5, v5, v17
    v_mfma_f32_16x16x32_bf16 a[160:163], v[188:191], v[36:39], a[160:163]
    s_waitcnt lgkmcnt(2)
    v_exp_f32 v19, v83
    v_cvt_pk_bf16_f32 v80, v16, v17
    v_mfma_f32_16x16x32_bf16 a[116:119], v[176:179], v[40:43], a[116:119]
    s_add_u32 s56, s56, 12288
    ds_read_b128 v[32:35], v1 offset:7168
    v_fma_f32 v247, v247, v49, v51
    v_mfma_f32_16x16x32_bf16 a[116:119], v[184:187], v[44:47], a[116:119]
    v_exp_f32 v16, v112
    v_add_f32 v5, v5, v18
    v_mfma_f32_16x16x32_bf16 a[164:167], v[180:183], v[40:43], a[164:167]
    ds_read_b128 v[36:39], v1 offset:19456
    v_add_u32 v2, s3, v2
    v_add_u32 v3, s3, v3
    v_mfma_f32_16x16x32_bf16 a[164:167], v[188:191], v[44:47], a[164:167]
    s_waitcnt lgkmcnt(2)
    v_add_f32 v5, v5, v19
    v_exp_f32 v17, v113
    v_mfma_f32_16x16x32_bf16 a[120:123], v[176:179], v[24:27], a[120:123]
    s_mov_b32 m0, s56
    ds_read_b128 v[40:43], v1 offset:8192
    v_cvt_pk_bf16_f32 v81, v18, v19
    v_mfma_f32_16x16x32_bf16 a[120:123], v[184:187], v[28:31], a[120:123]
    s_waitcnt vmcnt(14)
    buffer_load_dwordx4 v4, s[4:7], s27 offen offset:0 sc1 lds
    v_lshlrev_b32 v48, 16, v61
    v_mfma_f32_16x16x32_bf16 a[168:171], v[180:183], v[24:27], a[168:171]
    ds_read_b128 v[44:47], v1 offset:20480
    v_and_b32 v49, s97, v61
    v_mfma_f32_16x16x32_bf16 a[168:171], v[188:191], v[28:31], a[168:171]
    s_waitcnt lgkmcnt(2)
    v_exp_f32 v18, v114
    v_add_f32 v5, v5, v16
    v_mfma_f32_16x16x32_bf16 a[124:127], v[176:179], v[32:35], a[124:127]
    ds_read_b128 v[24:27], v1 offset:9216
    v_add_f32 v5, v5, v17
    v_mfma_f32_16x16x32_bf16 a[124:127], v[184:187], v[36:39], a[124:127]
    s_waitcnt vmcnt(14)
    buffer_load_dwordx4 v4, s[4:7], s27 offen offset:1024 sc1 lds
    v_lshlrev_b32 v50, 16, v63
    v_mfma_f32_16x16x32_bf16 a[172:175], v[180:183], v[32:35], a[172:175]
    ds_read_b128 v[28:31], v1 offset:21504
    v_and_b32 v51, s97, v63
    v_mfma_f32_16x16x32_bf16 a[172:175], v[188:191], v[36:39], a[172:175]
    s_waitcnt lgkmcnt(2)
    v_exp_f32 v19, v115
    v_cvt_pk_bf16_f32 v82, v16, v17
    v_mfma_f32_16x16x32_bf16 a[128:131], v[176:179], v[40:43], a[128:131]
    ds_read_b128 v[32:35], v1 offset:10240
    v_mul_f32_e64 v50, -v50, v48
    v_mfma_f32_16x16x32_bf16 a[128:131], v[184:187], v[44:47], a[128:131]
    s_waitcnt vmcnt(14)
    buffer_load_dwordx4 v4, s[4:7], s27 offen offset:2048 sc1 lds
    v_mul_f32_e64 v51, -v51, v49
    v_mfma_f32_16x16x32_bf16 a[176:179], v[180:183], v[40:43], a[176:179]
    ds_read_b128 v[36:39], v1 offset:22528
    v_cvt_f32_i32 v248, v248
    v_mfma_f32_16x16x32_bf16 a[176:179], v[188:191], v[44:47], a[176:179]
    s_waitcnt lgkmcnt(2)
    v_exp_f32 v16, v84
    v_add_f32 v5, v5, v18
    v_mfma_f32_16x16x32_bf16 a[132:135], v[176:179], v[24:27], a[132:135]
    ds_read_b128 v[40:43], v1 offset:11264
    v_add_f32 v5, v5, v19
    v_mfma_f32_16x16x32_bf16 a[132:135], v[184:187], v[28:31], a[132:135]
    s_waitcnt vmcnt(19)
    v_exp_f32 v17, v85
    v_cvt_f32_i32 v252, v252
    v_mfma_f32_16x16x32_bf16 a[180:183], v[180:183], v[24:27], a[180:183]
    s_mov_b32 s27, 208896
    ds_read_b128 v[44:47], v1 offset:23552
    v_cvt_pk_bf16_f32 v83, v18, v19
    v_mfma_f32_16x16x32_bf16 a[180:183], v[188:191], v[28:31], a[180:183]
    s_waitcnt lgkmcnt(2)
    s_barrier
    v_fma_f32 v248, v248, v48, v50
    v_mfma_f32_16x16x32_bf16 a[136:139], v[176:179], v[32:35], a[136:139]
    s_add_u32 s56, s56, 36864
    ds_read_b128 v[24:27], v2 offset:0
    v_fma_f32 v252, v252, v49, v51
    v_mfma_f32_16x16x32_bf16 a[136:139], v[184:187], v[36:39], a[136:139]
    v_exp_f32 v18, v86
    v_add_f32 v6, v6, v16
    v_mfma_f32_16x16x32_bf16 a[184:187], v[180:183], v[32:35], a[184:187]
    s_sub_u32 s58, s56, 147456
    ds_read_b128 v[28:31], v3 offset:0
    v_cvt_f32_i32 v249, v249
    v_mfma_f32_16x16x32_bf16 a[184:187], v[188:191], v[36:39], a[184:187]
    s_waitcnt lgkmcnt(2)
    v_add_f32 v6, v6, v17
    v_cvt_f32_i32 v253, v253
    v_fma_f32 v249, v249, v48, v50
    v_mfma_f32_16x16x32_bf16 a[140:143], v[176:179], v[40:43], a[140:143]
    s_nop 0
    ds_read_b128 v[32:35], v2 offset:6144
    v_fma_f32 v253, v253, v49, v51
    v_mfma_f32_16x16x32_bf16 a[140:143], v[184:187], v[44:47], a[140:143]
    s_min_u32 s56, s56, s58
    v_exp_f32 v19, v87
    v_cvt_pk_bf16_f32 v84, v16, v17
    v_mfma_f32_16x16x32_bf16 a[188:191], v[180:183], v[40:43], a[188:191]
    s_waitcnt lgkmcnt(1)
    ds_read_b128 v[36:39], v3 offset:6144
    v_exp_f32 v16, v116
    v_cvt_f32_i32 v250, v250
    v_add_f32 v6, v6, v18
    v_cvt_f32_i32 v254, v254
    v_add_f32 v6, v6, v19
    v_fma_f32 v250, v250, v48, v50
    v_exp_f32 v17, v117
    v_fma_f32 v254, v254, v49, v51
    v_cvt_f32_i32 v251, v251
    v_cvt_pk_bf16_f32 v85, v18, v19
    v_cvt_f32_i32 v255, v255
    v_exp_f32 v18, v118
    v_fma_f32 v251, v251, v48, v50
    v_fma_f32 v255, v255, v49, v51
    v_add_f32 v6, v6, v16
    v_cvt_pk_bf16_f32 v146, v240, v244
    v_add_f32 v6, v6, v17
    v_cvt_pk_bf16_f32 v150, v241, v245
    v_exp_f32 v19, v119
    v_cvt_pk_bf16_f32 v147, v248, v252
    v_cvt_pk_bf16_f32 v151, v249, v253
    v_cvt_pk_bf16_f32 v86, v16, v17
    v_cvt_pk_bf16_f32 v154, v242, v246
    v_add_f32 v6, v6, v18
    v_cvt_pk_bf16_f32 v155, v250, v254
    v_add_f32 v6, v6, v19
    v_cvt_pk_bf16_f32 v158, v243, v247
    v_cvt_pk_bf16_f32 v87, v18, v19
    v_cvt_pk_bf16_f32 v159, v251, v255
    v_mfma_f32_16x16x32_bf16 a[188:191], v[188:191], v[44:47], a[188:191]
    s_branch L_join
.p2align 6
L_loop:
    v_mfma_f32_16x16x32_bf16 v[160:163], v[24:27], a[192:195], v[128:131]
    s_mov_b32 m0, s56
    ds_read_b128 v[40:43], v2 offset:128
    v_fma_f32 v250, v250, v48, v50
    v_mfma_f32_16x16x32_bf16 v[160:163], v[28:31], a[196:199], v[160:163]
    buffer_load_dwordx4 v4, s[4:7], s27 offen offset:0 sc1 lds
    v_mfma_f32_16x16x32_bf16 v[164:167], v[24:27], a[216:219], v[132:135]
    v_exp_f32 v16, v88
    v_mfma_f32_16x16x32_bf16 v[164:167], v[28:31], a[220:223], v[164:167]
    v_exp_f32 v17, v89
    v_mfma_f32_16x16x32_bf16 v[168:171], v[24:27], a[240:243], v[136:139]
    ds_read_b128 v[44:47], v3 offset:128
    v_fma_f32 v251, v251, v49, v51
    v_mfma_f32_16x16x32_bf16 v[168:171], v[28:31], a[244:247], v[168:171]
    v_exp_f32 v18, v90
    v_mfma_f32_16x16x32_bf16 v[172:175], v[24:27], v[200:203], v[140:143]
    v_add_f32 v7, v7, v16
    v_add_f32 v7, v7, v17
    v_mfma_f32_16x16x32_bf16 v[172:175], v[28:31], v[204:207], v[172:175]
    s_waitcnt lgkmcnt(2)
    v_exp_f32 v19, v91
    v_mfma_f32_16x16x32_bf16 v[96:99], v[32:35], a[192:195], v[128:131]
    ds_read_b128 v[24:27], v2 offset:6272
    v_cvt_pk_bf16_f32 v235, v250, v251
    v_mfma_f32_16x16x32_bf16 v[96:99], v[36:39], a[196:199], v[96:99]
    buffer_load_dwordx4 v4, s[4:7], s27 offen offset:1024 sc1 lds
    v_mfma_f32_16x16x32_bf16 v[100:103], v[32:35], a[216:219], v[132:135]
    v_cvt_pk_bf16_f32 v88, v16, v17
    v_cvt_f32_i32 v254, v254
    v_mfma_f32_16x16x32_bf16 v[100:103], v[36:39], a[220:223], v[100:103]
    v_exp_f32 v16, v120
    v_mfma_f32_16x16x32_bf16 v[104:107], v[32:35], a[240:243], v[136:139]
    ds_read_b128 v[28:31], v3 offset:6272
    v_add_f32 v7, v7, v18
    v_mfma_f32_16x16x32_bf16 v[104:107], v[36:39], a[244:247], v[104:107]
    v_add_f32 v7, v7, v19
    v_cvt_f32_i32 v255, v255
    v_mfma_f32_16x16x32_bf16 v[108:111], v[32:35], v[200:203], v[140:143]
    v_exp_f32 v17, v121
    v_mfma_f32_16x16x32_bf16 v[108:111], v[36:39], v[204:207], v[108:111]
    s_waitcnt lgkmcnt(2)
    v_cvt_pk_bf16_f32 v89, v18, v19
    v_fma_f32 v254, v254, v48, v50
    v_mfma_f32_16x16x32_bf16 v[160:163], v[40:43], a[200:203], v[160:163]
    ds_read_b128 v[32:35], v2 offset:256
    v_mfma_f32_16x16x32_bf16 v[160:163], v[44:47], a[204:207], v[160:163]
    v_exp_f32 v18, v122
    v_mfma_f32_16x16x32_bf16 v[164:167], v[40:43], a[224:227], v[164:167]
    v_add_f32 v7, v7, v16
    v_add_f32 v7, v7, v17
    v_mfma_f32_16x16x32_bf16 v[164:167], v[44:47], a[228:231], v[164:167]
    buffer_load_dwordx4 v4, s[4:7], s27 offen offset:2048 sc1 lds
    v_mfma_f32_16x16x32_bf16 v[168:171], v[40:43], a[248:251], v[168:171]
    ds_read_b128 v[36:39], v3 offset:256
    v_fma_f32 v255, v255, v49, v51
    v_mfma_f32_16x16x32_bf16 v[168:171], v[44:47], a[252:255], v[168:171]
    v_exp_f32 v19, v123
    v_mfma_f32_16x16x32_bf16 v[172:175], v[40:43], v[208:211], v[172:175]
L_iw3:
L_pg3:
    s_cbranch_execz L_pg7
    v_cvt_pk_bf16_f32 v90, v16, v17
    v_cvt_pk_bf16_f32 v239, v254, v255
    v_mfma_f32_16x16x32_bf16 v[172:175], v[44:47], v[212:215], v[172:175]
    s_waitcnt lgkmcnt(2)
    v_exp_f32 v16, v92
    v_mfma_f32_16x16x32_bf16 v[96:99], v[24:27], a[200:203], v[96:99]
    ds_read_b128 v[40:43], v2 offset:6400
    v_add_f32 v7, v7, v18
    v_mfma_f32_16x16x32_bf16 v[96:99], v[28:31], a[204:207], v[96:99]
    s_add_u32 s27, s27, 24576
    v_add_f32 v7, v7, v19
    v_mfma_f32_16x16x32_bf16 v[100:103], v[24:27], a[224:227], v[100:103]
    v_exp_f32 v17, v93
    v_mfma_f32_16x16x32_bf16 v[100:103], v[28:31], a[228:231], v[100:103]
    v_cvt_pk_bf16_f32 v91, v18, v19
    v_mfma_f32_16x16x32_bf16 v[104:107], v[24:27], a[248:251], v[104:107]
    ds_read_b128 v[44:47], v3 offset:6400
    v_mfma_f32_16x16x32_bf16 v[104:107], v[28:31], a[252:255], v[104:107]
    v_exp_f32 v18, v94
    v_mfma_f32_16x16x32_bf16 v[108:111], v[24:27], v[208:211], v[108:111]
    s_add_u32 s29, s30, 49152
    v_add_f32 v8, v8, v16
    v_add_f32 v8, v8, v17
    v_mfma_f32_16x16x32_bf16 v[108:111], v[28:31], v[212:215], v[108:111]
    s_waitcnt lgkmcnt(2)
    v_exp_f32 v19, v95
    v_mfma_f32_16x16x32_bf16 v[160:163], v[32:35], a[208:211], v[160:163]
    s_waitcnt vmcnt(11)
    ds_read_b128 v[24:27], v2 offset:12288
    v_cvt_pk_bf16_f32 v92, v16, v17
    v_mfma_f32_16x16x32_bf16 v[160:163], v[36:39], a[212:215], v[160:163]
    s_sub_u32 s3, s29, 147456
    buffer_load_dwordx2 v[60:61], off, s[80:83], s37 offset:8
    v_mfma_f32_16x16x32_bf16 v[164:167], v[32:35], a[232:235], v[164:167]
    s_add_u32 s56, s56, 12288
    v_exp_f32 v16, v124
    v_mfma_f32_16x16x32_bf16 v[164:167], v[36:39], a[236:239], v[164:167]
    s_min_u32 s29, s29, s3
    v_add_f32 v8, v8, v18
    v_lshlrev_b32 v48, 16, v56
    v_mfma_f32_16x16x32_bf16 v[168:171], v[32:35], v[192:195], v[168:171]
    s_mov_b32 m0, s56
    ds_read_b128 v[28:31], v3 offset:12288
    v_add_f32 v8, v8, v19
    v_mfma_f32_16x16x32_bf16 v[168:171], v[36:39], v[196:199], v[168:171]
    buffer_load_dwordx2 v[62:63], off, s[84:87], s37 offset:8
    v_mfma_f32_16x16x32_bf16 v[172:175], v[32:35], v[216:219], v[172:175]
    v_exp_f32 v17, v125
    v_mfma_f32_16x16x32_bf16 v[172:175], v[36:39], v[220:223], v[172:175]
    s_waitcnt lgkmcnt(2)
    v_cvt_pk_bf16_f32 v93, v18, v19
    v_and_b32 v49, s97, v56
    v_mfma_f32_16x16x32_bf16 v[96:99], v[40:43], a[208:211], v[96:99]
    ds_read_b128 v[32:35], v2 offset:18432
    v_lshlrev_b32 v50, 16, v58
    v_mfma_f32_16x16x32_bf16 v[96:99], v[44:47], a[212:215], v[96:99]
    s_sub_u32 s3, s29, s30
    v_exp_f32 v18, v126
    v_mfma_f32_16x16x32_bf16 v[100:103], v[40:43], a[232:235], v[100:103]
    v_add_f32 v8, v8, v16
    v_add_f32 v8, v8, v17
    v_mfma_f32_16x16x32_bf16 v[100:103], v[44:47], a[236:239], v[100:103]
    buffer_load_dwordx4 v4, s[4:7], s27 offen offset:0 sc1 lds
    v_mfma_f32_16x16x32_bf16 v[104:107], v[40:43], v[192:195], v[104:107]
    ds_read_b128 v[36:39], v3 offset:18432
    v_and_b32 v51, s97, v58
    v_mfma_f32_16x16x32_bf16 v[104:107], v[44:47], v[196:199], v[104:107]
    v_exp_f32 v19, v127
    v_mfma_f32_16x16x32_bf16 v[108:111], v[40:43], v[216:219], v[108:111]
    v_cvt_pk_bf16_f32 v94, v16, v17
    v_add_f32 v8, v8, v18
    v_mfma_f32_16x16x32_bf16 v[108:111], v[44:47], v[220:223], v[108:111]
    s_waitcnt lgkmcnt(2)
    buffer_load_dwordx4 v[240:243], v12, s[68:71], s16 offen offset:0 nt
    v_mfma_f32_16x16x32_bf16 v[176:179], v[24:27], a[192:195], v[128:131]
    ds_read_b128 v[40:43], v2 offset:12416
    v_add_f32 v8, v8, v19
    v_mfma_f32_16x16x32_bf16 v[176:179], v[28:31], a[196:199], v[176:179]
    s_mov_b32 s30, s29
    v_cvt_pk_bf16_f32 v95, v18, v19
    v_mul_f32_e64 v50, -v50, v48
    v_mfma_f32_16x16x32_bf16 v[180:183], v[24:27], a[216:219], v[132:135]
    v_exp_f32 v16, v160
    v_mfma_f32_16x16x32_bf16 v[180:183], v[28:31], a[220:223], v[180:183]
    buffer_load_dwordx4 v4, s[4:7], s27 offen offset:1024 sc1 lds
    v_mfma_f32_16x16x32_bf16 v[184:187], v[24:27], a[240:243], v[136:139]
    ds_read_b128 v[44:47], v3 offset:12416
    v_mul_f32_e64 v51, -v51, v49
    v_mfma_f32_16x16x32_bf16 v[184:187], v[28:31], a[244:247], v[184:187]
    v_exp_f32 v17, v161
    v_mfma_f32_16x16x32_bf16 v[188:191], v[24:27], v[200:203], v[140:143]
    v_exp_f32 v18, v162
    v_mfma_f32_16x16x32_bf16 v[188:191], v[28:31], v[204:207], v[188:191]
    s_waitcnt lgkmcnt(2)
    buffer_load_dwordx4 v[244:247], v12, s[68:71], s16 offen offset:768 nt
    v_mfma_f32_16x16x32_bf16 v[112:115], v[32:35], a[192:195], v[128:131]
    ds_read_b128 v[24:27], v2 offset:18560
    v_add_f32 v5, v5, v16
    v_mfma_f32_16x16x32_bf16 v[112:115], v[36:39], a[196:199], v[112:115]
    v_add_f32 v5, v5, v17
    v_cvt_f32_i32 v144, v144
    v_mfma_f32_16x16x32_bf16 v[116:119], v[32:35], a[216:219], v[132:135]
    v_exp_f32 v19, v163
    v_mfma_f32_16x16x32_bf16 v[116:119], v[36:39], a[220:223], v[116:119]
    v_cvt_pk_bf16_f32 v160, v16, v17
    v_cvt_f32_i32 v148, v148
    v_mfma_f32_16x16x32_bf16 v[120:123], v[32:35], a[240:243], v[136:139]
    ds_read_b128 v[28:31], v3 offset:18560
    v_fma_f32 v144, v144, v48, v50
    v_mfma_f32_16x16x32_bf16 v[120:123], v[36:39], a[244:247], v[120:123]
    buffer_load_dwordx4 v[248:251], v12, s[68:71], s16 offen offset:1536 nt
    v_mfma_f32_16x16x32_bf16 v[124:127], v[32:35], v[200:203], v[140:143]
    v_exp_f32 v16, v96
    v_mfma_f32_16x16x32_bf16 v[124:127], v[36:39], v[204:207], v[124:127]
    s_waitcnt lgkmcnt(2)
    v_add_f32 v5, v5, v18
    v_add_f32 v5, v5, v19
    v_mfma_f32_16x16x32_bf16 v[176:179], v[40:43], a[200:203], v[176:179]
    ds_read_b128 v[32:35], v2 offset:12544
    v_fma_f32 v148, v148, v49, v51
    v_mfma_f32_16x16x32_bf16 v[176:179], v[44:47], a[204:207], v[176:179]
    buffer_load_dwordx4 v4, s[4:7], s27 offen offset:2048 sc1 lds
    v_mfma_f32_16x16x32_bf16 v[180:183], v[40:43], a[224:227], v[180:183]
    v_exp_f32 v17, v97
    v_mfma_f32_16x16x32_bf16 v[180:183], v[44:47], a[228:231], v[180:183]
    v_cvt_pk_bf16_f32 v161, v18, v19
    v_cvt_f32_i32 v145, v145
    v_mfma_f32_16x16x32_bf16 v[184:187], v[40:43], a[248:251], v[184:187]
    ds_read_b128 v[36:39], v3 offset:12544
    v_add_u32 v1, s3, v1
    v_mfma_f32_16x16x32_bf16 v[184:187], v[44:47], a[252:255], v[184:187]
    buffer_load_dwordx4 v[252:255], v12, s[68:71], s16 offen offset:2304 nt
    v_mfma_f32_16x16x32_bf16 v[188:191], v[40:43], v[208:211], v[188:191]
    v_exp_f32 v18, v98
    v_mfma_f32_16x16x32_bf16 v[188:191], v[44:47], v[212:215], v[188:191]
    s_waitcnt lgkmcnt(2)
    v_add_f32 v5, v5, v16
    v_add_f32 v5, v5, v17
    v_mfma_f32_16x16x32_bf16 v[112:115], v[24:27], a[200:203], v[112:115]
    ds_read_b128 v[40:43], v2 offset:18688
    v_cvt_f32_i32 v149, v149
    v_mfma_f32_16x16x32_bf16 v[112:115], v[28:31], a[204:207], v[112:115]
    v_exp_f32 v19, v99
    v_cvt_pk_bf16_f32 v162, v16, v17
    v_mfma_f32_16x16x32_bf16 v[116:119], v[24:27], a[224:227], v[116:119]
    v_exp_f32 v16, v164
    v_mfma_f32_16x16x32_bf16 v[116:119], v[28:31], a[228:231], v[116:119]
    s_add_u32 s27, s27, 24576
    v_add_f32 v5, v5, v18
    v_add_f32 v5, v5, v19
    v_mfma_f32_16x16x32_bf16 v[120:123], v[24:27], a[248:251], v[120:123]
    s_add_u32 s56, s56, 36864
    ds_read_b128 v[44:47], v3 offset:18688
    v_fma_f32 v145, v145, v48, v50
    v_mfma_f32_16x16x32_bf16 v[120:123], v[28:31], a[252:255], v[120:123]
    s_waitcnt lgkmcnt(2)
    v_exp_f32 v17, v165
    v_mfma_f32_16x16x32_bf16 v[124:127], v[24:27], v[208:211], v[124:127]
    s_waitcnt vmcnt(12)
    v_cvt_pk_bf16_f32 v163, v18, v19
    v_fma_f32 v149, v149, v49, v51
    v_mfma_f32_16x16x32_bf16 v[124:127], v[28:31], v[212:215], v[124:127]
    s_barrier
    s_sub_u32 s58, s56, 147456
    v_mfma_f32_16x16x32_bf16 v[176:179], v[32:35], a[208:211], v[176:179]
    s_min_u32 s56, s56, s58
    ds_read_b128 v[24:27], v1 offset:0
    v_cvt_f32_i32 v146, v146
    v_mfma_f32_16x16x32_bf16 v[176:179], v[36:39], a[212:215], v[176:179]
    v_exp_f32 v18, v166
    v_mfma_f32_16x16x32_bf16 v[180:183], v[32:35], a[232:235], v[180:183]
    v_add_f32 v6, v6, v16
    v_add_f32 v6, v6, v17
    v_mfma_f32_16x16x32_bf16 v[180:183], v[36:39], a[236:239], v[180:183]
    v_exp_f32 v19, v167
    v_mfma_f32_16x16x32_bf16 v[184:187], v[32:35], v[192:195], v[184:187]
    ds_read_b128 v[28:31], v1 offset:12288
    v_cvt_pk_bf16_f32 v164, v16, v17
    v_mfma_f32_16x16x32_bf16 v[184:187], v[36:39], v[196:199], v[184:187]
    v_exp_f32 v16, v100
    v_mfma_f32_16x16x32_bf16 v[188:191], v[32:35], v[216:219], v[188:191]
    v_add_f32 v6, v6, v18
    v_add_f32 v6, v6, v19
    v_mfma_f32_16x16x32_bf16 v[188:191], v[36:39], v[220:223], v[188:191]
    s_waitcnt lgkmcnt(2)
    v_exp_f32 v17, v101
    v_mfma_f32_16x16x32_bf16 v[112:115], v[40:43], a[208:211], v[112:115]
    ds_read_b128 v[32:35], v1 offset:1024
    v_cvt_pk_bf16_f32 v165, v18, v19
    v_mfma_f32_16x16x32_bf16 v[112:115], v[44:47], a[212:215], v[112:115]
    v_exp_f32 v18, v102
    v_mfma_f32_16x16x32_bf16 v[116:119], v[40:43], a[232:235], v[116:119]
    v_add_f32 v6, v6, v16
    v_cvt_f32_i32 v150, v150
    v_mfma_f32_16x16x32_bf16 v[116:119], v[44:47], a[236:239], v[116:119]
    v_add_f32 v6, v6, v17
    v_fma_f32 v146, v146, v48, v50
    v_mfma_f32_16x16x32_bf16 v[120:123], v[40:43], v[192:195], v[120:123]
    ds_read_b128 v[36:39], v1 offset:13312
    v_fma_f32 v150, v150, v49, v51
    v_mfma_f32_16x16x32_bf16 v[120:123], v[44:47], v[196:199], v[120:123]
    v_exp_f32 v19, v103
    v_mfma_f32_16x16x32_bf16 v[124:127], v[40:43], v[216:219], v[124:127]
    v_cvt_pk_bf16_f32 v166, v16, v17
    v_add_f32 v6, v6, v18
    v_mfma_f32_16x16x32_bf16 v[124:127], v[44:47], v[220:223], v[124:127]
    s_waitcnt lgkmcnt(2)
    v_add_f32 v6, v6, v19
    v_cvt_pk_bf16_f32 v167, v18, v19
    v_mfma_f32_16x16x32_bf16 a[0:3], v[64:67], v[24:27], a[0:3]
    ds_read_b128 v[40:43], v1 offset:2048
    v_cvt_f32_i32 v147, v147
    v_mfma_f32_16x16x32_bf16 a[0:3], v[80:83], v[28:31], a[0:3]
    buffer_store_dwordx4 v[224:227], v11, s[4:7], s33 offen offset:0 sc1
    v_mfma_f32_16x16x32_bf16 a[48:51], v[68:71], v[24:27], a[48:51]
    v_exp_f32 v16, v168
    v_mfma_f32_16x16x32_bf16 a[48:51], v[84:87], v[28:31], a[48:51]
    v_exp_f32 v17, v169
    v_mfma_f32_16x16x32_bf16 a[96:99], v[72:75], v[24:27], a[96:99]
    ds_read_b128 v[44:47], v1 offset:14336
    v_xor_b32 v55, 16, v11
    v_mfma_f32_16x16x32_bf16 a[96:99], v[88:91], v[28:31], a[96:99]
    v_exp_f32 v18, v170
    v_mfma_f32_16x16x32_bf16 a[144:147], v[76:79], v[24:27], a[144:147]
    v_add_f32 v7, v7, v16
    v_add_f32 v7, v7, v17
    v_mfma_f32_16x16x32_bf16 a[144:147], v[92:95], v[28:31], a[144:147]
    s_waitcnt lgkmcnt(2)
    v_exp_f32 v19, v171
    v_mfma_f32_16x16x32_bf16 a[4:7], v[64:67], v[32:35], a[4:7]
    ds_read_b128 v[24:27], v1 offset:3072
    v_cvt_f32_i32 v151, v151
    v_mfma_f32_16x16x32_bf16 a[4:7], v[80:83], v[36:39], a[4:7]
    buffer_store_dwordx4 v[228:231], v55, s[4:7], s33 offen offset:768 sc1
    v_mfma_f32_16x16x32_bf16 a[52:55], v[68:71], v[32:35], a[52:55]
    v_cvt_pk_bf16_f32 v168, v16, v17
    v_fma_f32 v147, v147, v48, v50
    v_mfma_f32_16x16x32_bf16 a[52:55], v[84:87], v[36:39], a[52:55]
    v_exp_f32 v16, v104
    v_mfma_f32_16x16x32_bf16 a[100:103], v[72:75], v[32:35], a[100:103]
    ds_read_b128 v[28:31], v1 offset:15360
    v_add_f32 v7, v7, v18
    v_mfma_f32_16x16x32_bf16 a[100:103], v[88:91], v[36:39], a[100:103]
    v_add_f32 v7, v7, v19
    v_xor_b32 v54, 32, v11
    v_mfma_f32_16x16x32_bf16 a[148:151], v[76:79], v[32:35], a[148:151]
    v_exp_f32 v17, v105
    v_mfma_f32_16x16x32_bf16 a[148:151], v[92:95], v[36:39], a[148:151]
    s_waitcnt lgkmcnt(2)
    v_cvt_pk_bf16_f32 v169, v18, v19
    v_fma_f32 v151, v151, v49, v51
    v_mfma_f32_16x16x32_bf16 a[8:11], v[64:67], v[40:43], a[8:11]
    ds_read_b128 v[32:35], v1 offset:4096
    v_lshlrev_b32 v48, 16, v57
    v_mfma_f32_16x16x32_bf16 a[8:11], v[80:83], v[44:47], a[8:11]
    buffer_store_dwordx4 v[232:235], v54, s[4:7], s33 offen offset:1536 sc1
    v_mfma_f32_16x16x32_bf16 a[56:59], v[68:71], v[40:43], a[56:59]
    v_exp_f32 v18, v106
    v_mfma_f32_16x16x32_bf16 a[56:59], v[84:87], v[44:47], a[56:59]
    v_add_f32 v7, v7, v16
    v_add_f32 v7, v7, v17
    v_mfma_f32_16x16x32_bf16 a[104:107], v[72:75], v[40:43], a[104:107]
    ds_read_b128 v[36:39], v1 offset:16384
    v_xor_b32 v55, 48, v11
    v_mfma_f32_16x16x32_bf16 a[104:107], v[88:91], v[44:47], a[104:107]
    v_exp_f32 v19, v107
    v_mfma_f32_16x16x32_bf16 a[152:155], v[76:79], v[40:43], a[152:155]
    v_cvt_pk_bf16_f32 v170, v16, v17
    v_and_b32 v49, s97, v57
    v_mfma_f32_16x16x32_bf16 a[152:155], v[92:95], v[44:47], a[152:155]
    s_waitcnt lgkmcnt(2)
    v_exp_f32 v16, v172
    v_mfma_f32_16x16x32_bf16 a[12:15], v[64:67], v[24:27], a[12:15]
    ds_read_b128 v[40:43], v1 offset:5120
    v_add_f32 v7, v7, v18
    v_mfma_f32_16x16x32_bf16 a[12:15], v[80:83], v[28:31], a[12:15]
    buffer_store_dwordx4 v[236:239], v55, s[4:7], s33 offen offset:2304 sc1
    v_mfma_f32_16x16x32_bf16 a[60:63], v[68:71], v[24:27], a[60:63]
    v_add_f32 v7, v7, v19
    v_lshlrev_b32 v50, 16, v59
    v_mfma_f32_16x16x32_bf16 a[60:63], v[84:87], v[28:31], a[60:63]
    v_exp_f32 v17, v173
    v_mfma_f32_16x16x32_bf16 a[108:111], v[72:75], v[24:27], a[108:111]
    ds_read_b128 v[44:47], v1 offset:17408
    v_cvt_pk_bf16_f32 v171, v18, v19
    v_mfma_f32_16x16x32_bf16 a[108:111], v[88:91], v[28:31], a[108:111]
    v_exp_f32 v18, v174
    v_mfma_f32_16x16x32_bf16 a[156:159], v[76:79], v[24:27], a[156:159]
    s_add_u32 s29, s28, 49152
    v_add_f32 v8, v8, v16
    v_add_f32 v8, v8, v17
    v_mfma_f32_16x16x32_bf16 a[156:159], v[92:95], v[28:31], a[156:159]
    s_waitcnt lgkmcnt(2)
    v_exp_f32 v19, v175
    v_mfma_f32_16x16x32_bf16 a[16:19], v[64:67], v[32:35], a[16:19]
    s_sub_u32 s3, s29, 147456
    ds_read_b128 v[24:27], v1 offset:6144
    v_cvt_pk_bf16_f32 v172, v16, v17
    v_mfma_f32_16x16x32_bf16 a[16:19], v[80:83], v[36:39], a[16:19]
    s_mov_b32 m0, s26
    v_exp_f32 v16, v108
    v_mfma_f32_16x16x32_bf16 a[64:67], v[68:71], v[32:35], a[64:67]
    s_min_u32 s29, s29, s3
    v_and_b32 v51, s97, v59
    v_add_f32 v8, v8, v18
    v_mfma_f32_16x16x32_bf16 a[64:67], v[84:87], v[36:39], a[64:67]
    buffer_load_dwordx4 v4, s[4:7], s32 offen offset:0 sc1 lds
    v_mfma_f32_16x16x32_bf16 a[112:115], v[72:75], v[32:35], a[112:115]
    ds_read_b128 v[28:31], v1 offset:18432
    v_add_f32 v8, v8, v19
    v_mfma_f32_16x16x32_bf16 a[112:115], v[88:91], v[36:39], a[112:115]
    v_exp_f32 v17, v109
    v_mfma_f32_16x16x32_bf16 a[160:163], v[76:79], v[32:35], a[160:163]
    v_cvt_pk_bf16_f32 v173, v18, v19
    v_mul_f32_e64 v50, -v50, v48
    v_mfma_f32_16x16x32_bf16 a[160:163], v[92:95], v[36:39], a[160:163]
    s_waitcnt lgkmcnt(2)
    buffer_load_dwordx4 v4, s[4:7], s32 offen offset:1024 sc1 lds
    v_mfma_f32_16x16x32_bf16 a[20:23], v[64:67], v[40:43], a[20:23]
    s_sub_u32 s3, s29, s28
    ds_read_b128 v[32:35], v1 offset:7168
    v_mul_f32_e64 v51, -v51, v49
    v_mfma_f32_16x16x32_bf16 a[20:23], v[80:83], v[44:47], a[20:23]
    v_exp_f32 v18, v110
    v_mfma_f32_16x16x32_bf16 a[68:71], v[68:71], v[40:43], a[68:71]
    v_add_f32 v8, v8, v16
    v_add_f32 v8, v8, v17
    v_mfma_f32_16x16x32_bf16 a[68:71], v[84:87], v[44:47], a[68:71]
    buffer_load_dwordx4 v4, s[4:7], s32 offen offset:2048 sc1 lds
    v_mfma_f32_16x16x32_bf16 a[116:119], v[72:75], v[40:43], a[116:119]
    ds_read_b128 v[36:39], v1 offset:19456
    v_cvt_f32_i32 v152, v152
    v_mfma_f32_16x16x32_bf16 a[116:119], v[88:91], v[44:47], a[116:119]
    v_exp_f32 v19, v111
    v_mfma_f32_16x16x32_bf16 a[164:167], v[76:79], v[40:43], a[164:167]
    s_mov_b32 s28, s29
    v_cvt_pk_bf16_f32 v174, v16, v17
    v_add_f32 v8, v8, v18
    v_mfma_f32_16x16x32_bf16 a[164:167], v[92:95], v[44:47], a[164:167]
    s_waitcnt lgkmcnt(2)
    v_add_f32 v8, v8, v19
    v_cvt_pk_bf16_f32 v175, v18, v19
    v_mfma_f32_16x16x32_bf16 a[24:27], v[64:67], v[24:27], a[24:27]
    s_add_u32 s32, s32, 24576
    ds_read_b128 v[40:43], v1 offset:8192
    v_cvt_f32_i32 v156, v156
    v_mfma_f32_16x16x32_bf16 a[24:27], v[80:83], v[28:31], a[24:27]
    v_exp_f32 v16, v176
    v_mfma_f32_16x16x32_bf16 a[72:75], v[68:71], v[24:27], a[72:75]
    s_add_u32 s26, s26, 12288
    v_exp_f32 v17, v177
    v_mfma_f32_16x16x32_bf16 a[72:75], v[84:87], v[28:31], a[72:75]
    v_exp_f32 v18, v178
    v_mfma_f32_16x16x32_bf16 a[120:123], v[72:75], v[24:27], a[120:123]
    s_mov_b32 m0, s26
    ds_read_b128 v[44:47], v1 offset:20480
    v_add_f32 v5, v5, v16
    v_mfma_f32_16x16x32_bf16 a[120:123], v[88:91], v[28:31], a[120:123]
    v_add_f32 v5, v5, v17
    v_fma_f32 v152, v152, v48, v50
    v_mfma_f32_16x16x32_bf16 a[168:171], v[76:79], v[24:27], a[168:171]
    v_exp_f32 v19, v179
    v_mfma_f32_16x16x32_bf16 a[168:171], v[92:95], v[28:31], a[168:171]
    s_waitcnt lgkmcnt(2)
    v_cvt_pk_bf16_f32 v176, v16, v17
    v_fma_f32 v156, v156, v49, v51
    v_mfma_f32_16x16x32_bf16 a[28:31], v[64:67], v[32:35], a[28:31]
    ds_read_b128 v[24:27], v1 offset:9216
    v_add_u32 v2, s3, v2
    v_mfma_f32_16x16x32_bf16 a[28:31], v[80:83], v[36:39], a[28:31]
    buffer_load_dwordx4 v4, s[4:7], s32 offen offset:0 sc1 lds
    v_mfma_f32_16x16x32_bf16 a[76:79], v[68:71], v[32:35], a[76:79]
    v_exp_f32 v16, v112
    v_mfma_f32_16x16x32_bf16 a[76:79], v[84:87], v[36:39], a[76:79]
    v_add_f32 v5, v5, v18
    v_add_f32 v5, v5, v19
    v_mfma_f32_16x16x32_bf16 a[124:127], v[72:75], v[32:35], a[124:127]
    ds_read_b128 v[28:31], v1 offset:21504
    v_cvt_f32_i32 v153, v153
    v_mfma_f32_16x16x32_bf16 a[124:127], v[88:91], v[36:39], a[124:127]
    buffer_load_dwordx4 v4, s[4:7], s32 offen offset:1024 sc1 lds
    v_mfma_f32_16x16x32_bf16 a[172:175], v[76:79], v[32:35], a[172:175]
    v_exp_f32 v17, v113
    v_mfma_f32_16x16x32_bf16 a[172:175], v[92:95], v[36:39], a[172:175]
    s_waitcnt lgkmcnt(2)
    v_cvt_pk_bf16_f32 v177, v18, v19
    v_add_u32 v3, s3, v3
    v_mfma_f32_16x16x32_bf16 a[32:35], v[64:67], v[40:43], a[32:35]
    ds_read_b128 v[32:35], v1 offset:10240
    v_cvt_f32_i32 v157, v157
    v_mfma_f32_16x16x32_bf16 a[32:35], v[80:83], v[44:47], a[32:35]
    v_exp_f32 v18, v114
    v_mfma_f32_16x16x32_bf16 a[80:83], v[68:71], v[40:43], a[80:83]
    v_add_f32 v5, v5, v16
    v_add_f32 v5, v5, v17
    v_mfma_f32_16x16x32_bf16 a[80:83], v[84:87], v[44:47], a[80:83]
    buffer_load_dwordx4 v4, s[4:7], s32 offen offset:2048 sc1 lds
    v_mfma_f32_16x16x32_bf16 a[128:131], v[72:75], v[40:43], a[128:131]
    ds_read_b128 v[36:39], v1 offset:22528
    v_mfma_f32_16x16x32_bf16 a[128:131], v[88:91], v[44:47], a[128:131]
    v_exp_f32 v19, v115
    v_mfma_f32_16x16x32_bf16 a[176:179], v[76:79], v[40:43], a[176:179]
    v_cvt_pk_bf16_f32 v178, v16, v17
    v_fma_f32 v153, v153, v48, v50
    v_mfma_f32_16x16x32_bf16 a[176:179], v[92:95], v[44:47], a[176:179]
    s_waitcnt lgkmcnt(2)
    v_exp_f32 v16, v180
    v_mfma_f32_16x16x32_bf16 a[36:39], v[64:67], v[24:27], a[36:39]
    ds_read_b128 v[40:43], v1 offset:11264
    v_add_f32 v5, v5, v18
    v_mfma_f32_16x16x32_bf16 a[36:39], v[80:83], v[28:31], a[36:39]
    v_add_f32 v5, v5, v19
    v_mfma_f32_16x16x32_bf16 a[84:87], v[68:71], v[24:27], a[84:87]
    v_exp_f32 v17, v181
    v_mfma_f32_16x16x32_bf16 a[84:87], v[84:87], v[28:31], a[84:87]
    s_add_u32 s32, s32, 24576
    v_cvt_pk_bf16_f32 v179, v18, v19
    s_add_u32 s26, s26, 36864
    v_mfma_f32_16x16x32_bf16 a[132:135], v[72:75], v[24:27], a[132:135]
    s_sub_u32 s57, s26, 147456
    ds_read_b128 v[44:47], v1 offset:23552
    v_fma_f32 v157, v157, v49, v51
    v_mfma_f32_16x16x32_bf16 a[132:135], v[88:91], v[28:31], a[132:135]
    s_waitcnt lgkmcnt(2)
    v_exp_f32 v18, v182
    v_mfma_f32_16x16x32_bf16 a[180:183], v[76:79], v[24:27], a[180:183]
    s_waitcnt vmcnt(6)
    v_add_f32 v6, v6, v16
    v_add_f32 v6, v6, v17
    v_mfma_f32_16x16x32_bf16 a[180:183], v[92:95], v[28:31], a[180:183]
    s_barrier
    v_cvt_f32_i32 v154, v154
    v_mfma_f32_16x16x32_bf16 a[40:43], v[64:67], v[32:35], a[40:43]
    s_min_u32 s26, s26, s57
    ds_read_b128 v[24:27], v2 offset:0
    v_add_u32 v0, 1, v0
    v_mfma_f32_16x16x32_bf16 a[40:43], v[80:83], v[36:39], a[40:43]
    buffer_store_dword v0, v13, s[20:23], 0 offen offset:32 sc1
    v_mfma_f32_16x16x32_bf16 a[88:91], v[68:71], v[32:35], a[88:91]
    v_exp_f32 v19, v183
    v_mfma_f32_16x16x32_bf16 a[88:91], v[84:87], v[36:39], a[88:91]
    v_cvt_pk_bf16_f32 v180, v16, v17
    v_cvt_f32_i32 v158, v158
    v_mfma_f32_16x16x32_bf16 a[136:139], v[72:75], v[32:35], a[136:139]
    ds_read_b128 v[28:31], v3 offset:0
    v_mfma_f32_16x16x32_bf16 a[136:139], v[88:91], v[36:39], a[136:139]
    v_exp_f32 v16, v116
    v_mfma_f32_16x16x32_bf16 a[184:187], v[76:79], v[32:35], a[184:187]
    v_add_f32 v6, v6, v18
    v_add_f32 v6, v6, v19
    v_mfma_f32_16x16x32_bf16 a[184:187], v[92:95], v[36:39], a[184:187]
    s_waitcnt lgkmcnt(2)
    v_exp_f32 v17, v117
    v_mfma_f32_16x16x32_bf16 a[44:47], v[64:67], v[40:43], a[44:47]
    ds_read_b128 v[32:35], v2 offset:6144
    v_cvt_pk_bf16_f32 v181, v18, v19
    v_mfma_f32_16x16x32_bf16 a[44:47], v[80:83], v[44:47], a[44:47]
    v_exp_f32 v18, v118
    v_mfma_f32_16x16x32_bf16 a[92:95], v[68:71], v[40:43], a[92:95]
    v_add_f32 v6, v6, v16
    v_add_f32 v6, v6, v17
    v_mfma_f32_16x16x32_bf16 a[92:95], v[84:87], v[44:47], a[92:95]
    v_exp_f32 v19, v119
    v_mfma_f32_16x16x32_bf16 a[140:143], v[72:75], v[40:43], a[140:143]
    ds_read_b128 v[36:39], v3 offset:6144
    v_cvt_pk_bf16_f32 v182, v16, v17
    v_mfma_f32_16x16x32_bf16 a[140:143], v[88:91], v[44:47], a[140:143]
    v_add_f32 v6, v6, v18
    v_add_f32 v6, v6, v19
    v_mfma_f32_16x16x32_bf16 a[188:191], v[76:79], v[40:43], a[188:191]
    v_cvt_pk_bf16_f32 v183, v18, v19
    v_mfma_f32_16x16x32_bf16 a[188:191], v[92:95], v[44:47], a[188:191]
    s_waitcnt lgkmcnt(2)
    v_mfma_f32_16x16x32_bf16 v[64:67], v[24:27], a[192:195], v[128:131]
    s_add_u32 s33, s33, 196608
    ds_read_b128 v[40:43], v2 offset:128
    v_fma_f32 v154, v154, v48, v50
    v_mfma_f32_16x16x32_bf16 v[64:67], v[28:31], a[196:199], v[64:67]
    s_mov_b32 m0, s56
    v_exp_f32 v16, v184
    v_mfma_f32_16x16x32_bf16 v[68:71], v[24:27], a[216:219], v[132:135]
    s_add_u32 s34, s34, 196608
    v_exp_f32 v17, v185
    v_mfma_f32_16x16x32_bf16 v[68:71], v[28:31], a[220:223], v[68:71]
    s_add_u32 s36, s36, 1536
    buffer_load_dwordx4 v4, s[4:7], s27 offen offset:0 sc1 lds
    v_mfma_f32_16x16x32_bf16 v[72:75], v[24:27], a[240:243], v[136:139]
    ds_read_b128 v[44:47], v3 offset:128
    v_fma_f32 v158, v158, v49, v51
    v_mfma_f32_16x16x32_bf16 v[72:75], v[28:31], a[244:247], v[72:75]
    v_exp_f32 v18, v186
    v_mfma_f32_16x16x32_bf16 v[76:79], v[24:27], v[200:203], v[140:143]
    v_add_f32 v7, v7, v16
    v_add_f32 v7, v7, v17
    v_mfma_f32_16x16x32_bf16 v[76:79], v[28:31], v[204:207], v[76:79]
    s_waitcnt lgkmcnt(2)
    buffer_load_dwordx2 v[56:57], v10, s[72:75], s36 offen offset:0
    v_mfma_f32_16x16x32_bf16 v[96:99], v[32:35], a[192:195], v[128:131]
    ds_read_b128 v[24:27], v2 offset:6272
    v_cvt_f32_i32 v155, v155
    v_mfma_f32_16x16x32_bf16 v[96:99], v[36:39], a[196:199], v[96:99]
    v_exp_f32 v19, v187
    v_mfma_f32_16x16x32_bf16 v[100:103], v[32:35], a[216:219], v[132:135]
    v_cvt_pk_bf16_f32 v184, v16, v17
    v_cvt_f32_i32 v159, v159
    v_mfma_f32_16x16x32_bf16 v[100:103], v[36:39], a[220:223], v[100:103]
    buffer_load_dwordx4 v4, s[4:7], s27 offen offset:1024 sc1 lds
    v_mfma_f32_16x16x32_bf16 v[104:107], v[32:35], a[240:243], v[136:139]
    ds_read_b128 v[28:31], v3 offset:6272
    v_fma_f32 v155, v155, v48, v50
    v_mfma_f32_16x16x32_bf16 v[104:107], v[36:39], a[244:247], v[104:107]
    v_exp_f32 v16, v120
    v_mfma_f32_16x16x32_bf16 v[108:111], v[32:35], v[200:203], v[140:143]
    v_add_f32 v7, v7, v18
    v_add_f32 v7, v7, v19
    v_mfma_f32_16x16x32_bf16 v[108:111], v[36:39], v[204:207], v[108:111]
    s_waitcnt lgkmcnt(2)
    buffer_load_dwordx2 v[58:59], v10, s[76:79], s36 offen offset:0
    v_mfma_f32_16x16x32_bf16 v[64:67], v[40:43], a[200:203], v[64:67]
    ds_read_b128 v[32:35], v2 offset:256
    v_fma_f32 v159, v159, v49, v51
    v_mfma_f32_16x16x32_bf16 v[64:67], v[44:47], a[204:207], v[64:67]
    v_exp_f32 v17, v121
    v_mfma_f32_16x16x32_bf16 v[68:71], v[40:43], a[224:227], v[68:71]
    v_cvt_pk_bf16_f32 v185, v18, v19
    v_cvt_pk_bf16_f32 v144, v144, v148
    v_mfma_f32_16x16x32_bf16 v[68:71], v[44:47], a[228:231], v[68:71]
    buffer_load_dwordx4 v[224:227], v9, s[64:67], s33 offen offset:0 nt
    v_mfma_f32_16x16x32_bf16 v[72:75], v[40:43], a[248:251], v[72:75]
    ds_read_b128 v[36:39], v3 offset:256
    v_cvt_pk_bf16_f32 v148, v145, v149
    v_mfma_f32_16x16x32_bf16 v[72:75], v[44:47], a[252:255], v[72:75]
    v_exp_f32 v18, v122
    v_mfma_f32_16x16x32_bf16 v[76:79], v[40:43], v[208:211], v[76:79]
    v_add_f32 v7, v7, v16
    v_add_f32 v7, v7, v17
    v_mfma_f32_16x16x32_bf16 v[76:79], v[44:47], v[212:215], v[76:79]
    s_waitcnt lgkmcnt(2)
    buffer_load_dwordx4 v4, s[4:7], s27 offen offset:2048 sc1 lds
    v_mfma_f32_16x16x32_bf16 v[96:99], v[24:27], a[200:203], v[96:99]
    ds_read_b128 v[40:43], v2 offset:6400
    v_cvt_pk_bf16_f32 v145, v152, v156
    v_mfma_f32_16x16x32_bf16 v[96:99], v[28:31], a[204:207], v[96:99]
    v_exp_f32 v19, v123
    v_cvt_pk_bf16_f32 v186, v16, v17
    v_mfma_f32_16x16x32_bf16 v[100:103], v[24:27], a[224:227], v[100:103]
    v_exp_f32 v16, v188
    v_mfma_f32_16x16x32_bf16 v[100:103], v[28:31], a[228:231], v[100:103]
    buffer_load_dwordx4 v[228:231], v9, s[64:67], s33 offen offset:1536 nt
    v_mfma_f32_16x16x32_bf16 v[104:107], v[24:27], a[248:251], v[104:107]
    ds_read_b128 v[44:47], v3 offset:6400
    v_add_f32 v7, v7, v18
    v_mfma_f32_16x16x32_bf16 v[104:107], v[28:31], a[252:255], v[104:107]
    v_add_f32 v7, v7, v19
    v_cvt_pk_bf16_f32 v149, v153, v157
    v_mfma_f32_16x16x32_bf16 v[108:111], v[24:27], v[208:211], v[108:111]
    s_add_u32 s29, s30, 49152
    v_exp_f32 v17, v189
    v_mfma_f32_16x16x32_bf16 v[108:111], v[28:31], v[212:215], v[108:111]
    s_waitcnt lgkmcnt(2)
    buffer_load_dwordx4 v[232:235], v9, s[64:67], s34 offen offset:0 nt
    v_cvt_pk_bf16_f32 v187, v18, v19
    v_mfma_f32_16x16x32_bf16 v[64:67], v[32:35], a[208:211], v[64:67]
    s_sub_u32 s3, s29, 147456
    ds_read_b128 v[24:27], v2 offset:12288
    s_add_u32 s27, s27, 24576
    v_mfma_f32_16x16x32_bf16 v[64:67], v[36:39], a[212:215], v[64:67]
    s_min_u32 s29, s29, s3
    v_exp_f32 v18, v190
    v_mfma_f32_16x16x32_bf16 v[68:71], v[32:35], a[232:235], v[68:71]
    v_add_f32 v8, v8, v16
    v_add_f32 v8, v8, v17
    v_mfma_f32_16x16x32_bf16 v[68:71], v[36:39], a[236:239], v[68:71]
    buffer_load_dwordx4 v[236:239], v9, s[64:67], s34 offen offset:1536 nt
    v_mfma_f32_16x16x32_bf16 v[72:75], v[32:35], v[192:195], v[72:75]
    s_add_u32 s56, s56, 12288
    ds_read_b128 v[28:31], v3 offset:12288
    v_cvt_pk_bf16_f32 v152, v146, v150
    v_mfma_f32_16x16x32_bf16 v[72:75], v[36:39], v[196:199], v[72:75]
    v_exp_f32 v19, v191
    v_cvt_pk_bf16_f32 v188, v16, v17
    v_mfma_f32_16x16x32_bf16 v[76:79], v[32:35], v[216:219], v[76:79]
    v_exp_f32 v16, v124
    v_mfma_f32_16x16x32_bf16 v[76:79], v[36:39], v[220:223], v[76:79]
    s_waitcnt lgkmcnt(2)
    v_add_f32 v8, v8, v18
    v_add_f32 v8, v8, v19
    v_mfma_f32_16x16x32_bf16 v[96:99], v[40:43], a[208:211], v[96:99]
    ds_read_b128 v[32:35], v2 offset:18432
    v_cvt_pk_bf16_f32 v153, v154, v158
    v_mfma_f32_16x16x32_bf16 v[96:99], v[44:47], a[212:215], v[96:99]
    s_sub_u32 s3, s29, s30
    v_exp_f32 v17, v125
    v_mfma_f32_16x16x32_bf16 v[100:103], v[40:43], a[232:235], v[100:103]
    s_mov_b32 m0, s56
    v_cvt_pk_bf16_f32 v189, v18, v19
    v_cvt_pk_bf16_f32 v156, v147, v151
    v_mfma_f32_16x16x32_bf16 v[100:103], v[44:47], a[236:239], v[100:103]
    v_exp_f32 v18, v126
    v_mfma_f32_16x16x32_bf16 v[104:107], v[40:43], v[192:195], v[104:107]
    ds_read_b128 v[36:39], v3 offset:18432
    v_add_f32 v8, v8, v16
    v_mfma_f32_16x16x32_bf16 v[104:107], v[44:47], v[196:199], v[104:107]
    v_add_f32 v8, v8, v17
    v_cvt_pk_bf16_f32 v157, v155, v159
    v_mfma_f32_16x16x32_bf16 v[108:111], v[40:43], v[216:219], v[108:111]
    v_exp_f32 v19, v127
    v_mfma_f32_16x16x32_bf16 v[108:111], v[44:47], v[220:223], v[108:111]
    s_waitcnt lgkmcnt(2)
    v_cvt_pk_bf16_f32 v190, v16, v17
    v_add_f32 v8, v8, v18
    v_mfma_f32_16x16x32_bf16 v[80:83], v[24:27], a[192:195], v[128:131]
    ds_read_b128 v[40:43], v2 offset:12416
    v_add_f32 v8, v8, v19
    v_mfma_f32_16x16x32_bf16 v[80:83], v[28:31], a[196:199], v[80:83]
    s_mov_b32 s30, s29
    v_cvt_pk_bf16_f32 v191, v18, v19
    v_mfma_f32_16x16x32_bf16 v[84:87], v[24:27], a[216:219], v[132:135]
    v_exp_f32 v16, v64
    v_mfma_f32_16x16x32_bf16 v[84:87], v[28:31], a[220:223], v[84:87]
    s_waitcnt vmcnt(20)
    buffer_load_dwordx4 v4, s[4:7], s27 offen offset:0 sc1 lds
    v_mfma_f32_16x16x32_bf16 v[88:91], v[24:27], a[240:243], v[136:139]
    ds_read_b128 v[44:47], v3 offset:12416
    v_lshlrev_b32 v48, 16, v60
    v_mfma_f32_16x16x32_bf16 v[88:91], v[28:31], a[244:247], v[88:91]
L_pg4:
    s_cbranch_execz L_pg8
    v_exp_f32 v17, v65
    v_mfma_f32_16x16x32_bf16 v[92:95], v[24:27], v[200:203], v[140:143]
    v_exp_f32 v18, v66
    v_mfma_f32_16x16x32_bf16 v[92:95], v[28:31], v[204:207], v[92:95]
    s_waitcnt lgkmcnt(2)
    v_add_f32 v5, v5, v16
    v_add_f32 v5, v5, v17
    v_mfma_f32_16x16x32_bf16 v[112:115], v[32:35], a[192:195], v[128:131]
    ds_read_b128 v[24:27], v2 offset:18560
    v_and_b32 v49, s97, v60
    v_mfma_f32_16x16x32_bf16 v[112:115], v[36:39], a[196:199], v[112:115]
    v_exp_f32 v19, v67
    v_mfma_f32_16x16x32_bf16 v[116:119], v[32:35], a[216:219], v[132:135]
    v_cvt_pk_bf16_f32 v64, v16, v17
    v_lshlrev_b32 v50, 16, v62
    v_mfma_f32_16x16x32_bf16 v[116:119], v[36:39], a[220:223], v[116:119]
    v_exp_f32 v16, v96
    v_mfma_f32_16x16x32_bf16 v[120:123], v[32:35], a[240:243], v[136:139]
    ds_read_b128 v[28:31], v3 offset:18560
    v_add_f32 v5, v5, v18
    v_mfma_f32_16x16x32_bf16 v[120:123], v[36:39], a[244:247], v[120:123]
    v_add_f32 v5, v5, v19
    v_and_b32 v51, s97, v62
    v_mfma_f32_16x16x32_bf16 v[124:127], v[32:35], v[200:203], v[140:143]
    v_exp_f32 v17, v97
    v_mfma_f32_16x16x32_bf16 v[124:127], v[36:39], v[204:207], v[124:127]
    s_waitcnt lgkmcnt(2)
    buffer_load_dwordx4 v4, s[4:7], s27 offen offset:1024 sc1 lds
    v_mfma_f32_16x16x32_bf16 v[80:83], v[40:43], a[200:203], v[80:83]
    ds_read_b128 v[32:35], v2 offset:12544
    v_cvt_pk_bf16_f32 v65, v18, v19
    v_mfma_f32_16x16x32_bf16 v[80:83], v[44:47], a[204:207], v[80:83]
    v_exp_f32 v18, v98
    v_mfma_f32_16x16x32_bf16 v[84:87], v[40:43], a[224:227], v[84:87]
    v_add_f32 v5, v5, v16
    v_add_f32 v5, v5, v17
    v_mfma_f32_16x16x32_bf16 v[84:87], v[44:47], a[228:231], v[84:87]
    v_exp_f32 v19, v99
    v_mfma_f32_16x16x32_bf16 v[88:91], v[40:43], a[248:251], v[88:91]
    ds_read_b128 v[36:39], v3 offset:12544
    v_cvt_pk_bf16_f32 v66, v16, v17
    v_mfma_f32_16x16x32_bf16 v[88:91], v[44:47], a[252:255], v[88:91]
    v_exp_f32 v16, v68
    v_mfma_f32_16x16x32_bf16 v[92:95], v[40:43], v[208:211], v[92:95]
    v_mul_f32_e64 v50, -v50, v48
    v_add_u32 v1, s3, v1
    v_mfma_f32_16x16x32_bf16 v[92:95], v[44:47], v[212:215], v[92:95]
    s_waitcnt lgkmcnt(2)
    v_add_f32 v5, v5, v18
    v_mul_f32_e64 v51, -v51, v49
    v_mfma_f32_16x16x32_bf16 v[112:115], v[24:27], a[200:203], v[112:115]
    ds_read_b128 v[40:43], v2 offset:18688
    v_add_f32 v5, v5, v19
    v_mfma_f32_16x16x32_bf16 v[112:115], v[28:31], a[204:207], v[112:115]
    buffer_load_dwordx4 v4, s[4:7], s27 offen offset:2048 sc1 lds
    v_mfma_f32_16x16x32_bf16 v[116:119], v[24:27], a[224:227], v[116:119]
    v_exp_f32 v17, v69
    v_mfma_f32_16x16x32_bf16 v[116:119], v[28:31], a[228:231], v[116:119]
    v_cvt_pk_bf16_f32 v67, v18, v19
    v_cvt_f32_i32 v240, v240
    v_mfma_f32_16x16x32_bf16 v[120:123], v[24:27], a[248:251], v[120:123]
    ds_read_b128 v[44:47], v3 offset:18688
    v_cvt_f32_i32 v244, v244
    v_mfma_f32_16x16x32_bf16 v[120:123], v[28:31], a[252:255], v[120:123]
    s_waitcnt lgkmcnt(2)
    v_exp_f32 v18, v70
    v_mfma_f32_16x16x32_bf16 v[124:127], v[24:27], v[208:211], v[124:127]
    s_waitcnt vmcnt(13)
    v_add_f32 v6, v6, v16
    v_add_f32 v6, v6, v17
    v_mfma_f32_16x16x32_bf16 v[124:127], v[28:31], v[212:215], v[124:127]
    s_barrier
    v_fma_f32 v240, v240, v48, v50
    v_mfma_f32_16x16x32_bf16 v[80:83], v[32:35], a[208:211], v[80:83]
    ds_read_b128 v[24:27], v1 offset:0
    v_fma_f32 v244, v244, v49, v51
    v_mfma_f32_16x16x32_bf16 v[80:83], v[36:39], a[212:215], v[80:83]
    v_exp_f32 v19, v71
    v_mfma_f32_16x16x32_bf16 v[84:87], v[32:35], a[232:235], v[84:87]
    v_cvt_pk_bf16_f32 v68, v16, v17
    v_mfma_f32_16x16x32_bf16 v[84:87], v[36:39], a[236:239], v[84:87]
    v_exp_f32 v16, v100
    v_mfma_f32_16x16x32_bf16 v[88:91], v[32:35], v[192:195], v[88:91]
    ds_read_b128 v[28:31], v1 offset:12288
    v_add_f32 v6, v6, v18
    v_mfma_f32_16x16x32_bf16 v[88:91], v[36:39], v[196:199], v[88:91]
    v_add_f32 v6, v6, v19
    v_cvt_f32_i32 v241, v241
    v_mfma_f32_16x16x32_bf16 v[92:95], v[32:35], v[216:219], v[92:95]
    v_exp_f32 v17, v101
    v_mfma_f32_16x16x32_bf16 v[92:95], v[36:39], v[220:223], v[92:95]
    s_waitcnt lgkmcnt(2)
    v_cvt_pk_bf16_f32 v69, v18, v19
    v_cvt_f32_i32 v245, v245
    v_mfma_f32_16x16x32_bf16 v[112:115], v[40:43], a[208:211], v[112:115]
    ds_read_b128 v[32:35], v1 offset:1024
    v_mfma_f32_16x16x32_bf16 v[112:115], v[44:47], a[212:215], v[112:115]
    v_exp_f32 v18, v102
    v_mfma_f32_16x16x32_bf16 v[116:119], v[40:43], a[232:235], v[116:119]
    v_add_f32 v6, v6, v16
    v_add_f32 v6, v6, v17
    v_mfma_f32_16x16x32_bf16 v[116:119], v[44:47], a[236:239], v[116:119]
    s_add_u32 s27, s27, 24576
    v_exp_f32 v19, v103
    v_mfma_f32_16x16x32_bf16 v[120:123], v[40:43], v[192:195], v[120:123]
    s_add_u32 s56, s56, 36864
    ds_read_b128 v[36:39], v1 offset:13312
    v_cvt_pk_bf16_f32 v70, v16, v17
    v_mfma_f32_16x16x32_bf16 v[120:123], v[44:47], v[196:199], v[120:123]
    s_sub_u32 s58, s56, 147456
    v_add_f32 v6, v6, v18
    v_add_f32 v6, v6, v19
    v_mfma_f32_16x16x32_bf16 v[124:127], v[40:43], v[216:219], v[124:127]
    s_min_u32 s56, s56, s58
    v_cvt_pk_bf16_f32 v71, v18, v19
    v_mfma_f32_16x16x32_bf16 v[124:127], v[44:47], v[220:223], v[124:127]
    s_waitcnt lgkmcnt(2)
    v_mfma_f32_16x16x32_bf16 a[0:3], v[160:163], v[24:27], a[0:3]
    s_mov_b32 m0, s56
    ds_read_b128 v[40:43], v1 offset:2048
    v_fma_f32 v241, v241, v48, v50
    v_mfma_f32_16x16x32_bf16 a[0:3], v[176:179], v[28:31], a[0:3]
    buffer_load_dwordx4 v4, s[4:7], s27 offen offset:0 sc1 lds
    v_mfma_f32_16x16x32_bf16 a[48:51], v[164:167], v[24:27], a[48:51]
    v_exp_f32 v16, v72
    v_mfma_f32_16x16x32_bf16 a[48:51], v[180:183], v[28:31], a[48:51]
    v_exp_f32 v17, v73
    v_mfma_f32_16x16x32_bf16 a[96:99], v[168:171], v[24:27], a[96:99]
    ds_read_b128 v[44:47], v1 offset:14336
    v_fma_f32 v245, v245, v49, v51
    v_mfma_f32_16x16x32_bf16 a[96:99], v[184:187], v[28:31], a[96:99]
    v_exp_f32 v18, v74
    v_mfma_f32_16x16x32_bf16 a[144:147], v[172:175], v[24:27], a[144:147]
    v_add_f32 v7, v7, v16
    v_add_f32 v7, v7, v17
    v_mfma_f32_16x16x32_bf16 a[144:147], v[188:191], v[28:31], a[144:147]
    s_waitcnt lgkmcnt(2)
    v_exp_f32 v19, v75
    v_mfma_f32_16x16x32_bf16 a[4:7], v[160:163], v[32:35], a[4:7]
    ds_read_b128 v[24:27], v1 offset:3072
    v_cvt_f32_i32 v242, v242
    v_mfma_f32_16x16x32_bf16 a[4:7], v[176:179], v[36:39], a[4:7]
    buffer_load_dwordx4 v4, s[4:7], s27 offen offset:1024 sc1 lds
    v_mfma_f32_16x16x32_bf16 a[52:55], v[164:167], v[32:35], a[52:55]
    v_cvt_pk_bf16_f32 v72, v16, v17
    v_cvt_f32_i32 v246, v246
    v_mfma_f32_16x16x32_bf16 a[52:55], v[180:183], v[36:39], a[52:55]
    v_exp_f32 v16, v104
    v_mfma_f32_16x16x32_bf16 a[100:103], v[168:171], v[32:35], a[100:103]
    ds_read_b128 v[28:31], v1 offset:15360
    v_add_f32 v7, v7, v18
    v_mfma_f32_16x16x32_bf16 a[100:103], v[184:187], v[36:39], a[100:103]
    v_add_f32 v7, v7, v19
    v_bfe_u32 v53, v4, 4, 6
    v_mfma_f32_16x16x32_bf16 a[148:151], v[172:175], v[32:35], a[148:151]
    v_exp_f32 v17, v105
    v_mfma_f32_16x16x32_bf16 a[148:151], v[188:191], v[36:39], a[148:151]
    s_waitcnt lgkmcnt(2)
    v_fma_f32 v242, v242, v48, v50
    v_cvt_pk_bf16_f32 v73, v18, v19
    v_mfma_f32_16x16x32_bf16 a[8:11], v[160:163], v[40:43], a[8:11]
    ds_read_b128 v[32:35], v1 offset:4096
    v_fma_f32 v246, v246, v49, v51
    v_mfma_f32_16x16x32_bf16 a[8:11], v[176:179], v[44:47], a[8:11]
    v_exp_f32 v18, v106
    v_mfma_f32_16x16x32_bf16 a[56:59], v[164:167], v[40:43], a[56:59]
    v_lshlrev_b32 v53, 2, v53
    v_add_f32 v7, v7, v16
    v_mfma_f32_16x16x32_bf16 a[56:59], v[180:183], v[44:47], a[56:59]
    buffer_load_dword v52, v53, s[20:23], s44 offen sc1
    v_mfma_f32_16x16x32_bf16 a[104:107], v[168:171], v[40:43], a[104:107]
    ds_read_b128 v[36:39], v1 offset:16384
    v_add_f32 v7, v7, v17
    v_mfma_f32_16x16x32_bf16 a[104:107], v[184:187], v[44:47], a[104:107]
    v_exp_f32 v19, v107
    v_mfma_f32_16x16x32_bf16 a[152:155], v[172:175], v[40:43], a[152:155]
    v_cvt_f32_i32 v243, v243
    v_cvt_pk_bf16_f32 v74, v16, v17
    v_mfma_f32_16x16x32_bf16 a[152:155], v[188:191], v[44:47], a[152:155]
    s_waitcnt lgkmcnt(2)
    buffer_load_dwordx4 v4, s[4:7], s27 offen offset:2048 sc1 lds
    v_mfma_f32_16x16x32_bf16 a[12:15], v[160:163], v[24:27], a[12:15]
    ds_read_b128 v[40:43], v1 offset:5120
    v_cvt_f32_i32 v247, v247
    v_mfma_f32_16x16x32_bf16 a[12:15], v[176:179], v[28:31], a[12:15]
    s_add_u32 s27, s27, 24576
    v_exp_f32 v16, v76
    v_mfma_f32_16x16x32_bf16 a[60:63], v[164:167], v[24:27], a[60:63]
    v_add_f32 v7, v7, v18
    v_add_f32 v7, v7, v19
    v_mfma_f32_16x16x32_bf16 a[60:63], v[180:183], v[28:31], a[60:63]
    v_fma_f32 v243, v243, v48, v50
    v_fma_f32 v247, v247, v49, v51
    v_mfma_f32_16x16x32_bf16 a[108:111], v[168:171], v[24:27], a[108:111]
    ds_read_b128 v[44:47], v1 offset:17408
    v_lshlrev_b32 v48, 16, v61
    v_mfma_f32_16x16x32_bf16 a[108:111], v[184:187], v[28:31], a[108:111]
    v_exp_f32 v17, v77
    v_mfma_f32_16x16x32_bf16 a[156:159], v[172:175], v[24:27], a[156:159]
    s_add_u32 s29, s28, 49152
    v_cvt_pk_bf16_f32 v75, v18, v19
    v_and_b32 v49, s97, v61
    v_mfma_f32_16x16x32_bf16 a[156:159], v[188:191], v[28:31], a[156:159]
    s_waitcnt lgkmcnt(2)
    v_exp_f32 v18, v78
    v_mfma_f32_16x16x32_bf16 a[16:19], v[160:163], v[32:35], a[16:19]
    s_sub_u32 s3, s29, 147456
    ds_read_b128 v[24:27], v1 offset:6144
    v_add_f32 v8, v8, v16
    v_mfma_f32_16x16x32_bf16 a[16:19], v[176:179], v[36:39], a[16:19]
    s_add_u32 s56, s56, 12288
    v_add_f32 v8, v8, v17
    v_lshlrev_b32 v50, 16, v63
    v_mfma_f32_16x16x32_bf16 a[64:67], v[164:167], v[32:35], a[64:67]
    s_min_u32 s29, s29, s3
    v_exp_f32 v19, v79
    v_mfma_f32_16x16x32_bf16 a[64:67], v[180:183], v[36:39], a[64:67]
    s_mov_b32 m0, s56
    v_cvt_pk_bf16_f32 v76, v16, v17
    v_and_b32 v51, s97, v63
    v_mfma_f32_16x16x32_bf16 a[112:115], v[168:171], v[32:35], a[112:115]
    ds_read_b128 v[28:31], v1 offset:18432
    v_mul_f32_e64 v50, -v50, v48
    v_mfma_f32_16x16x32_bf16 a[112:115], v[184:187], v[36:39], a[112:115]
    v_exp_f32 v16, v108
    v_mfma_f32_16x16x32_bf16 a[160:163], v[172:175], v[32:35], a[160:163]
    v_add_f32 v8, v8, v18
    v_add_f32 v8, v8, v19
    v_mfma_f32_16x16x32_bf16 a[160:163], v[188:191], v[36:39], a[160:163]
    s_waitcnt lgkmcnt(2)
    v_exp_f32 v17, v109
    v_mfma_f32_16x16x32_bf16 a[20:23], v[160:163], v[40:43], a[20:23]
    s_sub_u32 s3, s29, s28
    ds_read_b128 v[32:35], v1 offset:7168
    v_cvt_pk_bf16_f32 v77, v18, v19
    v_mfma_f32_16x16x32_bf16 a[20:23], v[176:179], v[44:47], a[20:23]
    v_exp_f32 v18, v110
    v_mfma_f32_16x16x32_bf16 a[68:71], v[164:167], v[40:43], a[68:71]
    v_mul_f32_e64 v51, -v51, v49
    v_add_f32 v8, v8, v16
    v_mfma_f32_16x16x32_bf16 a[68:71], v[180:183], v[44:47], a[68:71]
    buffer_load_dwordx4 v4, s[4:7], s27 offen offset:0 sc1 lds
    v_mfma_f32_16x16x32_bf16 a[116:119], v[168:171], v[40:43], a[116:119]
    ds_read_b128 v[36:39], v1 offset:19456
    v_add_f32 v8, v8, v17
    v_mfma_f32_16x16x32_bf16 a[116:119], v[184:187], v[44:47], a[116:119]
    v_exp_f32 v19, v111
    v_mfma_f32_16x16x32_bf16 a[164:167], v[172:175], v[40:43], a[164:167]
    s_mov_b32 s28, s29
    v_cvt_f32_i32 v248, v248
    v_cvt_pk_bf16_f32 v78, v16, v17
    v_mfma_f32_16x16x32_bf16 a[164:167], v[188:191], v[44:47], a[164:167]
    s_waitcnt lgkmcnt(2)
    v_add_f32 v8, v8, v18
    v_cvt_f32_i32 v252, v252
    v_mfma_f32_16x16x32_bf16 a[24:27], v[160:163], v[24:27], a[24:27]
    ds_read_b128 v[40:43], v1 offset:8192
    v_add_f32 v8, v8, v19
    v_mfma_f32_16x16x32_bf16 a[24:27], v[176:179], v[28:31], a[24:27]
    v_cvt_pk_bf16_f32 v79, v18, v19
    v_fma_f32 v248, v248, v48, v50
    v_mfma_f32_16x16x32_bf16 a[72:75], v[164:167], v[24:27], a[72:75]
    v_exp_f32 v16, v80
    v_mfma_f32_16x16x32_bf16 a[72:75], v[180:183], v[28:31], a[72:75]
    buffer_load_dwordx4 v4, s[4:7], s27 offen offset:1024 sc1 lds
    v_mfma_f32_16x16x32_bf16 a[120:123], v[168:171], v[24:27], a[120:123]
    ds_read_b128 v[44:47], v1 offset:20480
    v_fma_f32 v252, v252, v49, v51
    v_mfma_f32_16x16x32_bf16 a[120:123], v[184:187], v[28:31], a[120:123]
    v_exp_f32 v17, v81
    v_mfma_f32_16x16x32_bf16 a[168:171], v[172:175], v[24:27], a[168:171]
    v_exp_f32 v18, v82
    v_mfma_f32_16x16x32_bf16 a[168:171], v[188:191], v[28:31], a[168:171]
    s_waitcnt lgkmcnt(2)
    v_cvt_f32_i32 v249, v249
    v_add_f32 v5, v5, v16
    v_mfma_f32_16x16x32_bf16 a[28:31], v[160:163], v[32:35], a[28:31]
    ds_read_b128 v[24:27], v1 offset:9216
    v_add_f32 v5, v5, v17
    v_mfma_f32_16x16x32_bf16 a[28:31], v[176:179], v[36:39], a[28:31]
    v_exp_f32 v19, v83
    v_mfma_f32_16x16x32_bf16 a[76:79], v[164:167], v[32:35], a[76:79]
    v_cvt_f32_i32 v253, v253
    v_cvt_pk_bf16_f32 v80, v16, v17
    v_mfma_f32_16x16x32_bf16 a[76:79], v[180:183], v[36:39], a[76:79]
    v_exp_f32 v16, v112
    v_mfma_f32_16x16x32_bf16 a[124:127], v[168:171], v[32:35], a[124:127]
    ds_read_b128 v[28:31], v1 offset:21504
    v_fma_f32 v249, v249, v48, v50
    v_mfma_f32_16x16x32_bf16 a[124:127], v[184:187], v[36:39], a[124:127]
    buffer_load_dwordx4 v4, s[4:7], s27 offen offset:2048 sc1 lds
    v_mfma_f32_16x16x32_bf16 a[172:175], v[172:175], v[32:35], a[172:175]
    v_add_f32 v5, v5, v18
    v_add_f32 v5, v5, v19
    v_mfma_f32_16x16x32_bf16 a[172:175], v[188:191], v[36:39], a[172:175]
    s_waitcnt lgkmcnt(2)
    v_exp_f32 v17, v113
    v_mfma_f32_16x16x32_bf16 a[32:35], v[160:163], v[40:43], a[32:35]
    ds_read_b128 v[32:35], v1 offset:10240
    v_fma_f32 v253, v253, v49, v51
    v_mfma_f32_16x16x32_bf16 a[32:35], v[176:179], v[44:47], a[32:35]
    v_cvt_pk_bf16_f32 v81, v18, v19
    v_cvt_f32_i32 v250, v250
    v_mfma_f32_16x16x32_bf16 a[80:83], v[164:167], v[40:43], a[80:83]
    v_exp_f32 v18, v114
    v_mfma_f32_16x16x32_bf16 a[80:83], v[180:183], v[44:47], a[80:83]
    v_cvt_f32_i32 v254, v254
    v_add_f32 v5, v5, v16
    v_mfma_f32_16x16x32_bf16 a[128:131], v[168:171], v[40:43], a[128:131]
    ds_read_b128 v[36:39], v1 offset:22528
    v_add_f32 v5, v5, v17
    v_mfma_f32_16x16x32_bf16 a[128:131], v[184:187], v[44:47], a[128:131]
    v_exp_f32 v19, v115
    v_mfma_f32_16x16x32_bf16 a[176:179], v[172:175], v[40:43], a[176:179]
    v_fma_f32 v250, v250, v48, v50
    v_cvt_pk_bf16_f32 v82, v16, v17
    v_mfma_f32_16x16x32_bf16 a[176:179], v[188:191], v[44:47], a[176:179]
    s_waitcnt lgkmcnt(2)
    v_exp_f32 v16, v84
    v_mfma_f32_16x16x32_bf16 a[36:39], v[160:163], v[24:27], a[36:39]
    ds_read_b128 v[40:43], v1 offset:11264
    v_fma_f32 v254, v254, v49, v51
    v_mfma_f32_16x16x32_bf16 a[36:39], v[176:179], v[28:31], a[36:39]
    v_add_u32 v2, s3, v2
    v_add_f32 v5, v5, v18
    v_mfma_f32_16x16x32_bf16 a[84:87], v[164:167], v[24:27], a[84:87]
    v_add_f32 v5, v5, v19
    v_cvt_f32_i32 v251, v251
    v_mfma_f32_16x16x32_bf16 a[84:87], v[180:183], v[28:31], a[84:87]
    s_add_u32 s27, s27, 24576
    v_exp_f32 v17, v85
    v_mfma_f32_16x16x32_bf16 a[132:135], v[168:171], v[24:27], a[132:135]
    s_add_u32 s56, s56, 36864
    ds_read_b128 v[44:47], v1 offset:23552
    v_add_u32 v3, s3, v3
    v_mfma_f32_16x16x32_bf16 a[132:135], v[184:187], v[28:31], a[132:135]
    s_sub_u32 s58, s56, 147456
    v_cvt_pk_bf16_f32 v83, v18, v19
    v_cvt_f32_i32 v255, v255
    v_mfma_f32_16x16x32_bf16 a[180:183], v[172:175], v[24:27], a[180:183]
    v_exp_f32 v18, v86
    v_mfma_f32_16x16x32_bf16 a[180:183], v[188:191], v[28:31], a[180:183]
    s_waitcnt lgkmcnt(2)
    v_fma_f32 v251, v251, v48, v50
    v_add_f32 v6, v6, v16
    v_mfma_f32_16x16x32_bf16 a[40:43], v[160:163], v[32:35], a[40:43]
    s_min_u32 s56, s56, s58
    ds_read_b128 v[24:27], v2 offset:0
    v_add_f32 v6, v6, v17
    v_mfma_f32_16x16x32_bf16 a[40:43], v[176:179], v[36:39], a[40:43]
    buffer_load_dword v20, v4, s[88:91], s93 offen
    v_mfma_f32_16x16x32_bf16 a[88:91], v[164:167], v[32:35], a[88:91]
    v_exp_f32 v19, v87
    v_mfma_f32_16x16x32_bf16 a[88:91], v[180:183], v[36:39], a[88:91]
    v_cvt_pk_bf16_f32 v84, v16, v17
    v_fma_f32 v255, v255, v49, v51
    v_mfma_f32_16x16x32_bf16 a[136:139], v[168:171], v[32:35], a[136:139]
    ds_read_b128 v[28:31], v3 offset:0
    v_cvt_pk_bf16_f32 v146, v240, v244
    v_mfma_f32_16x16x32_bf16 a[136:139], v[184:187], v[36:39], a[136:139]
    v_exp_f32 v16, v116
    v_mfma_f32_16x16x32_bf16 a[184:187], v[172:175], v[32:35], a[184:187]
    v_add_f32 v6, v6, v18
    v_add_f32 v6, v6, v19
    v_mfma_f32_16x16x32_bf16 a[184:187], v[188:191], v[36:39], a[184:187]
    s_waitcnt lgkmcnt(2)
    v_exp_f32 v17, v117
    v_mfma_f32_16x16x32_bf16 a[44:47], v[160:163], v[40:43], a[44:47]
    ds_read_b128 v[32:35], v2 offset:6144
    v_cvt_pk_bf16_f32 v150, v241, v245
    v_mfma_f32_16x16x32_bf16 a[44:47], v[176:179], v[44:47], a[44:47]
    v_cvt_pk_bf16_f32 v85, v18, v19
    v_cvt_pk_bf16_f32 v147, v248, v252
    v_mfma_f32_16x16x32_bf16 a[92:95], v[164:167], v[40:43], a[92:95]
    v_exp_f32 v18, v118
    v_mfma_f32_16x16x32_bf16 a[92:95], v[180:183], v[44:47], a[92:95]
    v_cvt_pk_bf16_f32 v151, v249, v253
    v_add_f32 v6, v6, v16
    v_mfma_f32_16x16x32_bf16 a[140:143], v[168:171], v[40:43], a[140:143]
    ds_read_b128 v[36:39], v3 offset:6144
    v_add_f32 v6, v6, v17
    v_mfma_f32_16x16x32_bf16 a[140:143], v[184:187], v[44:47], a[140:143]
    v_exp_f32 v19, v119
    v_mfma_f32_16x16x32_bf16 a[188:191], v[172:175], v[40:43], a[188:191]
    v_cvt_pk_bf16_f32 v154, v242, v246
    v_cvt_pk_bf16_f32 v86, v16, v17
    v_mfma_f32_16x16x32_bf16 a[188:191], v[188:191], v[44:47], a[188:191]
    s_waitcnt lgkmcnt(2)
    v_add_f32 v6, v6, v18
    v_cvt_pk_bf16_f32 v155, v250, v254
    v_add_f32 v6, v6, v19
    v_cvt_pk_bf16_f32 v158, v243, v247
    v_cvt_pk_bf16_f32 v87, v18, v19
    v_cvt_pk_bf16_f32 v159, v251, v255
L_join:
    v_mfma_f32_16x16x32_bf16 v[160:163], v[24:27], a[192:195], v[128:131]
L_pg5:
    s_cbranch_execz L_pg9
    s_waitcnt vmcnt(7)
    ds_read_b128 v[40:43], v2 offset:128
    v_lshlrev_b32 v48, 16, v56
    v_mfma_f32_16x16x32_bf16 v[160:163], v[28:31], a[196:199], v[160:163]
    s_waitcnt vmcnt(5)
    v_subrev_u32 v52, s92, v52
    v_cmp_lt_u32 vcc, 15, v52
    v_mfma_f32_16x16x32_bf16 v[164:167], v[24:27], a[216:219], v[132:135]
    v_exp_f32 v16, v88
    v_mfma_f32_16x16x32_bf16 v[164:167], v[28:31], a[220:223], v[164:167]
    v_exp_f32 v17, v89
    v_mfma_f32_16x16x32_bf16 v[168:171], v[24:27], a[240:243], v[136:139]
    s_and_b32 s59, vcc_lo, 0xff
    ds_read_b128 v[44:47], v3 offset:128
    v_and_b32 v49, s97, v56
    v_mfma_f32_16x16x32_bf16 v[168:171], v[28:31], a[244:247], v[168:171]
    s_cbranch_scc1 L_pollslow1
L_pollok1:
    v_mfma_f32_16x16x32_bf16 v[172:175], v[24:27], v[200:203], v[140:143]
    s_add_u32 s92, s92, 1
    v_exp_f32 v18, v90
    v_mfma_f32_16x16x32_bf16 v[172:175], v[28:31], v[204:207], v[172:175]
    s_waitcnt lgkmcnt(2)
    v_add_f32 v7, v7, v16
    v_add_f32 v7, v7, v17
    v_mfma_f32_16x16x32_bf16 v[96:99], v[32:35], a[192:195], v[128:131]
    ds_read_b128 v[24:27], v2 offset:6272
    v_lshlrev_b32 v50, 16, v58
    v_mfma_f32_16x16x32_bf16 v[96:99], v[36:39], a[196:199], v[96:99]
    buffer_store_dwordx4 v[144:147], v15, s[4:7], s35 offen offset:0 sc1
    v_mfma_f32_16x16x32_bf16 v[100:103], v[32:35], a[216:219], v[132:135]
    v_exp_f32 v19, v91
    v_mfma_f32_16x16x32_bf16 v[100:103], v[36:39], a[220:223], v[100:103]
    v_cvt_pk_bf16_f32 v88, v16, v17
    v_mfma_f32_16x16x32_bf16 v[104:107], v[32:35], a[240:243], v[136:139]
    ds_read_b128 v[28:31], v3 offset:6272
    v_mfma_f32_16x16x32_bf16 v[104:107], v[36:39], a[244:247], v[104:107]
    v_exp_f32 v16, v120
    v_mfma_f32_16x16x32_bf16 v[108:111], v[32:35], v[200:203], v[140:143]
    v_add_f32 v7, v7, v18
    v_add_f32 v7, v7, v19
    v_mfma_f32_16x16x32_bf16 v[108:111], v[36:39], v[204:207], v[108:111]
    s_waitcnt lgkmcnt(2)
    v_exp_f32 v17, v121
    v_mfma_f32_16x16x32_bf16 v[160:163], v[40:43], a[200:203], v[160:163]
    ds_read_b128 v[32:35], v2 offset:256
    v_cvt_pk_bf16_f32 v89, v18, v19
    v_mfma_f32_16x16x32_bf16 v[160:163], v[44:47], a[204:207], v[160:163]
    buffer_store_dwordx4 v[148:151], v15, s[4:7], s35 offen offset:3072 sc1
    v_mfma_f32_16x16x32_bf16 v[164:167], v[40:43], a[224:227], v[164:167]
    v_exp_f32 v18, v122
    v_mfma_f32_16x16x32_bf16 v[164:167], v[44:47], a[228:231], v[164:167]
    v_add_f32 v7, v7, v16
    v_add_f32 v7, v7, v17
    v_mfma_f32_16x16x32_bf16 v[168:171], v[40:43], a[248:251], v[168:171]
    ds_read_b128 v[36:39], v3 offset:256
    v_and_b32 v51, s97, v58
    v_mfma_f32_16x16x32_bf16 v[168:171], v[44:47], a[252:255], v[168:171]
    v_exp_f32 v19, v123
    v_mfma_f32_16x16x32_bf16 v[172:175], v[40:43], v[208:211], v[172:175]
    v_cvt_pk_bf16_f32 v90, v16, v17
    v_mul_f32 v48, s38, v48
    v_mfma_f32_16x16x32_bf16 v[172:175], v[44:47], v[212:215], v[172:175]
    s_waitcnt lgkmcnt(2)
    v_exp_f32 v16, v92
    v_mfma_f32_16x16x32_bf16 v[96:99], v[24:27], a[200:203], v[96:99]
    ds_read_b128 v[40:43], v2 offset:6400
    v_add_f32 v7, v7, v18
    v_mfma_f32_16x16x32_bf16 v[96:99], v[28:31], a[204:207], v[96:99]
    buffer_store_dwordx4 v[152:155], v15, s[4:7], s17 offen offset:0 sc1
    v_mfma_f32_16x16x32_bf16 v[100:103], v[24:27], a[224:227], v[100:103]
    v_add_f32 v7, v7, v19
    v_mul_f32 v49, s38, v49
    v_mfma_f32_16x16x32_bf16 v[100:103], v[28:31], a[228:231], v[100:103]
    v_exp_f32 v17, v93
    v_mfma_f32_16x16x32_bf16 v[104:107], v[24:27], a[248:251], v[104:107]
    ds_read_b128 v[44:47], v3 offset:6400
    v_cvt_pk_bf16_f32 v91, v18, v19
    v_mfma_f32_16x16x32_bf16 v[104:107], v[28:31], a[252:255], v[104:107]
    v_exp_f32 v18, v94
    v_mfma_f32_16x16x32_bf16 v[108:111], v[24:27], v[208:211], v[108:111]
    s_add_u32 s29, s30, 49152
    v_add_f32 v8, v8, v16
    v_add_f32 v8, v8, v17
    v_mfma_f32_16x16x32_bf16 v[108:111], v[28:31], v[212:215], v[108:111]
    s_waitcnt lgkmcnt(2)
    v_exp_f32 v19, v95
    v_mfma_f32_16x16x32_bf16 v[160:163], v[32:35], a[208:211], v[160:163]
    s_sub_u32 s3, s29, 147456
    ds_read_b128 v[24:27], v2 offset:12288
    v_cvt_pk_bf16_f32 v92, v16, v17
    v_mfma_f32_16x16x32_bf16 v[160:163], v[36:39], a[212:215], v[160:163]
    buffer_store_dwordx4 v[156:159], v15, s[4:7], s17 offen offset:3072 sc1
    v_mfma_f32_16x16x32_bf16 v[164:167], v[32:35], a[232:235], v[164:167]
    s_min_u32 s29, s29, s3
    v_exp_f32 v16, v124
    v_mfma_f32_16x16x32_bf16 v[164:167], v[36:39], a[236:239], v[164:167]
    v_add_f32 v8, v8, v18
    v_add_f32 v8, v8, v19
    v_mfma_f32_16x16x32_bf16 v[168:171], v[32:35], v[192:195], v[168:171]
    ds_read_b128 v[28:31], v3 offset:12288
    v_mul_f32_e64 v50, -v50, v48
    v_mfma_f32_16x16x32_bf16 v[168:171], v[36:39], v[196:199], v[168:171]
    v_exp_f32 v17, v125
    v_mfma_f32_16x16x32_bf16 v[172:175], v[32:35], v[216:219], v[172:175]
    v_cvt_pk_bf16_f32 v93, v18, v19
    v_mul_f32_e64 v51, -v51, v49
    v_mfma_f32_16x16x32_bf16 v[172:175], v[36:39], v[220:223], v[172:175]
    s_waitcnt lgkmcnt(2)
    v_exp_f32 v18, v126
    v_mfma_f32_16x16x32_bf16 v[96:99], v[40:43], a[208:211], v[96:99]
    ds_read_b128 v[32:35], v2 offset:18432
    v_add_f32 v8, v8, v16
    v_mfma_f32_16x16x32_bf16 v[96:99], v[44:47], a[212:215], v[96:99]
    s_mov_b32 m0, s26
    v_add_f32 v8, v8, v17
    s_sub_u32 s3, s29, s30
    v_mfma_f32_16x16x32_bf16 v[100:103], v[40:43], a[232:235], v[100:103]
    v_exp_f32 v19, v127
    v_mfma_f32_16x16x32_bf16 v[100:103], v[44:47], a[236:239], v[100:103]
    buffer_load_dwordx4 v4, s[4:7], s32 offen offset:0 sc1 lds
    v_mfma_f32_16x16x32_bf16 v[104:107], v[40:43], v[192:195], v[104:107]
    ds_read_b128 v[36:39], v3 offset:18432
    v_cvt_pk_bf16_f32 v94, v16, v17
    v_mfma_f32_16x16x32_bf16 v[104:107], v[44:47], v[196:199], v[104:107]
    v_add_f32 v8, v8, v18
    v_add_f32 v8, v8, v19
    v_mfma_f32_16x16x32_bf16 v[108:111], v[40:43], v[216:219], v[108:111]
    v_cvt_pk_bf16_f32 v95, v18, v19
    v_cvt_f32_i32 v224, v224
    v_mfma_f32_16x16x32_bf16 v[108:111], v[44:47], v[220:223], v[108:111]
    s_waitcnt lgkmcnt(2)
    buffer_load_dwordx4 v4, s[4:7], s32 offen offset:1024 sc1 lds
    v_mfma_f32_16x16x32_bf16 v[176:179], v[24:27], a[192:195], v[128:131]
    ds_read_b128 v[40:43], v2 offset:12416
    v_cvt_f32_i32 v225, v225
    v_mfma_f32_16x16x32_bf16 v[176:179], v[28:31], a[196:199], v[176:179]
    s_mov_b32 s30, s29
    v_exp_f32 v16, v160
    v_mfma_f32_16x16x32_bf16 v[180:183], v[24:27], a[216:219], v[132:135]
    v_exp_f32 v17, v161
    v_mfma_f32_16x16x32_bf16 v[180:183], v[28:31], a[220:223], v[180:183]
    buffer_load_dwordx4 v4, s[4:7], s32 offen offset:2048 sc1 lds
    v_mfma_f32_16x16x32_bf16 v[184:187], v[24:27], a[240:243], v[136:139]
    s_add_u32 s32, s32, 24576
    ds_read_b128 v[44:47], v3 offset:12416
    v_mfma_f32_16x16x32_bf16 v[184:187], v[28:31], a[244:247], v[184:187]
    v_exp_f32 v18, v162
    v_mfma_f32_16x16x32_bf16 v[188:191], v[24:27], v[200:203], v[140:143]
    s_add_u32 s26, s26, 12288
    v_add_f32 v5, v5, v16
    v_add_f32 v5, v5, v17
    v_mfma_f32_16x16x32_bf16 v[188:191], v[28:31], v[204:207], v[188:191]
    s_waitcnt lgkmcnt(2)
    v_exp_f32 v19, v163
    v_mfma_f32_16x16x32_bf16 v[112:115], v[32:35], a[192:195], v[128:131]
    s_mov_b32 m0, s26
    ds_read_b128 v[24:27], v2 offset:18560
    v_cvt_pk_bf16_f32 v160, v16, v17
    v_mfma_f32_16x16x32_bf16 v[112:115], v[36:39], a[196:199], v[112:115]
    v_exp_f32 v16, v96
    v_mfma_f32_16x16x32_bf16 v[116:119], v[32:35], a[216:219], v[132:135]
    v_add_f32 v5, v5, v18
    v_fma_f32 v224, v224, v48, v50
    v_mfma_f32_16x16x32_bf16 v[116:119], v[36:39], a[220:223], v[116:119]
    v_add_f32 v5, v5, v19
    v_fma_f32 v225, v225, v49, v51
    v_mfma_f32_16x16x32_bf16 v[120:123], v[32:35], a[240:243], v[136:139]
    ds_read_b128 v[28:31], v3 offset:18560
    v_add_u32 v1, s3, v1
    v_mfma_f32_16x16x32_bf16 v[120:123], v[36:39], a[244:247], v[120:123]
    buffer_load_dwordx4 v4, s[4:7], s32 offen offset:0 sc1 lds
    v_mfma_f32_16x16x32_bf16 v[124:127], v[32:35], v[200:203], v[140:143]
    v_exp_f32 v17, v97
    v_mfma_f32_16x16x32_bf16 v[124:127], v[36:39], v[204:207], v[124:127]
    s_waitcnt lgkmcnt(2)
    v_cvt_pk_bf16_f32 v161, v18, v19
    v_mfma_f32_16x16x32_bf16 v[176:179], v[40:43], a[200:203], v[176:179]
    ds_read_b128 v[32:35], v2 offset:12544
    v_cvt_pk_bf16_f32 v224, v224, v225
    v_mfma_f32_16x16x32_bf16 v[176:179], v[44:47], a[204:207], v[176:179]
    buffer_load_dwordx4 v4, s[4:7], s32 offen offset:1024 sc1 lds
    v_mfma_f32_16x16x32_bf16 v[180:183], v[40:43], a[224:227], v[180:183]
    v_exp_f32 v18, v98
    v_mfma_f32_16x16x32_bf16 v[180:183], v[44:47], a[228:231], v[180:183]
    v_add_f32 v5, v5, v16
    v_add_f32 v5, v5, v17
    v_mfma_f32_16x16x32_bf16 v[184:187], v[40:43], a[248:251], v[184:187]
    ds_read_b128 v[36:39], v3 offset:12544
    v_mfma_f32_16x16x32_bf16 v[184:187], v[44:47], a[252:255], v[184:187]
    buffer_load_dwordx4 v4, s[4:7], s32 offen offset:2048 sc1 lds
    v_mfma_f32_16x16x32_bf16 v[188:191], v[40:43], v[208:211], v[188:191]
    v_exp_f32 v19, v99
    v_mfma_f32_16x16x32_bf16 v[188:191], v[44:47], v[212:215], v[188:191]
    s_waitcnt lgkmcnt(2)
    v_cvt_pk_bf16_f32 v162, v16, v17
    v_cvt_f32_i32 v228, v228
    v_mfma_f32_16x16x32_bf16 v[112:115], v[24:27], a[200:203], v[112:115]
    ds_read_b128 v[40:43], v2 offset:18688
    v_mfma_f32_16x16x32_bf16 v[112:115], v[28:31], a[204:207], v[112:115]
    v_exp_f32 v16, v164
    v_mfma_f32_16x16x32_bf16 v[116:119], v[24:27], a[224:227], v[116:119]
    v_add_f32 v5, v5, v18
    v_add_f32 v5, v5, v19
    v_mfma_f32_16x16x32_bf16 v[116:119], v[28:31], a[228:231], v[116:119]
    s_add_u32 s32, s32, 24576
    v_exp_f32 v17, v165
    v_mfma_f32_16x16x32_bf16 v[120:123], v[24:27], a[248:251], v[120:123]
    s_add_u32 s26, s26, 36864
    ds_read_b128 v[44:47], v3 offset:18688
    v_cvt_pk_bf16_f32 v163, v18, v19
    v_mfma_f32_16x16x32_bf16 v[120:123], v[28:31], a[252:255], v[120:123]
    s_waitcnt lgkmcnt(2)
    v_exp_f32 v18, v166
    v_mfma_f32_16x16x32_bf16 v[124:127], v[24:27], v[208:211], v[124:127]
    s_waitcnt vmcnt(6)
    v_add_f32 v6, v6, v16
    v_add_f32 v6, v6, v17
    v_mfma_f32_16x16x32_bf16 v[124:127], v[28:31], v[212:215], v[124:127]
    s_barrier
    s_sub_u32 s57, s26, 147456
    v_mfma_f32_16x16x32_bf16 v[176:179], v[32:35], a[208:211], v[176:179]
    s_min_u32 s26, s26, s57
    ds_read_b128 v[24:27], v1 offset:0
    v_add_u32 v0, 1, v0
    v_mfma_f32_16x16x32_bf16 v[176:179], v[36:39], a[212:215], v[176:179]
    buffer_store_dword v0, v13, s[20:23], 0 offen offset:32 sc1
    v_mfma_f32_16x16x32_bf16 v[180:183], v[32:35], a[232:235], v[180:183]
    v_exp_f32 v19, v167
    v_mfma_f32_16x16x32_bf16 v[180:183], v[36:39], a[236:239], v[180:183]
    v_cvt_pk_bf16_f32 v164, v16, v17
    v_cvt_f32_i32 v229, v229
    v_mfma_f32_16x16x32_bf16 v[184:187], v[32:35], v[192:195], v[184:187]
    ds_read_b128 v[28:31], v1 offset:12288
    v_fma_f32 v228, v228, v48, v50
    v_mfma_f32_16x16x32_bf16 v[184:187], v[36:39], v[196:199], v[184:187]
L_pg6:
    s_cbranch_execz L_pg10
    v_exp_f32 v16, v100
    v_mfma_f32_16x16x32_bf16 v[188:191], v[32:35], v[216:219], v[188:191]
    v_add_f32 v6, v6, v18
    v_add_f32 v6, v6, v19
    v_mfma_f32_16x16x32_bf16 v[188:191], v[36:39], v[220:223], v[188:191]
    s_waitcnt lgkmcnt(2)
    v_exp_f32 v17, v101
    v_mfma_f32_16x16x32_bf16 v[112:115], v[40:43], a[208:211], v[112:115]
    ds_read_b128 v[32:35], v1 offset:1024
    v_cvt_pk_bf16_f32 v165, v18, v19
    v_mfma_f32_16x16x32_bf16 v[112:115], v[44:47], a[212:215], v[112:115]
    v_exp_f32 v18, v102
    v_mfma_f32_16x16x32_bf16 v[116:119], v[40:43], a[232:235], v[116:119]
    v_add_f32 v6, v6, v16
    v_add_f32 v6, v6, v17
    v_mfma_f32_16x16x32_bf16 v[116:119], v[44:47], a[236:239], v[116:119]
    v_exp_f32 v19, v103
    v_mfma_f32_16x16x32_bf16 v[120:123], v[40:43], v[192:195], v[120:123]
    ds_read_b128 v[36:39], v1 offset:13312
    v_cvt_pk_bf16_f32 v166, v16, v17
    v_mfma_f32_16x16x32_bf16 v[120:123], v[44:47], v[196:199], v[120:123]
    v_add_f32 v6, v6, v18
    v_add_f32 v6, v6, v19
    v_mfma_f32_16x16x32_bf16 v[124:127], v[40:43], v[216:219], v[124:127]
    v_cvt_pk_bf16_f32 v167, v18, v19
    v_mfma_f32_16x16x32_bf16 v[124:127], v[44:47], v[220:223], v[124:127]
    s_waitcnt lgkmcnt(2)
    v_mfma_f32_16x16x32_bf16 a[0:3], v[64:67], v[24:27], a[0:3]
    s_mov_b32 m0, s26
    ds_read_b128 v[40:43], v1 offset:2048
    v_fma_f32 v229, v229, v49, v51
    v_mfma_f32_16x16x32_bf16 a[0:3], v[80:83], v[28:31], a[0:3]
    buffer_load_dwordx2 v[60:61], v10, s[72:75], s36 offen offset:192
    v_mfma_f32_16x16x32_bf16 a[48:51], v[68:71], v[24:27], a[48:51]
    v_exp_f32 v16, v168
    v_mfma_f32_16x16x32_bf16 a[48:51], v[84:87], v[28:31], a[48:51]
    v_exp_f32 v17, v169
    v_mfma_f32_16x16x32_bf16 a[96:99], v[72:75], v[24:27], a[96:99]
    ds_read_b128 v[44:47], v1 offset:14336
    v_cvt_pk_bf16_f32 v228, v228, v229
    v_mfma_f32_16x16x32_bf16 a[96:99], v[88:91], v[28:31], a[96:99]
    buffer_load_dwordx4 v4, s[4:7], s32 offen offset:0 sc1 lds
    v_mfma_f32_16x16x32_bf16 a[144:147], v[76:79], v[24:27], a[144:147]
    v_exp_f32 v18, v170
    v_mfma_f32_16x16x32_bf16 a[144:147], v[92:95], v[28:31], a[144:147]
    s_waitcnt lgkmcnt(2)
    v_add_f32 v7, v7, v16
    v_add_f32 v7, v7, v17
    v_mfma_f32_16x16x32_bf16 a[4:7], v[64:67], v[32:35], a[4:7]
    ds_read_b128 v[24:27], v1 offset:3072
    v_cvt_f32_i32 v232, v232
    v_mfma_f32_16x16x32_bf16 a[4:7], v[80:83], v[36:39], a[4:7]
    buffer_load_dwordx2 v[62:63], v10, s[76:79], s36 offen offset:192
    v_mfma_f32_16x16x32_bf16 a[52:55], v[68:71], v[32:35], a[52:55]
    v_exp_f32 v19, v171
    v_mfma_f32_16x16x32_bf16 a[52:55], v[84:87], v[36:39], a[52:55]
    v_cvt_pk_bf16_f32 v168, v16, v17
    v_cvt_f32_i32 v233, v233
    v_mfma_f32_16x16x32_bf16 a[100:103], v[72:75], v[32:35], a[100:103]
    ds_read_b128 v[28:31], v1 offset:15360
    v_fma_f32 v232, v232, v48, v50
    v_mfma_f32_16x16x32_bf16 a[100:103], v[88:91], v[36:39], a[100:103]
    buffer_load_dwordx4 v[240:243], v9, s[64:67], s33 offen offset:384 nt
    v_mfma_f32_16x16x32_bf16 a[148:151], v[76:79], v[32:35], a[148:151]
    v_exp_f32 v16, v104
    v_mfma_f32_16x16x32_bf16 a[148:151], v[92:95], v[36:39], a[148:151]
    s_waitcnt lgkmcnt(2)
    v_add_f32 v7, v7, v18
    v_add_f32 v7, v7, v19
    v_mfma_f32_16x16x32_bf16 a[8:11], v[64:67], v[40:43], a[8:11]
    ds_read_b128 v[32:35], v1 offset:4096
    v_fma_f32 v233, v233, v49, v51
    v_mfma_f32_16x16x32_bf16 a[8:11], v[80:83], v[44:47], a[8:11]
    buffer_load_dwordx4 v4, s[4:7], s32 offen offset:1024 sc1 lds
    v_mfma_f32_16x16x32_bf16 a[56:59], v[68:71], v[40:43], a[56:59]
    v_exp_f32 v17, v105
    v_mfma_f32_16x16x32_bf16 a[56:59], v[84:87], v[44:47], a[56:59]
    v_cvt_pk_bf16_f32 v169, v18, v19
    v_cvt_pk_bf16_f32 v232, v232, v233
    v_mfma_f32_16x16x32_bf16 a[104:107], v[72:75], v[40:43], a[104:107]
    ds_read_b128 v[36:39], v1 offset:16384
    v_cvt_f32_i32 v236, v236
    v_mfma_f32_16x16x32_bf16 a[104:107], v[88:91], v[44:47], a[104:107]
    buffer_load_dwordx4 v[244:247], v9, s[64:67], s33 offen offset:1920 nt
    v_mfma_f32_16x16x32_bf16 a[152:155], v[76:79], v[40:43], a[152:155]
    v_exp_f32 v18, v106
    v_mfma_f32_16x16x32_bf16 a[152:155], v[92:95], v[44:47], a[152:155]
    s_waitcnt lgkmcnt(2)
    v_add_f32 v7, v7, v16
    v_add_f32 v7, v7, v17
    v_mfma_f32_16x16x32_bf16 a[12:15], v[64:67], v[24:27], a[12:15]
    ds_read_b128 v[40:43], v1 offset:5120
    v_cvt_f32_i32 v237, v237
    v_mfma_f32_16x16x32_bf16 a[12:15], v[80:83], v[28:31], a[12:15]
    buffer_load_dwordx4 v4, s[4:7], s32 offen offset:2048 sc1 lds
    v_mfma_f32_16x16x32_bf16 a[60:63], v[68:71], v[24:27], a[60:63]
    v_exp_f32 v19, v107
    v_mfma_f32_16x16x32_bf16 a[60:63], v[84:87], v[28:31], a[60:63]
    v_cvt_pk_bf16_f32 v170, v16, v17
    v_exp_f32 v16, v172
    v_mfma_f32_16x16x32_bf16 a[108:111], v[72:75], v[24:27], a[108:111]
    ds_read_b128 v[44:47], v1 offset:17408
    v_add_f32 v7, v7, v18
    v_mfma_f32_16x16x32_bf16 a[108:111], v[88:91], v[28:31], a[108:111]
    buffer_load_dwordx4 v[248:251], v9, s[64:67], s34 offen offset:384 nt
    v_add_f32 v7, v7, v19
    v_mfma_f32_16x16x32_bf16 a[156:159], v[76:79], v[24:27], a[156:159]
    s_add_u32 s29, s28, 49152
    v_exp_f32 v17, v173
    v_mfma_f32_16x16x32_bf16 a[156:159], v[92:95], v[28:31], a[156:159]
    s_waitcnt lgkmcnt(2)
    v_cvt_pk_bf16_f32 v171, v18, v19
    v_fma_f32 v236, v236, v48, v50
    v_mfma_f32_16x16x32_bf16 a[16:19], v[64:67], v[32:35], a[16:19]
    s_sub_u32 s3, s29, 147456
    ds_read_b128 v[24:27], v1 offset:6144
    v_fma_f32 v237, v237, v49, v51
    v_mfma_f32_16x16x32_bf16 a[16:19], v[80:83], v[36:39], a[16:19]
    s_add_u32 s32, s32, 24576
    buffer_load_dwordx4 v[252:255], v9, s[64:67], s34 offen offset:1920 nt
    v_mfma_f32_16x16x32_bf16 a[64:67], v[68:71], v[32:35], a[64:67]
    s_min_u32 s29, s29, s3
    v_exp_f32 v18, v174
    v_mfma_f32_16x16x32_bf16 a[64:67], v[84:87], v[36:39], a[64:67]
    v_add_f32 v8, v8, v16
    v_add_f32 v8, v8, v17
    v_mfma_f32_16x16x32_bf16 a[112:115], v[72:75], v[32:35], a[112:115]
    s_add_u32 s26, s26, 12288
    ds_read_b128 v[28:31], v1 offset:18432
    v_cvt_pk_bf16_f32 v236, v236, v237
    v_mfma_f32_16x16x32_bf16 a[112:115], v[88:91], v[36:39], a[112:115]
    v_exp_f32 v19, v175
    v_cvt_pk_bf16_f32 v172, v16, v17
    v_mfma_f32_16x16x32_bf16 a[160:163], v[76:79], v[32:35], a[160:163]
    v_exp_f32 v16, v108
    v_mfma_f32_16x16x32_bf16 a[160:163], v[92:95], v[36:39], a[160:163]
    s_waitcnt lgkmcnt(2)
    v_add_f32 v8, v8, v18
    v_add_f32 v8, v8, v19
    v_mfma_f32_16x16x32_bf16 a[20:23], v[64:67], v[40:43], a[20:23]
    s_sub_u32 s3, s29, s28
    ds_read_b128 v[32:35], v1 offset:7168
    v_lshlrev_b32 v48, 16, v57
    v_mfma_f32_16x16x32_bf16 a[20:23], v[80:83], v[44:47], a[20:23]
    v_exp_f32 v17, v109
    v_mfma_f32_16x16x32_bf16 a[68:71], v[68:71], v[40:43], a[68:71]
    s_mov_b32 m0, s26
    v_cvt_pk_bf16_f32 v173, v18, v19
    v_and_b32 v49, s97, v57
    v_mfma_f32_16x16x32_bf16 a[68:71], v[84:87], v[44:47], a[68:71]
    v_exp_f32 v18, v110
    v_mfma_f32_16x16x32_bf16 a[116:119], v[72:75], v[40:43], a[116:119]
    ds_read_b128 v[36:39], v1 offset:19456
    v_add_f32 v8, v8, v16
    v_mfma_f32_16x16x32_bf16 a[116:119], v[88:91], v[44:47], a[116:119]
    v_add_f32 v8, v8, v17
    v_mfma_f32_16x16x32_bf16 a[164:167], v[76:79], v[40:43], a[164:167]
    s_mov_b32 s28, s29
    v_exp_f32 v19, v111
    v_mfma_f32_16x16x32_bf16 a[164:167], v[92:95], v[44:47], a[164:167]
    s_waitcnt lgkmcnt(2)
    v_cvt_pk_bf16_f32 v174, v16, v17
    v_add_f32 v8, v8, v18
    v_mfma_f32_16x16x32_bf16 a[24:27], v[64:67], v[24:27], a[24:27]
    ds_read_b128 v[40:43], v1 offset:8192
    v_add_f32 v8, v8, v19
    v_mfma_f32_16x16x32_bf16 a[24:27], v[80:83], v[28:31], a[24:27]
    v_cvt_pk_bf16_f32 v175, v18, v19
    v_lshlrev_b32 v50, 16, v59
    v_mfma_f32_16x16x32_bf16 a[72:75], v[68:71], v[24:27], a[72:75]
    v_exp_f32 v16, v176
    v_mfma_f32_16x16x32_bf16 a[72:75], v[84:87], v[28:31], a[72:75]
    buffer_load_dwordx4 v4, s[4:7], s32 offen offset:0 sc1 lds
    v_mfma_f32_16x16x32_bf16 a[120:123], v[72:75], v[24:27], a[120:123]
    ds_read_b128 v[44:47], v1 offset:20480
    v_and_b32 v51, s97, v59
    v_mfma_f32_16x16x32_bf16 a[120:123], v[88:91], v[28:31], a[120:123]
    v_exp_f32 v17, v177
    v_mfma_f32_16x16x32_bf16 a[168:171], v[76:79], v[24:27], a[168:171]
    v_exp_f32 v18, v178
    v_mfma_f32_16x16x32_bf16 a[168:171], v[92:95], v[28:31], a[168:171]
    s_waitcnt lgkmcnt(2)
    v_add_f32 v5, v5, v16
    v_add_f32 v5, v5, v17
    v_mfma_f32_16x16x32_bf16 a[28:31], v[64:67], v[32:35], a[28:31]
    ds_read_b128 v[24:27], v1 offset:9216
    v_mul_f32 v48, s38, v48
    v_mfma_f32_16x16x32_bf16 a[28:31], v[80:83], v[36:39], a[28:31]
    v_exp_f32 v19, v179
    v_mfma_f32_16x16x32_bf16 a[76:79], v[68:71], v[32:35], a[76:79]
    v_cvt_pk_bf16_f32 v176, v16, v17
    v_add_u32 v2, s3, v2
    v_mfma_f32_16x16x32_bf16 a[76:79], v[84:87], v[36:39], a[76:79]
    v_exp_f32 v16, v112
    v_mfma_f32_16x16x32_bf16 a[124:127], v[72:75], v[32:35], a[124:127]
    ds_read_b128 v[28:31], v1 offset:21504
    v_add_f32 v5, v5, v18
    v_mfma_f32_16x16x32_bf16 a[124:127], v[88:91], v[36:39], a[124:127]
    v_add_f32 v5, v5, v19
    v_mul_f32 v49, s38, v49
    v_mfma_f32_16x16x32_bf16 a[172:175], v[76:79], v[32:35], a[172:175]
    v_exp_f32 v17, v113
    v_mfma_f32_16x16x32_bf16 a[172:175], v[92:95], v[36:39], a[172:175]
    s_waitcnt lgkmcnt(2)
    buffer_load_dwordx4 v4, s[4:7], s32 offen offset:1024 sc1 lds
    v_mfma_f32_16x16x32_bf16 a[32:35], v[64:67], v[40:43], a[32:35]
    ds_read_b128 v[32:35], v1 offset:10240
    v_cvt_pk_bf16_f32 v177, v18, v19
    v_mfma_f32_16x16x32_bf16 a[32:35], v[80:83], v[44:47], a[32:35]
    v_exp_f32 v18, v114
    v_mfma_f32_16x16x32_bf16 a[80:83], v[68:71], v[40:43], a[80:83]
    v_add_f32 v5, v5, v16
    v_add_f32 v5, v5, v17
    v_mfma_f32_16x16x32_bf16 a[80:83], v[84:87], v[44:47], a[80:83]
    v_exp_f32 v19, v115
    v_mfma_f32_16x16x32_bf16 a[128:131], v[72:75], v[40:43], a[128:131]
    ds_read_b128 v[36:39], v1 offset:22528
    v_mul_f32_e64 v50, -v50, v48
    v_mfma_f32_16x16x32_bf16 a[128:131], v[88:91], v[44:47], a[128:131]
    v_cvt_pk_bf16_f32 v178, v16, v17
    v_mul_f32_e64 v51, -v51, v49
    v_mfma_f32_16x16x32_bf16 a[176:179], v[76:79], v[40:43], a[176:179]
    v_exp_f32 v16, v180
    v_mfma_f32_16x16x32_bf16 a[176:179], v[92:95], v[44:47], a[176:179]
    s_waitcnt lgkmcnt(2)
    v_add_f32 v5, v5, v18
    v_add_u32 v3, s3, v3
    v_mfma_f32_16x16x32_bf16 a[36:39], v[64:67], v[24:27], a[36:39]
    ds_read_b128 v[40:43], v1 offset:11264
    v_add_f32 v5, v5, v19
    v_mfma_f32_16x16x32_bf16 a[36:39], v[80:83], v[28:31], a[36:39]
    buffer_load_dwordx4 v4, s[4:7], s32 offen offset:2048 sc1 lds
    v_mfma_f32_16x16x32_bf16 a[84:87], v[68:71], v[24:27], a[84:87]
    v_exp_f32 v17, v181
    v_mfma_f32_16x16x32_bf16 a[84:87], v[84:87], v[28:31], a[84:87]
    v_cvt_pk_bf16_f32 v179, v18, v19
    v_cvt_f32_i32 v226, v226
    v_mfma_f32_16x16x32_bf16 a[132:135], v[72:75], v[24:27], a[132:135]
    ds_read_b128 v[44:47], v1 offset:23552
    v_cvt_f32_i32 v227, v227
    v_mfma_f32_16x16x32_bf16 a[132:135], v[88:91], v[28:31], a[132:135]
    s_waitcnt lgkmcnt(2)
    v_exp_f32 v18, v182
    v_mfma_f32_16x16x32_bf16 a[180:183], v[76:79], v[24:27], a[180:183]
    s_waitcnt vmcnt(13)
    v_add_f32 v6, v6, v16
    v_add_f32 v6, v6, v17
    v_mfma_f32_16x16x32_bf16 a[180:183], v[92:95], v[28:31], a[180:183]
    s_barrier
    v_fma_f32 v226, v226, v48, v50
    v_mfma_f32_16x16x32_bf16 a[40:43], v[64:67], v[32:35], a[40:43]
    ds_read_b128 v[24:27], v2 offset:0
    v_fma_f32 v227, v227, v49, v51
    v_mfma_f32_16x16x32_bf16 a[40:43], v[80:83], v[36:39], a[40:43]
    v_exp_f32 v19, v183
    v_mfma_f32_16x16x32_bf16 a[88:91], v[68:71], v[32:35], a[88:91]
    v_cvt_pk_bf16_f32 v180, v16, v17
    v_mfma_f32_16x16x32_bf16 a[88:91], v[84:87], v[36:39], a[88:91]
    v_exp_f32 v16, v116
    v_mfma_f32_16x16x32_bf16 a[136:139], v[72:75], v[32:35], a[136:139]
    ds_read_b128 v[28:31], v3 offset:0
    v_add_f32 v6, v6, v18
    v_mfma_f32_16x16x32_bf16 a[136:139], v[88:91], v[36:39], a[136:139]
    v_add_f32 v6, v6, v19
    v_cvt_pk_bf16_f32 v225, v226, v227
    v_mfma_f32_16x16x32_bf16 a[184:187], v[76:79], v[32:35], a[184:187]
    v_exp_f32 v17, v117
    v_mfma_f32_16x16x32_bf16 a[184:187], v[92:95], v[36:39], a[184:187]
    s_waitcnt lgkmcnt(2)
    v_cvt_pk_bf16_f32 v181, v18, v19
    v_cvt_f32_i32 v230, v230
    v_mfma_f32_16x16x32_bf16 a[44:47], v[64:67], v[40:43], a[44:47]
    ds_read_b128 v[32:35], v2 offset:6144
    v_mfma_f32_16x16x32_bf16 a[44:47], v[80:83], v[44:47], a[44:47]
    v_exp_f32 v18, v118
    v_mfma_f32_16x16x32_bf16 a[92:95], v[68:71], v[40:43], a[92:95]
    v_add_f32 v6, v6, v16
    v_add_f32 v6, v6, v17
    v_mfma_f32_16x16x32_bf16 a[92:95], v[84:87], v[44:47], a[92:95]
    s_add_u32 s32, s32, 24576
    v_exp_f32 v19, v119
    v_mfma_f32_16x16x32_bf16 a[140:143], v[72:75], v[40:43], a[140:143]
    s_add_u32 s26, s26, 36864
    ds_read_b128 v[36:39], v3 offset:6144
    v_cvt_pk_bf16_f32 v182, v16, v17
    v_mfma_f32_16x16x32_bf16 a[140:143], v[88:91], v[44:47], a[140:143]
    s_sub_u32 s57, s26, 147456
    v_add_f32 v6, v6, v18
    v_add_f32 v6, v6, v19
    v_mfma_f32_16x16x32_bf16 a[188:191], v[76:79], v[40:43], a[188:191]
    s_min_u32 s26, s26, s57
    v_cvt_pk_bf16_f32 v183, v18, v19
    v_mfma_f32_16x16x32_bf16 a[188:191], v[92:95], v[44:47], a[188:191]
    s_waitcnt lgkmcnt(2)
    v_mfma_f32_16x16x32_bf16 v[64:67], v[24:27], a[192:195], v[128:131]
    ds_read_b128 v[40:43], v2 offset:128
    v_cvt_f32_i32 v231, v231
    v_mfma_f32_16x16x32_bf16 v[64:67], v[28:31], a[196:199], v[64:67]
    v_exp_f32 v16, v184
    v_mfma_f32_16x16x32_bf16 v[68:71], v[24:27], a[216:219], v[132:135]
    v_exp_f32 v17, v185
    v_mfma_f32_16x16x32_bf16 v[68:71], v[28:31], a[220:223], v[68:71]
    v_bfe_u32 v53, v4, 4, 6
    v_fma_f32 v230, v230, v48, v50
    v_mfma_f32_16x16x32_bf16 v[72:75], v[24:27], a[240:243], v[136:139]
    ds_read_b128 v[44:47], v3 offset:128
    v_lshlrev_b32 v53, 2, v53
    v_mfma_f32_16x16x32_bf16 v[72:75], v[28:31], a[244:247], v[72:75]
    buffer_load_dword v52, v53, s[20:23], s44 offen sc1
    v_mfma_f32_16x16x32_bf16 v[76:79], v[24:27], v[200:203], v[140:143]
    v_exp_f32 v18, v186
    v_mfma_f32_16x16x32_bf16 v[76:79], v[28:31], v[204:207], v[76:79]
    s_waitcnt lgkmcnt(2)
    v_add_f32 v7, v7, v16
    v_add_f32 v7, v7, v17
    v_mfma_f32_16x16x32_bf16 v[96:99], v[32:35], a[192:195], v[128:131]
    ds_read_b128 v[24:27], v2 offset:6272
    v_fma_f32 v231, v231, v49, v51
    v_mfma_f32_16x16x32_bf16 v[96:99], v[36:39], a[196:199], v[96:99]
    v_exp_f32 v19, v187
    v_mfma_f32_16x16x32_bf16 v[100:103], v[32:35], a[216:219], v[132:135]
    v_cvt_pk_bf16_f32 v184, v16, v17
    v_cvt_pk_bf16_f32 v229, v230, v231
    v_mfma_f32_16x16x32_bf16 v[100:103], v[36:39], a[220:223], v[100:103]
    s_add_u32 s35, s35, 196608
    v_exp_f32 v16, v120
    v_mfma_f32_16x16x32_bf16 v[104:107], v[32:35], a[240:243], v[136:139]
    s_mov_b32 m0, s26
    ds_read_b128 v[28:31], v3 offset:6272
    v_add_f32 v7, v7, v18
    v_mfma_f32_16x16x32_bf16 v[104:107], v[36:39], a[244:247], v[104:107]
    s_add_u32 s16, s16, 196608
    buffer_load_dwordx4 v4, s[4:7], s32 offen offset:0 sc1 lds
    v_mfma_f32_16x16x32_bf16 v[108:111], v[32:35], v[200:203], v[140:143]
    s_add_u32 s17, s17, 196608
    v_add_f32 v7, v7, v19
    v_cvt_f32_i32 v234, v234
    v_mfma_f32_16x16x32_bf16 v[108:111], v[36:39], v[204:207], v[108:111]
    s_waitcnt lgkmcnt(2)
    v_exp_f32 v17, v121
    v_mfma_f32_16x16x32_bf16 v[64:67], v[40:43], a[200:203], v[64:67]
    s_add_u32 s37, s37, 512
    ds_read_b128 v[32:35], v2 offset:256
    v_cvt_pk_bf16_f32 v185, v18, v19
    v_mfma_f32_16x16x32_bf16 v[64:67], v[44:47], a[204:207], v[64:67]
    v_exp_f32 v18, v122
    v_mfma_f32_16x16x32_bf16 v[68:71], v[40:43], a[224:227], v[68:71]
    v_add_f32 v7, v7, v16
    v_add_f32 v7, v7, v17
    v_mfma_f32_16x16x32_bf16 v[68:71], v[44:47], a[228:231], v[68:71]
    v_exp_f32 v19, v123
    v_mfma_f32_16x16x32_bf16 v[72:75], v[40:43], a[248:251], v[72:75]
    ds_read_b128 v[36:39], v3 offset:256
    v_cvt_pk_bf16_f32 v186, v16, v17
    v_mfma_f32_16x16x32_bf16 v[72:75], v[44:47], a[252:255], v[72:75]
    buffer_load_dwordx4 v4, s[4:7], s32 offen offset:1024 sc1 lds
    v_mfma_f32_16x16x32_bf16 v[76:79], v[40:43], v[208:211], v[76:79]
    v_exp_f32 v16, v188
    v_mfma_f32_16x16x32_bf16 v[76:79], v[44:47], v[212:215], v[76:79]
    s_waitcnt lgkmcnt(2)
    v_add_f32 v7, v7, v18
    v_cvt_f32_i32 v235, v235
    v_mfma_f32_16x16x32_bf16 v[96:99], v[24:27], a[200:203], v[96:99]
    ds_read_b128 v[40:43], v2 offset:6400
    v_add_f32 v7, v7, v19
    v_mfma_f32_16x16x32_bf16 v[96:99], v[28:31], a[204:207], v[96:99]
    buffer_load_dwordx2 v[56:57], off, s[80:83], s37 offset:0
    v_mfma_f32_16x16x32_bf16 v[100:103], v[24:27], a[224:227], v[100:103]
    v_exp_f32 v17, v189
    v_mfma_f32_16x16x32_bf16 v[100:103], v[28:31], a[228:231], v[100:103]
    v_cvt_pk_bf16_f32 v187, v18, v19
    v_fma_f32 v234, v234, v48, v50
    v_mfma_f32_16x16x32_bf16 v[104:107], v[24:27], a[248:251], v[104:107]
    ds_read_b128 v[44:47], v3 offset:6400
    v_fma_f32 v235, v235, v49, v51
    v_mfma_f32_16x16x32_bf16 v[104:107], v[28:31], a[252:255], v[104:107]
    buffer_load_dwordx2 v[58:59], off, s[84:87], s37 offset:0
    v_mfma_f32_16x16x32_bf16 v[108:111], v[24:27], v[208:211], v[108:111]
    s_add_u32 s29, s30, 49152
    v_exp_f32 v18, v190
    v_mfma_f32_16x16x32_bf16 v[108:111], v[28:31], v[212:215], v[108:111]
    s_waitcnt lgkmcnt(2)
    v_add_f32 v8, v8, v16
    v_add_f32 v8, v8, v17
    v_mfma_f32_16x16x32_bf16 v[64:67], v[32:35], a[208:211], v[64:67]
    s_sub_u32 s3, s29, 147456
    ds_read_b128 v[24:27], v2 offset:12288
    v_cvt_pk_bf16_f32 v233, v234, v235
    v_mfma_f32_16x16x32_bf16 v[64:67], v[36:39], a[212:215], v[64:67]
    s_min_u32 s29, s29, s3
    buffer_load_dwordx4 v4, s[4:7], s32 offen offset:2048 sc1 lds
    v_mfma_f32_16x16x32_bf16 v[68:71], v[32:35], a[232:235], v[68:71]
    v_exp_f32 v19, v191
    v_mfma_f32_16x16x32_bf16 v[68:71], v[36:39], a[236:239], v[68:71]
    v_cvt_pk_bf16_f32 v188, v16, v17
    v_cvt_f32_i32 v238, v238
    v_mfma_f32_16x16x32_bf16 v[72:75], v[32:35], v[192:195], v[72:75]
    ds_read_b128 v[28:31], v3 offset:12288
    v_mfma_f32_16x16x32_bf16 v[72:75], v[36:39], v[196:199], v[72:75]
    buffer_load_dwordx4 v[144:147], v12, s[68:71], s35 offen offset:0 nt
    v_mfma_f32_16x16x32_bf16 v[76:79], v[32:35], v[216:219], v[76:79]
    v_exp_f32 v16, v124
    v_mfma_f32_16x16x32_bf16 v[76:79], v[36:39], v[220:223], v[76:79]
    s_waitcnt lgkmcnt(2)
    v_add_f32 v8, v8, v18
    v_add_f32 v8, v8, v19
    v_mfma_f32_16x16x32_bf16 v[96:99], v[40:43], a[208:211], v[96:99]
    s_add_u32 s32, s32, 24576
    ds_read_b128 v[32:35], v2 offset:18432
    v_cvt_f32_i32 v239, v239
    v_mfma_f32_16x16x32_bf16 v[96:99], v[44:47], a[212:215], v[96:99]
    s_sub_u32 s3, s29, s30
    v_exp_f32 v17, v125
    v_mfma_f32_16x16x32_bf16 v[100:103], v[40:43], a[232:235], v[100:103]
    v_cvt_pk_bf16_f32 v189, v18, v19
    v_fma_f32 v238, v238, v48, v50
    v_mfma_f32_16x16x32_bf16 v[100:103], v[44:47], a[236:239], v[100:103]
    v_exp_f32 v18, v126
    v_mfma_f32_16x16x32_bf16 v[104:107], v[40:43], v[192:195], v[104:107]
    s_add_u32 s26, s26, 12288
    ds_read_b128 v[36:39], v3 offset:18432
    v_add_f32 v8, v8, v16
    v_mfma_f32_16x16x32_bf16 v[104:107], v[44:47], v[196:199], v[104:107]
    buffer_load_dwordx4 v[148:151], v12, s[68:71], s35 offen offset:768 nt
    v_mfma_f32_16x16x32_bf16 v[108:111], v[40:43], v[216:219], v[108:111]
    v_add_f32 v8, v8, v17
    v_fma_f32 v239, v239, v49, v51
    v_mfma_f32_16x16x32_bf16 v[108:111], v[44:47], v[220:223], v[108:111]
    s_waitcnt lgkmcnt(2)
    v_exp_f32 v19, v127
    v_mfma_f32_16x16x32_bf16 v[80:83], v[24:27], a[192:195], v[128:131]
    ds_read_b128 v[40:43], v2 offset:12416
    v_cvt_pk_bf16_f32 v190, v16, v17
    v_mfma_f32_16x16x32_bf16 v[80:83], v[28:31], a[196:199], v[80:83]
    s_mov_b32 m0, s26
    v_add_f32 v8, v8, v18
    v_add_f32 v8, v8, v19
    v_mfma_f32_16x16x32_bf16 v[84:87], v[24:27], a[216:219], v[132:135]
    s_mov_b32 s30, s29
    v_cvt_pk_bf16_f32 v191, v18, v19
    v_cvt_pk_bf16_f32 v237, v238, v239
    v_mfma_f32_16x16x32_bf16 v[84:87], v[28:31], a[220:223], v[84:87]
    v_exp_f32 v16, v64
    v_mfma_f32_16x16x32_bf16 v[88:91], v[24:27], a[240:243], v[136:139]
    ds_read_b128 v[44:47], v3 offset:12416
    v_mfma_f32_16x16x32_bf16 v[88:91], v[28:31], a[244:247], v[88:91]
    buffer_load_dwordx4 v[152:155], v12, s[68:71], s35 offen offset:1536 nt
    v_mfma_f32_16x16x32_bf16 v[92:95], v[24:27], v[200:203], v[140:143]
    v_exp_f32 v17, v65
    v_mfma_f32_16x16x32_bf16 v[92:95], v[28:31], v[204:207], v[92:95]
    s_waitcnt lgkmcnt(2)
    v_exp_f32 v18, v66
    v_mfma_f32_16x16x32_bf16 v[112:115], v[32:35], a[192:195], v[128:131]
    ds_read_b128 v[24:27], v2 offset:18560
    v_add_f32 v5, v5, v16
    v_mfma_f32_16x16x32_bf16 v[112:115], v[36:39], a[196:199], v[112:115]
    buffer_load_dwordx4 v4, s[4:7], s32 offen offset:0 sc1 lds
    v_mfma_f32_16x16x32_bf16 v[116:119], v[32:35], a[216:219], v[132:135]
    v_add_f32 v5, v5, v17
    v_add_u32 v1, s3, v1
    v_mfma_f32_16x16x32_bf16 v[116:119], v[36:39], a[220:223], v[116:119]
    v_exp_f32 v19, v67
    v_mfma_f32_16x16x32_bf16 v[120:123], v[32:35], a[240:243], v[136:139]
    ds_read_b128 v[28:31], v3 offset:18560
    v_cvt_pk_bf16_f32 v64, v16, v17
    v_mfma_f32_16x16x32_bf16 v[120:123], v[36:39], a[244:247], v[120:123]
    s_waitcnt vmcnt(13)
    buffer_load_dwordx4 v[156:159], v12, s[68:71], s35 offen offset:2304 nt
    v_mfma_f32_16x16x32_bf16 v[124:127], v[32:35], v[200:203], v[140:143]
    v_exp_f32 v16, v96
    v_mfma_f32_16x16x32_bf16 v[124:127], v[36:39], v[204:207], v[124:127]
    s_waitcnt lgkmcnt(2)
    v_add_f32 v5, v5, v18
    v_add_f32 v5, v5, v19
    v_mfma_f32_16x16x32_bf16 v[80:83], v[40:43], a[200:203], v[80:83]
    ds_read_b128 v[32:35], v2 offset:12544
    v_lshlrev_b32 v48, 16, v60
    v_mfma_f32_16x16x32_bf16 v[80:83], v[44:47], a[204:207], v[80:83]
    v_exp_f32 v17, v97
    v_mfma_f32_16x16x32_bf16 v[84:87], v[40:43], a[224:227], v[84:87]
    v_cvt_pk_bf16_f32 v65, v18, v19
    v_and_b32 v49, s97, v60
    v_mfma_f32_16x16x32_bf16 v[84:87], v[44:47], a[228:231], v[84:87]
    buffer_load_dwordx4 v4, s[4:7], s32 offen offset:1024 sc1 lds
    v_mfma_f32_16x16x32_bf16 v[88:91], v[40:43], a[248:251], v[88:91]
    ds_read_b128 v[36:39], v3 offset:12544
    v_lshlrev_b32 v50, 16, v62
    v_mfma_f32_16x16x32_bf16 v[88:91], v[44:47], a[252:255], v[88:91]
    v_exp_f32 v18, v98
    v_mfma_f32_16x16x32_bf16 v[92:95], v[40:43], v[208:211], v[92:95]
    v_add_f32 v5, v5, v16
    v_add_f32 v5, v5, v17
    v_mfma_f32_16x16x32_bf16 v[92:95], v[44:47], v[212:215], v[92:95]
    s_waitcnt lgkmcnt(2)
    v_exp_f32 v19, v99
    v_mfma_f32_16x16x32_bf16 v[112:115], v[24:27], a[200:203], v[112:115]
    ds_read_b128 v[40:43], v2 offset:18688
    v_cvt_pk_bf16_f32 v66, v16, v17
    v_mfma_f32_16x16x32_bf16 v[112:115], v[28:31], a[204:207], v[112:115]
    v_exp_f32 v16, v68
    v_mfma_f32_16x16x32_bf16 v[116:119], v[24:27], a[224:227], v[116:119]
    v_add_f32 v5, v5, v18
    v_add_f32 v5, v5, v19
    v_mfma_f32_16x16x32_bf16 v[116:119], v[28:31], a[228:231], v[116:119]
    v_exp_f32 v17, v69
    v_mfma_f32_16x16x32_bf16 v[120:123], v[24:27], a[248:251], v[120:123]
    ds_read_b128 v[44:47], v3 offset:18688
    v_cvt_pk_bf16_f32 v67, v18, v19
    v_mfma_f32_16x16x32_bf16 v[120:123], v[28:31], a[252:255], v[120:123]
    s_waitcnt lgkmcnt(2)
    buffer_load_dwordx4 v4, s[4:7], s32 offen offset:2048 sc1 lds
    v_mfma_f32_16x16x32_bf16 v[124:127], v[24:27], v[208:211], v[124:127]
    s_waitcnt vmcnt(13)
    v_exp_f32 v18, v70
    v_mfma_f32_16x16x32_bf16 v[124:127], v[28:31], v[212:215], v[124:127]
    s_barrier
    v_add_f32 v6, v6, v16
    v_mfma_f32_16x16x32_bf16 v[80:83], v[32:35], a[208:211], v[80:83]
    ds_read_b128 v[24:27], v1 offset:0
    v_add_f32 v6, v6, v17
    v_mfma_f32_16x16x32_bf16 v[80:83], v[36:39], a[212:215], v[80:83]
    v_exp_f32 v19, v71
    v_mfma_f32_16x16x32_bf16 v[84:87], v[32:35], a[232:235], v[84:87]
    v_cvt_pk_bf16_f32 v68, v16, v17
    v_and_b32 v51, s97, v62
    v_mfma_f32_16x16x32_bf16 v[84:87], v[36:39], a[236:239], v[84:87]
    v_exp_f32 v16, v100
    v_mfma_f32_16x16x32_bf16 v[88:91], v[32:35], v[192:195], v[88:91]
    ds_read_b128 v[28:31], v1 offset:12288
    v_add_f32 v6, v6, v18
    v_mfma_f32_16x16x32_bf16 v[88:91], v[36:39], v[196:199], v[88:91]
    v_add_f32 v6, v6, v19
    v_mul_f32 v48, s38, v48
    v_mfma_f32_16x16x32_bf16 v[92:95], v[32:35], v[216:219], v[92:95]
    v_exp_f32 v17, v101
    v_mfma_f32_16x16x32_bf16 v[92:95], v[36:39], v[220:223], v[92:95]
    s_waitcnt lgkmcnt(2)
    v_cvt_pk_bf16_f32 v69, v18, v19
    v_mul_f32 v49, s38, v49
    v_mfma_f32_16x16x32_bf16 v[112:115], v[40:43], a[208:211], v[112:115]
    ds_read_b128 v[32:35], v1 offset:1024
    v_mul_f32_e64 v50, -v50, v48
    v_mfma_f32_16x16x32_bf16 v[112:115], v[44:47], a[212:215], v[112:115]
    v_exp_f32 v18, v102
    v_mfma_f32_16x16x32_bf16 v[116:119], v[40:43], a[232:235], v[116:119]
    v_add_f32 v6, v6, v16
    v_add_f32 v6, v6, v17
    v_mfma_f32_16x16x32_bf16 v[116:119], v[44:47], a[236:239], v[116:119]
    v_exp_f32 v19, v103
    v_mfma_f32_16x16x32_bf16 v[120:123], v[40:43], v[192:195], v[120:123]
    ds_read_b128 v[36:39], v1 offset:13312
    v_cvt_pk_bf16_f32 v70, v16, v17
    v_mfma_f32_16x16x32_bf16 v[120:123], v[44:47], v[196:199], v[120:123]
    s_add_u32 s32, s32, 24576
    v_add_f32 v6, v6, v18
    v_mul_f32_e64 v51, -v51, v49
    v_mfma_f32_16x16x32_bf16 v[124:127], v[40:43], v[216:219], v[124:127]
    s_add_u32 s26, s26, 36864
    v_add_f32 v6, v6, v19
    s_sub_u32 s57, s26, 147456
    v_mfma_f32_16x16x32_bf16 v[124:127], v[44:47], v[220:223], v[124:127]
    s_waitcnt lgkmcnt(2)
    v_cvt_pk_bf16_f32 v71, v18, v19
    s_min_u32 s26, s26, s57
    v_mfma_f32_16x16x32_bf16 a[0:3], v[160:163], v[24:27], a[0:3]
    ds_read_b128 v[40:43], v1 offset:2048
    v_cvt_f32_i32 v240, v240
    v_mfma_f32_16x16x32_bf16 a[0:3], v[176:179], v[28:31], a[0:3]
    s_waitcnt vmcnt(12)
    v_subrev_u32 v52, s92, v52
    v_cmp_lt_u32 vcc, 15, v52
    v_mfma_f32_16x16x32_bf16 a[48:51], v[164:167], v[24:27], a[48:51]
    v_exp_f32 v16, v72
    v_mfma_f32_16x16x32_bf16 a[48:51], v[180:183], v[28:31], a[48:51]
    v_exp_f32 v17, v73
    v_mfma_f32_16x16x32_bf16 a[96:99], v[168:171], v[24:27], a[96:99]
    s_and_b32 s59, vcc_lo, 0xff
    ds_read_b128 v[44:47], v1 offset:14336
    v_cvt_f32_i32 v241, v241
    v_mfma_f32_16x16x32_bf16 a[96:99], v[184:187], v[28:31], a[96:99]
    s_cbranch_scc1 L_pollslow2
L_pollok2:
    v_mfma_f32_16x16x32_bf16 a[144:147], v[172:175], v[24:27], a[144:147]
    s_add_u32 s92, s92, 1
    v_exp_f32 v18, v74
    v_mfma_f32_16x16x32_bf16 a[144:147], v[188:191], v[28:31], a[144:147]
    s_waitcnt lgkmcnt(2)
    v_add_f32 v7, v7, v16
    v_add_f32 v7, v7, v17
    v_mfma_f32_16x16x32_bf16 a[4:7], v[160:163], v[32:35], a[4:7]
    s_mov_b32 m0, s56
    ds_read_b128 v[24:27], v1 offset:3072
    v_fma_f32 v240, v240, v48, v50
    v_mfma_f32_16x16x32_bf16 a[4:7], v[176:179], v[36:39], a[4:7]
    buffer_load_dwordx4 v4, s[4:7], s27 offen offset:0 sc1 lds
    v_mfma_f32_16x16x32_bf16 a[52:55], v[164:167], v[32:35], a[52:55]
    v_exp_f32 v19, v75
    v_mfma_f32_16x16x32_bf16 a[52:55], v[180:183], v[36:39], a[52:55]
    v_cvt_pk_bf16_f32 v72, v16, v17
    v_fma_f32 v241, v241, v49, v51
    v_mfma_f32_16x16x32_bf16 a[100:103], v[168:171], v[32:35], a[100:103]
    ds_read_b128 v[28:31], v1 offset:15360
    v_cvt_pk_bf16_f32 v226, v240, v241
    v_mfma_f32_16x16x32_bf16 a[100:103], v[184:187], v[36:39], a[100:103]
    v_exp_f32 v16, v104
    v_mfma_f32_16x16x32_bf16 a[148:151], v[172:175], v[32:35], a[148:151]
    v_add_f32 v7, v7, v18
    v_add_f32 v7, v7, v19
    v_mfma_f32_16x16x32_bf16 a[148:151], v[188:191], v[36:39], a[148:151]
    s_waitcnt lgkmcnt(2)
    v_exp_f32 v17, v105
    v_mfma_f32_16x16x32_bf16 a[8:11], v[160:163], v[40:43], a[8:11]
    ds_read_b128 v[32:35], v1 offset:4096
    v_cvt_pk_bf16_f32 v73, v18, v19
    v_mfma_f32_16x16x32_bf16 a[8:11], v[176:179], v[44:47], a[8:11]
    buffer_load_dwordx4 v4, s[4:7], s27 offen offset:1024 sc1 lds
    v_mfma_f32_16x16x32_bf16 a[56:59], v[164:167], v[40:43], a[56:59]
    v_exp_f32 v18, v106
    v_mfma_f32_16x16x32_bf16 a[56:59], v[180:183], v[44:47], a[56:59]
    v_add_f32 v7, v7, v16
    v_cvt_f32_i32 v244, v244
    v_mfma_f32_16x16x32_bf16 a[104:107], v[168:171], v[40:43], a[104:107]
    ds_read_b128 v[36:39], v1 offset:16384
    v_add_f32 v7, v7, v17
    v_mfma_f32_16x16x32_bf16 a[104:107], v[184:187], v[44:47], a[104:107]
    v_exp_f32 v19, v107
    v_mfma_f32_16x16x32_bf16 a[152:155], v[172:175], v[40:43], a[152:155]
    v_cvt_f32_i32 v245, v245
    v_cvt_pk_bf16_f32 v74, v16, v17
    v_mfma_f32_16x16x32_bf16 a[152:155], v[188:191], v[44:47], a[152:155]
L_pg7:
    s_cbranch_execz L_iwret
    s_waitcnt lgkmcnt(2)
    v_exp_f32 v16, v76
    v_mfma_f32_16x16x32_bf16 a[12:15], v[160:163], v[24:27], a[12:15]
    ds_read_b128 v[40:43], v1 offset:5120
    v_fma_f32 v244, v244, v48, v50
    v_mfma_f32_16x16x32_bf16 a[12:15], v[176:179], v[28:31], a[12:15]
    buffer_load_dwordx4 v4, s[4:7], s27 offen offset:2048 sc1 lds
    v_mfma_f32_16x16x32_bf16 a[60:63], v[164:167], v[24:27], a[60:63]
    v_add_f32 v7, v7, v18
    v_add_f32 v7, v7, v19
    v_mfma_f32_16x16x32_bf16 a[60:63], v[180:183], v[28:31], a[60:63]
    v_exp_f32 v17, v77
    v_mfma_f32_16x16x32_bf16 a[108:111], v[168:171], v[24:27], a[108:111]
    ds_read_b128 v[44:47], v1 offset:17408
    v_fma_f32 v245, v245, v49, v51
    v_mfma_f32_16x16x32_bf16 a[108:111], v[184:187], v[28:31], a[108:111]
    v_cvt_pk_bf16_f32 v75, v18, v19
    v_cvt_pk_bf16_f32 v230, v244, v245
    v_mfma_f32_16x16x32_bf16 a[156:159], v[172:175], v[24:27], a[156:159]
    s_add_u32 s29, s28, 49152
    v_exp_f32 v18, v78
    v_mfma_f32_16x16x32_bf16 a[156:159], v[188:191], v[28:31], a[156:159]
    s_waitcnt lgkmcnt(2)
    v_add_f32 v8, v8, v16
    v_cvt_f32_i32 v248, v248
    v_mfma_f32_16x16x32_bf16 a[16:19], v[160:163], v[32:35], a[16:19]
    s_sub_u32 s3, s29, 147456
    ds_read_b128 v[24:27], v1 offset:6144
    v_add_f32 v8, v8, v17
    v_mfma_f32_16x16x32_bf16 a[16:19], v[176:179], v[36:39], a[16:19]
    s_add_u32 s27, s27, 24576
    v_exp_f32 v19, v79
    v_mfma_f32_16x16x32_bf16 a[64:67], v[164:167], v[32:35], a[64:67]
    s_min_u32 s29, s29, s3
    v_cvt_f32_i32 v249, v249
    v_cvt_pk_bf16_f32 v76, v16, v17
    v_mfma_f32_16x16x32_bf16 a[64:67], v[180:183], v[36:39], a[64:67]
    s_add_u32 s56, s56, 12288
    v_exp_f32 v16, v108
    v_mfma_f32_16x16x32_bf16 a[112:115], v[168:171], v[32:35], a[112:115]
    ds_read_b128 v[28:31], v1 offset:18432
    v_fma_f32 v248, v248, v48, v50
    v_mfma_f32_16x16x32_bf16 a[112:115], v[184:187], v[36:39], a[112:115]
    v_add_f32 v8, v8, v18
    v_fma_f32 v249, v249, v49, v51
    v_mfma_f32_16x16x32_bf16 a[160:163], v[172:175], v[32:35], a[160:163]
    v_add_f32 v8, v8, v19
    v_cvt_pk_bf16_f32 v234, v248, v249
    v_mfma_f32_16x16x32_bf16 a[160:163], v[188:191], v[36:39], a[160:163]
    s_waitcnt lgkmcnt(2)
    v_exp_f32 v17, v109
    v_mfma_f32_16x16x32_bf16 a[20:23], v[160:163], v[40:43], a[20:23]
    s_mov_b32 m0, s56
    ds_read_b128 v[32:35], v1 offset:7168
    v_cvt_pk_bf16_f32 v77, v18, v19
    v_mfma_f32_16x16x32_bf16 a[20:23], v[176:179], v[44:47], a[20:23]
    s_sub_u32 s3, s29, s28
    v_exp_f32 v18, v110
    v_mfma_f32_16x16x32_bf16 a[68:71], v[164:167], v[40:43], a[68:71]
    v_cvt_f32_i32 v252, v252
    v_add_f32 v8, v8, v16
    v_mfma_f32_16x16x32_bf16 a[68:71], v[180:183], v[44:47], a[68:71]
    v_add_f32 v8, v8, v17
    v_cvt_f32_i32 v253, v253
    v_mfma_f32_16x16x32_bf16 a[116:119], v[168:171], v[40:43], a[116:119]
    ds_read_b128 v[36:39], v1 offset:19456
    v_fma_f32 v252, v252, v48, v50
    v_mfma_f32_16x16x32_bf16 a[116:119], v[184:187], v[44:47], a[116:119]
    buffer_load_dwordx4 v4, s[4:7], s27 offen offset:0 sc1 lds
    v_mfma_f32_16x16x32_bf16 a[164:167], v[172:175], v[40:43], a[164:167]
    s_mov_b32 s28, s29
    v_exp_f32 v19, v111
    v_mfma_f32_16x16x32_bf16 a[164:167], v[188:191], v[44:47], a[164:167]
    s_waitcnt lgkmcnt(2)
    v_cvt_pk_bf16_f32 v78, v16, v17
    v_add_f32 v8, v8, v18
    v_mfma_f32_16x16x32_bf16 a[24:27], v[160:163], v[24:27], a[24:27]
    ds_read_b128 v[40:43], v1 offset:8192
    v_add_f32 v8, v8, v19
    v_mfma_f32_16x16x32_bf16 a[24:27], v[176:179], v[28:31], a[24:27]
    v_cvt_pk_bf16_f32 v79, v18, v19
    v_fma_f32 v253, v253, v49, v51
    v_mfma_f32_16x16x32_bf16 a[72:75], v[164:167], v[24:27], a[72:75]
    v_exp_f32 v16, v80
    v_mfma_f32_16x16x32_bf16 a[72:75], v[180:183], v[28:31], a[72:75]
    v_exp_f32 v17, v81
    v_mfma_f32_16x16x32_bf16 a[120:123], v[168:171], v[24:27], a[120:123]
    ds_read_b128 v[44:47], v1 offset:20480
    v_cvt_pk_bf16_f32 v238, v252, v253
    v_mfma_f32_16x16x32_bf16 a[120:123], v[184:187], v[28:31], a[120:123]
    v_exp_f32 v18, v82
    v_mfma_f32_16x16x32_bf16 a[168:171], v[172:175], v[24:27], a[168:171]
    v_lshlrev_b32 v48, 16, v61
    v_add_f32 v5, v5, v16
    v_mfma_f32_16x16x32_bf16 a[168:171], v[188:191], v[28:31], a[168:171]
    s_waitcnt lgkmcnt(2)
    buffer_load_dwordx4 v4, s[4:7], s27 offen offset:1024 sc1 lds
    v_mfma_f32_16x16x32_bf16 a[28:31], v[160:163], v[32:35], a[28:31]
    ds_read_b128 v[24:27], v1 offset:9216
    v_add_f32 v5, v5, v17
    v_mfma_f32_16x16x32_bf16 a[28:31], v[176:179], v[36:39], a[28:31]
    v_exp_f32 v19, v83
    v_mfma_f32_16x16x32_bf16 a[76:79], v[164:167], v[32:35], a[76:79]
    v_and_b32 v49, s97, v61
    v_cvt_pk_bf16_f32 v80, v16, v17
    v_mfma_f32_16x16x32_bf16 a[76:79], v[180:183], v[36:39], a[76:79]
    v_exp_f32 v16, v112
    v_mfma_f32_16x16x32_bf16 a[124:127], v[168:171], v[32:35], a[124:127]
    ds_read_b128 v[28:31], v1 offset:21504
    v_lshlrev_b32 v50, 16, v63
    v_mfma_f32_16x16x32_bf16 a[124:127], v[184:187], v[36:39], a[124:127]
    v_add_f32 v5, v5, v18
    v_and_b32 v51, s97, v63
    v_mfma_f32_16x16x32_bf16 a[172:175], v[172:175], v[32:35], a[172:175]
    v_add_f32 v5, v5, v19
    v_mul_f32 v48, s38, v48
    v_mfma_f32_16x16x32_bf16 a[172:175], v[188:191], v[36:39], a[172:175]
    s_waitcnt lgkmcnt(2)
    buffer_load_dwordx4 v4, s[4:7], s27 offen offset:2048 sc1 lds
    v_mfma_f32_16x16x32_bf16 a[32:35], v[160:163], v[40:43], a[32:35]
    ds_read_b128 v[32:35], v1 offset:10240
    v_mul_f32 v49, s38, v49
    v_mfma_f32_16x16x32_bf16 a[32:35], v[176:179], v[44:47], a[32:35]
    v_exp_f32 v17, v113
    v_mfma_f32_16x16x32_bf16 a[80:83], v[164:167], v[40:43], a[80:83]
    v_cvt_pk_bf16_f32 v81, v18, v19
    v_mul_f32_e64 v50, -v50, v48
    v_mfma_f32_16x16x32_bf16 a[80:83], v[180:183], v[44:47], a[80:83]
    v_exp_f32 v18, v114
    v_mfma_f32_16x16x32_bf16 a[128:131], v[168:171], v[40:43], a[128:131]
    ds_read_b128 v[36:39], v1 offset:22528
    v_add_f32 v5, v5, v16
    v_mfma_f32_16x16x32_bf16 a[128:131], v[184:187], v[44:47], a[128:131]
    v_add_f32 v5, v5, v17
    v_mul_f32_e64 v51, -v51, v49
    v_mfma_f32_16x16x32_bf16 a[176:179], v[172:175], v[40:43], a[176:179]
    v_exp_f32 v19, v115
    v_mfma_f32_16x16x32_bf16 a[176:179], v[188:191], v[44:47], a[176:179]
    s_waitcnt lgkmcnt(2)
    v_cvt_pk_bf16_f32 v82, v16, v17
    v_add_u32 v2, s3, v2
    v_mfma_f32_16x16x32_bf16 a[36:39], v[160:163], v[24:27], a[36:39]
    ds_read_b128 v[40:43], v1 offset:11264
    v_cvt_f32_i32 v242, v242
    v_mfma_f32_16x16x32_bf16 a[36:39], v[176:179], v[28:31], a[36:39]
    v_exp_f32 v16, v84
    v_mfma_f32_16x16x32_bf16 a[84:87], v[164:167], v[24:27], a[84:87]
    v_add_f32 v5, v5, v18
    v_add_f32 v5, v5, v19
    v_mfma_f32_16x16x32_bf16 a[84:87], v[180:183], v[28:31], a[84:87]
    s_add_u32 s27, s27, 24576
    v_exp_f32 v17, v85
    v_mfma_f32_16x16x32_bf16 a[132:135], v[168:171], v[24:27], a[132:135]
    s_add_u32 s56, s56, 36864
    ds_read_b128 v[44:47], v1 offset:23552
    v_add_u32 v3, s3, v3
    v_mfma_f32_16x16x32_bf16 a[132:135], v[184:187], v[28:31], a[132:135]
    s_sub_u32 s58, s56, 147456
    v_cvt_pk_bf16_f32 v83, v18, v19
    v_cvt_f32_i32 v243, v243
    v_mfma_f32_16x16x32_bf16 a[180:183], v[172:175], v[24:27], a[180:183]
    v_exp_f32 v18, v86
    v_mfma_f32_16x16x32_bf16 a[180:183], v[188:191], v[28:31], a[180:183]
    s_waitcnt lgkmcnt(2)
    v_add_f32 v6, v6, v16
    v_fma_f32 v242, v242, v48, v50
    v_mfma_f32_16x16x32_bf16 a[40:43], v[160:163], v[32:35], a[40:43]
    s_min_u32 s56, s56, s58
    ds_read_b128 v[24:27], v2 offset:0
    v_add_f32 v6, v6, v17
    v_mfma_f32_16x16x32_bf16 a[40:43], v[176:179], v[36:39], a[40:43]
    v_exp_f32 v19, v87
    v_mfma_f32_16x16x32_bf16 a[88:91], v[164:167], v[32:35], a[88:91]
    v_fma_f32 v243, v243, v49, v51
    v_cvt_pk_bf16_f32 v84, v16, v17
    v_mfma_f32_16x16x32_bf16 a[88:91], v[180:183], v[36:39], a[88:91]
    v_exp_f32 v16, v116
    v_mfma_f32_16x16x32_bf16 a[136:139], v[168:171], v[32:35], a[136:139]
    ds_read_b128 v[28:31], v3 offset:0
    v_cvt_pk_bf16_f32 v227, v242, v243
    v_mfma_f32_16x16x32_bf16 a[136:139], v[184:187], v[36:39], a[136:139]
    v_add_f32 v6, v6, v18
    v_add_f32 v6, v6, v19
    v_mfma_f32_16x16x32_bf16 a[184:187], v[172:175], v[32:35], a[184:187]
    v_cvt_f32_i32 v246, v246
    v_cvt_f32_i32 v247, v247
    v_mfma_f32_16x16x32_bf16 a[184:187], v[188:191], v[36:39], a[184:187]
    s_waitcnt lgkmcnt(2)
    v_exp_f32 v17, v117
    v_mfma_f32_16x16x32_bf16 a[44:47], v[160:163], v[40:43], a[44:47]
    ds_read_b128 v[32:35], v2 offset:6144
    v_cvt_pk_bf16_f32 v85, v18, v19
    v_mfma_f32_16x16x32_bf16 a[44:47], v[176:179], v[44:47], a[44:47]
    v_exp_f32 v18, v118
    v_mfma_f32_16x16x32_bf16 a[92:95], v[164:167], v[40:43], a[92:95]
    v_fma_f32 v246, v246, v48, v50
    v_add_f32 v6, v6, v16
    v_mfma_f32_16x16x32_bf16 a[92:95], v[180:183], v[44:47], a[92:95]
    v_add_f32 v6, v6, v17
    v_fma_f32 v247, v247, v49, v51
    v_mfma_f32_16x16x32_bf16 a[140:143], v[168:171], v[40:43], a[140:143]
    s_sub_u32 s31, s31, 1
    ds_read_b128 v[36:39], v3 offset:6144
    v_cvt_pk_bf16_f32 v231, v246, v247
    v_mfma_f32_16x16x32_bf16 a[140:143], v[184:187], v[44:47], a[140:143]
    v_exp_f32 v19, v119
    v_mfma_f32_16x16x32_bf16 a[188:191], v[172:175], v[40:43], a[188:191]
    s_waitcnt lgkmcnt(2)
    s_cmp_lg_u32 s31, 0
    v_cvt_pk_bf16_f32 v86, v16, v17
    v_add_f32 v6, v6, v18
    v_add_f32 v6, v6, v19
    v_cvt_f32_i32 v250, v250
    v_cvt_pk_bf16_f32 v87, v18, v19
    v_cvt_f32_i32 v251, v251
    v_mfma_f32_16x16x32_bf16 a[188:191], v[188:191], v[44:47], a[188:191]
    s_cbranch_scc1 L_loop
    v_mfma_f32_16x16x32_bf16 v[160:163], v[24:27], a[192:195], v[128:131]
    ds_read_b128 v[40:43], v2 offset:128
    v_mfma_f32_16x16x32_bf16 v[160:163], v[28:31], a[196:199], v[160:163]
    v_exp_f32 v16, v88
    v_mfma_f32_16x16x32_bf16 v[164:167], v[24:27], a[216:219], v[132:135]
    ds_read_b128 v[44:47], v3 offset:128
    v_mfma_f32_16x16x32_bf16 v[164:167], v[28:31], a[220:223], v[164:167]
    s_waitcnt lgkmcnt(2)
    v_exp_f32 v17, v89
    v_mfma_f32_16x16x32_bf16 v[96:99], v[32:35], a[192:195], v[128:131]
    ds_read_b128 v[24:27], v2 offset:6272
    v_mfma_f32_16x16x32_bf16 v[96:99], v[36:39], a[196:199], v[96:99]
    s_waitcnt vmcnt(6)
    v_exp_f32 v18, v90
    v_mfma_f32_16x16x32_bf16 v[100:103], v[32:35], a[216:219], v[132:135]
    ds_read_b128 v[28:31], v3 offset:6272
    v_add_f32 v7, v7, v16
    v_mfma_f32_16x16x32_bf16 v[100:103], v[36:39], a[220:223], v[100:103]
    s_waitcnt lgkmcnt(2)
    s_barrier
    v_mfma_f32_16x16x32_bf16 v[160:163], v[40:43], a[200:203], v[160:163]
    s_mov_b32 m0, s26
    ds_read_b128 v[32:35], v2 offset:256
    v_add_f32 v7, v7, v17
    v_mfma_f32_16x16x32_bf16 v[160:163], v[44:47], a[204:207], v[160:163]
    buffer_load_dwordx4 v4, s[4:7], s32 offen offset:0 sc1 lds
    v_mfma_f32_16x16x32_bf16 v[164:167], v[40:43], a[224:227], v[164:167]
    ds_read_b128 v[36:39], v3 offset:256
    v_mfma_f32_16x16x32_bf16 v[164:167], v[44:47], a[228:231], v[164:167]
    s_waitcnt lgkmcnt(2)
    v_exp_f32 v19, v91
    v_mfma_f32_16x16x32_bf16 v[96:99], v[24:27], a[200:203], v[96:99]
    ds_read_b128 v[40:43], v2 offset:6400
    v_cvt_pk_bf16_f32 v88, v16, v17
    v_mfma_f32_16x16x32_bf16 v[96:99], v[28:31], a[204:207], v[96:99]
    v_exp_f32 v16, v120
    v_mfma_f32_16x16x32_bf16 v[100:103], v[24:27], a[224:227], v[100:103]
    ds_read_b128 v[44:47], v3 offset:6400
    v_add_f32 v7, v7, v18
    v_mfma_f32_16x16x32_bf16 v[100:103], v[28:31], a[228:231], v[100:103]
    s_waitcnt lgkmcnt(2)
    buffer_load_dwordx4 v4, s[4:7], s32 offen offset:1024 sc1 lds
    v_mfma_f32_16x16x32_bf16 v[160:163], v[32:35], a[208:211], v[160:163]
    ds_read_b128 v[24:27], v2 offset:12288
    v_add_f32 v7, v7, v19
    v_mfma_f32_16x16x32_bf16 v[160:163], v[36:39], a[212:215], v[160:163]
    v_exp_f32 v17, v121
    v_mfma_f32_16x16x32_bf16 v[164:167], v[32:35], a[232:235], v[164:167]
    ds_read_b128 v[28:31], v3 offset:12288
    v_cvt_pk_bf16_f32 v89, v18, v19
    v_mfma_f32_16x16x32_bf16 v[164:167], v[36:39], a[236:239], v[164:167]
    s_waitcnt lgkmcnt(2)
    v_exp_f32 v18, v122
    v_mfma_f32_16x16x32_bf16 v[96:99], v[40:43], a[208:211], v[96:99]
    ds_read_b128 v[32:35], v2 offset:18432
    v_add_f32 v7, v7, v16
    v_mfma_f32_16x16x32_bf16 v[96:99], v[44:47], a[212:215], v[96:99]
    buffer_load_dwordx4 v4, s[4:7], s32 offen offset:2048 sc1 lds
    v_mfma_f32_16x16x32_bf16 v[100:103], v[40:43], a[232:235], v[100:103]
    ds_read_b128 v[36:39], v3 offset:18432
    v_add_f32 v7, v7, v17
    v_mfma_f32_16x16x32_bf16 v[100:103], v[44:47], a[236:239], v[100:103]
    s_waitcnt lgkmcnt(2)
    v_exp_f32 v19, v123
    v_mfma_f32_16x16x32_bf16 v[168:171], v[24:27], a[192:195], v[128:131]
    ds_read_b128 v[40:43], v2 offset:12416
    v_cvt_pk_bf16_f32 v90, v16, v17
    v_mfma_f32_16x16x32_bf16 v[168:171], v[28:31], a[196:199], v[168:171]
    v_exp_f32 v16, v92
    v_mfma_f32_16x16x32_bf16 v[172:175], v[24:27], a[216:219], v[132:135]
    s_add_u32 s32, s32, 24576
    ds_read_b128 v[44:47], v3 offset:12416
    v_add_f32 v7, v7, v18
    v_mfma_f32_16x16x32_bf16 v[172:175], v[28:31], a[220:223], v[172:175]
    s_waitcnt lgkmcnt(2)
    v_add_f32 v7, v7, v19
    v_mfma_f32_16x16x32_bf16 v[104:107], v[32:35], a[192:195], v[128:131]
    ds_read_b128 v[24:27], v2 offset:18560
    v_mfma_f32_16x16x32_bf16 v[104:107], v[36:39], a[196:199], v[104:107]
    s_add_u32 s26, s26, 12288
    v_exp_f32 v17, v93
    v_mfma_f32_16x16x32_bf16 v[108:111], v[32:35], a[216:219], v[132:135]
    s_add_u32 s29, s30, 49152
    ds_read_b128 v[28:31], v3 offset:18560
    v_cvt_pk_bf16_f32 v91, v18, v19
    v_mfma_f32_16x16x32_bf16 v[108:111], v[36:39], a[220:223], v[108:111]
    s_waitcnt lgkmcnt(2)
    v_exp_f32 v18, v94
    v_mfma_f32_16x16x32_bf16 v[168:171], v[40:43], a[200:203], v[168:171]
    s_sub_u32 s3, s29, 147456
    ds_read_b128 v[32:35], v2 offset:12544
    v_add_f32 v8, v8, v16
    v_mfma_f32_16x16x32_bf16 v[168:171], v[44:47], a[204:207], v[168:171]
    s_mov_b32 m0, s26
    v_add_f32 v8, v8, v17
    s_min_u32 s29, s29, s3
    v_mfma_f32_16x16x32_bf16 v[172:175], v[40:43], a[224:227], v[172:175]
    ds_read_b128 v[36:39], v3 offset:12544
    v_mfma_f32_16x16x32_bf16 v[172:175], v[44:47], a[228:231], v[172:175]
    s_waitcnt lgkmcnt(2)
    v_exp_f32 v19, v95
    v_mfma_f32_16x16x32_bf16 v[104:107], v[24:27], a[200:203], v[104:107]
    ds_read_b128 v[40:43], v2 offset:18688
    v_cvt_pk_bf16_f32 v92, v16, v17
    v_mfma_f32_16x16x32_bf16 v[104:107], v[28:31], a[204:207], v[104:107]
    buffer_load_dwordx4 v4, s[4:7], s32 offen offset:0 sc1 lds
    v_mfma_f32_16x16x32_bf16 v[108:111], v[24:27], a[224:227], v[108:111]
    ds_read_b128 v[44:47], v3 offset:18688
    v_mfma_f32_16x16x32_bf16 v[108:111], v[28:31], a[228:231], v[108:111]
    s_waitcnt lgkmcnt(2)
    v_subrev_u32 v2, 98304, v2
    v_subrev_u32 v3, 98304, v3
    v_mfma_f32_16x16x32_bf16 v[168:171], v[32:35], a[208:211], v[168:171]
    ds_read_b128 v[24:27], v2 offset:0
    v_mfma_f32_16x16x32_bf16 v[168:171], v[36:39], a[212:215], v[168:171]
    v_exp_f32 v16, v124
    v_add_f32 v8, v8, v18
    v_mfma_f32_16x16x32_bf16 v[172:175], v[32:35], a[232:235], v[172:175]
    s_sub_u32 s3, s29, s30
    ds_read_b128 v[28:31], v3 offset:0
    v_add_f32 v8, v8, v19
    v_mfma_f32_16x16x32_bf16 v[172:175], v[36:39], a[236:239], v[172:175]
    s_waitcnt lgkmcnt(2)
    v_exp_f32 v17, v125
    v_cvt_pk_bf16_f32 v93, v18, v19
    v_mfma_f32_16x16x32_bf16 v[104:107], v[40:43], a[208:211], v[104:107]
    ds_read_b128 v[32:35], v2 offset:6144
    v_mfma_f32_16x16x32_bf16 v[104:107], v[44:47], a[212:215], v[104:107]
    buffer_load_dwordx4 v4, s[4:7], s32 offen offset:1024 sc1 lds
    v_mfma_f32_16x16x32_bf16 v[108:111], v[40:43], a[232:235], v[108:111]
    ds_read_b128 v[36:39], v3 offset:6144
    v_mfma_f32_16x16x32_bf16 v[108:111], v[44:47], a[236:239], v[108:111]
    s_waitcnt lgkmcnt(2)
    v_exp_f32 v18, v126
    v_add_f32 v8, v8, v16
    v_mfma_f32_16x16x32_bf16 v[176:179], v[24:27], a[192:195], v[128:131]
    ds_read_b128 v[40:43], v2 offset:128
    v_add_f32 v8, v8, v17
    v_mfma_f32_16x16x32_bf16 v[176:179], v[28:31], a[196:199], v[176:179]
    v_exp_f32 v19, v127
    v_cvt_pk_bf16_f32 v94, v16, v17
    v_mfma_f32_16x16x32_bf16 v[180:183], v[24:27], a[216:219], v[132:135]
    ds_read_b128 v[44:47], v3 offset:128
    v_add_f32 v8, v8, v18
    v_add_f32 v8, v8, v19
    v_cvt_pk_bf16_f32 v95, v18, v19
    v_mfma_f32_16x16x32_bf16 v[180:183], v[28:31], a[220:223], v[180:183]
    s_waitcnt lgkmcnt(2)
    buffer_load_dwordx4 v4, s[4:7], s32 offen offset:2048 sc1 lds
    v_mfma_f32_16x16x32_bf16 v[112:115], v[32:35], a[192:195], v[128:131]
    s_mov_b32 s30, s29
    ds_read_b128 v[24:27], v2 offset:6272
    v_mfma_f32_16x16x32_bf16 v[112:115], v[36:39], a[196:199], v[112:115]
    v_exp_f32 v16, v160
    v_mfma_f32_16x16x32_bf16 v[116:119], v[32:35], a[216:219], v[132:135]
    ds_read_b128 v[28:31], v3 offset:6272
    v_mfma_f32_16x16x32_bf16 v[116:119], v[36:39], a[220:223], v[116:119]
    s_waitcnt lgkmcnt(2)
    v_exp_f32 v17, v161
    v_mfma_f32_16x16x32_bf16 v[176:179], v[40:43], a[200:203], v[176:179]
    ds_read_b128 v[32:35], v2 offset:256
    v_mfma_f32_16x16x32_bf16 v[176:179], v[44:47], a[204:207], v[176:179]
    v_exp_f32 v18, v162
    v_mfma_f32_16x16x32_bf16 v[180:183], v[40:43], a[224:227], v[180:183]
    ds_read_b128 v[36:39], v3 offset:256
    v_add_f32 v5, v5, v16
    v_mfma_f32_16x16x32_bf16 v[180:183], v[44:47], a[228:231], v[180:183]
    s_waitcnt lgkmcnt(2)
    v_add_f32 v5, v5, v17
    v_add_u32 v1, s3, v1
    v_mfma_f32_16x16x32_bf16 v[112:115], v[24:27], a[200:203], v[112:115]
    ds_read_b128 v[40:43], v2 offset:6400
    v_mfma_f32_16x16x32_bf16 v[112:115], v[28:31], a[204:207], v[112:115]
    v_exp_f32 v19, v163
    v_cvt_pk_bf16_f32 v160, v16, v17
    v_mfma_f32_16x16x32_bf16 v[116:119], v[24:27], a[224:227], v[116:119]
    s_add_u32 s32, s32, 24576
    ds_read_b128 v[44:47], v3 offset:6400
    s_add_u32 s26, s26, 36864
    v_mfma_f32_16x16x32_bf16 v[116:119], v[28:31], a[228:231], v[116:119]
    s_waitcnt lgkmcnt(2)
    v_exp_f32 v16, v96
    v_mfma_f32_16x16x32_bf16 v[176:179], v[32:35], a[208:211], v[176:179]
    s_sub_u32 s57, s26, 147456
    ds_read_b128 v[24:27], v2 offset:12288
    v_add_f32 v5, v5, v18
    v_mfma_f32_16x16x32_bf16 v[176:179], v[36:39], a[212:215], v[176:179]
    s_min_u32 s26, s26, s57
    v_add_f32 v5, v5, v19
    v_mfma_f32_16x16x32_bf16 v[180:183], v[32:35], a[232:235], v[180:183]
    ds_read_b128 v[28:31], v3 offset:12288
    v_mfma_f32_16x16x32_bf16 v[180:183], v[36:39], a[236:239], v[180:183]
    s_waitcnt lgkmcnt(2)
    v_exp_f32 v17, v97
    v_cvt_pk_bf16_f32 v161, v18, v19
    v_mfma_f32_16x16x32_bf16 v[112:115], v[40:43], a[208:211], v[112:115]
    ds_read_b128 v[32:35], v2 offset:18432
    v_mfma_f32_16x16x32_bf16 v[112:115], v[44:47], a[212:215], v[112:115]
    v_exp_f32 v18, v98
    v_mfma_f32_16x16x32_bf16 v[116:119], v[40:43], a[232:235], v[116:119]
    ds_read_b128 v[36:39], v3 offset:18432
    v_add_f32 v5, v5, v16
    v_mfma_f32_16x16x32_bf16 v[116:119], v[44:47], a[236:239], v[116:119]
    s_waitcnt lgkmcnt(2)
    v_add_f32 v5, v5, v17
    v_mfma_f32_16x16x32_bf16 v[184:187], v[24:27], a[192:195], v[128:131]
    ds_read_b128 v[40:43], v2 offset:12416
    v_mfma_f32_16x16x32_bf16 v[184:187], v[28:31], a[196:199], v[184:187]
    v_exp_f32 v19, v99
    v_cvt_pk_bf16_f32 v162, v16, v17
    v_mfma_f32_16x16x32_bf16 v[188:191], v[24:27], a[216:219], v[132:135]
    ds_read_b128 v[44:47], v3 offset:12416
    v_mfma_f32_16x16x32_bf16 v[188:191], v[28:31], a[220:223], v[188:191]
    s_waitcnt lgkmcnt(2)
    v_exp_f32 v16, v164
    v_mfma_f32_16x16x32_bf16 v[120:123], v[32:35], a[192:195], v[128:131]
    ds_read_b128 v[24:27], v2 offset:18560
    v_add_f32 v5, v5, v18
    v_mfma_f32_16x16x32_bf16 v[120:123], v[36:39], a[196:199], v[120:123]
    s_waitcnt vmcnt(6)
    v_add_f32 v5, v5, v19
    v_mfma_f32_16x16x32_bf16 v[124:127], v[32:35], a[216:219], v[132:135]
    ds_read_b128 v[28:31], v3 offset:18560
    v_mfma_f32_16x16x32_bf16 v[124:127], v[36:39], a[220:223], v[124:127]
    s_waitcnt lgkmcnt(2)
    s_barrier
    v_mfma_f32_16x16x32_bf16 v[184:187], v[40:43], a[200:203], v[184:187]
    ds_read_b128 v[32:35], v2 offset:12544
    v_mfma_f32_16x16x32_bf16 v[184:187], v[44:47], a[204:207], v[184:187]
    v_exp_f32 v17, v165
    v_cvt_pk_bf16_f32 v163, v18, v19
    v_mfma_f32_16x16x32_bf16 v[188:191], v[40:43], a[224:227], v[188:191]
    ds_read_b128 v[36:39], v3 offset:12544
    v_mfma_f32_16x16x32_bf16 v[188:191], v[44:47], a[228:231], v[188:191]
    s_waitcnt lgkmcnt(2)
    v_exp_f32 v18, v166
    v_add_f32 v6, v6, v16
    v_mfma_f32_16x16x32_bf16 v[120:123], v[24:27], a[200:203], v[120:123]
    ds_read_b128 v[40:43], v2 offset:18688
    v_add_f32 v6, v6, v17
    v_mfma_f32_16x16x32_bf16 v[120:123], v[28:31], a[204:207], v[120:123]
    v_exp_f32 v19, v167
    v_cvt_pk_bf16_f32 v164, v16, v17
    v_mfma_f32_16x16x32_bf16 v[124:127], v[24:27], a[224:227], v[124:127]
    ds_read_b128 v[44:47], v3 offset:18688
    v_mfma_f32_16x16x32_bf16 v[124:127], v[28:31], a[228:231], v[124:127]
    s_waitcnt lgkmcnt(2)
    v_exp_f32 v16, v100
    v_mfma_f32_16x16x32_bf16 v[184:187], v[32:35], a[208:211], v[184:187]
    ds_read_b128 v[24:27], v1 offset:0
    v_add_f32 v6, v6, v18
    v_mfma_f32_16x16x32_bf16 v[184:187], v[36:39], a[212:215], v[184:187]
    v_add_f32 v6, v6, v19
    v_mfma_f32_16x16x32_bf16 v[188:191], v[32:35], a[232:235], v[188:191]
    ds_read_b128 v[28:31], v1 offset:12288
    v_mfma_f32_16x16x32_bf16 v[188:191], v[36:39], a[236:239], v[188:191]
    s_waitcnt lgkmcnt(2)
    v_exp_f32 v17, v101
    v_cvt_pk_bf16_f32 v165, v18, v19
    v_mfma_f32_16x16x32_bf16 v[120:123], v[40:43], a[208:211], v[120:123]
    ds_read_b128 v[32:35], v1 offset:1024
    v_mfma_f32_16x16x32_bf16 v[120:123], v[44:47], a[212:215], v[120:123]
    v_exp_f32 v18, v102
    v_mfma_f32_16x16x32_bf16 v[124:127], v[40:43], a[232:235], v[124:127]
    ds_read_b128 v[36:39], v1 offset:13312
    v_add_f32 v6, v6, v16
    v_mfma_f32_16x16x32_bf16 v[124:127], v[44:47], a[236:239], v[124:127]
    s_waitcnt lgkmcnt(2)
    v_add_f32 v6, v6, v17
    v_exp_f32 v19, v103
    v_cvt_pk_bf16_f32 v166, v16, v17
    v_add_f32 v6, v6, v18
    v_add_f32 v6, v6, v19
    v_cvt_pk_bf16_f32 v167, v18, v19
    v_mfma_f32_16x16x32_bf16 a[0:3], v[64:67], v[24:27], a[0:3]
    s_mov_b32 m0, s56
    ds_read_b128 v[40:43], v1 offset:2048
    v_bfe_u32 v57, v4, 8, 2
    v_mfma_f32_16x16x32_bf16 a[0:3], v[80:83], v[28:31], a[0:3]
    buffer_load_dwordx4 v4, s[4:7], s27 offen offset:0 sc1 lds
    v_mfma_f32_16x16x32_bf16 a[48:51], v[68:71], v[24:27], a[48:51]
    v_exp_f32 v16, v168
    v_mfma_f32_16x16x32_bf16 a[48:51], v[84:87], v[28:31], a[48:51]
    v_exp_f32 v17, v169
    v_mfma_f32_16x16x32_bf16 a[96:99], v[72:75], v[24:27], a[96:99]
    ds_read_b128 v[44:47], v1 offset:14336
    v_mul_u32_u24 v56, 1536, v57
    v_mfma_f32_16x16x32_bf16 a[96:99], v[88:91], v[28:31], a[96:99]
    buffer_load_dwordx4 v4, s[4:7], s27 offen offset:1024 sc1 lds
    v_mfma_f32_16x16x32_bf16 a[144:147], v[76:79], v[24:27], a[144:147]
    v_exp_f32 v18, v170
    v_mfma_f32_16x16x32_bf16 a[144:147], v[92:95], v[28:31], a[144:147]
    s_waitcnt lgkmcnt(2)
    v_add_f32 v5, v5, v16
    v_add_f32 v5, v5, v17
    v_mfma_f32_16x16x32_bf16 a[4:7], v[64:67], v[32:35], a[4:7]
    ds_read_b128 v[24:27], v1 offset:3072
    v_lshlrev_b32 v58, 4, v57
    v_mfma_f32_16x16x32_bf16 a[4:7], v[80:83], v[36:39], a[4:7]
    buffer_load_dwordx4 v4, s[4:7], s27 offen offset:2048 sc1 lds
    v_mfma_f32_16x16x32_bf16 a[52:55], v[68:71], v[32:35], a[52:55]
    v_exp_f32 v19, v171
    v_mfma_f32_16x16x32_bf16 a[52:55], v[84:87], v[36:39], a[52:55]
    s_add_u32 s27, s27, 24576
    v_cvt_pk_bf16_f32 v168, v16, v17
    v_bfe_u32 v57, v4, 4, 4
    v_mfma_f32_16x16x32_bf16 a[100:103], v[72:75], v[32:35], a[100:103]
    ds_read_b128 v[28:31], v1 offset:15360
    v_mfma_f32_16x16x32_bf16 a[100:103], v[88:91], v[36:39], a[100:103]
    s_add_u32 s56, s56, 12288
    v_exp_f32 v16, v104
    v_mfma_f32_16x16x32_bf16 a[148:151], v[76:79], v[32:35], a[148:151]
    v_add_f32 v5, v5, v18
    v_add_f32 v5, v5, v19
    v_mfma_f32_16x16x32_bf16 a[148:151], v[92:95], v[36:39], a[148:151]
    s_waitcnt lgkmcnt(2)
    v_exp_f32 v17, v105
    v_mfma_f32_16x16x32_bf16 a[8:11], v[64:67], v[40:43], a[8:11]
    s_mov_b32 m0, s56
    ds_read_b128 v[32:35], v1 offset:4096
    v_cvt_pk_bf16_f32 v169, v18, v19
    v_mfma_f32_16x16x32_bf16 a[8:11], v[80:83], v[44:47], a[8:11]
    v_exp_f32 v18, v106
    v_mfma_f32_16x16x32_bf16 a[56:59], v[68:71], v[40:43], a[56:59]
    v_add_f32 v5, v5, v16
    v_add_f32 v5, v5, v17
    v_mfma_f32_16x16x32_bf16 a[56:59], v[84:87], v[44:47], a[56:59]
    buffer_load_dwordx4 v4, s[4:7], s27 offen offset:0 sc1 lds
    v_mfma_f32_16x16x32_bf16 a[104:107], v[72:75], v[40:43], a[104:107]
    ds_read_b128 v[36:39], v1 offset:16384
    v_lshl_add_u32 v56, v57, 3, v56
    v_mfma_f32_16x16x32_bf16 a[104:107], v[88:91], v[44:47], a[104:107]
    v_exp_f32 v19, v107
    v_mfma_f32_16x16x32_bf16 a[152:155], v[76:79], v[40:43], a[152:155]
    v_cvt_pk_bf16_f32 v170, v16, v17
    v_mfma_f32_16x16x32_bf16 a[152:155], v[92:95], v[44:47], a[152:155]
    s_waitcnt lgkmcnt(2)
    buffer_load_dwordx4 v4, s[4:7], s27 offen offset:1024 sc1 lds
    v_mfma_f32_16x16x32_bf16 a[12:15], v[64:67], v[24:27], a[12:15]
    ds_read_b128 v[40:43], v1 offset:5120
    v_mfma_f32_16x16x32_bf16 a[12:15], v[80:83], v[28:31], a[12:15]
    v_exp_f32 v16, v172
    v_mfma_f32_16x16x32_bf16 a[60:63], v[68:71], v[24:27], a[60:63]
    v_add_f32 v5, v5, v18
    v_add_f32 v5, v5, v19
    v_mfma_f32_16x16x32_bf16 a[60:63], v[84:87], v[28:31], a[60:63]
    buffer_load_dwordx4 v4, s[4:7], s27 offen offset:2048 sc1 lds
    v_mfma_f32_16x16x32_bf16 a[108:111], v[72:75], v[24:27], a[108:111]
    ds_read_b128 v[44:47], v1 offset:17408
    v_mov_b32 v57, 1.0
    v_mfma_f32_16x16x32_bf16 a[108:111], v[88:91], v[28:31], a[108:111]
    v_exp_f32 v17, v173
    v_mfma_f32_16x16x32_bf16 a[156:159], v[76:79], v[24:27], a[156:159]
    s_add_u32 s27, s27, 24576
    v_cvt_pk_bf16_f32 v171, v18, v19
    v_mfma_f32_16x16x32_bf16 a[156:159], v[92:95], v[28:31], a[156:159]
    s_waitcnt lgkmcnt(2)
    v_exp_f32 v18, v174
    v_mfma_f32_16x16x32_bf16 a[16:19], v[64:67], v[32:35], a[16:19]
    s_add_u32 s56, s56, 36864
    ds_read_b128 v[24:27], v1 offset:6144
    v_add_f32 v6, v6, v16
    v_mfma_f32_16x16x32_bf16 a[16:19], v[80:83], v[36:39], a[16:19]
    v_add_f32 v6, v6, v17
    v_mfma_f32_16x16x32_bf16 a[64:67], v[68:71], v[32:35], a[64:67]
    s_sub_u32 s58, s56, 147456
    v_exp_f32 v19, v175
    v_mfma_f32_16x16x32_bf16 a[64:67], v[84:87], v[36:39], a[64:67]
    s_lshl_b32 s24, s95, 2
    v_cvt_pk_bf16_f32 v172, v16, v17
    v_mfma_f32_16x16x32_bf16 a[112:115], v[72:75], v[32:35], a[112:115]
    s_min_u32 s56, s56, s58
    ds_read_b128 v[28:31], v1 offset:18432
    v_mfma_f32_16x16x32_bf16 a[112:115], v[88:91], v[36:39], a[112:115]
    v_exp_f32 v16, v108
    v_mfma_f32_16x16x32_bf16 a[160:163], v[76:79], v[32:35], a[160:163]
    s_mov_b32 m0, s56
    v_add_f32 v6, v6, v18
    v_add_f32 v6, v6, v19
    v_mfma_f32_16x16x32_bf16 a[160:163], v[92:95], v[36:39], a[160:163]
    s_waitcnt lgkmcnt(2)
    v_exp_f32 v17, v109
    v_mfma_f32_16x16x32_bf16 a[20:23], v[64:67], v[40:43], a[20:23]
    ds_read_b128 v[32:35], v1 offset:7168
    v_cvt_pk_bf16_f32 v173, v18, v19
    v_mfma_f32_16x16x32_bf16 a[20:23], v[80:83], v[44:47], a[20:23]
    buffer_load_dwordx4 v4, s[4:7], s27 offen offset:0 sc1 lds
    v_mfma_f32_16x16x32_bf16 a[68:71], v[68:71], v[40:43], a[68:71]
    v_exp_f32 v18, v110
    v_mfma_f32_16x16x32_bf16 a[68:71], v[84:87], v[44:47], a[68:71]
    s_add_u32 s24, s24, s25
    v_add_f32 v6, v6, v16
    v_add_f32 v6, v6, v17
    v_mfma_f32_16x16x32_bf16 a[116:119], v[72:75], v[40:43], a[116:119]
    ds_read_b128 v[36:39], v1 offset:19456
    v_mfma_f32_16x16x32_bf16 a[116:119], v[88:91], v[44:47], a[116:119]
    buffer_load_dwordx4 v4, s[4:7], s27 offen offset:1024 sc1 lds
    v_mfma_f32_16x16x32_bf16 a[164:167], v[76:79], v[40:43], a[164:167]
    v_exp_f32 v19, v111
    v_mfma_f32_16x16x32_bf16 a[164:167], v[92:95], v[44:47], a[164:167]
    s_waitcnt lgkmcnt(2)
    v_cvt_pk_bf16_f32 v174, v16, v17
    v_add_f32 v6, v6, v18
    v_mfma_f32_16x16x32_bf16 a[24:27], v[64:67], v[24:27], a[24:27]
    ds_read_b128 v[40:43], v1 offset:8192
    v_add_f32 v6, v6, v19
    v_mfma_f32_16x16x32_bf16 a[24:27], v[80:83], v[28:31], a[24:27]
    buffer_load_dwordx4 v4, s[4:7], s27 offen offset:2048 sc1 lds
    v_mfma_f32_16x16x32_bf16 a[72:75], v[68:71], v[24:27], a[72:75]
    v_cvt_pk_bf16_f32 v175, v18, v19
    v_mfma_f32_16x16x32_bf16 a[72:75], v[84:87], v[28:31], a[72:75]
L_pg8:
    s_cbranch_execz L_iwret
    s_mul_i32 s24, s24, 24576
    v_exp_f32 v16, v176
    v_mfma_f32_16x16x32_bf16 a[120:123], v[72:75], v[24:27], a[120:123]
    ds_read_b128 v[44:47], v1 offset:20480
    v_mfma_f32_16x16x32_bf16 a[120:123], v[88:91], v[28:31], a[120:123]
    s_add_u32 s27, s27, 24576
    v_exp_f32 v17, v177
    v_mfma_f32_16x16x32_bf16 a[168:171], v[76:79], v[24:27], a[168:171]
    v_exp_f32 v18, v178
    v_mfma_f32_16x16x32_bf16 a[168:171], v[92:95], v[28:31], a[168:171]
    s_waitcnt lgkmcnt(2)
    v_add_f32 v5, v5, v16
    v_add_f32 v5, v5, v17
    v_mfma_f32_16x16x32_bf16 a[28:31], v[64:67], v[32:35], a[28:31]
    s_add_u32 s56, s56, 12288
    ds_read_b128 v[24:27], v1 offset:9216
    v_mfma_f32_16x16x32_bf16 a[28:31], v[80:83], v[36:39], a[28:31]
    s_mov_b32 m0, s56
    v_exp_f32 v19, v179
    v_mfma_f32_16x16x32_bf16 a[76:79], v[68:71], v[32:35], a[76:79]
    v_cvt_pk_bf16_f32 v176, v16, v17
    v_mfma_f32_16x16x32_bf16 a[76:79], v[84:87], v[36:39], a[76:79]
    s_add_u32 s40, s24, 6144
    v_exp_f32 v16, v112
    v_mfma_f32_16x16x32_bf16 a[124:127], v[72:75], v[32:35], a[124:127]
    ds_read_b128 v[28:31], v1 offset:21504
    v_add_f32 v5, v5, v18
    v_mfma_f32_16x16x32_bf16 a[124:127], v[88:91], v[36:39], a[124:127]
    buffer_load_dwordx4 v4, s[4:7], s27 offen offset:0 sc1 lds
    v_mfma_f32_16x16x32_bf16 a[172:175], v[76:79], v[32:35], a[172:175]
    v_add_f32 v5, v5, v19
    v_mfma_f32_16x16x32_bf16 a[172:175], v[92:95], v[36:39], a[172:175]
    s_waitcnt lgkmcnt(2)
    v_exp_f32 v17, v113
    v_mfma_f32_16x16x32_bf16 a[32:35], v[64:67], v[40:43], a[32:35]
    ds_read_b128 v[32:35], v1 offset:10240
    v_cvt_pk_bf16_f32 v177, v18, v19
    v_mfma_f32_16x16x32_bf16 a[32:35], v[80:83], v[44:47], a[32:35]
    buffer_load_dwordx4 v4, s[4:7], s27 offen offset:1024 sc1 lds
    v_mfma_f32_16x16x32_bf16 a[80:83], v[68:71], v[40:43], a[80:83]
    v_exp_f32 v18, v114
    v_mfma_f32_16x16x32_bf16 a[80:83], v[84:87], v[44:47], a[80:83]
    s_add_u32 s41, s24, 12288
    v_add_f32 v5, v5, v16
    v_add_f32 v5, v5, v17
    v_mfma_f32_16x16x32_bf16 a[128:131], v[72:75], v[40:43], a[128:131]
    ds_read_b128 v[36:39], v1 offset:22528
    v_mfma_f32_16x16x32_bf16 a[128:131], v[88:91], v[44:47], a[128:131]
    buffer_load_dwordx4 v4, s[4:7], s27 offen offset:2048 sc1 lds
    v_mfma_f32_16x16x32_bf16 a[176:179], v[76:79], v[40:43], a[176:179]
    v_exp_f32 v19, v115
    v_mfma_f32_16x16x32_bf16 a[176:179], v[92:95], v[44:47], a[176:179]
    s_waitcnt lgkmcnt(2)
    v_cvt_pk_bf16_f32 v178, v16, v17
    v_mfma_f32_16x16x32_bf16 a[36:39], v[64:67], v[24:27], a[36:39]
    ds_read_b128 v[40:43], v1 offset:11264
    v_mfma_f32_16x16x32_bf16 a[36:39], v[80:83], v[28:31], a[36:39]
    v_exp_f32 v16, v180
    v_mfma_f32_16x16x32_bf16 a[84:87], v[68:71], v[24:27], a[84:87]
    v_add_f32 v5, v5, v18
    v_add_f32 v5, v5, v19
    v_mfma_f32_16x16x32_bf16 a[84:87], v[84:87], v[28:31], a[84:87]
    s_add_u32 s27, s27, 24576
    v_exp_f32 v17, v181
    v_mfma_f32_16x16x32_bf16 a[132:135], v[72:75], v[24:27], a[132:135]
    s_add_u32 s56, s56, 36864
    ds_read_b128 v[44:47], v1 offset:23552
    v_cvt_pk_bf16_f32 v179, v18, v19
    v_mfma_f32_16x16x32_bf16 a[132:135], v[88:91], v[28:31], a[132:135]
    s_waitcnt lgkmcnt(2)
    v_exp_f32 v18, v182
    v_mfma_f32_16x16x32_bf16 a[180:183], v[76:79], v[24:27], a[180:183]
    s_waitcnt vmcnt(12)
    v_add_f32 v6, v6, v16
    v_add_f32 v6, v6, v17
    v_mfma_f32_16x16x32_bf16 a[180:183], v[92:95], v[28:31], a[180:183]
    s_barrier
    v_add_u32 v2, 49152, v2
    v_add_u32 v3, 49152, v3
    v_mfma_f32_16x16x32_bf16 a[40:43], v[64:67], v[32:35], a[40:43]
    s_sub_u32 s58, s56, 147456
    ds_read_b128 v[24:27], v2 offset:0
    s_add_u32 s42, s24, 18432
    v_mfma_f32_16x16x32_bf16 a[40:43], v[80:83], v[36:39], a[40:43]
    s_min_u32 s56, s56, s58
    v_exp_f32 v19, v183
    v_mfma_f32_16x16x32_bf16 a[88:91], v[68:71], v[32:35], a[88:91]
    v_cvt_pk_bf16_f32 v180, v16, v17
    v_mfma_f32_16x16x32_bf16 a[88:91], v[84:87], v[36:39], a[88:91]
    v_exp_f32 v16, v116
    v_mfma_f32_16x16x32_bf16 a[136:139], v[72:75], v[32:35], a[136:139]
    ds_read_b128 v[28:31], v3 offset:0
    v_add_f32 v6, v6, v18
    v_mfma_f32_16x16x32_bf16 a[136:139], v[88:91], v[36:39], a[136:139]
    v_add_f32 v6, v6, v19
    v_mfma_f32_16x16x32_bf16 a[184:187], v[76:79], v[32:35], a[184:187]
    v_exp_f32 v17, v117
    v_mfma_f32_16x16x32_bf16 a[184:187], v[92:95], v[36:39], a[184:187]
    s_waitcnt lgkmcnt(2)
    v_cvt_pk_bf16_f32 v181, v18, v19
    v_mfma_f32_16x16x32_bf16 a[44:47], v[64:67], v[40:43], a[44:47]
    ds_read_b128 v[32:35], v2 offset:6144
    v_mfma_f32_16x16x32_bf16 a[44:47], v[80:83], v[44:47], a[44:47]
    v_exp_f32 v18, v118
    v_mfma_f32_16x16x32_bf16 a[92:95], v[68:71], v[40:43], a[92:95]
    v_add_f32 v6, v6, v16
    v_add_f32 v6, v6, v17
    v_mfma_f32_16x16x32_bf16 a[92:95], v[84:87], v[44:47], a[92:95]
    v_exp_f32 v19, v119
    v_mfma_f32_16x16x32_bf16 a[140:143], v[72:75], v[40:43], a[140:143]
    ds_read_b128 v[36:39], v3 offset:6144
    v_cvt_pk_bf16_f32 v182, v16, v17
    v_mfma_f32_16x16x32_bf16 a[140:143], v[88:91], v[44:47], a[140:143]
    v_add_f32 v6, v6, v18
    v_add_f32 v6, v6, v19
    v_mfma_f32_16x16x32_bf16 a[188:191], v[76:79], v[40:43], a[188:191]
    v_cvt_pk_bf16_f32 v183, v18, v19
    v_mfma_f32_16x16x32_bf16 a[188:191], v[92:95], v[44:47], a[188:191]
    s_waitcnt lgkmcnt(2)
    v_mfma_f32_16x16x32_bf16 v[64:67], v[24:27], a[192:195], v[128:131]
    ds_read_b128 v[40:43], v2 offset:128
    v_mfma_f32_16x16x32_bf16 v[64:67], v[28:31], a[196:199], v[64:67]
    v_exp_f32 v16, v184
    v_mfma_f32_16x16x32_bf16 v[68:71], v[24:27], a[216:219], v[132:135]
    ds_read_b128 v[44:47], v3 offset:128
    v_mfma_f32_16x16x32_bf16 v[68:71], v[28:31], a[220:223], v[68:71]
    s_waitcnt lgkmcnt(2)
    v_exp_f32 v17, v185
    v_mfma_f32_16x16x32_bf16 v[96:99], v[32:35], a[192:195], v[128:131]
    ds_read_b128 v[24:27], v2 offset:6272
    v_mfma_f32_16x16x32_bf16 v[96:99], v[36:39], a[196:199], v[96:99]
    v_exp_f32 v18, v186
    v_mfma_f32_16x16x32_bf16 v[100:103], v[32:35], a[216:219], v[132:135]
    ds_read_b128 v[28:31], v3 offset:6272
    v_add_f32 v5, v5, v16
    v_mfma_f32_16x16x32_bf16 v[100:103], v[36:39], a[220:223], v[100:103]
    s_waitcnt lgkmcnt(2)
    v_add_f32 v5, v5, v17
    v_mfma_f32_16x16x32_bf16 v[64:67], v[40:43], a[200:203], v[64:67]
    ds_read_b128 v[32:35], v2 offset:256
    v_mfma_f32_16x16x32_bf16 v[64:67], v[44:47], a[204:207], v[64:67]
    v_exp_f32 v19, v187
    v_mfma_f32_16x16x32_bf16 v[68:71], v[40:43], a[224:227], v[68:71]
    ds_read_b128 v[36:39], v3 offset:256
    v_cvt_pk_bf16_f32 v184, v16, v17
    v_mfma_f32_16x16x32_bf16 v[68:71], v[44:47], a[228:231], v[68:71]
    s_waitcnt lgkmcnt(2)
    v_exp_f32 v16, v120
    v_mfma_f32_16x16x32_bf16 v[96:99], v[24:27], a[200:203], v[96:99]
    ds_read_b128 v[40:43], v2 offset:6400
    v_add_f32 v5, v5, v18
    v_mfma_f32_16x16x32_bf16 v[96:99], v[28:31], a[204:207], v[96:99]
    s_waitcnt vmcnt(0)
    v_add_f32 v5, v5, v19
    v_mfma_f32_16x16x32_bf16 v[100:103], v[24:27], a[224:227], v[100:103]
    ds_read_b128 v[44:47], v3 offset:6400
    v_mfma_f32_16x16x32_bf16 v[100:103], v[28:31], a[228:231], v[100:103]
    s_waitcnt lgkmcnt(2)
    s_barrier
    v_mfma_f32_16x16x32_bf16 v[64:67], v[32:35], a[208:211], v[64:67]
    s_mov_b32 m0, s56
    ds_read_b128 v[24:27], v2 offset:12288
    v_mfma_f32_16x16x32_bf16 v[64:67], v[36:39], a[212:215], v[64:67]
    buffer_load_dwordx4 v4, s[4:7], s27 offen offset:0 sc1 lds
    v_mfma_f32_16x16x32_bf16 v[68:71], v[32:35], a[232:235], v[68:71]
    ds_read_b128 v[28:31], v3 offset:12288
    v_mfma_f32_16x16x32_bf16 v[68:71], v[36:39], a[236:239], v[68:71]
    s_waitcnt lgkmcnt(2)
    v_exp_f32 v17, v121
    v_cvt_pk_bf16_f32 v185, v18, v19
    v_mfma_f32_16x16x32_bf16 v[96:99], v[40:43], a[208:211], v[96:99]
    ds_read_b128 v[32:35], v2 offset:18432
    v_mfma_f32_16x16x32_bf16 v[96:99], v[44:47], a[212:215], v[96:99]
    buffer_load_dwordx4 v4, s[4:7], s27 offen offset:1024 sc1 lds
    v_mfma_f32_16x16x32_bf16 v[100:103], v[40:43], a[232:235], v[100:103]
    ds_read_b128 v[36:39], v3 offset:18432
    v_mfma_f32_16x16x32_bf16 v[100:103], v[44:47], a[236:239], v[100:103]
    s_waitcnt lgkmcnt(2)
    v_exp_f32 v18, v122
    v_add_f32 v5, v5, v16
    v_mfma_f32_16x16x32_bf16 v[72:75], v[24:27], a[192:195], v[128:131]
    ds_read_b128 v[40:43], v2 offset:12416
    v_add_f32 v5, v5, v17
    v_mfma_f32_16x16x32_bf16 v[72:75], v[28:31], a[196:199], v[72:75]
    v_exp_f32 v19, v123
    v_cvt_pk_bf16_f32 v186, v16, v17
    v_mfma_f32_16x16x32_bf16 v[76:79], v[24:27], a[216:219], v[132:135]
    ds_read_b128 v[44:47], v3 offset:12416
    v_mfma_f32_16x16x32_bf16 v[76:79], v[28:31], a[220:223], v[76:79]
    s_waitcnt lgkmcnt(2)
    buffer_load_dwordx4 v4, s[4:7], s27 offen offset:2048 sc1 lds
    v_mfma_f32_16x16x32_bf16 v[104:107], v[32:35], a[192:195], v[128:131]
    ds_read_b128 v[24:27], v2 offset:18560
    v_mfma_f32_16x16x32_bf16 v[104:107], v[36:39], a[196:199], v[104:107]
    v_exp_f32 v16, v188
    v_add_f32 v5, v5, v18
    v_mfma_f32_16x16x32_bf16 v[108:111], v[32:35], a[216:219], v[132:135]
    ds_read_b128 v[28:31], v3 offset:18560
    v_add_f32 v5, v5, v19
    v_mfma_f32_16x16x32_bf16 v[108:111], v[36:39], a[220:223], v[108:111]
    s_waitcnt lgkmcnt(2)
    v_exp_f32 v17, v189
    v_cvt_pk_bf16_f32 v187, v18, v19
    v_mfma_f32_16x16x32_bf16 v[72:75], v[40:43], a[200:203], v[72:75]
    s_add_u32 s27, s27, 24576
    ds_read_b128 v[32:35], v2 offset:12544
    v_mfma_f32_16x16x32_bf16 v[72:75], v[44:47], a[204:207], v[72:75]
    v_exp_f32 v18, v190
    v_mfma_f32_16x16x32_bf16 v[76:79], v[40:43], a[224:227], v[76:79]
    s_add_u32 s56, s56, 12288
    ds_read_b128 v[36:39], v3 offset:12544
    v_add_f32 v6, v6, v16
    v_mfma_f32_16x16x32_bf16 v[76:79], v[44:47], a[228:231], v[76:79]
    s_waitcnt lgkmcnt(2)
    v_add_f32 v6, v6, v17
    v_mfma_f32_16x16x32_bf16 v[104:107], v[24:27], a[200:203], v[104:107]
    ds_read_b128 v[40:43], v2 offset:18688
    v_mfma_f32_16x16x32_bf16 v[104:107], v[28:31], a[204:207], v[104:107]
    v_exp_f32 v19, v191
    v_cvt_pk_bf16_f32 v188, v16, v17
    v_mfma_f32_16x16x32_bf16 v[108:111], v[24:27], a[224:227], v[108:111]
    s_mov_b32 m0, s56
    ds_read_b128 v[44:47], v3 offset:18688
    v_mfma_f32_16x16x32_bf16 v[108:111], v[28:31], a[228:231], v[108:111]
    s_waitcnt lgkmcnt(2)
    v_add_u32 v2, 49152, v2
    v_add_u32 v3, 49152, v3
    v_mfma_f32_16x16x32_bf16 v[72:75], v[32:35], a[208:211], v[72:75]
    ds_read_b128 v[24:27], v2 offset:0
    v_mfma_f32_16x16x32_bf16 v[72:75], v[36:39], a[212:215], v[72:75]
    buffer_load_dwordx4 v4, s[4:7], s27 offen offset:0 sc1 lds
    v_mfma_f32_16x16x32_bf16 v[76:79], v[32:35], a[232:235], v[76:79]
    ds_read_b128 v[28:31], v3 offset:0
    v_mfma_f32_16x16x32_bf16 v[76:79], v[36:39], a[236:239], v[76:79]
    s_waitcnt lgkmcnt(2)
    v_exp_f32 v16, v124
    v_add_f32 v6, v6, v18
    v_mfma_f32_16x16x32_bf16 v[104:107], v[40:43], a[208:211], v[104:107]
    ds_read_b128 v[32:35], v2 offset:6144
    v_add_f32 v6, v6, v19
    v_mfma_f32_16x16x32_bf16 v[104:107], v[44:47], a[212:215], v[104:107]
    v_exp_f32 v17, v125
    v_cvt_pk_bf16_f32 v189, v18, v19
    v_mfma_f32_16x16x32_bf16 v[108:111], v[40:43], a[232:235], v[108:111]
    ds_read_b128 v[36:39], v3 offset:6144
    v_mfma_f32_16x16x32_bf16 v[108:111], v[44:47], a[236:239], v[108:111]
    s_waitcnt lgkmcnt(2)
    buffer_load_dwordx4 v4, s[4:7], s27 offen offset:1024 sc1 lds
    v_mfma_f32_16x16x32_bf16 v[80:83], v[24:27], a[240:243], v[136:139]
    ds_read_b128 v[40:43], v2 offset:128
    v_mfma_f32_16x16x32_bf16 v[80:83], v[28:31], a[244:247], v[80:83]
    v_exp_f32 v18, v126
    v_add_f32 v6, v6, v16
    v_mfma_f32_16x16x32_bf16 v[84:87], v[24:27], v[200:203], v[140:143]
    ds_read_b128 v[44:47], v3 offset:128
    v_add_f32 v6, v6, v17
    v_exp_f32 v19, v127
    v_cvt_pk_bf16_f32 v190, v16, v17
    v_add_f32 v6, v6, v18
    v_add_f32 v6, v6, v19
    v_cvt_pk_bf16_f32 v191, v18, v19
    v_mfma_f32_16x16x32_bf16 v[84:87], v[28:31], v[204:207], v[84:87]
    s_waitcnt lgkmcnt(2)
    v_exp_f32 v16, v64
    v_mfma_f32_16x16x32_bf16 v[112:115], v[32:35], a[240:243], v[136:139]
    ds_read_b128 v[24:27], v2 offset:6272
    v_mfma_f32_16x16x32_bf16 v[112:115], v[36:39], a[244:247], v[112:115]
    buffer_load_dwordx4 v4, s[4:7], s27 offen offset:2048 sc1 lds
    v_mfma_f32_16x16x32_bf16 v[116:119], v[32:35], v[200:203], v[140:143]
    ds_read_b128 v[28:31], v3 offset:6272
    v_mfma_f32_16x16x32_bf16 v[116:119], v[36:39], v[204:207], v[116:119]
    s_waitcnt lgkmcnt(2)
    v_exp_f32 v17, v65
    v_mfma_f32_16x16x32_bf16 v[80:83], v[40:43], a[248:251], v[80:83]
    ds_read_b128 v[32:35], v2 offset:256
    v_mfma_f32_16x16x32_bf16 v[80:83], v[44:47], a[252:255], v[80:83]
    v_exp_f32 v18, v66
    v_mfma_f32_16x16x32_bf16 v[84:87], v[40:43], v[208:211], v[84:87]
    ds_read_b128 v[36:39], v3 offset:256
    v_add_f32 v5, v5, v16
    v_mfma_f32_16x16x32_bf16 v[84:87], v[44:47], v[212:215], v[84:87]
    s_waitcnt lgkmcnt(2)
    v_add_f32 v5, v5, v17
    v_mfma_f32_16x16x32_bf16 v[112:115], v[24:27], a[248:251], v[112:115]
    ds_read_b128 v[40:43], v2 offset:6400
    v_mfma_f32_16x16x32_bf16 v[112:115], v[28:31], a[252:255], v[112:115]
    v_exp_f32 v19, v67
    v_cvt_pk_bf16_f32 v64, v16, v17
    v_mfma_f32_16x16x32_bf16 v[116:119], v[24:27], v[208:211], v[116:119]
    s_add_u32 s27, s27, 24576
    ds_read_b128 v[44:47], v3 offset:6400
    s_add_u32 s56, s56, 36864
    v_mfma_f32_16x16x32_bf16 v[116:119], v[28:31], v[212:215], v[116:119]
    s_waitcnt lgkmcnt(2)
    v_exp_f32 v16, v96
    v_mfma_f32_16x16x32_bf16 v[80:83], v[32:35], v[192:195], v[80:83]
    s_sub_u32 s58, s56, 147456
    ds_read_b128 v[24:27], v2 offset:12288
    v_add_f32 v5, v5, v18
    v_mfma_f32_16x16x32_bf16 v[80:83], v[36:39], v[196:199], v[80:83]
    s_min_u32 s56, s56, s58
    v_add_f32 v5, v5, v19
    v_mfma_f32_16x16x32_bf16 v[84:87], v[32:35], v[216:219], v[84:87]
    ds_read_b128 v[28:31], v3 offset:12288
    v_mfma_f32_16x16x32_bf16 v[84:87], v[36:39], v[220:223], v[84:87]
    s_waitcnt lgkmcnt(2)
    v_exp_f32 v17, v97
    v_cvt_pk_bf16_f32 v65, v18, v19
    v_mfma_f32_16x16x32_bf16 v[112:115], v[40:43], v[192:195], v[112:115]
    ds_read_b128 v[32:35], v2 offset:18432
    v_mfma_f32_16x16x32_bf16 v[112:115], v[44:47], v[196:199], v[112:115]
    v_exp_f32 v18, v98
    v_mfma_f32_16x16x32_bf16 v[116:119], v[40:43], v[216:219], v[116:119]
    ds_read_b128 v[36:39], v3 offset:18432
    v_add_f32 v5, v5, v16
    v_mfma_f32_16x16x32_bf16 v[116:119], v[44:47], v[220:223], v[116:119]
    s_waitcnt lgkmcnt(2)
    v_add_f32 v5, v5, v17
    v_mfma_f32_16x16x32_bf16 v[88:91], v[24:27], a[240:243], v[136:139]
    ds_read_b128 v[40:43], v2 offset:12416
    v_mfma_f32_16x16x32_bf16 v[88:91], v[28:31], a[244:247], v[88:91]
    v_exp_f32 v19, v99
    v_cvt_pk_bf16_f32 v66, v16, v17
    v_mfma_f32_16x16x32_bf16 v[92:95], v[24:27], v[200:203], v[140:143]
    ds_read_b128 v[44:47], v3 offset:12416
    v_mfma_f32_16x16x32_bf16 v[92:95], v[28:31], v[204:207], v[92:95]
    s_waitcnt lgkmcnt(2)
    v_exp_f32 v16, v68
    v_mfma_f32_16x16x32_bf16 v[120:123], v[32:35], a[240:243], v[136:139]
    ds_read_b128 v[24:27], v2 offset:18560
    v_add_f32 v5, v5, v18
    v_mfma_f32_16x16x32_bf16 v[120:123], v[36:39], a[244:247], v[120:123]
    v_add_f32 v5, v5, v19
    v_mfma_f32_16x16x32_bf16 v[124:127], v[32:35], v[200:203], v[140:143]
    ds_read_b128 v[28:31], v3 offset:18560
    v_mfma_f32_16x16x32_bf16 v[124:127], v[36:39], v[204:207], v[124:127]
    s_waitcnt lgkmcnt(2)
    v_exp_f32 v17, v69
    v_cvt_pk_bf16_f32 v67, v18, v19
    v_mfma_f32_16x16x32_bf16 v[88:91], v[40:43], a[248:251], v[88:91]
    ds_read_b128 v[32:35], v2 offset:12544
    v_mfma_f32_16x16x32_bf16 v[88:91], v[44:47], a[252:255], v[88:91]
    v_exp_f32 v18, v70
    v_mfma_f32_16x16x32_bf16 v[92:95], v[40:43], v[208:211], v[92:95]
    ds_read_b128 v[36:39], v3 offset:12544
    v_add_f32 v6, v6, v16
    v_mfma_f32_16x16x32_bf16 v[92:95], v[44:47], v[212:215], v[92:95]
    s_waitcnt lgkmcnt(2)
    v_add_f32 v6, v6, v17
    v_mfma_f32_16x16x32_bf16 v[120:123], v[24:27], a[248:251], v[120:123]
    ds_read_b128 v[40:43], v2 offset:18688
    v_mfma_f32_16x16x32_bf16 v[120:123], v[28:31], a[252:255], v[120:123]
    v_exp_f32 v19, v71
    v_cvt_pk_bf16_f32 v68, v16, v17
    v_mfma_f32_16x16x32_bf16 v[124:127], v[24:27], v[208:211], v[124:127]
    ds_read_b128 v[44:47], v3 offset:18688
    v_mfma_f32_16x16x32_bf16 v[124:127], v[28:31], v[212:215], v[124:127]
    s_waitcnt lgkmcnt(2)
    v_add_u32 v1, 49152, v1
    v_exp_f32 v16, v100
    v_mfma_f32_16x16x32_bf16 v[88:91], v[32:35], v[192:195], v[88:91]
    ds_read_b128 v[24:27], v1 offset:0
    v_add_f32 v6, v6, v18
    v_mfma_f32_16x16x32_bf16 v[88:91], v[36:39], v[196:199], v[88:91]
    v_add_f32 v6, v6, v19
    v_mfma_f32_16x16x32_bf16 v[92:95], v[32:35], v[216:219], v[92:95]
    ds_read_b128 v[28:31], v1 offset:12288
    v_mfma_f32_16x16x32_bf16 v[92:95], v[36:39], v[220:223], v[92:95]
    s_waitcnt lgkmcnt(2)
    v_exp_f32 v17, v101
    v_cvt_pk_bf16_f32 v69, v18, v19
    v_mfma_f32_16x16x32_bf16 v[120:123], v[40:43], v[192:195], v[120:123]
    ds_read_b128 v[32:35], v1 offset:1024
    v_mfma_f32_16x16x32_bf16 v[120:123], v[44:47], v[196:199], v[120:123]
    v_exp_f32 v18, v102
    v_mfma_f32_16x16x32_bf16 v[124:127], v[40:43], v[216:219], v[124:127]
    ds_read_b128 v[36:39], v1 offset:13312
    v_add_f32 v6, v6, v16
    v_mfma_f32_16x16x32_bf16 v[124:127], v[44:47], v[220:223], v[124:127]
    s_waitcnt lgkmcnt(2)
    v_add_f32 v6, v6, v17
    v_exp_f32 v19, v103
    v_cvt_pk_bf16_f32 v70, v16, v17
    v_add_f32 v6, v6, v18
    v_add_f32 v6, v6, v19
    v_cvt_pk_bf16_f32 v71, v18, v19
    v_mfma_f32_16x16x32_bf16 a[0:3], v[160:163], v[24:27], a[0:3]
    ds_read_b128 v[40:43], v1 offset:2048
    v_mfma_f32_16x16x32_bf16 a[0:3], v[168:171], v[28:31], a[0:3]
    v_exp_f32 v16, v72
    v_mfma_f32_16x16x32_bf16 a[48:51], v[164:167], v[24:27], a[48:51]
    ds_read_b128 v[44:47], v1 offset:14336
    v_mfma_f32_16x16x32_bf16 a[48:51], v[172:175], v[28:31], a[48:51]
    s_waitcnt lgkmcnt(2)
    v_exp_f32 v17, v73
    v_mfma_f32_16x16x32_bf16 a[4:7], v[160:163], v[32:35], a[4:7]
    ds_read_b128 v[24:27], v1 offset:3072
    v_mfma_f32_16x16x32_bf16 a[4:7], v[168:171], v[36:39], a[4:7]
    v_exp_f32 v18, v74
    v_mfma_f32_16x16x32_bf16 a[52:55], v[164:167], v[32:35], a[52:55]
    ds_read_b128 v[28:31], v1 offset:15360
    v_add_f32 v5, v5, v16
    v_mfma_f32_16x16x32_bf16 a[52:55], v[172:175], v[36:39], a[52:55]
    s_waitcnt lgkmcnt(2)
    v_add_f32 v5, v5, v17
    v_mfma_f32_16x16x32_bf16 a[8:11], v[160:163], v[40:43], a[8:11]
    ds_read_b128 v[32:35], v1 offset:4096
    v_mfma_f32_16x16x32_bf16 a[8:11], v[168:171], v[44:47], a[8:11]
    v_exp_f32 v19, v75
    v_mfma_f32_16x16x32_bf16 a[56:59], v[164:167], v[40:43], a[56:59]
    ds_read_b128 v[36:39], v1 offset:16384
    v_cvt_pk_bf16_f32 v72, v16, v17
    v_mfma_f32_16x16x32_bf16 a[56:59], v[172:175], v[44:47], a[56:59]
    s_waitcnt lgkmcnt(2)
    v_exp_f32 v16, v104
    v_mfma_f32_16x16x32_bf16 a[12:15], v[160:163], v[24:27], a[12:15]
    ds_read_b128 v[40:43], v1 offset:5120
    v_add_f32 v5, v5, v18
    v_mfma_f32_16x16x32_bf16 a[12:15], v[168:171], v[28:31], a[12:15]
    v_add_f32 v5, v5, v19
    v_mfma_f32_16x16x32_bf16 a[60:63], v[164:167], v[24:27], a[60:63]
    ds_read_b128 v[44:47], v1 offset:17408
    v_mfma_f32_16x16x32_bf16 a[60:63], v[172:175], v[28:31], a[60:63]
    s_waitcnt lgkmcnt(2)
    v_exp_f32 v17, v105
    v_mfma_f32_16x16x32_bf16 a[16:19], v[160:163], v[32:35], a[16:19]
    ds_read_b128 v[24:27], v1 offset:6144
    v_cvt_pk_bf16_f32 v73, v18, v19
    v_mfma_f32_16x16x32_bf16 a[16:19], v[168:171], v[36:39], a[16:19]
    v_exp_f32 v18, v106
    v_mfma_f32_16x16x32_bf16 a[64:67], v[164:167], v[32:35], a[64:67]
    ds_read_b128 v[28:31], v1 offset:18432
    v_add_f32 v5, v5, v16
    v_mfma_f32_16x16x32_bf16 a[64:67], v[172:175], v[36:39], a[64:67]
    s_waitcnt lgkmcnt(2)
    v_add_f32 v5, v5, v17
    v_mfma_f32_16x16x32_bf16 a[20:23], v[160:163], v[40:43], a[20:23]
    ds_read_b128 v[32:35], v1 offset:7168
    v_mfma_f32_16x16x32_bf16 a[20:23], v[168:171], v[44:47], a[20:23]
    v_exp_f32 v19, v107
    v_mfma_f32_16x16x32_bf16 a[68:71], v[164:167], v[40:43], a[68:71]
    ds_read_b128 v[36:39], v1 offset:19456
    v_cvt_pk_bf16_f32 v74, v16, v17
    v_mfma_f32_16x16x32_bf16 a[68:71], v[172:175], v[44:47], a[68:71]
    s_waitcnt lgkmcnt(2)
    v_exp_f32 v16, v76
    v_mfma_f32_16x16x32_bf16 a[24:27], v[160:163], v[24:27], a[24:27]
    ds_read_b128 v[40:43], v1 offset:8192
    v_add_f32 v5, v5, v18
    v_mfma_f32_16x16x32_bf16 a[24:27], v[168:171], v[28:31], a[24:27]
    v_add_f32 v5, v5, v19
    v_mfma_f32_16x16x32_bf16 a[72:75], v[164:167], v[24:27], a[72:75]
    ds_read_b128 v[44:47], v1 offset:20480
    v_mfma_f32_16x16x32_bf16 a[72:75], v[172:175], v[28:31], a[72:75]
    s_waitcnt lgkmcnt(2)
    v_exp_f32 v17, v77
    v_mfma_f32_16x16x32_bf16 a[28:31], v[160:163], v[32:35], a[28:31]
    ds_read_b128 v[24:27], v1 offset:9216
    v_cvt_pk_bf16_f32 v75, v18, v19
    v_mfma_f32_16x16x32_bf16 a[28:31], v[168:171], v[36:39], a[28:31]
    v_exp_f32 v18, v78
    v_mfma_f32_16x16x32_bf16 a[76:79], v[164:167], v[32:35], a[76:79]
    ds_read_b128 v[28:31], v1 offset:21504
    v_add_f32 v6, v6, v16
    v_mfma_f32_16x16x32_bf16 a[76:79], v[172:175], v[36:39], a[76:79]
    s_waitcnt lgkmcnt(2)
    v_add_f32 v6, v6, v17
    v_mfma_f32_16x16x32_bf16 a[32:35], v[160:163], v[40:43], a[32:35]
    ds_read_b128 v[32:35], v1 offset:10240
    v_mfma_f32_16x16x32_bf16 a[32:35], v[168:171], v[44:47], a[32:35]
    v_exp_f32 v19, v79
    v_mfma_f32_16x16x32_bf16 a[80:83], v[164:167], v[40:43], a[80:83]
    ds_read_b128 v[36:39], v1 offset:22528
    v_cvt_pk_bf16_f32 v76, v16, v17
    v_mfma_f32_16x16x32_bf16 a[80:83], v[172:175], v[44:47], a[80:83]
    s_waitcnt lgkmcnt(2)
    v_exp_f32 v16, v108
    v_mfma_f32_16x16x32_bf16 a[36:39], v[160:163], v[24:27], a[36:39]
    ds_read_b128 v[40:43], v1 offset:11264
    v_add_f32 v6, v6, v18
    v_mfma_f32_16x16x32_bf16 a[36:39], v[168:171], v[28:31], a[36:39]
    v_add_f32 v6, v6, v19
    v_mfma_f32_16x16x32_bf16 a[84:87], v[164:167], v[24:27], a[84:87]
    ds_read_b128 v[44:47], v1 offset:23552
    v_mfma_f32_16x16x32_bf16 a[84:87], v[172:175], v[28:31], a[84:87]
    s_waitcnt lgkmcnt(2)
    v_subrev_u32 v1, 98304, v1
    v_mfma_f32_16x16x32_bf16 a[40:43], v[160:163], v[32:35], a[40:43]
    ds_read_b128 v[24:27], v1 offset:0
    v_mfma_f32_16x16x32_bf16 a[40:43], v[168:171], v[36:39], a[40:43]
    v_exp_f32 v17, v109
    v_mfma_f32_16x16x32_bf16 a[88:91], v[164:167], v[32:35], a[88:91]
    ds_read_b128 v[28:31], v1 offset:12288
    v_cvt_pk_bf16_f32 v77, v18, v19
    v_mfma_f32_16x16x32_bf16 a[88:91], v[172:175], v[36:39], a[88:91]
    s_waitcnt lgkmcnt(2)
    v_exp_f32 v18, v110
    v_mfma_f32_16x16x32_bf16 a[44:47], v[160:163], v[40:43], a[44:47]
    ds_read_b128 v[32:35], v1 offset:1024
    v_add_f32 v6, v6, v16
    v_mfma_f32_16x16x32_bf16 a[44:47], v[168:171], v[44:47], a[44:47]
    v_add_f32 v6, v6, v17
    v_mfma_f32_16x16x32_bf16 a[92:95], v[164:167], v[40:43], a[92:95]
    ds_read_b128 v[36:39], v1 offset:13312
    v_mfma_f32_16x16x32_bf16 a[92:95], v[172:175], v[44:47], a[92:95]
    s_waitcnt lgkmcnt(2)
    v_exp_f32 v19, v111
    v_mfma_f32_16x16x32_bf16 a[0:3], v[176:179], v[24:27], a[0:3]
    ds_read_b128 v[40:43], v1 offset:2048
    v_cvt_pk_bf16_f32 v78, v16, v17
    v_mfma_f32_16x16x32_bf16 a[0:3], v[184:187], v[28:31], a[0:3]
    v_add_f32 v6, v6, v18
    v_add_f32 v6, v6, v19
    v_mfma_f32_16x16x32_bf16 a[48:51], v[180:183], v[24:27], a[48:51]
    ds_read_b128 v[44:47], v1 offset:14336
    v_cvt_pk_bf16_f32 v79, v18, v19
    v_mfma_f32_16x16x32_bf16 a[48:51], v[188:191], v[28:31], a[48:51]
    s_waitcnt lgkmcnt(2)
    v_exp_f32 v16, v80
    v_mfma_f32_16x16x32_bf16 a[4:7], v[176:179], v[32:35], a[4:7]
    ds_read_b128 v[24:27], v1 offset:3072
    v_mfma_f32_16x16x32_bf16 a[4:7], v[184:187], v[36:39], a[4:7]
    v_exp_f32 v17, v81
    v_mfma_f32_16x16x32_bf16 a[52:55], v[180:183], v[32:35], a[52:55]
    ds_read_b128 v[28:31], v1 offset:15360
    v_mfma_f32_16x16x32_bf16 a[52:55], v[188:191], v[36:39], a[52:55]
    s_waitcnt lgkmcnt(2)
    v_exp_f32 v18, v82
    v_mfma_f32_16x16x32_bf16 a[8:11], v[176:179], v[40:43], a[8:11]
    ds_read_b128 v[32:35], v1 offset:4096
    v_add_f32 v7, v7, v16
    v_mfma_f32_16x16x32_bf16 a[8:11], v[184:187], v[44:47], a[8:11]
    v_add_f32 v7, v7, v17
    v_mfma_f32_16x16x32_bf16 a[56:59], v[180:183], v[40:43], a[56:59]
    ds_read_b128 v[36:39], v1 offset:16384
    v_mfma_f32_16x16x32_bf16 a[56:59], v[188:191], v[44:47], a[56:59]
    s_waitcnt lgkmcnt(2)
    v_exp_f32 v19, v83
    v_mfma_f32_16x16x32_bf16 a[12:15], v[176:179], v[24:27], a[12:15]
    ds_read_b128 v[40:43], v1 offset:5120
    v_cvt_pk_bf16_f32 v80, v16, v17
    v_mfma_f32_16x16x32_bf16 a[12:15], v[184:187], v[28:31], a[12:15]
    v_exp_f32 v16, v112
    v_mfma_f32_16x16x32_bf16 a[60:63], v[180:183], v[24:27], a[60:63]
    ds_read_b128 v[44:47], v1 offset:17408
    v_add_f32 v7, v7, v18
    v_mfma_f32_16x16x32_bf16 a[60:63], v[188:191], v[28:31], a[60:63]
    s_waitcnt lgkmcnt(2)
    v_add_f32 v7, v7, v19
    v_mfma_f32_16x16x32_bf16 a[16:19], v[176:179], v[32:35], a[16:19]
    ds_read_b128 v[24:27], v1 offset:6144
    v_mfma_f32_16x16x32_bf16 a[16:19], v[184:187], v[36:39], a[16:19]
    v_exp_f32 v17, v113
    v_mfma_f32_16x16x32_bf16 a[64:67], v[180:183], v[32:35], a[64:67]
    ds_read_b128 v[28:31], v1 offset:18432
    v_cvt_pk_bf16_f32 v81, v18, v19
    v_mfma_f32_16x16x32_bf16 a[64:67], v[188:191], v[36:39], a[64:67]
    s_waitcnt lgkmcnt(2)
    v_exp_f32 v18, v114
    v_mfma_f32_16x16x32_bf16 a[20:23], v[176:179], v[40:43], a[20:23]
    ds_read_b128 v[32:35], v1 offset:7168
    v_add_f32 v7, v7, v16
    v_mfma_f32_16x16x32_bf16 a[20:23], v[184:187], v[44:47], a[20:23]
    v_add_f32 v7, v7, v17
    v_mfma_f32_16x16x32_bf16 a[68:71], v[180:183], v[40:43], a[68:71]
    ds_read_b128 v[36:39], v1 offset:19456
    v_mfma_f32_16x16x32_bf16 a[68:71], v[188:191], v[44:47], a[68:71]
    s_waitcnt lgkmcnt(2)
    v_exp_f32 v19, v115
    v_mfma_f32_16x16x32_bf16 a[24:27], v[176:179], v[24:27], a[24:27]
    ds_read_b128 v[40:43], v1 offset:8192
    v_cvt_pk_bf16_f32 v82, v16, v17
    v_mfma_f32_16x16x32_bf16 a[24:27], v[184:187], v[28:31], a[24:27]
    v_exp_f32 v16, v84
    v_mfma_f32_16x16x32_bf16 a[72:75], v[180:183], v[24:27], a[72:75]
    ds_read_b128 v[44:47], v1 offset:20480
    v_add_f32 v7, v7, v18
    v_mfma_f32_16x16x32_bf16 a[72:75], v[188:191], v[28:31], a[72:75]
    s_waitcnt lgkmcnt(2)
    v_add_f32 v7, v7, v19
    v_mfma_f32_16x16x32_bf16 a[28:31], v[176:179], v[32:35], a[28:31]
    ds_read_b128 v[24:27], v1 offset:9216
    v_mfma_f32_16x16x32_bf16 a[28:31], v[184:187], v[36:39], a[28:31]
    s_waitcnt vmcnt(0)
    v_exp_f32 v17, v85
    v_mfma_f32_16x16x32_bf16 a[76:79], v[180:183], v[32:35], a[76:79]
    ds_read_b128 v[28:31], v1 offset:21504
    v_cvt_pk_bf16_f32 v83, v18, v19
    v_mfma_f32_16x16x32_bf16 a[76:79], v[188:191], v[36:39], a[76:79]
    s_waitcnt lgkmcnt(2)
    s_barrier
    v_mfma_f32_16x16x32_bf16 a[32:35], v[176:179], v[40:43], a[32:35]
    ds_read_b128 v[32:35], v1 offset:10240
    v_mfma_f32_16x16x32_bf16 a[32:35], v[184:187], v[44:47], a[32:35]
    v_exp_f32 v18, v86
    v_mfma_f32_16x16x32_bf16 a[80:83], v[180:183], v[40:43], a[80:83]
    ds_read_b128 v[36:39], v1 offset:22528
    v_add_f32 v8, v8, v16
    v_mfma_f32_16x16x32_bf16 a[80:83], v[188:191], v[44:47], a[80:83]
    s_waitcnt lgkmcnt(2)
    v_add_f32 v8, v8, v17
    v_mfma_f32_16x16x32_bf16 a[36:39], v[176:179], v[24:27], a[36:39]
    ds_read_b128 v[40:43], v1 offset:11264
    v_mfma_f32_16x16x32_bf16 a[36:39], v[184:187], v[28:31], a[36:39]
    v_exp_f32 v19, v87
    v_cvt_pk_bf16_f32 v84, v16, v17
    v_mfma_f32_16x16x32_bf16 a[84:87], v[180:183], v[24:27], a[84:87]
    ds_read_b128 v[44:47], v1 offset:23552
    v_mfma_f32_16x16x32_bf16 a[84:87], v[188:191], v[28:31], a[84:87]
    s_waitcnt lgkmcnt(2)
    v_add_u32 v1, 49152, v1
    v_exp_f32 v16, v116
    v_mfma_f32_16x16x32_bf16 a[40:43], v[176:179], v[32:35], a[40:43]
    ds_read_b128 v[24:27], v1 offset:0
    v_add_f32 v8, v8, v18
    v_mfma_f32_16x16x32_bf16 a[40:43], v[184:187], v[36:39], a[40:43]
    v_add_f32 v8, v8, v19
    v_mfma_f32_16x16x32_bf16 a[88:91], v[180:183], v[32:35], a[88:91]
    ds_read_b128 v[28:31], v1 offset:12288
    v_mfma_f32_16x16x32_bf16 a[88:91], v[188:191], v[36:39], a[88:91]
L_pg9:
    s_cbranch_execz L_iwret
    s_waitcnt lgkmcnt(2)
    v_exp_f32 v17, v117
    v_cvt_pk_bf16_f32 v85, v18, v19
    v_mfma_f32_16x16x32_bf16 a[44:47], v[176:179], v[40:43], a[44:47]
    ds_read_b128 v[32:35], v1 offset:1024
    v_mfma_f32_16x16x32_bf16 a[44:47], v[184:187], v[44:47], a[44:47]
    v_exp_f32 v18, v118
    v_mfma_f32_16x16x32_bf16 a[92:95], v[180:183], v[40:43], a[92:95]
    ds_read_b128 v[36:39], v1 offset:13312
    v_add_f32 v8, v8, v16
    v_mfma_f32_16x16x32_bf16 a[92:95], v[188:191], v[44:47], a[92:95]
    s_waitcnt lgkmcnt(2)
    v_add_f32 v8, v8, v17
    v_exp_f32 v19, v119
    v_cvt_pk_bf16_f32 v86, v16, v17
    v_add_f32 v8, v8, v18
    v_add_f32 v8, v8, v19
    v_cvt_pk_bf16_f32 v87, v18, v19
    v_mfma_f32_16x16x32_bf16 a[0:3], v[64:67], v[24:27], a[0:3]
    ds_read_b128 v[40:43], v1 offset:2048
    v_mfma_f32_16x16x32_bf16 a[0:3], v[72:75], v[28:31], a[0:3]
    v_exp_f32 v16, v88
    v_exp_f32 v17, v89
    v_exp_f32 v18, v90
    v_mfma_f32_16x16x4_f32 v[48:51], v5, v57, 0
    v_mfma_f32_16x16x32_bf16 a[48:51], v[68:71], v[24:27], a[48:51]
    ds_read_b128 v[44:47], v1 offset:14336
    v_add_f32 v7, v7, v16
    v_mfma_f32_16x16x32_bf16 a[48:51], v[76:79], v[28:31], a[48:51]
    s_waitcnt lgkmcnt(2)
    v_add_f32 v7, v7, v17
    v_exp_f32 v19, v91
    v_cvt_pk_bf16_f32 v88, v16, v17
    v_exp_f32 v16, v120
    v_mfma_f32_16x16x4_f32 v[52:55], v6, v57, 0
    v_mfma_f32_16x16x32_bf16 a[4:7], v[64:67], v[32:35], a[4:7]
    ds_read_b128 v[24:27], v1 offset:3072
    v_add_f32 v7, v7, v18
    v_mfma_f32_16x16x32_bf16 a[4:7], v[72:75], v[36:39], a[4:7]
    v_add_f32 v7, v7, v19
    v_exp_f32 v17, v121
    v_mfma_f32_16x16x32_bf16 a[52:55], v[68:71], v[32:35], a[52:55]
    ds_read_b128 v[28:31], v1 offset:15360
    v_cvt_pk_bf16_f32 v89, v18, v19
    v_mfma_f32_16x16x32_bf16 a[52:55], v[76:79], v[36:39], a[52:55]
    s_waitcnt lgkmcnt(2)
    v_exp_f32 v18, v122
    v_mfma_f32_16x16x32_bf16 a[8:11], v[64:67], v[40:43], a[8:11]
    ds_read_b128 v[32:35], v1 offset:4096
    v_add_f32 v7, v7, v16
    v_mfma_f32_16x16x32_bf16 a[8:11], v[72:75], v[44:47], a[8:11]
    v_add_f32 v7, v7, v17
    v_exp_f32 v19, v123
    v_mfma_f32_16x16x32_bf16 a[56:59], v[68:71], v[40:43], a[56:59]
    ds_read_b128 v[36:39], v1 offset:16384
    v_cvt_pk_bf16_f32 v90, v16, v17
    v_mfma_f32_16x16x32_bf16 a[56:59], v[76:79], v[44:47], a[56:59]
    s_waitcnt lgkmcnt(2)
    v_exp_f32 v16, v92
    v_mfma_f32_16x16x32_bf16 a[12:15], v[64:67], v[24:27], a[12:15]
    ds_read_b128 v[40:43], v1 offset:5120
    v_add_f32 v7, v7, v18
    v_mfma_f32_16x16x32_bf16 a[12:15], v[72:75], v[28:31], a[12:15]
    v_add_f32 v7, v7, v19
    v_exp_f32 v17, v93
    v_mfma_f32_16x16x32_bf16 a[60:63], v[68:71], v[24:27], a[60:63]
    ds_read_b128 v[44:47], v1 offset:17408
    v_cvt_pk_bf16_f32 v91, v18, v19
    v_mfma_f32_16x16x32_bf16 a[60:63], v[76:79], v[28:31], a[60:63]
    s_waitcnt lgkmcnt(2)
    v_exp_f32 v18, v94
    v_mfma_f32_16x16x32_bf16 a[16:19], v[64:67], v[32:35], a[16:19]
    ds_read_b128 v[24:27], v1 offset:6144
    v_add_f32 v8, v8, v16
    v_mfma_f32_16x16x32_bf16 a[16:19], v[72:75], v[36:39], a[16:19]
    v_add_f32 v8, v8, v17
    v_exp_f32 v19, v95
    v_mfma_f32_16x16x32_bf16 a[64:67], v[68:71], v[32:35], a[64:67]
    ds_read_b128 v[28:31], v1 offset:18432
    v_cvt_pk_bf16_f32 v92, v16, v17
    v_mfma_f32_16x16x32_bf16 a[64:67], v[76:79], v[36:39], a[64:67]
    s_waitcnt lgkmcnt(2)
    v_exp_f32 v16, v124
    v_mfma_f32_16x16x32_bf16 a[20:23], v[64:67], v[40:43], a[20:23]
    ds_read_b128 v[32:35], v1 offset:7168
    v_add_f32 v8, v8, v18
    v_mfma_f32_16x16x32_bf16 a[20:23], v[72:75], v[44:47], a[20:23]
    v_add_f32 v8, v8, v19
    v_exp_f32 v17, v125
    v_mfma_f32_16x16x32_bf16 a[68:71], v[68:71], v[40:43], a[68:71]
    ds_read_b128 v[36:39], v1 offset:19456
    v_cvt_pk_bf16_f32 v93, v18, v19
    v_mfma_f32_16x16x32_bf16 a[68:71], v[76:79], v[44:47], a[68:71]
    s_waitcnt lgkmcnt(2)
    v_exp_f32 v18, v126
    v_mfma_f32_16x16x32_bf16 a[24:27], v[64:67], v[24:27], a[24:27]
    ds_read_b128 v[40:43], v1 offset:8192
    v_add_f32 v8, v8, v16
    v_mfma_f32_16x16x32_bf16 a[24:27], v[72:75], v[28:31], a[24:27]
    v_add_f32 v8, v8, v17
    v_exp_f32 v19, v127
    v_mfma_f32_16x16x32_bf16 a[72:75], v[68:71], v[24:27], a[72:75]
    ds_read_b128 v[44:47], v1 offset:20480
    v_cvt_pk_bf16_f32 v94, v16, v17
    v_mfma_f32_16x16x32_bf16 a[72:75], v[76:79], v[28:31], a[72:75]
    s_waitcnt lgkmcnt(2)
    v_add_f32 v8, v8, v18
    v_add_f32 v8, v8, v19
    v_mfma_f32_16x16x32_bf16 a[28:31], v[64:67], v[32:35], a[28:31]
    ds_read_b128 v[24:27], v1 offset:9216
    v_cvt_pk_bf16_f32 v95, v18, v19
    v_mfma_f32_16x16x32_bf16 a[28:31], v[72:75], v[36:39], a[28:31]
    v_rcp_f32 v48, v48
    v_mfma_f32_16x16x32_bf16 a[76:79], v[68:71], v[32:35], a[76:79]
    ds_read_b128 v[28:31], v1 offset:21504
    v_mfma_f32_16x16x32_bf16 a[76:79], v[76:79], v[36:39], a[76:79]
    s_waitcnt lgkmcnt(2)
    v_rcp_f32 v49, v49
    v_mfma_f32_16x16x32_bf16 a[32:35], v[64:67], v[40:43], a[32:35]
    ds_read_b128 v[32:35], v1 offset:10240
    v_mfma_f32_16x16x32_bf16 a[32:35], v[72:75], v[44:47], a[32:35]
    v_rcp_f32 v50, v50
    v_mfma_f32_16x16x32_bf16 a[80:83], v[68:71], v[40:43], a[80:83]
    ds_read_b128 v[36:39], v1 offset:22528
    v_mfma_f32_16x16x32_bf16 a[80:83], v[76:79], v[44:47], a[80:83]
    s_waitcnt lgkmcnt(2)
    v_rcp_f32 v51, v51
    v_mfma_f32_16x16x32_bf16 a[36:39], v[64:67], v[24:27], a[36:39]
    ds_read_b128 v[40:43], v1 offset:11264
    v_mfma_f32_16x16x32_bf16 a[36:39], v[72:75], v[28:31], a[36:39]
    v_rcp_f32 v52, v52
    v_mfma_f32_16x16x32_bf16 a[84:87], v[68:71], v[24:27], a[84:87]
    ds_read_b128 v[44:47], v1 offset:23552
    v_mfma_f32_16x16x32_bf16 a[84:87], v[76:79], v[28:31], a[84:87]
    s_waitcnt lgkmcnt(2)
    v_subrev_u32 v2, 98304, v2
    v_subrev_u32 v3, 98304, v3
    v_mfma_f32_16x16x32_bf16 a[40:43], v[64:67], v[32:35], a[40:43]
    ds_read_b128 v[24:27], v2 offset:0
    v_mfma_f32_16x16x32_bf16 a[40:43], v[72:75], v[36:39], a[40:43]
    v_rcp_f32 v53, v53
    v_mfma_f32_16x16x32_bf16 a[88:91], v[68:71], v[32:35], a[88:91]
    ds_read_b128 v[28:31], v3 offset:0
    v_mfma_f32_16x16x32_bf16 a[88:91], v[76:79], v[36:39], a[88:91]
    s_waitcnt lgkmcnt(2)
    v_rcp_f32 v54, v54
    v_mfma_f32_16x16x32_bf16 a[44:47], v[64:67], v[40:43], a[44:47]
    ds_read_b128 v[32:35], v2 offset:6144
    v_mfma_f32_16x16x32_bf16 a[44:47], v[72:75], v[44:47], a[44:47]
    v_rcp_f32 v55, v55
    v_mfma_f32_16x16x32_bf16 a[92:95], v[68:71], v[40:43], a[92:95]
    ds_read_b128 v[36:39], v3 offset:6144
    v_mfma_f32_16x16x32_bf16 a[92:95], v[76:79], v[44:47], a[92:95]
    s_waitcnt lgkmcnt(2)
    v_mfma_f32_16x16x32_bf16 v[160:163], v[24:27], a[240:243], v[136:139]
    ds_read_b128 v[40:43], v2 offset:128
    v_mfma_f32_16x16x32_bf16 v[160:163], v[28:31], a[244:247], v[160:163]
    v_mfma_f32_16x16x32_bf16 v[164:167], v[24:27], v[200:203], v[140:143]
    ds_read_b128 v[44:47], v3 offset:128
    v_mfma_f32_16x16x32_bf16 v[164:167], v[28:31], v[204:207], v[164:167]
    s_waitcnt lgkmcnt(2)
    v_mfma_f32_16x16x32_bf16 v[96:99], v[32:35], a[240:243], v[136:139]
    ds_read_b128 v[24:27], v2 offset:6272
    v_accvgpr_read_b32 v224, a0
    v_mfma_f32_16x16x32_bf16 v[96:99], v[36:39], a[244:247], v[96:99]
    v_accvgpr_read_b32 v225, a12
    v_accvgpr_read_b32 v226, a24
    v_accvgpr_read_b32 v227, a36
    v_mul_f32 v224, v224, v48
    v_mul_f32 v225, v225, v48
    v_mfma_f32_16x16x32_bf16 v[100:103], v[32:35], v[200:203], v[140:143]
    ds_read_b128 v[28:31], v3 offset:6272
    v_mul_f32 v226, v226, v48
    v_mfma_f32_16x16x32_bf16 v[100:103], v[36:39], v[204:207], v[100:103]
    s_waitcnt lgkmcnt(2)
    v_mul_f32 v227, v227, v48
    v_cvt_pk_bf16_f32 v224, v224, v225
    v_cvt_pk_bf16_f32 v225, v226, v227
    v_accvgpr_read_b32 v228, a1
    v_accvgpr_read_b32 v229, a13
    v_accvgpr_read_b32 v230, a25
    v_mfma_f32_16x16x32_bf16 v[160:163], v[40:43], a[248:251], v[160:163]
    ds_read_b128 v[32:35], v2 offset:256
    v_accvgpr_read_b32 v231, a37
    v_mfma_f32_16x16x32_bf16 v[160:163], v[44:47], a[252:255], v[160:163]
    buffer_store_dwordx2 v[224:225], v56, s[12:15], s24 offen offset:0 sc0 sc1
    v_mul_f32 v228, v228, v49
    v_mul_f32 v229, v229, v49
    v_mul_f32 v230, v230, v49
    v_mfma_f32_16x16x32_bf16 v[164:167], v[40:43], v[208:211], v[164:167]
    ds_read_b128 v[36:39], v3 offset:256
    v_mul_f32 v231, v231, v49
    v_mfma_f32_16x16x32_bf16 v[164:167], v[44:47], v[212:215], v[164:167]
    s_waitcnt lgkmcnt(2)
    v_cvt_pk_bf16_f32 v228, v228, v229
    v_cvt_pk_bf16_f32 v229, v230, v231
    v_accvgpr_read_b32 v232, a2
    v_accvgpr_read_b32 v233, a14
    v_accvgpr_read_b32 v234, a26
    v_accvgpr_read_b32 v235, a38
    v_mfma_f32_16x16x32_bf16 v[96:99], v[24:27], a[248:251], v[96:99]
    ds_read_b128 v[40:43], v2 offset:6400
    v_mul_f32 v232, v232, v50
    v_mfma_f32_16x16x32_bf16 v[96:99], v[28:31], a[252:255], v[96:99]
    buffer_store_dwordx2 v[228:229], v56, s[12:15], s24 offen offset:384 sc0 sc1
    v_mul_f32 v233, v233, v50
    v_mul_f32 v234, v234, v50
    v_mul_f32 v235, v235, v50
    v_mfma_f32_16x16x32_bf16 v[100:103], v[24:27], v[208:211], v[100:103]
    ds_read_b128 v[44:47], v3 offset:6400
    v_cvt_pk_bf16_f32 v232, v232, v233
    v_mfma_f32_16x16x32_bf16 v[100:103], v[28:31], v[212:215], v[100:103]
    s_waitcnt lgkmcnt(2)
    v_cvt_pk_bf16_f32 v233, v234, v235
    v_accvgpr_read_b32 v236, a3
    v_accvgpr_read_b32 v237, a15
    v_accvgpr_read_b32 v238, a27
    v_accvgpr_read_b32 v239, a39
    v_mul_f32 v236, v236, v51
    v_mfma_f32_16x16x32_bf16 v[160:163], v[32:35], v[192:195], v[160:163]
    ds_read_b128 v[24:27], v2 offset:12288
    v_mul_f32 v237, v237, v51
    v_mfma_f32_16x16x32_bf16 v[160:163], v[36:39], v[196:199], v[160:163]
    buffer_store_dwordx2 v[232:233], v56, s[12:15], s24 offen offset:768 sc0 sc1
    v_mul_f32 v238, v238, v51
    v_mul_f32 v239, v239, v51
    v_cvt_pk_bf16_f32 v236, v236, v237
    v_mfma_f32_16x16x32_bf16 v[164:167], v[32:35], v[216:219], v[164:167]
    ds_read_b128 v[28:31], v3 offset:12288
    v_cvt_pk_bf16_f32 v237, v238, v239
    v_mfma_f32_16x16x32_bf16 v[164:167], v[36:39], v[220:223], v[164:167]
    s_waitcnt lgkmcnt(2)
    buffer_store_dwordx2 v[236:237], v56, s[12:15], s24 offen offset:1152 sc0 sc1
    v_accvgpr_read_b32 v240, a4
    v_accvgpr_read_b32 v241, a16
    v_accvgpr_read_b32 v242, a28
    v_mfma_f32_16x16x32_bf16 v[96:99], v[40:43], v[192:195], v[96:99]
    ds_read_b128 v[32:35], v2 offset:18432
    v_accvgpr_read_b32 v243, a40
    v_mfma_f32_16x16x32_bf16 v[96:99], v[44:47], v[196:199], v[96:99]
    v_mul_f32 v240, v240, v48
    v_mul_f32 v241, v241, v48
    v_mul_f32 v242, v242, v48
    v_mul_f32 v243, v243, v48
    v_cvt_pk_bf16_f32 v240, v240, v241
    v_cvt_pk_bf16_f32 v241, v242, v243
    v_mfma_f32_16x16x32_bf16 v[100:103], v[40:43], v[216:219], v[100:103]
    ds_read_b128 v[36:39], v3 offset:18432
    v_accvgpr_read_b32 v244, a5
    v_mfma_f32_16x16x32_bf16 v[100:103], v[44:47], v[220:223], v[100:103]
    s_waitcnt lgkmcnt(2)
    buffer_store_dwordx2 v[240:241], v56, s[12:15], s24 offen offset:128 sc0 sc1
    v_accvgpr_read_b32 v245, a17
    v_accvgpr_read_b32 v246, a29
    v_accvgpr_read_b32 v247, a41
    v_mfma_f32_16x16x32_bf16 v[168:171], v[24:27], a[240:243], v[136:139]
    ds_read_b128 v[40:43], v2 offset:12416
    v_mul_f32 v244, v244, v49
    v_mfma_f32_16x16x32_bf16 v[168:171], v[28:31], a[244:247], v[168:171]
    v_mul_f32 v245, v245, v49
    v_mul_f32 v246, v246, v49
    v_mul_f32 v247, v247, v49
    v_cvt_pk_bf16_f32 v244, v244, v245
    v_cvt_pk_bf16_f32 v245, v246, v247
    v_accvgpr_read_b32 v248, a6
    v_mfma_f32_16x16x32_bf16 v[172:175], v[24:27], v[200:203], v[140:143]
    ds_read_b128 v[44:47], v3 offset:12416
    v_accvgpr_read_b32 v249, a18
    v_mfma_f32_16x16x32_bf16 v[172:175], v[28:31], v[204:207], v[172:175]
    s_waitcnt lgkmcnt(2)
    buffer_store_dwordx2 v[244:245], v56, s[12:15], s24 offen offset:512 sc0 sc1
    v_accvgpr_read_b32 v250, a30
    v_accvgpr_read_b32 v251, a42
    v_mul_f32 v248, v248, v50
    v_mfma_f32_16x16x32_bf16 v[104:107], v[32:35], a[240:243], v[136:139]
    ds_read_b128 v[24:27], v2 offset:18560
    v_mul_f32 v249, v249, v50
    v_mfma_f32_16x16x32_bf16 v[104:107], v[36:39], a[244:247], v[104:107]
    v_mul_f32 v250, v250, v50
    v_mul_f32 v251, v251, v50
    v_cvt_pk_bf16_f32 v248, v248, v249
    v_exp_f32 v16, v160
    v_mfma_f32_16x16x32_bf16 v[108:111], v[32:35], v[200:203], v[140:143]
    ds_read_b128 v[28:31], v3 offset:18560
    v_cvt_pk_bf16_f32 v249, v250, v251
    v_mfma_f32_16x16x32_bf16 v[108:111], v[36:39], v[204:207], v[108:111]
    s_waitcnt lgkmcnt(2)
    buffer_store_dwordx2 v[248:249], v56, s[12:15], s24 offen offset:896 sc0 sc1
    v_accvgpr_read_b32 v252, a7
    v_exp_f32 v17, v161
    v_mfma_f32_16x16x32_bf16 v[168:171], v[40:43], a[248:251], v[168:171]
    ds_read_b128 v[32:35], v2 offset:12544
    v_accvgpr_read_b32 v253, a19
    v_mfma_f32_16x16x32_bf16 v[168:171], v[44:47], a[252:255], v[168:171]
    v_exp_f32 v18, v162
    v_accvgpr_read_b32 v254, a31
    v_accvgpr_read_b32 v255, a43
    v_mul_f32 v252, v252, v51
    v_add_f32 v7, v7, v16
    v_mfma_f32_16x16x32_bf16 v[172:175], v[40:43], v[208:211], v[172:175]
    ds_read_b128 v[36:39], v3 offset:12544
    v_mul_f32 v253, v253, v51
    v_mfma_f32_16x16x32_bf16 v[172:175], v[44:47], v[212:215], v[172:175]
    s_waitcnt lgkmcnt(2)
    v_add_f32 v7, v7, v17
    v_mul_f32 v254, v254, v51
    v_exp_f32 v19, v163
    v_mul_f32 v255, v255, v51
    v_cvt_pk_bf16_f32 v252, v252, v253
    v_mfma_f32_16x16x32_bf16 v[104:107], v[24:27], a[248:251], v[104:107]
    ds_read_b128 v[40:43], v2 offset:18688
    v_cvt_pk_bf16_f32 v160, v16, v17
    v_mfma_f32_16x16x32_bf16 v[104:107], v[28:31], a[252:255], v[104:107]
    v_cvt_pk_bf16_f32 v253, v254, v255
    v_exp_f32 v16, v96
    v_accvgpr_read_b32 v224, a8
    v_accvgpr_read_b32 v225, a20
    v_accvgpr_read_b32 v226, a32
    v_mfma_f32_16x16x32_bf16 v[108:111], v[24:27], v[208:211], v[108:111]
    ds_read_b128 v[44:47], v3 offset:18688
    v_add_f32 v7, v7, v18
    v_mfma_f32_16x16x32_bf16 v[108:111], v[28:31], v[212:215], v[108:111]
    s_waitcnt lgkmcnt(2)
    buffer_store_dwordx2 v[252:253], v56, s[12:15], s24 offen offset:1280 sc0 sc1
    v_add_u32 v2, 49152, v2
    v_add_u32 v3, 49152, v3
    v_add_f32 v7, v7, v19
    v_mfma_f32_16x16x32_bf16 v[168:171], v[32:35], v[192:195], v[168:171]
    ds_read_b128 v[24:27], v2 offset:0
    v_accvgpr_read_b32 v227, a44
    v_mfma_f32_16x16x32_bf16 v[168:171], v[36:39], v[196:199], v[168:171]
    v_exp_f32 v17, v97
    v_mul_f32 v224, v224, v48
    v_mul_f32 v225, v225, v48
    v_cvt_pk_bf16_f32 v161, v18, v19
    v_mul_f32 v226, v226, v48
    v_mfma_f32_16x16x32_bf16 v[172:175], v[32:35], v[216:219], v[172:175]
    ds_read_b128 v[28:31], v3 offset:0
    v_mul_f32 v227, v227, v48
    v_mfma_f32_16x16x32_bf16 v[172:175], v[36:39], v[220:223], v[172:175]
    s_waitcnt lgkmcnt(2)
    v_exp_f32 v18, v98
    v_cvt_pk_bf16_f32 v224, v224, v225
    v_add_f32 v7, v7, v16
    v_cvt_pk_bf16_f32 v225, v226, v227
    v_accvgpr_read_b32 v228, a9
    v_mfma_f32_16x16x32_bf16 v[104:107], v[40:43], v[192:195], v[104:107]
    ds_read_b128 v[32:35], v2 offset:6144
    v_add_f32 v7, v7, v17
    v_mfma_f32_16x16x32_bf16 v[104:107], v[44:47], v[196:199], v[104:107]
    buffer_store_dwordx2 v[224:225], v56, s[12:15], s24 offen offset:256 sc0 sc1
    v_exp_f32 v19, v99
    v_accvgpr_read_b32 v229, a21
    v_mfma_f32_16x16x32_bf16 v[108:111], v[40:43], v[216:219], v[108:111]
    ds_read_b128 v[36:39], v3 offset:6144
    v_accvgpr_read_b32 v230, a33
    v_mfma_f32_16x16x32_bf16 v[108:111], v[44:47], v[220:223], v[108:111]
    s_waitcnt lgkmcnt(2)
    v_cvt_pk_bf16_f32 v162, v16, v17
    v_accvgpr_read_b32 v231, a45
    v_exp_f32 v16, v164
    v_mul_f32 v228, v228, v49
    v_mul_f32 v229, v229, v49
    v_mfma_f32_16x16x32_bf16 v[176:179], v[24:27], a[240:243], v[136:139]
    ds_read_b128 v[40:43], v2 offset:128
    v_mul_f32 v230, v230, v49
    v_mfma_f32_16x16x32_bf16 v[176:179], v[28:31], a[244:247], v[176:179]
    v_add_f32 v7, v7, v18
    v_add_f32 v7, v7, v19
    v_mul_f32 v231, v231, v49
    v_cvt_pk_bf16_f32 v228, v228, v229
    v_exp_f32 v17, v165
    v_mfma_f32_16x16x32_bf16 v[180:183], v[24:27], v[200:203], v[140:143]
    ds_read_b128 v[44:47], v3 offset:128
    v_cvt_pk_bf16_f32 v229, v230, v231
    v_mfma_f32_16x16x32_bf16 v[180:183], v[28:31], v[204:207], v[180:183]
    s_waitcnt lgkmcnt(2)
    buffer_store_dwordx2 v[228:229], v56, s[12:15], s24 offen offset:640 sc0 sc1
    v_cvt_pk_bf16_f32 v163, v18, v19
    v_accvgpr_read_b32 v232, a10
    v_accvgpr_read_b32 v233, a22
    v_mfma_f32_16x16x32_bf16 v[112:115], v[32:35], a[240:243], v[136:139]
    ds_read_b128 v[24:27], v2 offset:6272
    v_accvgpr_read_b32 v234, a34
    v_mfma_f32_16x16x32_bf16 v[112:115], v[36:39], a[244:247], v[112:115]
    v_exp_f32 v18, v166
    v_accvgpr_read_b32 v235, a46
    v_add_f32 v8, v8, v16
    v_mul_f32 v232, v232, v50
    v_mfma_f32_16x16x32_bf16 v[116:119], v[32:35], v[200:203], v[140:143]
    ds_read_b128 v[28:31], v3 offset:6272
    v_add_f32 v8, v8, v17
    v_mfma_f32_16x16x32_bf16 v[116:119], v[36:39], v[204:207], v[116:119]
    s_waitcnt lgkmcnt(2)
    v_exp_f32 v19, v167
    v_mul_f32 v233, v233, v50
    v_mul_f32 v234, v234, v50
    v_mul_f32 v235, v235, v50
    v_cvt_pk_bf16_f32 v232, v232, v233
    v_mfma_f32_16x16x32_bf16 v[176:179], v[40:43], a[248:251], v[176:179]
    ds_read_b128 v[32:35], v2 offset:256
    v_cvt_pk_bf16_f32 v164, v16, v17
    v_mfma_f32_16x16x32_bf16 v[176:179], v[44:47], a[252:255], v[176:179]
    v_exp_f32 v16, v100
    v_cvt_pk_bf16_f32 v233, v234, v235
    v_accvgpr_read_b32 v236, a11
    v_accvgpr_read_b32 v237, a23
    v_add_f32 v8, v8, v18
    v_mfma_f32_16x16x32_bf16 v[180:183], v[40:43], v[208:211], v[180:183]
    ds_read_b128 v[36:39], v3 offset:256
    v_accvgpr_read_b32 v238, a35
    v_mfma_f32_16x16x32_bf16 v[180:183], v[44:47], v[212:215], v[180:183]
    s_waitcnt lgkmcnt(2)
    buffer_store_dwordx2 v[232:233], v56, s[12:15], s24 offen offset:1024 sc0 sc1
    v_add_f32 v8, v8, v19
    v_exp_f32 v17, v101
    v_mfma_f32_16x16x32_bf16 v[112:115], v[24:27], a[248:251], v[112:115]
    ds_read_b128 v[40:43], v2 offset:6400
    v_accvgpr_read_b32 v239, a47
    v_mfma_f32_16x16x32_bf16 v[112:115], v[28:31], a[252:255], v[112:115]
    v_mul_f32 v236, v236, v51
    v_cvt_pk_bf16_f32 v165, v18, v19
    v_mul_f32 v237, v237, v51
    v_mul_f32 v238, v238, v51
    v_exp_f32 v18, v102
    v_mfma_f32_16x16x32_bf16 v[116:119], v[24:27], v[208:211], v[116:119]
    ds_read_b128 v[44:47], v3 offset:6400
    v_mul_f32 v239, v239, v51
    v_mfma_f32_16x16x32_bf16 v[116:119], v[28:31], v[212:215], v[116:119]
    s_waitcnt lgkmcnt(2)
    v_add_f32 v8, v8, v16
    v_cvt_pk_bf16_f32 v236, v236, v237
    v_cvt_pk_bf16_f32 v237, v238, v239
    v_add_f32 v8, v8, v17
    v_accvgpr_read_b32 v240, a48
    v_accvgpr_read_b32 v241, a60
    v_mfma_f32_16x16x32_bf16 v[176:179], v[32:35], v[192:195], v[176:179]
    ds_read_b128 v[24:27], v2 offset:12288
    v_accvgpr_read_b32 v242, a72
    v_mfma_f32_16x16x32_bf16 v[176:179], v[36:39], v[196:199], v[176:179]
    buffer_store_dwordx2 v[236:237], v56, s[12:15], s24 offen offset:1408 sc0 sc1
    v_exp_f32 v19, v103
    v_cvt_pk_bf16_f32 v166, v16, v17
    v_mfma_f32_16x16x32_bf16 v[180:183], v[32:35], v[216:219], v[180:183]
    ds_read_b128 v[28:31], v3 offset:12288
    v_accvgpr_read_b32 v243, a84
    v_mfma_f32_16x16x32_bf16 v[180:183], v[36:39], v[220:223], v[180:183]
    s_waitcnt lgkmcnt(2)
    v_add_f32 v8, v8, v18
    v_add_f32 v8, v8, v19
    v_mul_f32 v240, v240, v52
    v_mul_f32 v241, v241, v52
    v_cvt_pk_bf16_f32 v167, v18, v19
    v_mul_f32 v242, v242, v52
    v_mfma_f32_16x16x32_bf16 v[112:115], v[40:43], v[192:195], v[112:115]
    ds_read_b128 v[32:35], v2 offset:18432
    v_mul_f32 v243, v243, v52
    v_mfma_f32_16x16x32_bf16 v[112:115], v[44:47], v[196:199], v[112:115]
    v_exp_f32 v16, v168
    v_cvt_pk_bf16_f32 v240, v240, v241
    v_cvt_pk_bf16_f32 v241, v242, v243
    v_exp_f32 v17, v169
    v_mfma_f32_16x16x32_bf16 v[116:119], v[40:43], v[216:219], v[116:119]
    ds_read_b128 v[36:39], v3 offset:18432
    v_accvgpr_read_b32 v244, a49
    v_mfma_f32_16x16x32_bf16 v[116:119], v[44:47], v[220:223], v[116:119]
    s_waitcnt lgkmcnt(2)
    buffer_store_dwordx2 v[240:241], v56, s[12:15], s40 offen offset:0 sc0 sc1
    v_exp_f32 v18, v170
    v_accvgpr_read_b32 v245, a61
    v_mfma_f32_16x16x32_bf16 v[184:187], v[24:27], a[240:243], v[136:139]
    ds_read_b128 v[40:43], v2 offset:12416
    v_accvgpr_read_b32 v246, a73
    v_mfma_f32_16x16x32_bf16 v[184:187], v[28:31], a[244:247], v[184:187]
    v_add_f32 v7, v7, v16
    v_accvgpr_read_b32 v247, a85
    v_mul_f32 v244, v244, v53
    v_add_f32 v7, v7, v17
    v_mul_f32 v245, v245, v53
    v_mul_f32 v246, v246, v53
    v_mfma_f32_16x16x32_bf16 v[188:191], v[24:27], v[200:203], v[140:143]
    ds_read_b128 v[44:47], v3 offset:12416
    v_mul_f32 v247, v247, v53
    v_mfma_f32_16x16x32_bf16 v[188:191], v[28:31], v[204:207], v[188:191]
    s_waitcnt lgkmcnt(2)
    v_exp_f32 v19, v171
    v_cvt_pk_bf16_f32 v168, v16, v17
    v_cvt_pk_bf16_f32 v244, v244, v245
    v_cvt_pk_bf16_f32 v245, v246, v247
    v_accvgpr_read_b32 v248, a50
    v_mfma_f32_16x16x32_bf16 v[120:123], v[32:35], a[240:243], v[136:139]
    ds_read_b128 v[24:27], v2 offset:18560
    v_accvgpr_read_b32 v249, a62
    v_mfma_f32_16x16x32_bf16 v[120:123], v[36:39], a[244:247], v[120:123]
    buffer_store_dwordx2 v[244:245], v56, s[12:15], s40 offen offset:384 sc0 sc1
    v_exp_f32 v16, v104
    v_mfma_f32_16x16x32_bf16 v[124:127], v[32:35], v[200:203], v[140:143]
    ds_read_b128 v[28:31], v3 offset:18560
    v_add_f32 v7, v7, v18
    v_mfma_f32_16x16x32_bf16 v[124:127], v[36:39], v[204:207], v[124:127]
    s_waitcnt lgkmcnt(2)
    v_add_f32 v7, v7, v19
    v_accvgpr_read_b32 v250, a74
    v_exp_f32 v17, v105
    v_accvgpr_read_b32 v251, a86
    v_mul_f32 v248, v248, v54
    v_mfma_f32_16x16x32_bf16 v[184:187], v[40:43], a[248:251], v[184:187]
    ds_read_b128 v[32:35], v2 offset:12544
    v_mul_f32 v249, v249, v54
    v_mfma_f32_16x16x32_bf16 v[184:187], v[44:47], a[252:255], v[184:187]
    v_cvt_pk_bf16_f32 v169, v18, v19
    v_exp_f32 v18, v106
    v_mul_f32 v250, v250, v54
    v_mul_f32 v251, v251, v54
    v_cvt_pk_bf16_f32 v248, v248, v249
    v_mfma_f32_16x16x32_bf16 v[188:191], v[40:43], v[208:211], v[188:191]
    ds_read_b128 v[36:39], v3 offset:12544
    v_add_f32 v7, v7, v16
    v_mfma_f32_16x16x32_bf16 v[188:191], v[44:47], v[212:215], v[188:191]
    s_waitcnt lgkmcnt(2)
    v_cvt_pk_bf16_f32 v249, v250, v251
    v_add_f32 v7, v7, v17
    v_accvgpr_read_b32 v252, a51
    v_accvgpr_read_b32 v253, a63
    v_exp_f32 v19, v107
    v_mfma_f32_16x16x32_bf16 v[120:123], v[24:27], a[248:251], v[120:123]
    ds_read_b128 v[40:43], v2 offset:18688
    v_accvgpr_read_b32 v254, a75
    v_mfma_f32_16x16x32_bf16 v[120:123], v[28:31], a[252:255], v[120:123]
    buffer_store_dwordx2 v[248:249], v56, s[12:15], s40 offen offset:768 sc0 sc1
    v_cvt_pk_bf16_f32 v170, v16, v17
    v_accvgpr_read_b32 v255, a87
    v_mul_f32 v252, v252, v55
    v_mfma_f32_16x16x32_bf16 v[124:127], v[24:27], v[208:211], v[124:127]
    ds_read_b128 v[44:47], v3 offset:18688
    v_mul_f32 v253, v253, v55
    v_mfma_f32_16x16x32_bf16 v[124:127], v[28:31], v[212:215], v[124:127]
    s_waitcnt lgkmcnt(2)
    v_add_u32 v22, 49152, v1
    v_mov_b32 v23, v1
    v_subrev_u32 v1, 49152, v1
    v_exp_f32 v16, v172
    v_mul_f32 v254, v254, v55
    v_mfma_f32_16x16x32_bf16 v[184:187], v[32:35], v[192:195], v[184:187]
    ds_read_b128 v[24:27], v22 offset:0
    v_add_f32 v7, v7, v18
    v_mfma_f32_16x16x32_bf16 v[184:187], v[36:39], v[196:199], v[184:187]
    v_add_f32 v7, v7, v19
    v_mul_f32 v255, v255, v55
    v_exp_f32 v17, v173
    v_cvt_pk_bf16_f32 v252, v252, v253
    v_cvt_pk_bf16_f32 v253, v254, v255
    v_mfma_f32_16x16x32_bf16 v[188:191], v[32:35], v[216:219], v[188:191]
    ds_read_b128 v[28:31], v22 offset:12288
    v_accvgpr_read_b32 v224, a52
    v_mfma_f32_16x16x32_bf16 v[188:191], v[36:39], v[220:223], v[188:191]
    s_waitcnt lgkmcnt(2)
    buffer_store_dwordx2 v[252:253], v56, s[12:15], s40 offen offset:1152 sc0 sc1
    v_cvt_pk_bf16_f32 v171, v18, v19
    v_accvgpr_read_b32 v225, a64
    v_accvgpr_read_b32 v226, a76
    v_mfma_f32_16x16x32_bf16 v[120:123], v[40:43], v[192:195], v[120:123]
    ds_read_b128 v[32:35], v22 offset:3072
    v_accvgpr_read_b32 v227, a88
    v_mfma_f32_16x16x32_bf16 v[120:123], v[44:47], v[196:199], v[120:123]
    v_exp_f32 v18, v174
    v_add_f32 v8, v8, v16
    v_mul_f32 v224, v224, v52
    v_mul_f32 v225, v225, v52
    v_add_f32 v8, v8, v17
    v_mfma_f32_16x16x32_bf16 v[124:127], v[40:43], v[216:219], v[124:127]
    ds_read_b128 v[36:39], v22 offset:15360
    v_mul_f32 v226, v226, v52
    v_mfma_f32_16x16x32_bf16 v[124:127], v[44:47], v[220:223], v[124:127]
    s_waitcnt lgkmcnt(2)
    v_exp_f32 v19, v175
    v_mul_f32 v227, v227, v52
    v_cvt_pk_bf16_f32 v224, v224, v225
    v_cvt_pk_bf16_f32 v225, v226, v227
    v_accvgpr_read_b32 v228, a53
    v_mfma_f32_16x16x32_bf16 a[96:99], v[80:83], v[24:27], a[96:99]
    ds_read_b128 v[40:43], v22 offset:6144
    v_cvt_pk_bf16_f32 v172, v16, v17
    v_mfma_f32_16x16x32_bf16 a[96:99], v[88:91], v[28:31], a[96:99]
    buffer_store_dwordx2 v[224:225], v56, s[12:15], s40 offen offset:128 sc0 sc1
    v_exp_f32 v16, v108
    v_accvgpr_read_b32 v229, a65
    v_mfma_f32_16x16x32_bf16 a[144:147], v[84:87], v[24:27], a[144:147]
    ds_read_b128 v[44:47], v22 offset:18432
    v_add_f32 v8, v8, v18
    v_mfma_f32_16x16x32_bf16 a[144:147], v[92:95], v[28:31], a[144:147]
    s_waitcnt lgkmcnt(2)
    v_add_f32 v8, v8, v19
    v_accvgpr_read_b32 v230, a77
    v_accvgpr_read_b32 v231, a89
    v_mul_f32 v228, v228, v53
    v_mul_f32 v229, v229, v53
    v_mul_f32 v230, v230, v53
    v_mfma_f32_16x16x32_bf16 a[108:111], v[80:83], v[32:35], a[108:111]
    ds_read_b128 v[24:27], v22 offset:9216
    v_mul_f32 v231, v231, v53
    v_mfma_f32_16x16x32_bf16 a[108:111], v[88:91], v[36:39], a[108:111]
    v_exp_f32 v17, v109
    v_cvt_pk_bf16_f32 v173, v18, v19
    v_cvt_pk_bf16_f32 v228, v228, v229
    v_cvt_pk_bf16_f32 v229, v230, v231
    v_accvgpr_read_b32 v232, a54
    v_mfma_f32_16x16x32_bf16 a[156:159], v[84:87], v[32:35], a[156:159]
    ds_read_b128 v[28:31], v22 offset:21504
    v_accvgpr_read_b32 v233, a66
    v_mfma_f32_16x16x32_bf16 a[156:159], v[92:95], v[36:39], a[156:159]
    s_waitcnt lgkmcnt(2)
    buffer_store_dwordx2 v[228:229], v56, s[12:15], s40 offen offset:512 sc0 sc1
    v_exp_f32 v18, v110
    v_mfma_f32_16x16x32_bf16 a[120:123], v[80:83], v[40:43], a[120:123]
    ds_read_b128 v[32:35], v1 offset:0
    v_add_f32 v8, v8, v16
    v_mfma_f32_16x16x32_bf16 a[120:123], v[88:91], v[44:47], a[120:123]
    v_add_f32 v8, v8, v17
    v_accvgpr_read_b32 v234, a78
    v_exp_f32 v19, v111
    v_accvgpr_read_b32 v235, a90
    v_mul_f32 v232, v232, v54
    v_mfma_f32_16x16x32_bf16 a[168:171], v[84:87], v[40:43], a[168:171]
L_pg10:
    s_cbranch_execz L_iwret
    ds_read_b128 v[36:39], v1 offset:12288
    v_mul_f32 v233, v233, v54
    v_mfma_f32_16x16x32_bf16 a[168:171], v[92:95], v[44:47], a[168:171]
    s_waitcnt lgkmcnt(2)
    v_cvt_pk_bf16_f32 v174, v16, v17
    v_mul_f32 v234, v234, v54
    v_mul_f32 v235, v235, v54
    v_cvt_pk_bf16_f32 v232, v232, v233
    v_cvt_pk_bf16_f32 v233, v234, v235
    v_accvgpr_read_b32 v236, a55
    v_mfma_f32_16x16x32_bf16 a[132:135], v[80:83], v[24:27], a[132:135]
    ds_read_b128 v[40:43], v1 offset:3072
    v_add_f32 v8, v8, v18
    v_mfma_f32_16x16x32_bf16 a[132:135], v[88:91], v[28:31], a[132:135]
    buffer_store_dwordx2 v[232:233], v56, s[12:15], s40 offen offset:896 sc0 sc1
    v_add_f32 v8, v8, v19
    v_cvt_pk_bf16_f32 v175, v18, v19
    v_accvgpr_read_b32 v237, a67
    v_mfma_f32_16x16x32_bf16 a[180:183], v[84:87], v[24:27], a[180:183]
    ds_read_b128 v[44:47], v1 offset:15360
    v_accvgpr_read_b32 v238, a79
    v_mfma_f32_16x16x32_bf16 a[180:183], v[92:95], v[28:31], a[180:183]
    s_waitcnt lgkmcnt(2)
    v_exp_f32 v16, v176
    v_exp_f32 v17, v177
    v_exp_f32 v18, v178
    v_mfma_f32_16x16x32_bf16 a[96:99], v[160:163], v[32:35], a[96:99]
    ds_read_b128 v[24:27], v1 offset:6144
    v_add_f32 v7, v7, v16
    v_mfma_f32_16x16x32_bf16 a[96:99], v[168:171], v[36:39], a[96:99]
    v_add_f32 v7, v7, v17
    v_exp_f32 v19, v179
    v_cvt_pk_bf16_f32 v176, v16, v17
    v_exp_f32 v16, v112
    v_mfma_f32_16x16x32_bf16 a[144:147], v[164:167], v[32:35], a[144:147]
    ds_read_b128 v[28:31], v1 offset:18432
    v_add_f32 v7, v7, v18
    v_mfma_f32_16x16x32_bf16 a[144:147], v[172:175], v[36:39], a[144:147]
    s_waitcnt lgkmcnt(2)
    v_add_f32 v7, v7, v19
    v_exp_f32 v17, v113
    v_cvt_pk_bf16_f32 v177, v18, v19
    v_exp_f32 v18, v114
    v_mfma_f32_16x16x32_bf16 a[108:111], v[160:163], v[40:43], a[108:111]
    ds_read_b128 v[32:35], v1 offset:9216
    v_add_f32 v7, v7, v16
    v_mfma_f32_16x16x32_bf16 a[108:111], v[168:171], v[44:47], a[108:111]
    v_add_f32 v7, v7, v17
    v_exp_f32 v19, v115
    v_cvt_pk_bf16_f32 v178, v16, v17
    v_exp_f32 v16, v180
    v_mfma_f32_16x16x32_bf16 a[156:159], v[164:167], v[40:43], a[156:159]
    ds_read_b128 v[36:39], v1 offset:21504
    v_add_f32 v7, v7, v18
    v_mfma_f32_16x16x32_bf16 a[156:159], v[172:175], v[44:47], a[156:159]
    s_waitcnt lgkmcnt(2)
    v_add_f32 v7, v7, v19
    v_exp_f32 v17, v181
    v_cvt_pk_bf16_f32 v179, v18, v19
    v_exp_f32 v18, v182
    v_mfma_f32_16x16x32_bf16 a[120:123], v[160:163], v[24:27], a[120:123]
    ds_read_b128 v[40:43], v23 offset:0
    v_add_f32 v8, v8, v16
    v_mfma_f32_16x16x32_bf16 a[120:123], v[168:171], v[28:31], a[120:123]
    v_add_f32 v8, v8, v17
    v_exp_f32 v19, v183
    v_cvt_pk_bf16_f32 v180, v16, v17
    v_exp_f32 v16, v116
    v_mfma_f32_16x16x32_bf16 a[168:171], v[164:167], v[24:27], a[168:171]
    ds_read_b128 v[44:47], v23 offset:12288
    v_add_f32 v8, v8, v18
    v_mfma_f32_16x16x32_bf16 a[168:171], v[172:175], v[28:31], a[168:171]
    s_waitcnt lgkmcnt(2)
    v_add_f32 v8, v8, v19
    v_exp_f32 v17, v117
    v_cvt_pk_bf16_f32 v181, v18, v19
    v_exp_f32 v18, v118
    v_mfma_f32_16x16x32_bf16 a[132:135], v[160:163], v[32:35], a[132:135]
    ds_read_b128 v[24:27], v23 offset:3072
    v_add_f32 v8, v8, v16
    v_mfma_f32_16x16x32_bf16 a[132:135], v[168:171], v[36:39], a[132:135]
    v_add_f32 v8, v8, v17
    v_exp_f32 v19, v119
    v_cvt_pk_bf16_f32 v182, v16, v17
    v_add_f32 v8, v8, v18
    v_add_f32 v8, v8, v19
    v_cvt_pk_bf16_f32 v183, v18, v19
    v_exp_f32 v16, v184
    v_exp_f32 v17, v185
    v_exp_f32 v18, v186
    v_add_f32 v7, v7, v16
    v_add_f32 v7, v7, v17
    v_exp_f32 v19, v187
    v_cvt_pk_bf16_f32 v184, v16, v17
    v_exp_f32 v16, v120
    v_add_f32 v7, v7, v18
    v_add_f32 v7, v7, v19
    v_exp_f32 v17, v121
    v_cvt_pk_bf16_f32 v185, v18, v19
    v_exp_f32 v18, v122
    v_add_f32 v7, v7, v16
    v_add_f32 v7, v7, v17
    v_exp_f32 v19, v123
    v_cvt_pk_bf16_f32 v186, v16, v17
    v_exp_f32 v16, v188
    v_add_f32 v7, v7, v18
    v_add_f32 v7, v7, v19
    v_exp_f32 v17, v189
    v_cvt_pk_bf16_f32 v187, v18, v19
    v_exp_f32 v18, v190
    v_add_f32 v8, v8, v16
    v_add_f32 v8, v8, v17
    v_exp_f32 v19, v191
    v_cvt_pk_bf16_f32 v188, v16, v17
    v_exp_f32 v16, v124
    v_add_f32 v8, v8, v18
    v_add_f32 v8, v8, v19
    v_exp_f32 v17, v125
    v_cvt_pk_bf16_f32 v189, v18, v19
    v_exp_f32 v18, v126
    v_add_f32 v8, v8, v16
    v_add_f32 v8, v8, v17
    v_exp_f32 v19, v127
    v_cvt_pk_bf16_f32 v190, v16, v17
    v_add_f32 v8, v8, v18
    v_add_f32 v8, v8, v19
    v_cvt_pk_bf16_f32 v191, v18, v19
    v_mfma_f32_16x16x32_bf16 a[180:183], v[164:167], v[32:35], a[180:183]
    ds_read_b128 v[28:31], v23 offset:15360
    v_accvgpr_read_b32 v239, a91
    v_mfma_f32_16x16x32_bf16 a[180:183], v[172:175], v[36:39], a[180:183]
    s_waitcnt lgkmcnt(2)
    v_mul_f32 v236, v236, v55
    v_mul_f32 v237, v237, v55
    v_mul_f32 v238, v238, v55
    v_mul_f32 v239, v239, v55
    v_cvt_pk_bf16_f32 v236, v236, v237
    v_cvt_pk_bf16_f32 v237, v238, v239
    v_mfma_f32_16x16x4_f32 v[128:131], v7, v57, 0
    v_mfma_f32_16x16x32_bf16 a[96:99], v[176:179], v[40:43], a[96:99]
    ds_read_b128 v[32:35], v23 offset:6144
    v_accvgpr_read_b32 v240, a56
    v_mfma_f32_16x16x32_bf16 a[96:99], v[184:187], v[44:47], a[96:99]
    buffer_store_dwordx2 v[236:237], v56, s[12:15], s40 offen offset:1280 sc0 sc1
    v_accvgpr_read_b32 v241, a68
    v_accvgpr_read_b32 v242, a80
    v_accvgpr_read_b32 v243, a92
    v_mfma_f32_16x16x4_f32 v[132:135], v8, v57, 0
    v_mfma_f32_16x16x32_bf16 a[144:147], v[180:183], v[40:43], a[144:147]
    ds_read_b128 v[36:39], v23 offset:18432
    v_mul_f32 v240, v240, v52
    v_mfma_f32_16x16x32_bf16 a[144:147], v[188:191], v[44:47], a[144:147]
    s_waitcnt lgkmcnt(2)
    v_max3_f32 v18, v5, v6, v7
    v_mul_f32 v241, v241, v52
    v_max_f32 v18, v18, v8
    v_mul_f32 v242, v242, v52
    s_mov_b32 s29, 0x5f800000
    v_mfma_f32_16x16x32_bf16 a[108:111], v[176:179], v[24:27], a[108:111]
    ds_read_b128 v[40:43], v23 offset:9216
    v_mul_f32 v243, v243, v52
    v_mfma_f32_16x16x32_bf16 a[108:111], v[184:187], v[28:31], a[108:111]
    v_cmp_lt_f32 s[48:49], s29, v18
    v_cvt_pk_bf16_f32 v240, v240, v241
    v_cvt_pk_bf16_f32 v241, v242, v243
    v_accvgpr_read_b32 v244, a57
    v_accvgpr_read_b32 v245, a69
    v_accvgpr_read_b32 v246, a81
    v_mfma_f32_16x16x32_bf16 a[156:159], v[180:183], v[24:27], a[156:159]
    ds_read_b128 v[44:47], v23 offset:21504
    v_accvgpr_read_b32 v247, a93
    v_mfma_f32_16x16x32_bf16 a[156:159], v[188:191], v[28:31], a[156:159]
    s_waitcnt lgkmcnt(2)
    buffer_store_dwordx2 v[240:241], v56, s[12:15], s40 offen offset:256 sc0 sc1
    v_rcp_f32 v128, v128
    v_mul_f32 v244, v244, v53
    v_mfma_f32_16x16x32_bf16 a[120:123], v[176:179], v[32:35], a[120:123]
    ds_read_b128 v[24:27], v22 offset:1024
    v_mul_f32 v245, v245, v53
    v_mfma_f32_16x16x32_bf16 a[120:123], v[184:187], v[36:39], a[120:123]
    v_rcp_f32 v129, v129
    v_rcp_f32 v130, v130
    v_rcp_f32 v131, v131
    v_mfma_f32_16x16x32_bf16 a[168:171], v[180:183], v[32:35], a[168:171]
    ds_read_b128 v[28:31], v22 offset:13312
    v_mul_f32 v246, v246, v53
    v_mfma_f32_16x16x32_bf16 a[168:171], v[188:191], v[36:39], a[168:171]
    s_waitcnt lgkmcnt(2)
    v_rcp_f32 v132, v132
    v_mul_f32 v247, v247, v53
    v_cvt_pk_bf16_f32 v244, v244, v245
    v_rcp_f32 v133, v133
    v_mfma_f32_16x16x32_bf16 a[132:135], v[176:179], v[40:43], a[132:135]
    ds_read_b128 v[32:35], v22 offset:4096
    v_cvt_pk_bf16_f32 v245, v246, v247
    v_mfma_f32_16x16x32_bf16 a[132:135], v[184:187], v[44:47], a[132:135]
    buffer_store_dwordx2 v[244:245], v56, s[12:15], s40 offen offset:640 sc0 sc1
    v_rcp_f32 v134, v134
    v_accvgpr_read_b32 v248, a58
    v_mfma_f32_16x16x32_bf16 a[180:183], v[180:183], v[40:43], a[180:183]
    ds_read_b128 v[36:39], v22 offset:16384
    v_rcp_f32 v135, v135
    v_mfma_f32_16x16x32_bf16 a[180:183], v[188:191], v[44:47], a[180:183]
    s_waitcnt lgkmcnt(2)
    v_accvgpr_read_b32 v249, a70
    v_accvgpr_read_b32 v250, a82
    v_accvgpr_read_b32 v251, a94
    v_mul_f32 v248, v248, v54
    v_mul_f32 v249, v249, v54
    v_mfma_f32_16x16x32_bf16 a[100:103], v[80:83], v[24:27], a[100:103]
    ds_read_b128 v[40:43], v22 offset:7168
    v_mul_f32 v250, v250, v54
    v_mfma_f32_16x16x32_bf16 a[100:103], v[88:91], v[28:31], a[100:103]
    v_mul_f32 v251, v251, v54
    v_cvt_pk_bf16_f32 v248, v248, v249
    v_cvt_pk_bf16_f32 v249, v250, v251
    v_accvgpr_read_b32 v252, a59
    v_accvgpr_read_b32 v253, a71
    v_accvgpr_read_b32 v254, a83
    v_mfma_f32_16x16x32_bf16 a[148:151], v[84:87], v[24:27], a[148:151]
    ds_read_b128 v[44:47], v22 offset:19456
    v_accvgpr_read_b32 v255, a95
    v_mfma_f32_16x16x32_bf16 a[148:151], v[92:95], v[28:31], a[148:151]
    s_waitcnt lgkmcnt(2)
    s_cmp_lg_u64 s[48:49], 0
    s_cbranch_scc1 L_slow
    v_mul_f32 v252, v252, v55
    v_mul_f32 v253, v253, v55
    v_mfma_f32_16x16x32_bf16 a[112:115], v[80:83], v[32:35], a[112:115]
    ds_read_b128 v[24:27], v22 offset:10240
    v_mul_f32 v254, v254, v55
    v_mfma_f32_16x16x32_bf16 a[112:115], v[88:91], v[36:39], a[112:115]
    buffer_store_dwordx2 v[248:249], v56, s[12:15], s40 offen offset:1024 sc0 sc1
    v_mul_f32 v255, v255, v55
    v_cvt_pk_bf16_f32 v252, v252, v253
    v_cvt_pk_bf16_f32 v253, v254, v255
    v_mfma_f32_16x16x32_bf16 a[160:163], v[84:87], v[32:35], a[160:163]
    ds_read_b128 v[28:31], v22 offset:22528
    v_accvgpr_read_b32 v224, a96
    v_mfma_f32_16x16x32_bf16 a[160:163], v[92:95], v[36:39], a[160:163]
    s_waitcnt lgkmcnt(2)
    buffer_store_dwordx2 v[252:253], v56, s[12:15], s40 offen offset:1408 sc0 sc1
    v_accvgpr_read_b32 v225, a108
    v_accvgpr_read_b32 v226, a120
    v_accvgpr_read_b32 v227, a132
    v_mfma_f32_16x16x32_bf16 a[124:127], v[80:83], v[40:43], a[124:127]
    ds_read_b128 v[32:35], v1 offset:1024
    v_mul_f32 v224, v224, v128
    v_mfma_f32_16x16x32_bf16 a[124:127], v[88:91], v[44:47], a[124:127]
    v_mul_f32 v225, v225, v128
    v_mul_f32 v226, v226, v128
    v_mul_f32 v227, v227, v128
    v_cvt_pk_bf16_f32 v224, v224, v225
    v_cvt_pk_bf16_f32 v225, v226, v227
    v_accvgpr_read_b32 v228, a97
    v_mfma_f32_16x16x32_bf16 a[172:175], v[84:87], v[40:43], a[172:175]
    ds_read_b128 v[36:39], v1 offset:13312
    v_accvgpr_read_b32 v229, a109
    v_mfma_f32_16x16x32_bf16 a[172:175], v[92:95], v[44:47], a[172:175]
    s_waitcnt lgkmcnt(2)
    buffer_store_dwordx2 v[224:225], v56, s[12:15], s41 offen offset:0 sc0 sc1
    v_accvgpr_read_b32 v230, a121
    v_accvgpr_read_b32 v231, a133
    v_mul_f32 v228, v228, v129
    v_mfma_f32_16x16x32_bf16 a[136:139], v[80:83], v[24:27], a[136:139]
    ds_read_b128 v[40:43], v1 offset:4096
    v_mul_f32 v229, v229, v129
    v_mfma_f32_16x16x32_bf16 a[136:139], v[88:91], v[28:31], a[136:139]
    v_mul_f32 v230, v230, v129
    v_mul_f32 v231, v231, v129
    v_cvt_pk_bf16_f32 v228, v228, v229
    v_cvt_pk_bf16_f32 v229, v230, v231
    v_accvgpr_read_b32 v232, a98
    v_accvgpr_read_b32 v233, a110
    v_mfma_f32_16x16x32_bf16 a[184:187], v[84:87], v[24:27], a[184:187]
    ds_read_b128 v[44:47], v1 offset:16384
    v_accvgpr_read_b32 v234, a122
    v_mfma_f32_16x16x32_bf16 a[184:187], v[92:95], v[28:31], a[184:187]
    s_waitcnt lgkmcnt(2)
    buffer_store_dwordx2 v[228:229], v56, s[12:15], s41 offen offset:384 sc0 sc1
    v_accvgpr_read_b32 v235, a134
    v_mul_f32 v232, v232, v130
    v_mul_f32 v233, v233, v130
    v_mfma_f32_16x16x32_bf16 a[100:103], v[160:163], v[32:35], a[100:103]
    ds_read_b128 v[24:27], v1 offset:7168
    v_mul_f32 v234, v234, v130
    v_mfma_f32_16x16x32_bf16 a[100:103], v[168:171], v[36:39], a[100:103]
    v_mul_f32 v235, v235, v130
    v_cvt_pk_bf16_f32 v232, v232, v233
    v_cvt_pk_bf16_f32 v233, v234, v235
    v_accvgpr_read_b32 v236, a99
    v_accvgpr_read_b32 v237, a111
    v_accvgpr_read_b32 v238, a123
    v_mfma_f32_16x16x32_bf16 a[148:151], v[164:167], v[32:35], a[148:151]
    ds_read_b128 v[28:31], v1 offset:19456
    v_accvgpr_read_b32 v239, a135
    v_mfma_f32_16x16x32_bf16 a[148:151], v[172:175], v[36:39], a[148:151]
    s_waitcnt lgkmcnt(2)
    buffer_store_dwordx2 v[232:233], v56, s[12:15], s41 offen offset:768 sc0 sc1
    v_mul_f32 v236, v236, v131
    v_mul_f32 v237, v237, v131
    v_mul_f32 v238, v238, v131
    v_mfma_f32_16x16x32_bf16 a[112:115], v[160:163], v[40:43], a[112:115]
    ds_read_b128 v[32:35], v1 offset:10240
    v_mul_f32 v239, v239, v131
    v_mfma_f32_16x16x32_bf16 a[112:115], v[168:171], v[44:47], a[112:115]
    v_cvt_pk_bf16_f32 v236, v236, v237
    v_cvt_pk_bf16_f32 v237, v238, v239
    v_accvgpr_read_b32 v240, a144
    v_accvgpr_read_b32 v241, a156
    v_accvgpr_read_b32 v242, a168
    v_accvgpr_read_b32 v243, a180
    v_mfma_f32_16x16x32_bf16 a[160:163], v[164:167], v[40:43], a[160:163]
    ds_read_b128 v[36:39], v1 offset:22528
    v_mul_f32 v240, v240, v132
    v_mfma_f32_16x16x32_bf16 a[160:163], v[172:175], v[44:47], a[160:163]
    s_waitcnt lgkmcnt(2)
    buffer_store_dwordx2 v[236:237], v56, s[12:15], s41 offen offset:1152 sc0 sc1
    v_mul_f32 v241, v241, v132
    v_mul_f32 v242, v242, v132
    v_mul_f32 v243, v243, v132
    v_mfma_f32_16x16x32_bf16 a[124:127], v[160:163], v[24:27], a[124:127]
    ds_read_b128 v[40:43], v23 offset:1024
    v_cvt_pk_bf16_f32 v240, v240, v241
    v_mfma_f32_16x16x32_bf16 a[124:127], v[168:171], v[28:31], a[124:127]
    v_cvt_pk_bf16_f32 v241, v242, v243
    v_accvgpr_read_b32 v244, a145
    v_accvgpr_read_b32 v245, a157
    v_accvgpr_read_b32 v246, a169
    v_accvgpr_read_b32 v247, a181
    v_mfma_f32_16x16x32_bf16 a[172:175], v[164:167], v[24:27], a[172:175]
    ds_read_b128 v[44:47], v23 offset:13312
    v_mul_f32 v244, v244, v133
    v_mfma_f32_16x16x32_bf16 a[172:175], v[172:175], v[28:31], a[172:175]
    s_waitcnt lgkmcnt(2)
    buffer_store_dwordx2 v[240:241], v56, s[12:15], s42 offen offset:0 sc0 sc1
    v_mul_f32 v245, v245, v133
    v_mul_f32 v246, v246, v133
    v_mul_f32 v247, v247, v133
    v_mfma_f32_16x16x32_bf16 a[136:139], v[160:163], v[32:35], a[136:139]
    ds_read_b128 v[24:27], v23 offset:4096
    v_cvt_pk_bf16_f32 v244, v244, v245
    v_mfma_f32_16x16x32_bf16 a[136:139], v[168:171], v[36:39], a[136:139]
    v_cvt_pk_bf16_f32 v245, v246, v247
    v_accvgpr_read_b32 v248, a146
    v_accvgpr_read_b32 v249, a158
    v_accvgpr_read_b32 v250, a170
    v_accvgpr_read_b32 v251, a182
    v_mul_f32 v248, v248, v134
    v_mfma_f32_16x16x32_bf16 a[184:187], v[164:167], v[32:35], a[184:187]
    ds_read_b128 v[28:31], v23 offset:16384
    v_mul_f32 v249, v249, v134
    v_mfma_f32_16x16x32_bf16 a[184:187], v[172:175], v[36:39], a[184:187]
    s_waitcnt lgkmcnt(2)
    buffer_store_dwordx2 v[244:245], v56, s[12:15], s42 offen offset:384 sc0 sc1
    v_mul_f32 v250, v250, v134
    v_mul_f32 v251, v251, v134
    v_cvt_pk_bf16_f32 v248, v248, v249
    v_mfma_f32_16x16x32_bf16 a[100:103], v[176:179], v[40:43], a[100:103]
    ds_read_b128 v[32:35], v23 offset:7168
    v_cvt_pk_bf16_f32 v249, v250, v251
    v_mfma_f32_16x16x32_bf16 a[100:103], v[184:187], v[44:47], a[100:103]
    buffer_store_dwordx2 v[248:249], v56, s[12:15], s42 offen offset:768 sc0 sc1
    v_accvgpr_read_b32 v252, a147
    v_accvgpr_read_b32 v253, a159
    v_accvgpr_read_b32 v254, a171
    v_mfma_f32_16x16x32_bf16 a[148:151], v[180:183], v[40:43], a[148:151]
    ds_read_b128 v[36:39], v23 offset:19456
    v_accvgpr_read_b32 v255, a183
    v_mfma_f32_16x16x32_bf16 a[148:151], v[188:191], v[44:47], a[148:151]
    s_waitcnt lgkmcnt(2)
    v_mul_f32 v252, v252, v135
    v_mul_f32 v253, v253, v135
    v_mul_f32 v254, v254, v135
    v_mul_f32 v255, v255, v135
    v_cvt_pk_bf16_f32 v252, v252, v253
    v_cvt_pk_bf16_f32 v253, v254, v255
    v_mfma_f32_16x16x32_bf16 a[112:115], v[176:179], v[24:27], a[112:115]
    ds_read_b128 v[40:43], v23 offset:10240
    v_mfma_f32_16x16x32_bf16 a[112:115], v[184:187], v[28:31], a[112:115]
    buffer_store_dwordx2 v[252:253], v56, s[12:15], s42 offen offset:1152 sc0 sc1
    v_mfma_f32_16x16x32_bf16 a[160:163], v[180:183], v[24:27], a[160:163]
    ds_read_b128 v[44:47], v23 offset:22528
    v_mfma_f32_16x16x32_bf16 a[160:163], v[188:191], v[28:31], a[160:163]
    s_waitcnt lgkmcnt(2)
    v_mfma_f32_16x16x32_bf16 a[124:127], v[176:179], v[32:35], a[124:127]
    ds_read_b128 v[24:27], v22 offset:2048
    v_mfma_f32_16x16x32_bf16 a[124:127], v[184:187], v[36:39], a[124:127]
    v_mfma_f32_16x16x32_bf16 a[172:175], v[180:183], v[32:35], a[172:175]
    ds_read_b128 v[28:31], v22 offset:14336
    v_mfma_f32_16x16x32_bf16 a[172:175], v[188:191], v[36:39], a[172:175]
    s_waitcnt lgkmcnt(2)
    v_mfma_f32_16x16x32_bf16 a[136:139], v[176:179], v[40:43], a[136:139]
    ds_read_b128 v[32:35], v22 offset:5120
    v_mfma_f32_16x16x32_bf16 a[136:139], v[184:187], v[44:47], a[136:139]
    v_mfma_f32_16x16x32_bf16 a[184:187], v[180:183], v[40:43], a[184:187]
    ds_read_b128 v[36:39], v22 offset:17408
    v_mfma_f32_16x16x32_bf16 a[184:187], v[188:191], v[44:47], a[184:187]
    s_waitcnt lgkmcnt(2)
    v_mfma_f32_16x16x32_bf16 a[104:107], v[80:83], v[24:27], a[104:107]
    ds_read_b128 v[40:43], v22 offset:8192
    v_mfma_f32_16x16x32_bf16 a[104:107], v[88:91], v[28:31], a[104:107]
    v_mfma_f32_16x16x32_bf16 a[152:155], v[84:87], v[24:27], a[152:155]
    ds_read_b128 v[44:47], v22 offset:20480
    v_mfma_f32_16x16x32_bf16 a[152:155], v[92:95], v[28:31], a[152:155]
    s_waitcnt lgkmcnt(2)
    v_mfma_f32_16x16x32_bf16 a[116:119], v[80:83], v[32:35], a[116:119]
    ds_read_b128 v[24:27], v22 offset:11264
    v_accvgpr_read_b32 v224, a100
    v_mfma_f32_16x16x32_bf16 a[116:119], v[88:91], v[36:39], a[116:119]
    v_accvgpr_read_b32 v225, a112
    v_accvgpr_read_b32 v226, a124
    v_accvgpr_read_b32 v227, a136
    v_mul_f32 v224, v224, v128
    v_mul_f32 v225, v225, v128
    v_mul_f32 v226, v226, v128
    v_mul_f32 v227, v227, v128
    v_cvt_pk_bf16_f32 v224, v224, v225
    v_cvt_pk_bf16_f32 v225, v226, v227
    v_accvgpr_read_b32 v228, a101
    v_accvgpr_read_b32 v229, a113
    v_accvgpr_read_b32 v230, a125
    v_accvgpr_read_b32 v231, a137
    v_mul_f32 v228, v228, v129
    v_mul_f32 v229, v229, v129
    v_mul_f32 v230, v230, v129
    v_mul_f32 v231, v231, v129
    v_cvt_pk_bf16_f32 v228, v228, v229
    v_cvt_pk_bf16_f32 v229, v230, v231
    v_accvgpr_read_b32 v232, a102
    v_accvgpr_read_b32 v233, a114
    v_accvgpr_read_b32 v234, a126
    v_accvgpr_read_b32 v235, a138
    v_mul_f32 v232, v232, v130
    v_mul_f32 v233, v233, v130
    v_mul_f32 v234, v234, v130
    v_mul_f32 v235, v235, v130
    v_cvt_pk_bf16_f32 v232, v232, v233
    v_cvt_pk_bf16_f32 v233, v234, v235
    v_accvgpr_read_b32 v236, a103
    v_accvgpr_read_b32 v237, a115
    v_accvgpr_read_b32 v238, a127
    v_accvgpr_read_b32 v239, a139
    v_mul_f32 v236, v236, v131
    v_mul_f32 v237, v237, v131
    v_mul_f32 v238, v238, v131
    v_mfma_f32_16x16x32_bf16 a[164:167], v[84:87], v[32:35], a[164:167]
    ds_read_b128 v[28:31], v22 offset:23552
    v_mul_f32 v239, v239, v131
    v_mfma_f32_16x16x32_bf16 a[164:167], v[92:95], v[36:39], a[164:167]
    s_waitcnt lgkmcnt(2)
    buffer_store_dwordx2 v[224:225], v56, s[12:15], s41 offen offset:128 sc0 sc1
    v_cvt_pk_bf16_f32 v236, v236, v237
    v_cvt_pk_bf16_f32 v237, v238, v239
    v_accvgpr_read_b32 v240, a148
    v_mfma_f32_16x16x32_bf16 a[128:131], v[80:83], v[40:43], a[128:131]
    ds_read_b128 v[32:35], v1 offset:2048
    v_accvgpr_read_b32 v241, a160
    v_mfma_f32_16x16x32_bf16 a[128:131], v[88:91], v[44:47], a[128:131]
    buffer_store_dwordx2 v[228:229], v56, s[12:15], s41 offen offset:512 sc0 sc1
    v_accvgpr_read_b32 v242, a172
    v_accvgpr_read_b32 v243, a184
    v_mul_f32 v240, v240, v132
    v_mfma_f32_16x16x32_bf16 a[176:179], v[84:87], v[40:43], a[176:179]
    ds_read_b128 v[36:39], v1 offset:14336
    v_mul_f32 v241, v241, v132
    v_mfma_f32_16x16x32_bf16 a[176:179], v[92:95], v[44:47], a[176:179]
    s_waitcnt lgkmcnt(2)
    buffer_store_dwordx2 v[232:233], v56, s[12:15], s41 offen offset:896 sc0 sc1
    v_mul_f32 v242, v242, v132
    v_mul_f32 v243, v243, v132
    v_cvt_pk_bf16_f32 v240, v240, v241
    v_mfma_f32_16x16x32_bf16 a[140:143], v[80:83], v[24:27], a[140:143]
    ds_read_b128 v[40:43], v1 offset:5120
    v_cvt_pk_bf16_f32 v241, v242, v243
    v_mfma_f32_16x16x32_bf16 a[140:143], v[88:91], v[28:31], a[140:143]
    buffer_store_dwordx2 v[236:237], v56, s[12:15], s41 offen offset:1280 sc0 sc1
    v_accvgpr_read_b32 v244, a149
    v_accvgpr_read_b32 v245, a161
    v_accvgpr_read_b32 v246, a173
    v_mfma_f32_16x16x32_bf16 a[188:191], v[84:87], v[24:27], a[188:191]
    ds_read_b128 v[44:47], v1 offset:17408
    v_accvgpr_read_b32 v247, a185
    v_mfma_f32_16x16x32_bf16 a[188:191], v[92:95], v[28:31], a[188:191]
    s_waitcnt lgkmcnt(2)
    buffer_store_dwordx2 v[240:241], v56, s[12:15], s42 offen offset:128 sc0 sc1
    v_mul_f32 v244, v244, v133
    v_mul_f32 v245, v245, v133
    v_mul_f32 v246, v246, v133
    v_mfma_f32_16x16x32_bf16 a[104:107], v[160:163], v[32:35], a[104:107]
    ds_read_b128 v[24:27], v1 offset:8192
    v_mul_f32 v247, v247, v133
    v_mfma_f32_16x16x32_bf16 a[104:107], v[168:171], v[36:39], a[104:107]
    v_cvt_pk_bf16_f32 v244, v244, v245
    v_cvt_pk_bf16_f32 v245, v246, v247
    v_accvgpr_read_b32 v248, a150
    v_accvgpr_read_b32 v249, a162
    v_accvgpr_read_b32 v250, a174
    v_accvgpr_read_b32 v251, a186
    v_mfma_f32_16x16x32_bf16 a[152:155], v[164:167], v[32:35], a[152:155]
    ds_read_b128 v[28:31], v1 offset:20480
    v_mul_f32 v248, v248, v134
    v_mfma_f32_16x16x32_bf16 a[152:155], v[172:175], v[36:39], a[152:155]
    s_waitcnt lgkmcnt(2)
    buffer_store_dwordx2 v[244:245], v56, s[12:15], s42 offen offset:512 sc0 sc1
    v_mul_f32 v249, v249, v134
    v_mul_f32 v250, v250, v134
    v_mul_f32 v251, v251, v134
    v_mfma_f32_16x16x32_bf16 a[116:119], v[160:163], v[40:43], a[116:119]
    ds_read_b128 v[32:35], v1 offset:11264
    v_cvt_pk_bf16_f32 v248, v248, v249
    v_mfma_f32_16x16x32_bf16 a[116:119], v[168:171], v[44:47], a[116:119]
    v_cvt_pk_bf16_f32 v249, v250, v251
    v_accvgpr_read_b32 v252, a151
    v_accvgpr_read_b32 v253, a163
    v_accvgpr_read_b32 v254, a175
    v_accvgpr_read_b32 v255, a187
    v_mul_f32 v252, v252, v135
    v_mfma_f32_16x16x32_bf16 a[164:167], v[164:167], v[40:43], a[164:167]
    ds_read_b128 v[36:39], v1 offset:23552
    v_mul_f32 v253, v253, v135
    v_mfma_f32_16x16x32_bf16 a[164:167], v[172:175], v[44:47], a[164:167]
    s_waitcnt lgkmcnt(2)
    buffer_store_dwordx2 v[248:249], v56, s[12:15], s42 offen offset:896 sc0 sc1
    v_mul_f32 v254, v254, v135
    v_mul_f32 v255, v255, v135
    v_cvt_pk_bf16_f32 v252, v252, v253
    v_mfma_f32_16x16x32_bf16 a[128:131], v[160:163], v[24:27], a[128:131]
    ds_read_b128 v[40:43], v23 offset:2048
    v_cvt_pk_bf16_f32 v253, v254, v255
    v_mfma_f32_16x16x32_bf16 a[128:131], v[168:171], v[28:31], a[128:131]
    buffer_store_dwordx2 v[252:253], v56, s[12:15], s42 offen offset:1280 sc0 sc1
    v_mfma_f32_16x16x32_bf16 a[176:179], v[164:167], v[24:27], a[176:179]
    ds_read_b128 v[44:47], v23 offset:14336
    v_mfma_f32_16x16x32_bf16 a[176:179], v[172:175], v[28:31], a[176:179]
    s_waitcnt lgkmcnt(2)
    v_mfma_f32_16x16x32_bf16 a[140:143], v[160:163], v[32:35], a[140:143]
    ds_read_b128 v[24:27], v23 offset:5120
    v_mfma_f32_16x16x32_bf16 a[140:143], v[168:171], v[36:39], a[140:143]
    v_mfma_f32_16x16x32_bf16 a[188:191], v[164:167], v[32:35], a[188:191]
    ds_read_b128 v[28:31], v23 offset:17408
    v_mfma_f32_16x16x32_bf16 a[188:191], v[172:175], v[36:39], a[188:191]
    s_waitcnt lgkmcnt(2)
    v_mfma_f32_16x16x32_bf16 a[104:107], v[176:179], v[40:43], a[104:107]
    ds_read_b128 v[32:35], v23 offset:8192
    v_mfma_f32_16x16x32_bf16 a[104:107], v[184:187], v[44:47], a[104:107]
    v_mfma_f32_16x16x32_bf16 a[152:155], v[180:183], v[40:43], a[152:155]
    ds_read_b128 v[36:39], v23 offset:20480
    v_mfma_f32_16x16x32_bf16 a[152:155], v[188:191], v[44:47], a[152:155]
    s_waitcnt lgkmcnt(2)
    v_mfma_f32_16x16x32_bf16 a[116:119], v[176:179], v[24:27], a[116:119]
    ds_read_b128 v[40:43], v23 offset:11264
    v_mfma_f32_16x16x32_bf16 a[116:119], v[184:187], v[28:31], a[116:119]
    v_mfma_f32_16x16x32_bf16 a[164:167], v[180:183], v[24:27], a[164:167]
    ds_read_b128 v[44:47], v23 offset:23552
    v_mfma_f32_16x16x32_bf16 a[164:167], v[188:191], v[28:31], a[164:167]
    s_waitcnt lgkmcnt(2)
    v_mfma_f32_16x16x32_bf16 a[128:131], v[176:179], v[32:35], a[128:131]
    v_mfma_f32_16x16x32_bf16 a[128:131], v[184:187], v[36:39], a[128:131]
    v_mfma_f32_16x16x32_bf16 a[176:179], v[180:183], v[32:35], a[176:179]
    v_mfma_f32_16x16x32_bf16 a[176:179], v[188:191], v[36:39], a[176:179]
    s_waitcnt lgkmcnt(0)
    v_mfma_f32_16x16x32_bf16 a[140:143], v[176:179], v[40:43], a[140:143]
    v_mfma_f32_16x16x32_bf16 a[140:143], v[184:187], v[44:47], a[140:143]
    v_mfma_f32_16x16x32_bf16 a[188:191], v[180:183], v[40:43], a[188:191]
    v_mfma_f32_16x16x32_bf16 a[188:191], v[188:191], v[44:47], a[188:191]
    s_nop 7
    v_accvgpr_read_b32 v224, a104
    v_accvgpr_read_b32 v225, a116
    v_accvgpr_read_b32 v226, a128
    v_accvgpr_read_b32 v227, a140
    v_pk_mul_f32 v[224:225], v[224:225], v[128:129] op_sel_hi:[1,0]
    v_pk_mul_f32 v[226:227], v[226:227], v[128:129] op_sel_hi:[1,0]
    v_cvt_pk_bf16_f32 v224, v224, v225
    v_cvt_pk_bf16_f32 v225, v226, v227
    v_accvgpr_read_b32 v228, a105
    v_accvgpr_read_b32 v229, a117
    v_accvgpr_read_b32 v230, a129
    v_accvgpr_read_b32 v231, a141
    v_pk_mul_f32 v[228:229], v[228:229], v[128:129] op_sel:[0,1] op_sel_hi:[1,1]
    v_pk_mul_f32 v[230:231], v[230:231], v[128:129] op_sel:[0,1] op_sel_hi:[1,1]
    v_cvt_pk_bf16_f32 v228, v228, v229
    v_cvt_pk_bf16_f32 v229, v230, v231
    buffer_store_dwordx2 v[224:225], v56, s[12:15], s41 offen offset:256 sc0 sc1
    v_accvgpr_read_b32 v232, a106
    v_accvgpr_read_b32 v233, a118
    v_accvgpr_read_b32 v234, a130
    v_accvgpr_read_b32 v235, a142
    v_pk_mul_f32 v[232:233], v[232:233], v[130:131] op_sel_hi:[1,0]
    v_pk_mul_f32 v[234:235], v[234:235], v[130:131] op_sel_hi:[1,0]
    v_cvt_pk_bf16_f32 v232, v232, v233
    v_cvt_pk_bf16_f32 v233, v234, v235
    buffer_store_dwordx2 v[228:229], v56, s[12:15], s41 offen offset:640 sc0 sc1
    v_accvgpr_read_b32 v236, a107
    v_accvgpr_read_b32 v237, a119
    v_accvgpr_read_b32 v238, a131
    v_accvgpr_read_b32 v239, a143
    v_pk_mul_f32 v[236:237], v[236:237], v[130:131] op_sel:[0,1] op_sel_hi:[1,1]
    v_pk_mul_f32 v[238:239], v[238:239], v[130:131] op_sel:[0,1] op_sel_hi:[1,1]
    v_cvt_pk_bf16_f32 v236, v236, v237
    v_cvt_pk_bf16_f32 v237, v238, v239
    buffer_store_dwordx2 v[232:233], v56, s[12:15], s41 offen offset:1024 sc0 sc1
    buffer_store_dwordx2 v[236:237], v56, s[12:15], s41 offen offset:1408 sc0 sc1
    v_accvgpr_read_b32 v240, a152
    v_accvgpr_read_b32 v241, a164
    v_accvgpr_read_b32 v242, a176
    v_accvgpr_read_b32 v243, a188
    v_pk_mul_f32 v[240:241], v[240:241], v[132:133] op_sel_hi:[1,0]
    v_pk_mul_f32 v[242:243], v[242:243], v[132:133] op_sel_hi:[1,0]
    v_cvt_pk_bf16_f32 v240, v240, v241
    v_cvt_pk_bf16_f32 v241, v242, v243
    v_accvgpr_read_b32 v244, a153
    v_accvgpr_read_b32 v245, a165
    v_accvgpr_read_b32 v246, a177
    v_accvgpr_read_b32 v247, a189
    v_pk_mul_f32 v[244:245], v[244:245], v[132:133] op_sel:[0,1] op_sel_hi:[1,1]
    v_pk_mul_f32 v[246:247], v[246:247], v[132:133] op_sel:[0,1] op_sel_hi:[1,1]
    v_cvt_pk_bf16_f32 v244, v244, v245
    v_cvt_pk_bf16_f32 v245, v246, v247
    buffer_store_dwordx2 v[240:241], v56, s[12:15], s42 offen offset:256 sc0 sc1
    v_accvgpr_read_b32 v248, a154
    v_accvgpr_read_b32 v249, a166
    v_accvgpr_read_b32 v250, a178
    v_accvgpr_read_b32 v251, a190
    v_pk_mul_f32 v[248:249], v[248:249], v[134:135] op_sel_hi:[1,0]
    v_pk_mul_f32 v[250:251], v[250:251], v[134:135] op_sel_hi:[1,0]
    v_cvt_pk_bf16_f32 v248, v248, v249
    v_cvt_pk_bf16_f32 v249, v250, v251
    buffer_store_dwordx2 v[244:245], v56, s[12:15], s42 offen offset:640 sc0 sc1
    v_accvgpr_read_b32 v252, a155
    v_accvgpr_read_b32 v253, a167
    v_accvgpr_read_b32 v254, a179
    v_accvgpr_read_b32 v255, a191
    v_pk_mul_f32 v[252:253], v[252:253], v[134:135] op_sel:[0,1] op_sel_hi:[1,1]
    v_pk_mul_f32 v[254:255], v[254:255], v[134:135] op_sel:[0,1] op_sel_hi:[1,1]
    v_cvt_pk_bf16_f32 v252, v252, v253
    v_cvt_pk_bf16_f32 v253, v254, v255
    buffer_store_dwordx2 v[248:249], v56, s[12:15], s42 offen offset:1024 sc0 sc1
    buffer_store_dwordx2 v[252:253], v56, s[12:15], s42 offen offset:1408 sc0 sc1
L_fin:
L_done:
    s_endpgm
L_pollslow0:
    s_mov_b32 s59, 60
L_pollsm0:
    s_buffer_load_dwordx8 s[48:55], s[20:23], s44 glc
    s_waitcnt lgkmcnt(0)
    s_sub_u32 s48, s48, s92
    s_sub_u32 s49, s49, s92
    s_sub_u32 s50, s50, s92
    s_sub_u32 s51, s51, s92
    s_sub_u32 s52, s52, s92
    s_sub_u32 s53, s53, s92
    s_sub_u32 s54, s54, s92
    s_sub_u32 s55, s55, s92
    s_max_u32 s48, s48, s49
    s_max_u32 s48, s48, s50
    s_max_u32 s48, s48, s51
    s_max_u32 s48, s48, s52
    s_max_u32 s48, s48, s53
    s_max_u32 s48, s48, s54
    s_max_u32 s48, s48, s55
    s_cmp_lt_u32 s48, 16
    s_cbranch_scc1 L_pollok0
    s_sub_u32 s59, s59, 1
    s_cbranch_scc1 L_pollvec0
    s_sleep 1
    s_branch L_pollsm0
L_pollvec0:
    v_bfe_u32 v53, v4, 4, 6
    v_lshlrev_b32 v53, 2, v53
    s_sub_u32 s96, s96, 1
    s_cbranch_scc1 L_pollgiveup0
    s_sleep 2
    buffer_load_dword v52, v53, s[20:23], s44 offen sc1
    s_waitcnt vmcnt(0)
    s_bitcmp1_b32 s92, 9
    s_cbranch_scc1 L_nomix
    v_xor_b32 v53, s92, v52
    v_lshrrev_b32 v53, 5, v53
    v_add_u32 v53, -1, v53
    v_cmp_gt_u32 vcc, 31, v53
    s_nop 1
    s_and_b32 s59, vcc_lo, 0xff
    s_cbranch_scc0 L_nomix
    buffer_store_dwordx4 v[224:227], v11, s[4:7], s33 offen offset:0 sc1
    v_xor_b32 v55, 16, v11
    buffer_store_dwordx4 v[228:231], v55, s[4:7], s33 offen offset:768 sc1
    v_xor_b32 v54, 32, v11
    buffer_store_dwordx4 v[232:235], v54, s[4:7], s33 offen offset:1536 sc1
    v_xor_b32 v55, 48, v11
    buffer_store_dwordx4 v[236:239], v55, s[4:7], s33 offen offset:2304 sc1
    buffer_store_dwordx4 v[112:115], v15, s[4:7], s35 offen offset:0 sc1
    buffer_store_dwordx4 v[116:119], v15, s[4:7], s35 offen offset:3072 sc1
    buffer_store_dwordx4 v[120:123], v15, s[4:7], s17 offen offset:0 sc1
    buffer_store_dwordx4 v[124:127], v15, s[4:7], s17 offen offset:3072 sc1
    s_waitcnt vmcnt(0)
    s_barrier
    s_and_b32 s92, s92, 0xfffffc00
    s_add_u32 s92, s92, 512
    v_mov_b32 v0, s92
    s_add_u32 s92, s92, 1
    s_mov_b32 s44, 32
    v_add_u32 v0, 1, v0
    buffer_store_dword v0, v13, s[20:23], 0 offen offset:32 sc1
    s_branch L_pollvec0
L_nomix:
    v_subrev_u32 v52, s92, v52
    v_cmp_lt_u32 vcc, 15, v52
    s_nop 0
    s_and_b32 s59, vcc_lo, 0xff
    s_cbranch_scc1 L_pollvec0
    s_branch L_pollok0
L_pollgiveup0:
    s_mov_b32 s96, 0
    s_branch L_pollok0
L_pollslow1:
    s_mov_b32 s59, 200
L_pollsm1:
    s_buffer_load_dwordx8 s[48:55], s[20:23], s44 glc
    s_waitcnt lgkmcnt(0)
    s_sub_u32 s48, s48, s92
    s_sub_u32 s49, s49, s92
    s_sub_u32 s50, s50, s92
    s_sub_u32 s51, s51, s92
    s_sub_u32 s52, s52, s92
    s_sub_u32 s53, s53, s92
    s_sub_u32 s54, s54, s92
    s_sub_u32 s55, s55, s92
    s_max_u32 s48, s48, s49
    s_max_u32 s48, s48, s50
    s_max_u32 s48, s48, s51
    s_max_u32 s48, s48, s52
    s_max_u32 s48, s48, s53
    s_max_u32 s48, s48, s54
    s_max_u32 s48, s48, s55
    s_cmp_lt_u32 s48, 16
    s_cbranch_scc1 L_pollok1
    s_sub_u32 s59, s59, 1
    s_cbranch_scc1 L_pollvec1
    s_sleep 1
    s_branch L_pollsm1
L_pollvec1:
    v_bfe_u32 v53, v4, 4, 6
    v_lshlrev_b32 v53, 2, v53
    s_sub_u32 s96, s96, 1
    s_cbranch_scc1 L_pollgiveup1
    s_sleep 2
    buffer_load_dword v52, v53, s[20:23], s44 offen sc1
    s_waitcnt vmcnt(0)
    v_subrev_u32 v52, s92, v52
    v_cmp_lt_u32 vcc, 15, v52
    s_nop 0
    s_and_b32 s59, vcc_lo, 0xff
    s_cbranch_scc1 L_pollvec1
    s_branch L_pollok1
L_pollgiveup1:
    s_mov_b32 s96, 0
    s_branch L_pollok1
L_pollslow2:
    s_mov_b32 s59, 200
L_pollsm2:
    s_buffer_load_dwordx8 s[48:55], s[20:23], s44 glc
    s_waitcnt lgkmcnt(0)
    s_sub_u32 s48, s48, s92
    s_sub_u32 s49, s49, s92
    s_sub_u32 s50, s50, s92
    s_sub_u32 s51, s51, s92
    s_sub_u32 s52, s52, s92
    s_sub_u32 s53, s53, s92
    s_sub_u32 s54, s54, s92
    s_sub_u32 s55, s55, s92
    s_max_u32 s48, s48, s49
    s_max_u32 s48, s48, s50
    s_max_u32 s48, s48, s51
    s_max_u32 s48, s48, s52
    s_max_u32 s48, s48, s53
    s_max_u32 s48, s48, s54
    s_max_u32 s48, s48, s55
    s_cmp_lt_u32 s48, 16
    s_cbranch_scc1 L_pollok2
    s_sub_u32 s59, s59, 1
    s_cbranch_scc1 L_pollvec2
    s_sleep 1
    s_branch L_pollsm2
L_pollvec2:
    v_bfe_u32 v53, v4, 4, 6
    v_lshlrev_b32 v53, 2, v53
    s_sub_u32 s96, s96, 1
    s_cbranch_scc1 L_pollgiveup2
    s_sleep 2
    buffer_load_dword v52, v53, s[20:23], s44 offen sc1
    s_waitcnt vmcnt(0)
    v_subrev_u32 v52, s92, v52
    v_cmp_lt_u32 vcc, 15, v52
    s_nop 0
    s_and_b32 s59, vcc_lo, 0xff
    s_cbranch_scc1 L_pollvec2
    s_branch L_pollok2
L_pollgiveup2:
    s_mov_b32 s96, 0
    s_branch L_pollok2
L_tagslow:
    s_sub_u32 s96, s96, 1
    s_cbranch_scc1 L_taggiveup
    s_sleep 2
    buffer_load_dword v0, off, s[88:91], s93 sc1
    s_waitcnt vmcnt(0)
    v_readfirstlane_b32 s42, v0
    s_nop 0
    s_cmp_eq_u32 s42, s46
    s_cbranch_scc1 L_tagslow
    s_cmp_eq_u32 s42, 0
    s_cbranch_scc1 L_tagslow
    s_branch L_tagok
L_taggiveup:
    s_mov_b32 s96, 0
    s_branch L_tagok
L_slow:
    s_waitcnt vmcnt(0) lgkmcnt(0)
    s_nop 15
    v_accvgpr_write_b32 a0, 0
    v_accvgpr_write_b32 a1, 0
    v_accvgpr_write_b32 a2, 0
    v_accvgpr_write_b32 a3, 0
    v_accvgpr_write_b32 a4, 0
    v_accvgpr_write_b32 a5, 0
    v_accvgpr_write_b32 a6, 0
    v_accvgpr_write_b32 a7, 0
    v_accvgpr_write_b32 a8, 0
    v_accvgpr_write_b32 a9, 0
    v_accvgpr_write_b32 a10, 0
    v_accvgpr_write_b32 a11, 0
    v_accvgpr_write_b32 a12, 0
    v_accvgpr_write_b32 a13, 0
    v_accvgpr_write_b32 a14, 0
    v_accvgpr_write_b32 a15, 0
    v_accvgpr_write_b32 a16, 0
    v_accvgpr_write_b32 a17, 0
    v_accvgpr_write_b32 a18, 0
    v_accvgpr_write_b32 a19, 0
    v_accvgpr_write_b32 a20, 0
    v_accvgpr_write_b32 a21, 0
    v_accvgpr_write_b32 a22, 0
    v_accvgpr_write_b32 a23, 0
    v_accvgpr_write_b32 a24, 0
    v_accvgpr_write_b32 a25, 0
    v_accvgpr_write_b32 a26, 0
    v_accvgpr_write_b32 a27, 0
    v_accvgpr_write_b32 a28, 0
    v_accvgpr_write_b32 a29, 0
    v_accvgpr_write_b32 a30, 0
    v_accvgpr_write_b32 a31, 0
    v_accvgpr_write_b32 a32, 0
    v_accvgpr_write_b32 a33, 0
    v_accvgpr_write_b32 a34, 0
    v_accvgpr_write_b32 a35, 0
    v_accvgpr_write_b32 a36, 0
    v_accvgpr_write_b32 a37, 0
    v_accvgpr_write_b32 a38, 0
    v_accvgpr_write_b32 a39, 0
    v_accvgpr_write_b32 a40, 0
    v_accvgpr_write_b32 a41, 0
    v_accvgpr_write_b32 a42, 0
    v_accvgpr_write_b32 a43, 0
    v_accvgpr_write_b32 a44, 0
    v_accvgpr_write_b32 a45, 0
    v_accvgpr_write_b32 a46, 0
    v_accvgpr_write_b32 a47, 0
    v_accvgpr_write_b32 a48, 0
    v_accvgpr_write_b32 a49, 0
    v_accvgpr_write_b32 a50, 0
    v_accvgpr_write_b32 a51, 0
    v_accvgpr_write_b32 a52, 0
    v_accvgpr_write_b32 a53, 0
    v_accvgpr_write_b32 a54, 0
    v_accvgpr_write_b32 a55, 0
    v_accvgpr_write_b32 a56, 0
    v_accvgpr_write_b32 a57, 0
    v_accvgpr_write_b32 a58, 0
    v_accvgpr_write_b32 a59, 0
    v_accvgpr_write_b32 a60, 0
    v_accvgpr_write_b32 a61, 0
    v_accvgpr_write_b32 a62, 0
    v_accvgpr_write_b32 a63, 0
    v_accvgpr_write_b32 a64, 0
    v_accvgpr_write_b32 a65, 0
    v_accvgpr_write_b32 a66, 0
    v_accvgpr_write_b32 a67, 0
    v_accvgpr_write_b32 a68, 0
    v_accvgpr_write_b32 a69, 0
    v_accvgpr_write_b32 a70, 0
    v_accvgpr_write_b32 a71, 0
    v_accvgpr_write_b32 a72, 0
    v_accvgpr_write_b32 a73, 0
    v_accvgpr_write_b32 a74, 0
    v_accvgpr_write_b32 a75, 0
    v_accvgpr_write_b32 a76, 0
    v_accvgpr_write_b32 a77, 0
    v_accvgpr_write_b32 a78, 0
    v_accvgpr_write_b32 a79, 0
    v_accvgpr_write_b32 a80, 0
    v_accvgpr_write_b32 a81, 0
    v_accvgpr_write_b32 a82, 0
    v_accvgpr_write_b32 a83, 0
    v_accvgpr_write_b32 a84, 0
    v_accvgpr_write_b32 a85, 0
    v_accvgpr_write_b32 a86, 0
    v_accvgpr_write_b32 a87, 0
    v_accvgpr_write_b32 a88, 0
    v_accvgpr_write_b32 a89, 0
    v_accvgpr_write_b32 a90, 0
    v_accvgpr_write_b32 a91, 0
    v_accvgpr_write_b32 a92, 0
    v_accvgpr_write_b32 a93, 0
    v_accvgpr_write_b32 a94, 0
    v_accvgpr_write_b32 a95, 0
    v_accvgpr_write_b32 a96, 0
    v_accvgpr_write_b32 a97, 0
    v_accvgpr_write_b32 a98, 0
    v_accvgpr_write_b32 a99, 0
    v_accvgpr_write_b32 a100, 0
    v_accvgpr_write_b32 a101, 0
    v_accvgpr_write_b32 a102, 0
    v_accvgpr_write_b32 a103, 0
    v_accvgpr_write_b32 a104, 0
    v_accvgpr_write_b32 a105, 0
    v_accvgpr_write_b32 a106, 0
    v_accvgpr_write_b32 a107, 0
    v_accvgpr_write_b32 a108, 0
    v_accvgpr_write_b32 a109, 0
    v_accvgpr_write_b32 a110, 0
    v_accvgpr_write_b32 a111, 0
    v_accvgpr_write_b32 a112, 0
    v_accvgpr_write_b32 a113, 0
    v_accvgpr_write_b32 a114, 0
    v_accvgpr_write_b32 a115, 0
    v_accvgpr_write_b32 a116, 0
    v_accvgpr_write_b32 a117, 0
    v_accvgpr_write_b32 a118, 0
    v_accvgpr_write_b32 a119, 0
    v_accvgpr_write_b32 a120, 0
    v_accvgpr_write_b32 a121, 0
    v_accvgpr_write_b32 a122, 0
    v_accvgpr_write_b32 a123, 0
    v_accvgpr_write_b32 a124, 0
    v_accvgpr_write_b32 a125, 0
    v_accvgpr_write_b32 a126, 0
    v_accvgpr_write_b32 a127, 0
    v_accvgpr_write_b32 a128, 0
    v_accvgpr_write_b32 a129, 0
    v_accvgpr_write_b32 a130, 0
    v_accvgpr_write_b32 a131, 0
    v_accvgpr_write_b32 a132, 0
    v_accvgpr_write_b32 a133, 0
    v_accvgpr_write_b32 a134, 0
    v_accvgpr_write_b32 a135, 0
    v_accvgpr_write_b32 a136, 0
    v_accvgpr_write_b32 a137, 0
    v_accvgpr_write_b32 a138, 0
    v_accvgpr_write_b32 a139, 0
    v_accvgpr_write_b32 a140, 0
    v_accvgpr_write_b32 a141, 0
    v_accvgpr_write_b32 a142, 0
    v_accvgpr_write_b32 a143, 0
    v_accvgpr_write_b32 a144, 0
    v_accvgpr_write_b32 a145, 0
    v_accvgpr_write_b32 a146, 0
    v_accvgpr_write_b32 a147, 0
    v_accvgpr_write_b32 a148, 0
    v_accvgpr_write_b32 a149, 0
    v_accvgpr_write_b32 a150, 0
    v_accvgpr_write_b32 a151, 0
    v_accvgpr_write_b32 a152, 0
    v_accvgpr_write_b32 a153, 0
    v_accvgpr_write_b32 a154, 0
    v_accvgpr_write_b32 a155, 0
    v_accvgpr_write_b32 a156, 0
    v_accvgpr_write_b32 a157, 0
    v_accvgpr_write_b32 a158, 0
    v_accvgpr_write_b32 a159, 0
    v_accvgpr_write_b32 a160, 0
    v_accvgpr_write_b32 a161, 0
    v_accvgpr_write_b32 a162, 0
    v_accvgpr_write_b32 a163, 0
    v_accvgpr_write_b32 a164, 0
    v_accvgpr_write_b32 a165, 0
    v_accvgpr_write_b32 a166, 0
    v_accvgpr_write_b32 a167, 0
    v_accvgpr_write_b32 a168, 0
    v_accvgpr_write_b32 a169, 0
    v_accvgpr_write_b32 a170, 0
    v_accvgpr_write_b32 a171, 0
    v_accvgpr_write_b32 a172, 0
    v_accvgpr_write_b32 a173, 0
    v_accvgpr_write_b32 a174, 0
    v_accvgpr_write_b32 a175, 0
    v_accvgpr_write_b32 a176, 0
    v_accvgpr_write_b32 a177, 0
    v_accvgpr_write_b32 a178, 0
    v_accvgpr_write_b32 a179, 0
    v_accvgpr_write_b32 a180, 0
    v_accvgpr_write_b32 a181, 0
    v_accvgpr_write_b32 a182, 0
    v_accvgpr_write_b32 a183, 0
    v_accvgpr_write_b32 a184, 0
    v_accvgpr_write_b32 a185, 0
    v_accvgpr_write_b32 a186, 0
    v_accvgpr_write_b32 a187, 0
    v_accvgpr_write_b32 a188, 0
    v_accvgpr_write_b32 a189, 0
    v_accvgpr_write_b32 a190, 0
    v_accvgpr_write_b32 a191, 0
    v_mov_b32 v5, 0
    v_mov_b32 v240, 0xff7fffff
    v_mov_b32 v6, 0
    v_mov_b32 v241, 0xff7fffff
    v_mov_b32 v7, 0
    v_mov_b32 v242, 0xff7fffff
    v_mov_b32 v8, 0
    v_mov_b32 v243, 0xff7fffff
    v_subrev_u32 v244, 49152, v2
    v_subrev_u32 v245, 49152, v3
    v_subrev_u32 v246, 24576, v1
    s_mov_b32 s48, 0
L_slowloop:
    s_add_u32 s49, s48, 6144
    s_add_u32 s50, s48, 12288
    s_add_u32 s51, s48, 16384
    s_add_u32 s52, s48, 20480
    buffer_load_dwordx4 v[64:67], v244, s[4:7], s48 offen offset:0 sc1
    buffer_load_dwordx4 v[68:71], v245, s[4:7], s48 offen offset:0 sc1
    buffer_load_dwordx4 v[72:75], v244, s[4:7], s49 offen offset:0 sc1
    buffer_load_dwordx4 v[76:79], v245, s[4:7], s49 offen offset:0 sc1
    buffer_load_dwordx4 v[80:83], v244, s[4:7], s48 offen offset:128 sc1
    buffer_load_dwordx4 v[84:87], v245, s[4:7], s48 offen offset:128 sc1
    buffer_load_dwordx4 v[88:91], v244, s[4:7], s49 offen offset:128 sc1
    buffer_load_dwordx4 v[92:95], v245, s[4:7], s49 offen offset:128 sc1
    buffer_load_dwordx4 v[96:99], v244, s[4:7], s48 offen offset:256 sc1
    buffer_load_dwordx4 v[100:103], v245, s[4:7], s48 offen offset:256 sc1
    buffer_load_dwordx4 v[104:107], v244, s[4:7], s49 offen offset:256 sc1
    buffer_load_dwordx4 v[108:111], v245, s[4:7], s49 offen offset:256 sc1
    buffer_load_dwordx4 v[112:115], v246, s[4:7], s50 offen offset:0 sc1
    buffer_load_dwordx4 v[116:119], v246, s[4:7], s50 offen offset:1024 sc1
    buffer_load_dwordx4 v[120:123], v246, s[4:7], s50 offen offset:2048 sc1
    buffer_load_dwordx4 v[124:127], v246, s[4:7], s50 offen offset:3072 sc1
    buffer_load_dwordx4 v[128:131], v246, s[4:7], s51 offen offset:0 sc1
    buffer_load_dwordx4 v[132:135], v246, s[4:7], s51 offen offset:1024 sc1
    buffer_load_dwordx4 v[136:139], v246, s[4:7], s51 offen offset:2048 sc1
    buffer_load_dwordx4 v[140:143], v246, s[4:7], s51 offen offset:3072 sc1
    buffer_load_dwordx4 v[144:147], v246, s[4:7], s52 offen offset:0 sc1
    buffer_load_dwordx4 v[148:151], v246, s[4:7], s52 offen offset:1024 sc1
    buffer_load_dwordx4 v[152:155], v246, s[4:7], s52 offen offset:2048 sc1
    buffer_load_dwordx4 v[156:159], v246, s[4:7], s52 offen offset:3072 sc1
    s_waitcnt vmcnt(12)
    v_mfma_f32_16x16x32_bf16 v[160:163], v[64:67], a[192:195], 0
    v_mfma_f32_16x16x32_bf16 v[168:171], v[64:67], a[216:219], 0
    v_mfma_f32_16x16x32_bf16 v[176:179], v[64:67], a[240:243], 0
    v_mfma_f32_16x16x32_bf16 v[184:187], v[64:67], v[200:203], 0
    v_mfma_f32_16x16x32_bf16 v[160:163], v[68:71], a[196:199], v[160:163]
    v_mfma_f32_16x16x32_bf16 v[168:171], v[68:71], a[220:223], v[168:171]
    v_mfma_f32_16x16x32_bf16 v[176:179], v[68:71], a[244:247], v[176:179]
    v_mfma_f32_16x16x32_bf16 v[184:187], v[68:71], v[204:207], v[184:187]
    v_mfma_f32_16x16x32_bf16 v[164:167], v[72:75], a[192:195], 0
    v_mfma_f32_16x16x32_bf16 v[172:175], v[72:75], a[216:219], 0
    v_mfma_f32_16x16x32_bf16 v[180:183], v[72:75], a[240:243], 0
    v_mfma_f32_16x16x32_bf16 v[188:191], v[72:75], v[200:203], 0
    v_mfma_f32_16x16x32_bf16 v[164:167], v[76:79], a[196:199], v[164:167]
    v_mfma_f32_16x16x32_bf16 v[172:175], v[76:79], a[220:223], v[172:175]
    v_mfma_f32_16x16x32_bf16 v[180:183], v[76:79], a[244:247], v[180:183]
    v_mfma_f32_16x16x32_bf16 v[188:191], v[76:79], v[204:207], v[188:191]
    v_mfma_f32_16x16x32_bf16 v[160:163], v[80:83], a[200:203], v[160:163]
    v_mfma_f32_16x16x32_bf16 v[168:171], v[80:83], a[224:227], v[168:171]
    v_mfma_f32_16x16x32_bf16 v[176:179], v[80:83], a[248:251], v[176:179]
    v_mfma_f32_16x16x32_bf16 v[184:187], v[80:83], v[208:211], v[184:187]
    v_mfma_f32_16x16x32_bf16 v[160:163], v[84:87], a[204:207], v[160:163]
    v_mfma_f32_16x16x32_bf16 v[168:171], v[84:87], a[228:231], v[168:171]
    v_mfma_f32_16x16x32_bf16 v[176:179], v[84:87], a[252:255], v[176:179]
    v_mfma_f32_16x16x32_bf16 v[184:187], v[84:87], v[212:215], v[184:187]
    v_mfma_f32_16x16x32_bf16 v[164:167], v[88:91], a[200:203], v[164:167]
    v_mfma_f32_16x16x32_bf16 v[172:175], v[88:91], a[224:227], v[172:175]
    v_mfma_f32_16x16x32_bf16 v[180:183], v[88:91], a[248:251], v[180:183]
    v_mfma_f32_16x16x32_bf16 v[188:191], v[88:91], v[208:211], v[188:191]
    v_mfma_f32_16x16x32_bf16 v[164:167], v[92:95], a[204:207], v[164:167]
    v_mfma_f32_16x16x32_bf16 v[172:175], v[92:95], a[228:231], v[172:175]
    v_mfma_f32_16x16x32_bf16 v[180:183], v[92:95], a[252:255], v[180:183]
    v_mfma_f32_16x16x32_bf16 v[188:191], v[92:95], v[212:215], v[188:191]
    v_mfma_f32_16x16x32_bf16 v[160:163], v[96:99], a[208:211], v[160:163]
    v_mfma_f32_16x16x32_bf16 v[168:171], v[96:99], a[232:235], v[168:171]
    v_mfma_f32_16x16x32_bf16 v[176:179], v[96:99], v[192:195], v[176:179]
    v_mfma_f32_16x16x32_bf16 v[184:187], v[96:99], v[216:219], v[184:187]
    v_mfma_f32_16x16x32_bf16 v[160:163], v[100:103], a[212:215], v[160:163]
    v_mfma_f32_16x16x32_bf16 v[168:171], v[100:103], a[236:239], v[168:171]
    v_mfma_f32_16x16x32_bf16 v[176:179], v[100:103], v[196:199], v[176:179]
    v_mfma_f32_16x16x32_bf16 v[184:187], v[100:103], v[220:223], v[184:187]
    v_mfma_f32_16x16x32_bf16 v[164:167], v[104:107], a[208:211], v[164:167]
    v_mfma_f32_16x16x32_bf16 v[172:175], v[104:107], a[232:235], v[172:175]
    v_mfma_f32_16x16x32_bf16 v[180:183], v[104:107], v[192:195], v[180:183]
    v_mfma_f32_16x16x32_bf16 v[188:191], v[104:107], v[216:219], v[188:191]
    v_mfma_f32_16x16x32_bf16 v[164:167], v[108:111], a[212:215], v[164:167]
    v_mfma_f32_16x16x32_bf16 v[172:175], v[108:111], a[236:239], v[172:175]
    v_mfma_f32_16x16x32_bf16 v[180:183], v[108:111], v[196:199], v[180:183]
    v_mfma_f32_16x16x32_bf16 v[188:191], v[108:111], v[220:223], v[188:191]
    s_nop 9
    v_max3_f32 v16, v160, v161, v162
    v_max3_f32 v16, v16, v163, v164
    v_max3_f32 v16, v16, v165, v166
    v_max3_f32 v16, v16, v167, v240
    v_mov_b32 v17, v16
    s_nop 1
    v_permlane16_swap_b32 v16, v17
    s_nop 1
    v_max_f32 v16, v16, v17
    v_mov_b32 v17, v16
    s_nop 1
    v_permlane32_swap_b32 v16, v17
    s_nop 1
    v_max_f32 v16, v16, v17
    v_sub_f32 v17, v240, v16
    v_exp_f32 v17, v17
    v_mov_b32 v240, v16
    v_sub_f32 v160, v160, v16
    v_sub_f32 v161, v161, v16
    v_sub_f32 v162, v162, v16
    v_sub_f32 v163, v163, v16
    v_sub_f32 v164, v164, v16
    v_sub_f32 v165, v165, v16
    v_sub_f32 v166, v166, v16
    v_sub_f32 v167, v167, v16
    v_exp_f32 v160, v160
    v_exp_f32 v161, v161
    v_exp_f32 v162, v162
    v_exp_f32 v163, v163
    v_exp_f32 v164, v164
    v_exp_f32 v165, v165
    v_exp_f32 v166, v166
    v_exp_f32 v167, v167
    v_mul_f32 v5, v5, v17
    v_add_f32 v5, v5, v160
    v_add_f32 v5, v5, v161
    v_add_f32 v5, v5, v162
    v_add_f32 v5, v5, v163
    v_add_f32 v5, v5, v164
    v_add_f32 v5, v5, v165
    v_add_f32 v5, v5, v166
    v_add_f32 v5, v5, v167
    v_cvt_pk_bf16_f32 v224, v160, v161
    v_cvt_pk_bf16_f32 v225, v162, v163
    v_cvt_pk_bf16_f32 v226, v164, v165
    v_cvt_pk_bf16_f32 v227, v166, v167
    ds_bpermute_b32 v248, v58, v17 offset:0
    ds_bpermute_b32 v249, v58, v17 offset:4
    ds_bpermute_b32 v250, v58, v17 offset:8
    ds_bpermute_b32 v251, v58, v17 offset:12
    s_waitcnt lgkmcnt(0)
    v_accvgpr_read_b32 v18, a0
    v_mul_f32 v18, v18, v248
    v_accvgpr_write_b32 a0, v18
    v_accvgpr_read_b32 v19, a1
    v_mul_f32 v19, v19, v249
    v_accvgpr_write_b32 a1, v19
    v_accvgpr_read_b32 v18, a2
    v_mul_f32 v18, v18, v250
    v_accvgpr_write_b32 a2, v18
    v_accvgpr_read_b32 v19, a3
    v_mul_f32 v19, v19, v251
    v_accvgpr_write_b32 a3, v19
    v_accvgpr_read_b32 v18, a4
    v_mul_f32 v18, v18, v248
    v_accvgpr_write_b32 a4, v18
    v_accvgpr_read_b32 v19, a5
    v_mul_f32 v19, v19, v249
    v_accvgpr_write_b32 a5, v19
    v_accvgpr_read_b32 v18, a6
    v_mul_f32 v18, v18, v250
    v_accvgpr_write_b32 a6, v18
    v_accvgpr_read_b32 v19, a7
    v_mul_f32 v19, v19, v251
    v_accvgpr_write_b32 a7, v19
    v_accvgpr_read_b32 v18, a8
    v_mul_f32 v18, v18, v248
    v_accvgpr_write_b32 a8, v18
    v_accvgpr_read_b32 v19, a9
    v_mul_f32 v19, v19, v249
    v_accvgpr_write_b32 a9, v19
    v_accvgpr_read_b32 v18, a10
    v_mul_f32 v18, v18, v250
    v_accvgpr_write_b32 a10, v18
    v_accvgpr_read_b32 v19, a11
    v_mul_f32 v19, v19, v251
    v_accvgpr_write_b32 a11, v19
    v_accvgpr_read_b32 v18, a12
    v_mul_f32 v18, v18, v248
    v_accvgpr_write_b32 a12, v18
    v_accvgpr_read_b32 v19, a13
    v_mul_f32 v19, v19, v249
    v_accvgpr_write_b32 a13, v19
    v_accvgpr_read_b32 v18, a14
    v_mul_f32 v18, v18, v250
    v_accvgpr_write_b32 a14, v18
    v_accvgpr_read_b32 v19, a15
    v_mul_f32 v19, v19, v251
    v_accvgpr_write_b32 a15, v19
    v_accvgpr_read_b32 v18, a16
    v_mul_f32 v18, v18, v248
    v_accvgpr_write_b32 a16, v18
    v_accvgpr_read_b32 v19, a17
    v_mul_f32 v19, v19, v249
    v_accvgpr_write_b32 a17, v19
    v_accvgpr_read_b32 v18, a18
    v_mul_f32 v18, v18, v250
    v_accvgpr_write_b32 a18, v18
    v_accvgpr_read_b32 v19, a19
    v_mul_f32 v19, v19, v251
    v_accvgpr_write_b32 a19, v19
    v_accvgpr_read_b32 v18, a20
    v_mul_f32 v18, v18, v248
    v_accvgpr_write_b32 a20, v18
    v_accvgpr_read_b32 v19, a21
    v_mul_f32 v19, v19, v249
    v_accvgpr_write_b32 a21, v19
    v_accvgpr_read_b32 v18, a22
    v_mul_f32 v18, v18, v250
    v_accvgpr_write_b32 a22, v18
    v_accvgpr_read_b32 v19, a23
    v_mul_f32 v19, v19, v251
    v_accvgpr_write_b32 a23, v19
    v_accvgpr_read_b32 v18, a24
    v_mul_f32 v18, v18, v248
    v_accvgpr_write_b32 a24, v18
    v_accvgpr_read_b32 v19, a25
    v_mul_f32 v19, v19, v249
    v_accvgpr_write_b32 a25, v19
    v_accvgpr_read_b32 v18, a26
    v_mul_f32 v18, v18, v250
    v_accvgpr_write_b32 a26, v18
    v_accvgpr_read_b32 v19, a27
    v_mul_f32 v19, v19, v251
    v_accvgpr_write_b32 a27, v19
    v_accvgpr_read_b32 v18, a28
    v_mul_f32 v18, v18, v248
    v_accvgpr_write_b32 a28, v18
    v_accvgpr_read_b32 v19, a29
    v_mul_f32 v19, v19, v249
    v_accvgpr_write_b32 a29, v19
    v_accvgpr_read_b32 v18, a30
    v_mul_f32 v18, v18, v250
    v_accvgpr_write_b32 a30, v18
    v_accvgpr_read_b32 v19, a31
    v_mul_f32 v19, v19, v251
    v_accvgpr_write_b32 a31, v19
    v_accvgpr_read_b32 v18, a32
    v_mul_f32 v18, v18, v248
    v_accvgpr_write_b32 a32, v18
    v_accvgpr_read_b32 v19, a33
    v_mul_f32 v19, v19, v249
    v_accvgpr_write_b32 a33, v19
    v_accvgpr_read_b32 v18, a34
    v_mul_f32 v18, v18, v250
    v_accvgpr_write_b32 a34, v18
    v_accvgpr_read_b32 v19, a35
    v_mul_f32 v19, v19, v251
    v_accvgpr_write_b32 a35, v19
    v_accvgpr_read_b32 v18, a36
    v_mul_f32 v18, v18, v248
    v_accvgpr_write_b32 a36, v18
    v_accvgpr_read_b32 v19, a37
    v_mul_f32 v19, v19, v249
    v_accvgpr_write_b32 a37, v19
    v_accvgpr_read_b32 v18, a38
    v_mul_f32 v18, v18, v250
    v_accvgpr_write_b32 a38, v18
    v_accvgpr_read_b32 v19, a39
    v_mul_f32 v19, v19, v251
    v_accvgpr_write_b32 a39, v19
    v_accvgpr_read_b32 v18, a40
    v_mul_f32 v18, v18, v248
    v_accvgpr_write_b32 a40, v18
    v_accvgpr_read_b32 v19, a41
    v_mul_f32 v19, v19, v249
    v_accvgpr_write_b32 a41, v19
    v_accvgpr_read_b32 v18, a42
    v_mul_f32 v18, v18, v250
    v_accvgpr_write_b32 a42, v18
    v_accvgpr_read_b32 v19, a43
    v_mul_f32 v19, v19, v251
    v_accvgpr_write_b32 a43, v19
    v_accvgpr_read_b32 v18, a44
    v_mul_f32 v18, v18, v248
    v_accvgpr_write_b32 a44, v18
    v_accvgpr_read_b32 v19, a45
    v_mul_f32 v19, v19, v249
    v_accvgpr_write_b32 a45, v19
    v_accvgpr_read_b32 v18, a46
    v_mul_f32 v18, v18, v250
    v_accvgpr_write_b32 a46, v18
    v_accvgpr_read_b32 v19, a47
    v_mul_f32 v19, v19, v251
    v_accvgpr_write_b32 a47, v19
    v_max3_f32 v16, v168, v169, v170
    v_max3_f32 v16, v16, v171, v172
    v_max3_f32 v16, v16, v173, v174
    v_max3_f32 v16, v16, v175, v241
    v_mov_b32 v17, v16
    s_nop 1
    v_permlane16_swap_b32 v16, v17
    s_nop 1
    v_max_f32 v16, v16, v17
    v_mov_b32 v17, v16
    s_nop 1
    v_permlane32_swap_b32 v16, v17
    s_nop 1
    v_max_f32 v16, v16, v17
    v_sub_f32 v17, v241, v16
    v_exp_f32 v17, v17
    v_mov_b32 v241, v16
    v_sub_f32 v168, v168, v16
    v_sub_f32 v169, v169, v16
    v_sub_f32 v170, v170, v16
    v_sub_f32 v171, v171, v16
    v_sub_f32 v172, v172, v16
    v_sub_f32 v173, v173, v16
    v_sub_f32 v174, v174, v16
    v_sub_f32 v175, v175, v16
    v_exp_f32 v168, v168
    v_exp_f32 v169, v169
    v_exp_f32 v170, v170
    v_exp_f32 v171, v171
    v_exp_f32 v172, v172
    v_exp_f32 v173, v173
    v_exp_f32 v174, v174
    v_exp_f32 v175, v175
    v_mul_f32 v6, v6, v17
    v_add_f32 v6, v6, v168
    v_add_f32 v6, v6, v169
    v_add_f32 v6, v6, v170
    v_add_f32 v6, v6, v171
    v_add_f32 v6, v6, v172
    v_add_f32 v6, v6, v173
    v_add_f32 v6, v6, v174
    v_add_f32 v6, v6, v175
    v_cvt_pk_bf16_f32 v228, v168, v169
    v_cvt_pk_bf16_f32 v229, v170, v171
    v_cvt_pk_bf16_f32 v230, v172, v173
    v_cvt_pk_bf16_f32 v231, v174, v175
    ds_bpermute_b32 v248, v58, v17 offset:0
    ds_bpermute_b32 v249, v58, v17 offset:4
    ds_bpermute_b32 v250, v58, v17 offset:8
    ds_bpermute_b32 v251, v58, v17 offset:12
    s_waitcnt lgkmcnt(0)
    v_accvgpr_read_b32 v18, a48
    v_mul_f32 v18, v18, v248
    v_accvgpr_write_b32 a48, v18
    v_accvgpr_read_b32 v19, a49
    v_mul_f32 v19, v19, v249
    v_accvgpr_write_b32 a49, v19
    v_accvgpr_read_b32 v18, a50
    v_mul_f32 v18, v18, v250
    v_accvgpr_write_b32 a50, v18
    v_accvgpr_read_b32 v19, a51
    v_mul_f32 v19, v19, v251
    v_accvgpr_write_b32 a51, v19
    v_accvgpr_read_b32 v18, a52
    v_mul_f32 v18, v18, v248
    v_accvgpr_write_b32 a52, v18
    v_accvgpr_read_b32 v19, a53
    v_mul_f32 v19, v19, v249
    v_accvgpr_write_b32 a53, v19
    v_accvgpr_read_b32 v18, a54
    v_mul_f32 v18, v18, v250
    v_accvgpr_write_b32 a54, v18
    v_accvgpr_read_b32 v19, a55
    v_mul_f32 v19, v19, v251
    v_accvgpr_write_b32 a55, v19
    v_accvgpr_read_b32 v18, a56
    v_mul_f32 v18, v18, v248
    v_accvgpr_write_b32 a56, v18
    v_accvgpr_read_b32 v19, a57
    v_mul_f32 v19, v19, v249
    v_accvgpr_write_b32 a57, v19
    v_accvgpr_read_b32 v18, a58
    v_mul_f32 v18, v18, v250
    v_accvgpr_write_b32 a58, v18
    v_accvgpr_read_b32 v19, a59
    v_mul_f32 v19, v19, v251
    v_accvgpr_write_b32 a59, v19
    v_accvgpr_read_b32 v18, a60
    v_mul_f32 v18, v18, v248
    v_accvgpr_write_b32 a60, v18
    v_accvgpr_read_b32 v19, a61
    v_mul_f32 v19, v19, v249
    v_accvgpr_write_b32 a61, v19
    v_accvgpr_read_b32 v18, a62
    v_mul_f32 v18, v18, v250
    v_accvgpr_write_b32 a62, v18
    v_accvgpr_read_b32 v19, a63
    v_mul_f32 v19, v19, v251
    v_accvgpr_write_b32 a63, v19
    v_accvgpr_read_b32 v18, a64
    v_mul_f32 v18, v18, v248
    v_accvgpr_write_b32 a64, v18
    v_accvgpr_read_b32 v19, a65
    v_mul_f32 v19, v19, v249
    v_accvgpr_write_b32 a65, v19
    v_accvgpr_read_b32 v18, a66
    v_mul_f32 v18, v18, v250
    v_accvgpr_write_b32 a66, v18
    v_accvgpr_read_b32 v19, a67
    v_mul_f32 v19, v19, v251
    v_accvgpr_write_b32 a67, v19
    v_accvgpr_read_b32 v18, a68
    v_mul_f32 v18, v18, v248
    v_accvgpr_write_b32 a68, v18
    v_accvgpr_read_b32 v19, a69
    v_mul_f32 v19, v19, v249
    v_accvgpr_write_b32 a69, v19
    v_accvgpr_read_b32 v18, a70
    v_mul_f32 v18, v18, v250
    v_accvgpr_write_b32 a70, v18
    v_accvgpr_read_b32 v19, a71
    v_mul_f32 v19, v19, v251
    v_accvgpr_write_b32 a71, v19
    v_accvgpr_read_b32 v18, a72
    v_mul_f32 v18, v18, v248
    v_accvgpr_write_b32 a72, v18
    v_accvgpr_read_b32 v19, a73
    v_mul_f32 v19, v19, v249
    v_accvgpr_write_b32 a73, v19
    v_accvgpr_read_b32 v18, a74
    v_mul_f32 v18, v18, v250
    v_accvgpr_write_b32 a74, v18
    v_accvgpr_read_b32 v19, a75
    v_mul_f32 v19, v19, v251
    v_accvgpr_write_b32 a75, v19
    v_accvgpr_read_b32 v18, a76
    v_mul_f32 v18, v18, v248
    v_accvgpr_write_b32 a76, v18
    v_accvgpr_read_b32 v19, a77
    v_mul_f32 v19, v19, v249
    v_accvgpr_write_b32 a77, v19
    v_accvgpr_read_b32 v18, a78
    v_mul_f32 v18, v18, v250
    v_accvgpr_write_b32 a78, v18
    v_accvgpr_read_b32 v19, a79
    v_mul_f32 v19, v19, v251
    v_accvgpr_write_b32 a79, v19
    v_accvgpr_read_b32 v18, a80
    v_mul_f32 v18, v18, v248
    v_accvgpr_write_b32 a80, v18
    v_accvgpr_read_b32 v19, a81
    v_mul_f32 v19, v19, v249
    v_accvgpr_write_b32 a81, v19
    v_accvgpr_read_b32 v18, a82
    v_mul_f32 v18, v18, v250
    v_accvgpr_write_b32 a82, v18
    v_accvgpr_read_b32 v19, a83
    v_mul_f32 v19, v19, v251
    v_accvgpr_write_b32 a83, v19
    v_accvgpr_read_b32 v18, a84
    v_mul_f32 v18, v18, v248
    v_accvgpr_write_b32 a84, v18
    v_accvgpr_read_b32 v19, a85
    v_mul_f32 v19, v19, v249
    v_accvgpr_write_b32 a85, v19
    v_accvgpr_read_b32 v18, a86
    v_mul_f32 v18, v18, v250
    v_accvgpr_write_b32 a86, v18
    v_accvgpr_read_b32 v19, a87
    v_mul_f32 v19, v19, v251
    v_accvgpr_write_b32 a87, v19
    v_accvgpr_read_b32 v18, a88
    v_mul_f32 v18, v18, v248
    v_accvgpr_write_b32 a88, v18
    v_accvgpr_read_b32 v19, a89
    v_mul_f32 v19, v19, v249
    v_accvgpr_write_b32 a89, v19
    v_accvgpr_read_b32 v18, a90
    v_mul_f32 v18, v18, v250
    v_accvgpr_write_b32 a90, v18
    v_accvgpr_read_b32 v19, a91
    v_mul_f32 v19, v19, v251
    v_accvgpr_write_b32 a91, v19
    v_accvgpr_read_b32 v18, a92
    v_mul_f32 v18, v18, v248
    v_accvgpr_write_b32 a92, v18
    v_accvgpr_read_b32 v19, a93
    v_mul_f32 v19, v19, v249
    v_accvgpr_write_b32 a93, v19
    v_accvgpr_read_b32 v18, a94
    v_mul_f32 v18, v18, v250
    v_accvgpr_write_b32 a94, v18
    v_accvgpr_read_b32 v19, a95
    v_mul_f32 v19, v19, v251
    v_accvgpr_write_b32 a95, v19
    v_max3_f32 v16, v176, v177, v178
    v_max3_f32 v16, v16, v179, v180
    v_max3_f32 v16, v16, v181, v182
    v_max3_f32 v16, v16, v183, v242
    v_mov_b32 v17, v16
    s_nop 1
    v_permlane16_swap_b32 v16, v17
    s_nop 1
    v_max_f32 v16, v16, v17
    v_mov_b32 v17, v16
    s_nop 1
    v_permlane32_swap_b32 v16, v17
    s_nop 1
    v_max_f32 v16, v16, v17
    v_sub_f32 v17, v242, v16
    v_exp_f32 v17, v17
    v_mov_b32 v242, v16
    v_sub_f32 v176, v176, v16
    v_sub_f32 v177, v177, v16
    v_sub_f32 v178, v178, v16
    v_sub_f32 v179, v179, v16
    v_sub_f32 v180, v180, v16
    v_sub_f32 v181, v181, v16
    v_sub_f32 v182, v182, v16
    v_sub_f32 v183, v183, v16
    v_exp_f32 v176, v176
    v_exp_f32 v177, v177
    v_exp_f32 v178, v178
    v_exp_f32 v179, v179
    v_exp_f32 v180, v180
    v_exp_f32 v181, v181
    v_exp_f32 v182, v182
    v_exp_f32 v183, v183
    v_mul_f32 v7, v7, v17
    v_add_f32 v7, v7, v176
    v_add_f32 v7, v7, v177
    v_add_f32 v7, v7, v178
    v_add_f32 v7, v7, v179
    v_add_f32 v7, v7, v180
    v_add_f32 v7, v7, v181
    v_add_f32 v7, v7, v182
    v_add_f32 v7, v7, v183
    v_cvt_pk_bf16_f32 v232, v176, v177
    v_cvt_pk_bf16_f32 v233, v178, v179
    v_cvt_pk_bf16_f32 v234, v180, v181
    v_cvt_pk_bf16_f32 v235, v182, v183
    ds_bpermute_b32 v248, v58, v17 offset:0
    ds_bpermute_b32 v249, v58, v17 offset:4
    ds_bpermute_b32 v250, v58, v17 offset:8
    ds_bpermute_b32 v251, v58, v17 offset:12
    s_waitcnt lgkmcnt(0)
    v_accvgpr_read_b32 v18, a96
    v_mul_f32 v18, v18, v248
    v_accvgpr_write_b32 a96, v18
    v_accvgpr_read_b32 v19, a97
    v_mul_f32 v19, v19, v249
    v_accvgpr_write_b32 a97, v19
    v_accvgpr_read_b32 v18, a98
    v_mul_f32 v18, v18, v250
    v_accvgpr_write_b32 a98, v18
    v_accvgpr_read_b32 v19, a99
    v_mul_f32 v19, v19, v251
    v_accvgpr_write_b32 a99, v19
    v_accvgpr_read_b32 v18, a100
    v_mul_f32 v18, v18, v248
    v_accvgpr_write_b32 a100, v18
    v_accvgpr_read_b32 v19, a101
    v_mul_f32 v19, v19, v249
    v_accvgpr_write_b32 a101, v19
    v_accvgpr_read_b32 v18, a102
    v_mul_f32 v18, v18, v250
    v_accvgpr_write_b32 a102, v18
    v_accvgpr_read_b32 v19, a103
    v_mul_f32 v19, v19, v251
    v_accvgpr_write_b32 a103, v19
    v_accvgpr_read_b32 v18, a104
    v_mul_f32 v18, v18, v248
    v_accvgpr_write_b32 a104, v18
    v_accvgpr_read_b32 v19, a105
    v_mul_f32 v19, v19, v249
    v_accvgpr_write_b32 a105, v19
    v_accvgpr_read_b32 v18, a106
    v_mul_f32 v18, v18, v250
    v_accvgpr_write_b32 a106, v18
    v_accvgpr_read_b32 v19, a107
    v_mul_f32 v19, v19, v251
    v_accvgpr_write_b32 a107, v19
    v_accvgpr_read_b32 v18, a108
    v_mul_f32 v18, v18, v248
    v_accvgpr_write_b32 a108, v18
    v_accvgpr_read_b32 v19, a109
    v_mul_f32 v19, v19, v249
    v_accvgpr_write_b32 a109, v19
    v_accvgpr_read_b32 v18, a110
    v_mul_f32 v18, v18, v250
    v_accvgpr_write_b32 a110, v18
    v_accvgpr_read_b32 v19, a111
    v_mul_f32 v19, v19, v251
    v_accvgpr_write_b32 a111, v19
    v_accvgpr_read_b32 v18, a112
    v_mul_f32 v18, v18, v248
    v_accvgpr_write_b32 a112, v18
    v_accvgpr_read_b32 v19, a113
    v_mul_f32 v19, v19, v249
    v_accvgpr_write_b32 a113, v19
    v_accvgpr_read_b32 v18, a114
    v_mul_f32 v18, v18, v250
    v_accvgpr_write_b32 a114, v18
    v_accvgpr_read_b32 v19, a115
    v_mul_f32 v19, v19, v251
    v_accvgpr_write_b32 a115, v19
    v_accvgpr_read_b32 v18, a116
    v_mul_f32 v18, v18, v248
    v_accvgpr_write_b32 a116, v18
    v_accvgpr_read_b32 v19, a117
    v_mul_f32 v19, v19, v249
    v_accvgpr_write_b32 a117, v19
    v_accvgpr_read_b32 v18, a118
    v_mul_f32 v18, v18, v250
    v_accvgpr_write_b32 a118, v18
    v_accvgpr_read_b32 v19, a119
    v_mul_f32 v19, v19, v251
    v_accvgpr_write_b32 a119, v19
    v_accvgpr_read_b32 v18, a120
    v_mul_f32 v18, v18, v248
    v_accvgpr_write_b32 a120, v18
    v_accvgpr_read_b32 v19, a121
    v_mul_f32 v19, v19, v249
    v_accvgpr_write_b32 a121, v19
    v_accvgpr_read_b32 v18, a122
    v_mul_f32 v18, v18, v250
    v_accvgpr_write_b32 a122, v18
    v_accvgpr_read_b32 v19, a123
    v_mul_f32 v19, v19, v251
    v_accvgpr_write_b32 a123, v19
    v_accvgpr_read_b32 v18, a124
    v_mul_f32 v18, v18, v248
    v_accvgpr_write_b32 a124, v18
    v_accvgpr_read_b32 v19, a125
    v_mul_f32 v19, v19, v249
    v_accvgpr_write_b32 a125, v19
    v_accvgpr_read_b32 v18, a126
    v_mul_f32 v18, v18, v250
    v_accvgpr_write_b32 a126, v18
    v_accvgpr_read_b32 v19, a127
    v_mul_f32 v19, v19, v251
    v_accvgpr_write_b32 a127, v19
    v_accvgpr_read_b32 v18, a128
    v_mul_f32 v18, v18, v248
    v_accvgpr_write_b32 a128, v18
    v_accvgpr_read_b32 v19, a129
    v_mul_f32 v19, v19, v249
    v_accvgpr_write_b32 a129, v19
    v_accvgpr_read_b32 v18, a130
    v_mul_f32 v18, v18, v250
    v_accvgpr_write_b32 a130, v18
    v_accvgpr_read_b32 v19, a131
    v_mul_f32 v19, v19, v251
    v_accvgpr_write_b32 a131, v19
    v_accvgpr_read_b32 v18, a132
    v_mul_f32 v18, v18, v248
    v_accvgpr_write_b32 a132, v18
    v_accvgpr_read_b32 v19, a133
    v_mul_f32 v19, v19, v249
    v_accvgpr_write_b32 a133, v19
    v_accvgpr_read_b32 v18, a134
    v_mul_f32 v18, v18, v250
    v_accvgpr_write_b32 a134, v18
    v_accvgpr_read_b32 v19, a135
    v_mul_f32 v19, v19, v251
    v_accvgpr_write_b32 a135, v19
    v_accvgpr_read_b32 v18, a136
    v_mul_f32 v18, v18, v248
    v_accvgpr_write_b32 a136, v18
    v_accvgpr_read_b32 v19, a137
    v_mul_f32 v19, v19, v249
    v_accvgpr_write_b32 a137, v19
    v_accvgpr_read_b32 v18, a138
    v_mul_f32 v18, v18, v250
    v_accvgpr_write_b32 a138, v18
    v_accvgpr_read_b32 v19, a139
    v_mul_f32 v19, v19, v251
    v_accvgpr_write_b32 a139, v19
    v_accvgpr_read_b32 v18, a140
    v_mul_f32 v18, v18, v248
    v_accvgpr_write_b32 a140, v18
    v_accvgpr_read_b32 v19, a141
    v_mul_f32 v19, v19, v249
    v_accvgpr_write_b32 a141, v19
    v_accvgpr_read_b32 v18, a142
    v_mul_f32 v18, v18, v250
    v_accvgpr_write_b32 a142, v18
    v_accvgpr_read_b32 v19, a143
    v_mul_f32 v19, v19, v251
    v_accvgpr_write_b32 a143, v19
    v_max3_f32 v16, v184, v185, v186
    v_max3_f32 v16, v16, v187, v188
    v_max3_f32 v16, v16, v189, v190
    v_max3_f32 v16, v16, v191, v243
    v_mov_b32 v17, v16
    s_nop 1
    v_permlane16_swap_b32 v16, v17
    s_nop 1
    v_max_f32 v16, v16, v17
    v_mov_b32 v17, v16
    s_nop 1
    v_permlane32_swap_b32 v16, v17
    s_nop 1
    v_max_f32 v16, v16, v17
    v_sub_f32 v17, v243, v16
    v_exp_f32 v17, v17
    v_mov_b32 v243, v16
    v_sub_f32 v184, v184, v16
    v_sub_f32 v185, v185, v16
    v_sub_f32 v186, v186, v16
    v_sub_f32 v187, v187, v16
    v_sub_f32 v188, v188, v16
    v_sub_f32 v189, v189, v16
    v_sub_f32 v190, v190, v16
    v_sub_f32 v191, v191, v16
    v_exp_f32 v184, v184
    v_exp_f32 v185, v185
    v_exp_f32 v186, v186
    v_exp_f32 v187, v187
    v_exp_f32 v188, v188
    v_exp_f32 v189, v189
    v_exp_f32 v190, v190
    v_exp_f32 v191, v191
    v_mul_f32 v8, v8, v17
    v_add_f32 v8, v8, v184
    v_add_f32 v8, v8, v185
    v_add_f32 v8, v8, v186
    v_add_f32 v8, v8, v187
    v_add_f32 v8, v8, v188
    v_add_f32 v8, v8, v189
    v_add_f32 v8, v8, v190
    v_add_f32 v8, v8, v191
    v_cvt_pk_bf16_f32 v236, v184, v185
    v_cvt_pk_bf16_f32 v237, v186, v187
    v_cvt_pk_bf16_f32 v238, v188, v189
    v_cvt_pk_bf16_f32 v239, v190, v191
    ds_bpermute_b32 v248, v58, v17 offset:0
    ds_bpermute_b32 v249, v58, v17 offset:4
    ds_bpermute_b32 v250, v58, v17 offset:8
    ds_bpermute_b32 v251, v58, v17 offset:12
    s_waitcnt lgkmcnt(0)
    v_accvgpr_read_b32 v18, a144
    v_mul_f32 v18, v18, v248
    v_accvgpr_write_b32 a144, v18
    v_accvgpr_read_b32 v19, a145
    v_mul_f32 v19, v19, v249
    v_accvgpr_write_b32 a145, v19
    v_accvgpr_read_b32 v18, a146
    v_mul_f32 v18, v18, v250
    v_accvgpr_write_b32 a146, v18
    v_accvgpr_read_b32 v19, a147
    v_mul_f32 v19, v19, v251
    v_accvgpr_write_b32 a147, v19
    v_accvgpr_read_b32 v18, a148
    v_mul_f32 v18, v18, v248
    v_accvgpr_write_b32 a148, v18
    v_accvgpr_read_b32 v19, a149
    v_mul_f32 v19, v19, v249
    v_accvgpr_write_b32 a149, v19
    v_accvgpr_read_b32 v18, a150
    v_mul_f32 v18, v18, v250
    v_accvgpr_write_b32 a150, v18
    v_accvgpr_read_b32 v19, a151
    v_mul_f32 v19, v19, v251
    v_accvgpr_write_b32 a151, v19
    v_accvgpr_read_b32 v18, a152
    v_mul_f32 v18, v18, v248
    v_accvgpr_write_b32 a152, v18
    v_accvgpr_read_b32 v19, a153
    v_mul_f32 v19, v19, v249
    v_accvgpr_write_b32 a153, v19
    v_accvgpr_read_b32 v18, a154
    v_mul_f32 v18, v18, v250
    v_accvgpr_write_b32 a154, v18
    v_accvgpr_read_b32 v19, a155
    v_mul_f32 v19, v19, v251
    v_accvgpr_write_b32 a155, v19
    v_accvgpr_read_b32 v18, a156
    v_mul_f32 v18, v18, v248
    v_accvgpr_write_b32 a156, v18
    v_accvgpr_read_b32 v19, a157
    v_mul_f32 v19, v19, v249
    v_accvgpr_write_b32 a157, v19
    v_accvgpr_read_b32 v18, a158
    v_mul_f32 v18, v18, v250
    v_accvgpr_write_b32 a158, v18
    v_accvgpr_read_b32 v19, a159
    v_mul_f32 v19, v19, v251
    v_accvgpr_write_b32 a159, v19
    v_accvgpr_read_b32 v18, a160
    v_mul_f32 v18, v18, v248
    v_accvgpr_write_b32 a160, v18
    v_accvgpr_read_b32 v19, a161
    v_mul_f32 v19, v19, v249
    v_accvgpr_write_b32 a161, v19
    v_accvgpr_read_b32 v18, a162
    v_mul_f32 v18, v18, v250
    v_accvgpr_write_b32 a162, v18
    v_accvgpr_read_b32 v19, a163
    v_mul_f32 v19, v19, v251
    v_accvgpr_write_b32 a163, v19
    v_accvgpr_read_b32 v18, a164
    v_mul_f32 v18, v18, v248
    v_accvgpr_write_b32 a164, v18
    v_accvgpr_read_b32 v19, a165
    v_mul_f32 v19, v19, v249
    v_accvgpr_write_b32 a165, v19
    v_accvgpr_read_b32 v18, a166
    v_mul_f32 v18, v18, v250
    v_accvgpr_write_b32 a166, v18
    v_accvgpr_read_b32 v19, a167
    v_mul_f32 v19, v19, v251
    v_accvgpr_write_b32 a167, v19
    v_accvgpr_read_b32 v18, a168
    v_mul_f32 v18, v18, v248
    v_accvgpr_write_b32 a168, v18
    v_accvgpr_read_b32 v19, a169
    v_mul_f32 v19, v19, v249
    v_accvgpr_write_b32 a169, v19
    v_accvgpr_read_b32 v18, a170
    v_mul_f32 v18, v18, v250
    v_accvgpr_write_b32 a170, v18
    v_accvgpr_read_b32 v19, a171
    v_mul_f32 v19, v19, v251
    v_accvgpr_write_b32 a171, v19
    v_accvgpr_read_b32 v18, a172
    v_mul_f32 v18, v18, v248
    v_accvgpr_write_b32 a172, v18
    v_accvgpr_read_b32 v19, a173
    v_mul_f32 v19, v19, v249
    v_accvgpr_write_b32 a173, v19
    v_accvgpr_read_b32 v18, a174
    v_mul_f32 v18, v18, v250
    v_accvgpr_write_b32 a174, v18
    v_accvgpr_read_b32 v19, a175
    v_mul_f32 v19, v19, v251
    v_accvgpr_write_b32 a175, v19
    v_accvgpr_read_b32 v18, a176
    v_mul_f32 v18, v18, v248
    v_accvgpr_write_b32 a176, v18
    v_accvgpr_read_b32 v19, a177
    v_mul_f32 v19, v19, v249
    v_accvgpr_write_b32 a177, v19
    v_accvgpr_read_b32 v18, a178
    v_mul_f32 v18, v18, v250
    v_accvgpr_write_b32 a178, v18
    v_accvgpr_read_b32 v19, a179
    v_mul_f32 v19, v19, v251
    v_accvgpr_write_b32 a179, v19
    v_accvgpr_read_b32 v18, a180
    v_mul_f32 v18, v18, v248
    v_accvgpr_write_b32 a180, v18
    v_accvgpr_read_b32 v19, a181
    v_mul_f32 v19, v19, v249
    v_accvgpr_write_b32 a181, v19
    v_accvgpr_read_b32 v18, a182
    v_mul_f32 v18, v18, v250
    v_accvgpr_write_b32 a182, v18
    v_accvgpr_read_b32 v19, a183
    v_mul_f32 v19, v19, v251
    v_accvgpr_write_b32 a183, v19
    v_accvgpr_read_b32 v18, a184
    v_mul_f32 v18, v18, v248
    v_accvgpr_write_b32 a184, v18
    v_accvgpr_read_b32 v19, a185
    v_mul_f32 v19, v19, v249
    v_accvgpr_write_b32 a185, v19
    v_accvgpr_read_b32 v18, a186
    v_mul_f32 v18, v18, v250
    v_accvgpr_write_b32 a186, v18
    v_accvgpr_read_b32 v19, a187
    v_mul_f32 v19, v19, v251
    v_accvgpr_write_b32 a187, v19
    v_accvgpr_read_b32 v18, a188
    v_mul_f32 v18, v18, v248
    v_accvgpr_write_b32 a188, v18
    v_accvgpr_read_b32 v19, a189
    v_mul_f32 v19, v19, v249
    v_accvgpr_write_b32 a189, v19
    v_accvgpr_read_b32 v18, a190
    v_mul_f32 v18, v18, v250
    v_accvgpr_write_b32 a190, v18
    v_accvgpr_read_b32 v19, a191
    v_mul_f32 v19, v19, v251
    v_accvgpr_write_b32 a191, v19
    s_waitcnt vmcnt(0)
    s_nop 1
    v_mfma_f32_16x16x32_bf16 a[0:3], v[224:227], v[112:115], a[0:3]
    v_mfma_f32_16x16x32_bf16 a[48:51], v[228:231], v[112:115], a[48:51]
    v_mfma_f32_16x16x32_bf16 a[96:99], v[232:235], v[112:115], a[96:99]
    v_mfma_f32_16x16x32_bf16 a[144:147], v[236:239], v[112:115], a[144:147]
    v_mfma_f32_16x16x32_bf16 a[4:7], v[224:227], v[116:119], a[4:7]
    v_mfma_f32_16x16x32_bf16 a[52:55], v[228:231], v[116:119], a[52:55]
    v_mfma_f32_16x16x32_bf16 a[100:103], v[232:235], v[116:119], a[100:103]
    v_mfma_f32_16x16x32_bf16 a[148:151], v[236:239], v[116:119], a[148:151]
    v_mfma_f32_16x16x32_bf16 a[8:11], v[224:227], v[120:123], a[8:11]
    v_mfma_f32_16x16x32_bf16 a[56:59], v[228:231], v[120:123], a[56:59]
    v_mfma_f32_16x16x32_bf16 a[104:107], v[232:235], v[120:123], a[104:107]
    v_mfma_f32_16x16x32_bf16 a[152:155], v[236:239], v[120:123], a[152:155]
    v_mfma_f32_16x16x32_bf16 a[12:15], v[224:227], v[124:127], a[12:15]
    v_mfma_f32_16x16x32_bf16 a[60:63], v[228:231], v[124:127], a[60:63]
    v_mfma_f32_16x16x32_bf16 a[108:111], v[232:235], v[124:127], a[108:111]
    v_mfma_f32_16x16x32_bf16 a[156:159], v[236:239], v[124:127], a[156:159]
    v_mfma_f32_16x16x32_bf16 a[16:19], v[224:227], v[128:131], a[16:19]
    v_mfma_f32_16x16x32_bf16 a[64:67], v[228:231], v[128:131], a[64:67]
    v_mfma_f32_16x16x32_bf16 a[112:115], v[232:235], v[128:131], a[112:115]
    v_mfma_f32_16x16x32_bf16 a[160:163], v[236:239], v[128:131], a[160:163]
    v_mfma_f32_16x16x32_bf16 a[20:23], v[224:227], v[132:135], a[20:23]
    v_mfma_f32_16x16x32_bf16 a[68:71], v[228:231], v[132:135], a[68:71]
    v_mfma_f32_16x16x32_bf16 a[116:119], v[232:235], v[132:135], a[116:119]
    v_mfma_f32_16x16x32_bf16 a[164:167], v[236:239], v[132:135], a[164:167]
    v_mfma_f32_16x16x32_bf16 a[24:27], v[224:227], v[136:139], a[24:27]
    v_mfma_f32_16x16x32_bf16 a[72:75], v[228:231], v[136:139], a[72:75]
    v_mfma_f32_16x16x32_bf16 a[120:123], v[232:235], v[136:139], a[120:123]
    v_mfma_f32_16x16x32_bf16 a[168:171], v[236:239], v[136:139], a[168:171]
    v_mfma_f32_16x16x32_bf16 a[28:31], v[224:227], v[140:143], a[28:31]
    v_mfma_f32_16x16x32_bf16 a[76:79], v[228:231], v[140:143], a[76:79]
    v_mfma_f32_16x16x32_bf16 a[124:127], v[232:235], v[140:143], a[124:127]
    v_mfma_f32_16x16x32_bf16 a[172:175], v[236:239], v[140:143], a[172:175]
    v_mfma_f32_16x16x32_bf16 a[32:35], v[224:227], v[144:147], a[32:35]
    v_mfma_f32_16x16x32_bf16 a[80:83], v[228:231], v[144:147], a[80:83]
    v_mfma_f32_16x16x32_bf16 a[128:131], v[232:235], v[144:147], a[128:131]
    v_mfma_f32_16x16x32_bf16 a[176:179], v[236:239], v[144:147], a[176:179]
    v_mfma_f32_16x16x32_bf16 a[36:39], v[224:227], v[148:151], a[36:39]
    v_mfma_f32_16x16x32_bf16 a[84:87], v[228:231], v[148:151], a[84:87]
    v_mfma_f32_16x16x32_bf16 a[132:135], v[232:235], v[148:151], a[132:135]
    v_mfma_f32_16x16x32_bf16 a[180:183], v[236:239], v[148:151], a[180:183]
    v_mfma_f32_16x16x32_bf16 a[40:43], v[224:227], v[152:155], a[40:43]
    v_mfma_f32_16x16x32_bf16 a[88:91], v[228:231], v[152:155], a[88:91]
    v_mfma_f32_16x16x32_bf16 a[136:139], v[232:235], v[152:155], a[136:139]
    v_mfma_f32_16x16x32_bf16 a[184:187], v[236:239], v[152:155], a[184:187]
    v_mfma_f32_16x16x32_bf16 a[44:47], v[224:227], v[156:159], a[44:47]
    v_mfma_f32_16x16x32_bf16 a[92:95], v[228:231], v[156:159], a[92:95]
    v_mfma_f32_16x16x32_bf16 a[140:143], v[232:235], v[156:159], a[140:143]
    v_mfma_f32_16x16x32_bf16 a[188:191], v[236:239], v[156:159], a[188:191]
    s_add_u32 s48, s48, 24576
    s_cmp_lt_u32 s48, 1572864
    s_nop 7
    s_cbranch_scc1 L_slowloop
    s_nop 1
    v_mfma_f32_16x16x4_f32 v[48:51], v5, v57, 0
    v_mfma_f32_16x16x4_f32 v[52:55], v6, v57, 0
    s_nop 7
    s_nop 1
    v_rcp_f32 v48, v48
    v_rcp_f32 v49, v49
    v_rcp_f32 v50, v50
    v_rcp_f32 v51, v51
    v_rcp_f32 v52, v52
    v_rcp_f32 v53, v53
    v_rcp_f32 v54, v54
    v_rcp_f32 v55, v55
    v_mfma_f32_16x16x4_f32 v[128:131], v7, v57, 0
    v_mfma_f32_16x16x4_f32 v[132:135], v8, v57, 0
    s_nop 7
    s_nop 1
    v_rcp_f32 v128, v128
    v_rcp_f32 v129, v129
    v_rcp_f32 v130, v130
    v_rcp_f32 v131, v131
    v_rcp_f32 v132, v132
    v_rcp_f32 v133, v133
    v_rcp_f32 v134, v134
    v_rcp_f32 v135, v135
    s_nop 0
    v_accvgpr_read_b32 v64, a0
    v_accvgpr_read_b32 v65, a12
    v_accvgpr_read_b32 v66, a24
    v_accvgpr_read_b32 v67, a36
    v_pk_mul_f32 v[64:65], v[64:65], v[48:49] op_sel_hi:[1,0]
    v_pk_mul_f32 v[66:67], v[66:67], v[48:49] op_sel_hi:[1,0]
    v_cvt_pk_bf16_f32 v64, v64, v65
    v_cvt_pk_bf16_f32 v65, v66, v67
    v_accvgpr_read_b32 v68, a1
    v_accvgpr_read_b32 v69, a13
    v_accvgpr_read_b32 v70, a25
    v_accvgpr_read_b32 v71, a37
    v_pk_mul_f32 v[68:69], v[68:69], v[48:49] op_sel:[0,1] op_sel_hi:[1,1]
    v_pk_mul_f32 v[70:71], v[70:71], v[48:49] op_sel:[0,1] op_sel_hi:[1,1]
    v_cvt_pk_bf16_f32 v68, v68, v69
    v_cvt_pk_bf16_f32 v69, v70, v71
    buffer_store_dwordx2 v[64:65], v56, s[12:15], s24 offen offset:0 sc0 sc1
    v_accvgpr_read_b32 v72, a2
    v_accvgpr_read_b32 v73, a14
    v_accvgpr_read_b32 v74, a26
    v_accvgpr_read_b32 v75, a38
    v_pk_mul_f32 v[72:73], v[72:73], v[50:51] op_sel_hi:[1,0]
    v_pk_mul_f32 v[74:75], v[74:75], v[50:51] op_sel_hi:[1,0]
    v_cvt_pk_bf16_f32 v72, v72, v73
    v_cvt_pk_bf16_f32 v73, v74, v75
    buffer_store_dwordx2 v[68:69], v56, s[12:15], s24 offen offset:384 sc0 sc1
    v_accvgpr_read_b32 v76, a3
    v_accvgpr_read_b32 v77, a15
    v_accvgpr_read_b32 v78, a27
    v_accvgpr_read_b32 v79, a39
    v_pk_mul_f32 v[76:77], v[76:77], v[50:51] op_sel:[0,1] op_sel_hi:[1,1]
    v_pk_mul_f32 v[78:79], v[78:79], v[50:51] op_sel:[0,1] op_sel_hi:[1,1]
    v_cvt_pk_bf16_f32 v76, v76, v77
    v_cvt_pk_bf16_f32 v77, v78, v79
    buffer_store_dwordx2 v[72:73], v56, s[12:15], s24 offen offset:768 sc0 sc1
    v_accvgpr_read_b32 v80, a4
    v_accvgpr_read_b32 v81, a16
    v_accvgpr_read_b32 v82, a28
    v_accvgpr_read_b32 v83, a40
    v_pk_mul_f32 v[80:81], v[80:81], v[48:49] op_sel_hi:[1,0]
    v_pk_mul_f32 v[82:83], v[82:83], v[48:49] op_sel_hi:[1,0]
    v_cvt_pk_bf16_f32 v80, v80, v81
    v_cvt_pk_bf16_f32 v81, v82, v83
    buffer_store_dwordx2 v[76:77], v56, s[12:15], s24 offen offset:1152 sc0 sc1
    v_accvgpr_read_b32 v84, a5
    v_accvgpr_read_b32 v85, a17
    v_accvgpr_read_b32 v86, a29
    v_accvgpr_read_b32 v87, a41
    v_pk_mul_f32 v[84:85], v[84:85], v[48:49] op_sel:[0,1] op_sel_hi:[1,1]
    v_pk_mul_f32 v[86:87], v[86:87], v[48:49] op_sel:[0,1] op_sel_hi:[1,1]
    v_cvt_pk_bf16_f32 v84, v84, v85
    v_cvt_pk_bf16_f32 v85, v86, v87
    buffer_store_dwordx2 v[80:81], v56, s[12:15], s24 offen offset:128 sc0 sc1
    v_accvgpr_read_b32 v88, a6
    v_accvgpr_read_b32 v89, a18
    v_accvgpr_read_b32 v90, a30
    v_accvgpr_read_b32 v91, a42
    v_pk_mul_f32 v[88:89], v[88:89], v[50:51] op_sel_hi:[1,0]
    v_pk_mul_f32 v[90:91], v[90:91], v[50:51] op_sel_hi:[1,0]
    v_cvt_pk_bf16_f32 v88, v88, v89
    v_cvt_pk_bf16_f32 v89, v90, v91
    buffer_store_dwordx2 v[84:85], v56, s[12:15], s24 offen offset:512 sc0 sc1
    v_accvgpr_read_b32 v92, a7
    v_accvgpr_read_b32 v93, a19
    v_accvgpr_read_b32 v94, a31
    v_accvgpr_read_b32 v95, a43
    v_pk_mul_f32 v[92:93], v[92:93], v[50:51] op_sel:[0,1] op_sel_hi:[1,1]
    v_pk_mul_f32 v[94:95], v[94:95], v[50:51] op_sel:[0,1] op_sel_hi:[1,1]
    v_cvt_pk_bf16_f32 v92, v92, v93
    v_cvt_pk_bf16_f32 v93, v94, v95
    buffer_store_dwordx2 v[88:89], v56, s[12:15], s24 offen offset:896 sc0 sc1
    v_accvgpr_read_b32 v96, a8
    v_accvgpr_read_b32 v97, a20
    v_accvgpr_read_b32 v98, a32
    v_accvgpr_read_b32 v99, a44
    v_pk_mul_f32 v[96:97], v[96:97], v[48:49] op_sel_hi:[1,0]
    v_pk_mul_f32 v[98:99], v[98:99], v[48:49] op_sel_hi:[1,0]
    v_cvt_pk_bf16_f32 v96, v96, v97
    v_cvt_pk_bf16_f32 v97, v98, v99
    buffer_store_dwordx2 v[92:93], v56, s[12:15], s24 offen offset:1280 sc0 sc1
    v_accvgpr_read_b32 v100, a9
    v_accvgpr_read_b32 v101, a21
    v_accvgpr_read_b32 v102, a33
    v_accvgpr_read_b32 v103, a45
    v_pk_mul_f32 v[100:101], v[100:101], v[48:49] op_sel:[0,1] op_sel_hi:[1,1]
    v_pk_mul_f32 v[102:103], v[102:103], v[48:49] op_sel:[0,1] op_sel_hi:[1,1]
    v_cvt_pk_bf16_f32 v100, v100, v101
    v_cvt_pk_bf16_f32 v101, v102, v103
    buffer_store_dwordx2 v[96:97], v56, s[12:15], s24 offen offset:256 sc0 sc1
    v_accvgpr_read_b32 v104, a10
    v_accvgpr_read_b32 v105, a22
    v_accvgpr_read_b32 v106, a34
    v_accvgpr_read_b32 v107, a46
    v_pk_mul_f32 v[104:105], v[104:105], v[50:51] op_sel_hi:[1,0]
    v_pk_mul_f32 v[106:107], v[106:107], v[50:51] op_sel_hi:[1,0]
    v_cvt_pk_bf16_f32 v104, v104, v105
    v_cvt_pk_bf16_f32 v105, v106, v107
    buffer_store_dwordx2 v[100:101], v56, s[12:15], s24 offen offset:640 sc0 sc1
    v_accvgpr_read_b32 v108, a11
    v_accvgpr_read_b32 v109, a23
    v_accvgpr_read_b32 v110, a35
    v_accvgpr_read_b32 v111, a47
    v_pk_mul_f32 v[108:109], v[108:109], v[50:51] op_sel:[0,1] op_sel_hi:[1,1]
    v_pk_mul_f32 v[110:111], v[110:111], v[50:51] op_sel:[0,1] op_sel_hi:[1,1]
    v_cvt_pk_bf16_f32 v108, v108, v109
    v_cvt_pk_bf16_f32 v109, v110, v111
    buffer_store_dwordx2 v[104:105], v56, s[12:15], s24 offen offset:1024 sc0 sc1
    v_accvgpr_read_b32 v112, a48
    v_accvgpr_read_b32 v113, a60
    v_accvgpr_read_b32 v114, a72
    v_accvgpr_read_b32 v115, a84
    v_pk_mul_f32 v[112:113], v[112:113], v[52:53] op_sel_hi:[1,0]
    v_pk_mul_f32 v[114:115], v[114:115], v[52:53] op_sel_hi:[1,0]
    v_cvt_pk_bf16_f32 v112, v112, v113
    v_cvt_pk_bf16_f32 v113, v114, v115
    buffer_store_dwordx2 v[108:109], v56, s[12:15], s24 offen offset:1408 sc0 sc1
    v_accvgpr_read_b32 v116, a49
    v_accvgpr_read_b32 v117, a61
    v_accvgpr_read_b32 v118, a73
    v_accvgpr_read_b32 v119, a85
    v_pk_mul_f32 v[116:117], v[116:117], v[52:53] op_sel:[0,1] op_sel_hi:[1,1]
    v_pk_mul_f32 v[118:119], v[118:119], v[52:53] op_sel:[0,1] op_sel_hi:[1,1]
    v_cvt_pk_bf16_f32 v116, v116, v117
    v_cvt_pk_bf16_f32 v117, v118, v119
    buffer_store_dwordx2 v[112:113], v56, s[12:15], s40 offen offset:0 sc0 sc1
    v_accvgpr_read_b32 v120, a50
    v_accvgpr_read_b32 v121, a62
    v_accvgpr_read_b32 v122, a74
    v_accvgpr_read_b32 v123, a86
    v_pk_mul_f32 v[120:121], v[120:121], v[54:55] op_sel_hi:[1,0]
    v_pk_mul_f32 v[122:123], v[122:123], v[54:55] op_sel_hi:[1,0]
    v_cvt_pk_bf16_f32 v120, v120, v121
    v_cvt_pk_bf16_f32 v121, v122, v123
    buffer_store_dwordx2 v[116:117], v56, s[12:15], s40 offen offset:384 sc0 sc1
    v_accvgpr_read_b32 v124, a51
    v_accvgpr_read_b32 v125, a63
    v_accvgpr_read_b32 v126, a75
    v_accvgpr_read_b32 v127, a87
    v_pk_mul_f32 v[124:125], v[124:125], v[54:55] op_sel:[0,1] op_sel_hi:[1,1]
    v_pk_mul_f32 v[126:127], v[126:127], v[54:55] op_sel:[0,1] op_sel_hi:[1,1]
    v_cvt_pk_bf16_f32 v124, v124, v125
    v_cvt_pk_bf16_f32 v125, v126, v127
    buffer_store_dwordx2 v[120:121], v56, s[12:15], s40 offen offset:768 sc0 sc1
    v_accvgpr_read_b32 v64, a52
    v_accvgpr_read_b32 v65, a64
    v_accvgpr_read_b32 v66, a76
    v_accvgpr_read_b32 v67, a88
    v_pk_mul_f32 v[64:65], v[64:65], v[52:53] op_sel_hi:[1,0]
    v_pk_mul_f32 v[66:67], v[66:67], v[52:53] op_sel_hi:[1,0]
    v_cvt_pk_bf16_f32 v64, v64, v65
    v_cvt_pk_bf16_f32 v65, v66, v67
    buffer_store_dwordx2 v[124:125], v56, s[12:15], s40 offen offset:1152 sc0 sc1
    v_accvgpr_read_b32 v68, a53
    v_accvgpr_read_b32 v69, a65
    v_accvgpr_read_b32 v70, a77
    v_accvgpr_read_b32 v71, a89
    v_pk_mul_f32 v[68:69], v[68:69], v[52:53] op_sel:[0,1] op_sel_hi:[1,1]
    v_pk_mul_f32 v[70:71], v[70:71], v[52:53] op_sel:[0,1] op_sel_hi:[1,1]
    v_cvt_pk_bf16_f32 v68, v68, v69
    v_cvt_pk_bf16_f32 v69, v70, v71
    buffer_store_dwordx2 v[64:65], v56, s[12:15], s40 offen offset:128 sc0 sc1
    v_accvgpr_read_b32 v72, a54
    v_accvgpr_read_b32 v73, a66
    v_accvgpr_read_b32 v74, a78
    v_accvgpr_read_b32 v75, a90
    v_pk_mul_f32 v[72:73], v[72:73], v[54:55] op_sel_hi:[1,0]
    v_pk_mul_f32 v[74:75], v[74:75], v[54:55] op_sel_hi:[1,0]
    v_cvt_pk_bf16_f32 v72, v72, v73
    v_cvt_pk_bf16_f32 v73, v74, v75
    buffer_store_dwordx2 v[68:69], v56, s[12:15], s40 offen offset:512 sc0 sc1
    v_accvgpr_read_b32 v76, a55
    v_accvgpr_read_b32 v77, a67
    v_accvgpr_read_b32 v78, a79
    v_accvgpr_read_b32 v79, a91
    v_pk_mul_f32 v[76:77], v[76:77], v[54:55] op_sel:[0,1] op_sel_hi:[1,1]
    v_pk_mul_f32 v[78:79], v[78:79], v[54:55] op_sel:[0,1] op_sel_hi:[1,1]
    v_cvt_pk_bf16_f32 v76, v76, v77
    v_cvt_pk_bf16_f32 v77, v78, v79
    buffer_store_dwordx2 v[72:73], v56, s[12:15], s40 offen offset:896 sc0 sc1
    v_accvgpr_read_b32 v80, a56
    v_accvgpr_read_b32 v81, a68
    v_accvgpr_read_b32 v82, a80
    v_accvgpr_read_b32 v83, a92
    v_pk_mul_f32 v[80:81], v[80:81], v[52:53] op_sel_hi:[1,0]
    v_pk_mul_f32 v[82:83], v[82:83], v[52:53] op_sel_hi:[1,0]
    v_cvt_pk_bf16_f32 v80, v80, v81
    v_cvt_pk_bf16_f32 v81, v82, v83
    buffer_store_dwordx2 v[76:77], v56, s[12:15], s40 offen offset:1280 sc0 sc1
    v_accvgpr_read_b32 v84, a57
    v_accvgpr_read_b32 v85, a69
    v_accvgpr_read_b32 v86, a81
    v_accvgpr_read_b32 v87, a93
    v_pk_mul_f32 v[84:85], v[84:85], v[52:53] op_sel:[0,1] op_sel_hi:[1,1]
    v_pk_mul_f32 v[86:87], v[86:87], v[52:53] op_sel:[0,1] op_sel_hi:[1,1]
    v_cvt_pk_bf16_f32 v84, v84, v85
    v_cvt_pk_bf16_f32 v85, v86, v87
    buffer_store_dwordx2 v[80:81], v56, s[12:15], s40 offen offset:256 sc0 sc1
    v_accvgpr_read_b32 v88, a58
    v_accvgpr_read_b32 v89, a70
    v_accvgpr_read_b32 v90, a82
    v_accvgpr_read_b32 v91, a94
    v_pk_mul_f32 v[88:89], v[88:89], v[54:55] op_sel_hi:[1,0]
    v_pk_mul_f32 v[90:91], v[90:91], v[54:55] op_sel_hi:[1,0]
    v_cvt_pk_bf16_f32 v88, v88, v89
    v_cvt_pk_bf16_f32 v89, v90, v91
    buffer_store_dwordx2 v[84:85], v56, s[12:15], s40 offen offset:640 sc0 sc1
    v_accvgpr_read_b32 v92, a59
    v_accvgpr_read_b32 v93, a71
    v_accvgpr_read_b32 v94, a83
    v_accvgpr_read_b32 v95, a95
    v_pk_mul_f32 v[92:93], v[92:93], v[54:55] op_sel:[0,1] op_sel_hi:[1,1]
    v_pk_mul_f32 v[94:95], v[94:95], v[54:55] op_sel:[0,1] op_sel_hi:[1,1]
    v_cvt_pk_bf16_f32 v92, v92, v93
    v_cvt_pk_bf16_f32 v93, v94, v95
    buffer_store_dwordx2 v[88:89], v56, s[12:15], s40 offen offset:1024 sc0 sc1
    v_accvgpr_read_b32 v96, a96
    v_accvgpr_read_b32 v97, a108
    v_accvgpr_read_b32 v98, a120
    v_accvgpr_read_b32 v99, a132
    v_pk_mul_f32 v[96:97], v[96:97], v[128:129] op_sel_hi:[1,0]
    v_pk_mul_f32 v[98:99], v[98:99], v[128:129] op_sel_hi:[1,0]
    v_cvt_pk_bf16_f32 v96, v96, v97
    v_cvt_pk_bf16_f32 v97, v98, v99
    buffer_store_dwordx2 v[92:93], v56, s[12:15], s40 offen offset:1408 sc0 sc1
    v_accvgpr_read_b32 v100, a97
    v_accvgpr_read_b32 v101, a109
    v_accvgpr_read_b32 v102, a121
    v_accvgpr_read_b32 v103, a133
    v_pk_mul_f32 v[100:101], v[100:101], v[128:129] op_sel:[0,1] op_sel_hi:[1,1]
    v_pk_mul_f32 v[102:103], v[102:103], v[128:129] op_sel:[0,1] op_sel_hi:[1,1]
    v_cvt_pk_bf16_f32 v100, v100, v101
    v_cvt_pk_bf16_f32 v101, v102, v103
    buffer_store_dwordx2 v[96:97], v56, s[12:15], s41 offen offset:0 sc0 sc1
    v_accvgpr_read_b32 v104, a98
    v_accvgpr_read_b32 v105, a110
    v_accvgpr_read_b32 v106, a122
    v_accvgpr_read_b32 v107, a134
    v_pk_mul_f32 v[104:105], v[104:105], v[130:131] op_sel_hi:[1,0]
    v_pk_mul_f32 v[106:107], v[106:107], v[130:131] op_sel_hi:[1,0]
    v_cvt_pk_bf16_f32 v104, v104, v105
    v_cvt_pk_bf16_f32 v105, v106, v107
    buffer_store_dwordx2 v[100:101], v56, s[12:15], s41 offen offset:384 sc0 sc1
    v_accvgpr_read_b32 v108, a99
    v_accvgpr_read_b32 v109, a111
    v_accvgpr_read_b32 v110, a123
    v_accvgpr_read_b32 v111, a135
    v_pk_mul_f32 v[108:109], v[108:109], v[130:131] op_sel:[0,1] op_sel_hi:[1,1]
    v_pk_mul_f32 v[110:111], v[110:111], v[130:131] op_sel:[0,1] op_sel_hi:[1,1]
    v_cvt_pk_bf16_f32 v108, v108, v109
    v_cvt_pk_bf16_f32 v109, v110, v111
    buffer_store_dwordx2 v[104:105], v56, s[12:15], s41 offen offset:768 sc0 sc1
    v_accvgpr_read_b32 v112, a100
    v_accvgpr_read_b32 v113, a112
    v_accvgpr_read_b32 v114, a124
    v_accvgpr_read_b32 v115, a136
    v_pk_mul_f32 v[112:113], v[112:113], v[128:129] op_sel_hi:[1,0]
    v_pk_mul_f32 v[114:115], v[114:115], v[128:129] op_sel_hi:[1,0]
    v_cvt_pk_bf16_f32 v112, v112, v113
    v_cvt_pk_bf16_f32 v113, v114, v115
    buffer_store_dwordx2 v[108:109], v56, s[12:15], s41 offen offset:1152 sc0 sc1
    v_accvgpr_read_b32 v116, a101
    v_accvgpr_read_b32 v117, a113
    v_accvgpr_read_b32 v118, a125
    v_accvgpr_read_b32 v119, a137
    v_pk_mul_f32 v[116:117], v[116:117], v[128:129] op_sel:[0,1] op_sel_hi:[1,1]
    v_pk_mul_f32 v[118:119], v[118:119], v[128:129] op_sel:[0,1] op_sel_hi:[1,1]
    v_cvt_pk_bf16_f32 v116, v116, v117
    v_cvt_pk_bf16_f32 v117, v118, v119
    buffer_store_dwordx2 v[112:113], v56, s[12:15], s41 offen offset:128 sc0 sc1
    v_accvgpr_read_b32 v120, a102
    v_accvgpr_read_b32 v121, a114
    v_accvgpr_read_b32 v122, a126
    v_accvgpr_read_b32 v123, a138
    v_pk_mul_f32 v[120:121], v[120:121], v[130:131] op_sel_hi:[1,0]
    v_pk_mul_f32 v[122:123], v[122:123], v[130:131] op_sel_hi:[1,0]
    v_cvt_pk_bf16_f32 v120, v120, v121
    v_cvt_pk_bf16_f32 v121, v122, v123
    buffer_store_dwordx2 v[116:117], v56, s[12:15], s41 offen offset:512 sc0 sc1
    v_accvgpr_read_b32 v124, a103
    v_accvgpr_read_b32 v125, a115
    v_accvgpr_read_b32 v126, a127
    v_accvgpr_read_b32 v127, a139
    v_pk_mul_f32 v[124:125], v[124:125], v[130:131] op_sel:[0,1] op_sel_hi:[1,1]
    v_pk_mul_f32 v[126:127], v[126:127], v[130:131] op_sel:[0,1] op_sel_hi:[1,1]
    v_cvt_pk_bf16_f32 v124, v124, v125
    v_cvt_pk_bf16_f32 v125, v126, v127
    buffer_store_dwordx2 v[120:121], v56, s[12:15], s41 offen offset:896 sc0 sc1
    v_accvgpr_read_b32 v64, a104
    v_accvgpr_read_b32 v65, a116
    v_accvgpr_read_b32 v66, a128
    v_accvgpr_read_b32 v67, a140
    v_pk_mul_f32 v[64:65], v[64:65], v[128:129] op_sel_hi:[1,0]
    v_pk_mul_f32 v[66:67], v[66:67], v[128:129] op_sel_hi:[1,0]
    v_cvt_pk_bf16_f32 v64, v64, v65
    v_cvt_pk_bf16_f32 v65, v66, v67
    buffer_store_dwordx2 v[124:125], v56, s[12:15], s41 offen offset:1280 sc0 sc1
    v_accvgpr_read_b32 v68, a105
    v_accvgpr_read_b32 v69, a117
    v_accvgpr_read_b32 v70, a129
    v_accvgpr_read_b32 v71, a141
    v_pk_mul_f32 v[68:69], v[68:69], v[128:129] op_sel:[0,1] op_sel_hi:[1,1]
    v_pk_mul_f32 v[70:71], v[70:71], v[128:129] op_sel:[0,1] op_sel_hi:[1,1]
    v_cvt_pk_bf16_f32 v68, v68, v69
    v_cvt_pk_bf16_f32 v69, v70, v71
    buffer_store_dwordx2 v[64:65], v56, s[12:15], s41 offen offset:256 sc0 sc1
    v_accvgpr_read_b32 v72, a106
    v_accvgpr_read_b32 v73, a118
    v_accvgpr_read_b32 v74, a130
    v_accvgpr_read_b32 v75, a142
    v_pk_mul_f32 v[72:73], v[72:73], v[130:131] op_sel_hi:[1,0]
    v_pk_mul_f32 v[74:75], v[74:75], v[130:131] op_sel_hi:[1,0]
    v_cvt_pk_bf16_f32 v72, v72, v73
    v_cvt_pk_bf16_f32 v73, v74, v75
    buffer_store_dwordx2 v[68:69], v56, s[12:15], s41 offen offset:640 sc0 sc1
    v_accvgpr_read_b32 v76, a107
    v_accvgpr_read_b32 v77, a119
    v_accvgpr_read_b32 v78, a131
    v_accvgpr_read_b32 v79, a143
    v_pk_mul_f32 v[76:77], v[76:77], v[130:131] op_sel:[0,1] op_sel_hi:[1,1]
    v_pk_mul_f32 v[78:79], v[78:79], v[130:131] op_sel:[0,1] op_sel_hi:[1,1]
    v_cvt_pk_bf16_f32 v76, v76, v77
    v_cvt_pk_bf16_f32 v77, v78, v79
    buffer_store_dwordx2 v[72:73], v56, s[12:15], s41 offen offset:1024 sc0 sc1
    v_accvgpr_read_b32 v80, a144
    v_accvgpr_read_b32 v81, a156
    v_accvgpr_read_b32 v82, a168
    v_accvgpr_read_b32 v83, a180
    v_pk_mul_f32 v[80:81], v[80:81], v[132:133] op_sel_hi:[1,0]
    v_pk_mul_f32 v[82:83], v[82:83], v[132:133] op_sel_hi:[1,0]
    v_cvt_pk_bf16_f32 v80, v80, v81
    v_cvt_pk_bf16_f32 v81, v82, v83
    buffer_store_dwordx2 v[76:77], v56, s[12:15], s41 offen offset:1408 sc0 sc1
    v_accvgpr_read_b32 v84, a145
    v_accvgpr_read_b32 v85, a157
    v_accvgpr_read_b32 v86, a169
    v_accvgpr_read_b32 v87, a181
    v_pk_mul_f32 v[84:85], v[84:85], v[132:133] op_sel:[0,1] op_sel_hi:[1,1]
    v_pk_mul_f32 v[86:87], v[86:87], v[132:133] op_sel:[0,1] op_sel_hi:[1,1]
    v_cvt_pk_bf16_f32 v84, v84, v85
    v_cvt_pk_bf16_f32 v85, v86, v87
    buffer_store_dwordx2 v[80:81], v56, s[12:15], s42 offen offset:0 sc0 sc1
    v_accvgpr_read_b32 v88, a146
    v_accvgpr_read_b32 v89, a158
    v_accvgpr_read_b32 v90, a170
    v_accvgpr_read_b32 v91, a182
    v_pk_mul_f32 v[88:89], v[88:89], v[134:135] op_sel_hi:[1,0]
    v_pk_mul_f32 v[90:91], v[90:91], v[134:135] op_sel_hi:[1,0]
    v_cvt_pk_bf16_f32 v88, v88, v89
    v_cvt_pk_bf16_f32 v89, v90, v91
    buffer_store_dwordx2 v[84:85], v56, s[12:15], s42 offen offset:384 sc0 sc1
    v_accvgpr_read_b32 v92, a147
    v_accvgpr_read_b32 v93, a159
    v_accvgpr_read_b32 v94, a171
    v_accvgpr_read_b32 v95, a183
    v_pk_mul_f32 v[92:93], v[92:93], v[134:135] op_sel:[0,1] op_sel_hi:[1,1]
    v_pk_mul_f32 v[94:95], v[94:95], v[134:135] op_sel:[0,1] op_sel_hi:[1,1]
    v_cvt_pk_bf16_f32 v92, v92, v93
    v_cvt_pk_bf16_f32 v93, v94, v95
    buffer_store_dwordx2 v[88:89], v56, s[12:15], s42 offen offset:768 sc0 sc1
    v_accvgpr_read_b32 v96, a148
    v_accvgpr_read_b32 v97, a160
    v_accvgpr_read_b32 v98, a172
    v_accvgpr_read_b32 v99, a184
    v_pk_mul_f32 v[96:97], v[96:97], v[132:133] op_sel_hi:[1,0]
    v_pk_mul_f32 v[98:99], v[98:99], v[132:133] op_sel_hi:[1,0]
    v_cvt_pk_bf16_f32 v96, v96, v97
    v_cvt_pk_bf16_f32 v97, v98, v99
    buffer_store_dwordx2 v[92:93], v56, s[12:15], s42 offen offset:1152 sc0 sc1
    v_accvgpr_read_b32 v100, a149
    v_accvgpr_read_b32 v101, a161
    v_accvgpr_read_b32 v102, a173
    v_accvgpr_read_b32 v103, a185
    v_pk_mul_f32 v[100:101], v[100:101], v[132:133] op_sel:[0,1] op_sel_hi:[1,1]
    v_pk_mul_f32 v[102:103], v[102:103], v[132:133] op_sel:[0,1] op_sel_hi:[1,1]
    v_cvt_pk_bf16_f32 v100, v100, v101
    v_cvt_pk_bf16_f32 v101, v102, v103
    buffer_store_dwordx2 v[96:97], v56, s[12:15], s42 offen offset:128 sc0 sc1
    v_accvgpr_read_b32 v104, a150
    v_accvgpr_read_b32 v105, a162
    v_accvgpr_read_b32 v106, a174
    v_accvgpr_read_b32 v107, a186
    v_pk_mul_f32 v[104:105], v[104:105], v[134:135] op_sel_hi:[1,0]
    v_pk_mul_f32 v[106:107], v[106:107], v[134:135] op_sel_hi:[1,0]
    v_cvt_pk_bf16_f32 v104, v104, v105
    v_cvt_pk_bf16_f32 v105, v106, v107
    buffer_store_dwordx2 v[100:101], v56, s[12:15], s42 offen offset:512 sc0 sc1
    v_accvgpr_read_b32 v108, a151
    v_accvgpr_read_b32 v109, a163
    v_accvgpr_read_b32 v110, a175
    v_accvgpr_read_b32 v111, a187
    v_pk_mul_f32 v[108:109], v[108:109], v[134:135] op_sel:[0,1] op_sel_hi:[1,1]
    v_pk_mul_f32 v[110:111], v[110:111], v[134:135] op_sel:[0,1] op_sel_hi:[1,1]
    v_cvt_pk_bf16_f32 v108, v108, v109
    v_cvt_pk_bf16_f32 v109, v110, v111
    buffer_store_dwordx2 v[104:105], v56, s[12:15], s42 offen offset:896 sc0 sc1
    v_accvgpr_read_b32 v112, a152
    v_accvgpr_read_b32 v113, a164
    v_accvgpr_read_b32 v114, a176
    v_accvgpr_read_b32 v115, a188
    v_pk_mul_f32 v[112:113], v[112:113], v[132:133] op_sel_hi:[1,0]
    v_pk_mul_f32 v[114:115], v[114:115], v[132:133] op_sel_hi:[1,0]
    v_cvt_pk_bf16_f32 v112, v112, v113
    v_cvt_pk_bf16_f32 v113, v114, v115
    buffer_store_dwordx2 v[108:109], v56, s[12:15], s42 offen offset:1280 sc0 sc1
    v_accvgpr_read_b32 v116, a153
    v_accvgpr_read_b32 v117, a165
    v_accvgpr_read_b32 v118, a177
    v_accvgpr_read_b32 v119, a189
    v_pk_mul_f32 v[116:117], v[116:117], v[132:133] op_sel:[0,1] op_sel_hi:[1,1]
    v_pk_mul_f32 v[118:119], v[118:119], v[132:133] op_sel:[0,1] op_sel_hi:[1,1]
    v_cvt_pk_bf16_f32 v116, v116, v117
    v_cvt_pk_bf16_f32 v117, v118, v119
    buffer_store_dwordx2 v[112:113], v56, s[12:15], s42 offen offset:256 sc0 sc1
    v_accvgpr_read_b32 v120, a154
    v_accvgpr_read_b32 v121, a166
    v_accvgpr_read_b32 v122, a178
    v_accvgpr_read_b32 v123, a190
    v_pk_mul_f32 v[120:121], v[120:121], v[134:135] op_sel_hi:[1,0]
    v_pk_mul_f32 v[122:123], v[122:123], v[134:135] op_sel_hi:[1,0]
    v_cvt_pk_bf16_f32 v120, v120, v121
    v_cvt_pk_bf16_f32 v121, v122, v123
    buffer_store_dwordx2 v[116:117], v56, s[12:15], s42 offen offset:640 sc0 sc1
    v_accvgpr_read_b32 v124, a155
    v_accvgpr_read_b32 v125, a167
    v_accvgpr_read_b32 v126, a179
    v_accvgpr_read_b32 v127, a191
    v_pk_mul_f32 v[124:125], v[124:125], v[134:135] op_sel:[0,1] op_sel_hi:[1,1]
    v_pk_mul_f32 v[126:127], v[126:127], v[134:135] op_sel:[0,1] op_sel_hi:[1,1]
    v_cvt_pk_bf16_f32 v124, v124, v125
    v_cvt_pk_bf16_f32 v125, v126, v127
    buffer_store_dwordx2 v[120:121], v56, s[12:15], s42 offen offset:1024 sc0 sc1
    buffer_store_dwordx2 v[124:125], v56, s[12:15], s42 offen offset:1408 sc0 sc1
    s_branch L_fin
.section .rodata,"a"
.p2align 6
.amdhsa_kernel standalone__kv_cache_quant_int4_int2_kv_with_per_channel_or_per_token_scales__prompt_kernel
  .amdhsa_next_free_vgpr 512
  .amdhsa_next_free_sgpr 102
  .amdhsa_accum_offset 256
  .amdhsa_group_segment_fixed_size 0
  .amdhsa_kernarg_size 80
  .amdhsa_user_sgpr_count 2
  .amdhsa_user_sgpr_kernarg_segment_ptr 1
  .amdhsa_system_sgpr_workgroup_id_x 1
.end_amdhsa_kernel
```

```asm
; @launch grid=(256,1,1) block=(256,1,1) lds=147584
.amdgcn_target "amdgcn-amd-amdhsa--gfx950"
.text
.globl standalone__kv_cache_quant_int4_int2_kv_with_per_channel_or_per_token_scales__prompt_kernel
.p2align 8
.type standalone__kv_cache_quant_int4_int2_kv_with_per_channel_or_per_token_scales__prompt_kernel,@function
standalone__kv_cache_quant_int4_int2_kv_with_per_channel_or_per_token_scales__prompt_kernel:
    s_cmp_ge_u32 s2, 256
    s_cbranch_scc1 L_done
    s_load_dwordx16 s[40:55], s[0:1], 0
    s_load_dwordx4 s[16:19], s[0:1], 64
    s_and_b32 s94, s2, 7
    s_lshr_b32 s95, s2, 3
    s_lshr_b32 s24, s95, 3
    s_lshl_b32 s94, s94, 2
    s_add_u32 s94, s94, s24
    s_and_b32 s95, s95, 7
    s_getpc_b64 s[60:61]
L_pc:
    s_sub_u32 s60, s60, L_pc-standalone__kv_cache_quant_int4_int2_kv_with_per_channel_or_per_token_scales__prompt_kernel
    s_subb_u32 s61, s61, 0
    s_mov_b32 s62, L_slow-standalone__kv_cache_quant_int4_int2_kv_with_per_channel_or_per_token_scales__prompt_kernel
    s_mov_b32 s63, 0x20000
    s_lshr_b32 s22, s2, 3
    s_lshl_b32 s22, s22, 12
    v_lshlrev_b32 v30, 4, v0
    buffer_load_dwordx4 v[128:131], v30, s[60:63], s22 offen
    v_lshrrev_b32 v24, 6, v0
    v_and_b32 v25, 63, v0
    v_readfirstlane_b32 s25, v24
    v_lshlrev_b32 v1, 4, v25
    v_mul_u32_u24 v26, 43, v25
    v_lshrrev_b32 v26, 10, v26
    v_mul_u32_u24 v27, 24, v26
    v_sub_u32 v27, v25, v27
    v_lshrrev_b32 v28, 1, v24
    v_and_b32 v29, 1, v24
    v_lshlrev_b32 v30, 4, v29
    v_lshl_add_u32 v30, v28, 2, v30
    v_add_u32 v30, v30, v26
    v_mul_u32_u24 v30, 768, v30
    v_lshrrev_b32 v48, 1, v26
    v_lshlrev_b32 v48, 30, v48
    v_lshl_add_u32 v30, v27, 4, v30
    v_or_b32 v9, v30, v48
    v_lshl_or_b32 v10, v27, 3, v48
    v_mul_u32_u24 v30, 6144, v24
    v_mul_u32_u24 v31, 12, v25
    v_add_u32 v12, v30, v31
    s_mov_b32 s66, 1572864
    s_mov_b32 s67, 0x20000
    s_mov_b32 s70, 1572864
    s_mov_b32 s71, 0x20000
    s_mov_b32 s74, 12288
    s_mov_b32 s75, 0x20000
    s_mov_b32 s78, 12288
    s_mov_b32 s79, 0x20000
    s_mov_b32 s82, 4096
    s_mov_b32 s83, 0x20000
    s_mov_b32 s86, 4096
    s_mov_b32 s87, 0x20000
    s_mov_b32 s22, 64
    s_mov_b32 s23, 0x20000
    s_mul_i32 s33, s95, 24576
    s_add_u32 s34, s33, 6144
    s_mov_b32 s35, s33
    s_lshr_b32 s36, s95, 1
    s_mul_i32 s36, s36, 384
    s_lshl_b32 s37, s95, 6
    s_lshl_b32 s24, s25, 4
    s_add_u32 s37, s37, s24
    s_mul_i32 s24, s94, 1572864
    s_mul_i32 s56, s94, 12288
    s_lshl_b32 s57, s94, 12
    s_lshl_b32 s58, s94, 10
    s_add_u32 s58, s58, 51380320
    s_or_b32 s39, s95, s25
    s_waitcnt lgkmcnt(0)
    s_add_u32 s64, s42, s24
    s_addc_u32 s65, s43, 0
    s_add_u32 s72, s46, s56
    s_addc_u32 s73, s47, 0
    s_add_u32 s76, s48, s56
    s_addc_u32 s77, s49, 0
    buffer_load_dwordx4 v[224:227], v9, s[64:67], s33 offen offset:0 nt
    buffer_load_dwordx4 v[228:231], v9, s[64:67], s33 offen offset:1536 nt
    buffer_load_dwordx4 v[232:235], v9, s[64:67], s34 offen offset:0 nt
    buffer_load_dwordx4 v[236:239], v9, s[64:67], s34 offen offset:1536 nt
    buffer_load_dwordx2 v[32:33], v10, s[72:75], s36 offen offset:0
    buffer_load_dwordx2 v[34:35], v10, s[76:79], s36 offen offset:0
    buffer_load_dwordx2 v[36:37], v10, s[72:75], s36 offen offset:192
    buffer_load_dwordx2 v[38:39], v10, s[76:79], s36 offen offset:192
    s_add_u32 s20, s18, s58
    s_addc_u32 s21, s19, 0
    s_add_u32 s80, s50, s57
    s_addc_u32 s81, s51, 0
    s_add_u32 s84, s52, s57
    s_addc_u32 s85, s53, 0
    s_add_u32 s68, s44, s24
    s_addc_u32 s69, s45, 0
    s_mul_i32 s59, s94, 786432
    s_add_u32 s12, s54, s59
    s_addc_u32 s13, s55, 0
    s_add_u32 s8, s40, s59
    s_addc_u32 s9, s41, 0
    s_cmp_lg_u32 s39, 0
    s_cbranch_scc1 L_notleader0
    s_buffer_load_dwordx16 s[40:55], s[20:23], 0 glc
L_notleader0:
    buffer_load_dwordx4 v[240:243], v9, s[64:67], s33 offen offset:384 nt
    buffer_load_dwordx4 v[244:247], v9, s[64:67], s33 offen offset:1920 nt
    buffer_load_dwordx4 v[248:251], v9, s[64:67], s34 offen offset:384 nt
    buffer_load_dwordx4 v[252:255], v9, s[64:67], s34 offen offset:1920 nt
    s_add_u32 s4, s18, s24
    s_addc_u32 s5, s19, 0
    s_mov_b32 s6, 1572864
    s_mov_b32 s7, 0x20000
    s_mov_b32 s10, 786432
    s_mov_b32 s11, 0x20000
    s_mov_b32 s88, s16
    s_mov_b32 s89, s17
    s_add_u32 s16, s33, 3072
    s_add_u32 s17, s33, 6144
    s_mov_b32 s90, 256
    s_mov_b32 s91, 0x20000
    s_lshl_b32 s93, s94, 3
    s_cmp_lg_u32 s39, 0
    s_cbranch_scc1 L_notleader
    s_waitcnt lgkmcnt(0)
    s_mov_b32 s59, 1
    s_lshr_b32 s40, s40, 10
    s_min_u32 s40, s40, 31
    s_bitset1_b32 s59, s40
    s_lshr_b32 s41, s41, 10
    s_min_u32 s41, s41, 31
    s_bitset1_b32 s59, s41
    s_lshr_b32 s42, s42, 10
    s_min_u32 s42, s42, 31
    s_bitset1_b32 s59, s42
    s_lshr_b32 s43, s43, 10
    s_min_u32 s43, s43, 31
    s_bitset1_b32 s59, s43
    s_lshr_b32 s44, s44, 10
    s_min_u32 s44, s44, 31
    s_bitset1_b32 s59, s44
    s_lshr_b32 s45, s45, 10
    s_min_u32 s45, s45, 31
    s_bitset1_b32 s59, s45
    s_lshr_b32 s46, s46, 10
    s_min_u32 s46, s46, 31
    s_bitset1_b32 s59, s46
    s_lshr_b32 s47, s47, 10
    s_min_u32 s47, s47, 31
    s_bitset1_b32 s59, s47
    s_lshr_b32 s48, s48, 10
    s_min_u32 s48, s48, 31
    s_bitset1_b32 s59, s48
    s_lshr_b32 s49, s49, 10
    s_min_u32 s49, s49, 31
    s_bitset1_b32 s59, s49
    s_lshr_b32 s50, s50, 10
    s_min_u32 s50, s50, 31
    s_bitset1_b32 s59, s50
    s_lshr_b32 s51, s51, 10
    s_min_u32 s51, s51, 31
    s_bitset1_b32 s59, s51
    s_lshr_b32 s52, s52, 10
    s_min_u32 s52, s52, 31
    s_bitset1_b32 s59, s52
    s_lshr_b32 s53, s53, 10
    s_min_u32 s53, s53, 31
    s_bitset1_b32 s59, s53
    s_lshr_b32 s54, s54, 10
    s_min_u32 s54, s54, 31
    s_bitset1_b32 s59, s54
    s_lshr_b32 s55, s55, 10
    s_min_u32 s55, s55, 31
    s_bitset1_b32 s59, s55
    s_ff0_i32_b32 s59, s59
    s_lshl_b32 s59, s59, 10
    v_mov_b32 v52, s59
    s_mov_b64 exec, 1
    buffer_store_dword v52, off, s[88:91], s93 sc1
    s_mov_b64 exec, -1
L_notleader:
    s_lshl_b32 s24, s95, 2
    s_add_u32 s24, s24, 32
    s_buffer_load_dword s46, s[20:23], s24 glc
    s_getreg_b32 s45, hwreg(HW_REG_XCC_ID, 0, 4)
    s_lshl_b32 s45, s45, 5
    s_mov_b32 s44, 32
    buffer_load_dwordx3 v[112:114], v12, s[68:71], s35 offen offset:0 nt
    buffer_load_dwordx3 v[116:118], v12, s[68:71], s35 offen offset:768 nt
    buffer_load_dwordx3 v[120:122], v12, s[68:71], s35 offen offset:1536 nt
    buffer_load_dwordx3 v[124:126], v12, s[68:71], s35 offen offset:2304 nt
    buffer_load_dwordx2 v[40:41], off, s[80:83], s37 offset:0
    buffer_load_dwordx2 v[42:43], off, s[84:87], s37 offset:0
    buffer_load_dwordx2 v[44:45], off, s[80:83], s37 offset:8
    buffer_load_dwordx2 v[46:47], off, s[84:87], s37 offset:8
    s_mov_b32 s14, 786432
    s_mov_b32 s15, 0x20000
    s_lshl_b32 s24, s25, 8
    s_add_u32 s93, s93, s24
    v_mul_u32_u24 v30, 3072, v24
    v_add_u32 v4, v30, v1
    v_lshl_add_u32 v30, v24, 3, v26
    v_mul_u32_u24 v30, 384, v30
    v_lshlrev_b32 v31, 2, v29
    v_xor_b32 v31, v27, v31
    v_lshl_add_u32 v30, v31, 4, v30
    v_or_b32 v11, v30, v48
    v_lshlrev_b32 v30, 8, v24
    v_add_u32 v30, 12288, v30
    v_lshrrev_b32 v31, 5, v25
    v_mul_u32_u24 v31, 6144, v31
    v_add_u32 v30, v30, v31
    v_and_b32 v31, 1, v25
    v_mul_u32_u24 v31, 3072, v31
    v_add_u32 v30, v30, v31
    v_bfe_u32 v31, v25, 1, 4
    v_lshl_add_u32 v15, v31, 4, v30
    s_lshl_b32 s24, s95, 2
    v_lshl_add_u32 v13, v0, 2, s24
    v_cmp_lt_u32 vcc, 0, v0
    v_mov_b32 v30, 0x40000000
    s_nop 0
    v_cndmask_b32 v13, v13, v30, vcc
    s_mul_i32 s26, s25, 3072
    s_add_u32 s26, s26, 12288
    s_add_u32 s56, s26, 24576
    s_add_u32 s24, s95, 1
    s_and_b32 s24, s24, 7
    s_mul_i32 s32, s24, 24576
    s_add_u32 s27, s32, 12288
    s_mov_b32 s28, 98304
    s_mov_b32 s30, 73728
    v_add_u32 v1, 24576, v1
    s_mov_b32 s38, 0x3dd53b95
    s_mov_b32 s97, 0xffff0000
    s_mov_b32 s96, 100000
    v_and_b32 v26, 15, v25
    v_lshrrev_b32 v27, 4, v25
    v_bfe_u32 v28, v25, 1, 3
    v_xor_b32 v29, v27, v28
    v_mul_u32_u24 v30, 384, v26
    v_lshl_add_u32 v2, v29, 4, v30
    v_xor_b32 v3, 64, v2
    s_mul_i32 s40, s25, 6144
    s_add_u32 s40, s40, 73728
    v_lshrrev_b32 v29, 1, v27
    v_xor_b32 v29, v29, v28
    v_lshl_add_u32 v31, v29, 4, v30
    v_and_b32 v29, 1, v27
    v_lshl_add_u32 v31, v29, 3, v31
    v_xor_b32 v22, 0, v31
    v_add_u32 v22, s40, v22
    v_xor_b32 v23, 32, v31
    v_add_u32 v23, s40, v23
    v_xor_b32 v142, 64, v31
    v_add_u32 v142, s40, v142
    v_xor_b32 v143, 96, v31
    v_add_u32 v143, s40, v143
    s_lshl_b32 s24, s95, 2
    s_add_u32 s24, s24, s25
    s_mul_i32 s24, s24, 24576
    v_add_u32 v26, 0, v25
    v_mul_u32_u24 v27, 2731, v26
    v_lshrrev_b32 v27, 17, v27
    v_and_b32 v27, 7, v27
    v_xor_b32 v26, v26, v27
    v_lshlrev_b32 v136, 4, v26
    v_add_u32 v136, s24, v136
    v_add_u32 v26, 64, v25
    v_mul_u32_u24 v27, 2731, v26
    v_lshrrev_b32 v27, 17, v27
    v_and_b32 v27, 7, v27
    v_xor_b32 v26, v26, v27
    v_lshlrev_b32 v137, 4, v26
    v_add_u32 v137, s24, v137
    v_add_u32 v26, 128, v25
    v_mul_u32_u24 v27, 2731, v26
    v_lshrrev_b32 v27, 17, v27
    v_and_b32 v27, 7, v27
    v_xor_b32 v26, v26, v27
    v_lshlrev_b32 v138, 4, v26
    v_add_u32 v138, s24, v138
    v_add_u32 v26, 192, v25
    v_mul_u32_u24 v27, 2731, v26
    v_lshrrev_b32 v27, 17, v27
    v_and_b32 v27, 7, v27
    v_xor_b32 v26, v26, v27
    v_lshlrev_b32 v139, 4, v26
    v_add_u32 v139, s24, v139
    v_add_u32 v26, 256, v25
    v_mul_u32_u24 v27, 2731, v26
    v_lshrrev_b32 v27, 17, v27
    v_and_b32 v27, 7, v27
    v_xor_b32 v26, v26, v27
    v_lshlrev_b32 v140, 4, v26
    v_add_u32 v140, s24, v140
    v_add_u32 v26, 320, v25
    v_mul_u32_u24 v27, 2731, v26
    v_lshrrev_b32 v27, 17, v27
    v_and_b32 v27, 7, v27
    v_xor_b32 v26, v26, v27
    v_lshlrev_b32 v141, 4, v26
    v_add_u32 v141, s24, v141
    v_mov_b32 v5, 0
    v_mov_b32 v6, 0
    v_mov_b32 v7, 0
    v_mov_b32 v8, 0
    s_mov_b32 s62, -1
    s_mov_b32 s63, 0xffff
    s_waitcnt vmcnt(12)
    buffer_load_dwordx3 v[80:82], v12, s[68:71], s16 offen offset:0 nt
    buffer_load_dwordx3 v[84:86], v12, s[68:71], s16 offen offset:768 nt
    buffer_load_dwordx3 v[88:90], v12, s[68:71], s16 offen offset:1536 nt
    buffer_load_dwordx3 v[92:94], v12, s[68:71], s16 offen offset:2304 nt
    v_lshlrev_b32 v48, 16, v32
    v_and_b32 v49, s97, v32
    v_lshlrev_b32 v50, 16, v34
    v_and_b32 v51, s97, v34
    v_mul_f32 v48, s38, v48
    v_mul_f32 v49, s38, v49
    v_mul_f32_e64 v50, -v50, v48
    v_mul_f32_e64 v51, -v51, v49
    v_cvt_f32_i32 v224, v224
    v_cvt_f32_i32 v225, v225
    v_fma_f32 v224, v224, v48, v50
    v_fma_f32 v225, v225, v49, v51
    v_cvt_pk_bf16_f32 v224, v224, v225
    v_cvt_f32_i32 v228, v228
    v_cvt_f32_i32 v229, v229
    v_fma_f32 v228, v228, v48, v50
    v_fma_f32 v229, v229, v49, v51
    v_cvt_pk_bf16_f32 v228, v228, v229
    v_cvt_f32_i32 v232, v232
    v_cvt_f32_i32 v233, v233
    v_fma_f32 v232, v232, v48, v50
    v_fma_f32 v233, v233, v49, v51
    v_cvt_pk_bf16_f32 v232, v232, v233
    v_cvt_f32_i32 v236, v236
    v_cvt_f32_i32 v237, v237
    v_fma_f32 v236, v236, v48, v50
    v_fma_f32 v237, v237, v49, v51
    v_cvt_pk_bf16_f32 v236, v236, v237
    v_lshlrev_b32 v48, 16, v33
    v_and_b32 v49, s97, v33
    v_lshlrev_b32 v50, 16, v35
    v_and_b32 v51, s97, v35
    v_mul_f32 v48, s38, v48
    v_mul_f32 v49, s38, v49
    v_mul_f32_e64 v50, -v50, v48
    v_mul_f32_e64 v51, -v51, v49
    v_cvt_f32_i32 v226, v226
    v_cvt_f32_i32 v227, v227
    v_fma_f32 v226, v226, v48, v50
    v_fma_f32 v227, v227, v49, v51
    v_cvt_pk_bf16_f32 v225, v226, v227
    v_cvt_f32_i32 v230, v230
    v_cvt_f32_i32 v231, v231
    v_fma_f32 v230, v230, v48, v50
    v_fma_f32 v231, v231, v49, v51
    v_cvt_pk_bf16_f32 v229, v230, v231
    v_cvt_f32_i32 v234, v234
    v_cvt_f32_i32 v235, v235
    v_fma_f32 v234, v234, v48, v50
    v_fma_f32 v235, v235, v49, v51
    v_cvt_pk_bf16_f32 v233, v234, v235
    v_cvt_f32_i32 v238, v238
    v_cvt_f32_i32 v239, v239
    v_fma_f32 v238, v238, v48, v50
    v_fma_f32 v239, v239, v49, v51
    v_cvt_pk_bf16_f32 v237, v238, v239
    s_waitcnt vmcnt(12)
    v_lshlrev_b32 v48, 16, v36
    v_and_b32 v49, s97, v36
    v_lshlrev_b32 v50, 16, v38
    v_and_b32 v51, s97, v38
    v_mul_f32 v48, s38, v48
    v_mul_f32 v49, s38, v49
    v_mul_f32_e64 v50, -v50, v48
    v_mul_f32_e64 v51, -v51, v49
    v_cvt_f32_i32 v240, v240
    v_cvt_f32_i32 v241, v241
    v_fma_f32 v240, v240, v48, v50
    v_fma_f32 v241, v241, v49, v51
    v_cvt_pk_bf16_f32 v226, v240, v241
    v_cvt_f32_i32 v244, v244
    v_cvt_f32_i32 v245, v245
    v_fma_f32 v244, v244, v48, v50
    v_fma_f32 v245, v245, v49, v51
    v_cvt_pk_bf16_f32 v230, v244, v245
    v_cvt_f32_i32 v248, v248
    v_cvt_f32_i32 v249, v249
    v_fma_f32 v248, v248, v48, v50
    v_fma_f32 v249, v249, v49, v51
    v_cvt_pk_bf16_f32 v234, v248, v249
    v_cvt_f32_i32 v252, v252
    v_cvt_f32_i32 v253, v253
    v_fma_f32 v252, v252, v48, v50
    v_fma_f32 v253, v253, v49, v51
    v_cvt_pk_bf16_f32 v238, v252, v253
    v_lshlrev_b32 v48, 16, v37
    v_and_b32 v49, s97, v37
    v_lshlrev_b32 v50, 16, v39
    v_and_b32 v51, s97, v39
    v_mul_f32 v48, s38, v48
    v_mul_f32 v49, s38, v49
    v_mul_f32_e64 v50, -v50, v48
    v_mul_f32_e64 v51, -v51, v49
    v_cvt_f32_i32 v242, v242
    v_cvt_f32_i32 v243, v243
    v_fma_f32 v242, v242, v48, v50
    v_fma_f32 v243, v243, v49, v51
    v_cvt_pk_bf16_f32 v227, v242, v243
    v_cvt_f32_i32 v246, v246
    v_cvt_f32_i32 v247, v247
    v_fma_f32 v246, v246, v48, v50
    v_fma_f32 v247, v247, v49, v51
    v_cvt_pk_bf16_f32 v231, v246, v247
    v_cvt_f32_i32 v250, v250
    v_cvt_f32_i32 v251, v251
    v_fma_f32 v250, v250, v48, v50
    v_fma_f32 v251, v251, v49, v51
    v_cvt_pk_bf16_f32 v235, v250, v251
    v_cvt_f32_i32 v254, v254
    v_cvt_f32_i32 v255, v255
    v_fma_f32 v254, v254, v48, v50
    v_fma_f32 v255, v255, v49, v51
    v_cvt_pk_bf16_f32 v239, v254, v255
    buffer_store_dwordx4 v[224:227], v11, s[4:7], s33 offen offset:0
    s_mov_b64 exec, s[62:63]
    ds_write_b128 v11, v[224:227] offset:0
    s_mov_b64 exec, -1
    v_xor_b32 v55, 16, v11
    buffer_store_dwordx4 v[228:231], v55, s[4:7], s33 offen offset:768
    s_mov_b64 exec, s[62:63]
    ds_write_b128 v55, v[228:231] offset:768
    s_mov_b64 exec, -1
    v_xor_b32 v54, 32, v11
    buffer_store_dwordx4 v[232:235], v54, s[4:7], s33 offen offset:1536
    s_mov_b64 exec, s[62:63]
    ds_write_b128 v54, v[232:235] offset:1536
    s_mov_b64 exec, -1
    v_xor_b32 v55, 48, v11
    buffer_store_dwordx4 v[236:239], v55, s[4:7], s33 offen offset:2304
    s_mov_b64 exec, s[62:63]
    ds_write_b128 v55, v[236:239] offset:2304
    s_mov_b64 exec, -1
    s_mov_b32 s41, 0
    s_add_u32 m0, s40, 24576
    s_nop 0
    buffer_load_dwordx4 v136, s[8:11], s41 offen nt lds
    s_add_u32 m0, s40, 25600
    s_nop 0
    buffer_load_dwordx4 v137, s[8:11], s41 offen nt lds
    s_add_u32 m0, s40, 26624
    s_nop 0
    buffer_load_dwordx4 v138, s[8:11], s41 offen nt lds
    s_add_u32 m0, s40, 27648
    s_nop 0
    buffer_load_dwordx4 v139, s[8:11], s41 offen nt lds
    s_add_u32 m0, s40, 28672
    s_nop 0
    buffer_load_dwordx4 v140, s[8:11], s41 offen nt lds
    s_add_u32 m0, s40, 29696
    s_waitcnt vmcnt(20)
    buffer_load_dwordx4 v141, s[8:11], s41 offen nt lds
    s_waitcnt vmcnt(14)
    v_lshlrev_b32 v48, 16, v40
    v_and_b32 v49, s97, v40
    v_lshlrev_b32 v50, 16, v42
    v_and_b32 v51, s97, v42
    v_mul_f32_e64 v50, -v50, v48
    v_mul_f32_e64 v51, -v51, v49
    v_cvt_f32_i32 v112, v112
    v_cvt_f32_i32 v116, v116
    v_fma_f32 v112, v112, v48, v50
    v_fma_f32 v116, v116, v49, v51
    v_cvt_f32_i32 v113, v113
    v_cvt_f32_i32 v117, v117
    v_fma_f32 v113, v113, v48, v50
    v_fma_f32 v117, v117, v49, v51
    v_cvt_f32_i32 v114, v114
    v_cvt_f32_i32 v118, v118
    v_fma_f32 v114, v114, v48, v50
    v_fma_f32 v118, v118, v49, v51
    v_lshlrev_b32 v48, 16, v41
    v_and_b32 v49, s97, v41
    v_lshlrev_b32 v50, 16, v43
    v_and_b32 v51, s97, v43
    v_mul_f32_e64 v50, -v50, v48
    v_mul_f32_e64 v51, -v51, v49
    v_cvt_f32_i32 v120, v120
    v_cvt_f32_i32 v124, v124
    v_fma_f32 v120, v120, v48, v50
    v_fma_f32 v124, v124, v49, v51
    v_cvt_f32_i32 v121, v121
    v_cvt_f32_i32 v125, v125
    v_fma_f32 v121, v121, v48, v50
    v_fma_f32 v125, v125, v49, v51
    v_cvt_f32_i32 v122, v122
    v_cvt_f32_i32 v126, v126
    v_fma_f32 v122, v122, v48, v50
    v_fma_f32 v126, v126, v49, v51
    v_cvt_pk_bf16_f32 v112, v112, v116
    v_cvt_pk_bf16_f32 v116, v113, v117
    v_cvt_pk_bf16_f32 v113, v120, v124
    v_cvt_pk_bf16_f32 v117, v121, v125
    v_cvt_pk_bf16_f32 v120, v114, v118
    v_cvt_pk_bf16_f32 v121, v122, v126
    s_waitcnt vmcnt(10)
    v_lshlrev_b32 v48, 16, v44
    v_and_b32 v49, s97, v44
    v_lshlrev_b32 v50, 16, v46
    v_and_b32 v51, s97, v46
    v_mul_f32_e64 v50, -v50, v48
    v_mul_f32_e64 v51, -v51, v49
    v_cvt_f32_i32 v80, v80
    v_cvt_f32_i32 v84, v84
    v_fma_f32 v80, v80, v48, v50
    v_fma_f32 v84, v84, v49, v51
    v_cvt_f32_i32 v81, v81
    v_cvt_f32_i32 v85, v85
    v_fma_f32 v81, v81, v48, v50
    v_fma_f32 v85, v85, v49, v51
    v_cvt_f32_i32 v82, v82
    v_cvt_f32_i32 v86, v86
    v_fma_f32 v82, v82, v48, v50
    v_fma_f32 v86, v86, v49, v51
    v_lshlrev_b32 v48, 16, v45
    v_and_b32 v49, s97, v45
    v_lshlrev_b32 v50, 16, v47
    v_and_b32 v51, s97, v47
    v_mul_f32_e64 v50, -v50, v48
    v_mul_f32_e64 v51, -v51, v49
    v_cvt_f32_i32 v88, v88
    v_cvt_f32_i32 v92, v92
    v_fma_f32 v88, v88, v48, v50
    v_fma_f32 v92, v92, v49, v51
    v_cvt_f32_i32 v89, v89
    v_cvt_f32_i32 v93, v93
    v_fma_f32 v89, v89, v48, v50
    v_fma_f32 v93, v93, v49, v51
    v_cvt_f32_i32 v90, v90
    v_cvt_f32_i32 v94, v94
    v_fma_f32 v90, v90, v48, v50
    v_fma_f32 v94, v94, v49, v51
    v_cvt_pk_bf16_f32 v114, v80, v84
    v_cvt_pk_bf16_f32 v118, v81, v85
    v_cvt_pk_bf16_f32 v115, v88, v92
    v_cvt_pk_bf16_f32 v119, v89, v93
    v_cvt_pk_bf16_f32 v122, v82, v86
    v_cvt_pk_bf16_f32 v123, v90, v94
    buffer_store_dwordx4 v[112:115], v15, s[4:7], s35 offen offset:0
    buffer_store_dwordx4 v[116:119], v15, s[4:7], s35 offen offset:1024
    buffer_store_dwordx4 v[120:123], v15, s[4:7], s35 offen offset:2048
    ds_write_b128 v15, v[112:115] offset:12288
    ds_write_b128 v15, v[116:119] offset:13312
    ds_write_b128 v15, v[120:123] offset:14336
    buffer_load_dword v0, off, s[88:91], s93 sc1
    s_mov_b32 s41, 6144
    s_add_u32 m0, s40, 0
    s_nop 0
    buffer_load_dwordx4 v136, s[8:11], s41 offen nt lds
    s_add_u32 m0, s40, 1024
    s_nop 0
    buffer_load_dwordx4 v137, s[8:11], s41 offen nt lds
    s_add_u32 m0, s40, 2048
    s_nop 0
    buffer_load_dwordx4 v138, s[8:11], s41 offen nt lds
    s_add_u32 m0, s40, 3072
    s_nop 0
    buffer_load_dwordx4 v139, s[8:11], s41 offen nt lds
    s_add_u32 m0, s40, 4096
    s_nop 0
    buffer_load_dwordx4 v140, s[8:11], s41 offen nt lds
    s_add_u32 m0, s40, 5120
    s_waitcnt vmcnt(14)
    buffer_load_dwordx4 v141, s[8:11], s41 offen nt lds
    s_mov_b64 exec, 0
    s_cmp_eq_u32 s25, 0
    s_cbranch_scc1 L_iw0
    s_cmp_eq_u32 s25, 1
    s_cbranch_scc1 L_iw1
    s_cmp_eq_u32 s25, 2
    s_cbranch_scc1 L_iw2
    s_branch L_iw3
L_iwret:
    s_mov_b64 exec, -1
    s_waitcnt vmcnt(6)
    s_cmp_lg_u32 s25, 0
    s_cbranch_scc1 L_tagdone
    v_readfirstlane_b32 s42, v0
    s_mov_b32 s39, 100
    s_waitcnt lgkmcnt(0)
    s_and_b32 s46, s46, 0xfffffc00
L_tagretry:
    s_cmp_eq_u32 s42, s46
    s_cselect_b32 s42, 0, s42
    s_cmp_lg_u32 s42, 0
    s_cbranch_scc1 L_tagok
    s_sub_u32 s39, s39, 1
    s_cbranch_scc1 L_tagslow
    s_sleep 4
    s_buffer_load_dword s42, s[88:91], s93 glc
    s_waitcnt lgkmcnt(0)
    s_branch L_tagretry
L_tagok:
    s_add_u32 s42, s42, s45
    v_mov_b32 v0, s42
    v_mov_b32 v16, 147456
    ds_write_b32 v16, v0
L_tagdone:
    s_waitcnt lgkmcnt(0)
    s_barrier
    v_add_u32 v0, 1, v0
    buffer_store_dword v0, v13, s[20:23], 0 offen offset:32 sc1
    v_mov_b32 v16, 147456
    ds_read_b32 v17, v16
    s_mov_b32 s88, s60
    s_mov_b32 s89, s61
    s_mov_b32 s90, L_slow-standalone__kv_cache_quant_int4_int2_kv_with_per_channel_or_per_token_scales__prompt_kernel
    s_lshr_b32 s24, s2, 3
    s_mul_i32 s93, s24, 43
    s_lshr_b32 s93, s93, 7
    s_mul_i32 s39, s93, 3
    s_sub_u32 s24, s24, s39
    s_lshl_b32 s24, s24, 10
    s_mul_i32 s93, s93, 12288
    s_add_u32 s93, s93, s24
    ds_read_b128 v[144:147], v2 offset:0
    ds_read_b128 v[148:151], v3 offset:0
    ds_read_b128 v[152:155], v2 offset:6144
    ds_read_b128 v[156:159], v3 offset:6144
    ds_read_b128 v[160:163], v2 offset:128
    ds_read_b128 v[164:167], v3 offset:128
    ds_read_b128 v[168:171], v2 offset:6272
    ds_read_b128 v[172:175], v3 offset:6272
    ds_read_b128 v[176:179], v2 offset:256
    ds_read_b128 v[180:183], v3 offset:256
    ds_read_b128 v[184:187], v2 offset:6400
    ds_read_b128 v[188:191], v3 offset:6400
    s_waitcnt vmcnt(11)
    ds_read_b64 a[192:193], v22 offset:24576
    ds_read_b64 a[194:195], v142 offset:24704
    ds_read_b64 a[196:197], v23 offset:24576
    ds_read_b64 a[198:199], v143 offset:24704
    ds_read_b64 a[200:201], v142 offset:24576
    ds_read_b64 a[202:203], v22 offset:24832
    ds_read_b64 a[204:205], v143 offset:24576
    ds_read_b64 a[206:207], v23 offset:24832
    ds_read_b64 a[208:209], v22 offset:24704
    ds_read_b64 a[210:211], v142 offset:24832
    ds_read_b64 a[212:213], v23 offset:24704
    ds_read_b64 a[214:215], v143 offset:24832
    s_waitcnt lgkmcnt(15)
    v_readfirstlane_b32 s92, v17
    s_add_u32 s92, s92, 1
    s_mov_b32 s41, 12288
    s_add_u32 m0, s40, 49152
    s_nop 0
    buffer_load_dwordx4 v136, s[8:11], s41 offen nt lds
    s_add_u32 m0, s40, 50176
    s_nop 0
    buffer_load_dwordx4 v137, s[8:11], s41 offen nt lds
    s_add_u32 m0, s40, 51200
    s_nop 0
    buffer_load_dwordx4 v138, s[8:11], s41 offen nt lds
    s_waitcnt lgkmcnt(0)
    v_mfma_f32_16x16x32_bf16 v[64:67], v[144:147], a[192:195], 0
    v_mfma_f32_16x16x32_bf16 v[64:67], v[148:151], a[196:199], v[64:67]
    v_mfma_f32_16x16x32_bf16 v[64:67], v[160:163], a[200:203], v[64:67]
    v_mfma_f32_16x16x32_bf16 v[64:67], v[164:167], a[204:207], v[64:67]
    v_mfma_f32_16x16x32_bf16 v[64:67], v[176:179], a[208:211], v[64:67]
    v_mfma_f32_16x16x32_bf16 v[64:67], v[180:183], a[212:215], v[64:67]
    v_mfma_f32_16x16x32_bf16 v[96:99], v[152:155], a[192:195], 0
    v_mfma_f32_16x16x32_bf16 v[96:99], v[156:159], a[196:199], v[96:99]
    v_mfma_f32_16x16x32_bf16 v[96:99], v[168:171], a[200:203], v[96:99]
    v_mfma_f32_16x16x32_bf16 v[96:99], v[172:175], a[204:207], v[96:99]
    v_mfma_f32_16x16x32_bf16 v[96:99], v[184:187], a[208:211], v[96:99]
    v_mfma_f32_16x16x32_bf16 v[96:99], v[188:191], a[212:215], v[96:99]
    s_nop 7
    v_max3_f32 v48, v64, v65, v66
    v_max3_f32 v50, v67, v96, v97
    v_max3_f32 v48, v48, v98, v99
    v_max_f32 v48, v48, v50
    v_mov_b32 v49, v48
    s_nop 1
    v_permlane16_swap_b32 v48, v49
    s_nop 1
    v_max_f32 v48, v48, v49
    v_mov_b32 v49, v48
    s_nop 1
    v_permlane32_swap_b32 v48, v49
    s_nop 1
    v_max_f32 v48, v48, v49
    v_sub_f32 v64, v64, v48
    v_sub_f32 v65, v65, v48
    v_sub_f32 v66, v66, v48
    v_sub_f32 v67, v67, v48
    v_sub_f32 v96, v96, v48
    v_sub_f32 v97, v97, v48
    v_sub_f32 v98, v98, v48
    v_sub_f32 v99, v99, v48
    v_exp_f32 v64, v64
    v_exp_f32 v65, v65
    v_exp_f32 v66, v66
    v_exp_f32 v67, v67
    v_exp_f32 v96, v96
    v_exp_f32 v97, v97
    v_exp_f32 v98, v98
    v_exp_f32 v99, v99
    v_sub_f32 v128, 0, v48
    v_sub_f32 v129, 0, v48
    v_sub_f32 v130, 0, v48
    v_sub_f32 v131, 0, v48
    v_add_f32 v5, v5, v64
    v_add_f32 v5, v5, v65
    v_add_f32 v5, v5, v66
    v_add_f32 v5, v5, v67
    v_add_f32 v5, v5, v96
    v_add_f32 v5, v5, v97
    v_add_f32 v5, v5, v98
    v_add_f32 v5, v5, v99
    v_cvt_pk_bf16_f32 v64, v64, v65
    v_cvt_pk_bf16_f32 v65, v66, v67
    v_cvt_pk_bf16_f32 v66, v96, v97
    v_cvt_pk_bf16_f32 v67, v98, v99
L_iw0:
L_pg0:
    s_cbranch_execz L_pg4
    s_waitcnt vmcnt(4)
    ds_read_b64 a[216:217], v22 offset:0
    ds_read_b64 a[218:219], v142 offset:128
    ds_read_b64 a[220:221], v23 offset:0
    ds_read_b64 a[222:223], v143 offset:128
    ds_read_b64 a[224:225], v142 offset:0
    ds_read_b64 a[226:227], v22 offset:256
    ds_read_b64 a[228:229], v143 offset:0
    ds_read_b64 a[230:231], v23 offset:256
    ds_read_b64 a[232:233], v22 offset:128
    ds_read_b64 a[234:235], v142 offset:256
    ds_read_b64 a[236:237], v23 offset:128
    ds_read_b64 a[238:239], v143 offset:256
    s_mov_b32 s41, 12288
    s_add_u32 m0, s40, 52224
    s_nop 0
    buffer_load_dwordx4 v139, s[8:11], s41 offen nt lds
    s_add_u32 m0, s40, 53248
    s_nop 0
    buffer_load_dwordx4 v140, s[8:11], s41 offen nt lds
    s_add_u32 m0, s40, 54272
    s_nop 0
    buffer_load_dwordx4 v141, s[8:11], s41 offen nt lds
    s_waitcnt lgkmcnt(0)
    v_mfma_f32_16x16x32_bf16 v[68:71], v[144:147], a[216:219], 0
    v_mfma_f32_16x16x32_bf16 v[68:71], v[148:151], a[220:223], v[68:71]
    v_mfma_f32_16x16x32_bf16 v[68:71], v[160:163], a[224:227], v[68:71]
    v_mfma_f32_16x16x32_bf16 v[68:71], v[164:167], a[228:231], v[68:71]
    v_mfma_f32_16x16x32_bf16 v[68:71], v[176:179], a[232:235], v[68:71]
    v_mfma_f32_16x16x32_bf16 v[68:71], v[180:183], a[236:239], v[68:71]
    v_mfma_f32_16x16x32_bf16 v[100:103], v[152:155], a[216:219], 0
    v_mfma_f32_16x16x32_bf16 v[100:103], v[156:159], a[220:223], v[100:103]
    v_mfma_f32_16x16x32_bf16 v[100:103], v[168:171], a[224:227], v[100:103]
    v_mfma_f32_16x16x32_bf16 v[100:103], v[172:175], a[228:231], v[100:103]
    v_mfma_f32_16x16x32_bf16 v[100:103], v[184:187], a[232:235], v[100:103]
    v_mfma_f32_16x16x32_bf16 v[100:103], v[188:191], a[236:239], v[100:103]
    s_nop 7
    ds_read_b128 v[24:27], v1 offset:0
    ds_read_b128 v[28:31], v1 offset:1024
    ds_read_b128 v[32:35], v1 offset:2048
    ds_read_b128 v[36:39], v1 offset:3072
    s_mov_b32 s41, 18432
    s_add_u32 m0, s40, 24576
    s_nop 0
    buffer_load_dwordx4 v136, s[8:11], s41 offen nt lds
    v_max3_f32 v48, v68, v69, v70
    v_max3_f32 v50, v71, v100, v101
    v_max3_f32 v48, v48, v102, v103
    v_max_f32 v48, v48, v50
    v_mov_b32 v49, v48
    s_nop 1
    v_permlane16_swap_b32 v48, v49
    s_nop 1
    v_max_f32 v48, v48, v49
    v_mov_b32 v49, v48
    s_nop 1
    v_permlane32_swap_b32 v48, v49
    s_nop 1
    v_max_f32 v48, v48, v49
    v_sub_f32 v68, v68, v48
    v_sub_f32 v69, v69, v48
    s_add_u32 m0, s40, 25600
    s_nop 0
    buffer_load_dwordx4 v137, s[8:11], s41 offen nt lds
    v_sub_f32 v70, v70, v48
    v_sub_f32 v71, v71, v48
    v_sub_f32 v100, v100, v48
    v_sub_f32 v101, v101, v48
    v_sub_f32 v102, v102, v48
    v_sub_f32 v103, v103, v48
    v_exp_f32 v68, v68
    v_exp_f32 v69, v69
    v_exp_f32 v70, v70
    v_exp_f32 v71, v71
    v_exp_f32 v100, v100
    v_exp_f32 v101, v101
    v_exp_f32 v102, v102
    v_exp_f32 v103, v103
    v_sub_f32 v132, 0, v48
    s_add_u32 m0, s40, 26624
    s_nop 0
    buffer_load_dwordx4 v138, s[8:11], s41 offen nt lds
    v_sub_f32 v133, 0, v48
    v_sub_f32 v134, 0, v48
    v_sub_f32 v135, 0, v48
    v_add_f32 v6, v6, v68
    v_add_f32 v6, v6, v69
    v_add_f32 v6, v6, v70
    v_add_f32 v6, v6, v71
    v_add_f32 v6, v6, v100
    v_add_f32 v6, v6, v101
    v_add_f32 v6, v6, v102
    v_add_f32 v6, v6, v103
    v_cvt_pk_bf16_f32 v68, v68, v69
    v_cvt_pk_bf16_f32 v69, v70, v71
    v_cvt_pk_bf16_f32 v70, v100, v101
    v_cvt_pk_bf16_f32 v71, v102, v103
    s_buffer_load_dwordx8 s[48:55], s[20:23], s44 glc
    s_waitcnt lgkmcnt(2)
    v_mfma_f32_16x16x32_bf16 a[0:3], v[64:67], v[24:27], 0
    ds_read_b128 v[40:43], v1 offset:4096
    v_mfma_f32_16x16x32_bf16 a[4:7], v[64:67], v[28:31], 0
    v_mfma_f32_16x16x32_bf16 a[48:51], v[68:71], v[24:27], 0
    ds_read_b128 v[44:47], v1 offset:5120
    v_mfma_f32_16x16x32_bf16 a[52:55], v[68:71], v[28:31], 0
    s_waitcnt lgkmcnt(2)
    v_mfma_f32_16x16x32_bf16 a[8:11], v[64:67], v[32:35], 0
    ds_read_b128 v[24:27], v1 offset:6144
    v_mfma_f32_16x16x32_bf16 a[12:15], v[64:67], v[36:39], 0
    v_mfma_f32_16x16x32_bf16 a[56:59], v[68:71], v[32:35], 0
    ds_read_b128 v[28:31], v1 offset:7168
    v_mfma_f32_16x16x32_bf16 a[60:63], v[68:71], v[36:39], 0
    s_waitcnt lgkmcnt(2)
    v_mfma_f32_16x16x32_bf16 a[16:19], v[64:67], v[40:43], 0
    ds_read_b128 v[32:35], v1 offset:8192
    v_mfma_f32_16x16x32_bf16 a[20:23], v[64:67], v[44:47], 0
    v_mfma_f32_16x16x32_bf16 a[64:67], v[68:71], v[40:43], 0
    ds_read_b128 v[36:39], v1 offset:9216
    v_mfma_f32_16x16x32_bf16 a[68:71], v[68:71], v[44:47], 0
    s_waitcnt lgkmcnt(2)
    v_mfma_f32_16x16x32_bf16 a[24:27], v[64:67], v[24:27], 0
    ds_read_b128 v[40:43], v1 offset:10240
    v_mfma_f32_16x16x32_bf16 a[28:31], v[64:67], v[28:31], 0
    v_mfma_f32_16x16x32_bf16 a[72:75], v[68:71], v[24:27], 0
    ds_read_b128 v[44:47], v1 offset:11264
    v_mfma_f32_16x16x32_bf16 a[76:79], v[68:71], v[28:31], 0
    s_waitcnt lgkmcnt(2)
    v_mfma_f32_16x16x32_bf16 a[32:35], v[64:67], v[32:35], 0
    v_mfma_f32_16x16x32_bf16 a[36:39], v[64:67], v[36:39], 0
    v_mfma_f32_16x16x32_bf16 a[80:83], v[68:71], v[32:35], 0
    v_mfma_f32_16x16x32_bf16 a[84:87], v[68:71], v[36:39], 0
    s_waitcnt lgkmcnt(0)
    v_mfma_f32_16x16x32_bf16 a[40:43], v[64:67], v[40:43], 0
    v_mfma_f32_16x16x32_bf16 a[44:47], v[64:67], v[44:47], 0
    v_mfma_f32_16x16x32_bf16 a[88:91], v[68:71], v[40:43], 0
    v_mfma_f32_16x16x32_bf16 a[92:95], v[68:71], v[44:47], 0
    s_waitcnt lgkmcnt(0)
    s_sub_u32 s48, s48, s92
    s_sub_u32 s49, s49, s92
    s_sub_u32 s50, s50, s92
    s_sub_u32 s51, s51, s92
    s_sub_u32 s52, s52, s92
    s_sub_u32 s53, s53, s92
    s_sub_u32 s54, s54, s92
    s_sub_u32 s55, s55, s92
    s_max_u32 s48, s48, s49
    s_max_u32 s48, s48, s50
    s_max_u32 s48, s48, s51
    s_max_u32 s48, s48, s52
    s_max_u32 s48, s48, s53
    s_max_u32 s48, s48, s54
    s_max_u32 s48, s48, s55
    s_cmp_ge_u32 s48, 16
    s_cbranch_scc1 L_pollslow0
L_pollok0:
    s_add_u32 s92, s92, 1
    s_mov_b32 m0, s26
    s_nop 0
    buffer_load_dwordx4 v4, s[4:7], s32 offen offset:0 sc1 lds
    buffer_load_dwordx4 v4, s[4:7], s32 offen offset:1024 sc1 lds
    buffer_load_dwordx4 v4, s[4:7], s32 offen offset:2048 sc1 lds
    s_add_u32 s32, s32, 24576
    s_sub_u32 s57, s32, 196608
    s_min_u32 s32, s32, s57
    s_add_u32 s26, s26, 36864
    s_sub_u32 s57, s26, 147456
    s_min_u32 s26, s26, s57
    s_mov_b32 m0, s26
    s_waitcnt vmcnt(11)
    buffer_load_dwordx4 v4, s[4:7], s32 offen offset:0 sc1 lds
    s_waitcnt vmcnt(11)
    buffer_load_dwordx4 v4, s[4:7], s32 offen offset:1024 sc1 lds
    s_waitcnt vmcnt(11)
    buffer_load_dwordx4 v4, s[4:7], s32 offen offset:2048 sc1 lds
    s_add_u32 s32, s32, 24576
    s_sub_u32 s57, s32, 196608
    s_min_u32 s32, s32, s57
    s_add_u32 s26, s26, 12288
    s_mov_b32 m0, s26
    s_waitcnt vmcnt(11)
    buffer_load_dwordx4 v4, s[4:7], s32 offen offset:0 sc1 lds
    s_waitcnt vmcnt(11)
    buffer_load_dwordx4 v4, s[4:7], s32 offen offset:1024 sc1 lds
    s_waitcnt vmcnt(11)
    buffer_load_dwordx4 v4, s[4:7], s32 offen offset:2048 sc1 lds
    s_add_u32 s32, s32, 24576
    s_sub_u32 s57, s32, 196608
    s_min_u32 s32, s32, s57
    s_add_u32 s26, s26, 36864
    s_sub_u32 s57, s26, 147456
    s_min_u32 s26, s26, s57
    s_mov_b32 m0, s56
    s_waitcnt vmcnt(11)
    buffer_load_dwordx4 v4, s[4:7], s27 offen offset:0 sc1 lds
    s_waitcnt vmcnt(11)
    buffer_load_dwordx4 v4, s[4:7], s27 offen offset:1024 sc1 lds
    s_waitcnt vmcnt(11)
    buffer_load_dwordx4 v4, s[4:7], s27 offen offset:2048 sc1 lds
    s_add_u32 s27, s27, 24576
    s_sub_u32 s58, s27, 196608
    s_min_u32 s27, s27, s58
    s_add_u32 s56, s56, 36864
    s_sub_u32 s58, s56, 147456
    s_min_u32 s56, s56, s58
    s_add_u32 s33, s33, 196608
    s_add_u32 s34, s34, 196608
    s_add_u32 s36, s36, 1536
    s_add_u32 s35, s35, 196608
    s_add_u32 s16, s16, 196608
    s_add_u32 s17, s17, 196608
    s_add_u32 s37, s37, 512
    s_waitcnt vmcnt(9)
    s_barrier
    ds_read_b128 v[24:27], v2 offset:12288
    ds_read_b128 v[28:31], v3 offset:12288
    ds_read_b128 v[32:35], v2 offset:18432
    ds_read_b128 v[36:39], v3 offset:18432
    s_waitcnt lgkmcnt(2)
    v_mfma_f32_16x16x32_bf16 v[72:75], v[24:27], a[192:195], v[128:131]
    s_mov_b32 m0, s56
    ds_read_b128 v[40:43], v2 offset:12416
    v_mfma_f32_16x16x32_bf16 v[72:75], v[28:31], a[196:199], v[72:75]
    buffer_load_dwordx4 v4, s[4:7], s27 offen offset:0 sc1 lds
    v_mfma_f32_16x16x32_bf16 v[76:79], v[24:27], a[216:219], v[132:135]
    ds_read_b128 v[44:47], v3 offset:12416
    v_mfma_f32_16x16x32_bf16 v[76:79], v[28:31], a[220:223], v[76:79]
    s_waitcnt lgkmcnt(2)
    buffer_load_dwordx4 v4, s[4:7], s27 offen offset:1024 sc1 lds
    v_mfma_f32_16x16x32_bf16 v[104:107], v[32:35], a[192:195], v[128:131]
    ds_read_b128 v[24:27], v2 offset:18560
    v_mfma_f32_16x16x32_bf16 v[104:107], v[36:39], a[196:199], v[104:107]
    buffer_load_dwordx4 v4, s[4:7], s27 offen offset:2048 sc1 lds
    v_mfma_f32_16x16x32_bf16 v[108:111], v[32:35], a[216:219], v[132:135]
    s_add_u32 s27, s27, 24576
    ds_read_b128 v[28:31], v3 offset:18560
    v_mfma_f32_16x16x32_bf16 v[108:111], v[36:39], a[220:223], v[108:111]
    s_waitcnt lgkmcnt(2)
    s_sub_u32 s58, s27, 196608
    v_mfma_f32_16x16x32_bf16 v[72:75], v[40:43], a[200:203], v[72:75]
    ds_read_b128 v[32:35], v2 offset:12544
    v_mfma_f32_16x16x32_bf16 v[72:75], v[44:47], a[204:207], v[72:75]
    s_min_u32 s27, s27, s58
    v_mfma_f32_16x16x32_bf16 v[76:79], v[40:43], a[224:227], v[76:79]
    s_add_u32 s56, s56, 12288
    ds_read_b128 v[36:39], v3 offset:12544
    v_mfma_f32_16x16x32_bf16 v[76:79], v[44:47], a[228:231], v[76:79]
    s_waitcnt lgkmcnt(2)
    s_mov_b32 m0, s56
    v_mfma_f32_16x16x32_bf16 v[104:107], v[24:27], a[200:203], v[104:107]
    ds_read_b128 v[40:43], v2 offset:18688
    v_mfma_f32_16x16x32_bf16 v[104:107], v[28:31], a[204:207], v[104:107]
    s_waitcnt vmcnt(6)
    buffer_load_dwordx4 v4, s[4:7], s27 offen offset:0 sc1 lds
    v_mfma_f32_16x16x32_bf16 v[108:111], v[24:27], a[224:227], v[108:111]
    ds_read_b128 v[44:47], v3 offset:18688
    v_mfma_f32_16x16x32_bf16 v[108:111], v[28:31], a[228:231], v[108:111]
    s_waitcnt lgkmcnt(2)
    s_barrier
    v_add_u32 v2, 49152, v2
    v_add_u32 v3, 49152, v3
    v_mfma_f32_16x16x32_bf16 v[72:75], v[32:35], a[208:211], v[72:75]
    ds_read_b128 v[24:27], v2 offset:0
    v_mfma_f32_16x16x32_bf16 v[72:75], v[36:39], a[212:215], v[72:75]
    buffer_load_dwordx4 v4, s[4:7], s27 offen offset:1024 sc1 lds
    v_mfma_f32_16x16x32_bf16 v[76:79], v[32:35], a[232:235], v[76:79]
    ds_read_b128 v[28:31], v3 offset:0
    v_mfma_f32_16x16x32_bf16 v[76:79], v[36:39], a[236:239], v[76:79]
    s_waitcnt lgkmcnt(2)
    buffer_load_dwordx4 v4, s[4:7], s27 offen offset:2048 sc1 lds
    v_mfma_f32_16x16x32_bf16 v[104:107], v[40:43], a[208:211], v[104:107]
    ds_read_b128 v[32:35], v2 offset:6144
    v_mfma_f32_16x16x32_bf16 v[104:107], v[44:47], a[212:215], v[104:107]
    v_mfma_f32_16x16x32_bf16 v[108:111], v[40:43], a[232:235], v[108:111]
    s_add_u32 s27, s27, 24576
    ds_read_b128 v[36:39], v3 offset:6144
    s_sub_u32 s58, s27, 196608
    v_mfma_f32_16x16x32_bf16 v[108:111], v[44:47], a[236:239], v[108:111]
    s_waitcnt lgkmcnt(2)
    s_min_u32 s27, s27, s58
    s_add_u32 s56, s56, 36864
    s_sub_u32 s58, s56, 147456
    s_min_u32 s56, s56, s58
    v_mfma_f32_16x16x32_bf16 v[80:83], v[24:27], a[192:195], v[128:131]
    s_mov_b32 s41, 18432
    ds_read_b128 v[40:43], v2 offset:128
    s_add_u32 m0, s40, 27648
    v_mfma_f32_16x16x32_bf16 v[80:83], v[28:31], a[196:199], v[80:83]
    buffer_load_dwordx4 v139, s[8:11], s41 offen nt lds
    v_mfma_f32_16x16x32_bf16 v[84:87], v[24:27], a[216:219], v[132:135]
    s_add_u32 m0, s40, 28672
    ds_read_b128 v[44:47], v3 offset:128
    v_mfma_f32_16x16x32_bf16 v[84:87], v[28:31], a[220:223], v[84:87]
    s_waitcnt lgkmcnt(2)
    buffer_load_dwordx4 v140, s[8:11], s41 offen nt lds
    s_add_u32 m0, s40, 29696
    v_mfma_f32_16x16x32_bf16 v[112:115], v[32:35], a[192:195], v[128:131]
    ds_read_b128 v[24:27], v2 offset:6272
    v_mfma_f32_16x16x32_bf16 v[112:115], v[36:39], a[196:199], v[112:115]
    buffer_load_dwordx4 v141, s[8:11], s41 offen nt lds
    v_mfma_f32_16x16x32_bf16 v[116:119], v[32:35], a[216:219], v[132:135]
    ds_read_b128 v[28:31], v3 offset:6272
    v_mfma_f32_16x16x32_bf16 v[116:119], v[36:39], a[220:223], v[116:119]
    s_waitcnt lgkmcnt(2)
    v_exp_f32 v16, v72
    v_mfma_f32_16x16x32_bf16 v[80:83], v[40:43], a[200:203], v[80:83]
    ds_read_b128 v[32:35], v2 offset:256
    v_mfma_f32_16x16x32_bf16 v[80:83], v[44:47], a[204:207], v[80:83]
    v_exp_f32 v17, v73
    v_exp_f32 v18, v74
    v_mfma_f32_16x16x32_bf16 v[84:87], v[40:43], a[224:227], v[84:87]
    ds_read_b128 v[36:39], v3 offset:256
    v_add_f32 v5, v5, v16
    v_mfma_f32_16x16x32_bf16 v[84:87], v[44:47], a[228:231], v[84:87]
    s_waitcnt lgkmcnt(2)
    v_add_f32 v5, v5, v17
    v_exp_f32 v19, v75
    v_mfma_f32_16x16x32_bf16 v[112:115], v[24:27], a[200:203], v[112:115]
    ds_read_b128 v[40:43], v2 offset:6400
    v_cvt_pk_bf16_f32 v72, v16, v17
    v_mfma_f32_16x16x32_bf16 v[112:115], v[28:31], a[204:207], v[112:115]
    v_exp_f32 v16, v104
    v_mfma_f32_16x16x32_bf16 v[116:119], v[24:27], a[224:227], v[116:119]
    ds_read_b128 v[44:47], v3 offset:6400
    v_add_f32 v5, v5, v18
    v_mfma_f32_16x16x32_bf16 v[116:119], v[28:31], a[228:231], v[116:119]
    s_waitcnt lgkmcnt(2)
    v_add_f32 v5, v5, v19
    v_exp_f32 v17, v105
    v_mfma_f32_16x16x32_bf16 v[80:83], v[32:35], a[208:211], v[80:83]
    ds_read_b128 v[24:27], v2 offset:12288
    v_cvt_pk_bf16_f32 v73, v18, v19
    v_mfma_f32_16x16x32_bf16 v[80:83], v[36:39], a[212:215], v[80:83]
    v_exp_f32 v18, v106
    v_mfma_f32_16x16x32_bf16 v[84:87], v[32:35], a[232:235], v[84:87]
    ds_read_b128 v[28:31], v3 offset:12288
    v_add_f32 v5, v5, v16
    v_mfma_f32_16x16x32_bf16 v[84:87], v[36:39], a[236:239], v[84:87]
    s_waitcnt lgkmcnt(2)
    v_add_f32 v5, v5, v17
    v_exp_f32 v19, v107
    v_mfma_f32_16x16x32_bf16 v[112:115], v[40:43], a[208:211], v[112:115]
    ds_read_b128 v[32:35], v2 offset:18432
    v_cvt_pk_bf16_f32 v74, v16, v17
    v_mfma_f32_16x16x32_bf16 v[112:115], v[44:47], a[212:215], v[112:115]
    v_exp_f32 v16, v76
    v_add_f32 v5, v5, v18
    v_mfma_f32_16x16x32_bf16 v[116:119], v[40:43], a[232:235], v[116:119]
    ds_read_b128 v[36:39], v3 offset:18432
    v_add_f32 v5, v5, v19
    v_mfma_f32_16x16x32_bf16 v[116:119], v[44:47], a[236:239], v[116:119]
    s_waitcnt lgkmcnt(2)
    v_exp_f32 v17, v77
    v_mfma_f32_16x16x32_bf16 v[88:91], v[24:27], a[192:195], v[128:131]
    ds_read_b128 v[40:43], v2 offset:12416
    v_cvt_pk_bf16_f32 v75, v18, v19
    v_mfma_f32_16x16x32_bf16 v[88:91], v[28:31], a[196:199], v[88:91]
    s_waitcnt vmcnt(11)
    buffer_load_dwordx2 v[56:57], v10, s[72:75], s36 offen offset:0
    v_mfma_f32_16x16x32_bf16 v[92:95], v[24:27], a[216:219], v[132:135]
    ds_read_b128 v[44:47], v3 offset:12416
    v_mfma_f32_16x16x32_bf16 v[92:95], v[28:31], a[220:223], v[92:95]
    s_waitcnt lgkmcnt(2)
    buffer_load_dwordx2 v[58:59], v10, s[76:79], s36 offen offset:0
    v_exp_f32 v18, v78
    v_mfma_f32_16x16x32_bf16 v[120:123], v[32:35], a[192:195], v[128:131]
    ds_read_b128 v[24:27], v2 offset:18560
    v_add_f32 v6, v6, v16
    v_mfma_f32_16x16x32_bf16 v[120:123], v[36:39], a[196:199], v[120:123]
    s_waitcnt vmcnt(12)
    buffer_load_dwordx4 v[224:227], v9, s[64:67], s33 offen offset:0 nt
    v_mfma_f32_16x16x32_bf16 v[124:127], v[32:35], a[216:219], v[132:135]
    ds_read_b128 v[28:31], v3 offset:18560
    v_add_f32 v6, v6, v17
    v_mfma_f32_16x16x32_bf16 v[124:127], v[36:39], a[220:223], v[124:127]
    s_waitcnt lgkmcnt(2)
    s_waitcnt vmcnt(12)
    buffer_load_dwordx4 v[228:231], v9, s[64:67], s33 offen offset:1536 nt
    v_mfma_f32_16x16x32_bf16 v[88:91], v[40:43], a[200:203], v[88:91]
    ds_read_b128 v[32:35], v2 offset:12544
    v_mfma_f32_16x16x32_bf16 v[88:91], v[44:47], a[204:207], v[88:91]
    buffer_load_dwordx4 v[232:235], v9, s[64:67], s34 offen offset:0 nt
    v_mfma_f32_16x16x32_bf16 v[92:95], v[40:43], a[224:227], v[92:95]
    ds_read_b128 v[36:39], v3 offset:12544
    v_mfma_f32_16x16x32_bf16 v[92:95], v[44:47], a[228:231], v[92:95]
    s_waitcnt lgkmcnt(2)
    s_waitcnt vmcnt(13)
    buffer_load_dwordx4 v[236:239], v9, s[64:67], s34 offen offset:1536 nt
    v_exp_f32 v19, v79
    v_mfma_f32_16x16x32_bf16 v[120:123], v[24:27], a[200:203], v[120:123]
    ds_read_b128 v[40:43], v2 offset:18688
    v_cvt_pk_bf16_f32 v76, v16, v17
    v_mfma_f32_16x16x32_bf16 v[120:123], v[28:31], a[204:207], v[120:123]
    s_waitcnt vmcnt(9)
    v_exp_f32 v16, v108
    v_add_f32 v6, v6, v18
    v_mfma_f32_16x16x32_bf16 v[124:127], v[24:27], a[224:227], v[124:127]
    ds_read_b128 v[44:47], v3 offset:18688
    v_add_f32 v6, v6, v19
    v_mfma_f32_16x16x32_bf16 v[124:127], v[28:31], a[228:231], v[124:127]
    s_waitcnt lgkmcnt(2)
    s_barrier
    v_mfma_f32_16x16x32_bf16 v[88:91], v[32:35], a[208:211], v[88:91]
    ds_read_b128 v[24:27], v1 offset:12288
    v_mfma_f32_16x16x32_bf16 v[88:91], v[36:39], a[212:215], v[88:91]
    v_exp_f32 v17, v109
    v_cvt_pk_bf16_f32 v77, v18, v19
    v_mfma_f32_16x16x32_bf16 v[92:95], v[32:35], a[232:235], v[92:95]
    ds_read_b128 v[28:31], v1 offset:13312
    v_mfma_f32_16x16x32_bf16 v[92:95], v[36:39], a[236:239], v[92:95]
    s_waitcnt lgkmcnt(2)
    v_exp_f32 v18, v110
    v_add_f32 v6, v6, v16
    v_mfma_f32_16x16x32_bf16 v[120:123], v[40:43], a[208:211], v[120:123]
    ds_read_b128 v[32:35], v1 offset:14336
    v_add_f32 v6, v6, v17
    v_mfma_f32_16x16x32_bf16 v[120:123], v[44:47], a[212:215], v[120:123]
    v_exp_f32 v19, v111
    v_mfma_f32_16x16x32_bf16 v[124:127], v[40:43], a[232:235], v[124:127]
    ds_read_b128 v[36:39], v1 offset:15360
    v_cvt_pk_bf16_f32 v78, v16, v17
    v_mfma_f32_16x16x32_bf16 v[124:127], v[44:47], a[236:239], v[124:127]
    s_waitcnt lgkmcnt(2)
    v_add_f32 v6, v6, v18
    v_add_f32 v6, v6, v19
    v_cvt_pk_bf16_f32 v79, v18, v19
    v_mfma_f32_16x16x32_bf16 a[0:3], v[72:75], v[24:27], a[0:3]
    ds_read_b128 v[40:43], v1 offset:16384
    v_mfma_f32_16x16x32_bf16 a[4:7], v[72:75], v[28:31], a[4:7]
    buffer_load_dwordx2 v[60:61], v10, s[72:75], s36 offen offset:192
    v_exp_f32 v16, v80
    v_mfma_f32_16x16x32_bf16 a[48:51], v[76:79], v[24:27], a[48:51]
    ds_read_b128 v[44:47], v1 offset:17408
    v_mfma_f32_16x16x32_bf16 a[52:55], v[76:79], v[28:31], a[52:55]
    s_waitcnt lgkmcnt(2)
    buffer_load_dwordx2 v[62:63], v10, s[76:79], s36 offen offset:192
    v_exp_f32 v17, v81
    v_exp_f32 v18, v82
    v_mfma_f32_16x16x32_bf16 a[8:11], v[72:75], v[32:35], a[8:11]
    ds_read_b128 v[24:27], v1 offset:18432
    v_add_f32 v5, v5, v16
    v_mfma_f32_16x16x32_bf16 a[12:15], v[72:75], v[36:39], a[12:15]
    buffer_load_dwordx4 v[240:243], v9, s[64:67], s33 offen offset:384 nt
    v_add_f32 v5, v5, v17
    v_exp_f32 v19, v83
    v_mfma_f32_16x16x32_bf16 a[56:59], v[76:79], v[32:35], a[56:59]
    ds_read_b128 v[28:31], v1 offset:19456
    v_cvt_pk_bf16_f32 v80, v16, v17
    v_mfma_f32_16x16x32_bf16 a[60:63], v[76:79], v[36:39], a[60:63]
    s_waitcnt lgkmcnt(2)
    buffer_load_dwordx4 v[244:247], v9, s[64:67], s33 offen offset:1920 nt
    v_exp_f32 v16, v112
    v_add_f32 v5, v5, v18
    v_add_f32 v5, v5, v19
    v_mfma_f32_16x16x32_bf16 a[16:19], v[72:75], v[40:43], a[16:19]
    ds_read_b128 v[32:35], v1 offset:20480
    v_mfma_f32_16x16x32_bf16 a[20:23], v[72:75], v[44:47], a[20:23]
    buffer_load_dwordx4 v[248:251], v9, s[64:67], s34 offen offset:384 nt
    v_exp_f32 v17, v113
    v_cvt_pk_bf16_f32 v81, v18, v19
    v_mfma_f32_16x16x32_bf16 a[64:67], v[76:79], v[40:43], a[64:67]
    ds_read_b128 v[36:39], v1 offset:21504
    v_mfma_f32_16x16x32_bf16 a[68:71], v[76:79], v[44:47], a[68:71]
    s_waitcnt lgkmcnt(2)
    buffer_load_dwordx4 v[252:255], v9, s[64:67], s34 offen offset:1920 nt
    v_exp_f32 v18, v114
    v_add_f32 v5, v5, v16
    v_mfma_f32_16x16x32_bf16 a[24:27], v[72:75], v[24:27], a[24:27]
    ds_read_b128 v[40:43], v1 offset:22528
    v_add_f32 v5, v5, v17
    v_mfma_f32_16x16x32_bf16 a[28:31], v[72:75], v[28:31], a[28:31]
    v_exp_f32 v19, v115
    v_cvt_pk_bf16_f32 v82, v16, v17
    v_exp_f32 v16, v84
    v_mfma_f32_16x16x32_bf16 a[72:75], v[76:79], v[24:27], a[72:75]
    ds_read_b128 v[44:47], v1 offset:23552
    v_add_f32 v5, v5, v18
    v_mfma_f32_16x16x32_bf16 a[76:79], v[76:79], v[28:31], a[76:79]
    s_waitcnt lgkmcnt(2)
    v_add_u32 v1, 49152, v1
    v_add_f32 v5, v5, v19
    v_exp_f32 v17, v85
    v_cvt_pk_bf16_f32 v83, v18, v19
    v_mfma_f32_16x16x32_bf16 a[32:35], v[72:75], v[32:35], a[32:35]
    ds_read_b128 v[24:27], v1 offset:0
    v_mfma_f32_16x16x32_bf16 a[36:39], v[72:75], v[36:39], a[36:39]
    v_exp_f32 v18, v86
    v_add_f32 v6, v6, v16
    v_add_f32 v6, v6, v17
    v_exp_f32 v19, v87
    v_mfma_f32_16x16x32_bf16 a[80:83], v[76:79], v[32:35], a[80:83]
    ds_read_b128 v[28:31], v1 offset:1024
    v_cvt_pk_bf16_f32 v84, v16, v17
    v_mfma_f32_16x16x32_bf16 a[84:87], v[76:79], v[36:39], a[84:87]
    s_waitcnt lgkmcnt(2)
    v_exp_f32 v16, v116
    v_add_f32 v6, v6, v18
    v_add_f32 v6, v6, v19
    v_mfma_f32_16x16x32_bf16 a[40:43], v[72:75], v[40:43], a[40:43]
    ds_read_b128 v[32:35], v1 offset:2048
    v_mfma_f32_16x16x32_bf16 a[44:47], v[72:75], v[44:47], a[44:47]
    v_exp_f32 v17, v117
    v_cvt_pk_bf16_f32 v85, v18, v19
    v_exp_f32 v18, v118
    v_add_f32 v6, v6, v16
    v_mfma_f32_16x16x32_bf16 a[88:91], v[76:79], v[40:43], a[88:91]
    ds_read_b128 v[36:39], v1 offset:3072
    v_add_f32 v6, v6, v17
    v_mfma_f32_16x16x32_bf16 a[92:95], v[76:79], v[44:47], a[92:95]
    s_waitcnt lgkmcnt(2)
    v_exp_f32 v19, v119
    v_cvt_pk_bf16_f32 v86, v16, v17
    v_add_f32 v6, v6, v18
    v_add_f32 v6, v6, v19
    v_cvt_pk_bf16_f32 v87, v18, v19
    v_mfma_f32_16x16x32_bf16 a[0:3], v[80:83], v[24:27], a[0:3]
    ds_read_b128 v[40:43], v1 offset:4096
    v_mfma_f32_16x16x32_bf16 a[4:7], v[80:83], v[28:31], a[4:7]
    buffer_load_dwordx3 v[144:146], v12, s[68:71], s35 offen offset:0 nt
    v_exp_f32 v16, v88
    v_mfma_f32_16x16x32_bf16 a[48:51], v[84:87], v[24:27], a[48:51]
    ds_read_b128 v[44:47], v1 offset:5120
    v_mfma_f32_16x16x32_bf16 a[52:55], v[84:87], v[28:31], a[52:55]
    s_waitcnt lgkmcnt(2)
    buffer_load_dwordx3 v[148:150], v12, s[68:71], s35 offen offset:768 nt
    v_exp_f32 v17, v89
    v_mfma_f32_16x16x32_bf16 a[8:11], v[80:83], v[32:35], a[8:11]
    ds_read_b128 v[24:27], v1 offset:6144
    v_mfma_f32_16x16x32_bf16 a[12:15], v[80:83], v[36:39], a[12:15]
    s_waitcnt vmcnt(16)
    buffer_load_dwordx3 v[152:154], v12, s[68:71], s35 offen offset:1536 nt
    v_exp_f32 v18, v90
    v_mfma_f32_16x16x32_bf16 a[56:59], v[84:87], v[32:35], a[56:59]
    ds_read_b128 v[28:31], v1 offset:7168
    v_add_f32 v5, v5, v16
    v_mfma_f32_16x16x32_bf16 a[60:63], v[84:87], v[36:39], a[60:63]
    s_waitcnt lgkmcnt(2)
    s_waitcnt vmcnt(16)
    buffer_load_dwordx3 v[156:158], v12, s[68:71], s35 offen offset:2304 nt
    v_add_f32 v5, v5, v17
    v_mfma_f32_16x16x32_bf16 a[16:19], v[80:83], v[40:43], a[16:19]
    ds_read_b128 v[32:35], v1 offset:8192
    v_mfma_f32_16x16x32_bf16 a[20:23], v[80:83], v[44:47], a[20:23]
    v_exp_f32 v19, v91
    v_cvt_pk_bf16_f32 v88, v16, v17
    v_exp_f32 v16, v120
    v_mfma_f32_16x16x32_bf16 a[64:67], v[84:87], v[40:43], a[64:67]
    ds_read_b128 v[36:39], v1 offset:9216
    v_add_f32 v5, v5, v18
    v_mfma_f32_16x16x32_bf16 a[68:71], v[84:87], v[44:47], a[68:71]
    s_waitcnt lgkmcnt(2)
    v_add_f32 v5, v5, v19
    v_exp_f32 v17, v121
    v_cvt_pk_bf16_f32 v89, v18, v19
    v_mfma_f32_16x16x32_bf16 a[24:27], v[80:83], v[24:27], a[24:27]
    ds_read_b128 v[40:43], v1 offset:10240
    v_mfma_f32_16x16x32_bf16 a[28:31], v[80:83], v[28:31], a[28:31]
    v_exp_f32 v18, v122
    v_add_f32 v5, v5, v16
    v_add_f32 v5, v5, v17
    v_mfma_f32_16x16x32_bf16 a[72:75], v[84:87], v[24:27], a[72:75]
    ds_read_b128 v[44:47], v1 offset:11264
    v_mfma_f32_16x16x32_bf16 a[76:79], v[84:87], v[28:31], a[76:79]
    s_waitcnt lgkmcnt(2)
    v_exp_f32 v19, v123
    v_cvt_pk_bf16_f32 v90, v16, v17
    v_mfma_f32_16x16x32_bf16 a[32:35], v[80:83], v[32:35], a[32:35]
    s_waitcnt vmcnt(40)
    ds_read_b128 v[24:27], v1 offset:12288
    ds_read_b64 a[240:241], v22 offset:49152
    v_mfma_f32_16x16x32_bf16 a[36:39], v[80:83], v[36:39], a[36:39]
    ds_read_b64 a[242:243], v142 offset:49280
    ds_read_b64 a[244:245], v23 offset:49152
    ds_read_b64 a[246:247], v143 offset:49280
    ds_read_b64 a[248:249], v142 offset:49152
    ds_read_b64 a[250:251], v22 offset:49408
    v_mfma_f32_16x16x32_bf16 a[80:83], v[84:87], v[32:35], a[80:83]
    ds_read_b128 v[28:31], v1 offset:13312
    ds_read_b64 a[252:253], v143 offset:49152
    v_mfma_f32_16x16x32_bf16 a[84:87], v[84:87], v[36:39], a[84:87]
    s_waitcnt lgkmcnt(9)
    ds_read_b64 a[254:255], v23 offset:49408
    ds_read_b64 v[192:193], v22 offset:49280
    ds_read_b64 v[194:195], v142 offset:49408
    ds_read_b64 v[196:197], v23 offset:49280
    v_mfma_f32_16x16x32_bf16 a[40:43], v[80:83], v[40:43], a[40:43]
    ds_read_b128 v[32:35], v1 offset:14336
    ds_read_b64 v[198:199], v143 offset:49408
    v_mfma_f32_16x16x32_bf16 a[44:47], v[80:83], v[44:47], a[44:47]
    v_exp_f32 v16, v92
    v_add_f32 v5, v5, v18
    v_add_f32 v5, v5, v19
    v_exp_f32 v17, v93
    v_cvt_pk_bf16_f32 v91, v18, v19
    v_exp_f32 v18, v94
    v_add_f32 v6, v6, v16
    v_add_f32 v6, v6, v17
    v_exp_f32 v19, v95
    v_cvt_pk_bf16_f32 v92, v16, v17
    v_exp_f32 v16, v124
    v_add_f32 v6, v6, v18
    v_add_f32 v6, v6, v19
    v_exp_f32 v17, v125
    v_cvt_pk_bf16_f32 v93, v18, v19
    v_exp_f32 v18, v126
    v_add_f32 v6, v6, v16
    v_add_f32 v6, v6, v17
    v_exp_f32 v19, v127
    v_cvt_pk_bf16_f32 v94, v16, v17
    v_add_f32 v6, v6, v18
    v_add_f32 v6, v6, v19
    v_cvt_pk_bf16_f32 v95, v18, v19
    v_mfma_f32_16x16x32_bf16 a[88:91], v[84:87], v[40:43], a[88:91]
    s_waitcnt vmcnt(16)
    ds_read_b128 v[36:39], v1 offset:15360
    ds_read_b64 v[200:201], v22 offset:24576
    v_mfma_f32_16x16x32_bf16 a[92:95], v[84:87], v[44:47], a[92:95]
    s_waitcnt lgkmcnt(9)
    ds_read_b64 v[202:203], v142 offset:24704
    ds_read_b64 v[204:205], v23 offset:24576
    v_mfma_f32_16x16x32_bf16 a[0:3], v[88:91], v[24:27], a[0:3]
    ds_read_b128 v[40:43], v1 offset:16384
    ds_read_b64 v[206:207], v143 offset:24704
    v_mfma_f32_16x16x32_bf16 a[4:7], v[88:91], v[28:31], a[4:7]
    ds_read_b64 v[208:209], v142 offset:24576
    ds_read_b64 v[210:211], v22 offset:24832
    v_mfma_f32_16x16x32_bf16 a[48:51], v[92:95], v[24:27], a[48:51]
    ds_read_b128 v[44:47], v1 offset:17408
    ds_read_b64 v[212:213], v143 offset:24576
    v_mfma_f32_16x16x32_bf16 a[52:55], v[92:95], v[28:31], a[52:55]
    s_waitcnt lgkmcnt(9)
    ds_read_b64 v[214:215], v23 offset:24832
    ds_read_b64 v[216:217], v22 offset:24704
    v_mfma_f32_16x16x32_bf16 a[8:11], v[88:91], v[32:35], a[8:11]
L_iw1:
L_pg1:
    s_cbranch_execz L_pg5
    ds_read_b128 v[24:27], v1 offset:18432
    ds_read_b64 v[218:219], v142 offset:24832
    v_mfma_f32_16x16x32_bf16 a[12:15], v[88:91], v[36:39], a[12:15]
    ds_read_b64 v[220:221], v23 offset:24704
    ds_read_b64 v[222:223], v143 offset:24832
    v_mfma_f32_16x16x32_bf16 a[56:59], v[92:95], v[32:35], a[56:59]
    ds_read_b128 v[28:31], v1 offset:19456
    v_mfma_f32_16x16x32_bf16 a[60:63], v[92:95], v[36:39], a[60:63]
    s_waitcnt lgkmcnt(8)
    v_mfma_f32_16x16x32_bf16 a[16:19], v[88:91], v[40:43], a[16:19]
    ds_read_b128 v[32:35], v1 offset:20480
    v_mfma_f32_16x16x32_bf16 a[20:23], v[88:91], v[44:47], a[20:23]
    v_mfma_f32_16x16x32_bf16 a[64:67], v[92:95], v[40:43], a[64:67]
    ds_read_b128 v[36:39], v1 offset:21504
    v_mfma_f32_16x16x32_bf16 a[68:71], v[92:95], v[44:47], a[68:71]
    s_waitcnt lgkmcnt(2)
    v_mfma_f32_16x16x32_bf16 a[24:27], v[88:91], v[24:27], a[24:27]
    ds_read_b128 v[40:43], v1 offset:22528
    v_mfma_f32_16x16x32_bf16 a[28:31], v[88:91], v[28:31], a[28:31]
    v_mfma_f32_16x16x32_bf16 a[72:75], v[92:95], v[24:27], a[72:75]
    ds_read_b128 v[44:47], v1 offset:23552
    v_mfma_f32_16x16x32_bf16 a[76:79], v[92:95], v[28:31], a[76:79]
    s_waitcnt lgkmcnt(2)
    v_subrev_u32 v2, 49152, v2
    v_subrev_u32 v3, 49152, v3
    v_mfma_f32_16x16x32_bf16 a[32:35], v[88:91], v[32:35], a[32:35]
    ds_read_b128 v[24:27], v2 offset:0
    v_mfma_f32_16x16x32_bf16 a[36:39], v[88:91], v[36:39], a[36:39]
    v_mfma_f32_16x16x32_bf16 a[80:83], v[92:95], v[32:35], a[80:83]
    ds_read_b128 v[28:31], v3 offset:0
    v_mfma_f32_16x16x32_bf16 a[84:87], v[92:95], v[36:39], a[84:87]
    s_waitcnt lgkmcnt(2)
    v_mfma_f32_16x16x32_bf16 a[40:43], v[88:91], v[40:43], a[40:43]
    ds_read_b128 v[32:35], v2 offset:6144
    v_mfma_f32_16x16x32_bf16 a[44:47], v[88:91], v[44:47], a[44:47]
    v_mfma_f32_16x16x32_bf16 a[88:91], v[92:95], v[40:43], a[88:91]
    ds_read_b128 v[36:39], v3 offset:6144
    v_mfma_f32_16x16x32_bf16 a[92:95], v[92:95], v[44:47], a[92:95]
    s_waitcnt lgkmcnt(2)
    s_waitcnt lgkmcnt(0)
    s_barrier
    v_mfma_f32_16x16x32_bf16 v[160:163], v[24:27], a[240:243], 0
    s_waitcnt vmcnt(10)
    ds_read_b128 v[40:43], v2 offset:128
    v_lshlrev_b32 v48, 16, v56
    v_mfma_f32_16x16x32_bf16 v[160:163], v[28:31], a[244:247], v[160:163]
    s_mov_b32 m0, s26
    v_and_b32 v49, s97, v56
    v_lshlrev_b32 v50, 16, v58
    v_and_b32 v51, s97, v58
    v_mul_f32 v48, s38, v48
    v_mul_f32 v49, s38, v49
    v_mfma_f32_16x16x32_bf16 v[164:167], v[24:27], v[200:203], 0
    ds_read_b128 v[44:47], v3 offset:128
    v_mul_f32_e64 v50, -v50, v48
    v_mfma_f32_16x16x32_bf16 v[164:167], v[28:31], v[204:207], v[164:167]
    s_waitcnt lgkmcnt(2)
    buffer_load_dwordx4 v4, s[4:7], s32 offen offset:0 sc1 lds
    v_mul_f32_e64 v51, -v51, v49
    v_cvt_f32_i32 v224, v224
    v_cvt_f32_i32 v225, v225
    v_mfma_f32_16x16x32_bf16 v[96:99], v[32:35], a[240:243], 0
    ds_read_b128 v[24:27], v2 offset:6272
    v_fma_f32 v224, v224, v48, v50
    v_mfma_f32_16x16x32_bf16 v[96:99], v[36:39], a[244:247], v[96:99]
    buffer_load_dwordx4 v4, s[4:7], s32 offen offset:1024 sc1 lds
    v_fma_f32 v225, v225, v49, v51
    v_cvt_pk_bf16_f32 v224, v224, v225
    v_cvt_f32_i32 v228, v228
    v_mfma_f32_16x16x32_bf16 v[100:103], v[32:35], v[200:203], 0
    ds_read_b128 v[28:31], v3 offset:6272
    v_cvt_f32_i32 v229, v229
    v_mfma_f32_16x16x32_bf16 v[100:103], v[36:39], v[204:207], v[100:103]
    s_waitcnt lgkmcnt(2)
    buffer_load_dwordx4 v4, s[4:7], s32 offen offset:2048 sc1 lds
    v_fma_f32 v228, v228, v48, v50
    v_fma_f32 v229, v229, v49, v51
    v_cvt_pk_bf16_f32 v228, v228, v229
    v_mfma_f32_16x16x32_bf16 v[160:163], v[40:43], a[248:251], v[160:163]
    s_add_u32 s32, s32, 24576
    ds_read_b128 v[32:35], v2 offset:256
    v_cvt_f32_i32 v232, v232
    v_mfma_f32_16x16x32_bf16 v[160:163], v[44:47], a[252:255], v[160:163]
    s_sub_u32 s57, s32, 196608
    v_cvt_f32_i32 v233, v233
    v_fma_f32 v232, v232, v48, v50
    v_fma_f32 v233, v233, v49, v51
    v_cvt_pk_bf16_f32 v232, v232, v233
    v_cvt_f32_i32 v236, v236
    v_mfma_f32_16x16x32_bf16 v[164:167], v[40:43], v[208:211], v[164:167]
    s_min_u32 s32, s32, s57
    ds_read_b128 v[36:39], v3 offset:256
    v_cvt_f32_i32 v237, v237
    v_mfma_f32_16x16x32_bf16 v[164:167], v[44:47], v[212:215], v[164:167]
    s_waitcnt lgkmcnt(2)
    v_fma_f32 v236, v236, v48, v50
    v_fma_f32 v237, v237, v49, v51
    v_cvt_pk_bf16_f32 v236, v236, v237
    v_lshlrev_b32 v48, 16, v57
    v_and_b32 v49, s97, v57
    v_mfma_f32_16x16x32_bf16 v[96:99], v[24:27], a[248:251], v[96:99]
    s_add_u32 s26, s26, 12288
    ds_read_b128 v[40:43], v2 offset:6400
    v_lshlrev_b32 v50, 16, v59
    v_mfma_f32_16x16x32_bf16 v[96:99], v[28:31], a[252:255], v[96:99]
    s_mov_b32 m0, s26
    v_and_b32 v51, s97, v59
    v_mul_f32 v48, s38, v48
    v_mul_f32 v49, s38, v49
    v_mul_f32_e64 v50, -v50, v48
    v_mul_f32_e64 v51, -v51, v49
    v_mfma_f32_16x16x32_bf16 v[100:103], v[24:27], v[208:211], v[100:103]
    ds_read_b128 v[44:47], v3 offset:6400
    v_cvt_f32_i32 v226, v226
    v_mfma_f32_16x16x32_bf16 v[100:103], v[28:31], v[212:215], v[100:103]
    s_waitcnt lgkmcnt(2)
    buffer_load_dwordx4 v4, s[4:7], s32 offen offset:0 sc1 lds
    v_cvt_f32_i32 v227, v227
    v_fma_f32 v226, v226, v48, v50
    v_fma_f32 v227, v227, v49, v51
    v_mfma_f32_16x16x32_bf16 v[160:163], v[32:35], v[192:195], v[160:163]
    ds_read_b128 v[24:27], v2 offset:12288
    v_cvt_pk_bf16_f32 v225, v226, v227
    v_mfma_f32_16x16x32_bf16 v[160:163], v[36:39], v[196:199], v[160:163]
    buffer_load_dwordx4 v4, s[4:7], s32 offen offset:1024 sc1 lds
    v_cvt_f32_i32 v230, v230
    v_cvt_f32_i32 v231, v231
    v_fma_f32 v230, v230, v48, v50
    v_mfma_f32_16x16x32_bf16 v[164:167], v[32:35], v[216:219], v[164:167]
    ds_read_b128 v[28:31], v3 offset:12288
    v_fma_f32 v231, v231, v49, v51
    v_mfma_f32_16x16x32_bf16 v[164:167], v[36:39], v[220:223], v[164:167]
    s_waitcnt lgkmcnt(2)
    s_waitcnt vmcnt(13)
    buffer_load_dwordx4 v4, s[4:7], s32 offen offset:2048 sc1 lds
    v_cvt_pk_bf16_f32 v229, v230, v231
    v_cvt_f32_i32 v234, v234
    v_cvt_f32_i32 v235, v235
    v_mfma_f32_16x16x32_bf16 v[96:99], v[40:43], v[192:195], v[96:99]
    ds_read_b128 v[32:35], v2 offset:18432
    v_fma_f32 v234, v234, v48, v50
    v_mfma_f32_16x16x32_bf16 v[96:99], v[44:47], v[196:199], v[96:99]
    v_fma_f32 v235, v235, v49, v51
    v_cvt_pk_bf16_f32 v233, v234, v235
    v_cvt_f32_i32 v238, v238
    v_cvt_f32_i32 v239, v239
    v_fma_f32 v238, v238, v48, v50
    v_mfma_f32_16x16x32_bf16 v[100:103], v[40:43], v[216:219], v[100:103]
    ds_read_b128 v[36:39], v3 offset:18432
    v_fma_f32 v239, v239, v49, v51
    v_mfma_f32_16x16x32_bf16 v[100:103], v[44:47], v[220:223], v[100:103]
    s_waitcnt lgkmcnt(2)
    v_cvt_pk_bf16_f32 v237, v238, v239
    v_mfma_f32_16x16x32_bf16 v[168:171], v[24:27], a[240:243], 0
    ds_read_b128 v[40:43], v2 offset:12416
    v_mfma_f32_16x16x32_bf16 v[168:171], v[28:31], a[244:247], v[168:171]
    s_add_u32 s32, s32, 24576
    s_sub_u32 s57, s32, 196608
    s_min_u32 s32, s32, s57
    s_add_u32 s26, s26, 36864
    s_sub_u32 s57, s26, 147456
    s_min_u32 s26, s26, s57
    v_mfma_f32_16x16x32_bf16 v[172:175], v[24:27], v[200:203], 0
    ds_read_b128 v[44:47], v3 offset:12416
    v_mfma_f32_16x16x32_bf16 v[172:175], v[28:31], v[204:207], v[172:175]
    s_waitcnt lgkmcnt(2)
    v_max3_f32 v16, v160, v161, v162
    v_max3_f32 v18, v164, v165, v166
    v_max3_f32 v16, v16, v163, v96
    v_max3_f32 v18, v18, v167, v100
    v_max3_f32 v16, v16, v97, v98
    v_max3_f32 v18, v18, v101, v102
    v_max_f32 v16, v16, v99
    v_max_f32 v18, v18, v103
    v_mov_b32 v17, v16
    v_mfma_f32_16x16x32_bf16 v[104:107], v[32:35], a[240:243], 0
    ds_read_b128 v[24:27], v2 offset:18560
    v_mov_b32 v19, v18
    v_mfma_f32_16x16x32_bf16 v[104:107], v[36:39], a[244:247], v[104:107]
    s_nop 0
    v_permlane16_swap_b32 v16, v17
    v_permlane16_swap_b32 v18, v19
    s_nop 0
    v_max_f32 v16, v16, v17
    v_max_f32 v18, v18, v19
    v_mov_b32 v17, v16
    v_mov_b32 v19, v18
    v_mfma_f32_16x16x32_bf16 v[108:111], v[32:35], v[200:203], 0
    s_nop 0
    ds_read_b128 v[28:31], v3 offset:18560
    v_permlane32_swap_b32 v16, v17
    v_mfma_f32_16x16x32_bf16 v[108:111], v[36:39], v[204:207], v[108:111]
    s_waitcnt lgkmcnt(2)
    v_permlane32_swap_b32 v18, v19
    s_nop 0
    v_max_f32 v16, v16, v17
    v_max_f32 v18, v18, v19
    v_sub_f32 v136, 0, v16
    v_sub_f32 v137, 0, v16
    v_mfma_f32_16x16x32_bf16 v[168:171], v[40:43], a[248:251], v[168:171]
    ds_read_b128 v[32:35], v2 offset:12544
    v_sub_f32 v138, 0, v16
    v_mfma_f32_16x16x32_bf16 v[168:171], v[44:47], a[252:255], v[168:171]
    v_sub_f32 v139, 0, v16
    v_sub_f32 v140, 0, v18
    v_sub_f32 v141, 0, v18
    v_sub_f32 v142, 0, v18
    v_sub_f32 v143, 0, v18
    v_mfma_f32_16x16x32_bf16 v[172:175], v[40:43], v[208:211], v[172:175]
    ds_read_b128 v[36:39], v3 offset:12544
    v_mfma_f32_16x16x32_bf16 v[172:175], v[44:47], v[212:215], v[172:175]
    s_waitcnt lgkmcnt(2)
    s_waitcnt vmcnt(10)
    v_lshlrev_b32 v48, 16, v60
    v_and_b32 v49, s97, v60
    v_lshlrev_b32 v50, 16, v62
    v_and_b32 v51, s97, v62
    v_mul_f32 v48, s38, v48
    v_mul_f32 v49, s38, v49
    v_mul_f32_e64 v50, -v50, v48
    v_mfma_f32_16x16x32_bf16 v[104:107], v[24:27], a[248:251], v[104:107]
    ds_read_b128 v[40:43], v2 offset:18688
    v_mul_f32_e64 v51, -v51, v49
    v_mfma_f32_16x16x32_bf16 v[104:107], v[28:31], a[252:255], v[104:107]
    buffer_load_dwordx2 v[56:57], off, s[80:83], s37 offset:0
    v_cvt_f32_i32 v240, v240
    v_cvt_f32_i32 v241, v241
    v_fma_f32 v240, v240, v48, v50
    v_fma_f32 v241, v241, v49, v51
    v_cvt_pk_bf16_f32 v226, v240, v241
    v_mfma_f32_16x16x32_bf16 v[108:111], v[24:27], v[208:211], v[108:111]
    ds_read_b128 v[44:47], v3 offset:18688
    v_cvt_f32_i32 v244, v244
    v_mfma_f32_16x16x32_bf16 v[108:111], v[28:31], v[212:215], v[108:111]
    s_waitcnt lgkmcnt(2)
    buffer_load_dwordx2 v[58:59], off, s[84:87], s37 offset:0
    v_add_u32 v2, 49152, v2
    v_add_u32 v3, 49152, v3
    v_cvt_f32_i32 v245, v245
    v_fma_f32 v244, v244, v48, v50
    v_mfma_f32_16x16x32_bf16 v[168:171], v[32:35], v[192:195], v[168:171]
    ds_read_b128 v[24:27], v2 offset:0
    v_fma_f32 v245, v245, v49, v51
    v_mfma_f32_16x16x32_bf16 v[168:171], v[36:39], v[196:199], v[168:171]
    v_cvt_pk_bf16_f32 v230, v244, v245
    v_cvt_f32_i32 v248, v248
    v_cvt_f32_i32 v249, v249
    v_fma_f32 v248, v248, v48, v50
    v_fma_f32 v249, v249, v49, v51
    v_cvt_pk_bf16_f32 v234, v248, v249
    v_cvt_f32_i32 v252, v252
    v_mfma_f32_16x16x32_bf16 v[172:175], v[32:35], v[216:219], v[172:175]
    ds_read_b128 v[28:31], v3 offset:0
    v_cvt_f32_i32 v253, v253
    v_mfma_f32_16x16x32_bf16 v[172:175], v[36:39], v[220:223], v[172:175]
    s_waitcnt lgkmcnt(2)
    v_fma_f32 v252, v252, v48, v50
    v_fma_f32 v253, v253, v49, v51
    v_cvt_pk_bf16_f32 v238, v252, v253
    v_lshlrev_b32 v48, 16, v61
    v_and_b32 v49, s97, v61
    v_lshlrev_b32 v50, 16, v63
    v_and_b32 v51, s97, v63
    v_mfma_f32_16x16x32_bf16 v[104:107], v[40:43], v[192:195], v[104:107]
    ds_read_b128 v[32:35], v2 offset:6144
    v_mul_f32 v48, s38, v48
    v_mfma_f32_16x16x32_bf16 v[104:107], v[44:47], v[196:199], v[104:107]
    v_mul_f32 v49, s38, v49
    v_mul_f32_e64 v50, -v50, v48
    v_mul_f32_e64 v51, -v51, v49
    v_cvt_f32_i32 v242, v242
    v_cvt_f32_i32 v243, v243
    v_fma_f32 v242, v242, v48, v50
    v_mfma_f32_16x16x32_bf16 v[108:111], v[40:43], v[216:219], v[108:111]
    ds_read_b128 v[36:39], v3 offset:6144
    v_add_f32 v160, v160, v136
    v_mfma_f32_16x16x32_bf16 v[108:111], v[44:47], v[220:223], v[108:111]
    s_waitcnt lgkmcnt(2)
    v_add_f32 v161, v161, v136
    v_add_f32 v162, v162, v136
    v_add_f32 v163, v163, v136
    v_add_f32 v96, v96, v136
    v_add_f32 v97, v97, v136
    v_add_f32 v98, v98, v136
    v_add_f32 v99, v99, v136
    v_mfma_f32_16x16x32_bf16 v[176:179], v[24:27], a[240:243], v[136:139]
    ds_read_b128 v[40:43], v2 offset:128
    v_add_f32 v164, v164, v140
    v_mfma_f32_16x16x32_bf16 v[176:179], v[28:31], a[244:247], v[176:179]
    v_add_f32 v165, v165, v140
    v_add_f32 v166, v166, v140
    v_add_f32 v167, v167, v140
    v_add_f32 v100, v100, v140
    v_add_f32 v101, v101, v140
    v_add_f32 v102, v102, v140
    v_mfma_f32_16x16x32_bf16 v[180:183], v[24:27], v[200:203], v[140:143]
    ds_read_b128 v[44:47], v3 offset:128
    v_add_f32 v103, v103, v140
    v_mfma_f32_16x16x32_bf16 v[180:183], v[28:31], v[204:207], v[180:183]
    s_waitcnt lgkmcnt(2)
    v_exp_f32 v16, v160
    v_exp_f32 v17, v161
    v_exp_f32 v18, v162
    v_add_f32 v7, v7, v16
    v_mfma_f32_16x16x32_bf16 v[112:115], v[32:35], a[240:243], v[136:139]
    ds_read_b128 v[24:27], v2 offset:6272
    v_add_f32 v7, v7, v17
    v_mfma_f32_16x16x32_bf16 v[112:115], v[36:39], a[244:247], v[112:115]
    v_exp_f32 v19, v163
    v_cvt_pk_bf16_f32 v160, v16, v17
    v_exp_f32 v16, v96
    v_add_f32 v7, v7, v18
    v_add_f32 v7, v7, v19
    v_mfma_f32_16x16x32_bf16 v[116:119], v[32:35], v[200:203], v[140:143]
    ds_read_b128 v[28:31], v3 offset:6272
    v_fma_f32 v243, v243, v49, v51
    v_mfma_f32_16x16x32_bf16 v[116:119], v[36:39], v[204:207], v[116:119]
    s_waitcnt lgkmcnt(2)
    v_exp_f32 v17, v97
    v_cvt_pk_bf16_f32 v161, v18, v19
    v_exp_f32 v18, v98
    v_add_f32 v7, v7, v16
    v_mfma_f32_16x16x32_bf16 v[176:179], v[40:43], a[248:251], v[176:179]
    ds_read_b128 v[32:35], v2 offset:256
    v_add_f32 v7, v7, v17
    v_mfma_f32_16x16x32_bf16 v[176:179], v[44:47], a[252:255], v[176:179]
    v_exp_f32 v19, v99
    v_cvt_pk_bf16_f32 v162, v16, v17
    v_exp_f32 v16, v164
    v_add_f32 v7, v7, v18
    v_add_f32 v7, v7, v19
    v_mfma_f32_16x16x32_bf16 v[180:183], v[40:43], v[208:211], v[180:183]
    ds_read_b128 v[36:39], v3 offset:256
    v_cvt_pk_bf16_f32 v227, v242, v243
    v_mfma_f32_16x16x32_bf16 v[180:183], v[44:47], v[212:215], v[180:183]
    s_waitcnt lgkmcnt(2)
    v_exp_f32 v17, v165
    v_cvt_pk_bf16_f32 v163, v18, v19
    v_exp_f32 v18, v166
    v_add_f32 v8, v8, v16
    v_mfma_f32_16x16x32_bf16 v[112:115], v[24:27], a[248:251], v[112:115]
    ds_read_b128 v[40:43], v2 offset:6400
    v_add_f32 v8, v8, v17
    v_mfma_f32_16x16x32_bf16 v[112:115], v[28:31], a[252:255], v[112:115]
    v_exp_f32 v19, v167
    v_cvt_pk_bf16_f32 v164, v16, v17
    v_exp_f32 v16, v100
    v_add_f32 v8, v8, v18
    v_add_f32 v8, v8, v19
    v_mfma_f32_16x16x32_bf16 v[116:119], v[24:27], v[208:211], v[116:119]
    ds_read_b128 v[44:47], v3 offset:6400
    v_cvt_f32_i32 v246, v246
    v_mfma_f32_16x16x32_bf16 v[116:119], v[28:31], v[212:215], v[116:119]
    s_waitcnt lgkmcnt(2)
    v_exp_f32 v17, v101
    v_cvt_pk_bf16_f32 v165, v18, v19
    v_exp_f32 v18, v102
    v_add_f32 v8, v8, v16
    v_add_f32 v8, v8, v17
    v_mfma_f32_16x16x32_bf16 v[176:179], v[32:35], v[192:195], v[176:179]
    ds_read_b128 v[24:27], v2 offset:12288
    v_cvt_f32_i32 v247, v247
    v_mfma_f32_16x16x32_bf16 v[176:179], v[36:39], v[196:199], v[176:179]
    v_exp_f32 v19, v103
    v_cvt_pk_bf16_f32 v166, v16, v17
    v_add_f32 v8, v8, v18
    v_add_f32 v8, v8, v19
    v_cvt_pk_bf16_f32 v167, v18, v19
    v_mfma_f32_16x16x32_bf16 v[180:183], v[32:35], v[216:219], v[180:183]
    ds_read_b128 v[28:31], v3 offset:12288
    v_add_f32 v168, v168, v136
    v_mfma_f32_16x16x32_bf16 v[180:183], v[36:39], v[220:223], v[180:183]
    s_waitcnt lgkmcnt(2)
    v_add_f32 v169, v169, v136
    v_add_f32 v170, v170, v136
    v_add_f32 v171, v171, v136
    v_add_f32 v104, v104, v136
    v_add_f32 v105, v105, v136
    v_add_f32 v106, v106, v136
    v_add_f32 v107, v107, v136
    v_mfma_f32_16x16x32_bf16 v[112:115], v[40:43], v[192:195], v[112:115]
    ds_read_b128 v[32:35], v2 offset:18432
    v_fma_f32 v246, v246, v48, v50
    v_mfma_f32_16x16x32_bf16 v[112:115], v[44:47], v[196:199], v[112:115]
    v_fma_f32 v247, v247, v49, v51
    v_cvt_pk_bf16_f32 v231, v246, v247
    v_cvt_f32_i32 v250, v250
    v_add_f32 v172, v172, v140
    v_add_f32 v173, v173, v140
    v_add_f32 v174, v174, v140
    v_add_f32 v175, v175, v140
    v_mfma_f32_16x16x32_bf16 v[116:119], v[40:43], v[216:219], v[116:119]
    ds_read_b128 v[36:39], v3 offset:18432
    v_cvt_f32_i32 v251, v251
    v_mfma_f32_16x16x32_bf16 v[116:119], v[44:47], v[220:223], v[116:119]
    s_waitcnt lgkmcnt(2)
    v_fma_f32 v250, v250, v48, v50
    v_fma_f32 v251, v251, v49, v51
    v_cvt_pk_bf16_f32 v235, v250, v251
    v_cvt_f32_i32 v254, v254
    v_add_f32 v108, v108, v140
    v_add_f32 v109, v109, v140
    v_mfma_f32_16x16x32_bf16 v[184:187], v[24:27], a[240:243], v[136:139]
    ds_read_b128 v[40:43], v2 offset:12416
    v_cvt_f32_i32 v255, v255
    v_fma_f32 v254, v254, v48, v50
    v_fma_f32 v255, v255, v49, v51
    v_cvt_pk_bf16_f32 v239, v254, v255
    v_mfma_f32_16x16x32_bf16 v[184:187], v[28:31], a[244:247], v[184:187]
    buffer_store_dwordx4 v[224:227], v11, s[4:7], s33 offen offset:0 sc1
    v_add_f32 v110, v110, v140
    v_add_f32 v111, v111, v140
    v_xor_b32 v55, 16, v11
    v_mfma_f32_16x16x32_bf16 v[188:191], v[24:27], v[200:203], v[140:143]
    ds_read_b128 v[44:47], v3 offset:12416
    v_mfma_f32_16x16x32_bf16 v[188:191], v[28:31], v[204:207], v[188:191]
    s_waitcnt lgkmcnt(2)
    v_exp_f32 v16, v168
    v_exp_f32 v17, v169
    v_exp_f32 v18, v170
    v_mfma_f32_16x16x32_bf16 v[120:123], v[32:35], a[240:243], v[136:139]
    ds_read_b128 v[24:27], v2 offset:18560
    v_add_f32 v7, v7, v16
    v_mfma_f32_16x16x32_bf16 v[120:123], v[36:39], a[244:247], v[120:123]
    buffer_store_dwordx4 v[228:231], v55, s[4:7], s33 offen offset:768 sc1
    v_add_f32 v7, v7, v17
    v_exp_f32 v19, v171
    v_mfma_f32_16x16x32_bf16 v[124:127], v[32:35], v[200:203], v[140:143]
    ds_read_b128 v[28:31], v3 offset:18560
    v_cvt_pk_bf16_f32 v168, v16, v17
    v_mfma_f32_16x16x32_bf16 v[124:127], v[36:39], v[204:207], v[124:127]
    s_waitcnt lgkmcnt(2)
    v_exp_f32 v16, v104
    v_add_f32 v7, v7, v18
    v_add_f32 v7, v7, v19
    v_exp_f32 v17, v105
    v_cvt_pk_bf16_f32 v169, v18, v19
    v_mfma_f32_16x16x32_bf16 v[184:187], v[40:43], a[248:251], v[184:187]
    ds_read_b128 v[32:35], v2 offset:12544
    v_mfma_f32_16x16x32_bf16 v[184:187], v[44:47], a[252:255], v[184:187]
    v_exp_f32 v18, v106
    v_add_f32 v7, v7, v16
    v_add_f32 v7, v7, v17
    v_exp_f32 v19, v107
    v_mfma_f32_16x16x32_bf16 v[188:191], v[40:43], v[208:211], v[188:191]
    ds_read_b128 v[36:39], v3 offset:12544
    v_cvt_pk_bf16_f32 v170, v16, v17
    v_mfma_f32_16x16x32_bf16 v[188:191], v[44:47], v[212:215], v[188:191]
    s_waitcnt lgkmcnt(2)
    v_exp_f32 v16, v172
    v_add_f32 v7, v7, v18
    v_add_f32 v7, v7, v19
    v_exp_f32 v17, v173
    v_cvt_pk_bf16_f32 v171, v18, v19
    v_mfma_f32_16x16x32_bf16 v[120:123], v[24:27], a[248:251], v[120:123]
    ds_read_b128 v[40:43], v2 offset:18688
    v_xor_b32 v54, 32, v11
    v_mfma_f32_16x16x32_bf16 v[120:123], v[28:31], a[252:255], v[120:123]
    s_waitcnt vmcnt(4)
    v_exp_f32 v18, v174
    v_add_f32 v8, v8, v16
    v_add_f32 v8, v8, v17
    v_exp_f32 v19, v175
    v_cvt_pk_bf16_f32 v172, v16, v17
    v_mfma_f32_16x16x32_bf16 v[124:127], v[24:27], v[208:211], v[124:127]
    ds_read_b128 v[44:47], v3 offset:18688
    v_mfma_f32_16x16x32_bf16 v[124:127], v[28:31], v[212:215], v[124:127]
    s_waitcnt lgkmcnt(2)
    s_barrier
    v_add_u32 v2, 49152, v2
    v_add_u32 v3, 49152, v3
    v_exp_f32 v16, v108
    v_mfma_f32_16x16x32_bf16 v[184:187], v[32:35], v[192:195], v[184:187]
    ds_read_b128 v[24:27], v2 offset:0
    v_add_f32 v8, v8, v18
    v_mfma_f32_16x16x32_bf16 v[184:187], v[36:39], v[196:199], v[184:187]
    buffer_store_dwordx4 v[232:235], v54, s[4:7], s33 offen offset:1536 sc1
    v_add_f32 v8, v8, v19
    v_exp_f32 v17, v109
    v_mfma_f32_16x16x32_bf16 v[188:191], v[32:35], v[216:219], v[188:191]
    ds_read_b128 v[28:31], v3 offset:0
    v_cvt_pk_bf16_f32 v173, v18, v19
    v_mfma_f32_16x16x32_bf16 v[188:191], v[36:39], v[220:223], v[188:191]
    s_waitcnt lgkmcnt(2)
    v_exp_f32 v18, v110
    v_add_f32 v8, v8, v16
    v_add_f32 v8, v8, v17
    v_exp_f32 v19, v111
    v_cvt_pk_bf16_f32 v174, v16, v17
    v_mfma_f32_16x16x32_bf16 v[120:123], v[40:43], v[192:195], v[120:123]
    ds_read_b128 v[32:35], v2 offset:6144
    v_xor_b32 v55, 48, v11
    v_mfma_f32_16x16x32_bf16 v[120:123], v[44:47], v[196:199], v[120:123]
    buffer_store_dwordx4 v[236:239], v55, s[4:7], s33 offen offset:2304 sc1
    v_add_f32 v8, v8, v18
    v_add_f32 v8, v8, v19
    v_cvt_pk_bf16_f32 v175, v18, v19
    v_mfma_f32_16x16x32_bf16 v[124:127], v[40:43], v[216:219], v[124:127]
    ds_read_b128 v[36:39], v3 offset:6144
    v_mfma_f32_16x16x32_bf16 v[124:127], v[44:47], v[220:223], v[124:127]
    s_waitcnt lgkmcnt(2)
    v_mfma_f32_16x16x32_bf16 v[64:67], v[24:27], a[192:195], v[128:131]
    ds_read_b128 v[40:43], v2 offset:128
    v_mfma_f32_16x16x32_bf16 v[64:67], v[28:31], a[196:199], v[64:67]
    buffer_load_dwordx2 v[60:61], off, s[80:83], s37 offset:8
    v_mfma_f32_16x16x32_bf16 v[68:71], v[24:27], a[216:219], v[132:135]
    v_exp_f32 v16, v176
    v_mfma_f32_16x16x32_bf16 v[68:71], v[28:31], a[220:223], v[68:71]
    v_exp_f32 v17, v177
    v_mfma_f32_16x16x32_bf16 v[72:75], v[24:27], a[240:243], v[136:139]
    ds_read_b128 v[44:47], v3 offset:128
    v_mfma_f32_16x16x32_bf16 v[72:75], v[28:31], a[244:247], v[72:75]
    buffer_load_dwordx2 v[62:63], off, s[84:87], s37 offset:8
    v_mfma_f32_16x16x32_bf16 v[76:79], v[24:27], v[200:203], v[140:143]
    v_exp_f32 v18, v178
    v_mfma_f32_16x16x32_bf16 v[76:79], v[28:31], v[204:207], v[76:79]
    s_waitcnt lgkmcnt(2)
    v_add_f32 v7, v7, v16
    v_add_f32 v7, v7, v17
    v_mfma_f32_16x16x32_bf16 v[96:99], v[32:35], a[192:195], v[128:131]
    ds_read_b128 v[24:27], v2 offset:6272
    v_mfma_f32_16x16x32_bf16 v[96:99], v[36:39], a[196:199], v[96:99]
    buffer_load_dwordx3 v[240:242], v12, s[68:71], s16 offen offset:0 nt
    v_mfma_f32_16x16x32_bf16 v[100:103], v[32:35], a[216:219], v[132:135]
    s_waitcnt vmcnt(7)
    v_exp_f32 v19, v179
    v_mfma_f32_16x16x32_bf16 v[100:103], v[36:39], a[220:223], v[100:103]
    v_cvt_pk_bf16_f32 v176, v16, v17
    v_exp_f32 v16, v112
    v_mfma_f32_16x16x32_bf16 v[104:107], v[32:35], a[240:243], v[136:139]
    ds_read_b128 v[28:31], v3 offset:6272
    v_add_f32 v7, v7, v18
    v_mfma_f32_16x16x32_bf16 v[104:107], v[36:39], a[244:247], v[104:107]
    buffer_load_dwordx3 v[244:246], v12, s[68:71], s16 offen offset:768 nt
    v_add_f32 v7, v7, v19
    v_mfma_f32_16x16x32_bf16 v[108:111], v[32:35], v[200:203], v[140:143]
    v_exp_f32 v17, v113
    v_mfma_f32_16x16x32_bf16 v[108:111], v[36:39], v[204:207], v[108:111]
    s_waitcnt lgkmcnt(2)
    v_cvt_pk_bf16_f32 v177, v18, v19
    v_exp_f32 v18, v114
    v_mfma_f32_16x16x32_bf16 v[64:67], v[40:43], a[200:203], v[64:67]
    ds_read_b128 v[32:35], v2 offset:256
    v_add_f32 v7, v7, v16
    v_mfma_f32_16x16x32_bf16 v[64:67], v[44:47], a[204:207], v[64:67]
    buffer_load_dwordx3 v[248:250], v12, s[68:71], s16 offen offset:1536 nt
    v_add_f32 v7, v7, v17
    v_mfma_f32_16x16x32_bf16 v[68:71], v[40:43], a[224:227], v[68:71]
    v_exp_f32 v19, v115
    v_mfma_f32_16x16x32_bf16 v[68:71], v[44:47], a[228:231], v[68:71]
    v_cvt_pk_bf16_f32 v178, v16, v17
    v_exp_f32 v16, v180
    v_mfma_f32_16x16x32_bf16 v[72:75], v[40:43], a[248:251], v[72:75]
    ds_read_b128 v[36:39], v3 offset:256
    v_add_f32 v7, v7, v18
    v_mfma_f32_16x16x32_bf16 v[72:75], v[44:47], a[252:255], v[72:75]
    buffer_load_dwordx3 v[252:254], v12, s[68:71], s16 offen offset:2304 nt
    v_add_f32 v7, v7, v19
    v_mfma_f32_16x16x32_bf16 v[76:79], v[40:43], v[208:211], v[76:79]
    v_exp_f32 v17, v181
    v_mfma_f32_16x16x32_bf16 v[76:79], v[44:47], v[212:215], v[76:79]
    s_waitcnt lgkmcnt(2)
    v_cvt_pk_bf16_f32 v179, v18, v19
    v_exp_f32 v18, v182
    v_mfma_f32_16x16x32_bf16 v[96:99], v[24:27], a[200:203], v[96:99]
    s_mov_b32 m0, s26
    ds_read_b128 v[40:43], v2 offset:6400
    v_add_f32 v8, v8, v16
    v_mfma_f32_16x16x32_bf16 v[96:99], v[28:31], a[204:207], v[96:99]
    buffer_load_dwordx4 v4, s[4:7], s32 offen offset:0 sc1 lds
    v_add_f32 v8, v8, v17
    v_mfma_f32_16x16x32_bf16 v[100:103], v[24:27], a[224:227], v[100:103]
    v_exp_f32 v19, v183
    v_mfma_f32_16x16x32_bf16 v[100:103], v[28:31], a[228:231], v[100:103]
    v_cvt_pk_bf16_f32 v180, v16, v17
    v_exp_f32 v16, v116
    v_mfma_f32_16x16x32_bf16 v[104:107], v[24:27], a[248:251], v[104:107]
    ds_read_b128 v[44:47], v3 offset:6400
    v_add_f32 v8, v8, v18
    v_mfma_f32_16x16x32_bf16 v[104:107], v[28:31], a[252:255], v[104:107]
    buffer_load_dwordx4 v4, s[4:7], s32 offen offset:1024 sc1 lds
    v_add_f32 v8, v8, v19
    v_mfma_f32_16x16x32_bf16 v[108:111], v[24:27], v[208:211], v[108:111]
    v_exp_f32 v17, v117
    v_mfma_f32_16x16x32_bf16 v[108:111], v[28:31], v[212:215], v[108:111]
    s_waitcnt lgkmcnt(2)
    v_cvt_pk_bf16_f32 v181, v18, v19
    v_exp_f32 v18, v118
    v_mfma_f32_16x16x32_bf16 v[64:67], v[32:35], a[208:211], v[64:67]
    ds_read_b128 v[24:27], v2 offset:12288
    v_add_f32 v8, v8, v16
    v_mfma_f32_16x16x32_bf16 v[64:67], v[36:39], a[212:215], v[64:67]
    buffer_load_dwordx4 v4, s[4:7], s32 offen offset:2048 sc1 lds
    v_add_f32 v8, v8, v17
    v_mfma_f32_16x16x32_bf16 v[68:71], v[32:35], a[232:235], v[68:71]
    s_add_u32 s32, s32, 24576
    v_exp_f32 v19, v119
    v_mfma_f32_16x16x32_bf16 v[68:71], v[36:39], a[236:239], v[68:71]
    v_cvt_pk_bf16_f32 v182, v16, v17
    v_add_f32 v8, v8, v18
    v_add_f32 v8, v8, v19
    v_mfma_f32_16x16x32_bf16 v[72:75], v[32:35], v[192:195], v[72:75]
    s_sub_u32 s57, s32, 196608
    ds_read_b128 v[28:31], v3 offset:12288
    v_cvt_pk_bf16_f32 v183, v18, v19
    v_mfma_f32_16x16x32_bf16 v[72:75], v[36:39], v[196:199], v[72:75]
    s_waitcnt lgkmcnt(2)
    v_exp_f32 v16, v184
    v_lshlrev_b32 v48, 16, v56
    v_mfma_f32_16x16x32_bf16 v[76:79], v[32:35], v[216:219], v[76:79]
    s_waitcnt vmcnt(9)
    v_exp_f32 v17, v185
    v_mfma_f32_16x16x32_bf16 v[76:79], v[36:39], v[220:223], v[76:79]
    s_barrier
    v_exp_f32 v18, v186
    v_mfma_f32_16x16x32_bf16 v[96:99], v[40:43], a[208:211], v[96:99]
    s_min_u32 s32, s32, s57
    ds_read_b128 v[32:35], v2 offset:18432
    v_add_f32 v7, v7, v16
    v_mfma_f32_16x16x32_bf16 v[96:99], v[44:47], a[212:215], v[96:99]
    v_add_f32 v7, v7, v17
    v_exp_f32 v19, v187
    v_mfma_f32_16x16x32_bf16 v[100:103], v[40:43], a[232:235], v[100:103]
    s_add_u32 s26, s26, 12288
    v_cvt_pk_bf16_f32 v184, v16, v17
    v_and_b32 v49, s97, v56
    v_mfma_f32_16x16x32_bf16 v[100:103], v[44:47], a[236:239], v[100:103]
    v_exp_f32 v16, v120
    v_add_f32 v7, v7, v18
    v_mfma_f32_16x16x32_bf16 v[104:107], v[40:43], v[192:195], v[104:107]
    s_mov_b32 m0, s26
    ds_read_b128 v[36:39], v3 offset:18432
    v_add_f32 v7, v7, v19
    v_mfma_f32_16x16x32_bf16 v[104:107], v[44:47], v[196:199], v[104:107]
    buffer_load_dwordx4 v4, s[4:7], s32 offen offset:0 sc1 lds
    v_lshlrev_b32 v50, 16, v58
    v_mfma_f32_16x16x32_bf16 v[108:111], v[40:43], v[216:219], v[108:111]
    v_exp_f32 v17, v121
    v_mfma_f32_16x16x32_bf16 v[108:111], v[44:47], v[220:223], v[108:111]
    s_waitcnt lgkmcnt(2)
    v_cvt_pk_bf16_f32 v185, v18, v19
    v_exp_f32 v18, v122
    v_mfma_f32_16x16x32_bf16 v[80:83], v[24:27], a[192:195], v[128:131]
    ds_read_b128 v[40:43], v2 offset:12416
    v_add_f32 v7, v7, v16
    v_mfma_f32_16x16x32_bf16 v[80:83], v[28:31], a[196:199], v[80:83]
    buffer_load_dwordx4 v4, s[4:7], s32 offen offset:1024 sc1 lds
    v_add_f32 v7, v7, v17
    v_mfma_f32_16x16x32_bf16 v[84:87], v[24:27], a[216:219], v[132:135]
    v_exp_f32 v19, v123
    v_mfma_f32_16x16x32_bf16 v[84:87], v[28:31], a[220:223], v[84:87]
    v_cvt_pk_bf16_f32 v186, v16, v17
    v_exp_f32 v16, v188
    v_mfma_f32_16x16x32_bf16 v[88:91], v[24:27], a[240:243], v[136:139]
L_iw2:
L_pg2:
    s_cbranch_execz L_pg6
    ds_read_b128 v[44:47], v3 offset:12416
    v_add_f32 v7, v7, v18
    v_mfma_f32_16x16x32_bf16 v[88:91], v[28:31], a[244:247], v[88:91]
    v_add_u32 v0, 1, v0
    buffer_store_dword v0, v13, s[20:23], 0 offen offset:32 sc1
    v_mfma_f32_16x16x32_bf16 v[92:95], v[24:27], v[200:203], v[140:143]
    v_add_f32 v7, v7, v19
    v_exp_f32 v17, v189
    v_cvt_pk_bf16_f32 v187, v18, v19
    v_exp_f32 v18, v190
    v_add_f32 v8, v8, v16
    v_add_f32 v8, v8, v17
    v_exp_f32 v19, v191
    v_cvt_pk_bf16_f32 v188, v16, v17
    v_exp_f32 v16, v124
    v_add_f32 v8, v8, v18
    v_add_f32 v8, v8, v19
    v_exp_f32 v17, v125
    v_cvt_pk_bf16_f32 v189, v18, v19
    v_exp_f32 v18, v126
    v_add_f32 v8, v8, v16
    v_add_f32 v8, v8, v17
    v_exp_f32 v19, v127
    v_cvt_pk_bf16_f32 v190, v16, v17
    v_add_f32 v8, v8, v18
    v_add_f32 v8, v8, v19
    v_cvt_pk_bf16_f32 v191, v18, v19
    v_mfma_f32_16x16x32_bf16 v[92:95], v[28:31], v[204:207], v[92:95]
    s_waitcnt lgkmcnt(2)
    v_and_b32 v51, s97, v58
    v_mul_f32_e64 v50, -v50, v48
    v_mul_f32_e64 v51, -v51, v49
    v_mfma_f32_16x16x32_bf16 v[112:115], v[32:35], a[192:195], v[128:131]
    ds_read_b128 v[24:27], v2 offset:18560
    v_cvt_f32_i32 v144, v144
    v_mfma_f32_16x16x32_bf16 v[112:115], v[36:39], a[196:199], v[112:115]
    buffer_load_dwordx4 v4, s[4:7], s32 offen offset:2048 sc1 lds
    v_cvt_f32_i32 v148, v148
    v_mfma_f32_16x16x32_bf16 v[116:119], v[32:35], a[216:219], v[132:135]
    s_mov_b32 s32, 196608
    v_fma_f32 v144, v144, v48, v50
    v_fma_f32 v148, v148, v49, v51
    v_mfma_f32_16x16x32_bf16 v[116:119], v[36:39], a[220:223], v[116:119]
    v_cvt_f32_i32 v145, v145
    v_cvt_f32_i32 v149, v149
    v_fma_f32 v145, v145, v48, v50
    v_mfma_f32_16x16x32_bf16 v[120:123], v[32:35], a[240:243], v[136:139]
    s_add_u32 s26, s26, 36864
    ds_read_b128 v[28:31], v3 offset:18560
    v_fma_f32 v149, v149, v49, v51
    v_mfma_f32_16x16x32_bf16 v[120:123], v[36:39], a[244:247], v[120:123]
    v_cvt_f32_i32 v146, v146
    v_cvt_f32_i32 v150, v150
    v_fma_f32 v146, v146, v48, v50
    v_mfma_f32_16x16x32_bf16 v[124:127], v[32:35], v[200:203], v[140:143]
    s_sub_u32 s57, s26, 147456
    v_exp_f32 v16, v64
    v_mfma_f32_16x16x32_bf16 v[124:127], v[36:39], v[204:207], v[124:127]
    s_waitcnt lgkmcnt(2)
    v_exp_f32 v17, v65
    v_fma_f32 v150, v150, v49, v51
    v_mfma_f32_16x16x32_bf16 v[80:83], v[40:43], a[200:203], v[80:83]
    s_min_u32 s26, s26, s57
    ds_read_b128 v[32:35], v2 offset:12544
    v_lshlrev_b32 v48, 16, v57
    v_mfma_f32_16x16x32_bf16 v[80:83], v[44:47], a[204:207], v[80:83]
    v_exp_f32 v18, v66
    v_add_f32 v5, v5, v16
    v_mfma_f32_16x16x32_bf16 v[84:87], v[40:43], a[224:227], v[84:87]
    s_mov_b32 m0, s56
    v_add_f32 v5, v5, v17
    v_and_b32 v49, s97, v57
    v_mfma_f32_16x16x32_bf16 v[84:87], v[44:47], a[228:231], v[84:87]
    buffer_load_dwordx4 v4, s[4:7], s27 offen offset:0 sc1 lds
    v_lshlrev_b32 v50, 16, v59
    v_mfma_f32_16x16x32_bf16 v[88:91], v[40:43], a[248:251], v[88:91]
    ds_read_b128 v[36:39], v3 offset:12544
    v_and_b32 v51, s97, v59
    v_mfma_f32_16x16x32_bf16 v[88:91], v[44:47], a[252:255], v[88:91]
    v_exp_f32 v19, v67
    v_cvt_pk_bf16_f32 v64, v16, v17
    v_mfma_f32_16x16x32_bf16 v[92:95], v[40:43], v[208:211], v[92:95]
    v_exp_f32 v16, v96
    v_mfma_f32_16x16x32_bf16 v[92:95], v[44:47], v[212:215], v[92:95]
    s_waitcnt lgkmcnt(2)
    buffer_load_dwordx4 v4, s[4:7], s27 offen offset:1024 sc1 lds
    v_add_f32 v5, v5, v18
    v_mfma_f32_16x16x32_bf16 v[112:115], v[24:27], a[200:203], v[112:115]
    ds_read_b128 v[40:43], v2 offset:18688
    v_add_f32 v5, v5, v19
    v_mfma_f32_16x16x32_bf16 v[112:115], v[28:31], a[204:207], v[112:115]
    v_exp_f32 v17, v97
    v_mul_f32_e64 v50, -v50, v48
    v_mfma_f32_16x16x32_bf16 v[116:119], v[24:27], a[224:227], v[116:119]
    v_cvt_pk_bf16_f32 v65, v18, v19
    v_mul_f32_e64 v51, -v51, v49
    v_mfma_f32_16x16x32_bf16 v[116:119], v[28:31], a[228:231], v[116:119]
    s_waitcnt vmcnt(13)
    buffer_load_dwordx4 v4, s[4:7], s27 offen offset:2048 sc1 lds
    v_cvt_f32_i32 v152, v152
    v_mfma_f32_16x16x32_bf16 v[120:123], v[24:27], a[248:251], v[120:123]
    s_add_u32 s27, s27, 24576
    ds_read_b128 v[44:47], v3 offset:18688
    v_cvt_f32_i32 v156, v156
    v_mfma_f32_16x16x32_bf16 v[120:123], v[28:31], a[252:255], v[120:123]
    s_waitcnt lgkmcnt(2)
    v_exp_f32 v18, v98
    v_add_f32 v5, v5, v16
    v_mfma_f32_16x16x32_bf16 v[124:127], v[24:27], v[208:211], v[124:127]
    s_sub_u32 s58, s27, 196608
    v_add_f32 v5, v5, v17
    v_fma_f32 v152, v152, v48, v50
    v_mfma_f32_16x16x32_bf16 v[124:127], v[28:31], v[212:215], v[124:127]
    s_barrier
    v_subrev_u32 v1, 49152, v1
    v_fma_f32 v156, v156, v49, v51
    v_mfma_f32_16x16x32_bf16 v[80:83], v[32:35], a[208:211], v[80:83]
    s_min_u32 s27, s27, s58
    ds_read_b128 v[24:27], v1 offset:0
    v_cvt_f32_i32 v153, v153
    v_mfma_f32_16x16x32_bf16 v[80:83], v[36:39], a[212:215], v[80:83]
    v_exp_f32 v19, v99
    v_cvt_pk_bf16_f32 v66, v16, v17
    v_mfma_f32_16x16x32_bf16 v[84:87], v[32:35], a[232:235], v[84:87]
    s_add_u32 s56, s56, 12288
    v_exp_f32 v16, v68
    v_mfma_f32_16x16x32_bf16 v[84:87], v[36:39], a[236:239], v[84:87]
    v_add_f32 v5, v5, v18
    v_add_f32 v5, v5, v19
    v_cvt_f32_i32 v157, v157
    v_mfma_f32_16x16x32_bf16 v[88:91], v[32:35], v[192:195], v[88:91]
    s_mov_b32 m0, s56
    ds_read_b128 v[28:31], v1 offset:12288
    v_fma_f32 v153, v153, v48, v50
    v_mfma_f32_16x16x32_bf16 v[88:91], v[36:39], v[196:199], v[88:91]
    s_waitcnt vmcnt(12)
    buffer_load_dwordx4 v4, s[4:7], s27 offen offset:0 sc1 lds
    v_mfma_f32_16x16x32_bf16 v[92:95], v[32:35], v[216:219], v[92:95]
    v_exp_f32 v17, v69
    v_mfma_f32_16x16x32_bf16 v[92:95], v[36:39], v[220:223], v[92:95]
    s_waitcnt lgkmcnt(2)
    v_cvt_pk_bf16_f32 v67, v18, v19
    v_exp_f32 v18, v70
    v_mfma_f32_16x16x32_bf16 v[112:115], v[40:43], a[208:211], v[112:115]
    ds_read_b128 v[32:35], v1 offset:1024
    v_add_f32 v6, v6, v16
    v_mfma_f32_16x16x32_bf16 v[112:115], v[44:47], a[212:215], v[112:115]
    s_waitcnt vmcnt(12)
    buffer_load_dwordx4 v4, s[4:7], s27 offen offset:1024 sc1 lds
    v_add_f32 v6, v6, v17
    v_mfma_f32_16x16x32_bf16 v[116:119], v[40:43], a[232:235], v[116:119]
    s_waitcnt vmcnt(12)
    buffer_load_dwordx4 v4, s[4:7], s27 offen offset:2048 sc1 lds
    v_mfma_f32_16x16x32_bf16 v[116:119], v[44:47], a[236:239], v[116:119]
    v_exp_f32 v19, v71
    v_cvt_pk_bf16_f32 v68, v16, v17
    v_mfma_f32_16x16x32_bf16 v[120:123], v[40:43], v[192:195], v[120:123]
    s_add_u32 s27, s27, 24576
    ds_read_b128 v[36:39], v1 offset:13312
    v_fma_f32 v157, v157, v49, v51
    v_mfma_f32_16x16x32_bf16 v[120:123], v[44:47], v[196:199], v[120:123]
    v_exp_f32 v16, v100
    v_add_f32 v6, v6, v18
    v_mfma_f32_16x16x32_bf16 v[124:127], v[40:43], v[216:219], v[124:127]
    s_sub_u32 s58, s27, 196608
    v_add_f32 v6, v6, v19
    v_cvt_f32_i32 v154, v154
    v_mfma_f32_16x16x32_bf16 v[124:127], v[44:47], v[220:223], v[124:127]
    s_waitcnt lgkmcnt(2)
    v_exp_f32 v17, v101
    v_cvt_pk_bf16_f32 v69, v18, v19
    v_exp_f32 v18, v102
    v_cvt_f32_i32 v158, v158
    v_add_f32 v6, v6, v16
    v_fma_f32 v154, v154, v48, v50
    v_add_f32 v6, v6, v17
    v_fma_f32 v158, v158, v49, v51
    v_exp_f32 v19, v103
    v_cvt_pk_bf16_f32 v144, v144, v148
    v_cvt_pk_bf16_f32 v148, v145, v149
    v_cvt_pk_bf16_f32 v70, v16, v17
    s_min_u32 s27, s27, s58
    v_cvt_pk_bf16_f32 v145, v152, v156
    v_add_f32 v6, v6, v18
    s_add_u32 s56, s56, 36864
    v_cvt_pk_bf16_f32 v149, v153, v157
    v_add_f32 v6, v6, v19
    s_sub_u32 s58, s56, 147456
    v_cvt_pk_bf16_f32 v152, v146, v150
    v_cvt_pk_bf16_f32 v71, v18, v19
    s_min_u32 s56, s56, s58
    v_cvt_pk_bf16_f32 v153, v154, v158
    s_mov_b32 s31, 7
    s_mul_i32 s46, s95, 24576
    s_mov_b32 s47, 12288
    v_mfma_f32_16x16x32_bf16 a[96:99], v[160:163], v[24:27], 0
    s_add_u32 s33, s33, 196608
    ds_read_b128 v[40:43], v1 offset:2048
    v_mfma_f32_16x16x32_bf16 a[96:99], v[168:171], v[28:31], a[96:99]
    s_add_u32 s34, s34, 196608
    v_exp_f32 v16, v72
    v_mfma_f32_16x16x32_bf16 a[144:147], v[164:167], v[24:27], 0
    s_add_u32 s36, s36, 1536
    ds_read_b128 v[44:47], v1 offset:14336
    v_mfma_f32_16x16x32_bf16 a[144:147], v[172:175], v[28:31], a[144:147]
    s_waitcnt lgkmcnt(2)
    v_exp_f32 v17, v73
    v_mfma_f32_16x16x32_bf16 a[100:103], v[160:163], v[32:35], 0
    ds_read_b128 v[24:27], v1 offset:3072
    v_mfma_f32_16x16x32_bf16 a[100:103], v[168:171], v[36:39], a[100:103]
    s_waitcnt vmcnt(12)
    buffer_load_dwordx2 v[56:57], v10, s[72:75], s36 offen offset:0
    v_mfma_f32_16x16x32_bf16 a[148:151], v[164:167], v[32:35], 0
    ds_read_b128 v[28:31], v1 offset:15360
    v_mfma_f32_16x16x32_bf16 a[148:151], v[172:175], v[36:39], a[148:151]
    s_waitcnt lgkmcnt(2)
    v_exp_f32 v18, v74
    v_mfma_f32_16x16x32_bf16 a[104:107], v[160:163], v[40:43], 0
    ds_read_b128 v[32:35], v1 offset:4096
    v_add_f32 v7, v7, v16
    v_mfma_f32_16x16x32_bf16 a[104:107], v[168:171], v[44:47], a[104:107]
    buffer_load_dwordx2 v[58:59], v10, s[76:79], s36 offen offset:0
    v_mfma_f32_16x16x32_bf16 a[152:155], v[164:167], v[40:43], 0
    ds_read_b128 v[36:39], v1 offset:16384
    v_add_f32 v7, v7, v17
    v_mfma_f32_16x16x32_bf16 a[152:155], v[172:175], v[44:47], a[152:155]
    s_waitcnt lgkmcnt(2)
    v_exp_f32 v19, v75
    v_mfma_f32_16x16x32_bf16 a[108:111], v[160:163], v[24:27], 0
    ds_read_b128 v[40:43], v1 offset:5120
    v_cvt_pk_bf16_f32 v72, v16, v17
    v_mfma_f32_16x16x32_bf16 a[108:111], v[168:171], v[28:31], a[108:111]
    s_waitcnt vmcnt(13)
    buffer_load_dwordx4 v[224:227], v9, s[64:67], s33 offen offset:0 nt
    v_mfma_f32_16x16x32_bf16 a[156:159], v[164:167], v[24:27], 0
    ds_read_b128 v[44:47], v1 offset:17408
    v_mfma_f32_16x16x32_bf16 a[156:159], v[172:175], v[28:31], a[156:159]
    s_waitcnt lgkmcnt(2)
    v_exp_f32 v16, v104
    v_mfma_f32_16x16x32_bf16 a[112:115], v[160:163], v[32:35], 0
    ds_read_b128 v[24:27], v1 offset:6144
    v_add_f32 v7, v7, v18
    v_mfma_f32_16x16x32_bf16 a[112:115], v[168:171], v[36:39], a[112:115]
    s_waitcnt vmcnt(13)
    buffer_load_dwordx4 v[228:231], v9, s[64:67], s33 offen offset:1536 nt
    v_add_f32 v7, v7, v19
    v_mfma_f32_16x16x32_bf16 a[160:163], v[164:167], v[32:35], 0
    ds_read_b128 v[28:31], v1 offset:18432
    v_mfma_f32_16x16x32_bf16 a[160:163], v[172:175], v[36:39], a[160:163]
    s_waitcnt lgkmcnt(2)
    v_exp_f32 v17, v105
    v_cvt_pk_bf16_f32 v73, v18, v19
    v_mfma_f32_16x16x32_bf16 a[116:119], v[160:163], v[40:43], 0
    ds_read_b128 v[32:35], v1 offset:7168
    v_mfma_f32_16x16x32_bf16 a[116:119], v[168:171], v[44:47], a[116:119]
    buffer_load_dwordx4 v[232:235], v9, s[64:67], s34 offen offset:0 nt
    v_mfma_f32_16x16x32_bf16 a[164:167], v[164:167], v[40:43], 0
    ds_read_b128 v[36:39], v1 offset:19456
    v_mfma_f32_16x16x32_bf16 a[164:167], v[172:175], v[44:47], a[164:167]
    s_waitcnt lgkmcnt(2)
    v_exp_f32 v18, v106
    v_add_f32 v7, v7, v16
    v_mfma_f32_16x16x32_bf16 a[120:123], v[160:163], v[24:27], 0
    ds_read_b128 v[40:43], v1 offset:8192
    v_add_f32 v7, v7, v17
    v_mfma_f32_16x16x32_bf16 a[120:123], v[168:171], v[28:31], a[120:123]
    s_waitcnt vmcnt(14)
    buffer_load_dwordx4 v[236:239], v9, s[64:67], s34 offen offset:1536 nt
    v_mfma_f32_16x16x32_bf16 a[168:171], v[164:167], v[24:27], 0
    ds_read_b128 v[44:47], v1 offset:20480
    v_mfma_f32_16x16x32_bf16 a[168:171], v[172:175], v[28:31], a[168:171]
    s_waitcnt lgkmcnt(2)
    v_exp_f32 v19, v107
    v_cvt_pk_bf16_f32 v74, v16, v17
    v_mfma_f32_16x16x32_bf16 a[124:127], v[160:163], v[32:35], 0
    ds_read_b128 v[24:27], v1 offset:9216
    v_mfma_f32_16x16x32_bf16 a[124:127], v[168:171], v[36:39], a[124:127]
    v_exp_f32 v16, v76
    v_add_f32 v7, v7, v18
    v_mfma_f32_16x16x32_bf16 a[172:175], v[164:167], v[32:35], 0
    s_waitcnt vmcnt(19)
    ds_read_b128 v[28:31], v1 offset:21504
    v_add_f32 v7, v7, v19
    v_mfma_f32_16x16x32_bf16 a[172:175], v[172:175], v[36:39], a[172:175]
    s_waitcnt lgkmcnt(2)
    v_exp_f32 v17, v77
    v_cvt_pk_bf16_f32 v75, v18, v19
    v_mfma_f32_16x16x32_bf16 a[128:131], v[160:163], v[40:43], 0
    s_add_u32 s29, s28, 49152
    ds_read_b128 v[32:35], v1 offset:10240
    v_lshlrev_b32 v48, 16, v60
    v_mfma_f32_16x16x32_bf16 a[128:131], v[168:171], v[44:47], a[128:131]
    v_exp_f32 v18, v78
    v_add_f32 v8, v8, v16
    v_mfma_f32_16x16x32_bf16 a[176:179], v[164:167], v[40:43], 0
    s_sub_u32 s3, s29, 147456
    ds_read_b128 v[36:39], v1 offset:22528
    v_add_f32 v8, v8, v17
    v_mfma_f32_16x16x32_bf16 a[176:179], v[172:175], v[44:47], a[176:179]
    s_waitcnt lgkmcnt(2)
    v_exp_f32 v19, v79
    v_mfma_f32_16x16x32_bf16 a[132:135], v[160:163], v[24:27], 0
    s_min_u32 s29, s29, s3
    ds_read_b128 v[40:43], v1 offset:11264
    v_cvt_pk_bf16_f32 v76, v16, v17
    v_mfma_f32_16x16x32_bf16 a[132:135], v[168:171], v[28:31], a[132:135]
    v_exp_f32 v16, v108
    v_mfma_f32_16x16x32_bf16 a[180:183], v[164:167], v[24:27], 0
    s_sub_u32 s3, s29, s28
    ds_read_b128 v[44:47], v1 offset:23552
    v_add_f32 v8, v8, v18
    v_mfma_f32_16x16x32_bf16 a[180:183], v[172:175], v[28:31], a[180:183]
    s_waitcnt lgkmcnt(2)
    v_add_u32 v1, 49152, v1
    v_add_f32 v8, v8, v19
    v_mfma_f32_16x16x32_bf16 a[136:139], v[160:163], v[32:35], 0
    ds_read_b128 v[24:27], v1 offset:0
    v_and_b32 v49, s97, v60
    v_mfma_f32_16x16x32_bf16 a[136:139], v[168:171], v[36:39], a[136:139]
    v_exp_f32 v17, v109
    v_mfma_f32_16x16x32_bf16 a[184:187], v[164:167], v[32:35], 0
    ds_read_b128 v[28:31], v1 offset:12288
    v_cvt_pk_bf16_f32 v77, v18, v19
    v_mfma_f32_16x16x32_bf16 a[184:187], v[172:175], v[36:39], a[184:187]
    s_waitcnt lgkmcnt(2)
    v_lshlrev_b32 v50, 16, v62
    v_and_b32 v51, s97, v62
    v_mfma_f32_16x16x32_bf16 a[140:143], v[160:163], v[40:43], 0
    s_mov_b32 s28, s29
    ds_read_b128 v[32:35], v1 offset:1024
    v_bfe_u32 v53, v4, 4, 6
    v_mfma_f32_16x16x32_bf16 a[140:143], v[168:171], v[44:47], a[140:143]
    v_exp_f32 v18, v110
    v_add_f32 v8, v8, v16
    v_mfma_f32_16x16x32_bf16 a[188:191], v[164:167], v[40:43], 0
    ds_read_b128 v[36:39], v1 offset:13312
    v_lshlrev_b32 v53, 2, v53
    v_mfma_f32_16x16x32_bf16 a[188:191], v[172:175], v[44:47], a[188:191]
    s_waitcnt lgkmcnt(2)
    s_barrier
    v_add_f32 v8, v8, v17
    v_mfma_f32_16x16x32_bf16 a[96:99], v[176:179], v[24:27], a[96:99]
    ds_read_b128 v[40:43], v1 offset:2048
    buffer_load_dword v52, v53, s[20:23], s44 offen sc1
    v_mfma_f32_16x16x32_bf16 a[96:99], v[184:187], v[28:31], a[96:99]
    v_exp_f32 v19, v111
    v_mul_f32_e64 v50, -v50, v48
    v_mfma_f32_16x16x32_bf16 a[144:147], v[180:183], v[24:27], a[144:147]
    ds_read_b128 v[44:47], v1 offset:14336
    v_cvt_pk_bf16_f32 v78, v16, v17
    v_mfma_f32_16x16x32_bf16 a[144:147], v[188:191], v[28:31], a[144:147]
    s_waitcnt lgkmcnt(2)
    v_mul_f32_e64 v51, -v51, v49
    v_add_f32 v8, v8, v18
    v_cvt_f32_i32 v240, v240
    v_mfma_f32_16x16x32_bf16 a[100:103], v[176:179], v[32:35], a[100:103]
    s_mov_b32 m0, s56
    ds_read_b128 v[24:27], v1 offset:3072
    v_add_f32 v8, v8, v19
    v_mfma_f32_16x16x32_bf16 a[100:103], v[184:187], v[36:39], a[100:103]
    s_waitcnt vmcnt(15)
    buffer_load_dwordx4 v4, s[4:7], s27 offen offset:0 sc1 lds
    v_cvt_pk_bf16_f32 v79, v18, v19
    v_mfma_f32_16x16x32_bf16 a[148:151], v[180:183], v[32:35], a[148:151]
    ds_read_b128 v[28:31], v1 offset:15360
    v_cvt_f32_i32 v244, v244
    v_mfma_f32_16x16x32_bf16 a[148:151], v[188:191], v[36:39], a[148:151]
    s_waitcnt lgkmcnt(2)
    v_exp_f32 v16, v80
    v_fma_f32 v240, v240, v48, v50
    v_mfma_f32_16x16x32_bf16 a[104:107], v[176:179], v[40:43], a[104:107]
    ds_read_b128 v[32:35], v1 offset:4096
    v_fma_f32 v244, v244, v49, v51
    v_mfma_f32_16x16x32_bf16 a[104:107], v[184:187], v[44:47], a[104:107]
    s_waitcnt vmcnt(14)
    buffer_load_dwordx4 v4, s[4:7], s27 offen offset:1024 sc1 lds
    v_cvt_f32_i32 v241, v241
    v_mfma_f32_16x16x32_bf16 a[152:155], v[180:183], v[40:43], a[152:155]
    ds_read_b128 v[36:39], v1 offset:16384
    v_cvt_f32_i32 v245, v245
    v_mfma_f32_16x16x32_bf16 a[152:155], v[188:191], v[44:47], a[152:155]
    s_waitcnt lgkmcnt(2)
    v_exp_f32 v17, v81
    v_fma_f32 v241, v241, v48, v50
    v_mfma_f32_16x16x32_bf16 a[108:111], v[176:179], v[24:27], a[108:111]
    ds_read_b128 v[40:43], v1 offset:5120
    v_fma_f32 v245, v245, v49, v51
    v_mfma_f32_16x16x32_bf16 a[108:111], v[184:187], v[28:31], a[108:111]
    s_waitcnt vmcnt(14)
    buffer_load_dwordx4 v4, s[4:7], s27 offen offset:2048 sc1 lds
    v_cvt_f32_i32 v242, v242
    v_mfma_f32_16x16x32_bf16 a[156:159], v[180:183], v[24:27], a[156:159]
    s_add_u32 s27, s27, 24576
    ds_read_b128 v[44:47], v1 offset:17408
    v_cvt_f32_i32 v246, v246
    v_mfma_f32_16x16x32_bf16 a[156:159], v[188:191], v[28:31], a[156:159]
    s_waitcnt lgkmcnt(2)
    v_exp_f32 v18, v82
    v_add_f32 v5, v5, v16
    v_mfma_f32_16x16x32_bf16 a[112:115], v[176:179], v[32:35], a[112:115]
    s_sub_u32 s58, s27, 196608
    ds_read_b128 v[24:27], v1 offset:6144
    v_add_f32 v5, v5, v17
    v_mfma_f32_16x16x32_bf16 a[112:115], v[184:187], v[36:39], a[112:115]
    v_exp_f32 v19, v83
    v_cvt_pk_bf16_f32 v80, v16, v17
    v_mfma_f32_16x16x32_bf16 a[160:163], v[180:183], v[32:35], a[160:163]
    s_min_u32 s27, s27, s58
    ds_read_b128 v[28:31], v1 offset:18432
    v_fma_f32 v242, v242, v48, v50
    v_mfma_f32_16x16x32_bf16 a[160:163], v[188:191], v[36:39], a[160:163]
    s_waitcnt lgkmcnt(2)
    v_exp_f32 v16, v112
    v_add_f32 v5, v5, v18
    v_mfma_f32_16x16x32_bf16 a[116:119], v[176:179], v[40:43], a[116:119]
    s_add_u32 s56, s56, 12288
    ds_read_b128 v[32:35], v1 offset:7168
    v_add_f32 v5, v5, v19
    v_mfma_f32_16x16x32_bf16 a[116:119], v[184:187], v[44:47], a[116:119]
    v_exp_f32 v17, v113
    v_cvt_pk_bf16_f32 v81, v18, v19
    v_mfma_f32_16x16x32_bf16 a[164:167], v[180:183], v[40:43], a[164:167]
    ds_read_b128 v[36:39], v1 offset:19456
    v_add_u32 v2, s3, v2
    v_add_u32 v3, s3, v3
    v_mfma_f32_16x16x32_bf16 a[164:167], v[188:191], v[44:47], a[164:167]
    s_waitcnt lgkmcnt(2)
    v_exp_f32 v18, v114
    v_fma_f32 v246, v246, v49, v51
    v_mfma_f32_16x16x32_bf16 a[120:123], v[176:179], v[24:27], a[120:123]
    s_mov_b32 m0, s56
    ds_read_b128 v[40:43], v1 offset:8192
    v_add_f32 v5, v5, v16
    v_mfma_f32_16x16x32_bf16 a[120:123], v[184:187], v[28:31], a[120:123]
    s_waitcnt vmcnt(14)
    buffer_load_dwordx4 v4, s[4:7], s27 offen offset:0 sc1 lds
    v_add_f32 v5, v5, v17
    v_mfma_f32_16x16x32_bf16 a[168:171], v[180:183], v[24:27], a[168:171]
    ds_read_b128 v[44:47], v1 offset:20480
    v_lshlrev_b32 v48, 16, v61
    v_mfma_f32_16x16x32_bf16 a[168:171], v[188:191], v[28:31], a[168:171]
    s_waitcnt lgkmcnt(2)
    v_exp_f32 v19, v115
    v_and_b32 v49, s97, v61
    v_mfma_f32_16x16x32_bf16 a[124:127], v[176:179], v[32:35], a[124:127]
    ds_read_b128 v[24:27], v1 offset:9216
    v_cvt_pk_bf16_f32 v82, v16, v17
    v_mfma_f32_16x16x32_bf16 a[124:127], v[184:187], v[36:39], a[124:127]
    s_waitcnt vmcnt(14)
    buffer_load_dwordx4 v4, s[4:7], s27 offen offset:1024 sc1 lds
    v_lshlrev_b32 v50, 16, v63
    v_mfma_f32_16x16x32_bf16 a[172:175], v[180:183], v[32:35], a[172:175]
    ds_read_b128 v[28:31], v1 offset:21504
    v_and_b32 v51, s97, v63
    v_mfma_f32_16x16x32_bf16 a[172:175], v[188:191], v[36:39], a[172:175]
    s_waitcnt lgkmcnt(2)
    v_exp_f32 v16, v84
    v_add_f32 v5, v5, v18
    v_mfma_f32_16x16x32_bf16 a[128:131], v[176:179], v[40:43], a[128:131]
    ds_read_b128 v[32:35], v1 offset:10240
    v_add_f32 v5, v5, v19
    v_mfma_f32_16x16x32_bf16 a[128:131], v[184:187], v[44:47], a[128:131]
    s_waitcnt vmcnt(14)
    buffer_load_dwordx4 v4, s[4:7], s27 offen offset:2048 sc1 lds
    v_mul_f32_e64 v50, -v50, v48
    v_mfma_f32_16x16x32_bf16 a[176:179], v[180:183], v[40:43], a[176:179]
    ds_read_b128 v[36:39], v1 offset:22528
    v_mul_f32_e64 v51, -v51, v49
    v_mfma_f32_16x16x32_bf16 a[176:179], v[188:191], v[44:47], a[176:179]
    s_waitcnt lgkmcnt(2)
    v_exp_f32 v17, v85
    v_cvt_pk_bf16_f32 v83, v18, v19
    v_mfma_f32_16x16x32_bf16 a[132:135], v[176:179], v[24:27], a[132:135]
    ds_read_b128 v[40:43], v1 offset:11264
    v_cvt_f32_i32 v248, v248
    v_mfma_f32_16x16x32_bf16 a[132:135], v[184:187], v[28:31], a[132:135]
    s_waitcnt vmcnt(19)
    v_exp_f32 v18, v86
    v_add_f32 v6, v6, v16
    v_mfma_f32_16x16x32_bf16 a[180:183], v[180:183], v[24:27], a[180:183]
    s_mov_b32 s27, 208896
    ds_read_b128 v[44:47], v1 offset:23552
    v_cvt_f32_i32 v252, v252
    v_mfma_f32_16x16x32_bf16 a[180:183], v[188:191], v[28:31], a[180:183]
    s_waitcnt lgkmcnt(2)
    s_barrier
    v_add_f32 v6, v6, v17
    v_mfma_f32_16x16x32_bf16 a[136:139], v[176:179], v[32:35], a[136:139]
    s_add_u32 s56, s56, 36864
    ds_read_b128 v[24:27], v2 offset:0
    v_fma_f32 v248, v248, v48, v50
    v_mfma_f32_16x16x32_bf16 a[136:139], v[184:187], v[36:39], a[136:139]
    v_exp_f32 v19, v87
    v_cvt_pk_bf16_f32 v84, v16, v17
    v_mfma_f32_16x16x32_bf16 a[184:187], v[180:183], v[32:35], a[184:187]
    s_sub_u32 s58, s56, 147456
    ds_read_b128 v[28:31], v3 offset:0
    v_fma_f32 v252, v252, v49, v51
    v_mfma_f32_16x16x32_bf16 a[184:187], v[188:191], v[36:39], a[184:187]
    s_waitcnt lgkmcnt(2)
    v_exp_f32 v16, v116
    v_cvt_f32_i32 v249, v249
    v_mfma_f32_16x16x32_bf16 a[140:143], v[176:179], v[40:43], a[140:143]
    s_nop 0
    ds_read_b128 v[32:35], v2 offset:6144
    v_add_f32 v6, v6, v18
    v_mfma_f32_16x16x32_bf16 a[140:143], v[184:187], v[44:47], a[140:143]
    s_min_u32 s56, s56, s58
    v_add_f32 v6, v6, v19
    v_cvt_f32_i32 v253, v253
    v_fma_f32 v249, v249, v48, v50
    v_mfma_f32_16x16x32_bf16 a[188:191], v[180:183], v[40:43], a[188:191]
    s_waitcnt lgkmcnt(1)
    ds_read_b128 v[36:39], v3 offset:6144
    v_exp_f32 v17, v117
    v_cvt_pk_bf16_f32 v85, v18, v19
    v_fma_f32 v253, v253, v49, v51
    v_exp_f32 v18, v118
    v_cvt_f32_i32 v250, v250
    v_cvt_f32_i32 v254, v254
    v_add_f32 v6, v6, v16
    v_fma_f32 v250, v250, v48, v50
    v_add_f32 v6, v6, v17
    v_fma_f32 v254, v254, v49, v51
    v_exp_f32 v19, v119
    v_cvt_pk_bf16_f32 v146, v240, v244
    v_cvt_pk_bf16_f32 v150, v241, v245
    v_cvt_pk_bf16_f32 v86, v16, v17
    v_cvt_pk_bf16_f32 v147, v248, v252
    v_add_f32 v6, v6, v18
    v_cvt_pk_bf16_f32 v151, v249, v253
    v_add_f32 v6, v6, v19
    v_cvt_pk_bf16_f32 v154, v242, v246
    v_cvt_pk_bf16_f32 v87, v18, v19
    v_cvt_pk_bf16_f32 v155, v250, v254
    v_mfma_f32_16x16x32_bf16 a[188:191], v[188:191], v[44:47], a[188:191]
    s_branch L_join
.p2align 6
L_loop:
    v_mfma_f32_16x16x32_bf16 v[160:163], v[24:27], a[192:195], v[128:131]
    s_mov_b32 m0, s56
    ds_read_b128 v[40:43], v2 offset:128
    v_cvt_pk_bf16_f32 v227, v242, v243
    v_mfma_f32_16x16x32_bf16 v[160:163], v[28:31], a[196:199], v[160:163]
    buffer_load_dwordx4 v4, s[4:7], s27 offen offset:0 sc1 lds
    v_mfma_f32_16x16x32_bf16 v[164:167], v[24:27], a[216:219], v[132:135]
    v_exp_f32 v16, v88
    v_mfma_f32_16x16x32_bf16 v[164:167], v[28:31], a[220:223], v[164:167]
    v_exp_f32 v17, v89
    v_mfma_f32_16x16x32_bf16 v[168:171], v[24:27], a[240:243], v[136:139]
    ds_read_b128 v[44:47], v3 offset:128
    v_cvt_f32_i32 v246, v246
    v_mfma_f32_16x16x32_bf16 v[168:171], v[28:31], a[244:247], v[168:171]
    v_exp_f32 v18, v90
    v_mfma_f32_16x16x32_bf16 v[172:175], v[24:27], v[200:203], v[140:143]
    v_cvt_f32_i32 v247, v247
    v_add_f32 v7, v7, v16
    v_mfma_f32_16x16x32_bf16 v[172:175], v[28:31], v[204:207], v[172:175]
    s_waitcnt lgkmcnt(2)
    v_add_f32 v7, v7, v17
    v_fma_f32 v246, v246, v48, v50
    v_mfma_f32_16x16x32_bf16 v[96:99], v[32:35], a[192:195], v[128:131]
    ds_read_b128 v[24:27], v2 offset:6272
    v_fma_f32 v247, v247, v49, v51
    v_mfma_f32_16x16x32_bf16 v[96:99], v[36:39], a[196:199], v[96:99]
    buffer_load_dwordx4 v4, s[4:7], s27 offen offset:1024 sc1 lds
    v_mfma_f32_16x16x32_bf16 v[100:103], v[32:35], a[216:219], v[132:135]
    v_exp_f32 v19, v91
    v_mfma_f32_16x16x32_bf16 v[100:103], v[36:39], a[220:223], v[100:103]
    v_cvt_pk_bf16_f32 v88, v16, v17
    v_cvt_pk_bf16_f32 v231, v246, v247
    v_mfma_f32_16x16x32_bf16 v[104:107], v[32:35], a[240:243], v[136:139]
    ds_read_b128 v[28:31], v3 offset:6272
    v_cvt_f32_i32 v250, v250
    v_mfma_f32_16x16x32_bf16 v[104:107], v[36:39], a[244:247], v[104:107]
    v_exp_f32 v16, v120
    v_mfma_f32_16x16x32_bf16 v[108:111], v[32:35], v[200:203], v[140:143]
    v_add_f32 v7, v7, v18
    v_add_f32 v7, v7, v19
    v_mfma_f32_16x16x32_bf16 v[108:111], v[36:39], v[204:207], v[108:111]
    s_waitcnt lgkmcnt(2)
    v_exp_f32 v17, v121
    v_mfma_f32_16x16x32_bf16 v[160:163], v[40:43], a[200:203], v[160:163]
    ds_read_b128 v[32:35], v2 offset:256
    v_cvt_f32_i32 v251, v251
    v_mfma_f32_16x16x32_bf16 v[160:163], v[44:47], a[204:207], v[160:163]
    v_cvt_pk_bf16_f32 v89, v18, v19
    v_fma_f32 v250, v250, v48, v50
    v_mfma_f32_16x16x32_bf16 v[164:167], v[40:43], a[224:227], v[164:167]
    v_exp_f32 v18, v122
    v_mfma_f32_16x16x32_bf16 v[164:167], v[44:47], a[228:231], v[164:167]
    buffer_load_dwordx4 v4, s[4:7], s27 offen offset:2048 sc1 lds
    v_mfma_f32_16x16x32_bf16 v[168:171], v[40:43], a[248:251], v[168:171]
    ds_read_b128 v[36:39], v3 offset:256
    v_fma_f32 v251, v251, v49, v51
    v_mfma_f32_16x16x32_bf16 v[168:171], v[44:47], a[252:255], v[168:171]
    v_add_f32 v7, v7, v16
    v_add_f32 v7, v7, v17
    v_mfma_f32_16x16x32_bf16 v[172:175], v[40:43], v[208:211], v[172:175]
    v_cvt_pk_bf16_f32 v235, v250, v251
    v_cvt_f32_i32 v254, v254
    v_mfma_f32_16x16x32_bf16 v[172:175], v[44:47], v[212:215], v[172:175]
    s_waitcnt lgkmcnt(2)
    v_exp_f32 v19, v123
    v_mfma_f32_16x16x32_bf16 v[96:99], v[24:27], a[200:203], v[96:99]
    ds_read_b128 v[40:43], v2 offset:6400
    v_cvt_pk_bf16_f32 v90, v16, v17
    v_mfma_f32_16x16x32_bf16 v[96:99], v[28:31], a[204:207], v[96:99]
    s_add_u32 s27, s27, 24576
    v_exp_f32 v16, v92
    v_mfma_f32_16x16x32_bf16 v[100:103], v[24:27], a[224:227], v[100:103]
    v_cvt_f32_i32 v255, v255
    v_add_f32 v7, v7, v18
    v_mfma_f32_16x16x32_bf16 v[100:103], v[28:31], a[228:231], v[100:103]
    v_fma_f32 v254, v254, v48, v50
    v_add_f32 v7, v7, v19
    v_mfma_f32_16x16x32_bf16 v[104:107], v[24:27], a[248:251], v[104:107]
    ds_read_b128 v[44:47], v3 offset:6400
    v_fma_f32 v255, v255, v49, v51
    v_mfma_f32_16x16x32_bf16 v[104:107], v[28:31], a[252:255], v[104:107]
    v_exp_f32 v17, v93
    v_mfma_f32_16x16x32_bf16 v[108:111], v[24:27], v[208:211], v[108:111]
    s_add_u32 s29, s30, 49152
    v_cvt_pk_bf16_f32 v239, v254, v255
    v_cvt_pk_bf16_f32 v91, v18, v19
    v_mfma_f32_16x16x32_bf16 v[108:111], v[28:31], v[212:215], v[108:111]
    s_waitcnt lgkmcnt(2)
    v_exp_f32 v18, v94
    v_mfma_f32_16x16x32_bf16 v[160:163], v[32:35], a[208:211], v[160:163]
    s_waitcnt vmcnt(11)
    ds_read_b128 v[24:27], v2 offset:12288
    v_add_f32 v8, v8, v16
    v_mfma_f32_16x16x32_bf16 v[160:163], v[36:39], a[212:215], v[160:163]
    s_sub_u32 s3, s29, 147456
    buffer_load_dwordx2 v[60:61], off, s[80:83], s37 offset:8
    v_mfma_f32_16x16x32_bf16 v[164:167], v[32:35], a[232:235], v[164:167]
L_iw3:
L_pg3:
    s_cbranch_execz L_pg7
    s_add_u32 s56, s56, 12288
    v_add_f32 v8, v8, v17
    v_lshlrev_b32 v48, 16, v56
    v_mfma_f32_16x16x32_bf16 v[164:167], v[36:39], a[236:239], v[164:167]
    s_min_u32 s29, s29, s3
    v_exp_f32 v19, v95
    v_mfma_f32_16x16x32_bf16 v[168:171], v[32:35], v[192:195], v[168:171]
    s_mov_b32 m0, s56
    ds_read_b128 v[28:31], v3 offset:12288
    v_cvt_pk_bf16_f32 v92, v16, v17
    v_mfma_f32_16x16x32_bf16 v[168:171], v[36:39], v[196:199], v[168:171]
    buffer_load_dwordx2 v[62:63], off, s[84:87], s37 offset:8
    v_mfma_f32_16x16x32_bf16 v[172:175], v[32:35], v[216:219], v[172:175]
    v_exp_f32 v16, v124
    v_mfma_f32_16x16x32_bf16 v[172:175], v[36:39], v[220:223], v[172:175]
    s_waitcnt lgkmcnt(2)
    v_add_f32 v8, v8, v18
    v_add_f32 v8, v8, v19
    v_mfma_f32_16x16x32_bf16 v[96:99], v[40:43], a[208:211], v[96:99]
    ds_read_b128 v[32:35], v2 offset:18432
    v_and_b32 v49, s97, v56
    v_mfma_f32_16x16x32_bf16 v[96:99], v[44:47], a[212:215], v[96:99]
    s_sub_u32 s3, s29, s30
    v_exp_f32 v17, v125
    v_mfma_f32_16x16x32_bf16 v[100:103], v[40:43], a[232:235], v[100:103]
    v_cvt_pk_bf16_f32 v93, v18, v19
    v_lshlrev_b32 v50, 16, v58
    v_mfma_f32_16x16x32_bf16 v[100:103], v[44:47], a[236:239], v[100:103]
    buffer_load_dwordx4 v4, s[4:7], s27 offen offset:0 sc1 lds
    v_mfma_f32_16x16x32_bf16 v[104:107], v[40:43], v[192:195], v[104:107]
    ds_read_b128 v[36:39], v3 offset:18432
    v_mfma_f32_16x16x32_bf16 v[104:107], v[44:47], v[196:199], v[104:107]
    v_exp_f32 v18, v126
    v_mfma_f32_16x16x32_bf16 v[108:111], v[40:43], v[216:219], v[108:111]
    v_add_f32 v8, v8, v16
    v_add_f32 v8, v8, v17
    v_mfma_f32_16x16x32_bf16 v[108:111], v[44:47], v[220:223], v[108:111]
    s_waitcnt lgkmcnt(2)
    buffer_load_dwordx3 v[240:242], v12, s[68:71], s16 offen offset:0 nt
    v_mfma_f32_16x16x32_bf16 v[176:179], v[24:27], a[192:195], v[128:131]
    ds_read_b128 v[40:43], v2 offset:12416
    v_mfma_f32_16x16x32_bf16 v[176:179], v[28:31], a[196:199], v[176:179]
    v_exp_f32 v19, v127
    v_cvt_pk_bf16_f32 v94, v16, v17
    v_mfma_f32_16x16x32_bf16 v[180:183], v[24:27], a[216:219], v[132:135]
    s_mov_b32 s30, s29
    v_add_f32 v8, v8, v18
    v_add_f32 v8, v8, v19
    v_mfma_f32_16x16x32_bf16 v[180:183], v[28:31], a[220:223], v[180:183]
    buffer_load_dwordx4 v4, s[4:7], s27 offen offset:1024 sc1 lds
    v_mfma_f32_16x16x32_bf16 v[184:187], v[24:27], a[240:243], v[136:139]
    ds_read_b128 v[44:47], v3 offset:12416
    v_cvt_pk_bf16_f32 v95, v18, v19
    v_mfma_f32_16x16x32_bf16 v[184:187], v[28:31], a[244:247], v[184:187]
    v_exp_f32 v16, v160
    v_mfma_f32_16x16x32_bf16 v[188:191], v[24:27], v[200:203], v[140:143]
    v_exp_f32 v17, v161
    v_mfma_f32_16x16x32_bf16 v[188:191], v[28:31], v[204:207], v[188:191]
    s_waitcnt lgkmcnt(2)
    buffer_load_dwordx3 v[244:246], v12, s[68:71], s16 offen offset:768 nt
    v_mfma_f32_16x16x32_bf16 v[112:115], v[32:35], a[192:195], v[128:131]
    ds_read_b128 v[24:27], v2 offset:18560
    v_and_b32 v51, s97, v58
    v_mfma_f32_16x16x32_bf16 v[112:115], v[36:39], a[196:199], v[112:115]
    v_exp_f32 v18, v162
    v_mfma_f32_16x16x32_bf16 v[116:119], v[32:35], a[216:219], v[132:135]
    v_add_f32 v5, v5, v16
    v_add_f32 v5, v5, v17
    v_mfma_f32_16x16x32_bf16 v[116:119], v[36:39], a[220:223], v[116:119]
    v_exp_f32 v19, v163
    v_mfma_f32_16x16x32_bf16 v[120:123], v[32:35], a[240:243], v[136:139]
    ds_read_b128 v[28:31], v3 offset:18560
    v_cvt_pk_bf16_f32 v160, v16, v17
    v_mfma_f32_16x16x32_bf16 v[120:123], v[36:39], a[244:247], v[120:123]
    buffer_load_dwordx3 v[248:250], v12, s[68:71], s16 offen offset:1536 nt
    v_mfma_f32_16x16x32_bf16 v[124:127], v[32:35], v[200:203], v[140:143]
    v_exp_f32 v16, v96
    v_mfma_f32_16x16x32_bf16 v[124:127], v[36:39], v[204:207], v[124:127]
    s_waitcnt lgkmcnt(2)
    v_add_f32 v5, v5, v18
    v_add_f32 v5, v5, v19
    v_mfma_f32_16x16x32_bf16 v[176:179], v[40:43], a[200:203], v[176:179]
    ds_read_b128 v[32:35], v2 offset:12544
    v_mul_f32_e64 v50, -v50, v48
    v_mfma_f32_16x16x32_bf16 v[176:179], v[44:47], a[204:207], v[176:179]
    buffer_load_dwordx4 v4, s[4:7], s27 offen offset:2048 sc1 lds
    v_mfma_f32_16x16x32_bf16 v[180:183], v[40:43], a[224:227], v[180:183]
    v_exp_f32 v17, v97
    v_mfma_f32_16x16x32_bf16 v[180:183], v[44:47], a[228:231], v[180:183]
    v_cvt_pk_bf16_f32 v161, v18, v19
    v_add_u32 v1, s3, v1
    v_mfma_f32_16x16x32_bf16 v[184:187], v[40:43], a[248:251], v[184:187]
    ds_read_b128 v[36:39], v3 offset:12544
    v_mul_f32_e64 v51, -v51, v49
    v_mfma_f32_16x16x32_bf16 v[184:187], v[44:47], a[252:255], v[184:187]
    buffer_load_dwordx3 v[252:254], v12, s[68:71], s16 offen offset:2304 nt
    v_mfma_f32_16x16x32_bf16 v[188:191], v[40:43], v[208:211], v[188:191]
    v_exp_f32 v18, v98
    v_mfma_f32_16x16x32_bf16 v[188:191], v[44:47], v[212:215], v[188:191]
    s_waitcnt lgkmcnt(2)
    v_add_f32 v5, v5, v16
    v_add_f32 v5, v5, v17
    v_mfma_f32_16x16x32_bf16 v[112:115], v[24:27], a[200:203], v[112:115]
    ds_read_b128 v[40:43], v2 offset:18688
    v_cvt_f32_i32 v144, v144
    v_mfma_f32_16x16x32_bf16 v[112:115], v[28:31], a[204:207], v[112:115]
    v_exp_f32 v19, v99
    v_cvt_pk_bf16_f32 v162, v16, v17
    v_mfma_f32_16x16x32_bf16 v[116:119], v[24:27], a[224:227], v[116:119]
    v_exp_f32 v16, v164
    v_mfma_f32_16x16x32_bf16 v[116:119], v[28:31], a[228:231], v[116:119]
    s_add_u32 s27, s27, 24576
    v_add_f32 v5, v5, v18
    v_add_f32 v5, v5, v19
    v_mfma_f32_16x16x32_bf16 v[120:123], v[24:27], a[248:251], v[120:123]
    s_add_u32 s56, s56, 36864
    ds_read_b128 v[44:47], v3 offset:18688
    s_sub_u32 s58, s56, 147456
    v_mfma_f32_16x16x32_bf16 v[120:123], v[28:31], a[252:255], v[120:123]
    s_waitcnt lgkmcnt(2)
    v_exp_f32 v17, v165
    v_mfma_f32_16x16x32_bf16 v[124:127], v[24:27], v[208:211], v[124:127]
    s_waitcnt vmcnt(12)
    v_cvt_pk_bf16_f32 v163, v18, v19
    v_cvt_f32_i32 v148, v148
    v_mfma_f32_16x16x32_bf16 v[124:127], v[28:31], v[212:215], v[124:127]
    s_barrier
    s_min_u32 s56, s56, s58
    v_mfma_f32_16x16x32_bf16 v[176:179], v[32:35], a[208:211], v[176:179]
    ds_read_b128 v[24:27], v1 offset:0
    v_mfma_f32_16x16x32_bf16 v[176:179], v[36:39], a[212:215], v[176:179]
    v_exp_f32 v18, v166
    v_mfma_f32_16x16x32_bf16 v[180:183], v[32:35], a[232:235], v[180:183]
    v_add_f32 v6, v6, v16
    v_add_f32 v6, v6, v17
    v_mfma_f32_16x16x32_bf16 v[180:183], v[36:39], a[236:239], v[180:183]
    v_exp_f32 v19, v167
    v_mfma_f32_16x16x32_bf16 v[184:187], v[32:35], v[192:195], v[184:187]
    ds_read_b128 v[28:31], v1 offset:12288
    v_cvt_pk_bf16_f32 v164, v16, v17
    v_mfma_f32_16x16x32_bf16 v[184:187], v[36:39], v[196:199], v[184:187]
    v_exp_f32 v16, v100
    v_mfma_f32_16x16x32_bf16 v[188:191], v[32:35], v[216:219], v[188:191]
    v_add_f32 v6, v6, v18
    v_add_f32 v6, v6, v19
    v_mfma_f32_16x16x32_bf16 v[188:191], v[36:39], v[220:223], v[188:191]
    s_waitcnt lgkmcnt(2)
    v_exp_f32 v17, v101
    v_mfma_f32_16x16x32_bf16 v[112:115], v[40:43], a[208:211], v[112:115]
    ds_read_b128 v[32:35], v1 offset:1024
    v_cvt_pk_bf16_f32 v165, v18, v19
    v_mfma_f32_16x16x32_bf16 v[112:115], v[44:47], a[212:215], v[112:115]
    v_exp_f32 v18, v102
    v_mfma_f32_16x16x32_bf16 v[116:119], v[40:43], a[232:235], v[116:119]
    v_add_f32 v6, v6, v16
    v_add_f32 v6, v6, v17
    v_mfma_f32_16x16x32_bf16 v[116:119], v[44:47], a[236:239], v[116:119]
    v_exp_f32 v19, v103
    v_mfma_f32_16x16x32_bf16 v[120:123], v[40:43], v[192:195], v[120:123]
    ds_read_b128 v[36:39], v1 offset:13312
    v_cvt_pk_bf16_f32 v166, v16, v17
    v_mfma_f32_16x16x32_bf16 v[120:123], v[44:47], v[196:199], v[120:123]
    v_add_f32 v6, v6, v18
    v_add_f32 v6, v6, v19
    v_mfma_f32_16x16x32_bf16 v[124:127], v[40:43], v[216:219], v[124:127]
    v_cvt_pk_bf16_f32 v167, v18, v19
    v_mfma_f32_16x16x32_bf16 v[124:127], v[44:47], v[220:223], v[124:127]
    s_waitcnt lgkmcnt(2)
    v_mfma_f32_16x16x32_bf16 a[0:3], v[64:67], v[24:27], a[0:3]
    ds_read_b128 v[40:43], v1 offset:2048
    v_fma_f32 v144, v144, v48, v50
    v_mfma_f32_16x16x32_bf16 a[0:3], v[80:83], v[28:31], a[0:3]
    buffer_store_dwordx4 v[224:227], v11, s[4:7], s33 offen offset:0 sc1
    v_mfma_f32_16x16x32_bf16 a[48:51], v[68:71], v[24:27], a[48:51]
    v_exp_f32 v16, v168
    v_mfma_f32_16x16x32_bf16 a[48:51], v[84:87], v[28:31], a[48:51]
    v_exp_f32 v17, v169
    v_mfma_f32_16x16x32_bf16 a[96:99], v[72:75], v[24:27], a[96:99]
    ds_read_b128 v[44:47], v1 offset:14336
    v_xor_b32 v55, 16, v11
    v_mfma_f32_16x16x32_bf16 a[96:99], v[88:91], v[28:31], a[96:99]
    v_exp_f32 v18, v170
    v_mfma_f32_16x16x32_bf16 a[144:147], v[76:79], v[24:27], a[144:147]
    v_add_f32 v7, v7, v16
    v_add_f32 v7, v7, v17
    v_mfma_f32_16x16x32_bf16 a[144:147], v[92:95], v[28:31], a[144:147]
    s_waitcnt lgkmcnt(2)
    v_exp_f32 v19, v171
    v_mfma_f32_16x16x32_bf16 a[4:7], v[64:67], v[32:35], a[4:7]
    ds_read_b128 v[24:27], v1 offset:3072
    v_fma_f32 v148, v148, v49, v51
    v_mfma_f32_16x16x32_bf16 a[4:7], v[80:83], v[36:39], a[4:7]
    buffer_store_dwordx4 v[228:231], v55, s[4:7], s33 offen offset:768 sc1
    v_mfma_f32_16x16x32_bf16 a[52:55], v[68:71], v[32:35], a[52:55]
    v_cvt_pk_bf16_f32 v168, v16, v17
    v_cvt_f32_i32 v145, v145
    v_mfma_f32_16x16x32_bf16 a[52:55], v[84:87], v[36:39], a[52:55]
    v_exp_f32 v16, v104
    v_mfma_f32_16x16x32_bf16 a[100:103], v[72:75], v[32:35], a[100:103]
    ds_read_b128 v[28:31], v1 offset:15360
    v_add_f32 v7, v7, v18
    v_mfma_f32_16x16x32_bf16 a[100:103], v[88:91], v[36:39], a[100:103]
    v_add_f32 v7, v7, v19
    v_xor_b32 v54, 32, v11
    v_mfma_f32_16x16x32_bf16 a[148:151], v[76:79], v[32:35], a[148:151]
    v_exp_f32 v17, v105
    v_mfma_f32_16x16x32_bf16 a[148:151], v[92:95], v[36:39], a[148:151]
    s_waitcnt lgkmcnt(2)
    v_cvt_pk_bf16_f32 v169, v18, v19
    v_cvt_f32_i32 v149, v149
    v_mfma_f32_16x16x32_bf16 a[8:11], v[64:67], v[40:43], a[8:11]
    ds_read_b128 v[32:35], v1 offset:4096
    v_fma_f32 v145, v145, v48, v50
    v_mfma_f32_16x16x32_bf16 a[8:11], v[80:83], v[44:47], a[8:11]
    buffer_store_dwordx4 v[232:235], v54, s[4:7], s33 offen offset:1536 sc1
    v_mfma_f32_16x16x32_bf16 a[56:59], v[68:71], v[40:43], a[56:59]
    v_exp_f32 v18, v106
    v_mfma_f32_16x16x32_bf16 a[56:59], v[84:87], v[44:47], a[56:59]
    v_add_f32 v7, v7, v16
    v_add_f32 v7, v7, v17
    v_mfma_f32_16x16x32_bf16 a[104:107], v[72:75], v[40:43], a[104:107]
    ds_read_b128 v[36:39], v1 offset:16384
    v_xor_b32 v55, 48, v11
    v_mfma_f32_16x16x32_bf16 a[104:107], v[88:91], v[44:47], a[104:107]
    v_exp_f32 v19, v107
    v_mfma_f32_16x16x32_bf16 a[152:155], v[76:79], v[40:43], a[152:155]
    v_cvt_pk_bf16_f32 v170, v16, v17
    v_fma_f32 v149, v149, v49, v51
    v_mfma_f32_16x16x32_bf16 a[152:155], v[92:95], v[44:47], a[152:155]
    s_waitcnt lgkmcnt(2)
    v_exp_f32 v16, v172
    v_mfma_f32_16x16x32_bf16 a[12:15], v[64:67], v[24:27], a[12:15]
    ds_read_b128 v[40:43], v1 offset:5120
    v_add_f32 v7, v7, v18
    v_mfma_f32_16x16x32_bf16 a[12:15], v[80:83], v[28:31], a[12:15]
    buffer_store_dwordx4 v[236:239], v55, s[4:7], s33 offen offset:2304 sc1
    v_mfma_f32_16x16x32_bf16 a[60:63], v[68:71], v[24:27], a[60:63]
    v_add_f32 v7, v7, v19
    v_cvt_f32_i32 v146, v146
    v_mfma_f32_16x16x32_bf16 a[60:63], v[84:87], v[28:31], a[60:63]
    v_exp_f32 v17, v173
    v_mfma_f32_16x16x32_bf16 a[108:111], v[72:75], v[24:27], a[108:111]
    ds_read_b128 v[44:47], v1 offset:17408
    v_cvt_pk_bf16_f32 v171, v18, v19
    v_mfma_f32_16x16x32_bf16 a[108:111], v[88:91], v[28:31], a[108:111]
    v_exp_f32 v18, v174
    v_mfma_f32_16x16x32_bf16 a[156:159], v[76:79], v[24:27], a[156:159]
    s_add_u32 s29, s28, 49152
    v_add_f32 v8, v8, v16
    v_add_f32 v8, v8, v17
    v_mfma_f32_16x16x32_bf16 a[156:159], v[92:95], v[28:31], a[156:159]
    s_waitcnt lgkmcnt(2)
    v_exp_f32 v19, v175
    v_mfma_f32_16x16x32_bf16 a[16:19], v[64:67], v[32:35], a[16:19]
    s_sub_u32 s3, s29, 147456
    ds_read_b128 v[24:27], v1 offset:6144
    v_cvt_pk_bf16_f32 v172, v16, v17
    v_mfma_f32_16x16x32_bf16 a[16:19], v[80:83], v[36:39], a[16:19]
    s_mov_b32 m0, s26
    v_exp_f32 v16, v108
    v_mfma_f32_16x16x32_bf16 a[64:67], v[68:71], v[32:35], a[64:67]
    s_min_u32 s29, s29, s3
    v_cvt_f32_i32 v150, v150
    v_add_f32 v8, v8, v18
    v_mfma_f32_16x16x32_bf16 a[64:67], v[84:87], v[36:39], a[64:67]
    buffer_load_dwordx4 v4, s[4:7], s32 offen offset:0 sc1 lds
    v_mfma_f32_16x16x32_bf16 a[112:115], v[72:75], v[32:35], a[112:115]
    ds_read_b128 v[28:31], v1 offset:18432
    v_add_f32 v8, v8, v19
    v_mfma_f32_16x16x32_bf16 a[112:115], v[88:91], v[36:39], a[112:115]
    v_exp_f32 v17, v109
    v_mfma_f32_16x16x32_bf16 a[160:163], v[76:79], v[32:35], a[160:163]
    v_cvt_pk_bf16_f32 v173, v18, v19
    v_fma_f32 v146, v146, v48, v50
    v_mfma_f32_16x16x32_bf16 a[160:163], v[92:95], v[36:39], a[160:163]
    s_waitcnt lgkmcnt(2)
    buffer_load_dwordx4 v4, s[4:7], s32 offen offset:1024 sc1 lds
    v_mfma_f32_16x16x32_bf16 a[20:23], v[64:67], v[40:43], a[20:23]
    s_sub_u32 s3, s29, s28
    ds_read_b128 v[32:35], v1 offset:7168
    v_fma_f32 v150, v150, v49, v51
    v_mfma_f32_16x16x32_bf16 a[20:23], v[80:83], v[44:47], a[20:23]
    v_exp_f32 v18, v110
    v_mfma_f32_16x16x32_bf16 a[68:71], v[68:71], v[40:43], a[68:71]
    v_add_f32 v8, v8, v16
    v_add_f32 v8, v8, v17
    v_mfma_f32_16x16x32_bf16 a[68:71], v[84:87], v[44:47], a[68:71]
    buffer_load_dwordx4 v4, s[4:7], s32 offen offset:2048 sc1 lds
    v_mfma_f32_16x16x32_bf16 a[116:119], v[72:75], v[40:43], a[116:119]
    ds_read_b128 v[36:39], v1 offset:19456
    v_lshlrev_b32 v48, 16, v57
    v_mfma_f32_16x16x32_bf16 a[116:119], v[88:91], v[44:47], a[116:119]
    v_exp_f32 v19, v111
    v_mfma_f32_16x16x32_bf16 a[164:167], v[76:79], v[40:43], a[164:167]
    s_mov_b32 s28, s29
    v_cvt_pk_bf16_f32 v174, v16, v17
    v_add_f32 v8, v8, v18
    v_mfma_f32_16x16x32_bf16 a[164:167], v[92:95], v[44:47], a[164:167]
    s_waitcnt lgkmcnt(2)
    v_add_f32 v8, v8, v19
    v_cvt_pk_bf16_f32 v175, v18, v19
    v_mfma_f32_16x16x32_bf16 a[24:27], v[64:67], v[24:27], a[24:27]
    s_add_u32 s32, s32, 24576
    ds_read_b128 v[40:43], v1 offset:8192
    v_and_b32 v49, s97, v57
    v_mfma_f32_16x16x32_bf16 a[24:27], v[80:83], v[28:31], a[24:27]
    v_exp_f32 v16, v176
    v_mfma_f32_16x16x32_bf16 a[72:75], v[68:71], v[24:27], a[72:75]
    s_add_u32 s26, s26, 12288
    v_exp_f32 v17, v177
    v_mfma_f32_16x16x32_bf16 a[72:75], v[84:87], v[28:31], a[72:75]
    v_exp_f32 v18, v178
    v_mfma_f32_16x16x32_bf16 a[120:123], v[72:75], v[24:27], a[120:123]
    s_mov_b32 m0, s26
    ds_read_b128 v[44:47], v1 offset:20480
    v_add_f32 v5, v5, v16
    v_mfma_f32_16x16x32_bf16 a[120:123], v[88:91], v[28:31], a[120:123]
    v_add_f32 v5, v5, v17
    v_lshlrev_b32 v50, 16, v59
    v_mfma_f32_16x16x32_bf16 a[168:171], v[76:79], v[24:27], a[168:171]
    v_exp_f32 v19, v179
    v_mfma_f32_16x16x32_bf16 a[168:171], v[92:95], v[28:31], a[168:171]
    s_waitcnt lgkmcnt(2)
    v_cvt_pk_bf16_f32 v176, v16, v17
    v_and_b32 v51, s97, v59
    v_mfma_f32_16x16x32_bf16 a[28:31], v[64:67], v[32:35], a[28:31]
    ds_read_b128 v[24:27], v1 offset:9216
    v_add_u32 v2, s3, v2
    v_mfma_f32_16x16x32_bf16 a[28:31], v[80:83], v[36:39], a[28:31]
    buffer_load_dwordx4 v4, s[4:7], s32 offen offset:0 sc1 lds
    v_mfma_f32_16x16x32_bf16 a[76:79], v[68:71], v[32:35], a[76:79]
    v_exp_f32 v16, v112
    v_mfma_f32_16x16x32_bf16 a[76:79], v[84:87], v[36:39], a[76:79]
    v_add_f32 v5, v5, v18
    v_add_f32 v5, v5, v19
    v_mfma_f32_16x16x32_bf16 a[124:127], v[72:75], v[32:35], a[124:127]
    ds_read_b128 v[28:31], v1 offset:21504
    v_mul_f32_e64 v50, -v50, v48
    v_mfma_f32_16x16x32_bf16 a[124:127], v[88:91], v[36:39], a[124:127]
    buffer_load_dwordx4 v4, s[4:7], s32 offen offset:1024 sc1 lds
    v_mfma_f32_16x16x32_bf16 a[172:175], v[76:79], v[32:35], a[172:175]
    v_exp_f32 v17, v113
    v_mfma_f32_16x16x32_bf16 a[172:175], v[92:95], v[36:39], a[172:175]
    s_waitcnt lgkmcnt(2)
    v_cvt_pk_bf16_f32 v177, v18, v19
    v_add_u32 v3, s3, v3
    v_mfma_f32_16x16x32_bf16 a[32:35], v[64:67], v[40:43], a[32:35]
    ds_read_b128 v[32:35], v1 offset:10240
    v_mul_f32_e64 v51, -v51, v49
    v_mfma_f32_16x16x32_bf16 a[32:35], v[80:83], v[44:47], a[32:35]
    v_exp_f32 v18, v114
    v_mfma_f32_16x16x32_bf16 a[80:83], v[68:71], v[40:43], a[80:83]
    v_add_f32 v5, v5, v16
    v_add_f32 v5, v5, v17
    v_mfma_f32_16x16x32_bf16 a[80:83], v[84:87], v[44:47], a[80:83]
    buffer_load_dwordx4 v4, s[4:7], s32 offen offset:2048 sc1 lds
    v_mfma_f32_16x16x32_bf16 a[128:131], v[72:75], v[40:43], a[128:131]
    ds_read_b128 v[36:39], v1 offset:22528
    v_mfma_f32_16x16x32_bf16 a[128:131], v[88:91], v[44:47], a[128:131]
    v_exp_f32 v19, v115
    v_mfma_f32_16x16x32_bf16 a[176:179], v[76:79], v[40:43], a[176:179]
    v_cvt_pk_bf16_f32 v178, v16, v17
    v_cvt_f32_i32 v152, v152
    v_mfma_f32_16x16x32_bf16 a[176:179], v[92:95], v[44:47], a[176:179]
    s_waitcnt lgkmcnt(2)
    v_exp_f32 v16, v180
    v_mfma_f32_16x16x32_bf16 a[36:39], v[64:67], v[24:27], a[36:39]
    ds_read_b128 v[40:43], v1 offset:11264
    v_add_f32 v5, v5, v18
    v_mfma_f32_16x16x32_bf16 a[36:39], v[80:83], v[28:31], a[36:39]
    v_add_f32 v5, v5, v19
    v_mfma_f32_16x16x32_bf16 a[84:87], v[68:71], v[24:27], a[84:87]
    v_exp_f32 v17, v181
    v_mfma_f32_16x16x32_bf16 a[84:87], v[84:87], v[28:31], a[84:87]
    s_add_u32 s32, s32, 24576
    v_cvt_pk_bf16_f32 v179, v18, v19
    s_add_u32 s26, s26, 36864
    v_mfma_f32_16x16x32_bf16 a[132:135], v[72:75], v[24:27], a[132:135]
    s_sub_u32 s57, s26, 147456
    ds_read_b128 v[44:47], v1 offset:23552
    v_cvt_f32_i32 v156, v156
    v_mfma_f32_16x16x32_bf16 a[132:135], v[88:91], v[28:31], a[132:135]
    s_waitcnt lgkmcnt(2)
    v_exp_f32 v18, v182
    v_mfma_f32_16x16x32_bf16 a[180:183], v[76:79], v[24:27], a[180:183]
    s_waitcnt vmcnt(6)
    v_add_f32 v6, v6, v16
    v_add_f32 v6, v6, v17
    v_mfma_f32_16x16x32_bf16 a[180:183], v[92:95], v[28:31], a[180:183]
    s_barrier
    v_fma_f32 v152, v152, v48, v50
    v_mfma_f32_16x16x32_bf16 a[40:43], v[64:67], v[32:35], a[40:43]
    s_min_u32 s26, s26, s57
    ds_read_b128 v[24:27], v2 offset:0
    v_add_u32 v0, 1, v0
    v_mfma_f32_16x16x32_bf16 a[40:43], v[80:83], v[36:39], a[40:43]
    buffer_store_dword v0, v13, s[20:23], 0 offen offset:32 sc1
    v_mfma_f32_16x16x32_bf16 a[88:91], v[68:71], v[32:35], a[88:91]
    v_exp_f32 v19, v183
    v_mfma_f32_16x16x32_bf16 a[88:91], v[84:87], v[36:39], a[88:91]
    v_cvt_pk_bf16_f32 v180, v16, v17
    v_fma_f32 v156, v156, v49, v51
    v_mfma_f32_16x16x32_bf16 a[136:139], v[72:75], v[32:35], a[136:139]
    ds_read_b128 v[28:31], v3 offset:0
    v_mfma_f32_16x16x32_bf16 a[136:139], v[88:91], v[36:39], a[136:139]
    v_exp_f32 v16, v116
    v_mfma_f32_16x16x32_bf16 a[184:187], v[76:79], v[32:35], a[184:187]
    v_add_f32 v6, v6, v18
    v_add_f32 v6, v6, v19
    v_mfma_f32_16x16x32_bf16 a[184:187], v[92:95], v[36:39], a[184:187]
    s_waitcnt lgkmcnt(2)
    v_exp_f32 v17, v117
    v_mfma_f32_16x16x32_bf16 a[44:47], v[64:67], v[40:43], a[44:47]
    ds_read_b128 v[32:35], v2 offset:6144
    v_cvt_pk_bf16_f32 v181, v18, v19
    v_mfma_f32_16x16x32_bf16 a[44:47], v[80:83], v[44:47], a[44:47]
    v_exp_f32 v18, v118
    v_mfma_f32_16x16x32_bf16 a[92:95], v[68:71], v[40:43], a[92:95]
    v_add_f32 v6, v6, v16
    v_add_f32 v6, v6, v17
    v_mfma_f32_16x16x32_bf16 a[92:95], v[84:87], v[44:47], a[92:95]
    v_exp_f32 v19, v119
    v_mfma_f32_16x16x32_bf16 a[140:143], v[72:75], v[40:43], a[140:143]
    ds_read_b128 v[36:39], v3 offset:6144
    v_cvt_pk_bf16_f32 v182, v16, v17
    v_mfma_f32_16x16x32_bf16 a[140:143], v[88:91], v[44:47], a[140:143]
    v_add_f32 v6, v6, v18
    v_add_f32 v6, v6, v19
    v_mfma_f32_16x16x32_bf16 a[188:191], v[76:79], v[40:43], a[188:191]
    v_cvt_pk_bf16_f32 v183, v18, v19
    v_mfma_f32_16x16x32_bf16 a[188:191], v[92:95], v[44:47], a[188:191]
    s_waitcnt lgkmcnt(2)
    v_mfma_f32_16x16x32_bf16 v[64:67], v[24:27], a[192:195], v[128:131]
    s_add_u32 s33, s33, 196608
    ds_read_b128 v[40:43], v2 offset:128
    v_cvt_f32_i32 v153, v153
    v_mfma_f32_16x16x32_bf16 v[64:67], v[28:31], a[196:199], v[64:67]
    s_mov_b32 m0, s56
    v_exp_f32 v16, v184
    v_mfma_f32_16x16x32_bf16 v[68:71], v[24:27], a[216:219], v[132:135]
    s_add_u32 s34, s34, 196608
    v_exp_f32 v17, v185
    v_mfma_f32_16x16x32_bf16 v[68:71], v[28:31], a[220:223], v[68:71]
    s_add_u32 s36, s36, 1536
    buffer_load_dwordx4 v4, s[4:7], s27 offen offset:0 sc1 lds
    v_mfma_f32_16x16x32_bf16 v[72:75], v[24:27], a[240:243], v[136:139]
    ds_read_b128 v[44:47], v3 offset:128
    v_cvt_f32_i32 v157, v157
    v_mfma_f32_16x16x32_bf16 v[72:75], v[28:31], a[244:247], v[72:75]
    v_exp_f32 v18, v186
    v_mfma_f32_16x16x32_bf16 v[76:79], v[24:27], v[200:203], v[140:143]
    v_add_f32 v7, v7, v16
    v_add_f32 v7, v7, v17
    v_mfma_f32_16x16x32_bf16 v[76:79], v[28:31], v[204:207], v[76:79]
    s_waitcnt lgkmcnt(2)
    buffer_load_dwordx2 v[56:57], v10, s[72:75], s36 offen offset:0
    v_mfma_f32_16x16x32_bf16 v[96:99], v[32:35], a[192:195], v[128:131]
    ds_read_b128 v[24:27], v2 offset:6272
    v_fma_f32 v153, v153, v48, v50
    v_mfma_f32_16x16x32_bf16 v[96:99], v[36:39], a[196:199], v[96:99]
    v_exp_f32 v19, v187
    v_mfma_f32_16x16x32_bf16 v[100:103], v[32:35], a[216:219], v[132:135]
    v_cvt_pk_bf16_f32 v184, v16, v17
    v_fma_f32 v157, v157, v49, v51
    v_mfma_f32_16x16x32_bf16 v[100:103], v[36:39], a[220:223], v[100:103]
    buffer_load_dwordx4 v4, s[4:7], s27 offen offset:1024 sc1 lds
    v_mfma_f32_16x16x32_bf16 v[104:107], v[32:35], a[240:243], v[136:139]
    ds_read_b128 v[28:31], v3 offset:6272
    v_cvt_f32_i32 v154, v154
    v_mfma_f32_16x16x32_bf16 v[104:107], v[36:39], a[244:247], v[104:107]
    v_exp_f32 v16, v120
    v_mfma_f32_16x16x32_bf16 v[108:111], v[32:35], v[200:203], v[140:143]
    v_add_f32 v7, v7, v18
    v_add_f32 v7, v7, v19
    v_mfma_f32_16x16x32_bf16 v[108:111], v[36:39], v[204:207], v[108:111]
    s_waitcnt lgkmcnt(2)
    buffer_load_dwordx2 v[58:59], v10, s[76:79], s36 offen offset:0
    v_mfma_f32_16x16x32_bf16 v[64:67], v[40:43], a[200:203], v[64:67]
    ds_read_b128 v[32:35], v2 offset:256
    v_cvt_f32_i32 v158, v158
    v_mfma_f32_16x16x32_bf16 v[64:67], v[44:47], a[204:207], v[64:67]
    v_exp_f32 v17, v121
    v_mfma_f32_16x16x32_bf16 v[68:71], v[40:43], a[224:227], v[68:71]
    v_cvt_pk_bf16_f32 v185, v18, v19
    v_fma_f32 v154, v154, v48, v50
    v_mfma_f32_16x16x32_bf16 v[68:71], v[44:47], a[228:231], v[68:71]
    buffer_load_dwordx4 v[224:227], v9, s[64:67], s33 offen offset:0 nt
    v_mfma_f32_16x16x32_bf16 v[72:75], v[40:43], a[248:251], v[72:75]
    ds_read_b128 v[36:39], v3 offset:256
    v_fma_f32 v158, v158, v49, v51
    v_mfma_f32_16x16x32_bf16 v[72:75], v[44:47], a[252:255], v[72:75]
    v_exp_f32 v18, v122
    v_mfma_f32_16x16x32_bf16 v[76:79], v[40:43], v[208:211], v[76:79]
    v_add_f32 v7, v7, v16
    v_add_f32 v7, v7, v17
    v_mfma_f32_16x16x32_bf16 v[76:79], v[44:47], v[212:215], v[76:79]
    s_waitcnt lgkmcnt(2)
    buffer_load_dwordx4 v4, s[4:7], s27 offen offset:2048 sc1 lds
    v_mfma_f32_16x16x32_bf16 v[96:99], v[24:27], a[200:203], v[96:99]
    ds_read_b128 v[40:43], v2 offset:6400
    v_cvt_pk_bf16_f32 v144, v144, v148
    v_mfma_f32_16x16x32_bf16 v[96:99], v[28:31], a[204:207], v[96:99]
    v_exp_f32 v19, v123
    v_cvt_pk_bf16_f32 v186, v16, v17
    v_mfma_f32_16x16x32_bf16 v[100:103], v[24:27], a[224:227], v[100:103]
    v_exp_f32 v16, v188
    v_mfma_f32_16x16x32_bf16 v[100:103], v[28:31], a[228:231], v[100:103]
    buffer_load_dwordx4 v[228:231], v9, s[64:67], s33 offen offset:1536 nt
    v_mfma_f32_16x16x32_bf16 v[104:107], v[24:27], a[248:251], v[104:107]
    ds_read_b128 v[44:47], v3 offset:6400
    v_add_f32 v7, v7, v18
    v_mfma_f32_16x16x32_bf16 v[104:107], v[28:31], a[252:255], v[104:107]
    v_add_f32 v7, v7, v19
    v_cvt_pk_bf16_f32 v148, v145, v149
    v_mfma_f32_16x16x32_bf16 v[108:111], v[24:27], v[208:211], v[108:111]
    s_add_u32 s29, s30, 49152
    v_exp_f32 v17, v189
    v_mfma_f32_16x16x32_bf16 v[108:111], v[28:31], v[212:215], v[108:111]
    s_waitcnt lgkmcnt(2)
    buffer_load_dwordx4 v[232:235], v9, s[64:67], s34 offen offset:0 nt
    v_cvt_pk_bf16_f32 v187, v18, v19
    v_mfma_f32_16x16x32_bf16 v[64:67], v[32:35], a[208:211], v[64:67]
    s_sub_u32 s3, s29, 147456
    ds_read_b128 v[24:27], v2 offset:12288
    s_add_u32 s27, s27, 24576
    v_mfma_f32_16x16x32_bf16 v[64:67], v[36:39], a[212:215], v[64:67]
    s_min_u32 s29, s29, s3
    v_exp_f32 v18, v190
    v_mfma_f32_16x16x32_bf16 v[68:71], v[32:35], a[232:235], v[68:71]
    v_add_f32 v8, v8, v16
    v_add_f32 v8, v8, v17
    v_mfma_f32_16x16x32_bf16 v[68:71], v[36:39], a[236:239], v[68:71]
    buffer_load_dwordx4 v[236:239], v9, s[64:67], s34 offen offset:1536 nt
    v_mfma_f32_16x16x32_bf16 v[72:75], v[32:35], v[192:195], v[72:75]
    s_add_u32 s56, s56, 12288
    ds_read_b128 v[28:31], v3 offset:12288
    v_cvt_pk_bf16_f32 v145, v152, v156
    v_mfma_f32_16x16x32_bf16 v[72:75], v[36:39], v[196:199], v[72:75]
    v_exp_f32 v19, v191
    v_cvt_pk_bf16_f32 v188, v16, v17
    v_mfma_f32_16x16x32_bf16 v[76:79], v[32:35], v[216:219], v[76:79]
    v_exp_f32 v16, v124
    v_mfma_f32_16x16x32_bf16 v[76:79], v[36:39], v[220:223], v[76:79]
    s_waitcnt lgkmcnt(2)
    v_add_f32 v8, v8, v18
    v_add_f32 v8, v8, v19
    v_mfma_f32_16x16x32_bf16 v[96:99], v[40:43], a[208:211], v[96:99]
    ds_read_b128 v[32:35], v2 offset:18432
    v_cvt_pk_bf16_f32 v149, v153, v157
    v_mfma_f32_16x16x32_bf16 v[96:99], v[44:47], a[212:215], v[96:99]
    s_sub_u32 s3, s29, s30
    v_exp_f32 v17, v125
    v_mfma_f32_16x16x32_bf16 v[100:103], v[40:43], a[232:235], v[100:103]
    s_mov_b32 m0, s56
    v_cvt_pk_bf16_f32 v189, v18, v19
    v_cvt_pk_bf16_f32 v152, v146, v150
    v_mfma_f32_16x16x32_bf16 v[100:103], v[44:47], a[236:239], v[100:103]
    v_exp_f32 v18, v126
    v_mfma_f32_16x16x32_bf16 v[104:107], v[40:43], v[192:195], v[104:107]
    ds_read_b128 v[36:39], v3 offset:18432
    v_add_f32 v8, v8, v16
    v_mfma_f32_16x16x32_bf16 v[104:107], v[44:47], v[196:199], v[104:107]
    v_add_f32 v8, v8, v17
    v_cvt_pk_bf16_f32 v153, v154, v158
    v_mfma_f32_16x16x32_bf16 v[108:111], v[40:43], v[216:219], v[108:111]
    v_exp_f32 v19, v127
    v_mfma_f32_16x16x32_bf16 v[108:111], v[44:47], v[220:223], v[108:111]
    s_waitcnt lgkmcnt(2)
    v_cvt_pk_bf16_f32 v190, v16, v17
    v_add_f32 v8, v8, v18
    v_mfma_f32_16x16x32_bf16 v[80:83], v[24:27], a[192:195], v[128:131]
    ds_read_b128 v[40:43], v2 offset:12416
    v_add_f32 v8, v8, v19
    v_mfma_f32_16x16x32_bf16 v[80:83], v[28:31], a[196:199], v[80:83]
    s_mov_b32 s30, s29
    v_cvt_pk_bf16_f32 v191, v18, v19
    v_mfma_f32_16x16x32_bf16 v[84:87], v[24:27], a[216:219], v[132:135]
    v_exp_f32 v16, v64
    v_mfma_f32_16x16x32_bf16 v[84:87], v[28:31], a[220:223], v[84:87]
    s_waitcnt vmcnt(20)
    buffer_load_dwordx4 v4, s[4:7], s27 offen offset:0 sc1 lds
    v_mfma_f32_16x16x32_bf16 v[88:91], v[24:27], a[240:243], v[136:139]
    ds_read_b128 v[44:47], v3 offset:12416
    v_lshlrev_b32 v48, 16, v60
    v_mfma_f32_16x16x32_bf16 v[88:91], v[28:31], a[244:247], v[88:91]
    v_exp_f32 v17, v65
    v_mfma_f32_16x16x32_bf16 v[92:95], v[24:27], v[200:203], v[140:143]
    v_exp_f32 v18, v66
    v_mfma_f32_16x16x32_bf16 v[92:95], v[28:31], v[204:207], v[92:95]
    s_waitcnt lgkmcnt(2)
    v_add_f32 v5, v5, v16
    v_add_f32 v5, v5, v17
    v_mfma_f32_16x16x32_bf16 v[112:115], v[32:35], a[192:195], v[128:131]
    ds_read_b128 v[24:27], v2 offset:18560
    v_and_b32 v49, s97, v60
    v_mfma_f32_16x16x32_bf16 v[112:115], v[36:39], a[196:199], v[112:115]
    v_exp_f32 v19, v67
    v_mfma_f32_16x16x32_bf16 v[116:119], v[32:35], a[216:219], v[132:135]
    v_cvt_pk_bf16_f32 v64, v16, v17
    v_lshlrev_b32 v50, 16, v62
    v_mfma_f32_16x16x32_bf16 v[116:119], v[36:39], a[220:223], v[116:119]
    v_exp_f32 v16, v96
    v_mfma_f32_16x16x32_bf16 v[120:123], v[32:35], a[240:243], v[136:139]
    ds_read_b128 v[28:31], v3 offset:18560
    v_add_f32 v5, v5, v18
    v_mfma_f32_16x16x32_bf16 v[120:123], v[36:39], a[244:247], v[120:123]
    v_add_f32 v5, v5, v19
    v_add_u32 v1, s3, v1
    v_mfma_f32_16x16x32_bf16 v[124:127], v[32:35], v[200:203], v[140:143]
    v_exp_f32 v17, v97
    v_mfma_f32_16x16x32_bf16 v[124:127], v[36:39], v[204:207], v[124:127]
    s_waitcnt lgkmcnt(2)
    buffer_load_dwordx4 v4, s[4:7], s27 offen offset:1024 sc1 lds
    v_mfma_f32_16x16x32_bf16 v[80:83], v[40:43], a[200:203], v[80:83]
    ds_read_b128 v[32:35], v2 offset:12544
    v_cvt_pk_bf16_f32 v65, v18, v19
    v_mfma_f32_16x16x32_bf16 v[80:83], v[44:47], a[204:207], v[80:83]
    v_exp_f32 v18, v98
    v_mfma_f32_16x16x32_bf16 v[84:87], v[40:43], a[224:227], v[84:87]
    v_add_f32 v5, v5, v16
    v_add_f32 v5, v5, v17
    v_mfma_f32_16x16x32_bf16 v[84:87], v[44:47], a[228:231], v[84:87]
    v_exp_f32 v19, v99
    v_mfma_f32_16x16x32_bf16 v[88:91], v[40:43], a[248:251], v[88:91]
    ds_read_b128 v[36:39], v3 offset:12544
    v_cvt_pk_bf16_f32 v66, v16, v17
    v_mfma_f32_16x16x32_bf16 v[88:91], v[44:47], a[252:255], v[88:91]
    v_exp_f32 v16, v68
    v_mfma_f32_16x16x32_bf16 v[92:95], v[40:43], v[208:211], v[92:95]
L_pg4:
    s_cbranch_execz L_pg8
    v_and_b32 v51, s97, v62
    v_add_f32 v5, v5, v18
    v_mfma_f32_16x16x32_bf16 v[92:95], v[44:47], v[212:215], v[92:95]
    s_waitcnt lgkmcnt(2)
    v_add_f32 v5, v5, v19
    v_mul_f32_e64 v50, -v50, v48
    v_mfma_f32_16x16x32_bf16 v[112:115], v[24:27], a[200:203], v[112:115]
    ds_read_b128 v[40:43], v2 offset:18688
    v_mfma_f32_16x16x32_bf16 v[112:115], v[28:31], a[204:207], v[112:115]
    buffer_load_dwordx4 v4, s[4:7], s27 offen offset:2048 sc1 lds
    v_mfma_f32_16x16x32_bf16 v[116:119], v[24:27], a[224:227], v[116:119]
    v_exp_f32 v17, v69
    v_mfma_f32_16x16x32_bf16 v[116:119], v[28:31], a[228:231], v[116:119]
    v_cvt_pk_bf16_f32 v67, v18, v19
    v_mul_f32_e64 v51, -v51, v49
    v_mfma_f32_16x16x32_bf16 v[120:123], v[24:27], a[248:251], v[120:123]
    ds_read_b128 v[44:47], v3 offset:18688
    v_mfma_f32_16x16x32_bf16 v[120:123], v[28:31], a[252:255], v[120:123]
    s_waitcnt lgkmcnt(2)
    v_exp_f32 v18, v70
    v_mfma_f32_16x16x32_bf16 v[124:127], v[24:27], v[208:211], v[124:127]
    s_waitcnt vmcnt(13)
    v_add_f32 v6, v6, v16
    v_add_f32 v6, v6, v17
    v_mfma_f32_16x16x32_bf16 v[124:127], v[28:31], v[212:215], v[124:127]
    s_barrier
    v_cvt_f32_i32 v240, v240
    v_mfma_f32_16x16x32_bf16 v[80:83], v[32:35], a[208:211], v[80:83]
    ds_read_b128 v[24:27], v1 offset:0
    v_mfma_f32_16x16x32_bf16 v[80:83], v[36:39], a[212:215], v[80:83]
    v_exp_f32 v19, v71
    v_mfma_f32_16x16x32_bf16 v[84:87], v[32:35], a[232:235], v[84:87]
    v_cvt_pk_bf16_f32 v68, v16, v17
    v_mfma_f32_16x16x32_bf16 v[84:87], v[36:39], a[236:239], v[84:87]
    v_exp_f32 v16, v100
    v_mfma_f32_16x16x32_bf16 v[88:91], v[32:35], v[192:195], v[88:91]
    ds_read_b128 v[28:31], v1 offset:12288
    v_add_f32 v6, v6, v18
    v_mfma_f32_16x16x32_bf16 v[88:91], v[36:39], v[196:199], v[88:91]
    v_add_f32 v6, v6, v19
    v_cvt_f32_i32 v244, v244
    v_mfma_f32_16x16x32_bf16 v[92:95], v[32:35], v[216:219], v[92:95]
    v_exp_f32 v17, v101
    v_mfma_f32_16x16x32_bf16 v[92:95], v[36:39], v[220:223], v[92:95]
    s_waitcnt lgkmcnt(2)
    v_cvt_pk_bf16_f32 v69, v18, v19
    v_mfma_f32_16x16x32_bf16 v[112:115], v[40:43], a[208:211], v[112:115]
    ds_read_b128 v[32:35], v1 offset:1024
    v_mfma_f32_16x16x32_bf16 v[112:115], v[44:47], a[212:215], v[112:115]
    v_exp_f32 v18, v102
    v_mfma_f32_16x16x32_bf16 v[116:119], v[40:43], a[232:235], v[116:119]
    v_add_f32 v6, v6, v16
    v_add_f32 v6, v6, v17
    v_mfma_f32_16x16x32_bf16 v[116:119], v[44:47], a[236:239], v[116:119]
    s_add_u32 s27, s27, 24576
    v_exp_f32 v19, v103
    v_mfma_f32_16x16x32_bf16 v[120:123], v[40:43], v[192:195], v[120:123]
    s_add_u32 s56, s56, 36864
    ds_read_b128 v[36:39], v1 offset:13312
    v_cvt_pk_bf16_f32 v70, v16, v17
    v_mfma_f32_16x16x32_bf16 v[120:123], v[44:47], v[196:199], v[120:123]
    s_sub_u32 s58, s56, 147456
    v_add_f32 v6, v6, v18
    v_add_f32 v6, v6, v19
    v_mfma_f32_16x16x32_bf16 v[124:127], v[40:43], v[216:219], v[124:127]
    s_min_u32 s56, s56, s58
    v_cvt_pk_bf16_f32 v71, v18, v19
    v_mfma_f32_16x16x32_bf16 v[124:127], v[44:47], v[220:223], v[124:127]
    s_waitcnt lgkmcnt(2)
    v_mfma_f32_16x16x32_bf16 a[0:3], v[160:163], v[24:27], a[0:3]
    s_mov_b32 m0, s56
    ds_read_b128 v[40:43], v1 offset:2048
    v_fma_f32 v240, v240, v48, v50
    v_mfma_f32_16x16x32_bf16 a[0:3], v[176:179], v[28:31], a[0:3]
    buffer_load_dwordx4 v4, s[4:7], s27 offen offset:0 sc1 lds
    v_mfma_f32_16x16x32_bf16 a[48:51], v[164:167], v[24:27], a[48:51]
    v_exp_f32 v16, v72
    v_mfma_f32_16x16x32_bf16 a[48:51], v[180:183], v[28:31], a[48:51]
    v_exp_f32 v17, v73
    v_mfma_f32_16x16x32_bf16 a[96:99], v[168:171], v[24:27], a[96:99]
    ds_read_b128 v[44:47], v1 offset:14336
    v_fma_f32 v244, v244, v49, v51
    v_mfma_f32_16x16x32_bf16 a[96:99], v[184:187], v[28:31], a[96:99]
    v_exp_f32 v18, v74
    v_mfma_f32_16x16x32_bf16 a[144:147], v[172:175], v[24:27], a[144:147]
    v_add_f32 v7, v7, v16
    v_add_f32 v7, v7, v17
    v_mfma_f32_16x16x32_bf16 a[144:147], v[188:191], v[28:31], a[144:147]
    s_waitcnt lgkmcnt(2)
    v_exp_f32 v19, v75
    v_mfma_f32_16x16x32_bf16 a[4:7], v[160:163], v[32:35], a[4:7]
    ds_read_b128 v[24:27], v1 offset:3072
    v_cvt_f32_i32 v241, v241
    v_mfma_f32_16x16x32_bf16 a[4:7], v[176:179], v[36:39], a[4:7]
    buffer_load_dwordx4 v4, s[4:7], s27 offen offset:1024 sc1 lds
    v_mfma_f32_16x16x32_bf16 a[52:55], v[164:167], v[32:35], a[52:55]
    v_cvt_pk_bf16_f32 v72, v16, v17
    v_cvt_f32_i32 v245, v245
    v_mfma_f32_16x16x32_bf16 a[52:55], v[180:183], v[36:39], a[52:55]
    v_exp_f32 v16, v104
    v_mfma_f32_16x16x32_bf16 a[100:103], v[168:171], v[32:35], a[100:103]
    ds_read_b128 v[28:31], v1 offset:15360
    v_add_f32 v7, v7, v18
    v_mfma_f32_16x16x32_bf16 a[100:103], v[184:187], v[36:39], a[100:103]
    v_add_f32 v7, v7, v19
    v_bfe_u32 v53, v4, 4, 6
    v_mfma_f32_16x16x32_bf16 a[148:151], v[172:175], v[32:35], a[148:151]
    v_exp_f32 v17, v105
    v_mfma_f32_16x16x32_bf16 a[148:151], v[188:191], v[36:39], a[148:151]
    s_waitcnt lgkmcnt(2)
    v_cvt_pk_bf16_f32 v73, v18, v19
    v_fma_f32 v241, v241, v48, v50
    v_mfma_f32_16x16x32_bf16 a[8:11], v[160:163], v[40:43], a[8:11]
    ds_read_b128 v[32:35], v1 offset:4096
    v_lshlrev_b32 v53, 2, v53
    v_mfma_f32_16x16x32_bf16 a[8:11], v[176:179], v[44:47], a[8:11]
    buffer_load_dword v52, v53, s[20:23], s44 offen sc1
    v_mfma_f32_16x16x32_bf16 a[56:59], v[164:167], v[40:43], a[56:59]
    v_exp_f32 v18, v106
    v_mfma_f32_16x16x32_bf16 a[56:59], v[180:183], v[44:47], a[56:59]
    v_add_f32 v7, v7, v16
    v_add_f32 v7, v7, v17
    v_mfma_f32_16x16x32_bf16 a[104:107], v[168:171], v[40:43], a[104:107]
    ds_read_b128 v[36:39], v1 offset:16384
    v_fma_f32 v245, v245, v49, v51
    v_mfma_f32_16x16x32_bf16 a[104:107], v[184:187], v[44:47], a[104:107]
    buffer_load_dwordx4 v4, s[4:7], s27 offen offset:2048 sc1 lds
    v_mfma_f32_16x16x32_bf16 a[152:155], v[172:175], v[40:43], a[152:155]
    v_exp_f32 v19, v107
    v_mfma_f32_16x16x32_bf16 a[152:155], v[188:191], v[44:47], a[152:155]
    s_waitcnt lgkmcnt(2)
    v_cvt_pk_bf16_f32 v74, v16, v17
    v_cvt_f32_i32 v242, v242
    v_mfma_f32_16x16x32_bf16 a[12:15], v[160:163], v[24:27], a[12:15]
    ds_read_b128 v[40:43], v1 offset:5120
    v_cvt_f32_i32 v246, v246
    v_mfma_f32_16x16x32_bf16 a[12:15], v[176:179], v[28:31], a[12:15]
    s_add_u32 s27, s27, 24576
    v_exp_f32 v16, v76
    v_mfma_f32_16x16x32_bf16 a[60:63], v[164:167], v[24:27], a[60:63]
    v_add_f32 v7, v7, v18
    v_add_f32 v7, v7, v19
    v_mfma_f32_16x16x32_bf16 a[60:63], v[180:183], v[28:31], a[60:63]
    v_exp_f32 v17, v77
    v_mfma_f32_16x16x32_bf16 a[108:111], v[168:171], v[24:27], a[108:111]
    ds_read_b128 v[44:47], v1 offset:17408
    v_cvt_pk_bf16_f32 v75, v18, v19
    v_mfma_f32_16x16x32_bf16 a[108:111], v[184:187], v[28:31], a[108:111]
    v_exp_f32 v18, v78
    v_mfma_f32_16x16x32_bf16 a[156:159], v[172:175], v[24:27], a[156:159]
    s_add_u32 s29, s28, 49152
    v_fma_f32 v242, v242, v48, v50
    v_add_f32 v8, v8, v16
    v_mfma_f32_16x16x32_bf16 a[156:159], v[188:191], v[28:31], a[156:159]
    s_waitcnt lgkmcnt(2)
    v_add_f32 v8, v8, v17
    v_fma_f32 v246, v246, v49, v51
    v_mfma_f32_16x16x32_bf16 a[16:19], v[160:163], v[32:35], a[16:19]
    s_sub_u32 s3, s29, 147456
    ds_read_b128 v[24:27], v1 offset:6144
    v_lshlrev_b32 v48, 16, v61
    v_mfma_f32_16x16x32_bf16 a[16:19], v[176:179], v[36:39], a[16:19]
    s_add_u32 s56, s56, 12288
    v_exp_f32 v19, v79
    v_mfma_f32_16x16x32_bf16 a[64:67], v[164:167], v[32:35], a[64:67]
    s_min_u32 s29, s29, s3
    v_cvt_pk_bf16_f32 v76, v16, v17
    v_and_b32 v49, s97, v61
    v_mfma_f32_16x16x32_bf16 a[64:67], v[180:183], v[36:39], a[64:67]
    s_mov_b32 m0, s56
    v_exp_f32 v16, v108
    v_mfma_f32_16x16x32_bf16 a[112:115], v[168:171], v[32:35], a[112:115]
    ds_read_b128 v[28:31], v1 offset:18432
    v_add_f32 v8, v8, v18
    v_mfma_f32_16x16x32_bf16 a[112:115], v[184:187], v[36:39], a[112:115]
    v_add_f32 v8, v8, v19
    v_lshlrev_b32 v50, 16, v63
    v_mfma_f32_16x16x32_bf16 a[160:163], v[172:175], v[32:35], a[160:163]
    v_exp_f32 v17, v109
    v_mfma_f32_16x16x32_bf16 a[160:163], v[188:191], v[36:39], a[160:163]
    s_waitcnt lgkmcnt(2)
    v_cvt_pk_bf16_f32 v77, v18, v19
    v_and_b32 v51, s97, v63
    v_mfma_f32_16x16x32_bf16 a[20:23], v[160:163], v[40:43], a[20:23]
    s_sub_u32 s3, s29, s28
    ds_read_b128 v[32:35], v1 offset:7168
    v_mul_f32_e64 v50, -v50, v48
    v_mfma_f32_16x16x32_bf16 a[20:23], v[176:179], v[44:47], a[20:23]
    v_exp_f32 v18, v110
    v_mfma_f32_16x16x32_bf16 a[68:71], v[164:167], v[40:43], a[68:71]
    v_add_f32 v8, v8, v16
    v_add_f32 v8, v8, v17
    v_mfma_f32_16x16x32_bf16 a[68:71], v[180:183], v[44:47], a[68:71]
    buffer_load_dwordx4 v4, s[4:7], s27 offen offset:0 sc1 lds
    v_mfma_f32_16x16x32_bf16 a[116:119], v[168:171], v[40:43], a[116:119]
    ds_read_b128 v[36:39], v1 offset:19456
    v_mul_f32_e64 v51, -v51, v49
    v_mfma_f32_16x16x32_bf16 a[116:119], v[184:187], v[44:47], a[116:119]
    v_exp_f32 v19, v111
    v_mfma_f32_16x16x32_bf16 a[164:167], v[172:175], v[40:43], a[164:167]
    s_mov_b32 s28, s29
    v_cvt_pk_bf16_f32 v78, v16, v17
    v_add_f32 v8, v8, v18
    v_mfma_f32_16x16x32_bf16 a[164:167], v[188:191], v[44:47], a[164:167]
    s_waitcnt lgkmcnt(2)
    v_add_f32 v8, v8, v19
    v_cvt_pk_bf16_f32 v79, v18, v19
    v_mfma_f32_16x16x32_bf16 a[24:27], v[160:163], v[24:27], a[24:27]
    ds_read_b128 v[40:43], v1 offset:8192
    v_cvt_f32_i32 v248, v248
    v_mfma_f32_16x16x32_bf16 a[24:27], v[176:179], v[28:31], a[24:27]
    v_exp_f32 v16, v80
    v_mfma_f32_16x16x32_bf16 a[72:75], v[164:167], v[24:27], a[72:75]
    v_exp_f32 v17, v81
    v_mfma_f32_16x16x32_bf16 a[72:75], v[180:183], v[28:31], a[72:75]
    buffer_load_dwordx4 v4, s[4:7], s27 offen offset:1024 sc1 lds
    v_mfma_f32_16x16x32_bf16 a[120:123], v[168:171], v[24:27], a[120:123]
    ds_read_b128 v[44:47], v1 offset:20480
    v_cvt_f32_i32 v252, v252
    v_mfma_f32_16x16x32_bf16 a[120:123], v[184:187], v[28:31], a[120:123]
    v_exp_f32 v18, v82
    v_mfma_f32_16x16x32_bf16 a[168:171], v[172:175], v[24:27], a[168:171]
    v_add_f32 v5, v5, v16
    v_fma_f32 v248, v248, v48, v50
    v_mfma_f32_16x16x32_bf16 a[168:171], v[188:191], v[28:31], a[168:171]
    s_waitcnt lgkmcnt(2)
    v_add_f32 v5, v5, v17
    v_fma_f32 v252, v252, v49, v51
    v_mfma_f32_16x16x32_bf16 a[28:31], v[160:163], v[32:35], a[28:31]
    ds_read_b128 v[24:27], v1 offset:9216
    v_cvt_f32_i32 v249, v249
    v_mfma_f32_16x16x32_bf16 a[28:31], v[176:179], v[36:39], a[28:31]
    v_exp_f32 v19, v83
    v_mfma_f32_16x16x32_bf16 a[76:79], v[164:167], v[32:35], a[76:79]
    v_cvt_pk_bf16_f32 v80, v16, v17
    v_cvt_f32_i32 v253, v253
    v_mfma_f32_16x16x32_bf16 a[76:79], v[180:183], v[36:39], a[76:79]
    v_exp_f32 v16, v112
    v_mfma_f32_16x16x32_bf16 a[124:127], v[168:171], v[32:35], a[124:127]
    ds_read_b128 v[28:31], v1 offset:21504
    v_add_f32 v5, v5, v18
    v_mfma_f32_16x16x32_bf16 a[124:127], v[184:187], v[36:39], a[124:127]
    buffer_load_dwordx4 v4, s[4:7], s27 offen offset:2048 sc1 lds
    v_mfma_f32_16x16x32_bf16 a[172:175], v[172:175], v[32:35], a[172:175]
    v_add_f32 v5, v5, v19
    v_fma_f32 v249, v249, v48, v50
    v_mfma_f32_16x16x32_bf16 a[172:175], v[188:191], v[36:39], a[172:175]
    s_waitcnt lgkmcnt(2)
    v_exp_f32 v17, v113
    v_mfma_f32_16x16x32_bf16 a[32:35], v[160:163], v[40:43], a[32:35]
    ds_read_b128 v[32:35], v1 offset:10240
    v_cvt_pk_bf16_f32 v81, v18, v19
    v_mfma_f32_16x16x32_bf16 a[32:35], v[176:179], v[44:47], a[32:35]
    v_exp_f32 v18, v114
    v_mfma_f32_16x16x32_bf16 a[80:83], v[164:167], v[40:43], a[80:83]
    v_add_f32 v5, v5, v16
    v_add_f32 v5, v5, v17
    v_mfma_f32_16x16x32_bf16 a[80:83], v[180:183], v[44:47], a[80:83]
    v_exp_f32 v19, v115
    v_mfma_f32_16x16x32_bf16 a[128:131], v[168:171], v[40:43], a[128:131]
    ds_read_b128 v[36:39], v1 offset:22528
    v_fma_f32 v253, v253, v49, v51
    v_mfma_f32_16x16x32_bf16 a[128:131], v[184:187], v[44:47], a[128:131]
    v_add_u32 v2, s3, v2
    v_cvt_pk_bf16_f32 v82, v16, v17
    v_mfma_f32_16x16x32_bf16 a[176:179], v[172:175], v[40:43], a[176:179]
    v_exp_f32 v16, v84
    v_mfma_f32_16x16x32_bf16 a[176:179], v[188:191], v[44:47], a[176:179]
    s_waitcnt lgkmcnt(2)
    v_cvt_f32_i32 v250, v250
    v_add_f32 v5, v5, v18
    v_mfma_f32_16x16x32_bf16 a[36:39], v[160:163], v[24:27], a[36:39]
    ds_read_b128 v[40:43], v1 offset:11264
    v_add_f32 v5, v5, v19
    v_mfma_f32_16x16x32_bf16 a[36:39], v[176:179], v[28:31], a[36:39]
    v_exp_f32 v17, v85
    v_mfma_f32_16x16x32_bf16 a[84:87], v[164:167], v[24:27], a[84:87]
    v_add_u32 v3, s3, v3
    v_cvt_f32_i32 v254, v254
    v_mfma_f32_16x16x32_bf16 a[84:87], v[180:183], v[28:31], a[84:87]
    s_add_u32 s27, s27, 24576
    v_cvt_pk_bf16_f32 v83, v18, v19
    v_fma_f32 v250, v250, v48, v50
    v_mfma_f32_16x16x32_bf16 a[132:135], v[168:171], v[24:27], a[132:135]
    s_add_u32 s56, s56, 36864
    ds_read_b128 v[44:47], v1 offset:23552
    v_fma_f32 v254, v254, v49, v51
    v_mfma_f32_16x16x32_bf16 a[132:135], v[184:187], v[28:31], a[132:135]
    s_sub_u32 s58, s56, 147456
    v_exp_f32 v18, v86
    v_mfma_f32_16x16x32_bf16 a[180:183], v[172:175], v[24:27], a[180:183]
    v_add_f32 v6, v6, v16
    v_add_f32 v6, v6, v17
    v_mfma_f32_16x16x32_bf16 a[180:183], v[188:191], v[28:31], a[180:183]
    s_waitcnt lgkmcnt(2)
    v_exp_f32 v19, v87
    v_mfma_f32_16x16x32_bf16 a[40:43], v[160:163], v[32:35], a[40:43]
    s_min_u32 s56, s56, s58
    ds_read_b128 v[24:27], v2 offset:0
    v_cvt_pk_bf16_f32 v146, v240, v244
    v_mfma_f32_16x16x32_bf16 a[40:43], v[176:179], v[36:39], a[40:43]
    buffer_load_dword v20, v4, s[88:91], s93 offen
    v_mfma_f32_16x16x32_bf16 a[88:91], v[164:167], v[32:35], a[88:91]
    v_cvt_pk_bf16_f32 v84, v16, v17
    v_cvt_pk_bf16_f32 v150, v241, v245
    v_mfma_f32_16x16x32_bf16 a[88:91], v[180:183], v[36:39], a[88:91]
    v_exp_f32 v16, v116
    v_mfma_f32_16x16x32_bf16 a[136:139], v[168:171], v[32:35], a[136:139]
    ds_read_b128 v[28:31], v3 offset:0
    v_add_f32 v6, v6, v18
    v_mfma_f32_16x16x32_bf16 a[136:139], v[184:187], v[36:39], a[136:139]
    v_add_f32 v6, v6, v19
    v_cvt_pk_bf16_f32 v147, v248, v252
    v_mfma_f32_16x16x32_bf16 a[184:187], v[172:175], v[32:35], a[184:187]
    v_exp_f32 v17, v117
    v_mfma_f32_16x16x32_bf16 a[184:187], v[188:191], v[36:39], a[184:187]
    s_waitcnt lgkmcnt(2)
    v_cvt_pk_bf16_f32 v85, v18, v19
    v_cvt_pk_bf16_f32 v151, v249, v253
    v_mfma_f32_16x16x32_bf16 a[44:47], v[160:163], v[40:43], a[44:47]
    ds_read_b128 v[32:35], v2 offset:6144
    v_cvt_pk_bf16_f32 v154, v242, v246
    v_mfma_f32_16x16x32_bf16 a[44:47], v[176:179], v[44:47], a[44:47]
    v_exp_f32 v18, v118
    v_mfma_f32_16x16x32_bf16 a[92:95], v[164:167], v[40:43], a[92:95]
    v_add_f32 v6, v6, v16
    v_add_f32 v6, v6, v17
    v_mfma_f32_16x16x32_bf16 a[92:95], v[180:183], v[44:47], a[92:95]
    v_exp_f32 v19, v119
    v_mfma_f32_16x16x32_bf16 a[140:143], v[168:171], v[40:43], a[140:143]
    ds_read_b128 v[36:39], v3 offset:6144
    v_cvt_pk_bf16_f32 v86, v16, v17
    v_mfma_f32_16x16x32_bf16 a[140:143], v[184:187], v[44:47], a[140:143]
    v_add_f32 v6, v6, v18
    v_cvt_pk_bf16_f32 v155, v250, v254
    v_mfma_f32_16x16x32_bf16 a[188:191], v[172:175], v[40:43], a[188:191]
    v_add_f32 v6, v6, v19
    v_cvt_pk_bf16_f32 v87, v18, v19
    v_mfma_f32_16x16x32_bf16 a[188:191], v[188:191], v[44:47], a[188:191]
    s_waitcnt lgkmcnt(2)
L_join:
    v_mfma_f32_16x16x32_bf16 v[160:163], v[24:27], a[192:195], v[128:131]
L_pg5:
    s_cbranch_execz L_pg9
    s_waitcnt vmcnt(7)
    ds_read_b128 v[40:43], v2 offset:128
    v_lshlrev_b32 v48, 16, v56
    v_mfma_f32_16x16x32_bf16 v[160:163], v[28:31], a[196:199], v[160:163]
    s_waitcnt vmcnt(5)
    v_subrev_u32 v52, s92, v52
    v_cmp_lt_u32 vcc, 15, v52
    v_mfma_f32_16x16x32_bf16 v[164:167], v[24:27], a[216:219], v[132:135]
    v_exp_f32 v16, v88
    v_mfma_f32_16x16x32_bf16 v[164:167], v[28:31], a[220:223], v[164:167]
    v_exp_f32 v17, v89
    v_mfma_f32_16x16x32_bf16 v[168:171], v[24:27], a[240:243], v[136:139]
    s_and_b32 s59, vcc_lo, 0xff
    ds_read_b128 v[44:47], v3 offset:128
    v_and_b32 v49, s97, v56
    v_mfma_f32_16x16x32_bf16 v[168:171], v[28:31], a[244:247], v[168:171]
    s_cbranch_scc1 L_pollslow1
L_pollok1:
    v_mfma_f32_16x16x32_bf16 v[172:175], v[24:27], v[200:203], v[140:143]
    s_add_u32 s92, s92, 1
    v_exp_f32 v18, v90
    v_mfma_f32_16x16x32_bf16 v[172:175], v[28:31], v[204:207], v[172:175]
    s_waitcnt lgkmcnt(2)
    v_add_f32 v7, v7, v16
    v_add_f32 v7, v7, v17
    v_mfma_f32_16x16x32_bf16 v[96:99], v[32:35], a[192:195], v[128:131]
    ds_read_b128 v[24:27], v2 offset:6272
    v_lshlrev_b32 v50, 16, v58
    v_mfma_f32_16x16x32_bf16 v[96:99], v[36:39], a[196:199], v[96:99]
    buffer_store_dwordx4 v[144:147], v15, s[4:7], s35 offen offset:0 sc1
    v_mfma_f32_16x16x32_bf16 v[100:103], v[32:35], a[216:219], v[132:135]
    v_exp_f32 v19, v91
    v_mfma_f32_16x16x32_bf16 v[100:103], v[36:39], a[220:223], v[100:103]
    v_cvt_pk_bf16_f32 v88, v16, v17
    v_and_b32 v51, s97, v58
    v_mfma_f32_16x16x32_bf16 v[104:107], v[32:35], a[240:243], v[136:139]
    ds_read_b128 v[28:31], v3 offset:6272
    v_mfma_f32_16x16x32_bf16 v[104:107], v[36:39], a[244:247], v[104:107]
    v_exp_f32 v16, v120
    v_mfma_f32_16x16x32_bf16 v[108:111], v[32:35], v[200:203], v[140:143]
    v_add_f32 v7, v7, v18
    v_add_f32 v7, v7, v19
    v_mfma_f32_16x16x32_bf16 v[108:111], v[36:39], v[204:207], v[108:111]
    s_waitcnt lgkmcnt(2)
    v_exp_f32 v17, v121
    v_mfma_f32_16x16x32_bf16 v[160:163], v[40:43], a[200:203], v[160:163]
    ds_read_b128 v[32:35], v2 offset:256
    v_cvt_pk_bf16_f32 v89, v18, v19
    v_mfma_f32_16x16x32_bf16 v[160:163], v[44:47], a[204:207], v[160:163]
    buffer_store_dwordx4 v[148:151], v15, s[4:7], s35 offen offset:1024 sc1
    v_mfma_f32_16x16x32_bf16 v[164:167], v[40:43], a[224:227], v[164:167]
    v_exp_f32 v18, v122
    v_mfma_f32_16x16x32_bf16 v[164:167], v[44:47], a[228:231], v[164:167]
    v_add_f32 v7, v7, v16
    v_add_f32 v7, v7, v17
    v_mfma_f32_16x16x32_bf16 v[168:171], v[40:43], a[248:251], v[168:171]
    ds_read_b128 v[36:39], v3 offset:256
    v_mul_f32 v48, s38, v48
    v_mfma_f32_16x16x32_bf16 v[168:171], v[44:47], a[252:255], v[168:171]
    v_exp_f32 v19, v123
    v_mfma_f32_16x16x32_bf16 v[172:175], v[40:43], v[208:211], v[172:175]
    v_cvt_pk_bf16_f32 v90, v16, v17
    v_mul_f32 v49, s38, v49
    v_mfma_f32_16x16x32_bf16 v[172:175], v[44:47], v[212:215], v[172:175]
    s_waitcnt lgkmcnt(2)
    v_exp_f32 v16, v92
    v_mfma_f32_16x16x32_bf16 v[96:99], v[24:27], a[200:203], v[96:99]
    ds_read_b128 v[40:43], v2 offset:6400
    v_add_f32 v7, v7, v18
    v_mfma_f32_16x16x32_bf16 v[96:99], v[28:31], a[204:207], v[96:99]
    buffer_store_dwordx4 v[152:155], v15, s[4:7], s35 offen offset:2048 sc1
    v_mfma_f32_16x16x32_bf16 v[100:103], v[24:27], a[224:227], v[100:103]
    v_add_f32 v7, v7, v19
    v_mul_f32_e64 v50, -v50, v48
    v_mfma_f32_16x16x32_bf16 v[100:103], v[28:31], a[228:231], v[100:103]
    v_exp_f32 v17, v93
    v_mfma_f32_16x16x32_bf16 v[104:107], v[24:27], a[248:251], v[104:107]
    ds_read_b128 v[44:47], v3 offset:6400
    v_cvt_pk_bf16_f32 v91, v18, v19
    v_mfma_f32_16x16x32_bf16 v[104:107], v[28:31], a[252:255], v[104:107]
    v_exp_f32 v18, v94
    v_mfma_f32_16x16x32_bf16 v[108:111], v[24:27], v[208:211], v[108:111]
    s_add_u32 s29, s30, 49152
    v_add_f32 v8, v8, v16
    v_add_f32 v8, v8, v17
    v_mfma_f32_16x16x32_bf16 v[108:111], v[28:31], v[212:215], v[108:111]
    s_waitcnt lgkmcnt(2)
    v_exp_f32 v19, v95
    v_mfma_f32_16x16x32_bf16 v[160:163], v[32:35], a[208:211], v[160:163]
    s_sub_u32 s3, s29, 147456
    ds_read_b128 v[24:27], v2 offset:12288
    v_cvt_pk_bf16_f32 v92, v16, v17
    v_mfma_f32_16x16x32_bf16 v[160:163], v[36:39], a[212:215], v[160:163]
    s_min_u32 s29, s29, s3
    v_exp_f32 v16, v124
    v_mfma_f32_16x16x32_bf16 v[164:167], v[32:35], a[232:235], v[164:167]
    v_add_f32 v8, v8, v18
    v_mul_f32_e64 v51, -v51, v49
    v_mfma_f32_16x16x32_bf16 v[164:167], v[36:39], a[236:239], v[164:167]
    v_add_f32 v8, v8, v19
    v_cvt_f32_i32 v224, v224
    v_mfma_f32_16x16x32_bf16 v[168:171], v[32:35], v[192:195], v[168:171]
    ds_read_b128 v[28:31], v3 offset:12288
    v_mfma_f32_16x16x32_bf16 v[168:171], v[36:39], v[196:199], v[168:171]
    v_exp_f32 v17, v125
    v_mfma_f32_16x16x32_bf16 v[172:175], v[32:35], v[216:219], v[172:175]
    v_cvt_pk_bf16_f32 v93, v18, v19
    v_cvt_f32_i32 v225, v225
    v_mfma_f32_16x16x32_bf16 v[172:175], v[36:39], v[220:223], v[172:175]
    s_waitcnt lgkmcnt(2)
    v_exp_f32 v18, v126
    v_mfma_f32_16x16x32_bf16 v[96:99], v[40:43], a[208:211], v[96:99]
    ds_read_b128 v[32:35], v2 offset:18432
    v_add_f32 v8, v8, v16
    v_mfma_f32_16x16x32_bf16 v[96:99], v[44:47], a[212:215], v[96:99]
    s_mov_b32 m0, s26
    v_add_f32 v8, v8, v17
    s_sub_u32 s3, s29, s30
    v_mfma_f32_16x16x32_bf16 v[100:103], v[40:43], a[232:235], v[100:103]
    v_exp_f32 v19, v127
    v_mfma_f32_16x16x32_bf16 v[100:103], v[44:47], a[236:239], v[100:103]
    buffer_load_dwordx4 v4, s[4:7], s32 offen offset:0 sc1 lds
    v_mfma_f32_16x16x32_bf16 v[104:107], v[40:43], v[192:195], v[104:107]
    ds_read_b128 v[36:39], v3 offset:18432
    v_cvt_pk_bf16_f32 v94, v16, v17
    v_mfma_f32_16x16x32_bf16 v[104:107], v[44:47], v[196:199], v[104:107]
    v_add_f32 v8, v8, v18
    v_add_f32 v8, v8, v19
    v_mfma_f32_16x16x32_bf16 v[108:111], v[40:43], v[216:219], v[108:111]
    v_cvt_pk_bf16_f32 v95, v18, v19
    v_fma_f32 v224, v224, v48, v50
    v_mfma_f32_16x16x32_bf16 v[108:111], v[44:47], v[220:223], v[108:111]
    s_waitcnt lgkmcnt(2)
    buffer_load_dwordx4 v4, s[4:7], s32 offen offset:1024 sc1 lds
    v_mfma_f32_16x16x32_bf16 v[176:179], v[24:27], a[192:195], v[128:131]
    ds_read_b128 v[40:43], v2 offset:12416
    v_fma_f32 v225, v225, v49, v51
    v_mfma_f32_16x16x32_bf16 v[176:179], v[28:31], a[196:199], v[176:179]
    s_mov_b32 s30, s29
    v_exp_f32 v16, v160
    v_mfma_f32_16x16x32_bf16 v[180:183], v[24:27], a[216:219], v[132:135]
    v_exp_f32 v17, v161
    v_mfma_f32_16x16x32_bf16 v[180:183], v[28:31], a[220:223], v[180:183]
    buffer_load_dwordx4 v4, s[4:7], s32 offen offset:2048 sc1 lds
    v_mfma_f32_16x16x32_bf16 v[184:187], v[24:27], a[240:243], v[136:139]
    s_add_u32 s32, s32, 24576
    ds_read_b128 v[44:47], v3 offset:12416
    v_cvt_pk_bf16_f32 v224, v224, v225
    v_mfma_f32_16x16x32_bf16 v[184:187], v[28:31], a[244:247], v[184:187]
    v_exp_f32 v18, v162
    v_mfma_f32_16x16x32_bf16 v[188:191], v[24:27], v[200:203], v[140:143]
    s_add_u32 s26, s26, 12288
    v_add_f32 v5, v5, v16
    v_add_f32 v5, v5, v17
    v_mfma_f32_16x16x32_bf16 v[188:191], v[28:31], v[204:207], v[188:191]
    s_waitcnt lgkmcnt(2)
    v_exp_f32 v19, v163
    v_mfma_f32_16x16x32_bf16 v[112:115], v[32:35], a[192:195], v[128:131]
    s_mov_b32 m0, s26
    ds_read_b128 v[24:27], v2 offset:18560
    v_cvt_pk_bf16_f32 v160, v16, v17
    v_mfma_f32_16x16x32_bf16 v[112:115], v[36:39], a[196:199], v[112:115]
    v_exp_f32 v16, v96
    v_mfma_f32_16x16x32_bf16 v[116:119], v[32:35], a[216:219], v[132:135]
    v_add_f32 v5, v5, v18
    v_cvt_f32_i32 v228, v228
    v_mfma_f32_16x16x32_bf16 v[116:119], v[36:39], a[220:223], v[116:119]
    v_add_f32 v5, v5, v19
    v_add_u32 v1, s3, v1
    v_mfma_f32_16x16x32_bf16 v[120:123], v[32:35], a[240:243], v[136:139]
    ds_read_b128 v[28:31], v3 offset:18560
    v_mfma_f32_16x16x32_bf16 v[120:123], v[36:39], a[244:247], v[120:123]
    buffer_load_dwordx4 v4, s[4:7], s32 offen offset:0 sc1 lds
    v_mfma_f32_16x16x32_bf16 v[124:127], v[32:35], v[200:203], v[140:143]
    v_exp_f32 v17, v97
    v_mfma_f32_16x16x32_bf16 v[124:127], v[36:39], v[204:207], v[124:127]
    s_waitcnt lgkmcnt(2)
    v_cvt_pk_bf16_f32 v161, v18, v19
    v_cvt_f32_i32 v229, v229
    v_mfma_f32_16x16x32_bf16 v[176:179], v[40:43], a[200:203], v[176:179]
    ds_read_b128 v[32:35], v2 offset:12544
    v_mfma_f32_16x16x32_bf16 v[176:179], v[44:47], a[204:207], v[176:179]
    buffer_load_dwordx4 v4, s[4:7], s32 offen offset:1024 sc1 lds
    v_mfma_f32_16x16x32_bf16 v[180:183], v[40:43], a[224:227], v[180:183]
    v_exp_f32 v18, v98
    v_mfma_f32_16x16x32_bf16 v[180:183], v[44:47], a[228:231], v[180:183]
    v_add_f32 v5, v5, v16
    v_add_f32 v5, v5, v17
    v_mfma_f32_16x16x32_bf16 v[184:187], v[40:43], a[248:251], v[184:187]
    ds_read_b128 v[36:39], v3 offset:12544
    v_fma_f32 v228, v228, v48, v50
    v_mfma_f32_16x16x32_bf16 v[184:187], v[44:47], a[252:255], v[184:187]
    buffer_load_dwordx4 v4, s[4:7], s32 offen offset:2048 sc1 lds
    v_mfma_f32_16x16x32_bf16 v[188:191], v[40:43], v[208:211], v[188:191]
    v_exp_f32 v19, v99
    v_mfma_f32_16x16x32_bf16 v[188:191], v[44:47], v[212:215], v[188:191]
    s_waitcnt lgkmcnt(2)
    v_cvt_pk_bf16_f32 v162, v16, v17
    v_fma_f32 v229, v229, v49, v51
    v_mfma_f32_16x16x32_bf16 v[112:115], v[24:27], a[200:203], v[112:115]
    ds_read_b128 v[40:43], v2 offset:18688
    v_mfma_f32_16x16x32_bf16 v[112:115], v[28:31], a[204:207], v[112:115]
    v_exp_f32 v16, v164
    v_mfma_f32_16x16x32_bf16 v[116:119], v[24:27], a[224:227], v[116:119]
    v_add_f32 v5, v5, v18
    v_add_f32 v5, v5, v19
    v_mfma_f32_16x16x32_bf16 v[116:119], v[28:31], a[228:231], v[116:119]
    s_add_u32 s32, s32, 24576
    v_exp_f32 v17, v165
    v_mfma_f32_16x16x32_bf16 v[120:123], v[24:27], a[248:251], v[120:123]
    s_add_u32 s26, s26, 36864
    ds_read_b128 v[44:47], v3 offset:18688
    v_cvt_pk_bf16_f32 v163, v18, v19
    v_mfma_f32_16x16x32_bf16 v[120:123], v[28:31], a[252:255], v[120:123]
    s_waitcnt lgkmcnt(2)
    v_exp_f32 v18, v166
    v_mfma_f32_16x16x32_bf16 v[124:127], v[24:27], v[208:211], v[124:127]
    s_waitcnt vmcnt(6)
    v_add_f32 v6, v6, v16
    v_add_f32 v6, v6, v17
    v_mfma_f32_16x16x32_bf16 v[124:127], v[28:31], v[212:215], v[124:127]
    s_barrier
    s_sub_u32 s57, s26, 147456
    v_mfma_f32_16x16x32_bf16 v[176:179], v[32:35], a[208:211], v[176:179]
    s_min_u32 s26, s26, s57
    ds_read_b128 v[24:27], v1 offset:0
    v_add_u32 v0, 1, v0
    v_mfma_f32_16x16x32_bf16 v[176:179], v[36:39], a[212:215], v[176:179]
    buffer_store_dword v0, v13, s[20:23], 0 offen offset:32 sc1
    v_mfma_f32_16x16x32_bf16 v[180:183], v[32:35], a[232:235], v[180:183]
    v_exp_f32 v19, v167
    v_mfma_f32_16x16x32_bf16 v[180:183], v[36:39], a[236:239], v[180:183]
    v_cvt_pk_bf16_f32 v164, v16, v17
    v_cvt_pk_bf16_f32 v228, v228, v229
    v_mfma_f32_16x16x32_bf16 v[184:187], v[32:35], v[192:195], v[184:187]
    ds_read_b128 v[28:31], v1 offset:12288
    v_cvt_f32_i32 v232, v232
    v_mfma_f32_16x16x32_bf16 v[184:187], v[36:39], v[196:199], v[184:187]
    v_exp_f32 v16, v100
    v_mfma_f32_16x16x32_bf16 v[188:191], v[32:35], v[216:219], v[188:191]
    v_add_f32 v6, v6, v18
    v_add_f32 v6, v6, v19
    v_mfma_f32_16x16x32_bf16 v[188:191], v[36:39], v[220:223], v[188:191]
    s_waitcnt lgkmcnt(2)
    v_exp_f32 v17, v101
    v_mfma_f32_16x16x32_bf16 v[112:115], v[40:43], a[208:211], v[112:115]
    ds_read_b128 v[32:35], v1 offset:1024
    v_cvt_pk_bf16_f32 v165, v18, v19
    v_mfma_f32_16x16x32_bf16 v[112:115], v[44:47], a[212:215], v[112:115]
    v_exp_f32 v18, v102
    v_mfma_f32_16x16x32_bf16 v[116:119], v[40:43], a[232:235], v[116:119]
    v_add_f32 v6, v6, v16
    v_add_f32 v6, v6, v17
    v_mfma_f32_16x16x32_bf16 v[116:119], v[44:47], a[236:239], v[116:119]
    v_exp_f32 v19, v103
    v_mfma_f32_16x16x32_bf16 v[120:123], v[40:43], v[192:195], v[120:123]
    ds_read_b128 v[36:39], v1 offset:13312
    v_cvt_pk_bf16_f32 v166, v16, v17
    v_mfma_f32_16x16x32_bf16 v[120:123], v[44:47], v[196:199], v[120:123]
    v_add_f32 v6, v6, v18
    v_cvt_f32_i32 v233, v233
    v_mfma_f32_16x16x32_bf16 v[124:127], v[40:43], v[216:219], v[124:127]
    v_add_f32 v6, v6, v19
    v_cvt_pk_bf16_f32 v167, v18, v19
    v_mfma_f32_16x16x32_bf16 v[124:127], v[44:47], v[220:223], v[124:127]
    s_waitcnt lgkmcnt(2)
    v_mfma_f32_16x16x32_bf16 a[0:3], v[64:67], v[24:27], a[0:3]
    s_mov_b32 m0, s26
    ds_read_b128 v[40:43], v1 offset:2048
    v_fma_f32 v232, v232, v48, v50
    v_mfma_f32_16x16x32_bf16 a[0:3], v[80:83], v[28:31], a[0:3]
    buffer_load_dwordx2 v[60:61], v10, s[72:75], s36 offen offset:192
    v_mfma_f32_16x16x32_bf16 a[48:51], v[68:71], v[24:27], a[48:51]
    v_exp_f32 v16, v168
    v_mfma_f32_16x16x32_bf16 a[48:51], v[84:87], v[28:31], a[48:51]
    v_exp_f32 v17, v169
    v_mfma_f32_16x16x32_bf16 a[96:99], v[72:75], v[24:27], a[96:99]
    ds_read_b128 v[44:47], v1 offset:14336
    v_fma_f32 v233, v233, v49, v51
    v_mfma_f32_16x16x32_bf16 a[96:99], v[88:91], v[28:31], a[96:99]
    buffer_load_dwordx4 v4, s[4:7], s32 offen offset:0 sc1 lds
    v_mfma_f32_16x16x32_bf16 a[144:147], v[76:79], v[24:27], a[144:147]
    v_exp_f32 v18, v170
    v_mfma_f32_16x16x32_bf16 a[144:147], v[92:95], v[28:31], a[144:147]
    s_waitcnt lgkmcnt(2)
    v_add_f32 v7, v7, v16
    v_add_f32 v7, v7, v17
    v_mfma_f32_16x16x32_bf16 a[4:7], v[64:67], v[32:35], a[4:7]
    ds_read_b128 v[24:27], v1 offset:3072
    v_cvt_pk_bf16_f32 v232, v232, v233
    v_mfma_f32_16x16x32_bf16 a[4:7], v[80:83], v[36:39], a[4:7]
L_pg6:
    s_cbranch_execz L_pg10
    buffer_load_dwordx2 v[62:63], v10, s[76:79], s36 offen offset:192
    v_mfma_f32_16x16x32_bf16 a[52:55], v[68:71], v[32:35], a[52:55]
    v_exp_f32 v19, v171
    v_mfma_f32_16x16x32_bf16 a[52:55], v[84:87], v[36:39], a[52:55]
    v_cvt_pk_bf16_f32 v168, v16, v17
    v_cvt_f32_i32 v236, v236
    v_mfma_f32_16x16x32_bf16 a[100:103], v[72:75], v[32:35], a[100:103]
    ds_read_b128 v[28:31], v1 offset:15360
    v_cvt_f32_i32 v237, v237
    v_mfma_f32_16x16x32_bf16 a[100:103], v[88:91], v[36:39], a[100:103]
    buffer_load_dwordx4 v[240:243], v9, s[64:67], s33 offen offset:384 nt
    v_mfma_f32_16x16x32_bf16 a[148:151], v[76:79], v[32:35], a[148:151]
    v_exp_f32 v16, v104
    v_mfma_f32_16x16x32_bf16 a[148:151], v[92:95], v[36:39], a[148:151]
    s_waitcnt lgkmcnt(2)
    v_add_f32 v7, v7, v18
    v_add_f32 v7, v7, v19
    v_mfma_f32_16x16x32_bf16 a[8:11], v[64:67], v[40:43], a[8:11]
    ds_read_b128 v[32:35], v1 offset:4096
    v_fma_f32 v236, v236, v48, v50
    v_mfma_f32_16x16x32_bf16 a[8:11], v[80:83], v[44:47], a[8:11]
    buffer_load_dwordx4 v4, s[4:7], s32 offen offset:1024 sc1 lds
    v_mfma_f32_16x16x32_bf16 a[56:59], v[68:71], v[40:43], a[56:59]
    v_exp_f32 v17, v105
    v_mfma_f32_16x16x32_bf16 a[56:59], v[84:87], v[44:47], a[56:59]
    v_cvt_pk_bf16_f32 v169, v18, v19
    v_fma_f32 v237, v237, v49, v51
    v_mfma_f32_16x16x32_bf16 a[104:107], v[72:75], v[40:43], a[104:107]
    ds_read_b128 v[36:39], v1 offset:16384
    v_mfma_f32_16x16x32_bf16 a[104:107], v[88:91], v[44:47], a[104:107]
    buffer_load_dwordx4 v[244:247], v9, s[64:67], s33 offen offset:1920 nt
    v_mfma_f32_16x16x32_bf16 a[152:155], v[76:79], v[40:43], a[152:155]
    v_exp_f32 v18, v106
    v_mfma_f32_16x16x32_bf16 a[152:155], v[92:95], v[44:47], a[152:155]
    s_waitcnt lgkmcnt(2)
    v_add_f32 v7, v7, v16
    v_add_f32 v7, v7, v17
    v_mfma_f32_16x16x32_bf16 a[12:15], v[64:67], v[24:27], a[12:15]
    ds_read_b128 v[40:43], v1 offset:5120
    v_cvt_pk_bf16_f32 v236, v236, v237
    v_mfma_f32_16x16x32_bf16 a[12:15], v[80:83], v[28:31], a[12:15]
    buffer_load_dwordx4 v4, s[4:7], s32 offen offset:2048 sc1 lds
    v_mfma_f32_16x16x32_bf16 a[60:63], v[68:71], v[24:27], a[60:63]
    v_exp_f32 v19, v107
    v_mfma_f32_16x16x32_bf16 a[60:63], v[84:87], v[28:31], a[60:63]
    v_cvt_pk_bf16_f32 v170, v16, v17
    v_exp_f32 v16, v172
    v_mfma_f32_16x16x32_bf16 a[108:111], v[72:75], v[24:27], a[108:111]
    ds_read_b128 v[44:47], v1 offset:17408
    v_add_f32 v7, v7, v18
    v_mfma_f32_16x16x32_bf16 a[108:111], v[88:91], v[28:31], a[108:111]
    buffer_load_dwordx4 v[248:251], v9, s[64:67], s34 offen offset:384 nt
    v_add_f32 v7, v7, v19
    v_mfma_f32_16x16x32_bf16 a[156:159], v[76:79], v[24:27], a[156:159]
    s_add_u32 s29, s28, 49152
    v_exp_f32 v17, v173
    v_mfma_f32_16x16x32_bf16 a[156:159], v[92:95], v[28:31], a[156:159]
    s_waitcnt lgkmcnt(2)
    v_cvt_pk_bf16_f32 v171, v18, v19
    v_lshlrev_b32 v48, 16, v57
    v_mfma_f32_16x16x32_bf16 a[16:19], v[64:67], v[32:35], a[16:19]
    s_sub_u32 s3, s29, 147456
    ds_read_b128 v[24:27], v1 offset:6144
    v_and_b32 v49, s97, v57
    v_mfma_f32_16x16x32_bf16 a[16:19], v[80:83], v[36:39], a[16:19]
    s_add_u32 s32, s32, 24576
    buffer_load_dwordx4 v[252:255], v9, s[64:67], s34 offen offset:1920 nt
    v_mfma_f32_16x16x32_bf16 a[64:67], v[68:71], v[32:35], a[64:67]
    s_min_u32 s29, s29, s3
    v_exp_f32 v18, v174
    v_mfma_f32_16x16x32_bf16 a[64:67], v[84:87], v[36:39], a[64:67]
    v_add_f32 v8, v8, v16
    v_add_f32 v8, v8, v17
    v_mfma_f32_16x16x32_bf16 a[112:115], v[72:75], v[32:35], a[112:115]
    s_add_u32 s26, s26, 12288
    ds_read_b128 v[28:31], v1 offset:18432
    v_lshlrev_b32 v50, 16, v59
    v_mfma_f32_16x16x32_bf16 a[112:115], v[88:91], v[36:39], a[112:115]
    v_exp_f32 v19, v175
    v_cvt_pk_bf16_f32 v172, v16, v17
    v_mfma_f32_16x16x32_bf16 a[160:163], v[76:79], v[32:35], a[160:163]
    v_exp_f32 v16, v108
    v_mfma_f32_16x16x32_bf16 a[160:163], v[92:95], v[36:39], a[160:163]
    s_waitcnt lgkmcnt(2)
    v_add_f32 v8, v8, v18
    v_add_f32 v8, v8, v19
    v_mfma_f32_16x16x32_bf16 a[20:23], v[64:67], v[40:43], a[20:23]
    s_sub_u32 s3, s29, s28
    ds_read_b128 v[32:35], v1 offset:7168
    v_and_b32 v51, s97, v59
    v_mfma_f32_16x16x32_bf16 a[20:23], v[80:83], v[44:47], a[20:23]
    v_exp_f32 v17, v109
    v_mfma_f32_16x16x32_bf16 a[68:71], v[68:71], v[40:43], a[68:71]
    s_mov_b32 m0, s26
    v_cvt_pk_bf16_f32 v173, v18, v19
    v_mul_f32 v48, s38, v48
    v_mfma_f32_16x16x32_bf16 a[68:71], v[84:87], v[44:47], a[68:71]
    v_exp_f32 v18, v110
    v_mfma_f32_16x16x32_bf16 a[116:119], v[72:75], v[40:43], a[116:119]
    ds_read_b128 v[36:39], v1 offset:19456
    v_add_f32 v8, v8, v16
    v_mfma_f32_16x16x32_bf16 a[116:119], v[88:91], v[44:47], a[116:119]
    v_add_f32 v8, v8, v17
    v_mul_f32 v49, s38, v49
    v_mfma_f32_16x16x32_bf16 a[164:167], v[76:79], v[40:43], a[164:167]
    s_mov_b32 s28, s29
    v_exp_f32 v19, v111
    v_mfma_f32_16x16x32_bf16 a[164:167], v[92:95], v[44:47], a[164:167]
    s_waitcnt lgkmcnt(2)
    v_cvt_pk_bf16_f32 v174, v16, v17
    v_add_f32 v8, v8, v18
    v_mfma_f32_16x16x32_bf16 a[24:27], v[64:67], v[24:27], a[24:27]
    ds_read_b128 v[40:43], v1 offset:8192
    v_add_f32 v8, v8, v19
    v_mfma_f32_16x16x32_bf16 a[24:27], v[80:83], v[28:31], a[24:27]
    v_cvt_pk_bf16_f32 v175, v18, v19
    v_mul_f32_e64 v50, -v50, v48
    v_mfma_f32_16x16x32_bf16 a[72:75], v[68:71], v[24:27], a[72:75]
    v_exp_f32 v16, v176
    v_mfma_f32_16x16x32_bf16 a[72:75], v[84:87], v[28:31], a[72:75]
    buffer_load_dwordx4 v4, s[4:7], s32 offen offset:0 sc1 lds
    v_mfma_f32_16x16x32_bf16 a[120:123], v[72:75], v[24:27], a[120:123]
    ds_read_b128 v[44:47], v1 offset:20480
    v_mfma_f32_16x16x32_bf16 a[120:123], v[88:91], v[28:31], a[120:123]
    v_exp_f32 v17, v177
    v_mfma_f32_16x16x32_bf16 a[168:171], v[76:79], v[24:27], a[168:171]
    v_exp_f32 v18, v178
    v_mfma_f32_16x16x32_bf16 a[168:171], v[92:95], v[28:31], a[168:171]
    s_waitcnt lgkmcnt(2)
    v_add_f32 v5, v5, v16
    v_add_f32 v5, v5, v17
    v_mfma_f32_16x16x32_bf16 a[28:31], v[64:67], v[32:35], a[28:31]
    ds_read_b128 v[24:27], v1 offset:9216
    v_mul_f32_e64 v51, -v51, v49
    v_mfma_f32_16x16x32_bf16 a[28:31], v[80:83], v[36:39], a[28:31]
    v_exp_f32 v19, v179
    v_mfma_f32_16x16x32_bf16 a[76:79], v[68:71], v[32:35], a[76:79]
    v_cvt_pk_bf16_f32 v176, v16, v17
    v_add_u32 v2, s3, v2
    v_mfma_f32_16x16x32_bf16 a[76:79], v[84:87], v[36:39], a[76:79]
    v_exp_f32 v16, v112
    v_mfma_f32_16x16x32_bf16 a[124:127], v[72:75], v[32:35], a[124:127]
    ds_read_b128 v[28:31], v1 offset:21504
    v_add_f32 v5, v5, v18
    v_mfma_f32_16x16x32_bf16 a[124:127], v[88:91], v[36:39], a[124:127]
    v_add_f32 v5, v5, v19
    v_cvt_f32_i32 v226, v226
    v_mfma_f32_16x16x32_bf16 a[172:175], v[76:79], v[32:35], a[172:175]
    v_exp_f32 v17, v113
    v_mfma_f32_16x16x32_bf16 a[172:175], v[92:95], v[36:39], a[172:175]
    s_waitcnt lgkmcnt(2)
    buffer_load_dwordx4 v4, s[4:7], s32 offen offset:1024 sc1 lds
    v_mfma_f32_16x16x32_bf16 a[32:35], v[64:67], v[40:43], a[32:35]
    ds_read_b128 v[32:35], v1 offset:10240
    v_cvt_pk_bf16_f32 v177, v18, v19
    v_mfma_f32_16x16x32_bf16 a[32:35], v[80:83], v[44:47], a[32:35]
    v_exp_f32 v18, v114
    v_mfma_f32_16x16x32_bf16 a[80:83], v[68:71], v[40:43], a[80:83]
    v_add_f32 v5, v5, v16
    v_add_f32 v5, v5, v17
    v_mfma_f32_16x16x32_bf16 a[80:83], v[84:87], v[44:47], a[80:83]
    v_exp_f32 v19, v115
    v_mfma_f32_16x16x32_bf16 a[128:131], v[72:75], v[40:43], a[128:131]
    ds_read_b128 v[36:39], v1 offset:22528
    v_cvt_pk_bf16_f32 v178, v16, v17
    v_mfma_f32_16x16x32_bf16 a[128:131], v[88:91], v[44:47], a[128:131]
    v_exp_f32 v16, v180
    v_mfma_f32_16x16x32_bf16 a[176:179], v[76:79], v[40:43], a[176:179]
    v_cvt_f32_i32 v227, v227
    v_add_u32 v3, s3, v3
    v_mfma_f32_16x16x32_bf16 a[176:179], v[92:95], v[44:47], a[176:179]
    s_waitcnt lgkmcnt(2)
    v_add_f32 v5, v5, v18
    v_add_f32 v5, v5, v19
    v_mfma_f32_16x16x32_bf16 a[36:39], v[64:67], v[24:27], a[36:39]
    ds_read_b128 v[40:43], v1 offset:11264
    v_fma_f32 v226, v226, v48, v50
    v_mfma_f32_16x16x32_bf16 a[36:39], v[80:83], v[28:31], a[36:39]
    buffer_load_dwordx4 v4, s[4:7], s32 offen offset:2048 sc1 lds
    v_mfma_f32_16x16x32_bf16 a[84:87], v[68:71], v[24:27], a[84:87]
    v_exp_f32 v17, v181
    v_mfma_f32_16x16x32_bf16 a[84:87], v[84:87], v[28:31], a[84:87]
    v_cvt_pk_bf16_f32 v179, v18, v19
    v_fma_f32 v227, v227, v49, v51
    v_mfma_f32_16x16x32_bf16 a[132:135], v[72:75], v[24:27], a[132:135]
    ds_read_b128 v[44:47], v1 offset:23552
    v_cvt_pk_bf16_f32 v225, v226, v227
    v_mfma_f32_16x16x32_bf16 a[132:135], v[88:91], v[28:31], a[132:135]
    s_waitcnt lgkmcnt(2)
    v_exp_f32 v18, v182
    v_mfma_f32_16x16x32_bf16 a[180:183], v[76:79], v[24:27], a[180:183]
    s_waitcnt vmcnt(13)
    v_add_f32 v6, v6, v16
    v_add_f32 v6, v6, v17
    v_mfma_f32_16x16x32_bf16 a[180:183], v[92:95], v[28:31], a[180:183]
    s_barrier
    v_cvt_f32_i32 v230, v230
    v_mfma_f32_16x16x32_bf16 a[40:43], v[64:67], v[32:35], a[40:43]
    ds_read_b128 v[24:27], v2 offset:0
    v_mfma_f32_16x16x32_bf16 a[40:43], v[80:83], v[36:39], a[40:43]
    v_exp_f32 v19, v183
    v_mfma_f32_16x16x32_bf16 a[88:91], v[68:71], v[32:35], a[88:91]
    v_cvt_pk_bf16_f32 v180, v16, v17
    v_cvt_f32_i32 v231, v231
    v_mfma_f32_16x16x32_bf16 a[88:91], v[84:87], v[36:39], a[88:91]
    v_exp_f32 v16, v116
    v_mfma_f32_16x16x32_bf16 a[136:139], v[72:75], v[32:35], a[136:139]
    ds_read_b128 v[28:31], v3 offset:0
    v_add_f32 v6, v6, v18
    v_mfma_f32_16x16x32_bf16 a[136:139], v[88:91], v[36:39], a[136:139]
    v_add_f32 v6, v6, v19
    v_fma_f32 v230, v230, v48, v50
    v_mfma_f32_16x16x32_bf16 a[184:187], v[76:79], v[32:35], a[184:187]
    v_exp_f32 v17, v117
    v_mfma_f32_16x16x32_bf16 a[184:187], v[92:95], v[36:39], a[184:187]
    s_waitcnt lgkmcnt(2)
    v_cvt_pk_bf16_f32 v181, v18, v19
    v_mfma_f32_16x16x32_bf16 a[44:47], v[64:67], v[40:43], a[44:47]
    ds_read_b128 v[32:35], v2 offset:6144
    v_mfma_f32_16x16x32_bf16 a[44:47], v[80:83], v[44:47], a[44:47]
    v_exp_f32 v18, v118
    v_mfma_f32_16x16x32_bf16 a[92:95], v[68:71], v[40:43], a[92:95]
    v_add_f32 v6, v6, v16
    v_add_f32 v6, v6, v17
    v_mfma_f32_16x16x32_bf16 a[92:95], v[84:87], v[44:47], a[92:95]
    s_add_u32 s32, s32, 24576
    v_exp_f32 v19, v119
    v_mfma_f32_16x16x32_bf16 a[140:143], v[72:75], v[40:43], a[140:143]
    s_add_u32 s26, s26, 36864
    ds_read_b128 v[36:39], v3 offset:6144
    v_cvt_pk_bf16_f32 v182, v16, v17
    v_mfma_f32_16x16x32_bf16 a[140:143], v[88:91], v[44:47], a[140:143]
    s_sub_u32 s57, s26, 147456
    v_add_f32 v6, v6, v18
    v_add_f32 v6, v6, v19
    v_mfma_f32_16x16x32_bf16 a[188:191], v[76:79], v[40:43], a[188:191]
    s_min_u32 s26, s26, s57
    v_cvt_pk_bf16_f32 v183, v18, v19
    v_mfma_f32_16x16x32_bf16 a[188:191], v[92:95], v[44:47], a[188:191]
    s_waitcnt lgkmcnt(2)
    v_mfma_f32_16x16x32_bf16 v[64:67], v[24:27], a[192:195], v[128:131]
    ds_read_b128 v[40:43], v2 offset:128
    v_fma_f32 v231, v231, v49, v51
    v_mfma_f32_16x16x32_bf16 v[64:67], v[28:31], a[196:199], v[64:67]
    v_exp_f32 v16, v184
    v_mfma_f32_16x16x32_bf16 v[68:71], v[24:27], a[216:219], v[132:135]
    v_exp_f32 v17, v185
    v_mfma_f32_16x16x32_bf16 v[68:71], v[28:31], a[220:223], v[68:71]
    v_bfe_u32 v53, v4, 4, 6
    v_cvt_pk_bf16_f32 v229, v230, v231
    v_mfma_f32_16x16x32_bf16 v[72:75], v[24:27], a[240:243], v[136:139]
    ds_read_b128 v[44:47], v3 offset:128
    v_lshlrev_b32 v53, 2, v53
    v_mfma_f32_16x16x32_bf16 v[72:75], v[28:31], a[244:247], v[72:75]
    buffer_load_dword v52, v53, s[20:23], s44 offen sc1
    v_mfma_f32_16x16x32_bf16 v[76:79], v[24:27], v[200:203], v[140:143]
    v_exp_f32 v18, v186
    v_mfma_f32_16x16x32_bf16 v[76:79], v[28:31], v[204:207], v[76:79]
    s_waitcnt lgkmcnt(2)
    v_add_f32 v7, v7, v16
    v_add_f32 v7, v7, v17
    v_mfma_f32_16x16x32_bf16 v[96:99], v[32:35], a[192:195], v[128:131]
    ds_read_b128 v[24:27], v2 offset:6272
    v_cvt_f32_i32 v234, v234
    v_mfma_f32_16x16x32_bf16 v[96:99], v[36:39], a[196:199], v[96:99]
    v_exp_f32 v19, v187
    v_mfma_f32_16x16x32_bf16 v[100:103], v[32:35], a[216:219], v[132:135]
    v_cvt_pk_bf16_f32 v184, v16, v17
    v_cvt_f32_i32 v235, v235
    v_mfma_f32_16x16x32_bf16 v[100:103], v[36:39], a[220:223], v[100:103]
    s_add_u32 s35, s35, 196608
    v_exp_f32 v16, v120
    v_mfma_f32_16x16x32_bf16 v[104:107], v[32:35], a[240:243], v[136:139]
    s_mov_b32 m0, s26
    ds_read_b128 v[28:31], v3 offset:6272
    v_add_f32 v7, v7, v18
    v_mfma_f32_16x16x32_bf16 v[104:107], v[36:39], a[244:247], v[104:107]
    s_add_u32 s16, s16, 196608
    buffer_load_dwordx4 v4, s[4:7], s32 offen offset:0 sc1 lds
    v_mfma_f32_16x16x32_bf16 v[108:111], v[32:35], v[200:203], v[140:143]
    s_add_u32 s17, s17, 196608
    v_add_f32 v7, v7, v19
    v_fma_f32 v234, v234, v48, v50
    v_mfma_f32_16x16x32_bf16 v[108:111], v[36:39], v[204:207], v[108:111]
    s_waitcnt lgkmcnt(2)
    v_exp_f32 v17, v121
    v_mfma_f32_16x16x32_bf16 v[64:67], v[40:43], a[200:203], v[64:67]
    s_add_u32 s37, s37, 512
    ds_read_b128 v[32:35], v2 offset:256
    v_cvt_pk_bf16_f32 v185, v18, v19
    v_mfma_f32_16x16x32_bf16 v[64:67], v[44:47], a[204:207], v[64:67]
    v_exp_f32 v18, v122
    v_mfma_f32_16x16x32_bf16 v[68:71], v[40:43], a[224:227], v[68:71]
    v_add_f32 v7, v7, v16
    v_add_f32 v7, v7, v17
    v_mfma_f32_16x16x32_bf16 v[68:71], v[44:47], a[228:231], v[68:71]
    v_exp_f32 v19, v123
    v_mfma_f32_16x16x32_bf16 v[72:75], v[40:43], a[248:251], v[72:75]
    ds_read_b128 v[36:39], v3 offset:256
    v_cvt_pk_bf16_f32 v186, v16, v17
    v_mfma_f32_16x16x32_bf16 v[72:75], v[44:47], a[252:255], v[72:75]
    buffer_load_dwordx4 v4, s[4:7], s32 offen offset:1024 sc1 lds
    v_mfma_f32_16x16x32_bf16 v[76:79], v[40:43], v[208:211], v[76:79]
    v_exp_f32 v16, v188
    v_mfma_f32_16x16x32_bf16 v[76:79], v[44:47], v[212:215], v[76:79]
    s_waitcnt lgkmcnt(2)
    v_add_f32 v7, v7, v18
    v_add_f32 v7, v7, v19
    v_mfma_f32_16x16x32_bf16 v[96:99], v[24:27], a[200:203], v[96:99]
    ds_read_b128 v[40:43], v2 offset:6400
    v_fma_f32 v235, v235, v49, v51
    v_mfma_f32_16x16x32_bf16 v[96:99], v[28:31], a[204:207], v[96:99]
    buffer_load_dwordx2 v[56:57], off, s[80:83], s37 offset:0
    v_mfma_f32_16x16x32_bf16 v[100:103], v[24:27], a[224:227], v[100:103]
    v_exp_f32 v17, v189
    v_mfma_f32_16x16x32_bf16 v[100:103], v[28:31], a[228:231], v[100:103]
    v_cvt_pk_bf16_f32 v187, v18, v19
    v_cvt_pk_bf16_f32 v233, v234, v235
    v_mfma_f32_16x16x32_bf16 v[104:107], v[24:27], a[248:251], v[104:107]
    ds_read_b128 v[44:47], v3 offset:6400
    v_cvt_f32_i32 v238, v238
    v_mfma_f32_16x16x32_bf16 v[104:107], v[28:31], a[252:255], v[104:107]
    buffer_load_dwordx2 v[58:59], off, s[84:87], s37 offset:0
    v_mfma_f32_16x16x32_bf16 v[108:111], v[24:27], v[208:211], v[108:111]
    s_add_u32 s29, s30, 49152
    v_exp_f32 v18, v190
    v_mfma_f32_16x16x32_bf16 v[108:111], v[28:31], v[212:215], v[108:111]
    s_waitcnt lgkmcnt(2)
    v_add_f32 v8, v8, v16
    v_add_f32 v8, v8, v17
    v_mfma_f32_16x16x32_bf16 v[64:67], v[32:35], a[208:211], v[64:67]
    s_sub_u32 s3, s29, 147456
    ds_read_b128 v[24:27], v2 offset:12288
    v_mfma_f32_16x16x32_bf16 v[64:67], v[36:39], a[212:215], v[64:67]
    s_min_u32 s29, s29, s3
    buffer_load_dwordx4 v4, s[4:7], s32 offen offset:2048 sc1 lds
    v_mfma_f32_16x16x32_bf16 v[68:71], v[32:35], a[232:235], v[68:71]
    v_exp_f32 v19, v191
    v_mfma_f32_16x16x32_bf16 v[68:71], v[36:39], a[236:239], v[68:71]
    v_cvt_pk_bf16_f32 v188, v16, v17
    v_cvt_f32_i32 v239, v239
    v_mfma_f32_16x16x32_bf16 v[72:75], v[32:35], v[192:195], v[72:75]
    ds_read_b128 v[28:31], v3 offset:12288
    v_mfma_f32_16x16x32_bf16 v[72:75], v[36:39], v[196:199], v[72:75]
    buffer_load_dwordx3 v[144:146], v12, s[68:71], s35 offen offset:0 nt
    v_mfma_f32_16x16x32_bf16 v[76:79], v[32:35], v[216:219], v[76:79]
    v_exp_f32 v16, v124
    v_mfma_f32_16x16x32_bf16 v[76:79], v[36:39], v[220:223], v[76:79]
    s_waitcnt lgkmcnt(2)
    v_add_f32 v8, v8, v18
    v_add_f32 v8, v8, v19
    v_mfma_f32_16x16x32_bf16 v[96:99], v[40:43], a[208:211], v[96:99]
    s_add_u32 s32, s32, 24576
    ds_read_b128 v[32:35], v2 offset:18432
    v_fma_f32 v238, v238, v48, v50
    v_mfma_f32_16x16x32_bf16 v[96:99], v[44:47], a[212:215], v[96:99]
    s_sub_u32 s3, s29, s30
    v_exp_f32 v17, v125
    v_mfma_f32_16x16x32_bf16 v[100:103], v[40:43], a[232:235], v[100:103]
    v_cvt_pk_bf16_f32 v189, v18, v19
    v_mfma_f32_16x16x32_bf16 v[100:103], v[44:47], a[236:239], v[100:103]
    v_exp_f32 v18, v126
    v_mfma_f32_16x16x32_bf16 v[104:107], v[40:43], v[192:195], v[104:107]
    s_add_u32 s26, s26, 12288
    ds_read_b128 v[36:39], v3 offset:18432
    v_add_f32 v8, v8, v16
    v_mfma_f32_16x16x32_bf16 v[104:107], v[44:47], v[196:199], v[104:107]
    buffer_load_dwordx3 v[148:150], v12, s[68:71], s35 offen offset:768 nt
    v_mfma_f32_16x16x32_bf16 v[108:111], v[40:43], v[216:219], v[108:111]
    v_add_f32 v8, v8, v17
    v_fma_f32 v239, v239, v49, v51
    v_mfma_f32_16x16x32_bf16 v[108:111], v[44:47], v[220:223], v[108:111]
    s_waitcnt lgkmcnt(2)
    v_exp_f32 v19, v127
    v_mfma_f32_16x16x32_bf16 v[80:83], v[24:27], a[192:195], v[128:131]
    ds_read_b128 v[40:43], v2 offset:12416
    v_cvt_pk_bf16_f32 v190, v16, v17
    v_mfma_f32_16x16x32_bf16 v[80:83], v[28:31], a[196:199], v[80:83]
    s_mov_b32 m0, s26
    v_add_f32 v8, v8, v18
    v_add_f32 v8, v8, v19
    v_mfma_f32_16x16x32_bf16 v[84:87], v[24:27], a[216:219], v[132:135]
    s_mov_b32 s30, s29
    v_cvt_pk_bf16_f32 v191, v18, v19
    v_cvt_pk_bf16_f32 v237, v238, v239
    v_mfma_f32_16x16x32_bf16 v[84:87], v[28:31], a[220:223], v[84:87]
    v_exp_f32 v16, v64
    v_mfma_f32_16x16x32_bf16 v[88:91], v[24:27], a[240:243], v[136:139]
    ds_read_b128 v[44:47], v3 offset:12416
    v_mfma_f32_16x16x32_bf16 v[88:91], v[28:31], a[244:247], v[88:91]
    buffer_load_dwordx3 v[152:154], v12, s[68:71], s35 offen offset:1536 nt
    v_mfma_f32_16x16x32_bf16 v[92:95], v[24:27], v[200:203], v[140:143]
    v_exp_f32 v17, v65
    v_mfma_f32_16x16x32_bf16 v[92:95], v[28:31], v[204:207], v[92:95]
    s_waitcnt lgkmcnt(2)
    v_exp_f32 v18, v66
    v_mfma_f32_16x16x32_bf16 v[112:115], v[32:35], a[192:195], v[128:131]
    ds_read_b128 v[24:27], v2 offset:18560
    v_add_f32 v5, v5, v16
    v_mfma_f32_16x16x32_bf16 v[112:115], v[36:39], a[196:199], v[112:115]
    buffer_load_dwordx4 v4, s[4:7], s32 offen offset:0 sc1 lds
    v_mfma_f32_16x16x32_bf16 v[116:119], v[32:35], a[216:219], v[132:135]
    v_add_f32 v5, v5, v17
    v_add_u32 v1, s3, v1
    v_mfma_f32_16x16x32_bf16 v[116:119], v[36:39], a[220:223], v[116:119]
    v_exp_f32 v19, v67
    v_mfma_f32_16x16x32_bf16 v[120:123], v[32:35], a[240:243], v[136:139]
    ds_read_b128 v[28:31], v3 offset:18560
    v_cvt_pk_bf16_f32 v64, v16, v17
    v_mfma_f32_16x16x32_bf16 v[120:123], v[36:39], a[244:247], v[120:123]
    s_waitcnt vmcnt(13)
    buffer_load_dwordx3 v[156:158], v12, s[68:71], s35 offen offset:2304 nt
    v_mfma_f32_16x16x32_bf16 v[124:127], v[32:35], v[200:203], v[140:143]
    v_exp_f32 v16, v96
    v_mfma_f32_16x16x32_bf16 v[124:127], v[36:39], v[204:207], v[124:127]
    s_waitcnt lgkmcnt(2)
    v_add_f32 v5, v5, v18
    v_add_f32 v5, v5, v19
    v_mfma_f32_16x16x32_bf16 v[80:83], v[40:43], a[200:203], v[80:83]
    ds_read_b128 v[32:35], v2 offset:12544
    v_lshlrev_b32 v48, 16, v60
    v_mfma_f32_16x16x32_bf16 v[80:83], v[44:47], a[204:207], v[80:83]
    v_exp_f32 v17, v97
    v_mfma_f32_16x16x32_bf16 v[84:87], v[40:43], a[224:227], v[84:87]
    v_cvt_pk_bf16_f32 v65, v18, v19
    v_and_b32 v49, s97, v60
    v_mfma_f32_16x16x32_bf16 v[84:87], v[44:47], a[228:231], v[84:87]
    buffer_load_dwordx4 v4, s[4:7], s32 offen offset:1024 sc1 lds
    v_mfma_f32_16x16x32_bf16 v[88:91], v[40:43], a[248:251], v[88:91]
    ds_read_b128 v[36:39], v3 offset:12544
    v_mfma_f32_16x16x32_bf16 v[88:91], v[44:47], a[252:255], v[88:91]
    v_exp_f32 v18, v98
    v_mfma_f32_16x16x32_bf16 v[92:95], v[40:43], v[208:211], v[92:95]
    v_add_f32 v5, v5, v16
    v_add_f32 v5, v5, v17
    v_mfma_f32_16x16x32_bf16 v[92:95], v[44:47], v[212:215], v[92:95]
    s_waitcnt lgkmcnt(2)
    v_exp_f32 v19, v99
    v_mfma_f32_16x16x32_bf16 v[112:115], v[24:27], a[200:203], v[112:115]
    ds_read_b128 v[40:43], v2 offset:18688
    v_cvt_pk_bf16_f32 v66, v16, v17
    v_mfma_f32_16x16x32_bf16 v[112:115], v[28:31], a[204:207], v[112:115]
    v_exp_f32 v16, v68
    v_mfma_f32_16x16x32_bf16 v[116:119], v[24:27], a[224:227], v[116:119]
    v_add_f32 v5, v5, v18
    v_add_f32 v5, v5, v19
    v_mfma_f32_16x16x32_bf16 v[116:119], v[28:31], a[228:231], v[116:119]
    v_exp_f32 v17, v69
    v_mfma_f32_16x16x32_bf16 v[120:123], v[24:27], a[248:251], v[120:123]
    ds_read_b128 v[44:47], v3 offset:18688
    v_cvt_pk_bf16_f32 v67, v18, v19
    v_mfma_f32_16x16x32_bf16 v[120:123], v[28:31], a[252:255], v[120:123]
    s_waitcnt lgkmcnt(2)
    buffer_load_dwordx4 v4, s[4:7], s32 offen offset:2048 sc1 lds
    v_mfma_f32_16x16x32_bf16 v[124:127], v[24:27], v[208:211], v[124:127]
    s_waitcnt vmcnt(13)
    v_exp_f32 v18, v70
    v_mfma_f32_16x16x32_bf16 v[124:127], v[28:31], v[212:215], v[124:127]
    s_barrier
    v_add_f32 v6, v6, v16
    v_mfma_f32_16x16x32_bf16 v[80:83], v[32:35], a[208:211], v[80:83]
    ds_read_b128 v[24:27], v1 offset:0
    v_add_f32 v6, v6, v17
    v_mfma_f32_16x16x32_bf16 v[80:83], v[36:39], a[212:215], v[80:83]
    v_exp_f32 v19, v71
    v_mfma_f32_16x16x32_bf16 v[84:87], v[32:35], a[232:235], v[84:87]
    v_cvt_pk_bf16_f32 v68, v16, v17
    v_lshlrev_b32 v50, 16, v62
    v_mfma_f32_16x16x32_bf16 v[84:87], v[36:39], a[236:239], v[84:87]
    v_exp_f32 v16, v100
    v_mfma_f32_16x16x32_bf16 v[88:91], v[32:35], v[192:195], v[88:91]
    ds_read_b128 v[28:31], v1 offset:12288
    v_add_f32 v6, v6, v18
    v_mfma_f32_16x16x32_bf16 v[88:91], v[36:39], v[196:199], v[88:91]
    v_add_f32 v6, v6, v19
    v_and_b32 v51, s97, v62
    v_mfma_f32_16x16x32_bf16 v[92:95], v[32:35], v[216:219], v[92:95]
    v_exp_f32 v17, v101
    v_mfma_f32_16x16x32_bf16 v[92:95], v[36:39], v[220:223], v[92:95]
    s_waitcnt lgkmcnt(2)
    v_cvt_pk_bf16_f32 v69, v18, v19
    v_mfma_f32_16x16x32_bf16 v[112:115], v[40:43], a[208:211], v[112:115]
    ds_read_b128 v[32:35], v1 offset:1024
    v_mfma_f32_16x16x32_bf16 v[112:115], v[44:47], a[212:215], v[112:115]
    v_exp_f32 v18, v102
    v_mfma_f32_16x16x32_bf16 v[116:119], v[40:43], a[232:235], v[116:119]
    v_add_f32 v6, v6, v16
    v_add_f32 v6, v6, v17
    v_mfma_f32_16x16x32_bf16 v[116:119], v[44:47], a[236:239], v[116:119]
    v_exp_f32 v19, v103
    v_mfma_f32_16x16x32_bf16 v[120:123], v[40:43], v[192:195], v[120:123]
    ds_read_b128 v[36:39], v1 offset:13312
    v_cvt_pk_bf16_f32 v70, v16, v17
    v_mfma_f32_16x16x32_bf16 v[120:123], v[44:47], v[196:199], v[120:123]
    s_add_u32 s32, s32, 24576
    v_add_f32 v6, v6, v18
    s_add_u32 s26, s26, 36864
    v_mfma_f32_16x16x32_bf16 v[124:127], v[40:43], v[216:219], v[124:127]
    s_sub_u32 s57, s26, 147456
    v_add_f32 v6, v6, v19
    v_cvt_pk_bf16_f32 v71, v18, v19
    v_mfma_f32_16x16x32_bf16 v[124:127], v[44:47], v[220:223], v[124:127]
    s_waitcnt lgkmcnt(2)
    s_min_u32 s26, s26, s57
    v_mfma_f32_16x16x32_bf16 a[0:3], v[160:163], v[24:27], a[0:3]
    ds_read_b128 v[40:43], v1 offset:2048
    v_mul_f32 v48, s38, v48
    v_mfma_f32_16x16x32_bf16 a[0:3], v[176:179], v[28:31], a[0:3]
    s_waitcnt vmcnt(12)
    v_subrev_u32 v52, s92, v52
    v_cmp_lt_u32 vcc, 15, v52
    v_mfma_f32_16x16x32_bf16 a[48:51], v[164:167], v[24:27], a[48:51]
    v_exp_f32 v16, v72
    v_mfma_f32_16x16x32_bf16 a[48:51], v[180:183], v[28:31], a[48:51]
    v_exp_f32 v17, v73
    v_mfma_f32_16x16x32_bf16 a[96:99], v[168:171], v[24:27], a[96:99]
    s_and_b32 s59, vcc_lo, 0xff
    ds_read_b128 v[44:47], v1 offset:14336
    v_mul_f32 v49, s38, v49
    v_mfma_f32_16x16x32_bf16 a[96:99], v[184:187], v[28:31], a[96:99]
    s_cbranch_scc1 L_pollslow2
L_pollok2:
    v_mfma_f32_16x16x32_bf16 a[144:147], v[172:175], v[24:27], a[144:147]
    s_add_u32 s92, s92, 1
    v_exp_f32 v18, v74
    v_mfma_f32_16x16x32_bf16 a[144:147], v[188:191], v[28:31], a[144:147]
    s_waitcnt lgkmcnt(2)
    v_add_f32 v7, v7, v16
    v_add_f32 v7, v7, v17
    v_mfma_f32_16x16x32_bf16 a[4:7], v[160:163], v[32:35], a[4:7]
    s_mov_b32 m0, s56
    ds_read_b128 v[24:27], v1 offset:3072
    v_mul_f32_e64 v50, -v50, v48
    v_mfma_f32_16x16x32_bf16 a[4:7], v[176:179], v[36:39], a[4:7]
    buffer_load_dwordx4 v4, s[4:7], s27 offen offset:0 sc1 lds
    v_mfma_f32_16x16x32_bf16 a[52:55], v[164:167], v[32:35], a[52:55]
    v_exp_f32 v19, v75
    v_mfma_f32_16x16x32_bf16 a[52:55], v[180:183], v[36:39], a[52:55]
    v_cvt_pk_bf16_f32 v72, v16, v17
    v_mul_f32_e64 v51, -v51, v49
    v_mfma_f32_16x16x32_bf16 a[100:103], v[168:171], v[32:35], a[100:103]
    ds_read_b128 v[28:31], v1 offset:15360
    v_cvt_f32_i32 v240, v240
    v_mfma_f32_16x16x32_bf16 a[100:103], v[184:187], v[36:39], a[100:103]
    v_exp_f32 v16, v104
    v_mfma_f32_16x16x32_bf16 a[148:151], v[172:175], v[32:35], a[148:151]
    v_add_f32 v7, v7, v18
    v_add_f32 v7, v7, v19
    v_mfma_f32_16x16x32_bf16 a[148:151], v[188:191], v[36:39], a[148:151]
    s_waitcnt lgkmcnt(2)
    v_exp_f32 v17, v105
    v_mfma_f32_16x16x32_bf16 a[8:11], v[160:163], v[40:43], a[8:11]
    ds_read_b128 v[32:35], v1 offset:4096
    v_cvt_pk_bf16_f32 v73, v18, v19
    v_mfma_f32_16x16x32_bf16 a[8:11], v[176:179], v[44:47], a[8:11]
    buffer_load_dwordx4 v4, s[4:7], s27 offen offset:1024 sc1 lds
    v_mfma_f32_16x16x32_bf16 a[56:59], v[164:167], v[40:43], a[56:59]
    v_exp_f32 v18, v106
    v_mfma_f32_16x16x32_bf16 a[56:59], v[180:183], v[44:47], a[56:59]
    v_add_f32 v7, v7, v16
    v_cvt_f32_i32 v241, v241
    v_mfma_f32_16x16x32_bf16 a[104:107], v[168:171], v[40:43], a[104:107]
    ds_read_b128 v[36:39], v1 offset:16384
    v_add_f32 v7, v7, v17
    v_mfma_f32_16x16x32_bf16 a[104:107], v[184:187], v[44:47], a[104:107]
    v_exp_f32 v19, v107
    v_mfma_f32_16x16x32_bf16 a[152:155], v[172:175], v[40:43], a[152:155]
    v_cvt_pk_bf16_f32 v74, v16, v17
    v_fma_f32 v240, v240, v48, v50
    v_mfma_f32_16x16x32_bf16 a[152:155], v[188:191], v[44:47], a[152:155]
    s_waitcnt lgkmcnt(2)
    v_exp_f32 v16, v76
    v_mfma_f32_16x16x32_bf16 a[12:15], v[160:163], v[24:27], a[12:15]
    ds_read_b128 v[40:43], v1 offset:5120
    v_add_f32 v7, v7, v18
    v_mfma_f32_16x16x32_bf16 a[12:15], v[176:179], v[28:31], a[12:15]
    buffer_load_dwordx4 v4, s[4:7], s27 offen offset:2048 sc1 lds
    v_mfma_f32_16x16x32_bf16 a[60:63], v[164:167], v[24:27], a[60:63]
    v_add_f32 v7, v7, v19
    v_fma_f32 v241, v241, v49, v51
    v_mfma_f32_16x16x32_bf16 a[60:63], v[180:183], v[28:31], a[60:63]
    v_exp_f32 v17, v77
    v_mfma_f32_16x16x32_bf16 a[108:111], v[168:171], v[24:27], a[108:111]
    ds_read_b128 v[44:47], v1 offset:17408
    v_cvt_pk_bf16_f32 v75, v18, v19
    v_mfma_f32_16x16x32_bf16 a[108:111], v[184:187], v[28:31], a[108:111]
    v_exp_f32 v18, v78
    v_mfma_f32_16x16x32_bf16 a[156:159], v[172:175], v[24:27], a[156:159]
    s_add_u32 s29, s28, 49152
    v_cvt_pk_bf16_f32 v226, v240, v241
    v_cvt_f32_i32 v244, v244
    v_mfma_f32_16x16x32_bf16 a[156:159], v[188:191], v[28:31], a[156:159]
    s_waitcnt lgkmcnt(2)
    v_add_f32 v8, v8, v16
    v_add_f32 v8, v8, v17
    v_mfma_f32_16x16x32_bf16 a[16:19], v[160:163], v[32:35], a[16:19]
    s_sub_u32 s3, s29, 147456
    ds_read_b128 v[24:27], v1 offset:6144
    v_cvt_f32_i32 v245, v245
    v_mfma_f32_16x16x32_bf16 a[16:19], v[176:179], v[36:39], a[16:19]
    s_add_u32 s27, s27, 24576
    v_exp_f32 v19, v79
    v_mfma_f32_16x16x32_bf16 a[64:67], v[164:167], v[32:35], a[64:67]
    s_min_u32 s29, s29, s3
    v_cvt_pk_bf16_f32 v76, v16, v17
    v_fma_f32 v244, v244, v48, v50
    v_mfma_f32_16x16x32_bf16 a[64:67], v[180:183], v[36:39], a[64:67]
    s_add_u32 s56, s56, 12288
    v_exp_f32 v16, v108
    v_mfma_f32_16x16x32_bf16 a[112:115], v[168:171], v[32:35], a[112:115]
    ds_read_b128 v[28:31], v1 offset:18432
    v_add_f32 v8, v8, v18
    v_mfma_f32_16x16x32_bf16 a[112:115], v[184:187], v[36:39], a[112:115]
    v_add_f32 v8, v8, v19
    v_fma_f32 v245, v245, v49, v51
    v_mfma_f32_16x16x32_bf16 a[160:163], v[172:175], v[32:35], a[160:163]
    v_exp_f32 v17, v109
    v_mfma_f32_16x16x32_bf16 a[160:163], v[188:191], v[36:39], a[160:163]
    s_waitcnt lgkmcnt(2)
    v_cvt_pk_bf16_f32 v230, v244, v245
    v_cvt_pk_bf16_f32 v77, v18, v19
    v_mfma_f32_16x16x32_bf16 a[20:23], v[160:163], v[40:43], a[20:23]
    s_mov_b32 m0, s56
    ds_read_b128 v[32:35], v1 offset:7168
    v_cvt_f32_i32 v248, v248
    v_mfma_f32_16x16x32_bf16 a[20:23], v[176:179], v[44:47], a[20:23]
L_pg7:
    s_cbranch_execz L_iwret
    s_sub_u32 s3, s29, s28
    v_exp_f32 v18, v110
    v_mfma_f32_16x16x32_bf16 a[68:71], v[164:167], v[40:43], a[68:71]
    v_add_f32 v8, v8, v16
    v_add_f32 v8, v8, v17
    v_mfma_f32_16x16x32_bf16 a[68:71], v[180:183], v[44:47], a[68:71]
    v_exp_f32 v19, v111
    v_mfma_f32_16x16x32_bf16 a[116:119], v[168:171], v[40:43], a[116:119]
    ds_read_b128 v[36:39], v1 offset:19456
    v_cvt_f32_i32 v249, v249
    v_mfma_f32_16x16x32_bf16 a[116:119], v[184:187], v[44:47], a[116:119]
    buffer_load_dwordx4 v4, s[4:7], s27 offen offset:0 sc1 lds
    v_mfma_f32_16x16x32_bf16 a[164:167], v[172:175], v[40:43], a[164:167]
    s_mov_b32 s28, s29
    v_cvt_pk_bf16_f32 v78, v16, v17
    v_add_f32 v8, v8, v18
    v_mfma_f32_16x16x32_bf16 a[164:167], v[188:191], v[44:47], a[164:167]
    s_waitcnt lgkmcnt(2)
    v_add_f32 v8, v8, v19
    v_fma_f32 v248, v248, v48, v50
    v_mfma_f32_16x16x32_bf16 a[24:27], v[160:163], v[24:27], a[24:27]
    ds_read_b128 v[40:43], v1 offset:8192
    v_cvt_pk_bf16_f32 v79, v18, v19
    v_mfma_f32_16x16x32_bf16 a[24:27], v[176:179], v[28:31], a[24:27]
    v_exp_f32 v16, v80
    v_mfma_f32_16x16x32_bf16 a[72:75], v[164:167], v[24:27], a[72:75]
    v_fma_f32 v249, v249, v49, v51
    v_cvt_pk_bf16_f32 v234, v248, v249
    v_mfma_f32_16x16x32_bf16 a[72:75], v[180:183], v[28:31], a[72:75]
    v_exp_f32 v17, v81
    v_mfma_f32_16x16x32_bf16 a[120:123], v[168:171], v[24:27], a[120:123]
    ds_read_b128 v[44:47], v1 offset:20480
    v_cvt_f32_i32 v252, v252
    v_mfma_f32_16x16x32_bf16 a[120:123], v[184:187], v[28:31], a[120:123]
    v_exp_f32 v18, v82
    v_mfma_f32_16x16x32_bf16 a[168:171], v[172:175], v[24:27], a[168:171]
    v_add_f32 v5, v5, v16
    v_add_f32 v5, v5, v17
    v_mfma_f32_16x16x32_bf16 a[168:171], v[188:191], v[28:31], a[168:171]
    s_waitcnt lgkmcnt(2)
    buffer_load_dwordx4 v4, s[4:7], s27 offen offset:1024 sc1 lds
    v_mfma_f32_16x16x32_bf16 a[28:31], v[160:163], v[32:35], a[28:31]
    ds_read_b128 v[24:27], v1 offset:9216
    v_cvt_f32_i32 v253, v253
    v_mfma_f32_16x16x32_bf16 a[28:31], v[176:179], v[36:39], a[28:31]
    v_exp_f32 v19, v83
    v_mfma_f32_16x16x32_bf16 a[76:79], v[164:167], v[32:35], a[76:79]
    v_cvt_pk_bf16_f32 v80, v16, v17
    v_fma_f32 v252, v252, v48, v50
    v_mfma_f32_16x16x32_bf16 a[76:79], v[180:183], v[36:39], a[76:79]
    v_exp_f32 v16, v112
    v_mfma_f32_16x16x32_bf16 a[124:127], v[168:171], v[32:35], a[124:127]
    ds_read_b128 v[28:31], v1 offset:21504
    v_add_f32 v5, v5, v18
    v_mfma_f32_16x16x32_bf16 a[124:127], v[184:187], v[36:39], a[124:127]
    v_add_f32 v5, v5, v19
    v_fma_f32 v253, v253, v49, v51
    v_mfma_f32_16x16x32_bf16 a[172:175], v[172:175], v[32:35], a[172:175]
    v_exp_f32 v17, v113
    v_mfma_f32_16x16x32_bf16 a[172:175], v[188:191], v[36:39], a[172:175]
    s_waitcnt lgkmcnt(2)
    buffer_load_dwordx4 v4, s[4:7], s27 offen offset:2048 sc1 lds
    v_mfma_f32_16x16x32_bf16 a[32:35], v[160:163], v[40:43], a[32:35]
    ds_read_b128 v[32:35], v1 offset:10240
    v_cvt_pk_bf16_f32 v81, v18, v19
    v_mfma_f32_16x16x32_bf16 a[32:35], v[176:179], v[44:47], a[32:35]
    v_exp_f32 v18, v114
    v_mfma_f32_16x16x32_bf16 a[80:83], v[164:167], v[40:43], a[80:83]
    v_add_f32 v5, v5, v16
    v_cvt_pk_bf16_f32 v238, v252, v253
    v_mfma_f32_16x16x32_bf16 a[80:83], v[180:183], v[44:47], a[80:83]
    v_add_f32 v5, v5, v17
    v_lshlrev_b32 v48, 16, v61
    v_mfma_f32_16x16x32_bf16 a[128:131], v[168:171], v[40:43], a[128:131]
    ds_read_b128 v[36:39], v1 offset:22528
    v_add_u32 v2, s3, v2
    v_mfma_f32_16x16x32_bf16 a[128:131], v[184:187], v[44:47], a[128:131]
    v_exp_f32 v19, v115
    v_mfma_f32_16x16x32_bf16 a[176:179], v[172:175], v[40:43], a[176:179]
    v_cvt_pk_bf16_f32 v82, v16, v17
    v_and_b32 v49, s97, v61
    v_mfma_f32_16x16x32_bf16 a[176:179], v[188:191], v[44:47], a[176:179]
    s_waitcnt lgkmcnt(2)
    v_exp_f32 v16, v84
    v_mfma_f32_16x16x32_bf16 a[36:39], v[160:163], v[24:27], a[36:39]
    ds_read_b128 v[40:43], v1 offset:11264
    v_add_f32 v5, v5, v18
    v_mfma_f32_16x16x32_bf16 a[36:39], v[176:179], v[28:31], a[36:39]
    v_add_f32 v5, v5, v19
    v_lshlrev_b32 v50, 16, v63
    v_mfma_f32_16x16x32_bf16 a[84:87], v[164:167], v[24:27], a[84:87]
    v_exp_f32 v17, v85
    v_mfma_f32_16x16x32_bf16 a[84:87], v[180:183], v[28:31], a[84:87]
    s_add_u32 s27, s27, 24576
    v_add_u32 v3, s3, v3
    v_cvt_pk_bf16_f32 v83, v18, v19
    v_mfma_f32_16x16x32_bf16 a[132:135], v[168:171], v[24:27], a[132:135]
    s_add_u32 s56, s56, 36864
    ds_read_b128 v[44:47], v1 offset:23552
    v_and_b32 v51, s97, v63
    v_mfma_f32_16x16x32_bf16 a[132:135], v[184:187], v[28:31], a[132:135]
    s_sub_u32 s58, s56, 147456
    v_exp_f32 v18, v86
    v_mfma_f32_16x16x32_bf16 a[180:183], v[172:175], v[24:27], a[180:183]
    v_add_f32 v6, v6, v16
    v_add_f32 v6, v6, v17
    v_mfma_f32_16x16x32_bf16 a[180:183], v[188:191], v[28:31], a[180:183]
    s_waitcnt lgkmcnt(2)
    v_mul_f32 v48, s38, v48
    v_mul_f32 v49, s38, v49
    v_mfma_f32_16x16x32_bf16 a[40:43], v[160:163], v[32:35], a[40:43]
    s_min_u32 s56, s56, s58
    ds_read_b128 v[24:27], v2 offset:0
    v_mul_f32_e64 v50, -v50, v48
    v_mfma_f32_16x16x32_bf16 a[40:43], v[176:179], v[36:39], a[40:43]
    v_exp_f32 v19, v87
    v_mfma_f32_16x16x32_bf16 a[88:91], v[164:167], v[32:35], a[88:91]
    v_cvt_pk_bf16_f32 v84, v16, v17
    v_mul_f32_e64 v51, -v51, v49
    v_mfma_f32_16x16x32_bf16 a[88:91], v[180:183], v[36:39], a[88:91]
    v_exp_f32 v16, v116
    v_mfma_f32_16x16x32_bf16 a[136:139], v[168:171], v[32:35], a[136:139]
    ds_read_b128 v[28:31], v3 offset:0
    v_add_f32 v6, v6, v18
    v_mfma_f32_16x16x32_bf16 a[136:139], v[184:187], v[36:39], a[136:139]
    v_add_f32 v6, v6, v19
    v_cvt_f32_i32 v242, v242
    v_mfma_f32_16x16x32_bf16 a[184:187], v[172:175], v[32:35], a[184:187]
    v_exp_f32 v17, v117
    v_mfma_f32_16x16x32_bf16 a[184:187], v[188:191], v[36:39], a[184:187]
    s_waitcnt lgkmcnt(2)
    v_cvt_pk_bf16_f32 v85, v18, v19
    v_cvt_f32_i32 v243, v243
    v_mfma_f32_16x16x32_bf16 a[44:47], v[160:163], v[40:43], a[44:47]
    ds_read_b128 v[32:35], v2 offset:6144
    v_fma_f32 v242, v242, v48, v50
    v_mfma_f32_16x16x32_bf16 a[44:47], v[176:179], v[44:47], a[44:47]
    v_exp_f32 v18, v118
    v_mfma_f32_16x16x32_bf16 a[92:95], v[164:167], v[40:43], a[92:95]
    v_add_f32 v6, v6, v16
    v_add_f32 v6, v6, v17
    v_mfma_f32_16x16x32_bf16 a[92:95], v[180:183], v[44:47], a[92:95]
    v_exp_f32 v19, v119
    v_mfma_f32_16x16x32_bf16 a[140:143], v[168:171], v[40:43], a[140:143]
    s_sub_u32 s31, s31, 1
    ds_read_b128 v[36:39], v3 offset:6144
    v_cvt_pk_bf16_f32 v86, v16, v17
    v_mfma_f32_16x16x32_bf16 a[140:143], v[184:187], v[44:47], a[140:143]
    v_add_f32 v6, v6, v18
    v_add_f32 v6, v6, v19
    v_mfma_f32_16x16x32_bf16 a[188:191], v[172:175], v[40:43], a[188:191]
    s_waitcnt lgkmcnt(2)
    s_cmp_lg_u32 s31, 0
    v_cvt_pk_bf16_f32 v87, v18, v19
    v_fma_f32 v243, v243, v49, v51
    v_mfma_f32_16x16x32_bf16 a[188:191], v[188:191], v[44:47], a[188:191]
    s_cbranch_scc1 L_loop
    v_mfma_f32_16x16x32_bf16 v[160:163], v[24:27], a[192:195], v[128:131]
    ds_read_b128 v[40:43], v2 offset:128
    v_mfma_f32_16x16x32_bf16 v[160:163], v[28:31], a[196:199], v[160:163]
    v_exp_f32 v16, v88
    v_mfma_f32_16x16x32_bf16 v[164:167], v[24:27], a[216:219], v[132:135]
    ds_read_b128 v[44:47], v3 offset:128
    v_mfma_f32_16x16x32_bf16 v[164:167], v[28:31], a[220:223], v[164:167]
    s_waitcnt lgkmcnt(2)
    v_exp_f32 v17, v89
    v_mfma_f32_16x16x32_bf16 v[96:99], v[32:35], a[192:195], v[128:131]
    ds_read_b128 v[24:27], v2 offset:6272
    v_mfma_f32_16x16x32_bf16 v[96:99], v[36:39], a[196:199], v[96:99]
    s_waitcnt vmcnt(6)
    v_exp_f32 v18, v90
    v_mfma_f32_16x16x32_bf16 v[100:103], v[32:35], a[216:219], v[132:135]
    ds_read_b128 v[28:31], v3 offset:6272
    v_add_f32 v7, v7, v16
    v_mfma_f32_16x16x32_bf16 v[100:103], v[36:39], a[220:223], v[100:103]
    s_waitcnt lgkmcnt(2)
    s_barrier
    v_mfma_f32_16x16x32_bf16 v[160:163], v[40:43], a[200:203], v[160:163]
    s_mov_b32 m0, s26
    ds_read_b128 v[32:35], v2 offset:256
    v_add_f32 v7, v7, v17
    v_mfma_f32_16x16x32_bf16 v[160:163], v[44:47], a[204:207], v[160:163]
    buffer_load_dwordx4 v4, s[4:7], s32 offen offset:0 sc1 lds
    v_mfma_f32_16x16x32_bf16 v[164:167], v[40:43], a[224:227], v[164:167]
    ds_read_b128 v[36:39], v3 offset:256
    v_mfma_f32_16x16x32_bf16 v[164:167], v[44:47], a[228:231], v[164:167]
    s_waitcnt lgkmcnt(2)
    v_exp_f32 v19, v91
    v_mfma_f32_16x16x32_bf16 v[96:99], v[24:27], a[200:203], v[96:99]
    ds_read_b128 v[40:43], v2 offset:6400
    v_cvt_pk_bf16_f32 v88, v16, v17
    v_mfma_f32_16x16x32_bf16 v[96:99], v[28:31], a[204:207], v[96:99]
    v_exp_f32 v16, v120
    v_mfma_f32_16x16x32_bf16 v[100:103], v[24:27], a[224:227], v[100:103]
    ds_read_b128 v[44:47], v3 offset:6400
    v_add_f32 v7, v7, v18
    v_mfma_f32_16x16x32_bf16 v[100:103], v[28:31], a[228:231], v[100:103]
    s_waitcnt lgkmcnt(2)
    buffer_load_dwordx4 v4, s[4:7], s32 offen offset:1024 sc1 lds
    v_mfma_f32_16x16x32_bf16 v[160:163], v[32:35], a[208:211], v[160:163]
    ds_read_b128 v[24:27], v2 offset:12288
    v_add_f32 v7, v7, v19
    v_mfma_f32_16x16x32_bf16 v[160:163], v[36:39], a[212:215], v[160:163]
    v_exp_f32 v17, v121
    v_mfma_f32_16x16x32_bf16 v[164:167], v[32:35], a[232:235], v[164:167]
    ds_read_b128 v[28:31], v3 offset:12288
    v_cvt_pk_bf16_f32 v89, v18, v19
    v_mfma_f32_16x16x32_bf16 v[164:167], v[36:39], a[236:239], v[164:167]
    s_waitcnt lgkmcnt(2)
    v_exp_f32 v18, v122
    v_mfma_f32_16x16x32_bf16 v[96:99], v[40:43], a[208:211], v[96:99]
    ds_read_b128 v[32:35], v2 offset:18432
    v_add_f32 v7, v7, v16
    v_mfma_f32_16x16x32_bf16 v[96:99], v[44:47], a[212:215], v[96:99]
    buffer_load_dwordx4 v4, s[4:7], s32 offen offset:2048 sc1 lds
    v_mfma_f32_16x16x32_bf16 v[100:103], v[40:43], a[232:235], v[100:103]
    ds_read_b128 v[36:39], v3 offset:18432
    v_add_f32 v7, v7, v17
    v_mfma_f32_16x16x32_bf16 v[100:103], v[44:47], a[236:239], v[100:103]
    s_waitcnt lgkmcnt(2)
    v_exp_f32 v19, v123
    v_mfma_f32_16x16x32_bf16 v[168:171], v[24:27], a[192:195], v[128:131]
    ds_read_b128 v[40:43], v2 offset:12416
    v_cvt_pk_bf16_f32 v90, v16, v17
    v_mfma_f32_16x16x32_bf16 v[168:171], v[28:31], a[196:199], v[168:171]
    v_exp_f32 v16, v92
    v_mfma_f32_16x16x32_bf16 v[172:175], v[24:27], a[216:219], v[132:135]
    s_add_u32 s32, s32, 24576
    ds_read_b128 v[44:47], v3 offset:12416
    v_add_f32 v7, v7, v18
    v_mfma_f32_16x16x32_bf16 v[172:175], v[28:31], a[220:223], v[172:175]
    s_waitcnt lgkmcnt(2)
    v_add_f32 v7, v7, v19
    v_mfma_f32_16x16x32_bf16 v[104:107], v[32:35], a[192:195], v[128:131]
    ds_read_b128 v[24:27], v2 offset:18560
    v_mfma_f32_16x16x32_bf16 v[104:107], v[36:39], a[196:199], v[104:107]
    s_add_u32 s26, s26, 12288
    v_exp_f32 v17, v93
    v_mfma_f32_16x16x32_bf16 v[108:111], v[32:35], a[216:219], v[132:135]
    s_add_u32 s29, s30, 49152
    ds_read_b128 v[28:31], v3 offset:18560
    v_cvt_pk_bf16_f32 v91, v18, v19
    v_mfma_f32_16x16x32_bf16 v[108:111], v[36:39], a[220:223], v[108:111]
    s_waitcnt lgkmcnt(2)
    v_exp_f32 v18, v94
    v_mfma_f32_16x16x32_bf16 v[168:171], v[40:43], a[200:203], v[168:171]
    s_sub_u32 s3, s29, 147456
    ds_read_b128 v[32:35], v2 offset:12544
    v_add_f32 v8, v8, v16
    v_mfma_f32_16x16x32_bf16 v[168:171], v[44:47], a[204:207], v[168:171]
    s_mov_b32 m0, s26
    v_add_f32 v8, v8, v17
    s_min_u32 s29, s29, s3
    v_mfma_f32_16x16x32_bf16 v[172:175], v[40:43], a[224:227], v[172:175]
    ds_read_b128 v[36:39], v3 offset:12544
    v_mfma_f32_16x16x32_bf16 v[172:175], v[44:47], a[228:231], v[172:175]
    s_waitcnt lgkmcnt(2)
    v_exp_f32 v19, v95
    v_mfma_f32_16x16x32_bf16 v[104:107], v[24:27], a[200:203], v[104:107]
    ds_read_b128 v[40:43], v2 offset:18688
    v_cvt_pk_bf16_f32 v92, v16, v17
    v_mfma_f32_16x16x32_bf16 v[104:107], v[28:31], a[204:207], v[104:107]
    buffer_load_dwordx4 v4, s[4:7], s32 offen offset:0 sc1 lds
    v_mfma_f32_16x16x32_bf16 v[108:111], v[24:27], a[224:227], v[108:111]
    ds_read_b128 v[44:47], v3 offset:18688
    v_mfma_f32_16x16x32_bf16 v[108:111], v[28:31], a[228:231], v[108:111]
    s_waitcnt lgkmcnt(2)
    v_subrev_u32 v2, 98304, v2
    v_subrev_u32 v3, 98304, v3
    v_mfma_f32_16x16x32_bf16 v[168:171], v[32:35], a[208:211], v[168:171]
    ds_read_b128 v[24:27], v2 offset:0
    v_mfma_f32_16x16x32_bf16 v[168:171], v[36:39], a[212:215], v[168:171]
    v_exp_f32 v16, v124
    v_add_f32 v8, v8, v18
    v_mfma_f32_16x16x32_bf16 v[172:175], v[32:35], a[232:235], v[172:175]
    s_sub_u32 s3, s29, s30
    ds_read_b128 v[28:31], v3 offset:0
    v_add_f32 v8, v8, v19
    v_mfma_f32_16x16x32_bf16 v[172:175], v[36:39], a[236:239], v[172:175]
    s_waitcnt lgkmcnt(2)
    v_exp_f32 v17, v125
    v_cvt_pk_bf16_f32 v93, v18, v19
    v_mfma_f32_16x16x32_bf16 v[104:107], v[40:43], a[208:211], v[104:107]
    ds_read_b128 v[32:35], v2 offset:6144
    v_mfma_f32_16x16x32_bf16 v[104:107], v[44:47], a[212:215], v[104:107]
    buffer_load_dwordx4 v4, s[4:7], s32 offen offset:1024 sc1 lds
    v_mfma_f32_16x16x32_bf16 v[108:111], v[40:43], a[232:235], v[108:111]
    ds_read_b128 v[36:39], v3 offset:6144
    v_mfma_f32_16x16x32_bf16 v[108:111], v[44:47], a[236:239], v[108:111]
    s_waitcnt lgkmcnt(2)
    v_exp_f32 v18, v126
    v_add_f32 v8, v8, v16
    v_mfma_f32_16x16x32_bf16 v[176:179], v[24:27], a[192:195], v[128:131]
    ds_read_b128 v[40:43], v2 offset:128
    v_add_f32 v8, v8, v17
    v_mfma_f32_16x16x32_bf16 v[176:179], v[28:31], a[196:199], v[176:179]
    v_exp_f32 v19, v127
    v_cvt_pk_bf16_f32 v94, v16, v17
    v_mfma_f32_16x16x32_bf16 v[180:183], v[24:27], a[216:219], v[132:135]
    ds_read_b128 v[44:47], v3 offset:128
    v_add_f32 v8, v8, v18
    v_add_f32 v8, v8, v19
    v_cvt_pk_bf16_f32 v95, v18, v19
    v_mfma_f32_16x16x32_bf16 v[180:183], v[28:31], a[220:223], v[180:183]
    s_waitcnt lgkmcnt(2)
    buffer_load_dwordx4 v4, s[4:7], s32 offen offset:2048 sc1 lds
    v_mfma_f32_16x16x32_bf16 v[112:115], v[32:35], a[192:195], v[128:131]
    s_mov_b32 s30, s29
    ds_read_b128 v[24:27], v2 offset:6272
    v_mfma_f32_16x16x32_bf16 v[112:115], v[36:39], a[196:199], v[112:115]
    v_exp_f32 v16, v160
    v_mfma_f32_16x16x32_bf16 v[116:119], v[32:35], a[216:219], v[132:135]
    ds_read_b128 v[28:31], v3 offset:6272
    v_mfma_f32_16x16x32_bf16 v[116:119], v[36:39], a[220:223], v[116:119]
    s_waitcnt lgkmcnt(2)
    v_exp_f32 v17, v161
    v_mfma_f32_16x16x32_bf16 v[176:179], v[40:43], a[200:203], v[176:179]
    ds_read_b128 v[32:35], v2 offset:256
    v_mfma_f32_16x16x32_bf16 v[176:179], v[44:47], a[204:207], v[176:179]
    v_exp_f32 v18, v162
    v_mfma_f32_16x16x32_bf16 v[180:183], v[40:43], a[224:227], v[180:183]
    ds_read_b128 v[36:39], v3 offset:256
    v_add_f32 v5, v5, v16
    v_mfma_f32_16x16x32_bf16 v[180:183], v[44:47], a[228:231], v[180:183]
    s_waitcnt lgkmcnt(2)
    v_add_f32 v5, v5, v17
    v_add_u32 v1, s3, v1
    v_mfma_f32_16x16x32_bf16 v[112:115], v[24:27], a[200:203], v[112:115]
    ds_read_b128 v[40:43], v2 offset:6400
    v_mfma_f32_16x16x32_bf16 v[112:115], v[28:31], a[204:207], v[112:115]
    v_exp_f32 v19, v163
    v_cvt_pk_bf16_f32 v160, v16, v17
    v_mfma_f32_16x16x32_bf16 v[116:119], v[24:27], a[224:227], v[116:119]
    s_add_u32 s32, s32, 24576
    ds_read_b128 v[44:47], v3 offset:6400
    s_add_u32 s26, s26, 36864
    v_mfma_f32_16x16x32_bf16 v[116:119], v[28:31], a[228:231], v[116:119]
    s_waitcnt lgkmcnt(2)
    v_exp_f32 v16, v96
    v_mfma_f32_16x16x32_bf16 v[176:179], v[32:35], a[208:211], v[176:179]
    s_sub_u32 s57, s26, 147456
    ds_read_b128 v[24:27], v2 offset:12288
    v_add_f32 v5, v5, v18
    v_mfma_f32_16x16x32_bf16 v[176:179], v[36:39], a[212:215], v[176:179]
    s_min_u32 s26, s26, s57
    v_add_f32 v5, v5, v19
    v_mfma_f32_16x16x32_bf16 v[180:183], v[32:35], a[232:235], v[180:183]
    ds_read_b128 v[28:31], v3 offset:12288
    v_mfma_f32_16x16x32_bf16 v[180:183], v[36:39], a[236:239], v[180:183]
    s_waitcnt lgkmcnt(2)
    v_exp_f32 v17, v97
    v_cvt_pk_bf16_f32 v161, v18, v19
    v_mfma_f32_16x16x32_bf16 v[112:115], v[40:43], a[208:211], v[112:115]
    ds_read_b128 v[32:35], v2 offset:18432
    v_mfma_f32_16x16x32_bf16 v[112:115], v[44:47], a[212:215], v[112:115]
    v_exp_f32 v18, v98
    v_mfma_f32_16x16x32_bf16 v[116:119], v[40:43], a[232:235], v[116:119]
    ds_read_b128 v[36:39], v3 offset:18432
    v_add_f32 v5, v5, v16
    v_mfma_f32_16x16x32_bf16 v[116:119], v[44:47], a[236:239], v[116:119]
    s_waitcnt lgkmcnt(2)
    v_add_f32 v5, v5, v17
    v_mfma_f32_16x16x32_bf16 v[184:187], v[24:27], a[192:195], v[128:131]
    ds_read_b128 v[40:43], v2 offset:12416
    v_mfma_f32_16x16x32_bf16 v[184:187], v[28:31], a[196:199], v[184:187]
    v_exp_f32 v19, v99
    v_cvt_pk_bf16_f32 v162, v16, v17
    v_mfma_f32_16x16x32_bf16 v[188:191], v[24:27], a[216:219], v[132:135]
    ds_read_b128 v[44:47], v3 offset:12416
    v_mfma_f32_16x16x32_bf16 v[188:191], v[28:31], a[220:223], v[188:191]
    s_waitcnt lgkmcnt(2)
    v_exp_f32 v16, v164
    v_mfma_f32_16x16x32_bf16 v[120:123], v[32:35], a[192:195], v[128:131]
    ds_read_b128 v[24:27], v2 offset:18560
    v_add_f32 v5, v5, v18
    v_mfma_f32_16x16x32_bf16 v[120:123], v[36:39], a[196:199], v[120:123]
    s_waitcnt vmcnt(6)
    v_add_f32 v5, v5, v19
    v_mfma_f32_16x16x32_bf16 v[124:127], v[32:35], a[216:219], v[132:135]
    ds_read_b128 v[28:31], v3 offset:18560
    v_mfma_f32_16x16x32_bf16 v[124:127], v[36:39], a[220:223], v[124:127]
    s_waitcnt lgkmcnt(2)
    s_barrier
    v_mfma_f32_16x16x32_bf16 v[184:187], v[40:43], a[200:203], v[184:187]
    ds_read_b128 v[32:35], v2 offset:12544
    v_mfma_f32_16x16x32_bf16 v[184:187], v[44:47], a[204:207], v[184:187]
    v_exp_f32 v17, v165
    v_cvt_pk_bf16_f32 v163, v18, v19
    v_mfma_f32_16x16x32_bf16 v[188:191], v[40:43], a[224:227], v[188:191]
    ds_read_b128 v[36:39], v3 offset:12544
    v_mfma_f32_16x16x32_bf16 v[188:191], v[44:47], a[228:231], v[188:191]
    s_waitcnt lgkmcnt(2)
    v_exp_f32 v18, v166
    v_add_f32 v6, v6, v16
    v_mfma_f32_16x16x32_bf16 v[120:123], v[24:27], a[200:203], v[120:123]
    ds_read_b128 v[40:43], v2 offset:18688
    v_add_f32 v6, v6, v17
    v_mfma_f32_16x16x32_bf16 v[120:123], v[28:31], a[204:207], v[120:123]
    v_exp_f32 v19, v167
    v_cvt_pk_bf16_f32 v164, v16, v17
    v_mfma_f32_16x16x32_bf16 v[124:127], v[24:27], a[224:227], v[124:127]
    ds_read_b128 v[44:47], v3 offset:18688
    v_mfma_f32_16x16x32_bf16 v[124:127], v[28:31], a[228:231], v[124:127]
    s_waitcnt lgkmcnt(2)
    v_exp_f32 v16, v100
    v_mfma_f32_16x16x32_bf16 v[184:187], v[32:35], a[208:211], v[184:187]
    ds_read_b128 v[24:27], v1 offset:0
    v_add_f32 v6, v6, v18
    v_mfma_f32_16x16x32_bf16 v[184:187], v[36:39], a[212:215], v[184:187]
    v_add_f32 v6, v6, v19
    v_mfma_f32_16x16x32_bf16 v[188:191], v[32:35], a[232:235], v[188:191]
    ds_read_b128 v[28:31], v1 offset:12288
    v_mfma_f32_16x16x32_bf16 v[188:191], v[36:39], a[236:239], v[188:191]
    s_waitcnt lgkmcnt(2)
    v_exp_f32 v17, v101
    v_cvt_pk_bf16_f32 v165, v18, v19
    v_mfma_f32_16x16x32_bf16 v[120:123], v[40:43], a[208:211], v[120:123]
    ds_read_b128 v[32:35], v1 offset:1024
    v_mfma_f32_16x16x32_bf16 v[120:123], v[44:47], a[212:215], v[120:123]
    v_exp_f32 v18, v102
    v_mfma_f32_16x16x32_bf16 v[124:127], v[40:43], a[232:235], v[124:127]
    ds_read_b128 v[36:39], v1 offset:13312
    v_add_f32 v6, v6, v16
    v_mfma_f32_16x16x32_bf16 v[124:127], v[44:47], a[236:239], v[124:127]
    s_waitcnt lgkmcnt(2)
    v_add_f32 v6, v6, v17
    v_exp_f32 v19, v103
    v_cvt_pk_bf16_f32 v166, v16, v17
    v_add_f32 v6, v6, v18
    v_add_f32 v6, v6, v19
    v_cvt_pk_bf16_f32 v167, v18, v19
    v_mfma_f32_16x16x32_bf16 a[0:3], v[64:67], v[24:27], a[0:3]
    s_mov_b32 m0, s56
    ds_read_b128 v[40:43], v1 offset:2048
    v_bfe_u32 v57, v4, 8, 2
    v_mfma_f32_16x16x32_bf16 a[0:3], v[80:83], v[28:31], a[0:3]
    buffer_load_dwordx4 v4, s[4:7], s27 offen offset:0 sc1 lds
    v_mfma_f32_16x16x32_bf16 a[48:51], v[68:71], v[24:27], a[48:51]
    v_exp_f32 v16, v168
    v_mfma_f32_16x16x32_bf16 a[48:51], v[84:87], v[28:31], a[48:51]
    v_exp_f32 v17, v169
    v_mfma_f32_16x16x32_bf16 a[96:99], v[72:75], v[24:27], a[96:99]
    ds_read_b128 v[44:47], v1 offset:14336
    v_mul_u32_u24 v56, 1536, v57
    v_mfma_f32_16x16x32_bf16 a[96:99], v[88:91], v[28:31], a[96:99]
    buffer_load_dwordx4 v4, s[4:7], s27 offen offset:1024 sc1 lds
    v_mfma_f32_16x16x32_bf16 a[144:147], v[76:79], v[24:27], a[144:147]
    v_exp_f32 v18, v170
    v_mfma_f32_16x16x32_bf16 a[144:147], v[92:95], v[28:31], a[144:147]
    s_waitcnt lgkmcnt(2)
    v_add_f32 v5, v5, v16
    v_add_f32 v5, v5, v17
    v_mfma_f32_16x16x32_bf16 a[4:7], v[64:67], v[32:35], a[4:7]
    ds_read_b128 v[24:27], v1 offset:3072
    v_lshlrev_b32 v58, 4, v57
    v_mfma_f32_16x16x32_bf16 a[4:7], v[80:83], v[36:39], a[4:7]
    buffer_load_dwordx4 v4, s[4:7], s27 offen offset:2048 sc1 lds
    v_mfma_f32_16x16x32_bf16 a[52:55], v[68:71], v[32:35], a[52:55]
    v_exp_f32 v19, v171
    v_mfma_f32_16x16x32_bf16 a[52:55], v[84:87], v[36:39], a[52:55]
    s_add_u32 s27, s27, 24576
    v_cvt_pk_bf16_f32 v168, v16, v17
    v_bfe_u32 v57, v4, 4, 4
    v_mfma_f32_16x16x32_bf16 a[100:103], v[72:75], v[32:35], a[100:103]
    ds_read_b128 v[28:31], v1 offset:15360
    v_mfma_f32_16x16x32_bf16 a[100:103], v[88:91], v[36:39], a[100:103]
    s_add_u32 s56, s56, 12288
    v_exp_f32 v16, v104
    v_mfma_f32_16x16x32_bf16 a[148:151], v[76:79], v[32:35], a[148:151]
    v_add_f32 v5, v5, v18
    v_add_f32 v5, v5, v19
    v_mfma_f32_16x16x32_bf16 a[148:151], v[92:95], v[36:39], a[148:151]
    s_waitcnt lgkmcnt(2)
    v_exp_f32 v17, v105
    v_mfma_f32_16x16x32_bf16 a[8:11], v[64:67], v[40:43], a[8:11]
    s_mov_b32 m0, s56
    ds_read_b128 v[32:35], v1 offset:4096
    v_cvt_pk_bf16_f32 v169, v18, v19
    v_mfma_f32_16x16x32_bf16 a[8:11], v[80:83], v[44:47], a[8:11]
    v_exp_f32 v18, v106
    v_mfma_f32_16x16x32_bf16 a[56:59], v[68:71], v[40:43], a[56:59]
    v_add_f32 v5, v5, v16
    v_add_f32 v5, v5, v17
    v_mfma_f32_16x16x32_bf16 a[56:59], v[84:87], v[44:47], a[56:59]
    buffer_load_dwordx4 v4, s[4:7], s27 offen offset:0 sc1 lds
    v_mfma_f32_16x16x32_bf16 a[104:107], v[72:75], v[40:43], a[104:107]
    ds_read_b128 v[36:39], v1 offset:16384
    v_mul_u32_u24 v57, 12, v57
    v_mfma_f32_16x16x32_bf16 a[104:107], v[88:91], v[44:47], a[104:107]
    v_exp_f32 v19, v107
    v_mfma_f32_16x16x32_bf16 a[152:155], v[76:79], v[40:43], a[152:155]
    v_cvt_pk_bf16_f32 v170, v16, v17
    v_mfma_f32_16x16x32_bf16 a[152:155], v[92:95], v[44:47], a[152:155]
    s_waitcnt lgkmcnt(2)
    buffer_load_dwordx4 v4, s[4:7], s27 offen offset:1024 sc1 lds
    v_mfma_f32_16x16x32_bf16 a[12:15], v[64:67], v[24:27], a[12:15]
    ds_read_b128 v[40:43], v1 offset:5120
    v_mfma_f32_16x16x32_bf16 a[12:15], v[80:83], v[28:31], a[12:15]
    v_exp_f32 v16, v172
    v_mfma_f32_16x16x32_bf16 a[60:63], v[68:71], v[24:27], a[60:63]
    v_add_f32 v5, v5, v18
    v_add_f32 v5, v5, v19
    v_mfma_f32_16x16x32_bf16 a[60:63], v[84:87], v[28:31], a[60:63]
    buffer_load_dwordx4 v4, s[4:7], s27 offen offset:2048 sc1 lds
    v_mfma_f32_16x16x32_bf16 a[108:111], v[72:75], v[24:27], a[108:111]
    ds_read_b128 v[44:47], v1 offset:17408
    v_add_u32 v56, v56, v57
    v_mfma_f32_16x16x32_bf16 a[108:111], v[88:91], v[28:31], a[108:111]
    v_exp_f32 v17, v173
    v_mfma_f32_16x16x32_bf16 a[156:159], v[76:79], v[24:27], a[156:159]
    s_add_u32 s27, s27, 24576
    v_cvt_pk_bf16_f32 v171, v18, v19
    v_mfma_f32_16x16x32_bf16 a[156:159], v[92:95], v[28:31], a[156:159]
    s_waitcnt lgkmcnt(2)
    v_exp_f32 v18, v174
    v_mfma_f32_16x16x32_bf16 a[16:19], v[64:67], v[32:35], a[16:19]
    s_add_u32 s56, s56, 36864
    ds_read_b128 v[24:27], v1 offset:6144
    v_add_f32 v6, v6, v16
    v_mfma_f32_16x16x32_bf16 a[16:19], v[80:83], v[36:39], a[16:19]
    v_add_f32 v6, v6, v17
    v_mov_b32 v57, 1.0
    v_mfma_f32_16x16x32_bf16 a[64:67], v[68:71], v[32:35], a[64:67]
    s_sub_u32 s58, s56, 147456
    v_exp_f32 v19, v175
    v_mfma_f32_16x16x32_bf16 a[64:67], v[84:87], v[36:39], a[64:67]
    v_cvt_pk_bf16_f32 v172, v16, v17
    v_mfma_f32_16x16x32_bf16 a[112:115], v[72:75], v[32:35], a[112:115]
    s_min_u32 s56, s56, s58
    ds_read_b128 v[28:31], v1 offset:18432
    v_mfma_f32_16x16x32_bf16 a[112:115], v[88:91], v[36:39], a[112:115]
    v_exp_f32 v16, v108
    v_mfma_f32_16x16x32_bf16 a[160:163], v[76:79], v[32:35], a[160:163]
    s_mov_b32 m0, s56
    v_add_f32 v6, v6, v18
    v_add_f32 v6, v6, v19
    v_mfma_f32_16x16x32_bf16 a[160:163], v[92:95], v[36:39], a[160:163]
    s_waitcnt lgkmcnt(2)
    v_exp_f32 v17, v109
    v_mfma_f32_16x16x32_bf16 a[20:23], v[64:67], v[40:43], a[20:23]
    s_lshl_b32 s24, s95, 2
    ds_read_b128 v[32:35], v1 offset:7168
    v_cvt_pk_bf16_f32 v173, v18, v19
    v_mfma_f32_16x16x32_bf16 a[20:23], v[80:83], v[44:47], a[20:23]
    buffer_load_dwordx4 v4, s[4:7], s27 offen offset:0 sc1 lds
    v_mfma_f32_16x16x32_bf16 a[68:71], v[68:71], v[40:43], a[68:71]
    v_exp_f32 v18, v110
    v_mfma_f32_16x16x32_bf16 a[68:71], v[84:87], v[44:47], a[68:71]
    v_add_f32 v6, v6, v16
    v_add_f32 v6, v6, v17
    v_mfma_f32_16x16x32_bf16 a[116:119], v[72:75], v[40:43], a[116:119]
    ds_read_b128 v[36:39], v1 offset:19456
    v_mfma_f32_16x16x32_bf16 a[116:119], v[88:91], v[44:47], a[116:119]
    buffer_load_dwordx4 v4, s[4:7], s27 offen offset:1024 sc1 lds
    v_mfma_f32_16x16x32_bf16 a[164:167], v[76:79], v[40:43], a[164:167]
    v_exp_f32 v19, v111
    v_mfma_f32_16x16x32_bf16 a[164:167], v[92:95], v[44:47], a[164:167]
    s_waitcnt lgkmcnt(2)
    v_cvt_pk_bf16_f32 v174, v16, v17
    v_add_f32 v6, v6, v18
    v_mfma_f32_16x16x32_bf16 a[24:27], v[64:67], v[24:27], a[24:27]
    s_add_u32 s24, s24, s25
    ds_read_b128 v[40:43], v1 offset:8192
    v_add_f32 v6, v6, v19
    v_mfma_f32_16x16x32_bf16 a[24:27], v[80:83], v[28:31], a[24:27]
    buffer_load_dwordx4 v4, s[4:7], s27 offen offset:2048 sc1 lds
    v_mfma_f32_16x16x32_bf16 a[72:75], v[68:71], v[24:27], a[72:75]
    v_cvt_pk_bf16_f32 v175, v18, v19
    v_mfma_f32_16x16x32_bf16 a[72:75], v[84:87], v[28:31], a[72:75]
    v_exp_f32 v16, v176
    v_mfma_f32_16x16x32_bf16 a[120:123], v[72:75], v[24:27], a[120:123]
    ds_read_b128 v[44:47], v1 offset:20480
    v_mfma_f32_16x16x32_bf16 a[120:123], v[88:91], v[28:31], a[120:123]
    s_add_u32 s27, s27, 24576
    v_exp_f32 v17, v177
    v_mfma_f32_16x16x32_bf16 a[168:171], v[76:79], v[24:27], a[168:171]
    v_exp_f32 v18, v178
    v_mfma_f32_16x16x32_bf16 a[168:171], v[92:95], v[28:31], a[168:171]
    s_waitcnt lgkmcnt(2)
    v_add_f32 v5, v5, v16
    v_add_f32 v5, v5, v17
    v_mfma_f32_16x16x32_bf16 a[28:31], v[64:67], v[32:35], a[28:31]
    s_add_u32 s56, s56, 12288
    ds_read_b128 v[24:27], v1 offset:9216
    s_mul_i32 s24, s24, 24576
    v_mfma_f32_16x16x32_bf16 a[28:31], v[80:83], v[36:39], a[28:31]
    s_mov_b32 m0, s56
    v_exp_f32 v19, v179
    v_mfma_f32_16x16x32_bf16 a[76:79], v[68:71], v[32:35], a[76:79]
    v_cvt_pk_bf16_f32 v176, v16, v17
    v_mfma_f32_16x16x32_bf16 a[76:79], v[84:87], v[36:39], a[76:79]
    v_exp_f32 v16, v112
    v_mfma_f32_16x16x32_bf16 a[124:127], v[72:75], v[32:35], a[124:127]
    ds_read_b128 v[28:31], v1 offset:21504
    v_add_f32 v5, v5, v18
    v_mfma_f32_16x16x32_bf16 a[124:127], v[88:91], v[36:39], a[124:127]
    buffer_load_dwordx4 v4, s[4:7], s27 offen offset:0 sc1 lds
    v_mfma_f32_16x16x32_bf16 a[172:175], v[76:79], v[32:35], a[172:175]
    s_add_u32 s40, s24, 6144
    v_add_f32 v5, v5, v19
    v_mfma_f32_16x16x32_bf16 a[172:175], v[92:95], v[36:39], a[172:175]
    s_waitcnt lgkmcnt(2)
    v_exp_f32 v17, v113
    v_mfma_f32_16x16x32_bf16 a[32:35], v[64:67], v[40:43], a[32:35]
    ds_read_b128 v[32:35], v1 offset:10240
    v_cvt_pk_bf16_f32 v177, v18, v19
    v_mfma_f32_16x16x32_bf16 a[32:35], v[80:83], v[44:47], a[32:35]
    buffer_load_dwordx4 v4, s[4:7], s27 offen offset:1024 sc1 lds
    v_mfma_f32_16x16x32_bf16 a[80:83], v[68:71], v[40:43], a[80:83]
    v_exp_f32 v18, v114
    v_mfma_f32_16x16x32_bf16 a[80:83], v[84:87], v[44:47], a[80:83]
    v_add_f32 v5, v5, v16
    v_add_f32 v5, v5, v17
    v_mfma_f32_16x16x32_bf16 a[128:131], v[72:75], v[40:43], a[128:131]
    ds_read_b128 v[36:39], v1 offset:22528
    v_mfma_f32_16x16x32_bf16 a[128:131], v[88:91], v[44:47], a[128:131]
    buffer_load_dwordx4 v4, s[4:7], s27 offen offset:2048 sc1 lds
    v_mfma_f32_16x16x32_bf16 a[176:179], v[76:79], v[40:43], a[176:179]
    s_add_u32 s41, s24, 12288
    v_exp_f32 v19, v115
    v_mfma_f32_16x16x32_bf16 a[176:179], v[92:95], v[44:47], a[176:179]
    s_waitcnt lgkmcnt(2)
    v_cvt_pk_bf16_f32 v178, v16, v17
    v_mfma_f32_16x16x32_bf16 a[36:39], v[64:67], v[24:27], a[36:39]
    ds_read_b128 v[40:43], v1 offset:11264
    v_mfma_f32_16x16x32_bf16 a[36:39], v[80:83], v[28:31], a[36:39]
L_pg8:
    s_cbranch_execz L_iwret
    v_exp_f32 v16, v180
    v_mfma_f32_16x16x32_bf16 a[84:87], v[68:71], v[24:27], a[84:87]
    v_add_f32 v5, v5, v18
    v_add_f32 v5, v5, v19
    v_mfma_f32_16x16x32_bf16 a[84:87], v[84:87], v[28:31], a[84:87]
    s_add_u32 s27, s27, 24576
    v_exp_f32 v17, v181
    v_mfma_f32_16x16x32_bf16 a[132:135], v[72:75], v[24:27], a[132:135]
    s_add_u32 s56, s56, 36864
    ds_read_b128 v[44:47], v1 offset:23552
    v_cvt_pk_bf16_f32 v179, v18, v19
    v_mfma_f32_16x16x32_bf16 a[132:135], v[88:91], v[28:31], a[132:135]
    s_waitcnt lgkmcnt(2)
    v_exp_f32 v18, v182
    v_mfma_f32_16x16x32_bf16 a[180:183], v[76:79], v[24:27], a[180:183]
    s_waitcnt vmcnt(12)
    v_add_f32 v6, v6, v16
    v_add_f32 v6, v6, v17
    v_mfma_f32_16x16x32_bf16 a[180:183], v[92:95], v[28:31], a[180:183]
    s_barrier
    v_add_u32 v2, 49152, v2
    v_add_u32 v3, 49152, v3
    v_mfma_f32_16x16x32_bf16 a[40:43], v[64:67], v[32:35], a[40:43]
    s_sub_u32 s58, s56, 147456
    ds_read_b128 v[24:27], v2 offset:0
    s_add_u32 s42, s24, 18432
    v_mfma_f32_16x16x32_bf16 a[40:43], v[80:83], v[36:39], a[40:43]
    s_min_u32 s56, s56, s58
    v_exp_f32 v19, v183
    v_mfma_f32_16x16x32_bf16 a[88:91], v[68:71], v[32:35], a[88:91]
    v_cvt_pk_bf16_f32 v180, v16, v17
    v_mfma_f32_16x16x32_bf16 a[88:91], v[84:87], v[36:39], a[88:91]
    v_exp_f32 v16, v116
    v_mfma_f32_16x16x32_bf16 a[136:139], v[72:75], v[32:35], a[136:139]
    ds_read_b128 v[28:31], v3 offset:0
    v_add_f32 v6, v6, v18
    v_mfma_f32_16x16x32_bf16 a[136:139], v[88:91], v[36:39], a[136:139]
    v_add_f32 v6, v6, v19
    v_mfma_f32_16x16x32_bf16 a[184:187], v[76:79], v[32:35], a[184:187]
    v_exp_f32 v17, v117
    v_mfma_f32_16x16x32_bf16 a[184:187], v[92:95], v[36:39], a[184:187]
    s_waitcnt lgkmcnt(2)
    v_cvt_pk_bf16_f32 v181, v18, v19
    v_mfma_f32_16x16x32_bf16 a[44:47], v[64:67], v[40:43], a[44:47]
    ds_read_b128 v[32:35], v2 offset:6144
    v_mfma_f32_16x16x32_bf16 a[44:47], v[80:83], v[44:47], a[44:47]
    v_exp_f32 v18, v118
    v_mfma_f32_16x16x32_bf16 a[92:95], v[68:71], v[40:43], a[92:95]
    v_add_f32 v6, v6, v16
    v_add_f32 v6, v6, v17
    v_mfma_f32_16x16x32_bf16 a[92:95], v[84:87], v[44:47], a[92:95]
    v_exp_f32 v19, v119
    v_mfma_f32_16x16x32_bf16 a[140:143], v[72:75], v[40:43], a[140:143]
    ds_read_b128 v[36:39], v3 offset:6144
    v_cvt_pk_bf16_f32 v182, v16, v17
    v_mfma_f32_16x16x32_bf16 a[140:143], v[88:91], v[44:47], a[140:143]
    v_add_f32 v6, v6, v18
    v_add_f32 v6, v6, v19
    v_mfma_f32_16x16x32_bf16 a[188:191], v[76:79], v[40:43], a[188:191]
    v_cvt_pk_bf16_f32 v183, v18, v19
    v_mfma_f32_16x16x32_bf16 a[188:191], v[92:95], v[44:47], a[188:191]
    s_waitcnt lgkmcnt(2)
    v_mfma_f32_16x16x32_bf16 v[64:67], v[24:27], a[192:195], v[128:131]
    ds_read_b128 v[40:43], v2 offset:128
    v_mfma_f32_16x16x32_bf16 v[64:67], v[28:31], a[196:199], v[64:67]
    v_exp_f32 v16, v184
    v_mfma_f32_16x16x32_bf16 v[68:71], v[24:27], a[216:219], v[132:135]
    ds_read_b128 v[44:47], v3 offset:128
    v_mfma_f32_16x16x32_bf16 v[68:71], v[28:31], a[220:223], v[68:71]
    s_waitcnt lgkmcnt(2)
    v_exp_f32 v17, v185
    v_mfma_f32_16x16x32_bf16 v[96:99], v[32:35], a[192:195], v[128:131]
    ds_read_b128 v[24:27], v2 offset:6272
    v_mfma_f32_16x16x32_bf16 v[96:99], v[36:39], a[196:199], v[96:99]
    v_exp_f32 v18, v186
    v_mfma_f32_16x16x32_bf16 v[100:103], v[32:35], a[216:219], v[132:135]
    ds_read_b128 v[28:31], v3 offset:6272
    v_add_f32 v5, v5, v16
    v_mfma_f32_16x16x32_bf16 v[100:103], v[36:39], a[220:223], v[100:103]
    s_waitcnt lgkmcnt(2)
    v_add_f32 v5, v5, v17
    v_mfma_f32_16x16x32_bf16 v[64:67], v[40:43], a[200:203], v[64:67]
    ds_read_b128 v[32:35], v2 offset:256
    v_mfma_f32_16x16x32_bf16 v[64:67], v[44:47], a[204:207], v[64:67]
    v_exp_f32 v19, v187
    v_mfma_f32_16x16x32_bf16 v[68:71], v[40:43], a[224:227], v[68:71]
    ds_read_b128 v[36:39], v3 offset:256
    v_cvt_pk_bf16_f32 v184, v16, v17
    v_mfma_f32_16x16x32_bf16 v[68:71], v[44:47], a[228:231], v[68:71]
    s_waitcnt lgkmcnt(2)
    v_exp_f32 v16, v120
    v_mfma_f32_16x16x32_bf16 v[96:99], v[24:27], a[200:203], v[96:99]
    ds_read_b128 v[40:43], v2 offset:6400
    v_add_f32 v5, v5, v18
    v_mfma_f32_16x16x32_bf16 v[96:99], v[28:31], a[204:207], v[96:99]
    s_waitcnt vmcnt(0)
    v_add_f32 v5, v5, v19
    v_mfma_f32_16x16x32_bf16 v[100:103], v[24:27], a[224:227], v[100:103]
    ds_read_b128 v[44:47], v3 offset:6400
    v_mfma_f32_16x16x32_bf16 v[100:103], v[28:31], a[228:231], v[100:103]
    s_waitcnt lgkmcnt(2)
    s_barrier
    v_mfma_f32_16x16x32_bf16 v[64:67], v[32:35], a[208:211], v[64:67]
    s_mov_b32 m0, s56
    ds_read_b128 v[24:27], v2 offset:12288
    v_mfma_f32_16x16x32_bf16 v[64:67], v[36:39], a[212:215], v[64:67]
    buffer_load_dwordx4 v4, s[4:7], s27 offen offset:0 sc1 lds
    v_mfma_f32_16x16x32_bf16 v[68:71], v[32:35], a[232:235], v[68:71]
    ds_read_b128 v[28:31], v3 offset:12288
    v_mfma_f32_16x16x32_bf16 v[68:71], v[36:39], a[236:239], v[68:71]
    s_waitcnt lgkmcnt(2)
    v_exp_f32 v17, v121
    v_cvt_pk_bf16_f32 v185, v18, v19
    v_mfma_f32_16x16x32_bf16 v[96:99], v[40:43], a[208:211], v[96:99]
    ds_read_b128 v[32:35], v2 offset:18432
    v_mfma_f32_16x16x32_bf16 v[96:99], v[44:47], a[212:215], v[96:99]
    buffer_load_dwordx4 v4, s[4:7], s27 offen offset:1024 sc1 lds
    v_mfma_f32_16x16x32_bf16 v[100:103], v[40:43], a[232:235], v[100:103]
    ds_read_b128 v[36:39], v3 offset:18432
    v_mfma_f32_16x16x32_bf16 v[100:103], v[44:47], a[236:239], v[100:103]
    s_waitcnt lgkmcnt(2)
    v_exp_f32 v18, v122
    v_add_f32 v5, v5, v16
    v_mfma_f32_16x16x32_bf16 v[72:75], v[24:27], a[192:195], v[128:131]
    ds_read_b128 v[40:43], v2 offset:12416
    v_add_f32 v5, v5, v17
    v_mfma_f32_16x16x32_bf16 v[72:75], v[28:31], a[196:199], v[72:75]
    v_exp_f32 v19, v123
    v_cvt_pk_bf16_f32 v186, v16, v17
    v_mfma_f32_16x16x32_bf16 v[76:79], v[24:27], a[216:219], v[132:135]
    ds_read_b128 v[44:47], v3 offset:12416
    v_mfma_f32_16x16x32_bf16 v[76:79], v[28:31], a[220:223], v[76:79]
    s_waitcnt lgkmcnt(2)
    buffer_load_dwordx4 v4, s[4:7], s27 offen offset:2048 sc1 lds
    v_mfma_f32_16x16x32_bf16 v[104:107], v[32:35], a[192:195], v[128:131]
    ds_read_b128 v[24:27], v2 offset:18560
    v_mfma_f32_16x16x32_bf16 v[104:107], v[36:39], a[196:199], v[104:107]
    v_exp_f32 v16, v188
    v_add_f32 v5, v5, v18
    v_mfma_f32_16x16x32_bf16 v[108:111], v[32:35], a[216:219], v[132:135]
    ds_read_b128 v[28:31], v3 offset:18560
    v_add_f32 v5, v5, v19
    v_mfma_f32_16x16x32_bf16 v[108:111], v[36:39], a[220:223], v[108:111]
    s_waitcnt lgkmcnt(2)
    v_exp_f32 v17, v189
    v_cvt_pk_bf16_f32 v187, v18, v19
    v_mfma_f32_16x16x32_bf16 v[72:75], v[40:43], a[200:203], v[72:75]
    s_add_u32 s27, s27, 24576
    ds_read_b128 v[32:35], v2 offset:12544
    v_mfma_f32_16x16x32_bf16 v[72:75], v[44:47], a[204:207], v[72:75]
    v_exp_f32 v18, v190
    v_mfma_f32_16x16x32_bf16 v[76:79], v[40:43], a[224:227], v[76:79]
    s_add_u32 s56, s56, 12288
    ds_read_b128 v[36:39], v3 offset:12544
    v_add_f32 v6, v6, v16
    v_mfma_f32_16x16x32_bf16 v[76:79], v[44:47], a[228:231], v[76:79]
    s_waitcnt lgkmcnt(2)
    v_add_f32 v6, v6, v17
    v_mfma_f32_16x16x32_bf16 v[104:107], v[24:27], a[200:203], v[104:107]
    ds_read_b128 v[40:43], v2 offset:18688
    v_mfma_f32_16x16x32_bf16 v[104:107], v[28:31], a[204:207], v[104:107]
    v_exp_f32 v19, v191
    v_cvt_pk_bf16_f32 v188, v16, v17
    v_mfma_f32_16x16x32_bf16 v[108:111], v[24:27], a[224:227], v[108:111]
    s_mov_b32 m0, s56
    ds_read_b128 v[44:47], v3 offset:18688
    v_mfma_f32_16x16x32_bf16 v[108:111], v[28:31], a[228:231], v[108:111]
    s_waitcnt lgkmcnt(2)
    v_add_u32 v2, 49152, v2
    v_add_u32 v3, 49152, v3
    v_mfma_f32_16x16x32_bf16 v[72:75], v[32:35], a[208:211], v[72:75]
    ds_read_b128 v[24:27], v2 offset:0
    v_mfma_f32_16x16x32_bf16 v[72:75], v[36:39], a[212:215], v[72:75]
    buffer_load_dwordx4 v4, s[4:7], s27 offen offset:0 sc1 lds
    v_mfma_f32_16x16x32_bf16 v[76:79], v[32:35], a[232:235], v[76:79]
    ds_read_b128 v[28:31], v3 offset:0
    v_mfma_f32_16x16x32_bf16 v[76:79], v[36:39], a[236:239], v[76:79]
    s_waitcnt lgkmcnt(2)
    v_exp_f32 v16, v124
    v_add_f32 v6, v6, v18
    v_mfma_f32_16x16x32_bf16 v[104:107], v[40:43], a[208:211], v[104:107]
    ds_read_b128 v[32:35], v2 offset:6144
    v_add_f32 v6, v6, v19
    v_mfma_f32_16x16x32_bf16 v[104:107], v[44:47], a[212:215], v[104:107]
    v_exp_f32 v17, v125
    v_cvt_pk_bf16_f32 v189, v18, v19
    v_mfma_f32_16x16x32_bf16 v[108:111], v[40:43], a[232:235], v[108:111]
    ds_read_b128 v[36:39], v3 offset:6144
    v_mfma_f32_16x16x32_bf16 v[108:111], v[44:47], a[236:239], v[108:111]
    s_waitcnt lgkmcnt(2)
    buffer_load_dwordx4 v4, s[4:7], s27 offen offset:1024 sc1 lds
    v_mfma_f32_16x16x32_bf16 v[80:83], v[24:27], a[240:243], v[136:139]
    ds_read_b128 v[40:43], v2 offset:128
    v_mfma_f32_16x16x32_bf16 v[80:83], v[28:31], a[244:247], v[80:83]
    v_exp_f32 v18, v126
    v_add_f32 v6, v6, v16
    v_mfma_f32_16x16x32_bf16 v[84:87], v[24:27], v[200:203], v[140:143]
    ds_read_b128 v[44:47], v3 offset:128
    v_add_f32 v6, v6, v17
    v_exp_f32 v19, v127
    v_cvt_pk_bf16_f32 v190, v16, v17
    v_add_f32 v6, v6, v18
    v_add_f32 v6, v6, v19
    v_cvt_pk_bf16_f32 v191, v18, v19
    v_mfma_f32_16x16x32_bf16 v[84:87], v[28:31], v[204:207], v[84:87]
    s_waitcnt lgkmcnt(2)
    v_exp_f32 v16, v64
    v_mfma_f32_16x16x32_bf16 v[112:115], v[32:35], a[240:243], v[136:139]
    ds_read_b128 v[24:27], v2 offset:6272
    v_mfma_f32_16x16x32_bf16 v[112:115], v[36:39], a[244:247], v[112:115]
    buffer_load_dwordx4 v4, s[4:7], s27 offen offset:2048 sc1 lds
    v_mfma_f32_16x16x32_bf16 v[116:119], v[32:35], v[200:203], v[140:143]
    ds_read_b128 v[28:31], v3 offset:6272
    v_mfma_f32_16x16x32_bf16 v[116:119], v[36:39], v[204:207], v[116:119]
    s_waitcnt lgkmcnt(2)
    v_exp_f32 v17, v65
    v_mfma_f32_16x16x32_bf16 v[80:83], v[40:43], a[248:251], v[80:83]
    ds_read_b128 v[32:35], v2 offset:256
    v_mfma_f32_16x16x32_bf16 v[80:83], v[44:47], a[252:255], v[80:83]
    v_exp_f32 v18, v66
    v_mfma_f32_16x16x32_bf16 v[84:87], v[40:43], v[208:211], v[84:87]
    ds_read_b128 v[36:39], v3 offset:256
    v_add_f32 v5, v5, v16
    v_mfma_f32_16x16x32_bf16 v[84:87], v[44:47], v[212:215], v[84:87]
    s_waitcnt lgkmcnt(2)
    v_add_f32 v5, v5, v17
    v_mfma_f32_16x16x32_bf16 v[112:115], v[24:27], a[248:251], v[112:115]
    ds_read_b128 v[40:43], v2 offset:6400
    v_mfma_f32_16x16x32_bf16 v[112:115], v[28:31], a[252:255], v[112:115]
    v_exp_f32 v19, v67
    v_cvt_pk_bf16_f32 v64, v16, v17
    v_mfma_f32_16x16x32_bf16 v[116:119], v[24:27], v[208:211], v[116:119]
    s_add_u32 s27, s27, 24576
    ds_read_b128 v[44:47], v3 offset:6400
    s_add_u32 s56, s56, 36864
    v_mfma_f32_16x16x32_bf16 v[116:119], v[28:31], v[212:215], v[116:119]
    s_waitcnt lgkmcnt(2)
    v_exp_f32 v16, v96
    v_mfma_f32_16x16x32_bf16 v[80:83], v[32:35], v[192:195], v[80:83]
    s_sub_u32 s58, s56, 147456
    ds_read_b128 v[24:27], v2 offset:12288
    v_add_f32 v5, v5, v18
    v_mfma_f32_16x16x32_bf16 v[80:83], v[36:39], v[196:199], v[80:83]
    s_min_u32 s56, s56, s58
    v_add_f32 v5, v5, v19
    v_mfma_f32_16x16x32_bf16 v[84:87], v[32:35], v[216:219], v[84:87]
    ds_read_b128 v[28:31], v3 offset:12288
    v_mfma_f32_16x16x32_bf16 v[84:87], v[36:39], v[220:223], v[84:87]
    s_waitcnt lgkmcnt(2)
    v_exp_f32 v17, v97
    v_cvt_pk_bf16_f32 v65, v18, v19
    v_mfma_f32_16x16x32_bf16 v[112:115], v[40:43], v[192:195], v[112:115]
    ds_read_b128 v[32:35], v2 offset:18432
    v_mfma_f32_16x16x32_bf16 v[112:115], v[44:47], v[196:199], v[112:115]
    v_exp_f32 v18, v98
    v_mfma_f32_16x16x32_bf16 v[116:119], v[40:43], v[216:219], v[116:119]
    ds_read_b128 v[36:39], v3 offset:18432
    v_add_f32 v5, v5, v16
    v_mfma_f32_16x16x32_bf16 v[116:119], v[44:47], v[220:223], v[116:119]
    s_waitcnt lgkmcnt(2)
    v_add_f32 v5, v5, v17
    v_mfma_f32_16x16x32_bf16 v[88:91], v[24:27], a[240:243], v[136:139]
    ds_read_b128 v[40:43], v2 offset:12416
    v_mfma_f32_16x16x32_bf16 v[88:91], v[28:31], a[244:247], v[88:91]
    v_exp_f32 v19, v99
    v_cvt_pk_bf16_f32 v66, v16, v17
    v_mfma_f32_16x16x32_bf16 v[92:95], v[24:27], v[200:203], v[140:143]
    ds_read_b128 v[44:47], v3 offset:12416
    v_mfma_f32_16x16x32_bf16 v[92:95], v[28:31], v[204:207], v[92:95]
    s_waitcnt lgkmcnt(2)
    v_exp_f32 v16, v68
    v_mfma_f32_16x16x32_bf16 v[120:123], v[32:35], a[240:243], v[136:139]
    ds_read_b128 v[24:27], v2 offset:18560
    v_add_f32 v5, v5, v18
    v_mfma_f32_16x16x32_bf16 v[120:123], v[36:39], a[244:247], v[120:123]
    v_add_f32 v5, v5, v19
    v_mfma_f32_16x16x32_bf16 v[124:127], v[32:35], v[200:203], v[140:143]
    ds_read_b128 v[28:31], v3 offset:18560
    v_mfma_f32_16x16x32_bf16 v[124:127], v[36:39], v[204:207], v[124:127]
    s_waitcnt lgkmcnt(2)
    v_exp_f32 v17, v69
    v_cvt_pk_bf16_f32 v67, v18, v19
    v_mfma_f32_16x16x32_bf16 v[88:91], v[40:43], a[248:251], v[88:91]
    ds_read_b128 v[32:35], v2 offset:12544
    v_mfma_f32_16x16x32_bf16 v[88:91], v[44:47], a[252:255], v[88:91]
    v_exp_f32 v18, v70
    v_mfma_f32_16x16x32_bf16 v[92:95], v[40:43], v[208:211], v[92:95]
    ds_read_b128 v[36:39], v3 offset:12544
    v_add_f32 v6, v6, v16
    v_mfma_f32_16x16x32_bf16 v[92:95], v[44:47], v[212:215], v[92:95]
    s_waitcnt lgkmcnt(2)
    v_add_f32 v6, v6, v17
    v_mfma_f32_16x16x32_bf16 v[120:123], v[24:27], a[248:251], v[120:123]
    ds_read_b128 v[40:43], v2 offset:18688
    v_mfma_f32_16x16x32_bf16 v[120:123], v[28:31], a[252:255], v[120:123]
    v_exp_f32 v19, v71
    v_cvt_pk_bf16_f32 v68, v16, v17
    v_mfma_f32_16x16x32_bf16 v[124:127], v[24:27], v[208:211], v[124:127]
    ds_read_b128 v[44:47], v3 offset:18688
    v_mfma_f32_16x16x32_bf16 v[124:127], v[28:31], v[212:215], v[124:127]
    s_waitcnt lgkmcnt(2)
    v_add_u32 v1, 49152, v1
    v_exp_f32 v16, v100
    v_mfma_f32_16x16x32_bf16 v[88:91], v[32:35], v[192:195], v[88:91]
    ds_read_b128 v[24:27], v1 offset:0
    v_add_f32 v6, v6, v18
    v_mfma_f32_16x16x32_bf16 v[88:91], v[36:39], v[196:199], v[88:91]
    v_add_f32 v6, v6, v19
    v_mfma_f32_16x16x32_bf16 v[92:95], v[32:35], v[216:219], v[92:95]
    ds_read_b128 v[28:31], v1 offset:12288
    v_mfma_f32_16x16x32_bf16 v[92:95], v[36:39], v[220:223], v[92:95]
    s_waitcnt lgkmcnt(2)
    v_exp_f32 v17, v101
    v_cvt_pk_bf16_f32 v69, v18, v19
    v_mfma_f32_16x16x32_bf16 v[120:123], v[40:43], v[192:195], v[120:123]
    ds_read_b128 v[32:35], v1 offset:1024
    v_mfma_f32_16x16x32_bf16 v[120:123], v[44:47], v[196:199], v[120:123]
    v_exp_f32 v18, v102
    v_mfma_f32_16x16x32_bf16 v[124:127], v[40:43], v[216:219], v[124:127]
    ds_read_b128 v[36:39], v1 offset:13312
    v_add_f32 v6, v6, v16
    v_mfma_f32_16x16x32_bf16 v[124:127], v[44:47], v[220:223], v[124:127]
    s_waitcnt lgkmcnt(2)
    v_add_f32 v6, v6, v17
    v_exp_f32 v19, v103
    v_cvt_pk_bf16_f32 v70, v16, v17
    v_add_f32 v6, v6, v18
    v_add_f32 v6, v6, v19
    v_cvt_pk_bf16_f32 v71, v18, v19
    v_mfma_f32_16x16x32_bf16 a[0:3], v[160:163], v[24:27], a[0:3]
    ds_read_b128 v[40:43], v1 offset:2048
    v_mfma_f32_16x16x32_bf16 a[0:3], v[168:171], v[28:31], a[0:3]
    v_exp_f32 v16, v72
    v_mfma_f32_16x16x32_bf16 a[48:51], v[164:167], v[24:27], a[48:51]
    ds_read_b128 v[44:47], v1 offset:14336
    v_mfma_f32_16x16x32_bf16 a[48:51], v[172:175], v[28:31], a[48:51]
    s_waitcnt lgkmcnt(2)
    v_exp_f32 v17, v73
    v_mfma_f32_16x16x32_bf16 a[4:7], v[160:163], v[32:35], a[4:7]
    ds_read_b128 v[24:27], v1 offset:3072
    v_mfma_f32_16x16x32_bf16 a[4:7], v[168:171], v[36:39], a[4:7]
    v_exp_f32 v18, v74
    v_mfma_f32_16x16x32_bf16 a[52:55], v[164:167], v[32:35], a[52:55]
    ds_read_b128 v[28:31], v1 offset:15360
    v_add_f32 v5, v5, v16
    v_mfma_f32_16x16x32_bf16 a[52:55], v[172:175], v[36:39], a[52:55]
    s_waitcnt lgkmcnt(2)
    v_add_f32 v5, v5, v17
    v_mfma_f32_16x16x32_bf16 a[8:11], v[160:163], v[40:43], a[8:11]
    ds_read_b128 v[32:35], v1 offset:4096
    v_mfma_f32_16x16x32_bf16 a[8:11], v[168:171], v[44:47], a[8:11]
    v_exp_f32 v19, v75
    v_mfma_f32_16x16x32_bf16 a[56:59], v[164:167], v[40:43], a[56:59]
    ds_read_b128 v[36:39], v1 offset:16384
    v_cvt_pk_bf16_f32 v72, v16, v17
    v_mfma_f32_16x16x32_bf16 a[56:59], v[172:175], v[44:47], a[56:59]
    s_waitcnt lgkmcnt(2)
    v_exp_f32 v16, v104
    v_mfma_f32_16x16x32_bf16 a[12:15], v[160:163], v[24:27], a[12:15]
    ds_read_b128 v[40:43], v1 offset:5120
    v_add_f32 v5, v5, v18
    v_mfma_f32_16x16x32_bf16 a[12:15], v[168:171], v[28:31], a[12:15]
    v_add_f32 v5, v5, v19
    v_mfma_f32_16x16x32_bf16 a[60:63], v[164:167], v[24:27], a[60:63]
    ds_read_b128 v[44:47], v1 offset:17408
    v_mfma_f32_16x16x32_bf16 a[60:63], v[172:175], v[28:31], a[60:63]
    s_waitcnt lgkmcnt(2)
    v_exp_f32 v17, v105
    v_mfma_f32_16x16x32_bf16 a[16:19], v[160:163], v[32:35], a[16:19]
    ds_read_b128 v[24:27], v1 offset:6144
    v_cvt_pk_bf16_f32 v73, v18, v19
    v_mfma_f32_16x16x32_bf16 a[16:19], v[168:171], v[36:39], a[16:19]
    v_exp_f32 v18, v106
    v_mfma_f32_16x16x32_bf16 a[64:67], v[164:167], v[32:35], a[64:67]
    ds_read_b128 v[28:31], v1 offset:18432
    v_add_f32 v5, v5, v16
    v_mfma_f32_16x16x32_bf16 a[64:67], v[172:175], v[36:39], a[64:67]
    s_waitcnt lgkmcnt(2)
    v_add_f32 v5, v5, v17
    v_mfma_f32_16x16x32_bf16 a[20:23], v[160:163], v[40:43], a[20:23]
    ds_read_b128 v[32:35], v1 offset:7168
    v_mfma_f32_16x16x32_bf16 a[20:23], v[168:171], v[44:47], a[20:23]
    v_exp_f32 v19, v107
    v_mfma_f32_16x16x32_bf16 a[68:71], v[164:167], v[40:43], a[68:71]
    ds_read_b128 v[36:39], v1 offset:19456
    v_cvt_pk_bf16_f32 v74, v16, v17
    v_mfma_f32_16x16x32_bf16 a[68:71], v[172:175], v[44:47], a[68:71]
    s_waitcnt lgkmcnt(2)
    v_exp_f32 v16, v76
    v_mfma_f32_16x16x32_bf16 a[24:27], v[160:163], v[24:27], a[24:27]
    ds_read_b128 v[40:43], v1 offset:8192
    v_add_f32 v5, v5, v18
    v_mfma_f32_16x16x32_bf16 a[24:27], v[168:171], v[28:31], a[24:27]
    v_add_f32 v5, v5, v19
    v_mfma_f32_16x16x32_bf16 a[72:75], v[164:167], v[24:27], a[72:75]
    ds_read_b128 v[44:47], v1 offset:20480
    v_mfma_f32_16x16x32_bf16 a[72:75], v[172:175], v[28:31], a[72:75]
    s_waitcnt lgkmcnt(2)
    v_exp_f32 v17, v77
    v_mfma_f32_16x16x32_bf16 a[28:31], v[160:163], v[32:35], a[28:31]
    ds_read_b128 v[24:27], v1 offset:9216
    v_cvt_pk_bf16_f32 v75, v18, v19
    v_mfma_f32_16x16x32_bf16 a[28:31], v[168:171], v[36:39], a[28:31]
    v_exp_f32 v18, v78
    v_mfma_f32_16x16x32_bf16 a[76:79], v[164:167], v[32:35], a[76:79]
    ds_read_b128 v[28:31], v1 offset:21504
    v_add_f32 v6, v6, v16
    v_mfma_f32_16x16x32_bf16 a[76:79], v[172:175], v[36:39], a[76:79]
    s_waitcnt lgkmcnt(2)
    v_add_f32 v6, v6, v17
    v_mfma_f32_16x16x32_bf16 a[32:35], v[160:163], v[40:43], a[32:35]
    ds_read_b128 v[32:35], v1 offset:10240
    v_mfma_f32_16x16x32_bf16 a[32:35], v[168:171], v[44:47], a[32:35]
    v_exp_f32 v19, v79
    v_mfma_f32_16x16x32_bf16 a[80:83], v[164:167], v[40:43], a[80:83]
    ds_read_b128 v[36:39], v1 offset:22528
    v_cvt_pk_bf16_f32 v76, v16, v17
    v_mfma_f32_16x16x32_bf16 a[80:83], v[172:175], v[44:47], a[80:83]
    s_waitcnt lgkmcnt(2)
    v_exp_f32 v16, v108
    v_mfma_f32_16x16x32_bf16 a[36:39], v[160:163], v[24:27], a[36:39]
    ds_read_b128 v[40:43], v1 offset:11264
    v_add_f32 v6, v6, v18
    v_mfma_f32_16x16x32_bf16 a[36:39], v[168:171], v[28:31], a[36:39]
    v_add_f32 v6, v6, v19
    v_mfma_f32_16x16x32_bf16 a[84:87], v[164:167], v[24:27], a[84:87]
    ds_read_b128 v[44:47], v1 offset:23552
    v_mfma_f32_16x16x32_bf16 a[84:87], v[172:175], v[28:31], a[84:87]
    s_waitcnt lgkmcnt(2)
    v_subrev_u32 v1, 98304, v1
    v_mfma_f32_16x16x32_bf16 a[40:43], v[160:163], v[32:35], a[40:43]
    ds_read_b128 v[24:27], v1 offset:0
    v_mfma_f32_16x16x32_bf16 a[40:43], v[168:171], v[36:39], a[40:43]
    v_exp_f32 v17, v109
    v_mfma_f32_16x16x32_bf16 a[88:91], v[164:167], v[32:35], a[88:91]
    ds_read_b128 v[28:31], v1 offset:12288
    v_cvt_pk_bf16_f32 v77, v18, v19
    v_mfma_f32_16x16x32_bf16 a[88:91], v[172:175], v[36:39], a[88:91]
    s_waitcnt lgkmcnt(2)
    v_exp_f32 v18, v110
    v_mfma_f32_16x16x32_bf16 a[44:47], v[160:163], v[40:43], a[44:47]
    ds_read_b128 v[32:35], v1 offset:1024
    v_add_f32 v6, v6, v16
    v_mfma_f32_16x16x32_bf16 a[44:47], v[168:171], v[44:47], a[44:47]
    v_add_f32 v6, v6, v17
    v_mfma_f32_16x16x32_bf16 a[92:95], v[164:167], v[40:43], a[92:95]
    ds_read_b128 v[36:39], v1 offset:13312
    v_mfma_f32_16x16x32_bf16 a[92:95], v[172:175], v[44:47], a[92:95]
    s_waitcnt lgkmcnt(2)
    v_exp_f32 v19, v111
    v_mfma_f32_16x16x32_bf16 a[0:3], v[176:179], v[24:27], a[0:3]
    ds_read_b128 v[40:43], v1 offset:2048
    v_cvt_pk_bf16_f32 v78, v16, v17
    v_mfma_f32_16x16x32_bf16 a[0:3], v[184:187], v[28:31], a[0:3]
    v_add_f32 v6, v6, v18
    v_add_f32 v6, v6, v19
    v_mfma_f32_16x16x32_bf16 a[48:51], v[180:183], v[24:27], a[48:51]
    ds_read_b128 v[44:47], v1 offset:14336
    v_cvt_pk_bf16_f32 v79, v18, v19
    v_mfma_f32_16x16x32_bf16 a[48:51], v[188:191], v[28:31], a[48:51]
    s_waitcnt lgkmcnt(2)
    v_exp_f32 v16, v80
    v_mfma_f32_16x16x32_bf16 a[4:7], v[176:179], v[32:35], a[4:7]
    ds_read_b128 v[24:27], v1 offset:3072
    v_mfma_f32_16x16x32_bf16 a[4:7], v[184:187], v[36:39], a[4:7]
    v_exp_f32 v17, v81
    v_mfma_f32_16x16x32_bf16 a[52:55], v[180:183], v[32:35], a[52:55]
    ds_read_b128 v[28:31], v1 offset:15360
    v_mfma_f32_16x16x32_bf16 a[52:55], v[188:191], v[36:39], a[52:55]
    s_waitcnt lgkmcnt(2)
    v_exp_f32 v18, v82
    v_mfma_f32_16x16x32_bf16 a[8:11], v[176:179], v[40:43], a[8:11]
    ds_read_b128 v[32:35], v1 offset:4096
    v_add_f32 v7, v7, v16
    v_mfma_f32_16x16x32_bf16 a[8:11], v[184:187], v[44:47], a[8:11]
    v_add_f32 v7, v7, v17
    v_mfma_f32_16x16x32_bf16 a[56:59], v[180:183], v[40:43], a[56:59]
    ds_read_b128 v[36:39], v1 offset:16384
    v_mfma_f32_16x16x32_bf16 a[56:59], v[188:191], v[44:47], a[56:59]
    s_waitcnt lgkmcnt(2)
    v_exp_f32 v19, v83
    v_mfma_f32_16x16x32_bf16 a[12:15], v[176:179], v[24:27], a[12:15]
    ds_read_b128 v[40:43], v1 offset:5120
    v_cvt_pk_bf16_f32 v80, v16, v17
    v_mfma_f32_16x16x32_bf16 a[12:15], v[184:187], v[28:31], a[12:15]
    v_exp_f32 v16, v112
    v_mfma_f32_16x16x32_bf16 a[60:63], v[180:183], v[24:27], a[60:63]
    ds_read_b128 v[44:47], v1 offset:17408
    v_add_f32 v7, v7, v18
    v_mfma_f32_16x16x32_bf16 a[60:63], v[188:191], v[28:31], a[60:63]
    s_waitcnt lgkmcnt(2)
    v_add_f32 v7, v7, v19
    v_mfma_f32_16x16x32_bf16 a[16:19], v[176:179], v[32:35], a[16:19]
    ds_read_b128 v[24:27], v1 offset:6144
    v_mfma_f32_16x16x32_bf16 a[16:19], v[184:187], v[36:39], a[16:19]
    v_exp_f32 v17, v113
    v_mfma_f32_16x16x32_bf16 a[64:67], v[180:183], v[32:35], a[64:67]
    ds_read_b128 v[28:31], v1 offset:18432
    v_cvt_pk_bf16_f32 v81, v18, v19
    v_mfma_f32_16x16x32_bf16 a[64:67], v[188:191], v[36:39], a[64:67]
    s_waitcnt lgkmcnt(2)
    v_exp_f32 v18, v114
    v_mfma_f32_16x16x32_bf16 a[20:23], v[176:179], v[40:43], a[20:23]
    ds_read_b128 v[32:35], v1 offset:7168
    v_add_f32 v7, v7, v16
    v_mfma_f32_16x16x32_bf16 a[20:23], v[184:187], v[44:47], a[20:23]
    v_add_f32 v7, v7, v17
    v_mfma_f32_16x16x32_bf16 a[68:71], v[180:183], v[40:43], a[68:71]
    ds_read_b128 v[36:39], v1 offset:19456
    v_mfma_f32_16x16x32_bf16 a[68:71], v[188:191], v[44:47], a[68:71]
    s_waitcnt lgkmcnt(2)
    v_exp_f32 v19, v115
    v_mfma_f32_16x16x32_bf16 a[24:27], v[176:179], v[24:27], a[24:27]
    ds_read_b128 v[40:43], v1 offset:8192
    v_cvt_pk_bf16_f32 v82, v16, v17
    v_mfma_f32_16x16x32_bf16 a[24:27], v[184:187], v[28:31], a[24:27]
    v_exp_f32 v16, v84
    v_mfma_f32_16x16x32_bf16 a[72:75], v[180:183], v[24:27], a[72:75]
    ds_read_b128 v[44:47], v1 offset:20480
    v_add_f32 v7, v7, v18
    v_mfma_f32_16x16x32_bf16 a[72:75], v[188:191], v[28:31], a[72:75]
    s_waitcnt lgkmcnt(2)
    v_add_f32 v7, v7, v19
    v_mfma_f32_16x16x32_bf16 a[28:31], v[176:179], v[32:35], a[28:31]
    ds_read_b128 v[24:27], v1 offset:9216
    v_mfma_f32_16x16x32_bf16 a[28:31], v[184:187], v[36:39], a[28:31]
    s_waitcnt vmcnt(0)
    v_exp_f32 v17, v85
    v_mfma_f32_16x16x32_bf16 a[76:79], v[180:183], v[32:35], a[76:79]
    ds_read_b128 v[28:31], v1 offset:21504
    v_cvt_pk_bf16_f32 v83, v18, v19
    v_mfma_f32_16x16x32_bf16 a[76:79], v[188:191], v[36:39], a[76:79]
    s_waitcnt lgkmcnt(2)
    s_barrier
    v_mfma_f32_16x16x32_bf16 a[32:35], v[176:179], v[40:43], a[32:35]
    ds_read_b128 v[32:35], v1 offset:10240
    v_mfma_f32_16x16x32_bf16 a[32:35], v[184:187], v[44:47], a[32:35]
    v_exp_f32 v18, v86
    v_mfma_f32_16x16x32_bf16 a[80:83], v[180:183], v[40:43], a[80:83]
    ds_read_b128 v[36:39], v1 offset:22528
    v_add_f32 v8, v8, v16
    v_mfma_f32_16x16x32_bf16 a[80:83], v[188:191], v[44:47], a[80:83]
    s_waitcnt lgkmcnt(2)
    v_add_f32 v8, v8, v17
    v_mfma_f32_16x16x32_bf16 a[36:39], v[176:179], v[24:27], a[36:39]
    ds_read_b128 v[40:43], v1 offset:11264
    v_mfma_f32_16x16x32_bf16 a[36:39], v[184:187], v[28:31], a[36:39]
    v_exp_f32 v19, v87
    v_cvt_pk_bf16_f32 v84, v16, v17
    v_mfma_f32_16x16x32_bf16 a[84:87], v[180:183], v[24:27], a[84:87]
    ds_read_b128 v[44:47], v1 offset:23552
    v_mfma_f32_16x16x32_bf16 a[84:87], v[188:191], v[28:31], a[84:87]
    s_waitcnt lgkmcnt(2)
    v_add_u32 v1, 49152, v1
    v_exp_f32 v16, v116
    v_mfma_f32_16x16x32_bf16 a[40:43], v[176:179], v[32:35], a[40:43]
    ds_read_b128 v[24:27], v1 offset:0
    v_add_f32 v8, v8, v18
    v_mfma_f32_16x16x32_bf16 a[40:43], v[184:187], v[36:39], a[40:43]
    v_add_f32 v8, v8, v19
    v_mfma_f32_16x16x32_bf16 a[88:91], v[180:183], v[32:35], a[88:91]
    ds_read_b128 v[28:31], v1 offset:12288
    v_mfma_f32_16x16x32_bf16 a[88:91], v[188:191], v[36:39], a[88:91]
    s_waitcnt lgkmcnt(2)
    v_exp_f32 v17, v117
    v_cvt_pk_bf16_f32 v85, v18, v19
    v_mfma_f32_16x16x32_bf16 a[44:47], v[176:179], v[40:43], a[44:47]
    ds_read_b128 v[32:35], v1 offset:1024
    v_mfma_f32_16x16x32_bf16 a[44:47], v[184:187], v[44:47], a[44:47]
    v_exp_f32 v18, v118
    v_mfma_f32_16x16x32_bf16 a[92:95], v[180:183], v[40:43], a[92:95]
    ds_read_b128 v[36:39], v1 offset:13312
    v_add_f32 v8, v8, v16
    v_mfma_f32_16x16x32_bf16 a[92:95], v[188:191], v[44:47], a[92:95]
    s_waitcnt lgkmcnt(2)
    v_add_f32 v8, v8, v17
    v_exp_f32 v19, v119
    v_cvt_pk_bf16_f32 v86, v16, v17
    v_add_f32 v8, v8, v18
    v_add_f32 v8, v8, v19
    v_cvt_pk_bf16_f32 v87, v18, v19
    v_mfma_f32_16x16x32_bf16 a[0:3], v[64:67], v[24:27], a[0:3]
    ds_read_b128 v[40:43], v1 offset:2048
    v_mfma_f32_16x16x32_bf16 a[0:3], v[72:75], v[28:31], a[0:3]
    v_exp_f32 v16, v88
    v_exp_f32 v17, v89
    v_exp_f32 v18, v90
    v_mfma_f32_16x16x4_f32 v[48:51], v5, v57, 0
    v_mfma_f32_16x16x32_bf16 a[48:51], v[68:71], v[24:27], a[48:51]
    ds_read_b128 v[44:47], v1 offset:14336
    v_add_f32 v7, v7, v16
    v_mfma_f32_16x16x32_bf16 a[48:51], v[76:79], v[28:31], a[48:51]
    s_waitcnt lgkmcnt(2)
    v_add_f32 v7, v7, v17
    v_exp_f32 v19, v91
    v_cvt_pk_bf16_f32 v88, v16, v17
    v_exp_f32 v16, v120
    v_mfma_f32_16x16x4_f32 v[52:55], v6, v57, 0
    v_mfma_f32_16x16x32_bf16 a[4:7], v[64:67], v[32:35], a[4:7]
    ds_read_b128 v[24:27], v1 offset:3072
    v_add_f32 v7, v7, v18
    v_mfma_f32_16x16x32_bf16 a[4:7], v[72:75], v[36:39], a[4:7]
    v_add_f32 v7, v7, v19
    v_exp_f32 v17, v121
    v_mfma_f32_16x16x32_bf16 a[52:55], v[68:71], v[32:35], a[52:55]
    ds_read_b128 v[28:31], v1 offset:15360
    v_cvt_pk_bf16_f32 v89, v18, v19
    v_mfma_f32_16x16x32_bf16 a[52:55], v[76:79], v[36:39], a[52:55]
    s_waitcnt lgkmcnt(2)
    v_exp_f32 v18, v122
    v_mfma_f32_16x16x32_bf16 a[8:11], v[64:67], v[40:43], a[8:11]
    ds_read_b128 v[32:35], v1 offset:4096
    v_add_f32 v7, v7, v16
    v_mfma_f32_16x16x32_bf16 a[8:11], v[72:75], v[44:47], a[8:11]
    v_add_f32 v7, v7, v17
    v_exp_f32 v19, v123
    v_mfma_f32_16x16x32_bf16 a[56:59], v[68:71], v[40:43], a[56:59]
    ds_read_b128 v[36:39], v1 offset:16384
    v_cvt_pk_bf16_f32 v90, v16, v17
    v_mfma_f32_16x16x32_bf16 a[56:59], v[76:79], v[44:47], a[56:59]
    s_waitcnt lgkmcnt(2)
    v_exp_f32 v16, v92
    v_mfma_f32_16x16x32_bf16 a[12:15], v[64:67], v[24:27], a[12:15]
    ds_read_b128 v[40:43], v1 offset:5120
    v_add_f32 v7, v7, v18
    v_mfma_f32_16x16x32_bf16 a[12:15], v[72:75], v[28:31], a[12:15]
L_pg9:
    s_cbranch_execz L_iwret
    v_add_f32 v7, v7, v19
    v_exp_f32 v17, v93
    v_mfma_f32_16x16x32_bf16 a[60:63], v[68:71], v[24:27], a[60:63]
    ds_read_b128 v[44:47], v1 offset:17408
    v_cvt_pk_bf16_f32 v91, v18, v19
    v_mfma_f32_16x16x32_bf16 a[60:63], v[76:79], v[28:31], a[60:63]
    s_waitcnt lgkmcnt(2)
    v_exp_f32 v18, v94
    v_mfma_f32_16x16x32_bf16 a[16:19], v[64:67], v[32:35], a[16:19]
    ds_read_b128 v[24:27], v1 offset:6144
    v_add_f32 v8, v8, v16
    v_mfma_f32_16x16x32_bf16 a[16:19], v[72:75], v[36:39], a[16:19]
    v_add_f32 v8, v8, v17
    v_exp_f32 v19, v95
    v_mfma_f32_16x16x32_bf16 a[64:67], v[68:71], v[32:35], a[64:67]
    ds_read_b128 v[28:31], v1 offset:18432
    v_cvt_pk_bf16_f32 v92, v16, v17
    v_mfma_f32_16x16x32_bf16 a[64:67], v[76:79], v[36:39], a[64:67]
    s_waitcnt lgkmcnt(2)
    v_exp_f32 v16, v124
    v_mfma_f32_16x16x32_bf16 a[20:23], v[64:67], v[40:43], a[20:23]
    ds_read_b128 v[32:35], v1 offset:7168
    v_add_f32 v8, v8, v18
    v_mfma_f32_16x16x32_bf16 a[20:23], v[72:75], v[44:47], a[20:23]
    v_add_f32 v8, v8, v19
    v_exp_f32 v17, v125
    v_mfma_f32_16x16x32_bf16 a[68:71], v[68:71], v[40:43], a[68:71]
    ds_read_b128 v[36:39], v1 offset:19456
    v_cvt_pk_bf16_f32 v93, v18, v19
    v_mfma_f32_16x16x32_bf16 a[68:71], v[76:79], v[44:47], a[68:71]
    s_waitcnt lgkmcnt(2)
    v_exp_f32 v18, v126
    v_mfma_f32_16x16x32_bf16 a[24:27], v[64:67], v[24:27], a[24:27]
    ds_read_b128 v[40:43], v1 offset:8192
    v_add_f32 v8, v8, v16
    v_mfma_f32_16x16x32_bf16 a[24:27], v[72:75], v[28:31], a[24:27]
    v_add_f32 v8, v8, v17
    v_exp_f32 v19, v127
    v_mfma_f32_16x16x32_bf16 a[72:75], v[68:71], v[24:27], a[72:75]
    ds_read_b128 v[44:47], v1 offset:20480
    v_cvt_pk_bf16_f32 v94, v16, v17
    v_mfma_f32_16x16x32_bf16 a[72:75], v[76:79], v[28:31], a[72:75]
    s_waitcnt lgkmcnt(2)
    v_add_f32 v8, v8, v18
    v_add_f32 v8, v8, v19
    v_mfma_f32_16x16x32_bf16 a[28:31], v[64:67], v[32:35], a[28:31]
    ds_read_b128 v[24:27], v1 offset:9216
    v_cvt_pk_bf16_f32 v95, v18, v19
    v_mfma_f32_16x16x32_bf16 a[28:31], v[72:75], v[36:39], a[28:31]
    v_rcp_f32 v48, v48
    v_mfma_f32_16x16x32_bf16 a[76:79], v[68:71], v[32:35], a[76:79]
    ds_read_b128 v[28:31], v1 offset:21504
    v_mfma_f32_16x16x32_bf16 a[76:79], v[76:79], v[36:39], a[76:79]
    s_waitcnt lgkmcnt(2)
    v_rcp_f32 v49, v49
    v_mfma_f32_16x16x32_bf16 a[32:35], v[64:67], v[40:43], a[32:35]
    ds_read_b128 v[32:35], v1 offset:10240
    v_mfma_f32_16x16x32_bf16 a[32:35], v[72:75], v[44:47], a[32:35]
    v_rcp_f32 v50, v50
    v_mfma_f32_16x16x32_bf16 a[80:83], v[68:71], v[40:43], a[80:83]
    ds_read_b128 v[36:39], v1 offset:22528
    v_mfma_f32_16x16x32_bf16 a[80:83], v[76:79], v[44:47], a[80:83]
    s_waitcnt lgkmcnt(2)
    v_rcp_f32 v51, v51
    v_mfma_f32_16x16x32_bf16 a[36:39], v[64:67], v[24:27], a[36:39]
    ds_read_b128 v[40:43], v1 offset:11264
    v_mfma_f32_16x16x32_bf16 a[36:39], v[72:75], v[28:31], a[36:39]
    v_rcp_f32 v52, v52
    v_mfma_f32_16x16x32_bf16 a[84:87], v[68:71], v[24:27], a[84:87]
    ds_read_b128 v[44:47], v1 offset:23552
    v_mfma_f32_16x16x32_bf16 a[84:87], v[76:79], v[28:31], a[84:87]
    s_waitcnt lgkmcnt(2)
    v_subrev_u32 v2, 98304, v2
    v_subrev_u32 v3, 98304, v3
    v_mfma_f32_16x16x32_bf16 a[40:43], v[64:67], v[32:35], a[40:43]
    ds_read_b128 v[24:27], v2 offset:0
    v_mfma_f32_16x16x32_bf16 a[40:43], v[72:75], v[36:39], a[40:43]
    v_rcp_f32 v53, v53
    v_mfma_f32_16x16x32_bf16 a[88:91], v[68:71], v[32:35], a[88:91]
    ds_read_b128 v[28:31], v3 offset:0
    v_mfma_f32_16x16x32_bf16 a[88:91], v[76:79], v[36:39], a[88:91]
    s_waitcnt lgkmcnt(2)
    v_rcp_f32 v54, v54
    v_mfma_f32_16x16x32_bf16 a[44:47], v[64:67], v[40:43], a[44:47]
    ds_read_b128 v[32:35], v2 offset:6144
    v_mfma_f32_16x16x32_bf16 a[44:47], v[72:75], v[44:47], a[44:47]
    v_rcp_f32 v55, v55
    v_mfma_f32_16x16x32_bf16 a[92:95], v[68:71], v[40:43], a[92:95]
    ds_read_b128 v[36:39], v3 offset:6144
    v_mfma_f32_16x16x32_bf16 a[92:95], v[76:79], v[44:47], a[92:95]
    s_waitcnt lgkmcnt(2)
    v_mfma_f32_16x16x32_bf16 v[160:163], v[24:27], a[240:243], v[136:139]
    ds_read_b128 v[40:43], v2 offset:128
    v_mfma_f32_16x16x32_bf16 v[160:163], v[28:31], a[244:247], v[160:163]
    v_mfma_f32_16x16x32_bf16 v[164:167], v[24:27], v[200:203], v[140:143]
    ds_read_b128 v[44:47], v3 offset:128
    v_mfma_f32_16x16x32_bf16 v[164:167], v[28:31], v[204:207], v[164:167]
    s_waitcnt lgkmcnt(2)
    v_mfma_f32_16x16x32_bf16 v[96:99], v[32:35], a[240:243], v[136:139]
    ds_read_b128 v[24:27], v2 offset:6272
    v_accvgpr_read_b32 v224, a0
    v_mfma_f32_16x16x32_bf16 v[96:99], v[36:39], a[244:247], v[96:99]
    v_accvgpr_read_b32 v225, a4
    v_accvgpr_read_b32 v226, a8
    v_accvgpr_read_b32 v227, a12
    v_accvgpr_read_b32 v228, a16
    v_accvgpr_read_b32 v229, a20
    v_mfma_f32_16x16x32_bf16 v[100:103], v[32:35], v[200:203], v[140:143]
    ds_read_b128 v[28:31], v3 offset:6272
    v_mul_f32 v224, v224, v48
    v_mfma_f32_16x16x32_bf16 v[100:103], v[36:39], v[204:207], v[100:103]
    s_waitcnt lgkmcnt(2)
    v_mul_f32 v225, v225, v48
    v_mul_f32 v226, v226, v48
    v_mul_f32 v227, v227, v48
    v_mul_f32 v228, v228, v48
    v_mul_f32 v229, v229, v48
    v_cvt_pk_bf16_f32 v224, v224, v225
    v_mfma_f32_16x16x32_bf16 v[160:163], v[40:43], a[248:251], v[160:163]
    ds_read_b128 v[32:35], v2 offset:256
    v_cvt_pk_bf16_f32 v225, v226, v227
    v_mfma_f32_16x16x32_bf16 v[160:163], v[44:47], a[252:255], v[160:163]
    v_cvt_pk_bf16_f32 v226, v228, v229
    v_accvgpr_read_b32 v230, a1
    v_accvgpr_read_b32 v231, a5
    v_accvgpr_read_b32 v232, a9
    v_accvgpr_read_b32 v233, a13
    v_mfma_f32_16x16x32_bf16 v[164:167], v[40:43], v[208:211], v[164:167]
    ds_read_b128 v[36:39], v3 offset:256
    v_accvgpr_read_b32 v234, a17
    v_mfma_f32_16x16x32_bf16 v[164:167], v[44:47], v[212:215], v[164:167]
    s_waitcnt lgkmcnt(2)
    buffer_store_dwordx3 v[224:226], v56, s[12:15], s24 offen offset:0 sc0 sc1
    v_accvgpr_read_b32 v235, a21
    v_mul_f32 v230, v230, v49
    v_mfma_f32_16x16x32_bf16 v[96:99], v[24:27], a[248:251], v[96:99]
    ds_read_b128 v[40:43], v2 offset:6400
    v_mul_f32 v231, v231, v49
    v_mfma_f32_16x16x32_bf16 v[96:99], v[28:31], a[252:255], v[96:99]
    v_mul_f32 v232, v232, v49
    v_mul_f32 v233, v233, v49
    v_mul_f32 v234, v234, v49
    v_mul_f32 v235, v235, v49
    v_cvt_pk_bf16_f32 v230, v230, v231
    v_cvt_pk_bf16_f32 v231, v232, v233
    v_mfma_f32_16x16x32_bf16 v[100:103], v[24:27], v[208:211], v[100:103]
    ds_read_b128 v[44:47], v3 offset:6400
    v_cvt_pk_bf16_f32 v232, v234, v235
    v_mfma_f32_16x16x32_bf16 v[100:103], v[28:31], v[212:215], v[100:103]
    s_waitcnt lgkmcnt(2)
    buffer_store_dwordx3 v[230:232], v56, s[12:15], s24 offen offset:384 sc0 sc1
    v_accvgpr_read_b32 v236, a2
    v_mfma_f32_16x16x32_bf16 v[160:163], v[32:35], v[192:195], v[160:163]
    ds_read_b128 v[24:27], v2 offset:12288
    v_accvgpr_read_b32 v237, a6
    v_mfma_f32_16x16x32_bf16 v[160:163], v[36:39], v[196:199], v[160:163]
    v_accvgpr_read_b32 v238, a10
    v_accvgpr_read_b32 v239, a14
    v_accvgpr_read_b32 v240, a18
    v_accvgpr_read_b32 v241, a22
    v_mul_f32 v236, v236, v50
    v_mul_f32 v237, v237, v50
    v_mfma_f32_16x16x32_bf16 v[164:167], v[32:35], v[216:219], v[164:167]
    ds_read_b128 v[28:31], v3 offset:12288
    v_mul_f32 v238, v238, v50
    v_mfma_f32_16x16x32_bf16 v[164:167], v[36:39], v[220:223], v[164:167]
    s_waitcnt lgkmcnt(2)
    v_mul_f32 v239, v239, v50
    v_mul_f32 v240, v240, v50
    v_mul_f32 v241, v241, v50
    v_cvt_pk_bf16_f32 v236, v236, v237
    v_cvt_pk_bf16_f32 v237, v238, v239
    v_cvt_pk_bf16_f32 v238, v240, v241
    v_mfma_f32_16x16x32_bf16 v[96:99], v[40:43], v[192:195], v[96:99]
    ds_read_b128 v[32:35], v2 offset:18432
    v_accvgpr_read_b32 v242, a3
    v_mfma_f32_16x16x32_bf16 v[96:99], v[44:47], v[196:199], v[96:99]
    buffer_store_dwordx3 v[236:238], v56, s[12:15], s24 offen offset:768 sc0 sc1
    v_accvgpr_read_b32 v243, a7
    v_mfma_f32_16x16x32_bf16 v[100:103], v[40:43], v[216:219], v[100:103]
    ds_read_b128 v[36:39], v3 offset:18432
    v_accvgpr_read_b32 v244, a11
    v_mfma_f32_16x16x32_bf16 v[100:103], v[44:47], v[220:223], v[100:103]
    s_waitcnt lgkmcnt(2)
    v_accvgpr_read_b32 v245, a15
    v_accvgpr_read_b32 v246, a19
    v_accvgpr_read_b32 v247, a23
    v_mul_f32 v242, v242, v51
    v_mul_f32 v243, v243, v51
    v_mul_f32 v244, v244, v51
    v_mfma_f32_16x16x32_bf16 v[168:171], v[24:27], a[240:243], v[136:139]
    ds_read_b128 v[40:43], v2 offset:12416
    v_mul_f32 v245, v245, v51
    v_mfma_f32_16x16x32_bf16 v[168:171], v[28:31], a[244:247], v[168:171]
    v_mul_f32 v246, v246, v51
    v_mul_f32 v247, v247, v51
    v_cvt_pk_bf16_f32 v242, v242, v243
    v_cvt_pk_bf16_f32 v243, v244, v245
    v_cvt_pk_bf16_f32 v244, v246, v247
    v_accvgpr_read_b32 v248, a24
    v_mfma_f32_16x16x32_bf16 v[172:175], v[24:27], v[200:203], v[140:143]
    ds_read_b128 v[44:47], v3 offset:12416
    v_accvgpr_read_b32 v249, a28
    v_mfma_f32_16x16x32_bf16 v[172:175], v[28:31], v[204:207], v[172:175]
    s_waitcnt lgkmcnt(2)
    buffer_store_dwordx3 v[242:244], v56, s[12:15], s24 offen offset:1152 sc0 sc1
    v_accvgpr_read_b32 v250, a32
    v_mfma_f32_16x16x32_bf16 v[104:107], v[32:35], a[240:243], v[136:139]
    ds_read_b128 v[24:27], v2 offset:18560
    v_accvgpr_read_b32 v251, a36
    v_mfma_f32_16x16x32_bf16 v[104:107], v[36:39], a[244:247], v[104:107]
    v_exp_f32 v16, v160
    v_exp_f32 v17, v161
    v_accvgpr_read_b32 v252, a40
    v_accvgpr_read_b32 v253, a44
    v_mfma_f32_16x16x32_bf16 v[108:111], v[32:35], v[200:203], v[140:143]
    ds_read_b128 v[28:31], v3 offset:18560
    v_mul_f32 v248, v248, v48
    v_mfma_f32_16x16x32_bf16 v[108:111], v[36:39], v[204:207], v[108:111]
    s_waitcnt lgkmcnt(2)
    v_exp_f32 v18, v162
    v_add_f32 v7, v7, v16
    v_mul_f32 v249, v249, v48
    v_mul_f32 v250, v250, v48
    v_add_f32 v7, v7, v17
    v_mfma_f32_16x16x32_bf16 v[168:171], v[40:43], a[248:251], v[168:171]
    ds_read_b128 v[32:35], v2 offset:12544
    v_mul_f32 v251, v251, v48
    v_mfma_f32_16x16x32_bf16 v[168:171], v[44:47], a[252:255], v[168:171]
    v_exp_f32 v19, v163
    v_mul_f32 v252, v252, v48
    v_mul_f32 v253, v253, v48
    v_cvt_pk_bf16_f32 v160, v16, v17
    v_mfma_f32_16x16x32_bf16 v[172:175], v[40:43], v[208:211], v[172:175]
    ds_read_b128 v[36:39], v3 offset:12544
    v_cvt_pk_bf16_f32 v248, v248, v249
    v_mfma_f32_16x16x32_bf16 v[172:175], v[44:47], v[212:215], v[172:175]
    s_waitcnt lgkmcnt(2)
    v_exp_f32 v16, v96
    v_cvt_pk_bf16_f32 v249, v250, v251
    v_cvt_pk_bf16_f32 v250, v252, v253
    v_accvgpr_read_b32 v224, a25
    v_add_f32 v7, v7, v18
    v_mfma_f32_16x16x32_bf16 v[104:107], v[24:27], a[248:251], v[104:107]
    ds_read_b128 v[40:43], v2 offset:18688
    v_accvgpr_read_b32 v225, a29
    v_mfma_f32_16x16x32_bf16 v[104:107], v[28:31], a[252:255], v[104:107]
    buffer_store_dwordx3 v[248:250], v56, s[12:15], s24 offen offset:192 sc0 sc1
    v_add_f32 v7, v7, v19
    v_mfma_f32_16x16x32_bf16 v[108:111], v[24:27], v[208:211], v[108:111]
    ds_read_b128 v[44:47], v3 offset:18688
    v_accvgpr_read_b32 v226, a33
    v_mfma_f32_16x16x32_bf16 v[108:111], v[28:31], v[212:215], v[108:111]
    s_waitcnt lgkmcnt(2)
    v_add_u32 v2, 49152, v2
    v_add_u32 v3, 49152, v3
    v_exp_f32 v17, v97
    v_accvgpr_read_b32 v227, a37
    v_cvt_pk_bf16_f32 v161, v18, v19
    v_mfma_f32_16x16x32_bf16 v[168:171], v[32:35], v[192:195], v[168:171]
    ds_read_b128 v[24:27], v2 offset:0
    v_accvgpr_read_b32 v228, a41
    v_mfma_f32_16x16x32_bf16 v[168:171], v[36:39], v[196:199], v[168:171]
    v_exp_f32 v18, v98
    v_accvgpr_read_b32 v229, a45
    v_mul_f32 v224, v224, v49
    v_mul_f32 v225, v225, v49
    v_add_f32 v7, v7, v16
    v_mfma_f32_16x16x32_bf16 v[172:175], v[32:35], v[216:219], v[172:175]
    ds_read_b128 v[28:31], v3 offset:0
    v_mul_f32 v226, v226, v49
    v_mfma_f32_16x16x32_bf16 v[172:175], v[36:39], v[220:223], v[172:175]
    s_waitcnt lgkmcnt(2)
    v_add_f32 v7, v7, v17
    v_exp_f32 v19, v99
    v_mul_f32 v227, v227, v49
    v_mul_f32 v228, v228, v49
    v_mfma_f32_16x16x32_bf16 v[104:107], v[40:43], v[192:195], v[104:107]
    ds_read_b128 v[32:35], v2 offset:6144
    v_mul_f32 v229, v229, v49
    v_mfma_f32_16x16x32_bf16 v[104:107], v[44:47], v[196:199], v[104:107]
    v_cvt_pk_bf16_f32 v162, v16, v17
    v_cvt_pk_bf16_f32 v224, v224, v225
    v_exp_f32 v16, v164
    v_cvt_pk_bf16_f32 v225, v226, v227
    v_cvt_pk_bf16_f32 v226, v228, v229
    v_mfma_f32_16x16x32_bf16 v[108:111], v[40:43], v[216:219], v[108:111]
    ds_read_b128 v[36:39], v3 offset:6144
    v_accvgpr_read_b32 v230, a26
    v_mfma_f32_16x16x32_bf16 v[108:111], v[44:47], v[220:223], v[108:111]
    s_waitcnt lgkmcnt(2)
    buffer_store_dwordx3 v[224:226], v56, s[12:15], s24 offen offset:576 sc0 sc1
    v_add_f32 v7, v7, v18
    v_add_f32 v7, v7, v19
    v_mfma_f32_16x16x32_bf16 v[176:179], v[24:27], a[240:243], v[136:139]
    ds_read_b128 v[40:43], v2 offset:128
    v_accvgpr_read_b32 v231, a30
    v_mfma_f32_16x16x32_bf16 v[176:179], v[28:31], a[244:247], v[176:179]
    v_exp_f32 v17, v165
    v_accvgpr_read_b32 v232, a34
    v_accvgpr_read_b32 v233, a38
    v_accvgpr_read_b32 v234, a42
    v_mfma_f32_16x16x32_bf16 v[180:183], v[24:27], v[200:203], v[140:143]
    ds_read_b128 v[44:47], v3 offset:128
    v_cvt_pk_bf16_f32 v163, v18, v19
    v_mfma_f32_16x16x32_bf16 v[180:183], v[28:31], v[204:207], v[180:183]
    s_waitcnt lgkmcnt(2)
    v_exp_f32 v18, v166
    v_accvgpr_read_b32 v235, a46
    v_mul_f32 v230, v230, v50
    v_mul_f32 v231, v231, v50
    v_add_f32 v8, v8, v16
    v_mfma_f32_16x16x32_bf16 v[112:115], v[32:35], a[240:243], v[136:139]
    ds_read_b128 v[24:27], v2 offset:6272
    v_mul_f32 v232, v232, v50
    v_mfma_f32_16x16x32_bf16 v[112:115], v[36:39], a[244:247], v[112:115]
    v_add_f32 v8, v8, v17
    v_mul_f32 v233, v233, v50
    v_exp_f32 v19, v167
    v_mul_f32 v234, v234, v50
    v_mul_f32 v235, v235, v50
    v_mfma_f32_16x16x32_bf16 v[116:119], v[32:35], v[200:203], v[140:143]
    ds_read_b128 v[28:31], v3 offset:6272
    v_cvt_pk_bf16_f32 v230, v230, v231
    v_mfma_f32_16x16x32_bf16 v[116:119], v[36:39], v[204:207], v[116:119]
    s_waitcnt lgkmcnt(2)
    v_cvt_pk_bf16_f32 v164, v16, v17
    v_cvt_pk_bf16_f32 v231, v232, v233
    v_exp_f32 v16, v100
    v_cvt_pk_bf16_f32 v232, v234, v235
    v_mfma_f32_16x16x32_bf16 v[176:179], v[40:43], a[248:251], v[176:179]
    ds_read_b128 v[32:35], v2 offset:256
    v_accvgpr_read_b32 v236, a27
    v_mfma_f32_16x16x32_bf16 v[176:179], v[44:47], a[252:255], v[176:179]
    buffer_store_dwordx3 v[230:232], v56, s[12:15], s24 offen offset:960 sc0 sc1
    v_add_f32 v8, v8, v18
    v_accvgpr_read_b32 v237, a31
    v_mfma_f32_16x16x32_bf16 v[180:183], v[40:43], v[208:211], v[180:183]
    ds_read_b128 v[36:39], v3 offset:256
    v_add_f32 v8, v8, v19
    v_mfma_f32_16x16x32_bf16 v[180:183], v[44:47], v[212:215], v[180:183]
    s_waitcnt lgkmcnt(2)
    v_exp_f32 v17, v101
    v_accvgpr_read_b32 v238, a35
    v_accvgpr_read_b32 v239, a39
    v_accvgpr_read_b32 v240, a43
    v_accvgpr_read_b32 v241, a47
    v_mfma_f32_16x16x32_bf16 v[112:115], v[24:27], a[248:251], v[112:115]
    ds_read_b128 v[40:43], v2 offset:6400
    v_cvt_pk_bf16_f32 v165, v18, v19
    v_mfma_f32_16x16x32_bf16 v[112:115], v[28:31], a[252:255], v[112:115]
    v_exp_f32 v18, v102
    v_mul_f32 v236, v236, v51
    v_mul_f32 v237, v237, v51
    v_mul_f32 v238, v238, v51
    v_mfma_f32_16x16x32_bf16 v[116:119], v[24:27], v[208:211], v[116:119]
    ds_read_b128 v[44:47], v3 offset:6400
    v_add_f32 v8, v8, v16
    v_mfma_f32_16x16x32_bf16 v[116:119], v[28:31], v[212:215], v[116:119]
    s_waitcnt lgkmcnt(2)
    v_add_f32 v8, v8, v17
    v_mul_f32 v239, v239, v51
    v_mul_f32 v240, v240, v51
    v_exp_f32 v19, v103
    v_mul_f32 v241, v241, v51
    v_mfma_f32_16x16x32_bf16 v[176:179], v[32:35], v[192:195], v[176:179]
    ds_read_b128 v[24:27], v2 offset:12288
    v_cvt_pk_bf16_f32 v236, v236, v237
    v_mfma_f32_16x16x32_bf16 v[176:179], v[36:39], v[196:199], v[176:179]
    v_cvt_pk_bf16_f32 v166, v16, v17
    v_cvt_pk_bf16_f32 v237, v238, v239
    v_cvt_pk_bf16_f32 v238, v240, v241
    v_add_f32 v8, v8, v18
    v_accvgpr_read_b32 v242, a48
    v_mfma_f32_16x16x32_bf16 v[180:183], v[32:35], v[216:219], v[180:183]
    ds_read_b128 v[28:31], v3 offset:12288
    v_add_f32 v8, v8, v19
    v_mfma_f32_16x16x32_bf16 v[180:183], v[36:39], v[220:223], v[180:183]
    s_waitcnt lgkmcnt(2)
    buffer_store_dwordx3 v[236:238], v56, s[12:15], s24 offen offset:1344 sc0 sc1
    v_accvgpr_read_b32 v243, a52
    v_cvt_pk_bf16_f32 v167, v18, v19
    v_mfma_f32_16x16x32_bf16 v[112:115], v[40:43], v[192:195], v[112:115]
    ds_read_b128 v[32:35], v2 offset:18432
    v_accvgpr_read_b32 v244, a56
    v_mfma_f32_16x16x32_bf16 v[112:115], v[44:47], v[196:199], v[112:115]
    v_exp_f32 v16, v168
    v_accvgpr_read_b32 v245, a60
    v_accvgpr_read_b32 v246, a64
    v_accvgpr_read_b32 v247, a68
    v_mul_f32 v242, v242, v52
    v_mfma_f32_16x16x32_bf16 v[116:119], v[40:43], v[216:219], v[116:119]
    ds_read_b128 v[36:39], v3 offset:18432
    v_mul_f32 v243, v243, v52
    v_mfma_f32_16x16x32_bf16 v[116:119], v[44:47], v[220:223], v[116:119]
    s_waitcnt lgkmcnt(2)
    v_exp_f32 v17, v169
    v_exp_f32 v18, v170
    v_mul_f32 v244, v244, v52
    v_mfma_f32_16x16x32_bf16 v[184:187], v[24:27], a[240:243], v[136:139]
    ds_read_b128 v[40:43], v2 offset:12416
    v_mul_f32 v245, v245, v52
    v_mfma_f32_16x16x32_bf16 v[184:187], v[28:31], a[244:247], v[184:187]
    v_add_f32 v7, v7, v16
    v_mul_f32 v246, v246, v52
    v_mul_f32 v247, v247, v52
    v_add_f32 v7, v7, v17
    v_cvt_pk_bf16_f32 v242, v242, v243
    v_cvt_pk_bf16_f32 v243, v244, v245
    v_mfma_f32_16x16x32_bf16 v[188:191], v[24:27], v[200:203], v[140:143]
    ds_read_b128 v[44:47], v3 offset:12416
    v_cvt_pk_bf16_f32 v244, v246, v247
    v_mfma_f32_16x16x32_bf16 v[188:191], v[28:31], v[204:207], v[188:191]
    s_waitcnt lgkmcnt(2)
    buffer_store_dwordx3 v[242:244], v56, s[12:15], s40 offen offset:0 sc0 sc1
    v_exp_f32 v19, v171
    v_mfma_f32_16x16x32_bf16 v[120:123], v[32:35], a[240:243], v[136:139]
    ds_read_b128 v[24:27], v2 offset:18560
    v_cvt_pk_bf16_f32 v168, v16, v17
    v_mfma_f32_16x16x32_bf16 v[120:123], v[36:39], a[244:247], v[120:123]
    v_exp_f32 v16, v104
    v_accvgpr_read_b32 v248, a49
    v_accvgpr_read_b32 v249, a53
    v_accvgpr_read_b32 v250, a57
    v_mfma_f32_16x16x32_bf16 v[124:127], v[32:35], v[200:203], v[140:143]
    ds_read_b128 v[28:31], v3 offset:18560
    v_add_f32 v7, v7, v18
    v_mfma_f32_16x16x32_bf16 v[124:127], v[36:39], v[204:207], v[124:127]
    s_waitcnt lgkmcnt(2)
    v_accvgpr_read_b32 v251, a61
    v_add_f32 v7, v7, v19
    v_accvgpr_read_b32 v252, a65
    v_accvgpr_read_b32 v253, a69
    v_mul_f32 v248, v248, v53
    v_mul_f32 v249, v249, v53
    v_mfma_f32_16x16x32_bf16 v[184:187], v[40:43], a[248:251], v[184:187]
    ds_read_b128 v[32:35], v2 offset:12544
    v_mul_f32 v250, v250, v53
    v_mfma_f32_16x16x32_bf16 v[184:187], v[44:47], a[252:255], v[184:187]
    v_exp_f32 v17, v105
    v_cvt_pk_bf16_f32 v169, v18, v19
    v_mul_f32 v251, v251, v53
    v_mul_f32 v252, v252, v53
    v_mul_f32 v253, v253, v53
    v_mfma_f32_16x16x32_bf16 v[188:191], v[40:43], v[208:211], v[188:191]
    ds_read_b128 v[36:39], v3 offset:12544
    v_cvt_pk_bf16_f32 v248, v248, v249
    v_mfma_f32_16x16x32_bf16 v[188:191], v[44:47], v[212:215], v[188:191]
    s_waitcnt lgkmcnt(2)
    v_exp_f32 v18, v106
    v_add_f32 v7, v7, v16
    v_cvt_pk_bf16_f32 v249, v250, v251
    v_cvt_pk_bf16_f32 v250, v252, v253
    v_mfma_f32_16x16x32_bf16 v[120:123], v[24:27], a[248:251], v[120:123]
    ds_read_b128 v[40:43], v2 offset:18688
    v_add_f32 v7, v7, v17
    v_mfma_f32_16x16x32_bf16 v[120:123], v[28:31], a[252:255], v[120:123]
    buffer_store_dwordx3 v[248:250], v56, s[12:15], s40 offen offset:384 sc0 sc1
    v_exp_f32 v19, v107
    v_mfma_f32_16x16x32_bf16 v[124:127], v[24:27], v[208:211], v[124:127]
    ds_read_b128 v[44:47], v3 offset:18688
    v_accvgpr_read_b32 v224, a50
    v_mfma_f32_16x16x32_bf16 v[124:127], v[28:31], v[212:215], v[124:127]
    s_waitcnt lgkmcnt(2)
    v_add_u32 v22, 49152, v1
    v_mov_b32 v23, v1
    v_subrev_u32 v1, 49152, v1
    v_accvgpr_read_b32 v225, a54
    v_cvt_pk_bf16_f32 v170, v16, v17
    v_accvgpr_read_b32 v226, a58
    v_mfma_f32_16x16x32_bf16 v[184:187], v[32:35], v[192:195], v[184:187]
    ds_read_b128 v[24:27], v22 offset:0
    v_accvgpr_read_b32 v227, a62
    v_mfma_f32_16x16x32_bf16 v[184:187], v[36:39], v[196:199], v[184:187]
    v_exp_f32 v16, v172
    v_accvgpr_read_b32 v228, a66
    v_accvgpr_read_b32 v229, a70
    v_add_f32 v7, v7, v18
    v_mfma_f32_16x16x32_bf16 v[188:191], v[32:35], v[216:219], v[188:191]
    ds_read_b128 v[28:31], v22 offset:12288
    v_mul_f32 v224, v224, v54
    v_mfma_f32_16x16x32_bf16 v[188:191], v[36:39], v[220:223], v[188:191]
    s_waitcnt lgkmcnt(2)
    v_add_f32 v7, v7, v19
    v_mul_f32 v225, v225, v54
    v_exp_f32 v17, v173
    v_mul_f32 v226, v226, v54
    v_mul_f32 v227, v227, v54
    v_mfma_f32_16x16x32_bf16 v[120:123], v[40:43], v[192:195], v[120:123]
    ds_read_b128 v[32:35], v22 offset:1024
    v_mul_f32 v228, v228, v54
    v_mfma_f32_16x16x32_bf16 v[120:123], v[44:47], v[196:199], v[120:123]
    v_cvt_pk_bf16_f32 v171, v18, v19
    v_mul_f32 v229, v229, v54
    v_cvt_pk_bf16_f32 v224, v224, v225
    v_cvt_pk_bf16_f32 v225, v226, v227
    v_cvt_pk_bf16_f32 v226, v228, v229
    v_mfma_f32_16x16x32_bf16 v[124:127], v[40:43], v[216:219], v[124:127]
    ds_read_b128 v[36:39], v22 offset:13312
    v_accvgpr_read_b32 v230, a51
    v_mfma_f32_16x16x32_bf16 v[124:127], v[44:47], v[220:223], v[124:127]
    s_waitcnt lgkmcnt(2)
    buffer_store_dwordx3 v[224:226], v56, s[12:15], s40 offen offset:768 sc0 sc1
    v_exp_f32 v18, v174
    v_mfma_f32_16x16x32_bf16 a[96:99], v[80:83], v[24:27], a[96:99]
    ds_read_b128 v[40:43], v22 offset:2048
    v_add_f32 v8, v8, v16
    v_mfma_f32_16x16x32_bf16 a[96:99], v[88:91], v[28:31], a[96:99]
    v_add_f32 v8, v8, v17
    v_accvgpr_read_b32 v231, a55
    v_accvgpr_read_b32 v232, a59
    v_exp_f32 v19, v175
    v_accvgpr_read_b32 v233, a63
    v_mfma_f32_16x16x32_bf16 a[144:147], v[84:87], v[24:27], a[144:147]
    ds_read_b128 v[44:47], v22 offset:14336
    v_accvgpr_read_b32 v234, a67
    v_mfma_f32_16x16x32_bf16 a[144:147], v[92:95], v[28:31], a[144:147]
    s_waitcnt lgkmcnt(2)
    v_cvt_pk_bf16_f32 v172, v16, v17
    v_accvgpr_read_b32 v235, a71
    v_mul_f32 v230, v230, v55
    v_mul_f32 v231, v231, v55
    v_mul_f32 v232, v232, v55
    v_mfma_f32_16x16x32_bf16 a[100:103], v[80:83], v[32:35], a[100:103]
    ds_read_b128 v[24:27], v22 offset:3072
    v_mul_f32 v233, v233, v55
    v_mfma_f32_16x16x32_bf16 a[100:103], v[88:91], v[36:39], a[100:103]
    v_exp_f32 v16, v108
    v_mul_f32 v234, v234, v55
    v_mul_f32 v235, v235, v55
    v_add_f32 v8, v8, v18
    v_cvt_pk_bf16_f32 v230, v230, v231
    v_mfma_f32_16x16x32_bf16 a[148:151], v[84:87], v[32:35], a[148:151]
    ds_read_b128 v[28:31], v22 offset:15360
    v_add_f32 v8, v8, v19
    v_mfma_f32_16x16x32_bf16 a[148:151], v[92:95], v[36:39], a[148:151]
    s_waitcnt lgkmcnt(2)
    v_cvt_pk_bf16_f32 v231, v232, v233
    v_cvt_pk_bf16_f32 v232, v234, v235
    v_exp_f32 v17, v109
    v_accvgpr_read_b32 v236, a72
    v_accvgpr_read_b32 v237, a76
    v_mfma_f32_16x16x32_bf16 a[104:107], v[80:83], v[40:43], a[104:107]
    ds_read_b128 v[32:35], v22 offset:4096
    v_accvgpr_read_b32 v238, a80
    v_mfma_f32_16x16x32_bf16 a[104:107], v[88:91], v[44:47], a[104:107]
    buffer_store_dwordx3 v[230:232], v56, s[12:15], s40 offen offset:1152 sc0 sc1
    v_cvt_pk_bf16_f32 v173, v18, v19
    v_mfma_f32_16x16x32_bf16 a[152:155], v[84:87], v[40:43], a[152:155]
    ds_read_b128 v[36:39], v22 offset:16384
    v_accvgpr_read_b32 v239, a84
    v_mfma_f32_16x16x32_bf16 a[152:155], v[92:95], v[44:47], a[152:155]
    s_waitcnt lgkmcnt(2)
    v_exp_f32 v18, v110
    v_accvgpr_read_b32 v240, a88
    v_accvgpr_read_b32 v241, a92
    v_mul_f32 v236, v236, v52
    v_mul_f32 v237, v237, v52
    v_mfma_f32_16x16x32_bf16 a[108:111], v[80:83], v[24:27], a[108:111]
    ds_read_b128 v[40:43], v22 offset:5120
    v_add_f32 v8, v8, v16
    v_mfma_f32_16x16x32_bf16 a[108:111], v[88:91], v[28:31], a[108:111]
    v_mul_f32 v238, v238, v52
    v_mul_f32 v239, v239, v52
    v_mul_f32 v240, v240, v52
    v_add_f32 v8, v8, v17
    v_mul_f32 v241, v241, v52
    v_cvt_pk_bf16_f32 v236, v236, v237
    v_mfma_f32_16x16x32_bf16 a[156:159], v[84:87], v[24:27], a[156:159]
    ds_read_b128 v[44:47], v22 offset:17408
    v_cvt_pk_bf16_f32 v237, v238, v239
    v_mfma_f32_16x16x32_bf16 a[156:159], v[92:95], v[28:31], a[156:159]
    s_waitcnt lgkmcnt(2)
    v_exp_f32 v19, v111
    v_cvt_pk_bf16_f32 v238, v240, v241
    v_accvgpr_read_b32 v242, a73
    v_accvgpr_read_b32 v243, a77
    v_mfma_f32_16x16x32_bf16 a[112:115], v[80:83], v[32:35], a[112:115]
    ds_read_b128 v[24:27], v1 offset:0
    v_accvgpr_read_b32 v244, a81
    v_mfma_f32_16x16x32_bf16 a[112:115], v[88:91], v[36:39], a[112:115]
    buffer_store_dwordx3 v[236:238], v56, s[12:15], s40 offen offset:192 sc0 sc1
    v_cvt_pk_bf16_f32 v174, v16, v17
    v_accvgpr_read_b32 v245, a85
    v_mfma_f32_16x16x32_bf16 a[160:163], v[84:87], v[32:35], a[160:163]
    ds_read_b128 v[28:31], v1 offset:12288
    v_add_f32 v8, v8, v18
    v_mfma_f32_16x16x32_bf16 a[160:163], v[92:95], v[36:39], a[160:163]
    s_waitcnt lgkmcnt(2)
    v_accvgpr_read_b32 v246, a89
    v_accvgpr_read_b32 v247, a93
    v_mul_f32 v242, v242, v53
    v_add_f32 v8, v8, v19
    v_mul_f32 v243, v243, v53
    v_mul_f32 v244, v244, v53
    v_mfma_f32_16x16x32_bf16 a[116:119], v[80:83], v[40:43], a[116:119]
    ds_read_b128 v[32:35], v1 offset:1024
    v_mul_f32 v245, v245, v53
    v_mfma_f32_16x16x32_bf16 a[116:119], v[88:91], v[44:47], a[116:119]
    v_cvt_pk_bf16_f32 v175, v18, v19
    v_exp_f32 v16, v176
    v_exp_f32 v17, v177
    v_mfma_f32_16x16x32_bf16 a[164:167], v[84:87], v[40:43], a[164:167]
    ds_read_b128 v[36:39], v1 offset:13312
    v_mul_f32 v246, v246, v53
    v_mfma_f32_16x16x32_bf16 a[164:167], v[92:95], v[44:47], a[164:167]
    s_waitcnt lgkmcnt(2)
    v_exp_f32 v18, v178
    v_add_f32 v7, v7, v16
    v_add_f32 v7, v7, v17
    v_exp_f32 v19, v179
    v_mfma_f32_16x16x32_bf16 a[96:99], v[160:163], v[24:27], a[96:99]
    ds_read_b128 v[40:43], v1 offset:2048
    v_cvt_pk_bf16_f32 v176, v16, v17
    v_mfma_f32_16x16x32_bf16 a[96:99], v[168:171], v[28:31], a[96:99]
    v_exp_f32 v16, v112
    v_add_f32 v7, v7, v18
    v_add_f32 v7, v7, v19
    v_mul_f32 v247, v247, v53
    v_mfma_f32_16x16x32_bf16 a[144:147], v[164:167], v[24:27], a[144:147]
    ds_read_b128 v[44:47], v1 offset:14336
    v_cvt_pk_bf16_f32 v242, v242, v243
    v_mfma_f32_16x16x32_bf16 a[144:147], v[172:175], v[28:31], a[144:147]
L_pg10:
    s_cbranch_execz L_iwret
    s_waitcnt lgkmcnt(2)
    v_exp_f32 v17, v113
    v_cvt_pk_bf16_f32 v177, v18, v19
    v_exp_f32 v18, v114
    v_add_f32 v7, v7, v16
    v_mfma_f32_16x16x32_bf16 a[100:103], v[160:163], v[32:35], a[100:103]
    ds_read_b128 v[24:27], v1 offset:3072
    v_add_f32 v7, v7, v17
    v_mfma_f32_16x16x32_bf16 a[100:103], v[168:171], v[36:39], a[100:103]
    v_exp_f32 v19, v115
    v_cvt_pk_bf16_f32 v178, v16, v17
    v_exp_f32 v16, v180
    v_add_f32 v7, v7, v18
    v_mfma_f32_16x16x32_bf16 a[148:151], v[164:167], v[32:35], a[148:151]
    ds_read_b128 v[28:31], v1 offset:15360
    v_add_f32 v7, v7, v19
    v_mfma_f32_16x16x32_bf16 a[148:151], v[172:175], v[36:39], a[148:151]
    s_waitcnt lgkmcnt(2)
    v_exp_f32 v17, v181
    v_cvt_pk_bf16_f32 v179, v18, v19
    v_exp_f32 v18, v182
    v_mfma_f32_16x16x32_bf16 a[104:107], v[160:163], v[40:43], a[104:107]
    ds_read_b128 v[32:35], v1 offset:4096
    v_add_f32 v8, v8, v16
    v_mfma_f32_16x16x32_bf16 a[104:107], v[168:171], v[44:47], a[104:107]
    v_add_f32 v8, v8, v17
    v_exp_f32 v19, v183
    v_cvt_pk_bf16_f32 v180, v16, v17
    v_exp_f32 v16, v116
    v_mfma_f32_16x16x32_bf16 a[152:155], v[164:167], v[40:43], a[152:155]
    ds_read_b128 v[36:39], v1 offset:16384
    v_add_f32 v8, v8, v18
    v_mfma_f32_16x16x32_bf16 a[152:155], v[172:175], v[44:47], a[152:155]
    s_waitcnt lgkmcnt(2)
    v_add_f32 v8, v8, v19
    v_exp_f32 v17, v117
    v_cvt_pk_bf16_f32 v181, v18, v19
    v_exp_f32 v18, v118
    v_mfma_f32_16x16x32_bf16 a[108:111], v[160:163], v[24:27], a[108:111]
    ds_read_b128 v[40:43], v1 offset:5120
    v_add_f32 v8, v8, v16
    v_mfma_f32_16x16x32_bf16 a[108:111], v[168:171], v[28:31], a[108:111]
    v_add_f32 v8, v8, v17
    v_exp_f32 v19, v119
    v_cvt_pk_bf16_f32 v182, v16, v17
    v_add_f32 v8, v8, v18
    v_mfma_f32_16x16x32_bf16 a[156:159], v[164:167], v[24:27], a[156:159]
    ds_read_b128 v[44:47], v1 offset:17408
    v_add_f32 v8, v8, v19
    v_mfma_f32_16x16x32_bf16 a[156:159], v[172:175], v[28:31], a[156:159]
    s_waitcnt lgkmcnt(2)
    v_cvt_pk_bf16_f32 v183, v18, v19
    v_exp_f32 v16, v184
    v_exp_f32 v17, v185
    v_cvt_pk_bf16_f32 v243, v244, v245
    v_mfma_f32_16x16x32_bf16 a[112:115], v[160:163], v[32:35], a[112:115]
    ds_read_b128 v[24:27], v23 offset:0
    v_cvt_pk_bf16_f32 v244, v246, v247
    v_mfma_f32_16x16x32_bf16 a[112:115], v[168:171], v[36:39], a[112:115]
    buffer_store_dwordx3 v[242:244], v56, s[12:15], s40 offen offset:576 sc0 sc1
    v_exp_f32 v18, v186
    v_mfma_f32_16x16x32_bf16 a[160:163], v[164:167], v[32:35], a[160:163]
    ds_read_b128 v[28:31], v23 offset:12288
    v_add_f32 v7, v7, v16
    v_mfma_f32_16x16x32_bf16 a[160:163], v[172:175], v[36:39], a[160:163]
    s_waitcnt lgkmcnt(2)
    v_add_f32 v7, v7, v17
    v_exp_f32 v19, v187
    v_cvt_pk_bf16_f32 v184, v16, v17
    v_accvgpr_read_b32 v248, a74
    v_mfma_f32_16x16x32_bf16 a[116:119], v[160:163], v[40:43], a[116:119]
    ds_read_b128 v[32:35], v23 offset:1024
    v_accvgpr_read_b32 v249, a78
    v_mfma_f32_16x16x32_bf16 a[116:119], v[168:171], v[44:47], a[116:119]
    v_exp_f32 v16, v120
    v_add_f32 v7, v7, v18
    v_add_f32 v7, v7, v19
    v_exp_f32 v17, v121
    v_cvt_pk_bf16_f32 v185, v18, v19
    v_exp_f32 v18, v122
    v_add_f32 v7, v7, v16
    v_add_f32 v7, v7, v17
    v_exp_f32 v19, v123
    v_cvt_pk_bf16_f32 v186, v16, v17
    v_exp_f32 v16, v188
    v_add_f32 v7, v7, v18
    v_add_f32 v7, v7, v19
    v_exp_f32 v17, v189
    v_cvt_pk_bf16_f32 v187, v18, v19
    v_exp_f32 v18, v190
    v_add_f32 v8, v8, v16
    v_add_f32 v8, v8, v17
    v_exp_f32 v19, v191
    v_cvt_pk_bf16_f32 v188, v16, v17
    v_exp_f32 v16, v124
    v_add_f32 v8, v8, v18
    v_add_f32 v8, v8, v19
    v_exp_f32 v17, v125
    v_cvt_pk_bf16_f32 v189, v18, v19
    v_exp_f32 v18, v126
    v_add_f32 v8, v8, v16
    v_add_f32 v8, v8, v17
    v_exp_f32 v19, v127
    v_cvt_pk_bf16_f32 v190, v16, v17
    v_add_f32 v8, v8, v18
    v_add_f32 v8, v8, v19
    v_cvt_pk_bf16_f32 v191, v18, v19
    v_mfma_f32_16x16x32_bf16 a[164:167], v[164:167], v[40:43], a[164:167]
    ds_read_b128 v[36:39], v23 offset:13312
    v_max3_f32 v18, v5, v6, v7
    v_mfma_f32_16x16x32_bf16 a[164:167], v[172:175], v[44:47], a[164:167]
    s_waitcnt lgkmcnt(2)
    v_max_f32 v18, v18, v8
    s_mov_b32 s29, 0x5f800000
    v_cmp_lt_f32 s[48:49], s29, v18
    v_accvgpr_read_b32 v250, a82
    v_accvgpr_read_b32 v251, a86
    v_accvgpr_read_b32 v252, a90
    v_mfma_f32_16x16x4_f32 v[128:131], v7, v57, 0
    v_mfma_f32_16x16x32_bf16 a[96:99], v[176:179], v[24:27], a[96:99]
    ds_read_b128 v[40:43], v23 offset:2048
    v_accvgpr_read_b32 v253, a94
    v_mfma_f32_16x16x32_bf16 a[96:99], v[184:187], v[28:31], a[96:99]
    v_mul_f32 v248, v248, v54
    v_mul_f32 v249, v249, v54
    v_mul_f32 v250, v250, v54
    v_mul_f32 v251, v251, v54
    v_mul_f32 v252, v252, v54
    v_mul_f32 v253, v253, v54
    v_mfma_f32_16x16x4_f32 v[132:135], v8, v57, 0
    v_mfma_f32_16x16x32_bf16 a[144:147], v[180:183], v[24:27], a[144:147]
    ds_read_b128 v[44:47], v23 offset:14336
    v_cvt_pk_bf16_f32 v248, v248, v249
    v_mfma_f32_16x16x32_bf16 a[144:147], v[188:191], v[28:31], a[144:147]
    s_waitcnt lgkmcnt(2)
    v_cvt_pk_bf16_f32 v249, v250, v251
    v_cvt_pk_bf16_f32 v250, v252, v253
    v_accvgpr_read_b32 v224, a75
    v_accvgpr_read_b32 v225, a79
    v_accvgpr_read_b32 v226, a83
    v_mfma_f32_16x16x32_bf16 a[100:103], v[176:179], v[32:35], a[100:103]
    ds_read_b128 v[24:27], v23 offset:3072
    v_accvgpr_read_b32 v227, a87
    v_mfma_f32_16x16x32_bf16 a[100:103], v[184:187], v[36:39], a[100:103]
    buffer_store_dwordx3 v[248:250], v56, s[12:15], s40 offen offset:960 sc0 sc1
    v_accvgpr_read_b32 v228, a91
    v_accvgpr_read_b32 v229, a95
    v_mfma_f32_16x16x32_bf16 a[148:151], v[180:183], v[32:35], a[148:151]
    ds_read_b128 v[28:31], v23 offset:15360
    v_mul_f32 v224, v224, v55
    v_mfma_f32_16x16x32_bf16 a[148:151], v[188:191], v[36:39], a[148:151]
    s_waitcnt lgkmcnt(2)
    v_rcp_f32 v128, v128
    v_rcp_f32 v129, v129
    v_mul_f32 v225, v225, v55
    v_mfma_f32_16x16x32_bf16 a[104:107], v[176:179], v[40:43], a[104:107]
    ds_read_b128 v[32:35], v23 offset:4096
    v_mul_f32 v226, v226, v55
    v_mfma_f32_16x16x32_bf16 a[104:107], v[184:187], v[44:47], a[104:107]
    v_rcp_f32 v130, v130
    v_rcp_f32 v131, v131
    v_rcp_f32 v132, v132
    v_mfma_f32_16x16x32_bf16 a[152:155], v[180:183], v[40:43], a[152:155]
    ds_read_b128 v[36:39], v23 offset:16384
    v_mul_f32 v227, v227, v55
    v_mfma_f32_16x16x32_bf16 a[152:155], v[188:191], v[44:47], a[152:155]
    s_waitcnt lgkmcnt(2)
    v_rcp_f32 v133, v133
    v_rcp_f32 v134, v134
    v_rcp_f32 v135, v135
    v_mfma_f32_16x16x32_bf16 a[108:111], v[176:179], v[24:27], a[108:111]
    ds_read_b128 v[40:43], v23 offset:5120
    v_mul_f32 v228, v228, v55
    v_mfma_f32_16x16x32_bf16 a[108:111], v[184:187], v[28:31], a[108:111]
    v_mul_f32 v229, v229, v55
    v_cvt_pk_bf16_f32 v224, v224, v225
    v_cvt_pk_bf16_f32 v225, v226, v227
    v_cvt_pk_bf16_f32 v226, v228, v229
    v_mfma_f32_16x16x32_bf16 a[156:159], v[180:183], v[24:27], a[156:159]
    ds_read_b128 v[44:47], v23 offset:17408
    v_mfma_f32_16x16x32_bf16 a[156:159], v[188:191], v[28:31], a[156:159]
    s_waitcnt lgkmcnt(2)
    buffer_store_dwordx3 v[224:226], v56, s[12:15], s40 offen offset:1344 sc0 sc1
    v_mfma_f32_16x16x32_bf16 a[112:115], v[176:179], v[32:35], a[112:115]
    ds_read_b128 v[24:27], v22 offset:6144
    v_mfma_f32_16x16x32_bf16 a[112:115], v[184:187], v[36:39], a[112:115]
    v_mfma_f32_16x16x32_bf16 a[160:163], v[180:183], v[32:35], a[160:163]
    ds_read_b128 v[28:31], v22 offset:18432
    v_mfma_f32_16x16x32_bf16 a[160:163], v[188:191], v[36:39], a[160:163]
    s_waitcnt lgkmcnt(2)
    s_cmp_lg_u64 s[48:49], 0
    s_cbranch_scc1 L_slow
    v_mfma_f32_16x16x32_bf16 a[116:119], v[176:179], v[40:43], a[116:119]
    ds_read_b128 v[32:35], v22 offset:7168
    v_mfma_f32_16x16x32_bf16 a[116:119], v[184:187], v[44:47], a[116:119]
    v_mfma_f32_16x16x32_bf16 a[164:167], v[180:183], v[40:43], a[164:167]
    ds_read_b128 v[36:39], v22 offset:19456
    v_mfma_f32_16x16x32_bf16 a[164:167], v[188:191], v[44:47], a[164:167]
    s_waitcnt lgkmcnt(2)
    v_mfma_f32_16x16x32_bf16 a[120:123], v[80:83], v[24:27], a[120:123]
    ds_read_b128 v[40:43], v22 offset:8192
    v_mfma_f32_16x16x32_bf16 a[120:123], v[88:91], v[28:31], a[120:123]
    v_mfma_f32_16x16x32_bf16 a[168:171], v[84:87], v[24:27], a[168:171]
    ds_read_b128 v[44:47], v22 offset:20480
    v_mfma_f32_16x16x32_bf16 a[168:171], v[92:95], v[28:31], a[168:171]
    s_waitcnt lgkmcnt(2)
    v_mfma_f32_16x16x32_bf16 a[124:127], v[80:83], v[32:35], a[124:127]
    ds_read_b128 v[24:27], v1 offset:6144
    v_accvgpr_read_b32 v230, a96
    v_mfma_f32_16x16x32_bf16 a[124:127], v[88:91], v[36:39], a[124:127]
    v_accvgpr_read_b32 v231, a100
    v_accvgpr_read_b32 v232, a104
    v_accvgpr_read_b32 v233, a108
    v_accvgpr_read_b32 v234, a112
    v_accvgpr_read_b32 v235, a116
    v_mul_f32 v230, v230, v128
    v_mul_f32 v231, v231, v128
    v_mul_f32 v232, v232, v128
    v_mul_f32 v233, v233, v128
    v_mul_f32 v234, v234, v128
    v_mul_f32 v235, v235, v128
    v_cvt_pk_bf16_f32 v230, v230, v231
    v_cvt_pk_bf16_f32 v231, v232, v233
    v_cvt_pk_bf16_f32 v232, v234, v235
    v_accvgpr_read_b32 v236, a97
    v_accvgpr_read_b32 v237, a101
    v_accvgpr_read_b32 v238, a105
    v_accvgpr_read_b32 v239, a109
    v_accvgpr_read_b32 v240, a113
    v_accvgpr_read_b32 v241, a117
    v_mul_f32 v236, v236, v129
    v_mul_f32 v237, v237, v129
    v_mul_f32 v238, v238, v129
    v_mul_f32 v239, v239, v129
    v_mul_f32 v240, v240, v129
    v_mul_f32 v241, v241, v129
    v_cvt_pk_bf16_f32 v236, v236, v237
    v_cvt_pk_bf16_f32 v237, v238, v239
    v_cvt_pk_bf16_f32 v238, v240, v241
    v_mfma_f32_16x16x32_bf16 a[172:175], v[84:87], v[32:35], a[172:175]
    ds_read_b128 v[28:31], v1 offset:18432
    v_accvgpr_read_b32 v242, a98
    v_mfma_f32_16x16x32_bf16 a[172:175], v[92:95], v[36:39], a[172:175]
    s_waitcnt lgkmcnt(2)
    buffer_store_dwordx3 v[230:232], v56, s[12:15], s41 offen offset:0 sc0 sc1
    v_accvgpr_read_b32 v243, a102
    v_accvgpr_read_b32 v244, a106
    v_mfma_f32_16x16x32_bf16 a[128:131], v[80:83], v[40:43], a[128:131]
    ds_read_b128 v[32:35], v1 offset:7168
    v_accvgpr_read_b32 v245, a110
    v_mfma_f32_16x16x32_bf16 a[128:131], v[88:91], v[44:47], a[128:131]
    buffer_store_dwordx3 v[236:238], v56, s[12:15], s41 offen offset:384 sc0 sc1
    v_accvgpr_read_b32 v246, a114
    v_mfma_f32_16x16x32_bf16 a[176:179], v[84:87], v[40:43], a[176:179]
    ds_read_b128 v[36:39], v1 offset:19456
    v_accvgpr_read_b32 v247, a118
    v_mfma_f32_16x16x32_bf16 a[176:179], v[92:95], v[44:47], a[176:179]
    s_waitcnt lgkmcnt(2)
    v_mul_f32 v242, v242, v130
    v_mul_f32 v243, v243, v130
    v_mul_f32 v244, v244, v130
    v_mul_f32 v245, v245, v130
    v_mul_f32 v246, v246, v130
    v_mul_f32 v247, v247, v130
    v_mfma_f32_16x16x32_bf16 a[120:123], v[160:163], v[24:27], a[120:123]
    ds_read_b128 v[40:43], v1 offset:8192
    v_cvt_pk_bf16_f32 v242, v242, v243
    v_mfma_f32_16x16x32_bf16 a[120:123], v[168:171], v[28:31], a[120:123]
    v_cvt_pk_bf16_f32 v243, v244, v245
    v_cvt_pk_bf16_f32 v244, v246, v247
    v_accvgpr_read_b32 v248, a99
    v_accvgpr_read_b32 v249, a103
    v_accvgpr_read_b32 v250, a107
    v_mfma_f32_16x16x32_bf16 a[168:171], v[164:167], v[24:27], a[168:171]
    ds_read_b128 v[44:47], v1 offset:20480
    v_accvgpr_read_b32 v251, a111
    v_mfma_f32_16x16x32_bf16 a[168:171], v[172:175], v[28:31], a[168:171]
    s_waitcnt lgkmcnt(2)
    buffer_store_dwordx3 v[242:244], v56, s[12:15], s41 offen offset:768 sc0 sc1
    v_accvgpr_read_b32 v252, a115
    v_accvgpr_read_b32 v253, a119
    v_mfma_f32_16x16x32_bf16 a[124:127], v[160:163], v[32:35], a[124:127]
    ds_read_b128 v[24:27], v23 offset:6144
    v_mul_f32 v248, v248, v131
    v_mfma_f32_16x16x32_bf16 a[124:127], v[168:171], v[36:39], a[124:127]
    v_mul_f32 v249, v249, v131
    v_mul_f32 v250, v250, v131
    v_mul_f32 v251, v251, v131
    v_mul_f32 v252, v252, v131
    v_mul_f32 v253, v253, v131
    v_cvt_pk_bf16_f32 v248, v248, v249
    v_mfma_f32_16x16x32_bf16 a[172:175], v[164:167], v[32:35], a[172:175]
    ds_read_b128 v[28:31], v23 offset:18432
    v_cvt_pk_bf16_f32 v249, v250, v251
    v_mfma_f32_16x16x32_bf16 a[172:175], v[172:175], v[36:39], a[172:175]
    s_waitcnt lgkmcnt(2)
    v_cvt_pk_bf16_f32 v250, v252, v253
    v_accvgpr_read_b32 v224, a144
    v_accvgpr_read_b32 v225, a148
    v_accvgpr_read_b32 v226, a152
    v_accvgpr_read_b32 v227, a156
    v_mfma_f32_16x16x32_bf16 a[128:131], v[160:163], v[40:43], a[128:131]
    ds_read_b128 v[32:35], v23 offset:7168
    v_accvgpr_read_b32 v228, a160
    v_mfma_f32_16x16x32_bf16 a[128:131], v[168:171], v[44:47], a[128:131]
    buffer_store_dwordx3 v[248:250], v56, s[12:15], s41 offen offset:1152 sc0 sc1
    v_accvgpr_read_b32 v229, a164
    v_mul_f32 v224, v224, v132
    v_mfma_f32_16x16x32_bf16 a[176:179], v[164:167], v[40:43], a[176:179]
    ds_read_b128 v[36:39], v23 offset:19456
    v_mul_f32 v225, v225, v132
    v_mfma_f32_16x16x32_bf16 a[176:179], v[172:175], v[44:47], a[176:179]
    s_waitcnt lgkmcnt(2)
    v_mul_f32 v226, v226, v132
    v_mul_f32 v227, v227, v132
    v_mul_f32 v228, v228, v132
    v_mul_f32 v229, v229, v132
    v_cvt_pk_bf16_f32 v224, v224, v225
    v_cvt_pk_bf16_f32 v225, v226, v227
    v_mfma_f32_16x16x32_bf16 a[120:123], v[176:179], v[24:27], a[120:123]
    ds_read_b128 v[40:43], v23 offset:8192
    v_cvt_pk_bf16_f32 v226, v228, v229
    v_mfma_f32_16x16x32_bf16 a[120:123], v[184:187], v[28:31], a[120:123]
    buffer_store_dwordx3 v[224:226], v56, s[12:15], s42 offen offset:0 sc0 sc1
    v_accvgpr_read_b32 v230, a145
    v_mfma_f32_16x16x32_bf16 a[168:171], v[180:183], v[24:27], a[168:171]
    ds_read_b128 v[44:47], v23 offset:20480
    v_accvgpr_read_b32 v231, a149
    v_mfma_f32_16x16x32_bf16 a[168:171], v[188:191], v[28:31], a[168:171]
    s_waitcnt lgkmcnt(2)
    v_accvgpr_read_b32 v232, a153
    v_accvgpr_read_b32 v233, a157
    v_accvgpr_read_b32 v234, a161
    v_accvgpr_read_b32 v235, a165
    v_mul_f32 v230, v230, v133
    v_mul_f32 v231, v231, v133
    v_mfma_f32_16x16x32_bf16 a[124:127], v[176:179], v[32:35], a[124:127]
    ds_read_b128 v[24:27], v22 offset:9216
    v_mul_f32 v232, v232, v133
    v_mfma_f32_16x16x32_bf16 a[124:127], v[184:187], v[36:39], a[124:127]
    v_mul_f32 v233, v233, v133
    v_mul_f32 v234, v234, v133
    v_mul_f32 v235, v235, v133
    v_cvt_pk_bf16_f32 v230, v230, v231
    v_cvt_pk_bf16_f32 v231, v232, v233
    v_cvt_pk_bf16_f32 v232, v234, v235
    v_mfma_f32_16x16x32_bf16 a[172:175], v[180:183], v[32:35], a[172:175]
    ds_read_b128 v[28:31], v22 offset:21504
    v_accvgpr_read_b32 v236, a146
    v_mfma_f32_16x16x32_bf16 a[172:175], v[188:191], v[36:39], a[172:175]
    s_waitcnt lgkmcnt(2)
    buffer_store_dwordx3 v[230:232], v56, s[12:15], s42 offen offset:384 sc0 sc1
    v_accvgpr_read_b32 v237, a150
    v_mfma_f32_16x16x32_bf16 a[128:131], v[176:179], v[40:43], a[128:131]
    ds_read_b128 v[32:35], v22 offset:10240
    v_accvgpr_read_b32 v238, a154
    v_mfma_f32_16x16x32_bf16 a[128:131], v[184:187], v[44:47], a[128:131]
    v_accvgpr_read_b32 v239, a158
    v_accvgpr_read_b32 v240, a162
    v_accvgpr_read_b32 v241, a166
    v_mul_f32 v236, v236, v134
    v_mul_f32 v237, v237, v134
    v_mul_f32 v238, v238, v134
    v_mfma_f32_16x16x32_bf16 a[176:179], v[180:183], v[40:43], a[176:179]
    ds_read_b128 v[36:39], v22 offset:22528
    v_mul_f32 v239, v239, v134
    v_mfma_f32_16x16x32_bf16 a[176:179], v[188:191], v[44:47], a[176:179]
    s_waitcnt lgkmcnt(2)
    v_mul_f32 v240, v240, v134
    v_mul_f32 v241, v241, v134
    v_cvt_pk_bf16_f32 v236, v236, v237
    v_cvt_pk_bf16_f32 v237, v238, v239
    v_cvt_pk_bf16_f32 v238, v240, v241
    v_accvgpr_read_b32 v242, a147
    v_mfma_f32_16x16x32_bf16 a[132:135], v[80:83], v[24:27], a[132:135]
    ds_read_b128 v[40:43], v22 offset:11264
    v_accvgpr_read_b32 v243, a151
    v_mfma_f32_16x16x32_bf16 a[132:135], v[88:91], v[28:31], a[132:135]
    buffer_store_dwordx3 v[236:238], v56, s[12:15], s42 offen offset:768 sc0 sc1
    v_accvgpr_read_b32 v244, a155
    v_mfma_f32_16x16x32_bf16 a[180:183], v[84:87], v[24:27], a[180:183]
    ds_read_b128 v[44:47], v22 offset:23552
    v_accvgpr_read_b32 v245, a159
    v_mfma_f32_16x16x32_bf16 a[180:183], v[92:95], v[28:31], a[180:183]
    s_waitcnt lgkmcnt(2)
    v_accvgpr_read_b32 v246, a163
    v_accvgpr_read_b32 v247, a167
    v_mul_f32 v242, v242, v135
    v_mul_f32 v243, v243, v135
    v_mul_f32 v244, v244, v135
    v_mul_f32 v245, v245, v135
    v_mfma_f32_16x16x32_bf16 a[136:139], v[80:83], v[32:35], a[136:139]
    ds_read_b128 v[24:27], v1 offset:9216
    v_accvgpr_read_b32 v96, a120
    v_mfma_f32_16x16x32_bf16 a[136:139], v[88:91], v[36:39], a[136:139]
    v_accvgpr_read_b32 v97, a124
    v_accvgpr_read_b32 v98, a128
    v_mul_f32 v96, v96, v128
    v_mul_f32 v97, v97, v128
    v_mul_f32 v98, v98, v128
    v_mfma_f32_16x16x32_bf16 a[184:187], v[84:87], v[32:35], a[184:187]
    ds_read_b128 v[28:31], v1 offset:21504
    v_accvgpr_read_b32 v102, a121
    v_mfma_f32_16x16x32_bf16 a[184:187], v[92:95], v[36:39], a[184:187]
    s_waitcnt lgkmcnt(2)
    v_accvgpr_read_b32 v103, a125
    v_accvgpr_read_b32 v104, a129
    v_mul_f32 v102, v102, v129
    v_mul_f32 v103, v103, v129
    v_mul_f32 v104, v104, v129
    v_accvgpr_read_b32 v108, a122
    v_mfma_f32_16x16x32_bf16 a[140:143], v[80:83], v[40:43], a[140:143]
    ds_read_b128 v[32:35], v1 offset:10240
    v_accvgpr_read_b32 v109, a126
    v_mfma_f32_16x16x32_bf16 a[140:143], v[88:91], v[44:47], a[140:143]
    v_accvgpr_read_b32 v110, a130
    v_mul_f32 v108, v108, v130
    v_mul_f32 v109, v109, v130
    v_mul_f32 v110, v110, v130
    v_accvgpr_read_b32 v114, a123
    v_accvgpr_read_b32 v115, a127
    v_mfma_f32_16x16x32_bf16 a[188:191], v[84:87], v[40:43], a[188:191]
    ds_read_b128 v[36:39], v1 offset:22528
    v_accvgpr_read_b32 v116, a131
    v_mfma_f32_16x16x32_bf16 a[188:191], v[92:95], v[44:47], a[188:191]
    s_waitcnt lgkmcnt(2)
    v_mul_f32 v114, v114, v131
    v_mul_f32 v115, v115, v131
    v_mul_f32 v116, v116, v131
    v_accvgpr_read_b32 v120, a168
    v_accvgpr_read_b32 v121, a172
    v_mfma_f32_16x16x32_bf16 a[132:135], v[160:163], v[24:27], a[132:135]
    ds_read_b128 v[40:43], v1 offset:11264
    v_accvgpr_read_b32 v122, a176
    v_mfma_f32_16x16x32_bf16 a[132:135], v[168:171], v[28:31], a[132:135]
    v_mul_f32 v120, v120, v132
    v_mul_f32 v121, v121, v132
    v_mul_f32 v122, v122, v132
    v_accvgpr_read_b32 v64, a169
    v_accvgpr_read_b32 v65, a173
    v_accvgpr_read_b32 v66, a177
    v_mfma_f32_16x16x32_bf16 a[180:183], v[164:167], v[24:27], a[180:183]
    ds_read_b128 v[44:47], v1 offset:23552
    v_mul_f32 v64, v64, v133
    v_mfma_f32_16x16x32_bf16 a[180:183], v[172:175], v[28:31], a[180:183]
    s_waitcnt lgkmcnt(2)
    v_mul_f32 v65, v65, v133
    v_mul_f32 v66, v66, v133
    v_accvgpr_read_b32 v70, a170
    v_accvgpr_read_b32 v71, a174
    v_accvgpr_read_b32 v72, a178
    v_mul_f32 v70, v70, v134
    v_mfma_f32_16x16x32_bf16 a[136:139], v[160:163], v[32:35], a[136:139]
    ds_read_b128 v[24:27], v23 offset:9216
    v_mul_f32 v71, v71, v134
    v_mfma_f32_16x16x32_bf16 a[136:139], v[168:171], v[36:39], a[136:139]
    v_mul_f32 v72, v72, v134
    v_accvgpr_read_b32 v144, a171
    v_mul_f32 v246, v246, v135
    v_accvgpr_read_b32 v145, a175
    v_mul_f32 v247, v247, v135
    v_mfma_f32_16x16x32_bf16 a[184:187], v[164:167], v[32:35], a[184:187]
    ds_read_b128 v[28:31], v23 offset:21504
    v_accvgpr_read_b32 v146, a179
    v_mfma_f32_16x16x32_bf16 a[184:187], v[172:175], v[36:39], a[184:187]
    s_waitcnt lgkmcnt(2)
    v_cvt_pk_bf16_f32 v242, v242, v243
    v_mul_f32 v144, v144, v135
    v_cvt_pk_bf16_f32 v243, v244, v245
    v_mul_f32 v145, v145, v135
    v_cvt_pk_bf16_f32 v244, v246, v247
    v_mul_f32 v146, v146, v135
    v_mfma_f32_16x16x32_bf16 a[140:143], v[160:163], v[40:43], a[140:143]
    ds_read_b128 v[32:35], v23 offset:10240
    v_mfma_f32_16x16x32_bf16 a[140:143], v[168:171], v[44:47], a[140:143]
    buffer_store_dwordx3 v[242:244], v56, s[12:15], s42 offen offset:1152 sc0 sc1
    v_mfma_f32_16x16x32_bf16 a[188:191], v[164:167], v[40:43], a[188:191]
    ds_read_b128 v[36:39], v23 offset:22528
    v_mfma_f32_16x16x32_bf16 a[188:191], v[172:175], v[44:47], a[188:191]
    s_waitcnt lgkmcnt(2)
    v_mfma_f32_16x16x32_bf16 a[132:135], v[176:179], v[24:27], a[132:135]
    ds_read_b128 v[40:43], v23 offset:11264
    v_mfma_f32_16x16x32_bf16 a[132:135], v[184:187], v[28:31], a[132:135]
    v_mfma_f32_16x16x32_bf16 a[180:183], v[180:183], v[24:27], a[180:183]
    ds_read_b128 v[44:47], v23 offset:23552
    v_mfma_f32_16x16x32_bf16 a[180:183], v[188:191], v[28:31], a[180:183]
    s_waitcnt lgkmcnt(2)
    v_mfma_f32_16x16x32_bf16 a[136:139], v[176:179], v[32:35], a[136:139]
    v_mfma_f32_16x16x32_bf16 a[136:139], v[184:187], v[36:39], a[136:139]
    v_mfma_f32_16x16x32_bf16 a[184:187], v[180:183], v[32:35], a[184:187]
    v_mfma_f32_16x16x32_bf16 a[184:187], v[188:191], v[36:39], a[184:187]
    s_waitcnt lgkmcnt(0)
    v_mfma_f32_16x16x32_bf16 a[140:143], v[176:179], v[40:43], a[140:143]
    v_mfma_f32_16x16x32_bf16 a[140:143], v[184:187], v[44:47], a[140:143]
    v_mfma_f32_16x16x32_bf16 a[188:191], v[180:183], v[40:43], a[188:191]
    v_mfma_f32_16x16x32_bf16 a[188:191], v[188:191], v[44:47], a[188:191]
    s_nop 7
    v_accvgpr_read_b32 v99, a132
    v_accvgpr_read_b32 v100, a136
    v_accvgpr_read_b32 v101, a140
    v_cvt_pk_bf16_f32 v96, v96, v97
    v_mul_f32 v99, v99, v128
    v_mul_f32 v100, v100, v128
    v_mul_f32 v101, v101, v128
    v_cvt_pk_bf16_f32 v97, v98, v99
    v_cvt_pk_bf16_f32 v98, v100, v101
    buffer_store_dwordx3 v[96:98], v56, s[12:15], s41 offen offset:192 sc0 sc1
    v_accvgpr_read_b32 v105, a133
    v_accvgpr_read_b32 v106, a137
    v_accvgpr_read_b32 v107, a141
    v_cvt_pk_bf16_f32 v102, v102, v103
    v_mul_f32 v105, v105, v129
    v_mul_f32 v106, v106, v129
    v_mul_f32 v107, v107, v129
    v_cvt_pk_bf16_f32 v103, v104, v105
    v_cvt_pk_bf16_f32 v104, v106, v107
    buffer_store_dwordx3 v[102:104], v56, s[12:15], s41 offen offset:576 sc0 sc1
    v_accvgpr_read_b32 v111, a134
    v_accvgpr_read_b32 v112, a138
    v_accvgpr_read_b32 v113, a142
    v_cvt_pk_bf16_f32 v108, v108, v109
    v_mul_f32 v111, v111, v130
    v_mul_f32 v112, v112, v130
    v_mul_f32 v113, v113, v130
    v_cvt_pk_bf16_f32 v109, v110, v111
    v_cvt_pk_bf16_f32 v110, v112, v113
    buffer_store_dwordx3 v[108:110], v56, s[12:15], s41 offen offset:960 sc0 sc1
    v_accvgpr_read_b32 v117, a135
    v_accvgpr_read_b32 v118, a139
    v_accvgpr_read_b32 v119, a143
    v_cvt_pk_bf16_f32 v114, v114, v115
    v_mul_f32 v117, v117, v131
    v_mul_f32 v118, v118, v131
    v_mul_f32 v119, v119, v131
    v_cvt_pk_bf16_f32 v115, v116, v117
    v_cvt_pk_bf16_f32 v116, v118, v119
    buffer_store_dwordx3 v[114:116], v56, s[12:15], s41 offen offset:1344 sc0 sc1
    v_accvgpr_read_b32 v123, a180
    v_accvgpr_read_b32 v124, a184
    v_accvgpr_read_b32 v125, a188
    v_cvt_pk_bf16_f32 v120, v120, v121
    v_mul_f32 v123, v123, v132
    v_mul_f32 v124, v124, v132
    v_mul_f32 v125, v125, v132
    v_cvt_pk_bf16_f32 v121, v122, v123
    v_cvt_pk_bf16_f32 v122, v124, v125
    buffer_store_dwordx3 v[120:122], v56, s[12:15], s42 offen offset:192 sc0 sc1
    v_accvgpr_read_b32 v67, a181
    v_accvgpr_read_b32 v68, a185
    v_accvgpr_read_b32 v69, a189
    v_cvt_pk_bf16_f32 v64, v64, v65
    v_mul_f32 v67, v67, v133
    v_mul_f32 v68, v68, v133
    v_mul_f32 v69, v69, v133
    v_cvt_pk_bf16_f32 v65, v66, v67
    v_cvt_pk_bf16_f32 v66, v68, v69
    buffer_store_dwordx3 v[64:66], v56, s[12:15], s42 offen offset:576 sc0 sc1
    v_accvgpr_read_b32 v73, a182
    v_accvgpr_read_b32 v74, a186
    v_accvgpr_read_b32 v75, a190
    v_cvt_pk_bf16_f32 v70, v70, v71
    v_mul_f32 v73, v73, v134
    v_mul_f32 v74, v74, v134
    v_mul_f32 v75, v75, v134
    v_cvt_pk_bf16_f32 v71, v72, v73
    v_cvt_pk_bf16_f32 v72, v74, v75
    buffer_store_dwordx3 v[70:72], v56, s[12:15], s42 offen offset:960 sc0 sc1
    v_accvgpr_read_b32 v147, a183
    v_accvgpr_read_b32 v148, a187
    v_accvgpr_read_b32 v149, a191
    v_cvt_pk_bf16_f32 v144, v144, v145
    v_mul_f32 v147, v147, v135
    v_mul_f32 v148, v148, v135
    v_mul_f32 v149, v149, v135
    v_cvt_pk_bf16_f32 v145, v146, v147
    v_cvt_pk_bf16_f32 v146, v148, v149
    buffer_store_dwordx3 v[144:146], v56, s[12:15], s42 offen offset:1344 sc0 sc1
L_fin:
L_done:
    s_endpgm
L_pollslow0:
    s_mov_b32 s59, 60
L_pollsm0:
    s_buffer_load_dwordx8 s[48:55], s[20:23], s44 glc
    s_waitcnt lgkmcnt(0)
    s_sub_u32 s48, s48, s92
    s_sub_u32 s49, s49, s92
    s_sub_u32 s50, s50, s92
    s_sub_u32 s51, s51, s92
    s_sub_u32 s52, s52, s92
    s_sub_u32 s53, s53, s92
    s_sub_u32 s54, s54, s92
    s_sub_u32 s55, s55, s92
    s_max_u32 s48, s48, s49
    s_max_u32 s48, s48, s50
    s_max_u32 s48, s48, s51
    s_max_u32 s48, s48, s52
    s_max_u32 s48, s48, s53
    s_max_u32 s48, s48, s54
    s_max_u32 s48, s48, s55
    s_cmp_lt_u32 s48, 16
    s_cbranch_scc1 L_pollok0
    s_sub_u32 s59, s59, 1
    s_cbranch_scc1 L_pollvec0
    s_sleep 1
    s_branch L_pollsm0
L_pollvec0:
    v_bfe_u32 v53, v4, 4, 6
    v_lshlrev_b32 v53, 2, v53
    s_sub_u32 s96, s96, 1
    s_cbranch_scc1 L_pollgiveup0
    s_sleep 2
    buffer_load_dword v52, v53, s[20:23], s44 offen sc1
    s_waitcnt vmcnt(0)
    s_bitcmp1_b32 s92, 9
    s_cbranch_scc1 L_nomix
    v_xor_b32 v53, s92, v52
    v_lshrrev_b32 v53, 5, v53
    v_add_u32 v53, -1, v53
    v_cmp_gt_u32 vcc, 31, v53
    s_nop 1
    s_and_b32 s59, vcc_lo, 0xff
    s_cbranch_scc0 L_nomix
    buffer_store_dwordx4 v[224:227], v11, s[4:7], s33 offen offset:0 sc1
    v_xor_b32 v55, 16, v11
    buffer_store_dwordx4 v[228:231], v55, s[4:7], s33 offen offset:768 sc1
    v_xor_b32 v54, 32, v11
    buffer_store_dwordx4 v[232:235], v54, s[4:7], s33 offen offset:1536 sc1
    v_xor_b32 v55, 48, v11
    buffer_store_dwordx4 v[236:239], v55, s[4:7], s33 offen offset:2304 sc1
    buffer_store_dwordx4 v[112:115], v15, s[4:7], s35 offen offset:0 sc1
    buffer_store_dwordx4 v[116:119], v15, s[4:7], s35 offen offset:1024 sc1
    buffer_store_dwordx4 v[120:123], v15, s[4:7], s35 offen offset:2048 sc1
    s_waitcnt vmcnt(0)
    s_barrier
    s_and_b32 s92, s92, 0xfffffc00
    s_add_u32 s92, s92, 512
    v_mov_b32 v0, s92
    s_add_u32 s92, s92, 1
    s_mov_b32 s44, 32
    v_add_u32 v0, 1, v0
    buffer_store_dword v0, v13, s[20:23], 0 offen offset:32 sc1
    s_branch L_pollvec0
L_nomix:
    v_subrev_u32 v52, s92, v52
    v_cmp_lt_u32 vcc, 15, v52
    s_nop 0
    s_and_b32 s59, vcc_lo, 0xff
    s_cbranch_scc1 L_pollvec0
    s_branch L_pollok0
L_pollgiveup0:
    s_mov_b32 s96, 0
    s_branch L_pollok0
L_pollslow1:
    s_mov_b32 s59, 200
L_pollsm1:
    s_buffer_load_dwordx8 s[48:55], s[20:23], s44 glc
    s_waitcnt lgkmcnt(0)
    s_sub_u32 s48, s48, s92
    s_sub_u32 s49, s49, s92
    s_sub_u32 s50, s50, s92
    s_sub_u32 s51, s51, s92
    s_sub_u32 s52, s52, s92
    s_sub_u32 s53, s53, s92
    s_sub_u32 s54, s54, s92
    s_sub_u32 s55, s55, s92
    s_max_u32 s48, s48, s49
    s_max_u32 s48, s48, s50
    s_max_u32 s48, s48, s51
    s_max_u32 s48, s48, s52
    s_max_u32 s48, s48, s53
    s_max_u32 s48, s48, s54
    s_max_u32 s48, s48, s55
    s_cmp_lt_u32 s48, 16
    s_cbranch_scc1 L_pollok1
    s_sub_u32 s59, s59, 1
    s_cbranch_scc1 L_pollvec1
    s_sleep 1
    s_branch L_pollsm1
L_pollvec1:
    v_bfe_u32 v53, v4, 4, 6
    v_lshlrev_b32 v53, 2, v53
    s_sub_u32 s96, s96, 1
    s_cbranch_scc1 L_pollgiveup1
    s_sleep 2
    buffer_load_dword v52, v53, s[20:23], s44 offen sc1
    s_waitcnt vmcnt(0)
    v_subrev_u32 v52, s92, v52
    v_cmp_lt_u32 vcc, 15, v52
    s_nop 0
    s_and_b32 s59, vcc_lo, 0xff
    s_cbranch_scc1 L_pollvec1
    s_branch L_pollok1
L_pollgiveup1:
    s_mov_b32 s96, 0
    s_branch L_pollok1
L_pollslow2:
    s_mov_b32 s59, 200
L_pollsm2:
    s_buffer_load_dwordx8 s[48:55], s[20:23], s44 glc
    s_waitcnt lgkmcnt(0)
    s_sub_u32 s48, s48, s92
    s_sub_u32 s49, s49, s92
    s_sub_u32 s50, s50, s92
    s_sub_u32 s51, s51, s92
    s_sub_u32 s52, s52, s92
    s_sub_u32 s53, s53, s92
    s_sub_u32 s54, s54, s92
    s_sub_u32 s55, s55, s92
    s_max_u32 s48, s48, s49
    s_max_u32 s48, s48, s50
    s_max_u32 s48, s48, s51
    s_max_u32 s48, s48, s52
    s_max_u32 s48, s48, s53
    s_max_u32 s48, s48, s54
    s_max_u32 s48, s48, s55
    s_cmp_lt_u32 s48, 16
    s_cbranch_scc1 L_pollok2
    s_sub_u32 s59, s59, 1
    s_cbranch_scc1 L_pollvec2
    s_sleep 1
    s_branch L_pollsm2
L_pollvec2:
    v_bfe_u32 v53, v4, 4, 6
    v_lshlrev_b32 v53, 2, v53
    s_sub_u32 s96, s96, 1
    s_cbranch_scc1 L_pollgiveup2
    s_sleep 2
    buffer_load_dword v52, v53, s[20:23], s44 offen sc1
    s_waitcnt vmcnt(0)
    v_subrev_u32 v52, s92, v52
    v_cmp_lt_u32 vcc, 15, v52
    s_nop 0
    s_and_b32 s59, vcc_lo, 0xff
    s_cbranch_scc1 L_pollvec2
    s_branch L_pollok2
L_pollgiveup2:
    s_mov_b32 s96, 0
    s_branch L_pollok2
L_tagslow:
    s_sub_u32 s96, s96, 1
    s_cbranch_scc1 L_taggiveup
    s_sleep 2
    buffer_load_dword v0, off, s[88:91], s93 sc1
    s_waitcnt vmcnt(0)
    v_readfirstlane_b32 s42, v0
    s_nop 0
    s_cmp_eq_u32 s42, s46
    s_cbranch_scc1 L_tagslow
    s_cmp_eq_u32 s42, 0
    s_cbranch_scc1 L_tagslow
    s_branch L_tagok
L_taggiveup:
    s_mov_b32 s96, 0
    s_branch L_tagok
L_slow:
    s_waitcnt vmcnt(0) lgkmcnt(0)
    s_nop 15
    v_accvgpr_write_b32 a0, 0
    v_accvgpr_write_b32 a1, 0
    v_accvgpr_write_b32 a2, 0
    v_accvgpr_write_b32 a3, 0
    v_accvgpr_write_b32 a4, 0
    v_accvgpr_write_b32 a5, 0
    v_accvgpr_write_b32 a6, 0
    v_accvgpr_write_b32 a7, 0
    v_accvgpr_write_b32 a8, 0
    v_accvgpr_write_b32 a9, 0
    v_accvgpr_write_b32 a10, 0
    v_accvgpr_write_b32 a11, 0
    v_accvgpr_write_b32 a12, 0
    v_accvgpr_write_b32 a13, 0
    v_accvgpr_write_b32 a14, 0
    v_accvgpr_write_b32 a15, 0
    v_accvgpr_write_b32 a16, 0
    v_accvgpr_write_b32 a17, 0
    v_accvgpr_write_b32 a18, 0
    v_accvgpr_write_b32 a19, 0
    v_accvgpr_write_b32 a20, 0
    v_accvgpr_write_b32 a21, 0
    v_accvgpr_write_b32 a22, 0
    v_accvgpr_write_b32 a23, 0
    v_accvgpr_write_b32 a24, 0
    v_accvgpr_write_b32 a25, 0
    v_accvgpr_write_b32 a26, 0
    v_accvgpr_write_b32 a27, 0
    v_accvgpr_write_b32 a28, 0
    v_accvgpr_write_b32 a29, 0
    v_accvgpr_write_b32 a30, 0
    v_accvgpr_write_b32 a31, 0
    v_accvgpr_write_b32 a32, 0
    v_accvgpr_write_b32 a33, 0
    v_accvgpr_write_b32 a34, 0
    v_accvgpr_write_b32 a35, 0
    v_accvgpr_write_b32 a36, 0
    v_accvgpr_write_b32 a37, 0
    v_accvgpr_write_b32 a38, 0
    v_accvgpr_write_b32 a39, 0
    v_accvgpr_write_b32 a40, 0
    v_accvgpr_write_b32 a41, 0
    v_accvgpr_write_b32 a42, 0
    v_accvgpr_write_b32 a43, 0
    v_accvgpr_write_b32 a44, 0
    v_accvgpr_write_b32 a45, 0
    v_accvgpr_write_b32 a46, 0
    v_accvgpr_write_b32 a47, 0
    v_accvgpr_write_b32 a48, 0
    v_accvgpr_write_b32 a49, 0
    v_accvgpr_write_b32 a50, 0
    v_accvgpr_write_b32 a51, 0
    v_accvgpr_write_b32 a52, 0
    v_accvgpr_write_b32 a53, 0
    v_accvgpr_write_b32 a54, 0
    v_accvgpr_write_b32 a55, 0
    v_accvgpr_write_b32 a56, 0
    v_accvgpr_write_b32 a57, 0
    v_accvgpr_write_b32 a58, 0
    v_accvgpr_write_b32 a59, 0
    v_accvgpr_write_b32 a60, 0
    v_accvgpr_write_b32 a61, 0
    v_accvgpr_write_b32 a62, 0
    v_accvgpr_write_b32 a63, 0
    v_accvgpr_write_b32 a64, 0
    v_accvgpr_write_b32 a65, 0
    v_accvgpr_write_b32 a66, 0
    v_accvgpr_write_b32 a67, 0
    v_accvgpr_write_b32 a68, 0
    v_accvgpr_write_b32 a69, 0
    v_accvgpr_write_b32 a70, 0
    v_accvgpr_write_b32 a71, 0
    v_accvgpr_write_b32 a72, 0
    v_accvgpr_write_b32 a73, 0
    v_accvgpr_write_b32 a74, 0
    v_accvgpr_write_b32 a75, 0
    v_accvgpr_write_b32 a76, 0
    v_accvgpr_write_b32 a77, 0
    v_accvgpr_write_b32 a78, 0
    v_accvgpr_write_b32 a79, 0
    v_accvgpr_write_b32 a80, 0
    v_accvgpr_write_b32 a81, 0
    v_accvgpr_write_b32 a82, 0
    v_accvgpr_write_b32 a83, 0
    v_accvgpr_write_b32 a84, 0
    v_accvgpr_write_b32 a85, 0
    v_accvgpr_write_b32 a86, 0
    v_accvgpr_write_b32 a87, 0
    v_accvgpr_write_b32 a88, 0
    v_accvgpr_write_b32 a89, 0
    v_accvgpr_write_b32 a90, 0
    v_accvgpr_write_b32 a91, 0
    v_accvgpr_write_b32 a92, 0
    v_accvgpr_write_b32 a93, 0
    v_accvgpr_write_b32 a94, 0
    v_accvgpr_write_b32 a95, 0
    v_accvgpr_write_b32 a96, 0
    v_accvgpr_write_b32 a97, 0
    v_accvgpr_write_b32 a98, 0
    v_accvgpr_write_b32 a99, 0
    v_accvgpr_write_b32 a100, 0
    v_accvgpr_write_b32 a101, 0
    v_accvgpr_write_b32 a102, 0
    v_accvgpr_write_b32 a103, 0
    v_accvgpr_write_b32 a104, 0
    v_accvgpr_write_b32 a105, 0
    v_accvgpr_write_b32 a106, 0
    v_accvgpr_write_b32 a107, 0
    v_accvgpr_write_b32 a108, 0
    v_accvgpr_write_b32 a109, 0
    v_accvgpr_write_b32 a110, 0
    v_accvgpr_write_b32 a111, 0
    v_accvgpr_write_b32 a112, 0
    v_accvgpr_write_b32 a113, 0
    v_accvgpr_write_b32 a114, 0
    v_accvgpr_write_b32 a115, 0
    v_accvgpr_write_b32 a116, 0
    v_accvgpr_write_b32 a117, 0
    v_accvgpr_write_b32 a118, 0
    v_accvgpr_write_b32 a119, 0
    v_accvgpr_write_b32 a120, 0
    v_accvgpr_write_b32 a121, 0
    v_accvgpr_write_b32 a122, 0
    v_accvgpr_write_b32 a123, 0
    v_accvgpr_write_b32 a124, 0
    v_accvgpr_write_b32 a125, 0
    v_accvgpr_write_b32 a126, 0
    v_accvgpr_write_b32 a127, 0
    v_accvgpr_write_b32 a128, 0
    v_accvgpr_write_b32 a129, 0
    v_accvgpr_write_b32 a130, 0
    v_accvgpr_write_b32 a131, 0
    v_accvgpr_write_b32 a132, 0
    v_accvgpr_write_b32 a133, 0
    v_accvgpr_write_b32 a134, 0
    v_accvgpr_write_b32 a135, 0
    v_accvgpr_write_b32 a136, 0
    v_accvgpr_write_b32 a137, 0
    v_accvgpr_write_b32 a138, 0
    v_accvgpr_write_b32 a139, 0
    v_accvgpr_write_b32 a140, 0
    v_accvgpr_write_b32 a141, 0
    v_accvgpr_write_b32 a142, 0
    v_accvgpr_write_b32 a143, 0
    v_accvgpr_write_b32 a144, 0
    v_accvgpr_write_b32 a145, 0
    v_accvgpr_write_b32 a146, 0
    v_accvgpr_write_b32 a147, 0
    v_accvgpr_write_b32 a148, 0
    v_accvgpr_write_b32 a149, 0
    v_accvgpr_write_b32 a150, 0
    v_accvgpr_write_b32 a151, 0
    v_accvgpr_write_b32 a152, 0
    v_accvgpr_write_b32 a153, 0
    v_accvgpr_write_b32 a154, 0
    v_accvgpr_write_b32 a155, 0
    v_accvgpr_write_b32 a156, 0
    v_accvgpr_write_b32 a157, 0
    v_accvgpr_write_b32 a158, 0
    v_accvgpr_write_b32 a159, 0
    v_accvgpr_write_b32 a160, 0
    v_accvgpr_write_b32 a161, 0
    v_accvgpr_write_b32 a162, 0
    v_accvgpr_write_b32 a163, 0
    v_accvgpr_write_b32 a164, 0
    v_accvgpr_write_b32 a165, 0
    v_accvgpr_write_b32 a166, 0
    v_accvgpr_write_b32 a167, 0
    v_accvgpr_write_b32 a168, 0
    v_accvgpr_write_b32 a169, 0
    v_accvgpr_write_b32 a170, 0
    v_accvgpr_write_b32 a171, 0
    v_accvgpr_write_b32 a172, 0
    v_accvgpr_write_b32 a173, 0
    v_accvgpr_write_b32 a174, 0
    v_accvgpr_write_b32 a175, 0
    v_accvgpr_write_b32 a176, 0
    v_accvgpr_write_b32 a177, 0
    v_accvgpr_write_b32 a178, 0
    v_accvgpr_write_b32 a179, 0
    v_accvgpr_write_b32 a180, 0
    v_accvgpr_write_b32 a181, 0
    v_accvgpr_write_b32 a182, 0
    v_accvgpr_write_b32 a183, 0
    v_accvgpr_write_b32 a184, 0
    v_accvgpr_write_b32 a185, 0
    v_accvgpr_write_b32 a186, 0
    v_accvgpr_write_b32 a187, 0
    v_accvgpr_write_b32 a188, 0
    v_accvgpr_write_b32 a189, 0
    v_accvgpr_write_b32 a190, 0
    v_accvgpr_write_b32 a191, 0
    v_mov_b32 v5, 0
    v_mov_b32 v240, 0xff7fffff
    v_mov_b32 v6, 0
    v_mov_b32 v241, 0xff7fffff
    v_mov_b32 v7, 0
    v_mov_b32 v242, 0xff7fffff
    v_mov_b32 v8, 0
    v_mov_b32 v243, 0xff7fffff
    v_subrev_u32 v244, 49152, v2
    v_subrev_u32 v245, 49152, v3
    v_subrev_u32 v246, 24576, v1
    s_mov_b32 s48, 0
L_slowloop:
    s_add_u32 s49, s48, 6144
    s_add_u32 s50, s48, 12288
    s_add_u32 s51, s48, 16384
    s_add_u32 s52, s48, 20480
    buffer_load_dwordx4 v[64:67], v244, s[4:7], s48 offen offset:0 sc1
    buffer_load_dwordx4 v[68:71], v245, s[4:7], s48 offen offset:0 sc1
    buffer_load_dwordx4 v[72:75], v244, s[4:7], s49 offen offset:0 sc1
    buffer_load_dwordx4 v[76:79], v245, s[4:7], s49 offen offset:0 sc1
    buffer_load_dwordx4 v[80:83], v244, s[4:7], s48 offen offset:128 sc1
    buffer_load_dwordx4 v[84:87], v245, s[4:7], s48 offen offset:128 sc1
    buffer_load_dwordx4 v[88:91], v244, s[4:7], s49 offen offset:128 sc1
    buffer_load_dwordx4 v[92:95], v245, s[4:7], s49 offen offset:128 sc1
    buffer_load_dwordx4 v[96:99], v244, s[4:7], s48 offen offset:256 sc1
    buffer_load_dwordx4 v[100:103], v245, s[4:7], s48 offen offset:256 sc1
    buffer_load_dwordx4 v[104:107], v244, s[4:7], s49 offen offset:256 sc1
    buffer_load_dwordx4 v[108:111], v245, s[4:7], s49 offen offset:256 sc1
    buffer_load_dwordx4 v[112:115], v246, s[4:7], s50 offen offset:0 sc1
    buffer_load_dwordx4 v[116:119], v246, s[4:7], s50 offen offset:1024 sc1
    buffer_load_dwordx4 v[120:123], v246, s[4:7], s50 offen offset:2048 sc1
    buffer_load_dwordx4 v[124:127], v246, s[4:7], s50 offen offset:3072 sc1
    buffer_load_dwordx4 v[128:131], v246, s[4:7], s51 offen offset:0 sc1
    buffer_load_dwordx4 v[132:135], v246, s[4:7], s51 offen offset:1024 sc1
    buffer_load_dwordx4 v[136:139], v246, s[4:7], s51 offen offset:2048 sc1
    buffer_load_dwordx4 v[140:143], v246, s[4:7], s51 offen offset:3072 sc1
    buffer_load_dwordx4 v[144:147], v246, s[4:7], s52 offen offset:0 sc1
    buffer_load_dwordx4 v[148:151], v246, s[4:7], s52 offen offset:1024 sc1
    buffer_load_dwordx4 v[152:155], v246, s[4:7], s52 offen offset:2048 sc1
    buffer_load_dwordx4 v[156:159], v246, s[4:7], s52 offen offset:3072 sc1
    s_waitcnt vmcnt(12)
    v_mfma_f32_16x16x32_bf16 v[160:163], v[64:67], a[192:195], 0
    v_mfma_f32_16x16x32_bf16 v[168:171], v[64:67], a[216:219], 0
    v_mfma_f32_16x16x32_bf16 v[176:179], v[64:67], a[240:243], 0
    v_mfma_f32_16x16x32_bf16 v[184:187], v[64:67], v[200:203], 0
    v_mfma_f32_16x16x32_bf16 v[160:163], v[68:71], a[196:199], v[160:163]
    v_mfma_f32_16x16x32_bf16 v[168:171], v[68:71], a[220:223], v[168:171]
    v_mfma_f32_16x16x32_bf16 v[176:179], v[68:71], a[244:247], v[176:179]
    v_mfma_f32_16x16x32_bf16 v[184:187], v[68:71], v[204:207], v[184:187]
    v_mfma_f32_16x16x32_bf16 v[164:167], v[72:75], a[192:195], 0
    v_mfma_f32_16x16x32_bf16 v[172:175], v[72:75], a[216:219], 0
    v_mfma_f32_16x16x32_bf16 v[180:183], v[72:75], a[240:243], 0
    v_mfma_f32_16x16x32_bf16 v[188:191], v[72:75], v[200:203], 0
    v_mfma_f32_16x16x32_bf16 v[164:167], v[76:79], a[196:199], v[164:167]
    v_mfma_f32_16x16x32_bf16 v[172:175], v[76:79], a[220:223], v[172:175]
    v_mfma_f32_16x16x32_bf16 v[180:183], v[76:79], a[244:247], v[180:183]
    v_mfma_f32_16x16x32_bf16 v[188:191], v[76:79], v[204:207], v[188:191]
    v_mfma_f32_16x16x32_bf16 v[160:163], v[80:83], a[200:203], v[160:163]
    v_mfma_f32_16x16x32_bf16 v[168:171], v[80:83], a[224:227], v[168:171]
    v_mfma_f32_16x16x32_bf16 v[176:179], v[80:83], a[248:251], v[176:179]
    v_mfma_f32_16x16x32_bf16 v[184:187], v[80:83], v[208:211], v[184:187]
    v_mfma_f32_16x16x32_bf16 v[160:163], v[84:87], a[204:207], v[160:163]
    v_mfma_f32_16x16x32_bf16 v[168:171], v[84:87], a[228:231], v[168:171]
    v_mfma_f32_16x16x32_bf16 v[176:179], v[84:87], a[252:255], v[176:179]
    v_mfma_f32_16x16x32_bf16 v[184:187], v[84:87], v[212:215], v[184:187]
    v_mfma_f32_16x16x32_bf16 v[164:167], v[88:91], a[200:203], v[164:167]
    v_mfma_f32_16x16x32_bf16 v[172:175], v[88:91], a[224:227], v[172:175]
    v_mfma_f32_16x16x32_bf16 v[180:183], v[88:91], a[248:251], v[180:183]
    v_mfma_f32_16x16x32_bf16 v[188:191], v[88:91], v[208:211], v[188:191]
    v_mfma_f32_16x16x32_bf16 v[164:167], v[92:95], a[204:207], v[164:167]
    v_mfma_f32_16x16x32_bf16 v[172:175], v[92:95], a[228:231], v[172:175]
    v_mfma_f32_16x16x32_bf16 v[180:183], v[92:95], a[252:255], v[180:183]
    v_mfma_f32_16x16x32_bf16 v[188:191], v[92:95], v[212:215], v[188:191]
    v_mfma_f32_16x16x32_bf16 v[160:163], v[96:99], a[208:211], v[160:163]
    v_mfma_f32_16x16x32_bf16 v[168:171], v[96:99], a[232:235], v[168:171]
    v_mfma_f32_16x16x32_bf16 v[176:179], v[96:99], v[192:195], v[176:179]
    v_mfma_f32_16x16x32_bf16 v[184:187], v[96:99], v[216:219], v[184:187]
    v_mfma_f32_16x16x32_bf16 v[160:163], v[100:103], a[212:215], v[160:163]
    v_mfma_f32_16x16x32_bf16 v[168:171], v[100:103], a[236:239], v[168:171]
    v_mfma_f32_16x16x32_bf16 v[176:179], v[100:103], v[196:199], v[176:179]
    v_mfma_f32_16x16x32_bf16 v[184:187], v[100:103], v[220:223], v[184:187]
    v_mfma_f32_16x16x32_bf16 v[164:167], v[104:107], a[208:211], v[164:167]
    v_mfma_f32_16x16x32_bf16 v[172:175], v[104:107], a[232:235], v[172:175]
    v_mfma_f32_16x16x32_bf16 v[180:183], v[104:107], v[192:195], v[180:183]
    v_mfma_f32_16x16x32_bf16 v[188:191], v[104:107], v[216:219], v[188:191]
    v_mfma_f32_16x16x32_bf16 v[164:167], v[108:111], a[212:215], v[164:167]
    v_mfma_f32_16x16x32_bf16 v[172:175], v[108:111], a[236:239], v[172:175]
    v_mfma_f32_16x16x32_bf16 v[180:183], v[108:111], v[196:199], v[180:183]
    v_mfma_f32_16x16x32_bf16 v[188:191], v[108:111], v[220:223], v[188:191]
    s_nop 9
    v_max3_f32 v16, v160, v161, v162
    v_max3_f32 v16, v16, v163, v164
    v_max3_f32 v16, v16, v165, v166
    v_max3_f32 v16, v16, v167, v240
    v_mov_b32 v17, v16
    s_nop 1
    v_permlane16_swap_b32 v16, v17
    s_nop 1
    v_max_f32 v16, v16, v17
    v_mov_b32 v17, v16
    s_nop 1
    v_permlane32_swap_b32 v16, v17
    s_nop 1
    v_max_f32 v16, v16, v17
    v_sub_f32 v17, v240, v16
    v_exp_f32 v17, v17
    v_mov_b32 v240, v16
    v_sub_f32 v160, v160, v16
    v_sub_f32 v161, v161, v16
    v_sub_f32 v162, v162, v16
    v_sub_f32 v163, v163, v16
    v_sub_f32 v164, v164, v16
    v_sub_f32 v165, v165, v16
    v_sub_f32 v166, v166, v16
    v_sub_f32 v167, v167, v16
    v_exp_f32 v160, v160
    v_exp_f32 v161, v161
    v_exp_f32 v162, v162
    v_exp_f32 v163, v163
    v_exp_f32 v164, v164
    v_exp_f32 v165, v165
    v_exp_f32 v166, v166
    v_exp_f32 v167, v167
    v_mul_f32 v5, v5, v17
    v_add_f32 v5, v5, v160
    v_add_f32 v5, v5, v161
    v_add_f32 v5, v5, v162
    v_add_f32 v5, v5, v163
    v_add_f32 v5, v5, v164
    v_add_f32 v5, v5, v165
    v_add_f32 v5, v5, v166
    v_add_f32 v5, v5, v167
    v_cvt_pk_bf16_f32 v224, v160, v161
    v_cvt_pk_bf16_f32 v225, v162, v163
    v_cvt_pk_bf16_f32 v226, v164, v165
    v_cvt_pk_bf16_f32 v227, v166, v167
    ds_bpermute_b32 v248, v58, v17 offset:0
    ds_bpermute_b32 v249, v58, v17 offset:4
    ds_bpermute_b32 v250, v58, v17 offset:8
    ds_bpermute_b32 v251, v58, v17 offset:12
    s_waitcnt lgkmcnt(0)
    v_accvgpr_read_b32 v18, a0
    v_mul_f32 v18, v18, v248
    v_accvgpr_write_b32 a0, v18
    v_accvgpr_read_b32 v19, a1
    v_mul_f32 v19, v19, v249
    v_accvgpr_write_b32 a1, v19
    v_accvgpr_read_b32 v18, a2
    v_mul_f32 v18, v18, v250
    v_accvgpr_write_b32 a2, v18
    v_accvgpr_read_b32 v19, a3
    v_mul_f32 v19, v19, v251
    v_accvgpr_write_b32 a3, v19
    v_accvgpr_read_b32 v18, a4
    v_mul_f32 v18, v18, v248
    v_accvgpr_write_b32 a4, v18
    v_accvgpr_read_b32 v19, a5
    v_mul_f32 v19, v19, v249
    v_accvgpr_write_b32 a5, v19
    v_accvgpr_read_b32 v18, a6
    v_mul_f32 v18, v18, v250
    v_accvgpr_write_b32 a6, v18
    v_accvgpr_read_b32 v19, a7
    v_mul_f32 v19, v19, v251
    v_accvgpr_write_b32 a7, v19
    v_accvgpr_read_b32 v18, a8
    v_mul_f32 v18, v18, v248
    v_accvgpr_write_b32 a8, v18
    v_accvgpr_read_b32 v19, a9
    v_mul_f32 v19, v19, v249
    v_accvgpr_write_b32 a9, v19
    v_accvgpr_read_b32 v18, a10
    v_mul_f32 v18, v18, v250
    v_accvgpr_write_b32 a10, v18
    v_accvgpr_read_b32 v19, a11
    v_mul_f32 v19, v19, v251
    v_accvgpr_write_b32 a11, v19
    v_accvgpr_read_b32 v18, a12
    v_mul_f32 v18, v18, v248
    v_accvgpr_write_b32 a12, v18
    v_accvgpr_read_b32 v19, a13
    v_mul_f32 v19, v19, v249
    v_accvgpr_write_b32 a13, v19
    v_accvgpr_read_b32 v18, a14
    v_mul_f32 v18, v18, v250
    v_accvgpr_write_b32 a14, v18
    v_accvgpr_read_b32 v19, a15
    v_mul_f32 v19, v19, v251
    v_accvgpr_write_b32 a15, v19
    v_accvgpr_read_b32 v18, a16
    v_mul_f32 v18, v18, v248
    v_accvgpr_write_b32 a16, v18
    v_accvgpr_read_b32 v19, a17
    v_mul_f32 v19, v19, v249
    v_accvgpr_write_b32 a17, v19
    v_accvgpr_read_b32 v18, a18
    v_mul_f32 v18, v18, v250
    v_accvgpr_write_b32 a18, v18
    v_accvgpr_read_b32 v19, a19
    v_mul_f32 v19, v19, v251
    v_accvgpr_write_b32 a19, v19
    v_accvgpr_read_b32 v18, a20
    v_mul_f32 v18, v18, v248
    v_accvgpr_write_b32 a20, v18
    v_accvgpr_read_b32 v19, a21
    v_mul_f32 v19, v19, v249
    v_accvgpr_write_b32 a21, v19
    v_accvgpr_read_b32 v18, a22
    v_mul_f32 v18, v18, v250
    v_accvgpr_write_b32 a22, v18
    v_accvgpr_read_b32 v19, a23
    v_mul_f32 v19, v19, v251
    v_accvgpr_write_b32 a23, v19
    v_accvgpr_read_b32 v18, a24
    v_mul_f32 v18, v18, v248
    v_accvgpr_write_b32 a24, v18
    v_accvgpr_read_b32 v19, a25
    v_mul_f32 v19, v19, v249
    v_accvgpr_write_b32 a25, v19
    v_accvgpr_read_b32 v18, a26
    v_mul_f32 v18, v18, v250
    v_accvgpr_write_b32 a26, v18
    v_accvgpr_read_b32 v19, a27
    v_mul_f32 v19, v19, v251
    v_accvgpr_write_b32 a27, v19
    v_accvgpr_read_b32 v18, a28
    v_mul_f32 v18, v18, v248
    v_accvgpr_write_b32 a28, v18
    v_accvgpr_read_b32 v19, a29
    v_mul_f32 v19, v19, v249
    v_accvgpr_write_b32 a29, v19
    v_accvgpr_read_b32 v18, a30
    v_mul_f32 v18, v18, v250
    v_accvgpr_write_b32 a30, v18
    v_accvgpr_read_b32 v19, a31
    v_mul_f32 v19, v19, v251
    v_accvgpr_write_b32 a31, v19
    v_accvgpr_read_b32 v18, a32
    v_mul_f32 v18, v18, v248
    v_accvgpr_write_b32 a32, v18
    v_accvgpr_read_b32 v19, a33
    v_mul_f32 v19, v19, v249
    v_accvgpr_write_b32 a33, v19
    v_accvgpr_read_b32 v18, a34
    v_mul_f32 v18, v18, v250
    v_accvgpr_write_b32 a34, v18
    v_accvgpr_read_b32 v19, a35
    v_mul_f32 v19, v19, v251
    v_accvgpr_write_b32 a35, v19
    v_accvgpr_read_b32 v18, a36
    v_mul_f32 v18, v18, v248
    v_accvgpr_write_b32 a36, v18
    v_accvgpr_read_b32 v19, a37
    v_mul_f32 v19, v19, v249
    v_accvgpr_write_b32 a37, v19
    v_accvgpr_read_b32 v18, a38
    v_mul_f32 v18, v18, v250
    v_accvgpr_write_b32 a38, v18
    v_accvgpr_read_b32 v19, a39
    v_mul_f32 v19, v19, v251
    v_accvgpr_write_b32 a39, v19
    v_accvgpr_read_b32 v18, a40
    v_mul_f32 v18, v18, v248
    v_accvgpr_write_b32 a40, v18
    v_accvgpr_read_b32 v19, a41
    v_mul_f32 v19, v19, v249
    v_accvgpr_write_b32 a41, v19
    v_accvgpr_read_b32 v18, a42
    v_mul_f32 v18, v18, v250
    v_accvgpr_write_b32 a42, v18
    v_accvgpr_read_b32 v19, a43
    v_mul_f32 v19, v19, v251
    v_accvgpr_write_b32 a43, v19
    v_accvgpr_read_b32 v18, a44
    v_mul_f32 v18, v18, v248
    v_accvgpr_write_b32 a44, v18
    v_accvgpr_read_b32 v19, a45
    v_mul_f32 v19, v19, v249
    v_accvgpr_write_b32 a45, v19
    v_accvgpr_read_b32 v18, a46
    v_mul_f32 v18, v18, v250
    v_accvgpr_write_b32 a46, v18
    v_accvgpr_read_b32 v19, a47
    v_mul_f32 v19, v19, v251
    v_accvgpr_write_b32 a47, v19
    v_max3_f32 v16, v168, v169, v170
    v_max3_f32 v16, v16, v171, v172
    v_max3_f32 v16, v16, v173, v174
    v_max3_f32 v16, v16, v175, v241
    v_mov_b32 v17, v16
    s_nop 1
    v_permlane16_swap_b32 v16, v17
    s_nop 1
    v_max_f32 v16, v16, v17
    v_mov_b32 v17, v16
    s_nop 1
    v_permlane32_swap_b32 v16, v17
    s_nop 1
    v_max_f32 v16, v16, v17
    v_sub_f32 v17, v241, v16
    v_exp_f32 v17, v17
    v_mov_b32 v241, v16
    v_sub_f32 v168, v168, v16
    v_sub_f32 v169, v169, v16
    v_sub_f32 v170, v170, v16
    v_sub_f32 v171, v171, v16
    v_sub_f32 v172, v172, v16
    v_sub_f32 v173, v173, v16
    v_sub_f32 v174, v174, v16
    v_sub_f32 v175, v175, v16
    v_exp_f32 v168, v168
    v_exp_f32 v169, v169
    v_exp_f32 v170, v170
    v_exp_f32 v171, v171
    v_exp_f32 v172, v172
    v_exp_f32 v173, v173
    v_exp_f32 v174, v174
    v_exp_f32 v175, v175
    v_mul_f32 v6, v6, v17
    v_add_f32 v6, v6, v168
    v_add_f32 v6, v6, v169
    v_add_f32 v6, v6, v170
    v_add_f32 v6, v6, v171
    v_add_f32 v6, v6, v172
    v_add_f32 v6, v6, v173
    v_add_f32 v6, v6, v174
    v_add_f32 v6, v6, v175
    v_cvt_pk_bf16_f32 v228, v168, v169
    v_cvt_pk_bf16_f32 v229, v170, v171
    v_cvt_pk_bf16_f32 v230, v172, v173
    v_cvt_pk_bf16_f32 v231, v174, v175
    ds_bpermute_b32 v248, v58, v17 offset:0
    ds_bpermute_b32 v249, v58, v17 offset:4
    ds_bpermute_b32 v250, v58, v17 offset:8
    ds_bpermute_b32 v251, v58, v17 offset:12
    s_waitcnt lgkmcnt(0)
    v_accvgpr_read_b32 v18, a48
    v_mul_f32 v18, v18, v248
    v_accvgpr_write_b32 a48, v18
    v_accvgpr_read_b32 v19, a49
    v_mul_f32 v19, v19, v249
    v_accvgpr_write_b32 a49, v19
    v_accvgpr_read_b32 v18, a50
    v_mul_f32 v18, v18, v250
    v_accvgpr_write_b32 a50, v18
    v_accvgpr_read_b32 v19, a51
    v_mul_f32 v19, v19, v251
    v_accvgpr_write_b32 a51, v19
    v_accvgpr_read_b32 v18, a52
    v_mul_f32 v18, v18, v248
    v_accvgpr_write_b32 a52, v18
    v_accvgpr_read_b32 v19, a53
    v_mul_f32 v19, v19, v249
    v_accvgpr_write_b32 a53, v19
    v_accvgpr_read_b32 v18, a54
    v_mul_f32 v18, v18, v250
    v_accvgpr_write_b32 a54, v18
    v_accvgpr_read_b32 v19, a55
    v_mul_f32 v19, v19, v251
    v_accvgpr_write_b32 a55, v19
    v_accvgpr_read_b32 v18, a56
    v_mul_f32 v18, v18, v248
    v_accvgpr_write_b32 a56, v18
    v_accvgpr_read_b32 v19, a57
    v_mul_f32 v19, v19, v249
    v_accvgpr_write_b32 a57, v19
    v_accvgpr_read_b32 v18, a58
    v_mul_f32 v18, v18, v250
    v_accvgpr_write_b32 a58, v18
    v_accvgpr_read_b32 v19, a59
    v_mul_f32 v19, v19, v251
    v_accvgpr_write_b32 a59, v19
    v_accvgpr_read_b32 v18, a60
    v_mul_f32 v18, v18, v248
    v_accvgpr_write_b32 a60, v18
    v_accvgpr_read_b32 v19, a61
    v_mul_f32 v19, v19, v249
    v_accvgpr_write_b32 a61, v19
    v_accvgpr_read_b32 v18, a62
    v_mul_f32 v18, v18, v250
    v_accvgpr_write_b32 a62, v18
    v_accvgpr_read_b32 v19, a63
    v_mul_f32 v19, v19, v251
    v_accvgpr_write_b32 a63, v19
    v_accvgpr_read_b32 v18, a64
    v_mul_f32 v18, v18, v248
    v_accvgpr_write_b32 a64, v18
    v_accvgpr_read_b32 v19, a65
    v_mul_f32 v19, v19, v249
    v_accvgpr_write_b32 a65, v19
    v_accvgpr_read_b32 v18, a66
    v_mul_f32 v18, v18, v250
    v_accvgpr_write_b32 a66, v18
    v_accvgpr_read_b32 v19, a67
    v_mul_f32 v19, v19, v251
    v_accvgpr_write_b32 a67, v19
    v_accvgpr_read_b32 v18, a68
    v_mul_f32 v18, v18, v248
    v_accvgpr_write_b32 a68, v18
    v_accvgpr_read_b32 v19, a69
    v_mul_f32 v19, v19, v249
    v_accvgpr_write_b32 a69, v19
    v_accvgpr_read_b32 v18, a70
    v_mul_f32 v18, v18, v250
    v_accvgpr_write_b32 a70, v18
    v_accvgpr_read_b32 v19, a71
    v_mul_f32 v19, v19, v251
    v_accvgpr_write_b32 a71, v19
    v_accvgpr_read_b32 v18, a72
    v_mul_f32 v18, v18, v248
    v_accvgpr_write_b32 a72, v18
    v_accvgpr_read_b32 v19, a73
    v_mul_f32 v19, v19, v249
    v_accvgpr_write_b32 a73, v19
    v_accvgpr_read_b32 v18, a74
    v_mul_f32 v18, v18, v250
    v_accvgpr_write_b32 a74, v18
    v_accvgpr_read_b32 v19, a75
    v_mul_f32 v19, v19, v251
    v_accvgpr_write_b32 a75, v19
    v_accvgpr_read_b32 v18, a76
    v_mul_f32 v18, v18, v248
    v_accvgpr_write_b32 a76, v18
    v_accvgpr_read_b32 v19, a77
    v_mul_f32 v19, v19, v249
    v_accvgpr_write_b32 a77, v19
    v_accvgpr_read_b32 v18, a78
    v_mul_f32 v18, v18, v250
    v_accvgpr_write_b32 a78, v18
    v_accvgpr_read_b32 v19, a79
    v_mul_f32 v19, v19, v251
    v_accvgpr_write_b32 a79, v19
    v_accvgpr_read_b32 v18, a80
    v_mul_f32 v18, v18, v248
    v_accvgpr_write_b32 a80, v18
    v_accvgpr_read_b32 v19, a81
    v_mul_f32 v19, v19, v249
    v_accvgpr_write_b32 a81, v19
    v_accvgpr_read_b32 v18, a82
    v_mul_f32 v18, v18, v250
    v_accvgpr_write_b32 a82, v18
    v_accvgpr_read_b32 v19, a83
    v_mul_f32 v19, v19, v251
    v_accvgpr_write_b32 a83, v19
    v_accvgpr_read_b32 v18, a84
    v_mul_f32 v18, v18, v248
    v_accvgpr_write_b32 a84, v18
    v_accvgpr_read_b32 v19, a85
    v_mul_f32 v19, v19, v249
    v_accvgpr_write_b32 a85, v19
    v_accvgpr_read_b32 v18, a86
    v_mul_f32 v18, v18, v250
    v_accvgpr_write_b32 a86, v18
    v_accvgpr_read_b32 v19, a87
    v_mul_f32 v19, v19, v251
    v_accvgpr_write_b32 a87, v19
    v_accvgpr_read_b32 v18, a88
    v_mul_f32 v18, v18, v248
    v_accvgpr_write_b32 a88, v18
    v_accvgpr_read_b32 v19, a89
    v_mul_f32 v19, v19, v249
    v_accvgpr_write_b32 a89, v19
    v_accvgpr_read_b32 v18, a90
    v_mul_f32 v18, v18, v250
    v_accvgpr_write_b32 a90, v18
    v_accvgpr_read_b32 v19, a91
    v_mul_f32 v19, v19, v251
    v_accvgpr_write_b32 a91, v19
    v_accvgpr_read_b32 v18, a92
    v_mul_f32 v18, v18, v248
    v_accvgpr_write_b32 a92, v18
    v_accvgpr_read_b32 v19, a93
    v_mul_f32 v19, v19, v249
    v_accvgpr_write_b32 a93, v19
    v_accvgpr_read_b32 v18, a94
    v_mul_f32 v18, v18, v250
    v_accvgpr_write_b32 a94, v18
    v_accvgpr_read_b32 v19, a95
    v_mul_f32 v19, v19, v251
    v_accvgpr_write_b32 a95, v19
    v_max3_f32 v16, v176, v177, v178
    v_max3_f32 v16, v16, v179, v180
    v_max3_f32 v16, v16, v181, v182
    v_max3_f32 v16, v16, v183, v242
    v_mov_b32 v17, v16
    s_nop 1
    v_permlane16_swap_b32 v16, v17
    s_nop 1
    v_max_f32 v16, v16, v17
    v_mov_b32 v17, v16
    s_nop 1
    v_permlane32_swap_b32 v16, v17
    s_nop 1
    v_max_f32 v16, v16, v17
    v_sub_f32 v17, v242, v16
    v_exp_f32 v17, v17
    v_mov_b32 v242, v16
    v_sub_f32 v176, v176, v16
    v_sub_f32 v177, v177, v16
    v_sub_f32 v178, v178, v16
    v_sub_f32 v179, v179, v16
    v_sub_f32 v180, v180, v16
    v_sub_f32 v181, v181, v16
    v_sub_f32 v182, v182, v16
    v_sub_f32 v183, v183, v16
    v_exp_f32 v176, v176
    v_exp_f32 v177, v177
    v_exp_f32 v178, v178
    v_exp_f32 v179, v179
    v_exp_f32 v180, v180
    v_exp_f32 v181, v181
    v_exp_f32 v182, v182
    v_exp_f32 v183, v183
    v_mul_f32 v7, v7, v17
    v_add_f32 v7, v7, v176
    v_add_f32 v7, v7, v177
    v_add_f32 v7, v7, v178
    v_add_f32 v7, v7, v179
    v_add_f32 v7, v7, v180
    v_add_f32 v7, v7, v181
    v_add_f32 v7, v7, v182
    v_add_f32 v7, v7, v183
    v_cvt_pk_bf16_f32 v232, v176, v177
    v_cvt_pk_bf16_f32 v233, v178, v179
    v_cvt_pk_bf16_f32 v234, v180, v181
    v_cvt_pk_bf16_f32 v235, v182, v183
    ds_bpermute_b32 v248, v58, v17 offset:0
    ds_bpermute_b32 v249, v58, v17 offset:4
    ds_bpermute_b32 v250, v58, v17 offset:8
    ds_bpermute_b32 v251, v58, v17 offset:12
    s_waitcnt lgkmcnt(0)
    v_accvgpr_read_b32 v18, a96
    v_mul_f32 v18, v18, v248
    v_accvgpr_write_b32 a96, v18
    v_accvgpr_read_b32 v19, a97
    v_mul_f32 v19, v19, v249
    v_accvgpr_write_b32 a97, v19
    v_accvgpr_read_b32 v18, a98
    v_mul_f32 v18, v18, v250
    v_accvgpr_write_b32 a98, v18
    v_accvgpr_read_b32 v19, a99
    v_mul_f32 v19, v19, v251
    v_accvgpr_write_b32 a99, v19
    v_accvgpr_read_b32 v18, a100
    v_mul_f32 v18, v18, v248
    v_accvgpr_write_b32 a100, v18
    v_accvgpr_read_b32 v19, a101
    v_mul_f32 v19, v19, v249
    v_accvgpr_write_b32 a101, v19
    v_accvgpr_read_b32 v18, a102
    v_mul_f32 v18, v18, v250
    v_accvgpr_write_b32 a102, v18
    v_accvgpr_read_b32 v19, a103
    v_mul_f32 v19, v19, v251
    v_accvgpr_write_b32 a103, v19
    v_accvgpr_read_b32 v18, a104
    v_mul_f32 v18, v18, v248
    v_accvgpr_write_b32 a104, v18
    v_accvgpr_read_b32 v19, a105
    v_mul_f32 v19, v19, v249
    v_accvgpr_write_b32 a105, v19
    v_accvgpr_read_b32 v18, a106
    v_mul_f32 v18, v18, v250
    v_accvgpr_write_b32 a106, v18
    v_accvgpr_read_b32 v19, a107
    v_mul_f32 v19, v19, v251
    v_accvgpr_write_b32 a107, v19
    v_accvgpr_read_b32 v18, a108
    v_mul_f32 v18, v18, v248
    v_accvgpr_write_b32 a108, v18
    v_accvgpr_read_b32 v19, a109
    v_mul_f32 v19, v19, v249
    v_accvgpr_write_b32 a109, v19
    v_accvgpr_read_b32 v18, a110
    v_mul_f32 v18, v18, v250
    v_accvgpr_write_b32 a110, v18
    v_accvgpr_read_b32 v19, a111
    v_mul_f32 v19, v19, v251
    v_accvgpr_write_b32 a111, v19
    v_accvgpr_read_b32 v18, a112
    v_mul_f32 v18, v18, v248
    v_accvgpr_write_b32 a112, v18
    v_accvgpr_read_b32 v19, a113
    v_mul_f32 v19, v19, v249
    v_accvgpr_write_b32 a113, v19
    v_accvgpr_read_b32 v18, a114
    v_mul_f32 v18, v18, v250
    v_accvgpr_write_b32 a114, v18
    v_accvgpr_read_b32 v19, a115
    v_mul_f32 v19, v19, v251
    v_accvgpr_write_b32 a115, v19
    v_accvgpr_read_b32 v18, a116
    v_mul_f32 v18, v18, v248
    v_accvgpr_write_b32 a116, v18
    v_accvgpr_read_b32 v19, a117
    v_mul_f32 v19, v19, v249
    v_accvgpr_write_b32 a117, v19
    v_accvgpr_read_b32 v18, a118
    v_mul_f32 v18, v18, v250
    v_accvgpr_write_b32 a118, v18
    v_accvgpr_read_b32 v19, a119
    v_mul_f32 v19, v19, v251
    v_accvgpr_write_b32 a119, v19
    v_accvgpr_read_b32 v18, a120
    v_mul_f32 v18, v18, v248
    v_accvgpr_write_b32 a120, v18
    v_accvgpr_read_b32 v19, a121
    v_mul_f32 v19, v19, v249
    v_accvgpr_write_b32 a121, v19
    v_accvgpr_read_b32 v18, a122
    v_mul_f32 v18, v18, v250
    v_accvgpr_write_b32 a122, v18
    v_accvgpr_read_b32 v19, a123
    v_mul_f32 v19, v19, v251
    v_accvgpr_write_b32 a123, v19
    v_accvgpr_read_b32 v18, a124
    v_mul_f32 v18, v18, v248
    v_accvgpr_write_b32 a124, v18
    v_accvgpr_read_b32 v19, a125
    v_mul_f32 v19, v19, v249
    v_accvgpr_write_b32 a125, v19
    v_accvgpr_read_b32 v18, a126
    v_mul_f32 v18, v18, v250
    v_accvgpr_write_b32 a126, v18
    v_accvgpr_read_b32 v19, a127
    v_mul_f32 v19, v19, v251
    v_accvgpr_write_b32 a127, v19
    v_accvgpr_read_b32 v18, a128
    v_mul_f32 v18, v18, v248
    v_accvgpr_write_b32 a128, v18
    v_accvgpr_read_b32 v19, a129
    v_mul_f32 v19, v19, v249
    v_accvgpr_write_b32 a129, v19
    v_accvgpr_read_b32 v18, a130
    v_mul_f32 v18, v18, v250
    v_accvgpr_write_b32 a130, v18
    v_accvgpr_read_b32 v19, a131
    v_mul_f32 v19, v19, v251
    v_accvgpr_write_b32 a131, v19
    v_accvgpr_read_b32 v18, a132
    v_mul_f32 v18, v18, v248
    v_accvgpr_write_b32 a132, v18
    v_accvgpr_read_b32 v19, a133
    v_mul_f32 v19, v19, v249
    v_accvgpr_write_b32 a133, v19
    v_accvgpr_read_b32 v18, a134
    v_mul_f32 v18, v18, v250
    v_accvgpr_write_b32 a134, v18
    v_accvgpr_read_b32 v19, a135
    v_mul_f32 v19, v19, v251
    v_accvgpr_write_b32 a135, v19
    v_accvgpr_read_b32 v18, a136
    v_mul_f32 v18, v18, v248
    v_accvgpr_write_b32 a136, v18
    v_accvgpr_read_b32 v19, a137
    v_mul_f32 v19, v19, v249
    v_accvgpr_write_b32 a137, v19
    v_accvgpr_read_b32 v18, a138
    v_mul_f32 v18, v18, v250
    v_accvgpr_write_b32 a138, v18
    v_accvgpr_read_b32 v19, a139
    v_mul_f32 v19, v19, v251
    v_accvgpr_write_b32 a139, v19
    v_accvgpr_read_b32 v18, a140
    v_mul_f32 v18, v18, v248
    v_accvgpr_write_b32 a140, v18
    v_accvgpr_read_b32 v19, a141
    v_mul_f32 v19, v19, v249
    v_accvgpr_write_b32 a141, v19
    v_accvgpr_read_b32 v18, a142
    v_mul_f32 v18, v18, v250
    v_accvgpr_write_b32 a142, v18
    v_accvgpr_read_b32 v19, a143
    v_mul_f32 v19, v19, v251
    v_accvgpr_write_b32 a143, v19
    v_max3_f32 v16, v184, v185, v186
    v_max3_f32 v16, v16, v187, v188
    v_max3_f32 v16, v16, v189, v190
    v_max3_f32 v16, v16, v191, v243
    v_mov_b32 v17, v16
    s_nop 1
    v_permlane16_swap_b32 v16, v17
    s_nop 1
    v_max_f32 v16, v16, v17
    v_mov_b32 v17, v16
    s_nop 1
    v_permlane32_swap_b32 v16, v17
    s_nop 1
    v_max_f32 v16, v16, v17
    v_sub_f32 v17, v243, v16
    v_exp_f32 v17, v17
    v_mov_b32 v243, v16
    v_sub_f32 v184, v184, v16
    v_sub_f32 v185, v185, v16
    v_sub_f32 v186, v186, v16
    v_sub_f32 v187, v187, v16
    v_sub_f32 v188, v188, v16
    v_sub_f32 v189, v189, v16
    v_sub_f32 v190, v190, v16
    v_sub_f32 v191, v191, v16
    v_exp_f32 v184, v184
    v_exp_f32 v185, v185
    v_exp_f32 v186, v186
    v_exp_f32 v187, v187
    v_exp_f32 v188, v188
    v_exp_f32 v189, v189
    v_exp_f32 v190, v190
    v_exp_f32 v191, v191
    v_mul_f32 v8, v8, v17
    v_add_f32 v8, v8, v184
    v_add_f32 v8, v8, v185
    v_add_f32 v8, v8, v186
    v_add_f32 v8, v8, v187
    v_add_f32 v8, v8, v188
    v_add_f32 v8, v8, v189
    v_add_f32 v8, v8, v190
    v_add_f32 v8, v8, v191
    v_cvt_pk_bf16_f32 v236, v184, v185
    v_cvt_pk_bf16_f32 v237, v186, v187
    v_cvt_pk_bf16_f32 v238, v188, v189
    v_cvt_pk_bf16_f32 v239, v190, v191
    ds_bpermute_b32 v248, v58, v17 offset:0
    ds_bpermute_b32 v249, v58, v17 offset:4
    ds_bpermute_b32 v250, v58, v17 offset:8
    ds_bpermute_b32 v251, v58, v17 offset:12
    s_waitcnt lgkmcnt(0)
    v_accvgpr_read_b32 v18, a144
    v_mul_f32 v18, v18, v248
    v_accvgpr_write_b32 a144, v18
    v_accvgpr_read_b32 v19, a145
    v_mul_f32 v19, v19, v249
    v_accvgpr_write_b32 a145, v19
    v_accvgpr_read_b32 v18, a146
    v_mul_f32 v18, v18, v250
    v_accvgpr_write_b32 a146, v18
    v_accvgpr_read_b32 v19, a147
    v_mul_f32 v19, v19, v251
    v_accvgpr_write_b32 a147, v19
    v_accvgpr_read_b32 v18, a148
    v_mul_f32 v18, v18, v248
    v_accvgpr_write_b32 a148, v18
    v_accvgpr_read_b32 v19, a149
    v_mul_f32 v19, v19, v249
    v_accvgpr_write_b32 a149, v19
    v_accvgpr_read_b32 v18, a150
    v_mul_f32 v18, v18, v250
    v_accvgpr_write_b32 a150, v18
    v_accvgpr_read_b32 v19, a151
    v_mul_f32 v19, v19, v251
    v_accvgpr_write_b32 a151, v19
    v_accvgpr_read_b32 v18, a152
    v_mul_f32 v18, v18, v248
    v_accvgpr_write_b32 a152, v18
    v_accvgpr_read_b32 v19, a153
    v_mul_f32 v19, v19, v249
    v_accvgpr_write_b32 a153, v19
    v_accvgpr_read_b32 v18, a154
    v_mul_f32 v18, v18, v250
    v_accvgpr_write_b32 a154, v18
    v_accvgpr_read_b32 v19, a155
    v_mul_f32 v19, v19, v251
    v_accvgpr_write_b32 a155, v19
    v_accvgpr_read_b32 v18, a156
    v_mul_f32 v18, v18, v248
    v_accvgpr_write_b32 a156, v18
    v_accvgpr_read_b32 v19, a157
    v_mul_f32 v19, v19, v249
    v_accvgpr_write_b32 a157, v19
    v_accvgpr_read_b32 v18, a158
    v_mul_f32 v18, v18, v250
    v_accvgpr_write_b32 a158, v18
    v_accvgpr_read_b32 v19, a159
    v_mul_f32 v19, v19, v251
    v_accvgpr_write_b32 a159, v19
    v_accvgpr_read_b32 v18, a160
    v_mul_f32 v18, v18, v248
    v_accvgpr_write_b32 a160, v18
    v_accvgpr_read_b32 v19, a161
    v_mul_f32 v19, v19, v249
    v_accvgpr_write_b32 a161, v19
    v_accvgpr_read_b32 v18, a162
    v_mul_f32 v18, v18, v250
    v_accvgpr_write_b32 a162, v18
    v_accvgpr_read_b32 v19, a163
    v_mul_f32 v19, v19, v251
    v_accvgpr_write_b32 a163, v19
    v_accvgpr_read_b32 v18, a164
    v_mul_f32 v18, v18, v248
    v_accvgpr_write_b32 a164, v18
    v_accvgpr_read_b32 v19, a165
    v_mul_f32 v19, v19, v249
    v_accvgpr_write_b32 a165, v19
    v_accvgpr_read_b32 v18, a166
    v_mul_f32 v18, v18, v250
    v_accvgpr_write_b32 a166, v18
    v_accvgpr_read_b32 v19, a167
    v_mul_f32 v19, v19, v251
    v_accvgpr_write_b32 a167, v19
    v_accvgpr_read_b32 v18, a168
    v_mul_f32 v18, v18, v248
    v_accvgpr_write_b32 a168, v18
    v_accvgpr_read_b32 v19, a169
    v_mul_f32 v19, v19, v249
    v_accvgpr_write_b32 a169, v19
    v_accvgpr_read_b32 v18, a170
    v_mul_f32 v18, v18, v250
    v_accvgpr_write_b32 a170, v18
    v_accvgpr_read_b32 v19, a171
    v_mul_f32 v19, v19, v251
    v_accvgpr_write_b32 a171, v19
    v_accvgpr_read_b32 v18, a172
    v_mul_f32 v18, v18, v248
    v_accvgpr_write_b32 a172, v18
    v_accvgpr_read_b32 v19, a173
    v_mul_f32 v19, v19, v249
    v_accvgpr_write_b32 a173, v19
    v_accvgpr_read_b32 v18, a174
    v_mul_f32 v18, v18, v250
    v_accvgpr_write_b32 a174, v18
    v_accvgpr_read_b32 v19, a175
    v_mul_f32 v19, v19, v251
    v_accvgpr_write_b32 a175, v19
    v_accvgpr_read_b32 v18, a176
    v_mul_f32 v18, v18, v248
    v_accvgpr_write_b32 a176, v18
    v_accvgpr_read_b32 v19, a177
    v_mul_f32 v19, v19, v249
    v_accvgpr_write_b32 a177, v19
    v_accvgpr_read_b32 v18, a178
    v_mul_f32 v18, v18, v250
    v_accvgpr_write_b32 a178, v18
    v_accvgpr_read_b32 v19, a179
    v_mul_f32 v19, v19, v251
    v_accvgpr_write_b32 a179, v19
    v_accvgpr_read_b32 v18, a180
    v_mul_f32 v18, v18, v248
    v_accvgpr_write_b32 a180, v18
    v_accvgpr_read_b32 v19, a181
    v_mul_f32 v19, v19, v249
    v_accvgpr_write_b32 a181, v19
    v_accvgpr_read_b32 v18, a182
    v_mul_f32 v18, v18, v250
    v_accvgpr_write_b32 a182, v18
    v_accvgpr_read_b32 v19, a183
    v_mul_f32 v19, v19, v251
    v_accvgpr_write_b32 a183, v19
    v_accvgpr_read_b32 v18, a184
    v_mul_f32 v18, v18, v248
    v_accvgpr_write_b32 a184, v18
    v_accvgpr_read_b32 v19, a185
    v_mul_f32 v19, v19, v249
    v_accvgpr_write_b32 a185, v19
    v_accvgpr_read_b32 v18, a186
    v_mul_f32 v18, v18, v250
    v_accvgpr_write_b32 a186, v18
    v_accvgpr_read_b32 v19, a187
    v_mul_f32 v19, v19, v251
    v_accvgpr_write_b32 a187, v19
    v_accvgpr_read_b32 v18, a188
    v_mul_f32 v18, v18, v248
    v_accvgpr_write_b32 a188, v18
    v_accvgpr_read_b32 v19, a189
    v_mul_f32 v19, v19, v249
    v_accvgpr_write_b32 a189, v19
    v_accvgpr_read_b32 v18, a190
    v_mul_f32 v18, v18, v250
    v_accvgpr_write_b32 a190, v18
    v_accvgpr_read_b32 v19, a191
    v_mul_f32 v19, v19, v251
    v_accvgpr_write_b32 a191, v19
    s_waitcnt vmcnt(0)
    s_nop 1
    v_mfma_f32_16x16x32_bf16 a[0:3], v[224:227], v[112:115], a[0:3]
    v_mfma_f32_16x16x32_bf16 a[48:51], v[228:231], v[112:115], a[48:51]
    v_mfma_f32_16x16x32_bf16 a[96:99], v[232:235], v[112:115], a[96:99]
    v_mfma_f32_16x16x32_bf16 a[144:147], v[236:239], v[112:115], a[144:147]
    v_mfma_f32_16x16x32_bf16 a[4:7], v[224:227], v[116:119], a[4:7]
    v_mfma_f32_16x16x32_bf16 a[52:55], v[228:231], v[116:119], a[52:55]
    v_mfma_f32_16x16x32_bf16 a[100:103], v[232:235], v[116:119], a[100:103]
    v_mfma_f32_16x16x32_bf16 a[148:151], v[236:239], v[116:119], a[148:151]
    v_mfma_f32_16x16x32_bf16 a[8:11], v[224:227], v[120:123], a[8:11]
    v_mfma_f32_16x16x32_bf16 a[56:59], v[228:231], v[120:123], a[56:59]
    v_mfma_f32_16x16x32_bf16 a[104:107], v[232:235], v[120:123], a[104:107]
    v_mfma_f32_16x16x32_bf16 a[152:155], v[236:239], v[120:123], a[152:155]
    v_mfma_f32_16x16x32_bf16 a[12:15], v[224:227], v[124:127], a[12:15]
    v_mfma_f32_16x16x32_bf16 a[60:63], v[228:231], v[124:127], a[60:63]
    v_mfma_f32_16x16x32_bf16 a[108:111], v[232:235], v[124:127], a[108:111]
    v_mfma_f32_16x16x32_bf16 a[156:159], v[236:239], v[124:127], a[156:159]
    v_mfma_f32_16x16x32_bf16 a[16:19], v[224:227], v[128:131], a[16:19]
    v_mfma_f32_16x16x32_bf16 a[64:67], v[228:231], v[128:131], a[64:67]
    v_mfma_f32_16x16x32_bf16 a[112:115], v[232:235], v[128:131], a[112:115]
    v_mfma_f32_16x16x32_bf16 a[160:163], v[236:239], v[128:131], a[160:163]
    v_mfma_f32_16x16x32_bf16 a[20:23], v[224:227], v[132:135], a[20:23]
    v_mfma_f32_16x16x32_bf16 a[68:71], v[228:231], v[132:135], a[68:71]
    v_mfma_f32_16x16x32_bf16 a[116:119], v[232:235], v[132:135], a[116:119]
    v_mfma_f32_16x16x32_bf16 a[164:167], v[236:239], v[132:135], a[164:167]
    v_mfma_f32_16x16x32_bf16 a[24:27], v[224:227], v[136:139], a[24:27]
    v_mfma_f32_16x16x32_bf16 a[72:75], v[228:231], v[136:139], a[72:75]
    v_mfma_f32_16x16x32_bf16 a[120:123], v[232:235], v[136:139], a[120:123]
    v_mfma_f32_16x16x32_bf16 a[168:171], v[236:239], v[136:139], a[168:171]
    v_mfma_f32_16x16x32_bf16 a[28:31], v[224:227], v[140:143], a[28:31]
    v_mfma_f32_16x16x32_bf16 a[76:79], v[228:231], v[140:143], a[76:79]
    v_mfma_f32_16x16x32_bf16 a[124:127], v[232:235], v[140:143], a[124:127]
    v_mfma_f32_16x16x32_bf16 a[172:175], v[236:239], v[140:143], a[172:175]
    v_mfma_f32_16x16x32_bf16 a[32:35], v[224:227], v[144:147], a[32:35]
    v_mfma_f32_16x16x32_bf16 a[80:83], v[228:231], v[144:147], a[80:83]
    v_mfma_f32_16x16x32_bf16 a[128:131], v[232:235], v[144:147], a[128:131]
    v_mfma_f32_16x16x32_bf16 a[176:179], v[236:239], v[144:147], a[176:179]
    v_mfma_f32_16x16x32_bf16 a[36:39], v[224:227], v[148:151], a[36:39]
    v_mfma_f32_16x16x32_bf16 a[84:87], v[228:231], v[148:151], a[84:87]
    v_mfma_f32_16x16x32_bf16 a[132:135], v[232:235], v[148:151], a[132:135]
    v_mfma_f32_16x16x32_bf16 a[180:183], v[236:239], v[148:151], a[180:183]
    v_mfma_f32_16x16x32_bf16 a[40:43], v[224:227], v[152:155], a[40:43]
    v_mfma_f32_16x16x32_bf16 a[88:91], v[228:231], v[152:155], a[88:91]
    v_mfma_f32_16x16x32_bf16 a[136:139], v[232:235], v[152:155], a[136:139]
    v_mfma_f32_16x16x32_bf16 a[184:187], v[236:239], v[152:155], a[184:187]
    v_mfma_f32_16x16x32_bf16 a[44:47], v[224:227], v[156:159], a[44:47]
    v_mfma_f32_16x16x32_bf16 a[92:95], v[228:231], v[156:159], a[92:95]
    v_mfma_f32_16x16x32_bf16 a[140:143], v[232:235], v[156:159], a[140:143]
    v_mfma_f32_16x16x32_bf16 a[188:191], v[236:239], v[156:159], a[188:191]
    s_add_u32 s48, s48, 24576
    s_cmp_lt_u32 s48, 1572864
    s_nop 7
    s_cbranch_scc1 L_slowloop
    s_nop 1
    v_mfma_f32_16x16x4_f32 v[48:51], v5, v57, 0
    v_mfma_f32_16x16x4_f32 v[52:55], v6, v57, 0
    s_nop 7
    s_nop 1
    v_rcp_f32 v48, v48
    v_rcp_f32 v49, v49
    v_rcp_f32 v50, v50
    v_rcp_f32 v51, v51
    v_rcp_f32 v52, v52
    v_rcp_f32 v53, v53
    v_rcp_f32 v54, v54
    v_rcp_f32 v55, v55
    v_mfma_f32_16x16x4_f32 v[128:131], v7, v57, 0
    v_mfma_f32_16x16x4_f32 v[132:135], v8, v57, 0
    s_nop 7
    s_nop 1
    v_rcp_f32 v128, v128
    v_rcp_f32 v129, v129
    v_rcp_f32 v130, v130
    v_rcp_f32 v131, v131
    v_rcp_f32 v132, v132
    v_rcp_f32 v133, v133
    v_rcp_f32 v134, v134
    v_rcp_f32 v135, v135
    s_nop 0
    v_accvgpr_read_b32 v64, a0
    v_accvgpr_read_b32 v65, a4
    v_accvgpr_read_b32 v66, a8
    v_accvgpr_read_b32 v67, a12
    v_accvgpr_read_b32 v68, a16
    v_accvgpr_read_b32 v69, a20
    v_pk_mul_f32 v[64:65], v[64:65], v[48:49] op_sel_hi:[1,0]
    v_pk_mul_f32 v[66:67], v[66:67], v[48:49] op_sel_hi:[1,0]
    v_pk_mul_f32 v[68:69], v[68:69], v[48:49] op_sel_hi:[1,0]
    v_cvt_pk_bf16_f32 v64, v64, v65
    v_cvt_pk_bf16_f32 v65, v66, v67
    v_cvt_pk_bf16_f32 v66, v68, v69
    v_accvgpr_read_b32 v70, a1
    v_accvgpr_read_b32 v71, a5
    v_accvgpr_read_b32 v72, a9
    v_accvgpr_read_b32 v73, a13
    v_accvgpr_read_b32 v74, a17
    v_accvgpr_read_b32 v75, a21
    v_pk_mul_f32 v[70:71], v[70:71], v[48:49] op_sel:[0,1] op_sel_hi:[1,1]
    v_pk_mul_f32 v[72:73], v[72:73], v[48:49] op_sel:[0,1] op_sel_hi:[1,1]
    v_pk_mul_f32 v[74:75], v[74:75], v[48:49] op_sel:[0,1] op_sel_hi:[1,1]
    v_cvt_pk_bf16_f32 v70, v70, v71
    v_cvt_pk_bf16_f32 v71, v72, v73
    v_cvt_pk_bf16_f32 v72, v74, v75
    buffer_store_dwordx3 v[64:66], v56, s[12:15], s24 offen offset:0 sc0 sc1
    v_accvgpr_read_b32 v76, a2
    v_accvgpr_read_b32 v77, a6
    v_accvgpr_read_b32 v78, a10
    v_accvgpr_read_b32 v79, a14
    v_accvgpr_read_b32 v80, a18
    v_accvgpr_read_b32 v81, a22
    v_pk_mul_f32 v[76:77], v[76:77], v[50:51] op_sel_hi:[1,0]
    v_pk_mul_f32 v[78:79], v[78:79], v[50:51] op_sel_hi:[1,0]
    v_pk_mul_f32 v[80:81], v[80:81], v[50:51] op_sel_hi:[1,0]
    v_cvt_pk_bf16_f32 v76, v76, v77
    v_cvt_pk_bf16_f32 v77, v78, v79
    v_cvt_pk_bf16_f32 v78, v80, v81
    buffer_store_dwordx3 v[70:72], v56, s[12:15], s24 offen offset:384 sc0 sc1
    v_accvgpr_read_b32 v82, a3
    v_accvgpr_read_b32 v83, a7
    v_accvgpr_read_b32 v84, a11
    v_accvgpr_read_b32 v85, a15
    v_accvgpr_read_b32 v86, a19
    v_accvgpr_read_b32 v87, a23
    v_pk_mul_f32 v[82:83], v[82:83], v[50:51] op_sel:[0,1] op_sel_hi:[1,1]
    v_pk_mul_f32 v[84:85], v[84:85], v[50:51] op_sel:[0,1] op_sel_hi:[1,1]
    v_pk_mul_f32 v[86:87], v[86:87], v[50:51] op_sel:[0,1] op_sel_hi:[1,1]
    v_cvt_pk_bf16_f32 v82, v82, v83
    v_cvt_pk_bf16_f32 v83, v84, v85
    v_cvt_pk_bf16_f32 v84, v86, v87
    buffer_store_dwordx3 v[76:78], v56, s[12:15], s24 offen offset:768 sc0 sc1
    v_accvgpr_read_b32 v88, a24
    v_accvgpr_read_b32 v89, a28
    v_accvgpr_read_b32 v90, a32
    v_accvgpr_read_b32 v91, a36
    v_accvgpr_read_b32 v92, a40
    v_accvgpr_read_b32 v93, a44
    v_pk_mul_f32 v[88:89], v[88:89], v[48:49] op_sel_hi:[1,0]
    v_pk_mul_f32 v[90:91], v[90:91], v[48:49] op_sel_hi:[1,0]
    v_pk_mul_f32 v[92:93], v[92:93], v[48:49] op_sel_hi:[1,0]
    v_cvt_pk_bf16_f32 v88, v88, v89
    v_cvt_pk_bf16_f32 v89, v90, v91
    v_cvt_pk_bf16_f32 v90, v92, v93
    buffer_store_dwordx3 v[82:84], v56, s[12:15], s24 offen offset:1152 sc0 sc1
    v_accvgpr_read_b32 v94, a25
    v_accvgpr_read_b32 v95, a29
    v_accvgpr_read_b32 v96, a33
    v_accvgpr_read_b32 v97, a37
    v_accvgpr_read_b32 v98, a41
    v_accvgpr_read_b32 v99, a45
    v_pk_mul_f32 v[94:95], v[94:95], v[48:49] op_sel:[0,1] op_sel_hi:[1,1]
    v_pk_mul_f32 v[96:97], v[96:97], v[48:49] op_sel:[0,1] op_sel_hi:[1,1]
    v_pk_mul_f32 v[98:99], v[98:99], v[48:49] op_sel:[0,1] op_sel_hi:[1,1]
    v_cvt_pk_bf16_f32 v94, v94, v95
    v_cvt_pk_bf16_f32 v95, v96, v97
    v_cvt_pk_bf16_f32 v96, v98, v99
    buffer_store_dwordx3 v[88:90], v56, s[12:15], s24 offen offset:192 sc0 sc1
    v_accvgpr_read_b32 v100, a26
    v_accvgpr_read_b32 v101, a30
    v_accvgpr_read_b32 v102, a34
    v_accvgpr_read_b32 v103, a38
    v_accvgpr_read_b32 v104, a42
    v_accvgpr_read_b32 v105, a46
    v_pk_mul_f32 v[100:101], v[100:101], v[50:51] op_sel_hi:[1,0]
    v_pk_mul_f32 v[102:103], v[102:103], v[50:51] op_sel_hi:[1,0]
    v_pk_mul_f32 v[104:105], v[104:105], v[50:51] op_sel_hi:[1,0]
    v_cvt_pk_bf16_f32 v100, v100, v101
    v_cvt_pk_bf16_f32 v101, v102, v103
    v_cvt_pk_bf16_f32 v102, v104, v105
    buffer_store_dwordx3 v[94:96], v56, s[12:15], s24 offen offset:576 sc0 sc1
    v_accvgpr_read_b32 v106, a27
    v_accvgpr_read_b32 v107, a31
    v_accvgpr_read_b32 v108, a35
    v_accvgpr_read_b32 v109, a39
    v_accvgpr_read_b32 v110, a43
    v_accvgpr_read_b32 v111, a47
    v_pk_mul_f32 v[106:107], v[106:107], v[50:51] op_sel:[0,1] op_sel_hi:[1,1]
    v_pk_mul_f32 v[108:109], v[108:109], v[50:51] op_sel:[0,1] op_sel_hi:[1,1]
    v_pk_mul_f32 v[110:111], v[110:111], v[50:51] op_sel:[0,1] op_sel_hi:[1,1]
    v_cvt_pk_bf16_f32 v106, v106, v107
    v_cvt_pk_bf16_f32 v107, v108, v109
    v_cvt_pk_bf16_f32 v108, v110, v111
    buffer_store_dwordx3 v[100:102], v56, s[12:15], s24 offen offset:960 sc0 sc1
    v_accvgpr_read_b32 v64, a48
    v_accvgpr_read_b32 v65, a52
    v_accvgpr_read_b32 v66, a56
    v_accvgpr_read_b32 v67, a60
    v_accvgpr_read_b32 v68, a64
    v_accvgpr_read_b32 v69, a68
    v_pk_mul_f32 v[64:65], v[64:65], v[52:53] op_sel_hi:[1,0]
    v_pk_mul_f32 v[66:67], v[66:67], v[52:53] op_sel_hi:[1,0]
    v_pk_mul_f32 v[68:69], v[68:69], v[52:53] op_sel_hi:[1,0]
    v_cvt_pk_bf16_f32 v64, v64, v65
    v_cvt_pk_bf16_f32 v65, v66, v67
    v_cvt_pk_bf16_f32 v66, v68, v69
    buffer_store_dwordx3 v[106:108], v56, s[12:15], s24 offen offset:1344 sc0 sc1
    v_accvgpr_read_b32 v70, a49
    v_accvgpr_read_b32 v71, a53
    v_accvgpr_read_b32 v72, a57
    v_accvgpr_read_b32 v73, a61
    v_accvgpr_read_b32 v74, a65
    v_accvgpr_read_b32 v75, a69
    v_pk_mul_f32 v[70:71], v[70:71], v[52:53] op_sel:[0,1] op_sel_hi:[1,1]
    v_pk_mul_f32 v[72:73], v[72:73], v[52:53] op_sel:[0,1] op_sel_hi:[1,1]
    v_pk_mul_f32 v[74:75], v[74:75], v[52:53] op_sel:[0,1] op_sel_hi:[1,1]
    v_cvt_pk_bf16_f32 v70, v70, v71
    v_cvt_pk_bf16_f32 v71, v72, v73
    v_cvt_pk_bf16_f32 v72, v74, v75
    buffer_store_dwordx3 v[64:66], v56, s[12:15], s40 offen offset:0 sc0 sc1
    v_accvgpr_read_b32 v76, a50
    v_accvgpr_read_b32 v77, a54
    v_accvgpr_read_b32 v78, a58
    v_accvgpr_read_b32 v79, a62
    v_accvgpr_read_b32 v80, a66
    v_accvgpr_read_b32 v81, a70
    v_pk_mul_f32 v[76:77], v[76:77], v[54:55] op_sel_hi:[1,0]
    v_pk_mul_f32 v[78:79], v[78:79], v[54:55] op_sel_hi:[1,0]
    v_pk_mul_f32 v[80:81], v[80:81], v[54:55] op_sel_hi:[1,0]
    v_cvt_pk_bf16_f32 v76, v76, v77
    v_cvt_pk_bf16_f32 v77, v78, v79
    v_cvt_pk_bf16_f32 v78, v80, v81
    buffer_store_dwordx3 v[70:72], v56, s[12:15], s40 offen offset:384 sc0 sc1
    v_accvgpr_read_b32 v82, a51
    v_accvgpr_read_b32 v83, a55
    v_accvgpr_read_b32 v84, a59
    v_accvgpr_read_b32 v85, a63
    v_accvgpr_read_b32 v86, a67
    v_accvgpr_read_b32 v87, a71
    v_pk_mul_f32 v[82:83], v[82:83], v[54:55] op_sel:[0,1] op_sel_hi:[1,1]
    v_pk_mul_f32 v[84:85], v[84:85], v[54:55] op_sel:[0,1] op_sel_hi:[1,1]
    v_pk_mul_f32 v[86:87], v[86:87], v[54:55] op_sel:[0,1] op_sel_hi:[1,1]
    v_cvt_pk_bf16_f32 v82, v82, v83
    v_cvt_pk_bf16_f32 v83, v84, v85
    v_cvt_pk_bf16_f32 v84, v86, v87
    buffer_store_dwordx3 v[76:78], v56, s[12:15], s40 offen offset:768 sc0 sc1
    v_accvgpr_read_b32 v88, a72
    v_accvgpr_read_b32 v89, a76
    v_accvgpr_read_b32 v90, a80
    v_accvgpr_read_b32 v91, a84
    v_accvgpr_read_b32 v92, a88
    v_accvgpr_read_b32 v93, a92
    v_pk_mul_f32 v[88:89], v[88:89], v[52:53] op_sel_hi:[1,0]
    v_pk_mul_f32 v[90:91], v[90:91], v[52:53] op_sel_hi:[1,0]
    v_pk_mul_f32 v[92:93], v[92:93], v[52:53] op_sel_hi:[1,0]
    v_cvt_pk_bf16_f32 v88, v88, v89
    v_cvt_pk_bf16_f32 v89, v90, v91
    v_cvt_pk_bf16_f32 v90, v92, v93
    buffer_store_dwordx3 v[82:84], v56, s[12:15], s40 offen offset:1152 sc0 sc1
    v_accvgpr_read_b32 v94, a73
    v_accvgpr_read_b32 v95, a77
    v_accvgpr_read_b32 v96, a81
    v_accvgpr_read_b32 v97, a85
    v_accvgpr_read_b32 v98, a89
    v_accvgpr_read_b32 v99, a93
    v_pk_mul_f32 v[94:95], v[94:95], v[52:53] op_sel:[0,1] op_sel_hi:[1,1]
    v_pk_mul_f32 v[96:97], v[96:97], v[52:53] op_sel:[0,1] op_sel_hi:[1,1]
    v_pk_mul_f32 v[98:99], v[98:99], v[52:53] op_sel:[0,1] op_sel_hi:[1,1]
    v_cvt_pk_bf16_f32 v94, v94, v95
    v_cvt_pk_bf16_f32 v95, v96, v97
    v_cvt_pk_bf16_f32 v96, v98, v99
    buffer_store_dwordx3 v[88:90], v56, s[12:15], s40 offen offset:192 sc0 sc1
    v_accvgpr_read_b32 v100, a74
    v_accvgpr_read_b32 v101, a78
    v_accvgpr_read_b32 v102, a82
    v_accvgpr_read_b32 v103, a86
    v_accvgpr_read_b32 v104, a90
    v_accvgpr_read_b32 v105, a94
    v_pk_mul_f32 v[100:101], v[100:101], v[54:55] op_sel_hi:[1,0]
    v_pk_mul_f32 v[102:103], v[102:103], v[54:55] op_sel_hi:[1,0]
    v_pk_mul_f32 v[104:105], v[104:105], v[54:55] op_sel_hi:[1,0]
    v_cvt_pk_bf16_f32 v100, v100, v101
    v_cvt_pk_bf16_f32 v101, v102, v103
    v_cvt_pk_bf16_f32 v102, v104, v105
    buffer_store_dwordx3 v[94:96], v56, s[12:15], s40 offen offset:576 sc0 sc1
    v_accvgpr_read_b32 v106, a75
    v_accvgpr_read_b32 v107, a79
    v_accvgpr_read_b32 v108, a83
    v_accvgpr_read_b32 v109, a87
    v_accvgpr_read_b32 v110, a91
    v_accvgpr_read_b32 v111, a95
    v_pk_mul_f32 v[106:107], v[106:107], v[54:55] op_sel:[0,1] op_sel_hi:[1,1]
    v_pk_mul_f32 v[108:109], v[108:109], v[54:55] op_sel:[0,1] op_sel_hi:[1,1]
    v_pk_mul_f32 v[110:111], v[110:111], v[54:55] op_sel:[0,1] op_sel_hi:[1,1]
    v_cvt_pk_bf16_f32 v106, v106, v107
    v_cvt_pk_bf16_f32 v107, v108, v109
    v_cvt_pk_bf16_f32 v108, v110, v111
    buffer_store_dwordx3 v[100:102], v56, s[12:15], s40 offen offset:960 sc0 sc1
    v_accvgpr_read_b32 v64, a96
    v_accvgpr_read_b32 v65, a100
    v_accvgpr_read_b32 v66, a104
    v_accvgpr_read_b32 v67, a108
    v_accvgpr_read_b32 v68, a112
    v_accvgpr_read_b32 v69, a116
    v_pk_mul_f32 v[64:65], v[64:65], v[128:129] op_sel_hi:[1,0]
    v_pk_mul_f32 v[66:67], v[66:67], v[128:129] op_sel_hi:[1,0]
    v_pk_mul_f32 v[68:69], v[68:69], v[128:129] op_sel_hi:[1,0]
    v_cvt_pk_bf16_f32 v64, v64, v65
    v_cvt_pk_bf16_f32 v65, v66, v67
    v_cvt_pk_bf16_f32 v66, v68, v69
    buffer_store_dwordx3 v[106:108], v56, s[12:15], s40 offen offset:1344 sc0 sc1
    v_accvgpr_read_b32 v70, a97
    v_accvgpr_read_b32 v71, a101
    v_accvgpr_read_b32 v72, a105
    v_accvgpr_read_b32 v73, a109
    v_accvgpr_read_b32 v74, a113
    v_accvgpr_read_b32 v75, a117
    v_pk_mul_f32 v[70:71], v[70:71], v[128:129] op_sel:[0,1] op_sel_hi:[1,1]
    v_pk_mul_f32 v[72:73], v[72:73], v[128:129] op_sel:[0,1] op_sel_hi:[1,1]
    v_pk_mul_f32 v[74:75], v[74:75], v[128:129] op_sel:[0,1] op_sel_hi:[1,1]
    v_cvt_pk_bf16_f32 v70, v70, v71
    v_cvt_pk_bf16_f32 v71, v72, v73
    v_cvt_pk_bf16_f32 v72, v74, v75
    buffer_store_dwordx3 v[64:66], v56, s[12:15], s41 offen offset:0 sc0 sc1
    v_accvgpr_read_b32 v76, a98
    v_accvgpr_read_b32 v77, a102
    v_accvgpr_read_b32 v78, a106
    v_accvgpr_read_b32 v79, a110
    v_accvgpr_read_b32 v80, a114
    v_accvgpr_read_b32 v81, a118
    v_pk_mul_f32 v[76:77], v[76:77], v[130:131] op_sel_hi:[1,0]
    v_pk_mul_f32 v[78:79], v[78:79], v[130:131] op_sel_hi:[1,0]
    v_pk_mul_f32 v[80:81], v[80:81], v[130:131] op_sel_hi:[1,0]
    v_cvt_pk_bf16_f32 v76, v76, v77
    v_cvt_pk_bf16_f32 v77, v78, v79
    v_cvt_pk_bf16_f32 v78, v80, v81
    buffer_store_dwordx3 v[70:72], v56, s[12:15], s41 offen offset:384 sc0 sc1
    v_accvgpr_read_b32 v82, a99
    v_accvgpr_read_b32 v83, a103
    v_accvgpr_read_b32 v84, a107
    v_accvgpr_read_b32 v85, a111
    v_accvgpr_read_b32 v86, a115
    v_accvgpr_read_b32 v87, a119
    v_pk_mul_f32 v[82:83], v[82:83], v[130:131] op_sel:[0,1] op_sel_hi:[1,1]
    v_pk_mul_f32 v[84:85], v[84:85], v[130:131] op_sel:[0,1] op_sel_hi:[1,1]
    v_pk_mul_f32 v[86:87], v[86:87], v[130:131] op_sel:[0,1] op_sel_hi:[1,1]
    v_cvt_pk_bf16_f32 v82, v82, v83
    v_cvt_pk_bf16_f32 v83, v84, v85
    v_cvt_pk_bf16_f32 v84, v86, v87
    buffer_store_dwordx3 v[76:78], v56, s[12:15], s41 offen offset:768 sc0 sc1
    v_accvgpr_read_b32 v88, a120
    v_accvgpr_read_b32 v89, a124
    v_accvgpr_read_b32 v90, a128
    v_accvgpr_read_b32 v91, a132
    v_accvgpr_read_b32 v92, a136
    v_accvgpr_read_b32 v93, a140
    v_pk_mul_f32 v[88:89], v[88:89], v[128:129] op_sel_hi:[1,0]
    v_pk_mul_f32 v[90:91], v[90:91], v[128:129] op_sel_hi:[1,0]
    v_pk_mul_f32 v[92:93], v[92:93], v[128:129] op_sel_hi:[1,0]
    v_cvt_pk_bf16_f32 v88, v88, v89
    v_cvt_pk_bf16_f32 v89, v90, v91
    v_cvt_pk_bf16_f32 v90, v92, v93
    buffer_store_dwordx3 v[82:84], v56, s[12:15], s41 offen offset:1152 sc0 sc1
    v_accvgpr_read_b32 v94, a121
    v_accvgpr_read_b32 v95, a125
    v_accvgpr_read_b32 v96, a129
    v_accvgpr_read_b32 v97, a133
    v_accvgpr_read_b32 v98, a137
    v_accvgpr_read_b32 v99, a141
    v_pk_mul_f32 v[94:95], v[94:95], v[128:129] op_sel:[0,1] op_sel_hi:[1,1]
    v_pk_mul_f32 v[96:97], v[96:97], v[128:129] op_sel:[0,1] op_sel_hi:[1,1]
    v_pk_mul_f32 v[98:99], v[98:99], v[128:129] op_sel:[0,1] op_sel_hi:[1,1]
    v_cvt_pk_bf16_f32 v94, v94, v95
    v_cvt_pk_bf16_f32 v95, v96, v97
    v_cvt_pk_bf16_f32 v96, v98, v99
    buffer_store_dwordx3 v[88:90], v56, s[12:15], s41 offen offset:192 sc0 sc1
    v_accvgpr_read_b32 v100, a122
    v_accvgpr_read_b32 v101, a126
    v_accvgpr_read_b32 v102, a130
    v_accvgpr_read_b32 v103, a134
    v_accvgpr_read_b32 v104, a138
    v_accvgpr_read_b32 v105, a142
    v_pk_mul_f32 v[100:101], v[100:101], v[130:131] op_sel_hi:[1,0]
    v_pk_mul_f32 v[102:103], v[102:103], v[130:131] op_sel_hi:[1,0]
    v_pk_mul_f32 v[104:105], v[104:105], v[130:131] op_sel_hi:[1,0]
    v_cvt_pk_bf16_f32 v100, v100, v101
    v_cvt_pk_bf16_f32 v101, v102, v103
    v_cvt_pk_bf16_f32 v102, v104, v105
    buffer_store_dwordx3 v[94:96], v56, s[12:15], s41 offen offset:576 sc0 sc1
    v_accvgpr_read_b32 v106, a123
    v_accvgpr_read_b32 v107, a127
    v_accvgpr_read_b32 v108, a131
    v_accvgpr_read_b32 v109, a135
    v_accvgpr_read_b32 v110, a139
    v_accvgpr_read_b32 v111, a143
    v_pk_mul_f32 v[106:107], v[106:107], v[130:131] op_sel:[0,1] op_sel_hi:[1,1]
    v_pk_mul_f32 v[108:109], v[108:109], v[130:131] op_sel:[0,1] op_sel_hi:[1,1]
    v_pk_mul_f32 v[110:111], v[110:111], v[130:131] op_sel:[0,1] op_sel_hi:[1,1]
    v_cvt_pk_bf16_f32 v106, v106, v107
    v_cvt_pk_bf16_f32 v107, v108, v109
    v_cvt_pk_bf16_f32 v108, v110, v111
    buffer_store_dwordx3 v[100:102], v56, s[12:15], s41 offen offset:960 sc0 sc1
    v_accvgpr_read_b32 v64, a144
    v_accvgpr_read_b32 v65, a148
    v_accvgpr_read_b32 v66, a152
    v_accvgpr_read_b32 v67, a156
    v_accvgpr_read_b32 v68, a160
    v_accvgpr_read_b32 v69, a164
    v_pk_mul_f32 v[64:65], v[64:65], v[132:133] op_sel_hi:[1,0]
    v_pk_mul_f32 v[66:67], v[66:67], v[132:133] op_sel_hi:[1,0]
    v_pk_mul_f32 v[68:69], v[68:69], v[132:133] op_sel_hi:[1,0]
    v_cvt_pk_bf16_f32 v64, v64, v65
    v_cvt_pk_bf16_f32 v65, v66, v67
    v_cvt_pk_bf16_f32 v66, v68, v69
    buffer_store_dwordx3 v[106:108], v56, s[12:15], s41 offen offset:1344 sc0 sc1
    v_accvgpr_read_b32 v70, a145
    v_accvgpr_read_b32 v71, a149
    v_accvgpr_read_b32 v72, a153
    v_accvgpr_read_b32 v73, a157
    v_accvgpr_read_b32 v74, a161
    v_accvgpr_read_b32 v75, a165
    v_pk_mul_f32 v[70:71], v[70:71], v[132:133] op_sel:[0,1] op_sel_hi:[1,1]
    v_pk_mul_f32 v[72:73], v[72:73], v[132:133] op_sel:[0,1] op_sel_hi:[1,1]
    v_pk_mul_f32 v[74:75], v[74:75], v[132:133] op_sel:[0,1] op_sel_hi:[1,1]
    v_cvt_pk_bf16_f32 v70, v70, v71
    v_cvt_pk_bf16_f32 v71, v72, v73
    v_cvt_pk_bf16_f32 v72, v74, v75
    buffer_store_dwordx3 v[64:66], v56, s[12:15], s42 offen offset:0 sc0 sc1
    v_accvgpr_read_b32 v76, a146
    v_accvgpr_read_b32 v77, a150
    v_accvgpr_read_b32 v78, a154
    v_accvgpr_read_b32 v79, a158
    v_accvgpr_read_b32 v80, a162
    v_accvgpr_read_b32 v81, a166
    v_pk_mul_f32 v[76:77], v[76:77], v[134:135] op_sel_hi:[1,0]
    v_pk_mul_f32 v[78:79], v[78:79], v[134:135] op_sel_hi:[1,0]
    v_pk_mul_f32 v[80:81], v[80:81], v[134:135] op_sel_hi:[1,0]
    v_cvt_pk_bf16_f32 v76, v76, v77
    v_cvt_pk_bf16_f32 v77, v78, v79
    v_cvt_pk_bf16_f32 v78, v80, v81
    buffer_store_dwordx3 v[70:72], v56, s[12:15], s42 offen offset:384 sc0 sc1
    v_accvgpr_read_b32 v82, a147
    v_accvgpr_read_b32 v83, a151
    v_accvgpr_read_b32 v84, a155
    v_accvgpr_read_b32 v85, a159
    v_accvgpr_read_b32 v86, a163
    v_accvgpr_read_b32 v87, a167
    v_pk_mul_f32 v[82:83], v[82:83], v[134:135] op_sel:[0,1] op_sel_hi:[1,1]
    v_pk_mul_f32 v[84:85], v[84:85], v[134:135] op_sel:[0,1] op_sel_hi:[1,1]
    v_pk_mul_f32 v[86:87], v[86:87], v[134:135] op_sel:[0,1] op_sel_hi:[1,1]
    v_cvt_pk_bf16_f32 v82, v82, v83
    v_cvt_pk_bf16_f32 v83, v84, v85
    v_cvt_pk_bf16_f32 v84, v86, v87
    buffer_store_dwordx3 v[76:78], v56, s[12:15], s42 offen offset:768 sc0 sc1
    v_accvgpr_read_b32 v88, a168
    v_accvgpr_read_b32 v89, a172
    v_accvgpr_read_b32 v90, a176
    v_accvgpr_read_b32 v91, a180
    v_accvgpr_read_b32 v92, a184
    v_accvgpr_read_b32 v93, a188
    v_pk_mul_f32 v[88:89], v[88:89], v[132:133] op_sel_hi:[1,0]
    v_pk_mul_f32 v[90:91], v[90:91], v[132:133] op_sel_hi:[1,0]
    v_pk_mul_f32 v[92:93], v[92:93], v[132:133] op_sel_hi:[1,0]
    v_cvt_pk_bf16_f32 v88, v88, v89
    v_cvt_pk_bf16_f32 v89, v90, v91
    v_cvt_pk_bf16_f32 v90, v92, v93
    buffer_store_dwordx3 v[82:84], v56, s[12:15], s42 offen offset:1152 sc0 sc1
    v_accvgpr_read_b32 v94, a169
    v_accvgpr_read_b32 v95, a173
    v_accvgpr_read_b32 v96, a177
    v_accvgpr_read_b32 v97, a181
    v_accvgpr_read_b32 v98, a185
    v_accvgpr_read_b32 v99, a189
    v_pk_mul_f32 v[94:95], v[94:95], v[132:133] op_sel:[0,1] op_sel_hi:[1,1]
    v_pk_mul_f32 v[96:97], v[96:97], v[132:133] op_sel:[0,1] op_sel_hi:[1,1]
    v_pk_mul_f32 v[98:99], v[98:99], v[132:133] op_sel:[0,1] op_sel_hi:[1,1]
    v_cvt_pk_bf16_f32 v94, v94, v95
    v_cvt_pk_bf16_f32 v95, v96, v97
    v_cvt_pk_bf16_f32 v96, v98, v99
    buffer_store_dwordx3 v[88:90], v56, s[12:15], s42 offen offset:192 sc0 sc1
    v_accvgpr_read_b32 v100, a170
    v_accvgpr_read_b32 v101, a174
    v_accvgpr_read_b32 v102, a178
    v_accvgpr_read_b32 v103, a182
    v_accvgpr_read_b32 v104, a186
    v_accvgpr_read_b32 v105, a190
    v_pk_mul_f32 v[100:101], v[100:101], v[134:135] op_sel_hi:[1,0]
    v_pk_mul_f32 v[102:103], v[102:103], v[134:135] op_sel_hi:[1,0]
    v_pk_mul_f32 v[104:105], v[104:105], v[134:135] op_sel_hi:[1,0]
    v_cvt_pk_bf16_f32 v100, v100, v101
    v_cvt_pk_bf16_f32 v101, v102, v103
    v_cvt_pk_bf16_f32 v102, v104, v105
    buffer_store_dwordx3 v[94:96], v56, s[12:15], s42 offen offset:576 sc0 sc1
    v_accvgpr_read_b32 v106, a171
    v_accvgpr_read_b32 v107, a175
    v_accvgpr_read_b32 v108, a179
    v_accvgpr_read_b32 v109, a183
    v_accvgpr_read_b32 v110, a187
    v_accvgpr_read_b32 v111, a191
    v_pk_mul_f32 v[106:107], v[106:107], v[134:135] op_sel:[0,1] op_sel_hi:[1,1]
    v_pk_mul_f32 v[108:109], v[108:109], v[134:135] op_sel:[0,1] op_sel_hi:[1,1]
    v_pk_mul_f32 v[110:111], v[110:111], v[134:135] op_sel:[0,1] op_sel_hi:[1,1]
    v_cvt_pk_bf16_f32 v106, v106, v107
    v_cvt_pk_bf16_f32 v107, v108, v109
    v_cvt_pk_bf16_f32 v108, v110, v111
    buffer_store_dwordx3 v[100:102], v56, s[12:15], s42 offen offset:960 sc0 sc1
    buffer_store_dwordx3 v[106:108], v56, s[12:15], s42 offen offset:1344 sc0 sc1
    s_branch L_fin
.section .rodata,"a"
.p2align 6
.amdhsa_kernel standalone__kv_cache_quant_int4_int2_kv_with_per_channel_or_per_token_scales__prompt_kernel
  .amdhsa_next_free_vgpr 512
  .amdhsa_next_free_sgpr 102
  .amdhsa_accum_offset 256
  .amdhsa_group_segment_fixed_size 0
  .amdhsa_kernarg_size 80
  .amdhsa_user_sgpr_count 2
  .amdhsa_user_sgpr_kernarg_segment_ptr 1
  .amdhsa_system_sgpr_workgroup_id_x 1
.end_amdhsa_kernel
```

```asm
; @launch grid=(256,1,1) block=(256,1,1) lds=147584
.amdgcn_target "amdgcn-amd-amdhsa--gfx950"
.text
.globl standalone__kv_cache_quant_int4_int2_kv_with_per_channel_or_per_token_scales__prompt_kernel
.p2align 8
.type standalone__kv_cache_quant_int4_int2_kv_with_per_channel_or_per_token_scales__prompt_kernel,@function
standalone__kv_cache_quant_int4_int2_kv_with_per_channel_or_per_token_scales__prompt_kernel:
    s_cmp_ge_u32 s2, 256
    s_cbranch_scc1 L_done
    s_load_dwordx16 s[40:55], s[0:1], 0
    s_load_dwordx4 s[16:19], s[0:1], 64
    s_and_b32 s94, s2, 7
    s_lshr_b32 s95, s2, 3
    s_lshr_b32 s24, s95, 3
    s_lshl_b32 s94, s94, 2
    s_add_u32 s94, s94, s24
    s_and_b32 s95, s95, 7
    s_getpc_b64 s[60:61]
L_pc:
    s_sub_u32 s60, s60, L_pc-standalone__kv_cache_quant_int4_int2_kv_with_per_channel_or_per_token_scales__prompt_kernel
    s_subb_u32 s61, s61, 0
    s_mov_b32 s62, L_slow-standalone__kv_cache_quant_int4_int2_kv_with_per_channel_or_per_token_scales__prompt_kernel
    s_mov_b32 s63, 0x20000
    s_lshr_b32 s22, s2, 3
    s_lshl_b32 s22, s22, 12
    v_lshlrev_b32 v30, 4, v0
    buffer_load_dwordx4 v[128:131], v30, s[60:63], s22 offen
    v_lshrrev_b32 v24, 6, v0
    v_and_b32 v25, 63, v0
    v_readfirstlane_b32 s25, v24
    v_lshlrev_b32 v1, 4, v25
    v_mul_u32_u24 v26, 43, v25
    v_lshrrev_b32 v26, 10, v26
    v_mul_u32_u24 v27, 24, v26
    v_sub_u32 v27, v25, v27
    v_lshrrev_b32 v28, 1, v24
    v_and_b32 v29, 1, v24
    v_lshlrev_b32 v30, 4, v29
    v_lshl_add_u32 v30, v28, 2, v30
    v_add_u32 v30, v30, v26
    v_mul_u32_u24 v30, 768, v30
    v_lshrrev_b32 v48, 1, v26
    v_lshlrev_b32 v48, 30, v48
    v_lshl_add_u32 v30, v27, 4, v30
    v_or_b32 v9, v30, v48
    v_lshl_or_b32 v10, v27, 3, v48
    v_mul_u32_u24 v30, 6144, v24
    v_mul_u32_u24 v31, 12, v25
    v_add_u32 v12, v30, v31
    s_mov_b32 s66, 1572864
    s_mov_b32 s67, 0x20000
    s_mov_b32 s70, 1572864
    s_mov_b32 s71, 0x20000
    s_mov_b32 s74, 12288
    s_mov_b32 s75, 0x20000
    s_mov_b32 s78, 12288
    s_mov_b32 s79, 0x20000
    s_mov_b32 s82, 4096
    s_mov_b32 s83, 0x20000
    s_mov_b32 s86, 4096
    s_mov_b32 s87, 0x20000
    s_mov_b32 s22, 64
    s_mov_b32 s23, 0x20000
    s_mul_i32 s33, s95, 24576
    s_add_u32 s34, s33, 6144
    s_mov_b32 s35, s33
    s_lshr_b32 s36, s95, 1
    s_mul_i32 s36, s36, 384
    s_lshl_b32 s37, s95, 6
    s_lshl_b32 s24, s25, 4
    s_add_u32 s37, s37, s24
    s_mul_i32 s24, s94, 1572864
    s_mul_i32 s56, s94, 12288
    s_lshl_b32 s57, s94, 12
    s_lshl_b32 s58, s94, 10
    s_add_u32 s58, s58, 51380320
    s_or_b32 s39, s95, s25
    s_waitcnt lgkmcnt(0)
    s_add_u32 s64, s42, s24
    s_addc_u32 s65, s43, 0
    s_add_u32 s72, s46, s56
    s_addc_u32 s73, s47, 0
    s_add_u32 s76, s48, s56
    s_addc_u32 s77, s49, 0
    buffer_load_dwordx4 v[224:227], v9, s[64:67], s33 offen offset:0 nt
    buffer_load_dwordx4 v[228:231], v9, s[64:67], s33 offen offset:1536 nt
    buffer_load_dwordx4 v[232:235], v9, s[64:67], s34 offen offset:0 nt
    buffer_load_dwordx4 v[236:239], v9, s[64:67], s34 offen offset:1536 nt
    buffer_load_dwordx2 v[32:33], v10, s[72:75], s36 offen offset:0
    buffer_load_dwordx2 v[34:35], v10, s[76:79], s36 offen offset:0
    buffer_load_dwordx2 v[36:37], v10, s[72:75], s36 offen offset:192
    buffer_load_dwordx2 v[38:39], v10, s[76:79], s36 offen offset:192
    s_add_u32 s20, s18, s58
    s_addc_u32 s21, s19, 0
    s_add_u32 s80, s50, s57
    s_addc_u32 s81, s51, 0
    s_add_u32 s84, s52, s57
    s_addc_u32 s85, s53, 0
    s_add_u32 s68, s44, s24
    s_addc_u32 s69, s45, 0
    s_mul_i32 s59, s94, 786432
    s_add_u32 s12, s54, s59
    s_addc_u32 s13, s55, 0
    s_add_u32 s8, s40, s59
    s_addc_u32 s9, s41, 0
    s_cmp_lg_u32 s39, 0
    s_cbranch_scc1 L_notleader0
    s_buffer_load_dwordx16 s[40:55], s[20:23], 0 glc
L_notleader0:
    buffer_load_dwordx4 v[240:243], v9, s[64:67], s33 offen offset:384 nt
    buffer_load_dwordx4 v[244:247], v9, s[64:67], s33 offen offset:1920 nt
    buffer_load_dwordx4 v[248:251], v9, s[64:67], s34 offen offset:384 nt
    buffer_load_dwordx4 v[252:255], v9, s[64:67], s34 offen offset:1920 nt
    s_add_u32 s4, s18, s24
    s_addc_u32 s5, s19, 0
    s_mov_b32 s6, 1572864
    s_mov_b32 s7, 0x20000
    s_mov_b32 s10, 786432
    s_mov_b32 s11, 0x20000
    s_mov_b32 s88, s16
    s_mov_b32 s89, s17
    s_add_u32 s16, s33, 3072
    s_add_u32 s17, s33, 6144
    s_mov_b32 s90, 256
    s_mov_b32 s91, 0x20000
    s_lshl_b32 s93, s94, 3
    s_cmp_lg_u32 s39, 0
    s_cbranch_scc1 L_notleader
    s_waitcnt lgkmcnt(0)
    s_mov_b32 s59, 1
    s_lshr_b32 s40, s40, 10
    s_min_u32 s40, s40, 31
    s_bitset1_b32 s59, s40
    s_lshr_b32 s41, s41, 10
    s_min_u32 s41, s41, 31
    s_bitset1_b32 s59, s41
    s_lshr_b32 s42, s42, 10
    s_min_u32 s42, s42, 31
    s_bitset1_b32 s59, s42
    s_lshr_b32 s43, s43, 10
    s_min_u32 s43, s43, 31
    s_bitset1_b32 s59, s43
    s_lshr_b32 s44, s44, 10
    s_min_u32 s44, s44, 31
    s_bitset1_b32 s59, s44
    s_lshr_b32 s45, s45, 10
    s_min_u32 s45, s45, 31
    s_bitset1_b32 s59, s45
    s_lshr_b32 s46, s46, 10
    s_min_u32 s46, s46, 31
    s_bitset1_b32 s59, s46
    s_lshr_b32 s47, s47, 10
    s_min_u32 s47, s47, 31
    s_bitset1_b32 s59, s47
    s_lshr_b32 s48, s48, 10
    s_min_u32 s48, s48, 31
    s_bitset1_b32 s59, s48
    s_lshr_b32 s49, s49, 10
    s_min_u32 s49, s49, 31
    s_bitset1_b32 s59, s49
    s_lshr_b32 s50, s50, 10
    s_min_u32 s50, s50, 31
    s_bitset1_b32 s59, s50
    s_lshr_b32 s51, s51, 10
    s_min_u32 s51, s51, 31
    s_bitset1_b32 s59, s51
    s_lshr_b32 s52, s52, 10
    s_min_u32 s52, s52, 31
    s_bitset1_b32 s59, s52
    s_lshr_b32 s53, s53, 10
    s_min_u32 s53, s53, 31
    s_bitset1_b32 s59, s53
    s_lshr_b32 s54, s54, 10
    s_min_u32 s54, s54, 31
    s_bitset1_b32 s59, s54
    s_lshr_b32 s55, s55, 10
    s_min_u32 s55, s55, 31
    s_bitset1_b32 s59, s55
    s_ff0_i32_b32 s59, s59
    s_lshl_b32 s59, s59, 10
    v_mov_b32 v52, s59
    s_mov_b64 exec, 1
    buffer_store_dword v52, off, s[88:91], s93 sc1
    s_mov_b64 exec, -1
L_notleader:
    s_lshl_b32 s24, s95, 2
    s_add_u32 s24, s24, 32
    s_buffer_load_dword s46, s[20:23], s24 glc
    s_getreg_b32 s45, hwreg(HW_REG_XCC_ID, 0, 4)
    s_lshl_b32 s45, s45, 5
    s_mov_b32 s44, 32
    buffer_load_dwordx3 v[112:114], v12, s[68:71], s35 offen offset:0 nt
    buffer_load_dwordx3 v[116:118], v12, s[68:71], s35 offen offset:768 nt
    buffer_load_dwordx3 v[120:122], v12, s[68:71], s35 offen offset:1536 nt
    buffer_load_dwordx3 v[124:126], v12, s[68:71], s35 offen offset:2304 nt
    buffer_load_dwordx2 v[40:41], off, s[80:83], s37 offset:0
    buffer_load_dwordx2 v[42:43], off, s[84:87], s37 offset:0
    buffer_load_dwordx2 v[44:45], off, s[80:83], s37 offset:8
    buffer_load_dwordx2 v[46:47], off, s[84:87], s37 offset:8
    s_mov_b32 s14, 786432
    s_mov_b32 s15, 0x20000
    s_lshl_b32 s24, s25, 8
    s_add_u32 s93, s93, s24
    v_mul_u32_u24 v30, 3072, v24
    v_add_u32 v4, v30, v1
    v_lshl_add_u32 v30, v24, 3, v26
    v_mul_u32_u24 v30, 384, v30
    v_lshlrev_b32 v31, 2, v29
    v_xor_b32 v31, v27, v31
    v_lshl_add_u32 v30, v31, 4, v30
    v_or_b32 v11, v30, v48
    v_lshlrev_b32 v30, 8, v24
    v_add_u32 v30, 12288, v30
    v_lshrrev_b32 v31, 5, v25
    v_mul_u32_u24 v31, 6144, v31
    v_add_u32 v30, v30, v31
    v_and_b32 v31, 1, v25
    v_mul_u32_u24 v31, 3072, v31
    v_add_u32 v30, v30, v31
    v_bfe_u32 v31, v25, 1, 4
    v_lshl_add_u32 v15, v31, 4, v30
    s_lshl_b32 s24, s95, 2
    v_lshl_add_u32 v13, v0, 2, s24
    v_cmp_lt_u32 vcc, 0, v0
    v_mov_b32 v30, 0x40000000
    s_nop 0
    v_cndmask_b32 v13, v13, v30, vcc
    s_mul_i32 s26, s25, 3072
    s_add_u32 s26, s26, 12288
    s_add_u32 s56, s26, 24576
    s_add_u32 s24, s95, 1
    s_and_b32 s24, s24, 7
    s_mul_i32 s32, s24, 24576
    s_add_u32 s27, s32, 12288
    s_mov_b32 s28, 98304
    s_mov_b32 s30, 73728
    v_add_u32 v1, 24576, v1
    s_mov_b32 s38, 0x3dd53b95
    s_mov_b32 s97, 0xffff0000
    s_mov_b32 s96, 100000
    v_and_b32 v26, 15, v25
    v_lshrrev_b32 v27, 4, v25
    v_bfe_u32 v28, v25, 1, 3
    v_xor_b32 v29, v27, v28
    v_mul_u32_u24 v30, 384, v26
    v_lshl_add_u32 v2, v29, 4, v30
    v_xor_b32 v3, 64, v2
    s_mul_i32 s40, s25, 6144
    s_add_u32 s40, s40, 73728
    v_lshrrev_b32 v29, 1, v27
    v_xor_b32 v29, v29, v28
    v_lshl_add_u32 v31, v29, 4, v30
    v_and_b32 v29, 1, v27
    v_lshl_add_u32 v31, v29, 3, v31
    v_xor_b32 v22, 0, v31
    v_add_u32 v22, s40, v22
    v_xor_b32 v23, 32, v31
    v_add_u32 v23, s40, v23
    v_xor_b32 v142, 64, v31
    v_add_u32 v142, s40, v142
    v_xor_b32 v143, 96, v31
    v_add_u32 v143, s40, v143
    s_lshl_b32 s24, s95, 2
    s_add_u32 s24, s24, s25
    s_mul_i32 s24, s24, 24576
    v_add_u32 v26, 0, v25
    v_mul_u32_u24 v27, 2731, v26
    v_lshrrev_b32 v27, 17, v27
    v_and_b32 v27, 7, v27
    v_xor_b32 v26, v26, v27
    v_lshlrev_b32 v136, 4, v26
    v_add_u32 v136, s24, v136
    v_add_u32 v26, 64, v25
    v_mul_u32_u24 v27, 2731, v26
    v_lshrrev_b32 v27, 17, v27
    v_and_b32 v27, 7, v27
    v_xor_b32 v26, v26, v27
    v_lshlrev_b32 v137, 4, v26
    v_add_u32 v137, s24, v137
    v_add_u32 v26, 128, v25
    v_mul_u32_u24 v27, 2731, v26
    v_lshrrev_b32 v27, 17, v27
    v_and_b32 v27, 7, v27
    v_xor_b32 v26, v26, v27
    v_lshlrev_b32 v138, 4, v26
    v_add_u32 v138, s24, v138
    v_add_u32 v26, 192, v25
    v_mul_u32_u24 v27, 2731, v26
    v_lshrrev_b32 v27, 17, v27
    v_and_b32 v27, 7, v27
    v_xor_b32 v26, v26, v27
    v_lshlrev_b32 v139, 4, v26
    v_add_u32 v139, s24, v139
    v_add_u32 v26, 256, v25
    v_mul_u32_u24 v27, 2731, v26
    v_lshrrev_b32 v27, 17, v27
    v_and_b32 v27, 7, v27
    v_xor_b32 v26, v26, v27
    v_lshlrev_b32 v140, 4, v26
    v_add_u32 v140, s24, v140
    v_add_u32 v26, 320, v25
    v_mul_u32_u24 v27, 2731, v26
    v_lshrrev_b32 v27, 17, v27
    v_and_b32 v27, 7, v27
    v_xor_b32 v26, v26, v27
    v_lshlrev_b32 v141, 4, v26
    v_add_u32 v141, s24, v141
    v_mov_b32 v5, 0
    v_mov_b32 v6, 0
    v_mov_b32 v7, 0
    v_mov_b32 v8, 0
    s_mov_b32 s62, -1
    s_mov_b32 s63, 0xffff
    s_waitcnt vmcnt(12)
    buffer_load_dwordx3 v[80:82], v12, s[68:71], s16 offen offset:0 nt
    buffer_load_dwordx3 v[84:86], v12, s[68:71], s16 offen offset:768 nt
    buffer_load_dwordx3 v[88:90], v12, s[68:71], s16 offen offset:1536 nt
    buffer_load_dwordx3 v[92:94], v12, s[68:71], s16 offen offset:2304 nt
    v_lshlrev_b32 v48, 16, v32
    v_and_b32 v49, s97, v32
    v_lshlrev_b32 v50, 16, v34
    v_and_b32 v51, s97, v34
    v_mul_f32 v48, s38, v48
    v_mul_f32 v49, s38, v49
    v_mul_f32_e64 v50, -v50, v48
    v_mul_f32_e64 v51, -v51, v49
    v_cvt_f32_i32 v224, v224
    v_cvt_f32_i32 v225, v225
    v_fma_f32 v224, v224, v48, v50
    v_fma_f32 v225, v225, v49, v51
    v_cvt_pk_bf16_f32 v224, v224, v225
    v_cvt_f32_i32 v228, v228
    v_cvt_f32_i32 v229, v229
    v_fma_f32 v228, v228, v48, v50
    v_fma_f32 v229, v229, v49, v51
    v_cvt_pk_bf16_f32 v228, v228, v229
    v_cvt_f32_i32 v232, v232
    v_cvt_f32_i32 v233, v233
    v_fma_f32 v232, v232, v48, v50
    v_fma_f32 v233, v233, v49, v51
    v_cvt_pk_bf16_f32 v232, v232, v233
    v_cvt_f32_i32 v236, v236
    v_cvt_f32_i32 v237, v237
    v_fma_f32 v236, v236, v48, v50
    v_fma_f32 v237, v237, v49, v51
    v_cvt_pk_bf16_f32 v236, v236, v237
    v_lshlrev_b32 v48, 16, v33
    v_and_b32 v49, s97, v33
    v_lshlrev_b32 v50, 16, v35
    v_and_b32 v51, s97, v35
    v_mul_f32 v48, s38, v48
    v_mul_f32 v49, s38, v49
    v_mul_f32_e64 v50, -v50, v48
    v_mul_f32_e64 v51, -v51, v49
    v_cvt_f32_i32 v226, v226
    v_cvt_f32_i32 v227, v227
    v_fma_f32 v226, v226, v48, v50
    v_fma_f32 v227, v227, v49, v51
    v_cvt_pk_bf16_f32 v225, v226, v227
    v_cvt_f32_i32 v230, v230
    v_cvt_f32_i32 v231, v231
    v_fma_f32 v230, v230, v48, v50
    v_fma_f32 v231, v231, v49, v51
    v_cvt_pk_bf16_f32 v229, v230, v231
    v_cvt_f32_i32 v234, v234
    v_cvt_f32_i32 v235, v235
    v_fma_f32 v234, v234, v48, v50
    v_fma_f32 v235, v235, v49, v51
    v_cvt_pk_bf16_f32 v233, v234, v235
    v_cvt_f32_i32 v238, v238
    v_cvt_f32_i32 v239, v239
    v_fma_f32 v238, v238, v48, v50
    v_fma_f32 v239, v239, v49, v51
    v_cvt_pk_bf16_f32 v237, v238, v239
    s_waitcnt vmcnt(12)
    v_lshlrev_b32 v48, 16, v36
    v_and_b32 v49, s97, v36
    v_lshlrev_b32 v50, 16, v38
    v_and_b32 v51, s97, v38
    v_mul_f32 v48, s38, v48
    v_mul_f32 v49, s38, v49
    v_mul_f32_e64 v50, -v50, v48
    v_mul_f32_e64 v51, -v51, v49
    v_cvt_f32_i32 v240, v240
    v_cvt_f32_i32 v241, v241
    v_fma_f32 v240, v240, v48, v50
    v_fma_f32 v241, v241, v49, v51
    v_cvt_pk_bf16_f32 v226, v240, v241
    v_cvt_f32_i32 v244, v244
    v_cvt_f32_i32 v245, v245
    v_fma_f32 v244, v244, v48, v50
    v_fma_f32 v245, v245, v49, v51
    v_cvt_pk_bf16_f32 v230, v244, v245
    v_cvt_f32_i32 v248, v248
    v_cvt_f32_i32 v249, v249
    v_fma_f32 v248, v248, v48, v50
    v_fma_f32 v249, v249, v49, v51
    v_cvt_pk_bf16_f32 v234, v248, v249
    v_cvt_f32_i32 v252, v252
    v_cvt_f32_i32 v253, v253
    v_fma_f32 v252, v252, v48, v50
    v_fma_f32 v253, v253, v49, v51
    v_cvt_pk_bf16_f32 v238, v252, v253
    v_lshlrev_b32 v48, 16, v37
    v_and_b32 v49, s97, v37
    v_lshlrev_b32 v50, 16, v39
    v_and_b32 v51, s97, v39
    v_mul_f32 v48, s38, v48
    v_mul_f32 v49, s38, v49
    v_mul_f32_e64 v50, -v50, v48
    v_mul_f32_e64 v51, -v51, v49
    v_cvt_f32_i32 v242, v242
    v_cvt_f32_i32 v243, v243
    v_fma_f32 v242, v242, v48, v50
    v_fma_f32 v243, v243, v49, v51
    v_cvt_pk_bf16_f32 v227, v242, v243
    v_cvt_f32_i32 v246, v246
    v_cvt_f32_i32 v247, v247
    v_fma_f32 v246, v246, v48, v50
    v_fma_f32 v247, v247, v49, v51
    v_cvt_pk_bf16_f32 v231, v246, v247
    v_cvt_f32_i32 v250, v250
    v_cvt_f32_i32 v251, v251
    v_fma_f32 v250, v250, v48, v50
    v_fma_f32 v251, v251, v49, v51
    v_cvt_pk_bf16_f32 v235, v250, v251
    v_cvt_f32_i32 v254, v254
    v_cvt_f32_i32 v255, v255
    v_fma_f32 v254, v254, v48, v50
    v_fma_f32 v255, v255, v49, v51
    v_cvt_pk_bf16_f32 v239, v254, v255
    buffer_store_dwordx4 v[224:227], v11, s[4:7], s33 offen offset:0
    s_mov_b64 exec, s[62:63]
    ds_write_b128 v11, v[224:227] offset:0
    s_mov_b64 exec, -1
    v_xor_b32 v55, 16, v11
    buffer_store_dwordx4 v[228:231], v55, s[4:7], s33 offen offset:768
    s_mov_b64 exec, s[62:63]
    ds_write_b128 v55, v[228:231] offset:768
    s_mov_b64 exec, -1
    v_xor_b32 v54, 32, v11
    buffer_store_dwordx4 v[232:235], v54, s[4:7], s33 offen offset:1536
    s_mov_b64 exec, s[62:63]
    ds_write_b128 v54, v[232:235] offset:1536
    s_mov_b64 exec, -1
    v_xor_b32 v55, 48, v11
    buffer_store_dwordx4 v[236:239], v55, s[4:7], s33 offen offset:2304
    s_mov_b64 exec, s[62:63]
    ds_write_b128 v55, v[236:239] offset:2304
    s_mov_b64 exec, -1
    s_mov_b32 s41, 0
    s_add_u32 m0, s40, 24576
    s_nop 0
    buffer_load_dwordx4 v136, s[8:11], s41 offen nt lds
    s_add_u32 m0, s40, 25600
    s_nop 0
    buffer_load_dwordx4 v137, s[8:11], s41 offen nt lds
    s_add_u32 m0, s40, 26624
    s_nop 0
    buffer_load_dwordx4 v138, s[8:11], s41 offen nt lds
    s_add_u32 m0, s40, 27648
    s_nop 0
    buffer_load_dwordx4 v139, s[8:11], s41 offen nt lds
    s_add_u32 m0, s40, 28672
    s_nop 0
    buffer_load_dwordx4 v140, s[8:11], s41 offen nt lds
    s_add_u32 m0, s40, 29696
    s_waitcnt vmcnt(20)
    buffer_load_dwordx4 v141, s[8:11], s41 offen nt lds
    s_waitcnt vmcnt(14)
    v_lshlrev_b32 v48, 16, v40
    v_and_b32 v49, s97, v40
    v_lshlrev_b32 v50, 16, v42
    v_and_b32 v51, s97, v42
    v_mul_f32_e64 v50, -v50, v48
    v_mul_f32_e64 v51, -v51, v49
    v_cvt_f32_i32 v112, v112
    v_cvt_f32_i32 v116, v116
    v_fma_f32 v112, v112, v48, v50
    v_fma_f32 v116, v116, v49, v51
    v_cvt_f32_i32 v113, v113
    v_cvt_f32_i32 v117, v117
    v_fma_f32 v113, v113, v48, v50
    v_fma_f32 v117, v117, v49, v51
    v_cvt_f32_i32 v114, v114
    v_cvt_f32_i32 v118, v118
    v_fma_f32 v114, v114, v48, v50
    v_fma_f32 v118, v118, v49, v51
    v_lshlrev_b32 v48, 16, v41
    v_and_b32 v49, s97, v41
    v_lshlrev_b32 v50, 16, v43
    v_and_b32 v51, s97, v43
    v_mul_f32_e64 v50, -v50, v48
    v_mul_f32_e64 v51, -v51, v49
    v_cvt_f32_i32 v120, v120
    v_cvt_f32_i32 v124, v124
    v_fma_f32 v120, v120, v48, v50
    v_fma_f32 v124, v124, v49, v51
    v_cvt_f32_i32 v121, v121
    v_cvt_f32_i32 v125, v125
    v_fma_f32 v121, v121, v48, v50
    v_fma_f32 v125, v125, v49, v51
    v_cvt_f32_i32 v122, v122
    v_cvt_f32_i32 v126, v126
    v_fma_f32 v122, v122, v48, v50
    v_fma_f32 v126, v126, v49, v51
    v_cvt_pk_bf16_f32 v112, v112, v116
    v_cvt_pk_bf16_f32 v116, v113, v117
    v_cvt_pk_bf16_f32 v113, v120, v124
    v_cvt_pk_bf16_f32 v117, v121, v125
    v_cvt_pk_bf16_f32 v120, v114, v118
    v_cvt_pk_bf16_f32 v121, v122, v126
    s_waitcnt vmcnt(10)
    v_lshlrev_b32 v48, 16, v44
    v_and_b32 v49, s97, v44
    v_lshlrev_b32 v50, 16, v46
    v_and_b32 v51, s97, v46
    v_mul_f32_e64 v50, -v50, v48
    v_mul_f32_e64 v51, -v51, v49
    v_cvt_f32_i32 v80, v80
    v_cvt_f32_i32 v84, v84
    v_fma_f32 v80, v80, v48, v50
    v_fma_f32 v84, v84, v49, v51
    v_cvt_f32_i32 v81, v81
    v_cvt_f32_i32 v85, v85
    v_fma_f32 v81, v81, v48, v50
    v_fma_f32 v85, v85, v49, v51
    v_cvt_f32_i32 v82, v82
    v_cvt_f32_i32 v86, v86
    v_fma_f32 v82, v82, v48, v50
    v_fma_f32 v86, v86, v49, v51
    v_lshlrev_b32 v48, 16, v45
    v_and_b32 v49, s97, v45
    v_lshlrev_b32 v50, 16, v47
    v_and_b32 v51, s97, v47
    v_mul_f32_e64 v50, -v50, v48
    v_mul_f32_e64 v51, -v51, v49
    v_cvt_f32_i32 v88, v88
    v_cvt_f32_i32 v92, v92
    v_fma_f32 v88, v88, v48, v50
    v_fma_f32 v92, v92, v49, v51
    v_cvt_f32_i32 v89, v89
    v_cvt_f32_i32 v93, v93
    v_fma_f32 v89, v89, v48, v50
    v_fma_f32 v93, v93, v49, v51
    v_cvt_f32_i32 v90, v90
    v_cvt_f32_i32 v94, v94
    v_fma_f32 v90, v90, v48, v50
    v_fma_f32 v94, v94, v49, v51
    v_cvt_pk_bf16_f32 v114, v80, v84
    v_cvt_pk_bf16_f32 v118, v81, v85
    v_cvt_pk_bf16_f32 v115, v88, v92
    v_cvt_pk_bf16_f32 v119, v89, v93
    v_cvt_pk_bf16_f32 v122, v82, v86
    v_cvt_pk_bf16_f32 v123, v90, v94
    buffer_store_dwordx4 v[112:115], v15, s[4:7], s35 offen offset:0
    buffer_store_dwordx4 v[116:119], v15, s[4:7], s35 offen offset:1024
    buffer_store_dwordx4 v[120:123], v15, s[4:7], s35 offen offset:2048
    ds_write_b128 v15, v[112:115] offset:12288
    ds_write_b128 v15, v[116:119] offset:13312
    ds_write_b128 v15, v[120:123] offset:14336
    buffer_load_dword v0, off, s[88:91], s93 sc1
    s_mov_b32 s41, 6144
    s_add_u32 m0, s40, 0
    s_nop 0
    buffer_load_dwordx4 v136, s[8:11], s41 offen nt lds
    s_add_u32 m0, s40, 1024
    s_nop 0
    buffer_load_dwordx4 v137, s[8:11], s41 offen nt lds
    s_add_u32 m0, s40, 2048
    s_nop 0
    buffer_load_dwordx4 v138, s[8:11], s41 offen nt lds
    s_add_u32 m0, s40, 3072
    s_nop 0
    buffer_load_dwordx4 v139, s[8:11], s41 offen nt lds
    s_add_u32 m0, s40, 4096
    s_nop 0
    buffer_load_dwordx4 v140, s[8:11], s41 offen nt lds
    s_add_u32 m0, s40, 5120
    s_waitcnt vmcnt(14)
    buffer_load_dwordx4 v141, s[8:11], s41 offen nt lds
    s_mov_b64 exec, 0
    s_cmp_eq_u32 s25, 0
    s_cbranch_scc1 L_iw0
    s_cmp_eq_u32 s25, 1
    s_cbranch_scc1 L_iw1
    s_cmp_eq_u32 s25, 2
    s_cbranch_scc1 L_iw2
    s_branch L_iw3
L_iwret:
    s_mov_b64 exec, -1
    s_waitcnt vmcnt(6)
    s_cmp_lg_u32 s25, 0
    s_cbranch_scc1 L_tagdone
    v_readfirstlane_b32 s42, v0
    s_mov_b32 s39, 100
    s_waitcnt lgkmcnt(0)
    s_and_b32 s46, s46, 0xfffffc00
L_tagretry:
    s_cmp_eq_u32 s42, s46
    s_cselect_b32 s42, 0, s42
    s_cmp_lg_u32 s42, 0
    s_cbranch_scc1 L_tagok
    s_sub_u32 s39, s39, 1
    s_cbranch_scc1 L_tagslow
    s_sleep 4
    s_buffer_load_dword s42, s[88:91], s93 glc
    s_waitcnt lgkmcnt(0)
    s_branch L_tagretry
L_tagok:
    s_add_u32 s42, s42, s45
    v_mov_b32 v0, s42
    v_mov_b32 v16, 147456
    ds_write_b32 v16, v0
L_tagdone:
    s_waitcnt lgkmcnt(0)
    s_barrier
    v_add_u32 v0, 1, v0
    buffer_store_dword v0, v13, s[20:23], 0 offen offset:32 sc1
    v_mov_b32 v16, 147456
    ds_read_b32 v17, v16
    s_mov_b32 s88, s60
    s_mov_b32 s89, s61
    s_mov_b32 s90, L_slow-standalone__kv_cache_quant_int4_int2_kv_with_per_channel_or_per_token_scales__prompt_kernel
    s_lshr_b32 s24, s2, 3
    s_mul_i32 s93, s24, 43
    s_lshr_b32 s93, s93, 7
    s_mul_i32 s39, s93, 3
    s_sub_u32 s24, s24, s39
    s_lshl_b32 s24, s24, 10
    s_mul_i32 s93, s93, 12288
    s_add_u32 s93, s93, s24
    ds_read_b128 v[144:147], v2 offset:0
    ds_read_b128 v[148:151], v3 offset:0
    ds_read_b128 v[152:155], v2 offset:6144
    ds_read_b128 v[156:159], v3 offset:6144
    ds_read_b128 v[160:163], v2 offset:128
    ds_read_b128 v[164:167], v3 offset:128
    ds_read_b128 v[168:171], v2 offset:6272
    ds_read_b128 v[172:175], v3 offset:6272
    ds_read_b128 v[176:179], v2 offset:256
    ds_read_b128 v[180:183], v3 offset:256
    ds_read_b128 v[184:187], v2 offset:6400
    ds_read_b128 v[188:191], v3 offset:6400
    s_waitcnt vmcnt(11)
    ds_read_b64 a[192:193], v22 offset:24576
    ds_read_b64 a[194:195], v142 offset:24704
    ds_read_b64 a[196:197], v23 offset:24576
    ds_read_b64 a[198:199], v143 offset:24704
    ds_read_b64 a[200:201], v142 offset:24576
    ds_read_b64 a[202:203], v22 offset:24832
    ds_read_b64 a[204:205], v143 offset:24576
    ds_read_b64 a[206:207], v23 offset:24832
    ds_read_b64 a[208:209], v22 offset:24704
    ds_read_b64 a[210:211], v142 offset:24832
    ds_read_b64 a[212:213], v23 offset:24704
    ds_read_b64 a[214:215], v143 offset:24832
    s_waitcnt lgkmcnt(15)
    v_readfirstlane_b32 s92, v17
    s_add_u32 s92, s92, 1
    s_mov_b32 s41, 12288
    s_add_u32 m0, s40, 49152
    s_nop 0
    buffer_load_dwordx4 v136, s[8:11], s41 offen nt lds
    s_add_u32 m0, s40, 50176
    s_nop 0
    buffer_load_dwordx4 v137, s[8:11], s41 offen nt lds
    s_add_u32 m0, s40, 51200
    s_nop 0
    buffer_load_dwordx4 v138, s[8:11], s41 offen nt lds
    s_waitcnt lgkmcnt(0)
    v_mfma_f32_16x16x32_bf16 v[64:67], v[144:147], a[192:195], 0
    v_mfma_f32_16x16x32_bf16 v[64:67], v[148:151], a[196:199], v[64:67]
    v_mfma_f32_16x16x32_bf16 v[64:67], v[160:163], a[200:203], v[64:67]
    v_mfma_f32_16x16x32_bf16 v[64:67], v[164:167], a[204:207], v[64:67]
    v_mfma_f32_16x16x32_bf16 v[64:67], v[176:179], a[208:211], v[64:67]
    v_mfma_f32_16x16x32_bf16 v[64:67], v[180:183], a[212:215], v[64:67]
    v_mfma_f32_16x16x32_bf16 v[96:99], v[152:155], a[192:195], 0
    v_mfma_f32_16x16x32_bf16 v[96:99], v[156:159], a[196:199], v[96:99]
    v_mfma_f32_16x16x32_bf16 v[96:99], v[168:171], a[200:203], v[96:99]
    v_mfma_f32_16x16x32_bf16 v[96:99], v[172:175], a[204:207], v[96:99]
    v_mfma_f32_16x16x32_bf16 v[96:99], v[184:187], a[208:211], v[96:99]
    v_mfma_f32_16x16x32_bf16 v[96:99], v[188:191], a[212:215], v[96:99]
    s_nop 7
    v_max3_f32 v48, v64, v65, v66
    v_max3_f32 v50, v67, v96, v97
    v_max3_f32 v48, v48, v98, v99
    v_max_f32 v48, v48, v50
    v_mov_b32 v49, v48
    s_nop 1
    v_permlane16_swap_b32 v48, v49
    s_nop 1
    v_max_f32 v48, v48, v49
    v_mov_b32 v49, v48
    s_nop 1
    v_permlane32_swap_b32 v48, v49
    s_nop 1
    v_max_f32 v48, v48, v49
    v_sub_f32 v64, v64, v48
    v_sub_f32 v65, v65, v48
    v_sub_f32 v66, v66, v48
    v_sub_f32 v67, v67, v48
    v_sub_f32 v96, v96, v48
    v_sub_f32 v97, v97, v48
    v_sub_f32 v98, v98, v48
    v_sub_f32 v99, v99, v48
    v_exp_f32 v64, v64
    v_exp_f32 v65, v65
    v_exp_f32 v66, v66
    v_exp_f32 v67, v67
    v_exp_f32 v96, v96
    v_exp_f32 v97, v97
    v_exp_f32 v98, v98
    v_exp_f32 v99, v99
    v_sub_f32 v128, 0, v48
    v_sub_f32 v129, 0, v48
    v_sub_f32 v130, 0, v48
    v_sub_f32 v131, 0, v48
    v_add_f32 v5, v5, v64
    v_add_f32 v5, v5, v65
    v_add_f32 v5, v5, v66
    v_add_f32 v5, v5, v67
    v_add_f32 v5, v5, v96
    v_add_f32 v5, v5, v97
    v_add_f32 v5, v5, v98
    v_add_f32 v5, v5, v99
    v_cvt_pk_bf16_f32 v64, v64, v65
    v_cvt_pk_bf16_f32 v65, v66, v67
    v_cvt_pk_bf16_f32 v66, v96, v97
    v_cvt_pk_bf16_f32 v67, v98, v99
L_iw0:
L_pg0:
    s_cbranch_execz L_pg4
    s_waitcnt vmcnt(4)
    ds_read_b64 a[216:217], v22 offset:0
    ds_read_b64 a[218:219], v142 offset:128
    ds_read_b64 a[220:221], v23 offset:0
    ds_read_b64 a[222:223], v143 offset:128
    ds_read_b64 a[224:225], v142 offset:0
    ds_read_b64 a[226:227], v22 offset:256
    ds_read_b64 a[228:229], v143 offset:0
    ds_read_b64 a[230:231], v23 offset:256
    ds_read_b64 a[232:233], v22 offset:128
    ds_read_b64 a[234:235], v142 offset:256
    ds_read_b64 a[236:237], v23 offset:128
    ds_read_b64 a[238:239], v143 offset:256
    s_mov_b32 s41, 12288
    s_add_u32 m0, s40, 52224
    s_nop 0
    buffer_load_dwordx4 v139, s[8:11], s41 offen nt lds
    s_add_u32 m0, s40, 53248
    s_nop 0
    buffer_load_dwordx4 v140, s[8:11], s41 offen nt lds
    s_add_u32 m0, s40, 54272
    s_nop 0
    buffer_load_dwordx4 v141, s[8:11], s41 offen nt lds
    s_waitcnt lgkmcnt(0)
    v_mfma_f32_16x16x32_bf16 v[68:71], v[144:147], a[216:219], 0
    v_mfma_f32_16x16x32_bf16 v[68:71], v[148:151], a[220:223], v[68:71]
    v_mfma_f32_16x16x32_bf16 v[68:71], v[160:163], a[224:227], v[68:71]
    v_mfma_f32_16x16x32_bf16 v[68:71], v[164:167], a[228:231], v[68:71]
    v_mfma_f32_16x16x32_bf16 v[68:71], v[176:179], a[232:235], v[68:71]
    v_mfma_f32_16x16x32_bf16 v[68:71], v[180:183], a[236:239], v[68:71]
    v_mfma_f32_16x16x32_bf16 v[100:103], v[152:155], a[216:219], 0
    v_mfma_f32_16x16x32_bf16 v[100:103], v[156:159], a[220:223], v[100:103]
    v_mfma_f32_16x16x32_bf16 v[100:103], v[168:171], a[224:227], v[100:103]
    v_mfma_f32_16x16x32_bf16 v[100:103], v[172:175], a[228:231], v[100:103]
    v_mfma_f32_16x16x32_bf16 v[100:103], v[184:187], a[232:235], v[100:103]
    v_mfma_f32_16x16x32_bf16 v[100:103], v[188:191], a[236:239], v[100:103]
    s_nop 7
    ds_read_b128 v[24:27], v1 offset:0
    ds_read_b128 v[28:31], v1 offset:1024
    ds_read_b128 v[32:35], v1 offset:2048
    ds_read_b128 v[36:39], v1 offset:3072
    s_mov_b32 s41, 18432
    s_add_u32 m0, s40, 24576
    s_nop 0
    buffer_load_dwordx4 v136, s[8:11], s41 offen nt lds
    v_max3_f32 v48, v68, v69, v70
    v_max3_f32 v50, v71, v100, v101
    v_max3_f32 v48, v48, v102, v103
    v_max_f32 v48, v48, v50
    v_mov_b32 v49, v48
    s_nop 1
    v_permlane16_swap_b32 v48, v49
    s_nop 1
    v_max_f32 v48, v48, v49
    v_mov_b32 v49, v48
    s_nop 1
    v_permlane32_swap_b32 v48, v49
    s_nop 1
    v_max_f32 v48, v48, v49
    v_sub_f32 v68, v68, v48
    v_sub_f32 v69, v69, v48
    s_add_u32 m0, s40, 25600
    s_nop 0
    buffer_load_dwordx4 v137, s[8:11], s41 offen nt lds
    v_sub_f32 v70, v70, v48
    v_sub_f32 v71, v71, v48
    v_sub_f32 v100, v100, v48
    v_sub_f32 v101, v101, v48
    v_sub_f32 v102, v102, v48
    v_sub_f32 v103, v103, v48
    v_exp_f32 v68, v68
    v_exp_f32 v69, v69
    v_exp_f32 v70, v70
    v_exp_f32 v71, v71
    v_exp_f32 v100, v100
    v_exp_f32 v101, v101
    v_exp_f32 v102, v102
    v_exp_f32 v103, v103
    v_sub_f32 v132, 0, v48
    s_add_u32 m0, s40, 26624
    s_nop 0
    buffer_load_dwordx4 v138, s[8:11], s41 offen nt lds
    v_sub_f32 v133, 0, v48
    v_sub_f32 v134, 0, v48
    v_sub_f32 v135, 0, v48
    v_add_f32 v6, v6, v68
    v_add_f32 v6, v6, v69
    v_add_f32 v6, v6, v70
    v_add_f32 v6, v6, v71
    v_add_f32 v6, v6, v100
    v_add_f32 v6, v6, v101
    v_add_f32 v6, v6, v102
    v_add_f32 v6, v6, v103
    v_cvt_pk_bf16_f32 v68, v68, v69
    v_cvt_pk_bf16_f32 v69, v70, v71
    v_cvt_pk_bf16_f32 v70, v100, v101
    v_cvt_pk_bf16_f32 v71, v102, v103
    s_buffer_load_dwordx8 s[48:55], s[20:23], s44 glc
    s_waitcnt lgkmcnt(2)
    v_mfma_f32_16x16x32_bf16 a[0:3], v[64:67], v[24:27], 0
    ds_read_b128 v[40:43], v1 offset:4096
    v_mfma_f32_16x16x32_bf16 a[4:7], v[64:67], v[28:31], 0
    v_mfma_f32_16x16x32_bf16 a[48:51], v[68:71], v[24:27], 0
    ds_read_b128 v[44:47], v1 offset:5120
    v_mfma_f32_16x16x32_bf16 a[52:55], v[68:71], v[28:31], 0
    s_waitcnt lgkmcnt(2)
    v_mfma_f32_16x16x32_bf16 a[8:11], v[64:67], v[32:35], 0
    ds_read_b128 v[24:27], v1 offset:6144
    v_mfma_f32_16x16x32_bf16 a[12:15], v[64:67], v[36:39], 0
    v_mfma_f32_16x16x32_bf16 a[56:59], v[68:71], v[32:35], 0
    ds_read_b128 v[28:31], v1 offset:7168
    v_mfma_f32_16x16x32_bf16 a[60:63], v[68:71], v[36:39], 0
    s_waitcnt lgkmcnt(2)
    v_mfma_f32_16x16x32_bf16 a[16:19], v[64:67], v[40:43], 0
    ds_read_b128 v[32:35], v1 offset:8192
    v_mfma_f32_16x16x32_bf16 a[20:23], v[64:67], v[44:47], 0
    v_mfma_f32_16x16x32_bf16 a[64:67], v[68:71], v[40:43], 0
    ds_read_b128 v[36:39], v1 offset:9216
    v_mfma_f32_16x16x32_bf16 a[68:71], v[68:71], v[44:47], 0
    s_waitcnt lgkmcnt(2)
    v_mfma_f32_16x16x32_bf16 a[24:27], v[64:67], v[24:27], 0
    ds_read_b128 v[40:43], v1 offset:10240
    v_mfma_f32_16x16x32_bf16 a[28:31], v[64:67], v[28:31], 0
    v_mfma_f32_16x16x32_bf16 a[72:75], v[68:71], v[24:27], 0
    ds_read_b128 v[44:47], v1 offset:11264
    v_mfma_f32_16x16x32_bf16 a[76:79], v[68:71], v[28:31], 0
    s_waitcnt lgkmcnt(2)
    v_mfma_f32_16x16x32_bf16 a[32:35], v[64:67], v[32:35], 0
    v_mfma_f32_16x16x32_bf16 a[36:39], v[64:67], v[36:39], 0
    v_mfma_f32_16x16x32_bf16 a[80:83], v[68:71], v[32:35], 0
    v_mfma_f32_16x16x32_bf16 a[84:87], v[68:71], v[36:39], 0
    s_waitcnt lgkmcnt(0)
    v_mfma_f32_16x16x32_bf16 a[40:43], v[64:67], v[40:43], 0
    v_mfma_f32_16x16x32_bf16 a[44:47], v[64:67], v[44:47], 0
    v_mfma_f32_16x16x32_bf16 a[88:91], v[68:71], v[40:43], 0
    v_mfma_f32_16x16x32_bf16 a[92:95], v[68:71], v[44:47], 0
    s_waitcnt lgkmcnt(0)
    s_sub_u32 s48, s48, s92
    s_sub_u32 s49, s49, s92
    s_sub_u32 s50, s50, s92
    s_sub_u32 s51, s51, s92
    s_sub_u32 s52, s52, s92
    s_sub_u32 s53, s53, s92
    s_sub_u32 s54, s54, s92
    s_sub_u32 s55, s55, s92
    s_max_u32 s48, s48, s49
    s_max_u32 s48, s48, s50
    s_max_u32 s48, s48, s51
    s_max_u32 s48, s48, s52
    s_max_u32 s48, s48, s53
    s_max_u32 s48, s48, s54
    s_max_u32 s48, s48, s55
    s_cmp_ge_u32 s48, 16
    s_cbranch_scc1 L_pollslow0
L_pollok0:
    s_add_u32 s92, s92, 1
    s_mov_b32 m0, s26
    s_nop 0
    buffer_load_dwordx4 v4, s[4:7], s32 offen offset:0 sc1 lds
    buffer_load_dwordx4 v4, s[4:7], s32 offen offset:1024 sc1 lds
    buffer_load_dwordx4 v4, s[4:7], s32 offen offset:2048 sc1 lds
    s_add_u32 s32, s32, 24576
    s_sub_u32 s57, s32, 196608
    s_min_u32 s32, s32, s57
    s_add_u32 s26, s26, 36864
    s_sub_u32 s57, s26, 147456
    s_min_u32 s26, s26, s57
    s_mov_b32 m0, s26
    s_waitcnt vmcnt(11)
    buffer_load_dwordx4 v4, s[4:7], s32 offen offset:0 sc1 lds
    s_waitcnt vmcnt(11)
    buffer_load_dwordx4 v4, s[4:7], s32 offen offset:1024 sc1 lds
    s_waitcnt vmcnt(11)
    buffer_load_dwordx4 v4, s[4:7], s32 offen offset:2048 sc1 lds
    s_add_u32 s32, s32, 24576
    s_sub_u32 s57, s32, 196608
    s_min_u32 s32, s32, s57
    s_add_u32 s26, s26, 12288
    s_mov_b32 m0, s26
    s_waitcnt vmcnt(11)
    buffer_load_dwordx4 v4, s[4:7], s32 offen offset:0 sc1 lds
    s_waitcnt vmcnt(11)
    buffer_load_dwordx4 v4, s[4:7], s32 offen offset:1024 sc1 lds
    s_waitcnt vmcnt(11)
    buffer_load_dwordx4 v4, s[4:7], s32 offen offset:2048 sc1 lds
    s_add_u32 s32, s32, 24576
    s_sub_u32 s57, s32, 196608
    s_min_u32 s32, s32, s57
    s_add_u32 s26, s26, 36864
    s_sub_u32 s57, s26, 147456
    s_min_u32 s26, s26, s57
    s_mov_b32 m0, s56
    s_waitcnt vmcnt(11)
    buffer_load_dwordx4 v4, s[4:7], s27 offen offset:0 sc1 lds
    s_waitcnt vmcnt(11)
    buffer_load_dwordx4 v4, s[4:7], s27 offen offset:1024 sc1 lds
    s_waitcnt vmcnt(11)
    buffer_load_dwordx4 v4, s[4:7], s27 offen offset:2048 sc1 lds
    s_add_u32 s27, s27, 24576
    s_sub_u32 s58, s27, 196608
    s_min_u32 s27, s27, s58
    s_add_u32 s56, s56, 36864
    s_sub_u32 s58, s56, 147456
    s_min_u32 s56, s56, s58
    s_add_u32 s33, s33, 196608
    s_add_u32 s34, s34, 196608
    s_add_u32 s36, s36, 1536
    s_add_u32 s35, s35, 196608
    s_add_u32 s16, s16, 196608
    s_add_u32 s17, s17, 196608
    s_add_u32 s37, s37, 512
    s_waitcnt vmcnt(9)
    s_barrier
    ds_read_b128 v[24:27], v2 offset:12288
    ds_read_b128 v[28:31], v3 offset:12288
    ds_read_b128 v[32:35], v2 offset:18432
    ds_read_b128 v[36:39], v3 offset:18432
    s_waitcnt lgkmcnt(2)
    v_mfma_f32_16x16x32_bf16 v[72:75], v[24:27], a[192:195], v[128:131]
    s_mov_b32 m0, s56
    ds_read_b128 v[40:43], v2 offset:12416
    v_mfma_f32_16x16x32_bf16 v[72:75], v[28:31], a[196:199], v[72:75]
    buffer_load_dwordx4 v4, s[4:7], s27 offen offset:0 sc1 lds
    v_mfma_f32_16x16x32_bf16 v[76:79], v[24:27], a[216:219], v[132:135]
    ds_read_b128 v[44:47], v3 offset:12416
    v_mfma_f32_16x16x32_bf16 v[76:79], v[28:31], a[220:223], v[76:79]
    s_waitcnt lgkmcnt(2)
    buffer_load_dwordx4 v4, s[4:7], s27 offen offset:1024 sc1 lds
    v_mfma_f32_16x16x32_bf16 v[104:107], v[32:35], a[192:195], v[128:131]
    ds_read_b128 v[24:27], v2 offset:18560
    v_mfma_f32_16x16x32_bf16 v[104:107], v[36:39], a[196:199], v[104:107]
    buffer_load_dwordx4 v4, s[4:7], s27 offen offset:2048 sc1 lds
    v_mfma_f32_16x16x32_bf16 v[108:111], v[32:35], a[216:219], v[132:135]
    s_add_u32 s27, s27, 24576
    ds_read_b128 v[28:31], v3 offset:18560
    v_mfma_f32_16x16x32_bf16 v[108:111], v[36:39], a[220:223], v[108:111]
    s_waitcnt lgkmcnt(2)
    s_sub_u32 s58, s27, 196608
    v_mfma_f32_16x16x32_bf16 v[72:75], v[40:43], a[200:203], v[72:75]
    ds_read_b128 v[32:35], v2 offset:12544
    v_mfma_f32_16x16x32_bf16 v[72:75], v[44:47], a[204:207], v[72:75]
    s_min_u32 s27, s27, s58
    v_mfma_f32_16x16x32_bf16 v[76:79], v[40:43], a[224:227], v[76:79]
    s_add_u32 s56, s56, 12288
    ds_read_b128 v[36:39], v3 offset:12544
    v_mfma_f32_16x16x32_bf16 v[76:79], v[44:47], a[228:231], v[76:79]
    s_waitcnt lgkmcnt(2)
    s_mov_b32 m0, s56
    v_mfma_f32_16x16x32_bf16 v[104:107], v[24:27], a[200:203], v[104:107]
    ds_read_b128 v[40:43], v2 offset:18688
    v_mfma_f32_16x16x32_bf16 v[104:107], v[28:31], a[204:207], v[104:107]
    s_waitcnt vmcnt(6)
    buffer_load_dwordx4 v4, s[4:7], s27 offen offset:0 sc1 lds
    v_mfma_f32_16x16x32_bf16 v[108:111], v[24:27], a[224:227], v[108:111]
    ds_read_b128 v[44:47], v3 offset:18688
    v_mfma_f32_16x16x32_bf16 v[108:111], v[28:31], a[228:231], v[108:111]
    s_waitcnt lgkmcnt(2)
    s_barrier
    v_add_u32 v2, 49152, v2
    v_add_u32 v3, 49152, v3
    v_mfma_f32_16x16x32_bf16 v[72:75], v[32:35], a[208:211], v[72:75]
    ds_read_b128 v[24:27], v2 offset:0
    v_mfma_f32_16x16x32_bf16 v[72:75], v[36:39], a[212:215], v[72:75]
    buffer_load_dwordx4 v4, s[4:7], s27 offen offset:1024 sc1 lds
    v_mfma_f32_16x16x32_bf16 v[76:79], v[32:35], a[232:235], v[76:79]
    ds_read_b128 v[28:31], v3 offset:0
    v_mfma_f32_16x16x32_bf16 v[76:79], v[36:39], a[236:239], v[76:79]
    s_waitcnt lgkmcnt(2)
    buffer_load_dwordx4 v4, s[4:7], s27 offen offset:2048 sc1 lds
    v_mfma_f32_16x16x32_bf16 v[104:107], v[40:43], a[208:211], v[104:107]
    ds_read_b128 v[32:35], v2 offset:6144
    v_mfma_f32_16x16x32_bf16 v[104:107], v[44:47], a[212:215], v[104:107]
    v_mfma_f32_16x16x32_bf16 v[108:111], v[40:43], a[232:235], v[108:111]
    s_add_u32 s27, s27, 24576
    ds_read_b128 v[36:39], v3 offset:6144
    s_sub_u32 s58, s27, 196608
    v_mfma_f32_16x16x32_bf16 v[108:111], v[44:47], a[236:239], v[108:111]
    s_waitcnt lgkmcnt(2)
    s_min_u32 s27, s27, s58
    s_add_u32 s56, s56, 36864
    s_sub_u32 s58, s56, 147456
    s_min_u32 s56, s56, s58
    v_mfma_f32_16x16x32_bf16 v[80:83], v[24:27], a[192:195], v[128:131]
    s_mov_b32 s41, 18432
    ds_read_b128 v[40:43], v2 offset:128
    s_add_u32 m0, s40, 27648
    v_mfma_f32_16x16x32_bf16 v[80:83], v[28:31], a[196:199], v[80:83]
    buffer_load_dwordx4 v139, s[8:11], s41 offen nt lds
    v_mfma_f32_16x16x32_bf16 v[84:87], v[24:27], a[216:219], v[132:135]
    s_add_u32 m0, s40, 28672
    ds_read_b128 v[44:47], v3 offset:128
    v_mfma_f32_16x16x32_bf16 v[84:87], v[28:31], a[220:223], v[84:87]
    s_waitcnt lgkmcnt(2)
    buffer_load_dwordx4 v140, s[8:11], s41 offen nt lds
    s_add_u32 m0, s40, 29696
    v_mfma_f32_16x16x32_bf16 v[112:115], v[32:35], a[192:195], v[128:131]
    ds_read_b128 v[24:27], v2 offset:6272
    v_mfma_f32_16x16x32_bf16 v[112:115], v[36:39], a[196:199], v[112:115]
    buffer_load_dwordx4 v141, s[8:11], s41 offen nt lds
    v_mfma_f32_16x16x32_bf16 v[116:119], v[32:35], a[216:219], v[132:135]
    ds_read_b128 v[28:31], v3 offset:6272
    v_mfma_f32_16x16x32_bf16 v[116:119], v[36:39], a[220:223], v[116:119]
    s_waitcnt lgkmcnt(2)
    v_exp_f32 v16, v72
    v_mfma_f32_16x16x32_bf16 v[80:83], v[40:43], a[200:203], v[80:83]
    ds_read_b128 v[32:35], v2 offset:256
    v_mfma_f32_16x16x32_bf16 v[80:83], v[44:47], a[204:207], v[80:83]
    v_exp_f32 v17, v73
    v_exp_f32 v18, v74
    v_mfma_f32_16x16x32_bf16 v[84:87], v[40:43], a[224:227], v[84:87]
    ds_read_b128 v[36:39], v3 offset:256
    v_add_f32 v5, v5, v16
    v_mfma_f32_16x16x32_bf16 v[84:87], v[44:47], a[228:231], v[84:87]
    s_waitcnt lgkmcnt(2)
    v_add_f32 v5, v5, v17
    v_exp_f32 v19, v75
    v_mfma_f32_16x16x32_bf16 v[112:115], v[24:27], a[200:203], v[112:115]
    ds_read_b128 v[40:43], v2 offset:6400
    v_cvt_pk_bf16_f32 v72, v16, v17
    v_mfma_f32_16x16x32_bf16 v[112:115], v[28:31], a[204:207], v[112:115]
    v_exp_f32 v16, v104
    v_mfma_f32_16x16x32_bf16 v[116:119], v[24:27], a[224:227], v[116:119]
    ds_read_b128 v[44:47], v3 offset:6400
    v_add_f32 v5, v5, v18
    v_mfma_f32_16x16x32_bf16 v[116:119], v[28:31], a[228:231], v[116:119]
    s_waitcnt lgkmcnt(2)
    v_add_f32 v5, v5, v19
    v_exp_f32 v17, v105
    v_mfma_f32_16x16x32_bf16 v[80:83], v[32:35], a[208:211], v[80:83]
    ds_read_b128 v[24:27], v2 offset:12288
    v_cvt_pk_bf16_f32 v73, v18, v19
    v_mfma_f32_16x16x32_bf16 v[80:83], v[36:39], a[212:215], v[80:83]
    v_exp_f32 v18, v106
    v_mfma_f32_16x16x32_bf16 v[84:87], v[32:35], a[232:235], v[84:87]
    ds_read_b128 v[28:31], v3 offset:12288
    v_add_f32 v5, v5, v16
    v_mfma_f32_16x16x32_bf16 v[84:87], v[36:39], a[236:239], v[84:87]
    s_waitcnt lgkmcnt(2)
    v_add_f32 v5, v5, v17
    v_exp_f32 v19, v107
    v_mfma_f32_16x16x32_bf16 v[112:115], v[40:43], a[208:211], v[112:115]
    ds_read_b128 v[32:35], v2 offset:18432
    v_cvt_pk_bf16_f32 v74, v16, v17
    v_mfma_f32_16x16x32_bf16 v[112:115], v[44:47], a[212:215], v[112:115]
    v_exp_f32 v16, v76
    v_add_f32 v5, v5, v18
    v_mfma_f32_16x16x32_bf16 v[116:119], v[40:43], a[232:235], v[116:119]
    ds_read_b128 v[36:39], v3 offset:18432
    v_add_f32 v5, v5, v19
    v_mfma_f32_16x16x32_bf16 v[116:119], v[44:47], a[236:239], v[116:119]
    s_waitcnt lgkmcnt(2)
    v_exp_f32 v17, v77
    v_mfma_f32_16x16x32_bf16 v[88:91], v[24:27], a[192:195], v[128:131]
    ds_read_b128 v[40:43], v2 offset:12416
    v_cvt_pk_bf16_f32 v75, v18, v19
    v_mfma_f32_16x16x32_bf16 v[88:91], v[28:31], a[196:199], v[88:91]
    s_waitcnt vmcnt(11)
    buffer_load_dwordx2 v[56:57], v10, s[72:75], s36 offen offset:0
    v_mfma_f32_16x16x32_bf16 v[92:95], v[24:27], a[216:219], v[132:135]
    ds_read_b128 v[44:47], v3 offset:12416
    v_mfma_f32_16x16x32_bf16 v[92:95], v[28:31], a[220:223], v[92:95]
    s_waitcnt lgkmcnt(2)
    buffer_load_dwordx2 v[58:59], v10, s[76:79], s36 offen offset:0
    v_exp_f32 v18, v78
    v_mfma_f32_16x16x32_bf16 v[120:123], v[32:35], a[192:195], v[128:131]
    ds_read_b128 v[24:27], v2 offset:18560
    v_add_f32 v6, v6, v16
    v_mfma_f32_16x16x32_bf16 v[120:123], v[36:39], a[196:199], v[120:123]
    s_waitcnt vmcnt(12)
    buffer_load_dwordx4 v[224:227], v9, s[64:67], s33 offen offset:0 nt
    v_mfma_f32_16x16x32_bf16 v[124:127], v[32:35], a[216:219], v[132:135]
    ds_read_b128 v[28:31], v3 offset:18560
    v_add_f32 v6, v6, v17
    v_mfma_f32_16x16x32_bf16 v[124:127], v[36:39], a[220:223], v[124:127]
    s_waitcnt lgkmcnt(2)
    s_waitcnt vmcnt(12)
    buffer_load_dwordx4 v[228:231], v9, s[64:67], s33 offen offset:1536 nt
    v_mfma_f32_16x16x32_bf16 v[88:91], v[40:43], a[200:203], v[88:91]
    ds_read_b128 v[32:35], v2 offset:12544
    v_mfma_f32_16x16x32_bf16 v[88:91], v[44:47], a[204:207], v[88:91]
    buffer_load_dwordx4 v[232:235], v9, s[64:67], s34 offen offset:0 nt
    v_mfma_f32_16x16x32_bf16 v[92:95], v[40:43], a[224:227], v[92:95]
    ds_read_b128 v[36:39], v3 offset:12544
    v_mfma_f32_16x16x32_bf16 v[92:95], v[44:47], a[228:231], v[92:95]
    s_waitcnt lgkmcnt(2)
    s_waitcnt vmcnt(13)
    buffer_load_dwordx4 v[236:239], v9, s[64:67], s34 offen offset:1536 nt
    v_exp_f32 v19, v79
    v_mfma_f32_16x16x32_bf16 v[120:123], v[24:27], a[200:203], v[120:123]
    ds_read_b128 v[40:43], v2 offset:18688
    v_cvt_pk_bf16_f32 v76, v16, v17
    v_mfma_f32_16x16x32_bf16 v[120:123], v[28:31], a[204:207], v[120:123]
    s_waitcnt vmcnt(9)
    v_exp_f32 v16, v108
    v_add_f32 v6, v6, v18
    v_mfma_f32_16x16x32_bf16 v[124:127], v[24:27], a[224:227], v[124:127]
    ds_read_b128 v[44:47], v3 offset:18688
    v_add_f32 v6, v6, v19
    v_mfma_f32_16x16x32_bf16 v[124:127], v[28:31], a[228:231], v[124:127]
    s_waitcnt lgkmcnt(2)
    s_barrier
    v_mfma_f32_16x16x32_bf16 v[88:91], v[32:35], a[208:211], v[88:91]
    ds_read_b128 v[24:27], v1 offset:12288
    v_mfma_f32_16x16x32_bf16 v[88:91], v[36:39], a[212:215], v[88:91]
    v_exp_f32 v17, v109
    v_cvt_pk_bf16_f32 v77, v18, v19
    v_mfma_f32_16x16x32_bf16 v[92:95], v[32:35], a[232:235], v[92:95]
    ds_read_b128 v[28:31], v1 offset:13312
    v_mfma_f32_16x16x32_bf16 v[92:95], v[36:39], a[236:239], v[92:95]
    s_waitcnt lgkmcnt(2)
    v_exp_f32 v18, v110
    v_add_f32 v6, v6, v16
    v_mfma_f32_16x16x32_bf16 v[120:123], v[40:43], a[208:211], v[120:123]
    ds_read_b128 v[32:35], v1 offset:14336
    v_add_f32 v6, v6, v17
    v_mfma_f32_16x16x32_bf16 v[120:123], v[44:47], a[212:215], v[120:123]
    v_exp_f32 v19, v111
    v_mfma_f32_16x16x32_bf16 v[124:127], v[40:43], a[232:235], v[124:127]
    ds_read_b128 v[36:39], v1 offset:15360
    v_cvt_pk_bf16_f32 v78, v16, v17
    v_mfma_f32_16x16x32_bf16 v[124:127], v[44:47], a[236:239], v[124:127]
    s_waitcnt lgkmcnt(2)
    v_add_f32 v6, v6, v18
    v_add_f32 v6, v6, v19
    v_cvt_pk_bf16_f32 v79, v18, v19
    v_mfma_f32_16x16x32_bf16 a[0:3], v[72:75], v[24:27], a[0:3]
    ds_read_b128 v[40:43], v1 offset:16384
    v_mfma_f32_16x16x32_bf16 a[4:7], v[72:75], v[28:31], a[4:7]
    buffer_load_dwordx2 v[60:61], v10, s[72:75], s36 offen offset:192
    v_exp_f32 v16, v80
    v_mfma_f32_16x16x32_bf16 a[48:51], v[76:79], v[24:27], a[48:51]
    ds_read_b128 v[44:47], v1 offset:17408
    v_mfma_f32_16x16x32_bf16 a[52:55], v[76:79], v[28:31], a[52:55]
    s_waitcnt lgkmcnt(2)
    buffer_load_dwordx2 v[62:63], v10, s[76:79], s36 offen offset:192
    v_exp_f32 v17, v81
    v_exp_f32 v18, v82
    v_mfma_f32_16x16x32_bf16 a[8:11], v[72:75], v[32:35], a[8:11]
    ds_read_b128 v[24:27], v1 offset:18432
    v_add_f32 v5, v5, v16
    v_mfma_f32_16x16x32_bf16 a[12:15], v[72:75], v[36:39], a[12:15]
    buffer_load_dwordx4 v[240:243], v9, s[64:67], s33 offen offset:384 nt
    v_add_f32 v5, v5, v17
    v_exp_f32 v19, v83
    v_mfma_f32_16x16x32_bf16 a[56:59], v[76:79], v[32:35], a[56:59]
    ds_read_b128 v[28:31], v1 offset:19456
    v_cvt_pk_bf16_f32 v80, v16, v17
    v_mfma_f32_16x16x32_bf16 a[60:63], v[76:79], v[36:39], a[60:63]
    s_waitcnt lgkmcnt(2)
    buffer_load_dwordx4 v[244:247], v9, s[64:67], s33 offen offset:1920 nt
    v_exp_f32 v16, v112
    v_add_f32 v5, v5, v18
    v_add_f32 v5, v5, v19
    v_mfma_f32_16x16x32_bf16 a[16:19], v[72:75], v[40:43], a[16:19]
    ds_read_b128 v[32:35], v1 offset:20480
    v_mfma_f32_16x16x32_bf16 a[20:23], v[72:75], v[44:47], a[20:23]
    buffer_load_dwordx4 v[248:251], v9, s[64:67], s34 offen offset:384 nt
    v_exp_f32 v17, v113
    v_cvt_pk_bf16_f32 v81, v18, v19
    v_mfma_f32_16x16x32_bf16 a[64:67], v[76:79], v[40:43], a[64:67]
    ds_read_b128 v[36:39], v1 offset:21504
    v_mfma_f32_16x16x32_bf16 a[68:71], v[76:79], v[44:47], a[68:71]
    s_waitcnt lgkmcnt(2)
    buffer_load_dwordx4 v[252:255], v9, s[64:67], s34 offen offset:1920 nt
    v_exp_f32 v18, v114
    v_add_f32 v5, v5, v16
    v_mfma_f32_16x16x32_bf16 a[24:27], v[72:75], v[24:27], a[24:27]
    ds_read_b128 v[40:43], v1 offset:22528
    v_add_f32 v5, v5, v17
    v_mfma_f32_16x16x32_bf16 a[28:31], v[72:75], v[28:31], a[28:31]
    v_exp_f32 v19, v115
    v_cvt_pk_bf16_f32 v82, v16, v17
    v_exp_f32 v16, v84
    v_mfma_f32_16x16x32_bf16 a[72:75], v[76:79], v[24:27], a[72:75]
    ds_read_b128 v[44:47], v1 offset:23552
    v_add_f32 v5, v5, v18
    v_mfma_f32_16x16x32_bf16 a[76:79], v[76:79], v[28:31], a[76:79]
    s_waitcnt lgkmcnt(2)
    v_add_u32 v1, 49152, v1
    v_add_f32 v5, v5, v19
    v_exp_f32 v17, v85
    v_cvt_pk_bf16_f32 v83, v18, v19
    v_mfma_f32_16x16x32_bf16 a[32:35], v[72:75], v[32:35], a[32:35]
    ds_read_b128 v[24:27], v1 offset:0
    v_mfma_f32_16x16x32_bf16 a[36:39], v[72:75], v[36:39], a[36:39]
    v_exp_f32 v18, v86
    v_add_f32 v6, v6, v16
    v_add_f32 v6, v6, v17
    v_exp_f32 v19, v87
    v_mfma_f32_16x16x32_bf16 a[80:83], v[76:79], v[32:35], a[80:83]
    ds_read_b128 v[28:31], v1 offset:1024
    v_cvt_pk_bf16_f32 v84, v16, v17
    v_mfma_f32_16x16x32_bf16 a[84:87], v[76:79], v[36:39], a[84:87]
    s_waitcnt lgkmcnt(2)
    v_exp_f32 v16, v116
    v_add_f32 v6, v6, v18
    v_add_f32 v6, v6, v19
    v_mfma_f32_16x16x32_bf16 a[40:43], v[72:75], v[40:43], a[40:43]
    ds_read_b128 v[32:35], v1 offset:2048
    v_mfma_f32_16x16x32_bf16 a[44:47], v[72:75], v[44:47], a[44:47]
    v_exp_f32 v17, v117
    v_cvt_pk_bf16_f32 v85, v18, v19
    v_exp_f32 v18, v118
    v_add_f32 v6, v6, v16
    v_mfma_f32_16x16x32_bf16 a[88:91], v[76:79], v[40:43], a[88:91]
    ds_read_b128 v[36:39], v1 offset:3072
    v_add_f32 v6, v6, v17
    v_mfma_f32_16x16x32_bf16 a[92:95], v[76:79], v[44:47], a[92:95]
    s_waitcnt lgkmcnt(2)
    v_exp_f32 v19, v119
    v_cvt_pk_bf16_f32 v86, v16, v17
    v_add_f32 v6, v6, v18
    v_add_f32 v6, v6, v19
    v_cvt_pk_bf16_f32 v87, v18, v19
    v_mfma_f32_16x16x32_bf16 a[0:3], v[80:83], v[24:27], a[0:3]
    ds_read_b128 v[40:43], v1 offset:4096
    v_mfma_f32_16x16x32_bf16 a[4:7], v[80:83], v[28:31], a[4:7]
    buffer_load_dwordx3 v[144:146], v12, s[68:71], s35 offen offset:0 nt
    v_exp_f32 v16, v88
    v_mfma_f32_16x16x32_bf16 a[48:51], v[84:87], v[24:27], a[48:51]
    ds_read_b128 v[44:47], v1 offset:5120
    v_mfma_f32_16x16x32_bf16 a[52:55], v[84:87], v[28:31], a[52:55]
    s_waitcnt lgkmcnt(2)
    buffer_load_dwordx3 v[148:150], v12, s[68:71], s35 offen offset:768 nt
    v_exp_f32 v17, v89
    v_mfma_f32_16x16x32_bf16 a[8:11], v[80:83], v[32:35], a[8:11]
    ds_read_b128 v[24:27], v1 offset:6144
    v_mfma_f32_16x16x32_bf16 a[12:15], v[80:83], v[36:39], a[12:15]
    s_waitcnt vmcnt(16)
    buffer_load_dwordx3 v[152:154], v12, s[68:71], s35 offen offset:1536 nt
    v_exp_f32 v18, v90
    v_mfma_f32_16x16x32_bf16 a[56:59], v[84:87], v[32:35], a[56:59]
    ds_read_b128 v[28:31], v1 offset:7168
    v_add_f32 v5, v5, v16
    v_mfma_f32_16x16x32_bf16 a[60:63], v[84:87], v[36:39], a[60:63]
    s_waitcnt lgkmcnt(2)
    s_waitcnt vmcnt(16)
    buffer_load_dwordx3 v[156:158], v12, s[68:71], s35 offen offset:2304 nt
    v_add_f32 v5, v5, v17
    v_mfma_f32_16x16x32_bf16 a[16:19], v[80:83], v[40:43], a[16:19]
    ds_read_b128 v[32:35], v1 offset:8192
    v_mfma_f32_16x16x32_bf16 a[20:23], v[80:83], v[44:47], a[20:23]
    v_exp_f32 v19, v91
    v_cvt_pk_bf16_f32 v88, v16, v17
    v_exp_f32 v16, v120
    v_mfma_f32_16x16x32_bf16 a[64:67], v[84:87], v[40:43], a[64:67]
    ds_read_b128 v[36:39], v1 offset:9216
    v_add_f32 v5, v5, v18
    v_mfma_f32_16x16x32_bf16 a[68:71], v[84:87], v[44:47], a[68:71]
    s_waitcnt lgkmcnt(2)
    v_add_f32 v5, v5, v19
    v_exp_f32 v17, v121
    v_cvt_pk_bf16_f32 v89, v18, v19
    v_mfma_f32_16x16x32_bf16 a[24:27], v[80:83], v[24:27], a[24:27]
    ds_read_b128 v[40:43], v1 offset:10240
    v_mfma_f32_16x16x32_bf16 a[28:31], v[80:83], v[28:31], a[28:31]
    v_exp_f32 v18, v122
    v_add_f32 v5, v5, v16
    v_add_f32 v5, v5, v17
    v_mfma_f32_16x16x32_bf16 a[72:75], v[84:87], v[24:27], a[72:75]
    ds_read_b128 v[44:47], v1 offset:11264
    v_mfma_f32_16x16x32_bf16 a[76:79], v[84:87], v[28:31], a[76:79]
    s_waitcnt lgkmcnt(2)
    v_exp_f32 v19, v123
    v_cvt_pk_bf16_f32 v90, v16, v17
    v_mfma_f32_16x16x32_bf16 a[32:35], v[80:83], v[32:35], a[32:35]
    s_waitcnt vmcnt(40)
    ds_read_b128 v[24:27], v1 offset:12288
    ds_read_b64 a[240:241], v22 offset:49152
    v_mfma_f32_16x16x32_bf16 a[36:39], v[80:83], v[36:39], a[36:39]
    ds_read_b64 a[242:243], v142 offset:49280
    ds_read_b64 a[244:245], v23 offset:49152
    ds_read_b64 a[246:247], v143 offset:49280
    ds_read_b64 a[248:249], v142 offset:49152
    ds_read_b64 a[250:251], v22 offset:49408
    v_mfma_f32_16x16x32_bf16 a[80:83], v[84:87], v[32:35], a[80:83]
    ds_read_b128 v[28:31], v1 offset:13312
    ds_read_b64 a[252:253], v143 offset:49152
    v_mfma_f32_16x16x32_bf16 a[84:87], v[84:87], v[36:39], a[84:87]
    s_waitcnt lgkmcnt(9)
    ds_read_b64 a[254:255], v23 offset:49408
    ds_read_b64 v[192:193], v22 offset:49280
    ds_read_b64 v[194:195], v142 offset:49408
    ds_read_b64 v[196:197], v23 offset:49280
    v_mfma_f32_16x16x32_bf16 a[40:43], v[80:83], v[40:43], a[40:43]
    ds_read_b128 v[32:35], v1 offset:14336
    ds_read_b64 v[198:199], v143 offset:49408
    v_mfma_f32_16x16x32_bf16 a[44:47], v[80:83], v[44:47], a[44:47]
    v_exp_f32 v16, v92
    v_add_f32 v5, v5, v18
    v_add_f32 v5, v5, v19
    v_exp_f32 v17, v93
    v_cvt_pk_bf16_f32 v91, v18, v19
    v_exp_f32 v18, v94
    v_add_f32 v6, v6, v16
    v_add_f32 v6, v6, v17
    v_exp_f32 v19, v95
    v_cvt_pk_bf16_f32 v92, v16, v17
    v_exp_f32 v16, v124
    v_add_f32 v6, v6, v18
    v_add_f32 v6, v6, v19
    v_exp_f32 v17, v125
    v_cvt_pk_bf16_f32 v93, v18, v19
    v_exp_f32 v18, v126
    v_add_f32 v6, v6, v16
    v_add_f32 v6, v6, v17
    v_exp_f32 v19, v127
    v_cvt_pk_bf16_f32 v94, v16, v17
    v_add_f32 v6, v6, v18
    v_add_f32 v6, v6, v19
    v_cvt_pk_bf16_f32 v95, v18, v19
    v_mfma_f32_16x16x32_bf16 a[88:91], v[84:87], v[40:43], a[88:91]
    s_waitcnt vmcnt(16)
    ds_read_b128 v[36:39], v1 offset:15360
    ds_read_b64 v[200:201], v22 offset:24576
    v_mfma_f32_16x16x32_bf16 a[92:95], v[84:87], v[44:47], a[92:95]
    s_waitcnt lgkmcnt(9)
    ds_read_b64 v[202:203], v142 offset:24704
    ds_read_b64 v[204:205], v23 offset:24576
    v_mfma_f32_16x16x32_bf16 a[0:3], v[88:91], v[24:27], a[0:3]
    ds_read_b128 v[40:43], v1 offset:16384
    ds_read_b64 v[206:207], v143 offset:24704
    v_mfma_f32_16x16x32_bf16 a[4:7], v[88:91], v[28:31], a[4:7]
    ds_read_b64 v[208:209], v142 offset:24576
    ds_read_b64 v[210:211], v22 offset:24832
    v_mfma_f32_16x16x32_bf16 a[48:51], v[92:95], v[24:27], a[48:51]
    ds_read_b128 v[44:47], v1 offset:17408
    ds_read_b64 v[212:213], v143 offset:24576
    v_mfma_f32_16x16x32_bf16 a[52:55], v[92:95], v[28:31], a[52:55]
    s_waitcnt lgkmcnt(9)
    ds_read_b64 v[214:215], v23 offset:24832
    ds_read_b64 v[216:217], v22 offset:24704
    v_mfma_f32_16x16x32_bf16 a[8:11], v[88:91], v[32:35], a[8:11]
L_iw1:
L_pg1:
    s_cbranch_execz L_pg5
    ds_read_b128 v[24:27], v1 offset:18432
    ds_read_b64 v[218:219], v142 offset:24832
    v_mfma_f32_16x16x32_bf16 a[12:15], v[88:91], v[36:39], a[12:15]
    ds_read_b64 v[220:221], v23 offset:24704
    ds_read_b64 v[222:223], v143 offset:24832
    v_mfma_f32_16x16x32_bf16 a[56:59], v[92:95], v[32:35], a[56:59]
    ds_read_b128 v[28:31], v1 offset:19456
    v_mfma_f32_16x16x32_bf16 a[60:63], v[92:95], v[36:39], a[60:63]
    s_waitcnt lgkmcnt(8)
    v_mfma_f32_16x16x32_bf16 a[16:19], v[88:91], v[40:43], a[16:19]
    ds_read_b128 v[32:35], v1 offset:20480
    v_mfma_f32_16x16x32_bf16 a[20:23], v[88:91], v[44:47], a[20:23]
    v_mfma_f32_16x16x32_bf16 a[64:67], v[92:95], v[40:43], a[64:67]
    ds_read_b128 v[36:39], v1 offset:21504
    v_mfma_f32_16x16x32_bf16 a[68:71], v[92:95], v[44:47], a[68:71]
    s_waitcnt lgkmcnt(2)
    v_mfma_f32_16x16x32_bf16 a[24:27], v[88:91], v[24:27], a[24:27]
    ds_read_b128 v[40:43], v1 offset:22528
    v_mfma_f32_16x16x32_bf16 a[28:31], v[88:91], v[28:31], a[28:31]
    v_mfma_f32_16x16x32_bf16 a[72:75], v[92:95], v[24:27], a[72:75]
    ds_read_b128 v[44:47], v1 offset:23552
    v_mfma_f32_16x16x32_bf16 a[76:79], v[92:95], v[28:31], a[76:79]
    s_waitcnt lgkmcnt(2)
    v_subrev_u32 v2, 49152, v2
    v_subrev_u32 v3, 49152, v3
    v_mfma_f32_16x16x32_bf16 a[32:35], v[88:91], v[32:35], a[32:35]
    ds_read_b128 v[24:27], v2 offset:0
    v_mfma_f32_16x16x32_bf16 a[36:39], v[88:91], v[36:39], a[36:39]
    v_mfma_f32_16x16x32_bf16 a[80:83], v[92:95], v[32:35], a[80:83]
    ds_read_b128 v[28:31], v3 offset:0
    v_mfma_f32_16x16x32_bf16 a[84:87], v[92:95], v[36:39], a[84:87]
    s_waitcnt lgkmcnt(2)
    v_mfma_f32_16x16x32_bf16 a[40:43], v[88:91], v[40:43], a[40:43]
    ds_read_b128 v[32:35], v2 offset:6144
    v_mfma_f32_16x16x32_bf16 a[44:47], v[88:91], v[44:47], a[44:47]
    v_mfma_f32_16x16x32_bf16 a[88:91], v[92:95], v[40:43], a[88:91]
    ds_read_b128 v[36:39], v3 offset:6144
    v_mfma_f32_16x16x32_bf16 a[92:95], v[92:95], v[44:47], a[92:95]
    s_waitcnt lgkmcnt(2)
    s_waitcnt lgkmcnt(0)
    s_barrier
    v_mfma_f32_16x16x32_bf16 v[160:163], v[24:27], a[240:243], 0
    s_waitcnt vmcnt(10)
    ds_read_b128 v[40:43], v2 offset:128
    v_lshlrev_b32 v48, 16, v56
    v_mfma_f32_16x16x32_bf16 v[160:163], v[28:31], a[244:247], v[160:163]
    s_mov_b32 m0, s26
    v_and_b32 v49, s97, v56
    v_lshlrev_b32 v50, 16, v58
    v_and_b32 v51, s97, v58
    v_mul_f32 v48, s38, v48
    v_mul_f32 v49, s38, v49
    v_mfma_f32_16x16x32_bf16 v[164:167], v[24:27], v[200:203], 0
    ds_read_b128 v[44:47], v3 offset:128
    v_mul_f32_e64 v50, -v50, v48
    v_mfma_f32_16x16x32_bf16 v[164:167], v[28:31], v[204:207], v[164:167]
    s_waitcnt lgkmcnt(2)
    buffer_load_dwordx4 v4, s[4:7], s32 offen offset:0 sc1 lds
    v_mul_f32_e64 v51, -v51, v49
    v_cvt_f32_i32 v224, v224
    v_cvt_f32_i32 v225, v225
    v_mfma_f32_16x16x32_bf16 v[96:99], v[32:35], a[240:243], 0
    ds_read_b128 v[24:27], v2 offset:6272
    v_fma_f32 v224, v224, v48, v50
    v_mfma_f32_16x16x32_bf16 v[96:99], v[36:39], a[244:247], v[96:99]
    buffer_load_dwordx4 v4, s[4:7], s32 offen offset:1024 sc1 lds
    v_fma_f32 v225, v225, v49, v51
    v_cvt_pk_bf16_f32 v224, v224, v225
    v_cvt_f32_i32 v228, v228
    v_mfma_f32_16x16x32_bf16 v[100:103], v[32:35], v[200:203], 0
    ds_read_b128 v[28:31], v3 offset:6272
    v_cvt_f32_i32 v229, v229
    v_mfma_f32_16x16x32_bf16 v[100:103], v[36:39], v[204:207], v[100:103]
    s_waitcnt lgkmcnt(2)
    buffer_load_dwordx4 v4, s[4:7], s32 offen offset:2048 sc1 lds
    v_fma_f32 v228, v228, v48, v50
    v_fma_f32 v229, v229, v49, v51
    v_cvt_pk_bf16_f32 v228, v228, v229
    v_mfma_f32_16x16x32_bf16 v[160:163], v[40:43], a[248:251], v[160:163]
    s_add_u32 s32, s32, 24576
    ds_read_b128 v[32:35], v2 offset:256
    v_cvt_f32_i32 v232, v232
    v_mfma_f32_16x16x32_bf16 v[160:163], v[44:47], a[252:255], v[160:163]
    s_sub_u32 s57, s32, 196608
    v_cvt_f32_i32 v233, v233
    v_fma_f32 v232, v232, v48, v50
    v_fma_f32 v233, v233, v49, v51
    v_cvt_pk_bf16_f32 v232, v232, v233
    v_cvt_f32_i32 v236, v236
    v_mfma_f32_16x16x32_bf16 v[164:167], v[40:43], v[208:211], v[164:167]
    s_min_u32 s32, s32, s57
    ds_read_b128 v[36:39], v3 offset:256
    v_cvt_f32_i32 v237, v237
    v_mfma_f32_16x16x32_bf16 v[164:167], v[44:47], v[212:215], v[164:167]
    s_waitcnt lgkmcnt(2)
    v_fma_f32 v236, v236, v48, v50
    v_fma_f32 v237, v237, v49, v51
    v_cvt_pk_bf16_f32 v236, v236, v237
    v_lshlrev_b32 v48, 16, v57
    v_and_b32 v49, s97, v57
    v_mfma_f32_16x16x32_bf16 v[96:99], v[24:27], a[248:251], v[96:99]
    s_add_u32 s26, s26, 12288
    ds_read_b128 v[40:43], v2 offset:6400
    v_lshlrev_b32 v50, 16, v59
    v_mfma_f32_16x16x32_bf16 v[96:99], v[28:31], a[252:255], v[96:99]
    s_mov_b32 m0, s26
    v_and_b32 v51, s97, v59
    v_mul_f32 v48, s38, v48
    v_mul_f32 v49, s38, v49
    v_mul_f32_e64 v50, -v50, v48
    v_mul_f32_e64 v51, -v51, v49
    v_mfma_f32_16x16x32_bf16 v[100:103], v[24:27], v[208:211], v[100:103]
    ds_read_b128 v[44:47], v3 offset:6400
    v_cvt_f32_i32 v226, v226
    v_mfma_f32_16x16x32_bf16 v[100:103], v[28:31], v[212:215], v[100:103]
    s_waitcnt lgkmcnt(2)
    buffer_load_dwordx4 v4, s[4:7], s32 offen offset:0 sc1 lds
    v_cvt_f32_i32 v227, v227
    v_fma_f32 v226, v226, v48, v50
    v_fma_f32 v227, v227, v49, v51
    v_mfma_f32_16x16x32_bf16 v[160:163], v[32:35], v[192:195], v[160:163]
    ds_read_b128 v[24:27], v2 offset:12288
    v_cvt_pk_bf16_f32 v225, v226, v227
    v_mfma_f32_16x16x32_bf16 v[160:163], v[36:39], v[196:199], v[160:163]
    buffer_load_dwordx4 v4, s[4:7], s32 offen offset:1024 sc1 lds
    v_cvt_f32_i32 v230, v230
    v_cvt_f32_i32 v231, v231
    v_fma_f32 v230, v230, v48, v50
    v_mfma_f32_16x16x32_bf16 v[164:167], v[32:35], v[216:219], v[164:167]
    ds_read_b128 v[28:31], v3 offset:12288
    v_fma_f32 v231, v231, v49, v51
    v_mfma_f32_16x16x32_bf16 v[164:167], v[36:39], v[220:223], v[164:167]
    s_waitcnt lgkmcnt(2)
    s_waitcnt vmcnt(13)
    buffer_load_dwordx4 v4, s[4:7], s32 offen offset:2048 sc1 lds
    v_cvt_pk_bf16_f32 v229, v230, v231
    v_cvt_f32_i32 v234, v234
    v_cvt_f32_i32 v235, v235
    v_mfma_f32_16x16x32_bf16 v[96:99], v[40:43], v[192:195], v[96:99]
    ds_read_b128 v[32:35], v2 offset:18432
    v_fma_f32 v234, v234, v48, v50
    v_mfma_f32_16x16x32_bf16 v[96:99], v[44:47], v[196:199], v[96:99]
    v_fma_f32 v235, v235, v49, v51
    v_cvt_pk_bf16_f32 v233, v234, v235
    v_cvt_f32_i32 v238, v238
    v_cvt_f32_i32 v239, v239
    v_fma_f32 v238, v238, v48, v50
    v_mfma_f32_16x16x32_bf16 v[100:103], v[40:43], v[216:219], v[100:103]
    ds_read_b128 v[36:39], v3 offset:18432
    v_fma_f32 v239, v239, v49, v51
    v_mfma_f32_16x16x32_bf16 v[100:103], v[44:47], v[220:223], v[100:103]
    s_waitcnt lgkmcnt(2)
    v_cvt_pk_bf16_f32 v237, v238, v239
    v_mfma_f32_16x16x32_bf16 v[168:171], v[24:27], a[240:243], 0
    ds_read_b128 v[40:43], v2 offset:12416
    v_mfma_f32_16x16x32_bf16 v[168:171], v[28:31], a[244:247], v[168:171]
    s_add_u32 s32, s32, 24576
    s_sub_u32 s57, s32, 196608
    s_min_u32 s32, s32, s57
    s_add_u32 s26, s26, 36864
    s_sub_u32 s57, s26, 147456
    s_min_u32 s26, s26, s57
    v_mfma_f32_16x16x32_bf16 v[172:175], v[24:27], v[200:203], 0
    ds_read_b128 v[44:47], v3 offset:12416
    v_mfma_f32_16x16x32_bf16 v[172:175], v[28:31], v[204:207], v[172:175]
    s_waitcnt lgkmcnt(2)
    v_max3_f32 v16, v160, v161, v162
    v_max3_f32 v18, v164, v165, v166
    v_max3_f32 v16, v16, v163, v96
    v_max3_f32 v18, v18, v167, v100
    v_max3_f32 v16, v16, v97, v98
    v_max3_f32 v18, v18, v101, v102
    v_max_f32 v16, v16, v99
    v_max_f32 v18, v18, v103
    v_mov_b32 v17, v16
    v_mfma_f32_16x16x32_bf16 v[104:107], v[32:35], a[240:243], 0
    ds_read_b128 v[24:27], v2 offset:18560
    v_mov_b32 v19, v18
    v_mfma_f32_16x16x32_bf16 v[104:107], v[36:39], a[244:247], v[104:107]
    s_nop 0
    v_permlane16_swap_b32 v16, v17
    v_permlane16_swap_b32 v18, v19
    s_nop 0
    v_max_f32 v16, v16, v17
    v_max_f32 v18, v18, v19
    v_mov_b32 v17, v16
    v_mov_b32 v19, v18
    v_mfma_f32_16x16x32_bf16 v[108:111], v[32:35], v[200:203], 0
    s_nop 0
    ds_read_b128 v[28:31], v3 offset:18560
    v_permlane32_swap_b32 v16, v17
    v_mfma_f32_16x16x32_bf16 v[108:111], v[36:39], v[204:207], v[108:111]
    s_waitcnt lgkmcnt(2)
    v_permlane32_swap_b32 v18, v19
    s_nop 0
    v_max_f32 v16, v16, v17
    v_max_f32 v18, v18, v19
    v_sub_f32 v136, 0, v16
    v_sub_f32 v137, 0, v16
    v_mfma_f32_16x16x32_bf16 v[168:171], v[40:43], a[248:251], v[168:171]
    ds_read_b128 v[32:35], v2 offset:12544
    v_sub_f32 v138, 0, v16
    v_mfma_f32_16x16x32_bf16 v[168:171], v[44:47], a[252:255], v[168:171]
    v_sub_f32 v139, 0, v16
    v_sub_f32 v140, 0, v18
    v_sub_f32 v141, 0, v18
    v_sub_f32 v142, 0, v18
    v_sub_f32 v143, 0, v18
    v_mfma_f32_16x16x32_bf16 v[172:175], v[40:43], v[208:211], v[172:175]
    ds_read_b128 v[36:39], v3 offset:12544
    v_mfma_f32_16x16x32_bf16 v[172:175], v[44:47], v[212:215], v[172:175]
    s_waitcnt lgkmcnt(2)
    s_waitcnt vmcnt(10)
    v_lshlrev_b32 v48, 16, v60
    v_and_b32 v49, s97, v60
    v_lshlrev_b32 v50, 16, v62
    v_and_b32 v51, s97, v62
    v_mul_f32 v48, s38, v48
    v_mul_f32 v49, s38, v49
    v_mul_f32_e64 v50, -v50, v48
    v_mfma_f32_16x16x32_bf16 v[104:107], v[24:27], a[248:251], v[104:107]
    ds_read_b128 v[40:43], v2 offset:18688
    v_mul_f32_e64 v51, -v51, v49
    v_mfma_f32_16x16x32_bf16 v[104:107], v[28:31], a[252:255], v[104:107]
    buffer_load_dwordx2 v[56:57], off, s[80:83], s37 offset:0
    v_cvt_f32_i32 v240, v240
    v_cvt_f32_i32 v241, v241
    v_fma_f32 v240, v240, v48, v50
    v_fma_f32 v241, v241, v49, v51
    v_cvt_pk_bf16_f32 v226, v240, v241
    v_mfma_f32_16x16x32_bf16 v[108:111], v[24:27], v[208:211], v[108:111]
    ds_read_b128 v[44:47], v3 offset:18688
    v_cvt_f32_i32 v244, v244
    v_mfma_f32_16x16x32_bf16 v[108:111], v[28:31], v[212:215], v[108:111]
    s_waitcnt lgkmcnt(2)
    buffer_load_dwordx2 v[58:59], off, s[84:87], s37 offset:0
    v_add_u32 v2, 49152, v2
    v_add_u32 v3, 49152, v3
    v_cvt_f32_i32 v245, v245
    v_fma_f32 v244, v244, v48, v50
    v_mfma_f32_16x16x32_bf16 v[168:171], v[32:35], v[192:195], v[168:171]
    ds_read_b128 v[24:27], v2 offset:0
    v_fma_f32 v245, v245, v49, v51
    v_mfma_f32_16x16x32_bf16 v[168:171], v[36:39], v[196:199], v[168:171]
    v_cvt_pk_bf16_f32 v230, v244, v245
    v_cvt_f32_i32 v248, v248
    v_cvt_f32_i32 v249, v249
    v_fma_f32 v248, v248, v48, v50
    v_fma_f32 v249, v249, v49, v51
    v_cvt_pk_bf16_f32 v234, v248, v249
    v_cvt_f32_i32 v252, v252
    v_mfma_f32_16x16x32_bf16 v[172:175], v[32:35], v[216:219], v[172:175]
    ds_read_b128 v[28:31], v3 offset:0
    v_cvt_f32_i32 v253, v253
    v_mfma_f32_16x16x32_bf16 v[172:175], v[36:39], v[220:223], v[172:175]
    s_waitcnt lgkmcnt(2)
    v_fma_f32 v252, v252, v48, v50
    v_fma_f32 v253, v253, v49, v51
    v_cvt_pk_bf16_f32 v238, v252, v253
    v_lshlrev_b32 v48, 16, v61
    v_and_b32 v49, s97, v61
    v_lshlrev_b32 v50, 16, v63
    v_and_b32 v51, s97, v63
    v_mfma_f32_16x16x32_bf16 v[104:107], v[40:43], v[192:195], v[104:107]
    ds_read_b128 v[32:35], v2 offset:6144
    v_mul_f32 v48, s38, v48
    v_mfma_f32_16x16x32_bf16 v[104:107], v[44:47], v[196:199], v[104:107]
    v_mul_f32 v49, s38, v49
    v_mul_f32_e64 v50, -v50, v48
    v_mul_f32_e64 v51, -v51, v49
    v_cvt_f32_i32 v242, v242
    v_cvt_f32_i32 v243, v243
    v_fma_f32 v242, v242, v48, v50
    v_mfma_f32_16x16x32_bf16 v[108:111], v[40:43], v[216:219], v[108:111]
    ds_read_b128 v[36:39], v3 offset:6144
    v_add_f32 v160, v160, v136
    v_mfma_f32_16x16x32_bf16 v[108:111], v[44:47], v[220:223], v[108:111]
    s_waitcnt lgkmcnt(2)
    v_add_f32 v161, v161, v136
    v_add_f32 v162, v162, v136
    v_add_f32 v163, v163, v136
    v_add_f32 v96, v96, v136
    v_add_f32 v97, v97, v136
    v_add_f32 v98, v98, v136
    v_add_f32 v99, v99, v136
    v_mfma_f32_16x16x32_bf16 v[176:179], v[24:27], a[240:243], v[136:139]
    ds_read_b128 v[40:43], v2 offset:128
    v_add_f32 v164, v164, v140
    v_mfma_f32_16x16x32_bf16 v[176:179], v[28:31], a[244:247], v[176:179]
    v_add_f32 v165, v165, v140
    v_add_f32 v166, v166, v140
    v_add_f32 v167, v167, v140
    v_add_f32 v100, v100, v140
    v_add_f32 v101, v101, v140
    v_add_f32 v102, v102, v140
    v_mfma_f32_16x16x32_bf16 v[180:183], v[24:27], v[200:203], v[140:143]
    ds_read_b128 v[44:47], v3 offset:128
    v_add_f32 v103, v103, v140
    v_mfma_f32_16x16x32_bf16 v[180:183], v[28:31], v[204:207], v[180:183]
    s_waitcnt lgkmcnt(2)
    v_exp_f32 v16, v160
    v_exp_f32 v17, v161
    v_exp_f32 v18, v162
    v_add_f32 v7, v7, v16
    v_mfma_f32_16x16x32_bf16 v[112:115], v[32:35], a[240:243], v[136:139]
    ds_read_b128 v[24:27], v2 offset:6272
    v_add_f32 v7, v7, v17
    v_mfma_f32_16x16x32_bf16 v[112:115], v[36:39], a[244:247], v[112:115]
    v_exp_f32 v19, v163
    v_cvt_pk_bf16_f32 v160, v16, v17
    v_exp_f32 v16, v96
    v_add_f32 v7, v7, v18
    v_add_f32 v7, v7, v19
    v_mfma_f32_16x16x32_bf16 v[116:119], v[32:35], v[200:203], v[140:143]
    ds_read_b128 v[28:31], v3 offset:6272
    v_fma_f32 v243, v243, v49, v51
    v_mfma_f32_16x16x32_bf16 v[116:119], v[36:39], v[204:207], v[116:119]
    s_waitcnt lgkmcnt(2)
    v_exp_f32 v17, v97
    v_cvt_pk_bf16_f32 v161, v18, v19
    v_exp_f32 v18, v98
    v_add_f32 v7, v7, v16
    v_mfma_f32_16x16x32_bf16 v[176:179], v[40:43], a[248:251], v[176:179]
    ds_read_b128 v[32:35], v2 offset:256
    v_add_f32 v7, v7, v17
    v_mfma_f32_16x16x32_bf16 v[176:179], v[44:47], a[252:255], v[176:179]
    v_exp_f32 v19, v99
    v_cvt_pk_bf16_f32 v162, v16, v17
    v_exp_f32 v16, v164
    v_add_f32 v7, v7, v18
    v_add_f32 v7, v7, v19
    v_mfma_f32_16x16x32_bf16 v[180:183], v[40:43], v[208:211], v[180:183]
    ds_read_b128 v[36:39], v3 offset:256
    v_cvt_pk_bf16_f32 v227, v242, v243
    v_mfma_f32_16x16x32_bf16 v[180:183], v[44:47], v[212:215], v[180:183]
    s_waitcnt lgkmcnt(2)
    v_exp_f32 v17, v165
    v_cvt_pk_bf16_f32 v163, v18, v19
    v_exp_f32 v18, v166
    v_add_f32 v8, v8, v16
    v_mfma_f32_16x16x32_bf16 v[112:115], v[24:27], a[248:251], v[112:115]
    ds_read_b128 v[40:43], v2 offset:6400
    v_add_f32 v8, v8, v17
    v_mfma_f32_16x16x32_bf16 v[112:115], v[28:31], a[252:255], v[112:115]
    v_exp_f32 v19, v167
    v_cvt_pk_bf16_f32 v164, v16, v17
    v_exp_f32 v16, v100
    v_add_f32 v8, v8, v18
    v_add_f32 v8, v8, v19
    v_mfma_f32_16x16x32_bf16 v[116:119], v[24:27], v[208:211], v[116:119]
    ds_read_b128 v[44:47], v3 offset:6400
    v_cvt_f32_i32 v246, v246
    v_mfma_f32_16x16x32_bf16 v[116:119], v[28:31], v[212:215], v[116:119]
    s_waitcnt lgkmcnt(2)
    v_exp_f32 v17, v101
    v_cvt_pk_bf16_f32 v165, v18, v19
    v_exp_f32 v18, v102
    v_add_f32 v8, v8, v16
    v_add_f32 v8, v8, v17
    v_mfma_f32_16x16x32_bf16 v[176:179], v[32:35], v[192:195], v[176:179]
    ds_read_b128 v[24:27], v2 offset:12288
    v_cvt_f32_i32 v247, v247
    v_mfma_f32_16x16x32_bf16 v[176:179], v[36:39], v[196:199], v[176:179]
    v_exp_f32 v19, v103
    v_cvt_pk_bf16_f32 v166, v16, v17
    v_add_f32 v8, v8, v18
    v_add_f32 v8, v8, v19
    v_cvt_pk_bf16_f32 v167, v18, v19
    v_mfma_f32_16x16x32_bf16 v[180:183], v[32:35], v[216:219], v[180:183]
    ds_read_b128 v[28:31], v3 offset:12288
    v_add_f32 v168, v168, v136
    v_mfma_f32_16x16x32_bf16 v[180:183], v[36:39], v[220:223], v[180:183]
    s_waitcnt lgkmcnt(2)
    v_add_f32 v169, v169, v136
    v_add_f32 v170, v170, v136
    v_add_f32 v171, v171, v136
    v_add_f32 v104, v104, v136
    v_add_f32 v105, v105, v136
    v_add_f32 v106, v106, v136
    v_add_f32 v107, v107, v136
    v_mfma_f32_16x16x32_bf16 v[112:115], v[40:43], v[192:195], v[112:115]
    ds_read_b128 v[32:35], v2 offset:18432
    v_fma_f32 v246, v246, v48, v50
    v_mfma_f32_16x16x32_bf16 v[112:115], v[44:47], v[196:199], v[112:115]
    v_fma_f32 v247, v247, v49, v51
    v_cvt_pk_bf16_f32 v231, v246, v247
    v_cvt_f32_i32 v250, v250
    v_add_f32 v172, v172, v140
    v_add_f32 v173, v173, v140
    v_add_f32 v174, v174, v140
    v_add_f32 v175, v175, v140
    v_mfma_f32_16x16x32_bf16 v[116:119], v[40:43], v[216:219], v[116:119]
    ds_read_b128 v[36:39], v3 offset:18432
    v_cvt_f32_i32 v251, v251
    v_mfma_f32_16x16x32_bf16 v[116:119], v[44:47], v[220:223], v[116:119]
    s_waitcnt lgkmcnt(2)
    v_fma_f32 v250, v250, v48, v50
    v_fma_f32 v251, v251, v49, v51
    v_cvt_pk_bf16_f32 v235, v250, v251
    v_cvt_f32_i32 v254, v254
    v_add_f32 v108, v108, v140
    v_add_f32 v109, v109, v140
    v_mfma_f32_16x16x32_bf16 v[184:187], v[24:27], a[240:243], v[136:139]
    ds_read_b128 v[40:43], v2 offset:12416
    v_cvt_f32_i32 v255, v255
    v_fma_f32 v254, v254, v48, v50
    v_fma_f32 v255, v255, v49, v51
    v_cvt_pk_bf16_f32 v239, v254, v255
    v_mfma_f32_16x16x32_bf16 v[184:187], v[28:31], a[244:247], v[184:187]
    buffer_store_dwordx4 v[224:227], v11, s[4:7], s33 offen offset:0 sc1
    v_add_f32 v110, v110, v140
    v_add_f32 v111, v111, v140
    v_xor_b32 v55, 16, v11
    v_mfma_f32_16x16x32_bf16 v[188:191], v[24:27], v[200:203], v[140:143]
    ds_read_b128 v[44:47], v3 offset:12416
    v_mfma_f32_16x16x32_bf16 v[188:191], v[28:31], v[204:207], v[188:191]
    s_waitcnt lgkmcnt(2)
    v_exp_f32 v16, v168
    v_exp_f32 v17, v169
    v_exp_f32 v18, v170
    v_mfma_f32_16x16x32_bf16 v[120:123], v[32:35], a[240:243], v[136:139]
    ds_read_b128 v[24:27], v2 offset:18560
    v_add_f32 v7, v7, v16
    v_mfma_f32_16x16x32_bf16 v[120:123], v[36:39], a[244:247], v[120:123]
    buffer_store_dwordx4 v[228:231], v55, s[4:7], s33 offen offset:768 sc1
    v_add_f32 v7, v7, v17
    v_exp_f32 v19, v171
    v_mfma_f32_16x16x32_bf16 v[124:127], v[32:35], v[200:203], v[140:143]
    ds_read_b128 v[28:31], v3 offset:18560
    v_cvt_pk_bf16_f32 v168, v16, v17
    v_mfma_f32_16x16x32_bf16 v[124:127], v[36:39], v[204:207], v[124:127]
    s_waitcnt lgkmcnt(2)
    v_exp_f32 v16, v104
    v_add_f32 v7, v7, v18
    v_add_f32 v7, v7, v19
    v_exp_f32 v17, v105
    v_cvt_pk_bf16_f32 v169, v18, v19
    v_mfma_f32_16x16x32_bf16 v[184:187], v[40:43], a[248:251], v[184:187]
    ds_read_b128 v[32:35], v2 offset:12544
    v_mfma_f32_16x16x32_bf16 v[184:187], v[44:47], a[252:255], v[184:187]
    v_exp_f32 v18, v106
    v_add_f32 v7, v7, v16
    v_add_f32 v7, v7, v17
    v_exp_f32 v19, v107
    v_mfma_f32_16x16x32_bf16 v[188:191], v[40:43], v[208:211], v[188:191]
    ds_read_b128 v[36:39], v3 offset:12544
    v_cvt_pk_bf16_f32 v170, v16, v17
    v_mfma_f32_16x16x32_bf16 v[188:191], v[44:47], v[212:215], v[188:191]
    s_waitcnt lgkmcnt(2)
    v_exp_f32 v16, v172
    v_add_f32 v7, v7, v18
    v_add_f32 v7, v7, v19
    v_exp_f32 v17, v173
    v_cvt_pk_bf16_f32 v171, v18, v19
    v_mfma_f32_16x16x32_bf16 v[120:123], v[24:27], a[248:251], v[120:123]
    ds_read_b128 v[40:43], v2 offset:18688
    v_xor_b32 v54, 32, v11
    v_mfma_f32_16x16x32_bf16 v[120:123], v[28:31], a[252:255], v[120:123]
    s_waitcnt vmcnt(4)
    v_exp_f32 v18, v174
    v_add_f32 v8, v8, v16
    v_add_f32 v8, v8, v17
    v_exp_f32 v19, v175
    v_cvt_pk_bf16_f32 v172, v16, v17
    v_mfma_f32_16x16x32_bf16 v[124:127], v[24:27], v[208:211], v[124:127]
    ds_read_b128 v[44:47], v3 offset:18688
    v_mfma_f32_16x16x32_bf16 v[124:127], v[28:31], v[212:215], v[124:127]
    s_waitcnt lgkmcnt(2)
    s_barrier
    v_add_u32 v2, 49152, v2
    v_add_u32 v3, 49152, v3
    v_exp_f32 v16, v108
    v_mfma_f32_16x16x32_bf16 v[184:187], v[32:35], v[192:195], v[184:187]
    ds_read_b128 v[24:27], v2 offset:0
    v_add_f32 v8, v8, v18
    v_mfma_f32_16x16x32_bf16 v[184:187], v[36:39], v[196:199], v[184:187]
    buffer_store_dwordx4 v[232:235], v54, s[4:7], s33 offen offset:1536 sc1
    v_add_f32 v8, v8, v19
    v_exp_f32 v17, v109
    v_mfma_f32_16x16x32_bf16 v[188:191], v[32:35], v[216:219], v[188:191]
    ds_read_b128 v[28:31], v3 offset:0
    v_cvt_pk_bf16_f32 v173, v18, v19
    v_mfma_f32_16x16x32_bf16 v[188:191], v[36:39], v[220:223], v[188:191]
    s_waitcnt lgkmcnt(2)
    v_exp_f32 v18, v110
    v_add_f32 v8, v8, v16
    v_add_f32 v8, v8, v17
    v_exp_f32 v19, v111
    v_cvt_pk_bf16_f32 v174, v16, v17
    v_mfma_f32_16x16x32_bf16 v[120:123], v[40:43], v[192:195], v[120:123]
    ds_read_b128 v[32:35], v2 offset:6144
    v_xor_b32 v55, 48, v11
    v_mfma_f32_16x16x32_bf16 v[120:123], v[44:47], v[196:199], v[120:123]
    buffer_store_dwordx4 v[236:239], v55, s[4:7], s33 offen offset:2304 sc1
    v_add_f32 v8, v8, v18
    v_add_f32 v8, v8, v19
    v_cvt_pk_bf16_f32 v175, v18, v19
    v_mfma_f32_16x16x32_bf16 v[124:127], v[40:43], v[216:219], v[124:127]
    ds_read_b128 v[36:39], v3 offset:6144
    v_mfma_f32_16x16x32_bf16 v[124:127], v[44:47], v[220:223], v[124:127]
    s_waitcnt lgkmcnt(2)
    v_mfma_f32_16x16x32_bf16 v[64:67], v[24:27], a[192:195], v[128:131]
    ds_read_b128 v[40:43], v2 offset:128
    v_mfma_f32_16x16x32_bf16 v[64:67], v[28:31], a[196:199], v[64:67]
    buffer_load_dwordx2 v[60:61], off, s[80:83], s37 offset:8
    v_mfma_f32_16x16x32_bf16 v[68:71], v[24:27], a[216:219], v[132:135]
    v_exp_f32 v16, v176
    v_mfma_f32_16x16x32_bf16 v[68:71], v[28:31], a[220:223], v[68:71]
    v_exp_f32 v17, v177
    v_mfma_f32_16x16x32_bf16 v[72:75], v[24:27], a[240:243], v[136:139]
    ds_read_b128 v[44:47], v3 offset:128
    v_mfma_f32_16x16x32_bf16 v[72:75], v[28:31], a[244:247], v[72:75]
    buffer_load_dwordx2 v[62:63], off, s[84:87], s37 offset:8
    v_mfma_f32_16x16x32_bf16 v[76:79], v[24:27], v[200:203], v[140:143]
    v_exp_f32 v18, v178
    v_mfma_f32_16x16x32_bf16 v[76:79], v[28:31], v[204:207], v[76:79]
    s_waitcnt lgkmcnt(2)
    v_add_f32 v7, v7, v16
    v_add_f32 v7, v7, v17
    v_mfma_f32_16x16x32_bf16 v[96:99], v[32:35], a[192:195], v[128:131]
    ds_read_b128 v[24:27], v2 offset:6272
    v_mfma_f32_16x16x32_bf16 v[96:99], v[36:39], a[196:199], v[96:99]
    buffer_load_dwordx3 v[240:242], v12, s[68:71], s16 offen offset:0 nt
    v_mfma_f32_16x16x32_bf16 v[100:103], v[32:35], a[216:219], v[132:135]
    s_waitcnt vmcnt(7)
    v_exp_f32 v19, v179
    v_mfma_f32_16x16x32_bf16 v[100:103], v[36:39], a[220:223], v[100:103]
    v_cvt_pk_bf16_f32 v176, v16, v17
    v_exp_f32 v16, v112
    v_mfma_f32_16x16x32_bf16 v[104:107], v[32:35], a[240:243], v[136:139]
    ds_read_b128 v[28:31], v3 offset:6272
    v_add_f32 v7, v7, v18
    v_mfma_f32_16x16x32_bf16 v[104:107], v[36:39], a[244:247], v[104:107]
    buffer_load_dwordx3 v[244:246], v12, s[68:71], s16 offen offset:768 nt
    v_add_f32 v7, v7, v19
    v_mfma_f32_16x16x32_bf16 v[108:111], v[32:35], v[200:203], v[140:143]
    v_exp_f32 v17, v113
    v_mfma_f32_16x16x32_bf16 v[108:111], v[36:39], v[204:207], v[108:111]
    s_waitcnt lgkmcnt(2)
    v_cvt_pk_bf16_f32 v177, v18, v19
    v_exp_f32 v18, v114
    v_mfma_f32_16x16x32_bf16 v[64:67], v[40:43], a[200:203], v[64:67]
    ds_read_b128 v[32:35], v2 offset:256
    v_add_f32 v7, v7, v16
    v_mfma_f32_16x16x32_bf16 v[64:67], v[44:47], a[204:207], v[64:67]
    buffer_load_dwordx3 v[248:250], v12, s[68:71], s16 offen offset:1536 nt
    v_add_f32 v7, v7, v17
    v_mfma_f32_16x16x32_bf16 v[68:71], v[40:43], a[224:227], v[68:71]
    v_exp_f32 v19, v115
    v_mfma_f32_16x16x32_bf16 v[68:71], v[44:47], a[228:231], v[68:71]
    v_cvt_pk_bf16_f32 v178, v16, v17
    v_exp_f32 v16, v180
    v_mfma_f32_16x16x32_bf16 v[72:75], v[40:43], a[248:251], v[72:75]
    ds_read_b128 v[36:39], v3 offset:256
    v_add_f32 v7, v7, v18
    v_mfma_f32_16x16x32_bf16 v[72:75], v[44:47], a[252:255], v[72:75]
    buffer_load_dwordx3 v[252:254], v12, s[68:71], s16 offen offset:2304 nt
    v_add_f32 v7, v7, v19
    v_mfma_f32_16x16x32_bf16 v[76:79], v[40:43], v[208:211], v[76:79]
    v_exp_f32 v17, v181
    v_mfma_f32_16x16x32_bf16 v[76:79], v[44:47], v[212:215], v[76:79]
    s_waitcnt lgkmcnt(2)
    v_cvt_pk_bf16_f32 v179, v18, v19
    v_exp_f32 v18, v182
    v_mfma_f32_16x16x32_bf16 v[96:99], v[24:27], a[200:203], v[96:99]
    s_mov_b32 m0, s26
    ds_read_b128 v[40:43], v2 offset:6400
    v_add_f32 v8, v8, v16
    v_mfma_f32_16x16x32_bf16 v[96:99], v[28:31], a[204:207], v[96:99]
    buffer_load_dwordx4 v4, s[4:7], s32 offen offset:0 sc1 lds
    v_add_f32 v8, v8, v17
    v_mfma_f32_16x16x32_bf16 v[100:103], v[24:27], a[224:227], v[100:103]
    v_exp_f32 v19, v183
    v_mfma_f32_16x16x32_bf16 v[100:103], v[28:31], a[228:231], v[100:103]
    v_cvt_pk_bf16_f32 v180, v16, v17
    v_exp_f32 v16, v116
    v_mfma_f32_16x16x32_bf16 v[104:107], v[24:27], a[248:251], v[104:107]
    ds_read_b128 v[44:47], v3 offset:6400
    v_add_f32 v8, v8, v18
    v_mfma_f32_16x16x32_bf16 v[104:107], v[28:31], a[252:255], v[104:107]
    buffer_load_dwordx4 v4, s[4:7], s32 offen offset:1024 sc1 lds
    v_add_f32 v8, v8, v19
    v_mfma_f32_16x16x32_bf16 v[108:111], v[24:27], v[208:211], v[108:111]
    v_exp_f32 v17, v117
    v_mfma_f32_16x16x32_bf16 v[108:111], v[28:31], v[212:215], v[108:111]
    s_waitcnt lgkmcnt(2)
    v_cvt_pk_bf16_f32 v181, v18, v19
    v_exp_f32 v18, v118
    v_mfma_f32_16x16x32_bf16 v[64:67], v[32:35], a[208:211], v[64:67]
    ds_read_b128 v[24:27], v2 offset:12288
    v_add_f32 v8, v8, v16
    v_mfma_f32_16x16x32_bf16 v[64:67], v[36:39], a[212:215], v[64:67]
    buffer_load_dwordx4 v4, s[4:7], s32 offen offset:2048 sc1 lds
    v_add_f32 v8, v8, v17
    v_mfma_f32_16x16x32_bf16 v[68:71], v[32:35], a[232:235], v[68:71]
    s_add_u32 s32, s32, 24576
    v_exp_f32 v19, v119
    v_mfma_f32_16x16x32_bf16 v[68:71], v[36:39], a[236:239], v[68:71]
    v_cvt_pk_bf16_f32 v182, v16, v17
    v_add_f32 v8, v8, v18
    v_add_f32 v8, v8, v19
    v_mfma_f32_16x16x32_bf16 v[72:75], v[32:35], v[192:195], v[72:75]
    s_sub_u32 s57, s32, 196608
    ds_read_b128 v[28:31], v3 offset:12288
    v_cvt_pk_bf16_f32 v183, v18, v19
    v_mfma_f32_16x16x32_bf16 v[72:75], v[36:39], v[196:199], v[72:75]
    s_waitcnt lgkmcnt(2)
    v_exp_f32 v16, v184
    v_lshlrev_b32 v48, 16, v56
    v_mfma_f32_16x16x32_bf16 v[76:79], v[32:35], v[216:219], v[76:79]
    s_waitcnt vmcnt(9)
    v_exp_f32 v17, v185
    v_mfma_f32_16x16x32_bf16 v[76:79], v[36:39], v[220:223], v[76:79]
    s_barrier
    v_exp_f32 v18, v186
    v_mfma_f32_16x16x32_bf16 v[96:99], v[40:43], a[208:211], v[96:99]
    s_min_u32 s32, s32, s57
    ds_read_b128 v[32:35], v2 offset:18432
    v_add_f32 v7, v7, v16
    v_mfma_f32_16x16x32_bf16 v[96:99], v[44:47], a[212:215], v[96:99]
    v_add_f32 v7, v7, v17
    v_exp_f32 v19, v187
    v_mfma_f32_16x16x32_bf16 v[100:103], v[40:43], a[232:235], v[100:103]
    s_add_u32 s26, s26, 12288
    v_cvt_pk_bf16_f32 v184, v16, v17
    v_and_b32 v49, s97, v56
    v_mfma_f32_16x16x32_bf16 v[100:103], v[44:47], a[236:239], v[100:103]
    v_exp_f32 v16, v120
    v_add_f32 v7, v7, v18
    v_mfma_f32_16x16x32_bf16 v[104:107], v[40:43], v[192:195], v[104:107]
    s_mov_b32 m0, s26
    ds_read_b128 v[36:39], v3 offset:18432
    v_add_f32 v7, v7, v19
    v_mfma_f32_16x16x32_bf16 v[104:107], v[44:47], v[196:199], v[104:107]
    buffer_load_dwordx4 v4, s[4:7], s32 offen offset:0 sc1 lds
    v_lshlrev_b32 v50, 16, v58
    v_mfma_f32_16x16x32_bf16 v[108:111], v[40:43], v[216:219], v[108:111]
    v_exp_f32 v17, v121
    v_mfma_f32_16x16x32_bf16 v[108:111], v[44:47], v[220:223], v[108:111]
    s_waitcnt lgkmcnt(2)
    v_cvt_pk_bf16_f32 v185, v18, v19
    v_exp_f32 v18, v122
    v_mfma_f32_16x16x32_bf16 v[80:83], v[24:27], a[192:195], v[128:131]
    ds_read_b128 v[40:43], v2 offset:12416
    v_add_f32 v7, v7, v16
    v_mfma_f32_16x16x32_bf16 v[80:83], v[28:31], a[196:199], v[80:83]
    buffer_load_dwordx4 v4, s[4:7], s32 offen offset:1024 sc1 lds
    v_add_f32 v7, v7, v17
    v_mfma_f32_16x16x32_bf16 v[84:87], v[24:27], a[216:219], v[132:135]
    v_exp_f32 v19, v123
    v_mfma_f32_16x16x32_bf16 v[84:87], v[28:31], a[220:223], v[84:87]
    v_cvt_pk_bf16_f32 v186, v16, v17
    v_exp_f32 v16, v188
    v_mfma_f32_16x16x32_bf16 v[88:91], v[24:27], a[240:243], v[136:139]
L_iw2:
L_pg2:
    s_cbranch_execz L_pg6
    ds_read_b128 v[44:47], v3 offset:12416
    v_add_f32 v7, v7, v18
    v_mfma_f32_16x16x32_bf16 v[88:91], v[28:31], a[244:247], v[88:91]
    v_add_u32 v0, 1, v0
    buffer_store_dword v0, v13, s[20:23], 0 offen offset:32 sc1
    v_mfma_f32_16x16x32_bf16 v[92:95], v[24:27], v[200:203], v[140:143]
    v_add_f32 v7, v7, v19
    v_exp_f32 v17, v189
    v_cvt_pk_bf16_f32 v187, v18, v19
    v_exp_f32 v18, v190
    v_add_f32 v8, v8, v16
    v_add_f32 v8, v8, v17
    v_exp_f32 v19, v191
    v_cvt_pk_bf16_f32 v188, v16, v17
    v_exp_f32 v16, v124
    v_add_f32 v8, v8, v18
    v_add_f32 v8, v8, v19
    v_exp_f32 v17, v125
    v_cvt_pk_bf16_f32 v189, v18, v19
    v_exp_f32 v18, v126
    v_add_f32 v8, v8, v16
    v_add_f32 v8, v8, v17
    v_exp_f32 v19, v127
    v_cvt_pk_bf16_f32 v190, v16, v17
    v_add_f32 v8, v8, v18
    v_add_f32 v8, v8, v19
    v_cvt_pk_bf16_f32 v191, v18, v19
    v_mfma_f32_16x16x32_bf16 v[92:95], v[28:31], v[204:207], v[92:95]
    s_waitcnt lgkmcnt(2)
    v_and_b32 v51, s97, v58
    v_mul_f32_e64 v50, -v50, v48
    v_mul_f32_e64 v51, -v51, v49
    v_mfma_f32_16x16x32_bf16 v[112:115], v[32:35], a[192:195], v[128:131]
    ds_read_b128 v[24:27], v2 offset:18560
    v_cvt_f32_i32 v144, v144
    v_mfma_f32_16x16x32_bf16 v[112:115], v[36:39], a[196:199], v[112:115]
    buffer_load_dwordx4 v4, s[4:7], s32 offen offset:2048 sc1 lds
    v_cvt_f32_i32 v148, v148
    v_mfma_f32_16x16x32_bf16 v[116:119], v[32:35], a[216:219], v[132:135]
    s_mov_b32 s32, 196608
    v_fma_f32 v144, v144, v48, v50
    v_fma_f32 v148, v148, v49, v51
    v_mfma_f32_16x16x32_bf16 v[116:119], v[36:39], a[220:223], v[116:119]
    v_cvt_f32_i32 v145, v145
    v_cvt_f32_i32 v149, v149
    v_fma_f32 v145, v145, v48, v50
    v_mfma_f32_16x16x32_bf16 v[120:123], v[32:35], a[240:243], v[136:139]
    s_add_u32 s26, s26, 36864
    ds_read_b128 v[28:31], v3 offset:18560
    v_fma_f32 v149, v149, v49, v51
    v_mfma_f32_16x16x32_bf16 v[120:123], v[36:39], a[244:247], v[120:123]
    v_cvt_f32_i32 v146, v146
    v_cvt_f32_i32 v150, v150
    v_fma_f32 v146, v146, v48, v50
    v_mfma_f32_16x16x32_bf16 v[124:127], v[32:35], v[200:203], v[140:143]
    s_sub_u32 s57, s26, 147456
    v_exp_f32 v16, v64
    v_mfma_f32_16x16x32_bf16 v[124:127], v[36:39], v[204:207], v[124:127]
    s_waitcnt lgkmcnt(2)
    v_exp_f32 v17, v65
    v_fma_f32 v150, v150, v49, v51
    v_mfma_f32_16x16x32_bf16 v[80:83], v[40:43], a[200:203], v[80:83]
    s_min_u32 s26, s26, s57
    ds_read_b128 v[32:35], v2 offset:12544
    v_lshlrev_b32 v48, 16, v57
    v_mfma_f32_16x16x32_bf16 v[80:83], v[44:47], a[204:207], v[80:83]
    v_exp_f32 v18, v66
    v_add_f32 v5, v5, v16
    v_mfma_f32_16x16x32_bf16 v[84:87], v[40:43], a[224:227], v[84:87]
    s_mov_b32 m0, s56
    v_add_f32 v5, v5, v17
    v_and_b32 v49, s97, v57
    v_mfma_f32_16x16x32_bf16 v[84:87], v[44:47], a[228:231], v[84:87]
    buffer_load_dwordx4 v4, s[4:7], s27 offen offset:0 sc1 lds
    v_lshlrev_b32 v50, 16, v59
    v_mfma_f32_16x16x32_bf16 v[88:91], v[40:43], a[248:251], v[88:91]
    ds_read_b128 v[36:39], v3 offset:12544
    v_and_b32 v51, s97, v59
    v_mfma_f32_16x16x32_bf16 v[88:91], v[44:47], a[252:255], v[88:91]
    v_exp_f32 v19, v67
    v_cvt_pk_bf16_f32 v64, v16, v17
    v_mfma_f32_16x16x32_bf16 v[92:95], v[40:43], v[208:211], v[92:95]
    v_exp_f32 v16, v96
    v_mfma_f32_16x16x32_bf16 v[92:95], v[44:47], v[212:215], v[92:95]
    s_waitcnt lgkmcnt(2)
    buffer_load_dwordx4 v4, s[4:7], s27 offen offset:1024 sc1 lds
    v_add_f32 v5, v5, v18
    v_mfma_f32_16x16x32_bf16 v[112:115], v[24:27], a[200:203], v[112:115]
    ds_read_b128 v[40:43], v2 offset:18688
    v_add_f32 v5, v5, v19
    v_mfma_f32_16x16x32_bf16 v[112:115], v[28:31], a[204:207], v[112:115]
    v_exp_f32 v17, v97
    v_mul_f32_e64 v50, -v50, v48
    v_mfma_f32_16x16x32_bf16 v[116:119], v[24:27], a[224:227], v[116:119]
    v_cvt_pk_bf16_f32 v65, v18, v19
    v_mul_f32_e64 v51, -v51, v49
    v_mfma_f32_16x16x32_bf16 v[116:119], v[28:31], a[228:231], v[116:119]
    s_waitcnt vmcnt(13)
    buffer_load_dwordx4 v4, s[4:7], s27 offen offset:2048 sc1 lds
    v_cvt_f32_i32 v152, v152
    v_mfma_f32_16x16x32_bf16 v[120:123], v[24:27], a[248:251], v[120:123]
    s_add_u32 s27, s27, 24576
    ds_read_b128 v[44:47], v3 offset:18688
    v_cvt_f32_i32 v156, v156
    v_mfma_f32_16x16x32_bf16 v[120:123], v[28:31], a[252:255], v[120:123]
    s_waitcnt lgkmcnt(2)
    v_exp_f32 v18, v98
    v_add_f32 v5, v5, v16
    v_mfma_f32_16x16x32_bf16 v[124:127], v[24:27], v[208:211], v[124:127]
    s_sub_u32 s58, s27, 196608
    v_add_f32 v5, v5, v17
    v_fma_f32 v152, v152, v48, v50
    v_mfma_f32_16x16x32_bf16 v[124:127], v[28:31], v[212:215], v[124:127]
    s_barrier
    v_subrev_u32 v1, 49152, v1
    v_fma_f32 v156, v156, v49, v51
    v_mfma_f32_16x16x32_bf16 v[80:83], v[32:35], a[208:211], v[80:83]
    s_min_u32 s27, s27, s58
    ds_read_b128 v[24:27], v1 offset:0
    v_cvt_f32_i32 v153, v153
    v_mfma_f32_16x16x32_bf16 v[80:83], v[36:39], a[212:215], v[80:83]
    v_exp_f32 v19, v99
    v_cvt_pk_bf16_f32 v66, v16, v17
    v_mfma_f32_16x16x32_bf16 v[84:87], v[32:35], a[232:235], v[84:87]
    s_add_u32 s56, s56, 12288
    v_exp_f32 v16, v68
    v_mfma_f32_16x16x32_bf16 v[84:87], v[36:39], a[236:239], v[84:87]
    v_add_f32 v5, v5, v18
    v_add_f32 v5, v5, v19
    v_cvt_f32_i32 v157, v157
    v_mfma_f32_16x16x32_bf16 v[88:91], v[32:35], v[192:195], v[88:91]
    s_mov_b32 m0, s56
    ds_read_b128 v[28:31], v1 offset:12288
    v_fma_f32 v153, v153, v48, v50
    v_mfma_f32_16x16x32_bf16 v[88:91], v[36:39], v[196:199], v[88:91]
    s_waitcnt vmcnt(12)
    buffer_load_dwordx4 v4, s[4:7], s27 offen offset:0 sc1 lds
    v_mfma_f32_16x16x32_bf16 v[92:95], v[32:35], v[216:219], v[92:95]
    v_exp_f32 v17, v69
    v_mfma_f32_16x16x32_bf16 v[92:95], v[36:39], v[220:223], v[92:95]
    s_waitcnt lgkmcnt(2)
    v_cvt_pk_bf16_f32 v67, v18, v19
    v_exp_f32 v18, v70
    v_mfma_f32_16x16x32_bf16 v[112:115], v[40:43], a[208:211], v[112:115]
    ds_read_b128 v[32:35], v1 offset:1024
    v_add_f32 v6, v6, v16
    v_mfma_f32_16x16x32_bf16 v[112:115], v[44:47], a[212:215], v[112:115]
    s_waitcnt vmcnt(12)
    buffer_load_dwordx4 v4, s[4:7], s27 offen offset:1024 sc1 lds
    v_add_f32 v6, v6, v17
    v_mfma_f32_16x16x32_bf16 v[116:119], v[40:43], a[232:235], v[116:119]
    s_waitcnt vmcnt(12)
    buffer_load_dwordx4 v4, s[4:7], s27 offen offset:2048 sc1 lds
    v_mfma_f32_16x16x32_bf16 v[116:119], v[44:47], a[236:239], v[116:119]
    v_exp_f32 v19, v71
    v_cvt_pk_bf16_f32 v68, v16, v17
    v_mfma_f32_16x16x32_bf16 v[120:123], v[40:43], v[192:195], v[120:123]
    s_add_u32 s27, s27, 24576
    ds_read_b128 v[36:39], v1 offset:13312
    v_fma_f32 v157, v157, v49, v51
    v_mfma_f32_16x16x32_bf16 v[120:123], v[44:47], v[196:199], v[120:123]
    v_exp_f32 v16, v100
    v_add_f32 v6, v6, v18
    v_mfma_f32_16x16x32_bf16 v[124:127], v[40:43], v[216:219], v[124:127]
    s_sub_u32 s58, s27, 196608
    v_add_f32 v6, v6, v19
    v_cvt_f32_i32 v154, v154
    v_mfma_f32_16x16x32_bf16 v[124:127], v[44:47], v[220:223], v[124:127]
    s_waitcnt lgkmcnt(2)
    v_exp_f32 v17, v101
    v_cvt_pk_bf16_f32 v69, v18, v19
    v_exp_f32 v18, v102
    v_cvt_f32_i32 v158, v158
    v_add_f32 v6, v6, v16
    v_fma_f32 v154, v154, v48, v50
    v_add_f32 v6, v6, v17
    v_fma_f32 v158, v158, v49, v51
    v_exp_f32 v19, v103
    v_cvt_pk_bf16_f32 v144, v144, v148
    v_cvt_pk_bf16_f32 v148, v145, v149
    v_cvt_pk_bf16_f32 v70, v16, v17
    s_min_u32 s27, s27, s58
    v_cvt_pk_bf16_f32 v145, v152, v156
    v_add_f32 v6, v6, v18
    s_add_u32 s56, s56, 36864
    v_cvt_pk_bf16_f32 v149, v153, v157
    v_add_f32 v6, v6, v19
    s_sub_u32 s58, s56, 147456
    v_cvt_pk_bf16_f32 v152, v146, v150
    v_cvt_pk_bf16_f32 v71, v18, v19
    s_min_u32 s56, s56, s58
    v_cvt_pk_bf16_f32 v153, v154, v158
    s_mov_b32 s31, 6
    s_mul_i32 s46, s95, 24576
    s_mov_b32 s47, 12288
    v_mfma_f32_16x16x32_bf16 a[96:99], v[160:163], v[24:27], 0
    s_add_u32 s33, s33, 196608
    ds_read_b128 v[40:43], v1 offset:2048
    v_mfma_f32_16x16x32_bf16 a[96:99], v[168:171], v[28:31], a[96:99]
    s_add_u32 s34, s34, 196608
    v_exp_f32 v16, v72
    v_mfma_f32_16x16x32_bf16 a[144:147], v[164:167], v[24:27], 0
    s_add_u32 s36, s36, 1536
    ds_read_b128 v[44:47], v1 offset:14336
    v_mfma_f32_16x16x32_bf16 a[144:147], v[172:175], v[28:31], a[144:147]
    s_waitcnt lgkmcnt(2)
    v_exp_f32 v17, v73
    v_mfma_f32_16x16x32_bf16 a[100:103], v[160:163], v[32:35], 0
    ds_read_b128 v[24:27], v1 offset:3072
    v_mfma_f32_16x16x32_bf16 a[100:103], v[168:171], v[36:39], a[100:103]
    s_waitcnt vmcnt(12)
    buffer_load_dwordx2 v[56:57], v10, s[72:75], s36 offen offset:0
    v_mfma_f32_16x16x32_bf16 a[148:151], v[164:167], v[32:35], 0
    ds_read_b128 v[28:31], v1 offset:15360
    v_mfma_f32_16x16x32_bf16 a[148:151], v[172:175], v[36:39], a[148:151]
    s_waitcnt lgkmcnt(2)
    v_exp_f32 v18, v74
    v_mfma_f32_16x16x32_bf16 a[104:107], v[160:163], v[40:43], 0
    ds_read_b128 v[32:35], v1 offset:4096
    v_add_f32 v7, v7, v16
    v_mfma_f32_16x16x32_bf16 a[104:107], v[168:171], v[44:47], a[104:107]
    buffer_load_dwordx2 v[58:59], v10, s[76:79], s36 offen offset:0
    v_mfma_f32_16x16x32_bf16 a[152:155], v[164:167], v[40:43], 0
    ds_read_b128 v[36:39], v1 offset:16384
    v_add_f32 v7, v7, v17
    v_mfma_f32_16x16x32_bf16 a[152:155], v[172:175], v[44:47], a[152:155]
    s_waitcnt lgkmcnt(2)
    v_exp_f32 v19, v75
    v_mfma_f32_16x16x32_bf16 a[108:111], v[160:163], v[24:27], 0
    ds_read_b128 v[40:43], v1 offset:5120
    v_cvt_pk_bf16_f32 v72, v16, v17
    v_mfma_f32_16x16x32_bf16 a[108:111], v[168:171], v[28:31], a[108:111]
    s_waitcnt vmcnt(13)
    buffer_load_dwordx4 v[224:227], v9, s[64:67], s33 offen offset:0 nt
    v_mfma_f32_16x16x32_bf16 a[156:159], v[164:167], v[24:27], 0
    ds_read_b128 v[44:47], v1 offset:17408
    v_mfma_f32_16x16x32_bf16 a[156:159], v[172:175], v[28:31], a[156:159]
    s_waitcnt lgkmcnt(2)
    v_exp_f32 v16, v104
    v_mfma_f32_16x16x32_bf16 a[112:115], v[160:163], v[32:35], 0
    ds_read_b128 v[24:27], v1 offset:6144
    v_add_f32 v7, v7, v18
    v_mfma_f32_16x16x32_bf16 a[112:115], v[168:171], v[36:39], a[112:115]
    s_waitcnt vmcnt(13)
    buffer_load_dwordx4 v[228:231], v9, s[64:67], s33 offen offset:1536 nt
    v_add_f32 v7, v7, v19
    v_mfma_f32_16x16x32_bf16 a[160:163], v[164:167], v[32:35], 0
    ds_read_b128 v[28:31], v1 offset:18432
    v_mfma_f32_16x16x32_bf16 a[160:163], v[172:175], v[36:39], a[160:163]
    s_waitcnt lgkmcnt(2)
    v_exp_f32 v17, v105
    v_cvt_pk_bf16_f32 v73, v18, v19
    v_mfma_f32_16x16x32_bf16 a[116:119], v[160:163], v[40:43], 0
    ds_read_b128 v[32:35], v1 offset:7168
    v_mfma_f32_16x16x32_bf16 a[116:119], v[168:171], v[44:47], a[116:119]
    buffer_load_dwordx4 v[232:235], v9, s[64:67], s34 offen offset:0 nt
    v_mfma_f32_16x16x32_bf16 a[164:167], v[164:167], v[40:43], 0
    ds_read_b128 v[36:39], v1 offset:19456
    v_mfma_f32_16x16x32_bf16 a[164:167], v[172:175], v[44:47], a[164:167]
    s_waitcnt lgkmcnt(2)
    v_exp_f32 v18, v106
    v_add_f32 v7, v7, v16
    v_mfma_f32_16x16x32_bf16 a[120:123], v[160:163], v[24:27], 0
    ds_read_b128 v[40:43], v1 offset:8192
    v_add_f32 v7, v7, v17
    v_mfma_f32_16x16x32_bf16 a[120:123], v[168:171], v[28:31], a[120:123]
    s_waitcnt vmcnt(14)
    buffer_load_dwordx4 v[236:239], v9, s[64:67], s34 offen offset:1536 nt
    v_mfma_f32_16x16x32_bf16 a[168:171], v[164:167], v[24:27], 0
    ds_read_b128 v[44:47], v1 offset:20480
    v_mfma_f32_16x16x32_bf16 a[168:171], v[172:175], v[28:31], a[168:171]
    s_waitcnt lgkmcnt(2)
    v_exp_f32 v19, v107
    v_cvt_pk_bf16_f32 v74, v16, v17
    v_mfma_f32_16x16x32_bf16 a[124:127], v[160:163], v[32:35], 0
    ds_read_b128 v[24:27], v1 offset:9216
    v_mfma_f32_16x16x32_bf16 a[124:127], v[168:171], v[36:39], a[124:127]
    v_exp_f32 v16, v76
    v_add_f32 v7, v7, v18
    v_mfma_f32_16x16x32_bf16 a[172:175], v[164:167], v[32:35], 0
    s_waitcnt vmcnt(19)
    ds_read_b128 v[28:31], v1 offset:21504
    v_add_f32 v7, v7, v19
    v_mfma_f32_16x16x32_bf16 a[172:175], v[172:175], v[36:39], a[172:175]
    s_waitcnt lgkmcnt(2)
    v_exp_f32 v17, v77
    v_cvt_pk_bf16_f32 v75, v18, v19
    v_mfma_f32_16x16x32_bf16 a[128:131], v[160:163], v[40:43], 0
    s_add_u32 s29, s28, 49152
    ds_read_b128 v[32:35], v1 offset:10240
    v_lshlrev_b32 v48, 16, v60
    v_mfma_f32_16x16x32_bf16 a[128:131], v[168:171], v[44:47], a[128:131]
    v_exp_f32 v18, v78
    v_add_f32 v8, v8, v16
    v_mfma_f32_16x16x32_bf16 a[176:179], v[164:167], v[40:43], 0
    s_sub_u32 s3, s29, 147456
    ds_read_b128 v[36:39], v1 offset:22528
    v_add_f32 v8, v8, v17
    v_mfma_f32_16x16x32_bf16 a[176:179], v[172:175], v[44:47], a[176:179]
    s_waitcnt lgkmcnt(2)
    v_exp_f32 v19, v79
    v_mfma_f32_16x16x32_bf16 a[132:135], v[160:163], v[24:27], 0
    s_min_u32 s29, s29, s3
    ds_read_b128 v[40:43], v1 offset:11264
    v_cvt_pk_bf16_f32 v76, v16, v17
    v_mfma_f32_16x16x32_bf16 a[132:135], v[168:171], v[28:31], a[132:135]
    v_exp_f32 v16, v108
    v_mfma_f32_16x16x32_bf16 a[180:183], v[164:167], v[24:27], 0
    s_sub_u32 s3, s29, s28
    ds_read_b128 v[44:47], v1 offset:23552
    v_add_f32 v8, v8, v18
    v_mfma_f32_16x16x32_bf16 a[180:183], v[172:175], v[28:31], a[180:183]
    s_waitcnt lgkmcnt(2)
    v_add_u32 v1, 49152, v1
    v_add_f32 v8, v8, v19
    v_mfma_f32_16x16x32_bf16 a[136:139], v[160:163], v[32:35], 0
    ds_read_b128 v[24:27], v1 offset:0
    v_and_b32 v49, s97, v60
    v_mfma_f32_16x16x32_bf16 a[136:139], v[168:171], v[36:39], a[136:139]
    v_exp_f32 v17, v109
    v_mfma_f32_16x16x32_bf16 a[184:187], v[164:167], v[32:35], 0
    ds_read_b128 v[28:31], v1 offset:12288
    v_cvt_pk_bf16_f32 v77, v18, v19
    v_mfma_f32_16x16x32_bf16 a[184:187], v[172:175], v[36:39], a[184:187]
    s_waitcnt lgkmcnt(2)
    v_lshlrev_b32 v50, 16, v62
    v_and_b32 v51, s97, v62
    v_mfma_f32_16x16x32_bf16 a[140:143], v[160:163], v[40:43], 0
    s_mov_b32 s28, s29
    ds_read_b128 v[32:35], v1 offset:1024
    v_bfe_u32 v53, v4, 4, 6
    v_mfma_f32_16x16x32_bf16 a[140:143], v[168:171], v[44:47], a[140:143]
    v_exp_f32 v18, v110
    v_add_f32 v8, v8, v16
    v_mfma_f32_16x16x32_bf16 a[188:191], v[164:167], v[40:43], 0
    ds_read_b128 v[36:39], v1 offset:13312
    v_lshlrev_b32 v53, 2, v53
    v_mfma_f32_16x16x32_bf16 a[188:191], v[172:175], v[44:47], a[188:191]
    s_waitcnt lgkmcnt(2)
    s_barrier
    v_add_f32 v8, v8, v17
    v_mfma_f32_16x16x32_bf16 a[96:99], v[176:179], v[24:27], a[96:99]
    ds_read_b128 v[40:43], v1 offset:2048
    buffer_load_dword v52, v53, s[20:23], s44 offen sc1
    v_mfma_f32_16x16x32_bf16 a[96:99], v[184:187], v[28:31], a[96:99]
    v_exp_f32 v19, v111
    v_mul_f32_e64 v50, -v50, v48
    v_mfma_f32_16x16x32_bf16 a[144:147], v[180:183], v[24:27], a[144:147]
    ds_read_b128 v[44:47], v1 offset:14336
    v_cvt_pk_bf16_f32 v78, v16, v17
    v_mfma_f32_16x16x32_bf16 a[144:147], v[188:191], v[28:31], a[144:147]
    s_waitcnt lgkmcnt(2)
    v_mul_f32_e64 v51, -v51, v49
    v_add_f32 v8, v8, v18
    v_cvt_f32_i32 v240, v240
    v_mfma_f32_16x16x32_bf16 a[100:103], v[176:179], v[32:35], a[100:103]
    s_mov_b32 m0, s56
    ds_read_b128 v[24:27], v1 offset:3072
    v_add_f32 v8, v8, v19
    v_mfma_f32_16x16x32_bf16 a[100:103], v[184:187], v[36:39], a[100:103]
    s_waitcnt vmcnt(15)
    buffer_load_dwordx4 v4, s[4:7], s27 offen offset:0 sc1 lds
    v_cvt_pk_bf16_f32 v79, v18, v19
    v_mfma_f32_16x16x32_bf16 a[148:151], v[180:183], v[32:35], a[148:151]
    ds_read_b128 v[28:31], v1 offset:15360
    v_cvt_f32_i32 v244, v244
    v_mfma_f32_16x16x32_bf16 a[148:151], v[188:191], v[36:39], a[148:151]
    s_waitcnt lgkmcnt(2)
    v_exp_f32 v16, v80
    v_fma_f32 v240, v240, v48, v50
    v_mfma_f32_16x16x32_bf16 a[104:107], v[176:179], v[40:43], a[104:107]
    ds_read_b128 v[32:35], v1 offset:4096
    v_fma_f32 v244, v244, v49, v51
    v_mfma_f32_16x16x32_bf16 a[104:107], v[184:187], v[44:47], a[104:107]
    s_waitcnt vmcnt(14)
    buffer_load_dwordx4 v4, s[4:7], s27 offen offset:1024 sc1 lds
    v_cvt_f32_i32 v241, v241
    v_mfma_f32_16x16x32_bf16 a[152:155], v[180:183], v[40:43], a[152:155]
    ds_read_b128 v[36:39], v1 offset:16384
    v_cvt_f32_i32 v245, v245
    v_mfma_f32_16x16x32_bf16 a[152:155], v[188:191], v[44:47], a[152:155]
    s_waitcnt lgkmcnt(2)
    v_exp_f32 v17, v81
    v_fma_f32 v241, v241, v48, v50
    v_mfma_f32_16x16x32_bf16 a[108:111], v[176:179], v[24:27], a[108:111]
    ds_read_b128 v[40:43], v1 offset:5120
    v_fma_f32 v245, v245, v49, v51
    v_mfma_f32_16x16x32_bf16 a[108:111], v[184:187], v[28:31], a[108:111]
    s_waitcnt vmcnt(14)
    buffer_load_dwordx4 v4, s[4:7], s27 offen offset:2048 sc1 lds
    v_cvt_f32_i32 v242, v242
    v_mfma_f32_16x16x32_bf16 a[156:159], v[180:183], v[24:27], a[156:159]
    s_add_u32 s27, s27, 24576
    ds_read_b128 v[44:47], v1 offset:17408
    v_cvt_f32_i32 v246, v246
    v_mfma_f32_16x16x32_bf16 a[156:159], v[188:191], v[28:31], a[156:159]
    s_waitcnt lgkmcnt(2)
    v_exp_f32 v18, v82
    v_add_f32 v5, v5, v16
    v_mfma_f32_16x16x32_bf16 a[112:115], v[176:179], v[32:35], a[112:115]
    s_sub_u32 s58, s27, 196608
    ds_read_b128 v[24:27], v1 offset:6144
    v_add_f32 v5, v5, v17
    v_mfma_f32_16x16x32_bf16 a[112:115], v[184:187], v[36:39], a[112:115]
    v_exp_f32 v19, v83
    v_cvt_pk_bf16_f32 v80, v16, v17
    v_mfma_f32_16x16x32_bf16 a[160:163], v[180:183], v[32:35], a[160:163]
    s_min_u32 s27, s27, s58
    ds_read_b128 v[28:31], v1 offset:18432
    v_fma_f32 v242, v242, v48, v50
    v_mfma_f32_16x16x32_bf16 a[160:163], v[188:191], v[36:39], a[160:163]
    s_waitcnt lgkmcnt(2)
    v_exp_f32 v16, v112
    v_add_f32 v5, v5, v18
    v_mfma_f32_16x16x32_bf16 a[116:119], v[176:179], v[40:43], a[116:119]
    s_add_u32 s56, s56, 12288
    ds_read_b128 v[32:35], v1 offset:7168
    v_add_f32 v5, v5, v19
    v_mfma_f32_16x16x32_bf16 a[116:119], v[184:187], v[44:47], a[116:119]
    v_exp_f32 v17, v113
    v_cvt_pk_bf16_f32 v81, v18, v19
    v_mfma_f32_16x16x32_bf16 a[164:167], v[180:183], v[40:43], a[164:167]
    ds_read_b128 v[36:39], v1 offset:19456
    v_add_u32 v2, s3, v2
    v_add_u32 v3, s3, v3
    v_mfma_f32_16x16x32_bf16 a[164:167], v[188:191], v[44:47], a[164:167]
    s_waitcnt lgkmcnt(2)
    v_exp_f32 v18, v114
    v_fma_f32 v246, v246, v49, v51
    v_mfma_f32_16x16x32_bf16 a[120:123], v[176:179], v[24:27], a[120:123]
    s_mov_b32 m0, s56
    ds_read_b128 v[40:43], v1 offset:8192
    v_add_f32 v5, v5, v16
    v_mfma_f32_16x16x32_bf16 a[120:123], v[184:187], v[28:31], a[120:123]
    s_waitcnt vmcnt(14)
    buffer_load_dwordx4 v4, s[4:7], s27 offen offset:0 sc1 lds
    v_add_f32 v5, v5, v17
    v_mfma_f32_16x16x32_bf16 a[168:171], v[180:183], v[24:27], a[168:171]
    ds_read_b128 v[44:47], v1 offset:20480
    v_lshlrev_b32 v48, 16, v61
    v_mfma_f32_16x16x32_bf16 a[168:171], v[188:191], v[28:31], a[168:171]
    s_waitcnt lgkmcnt(2)
    v_exp_f32 v19, v115
    v_and_b32 v49, s97, v61
    v_mfma_f32_16x16x32_bf16 a[124:127], v[176:179], v[32:35], a[124:127]
    ds_read_b128 v[24:27], v1 offset:9216
    v_cvt_pk_bf16_f32 v82, v16, v17
    v_mfma_f32_16x16x32_bf16 a[124:127], v[184:187], v[36:39], a[124:127]
    s_waitcnt vmcnt(14)
    buffer_load_dwordx4 v4, s[4:7], s27 offen offset:1024 sc1 lds
    v_lshlrev_b32 v50, 16, v63
    v_mfma_f32_16x16x32_bf16 a[172:175], v[180:183], v[32:35], a[172:175]
    ds_read_b128 v[28:31], v1 offset:21504
    v_and_b32 v51, s97, v63
    v_mfma_f32_16x16x32_bf16 a[172:175], v[188:191], v[36:39], a[172:175]
    s_waitcnt lgkmcnt(2)
    v_exp_f32 v16, v84
    v_add_f32 v5, v5, v18
    v_mfma_f32_16x16x32_bf16 a[128:131], v[176:179], v[40:43], a[128:131]
    ds_read_b128 v[32:35], v1 offset:10240
    v_add_f32 v5, v5, v19
    v_mfma_f32_16x16x32_bf16 a[128:131], v[184:187], v[44:47], a[128:131]
    s_waitcnt vmcnt(14)
    buffer_load_dwordx4 v4, s[4:7], s27 offen offset:2048 sc1 lds
    v_mul_f32_e64 v50, -v50, v48
    v_mfma_f32_16x16x32_bf16 a[176:179], v[180:183], v[40:43], a[176:179]
    ds_read_b128 v[36:39], v1 offset:22528
    v_mul_f32_e64 v51, -v51, v49
    v_mfma_f32_16x16x32_bf16 a[176:179], v[188:191], v[44:47], a[176:179]
    s_waitcnt lgkmcnt(2)
    v_exp_f32 v17, v85
    v_cvt_pk_bf16_f32 v83, v18, v19
    v_mfma_f32_16x16x32_bf16 a[132:135], v[176:179], v[24:27], a[132:135]
    ds_read_b128 v[40:43], v1 offset:11264
    v_cvt_f32_i32 v248, v248
    v_mfma_f32_16x16x32_bf16 a[132:135], v[184:187], v[28:31], a[132:135]
    s_waitcnt vmcnt(19)
    v_exp_f32 v18, v86
    v_add_f32 v6, v6, v16
    v_mfma_f32_16x16x32_bf16 a[180:183], v[180:183], v[24:27], a[180:183]
    s_mov_b32 s27, 208896
    ds_read_b128 v[44:47], v1 offset:23552
    v_cvt_f32_i32 v252, v252
    v_mfma_f32_16x16x32_bf16 a[180:183], v[188:191], v[28:31], a[180:183]
    s_waitcnt lgkmcnt(2)
    s_barrier
    v_add_f32 v6, v6, v17
    v_mfma_f32_16x16x32_bf16 a[136:139], v[176:179], v[32:35], a[136:139]
    s_add_u32 s56, s56, 36864
    ds_read_b128 v[24:27], v2 offset:0
    v_fma_f32 v248, v248, v48, v50
    v_mfma_f32_16x16x32_bf16 a[136:139], v[184:187], v[36:39], a[136:139]
    v_exp_f32 v19, v87
    v_cvt_pk_bf16_f32 v84, v16, v17
    v_mfma_f32_16x16x32_bf16 a[184:187], v[180:183], v[32:35], a[184:187]
    s_sub_u32 s58, s56, 147456
    ds_read_b128 v[28:31], v3 offset:0
    v_fma_f32 v252, v252, v49, v51
    v_mfma_f32_16x16x32_bf16 a[184:187], v[188:191], v[36:39], a[184:187]
    s_waitcnt lgkmcnt(2)
    v_exp_f32 v16, v116
    v_cvt_f32_i32 v249, v249
    v_mfma_f32_16x16x32_bf16 a[140:143], v[176:179], v[40:43], a[140:143]
    s_nop 0
    ds_read_b128 v[32:35], v2 offset:6144
    v_add_f32 v6, v6, v18
    v_mfma_f32_16x16x32_bf16 a[140:143], v[184:187], v[44:47], a[140:143]
    s_min_u32 s56, s56, s58
    v_add_f32 v6, v6, v19
    v_cvt_f32_i32 v253, v253
    v_fma_f32 v249, v249, v48, v50
    v_mfma_f32_16x16x32_bf16 a[188:191], v[180:183], v[40:43], a[188:191]
    s_waitcnt lgkmcnt(1)
    ds_read_b128 v[36:39], v3 offset:6144
    v_exp_f32 v17, v117
    v_cvt_pk_bf16_f32 v85, v18, v19
    v_fma_f32 v253, v253, v49, v51
    v_exp_f32 v18, v118
    v_cvt_f32_i32 v250, v250
    v_cvt_f32_i32 v254, v254
    v_add_f32 v6, v6, v16
    v_fma_f32 v250, v250, v48, v50
    v_add_f32 v6, v6, v17
    v_fma_f32 v254, v254, v49, v51
    v_exp_f32 v19, v119
    v_cvt_pk_bf16_f32 v146, v240, v244
    v_cvt_pk_bf16_f32 v150, v241, v245
    v_cvt_pk_bf16_f32 v86, v16, v17
    v_cvt_pk_bf16_f32 v147, v248, v252
    v_add_f32 v6, v6, v18
    v_cvt_pk_bf16_f32 v151, v249, v253
    v_add_f32 v6, v6, v19
    v_cvt_pk_bf16_f32 v154, v242, v246
    v_cvt_pk_bf16_f32 v87, v18, v19
    v_cvt_pk_bf16_f32 v155, v250, v254
    v_mfma_f32_16x16x32_bf16 a[188:191], v[188:191], v[44:47], a[188:191]
    s_branch L_join
.p2align 6
L_loop:
    v_mfma_f32_16x16x32_bf16 v[160:163], v[24:27], a[192:195], v[128:131]
    s_mov_b32 m0, s56
    ds_read_b128 v[40:43], v2 offset:128
    v_cvt_pk_bf16_f32 v227, v242, v243
    v_mfma_f32_16x16x32_bf16 v[160:163], v[28:31], a[196:199], v[160:163]
    buffer_load_dwordx4 v4, s[4:7], s27 offen offset:0 sc1 lds
    v_mfma_f32_16x16x32_bf16 v[164:167], v[24:27], a[216:219], v[132:135]
    v_exp_f32 v16, v88
    v_mfma_f32_16x16x32_bf16 v[164:167], v[28:31], a[220:223], v[164:167]
    v_exp_f32 v17, v89
    v_mfma_f32_16x16x32_bf16 v[168:171], v[24:27], a[240:243], v[136:139]
    ds_read_b128 v[44:47], v3 offset:128
    v_cvt_f32_i32 v246, v246
    v_mfma_f32_16x16x32_bf16 v[168:171], v[28:31], a[244:247], v[168:171]
    v_exp_f32 v18, v90
    v_mfma_f32_16x16x32_bf16 v[172:175], v[24:27], v[200:203], v[140:143]
    v_cvt_f32_i32 v247, v247
    v_add_f32 v7, v7, v16
    v_mfma_f32_16x16x32_bf16 v[172:175], v[28:31], v[204:207], v[172:175]
    s_waitcnt lgkmcnt(2)
    v_add_f32 v7, v7, v17
    v_fma_f32 v246, v246, v48, v50
    v_mfma_f32_16x16x32_bf16 v[96:99], v[32:35], a[192:195], v[128:131]
    ds_read_b128 v[24:27], v2 offset:6272
    v_fma_f32 v247, v247, v49, v51
    v_mfma_f32_16x16x32_bf16 v[96:99], v[36:39], a[196:199], v[96:99]
    buffer_load_dwordx4 v4, s[4:7], s27 offen offset:1024 sc1 lds
    v_mfma_f32_16x16x32_bf16 v[100:103], v[32:35], a[216:219], v[132:135]
    v_exp_f32 v19, v91
    v_mfma_f32_16x16x32_bf16 v[100:103], v[36:39], a[220:223], v[100:103]
    v_cvt_pk_bf16_f32 v88, v16, v17
    v_cvt_pk_bf16_f32 v231, v246, v247
    v_mfma_f32_16x16x32_bf16 v[104:107], v[32:35], a[240:243], v[136:139]
    ds_read_b128 v[28:31], v3 offset:6272
    v_cvt_f32_i32 v250, v250
    v_mfma_f32_16x16x32_bf16 v[104:107], v[36:39], a[244:247], v[104:107]
    v_exp_f32 v16, v120
    v_mfma_f32_16x16x32_bf16 v[108:111], v[32:35], v[200:203], v[140:143]
    v_add_f32 v7, v7, v18
    v_add_f32 v7, v7, v19
    v_mfma_f32_16x16x32_bf16 v[108:111], v[36:39], v[204:207], v[108:111]
    s_waitcnt lgkmcnt(2)
    v_exp_f32 v17, v121
    v_mfma_f32_16x16x32_bf16 v[160:163], v[40:43], a[200:203], v[160:163]
    ds_read_b128 v[32:35], v2 offset:256
    v_cvt_f32_i32 v251, v251
    v_mfma_f32_16x16x32_bf16 v[160:163], v[44:47], a[204:207], v[160:163]
    v_cvt_pk_bf16_f32 v89, v18, v19
    v_fma_f32 v250, v250, v48, v50
    v_mfma_f32_16x16x32_bf16 v[164:167], v[40:43], a[224:227], v[164:167]
    v_exp_f32 v18, v122
    v_mfma_f32_16x16x32_bf16 v[164:167], v[44:47], a[228:231], v[164:167]
    buffer_load_dwordx4 v4, s[4:7], s27 offen offset:2048 sc1 lds
    v_mfma_f32_16x16x32_bf16 v[168:171], v[40:43], a[248:251], v[168:171]
    ds_read_b128 v[36:39], v3 offset:256
    v_fma_f32 v251, v251, v49, v51
    v_mfma_f32_16x16x32_bf16 v[168:171], v[44:47], a[252:255], v[168:171]
    v_add_f32 v7, v7, v16
    v_add_f32 v7, v7, v17
    v_mfma_f32_16x16x32_bf16 v[172:175], v[40:43], v[208:211], v[172:175]
    v_cvt_pk_bf16_f32 v235, v250, v251
    v_cvt_f32_i32 v254, v254
    v_mfma_f32_16x16x32_bf16 v[172:175], v[44:47], v[212:215], v[172:175]
    s_waitcnt lgkmcnt(2)
    v_exp_f32 v19, v123
    v_mfma_f32_16x16x32_bf16 v[96:99], v[24:27], a[200:203], v[96:99]
    ds_read_b128 v[40:43], v2 offset:6400
    v_cvt_pk_bf16_f32 v90, v16, v17
    v_mfma_f32_16x16x32_bf16 v[96:99], v[28:31], a[204:207], v[96:99]
    s_add_u32 s27, s27, 24576
    v_exp_f32 v16, v92
    v_mfma_f32_16x16x32_bf16 v[100:103], v[24:27], a[224:227], v[100:103]
    v_cvt_f32_i32 v255, v255
    v_add_f32 v7, v7, v18
    v_mfma_f32_16x16x32_bf16 v[100:103], v[28:31], a[228:231], v[100:103]
    v_fma_f32 v254, v254, v48, v50
    v_add_f32 v7, v7, v19
    v_mfma_f32_16x16x32_bf16 v[104:107], v[24:27], a[248:251], v[104:107]
    ds_read_b128 v[44:47], v3 offset:6400
    v_fma_f32 v255, v255, v49, v51
    v_mfma_f32_16x16x32_bf16 v[104:107], v[28:31], a[252:255], v[104:107]
    v_exp_f32 v17, v93
    v_mfma_f32_16x16x32_bf16 v[108:111], v[24:27], v[208:211], v[108:111]
    s_add_u32 s29, s30, 49152
    v_cvt_pk_bf16_f32 v239, v254, v255
    v_cvt_pk_bf16_f32 v91, v18, v19
    v_mfma_f32_16x16x32_bf16 v[108:111], v[28:31], v[212:215], v[108:111]
    s_waitcnt lgkmcnt(2)
    v_exp_f32 v18, v94
    v_mfma_f32_16x16x32_bf16 v[160:163], v[32:35], a[208:211], v[160:163]
    s_waitcnt vmcnt(11)
    ds_read_b128 v[24:27], v2 offset:12288
    v_add_f32 v8, v8, v16
    v_mfma_f32_16x16x32_bf16 v[160:163], v[36:39], a[212:215], v[160:163]
    s_sub_u32 s3, s29, 147456
    buffer_load_dwordx2 v[60:61], off, s[80:83], s37 offset:8
    v_mfma_f32_16x16x32_bf16 v[164:167], v[32:35], a[232:235], v[164:167]
L_iw3:
L_pg3:
    s_cbranch_execz L_pg7
    s_add_u32 s56, s56, 12288
    v_add_f32 v8, v8, v17
    v_lshlrev_b32 v48, 16, v56
    v_mfma_f32_16x16x32_bf16 v[164:167], v[36:39], a[236:239], v[164:167]
    s_min_u32 s29, s29, s3
    v_exp_f32 v19, v95
    v_mfma_f32_16x16x32_bf16 v[168:171], v[32:35], v[192:195], v[168:171]
    s_mov_b32 m0, s56
    ds_read_b128 v[28:31], v3 offset:12288
    v_cvt_pk_bf16_f32 v92, v16, v17
    v_mfma_f32_16x16x32_bf16 v[168:171], v[36:39], v[196:199], v[168:171]
    buffer_load_dwordx2 v[62:63], off, s[84:87], s37 offset:8
    v_mfma_f32_16x16x32_bf16 v[172:175], v[32:35], v[216:219], v[172:175]
    v_exp_f32 v16, v124
    v_mfma_f32_16x16x32_bf16 v[172:175], v[36:39], v[220:223], v[172:175]
    s_waitcnt lgkmcnt(2)
    v_add_f32 v8, v8, v18
    v_add_f32 v8, v8, v19
    v_mfma_f32_16x16x32_bf16 v[96:99], v[40:43], a[208:211], v[96:99]
    ds_read_b128 v[32:35], v2 offset:18432
    v_and_b32 v49, s97, v56
    v_mfma_f32_16x16x32_bf16 v[96:99], v[44:47], a[212:215], v[96:99]
    s_sub_u32 s3, s29, s30
    v_exp_f32 v17, v125
    v_mfma_f32_16x16x32_bf16 v[100:103], v[40:43], a[232:235], v[100:103]
    v_cvt_pk_bf16_f32 v93, v18, v19
    v_lshlrev_b32 v50, 16, v58
    v_mfma_f32_16x16x32_bf16 v[100:103], v[44:47], a[236:239], v[100:103]
    buffer_load_dwordx4 v4, s[4:7], s27 offen offset:0 sc1 lds
    v_mfma_f32_16x16x32_bf16 v[104:107], v[40:43], v[192:195], v[104:107]
    ds_read_b128 v[36:39], v3 offset:18432
    v_mfma_f32_16x16x32_bf16 v[104:107], v[44:47], v[196:199], v[104:107]
    v_exp_f32 v18, v126
    v_mfma_f32_16x16x32_bf16 v[108:111], v[40:43], v[216:219], v[108:111]
    v_add_f32 v8, v8, v16
    v_add_f32 v8, v8, v17
    v_mfma_f32_16x16x32_bf16 v[108:111], v[44:47], v[220:223], v[108:111]
    s_waitcnt lgkmcnt(2)
    buffer_load_dwordx3 v[240:242], v12, s[68:71], s16 offen offset:0 nt
    v_mfma_f32_16x16x32_bf16 v[176:179], v[24:27], a[192:195], v[128:131]
    ds_read_b128 v[40:43], v2 offset:12416
    v_mfma_f32_16x16x32_bf16 v[176:179], v[28:31], a[196:199], v[176:179]
    v_exp_f32 v19, v127
    v_cvt_pk_bf16_f32 v94, v16, v17
    v_mfma_f32_16x16x32_bf16 v[180:183], v[24:27], a[216:219], v[132:135]
    s_mov_b32 s30, s29
    v_add_f32 v8, v8, v18
    v_add_f32 v8, v8, v19
    v_mfma_f32_16x16x32_bf16 v[180:183], v[28:31], a[220:223], v[180:183]
    buffer_load_dwordx4 v4, s[4:7], s27 offen offset:1024 sc1 lds
    v_mfma_f32_16x16x32_bf16 v[184:187], v[24:27], a[240:243], v[136:139]
    ds_read_b128 v[44:47], v3 offset:12416
    v_cvt_pk_bf16_f32 v95, v18, v19
    v_mfma_f32_16x16x32_bf16 v[184:187], v[28:31], a[244:247], v[184:187]
    v_exp_f32 v16, v160
    v_mfma_f32_16x16x32_bf16 v[188:191], v[24:27], v[200:203], v[140:143]
    v_exp_f32 v17, v161
    v_mfma_f32_16x16x32_bf16 v[188:191], v[28:31], v[204:207], v[188:191]
    s_waitcnt lgkmcnt(2)
    buffer_load_dwordx3 v[244:246], v12, s[68:71], s16 offen offset:768 nt
    v_mfma_f32_16x16x32_bf16 v[112:115], v[32:35], a[192:195], v[128:131]
    ds_read_b128 v[24:27], v2 offset:18560
    v_and_b32 v51, s97, v58
    v_mfma_f32_16x16x32_bf16 v[112:115], v[36:39], a[196:199], v[112:115]
    v_exp_f32 v18, v162
    v_mfma_f32_16x16x32_bf16 v[116:119], v[32:35], a[216:219], v[132:135]
    v_add_f32 v5, v5, v16
    v_add_f32 v5, v5, v17
    v_mfma_f32_16x16x32_bf16 v[116:119], v[36:39], a[220:223], v[116:119]
    v_exp_f32 v19, v163
    v_mfma_f32_16x16x32_bf16 v[120:123], v[32:35], a[240:243], v[136:139]
    ds_read_b128 v[28:31], v3 offset:18560
    v_cvt_pk_bf16_f32 v160, v16, v17
    v_mfma_f32_16x16x32_bf16 v[120:123], v[36:39], a[244:247], v[120:123]
    buffer_load_dwordx3 v[248:250], v12, s[68:71], s16 offen offset:1536 nt
    v_mfma_f32_16x16x32_bf16 v[124:127], v[32:35], v[200:203], v[140:143]
    v_exp_f32 v16, v96
    v_mfma_f32_16x16x32_bf16 v[124:127], v[36:39], v[204:207], v[124:127]
    s_waitcnt lgkmcnt(2)
    v_add_f32 v5, v5, v18
    v_add_f32 v5, v5, v19
    v_mfma_f32_16x16x32_bf16 v[176:179], v[40:43], a[200:203], v[176:179]
    ds_read_b128 v[32:35], v2 offset:12544
    v_mul_f32_e64 v50, -v50, v48
    v_mfma_f32_16x16x32_bf16 v[176:179], v[44:47], a[204:207], v[176:179]
    buffer_load_dwordx4 v4, s[4:7], s27 offen offset:2048 sc1 lds
    v_mfma_f32_16x16x32_bf16 v[180:183], v[40:43], a[224:227], v[180:183]
    v_exp_f32 v17, v97
    v_mfma_f32_16x16x32_bf16 v[180:183], v[44:47], a[228:231], v[180:183]
    v_cvt_pk_bf16_f32 v161, v18, v19
    v_add_u32 v1, s3, v1
    v_mfma_f32_16x16x32_bf16 v[184:187], v[40:43], a[248:251], v[184:187]
    ds_read_b128 v[36:39], v3 offset:12544
    v_mul_f32_e64 v51, -v51, v49
    v_mfma_f32_16x16x32_bf16 v[184:187], v[44:47], a[252:255], v[184:187]
    buffer_load_dwordx3 v[252:254], v12, s[68:71], s16 offen offset:2304 nt
    v_mfma_f32_16x16x32_bf16 v[188:191], v[40:43], v[208:211], v[188:191]
    v_exp_f32 v18, v98
    v_mfma_f32_16x16x32_bf16 v[188:191], v[44:47], v[212:215], v[188:191]
    s_waitcnt lgkmcnt(2)
    v_add_f32 v5, v5, v16
    v_add_f32 v5, v5, v17
    v_mfma_f32_16x16x32_bf16 v[112:115], v[24:27], a[200:203], v[112:115]
    ds_read_b128 v[40:43], v2 offset:18688
    v_cvt_f32_i32 v144, v144
    v_mfma_f32_16x16x32_bf16 v[112:115], v[28:31], a[204:207], v[112:115]
    v_exp_f32 v19, v99
    v_cvt_pk_bf16_f32 v162, v16, v17
    v_mfma_f32_16x16x32_bf16 v[116:119], v[24:27], a[224:227], v[116:119]
    v_exp_f32 v16, v164
    v_mfma_f32_16x16x32_bf16 v[116:119], v[28:31], a[228:231], v[116:119]
    s_add_u32 s27, s27, 24576
    v_add_f32 v5, v5, v18
    v_add_f32 v5, v5, v19
    v_mfma_f32_16x16x32_bf16 v[120:123], v[24:27], a[248:251], v[120:123]
    s_add_u32 s56, s56, 36864
    ds_read_b128 v[44:47], v3 offset:18688
    s_sub_u32 s58, s56, 147456
    v_mfma_f32_16x16x32_bf16 v[120:123], v[28:31], a[252:255], v[120:123]
    s_waitcnt lgkmcnt(2)
    v_exp_f32 v17, v165
    v_mfma_f32_16x16x32_bf16 v[124:127], v[24:27], v[208:211], v[124:127]
    s_waitcnt vmcnt(12)
    v_cvt_pk_bf16_f32 v163, v18, v19
    v_cvt_f32_i32 v148, v148
    v_mfma_f32_16x16x32_bf16 v[124:127], v[28:31], v[212:215], v[124:127]
    s_barrier
    s_min_u32 s56, s56, s58
    v_mfma_f32_16x16x32_bf16 v[176:179], v[32:35], a[208:211], v[176:179]
    ds_read_b128 v[24:27], v1 offset:0
    v_mfma_f32_16x16x32_bf16 v[176:179], v[36:39], a[212:215], v[176:179]
    v_exp_f32 v18, v166
    v_mfma_f32_16x16x32_bf16 v[180:183], v[32:35], a[232:235], v[180:183]
    v_add_f32 v6, v6, v16
    v_add_f32 v6, v6, v17
    v_mfma_f32_16x16x32_bf16 v[180:183], v[36:39], a[236:239], v[180:183]
    v_exp_f32 v19, v167
    v_mfma_f32_16x16x32_bf16 v[184:187], v[32:35], v[192:195], v[184:187]
    ds_read_b128 v[28:31], v1 offset:12288
    v_cvt_pk_bf16_f32 v164, v16, v17
    v_mfma_f32_16x16x32_bf16 v[184:187], v[36:39], v[196:199], v[184:187]
    v_exp_f32 v16, v100
    v_mfma_f32_16x16x32_bf16 v[188:191], v[32:35], v[216:219], v[188:191]
    v_add_f32 v6, v6, v18
    v_add_f32 v6, v6, v19
    v_mfma_f32_16x16x32_bf16 v[188:191], v[36:39], v[220:223], v[188:191]
    s_waitcnt lgkmcnt(2)
    v_exp_f32 v17, v101
    v_mfma_f32_16x16x32_bf16 v[112:115], v[40:43], a[208:211], v[112:115]
    ds_read_b128 v[32:35], v1 offset:1024
    v_cvt_pk_bf16_f32 v165, v18, v19
    v_mfma_f32_16x16x32_bf16 v[112:115], v[44:47], a[212:215], v[112:115]
    v_exp_f32 v18, v102
    v_mfma_f32_16x16x32_bf16 v[116:119], v[40:43], a[232:235], v[116:119]
    v_add_f32 v6, v6, v16
    v_add_f32 v6, v6, v17
    v_mfma_f32_16x16x32_bf16 v[116:119], v[44:47], a[236:239], v[116:119]
    v_exp_f32 v19, v103
    v_mfma_f32_16x16x32_bf16 v[120:123], v[40:43], v[192:195], v[120:123]
    ds_read_b128 v[36:39], v1 offset:13312
    v_cvt_pk_bf16_f32 v166, v16, v17
    v_mfma_f32_16x16x32_bf16 v[120:123], v[44:47], v[196:199], v[120:123]
    v_add_f32 v6, v6, v18
    v_add_f32 v6, v6, v19
    v_mfma_f32_16x16x32_bf16 v[124:127], v[40:43], v[216:219], v[124:127]
    v_cvt_pk_bf16_f32 v167, v18, v19
    v_mfma_f32_16x16x32_bf16 v[124:127], v[44:47], v[220:223], v[124:127]
    s_waitcnt lgkmcnt(2)
    v_mfma_f32_16x16x32_bf16 a[0:3], v[64:67], v[24:27], a[0:3]
    ds_read_b128 v[40:43], v1 offset:2048
    v_fma_f32 v144, v144, v48, v50
    v_mfma_f32_16x16x32_bf16 a[0:3], v[80:83], v[28:31], a[0:3]
    buffer_store_dwordx4 v[224:227], v11, s[4:7], s33 offen offset:0 sc1
    v_mfma_f32_16x16x32_bf16 a[48:51], v[68:71], v[24:27], a[48:51]
    v_exp_f32 v16, v168
    v_mfma_f32_16x16x32_bf16 a[48:51], v[84:87], v[28:31], a[48:51]
    v_exp_f32 v17, v169
    v_mfma_f32_16x16x32_bf16 a[96:99], v[72:75], v[24:27], a[96:99]
    ds_read_b128 v[44:47], v1 offset:14336
    v_xor_b32 v55, 16, v11
    v_mfma_f32_16x16x32_bf16 a[96:99], v[88:91], v[28:31], a[96:99]
    v_exp_f32 v18, v170
    v_mfma_f32_16x16x32_bf16 a[144:147], v[76:79], v[24:27], a[144:147]
    v_add_f32 v7, v7, v16
    v_add_f32 v7, v7, v17
    v_mfma_f32_16x16x32_bf16 a[144:147], v[92:95], v[28:31], a[144:147]
    s_waitcnt lgkmcnt(2)
    v_exp_f32 v19, v171
    v_mfma_f32_16x16x32_bf16 a[4:7], v[64:67], v[32:35], a[4:7]
    ds_read_b128 v[24:27], v1 offset:3072
    v_fma_f32 v148, v148, v49, v51
    v_mfma_f32_16x16x32_bf16 a[4:7], v[80:83], v[36:39], a[4:7]
    buffer_store_dwordx4 v[228:231], v55, s[4:7], s33 offen offset:768 sc1
    v_mfma_f32_16x16x32_bf16 a[52:55], v[68:71], v[32:35], a[52:55]
    v_cvt_pk_bf16_f32 v168, v16, v17
    v_cvt_f32_i32 v145, v145
    v_mfma_f32_16x16x32_bf16 a[52:55], v[84:87], v[36:39], a[52:55]
    v_exp_f32 v16, v104
    v_mfma_f32_16x16x32_bf16 a[100:103], v[72:75], v[32:35], a[100:103]
    ds_read_b128 v[28:31], v1 offset:15360
    v_add_f32 v7, v7, v18
    v_mfma_f32_16x16x32_bf16 a[100:103], v[88:91], v[36:39], a[100:103]
    v_add_f32 v7, v7, v19
    v_xor_b32 v54, 32, v11
    v_mfma_f32_16x16x32_bf16 a[148:151], v[76:79], v[32:35], a[148:151]
    v_exp_f32 v17, v105
    v_mfma_f32_16x16x32_bf16 a[148:151], v[92:95], v[36:39], a[148:151]
    s_waitcnt lgkmcnt(2)
    v_cvt_pk_bf16_f32 v169, v18, v19
    v_cvt_f32_i32 v149, v149
    v_mfma_f32_16x16x32_bf16 a[8:11], v[64:67], v[40:43], a[8:11]
    ds_read_b128 v[32:35], v1 offset:4096
    v_fma_f32 v145, v145, v48, v50
    v_mfma_f32_16x16x32_bf16 a[8:11], v[80:83], v[44:47], a[8:11]
    buffer_store_dwordx4 v[232:235], v54, s[4:7], s33 offen offset:1536 sc1
    v_mfma_f32_16x16x32_bf16 a[56:59], v[68:71], v[40:43], a[56:59]
    v_exp_f32 v18, v106
    v_mfma_f32_16x16x32_bf16 a[56:59], v[84:87], v[44:47], a[56:59]
    v_add_f32 v7, v7, v16
    v_add_f32 v7, v7, v17
    v_mfma_f32_16x16x32_bf16 a[104:107], v[72:75], v[40:43], a[104:107]
    ds_read_b128 v[36:39], v1 offset:16384
    v_xor_b32 v55, 48, v11
    v_mfma_f32_16x16x32_bf16 a[104:107], v[88:91], v[44:47], a[104:107]
    v_exp_f32 v19, v107
    v_mfma_f32_16x16x32_bf16 a[152:155], v[76:79], v[40:43], a[152:155]
    v_cvt_pk_bf16_f32 v170, v16, v17
    v_fma_f32 v149, v149, v49, v51
    v_mfma_f32_16x16x32_bf16 a[152:155], v[92:95], v[44:47], a[152:155]
    s_waitcnt lgkmcnt(2)
    v_exp_f32 v16, v172
    v_mfma_f32_16x16x32_bf16 a[12:15], v[64:67], v[24:27], a[12:15]
    ds_read_b128 v[40:43], v1 offset:5120
    v_add_f32 v7, v7, v18
    v_mfma_f32_16x16x32_bf16 a[12:15], v[80:83], v[28:31], a[12:15]
    buffer_store_dwordx4 v[236:239], v55, s[4:7], s33 offen offset:2304 sc1
    v_mfma_f32_16x16x32_bf16 a[60:63], v[68:71], v[24:27], a[60:63]
    v_add_f32 v7, v7, v19
    v_cvt_f32_i32 v146, v146
    v_mfma_f32_16x16x32_bf16 a[60:63], v[84:87], v[28:31], a[60:63]
    v_exp_f32 v17, v173
    v_mfma_f32_16x16x32_bf16 a[108:111], v[72:75], v[24:27], a[108:111]
    ds_read_b128 v[44:47], v1 offset:17408
    v_cvt_pk_bf16_f32 v171, v18, v19
    v_mfma_f32_16x16x32_bf16 a[108:111], v[88:91], v[28:31], a[108:111]
    v_exp_f32 v18, v174
    v_mfma_f32_16x16x32_bf16 a[156:159], v[76:79], v[24:27], a[156:159]
    s_add_u32 s29, s28, 49152
    v_add_f32 v8, v8, v16
    v_add_f32 v8, v8, v17
    v_mfma_f32_16x16x32_bf16 a[156:159], v[92:95], v[28:31], a[156:159]
    s_waitcnt lgkmcnt(2)
    v_exp_f32 v19, v175
    v_mfma_f32_16x16x32_bf16 a[16:19], v[64:67], v[32:35], a[16:19]
    s_sub_u32 s3, s29, 147456
    ds_read_b128 v[24:27], v1 offset:6144
    v_cvt_pk_bf16_f32 v172, v16, v17
    v_mfma_f32_16x16x32_bf16 a[16:19], v[80:83], v[36:39], a[16:19]
    s_mov_b32 m0, s26
    v_exp_f32 v16, v108
    v_mfma_f32_16x16x32_bf16 a[64:67], v[68:71], v[32:35], a[64:67]
    s_min_u32 s29, s29, s3
    v_cvt_f32_i32 v150, v150
    v_add_f32 v8, v8, v18
    v_mfma_f32_16x16x32_bf16 a[64:67], v[84:87], v[36:39], a[64:67]
    buffer_load_dwordx4 v4, s[4:7], s32 offen offset:0 sc1 lds
    v_mfma_f32_16x16x32_bf16 a[112:115], v[72:75], v[32:35], a[112:115]
    ds_read_b128 v[28:31], v1 offset:18432
    v_add_f32 v8, v8, v19
    v_mfma_f32_16x16x32_bf16 a[112:115], v[88:91], v[36:39], a[112:115]
    v_exp_f32 v17, v109
    v_mfma_f32_16x16x32_bf16 a[160:163], v[76:79], v[32:35], a[160:163]
    v_cvt_pk_bf16_f32 v173, v18, v19
    v_fma_f32 v146, v146, v48, v50
    v_mfma_f32_16x16x32_bf16 a[160:163], v[92:95], v[36:39], a[160:163]
    s_waitcnt lgkmcnt(2)
    buffer_load_dwordx4 v4, s[4:7], s32 offen offset:1024 sc1 lds
    v_mfma_f32_16x16x32_bf16 a[20:23], v[64:67], v[40:43], a[20:23]
    s_sub_u32 s3, s29, s28
    ds_read_b128 v[32:35], v1 offset:7168
    v_fma_f32 v150, v150, v49, v51
    v_mfma_f32_16x16x32_bf16 a[20:23], v[80:83], v[44:47], a[20:23]
    v_exp_f32 v18, v110
    v_mfma_f32_16x16x32_bf16 a[68:71], v[68:71], v[40:43], a[68:71]
    v_add_f32 v8, v8, v16
    v_add_f32 v8, v8, v17
    v_mfma_f32_16x16x32_bf16 a[68:71], v[84:87], v[44:47], a[68:71]
    buffer_load_dwordx4 v4, s[4:7], s32 offen offset:2048 sc1 lds
    v_mfma_f32_16x16x32_bf16 a[116:119], v[72:75], v[40:43], a[116:119]
    ds_read_b128 v[36:39], v1 offset:19456
    v_lshlrev_b32 v48, 16, v57
    v_mfma_f32_16x16x32_bf16 a[116:119], v[88:91], v[44:47], a[116:119]
    v_exp_f32 v19, v111
    v_mfma_f32_16x16x32_bf16 a[164:167], v[76:79], v[40:43], a[164:167]
    s_mov_b32 s28, s29
    v_cvt_pk_bf16_f32 v174, v16, v17
    v_add_f32 v8, v8, v18
    v_mfma_f32_16x16x32_bf16 a[164:167], v[92:95], v[44:47], a[164:167]
    s_waitcnt lgkmcnt(2)
    v_add_f32 v8, v8, v19
    v_cvt_pk_bf16_f32 v175, v18, v19
    v_mfma_f32_16x16x32_bf16 a[24:27], v[64:67], v[24:27], a[24:27]
    s_add_u32 s32, s32, 24576
    ds_read_b128 v[40:43], v1 offset:8192
    v_and_b32 v49, s97, v57
    v_mfma_f32_16x16x32_bf16 a[24:27], v[80:83], v[28:31], a[24:27]
    v_exp_f32 v16, v176
    v_mfma_f32_16x16x32_bf16 a[72:75], v[68:71], v[24:27], a[72:75]
    s_add_u32 s26, s26, 12288
    v_exp_f32 v17, v177
    v_mfma_f32_16x16x32_bf16 a[72:75], v[84:87], v[28:31], a[72:75]
    v_exp_f32 v18, v178
    v_mfma_f32_16x16x32_bf16 a[120:123], v[72:75], v[24:27], a[120:123]
    s_mov_b32 m0, s26
    ds_read_b128 v[44:47], v1 offset:20480
    v_add_f32 v5, v5, v16
    v_mfma_f32_16x16x32_bf16 a[120:123], v[88:91], v[28:31], a[120:123]
    v_add_f32 v5, v5, v17
    v_lshlrev_b32 v50, 16, v59
    v_mfma_f32_16x16x32_bf16 a[168:171], v[76:79], v[24:27], a[168:171]
    v_exp_f32 v19, v179
    v_mfma_f32_16x16x32_bf16 a[168:171], v[92:95], v[28:31], a[168:171]
    s_waitcnt lgkmcnt(2)
    v_cvt_pk_bf16_f32 v176, v16, v17
    v_and_b32 v51, s97, v59
    v_mfma_f32_16x16x32_bf16 a[28:31], v[64:67], v[32:35], a[28:31]
    ds_read_b128 v[24:27], v1 offset:9216
    v_add_u32 v2, s3, v2
    v_mfma_f32_16x16x32_bf16 a[28:31], v[80:83], v[36:39], a[28:31]
    buffer_load_dwordx4 v4, s[4:7], s32 offen offset:0 sc1 lds
    v_mfma_f32_16x16x32_bf16 a[76:79], v[68:71], v[32:35], a[76:79]
    v_exp_f32 v16, v112
    v_mfma_f32_16x16x32_bf16 a[76:79], v[84:87], v[36:39], a[76:79]
    v_add_f32 v5, v5, v18
    v_add_f32 v5, v5, v19
    v_mfma_f32_16x16x32_bf16 a[124:127], v[72:75], v[32:35], a[124:127]
    ds_read_b128 v[28:31], v1 offset:21504
    v_mul_f32_e64 v50, -v50, v48
    v_mfma_f32_16x16x32_bf16 a[124:127], v[88:91], v[36:39], a[124:127]
    buffer_load_dwordx4 v4, s[4:7], s32 offen offset:1024 sc1 lds
    v_mfma_f32_16x16x32_bf16 a[172:175], v[76:79], v[32:35], a[172:175]
    v_exp_f32 v17, v113
    v_mfma_f32_16x16x32_bf16 a[172:175], v[92:95], v[36:39], a[172:175]
    s_waitcnt lgkmcnt(2)
    v_cvt_pk_bf16_f32 v177, v18, v19
    v_add_u32 v3, s3, v3
    v_mfma_f32_16x16x32_bf16 a[32:35], v[64:67], v[40:43], a[32:35]
    ds_read_b128 v[32:35], v1 offset:10240
    v_mul_f32_e64 v51, -v51, v49
    v_mfma_f32_16x16x32_bf16 a[32:35], v[80:83], v[44:47], a[32:35]
    v_exp_f32 v18, v114
    v_mfma_f32_16x16x32_bf16 a[80:83], v[68:71], v[40:43], a[80:83]
    v_add_f32 v5, v5, v16
    v_add_f32 v5, v5, v17
    v_mfma_f32_16x16x32_bf16 a[80:83], v[84:87], v[44:47], a[80:83]
    buffer_load_dwordx4 v4, s[4:7], s32 offen offset:2048 sc1 lds
    v_mfma_f32_16x16x32_bf16 a[128:131], v[72:75], v[40:43], a[128:131]
    ds_read_b128 v[36:39], v1 offset:22528
    v_mfma_f32_16x16x32_bf16 a[128:131], v[88:91], v[44:47], a[128:131]
    v_exp_f32 v19, v115
    v_mfma_f32_16x16x32_bf16 a[176:179], v[76:79], v[40:43], a[176:179]
    v_cvt_pk_bf16_f32 v178, v16, v17
    v_cvt_f32_i32 v152, v152
    v_mfma_f32_16x16x32_bf16 a[176:179], v[92:95], v[44:47], a[176:179]
    s_waitcnt lgkmcnt(2)
    v_exp_f32 v16, v180
    v_mfma_f32_16x16x32_bf16 a[36:39], v[64:67], v[24:27], a[36:39]
    ds_read_b128 v[40:43], v1 offset:11264
    v_add_f32 v5, v5, v18
    v_mfma_f32_16x16x32_bf16 a[36:39], v[80:83], v[28:31], a[36:39]
    v_add_f32 v5, v5, v19
    v_mfma_f32_16x16x32_bf16 a[84:87], v[68:71], v[24:27], a[84:87]
    v_exp_f32 v17, v181
    v_mfma_f32_16x16x32_bf16 a[84:87], v[84:87], v[28:31], a[84:87]
    s_add_u32 s32, s32, 24576
    v_cvt_pk_bf16_f32 v179, v18, v19
    s_add_u32 s26, s26, 36864
    v_mfma_f32_16x16x32_bf16 a[132:135], v[72:75], v[24:27], a[132:135]
    s_sub_u32 s57, s26, 147456
    ds_read_b128 v[44:47], v1 offset:23552
    v_cvt_f32_i32 v156, v156
    v_mfma_f32_16x16x32_bf16 a[132:135], v[88:91], v[28:31], a[132:135]
    s_waitcnt lgkmcnt(2)
    v_exp_f32 v18, v182
    v_mfma_f32_16x16x32_bf16 a[180:183], v[76:79], v[24:27], a[180:183]
    s_waitcnt vmcnt(6)
    v_add_f32 v6, v6, v16
    v_add_f32 v6, v6, v17
    v_mfma_f32_16x16x32_bf16 a[180:183], v[92:95], v[28:31], a[180:183]
    s_barrier
    v_fma_f32 v152, v152, v48, v50
    v_mfma_f32_16x16x32_bf16 a[40:43], v[64:67], v[32:35], a[40:43]
    s_min_u32 s26, s26, s57
    ds_read_b128 v[24:27], v2 offset:0
    v_add_u32 v0, 1, v0
    v_mfma_f32_16x16x32_bf16 a[40:43], v[80:83], v[36:39], a[40:43]
    buffer_store_dword v0, v13, s[20:23], 0 offen offset:32 sc1
    v_mfma_f32_16x16x32_bf16 a[88:91], v[68:71], v[32:35], a[88:91]
    v_exp_f32 v19, v183
    v_mfma_f32_16x16x32_bf16 a[88:91], v[84:87], v[36:39], a[88:91]
    v_cvt_pk_bf16_f32 v180, v16, v17
    v_fma_f32 v156, v156, v49, v51
    v_mfma_f32_16x16x32_bf16 a[136:139], v[72:75], v[32:35], a[136:139]
    ds_read_b128 v[28:31], v3 offset:0
    v_mfma_f32_16x16x32_bf16 a[136:139], v[88:91], v[36:39], a[136:139]
    v_exp_f32 v16, v116
    v_mfma_f32_16x16x32_bf16 a[184:187], v[76:79], v[32:35], a[184:187]
    v_add_f32 v6, v6, v18
    v_add_f32 v6, v6, v19
    v_mfma_f32_16x16x32_bf16 a[184:187], v[92:95], v[36:39], a[184:187]
    s_waitcnt lgkmcnt(2)
    v_exp_f32 v17, v117
    v_mfma_f32_16x16x32_bf16 a[44:47], v[64:67], v[40:43], a[44:47]
    ds_read_b128 v[32:35], v2 offset:6144
    v_cvt_pk_bf16_f32 v181, v18, v19
    v_mfma_f32_16x16x32_bf16 a[44:47], v[80:83], v[44:47], a[44:47]
    v_exp_f32 v18, v118
    v_mfma_f32_16x16x32_bf16 a[92:95], v[68:71], v[40:43], a[92:95]
    v_add_f32 v6, v6, v16
    v_add_f32 v6, v6, v17
    v_mfma_f32_16x16x32_bf16 a[92:95], v[84:87], v[44:47], a[92:95]
    v_exp_f32 v19, v119
    v_mfma_f32_16x16x32_bf16 a[140:143], v[72:75], v[40:43], a[140:143]
    ds_read_b128 v[36:39], v3 offset:6144
    v_cvt_pk_bf16_f32 v182, v16, v17
    v_mfma_f32_16x16x32_bf16 a[140:143], v[88:91], v[44:47], a[140:143]
    v_add_f32 v6, v6, v18
    v_add_f32 v6, v6, v19
    v_mfma_f32_16x16x32_bf16 a[188:191], v[76:79], v[40:43], a[188:191]
    v_cvt_pk_bf16_f32 v183, v18, v19
    v_mfma_f32_16x16x32_bf16 a[188:191], v[92:95], v[44:47], a[188:191]
    s_waitcnt lgkmcnt(2)
    v_mfma_f32_16x16x32_bf16 v[64:67], v[24:27], a[192:195], v[128:131]
    s_add_u32 s33, s33, 196608
    ds_read_b128 v[40:43], v2 offset:128
    v_cvt_f32_i32 v153, v153
    v_mfma_f32_16x16x32_bf16 v[64:67], v[28:31], a[196:199], v[64:67]
    s_mov_b32 m0, s56
    v_exp_f32 v16, v184
    v_mfma_f32_16x16x32_bf16 v[68:71], v[24:27], a[216:219], v[132:135]
    s_add_u32 s34, s34, 196608
    v_exp_f32 v17, v185
    v_mfma_f32_16x16x32_bf16 v[68:71], v[28:31], a[220:223], v[68:71]
    s_add_u32 s36, s36, 1536
    buffer_load_dwordx4 v4, s[4:7], s27 offen offset:0 sc1 lds
    v_mfma_f32_16x16x32_bf16 v[72:75], v[24:27], a[240:243], v[136:139]
    ds_read_b128 v[44:47], v3 offset:128
    v_cvt_f32_i32 v157, v157
    v_mfma_f32_16x16x32_bf16 v[72:75], v[28:31], a[244:247], v[72:75]
    v_exp_f32 v18, v186
    v_mfma_f32_16x16x32_bf16 v[76:79], v[24:27], v[200:203], v[140:143]
    v_add_f32 v7, v7, v16
    v_add_f32 v7, v7, v17
    v_mfma_f32_16x16x32_bf16 v[76:79], v[28:31], v[204:207], v[76:79]
    s_waitcnt lgkmcnt(2)
    buffer_load_dwordx2 v[56:57], v10, s[72:75], s36 offen offset:0
    v_mfma_f32_16x16x32_bf16 v[96:99], v[32:35], a[192:195], v[128:131]
    ds_read_b128 v[24:27], v2 offset:6272
    v_fma_f32 v153, v153, v48, v50
    v_mfma_f32_16x16x32_bf16 v[96:99], v[36:39], a[196:199], v[96:99]
    v_exp_f32 v19, v187
    v_mfma_f32_16x16x32_bf16 v[100:103], v[32:35], a[216:219], v[132:135]
    v_cvt_pk_bf16_f32 v184, v16, v17
    v_fma_f32 v157, v157, v49, v51
    v_mfma_f32_16x16x32_bf16 v[100:103], v[36:39], a[220:223], v[100:103]
    buffer_load_dwordx4 v4, s[4:7], s27 offen offset:1024 sc1 lds
    v_mfma_f32_16x16x32_bf16 v[104:107], v[32:35], a[240:243], v[136:139]
    ds_read_b128 v[28:31], v3 offset:6272
    v_cvt_f32_i32 v154, v154
    v_mfma_f32_16x16x32_bf16 v[104:107], v[36:39], a[244:247], v[104:107]
    v_exp_f32 v16, v120
    v_mfma_f32_16x16x32_bf16 v[108:111], v[32:35], v[200:203], v[140:143]
    v_add_f32 v7, v7, v18
    v_add_f32 v7, v7, v19
    v_mfma_f32_16x16x32_bf16 v[108:111], v[36:39], v[204:207], v[108:111]
    s_waitcnt lgkmcnt(2)
    buffer_load_dwordx2 v[58:59], v10, s[76:79], s36 offen offset:0
    v_mfma_f32_16x16x32_bf16 v[64:67], v[40:43], a[200:203], v[64:67]
    ds_read_b128 v[32:35], v2 offset:256
    v_cvt_f32_i32 v158, v158
    v_mfma_f32_16x16x32_bf16 v[64:67], v[44:47], a[204:207], v[64:67]
    v_exp_f32 v17, v121
    v_mfma_f32_16x16x32_bf16 v[68:71], v[40:43], a[224:227], v[68:71]
    v_cvt_pk_bf16_f32 v185, v18, v19
    v_fma_f32 v154, v154, v48, v50
    v_mfma_f32_16x16x32_bf16 v[68:71], v[44:47], a[228:231], v[68:71]
    buffer_load_dwordx4 v[224:227], v9, s[64:67], s33 offen offset:0 nt
    v_mfma_f32_16x16x32_bf16 v[72:75], v[40:43], a[248:251], v[72:75]
    ds_read_b128 v[36:39], v3 offset:256
    v_fma_f32 v158, v158, v49, v51
    v_mfma_f32_16x16x32_bf16 v[72:75], v[44:47], a[252:255], v[72:75]
    v_exp_f32 v18, v122
    v_mfma_f32_16x16x32_bf16 v[76:79], v[40:43], v[208:211], v[76:79]
    v_add_f32 v7, v7, v16
    v_add_f32 v7, v7, v17
    v_mfma_f32_16x16x32_bf16 v[76:79], v[44:47], v[212:215], v[76:79]
    s_waitcnt lgkmcnt(2)
    buffer_load_dwordx4 v4, s[4:7], s27 offen offset:2048 sc1 lds
    v_mfma_f32_16x16x32_bf16 v[96:99], v[24:27], a[200:203], v[96:99]
    ds_read_b128 v[40:43], v2 offset:6400
    v_cvt_pk_bf16_f32 v144, v144, v148
    v_mfma_f32_16x16x32_bf16 v[96:99], v[28:31], a[204:207], v[96:99]
    v_exp_f32 v19, v123
    v_cvt_pk_bf16_f32 v186, v16, v17
    v_mfma_f32_16x16x32_bf16 v[100:103], v[24:27], a[224:227], v[100:103]
    v_exp_f32 v16, v188
    v_mfma_f32_16x16x32_bf16 v[100:103], v[28:31], a[228:231], v[100:103]
    buffer_load_dwordx4 v[228:231], v9, s[64:67], s33 offen offset:1536 nt
    v_mfma_f32_16x16x32_bf16 v[104:107], v[24:27], a[248:251], v[104:107]
    ds_read_b128 v[44:47], v3 offset:6400
    v_add_f32 v7, v7, v18
    v_mfma_f32_16x16x32_bf16 v[104:107], v[28:31], a[252:255], v[104:107]
    v_add_f32 v7, v7, v19
    v_cvt_pk_bf16_f32 v148, v145, v149
    v_mfma_f32_16x16x32_bf16 v[108:111], v[24:27], v[208:211], v[108:111]
    s_add_u32 s29, s30, 49152
    v_exp_f32 v17, v189
    v_mfma_f32_16x16x32_bf16 v[108:111], v[28:31], v[212:215], v[108:111]
    s_waitcnt lgkmcnt(2)
    buffer_load_dwordx4 v[232:235], v9, s[64:67], s34 offen offset:0 nt
    v_cvt_pk_bf16_f32 v187, v18, v19
    v_mfma_f32_16x16x32_bf16 v[64:67], v[32:35], a[208:211], v[64:67]
    s_sub_u32 s3, s29, 147456
    ds_read_b128 v[24:27], v2 offset:12288
    s_add_u32 s27, s27, 24576
    v_mfma_f32_16x16x32_bf16 v[64:67], v[36:39], a[212:215], v[64:67]
    s_min_u32 s29, s29, s3
    v_exp_f32 v18, v190
    v_mfma_f32_16x16x32_bf16 v[68:71], v[32:35], a[232:235], v[68:71]
    v_add_f32 v8, v8, v16
    v_add_f32 v8, v8, v17
    v_mfma_f32_16x16x32_bf16 v[68:71], v[36:39], a[236:239], v[68:71]
    buffer_load_dwordx4 v[236:239], v9, s[64:67], s34 offen offset:1536 nt
    v_mfma_f32_16x16x32_bf16 v[72:75], v[32:35], v[192:195], v[72:75]
    s_add_u32 s56, s56, 12288
    ds_read_b128 v[28:31], v3 offset:12288
    v_cvt_pk_bf16_f32 v145, v152, v156
    v_mfma_f32_16x16x32_bf16 v[72:75], v[36:39], v[196:199], v[72:75]
    v_exp_f32 v19, v191
    v_cvt_pk_bf16_f32 v188, v16, v17
    v_mfma_f32_16x16x32_bf16 v[76:79], v[32:35], v[216:219], v[76:79]
    v_exp_f32 v16, v124
    v_mfma_f32_16x16x32_bf16 v[76:79], v[36:39], v[220:223], v[76:79]
    s_waitcnt lgkmcnt(2)
    v_add_f32 v8, v8, v18
    v_add_f32 v8, v8, v19
    v_mfma_f32_16x16x32_bf16 v[96:99], v[40:43], a[208:211], v[96:99]
    ds_read_b128 v[32:35], v2 offset:18432
    v_cvt_pk_bf16_f32 v149, v153, v157
    v_mfma_f32_16x16x32_bf16 v[96:99], v[44:47], a[212:215], v[96:99]
    s_sub_u32 s3, s29, s30
    v_exp_f32 v17, v125
    v_mfma_f32_16x16x32_bf16 v[100:103], v[40:43], a[232:235], v[100:103]
    s_mov_b32 m0, s56
    v_cvt_pk_bf16_f32 v189, v18, v19
    v_cvt_pk_bf16_f32 v152, v146, v150
    v_mfma_f32_16x16x32_bf16 v[100:103], v[44:47], a[236:239], v[100:103]
    v_exp_f32 v18, v126
    v_mfma_f32_16x16x32_bf16 v[104:107], v[40:43], v[192:195], v[104:107]
    ds_read_b128 v[36:39], v3 offset:18432
    v_add_f32 v8, v8, v16
    v_mfma_f32_16x16x32_bf16 v[104:107], v[44:47], v[196:199], v[104:107]
    v_add_f32 v8, v8, v17
    v_cvt_pk_bf16_f32 v153, v154, v158
    v_mfma_f32_16x16x32_bf16 v[108:111], v[40:43], v[216:219], v[108:111]
    v_exp_f32 v19, v127
    v_mfma_f32_16x16x32_bf16 v[108:111], v[44:47], v[220:223], v[108:111]
    s_waitcnt lgkmcnt(2)
    v_cvt_pk_bf16_f32 v190, v16, v17
    v_add_f32 v8, v8, v18
    v_mfma_f32_16x16x32_bf16 v[80:83], v[24:27], a[192:195], v[128:131]
    ds_read_b128 v[40:43], v2 offset:12416
    v_add_f32 v8, v8, v19
    v_mfma_f32_16x16x32_bf16 v[80:83], v[28:31], a[196:199], v[80:83]
    s_mov_b32 s30, s29
    v_cvt_pk_bf16_f32 v191, v18, v19
    v_mfma_f32_16x16x32_bf16 v[84:87], v[24:27], a[216:219], v[132:135]
    v_exp_f32 v16, v64
    v_mfma_f32_16x16x32_bf16 v[84:87], v[28:31], a[220:223], v[84:87]
    s_waitcnt vmcnt(20)
    buffer_load_dwordx4 v4, s[4:7], s27 offen offset:0 sc1 lds
    v_mfma_f32_16x16x32_bf16 v[88:91], v[24:27], a[240:243], v[136:139]
    ds_read_b128 v[44:47], v3 offset:12416
    v_lshlrev_b32 v48, 16, v60
    v_mfma_f32_16x16x32_bf16 v[88:91], v[28:31], a[244:247], v[88:91]
    v_exp_f32 v17, v65
    v_mfma_f32_16x16x32_bf16 v[92:95], v[24:27], v[200:203], v[140:143]
    v_exp_f32 v18, v66
    v_mfma_f32_16x16x32_bf16 v[92:95], v[28:31], v[204:207], v[92:95]
    s_waitcnt lgkmcnt(2)
    v_add_f32 v5, v5, v16
    v_add_f32 v5, v5, v17
    v_mfma_f32_16x16x32_bf16 v[112:115], v[32:35], a[192:195], v[128:131]
    ds_read_b128 v[24:27], v2 offset:18560
    v_and_b32 v49, s97, v60
    v_mfma_f32_16x16x32_bf16 v[112:115], v[36:39], a[196:199], v[112:115]
    v_exp_f32 v19, v67
    v_mfma_f32_16x16x32_bf16 v[116:119], v[32:35], a[216:219], v[132:135]
    v_cvt_pk_bf16_f32 v64, v16, v17
    v_lshlrev_b32 v50, 16, v62
    v_mfma_f32_16x16x32_bf16 v[116:119], v[36:39], a[220:223], v[116:119]
    v_exp_f32 v16, v96
    v_mfma_f32_16x16x32_bf16 v[120:123], v[32:35], a[240:243], v[136:139]
    ds_read_b128 v[28:31], v3 offset:18560
    v_add_f32 v5, v5, v18
    v_mfma_f32_16x16x32_bf16 v[120:123], v[36:39], a[244:247], v[120:123]
    v_add_f32 v5, v5, v19
    v_add_u32 v1, s3, v1
    v_mfma_f32_16x16x32_bf16 v[124:127], v[32:35], v[200:203], v[140:143]
    v_exp_f32 v17, v97
    v_mfma_f32_16x16x32_bf16 v[124:127], v[36:39], v[204:207], v[124:127]
    s_waitcnt lgkmcnt(2)
    buffer_load_dwordx4 v4, s[4:7], s27 offen offset:1024 sc1 lds
    v_mfma_f32_16x16x32_bf16 v[80:83], v[40:43], a[200:203], v[80:83]
    ds_read_b128 v[32:35], v2 offset:12544
    v_cvt_pk_bf16_f32 v65, v18, v19
    v_mfma_f32_16x16x32_bf16 v[80:83], v[44:47], a[204:207], v[80:83]
    v_exp_f32 v18, v98
    v_mfma_f32_16x16x32_bf16 v[84:87], v[40:43], a[224:227], v[84:87]
    v_add_f32 v5, v5, v16
    v_add_f32 v5, v5, v17
    v_mfma_f32_16x16x32_bf16 v[84:87], v[44:47], a[228:231], v[84:87]
    v_exp_f32 v19, v99
    v_mfma_f32_16x16x32_bf16 v[88:91], v[40:43], a[248:251], v[88:91]
    ds_read_b128 v[36:39], v3 offset:12544
    v_cvt_pk_bf16_f32 v66, v16, v17
    v_mfma_f32_16x16x32_bf16 v[88:91], v[44:47], a[252:255], v[88:91]
    v_exp_f32 v16, v68
    v_mfma_f32_16x16x32_bf16 v[92:95], v[40:43], v[208:211], v[92:95]
L_pg4:
    s_cbranch_execz L_pg8
    v_and_b32 v51, s97, v62
    v_add_f32 v5, v5, v18
    v_mfma_f32_16x16x32_bf16 v[92:95], v[44:47], v[212:215], v[92:95]
    s_waitcnt lgkmcnt(2)
    v_add_f32 v5, v5, v19
    v_mul_f32_e64 v50, -v50, v48
    v_mfma_f32_16x16x32_bf16 v[112:115], v[24:27], a[200:203], v[112:115]
    ds_read_b128 v[40:43], v2 offset:18688
    v_mfma_f32_16x16x32_bf16 v[112:115], v[28:31], a[204:207], v[112:115]
    buffer_load_dwordx4 v4, s[4:7], s27 offen offset:2048 sc1 lds
    v_mfma_f32_16x16x32_bf16 v[116:119], v[24:27], a[224:227], v[116:119]
    v_exp_f32 v17, v69
    v_mfma_f32_16x16x32_bf16 v[116:119], v[28:31], a[228:231], v[116:119]
    v_cvt_pk_bf16_f32 v67, v18, v19
    v_mul_f32_e64 v51, -v51, v49
    v_mfma_f32_16x16x32_bf16 v[120:123], v[24:27], a[248:251], v[120:123]
    ds_read_b128 v[44:47], v3 offset:18688
    v_mfma_f32_16x16x32_bf16 v[120:123], v[28:31], a[252:255], v[120:123]
    s_waitcnt lgkmcnt(2)
    v_exp_f32 v18, v70
    v_mfma_f32_16x16x32_bf16 v[124:127], v[24:27], v[208:211], v[124:127]
    s_waitcnt vmcnt(13)
    v_add_f32 v6, v6, v16
    v_add_f32 v6, v6, v17
    v_mfma_f32_16x16x32_bf16 v[124:127], v[28:31], v[212:215], v[124:127]
    s_barrier
    v_cvt_f32_i32 v240, v240
    v_mfma_f32_16x16x32_bf16 v[80:83], v[32:35], a[208:211], v[80:83]
    ds_read_b128 v[24:27], v1 offset:0
    v_mfma_f32_16x16x32_bf16 v[80:83], v[36:39], a[212:215], v[80:83]
    v_exp_f32 v19, v71
    v_mfma_f32_16x16x32_bf16 v[84:87], v[32:35], a[232:235], v[84:87]
    v_cvt_pk_bf16_f32 v68, v16, v17
    v_mfma_f32_16x16x32_bf16 v[84:87], v[36:39], a[236:239], v[84:87]
    v_exp_f32 v16, v100
    v_mfma_f32_16x16x32_bf16 v[88:91], v[32:35], v[192:195], v[88:91]
    ds_read_b128 v[28:31], v1 offset:12288
    v_add_f32 v6, v6, v18
    v_mfma_f32_16x16x32_bf16 v[88:91], v[36:39], v[196:199], v[88:91]
    v_add_f32 v6, v6, v19
    v_cvt_f32_i32 v244, v244
    v_mfma_f32_16x16x32_bf16 v[92:95], v[32:35], v[216:219], v[92:95]
    v_exp_f32 v17, v101
    v_mfma_f32_16x16x32_bf16 v[92:95], v[36:39], v[220:223], v[92:95]
    s_waitcnt lgkmcnt(2)
    v_cvt_pk_bf16_f32 v69, v18, v19
    v_mfma_f32_16x16x32_bf16 v[112:115], v[40:43], a[208:211], v[112:115]
    ds_read_b128 v[32:35], v1 offset:1024
    v_mfma_f32_16x16x32_bf16 v[112:115], v[44:47], a[212:215], v[112:115]
    v_exp_f32 v18, v102
    v_mfma_f32_16x16x32_bf16 v[116:119], v[40:43], a[232:235], v[116:119]
    v_add_f32 v6, v6, v16
    v_add_f32 v6, v6, v17
    v_mfma_f32_16x16x32_bf16 v[116:119], v[44:47], a[236:239], v[116:119]
    s_add_u32 s27, s27, 24576
    v_exp_f32 v19, v103
    v_mfma_f32_16x16x32_bf16 v[120:123], v[40:43], v[192:195], v[120:123]
    s_add_u32 s56, s56, 36864
    ds_read_b128 v[36:39], v1 offset:13312
    v_cvt_pk_bf16_f32 v70, v16, v17
    v_mfma_f32_16x16x32_bf16 v[120:123], v[44:47], v[196:199], v[120:123]
    s_sub_u32 s58, s56, 147456
    v_add_f32 v6, v6, v18
    v_add_f32 v6, v6, v19
    v_mfma_f32_16x16x32_bf16 v[124:127], v[40:43], v[216:219], v[124:127]
    s_min_u32 s56, s56, s58
    v_cvt_pk_bf16_f32 v71, v18, v19
    v_mfma_f32_16x16x32_bf16 v[124:127], v[44:47], v[220:223], v[124:127]
    s_waitcnt lgkmcnt(2)
    v_mfma_f32_16x16x32_bf16 a[0:3], v[160:163], v[24:27], a[0:3]
    s_mov_b32 m0, s56
    ds_read_b128 v[40:43], v1 offset:2048
    v_fma_f32 v240, v240, v48, v50
    v_mfma_f32_16x16x32_bf16 a[0:3], v[176:179], v[28:31], a[0:3]
    buffer_load_dwordx4 v4, s[4:7], s27 offen offset:0 sc1 lds
    v_mfma_f32_16x16x32_bf16 a[48:51], v[164:167], v[24:27], a[48:51]
    v_exp_f32 v16, v72
    v_mfma_f32_16x16x32_bf16 a[48:51], v[180:183], v[28:31], a[48:51]
    v_exp_f32 v17, v73
    v_mfma_f32_16x16x32_bf16 a[96:99], v[168:171], v[24:27], a[96:99]
    ds_read_b128 v[44:47], v1 offset:14336
    v_fma_f32 v244, v244, v49, v51
    v_mfma_f32_16x16x32_bf16 a[96:99], v[184:187], v[28:31], a[96:99]
    v_exp_f32 v18, v74
    v_mfma_f32_16x16x32_bf16 a[144:147], v[172:175], v[24:27], a[144:147]
    v_add_f32 v7, v7, v16
    v_add_f32 v7, v7, v17
    v_mfma_f32_16x16x32_bf16 a[144:147], v[188:191], v[28:31], a[144:147]
    s_waitcnt lgkmcnt(2)
    v_exp_f32 v19, v75
    v_mfma_f32_16x16x32_bf16 a[4:7], v[160:163], v[32:35], a[4:7]
    ds_read_b128 v[24:27], v1 offset:3072
    v_cvt_f32_i32 v241, v241
    v_mfma_f32_16x16x32_bf16 a[4:7], v[176:179], v[36:39], a[4:7]
    buffer_load_dwordx4 v4, s[4:7], s27 offen offset:1024 sc1 lds
    v_mfma_f32_16x16x32_bf16 a[52:55], v[164:167], v[32:35], a[52:55]
    v_cvt_pk_bf16_f32 v72, v16, v17
    v_cvt_f32_i32 v245, v245
    v_mfma_f32_16x16x32_bf16 a[52:55], v[180:183], v[36:39], a[52:55]
    v_exp_f32 v16, v104
    v_mfma_f32_16x16x32_bf16 a[100:103], v[168:171], v[32:35], a[100:103]
    ds_read_b128 v[28:31], v1 offset:15360
    v_add_f32 v7, v7, v18
    v_mfma_f32_16x16x32_bf16 a[100:103], v[184:187], v[36:39], a[100:103]
    v_add_f32 v7, v7, v19
    v_bfe_u32 v53, v4, 4, 6
    v_mfma_f32_16x16x32_bf16 a[148:151], v[172:175], v[32:35], a[148:151]
    v_exp_f32 v17, v105
    v_mfma_f32_16x16x32_bf16 a[148:151], v[188:191], v[36:39], a[148:151]
    s_waitcnt lgkmcnt(2)
    v_cvt_pk_bf16_f32 v73, v18, v19
    v_fma_f32 v241, v241, v48, v50
    v_mfma_f32_16x16x32_bf16 a[8:11], v[160:163], v[40:43], a[8:11]
    ds_read_b128 v[32:35], v1 offset:4096
    v_lshlrev_b32 v53, 2, v53
    v_mfma_f32_16x16x32_bf16 a[8:11], v[176:179], v[44:47], a[8:11]
    buffer_load_dword v52, v53, s[20:23], s44 offen sc1
    v_mfma_f32_16x16x32_bf16 a[56:59], v[164:167], v[40:43], a[56:59]
    v_exp_f32 v18, v106
    v_mfma_f32_16x16x32_bf16 a[56:59], v[180:183], v[44:47], a[56:59]
    v_add_f32 v7, v7, v16
    v_add_f32 v7, v7, v17
    v_mfma_f32_16x16x32_bf16 a[104:107], v[168:171], v[40:43], a[104:107]
    ds_read_b128 v[36:39], v1 offset:16384
    v_fma_f32 v245, v245, v49, v51
    v_mfma_f32_16x16x32_bf16 a[104:107], v[184:187], v[44:47], a[104:107]
    buffer_load_dwordx4 v4, s[4:7], s27 offen offset:2048 sc1 lds
    v_mfma_f32_16x16x32_bf16 a[152:155], v[172:175], v[40:43], a[152:155]
    v_exp_f32 v19, v107
    v_mfma_f32_16x16x32_bf16 a[152:155], v[188:191], v[44:47], a[152:155]
    s_waitcnt lgkmcnt(2)
    v_cvt_pk_bf16_f32 v74, v16, v17
    v_cvt_f32_i32 v242, v242
    v_mfma_f32_16x16x32_bf16 a[12:15], v[160:163], v[24:27], a[12:15]
    ds_read_b128 v[40:43], v1 offset:5120
    v_cvt_f32_i32 v246, v246
    v_mfma_f32_16x16x32_bf16 a[12:15], v[176:179], v[28:31], a[12:15]
    s_add_u32 s27, s27, 24576
    v_exp_f32 v16, v76
    v_mfma_f32_16x16x32_bf16 a[60:63], v[164:167], v[24:27], a[60:63]
    v_add_f32 v7, v7, v18
    v_add_f32 v7, v7, v19
    v_mfma_f32_16x16x32_bf16 a[60:63], v[180:183], v[28:31], a[60:63]
    v_exp_f32 v17, v77
    v_mfma_f32_16x16x32_bf16 a[108:111], v[168:171], v[24:27], a[108:111]
    ds_read_b128 v[44:47], v1 offset:17408
    v_cvt_pk_bf16_f32 v75, v18, v19
    v_mfma_f32_16x16x32_bf16 a[108:111], v[184:187], v[28:31], a[108:111]
    v_exp_f32 v18, v78
    v_mfma_f32_16x16x32_bf16 a[156:159], v[172:175], v[24:27], a[156:159]
    s_add_u32 s29, s28, 49152
    v_fma_f32 v242, v242, v48, v50
    v_add_f32 v8, v8, v16
    v_mfma_f32_16x16x32_bf16 a[156:159], v[188:191], v[28:31], a[156:159]
    s_waitcnt lgkmcnt(2)
    v_add_f32 v8, v8, v17
    v_fma_f32 v246, v246, v49, v51
    v_mfma_f32_16x16x32_bf16 a[16:19], v[160:163], v[32:35], a[16:19]
    s_sub_u32 s3, s29, 147456
    ds_read_b128 v[24:27], v1 offset:6144
    v_lshlrev_b32 v48, 16, v61
    v_mfma_f32_16x16x32_bf16 a[16:19], v[176:179], v[36:39], a[16:19]
    s_add_u32 s56, s56, 12288
    v_exp_f32 v19, v79
    v_mfma_f32_16x16x32_bf16 a[64:67], v[164:167], v[32:35], a[64:67]
    s_min_u32 s29, s29, s3
    v_cvt_pk_bf16_f32 v76, v16, v17
    v_and_b32 v49, s97, v61
    v_mfma_f32_16x16x32_bf16 a[64:67], v[180:183], v[36:39], a[64:67]
    s_mov_b32 m0, s56
    v_exp_f32 v16, v108
    v_mfma_f32_16x16x32_bf16 a[112:115], v[168:171], v[32:35], a[112:115]
    ds_read_b128 v[28:31], v1 offset:18432
    v_add_f32 v8, v8, v18
    v_mfma_f32_16x16x32_bf16 a[112:115], v[184:187], v[36:39], a[112:115]
    v_add_f32 v8, v8, v19
    v_lshlrev_b32 v50, 16, v63
    v_mfma_f32_16x16x32_bf16 a[160:163], v[172:175], v[32:35], a[160:163]
    v_exp_f32 v17, v109
    v_mfma_f32_16x16x32_bf16 a[160:163], v[188:191], v[36:39], a[160:163]
    s_waitcnt lgkmcnt(2)
    v_cvt_pk_bf16_f32 v77, v18, v19
    v_and_b32 v51, s97, v63
    v_mfma_f32_16x16x32_bf16 a[20:23], v[160:163], v[40:43], a[20:23]
    s_sub_u32 s3, s29, s28
    ds_read_b128 v[32:35], v1 offset:7168
    v_mul_f32_e64 v50, -v50, v48
    v_mfma_f32_16x16x32_bf16 a[20:23], v[176:179], v[44:47], a[20:23]
    v_exp_f32 v18, v110
    v_mfma_f32_16x16x32_bf16 a[68:71], v[164:167], v[40:43], a[68:71]
    v_add_f32 v8, v8, v16
    v_add_f32 v8, v8, v17
    v_mfma_f32_16x16x32_bf16 a[68:71], v[180:183], v[44:47], a[68:71]
    buffer_load_dwordx4 v4, s[4:7], s27 offen offset:0 sc1 lds
    v_mfma_f32_16x16x32_bf16 a[116:119], v[168:171], v[40:43], a[116:119]
    ds_read_b128 v[36:39], v1 offset:19456
    v_mul_f32_e64 v51, -v51, v49
    v_mfma_f32_16x16x32_bf16 a[116:119], v[184:187], v[44:47], a[116:119]
    v_exp_f32 v19, v111
    v_mfma_f32_16x16x32_bf16 a[164:167], v[172:175], v[40:43], a[164:167]
    s_mov_b32 s28, s29
    v_cvt_pk_bf16_f32 v78, v16, v17
    v_add_f32 v8, v8, v18
    v_mfma_f32_16x16x32_bf16 a[164:167], v[188:191], v[44:47], a[164:167]
    s_waitcnt lgkmcnt(2)
    v_add_f32 v8, v8, v19
    v_cvt_pk_bf16_f32 v79, v18, v19
    v_mfma_f32_16x16x32_bf16 a[24:27], v[160:163], v[24:27], a[24:27]
    ds_read_b128 v[40:43], v1 offset:8192
    v_cvt_f32_i32 v248, v248
    v_mfma_f32_16x16x32_bf16 a[24:27], v[176:179], v[28:31], a[24:27]
    v_exp_f32 v16, v80
    v_mfma_f32_16x16x32_bf16 a[72:75], v[164:167], v[24:27], a[72:75]
    v_exp_f32 v17, v81
    v_mfma_f32_16x16x32_bf16 a[72:75], v[180:183], v[28:31], a[72:75]
    buffer_load_dwordx4 v4, s[4:7], s27 offen offset:1024 sc1 lds
    v_mfma_f32_16x16x32_bf16 a[120:123], v[168:171], v[24:27], a[120:123]
    ds_read_b128 v[44:47], v1 offset:20480
    v_cvt_f32_i32 v252, v252
    v_mfma_f32_16x16x32_bf16 a[120:123], v[184:187], v[28:31], a[120:123]
    v_exp_f32 v18, v82
    v_mfma_f32_16x16x32_bf16 a[168:171], v[172:175], v[24:27], a[168:171]
    v_add_f32 v5, v5, v16
    v_fma_f32 v248, v248, v48, v50
    v_mfma_f32_16x16x32_bf16 a[168:171], v[188:191], v[28:31], a[168:171]
    s_waitcnt lgkmcnt(2)
    v_add_f32 v5, v5, v17
    v_fma_f32 v252, v252, v49, v51
    v_mfma_f32_16x16x32_bf16 a[28:31], v[160:163], v[32:35], a[28:31]
    ds_read_b128 v[24:27], v1 offset:9216
    v_cvt_f32_i32 v249, v249
    v_mfma_f32_16x16x32_bf16 a[28:31], v[176:179], v[36:39], a[28:31]
    v_exp_f32 v19, v83
    v_mfma_f32_16x16x32_bf16 a[76:79], v[164:167], v[32:35], a[76:79]
    v_cvt_pk_bf16_f32 v80, v16, v17
    v_cvt_f32_i32 v253, v253
    v_mfma_f32_16x16x32_bf16 a[76:79], v[180:183], v[36:39], a[76:79]
    v_exp_f32 v16, v112
    v_mfma_f32_16x16x32_bf16 a[124:127], v[168:171], v[32:35], a[124:127]
    ds_read_b128 v[28:31], v1 offset:21504
    v_add_f32 v5, v5, v18
    v_mfma_f32_16x16x32_bf16 a[124:127], v[184:187], v[36:39], a[124:127]
    buffer_load_dwordx4 v4, s[4:7], s27 offen offset:2048 sc1 lds
    v_mfma_f32_16x16x32_bf16 a[172:175], v[172:175], v[32:35], a[172:175]
    v_add_f32 v5, v5, v19
    v_fma_f32 v249, v249, v48, v50
    v_mfma_f32_16x16x32_bf16 a[172:175], v[188:191], v[36:39], a[172:175]
    s_waitcnt lgkmcnt(2)
    v_exp_f32 v17, v113
    v_mfma_f32_16x16x32_bf16 a[32:35], v[160:163], v[40:43], a[32:35]
    ds_read_b128 v[32:35], v1 offset:10240
    v_cvt_pk_bf16_f32 v81, v18, v19
    v_mfma_f32_16x16x32_bf16 a[32:35], v[176:179], v[44:47], a[32:35]
    v_exp_f32 v18, v114
    v_mfma_f32_16x16x32_bf16 a[80:83], v[164:167], v[40:43], a[80:83]
    v_add_f32 v5, v5, v16
    v_add_f32 v5, v5, v17
    v_mfma_f32_16x16x32_bf16 a[80:83], v[180:183], v[44:47], a[80:83]
    v_exp_f32 v19, v115
    v_mfma_f32_16x16x32_bf16 a[128:131], v[168:171], v[40:43], a[128:131]
    ds_read_b128 v[36:39], v1 offset:22528
    v_fma_f32 v253, v253, v49, v51
    v_mfma_f32_16x16x32_bf16 a[128:131], v[184:187], v[44:47], a[128:131]
    v_add_u32 v2, s3, v2
    v_cvt_pk_bf16_f32 v82, v16, v17
    v_mfma_f32_16x16x32_bf16 a[176:179], v[172:175], v[40:43], a[176:179]
    v_exp_f32 v16, v84
    v_mfma_f32_16x16x32_bf16 a[176:179], v[188:191], v[44:47], a[176:179]
    s_waitcnt lgkmcnt(2)
    v_cvt_f32_i32 v250, v250
    v_add_f32 v5, v5, v18
    v_mfma_f32_16x16x32_bf16 a[36:39], v[160:163], v[24:27], a[36:39]
    ds_read_b128 v[40:43], v1 offset:11264
    v_add_f32 v5, v5, v19
    v_mfma_f32_16x16x32_bf16 a[36:39], v[176:179], v[28:31], a[36:39]
    v_exp_f32 v17, v85
    v_mfma_f32_16x16x32_bf16 a[84:87], v[164:167], v[24:27], a[84:87]
    v_add_u32 v3, s3, v3
    v_cvt_f32_i32 v254, v254
    v_mfma_f32_16x16x32_bf16 a[84:87], v[180:183], v[28:31], a[84:87]
    s_add_u32 s27, s27, 24576
    v_cvt_pk_bf16_f32 v83, v18, v19
    v_fma_f32 v250, v250, v48, v50
    v_mfma_f32_16x16x32_bf16 a[132:135], v[168:171], v[24:27], a[132:135]
    s_add_u32 s56, s56, 36864
    ds_read_b128 v[44:47], v1 offset:23552
    v_fma_f32 v254, v254, v49, v51
    v_mfma_f32_16x16x32_bf16 a[132:135], v[184:187], v[28:31], a[132:135]
    s_sub_u32 s58, s56, 147456
    v_exp_f32 v18, v86
    v_mfma_f32_16x16x32_bf16 a[180:183], v[172:175], v[24:27], a[180:183]
    v_add_f32 v6, v6, v16
    v_add_f32 v6, v6, v17
    v_mfma_f32_16x16x32_bf16 a[180:183], v[188:191], v[28:31], a[180:183]
    s_waitcnt lgkmcnt(2)
    v_exp_f32 v19, v87
    v_mfma_f32_16x16x32_bf16 a[40:43], v[160:163], v[32:35], a[40:43]
    s_min_u32 s56, s56, s58
    ds_read_b128 v[24:27], v2 offset:0
    v_cvt_pk_bf16_f32 v146, v240, v244
    v_mfma_f32_16x16x32_bf16 a[40:43], v[176:179], v[36:39], a[40:43]
    buffer_load_dword v20, v4, s[88:91], s93 offen
    v_mfma_f32_16x16x32_bf16 a[88:91], v[164:167], v[32:35], a[88:91]
    v_cvt_pk_bf16_f32 v84, v16, v17
    v_cvt_pk_bf16_f32 v150, v241, v245
    v_mfma_f32_16x16x32_bf16 a[88:91], v[180:183], v[36:39], a[88:91]
    v_exp_f32 v16, v116
    v_mfma_f32_16x16x32_bf16 a[136:139], v[168:171], v[32:35], a[136:139]
    ds_read_b128 v[28:31], v3 offset:0
    v_add_f32 v6, v6, v18
    v_mfma_f32_16x16x32_bf16 a[136:139], v[184:187], v[36:39], a[136:139]
    v_add_f32 v6, v6, v19
    v_cvt_pk_bf16_f32 v147, v248, v252
    v_mfma_f32_16x16x32_bf16 a[184:187], v[172:175], v[32:35], a[184:187]
    v_exp_f32 v17, v117
    v_mfma_f32_16x16x32_bf16 a[184:187], v[188:191], v[36:39], a[184:187]
    s_waitcnt lgkmcnt(2)
    v_cvt_pk_bf16_f32 v85, v18, v19
    v_cvt_pk_bf16_f32 v151, v249, v253
    v_mfma_f32_16x16x32_bf16 a[44:47], v[160:163], v[40:43], a[44:47]
    ds_read_b128 v[32:35], v2 offset:6144
    v_cvt_pk_bf16_f32 v154, v242, v246
    v_mfma_f32_16x16x32_bf16 a[44:47], v[176:179], v[44:47], a[44:47]
    v_exp_f32 v18, v118
    v_mfma_f32_16x16x32_bf16 a[92:95], v[164:167], v[40:43], a[92:95]
    v_add_f32 v6, v6, v16
    v_add_f32 v6, v6, v17
    v_mfma_f32_16x16x32_bf16 a[92:95], v[180:183], v[44:47], a[92:95]
    v_exp_f32 v19, v119
    v_mfma_f32_16x16x32_bf16 a[140:143], v[168:171], v[40:43], a[140:143]
    ds_read_b128 v[36:39], v3 offset:6144
    v_cvt_pk_bf16_f32 v86, v16, v17
    v_mfma_f32_16x16x32_bf16 a[140:143], v[184:187], v[44:47], a[140:143]
    v_add_f32 v6, v6, v18
    v_cvt_pk_bf16_f32 v155, v250, v254
    v_mfma_f32_16x16x32_bf16 a[188:191], v[172:175], v[40:43], a[188:191]
    v_add_f32 v6, v6, v19
    v_cvt_pk_bf16_f32 v87, v18, v19
    v_mfma_f32_16x16x32_bf16 a[188:191], v[188:191], v[44:47], a[188:191]
    s_waitcnt lgkmcnt(2)
L_join:
    v_mfma_f32_16x16x32_bf16 v[160:163], v[24:27], a[192:195], v[128:131]
L_pg5:
    s_cbranch_execz L_pg9
    s_waitcnt vmcnt(7)
    ds_read_b128 v[40:43], v2 offset:128
    v_lshlrev_b32 v48, 16, v56
    v_mfma_f32_16x16x32_bf16 v[160:163], v[28:31], a[196:199], v[160:163]
    s_waitcnt vmcnt(5)
    v_subrev_u32 v52, s92, v52
    v_cmp_lt_u32 vcc, 15, v52
    v_mfma_f32_16x16x32_bf16 v[164:167], v[24:27], a[216:219], v[132:135]
    v_exp_f32 v16, v88
    v_mfma_f32_16x16x32_bf16 v[164:167], v[28:31], a[220:223], v[164:167]
    v_exp_f32 v17, v89
    v_mfma_f32_16x16x32_bf16 v[168:171], v[24:27], a[240:243], v[136:139]
    s_and_b32 s59, vcc_lo, 0xff
    ds_read_b128 v[44:47], v3 offset:128
    v_and_b32 v49, s97, v56
    v_mfma_f32_16x16x32_bf16 v[168:171], v[28:31], a[244:247], v[168:171]
    s_cbranch_scc1 L_pollslow1
L_pollok1:
    v_mfma_f32_16x16x32_bf16 v[172:175], v[24:27], v[200:203], v[140:143]
    s_add_u32 s92, s92, 1
    v_exp_f32 v18, v90
    v_mfma_f32_16x16x32_bf16 v[172:175], v[28:31], v[204:207], v[172:175]
    s_waitcnt lgkmcnt(2)
    v_add_f32 v7, v7, v16
    v_add_f32 v7, v7, v17
    v_mfma_f32_16x16x32_bf16 v[96:99], v[32:35], a[192:195], v[128:131]
    ds_read_b128 v[24:27], v2 offset:6272
    v_lshlrev_b32 v50, 16, v58
    v_mfma_f32_16x16x32_bf16 v[96:99], v[36:39], a[196:199], v[96:99]
    buffer_store_dwordx4 v[144:147], v15, s[4:7], s35 offen offset:0 sc1
    v_mfma_f32_16x16x32_bf16 v[100:103], v[32:35], a[216:219], v[132:135]
    v_exp_f32 v19, v91
    v_mfma_f32_16x16x32_bf16 v[100:103], v[36:39], a[220:223], v[100:103]
    v_cvt_pk_bf16_f32 v88, v16, v17
    v_and_b32 v51, s97, v58
    v_mfma_f32_16x16x32_bf16 v[104:107], v[32:35], a[240:243], v[136:139]
    ds_read_b128 v[28:31], v3 offset:6272
    v_mfma_f32_16x16x32_bf16 v[104:107], v[36:39], a[244:247], v[104:107]
    v_exp_f32 v16, v120
    v_mfma_f32_16x16x32_bf16 v[108:111], v[32:35], v[200:203], v[140:143]
    v_add_f32 v7, v7, v18
    v_add_f32 v7, v7, v19
    v_mfma_f32_16x16x32_bf16 v[108:111], v[36:39], v[204:207], v[108:111]
    s_waitcnt lgkmcnt(2)
    v_exp_f32 v17, v121
    v_mfma_f32_16x16x32_bf16 v[160:163], v[40:43], a[200:203], v[160:163]
    ds_read_b128 v[32:35], v2 offset:256
    v_cvt_pk_bf16_f32 v89, v18, v19
    v_mfma_f32_16x16x32_bf16 v[160:163], v[44:47], a[204:207], v[160:163]
    buffer_store_dwordx4 v[148:151], v15, s[4:7], s35 offen offset:1024 sc1
    v_mfma_f32_16x16x32_bf16 v[164:167], v[40:43], a[224:227], v[164:167]
    v_exp_f32 v18, v122
    v_mfma_f32_16x16x32_bf16 v[164:167], v[44:47], a[228:231], v[164:167]
    v_add_f32 v7, v7, v16
    v_add_f32 v7, v7, v17
    v_mfma_f32_16x16x32_bf16 v[168:171], v[40:43], a[248:251], v[168:171]
    ds_read_b128 v[36:39], v3 offset:256
    v_mul_f32 v48, s38, v48
    v_mfma_f32_16x16x32_bf16 v[168:171], v[44:47], a[252:255], v[168:171]
    v_exp_f32 v19, v123
    v_mfma_f32_16x16x32_bf16 v[172:175], v[40:43], v[208:211], v[172:175]
    v_cvt_pk_bf16_f32 v90, v16, v17
    v_mul_f32 v49, s38, v49
    v_mfma_f32_16x16x32_bf16 v[172:175], v[44:47], v[212:215], v[172:175]
    s_waitcnt lgkmcnt(2)
    v_exp_f32 v16, v92
    v_mfma_f32_16x16x32_bf16 v[96:99], v[24:27], a[200:203], v[96:99]
    ds_read_b128 v[40:43], v2 offset:6400
    v_add_f32 v7, v7, v18
    v_mfma_f32_16x16x32_bf16 v[96:99], v[28:31], a[204:207], v[96:99]
    buffer_store_dwordx4 v[152:155], v15, s[4:7], s35 offen offset:2048 sc1
    v_mfma_f32_16x16x32_bf16 v[100:103], v[24:27], a[224:227], v[100:103]
    v_add_f32 v7, v7, v19
    v_mul_f32_e64 v50, -v50, v48
    v_mfma_f32_16x16x32_bf16 v[100:103], v[28:31], a[228:231], v[100:103]
    v_exp_f32 v17, v93
    v_mfma_f32_16x16x32_bf16 v[104:107], v[24:27], a[248:251], v[104:107]
    ds_read_b128 v[44:47], v3 offset:6400
    v_cvt_pk_bf16_f32 v91, v18, v19
    v_mfma_f32_16x16x32_bf16 v[104:107], v[28:31], a[252:255], v[104:107]
    v_exp_f32 v18, v94
    v_mfma_f32_16x16x32_bf16 v[108:111], v[24:27], v[208:211], v[108:111]
    s_add_u32 s29, s30, 49152
    v_add_f32 v8, v8, v16
    v_add_f32 v8, v8, v17
    v_mfma_f32_16x16x32_bf16 v[108:111], v[28:31], v[212:215], v[108:111]
    s_waitcnt lgkmcnt(2)
    v_exp_f32 v19, v95
    v_mfma_f32_16x16x32_bf16 v[160:163], v[32:35], a[208:211], v[160:163]
    s_sub_u32 s3, s29, 147456
    ds_read_b128 v[24:27], v2 offset:12288
    v_cvt_pk_bf16_f32 v92, v16, v17
    v_mfma_f32_16x16x32_bf16 v[160:163], v[36:39], a[212:215], v[160:163]
    s_min_u32 s29, s29, s3
    v_exp_f32 v16, v124
    v_mfma_f32_16x16x32_bf16 v[164:167], v[32:35], a[232:235], v[164:167]
    v_add_f32 v8, v8, v18
    v_mul_f32_e64 v51, -v51, v49
    v_mfma_f32_16x16x32_bf16 v[164:167], v[36:39], a[236:239], v[164:167]
    v_add_f32 v8, v8, v19
    v_cvt_f32_i32 v224, v224
    v_mfma_f32_16x16x32_bf16 v[168:171], v[32:35], v[192:195], v[168:171]
    ds_read_b128 v[28:31], v3 offset:12288
    v_mfma_f32_16x16x32_bf16 v[168:171], v[36:39], v[196:199], v[168:171]
    v_exp_f32 v17, v125
    v_mfma_f32_16x16x32_bf16 v[172:175], v[32:35], v[216:219], v[172:175]
    v_cvt_pk_bf16_f32 v93, v18, v19
    v_cvt_f32_i32 v225, v225
    v_mfma_f32_16x16x32_bf16 v[172:175], v[36:39], v[220:223], v[172:175]
    s_waitcnt lgkmcnt(2)
    v_exp_f32 v18, v126
    v_mfma_f32_16x16x32_bf16 v[96:99], v[40:43], a[208:211], v[96:99]
    ds_read_b128 v[32:35], v2 offset:18432
    v_add_f32 v8, v8, v16
    v_mfma_f32_16x16x32_bf16 v[96:99], v[44:47], a[212:215], v[96:99]
    s_mov_b32 m0, s26
    v_add_f32 v8, v8, v17
    s_sub_u32 s3, s29, s30
    v_mfma_f32_16x16x32_bf16 v[100:103], v[40:43], a[232:235], v[100:103]
    v_exp_f32 v19, v127
    v_mfma_f32_16x16x32_bf16 v[100:103], v[44:47], a[236:239], v[100:103]
    buffer_load_dwordx4 v4, s[4:7], s32 offen offset:0 sc1 lds
    v_mfma_f32_16x16x32_bf16 v[104:107], v[40:43], v[192:195], v[104:107]
    ds_read_b128 v[36:39], v3 offset:18432
    v_cvt_pk_bf16_f32 v94, v16, v17
    v_mfma_f32_16x16x32_bf16 v[104:107], v[44:47], v[196:199], v[104:107]
    v_add_f32 v8, v8, v18
    v_add_f32 v8, v8, v19
    v_mfma_f32_16x16x32_bf16 v[108:111], v[40:43], v[216:219], v[108:111]
    v_cvt_pk_bf16_f32 v95, v18, v19
    v_fma_f32 v224, v224, v48, v50
    v_mfma_f32_16x16x32_bf16 v[108:111], v[44:47], v[220:223], v[108:111]
    s_waitcnt lgkmcnt(2)
    buffer_load_dwordx4 v4, s[4:7], s32 offen offset:1024 sc1 lds
    v_mfma_f32_16x16x32_bf16 v[176:179], v[24:27], a[192:195], v[128:131]
    ds_read_b128 v[40:43], v2 offset:12416
    v_fma_f32 v225, v225, v49, v51
    v_mfma_f32_16x16x32_bf16 v[176:179], v[28:31], a[196:199], v[176:179]
    s_mov_b32 s30, s29
    v_exp_f32 v16, v160
    v_mfma_f32_16x16x32_bf16 v[180:183], v[24:27], a[216:219], v[132:135]
    v_exp_f32 v17, v161
    v_mfma_f32_16x16x32_bf16 v[180:183], v[28:31], a[220:223], v[180:183]
    buffer_load_dwordx4 v4, s[4:7], s32 offen offset:2048 sc1 lds
    v_mfma_f32_16x16x32_bf16 v[184:187], v[24:27], a[240:243], v[136:139]
    s_add_u32 s32, s32, 24576
    ds_read_b128 v[44:47], v3 offset:12416
    v_cvt_pk_bf16_f32 v224, v224, v225
    v_mfma_f32_16x16x32_bf16 v[184:187], v[28:31], a[244:247], v[184:187]
    v_exp_f32 v18, v162
    v_mfma_f32_16x16x32_bf16 v[188:191], v[24:27], v[200:203], v[140:143]
    s_add_u32 s26, s26, 12288
    v_add_f32 v5, v5, v16
    v_add_f32 v5, v5, v17
    v_mfma_f32_16x16x32_bf16 v[188:191], v[28:31], v[204:207], v[188:191]
    s_waitcnt lgkmcnt(2)
    v_exp_f32 v19, v163
    v_mfma_f32_16x16x32_bf16 v[112:115], v[32:35], a[192:195], v[128:131]
    s_mov_b32 m0, s26
    ds_read_b128 v[24:27], v2 offset:18560
    v_cvt_pk_bf16_f32 v160, v16, v17
    v_mfma_f32_16x16x32_bf16 v[112:115], v[36:39], a[196:199], v[112:115]
    v_exp_f32 v16, v96
    v_mfma_f32_16x16x32_bf16 v[116:119], v[32:35], a[216:219], v[132:135]
    v_add_f32 v5, v5, v18
    v_cvt_f32_i32 v228, v228
    v_mfma_f32_16x16x32_bf16 v[116:119], v[36:39], a[220:223], v[116:119]
    v_add_f32 v5, v5, v19
    v_add_u32 v1, s3, v1
    v_mfma_f32_16x16x32_bf16 v[120:123], v[32:35], a[240:243], v[136:139]
    ds_read_b128 v[28:31], v3 offset:18560
    v_mfma_f32_16x16x32_bf16 v[120:123], v[36:39], a[244:247], v[120:123]
    buffer_load_dwordx4 v4, s[4:7], s32 offen offset:0 sc1 lds
    v_mfma_f32_16x16x32_bf16 v[124:127], v[32:35], v[200:203], v[140:143]
    v_exp_f32 v17, v97
    v_mfma_f32_16x16x32_bf16 v[124:127], v[36:39], v[204:207], v[124:127]
    s_waitcnt lgkmcnt(2)
    v_cvt_pk_bf16_f32 v161, v18, v19
    v_cvt_f32_i32 v229, v229
    v_mfma_f32_16x16x32_bf16 v[176:179], v[40:43], a[200:203], v[176:179]
    ds_read_b128 v[32:35], v2 offset:12544
    v_mfma_f32_16x16x32_bf16 v[176:179], v[44:47], a[204:207], v[176:179]
    buffer_load_dwordx4 v4, s[4:7], s32 offen offset:1024 sc1 lds
    v_mfma_f32_16x16x32_bf16 v[180:183], v[40:43], a[224:227], v[180:183]
    v_exp_f32 v18, v98
    v_mfma_f32_16x16x32_bf16 v[180:183], v[44:47], a[228:231], v[180:183]
    v_add_f32 v5, v5, v16
    v_add_f32 v5, v5, v17
    v_mfma_f32_16x16x32_bf16 v[184:187], v[40:43], a[248:251], v[184:187]
    ds_read_b128 v[36:39], v3 offset:12544
    v_fma_f32 v228, v228, v48, v50
    v_mfma_f32_16x16x32_bf16 v[184:187], v[44:47], a[252:255], v[184:187]
    buffer_load_dwordx4 v4, s[4:7], s32 offen offset:2048 sc1 lds
    v_mfma_f32_16x16x32_bf16 v[188:191], v[40:43], v[208:211], v[188:191]
    v_exp_f32 v19, v99
    v_mfma_f32_16x16x32_bf16 v[188:191], v[44:47], v[212:215], v[188:191]
    s_waitcnt lgkmcnt(2)
    v_cvt_pk_bf16_f32 v162, v16, v17
    v_fma_f32 v229, v229, v49, v51
    v_mfma_f32_16x16x32_bf16 v[112:115], v[24:27], a[200:203], v[112:115]
    ds_read_b128 v[40:43], v2 offset:18688
    v_mfma_f32_16x16x32_bf16 v[112:115], v[28:31], a[204:207], v[112:115]
    v_exp_f32 v16, v164
    v_mfma_f32_16x16x32_bf16 v[116:119], v[24:27], a[224:227], v[116:119]
    v_add_f32 v5, v5, v18
    v_add_f32 v5, v5, v19
    v_mfma_f32_16x16x32_bf16 v[116:119], v[28:31], a[228:231], v[116:119]
    s_add_u32 s32, s32, 24576
    v_exp_f32 v17, v165
    v_mfma_f32_16x16x32_bf16 v[120:123], v[24:27], a[248:251], v[120:123]
    s_add_u32 s26, s26, 36864
    ds_read_b128 v[44:47], v3 offset:18688
    v_cvt_pk_bf16_f32 v163, v18, v19
    v_mfma_f32_16x16x32_bf16 v[120:123], v[28:31], a[252:255], v[120:123]
    s_waitcnt lgkmcnt(2)
    v_exp_f32 v18, v166
    v_mfma_f32_16x16x32_bf16 v[124:127], v[24:27], v[208:211], v[124:127]
    s_waitcnt vmcnt(6)
    v_add_f32 v6, v6, v16
    v_add_f32 v6, v6, v17
    v_mfma_f32_16x16x32_bf16 v[124:127], v[28:31], v[212:215], v[124:127]
    s_barrier
    s_sub_u32 s57, s26, 147456
    v_mfma_f32_16x16x32_bf16 v[176:179], v[32:35], a[208:211], v[176:179]
    s_min_u32 s26, s26, s57
    ds_read_b128 v[24:27], v1 offset:0
    v_add_u32 v0, 1, v0
    v_mfma_f32_16x16x32_bf16 v[176:179], v[36:39], a[212:215], v[176:179]
    buffer_store_dword v0, v13, s[20:23], 0 offen offset:32 sc1
    v_mfma_f32_16x16x32_bf16 v[180:183], v[32:35], a[232:235], v[180:183]
    v_exp_f32 v19, v167
    v_mfma_f32_16x16x32_bf16 v[180:183], v[36:39], a[236:239], v[180:183]
    v_cvt_pk_bf16_f32 v164, v16, v17
    v_cvt_pk_bf16_f32 v228, v228, v229
    v_mfma_f32_16x16x32_bf16 v[184:187], v[32:35], v[192:195], v[184:187]
    ds_read_b128 v[28:31], v1 offset:12288
    v_cvt_f32_i32 v232, v232
    v_mfma_f32_16x16x32_bf16 v[184:187], v[36:39], v[196:199], v[184:187]
    v_exp_f32 v16, v100
    v_mfma_f32_16x16x32_bf16 v[188:191], v[32:35], v[216:219], v[188:191]
    v_add_f32 v6, v6, v18
    v_add_f32 v6, v6, v19
    v_mfma_f32_16x16x32_bf16 v[188:191], v[36:39], v[220:223], v[188:191]
    s_waitcnt lgkmcnt(2)
    v_exp_f32 v17, v101
    v_mfma_f32_16x16x32_bf16 v[112:115], v[40:43], a[208:211], v[112:115]
    ds_read_b128 v[32:35], v1 offset:1024
    v_cvt_pk_bf16_f32 v165, v18, v19
    v_mfma_f32_16x16x32_bf16 v[112:115], v[44:47], a[212:215], v[112:115]
    v_exp_f32 v18, v102
    v_mfma_f32_16x16x32_bf16 v[116:119], v[40:43], a[232:235], v[116:119]
    v_add_f32 v6, v6, v16
    v_add_f32 v6, v6, v17
    v_mfma_f32_16x16x32_bf16 v[116:119], v[44:47], a[236:239], v[116:119]
    v_exp_f32 v19, v103
    v_mfma_f32_16x16x32_bf16 v[120:123], v[40:43], v[192:195], v[120:123]
    ds_read_b128 v[36:39], v1 offset:13312
    v_cvt_pk_bf16_f32 v166, v16, v17
    v_mfma_f32_16x16x32_bf16 v[120:123], v[44:47], v[196:199], v[120:123]
    v_add_f32 v6, v6, v18
    v_cvt_f32_i32 v233, v233
    v_mfma_f32_16x16x32_bf16 v[124:127], v[40:43], v[216:219], v[124:127]
    v_add_f32 v6, v6, v19
    v_cvt_pk_bf16_f32 v167, v18, v19
    v_mfma_f32_16x16x32_bf16 v[124:127], v[44:47], v[220:223], v[124:127]
    s_waitcnt lgkmcnt(2)
    v_mfma_f32_16x16x32_bf16 a[0:3], v[64:67], v[24:27], a[0:3]
    s_mov_b32 m0, s26
    ds_read_b128 v[40:43], v1 offset:2048
    v_fma_f32 v232, v232, v48, v50
    v_mfma_f32_16x16x32_bf16 a[0:3], v[80:83], v[28:31], a[0:3]
    buffer_load_dwordx2 v[60:61], v10, s[72:75], s36 offen offset:192
    v_mfma_f32_16x16x32_bf16 a[48:51], v[68:71], v[24:27], a[48:51]
    v_exp_f32 v16, v168
    v_mfma_f32_16x16x32_bf16 a[48:51], v[84:87], v[28:31], a[48:51]
    v_exp_f32 v17, v169
    v_mfma_f32_16x16x32_bf16 a[96:99], v[72:75], v[24:27], a[96:99]
    ds_read_b128 v[44:47], v1 offset:14336
    v_fma_f32 v233, v233, v49, v51
    v_mfma_f32_16x16x32_bf16 a[96:99], v[88:91], v[28:31], a[96:99]
    buffer_load_dwordx4 v4, s[4:7], s32 offen offset:0 sc1 lds
    v_mfma_f32_16x16x32_bf16 a[144:147], v[76:79], v[24:27], a[144:147]
    v_exp_f32 v18, v170
    v_mfma_f32_16x16x32_bf16 a[144:147], v[92:95], v[28:31], a[144:147]
    s_waitcnt lgkmcnt(2)
    v_add_f32 v7, v7, v16
    v_add_f32 v7, v7, v17
    v_mfma_f32_16x16x32_bf16 a[4:7], v[64:67], v[32:35], a[4:7]
    ds_read_b128 v[24:27], v1 offset:3072
    v_cvt_pk_bf16_f32 v232, v232, v233
    v_mfma_f32_16x16x32_bf16 a[4:7], v[80:83], v[36:39], a[4:7]
L_pg6:
    s_cbranch_execz L_pg10
    buffer_load_dwordx2 v[62:63], v10, s[76:79], s36 offen offset:192
    v_mfma_f32_16x16x32_bf16 a[52:55], v[68:71], v[32:35], a[52:55]
    v_exp_f32 v19, v171
    v_mfma_f32_16x16x32_bf16 a[52:55], v[84:87], v[36:39], a[52:55]
    v_cvt_pk_bf16_f32 v168, v16, v17
    v_cvt_f32_i32 v236, v236
    v_mfma_f32_16x16x32_bf16 a[100:103], v[72:75], v[32:35], a[100:103]
    ds_read_b128 v[28:31], v1 offset:15360
    v_cvt_f32_i32 v237, v237
    v_mfma_f32_16x16x32_bf16 a[100:103], v[88:91], v[36:39], a[100:103]
    buffer_load_dwordx4 v[240:243], v9, s[64:67], s33 offen offset:384 nt
    v_mfma_f32_16x16x32_bf16 a[148:151], v[76:79], v[32:35], a[148:151]
    v_exp_f32 v16, v104
    v_mfma_f32_16x16x32_bf16 a[148:151], v[92:95], v[36:39], a[148:151]
    s_waitcnt lgkmcnt(2)
    v_add_f32 v7, v7, v18
    v_add_f32 v7, v7, v19
    v_mfma_f32_16x16x32_bf16 a[8:11], v[64:67], v[40:43], a[8:11]
    ds_read_b128 v[32:35], v1 offset:4096
    v_fma_f32 v236, v236, v48, v50
    v_mfma_f32_16x16x32_bf16 a[8:11], v[80:83], v[44:47], a[8:11]
    buffer_load_dwordx4 v4, s[4:7], s32 offen offset:1024 sc1 lds
    v_mfma_f32_16x16x32_bf16 a[56:59], v[68:71], v[40:43], a[56:59]
    v_exp_f32 v17, v105
    v_mfma_f32_16x16x32_bf16 a[56:59], v[84:87], v[44:47], a[56:59]
    v_cvt_pk_bf16_f32 v169, v18, v19
    v_fma_f32 v237, v237, v49, v51
    v_mfma_f32_16x16x32_bf16 a[104:107], v[72:75], v[40:43], a[104:107]
    ds_read_b128 v[36:39], v1 offset:16384
    v_mfma_f32_16x16x32_bf16 a[104:107], v[88:91], v[44:47], a[104:107]
    buffer_load_dwordx4 v[244:247], v9, s[64:67], s33 offen offset:1920 nt
    v_mfma_f32_16x16x32_bf16 a[152:155], v[76:79], v[40:43], a[152:155]
    v_exp_f32 v18, v106
    v_mfma_f32_16x16x32_bf16 a[152:155], v[92:95], v[44:47], a[152:155]
    s_waitcnt lgkmcnt(2)
    v_add_f32 v7, v7, v16
    v_add_f32 v7, v7, v17
    v_mfma_f32_16x16x32_bf16 a[12:15], v[64:67], v[24:27], a[12:15]
    ds_read_b128 v[40:43], v1 offset:5120
    v_cvt_pk_bf16_f32 v236, v236, v237
    v_mfma_f32_16x16x32_bf16 a[12:15], v[80:83], v[28:31], a[12:15]
    buffer_load_dwordx4 v4, s[4:7], s32 offen offset:2048 sc1 lds
    v_mfma_f32_16x16x32_bf16 a[60:63], v[68:71], v[24:27], a[60:63]
    v_exp_f32 v19, v107
    v_mfma_f32_16x16x32_bf16 a[60:63], v[84:87], v[28:31], a[60:63]
    v_cvt_pk_bf16_f32 v170, v16, v17
    v_exp_f32 v16, v172
    v_mfma_f32_16x16x32_bf16 a[108:111], v[72:75], v[24:27], a[108:111]
    ds_read_b128 v[44:47], v1 offset:17408
    v_add_f32 v7, v7, v18
    v_mfma_f32_16x16x32_bf16 a[108:111], v[88:91], v[28:31], a[108:111]
    buffer_load_dwordx4 v[248:251], v9, s[64:67], s34 offen offset:384 nt
    v_add_f32 v7, v7, v19
    v_mfma_f32_16x16x32_bf16 a[156:159], v[76:79], v[24:27], a[156:159]
    s_add_u32 s29, s28, 49152
    v_exp_f32 v17, v173
    v_mfma_f32_16x16x32_bf16 a[156:159], v[92:95], v[28:31], a[156:159]
    s_waitcnt lgkmcnt(2)
    v_cvt_pk_bf16_f32 v171, v18, v19
    v_lshlrev_b32 v48, 16, v57
    v_mfma_f32_16x16x32_bf16 a[16:19], v[64:67], v[32:35], a[16:19]
    s_sub_u32 s3, s29, 147456
    ds_read_b128 v[24:27], v1 offset:6144
    v_and_b32 v49, s97, v57
    v_mfma_f32_16x16x32_bf16 a[16:19], v[80:83], v[36:39], a[16:19]
    s_add_u32 s32, s32, 24576
    buffer_load_dwordx4 v[252:255], v9, s[64:67], s34 offen offset:1920 nt
    v_mfma_f32_16x16x32_bf16 a[64:67], v[68:71], v[32:35], a[64:67]
    s_min_u32 s29, s29, s3
    v_exp_f32 v18, v174
    v_mfma_f32_16x16x32_bf16 a[64:67], v[84:87], v[36:39], a[64:67]
    v_add_f32 v8, v8, v16
    v_add_f32 v8, v8, v17
    v_mfma_f32_16x16x32_bf16 a[112:115], v[72:75], v[32:35], a[112:115]
    s_add_u32 s26, s26, 12288
    ds_read_b128 v[28:31], v1 offset:18432
    v_lshlrev_b32 v50, 16, v59
    v_mfma_f32_16x16x32_bf16 a[112:115], v[88:91], v[36:39], a[112:115]
    v_exp_f32 v19, v175
    v_cvt_pk_bf16_f32 v172, v16, v17
    v_mfma_f32_16x16x32_bf16 a[160:163], v[76:79], v[32:35], a[160:163]
    v_exp_f32 v16, v108
    v_mfma_f32_16x16x32_bf16 a[160:163], v[92:95], v[36:39], a[160:163]
    s_waitcnt lgkmcnt(2)
    v_add_f32 v8, v8, v18
    v_add_f32 v8, v8, v19
    v_mfma_f32_16x16x32_bf16 a[20:23], v[64:67], v[40:43], a[20:23]
    s_sub_u32 s3, s29, s28
    ds_read_b128 v[32:35], v1 offset:7168
    v_and_b32 v51, s97, v59
    v_mfma_f32_16x16x32_bf16 a[20:23], v[80:83], v[44:47], a[20:23]
    v_exp_f32 v17, v109
    v_mfma_f32_16x16x32_bf16 a[68:71], v[68:71], v[40:43], a[68:71]
    s_mov_b32 m0, s26
    v_cvt_pk_bf16_f32 v173, v18, v19
    v_mul_f32 v48, s38, v48
    v_mfma_f32_16x16x32_bf16 a[68:71], v[84:87], v[44:47], a[68:71]
    v_exp_f32 v18, v110
    v_mfma_f32_16x16x32_bf16 a[116:119], v[72:75], v[40:43], a[116:119]
    ds_read_b128 v[36:39], v1 offset:19456
    v_add_f32 v8, v8, v16
    v_mfma_f32_16x16x32_bf16 a[116:119], v[88:91], v[44:47], a[116:119]
    v_add_f32 v8, v8, v17
    v_mul_f32 v49, s38, v49
    v_mfma_f32_16x16x32_bf16 a[164:167], v[76:79], v[40:43], a[164:167]
    s_mov_b32 s28, s29
    v_exp_f32 v19, v111
    v_mfma_f32_16x16x32_bf16 a[164:167], v[92:95], v[44:47], a[164:167]
    s_waitcnt lgkmcnt(2)
    v_cvt_pk_bf16_f32 v174, v16, v17
    v_add_f32 v8, v8, v18
    v_mfma_f32_16x16x32_bf16 a[24:27], v[64:67], v[24:27], a[24:27]
    ds_read_b128 v[40:43], v1 offset:8192
    v_add_f32 v8, v8, v19
    v_mfma_f32_16x16x32_bf16 a[24:27], v[80:83], v[28:31], a[24:27]
    v_cvt_pk_bf16_f32 v175, v18, v19
    v_mul_f32_e64 v50, -v50, v48
    v_mfma_f32_16x16x32_bf16 a[72:75], v[68:71], v[24:27], a[72:75]
    v_exp_f32 v16, v176
    v_mfma_f32_16x16x32_bf16 a[72:75], v[84:87], v[28:31], a[72:75]
    buffer_load_dwordx4 v4, s[4:7], s32 offen offset:0 sc1 lds
    v_mfma_f32_16x16x32_bf16 a[120:123], v[72:75], v[24:27], a[120:123]
    ds_read_b128 v[44:47], v1 offset:20480
    v_mfma_f32_16x16x32_bf16 a[120:123], v[88:91], v[28:31], a[120:123]
    v_exp_f32 v17, v177
    v_mfma_f32_16x16x32_bf16 a[168:171], v[76:79], v[24:27], a[168:171]
    v_exp_f32 v18, v178
    v_mfma_f32_16x16x32_bf16 a[168:171], v[92:95], v[28:31], a[168:171]
    s_waitcnt lgkmcnt(2)
    v_add_f32 v5, v5, v16
    v_add_f32 v5, v5, v17
    v_mfma_f32_16x16x32_bf16 a[28:31], v[64:67], v[32:35], a[28:31]
    ds_read_b128 v[24:27], v1 offset:9216
    v_mul_f32_e64 v51, -v51, v49
    v_mfma_f32_16x16x32_bf16 a[28:31], v[80:83], v[36:39], a[28:31]
    v_exp_f32 v19, v179
    v_mfma_f32_16x16x32_bf16 a[76:79], v[68:71], v[32:35], a[76:79]
    v_cvt_pk_bf16_f32 v176, v16, v17
    v_add_u32 v2, s3, v2
    v_mfma_f32_16x16x32_bf16 a[76:79], v[84:87], v[36:39], a[76:79]
    v_exp_f32 v16, v112
    v_mfma_f32_16x16x32_bf16 a[124:127], v[72:75], v[32:35], a[124:127]
    ds_read_b128 v[28:31], v1 offset:21504
    v_add_f32 v5, v5, v18
    v_mfma_f32_16x16x32_bf16 a[124:127], v[88:91], v[36:39], a[124:127]
    v_add_f32 v5, v5, v19
    v_cvt_f32_i32 v226, v226
    v_mfma_f32_16x16x32_bf16 a[172:175], v[76:79], v[32:35], a[172:175]
    v_exp_f32 v17, v113
    v_mfma_f32_16x16x32_bf16 a[172:175], v[92:95], v[36:39], a[172:175]
    s_waitcnt lgkmcnt(2)
    buffer_load_dwordx4 v4, s[4:7], s32 offen offset:1024 sc1 lds
    v_mfma_f32_16x16x32_bf16 a[32:35], v[64:67], v[40:43], a[32:35]
    ds_read_b128 v[32:35], v1 offset:10240
    v_cvt_pk_bf16_f32 v177, v18, v19
    v_mfma_f32_16x16x32_bf16 a[32:35], v[80:83], v[44:47], a[32:35]
    v_exp_f32 v18, v114
    v_mfma_f32_16x16x32_bf16 a[80:83], v[68:71], v[40:43], a[80:83]
    v_add_f32 v5, v5, v16
    v_add_f32 v5, v5, v17
    v_mfma_f32_16x16x32_bf16 a[80:83], v[84:87], v[44:47], a[80:83]
    v_exp_f32 v19, v115
    v_mfma_f32_16x16x32_bf16 a[128:131], v[72:75], v[40:43], a[128:131]
    ds_read_b128 v[36:39], v1 offset:22528
    v_cvt_pk_bf16_f32 v178, v16, v17
    v_mfma_f32_16x16x32_bf16 a[128:131], v[88:91], v[44:47], a[128:131]
    v_exp_f32 v16, v180
    v_mfma_f32_16x16x32_bf16 a[176:179], v[76:79], v[40:43], a[176:179]
    v_cvt_f32_i32 v227, v227
    v_add_u32 v3, s3, v3
    v_mfma_f32_16x16x32_bf16 a[176:179], v[92:95], v[44:47], a[176:179]
    s_waitcnt lgkmcnt(2)
    v_add_f32 v5, v5, v18
    v_add_f32 v5, v5, v19
    v_mfma_f32_16x16x32_bf16 a[36:39], v[64:67], v[24:27], a[36:39]
    ds_read_b128 v[40:43], v1 offset:11264
    v_fma_f32 v226, v226, v48, v50
    v_mfma_f32_16x16x32_bf16 a[36:39], v[80:83], v[28:31], a[36:39]
    buffer_load_dwordx4 v4, s[4:7], s32 offen offset:2048 sc1 lds
    v_mfma_f32_16x16x32_bf16 a[84:87], v[68:71], v[24:27], a[84:87]
    v_exp_f32 v17, v181
    v_mfma_f32_16x16x32_bf16 a[84:87], v[84:87], v[28:31], a[84:87]
    v_cvt_pk_bf16_f32 v179, v18, v19
    v_fma_f32 v227, v227, v49, v51
    v_mfma_f32_16x16x32_bf16 a[132:135], v[72:75], v[24:27], a[132:135]
    ds_read_b128 v[44:47], v1 offset:23552
    v_cvt_pk_bf16_f32 v225, v226, v227
    v_mfma_f32_16x16x32_bf16 a[132:135], v[88:91], v[28:31], a[132:135]
    s_waitcnt lgkmcnt(2)
    v_exp_f32 v18, v182
    v_mfma_f32_16x16x32_bf16 a[180:183], v[76:79], v[24:27], a[180:183]
    s_waitcnt vmcnt(13)
    v_add_f32 v6, v6, v16
    v_add_f32 v6, v6, v17
    v_mfma_f32_16x16x32_bf16 a[180:183], v[92:95], v[28:31], a[180:183]
    s_barrier
    v_cvt_f32_i32 v230, v230
    v_mfma_f32_16x16x32_bf16 a[40:43], v[64:67], v[32:35], a[40:43]
    ds_read_b128 v[24:27], v2 offset:0
    v_mfma_f32_16x16x32_bf16 a[40:43], v[80:83], v[36:39], a[40:43]
    v_exp_f32 v19, v183
    v_mfma_f32_16x16x32_bf16 a[88:91], v[68:71], v[32:35], a[88:91]
    v_cvt_pk_bf16_f32 v180, v16, v17
    v_cvt_f32_i32 v231, v231
    v_mfma_f32_16x16x32_bf16 a[88:91], v[84:87], v[36:39], a[88:91]
    v_exp_f32 v16, v116
    v_mfma_f32_16x16x32_bf16 a[136:139], v[72:75], v[32:35], a[136:139]
    ds_read_b128 v[28:31], v3 offset:0
    v_add_f32 v6, v6, v18
    v_mfma_f32_16x16x32_bf16 a[136:139], v[88:91], v[36:39], a[136:139]
    v_add_f32 v6, v6, v19
    v_fma_f32 v230, v230, v48, v50
    v_mfma_f32_16x16x32_bf16 a[184:187], v[76:79], v[32:35], a[184:187]
    v_exp_f32 v17, v117
    v_mfma_f32_16x16x32_bf16 a[184:187], v[92:95], v[36:39], a[184:187]
    s_waitcnt lgkmcnt(2)
    v_cvt_pk_bf16_f32 v181, v18, v19
    v_mfma_f32_16x16x32_bf16 a[44:47], v[64:67], v[40:43], a[44:47]
    ds_read_b128 v[32:35], v2 offset:6144
    v_mfma_f32_16x16x32_bf16 a[44:47], v[80:83], v[44:47], a[44:47]
    v_exp_f32 v18, v118
    v_mfma_f32_16x16x32_bf16 a[92:95], v[68:71], v[40:43], a[92:95]
    v_add_f32 v6, v6, v16
    v_add_f32 v6, v6, v17
    v_mfma_f32_16x16x32_bf16 a[92:95], v[84:87], v[44:47], a[92:95]
    s_add_u32 s32, s32, 24576
    v_exp_f32 v19, v119
    v_mfma_f32_16x16x32_bf16 a[140:143], v[72:75], v[40:43], a[140:143]
    s_add_u32 s26, s26, 36864
    ds_read_b128 v[36:39], v3 offset:6144
    v_cvt_pk_bf16_f32 v182, v16, v17
    v_mfma_f32_16x16x32_bf16 a[140:143], v[88:91], v[44:47], a[140:143]
    s_sub_u32 s57, s26, 147456
    v_add_f32 v6, v6, v18
    v_add_f32 v6, v6, v19
    v_mfma_f32_16x16x32_bf16 a[188:191], v[76:79], v[40:43], a[188:191]
    s_min_u32 s26, s26, s57
    v_cvt_pk_bf16_f32 v183, v18, v19
    v_mfma_f32_16x16x32_bf16 a[188:191], v[92:95], v[44:47], a[188:191]
    s_waitcnt lgkmcnt(2)
    v_mfma_f32_16x16x32_bf16 v[64:67], v[24:27], a[192:195], v[128:131]
    ds_read_b128 v[40:43], v2 offset:128
    v_fma_f32 v231, v231, v49, v51
    v_mfma_f32_16x16x32_bf16 v[64:67], v[28:31], a[196:199], v[64:67]
    v_exp_f32 v16, v184
    v_mfma_f32_16x16x32_bf16 v[68:71], v[24:27], a[216:219], v[132:135]
    v_exp_f32 v17, v185
    v_mfma_f32_16x16x32_bf16 v[68:71], v[28:31], a[220:223], v[68:71]
    v_bfe_u32 v53, v4, 4, 6
    v_cvt_pk_bf16_f32 v229, v230, v231
    v_mfma_f32_16x16x32_bf16 v[72:75], v[24:27], a[240:243], v[136:139]
    ds_read_b128 v[44:47], v3 offset:128
    v_lshlrev_b32 v53, 2, v53
    v_mfma_f32_16x16x32_bf16 v[72:75], v[28:31], a[244:247], v[72:75]
    buffer_load_dword v52, v53, s[20:23], s44 offen sc1
    v_mfma_f32_16x16x32_bf16 v[76:79], v[24:27], v[200:203], v[140:143]
    v_exp_f32 v18, v186
    v_mfma_f32_16x16x32_bf16 v[76:79], v[28:31], v[204:207], v[76:79]
    s_waitcnt lgkmcnt(2)
    v_add_f32 v7, v7, v16
    v_add_f32 v7, v7, v17
    v_mfma_f32_16x16x32_bf16 v[96:99], v[32:35], a[192:195], v[128:131]
    ds_read_b128 v[24:27], v2 offset:6272
    v_cvt_f32_i32 v234, v234
    v_mfma_f32_16x16x32_bf16 v[96:99], v[36:39], a[196:199], v[96:99]
    v_exp_f32 v19, v187
    v_mfma_f32_16x16x32_bf16 v[100:103], v[32:35], a[216:219], v[132:135]
    v_cvt_pk_bf16_f32 v184, v16, v17
    v_cvt_f32_i32 v235, v235
    v_mfma_f32_16x16x32_bf16 v[100:103], v[36:39], a[220:223], v[100:103]
    s_add_u32 s35, s35, 196608
    v_exp_f32 v16, v120
    v_mfma_f32_16x16x32_bf16 v[104:107], v[32:35], a[240:243], v[136:139]
    s_mov_b32 m0, s26
    ds_read_b128 v[28:31], v3 offset:6272
    v_add_f32 v7, v7, v18
    v_mfma_f32_16x16x32_bf16 v[104:107], v[36:39], a[244:247], v[104:107]
    s_add_u32 s16, s16, 196608
    buffer_load_dwordx4 v4, s[4:7], s32 offen offset:0 sc1 lds
    v_mfma_f32_16x16x32_bf16 v[108:111], v[32:35], v[200:203], v[140:143]
    s_add_u32 s17, s17, 196608
    v_add_f32 v7, v7, v19
    v_fma_f32 v234, v234, v48, v50
    v_mfma_f32_16x16x32_bf16 v[108:111], v[36:39], v[204:207], v[108:111]
    s_waitcnt lgkmcnt(2)
    v_exp_f32 v17, v121
    v_mfma_f32_16x16x32_bf16 v[64:67], v[40:43], a[200:203], v[64:67]
    s_add_u32 s37, s37, 512
    ds_read_b128 v[32:35], v2 offset:256
    v_cvt_pk_bf16_f32 v185, v18, v19
    v_mfma_f32_16x16x32_bf16 v[64:67], v[44:47], a[204:207], v[64:67]
    v_exp_f32 v18, v122
    v_mfma_f32_16x16x32_bf16 v[68:71], v[40:43], a[224:227], v[68:71]
    v_add_f32 v7, v7, v16
    v_add_f32 v7, v7, v17
    v_mfma_f32_16x16x32_bf16 v[68:71], v[44:47], a[228:231], v[68:71]
    v_exp_f32 v19, v123
    v_mfma_f32_16x16x32_bf16 v[72:75], v[40:43], a[248:251], v[72:75]
    ds_read_b128 v[36:39], v3 offset:256
    v_cvt_pk_bf16_f32 v186, v16, v17
    v_mfma_f32_16x16x32_bf16 v[72:75], v[44:47], a[252:255], v[72:75]
    buffer_load_dwordx4 v4, s[4:7], s32 offen offset:1024 sc1 lds
    v_mfma_f32_16x16x32_bf16 v[76:79], v[40:43], v[208:211], v[76:79]
    v_exp_f32 v16, v188
    v_mfma_f32_16x16x32_bf16 v[76:79], v[44:47], v[212:215], v[76:79]
    s_waitcnt lgkmcnt(2)
    v_add_f32 v7, v7, v18
    v_add_f32 v7, v7, v19
    v_mfma_f32_16x16x32_bf16 v[96:99], v[24:27], a[200:203], v[96:99]
    ds_read_b128 v[40:43], v2 offset:6400
    v_fma_f32 v235, v235, v49, v51
    v_mfma_f32_16x16x32_bf16 v[96:99], v[28:31], a[204:207], v[96:99]
    buffer_load_dwordx2 v[56:57], off, s[80:83], s37 offset:0
    v_mfma_f32_16x16x32_bf16 v[100:103], v[24:27], a[224:227], v[100:103]
    v_exp_f32 v17, v189
    v_mfma_f32_16x16x32_bf16 v[100:103], v[28:31], a[228:231], v[100:103]
    v_cvt_pk_bf16_f32 v187, v18, v19
    v_cvt_pk_bf16_f32 v233, v234, v235
    v_mfma_f32_16x16x32_bf16 v[104:107], v[24:27], a[248:251], v[104:107]
    ds_read_b128 v[44:47], v3 offset:6400
    v_cvt_f32_i32 v238, v238
    v_mfma_f32_16x16x32_bf16 v[104:107], v[28:31], a[252:255], v[104:107]
    buffer_load_dwordx2 v[58:59], off, s[84:87], s37 offset:0
    v_mfma_f32_16x16x32_bf16 v[108:111], v[24:27], v[208:211], v[108:111]
    s_add_u32 s29, s30, 49152
    v_exp_f32 v18, v190
    v_mfma_f32_16x16x32_bf16 v[108:111], v[28:31], v[212:215], v[108:111]
    s_waitcnt lgkmcnt(2)
    v_add_f32 v8, v8, v16
    v_add_f32 v8, v8, v17
    v_mfma_f32_16x16x32_bf16 v[64:67], v[32:35], a[208:211], v[64:67]
    s_sub_u32 s3, s29, 147456
    ds_read_b128 v[24:27], v2 offset:12288
    v_mfma_f32_16x16x32_bf16 v[64:67], v[36:39], a[212:215], v[64:67]
    s_min_u32 s29, s29, s3
    buffer_load_dwordx4 v4, s[4:7], s32 offen offset:2048 sc1 lds
    v_mfma_f32_16x16x32_bf16 v[68:71], v[32:35], a[232:235], v[68:71]
    v_exp_f32 v19, v191
    v_mfma_f32_16x16x32_bf16 v[68:71], v[36:39], a[236:239], v[68:71]
    v_cvt_pk_bf16_f32 v188, v16, v17
    v_cvt_f32_i32 v239, v239
    v_mfma_f32_16x16x32_bf16 v[72:75], v[32:35], v[192:195], v[72:75]
    ds_read_b128 v[28:31], v3 offset:12288
    v_mfma_f32_16x16x32_bf16 v[72:75], v[36:39], v[196:199], v[72:75]
    buffer_load_dwordx3 v[144:146], v12, s[68:71], s35 offen offset:0 nt
    v_mfma_f32_16x16x32_bf16 v[76:79], v[32:35], v[216:219], v[76:79]
    v_exp_f32 v16, v124
    v_mfma_f32_16x16x32_bf16 v[76:79], v[36:39], v[220:223], v[76:79]
    s_waitcnt lgkmcnt(2)
    v_add_f32 v8, v8, v18
    v_add_f32 v8, v8, v19
    v_mfma_f32_16x16x32_bf16 v[96:99], v[40:43], a[208:211], v[96:99]
    s_add_u32 s32, s32, 24576
    ds_read_b128 v[32:35], v2 offset:18432
    v_fma_f32 v238, v238, v48, v50
    v_mfma_f32_16x16x32_bf16 v[96:99], v[44:47], a[212:215], v[96:99]
    s_sub_u32 s3, s29, s30
    v_exp_f32 v17, v125
    v_mfma_f32_16x16x32_bf16 v[100:103], v[40:43], a[232:235], v[100:103]
    v_cvt_pk_bf16_f32 v189, v18, v19
    v_mfma_f32_16x16x32_bf16 v[100:103], v[44:47], a[236:239], v[100:103]
    v_exp_f32 v18, v126
    v_mfma_f32_16x16x32_bf16 v[104:107], v[40:43], v[192:195], v[104:107]
    s_add_u32 s26, s26, 12288
    ds_read_b128 v[36:39], v3 offset:18432
    v_add_f32 v8, v8, v16
    v_mfma_f32_16x16x32_bf16 v[104:107], v[44:47], v[196:199], v[104:107]
    buffer_load_dwordx3 v[148:150], v12, s[68:71], s35 offen offset:768 nt
    v_mfma_f32_16x16x32_bf16 v[108:111], v[40:43], v[216:219], v[108:111]
    v_add_f32 v8, v8, v17
    v_fma_f32 v239, v239, v49, v51
    v_mfma_f32_16x16x32_bf16 v[108:111], v[44:47], v[220:223], v[108:111]
    s_waitcnt lgkmcnt(2)
    v_exp_f32 v19, v127
    v_mfma_f32_16x16x32_bf16 v[80:83], v[24:27], a[192:195], v[128:131]
    ds_read_b128 v[40:43], v2 offset:12416
    v_cvt_pk_bf16_f32 v190, v16, v17
    v_mfma_f32_16x16x32_bf16 v[80:83], v[28:31], a[196:199], v[80:83]
    s_mov_b32 m0, s26
    v_add_f32 v8, v8, v18
    v_add_f32 v8, v8, v19
    v_mfma_f32_16x16x32_bf16 v[84:87], v[24:27], a[216:219], v[132:135]
    s_mov_b32 s30, s29
    v_cvt_pk_bf16_f32 v191, v18, v19
    v_cvt_pk_bf16_f32 v237, v238, v239
    v_mfma_f32_16x16x32_bf16 v[84:87], v[28:31], a[220:223], v[84:87]
    v_exp_f32 v16, v64
    v_mfma_f32_16x16x32_bf16 v[88:91], v[24:27], a[240:243], v[136:139]
    ds_read_b128 v[44:47], v3 offset:12416
    v_mfma_f32_16x16x32_bf16 v[88:91], v[28:31], a[244:247], v[88:91]
    buffer_load_dwordx3 v[152:154], v12, s[68:71], s35 offen offset:1536 nt
    v_mfma_f32_16x16x32_bf16 v[92:95], v[24:27], v[200:203], v[140:143]
    v_exp_f32 v17, v65
    v_mfma_f32_16x16x32_bf16 v[92:95], v[28:31], v[204:207], v[92:95]
    s_waitcnt lgkmcnt(2)
    v_exp_f32 v18, v66
    v_mfma_f32_16x16x32_bf16 v[112:115], v[32:35], a[192:195], v[128:131]
    ds_read_b128 v[24:27], v2 offset:18560
    v_add_f32 v5, v5, v16
    v_mfma_f32_16x16x32_bf16 v[112:115], v[36:39], a[196:199], v[112:115]
    buffer_load_dwordx4 v4, s[4:7], s32 offen offset:0 sc1 lds
    v_mfma_f32_16x16x32_bf16 v[116:119], v[32:35], a[216:219], v[132:135]
    v_add_f32 v5, v5, v17
    v_add_u32 v1, s3, v1
    v_mfma_f32_16x16x32_bf16 v[116:119], v[36:39], a[220:223], v[116:119]
    v_exp_f32 v19, v67
    v_mfma_f32_16x16x32_bf16 v[120:123], v[32:35], a[240:243], v[136:139]
    ds_read_b128 v[28:31], v3 offset:18560
    v_cvt_pk_bf16_f32 v64, v16, v17
    v_mfma_f32_16x16x32_bf16 v[120:123], v[36:39], a[244:247], v[120:123]
    s_waitcnt vmcnt(13)
    buffer_load_dwordx3 v[156:158], v12, s[68:71], s35 offen offset:2304 nt
    v_mfma_f32_16x16x32_bf16 v[124:127], v[32:35], v[200:203], v[140:143]
    v_exp_f32 v16, v96
    v_mfma_f32_16x16x32_bf16 v[124:127], v[36:39], v[204:207], v[124:127]
    s_waitcnt lgkmcnt(2)
    v_add_f32 v5, v5, v18
    v_add_f32 v5, v5, v19
    v_mfma_f32_16x16x32_bf16 v[80:83], v[40:43], a[200:203], v[80:83]
    ds_read_b128 v[32:35], v2 offset:12544
    v_lshlrev_b32 v48, 16, v60
    v_mfma_f32_16x16x32_bf16 v[80:83], v[44:47], a[204:207], v[80:83]
    v_exp_f32 v17, v97
    v_mfma_f32_16x16x32_bf16 v[84:87], v[40:43], a[224:227], v[84:87]
    v_cvt_pk_bf16_f32 v65, v18, v19
    v_and_b32 v49, s97, v60
    v_mfma_f32_16x16x32_bf16 v[84:87], v[44:47], a[228:231], v[84:87]
    buffer_load_dwordx4 v4, s[4:7], s32 offen offset:1024 sc1 lds
    v_mfma_f32_16x16x32_bf16 v[88:91], v[40:43], a[248:251], v[88:91]
    ds_read_b128 v[36:39], v3 offset:12544
    v_mfma_f32_16x16x32_bf16 v[88:91], v[44:47], a[252:255], v[88:91]
    v_exp_f32 v18, v98
    v_mfma_f32_16x16x32_bf16 v[92:95], v[40:43], v[208:211], v[92:95]
    v_add_f32 v5, v5, v16
    v_add_f32 v5, v5, v17
    v_mfma_f32_16x16x32_bf16 v[92:95], v[44:47], v[212:215], v[92:95]
    s_waitcnt lgkmcnt(2)
    v_exp_f32 v19, v99
    v_mfma_f32_16x16x32_bf16 v[112:115], v[24:27], a[200:203], v[112:115]
    ds_read_b128 v[40:43], v2 offset:18688
    v_cvt_pk_bf16_f32 v66, v16, v17
    v_mfma_f32_16x16x32_bf16 v[112:115], v[28:31], a[204:207], v[112:115]
    v_exp_f32 v16, v68
    v_mfma_f32_16x16x32_bf16 v[116:119], v[24:27], a[224:227], v[116:119]
    v_add_f32 v5, v5, v18
    v_add_f32 v5, v5, v19
    v_mfma_f32_16x16x32_bf16 v[116:119], v[28:31], a[228:231], v[116:119]
    v_exp_f32 v17, v69
    v_mfma_f32_16x16x32_bf16 v[120:123], v[24:27], a[248:251], v[120:123]
    ds_read_b128 v[44:47], v3 offset:18688
    v_cvt_pk_bf16_f32 v67, v18, v19
    v_mfma_f32_16x16x32_bf16 v[120:123], v[28:31], a[252:255], v[120:123]
    s_waitcnt lgkmcnt(2)
    buffer_load_dwordx4 v4, s[4:7], s32 offen offset:2048 sc1 lds
    v_mfma_f32_16x16x32_bf16 v[124:127], v[24:27], v[208:211], v[124:127]
    s_waitcnt vmcnt(13)
    v_exp_f32 v18, v70
    v_mfma_f32_16x16x32_bf16 v[124:127], v[28:31], v[212:215], v[124:127]
    s_barrier
    v_add_f32 v6, v6, v16
    v_mfma_f32_16x16x32_bf16 v[80:83], v[32:35], a[208:211], v[80:83]
    ds_read_b128 v[24:27], v1 offset:0
    v_add_f32 v6, v6, v17
    v_mfma_f32_16x16x32_bf16 v[80:83], v[36:39], a[212:215], v[80:83]
    v_exp_f32 v19, v71
    v_mfma_f32_16x16x32_bf16 v[84:87], v[32:35], a[232:235], v[84:87]
    v_cvt_pk_bf16_f32 v68, v16, v17
    v_lshlrev_b32 v50, 16, v62
    v_mfma_f32_16x16x32_bf16 v[84:87], v[36:39], a[236:239], v[84:87]
    v_exp_f32 v16, v100
    v_mfma_f32_16x16x32_bf16 v[88:91], v[32:35], v[192:195], v[88:91]
    ds_read_b128 v[28:31], v1 offset:12288
    v_add_f32 v6, v6, v18
    v_mfma_f32_16x16x32_bf16 v[88:91], v[36:39], v[196:199], v[88:91]
    v_add_f32 v6, v6, v19
    v_and_b32 v51, s97, v62
    v_mfma_f32_16x16x32_bf16 v[92:95], v[32:35], v[216:219], v[92:95]
    v_exp_f32 v17, v101
    v_mfma_f32_16x16x32_bf16 v[92:95], v[36:39], v[220:223], v[92:95]
    s_waitcnt lgkmcnt(2)
    v_cvt_pk_bf16_f32 v69, v18, v19
    v_mfma_f32_16x16x32_bf16 v[112:115], v[40:43], a[208:211], v[112:115]
    ds_read_b128 v[32:35], v1 offset:1024
    v_mfma_f32_16x16x32_bf16 v[112:115], v[44:47], a[212:215], v[112:115]
    v_exp_f32 v18, v102
    v_mfma_f32_16x16x32_bf16 v[116:119], v[40:43], a[232:235], v[116:119]
    v_add_f32 v6, v6, v16
    v_add_f32 v6, v6, v17
    v_mfma_f32_16x16x32_bf16 v[116:119], v[44:47], a[236:239], v[116:119]
    v_exp_f32 v19, v103
    v_mfma_f32_16x16x32_bf16 v[120:123], v[40:43], v[192:195], v[120:123]
    ds_read_b128 v[36:39], v1 offset:13312
    v_cvt_pk_bf16_f32 v70, v16, v17
    v_mfma_f32_16x16x32_bf16 v[120:123], v[44:47], v[196:199], v[120:123]
    s_add_u32 s32, s32, 24576
    v_add_f32 v6, v6, v18
    s_add_u32 s26, s26, 36864
    v_mfma_f32_16x16x32_bf16 v[124:127], v[40:43], v[216:219], v[124:127]
    s_sub_u32 s57, s26, 147456
    v_add_f32 v6, v6, v19
    v_cvt_pk_bf16_f32 v71, v18, v19
    v_mfma_f32_16x16x32_bf16 v[124:127], v[44:47], v[220:223], v[124:127]
    s_waitcnt lgkmcnt(2)
    s_min_u32 s26, s26, s57
    v_mfma_f32_16x16x32_bf16 a[0:3], v[160:163], v[24:27], a[0:3]
    ds_read_b128 v[40:43], v1 offset:2048
    v_mul_f32 v48, s38, v48
    v_mfma_f32_16x16x32_bf16 a[0:3], v[176:179], v[28:31], a[0:3]
    s_waitcnt vmcnt(12)
    v_subrev_u32 v52, s92, v52
    v_cmp_lt_u32 vcc, 15, v52
    v_mfma_f32_16x16x32_bf16 a[48:51], v[164:167], v[24:27], a[48:51]
    v_exp_f32 v16, v72
    v_mfma_f32_16x16x32_bf16 a[48:51], v[180:183], v[28:31], a[48:51]
    v_exp_f32 v17, v73
    v_mfma_f32_16x16x32_bf16 a[96:99], v[168:171], v[24:27], a[96:99]
    s_and_b32 s59, vcc_lo, 0xff
    ds_read_b128 v[44:47], v1 offset:14336
    v_mul_f32 v49, s38, v49
    v_mfma_f32_16x16x32_bf16 a[96:99], v[184:187], v[28:31], a[96:99]
    s_cbranch_scc1 L_pollslow2
L_pollok2:
    v_mfma_f32_16x16x32_bf16 a[144:147], v[172:175], v[24:27], a[144:147]
    s_add_u32 s92, s92, 1
    v_exp_f32 v18, v74
    v_mfma_f32_16x16x32_bf16 a[144:147], v[188:191], v[28:31], a[144:147]
    s_waitcnt lgkmcnt(2)
    v_add_f32 v7, v7, v16
    v_add_f32 v7, v7, v17
    v_mfma_f32_16x16x32_bf16 a[4:7], v[160:163], v[32:35], a[4:7]
    s_mov_b32 m0, s56
    ds_read_b128 v[24:27], v1 offset:3072
    v_mul_f32_e64 v50, -v50, v48
    v_mfma_f32_16x16x32_bf16 a[4:7], v[176:179], v[36:39], a[4:7]
    buffer_load_dwordx4 v4, s[4:7], s27 offen offset:0 sc1 lds
    v_mfma_f32_16x16x32_bf16 a[52:55], v[164:167], v[32:35], a[52:55]
    v_exp_f32 v19, v75
    v_mfma_f32_16x16x32_bf16 a[52:55], v[180:183], v[36:39], a[52:55]
    v_cvt_pk_bf16_f32 v72, v16, v17
    v_mul_f32_e64 v51, -v51, v49
    v_mfma_f32_16x16x32_bf16 a[100:103], v[168:171], v[32:35], a[100:103]
    ds_read_b128 v[28:31], v1 offset:15360
    v_cvt_f32_i32 v240, v240
    v_mfma_f32_16x16x32_bf16 a[100:103], v[184:187], v[36:39], a[100:103]
    v_exp_f32 v16, v104
    v_mfma_f32_16x16x32_bf16 a[148:151], v[172:175], v[32:35], a[148:151]
    v_add_f32 v7, v7, v18
    v_add_f32 v7, v7, v19
    v_mfma_f32_16x16x32_bf16 a[148:151], v[188:191], v[36:39], a[148:151]
    s_waitcnt lgkmcnt(2)
    v_exp_f32 v17, v105
    v_mfma_f32_16x16x32_bf16 a[8:11], v[160:163], v[40:43], a[8:11]
    ds_read_b128 v[32:35], v1 offset:4096
    v_cvt_pk_bf16_f32 v73, v18, v19
    v_mfma_f32_16x16x32_bf16 a[8:11], v[176:179], v[44:47], a[8:11]
    buffer_load_dwordx4 v4, s[4:7], s27 offen offset:1024 sc1 lds
    v_mfma_f32_16x16x32_bf16 a[56:59], v[164:167], v[40:43], a[56:59]
    v_exp_f32 v18, v106
    v_mfma_f32_16x16x32_bf16 a[56:59], v[180:183], v[44:47], a[56:59]
    v_add_f32 v7, v7, v16
    v_cvt_f32_i32 v241, v241
    v_mfma_f32_16x16x32_bf16 a[104:107], v[168:171], v[40:43], a[104:107]
    ds_read_b128 v[36:39], v1 offset:16384
    v_add_f32 v7, v7, v17
    v_mfma_f32_16x16x32_bf16 a[104:107], v[184:187], v[44:47], a[104:107]
    v_exp_f32 v19, v107
    v_mfma_f32_16x16x32_bf16 a[152:155], v[172:175], v[40:43], a[152:155]
    v_cvt_pk_bf16_f32 v74, v16, v17
    v_fma_f32 v240, v240, v48, v50
    v_mfma_f32_16x16x32_bf16 a[152:155], v[188:191], v[44:47], a[152:155]
    s_waitcnt lgkmcnt(2)
    v_exp_f32 v16, v76
    v_mfma_f32_16x16x32_bf16 a[12:15], v[160:163], v[24:27], a[12:15]
    ds_read_b128 v[40:43], v1 offset:5120
    v_add_f32 v7, v7, v18
    v_mfma_f32_16x16x32_bf16 a[12:15], v[176:179], v[28:31], a[12:15]
    buffer_load_dwordx4 v4, s[4:7], s27 offen offset:2048 sc1 lds
    v_mfma_f32_16x16x32_bf16 a[60:63], v[164:167], v[24:27], a[60:63]
    v_add_f32 v7, v7, v19
    v_fma_f32 v241, v241, v49, v51
    v_mfma_f32_16x16x32_bf16 a[60:63], v[180:183], v[28:31], a[60:63]
    v_exp_f32 v17, v77
    v_mfma_f32_16x16x32_bf16 a[108:111], v[168:171], v[24:27], a[108:111]
    ds_read_b128 v[44:47], v1 offset:17408
    v_cvt_pk_bf16_f32 v75, v18, v19
    v_mfma_f32_16x16x32_bf16 a[108:111], v[184:187], v[28:31], a[108:111]
    v_exp_f32 v18, v78
    v_mfma_f32_16x16x32_bf16 a[156:159], v[172:175], v[24:27], a[156:159]
    s_add_u32 s29, s28, 49152
    v_cvt_pk_bf16_f32 v226, v240, v241
    v_cvt_f32_i32 v244, v244
    v_mfma_f32_16x16x32_bf16 a[156:159], v[188:191], v[28:31], a[156:159]
    s_waitcnt lgkmcnt(2)
    v_add_f32 v8, v8, v16
    v_add_f32 v8, v8, v17
    v_mfma_f32_16x16x32_bf16 a[16:19], v[160:163], v[32:35], a[16:19]
    s_sub_u32 s3, s29, 147456
    ds_read_b128 v[24:27], v1 offset:6144
    v_cvt_f32_i32 v245, v245
    v_mfma_f32_16x16x32_bf16 a[16:19], v[176:179], v[36:39], a[16:19]
    s_add_u32 s27, s27, 24576
    v_exp_f32 v19, v79
    v_mfma_f32_16x16x32_bf16 a[64:67], v[164:167], v[32:35], a[64:67]
    s_min_u32 s29, s29, s3
    v_cvt_pk_bf16_f32 v76, v16, v17
    v_fma_f32 v244, v244, v48, v50
    v_mfma_f32_16x16x32_bf16 a[64:67], v[180:183], v[36:39], a[64:67]
    s_add_u32 s56, s56, 12288
    v_exp_f32 v16, v108
    v_mfma_f32_16x16x32_bf16 a[112:115], v[168:171], v[32:35], a[112:115]
    ds_read_b128 v[28:31], v1 offset:18432
    v_add_f32 v8, v8, v18
    v_mfma_f32_16x16x32_bf16 a[112:115], v[184:187], v[36:39], a[112:115]
    v_add_f32 v8, v8, v19
    v_fma_f32 v245, v245, v49, v51
    v_mfma_f32_16x16x32_bf16 a[160:163], v[172:175], v[32:35], a[160:163]
    v_exp_f32 v17, v109
    v_mfma_f32_16x16x32_bf16 a[160:163], v[188:191], v[36:39], a[160:163]
    s_waitcnt lgkmcnt(2)
    v_cvt_pk_bf16_f32 v230, v244, v245
    v_cvt_pk_bf16_f32 v77, v18, v19
    v_mfma_f32_16x16x32_bf16 a[20:23], v[160:163], v[40:43], a[20:23]
    s_mov_b32 m0, s56
    ds_read_b128 v[32:35], v1 offset:7168
    v_cvt_f32_i32 v248, v248
    v_mfma_f32_16x16x32_bf16 a[20:23], v[176:179], v[44:47], a[20:23]
L_pg7:
    s_cbranch_execz L_pg11
    s_sub_u32 s3, s29, s28
    v_exp_f32 v18, v110
    v_mfma_f32_16x16x32_bf16 a[68:71], v[164:167], v[40:43], a[68:71]
    v_add_f32 v8, v8, v16
    v_add_f32 v8, v8, v17
    v_mfma_f32_16x16x32_bf16 a[68:71], v[180:183], v[44:47], a[68:71]
    v_exp_f32 v19, v111
    v_mfma_f32_16x16x32_bf16 a[116:119], v[168:171], v[40:43], a[116:119]
    ds_read_b128 v[36:39], v1 offset:19456
    v_cvt_f32_i32 v249, v249
    v_mfma_f32_16x16x32_bf16 a[116:119], v[184:187], v[44:47], a[116:119]
    buffer_load_dwordx4 v4, s[4:7], s27 offen offset:0 sc1 lds
    v_mfma_f32_16x16x32_bf16 a[164:167], v[172:175], v[40:43], a[164:167]
    s_mov_b32 s28, s29
    v_cvt_pk_bf16_f32 v78, v16, v17
    v_add_f32 v8, v8, v18
    v_mfma_f32_16x16x32_bf16 a[164:167], v[188:191], v[44:47], a[164:167]
    s_waitcnt lgkmcnt(2)
    v_add_f32 v8, v8, v19
    v_fma_f32 v248, v248, v48, v50
    v_mfma_f32_16x16x32_bf16 a[24:27], v[160:163], v[24:27], a[24:27]
    ds_read_b128 v[40:43], v1 offset:8192
    v_cvt_pk_bf16_f32 v79, v18, v19
    v_mfma_f32_16x16x32_bf16 a[24:27], v[176:179], v[28:31], a[24:27]
    v_exp_f32 v16, v80
    v_mfma_f32_16x16x32_bf16 a[72:75], v[164:167], v[24:27], a[72:75]
    v_fma_f32 v249, v249, v49, v51
    v_cvt_pk_bf16_f32 v234, v248, v249
    v_mfma_f32_16x16x32_bf16 a[72:75], v[180:183], v[28:31], a[72:75]
    v_exp_f32 v17, v81
    v_mfma_f32_16x16x32_bf16 a[120:123], v[168:171], v[24:27], a[120:123]
    ds_read_b128 v[44:47], v1 offset:20480
    v_cvt_f32_i32 v252, v252
    v_mfma_f32_16x16x32_bf16 a[120:123], v[184:187], v[28:31], a[120:123]
    v_exp_f32 v18, v82
    v_mfma_f32_16x16x32_bf16 a[168:171], v[172:175], v[24:27], a[168:171]
    v_add_f32 v5, v5, v16
    v_add_f32 v5, v5, v17
    v_mfma_f32_16x16x32_bf16 a[168:171], v[188:191], v[28:31], a[168:171]
    s_waitcnt lgkmcnt(2)
    buffer_load_dwordx4 v4, s[4:7], s27 offen offset:1024 sc1 lds
    v_mfma_f32_16x16x32_bf16 a[28:31], v[160:163], v[32:35], a[28:31]
    ds_read_b128 v[24:27], v1 offset:9216
    v_cvt_f32_i32 v253, v253
    v_mfma_f32_16x16x32_bf16 a[28:31], v[176:179], v[36:39], a[28:31]
    v_exp_f32 v19, v83
    v_mfma_f32_16x16x32_bf16 a[76:79], v[164:167], v[32:35], a[76:79]
    v_cvt_pk_bf16_f32 v80, v16, v17
    v_fma_f32 v252, v252, v48, v50
    v_mfma_f32_16x16x32_bf16 a[76:79], v[180:183], v[36:39], a[76:79]
    v_exp_f32 v16, v112
    v_mfma_f32_16x16x32_bf16 a[124:127], v[168:171], v[32:35], a[124:127]
    ds_read_b128 v[28:31], v1 offset:21504
    v_add_f32 v5, v5, v18
    v_mfma_f32_16x16x32_bf16 a[124:127], v[184:187], v[36:39], a[124:127]
    v_add_f32 v5, v5, v19
    v_fma_f32 v253, v253, v49, v51
    v_mfma_f32_16x16x32_bf16 a[172:175], v[172:175], v[32:35], a[172:175]
    v_exp_f32 v17, v113
    v_mfma_f32_16x16x32_bf16 a[172:175], v[188:191], v[36:39], a[172:175]
    s_waitcnt lgkmcnt(2)
    buffer_load_dwordx4 v4, s[4:7], s27 offen offset:2048 sc1 lds
    v_mfma_f32_16x16x32_bf16 a[32:35], v[160:163], v[40:43], a[32:35]
    ds_read_b128 v[32:35], v1 offset:10240
    v_cvt_pk_bf16_f32 v81, v18, v19
    v_mfma_f32_16x16x32_bf16 a[32:35], v[176:179], v[44:47], a[32:35]
    v_exp_f32 v18, v114
    v_mfma_f32_16x16x32_bf16 a[80:83], v[164:167], v[40:43], a[80:83]
    v_add_f32 v5, v5, v16
    v_cvt_pk_bf16_f32 v238, v252, v253
    v_mfma_f32_16x16x32_bf16 a[80:83], v[180:183], v[44:47], a[80:83]
    v_add_f32 v5, v5, v17
    v_lshlrev_b32 v48, 16, v61
    v_mfma_f32_16x16x32_bf16 a[128:131], v[168:171], v[40:43], a[128:131]
    ds_read_b128 v[36:39], v1 offset:22528
    v_add_u32 v2, s3, v2
    v_mfma_f32_16x16x32_bf16 a[128:131], v[184:187], v[44:47], a[128:131]
    v_exp_f32 v19, v115
    v_mfma_f32_16x16x32_bf16 a[176:179], v[172:175], v[40:43], a[176:179]
    v_cvt_pk_bf16_f32 v82, v16, v17
    v_and_b32 v49, s97, v61
    v_mfma_f32_16x16x32_bf16 a[176:179], v[188:191], v[44:47], a[176:179]
    s_waitcnt lgkmcnt(2)
    v_exp_f32 v16, v84
    v_mfma_f32_16x16x32_bf16 a[36:39], v[160:163], v[24:27], a[36:39]
    ds_read_b128 v[40:43], v1 offset:11264
    v_add_f32 v5, v5, v18
    v_mfma_f32_16x16x32_bf16 a[36:39], v[176:179], v[28:31], a[36:39]
    v_add_f32 v5, v5, v19
    v_lshlrev_b32 v50, 16, v63
    v_mfma_f32_16x16x32_bf16 a[84:87], v[164:167], v[24:27], a[84:87]
    v_exp_f32 v17, v85
    v_mfma_f32_16x16x32_bf16 a[84:87], v[180:183], v[28:31], a[84:87]
    s_add_u32 s27, s27, 24576
    v_add_u32 v3, s3, v3
    v_cvt_pk_bf16_f32 v83, v18, v19
    v_mfma_f32_16x16x32_bf16 a[132:135], v[168:171], v[24:27], a[132:135]
    s_add_u32 s56, s56, 36864
    ds_read_b128 v[44:47], v1 offset:23552
    v_and_b32 v51, s97, v63
    v_mfma_f32_16x16x32_bf16 a[132:135], v[184:187], v[28:31], a[132:135]
    s_sub_u32 s58, s56, 147456
    v_exp_f32 v18, v86
    v_mfma_f32_16x16x32_bf16 a[180:183], v[172:175], v[24:27], a[180:183]
    v_add_f32 v6, v6, v16
    v_add_f32 v6, v6, v17
    v_mfma_f32_16x16x32_bf16 a[180:183], v[188:191], v[28:31], a[180:183]
    s_waitcnt lgkmcnt(2)
    v_mul_f32 v48, s38, v48
    v_mul_f32 v49, s38, v49
    v_mfma_f32_16x16x32_bf16 a[40:43], v[160:163], v[32:35], a[40:43]
    s_min_u32 s56, s56, s58
    ds_read_b128 v[24:27], v2 offset:0
    v_mul_f32_e64 v50, -v50, v48
    v_mfma_f32_16x16x32_bf16 a[40:43], v[176:179], v[36:39], a[40:43]
    v_exp_f32 v19, v87
    v_mfma_f32_16x16x32_bf16 a[88:91], v[164:167], v[32:35], a[88:91]
    v_cvt_pk_bf16_f32 v84, v16, v17
    v_mul_f32_e64 v51, -v51, v49
    v_mfma_f32_16x16x32_bf16 a[88:91], v[180:183], v[36:39], a[88:91]
    v_exp_f32 v16, v116
    v_mfma_f32_16x16x32_bf16 a[136:139], v[168:171], v[32:35], a[136:139]
    ds_read_b128 v[28:31], v3 offset:0
    v_add_f32 v6, v6, v18
    v_mfma_f32_16x16x32_bf16 a[136:139], v[184:187], v[36:39], a[136:139]
    v_add_f32 v6, v6, v19
    v_cvt_f32_i32 v242, v242
    v_mfma_f32_16x16x32_bf16 a[184:187], v[172:175], v[32:35], a[184:187]
    v_exp_f32 v17, v117
    v_mfma_f32_16x16x32_bf16 a[184:187], v[188:191], v[36:39], a[184:187]
    s_waitcnt lgkmcnt(2)
    v_cvt_pk_bf16_f32 v85, v18, v19
    v_cvt_f32_i32 v243, v243
    v_mfma_f32_16x16x32_bf16 a[44:47], v[160:163], v[40:43], a[44:47]
    ds_read_b128 v[32:35], v2 offset:6144
    v_fma_f32 v242, v242, v48, v50
    v_mfma_f32_16x16x32_bf16 a[44:47], v[176:179], v[44:47], a[44:47]
    v_exp_f32 v18, v118
    v_mfma_f32_16x16x32_bf16 a[92:95], v[164:167], v[40:43], a[92:95]
    v_add_f32 v6, v6, v16
    v_add_f32 v6, v6, v17
    v_mfma_f32_16x16x32_bf16 a[92:95], v[180:183], v[44:47], a[92:95]
    v_exp_f32 v19, v119
    v_mfma_f32_16x16x32_bf16 a[140:143], v[168:171], v[40:43], a[140:143]
    s_sub_u32 s31, s31, 1
    ds_read_b128 v[36:39], v3 offset:6144
    v_cvt_pk_bf16_f32 v86, v16, v17
    v_mfma_f32_16x16x32_bf16 a[140:143], v[184:187], v[44:47], a[140:143]
    v_add_f32 v6, v6, v18
    v_add_f32 v6, v6, v19
    v_mfma_f32_16x16x32_bf16 a[188:191], v[172:175], v[40:43], a[188:191]
    s_waitcnt lgkmcnt(2)
    s_cmp_lg_u32 s31, 0
    v_cvt_pk_bf16_f32 v87, v18, v19
    v_fma_f32 v243, v243, v49, v51
    v_mfma_f32_16x16x32_bf16 a[188:191], v[188:191], v[44:47], a[188:191]
    s_cbranch_scc1 L_loop
    v_mfma_f32_16x16x32_bf16 v[160:163], v[24:27], a[192:195], v[128:131]
    s_mov_b32 m0, s56
    ds_read_b128 v[40:43], v2 offset:128
    v_cvt_pk_bf16_f32 v227, v242, v243
    v_mfma_f32_16x16x32_bf16 v[160:163], v[28:31], a[196:199], v[160:163]
    buffer_load_dwordx4 v4, s[4:7], s27 offen offset:0 sc1 lds
    v_mfma_f32_16x16x32_bf16 v[164:167], v[24:27], a[216:219], v[132:135]
    v_exp_f32 v16, v88
    v_mfma_f32_16x16x32_bf16 v[164:167], v[28:31], a[220:223], v[164:167]
    v_exp_f32 v17, v89
    v_mfma_f32_16x16x32_bf16 v[168:171], v[24:27], a[240:243], v[136:139]
    ds_read_b128 v[44:47], v3 offset:128
    v_cvt_f32_i32 v246, v246
    v_mfma_f32_16x16x32_bf16 v[168:171], v[28:31], a[244:247], v[168:171]
    v_exp_f32 v18, v90
    v_mfma_f32_16x16x32_bf16 v[172:175], v[24:27], v[200:203], v[140:143]
    v_cvt_f32_i32 v247, v247
    v_add_f32 v7, v7, v16
    v_mfma_f32_16x16x32_bf16 v[172:175], v[28:31], v[204:207], v[172:175]
    s_waitcnt lgkmcnt(2)
    v_add_f32 v7, v7, v17
    v_fma_f32 v246, v246, v48, v50
    v_mfma_f32_16x16x32_bf16 v[96:99], v[32:35], a[192:195], v[128:131]
    ds_read_b128 v[24:27], v2 offset:6272
    v_fma_f32 v247, v247, v49, v51
    v_mfma_f32_16x16x32_bf16 v[96:99], v[36:39], a[196:199], v[96:99]
    buffer_load_dwordx4 v4, s[4:7], s27 offen offset:1024 sc1 lds
    v_mfma_f32_16x16x32_bf16 v[100:103], v[32:35], a[216:219], v[132:135]
    v_exp_f32 v19, v91
    v_mfma_f32_16x16x32_bf16 v[100:103], v[36:39], a[220:223], v[100:103]
    v_cvt_pk_bf16_f32 v88, v16, v17
    v_cvt_pk_bf16_f32 v231, v246, v247
    v_mfma_f32_16x16x32_bf16 v[104:107], v[32:35], a[240:243], v[136:139]
    ds_read_b128 v[28:31], v3 offset:6272
    v_cvt_f32_i32 v250, v250
    v_mfma_f32_16x16x32_bf16 v[104:107], v[36:39], a[244:247], v[104:107]
    v_exp_f32 v16, v120
    v_mfma_f32_16x16x32_bf16 v[108:111], v[32:35], v[200:203], v[140:143]
    v_add_f32 v7, v7, v18
    v_add_f32 v7, v7, v19
    v_mfma_f32_16x16x32_bf16 v[108:111], v[36:39], v[204:207], v[108:111]
    s_waitcnt lgkmcnt(2)
    v_exp_f32 v17, v121
    v_mfma_f32_16x16x32_bf16 v[160:163], v[40:43], a[200:203], v[160:163]
    ds_read_b128 v[32:35], v2 offset:256
    v_cvt_f32_i32 v251, v251
    v_mfma_f32_16x16x32_bf16 v[160:163], v[44:47], a[204:207], v[160:163]
    v_cvt_pk_bf16_f32 v89, v18, v19
    v_fma_f32 v250, v250, v48, v50
    v_mfma_f32_16x16x32_bf16 v[164:167], v[40:43], a[224:227], v[164:167]
    v_exp_f32 v18, v122
    v_mfma_f32_16x16x32_bf16 v[164:167], v[44:47], a[228:231], v[164:167]
    buffer_load_dwordx4 v4, s[4:7], s27 offen offset:2048 sc1 lds
    v_mfma_f32_16x16x32_bf16 v[168:171], v[40:43], a[248:251], v[168:171]
    ds_read_b128 v[36:39], v3 offset:256
    v_fma_f32 v251, v251, v49, v51
    v_mfma_f32_16x16x32_bf16 v[168:171], v[44:47], a[252:255], v[168:171]
    v_add_f32 v7, v7, v16
    v_add_f32 v7, v7, v17
    v_mfma_f32_16x16x32_bf16 v[172:175], v[40:43], v[208:211], v[172:175]
    v_cvt_pk_bf16_f32 v235, v250, v251
    v_cvt_f32_i32 v254, v254
    v_mfma_f32_16x16x32_bf16 v[172:175], v[44:47], v[212:215], v[172:175]
    s_waitcnt lgkmcnt(2)
    v_exp_f32 v19, v123
    v_mfma_f32_16x16x32_bf16 v[96:99], v[24:27], a[200:203], v[96:99]
    ds_read_b128 v[40:43], v2 offset:6400
    v_cvt_pk_bf16_f32 v90, v16, v17
    v_mfma_f32_16x16x32_bf16 v[96:99], v[28:31], a[204:207], v[96:99]
    s_add_u32 s27, s27, 24576
    v_exp_f32 v16, v92
    v_mfma_f32_16x16x32_bf16 v[100:103], v[24:27], a[224:227], v[100:103]
    v_cvt_f32_i32 v255, v255
    v_add_f32 v7, v7, v18
    v_mfma_f32_16x16x32_bf16 v[100:103], v[28:31], a[228:231], v[100:103]
    v_fma_f32 v254, v254, v48, v50
    v_add_f32 v7, v7, v19
    v_mfma_f32_16x16x32_bf16 v[104:107], v[24:27], a[248:251], v[104:107]
    ds_read_b128 v[44:47], v3 offset:6400
    v_fma_f32 v255, v255, v49, v51
    v_mfma_f32_16x16x32_bf16 v[104:107], v[28:31], a[252:255], v[104:107]
    v_exp_f32 v17, v93
    v_mfma_f32_16x16x32_bf16 v[108:111], v[24:27], v[208:211], v[108:111]
    s_add_u32 s29, s30, 49152
    v_cvt_pk_bf16_f32 v239, v254, v255
    v_cvt_pk_bf16_f32 v91, v18, v19
    v_mfma_f32_16x16x32_bf16 v[108:111], v[28:31], v[212:215], v[108:111]
    s_waitcnt lgkmcnt(2)
    v_exp_f32 v18, v94
    v_mfma_f32_16x16x32_bf16 v[160:163], v[32:35], a[208:211], v[160:163]
    s_waitcnt vmcnt(11)
    ds_read_b128 v[24:27], v2 offset:12288
    v_add_f32 v8, v8, v16
    v_mfma_f32_16x16x32_bf16 v[160:163], v[36:39], a[212:215], v[160:163]
    s_sub_u32 s3, s29, 147456
    buffer_load_dwordx2 v[60:61], off, s[80:83], s37 offset:8
    v_mfma_f32_16x16x32_bf16 v[164:167], v[32:35], a[232:235], v[164:167]
    s_add_u32 s56, s56, 12288
    v_add_f32 v8, v8, v17
    v_lshlrev_b32 v48, 16, v56
    v_mfma_f32_16x16x32_bf16 v[164:167], v[36:39], a[236:239], v[164:167]
    s_min_u32 s29, s29, s3
    v_exp_f32 v19, v95
    v_mfma_f32_16x16x32_bf16 v[168:171], v[32:35], v[192:195], v[168:171]
    s_mov_b32 m0, s56
    ds_read_b128 v[28:31], v3 offset:12288
    v_cvt_pk_bf16_f32 v92, v16, v17
    v_mfma_f32_16x16x32_bf16 v[168:171], v[36:39], v[196:199], v[168:171]
    buffer_load_dwordx2 v[62:63], off, s[84:87], s37 offset:8
    v_mfma_f32_16x16x32_bf16 v[172:175], v[32:35], v[216:219], v[172:175]
    v_exp_f32 v16, v124
    v_mfma_f32_16x16x32_bf16 v[172:175], v[36:39], v[220:223], v[172:175]
    s_waitcnt lgkmcnt(2)
    v_add_f32 v8, v8, v18
    v_add_f32 v8, v8, v19
    v_mfma_f32_16x16x32_bf16 v[96:99], v[40:43], a[208:211], v[96:99]
    ds_read_b128 v[32:35], v2 offset:18432
    v_and_b32 v49, s97, v56
    v_mfma_f32_16x16x32_bf16 v[96:99], v[44:47], a[212:215], v[96:99]
    s_sub_u32 s3, s29, s30
    v_exp_f32 v17, v125
    v_mfma_f32_16x16x32_bf16 v[100:103], v[40:43], a[232:235], v[100:103]
    v_cvt_pk_bf16_f32 v93, v18, v19
    v_lshlrev_b32 v50, 16, v58
    v_mfma_f32_16x16x32_bf16 v[100:103], v[44:47], a[236:239], v[100:103]
    buffer_load_dwordx4 v4, s[4:7], s27 offen offset:0 sc1 lds
    v_mfma_f32_16x16x32_bf16 v[104:107], v[40:43], v[192:195], v[104:107]
    ds_read_b128 v[36:39], v3 offset:18432
    v_mfma_f32_16x16x32_bf16 v[104:107], v[44:47], v[196:199], v[104:107]
    v_exp_f32 v18, v126
    v_mfma_f32_16x16x32_bf16 v[108:111], v[40:43], v[216:219], v[108:111]
    v_add_f32 v8, v8, v16
    v_add_f32 v8, v8, v17
    v_mfma_f32_16x16x32_bf16 v[108:111], v[44:47], v[220:223], v[108:111]
    s_waitcnt lgkmcnt(2)
    buffer_load_dwordx3 v[240:242], v12, s[68:71], s16 offen offset:0 nt
    v_mfma_f32_16x16x32_bf16 v[176:179], v[24:27], a[192:195], v[128:131]
    ds_read_b128 v[40:43], v2 offset:12416
    v_mfma_f32_16x16x32_bf16 v[176:179], v[28:31], a[196:199], v[176:179]
    v_exp_f32 v19, v127
    v_cvt_pk_bf16_f32 v94, v16, v17
    v_mfma_f32_16x16x32_bf16 v[180:183], v[24:27], a[216:219], v[132:135]
    s_mov_b32 s30, s29
    v_add_f32 v8, v8, v18
    v_add_f32 v8, v8, v19
    v_mfma_f32_16x16x32_bf16 v[180:183], v[28:31], a[220:223], v[180:183]
    buffer_load_dwordx4 v4, s[4:7], s27 offen offset:1024 sc1 lds
    v_mfma_f32_16x16x32_bf16 v[184:187], v[24:27], a[240:243], v[136:139]
    ds_read_b128 v[44:47], v3 offset:12416
    v_cvt_pk_bf16_f32 v95, v18, v19
    v_mfma_f32_16x16x32_bf16 v[184:187], v[28:31], a[244:247], v[184:187]
    v_exp_f32 v16, v160
    v_mfma_f32_16x16x32_bf16 v[188:191], v[24:27], v[200:203], v[140:143]
    v_exp_f32 v17, v161
    v_mfma_f32_16x16x32_bf16 v[188:191], v[28:31], v[204:207], v[188:191]
    s_waitcnt lgkmcnt(2)
    buffer_load_dwordx3 v[244:246], v12, s[68:71], s16 offen offset:768 nt
    v_mfma_f32_16x16x32_bf16 v[112:115], v[32:35], a[192:195], v[128:131]
    ds_read_b128 v[24:27], v2 offset:18560
    v_and_b32 v51, s97, v58
    v_mfma_f32_16x16x32_bf16 v[112:115], v[36:39], a[196:199], v[112:115]
    v_exp_f32 v18, v162
    v_mfma_f32_16x16x32_bf16 v[116:119], v[32:35], a[216:219], v[132:135]
    v_add_f32 v5, v5, v16
    v_add_f32 v5, v5, v17
    v_mfma_f32_16x16x32_bf16 v[116:119], v[36:39], a[220:223], v[116:119]
    v_exp_f32 v19, v163
    v_mfma_f32_16x16x32_bf16 v[120:123], v[32:35], a[240:243], v[136:139]
    ds_read_b128 v[28:31], v3 offset:18560
    v_cvt_pk_bf16_f32 v160, v16, v17
    v_mfma_f32_16x16x32_bf16 v[120:123], v[36:39], a[244:247], v[120:123]
    buffer_load_dwordx3 v[248:250], v12, s[68:71], s16 offen offset:1536 nt
    v_mfma_f32_16x16x32_bf16 v[124:127], v[32:35], v[200:203], v[140:143]
    v_exp_f32 v16, v96
    v_mfma_f32_16x16x32_bf16 v[124:127], v[36:39], v[204:207], v[124:127]
    s_waitcnt lgkmcnt(2)
    v_add_f32 v5, v5, v18
    v_add_f32 v5, v5, v19
    v_mfma_f32_16x16x32_bf16 v[176:179], v[40:43], a[200:203], v[176:179]
    ds_read_b128 v[32:35], v2 offset:12544
    v_mul_f32_e64 v50, -v50, v48
    v_mfma_f32_16x16x32_bf16 v[176:179], v[44:47], a[204:207], v[176:179]
    buffer_load_dwordx4 v4, s[4:7], s27 offen offset:2048 sc1 lds
    v_mfma_f32_16x16x32_bf16 v[180:183], v[40:43], a[224:227], v[180:183]
    v_exp_f32 v17, v97
    v_mfma_f32_16x16x32_bf16 v[180:183], v[44:47], a[228:231], v[180:183]
    v_cvt_pk_bf16_f32 v161, v18, v19
    v_add_u32 v1, s3, v1
    v_mfma_f32_16x16x32_bf16 v[184:187], v[40:43], a[248:251], v[184:187]
    ds_read_b128 v[36:39], v3 offset:12544
    v_mul_f32_e64 v51, -v51, v49
    v_mfma_f32_16x16x32_bf16 v[184:187], v[44:47], a[252:255], v[184:187]
    buffer_load_dwordx3 v[252:254], v12, s[68:71], s16 offen offset:2304 nt
    v_mfma_f32_16x16x32_bf16 v[188:191], v[40:43], v[208:211], v[188:191]
    v_exp_f32 v18, v98
    v_mfma_f32_16x16x32_bf16 v[188:191], v[44:47], v[212:215], v[188:191]
    s_waitcnt lgkmcnt(2)
    v_add_f32 v5, v5, v16
    v_add_f32 v5, v5, v17
    v_mfma_f32_16x16x32_bf16 v[112:115], v[24:27], a[200:203], v[112:115]
    ds_read_b128 v[40:43], v2 offset:18688
    v_cvt_f32_i32 v144, v144
    v_mfma_f32_16x16x32_bf16 v[112:115], v[28:31], a[204:207], v[112:115]
    v_exp_f32 v19, v99
    v_cvt_pk_bf16_f32 v162, v16, v17
    v_mfma_f32_16x16x32_bf16 v[116:119], v[24:27], a[224:227], v[116:119]
    v_exp_f32 v16, v164
    v_mfma_f32_16x16x32_bf16 v[116:119], v[28:31], a[228:231], v[116:119]
    s_add_u32 s27, s27, 24576
    v_add_f32 v5, v5, v18
    v_add_f32 v5, v5, v19
    v_mfma_f32_16x16x32_bf16 v[120:123], v[24:27], a[248:251], v[120:123]
    s_add_u32 s56, s56, 36864
    ds_read_b128 v[44:47], v3 offset:18688
    s_sub_u32 s58, s56, 147456
    v_mfma_f32_16x16x32_bf16 v[120:123], v[28:31], a[252:255], v[120:123]
    s_waitcnt lgkmcnt(2)
    v_exp_f32 v17, v165
    v_mfma_f32_16x16x32_bf16 v[124:127], v[24:27], v[208:211], v[124:127]
    s_waitcnt vmcnt(12)
    v_cvt_pk_bf16_f32 v163, v18, v19
    v_cvt_f32_i32 v148, v148
    v_mfma_f32_16x16x32_bf16 v[124:127], v[28:31], v[212:215], v[124:127]
    s_barrier
    s_min_u32 s56, s56, s58
    v_mfma_f32_16x16x32_bf16 v[176:179], v[32:35], a[208:211], v[176:179]
    ds_read_b128 v[24:27], v1 offset:0
    v_mfma_f32_16x16x32_bf16 v[176:179], v[36:39], a[212:215], v[176:179]
    v_exp_f32 v18, v166
    v_mfma_f32_16x16x32_bf16 v[180:183], v[32:35], a[232:235], v[180:183]
    v_add_f32 v6, v6, v16
    v_add_f32 v6, v6, v17
    v_mfma_f32_16x16x32_bf16 v[180:183], v[36:39], a[236:239], v[180:183]
    v_exp_f32 v19, v167
    v_mfma_f32_16x16x32_bf16 v[184:187], v[32:35], v[192:195], v[184:187]
    ds_read_b128 v[28:31], v1 offset:12288
    v_cvt_pk_bf16_f32 v164, v16, v17
    v_mfma_f32_16x16x32_bf16 v[184:187], v[36:39], v[196:199], v[184:187]
    v_exp_f32 v16, v100
    v_mfma_f32_16x16x32_bf16 v[188:191], v[32:35], v[216:219], v[188:191]
    v_add_f32 v6, v6, v18
    v_add_f32 v6, v6, v19
    v_mfma_f32_16x16x32_bf16 v[188:191], v[36:39], v[220:223], v[188:191]
    s_waitcnt lgkmcnt(2)
    v_exp_f32 v17, v101
    v_mfma_f32_16x16x32_bf16 v[112:115], v[40:43], a[208:211], v[112:115]
    ds_read_b128 v[32:35], v1 offset:1024
    v_cvt_pk_bf16_f32 v165, v18, v19
    v_mfma_f32_16x16x32_bf16 v[112:115], v[44:47], a[212:215], v[112:115]
    v_exp_f32 v18, v102
    v_mfma_f32_16x16x32_bf16 v[116:119], v[40:43], a[232:235], v[116:119]
    v_add_f32 v6, v6, v16
    v_add_f32 v6, v6, v17
    v_mfma_f32_16x16x32_bf16 v[116:119], v[44:47], a[236:239], v[116:119]
    v_exp_f32 v19, v103
    v_mfma_f32_16x16x32_bf16 v[120:123], v[40:43], v[192:195], v[120:123]
    ds_read_b128 v[36:39], v1 offset:13312
    v_cvt_pk_bf16_f32 v166, v16, v17
    v_mfma_f32_16x16x32_bf16 v[120:123], v[44:47], v[196:199], v[120:123]
    v_add_f32 v6, v6, v18
    v_add_f32 v6, v6, v19
    v_mfma_f32_16x16x32_bf16 v[124:127], v[40:43], v[216:219], v[124:127]
    v_cvt_pk_bf16_f32 v167, v18, v19
    v_mfma_f32_16x16x32_bf16 v[124:127], v[44:47], v[220:223], v[124:127]
    s_waitcnt lgkmcnt(2)
    v_mfma_f32_16x16x32_bf16 a[0:3], v[64:67], v[24:27], a[0:3]
    ds_read_b128 v[40:43], v1 offset:2048
    v_fma_f32 v144, v144, v48, v50
    v_mfma_f32_16x16x32_bf16 a[0:3], v[80:83], v[28:31], a[0:3]
    buffer_store_dwordx4 v[224:227], v11, s[4:7], s33 offen offset:0 sc1
    v_mfma_f32_16x16x32_bf16 a[48:51], v[68:71], v[24:27], a[48:51]
    v_exp_f32 v16, v168
    v_mfma_f32_16x16x32_bf16 a[48:51], v[84:87], v[28:31], a[48:51]
    v_exp_f32 v17, v169
    v_mfma_f32_16x16x32_bf16 a[96:99], v[72:75], v[24:27], a[96:99]
    ds_read_b128 v[44:47], v1 offset:14336
    v_xor_b32 v55, 16, v11
    v_mfma_f32_16x16x32_bf16 a[96:99], v[88:91], v[28:31], a[96:99]
    v_exp_f32 v18, v170
    v_mfma_f32_16x16x32_bf16 a[144:147], v[76:79], v[24:27], a[144:147]
    v_add_f32 v7, v7, v16
    v_add_f32 v7, v7, v17
    v_mfma_f32_16x16x32_bf16 a[144:147], v[92:95], v[28:31], a[144:147]
    s_waitcnt lgkmcnt(2)
    v_exp_f32 v19, v171
    v_mfma_f32_16x16x32_bf16 a[4:7], v[64:67], v[32:35], a[4:7]
    ds_read_b128 v[24:27], v1 offset:3072
    v_fma_f32 v148, v148, v49, v51
    v_mfma_f32_16x16x32_bf16 a[4:7], v[80:83], v[36:39], a[4:7]
    buffer_store_dwordx4 v[228:231], v55, s[4:7], s33 offen offset:768 sc1
    v_mfma_f32_16x16x32_bf16 a[52:55], v[68:71], v[32:35], a[52:55]
    v_cvt_pk_bf16_f32 v168, v16, v17
    v_cvt_f32_i32 v145, v145
    v_mfma_f32_16x16x32_bf16 a[52:55], v[84:87], v[36:39], a[52:55]
    v_exp_f32 v16, v104
    v_mfma_f32_16x16x32_bf16 a[100:103], v[72:75], v[32:35], a[100:103]
    ds_read_b128 v[28:31], v1 offset:15360
    v_add_f32 v7, v7, v18
    v_mfma_f32_16x16x32_bf16 a[100:103], v[88:91], v[36:39], a[100:103]
    v_add_f32 v7, v7, v19
    v_xor_b32 v54, 32, v11
    v_mfma_f32_16x16x32_bf16 a[148:151], v[76:79], v[32:35], a[148:151]
    v_exp_f32 v17, v105
    v_mfma_f32_16x16x32_bf16 a[148:151], v[92:95], v[36:39], a[148:151]
    s_waitcnt lgkmcnt(2)
    v_cvt_pk_bf16_f32 v169, v18, v19
    v_cvt_f32_i32 v149, v149
    v_mfma_f32_16x16x32_bf16 a[8:11], v[64:67], v[40:43], a[8:11]
    ds_read_b128 v[32:35], v1 offset:4096
    v_fma_f32 v145, v145, v48, v50
    v_mfma_f32_16x16x32_bf16 a[8:11], v[80:83], v[44:47], a[8:11]
    buffer_store_dwordx4 v[232:235], v54, s[4:7], s33 offen offset:1536 sc1
    v_mfma_f32_16x16x32_bf16 a[56:59], v[68:71], v[40:43], a[56:59]
    v_exp_f32 v18, v106
    v_mfma_f32_16x16x32_bf16 a[56:59], v[84:87], v[44:47], a[56:59]
    v_add_f32 v7, v7, v16
    v_add_f32 v7, v7, v17
    v_mfma_f32_16x16x32_bf16 a[104:107], v[72:75], v[40:43], a[104:107]
    ds_read_b128 v[36:39], v1 offset:16384
    v_xor_b32 v55, 48, v11
    v_mfma_f32_16x16x32_bf16 a[104:107], v[88:91], v[44:47], a[104:107]
    v_exp_f32 v19, v107
    v_mfma_f32_16x16x32_bf16 a[152:155], v[76:79], v[40:43], a[152:155]
    v_cvt_pk_bf16_f32 v170, v16, v17
    v_fma_f32 v149, v149, v49, v51
    v_mfma_f32_16x16x32_bf16 a[152:155], v[92:95], v[44:47], a[152:155]
    s_waitcnt lgkmcnt(2)
    v_exp_f32 v16, v172
    v_mfma_f32_16x16x32_bf16 a[12:15], v[64:67], v[24:27], a[12:15]
    ds_read_b128 v[40:43], v1 offset:5120
    v_add_f32 v7, v7, v18
    v_mfma_f32_16x16x32_bf16 a[12:15], v[80:83], v[28:31], a[12:15]
    buffer_store_dwordx4 v[236:239], v55, s[4:7], s33 offen offset:2304 sc1
    v_mfma_f32_16x16x32_bf16 a[60:63], v[68:71], v[24:27], a[60:63]
    v_add_f32 v7, v7, v19
    v_cvt_f32_i32 v146, v146
    v_mfma_f32_16x16x32_bf16 a[60:63], v[84:87], v[28:31], a[60:63]
    v_exp_f32 v17, v173
    v_mfma_f32_16x16x32_bf16 a[108:111], v[72:75], v[24:27], a[108:111]
    ds_read_b128 v[44:47], v1 offset:17408
    v_cvt_pk_bf16_f32 v171, v18, v19
    v_mfma_f32_16x16x32_bf16 a[108:111], v[88:91], v[28:31], a[108:111]
    v_exp_f32 v18, v174
    v_mfma_f32_16x16x32_bf16 a[156:159], v[76:79], v[24:27], a[156:159]
    s_add_u32 s29, s28, 49152
    v_add_f32 v8, v8, v16
    v_add_f32 v8, v8, v17
    v_mfma_f32_16x16x32_bf16 a[156:159], v[92:95], v[28:31], a[156:159]
    s_waitcnt lgkmcnt(2)
    v_exp_f32 v19, v175
    v_mfma_f32_16x16x32_bf16 a[16:19], v[64:67], v[32:35], a[16:19]
    s_sub_u32 s3, s29, 147456
    ds_read_b128 v[24:27], v1 offset:6144
    v_cvt_pk_bf16_f32 v172, v16, v17
    v_mfma_f32_16x16x32_bf16 a[16:19], v[80:83], v[36:39], a[16:19]
    s_mov_b32 m0, s26
    v_exp_f32 v16, v108
    v_mfma_f32_16x16x32_bf16 a[64:67], v[68:71], v[32:35], a[64:67]
    s_min_u32 s29, s29, s3
    v_cvt_f32_i32 v150, v150
    v_add_f32 v8, v8, v18
    v_mfma_f32_16x16x32_bf16 a[64:67], v[84:87], v[36:39], a[64:67]
    buffer_load_dwordx4 v4, s[4:7], s32 offen offset:0 sc1 lds
    v_mfma_f32_16x16x32_bf16 a[112:115], v[72:75], v[32:35], a[112:115]
    ds_read_b128 v[28:31], v1 offset:18432
    v_add_f32 v8, v8, v19
    v_mfma_f32_16x16x32_bf16 a[112:115], v[88:91], v[36:39], a[112:115]
    v_exp_f32 v17, v109
    v_mfma_f32_16x16x32_bf16 a[160:163], v[76:79], v[32:35], a[160:163]
    v_cvt_pk_bf16_f32 v173, v18, v19
    v_fma_f32 v146, v146, v48, v50
    v_mfma_f32_16x16x32_bf16 a[160:163], v[92:95], v[36:39], a[160:163]
    s_waitcnt lgkmcnt(2)
    buffer_load_dwordx4 v4, s[4:7], s32 offen offset:1024 sc1 lds
    v_mfma_f32_16x16x32_bf16 a[20:23], v[64:67], v[40:43], a[20:23]
    s_sub_u32 s3, s29, s28
    ds_read_b128 v[32:35], v1 offset:7168
    v_fma_f32 v150, v150, v49, v51
    v_mfma_f32_16x16x32_bf16 a[20:23], v[80:83], v[44:47], a[20:23]
    v_exp_f32 v18, v110
    v_mfma_f32_16x16x32_bf16 a[68:71], v[68:71], v[40:43], a[68:71]
    v_add_f32 v8, v8, v16
    v_add_f32 v8, v8, v17
    v_mfma_f32_16x16x32_bf16 a[68:71], v[84:87], v[44:47], a[68:71]
    buffer_load_dwordx4 v4, s[4:7], s32 offen offset:2048 sc1 lds
    v_mfma_f32_16x16x32_bf16 a[116:119], v[72:75], v[40:43], a[116:119]
    ds_read_b128 v[36:39], v1 offset:19456
    v_lshlrev_b32 v48, 16, v57
    v_mfma_f32_16x16x32_bf16 a[116:119], v[88:91], v[44:47], a[116:119]
    v_exp_f32 v19, v111
    v_mfma_f32_16x16x32_bf16 a[164:167], v[76:79], v[40:43], a[164:167]
    s_mov_b32 s28, s29
    v_cvt_pk_bf16_f32 v174, v16, v17
    v_add_f32 v8, v8, v18
    v_mfma_f32_16x16x32_bf16 a[164:167], v[92:95], v[44:47], a[164:167]
    s_waitcnt lgkmcnt(2)
    v_add_f32 v8, v8, v19
    v_cvt_pk_bf16_f32 v175, v18, v19
    v_mfma_f32_16x16x32_bf16 a[24:27], v[64:67], v[24:27], a[24:27]
    s_add_u32 s32, s32, 24576
    ds_read_b128 v[40:43], v1 offset:8192
    v_and_b32 v49, s97, v57
    v_mfma_f32_16x16x32_bf16 a[24:27], v[80:83], v[28:31], a[24:27]
    v_exp_f32 v16, v176
    v_mfma_f32_16x16x32_bf16 a[72:75], v[68:71], v[24:27], a[72:75]
    s_add_u32 s26, s26, 12288
    v_exp_f32 v17, v177
    v_mfma_f32_16x16x32_bf16 a[72:75], v[84:87], v[28:31], a[72:75]
    v_exp_f32 v18, v178
    v_mfma_f32_16x16x32_bf16 a[120:123], v[72:75], v[24:27], a[120:123]
    s_mov_b32 m0, s26
    ds_read_b128 v[44:47], v1 offset:20480
    v_add_f32 v5, v5, v16
    v_mfma_f32_16x16x32_bf16 a[120:123], v[88:91], v[28:31], a[120:123]
    v_add_f32 v5, v5, v17
    v_lshlrev_b32 v50, 16, v59
    v_mfma_f32_16x16x32_bf16 a[168:171], v[76:79], v[24:27], a[168:171]
    v_exp_f32 v19, v179
    v_mfma_f32_16x16x32_bf16 a[168:171], v[92:95], v[28:31], a[168:171]
    s_waitcnt lgkmcnt(2)
    v_cvt_pk_bf16_f32 v176, v16, v17
    v_and_b32 v51, s97, v59
    v_mfma_f32_16x16x32_bf16 a[28:31], v[64:67], v[32:35], a[28:31]
    ds_read_b128 v[24:27], v1 offset:9216
    v_add_u32 v2, s3, v2
    v_mfma_f32_16x16x32_bf16 a[28:31], v[80:83], v[36:39], a[28:31]
    buffer_load_dwordx4 v4, s[4:7], s32 offen offset:0 sc1 lds
    v_mfma_f32_16x16x32_bf16 a[76:79], v[68:71], v[32:35], a[76:79]
    v_exp_f32 v16, v112
    v_mfma_f32_16x16x32_bf16 a[76:79], v[84:87], v[36:39], a[76:79]
    v_add_f32 v5, v5, v18
    v_add_f32 v5, v5, v19
    v_mfma_f32_16x16x32_bf16 a[124:127], v[72:75], v[32:35], a[124:127]
    ds_read_b128 v[28:31], v1 offset:21504
    v_mul_f32_e64 v50, -v50, v48
    v_mfma_f32_16x16x32_bf16 a[124:127], v[88:91], v[36:39], a[124:127]
    buffer_load_dwordx4 v4, s[4:7], s32 offen offset:1024 sc1 lds
    v_mfma_f32_16x16x32_bf16 a[172:175], v[76:79], v[32:35], a[172:175]
    v_exp_f32 v17, v113
    v_mfma_f32_16x16x32_bf16 a[172:175], v[92:95], v[36:39], a[172:175]
    s_waitcnt lgkmcnt(2)
    v_cvt_pk_bf16_f32 v177, v18, v19
    v_add_u32 v3, s3, v3
    v_mfma_f32_16x16x32_bf16 a[32:35], v[64:67], v[40:43], a[32:35]
    ds_read_b128 v[32:35], v1 offset:10240
    v_mul_f32_e64 v51, -v51, v49
    v_mfma_f32_16x16x32_bf16 a[32:35], v[80:83], v[44:47], a[32:35]
    v_exp_f32 v18, v114
    v_mfma_f32_16x16x32_bf16 a[80:83], v[68:71], v[40:43], a[80:83]
    v_add_f32 v5, v5, v16
    v_add_f32 v5, v5, v17
    v_mfma_f32_16x16x32_bf16 a[80:83], v[84:87], v[44:47], a[80:83]
    buffer_load_dwordx4 v4, s[4:7], s32 offen offset:2048 sc1 lds
    v_mfma_f32_16x16x32_bf16 a[128:131], v[72:75], v[40:43], a[128:131]
    ds_read_b128 v[36:39], v1 offset:22528
    v_mfma_f32_16x16x32_bf16 a[128:131], v[88:91], v[44:47], a[128:131]
    v_exp_f32 v19, v115
    v_mfma_f32_16x16x32_bf16 a[176:179], v[76:79], v[40:43], a[176:179]
    v_cvt_pk_bf16_f32 v178, v16, v17
    v_cvt_f32_i32 v152, v152
    v_mfma_f32_16x16x32_bf16 a[176:179], v[92:95], v[44:47], a[176:179]
    s_waitcnt lgkmcnt(2)
    v_exp_f32 v16, v180
    v_mfma_f32_16x16x32_bf16 a[36:39], v[64:67], v[24:27], a[36:39]
    ds_read_b128 v[40:43], v1 offset:11264
    v_add_f32 v5, v5, v18
    v_mfma_f32_16x16x32_bf16 a[36:39], v[80:83], v[28:31], a[36:39]
    v_add_f32 v5, v5, v19
    v_mfma_f32_16x16x32_bf16 a[84:87], v[68:71], v[24:27], a[84:87]
    v_exp_f32 v17, v181
    v_mfma_f32_16x16x32_bf16 a[84:87], v[84:87], v[28:31], a[84:87]
    s_add_u32 s32, s32, 24576
    v_cvt_pk_bf16_f32 v179, v18, v19
    s_add_u32 s26, s26, 36864
    v_mfma_f32_16x16x32_bf16 a[132:135], v[72:75], v[24:27], a[132:135]
L_pg8:
    s_cbranch_execz L_pg12
    s_sub_u32 s57, s26, 147456
    ds_read_b128 v[44:47], v1 offset:23552
    v_cvt_f32_i32 v156, v156
    v_mfma_f32_16x16x32_bf16 a[132:135], v[88:91], v[28:31], a[132:135]
    s_waitcnt lgkmcnt(2)
    v_exp_f32 v18, v182
    v_mfma_f32_16x16x32_bf16 a[180:183], v[76:79], v[24:27], a[180:183]
    s_waitcnt vmcnt(6)
    v_add_f32 v6, v6, v16
    v_add_f32 v6, v6, v17
    v_mfma_f32_16x16x32_bf16 a[180:183], v[92:95], v[28:31], a[180:183]
    s_barrier
    v_fma_f32 v152, v152, v48, v50
    v_mfma_f32_16x16x32_bf16 a[40:43], v[64:67], v[32:35], a[40:43]
    s_min_u32 s26, s26, s57
    ds_read_b128 v[24:27], v2 offset:0
    v_add_u32 v0, 1, v0
    v_mfma_f32_16x16x32_bf16 a[40:43], v[80:83], v[36:39], a[40:43]
    buffer_store_dword v0, v13, s[20:23], 0 offen offset:32 sc1
    v_mfma_f32_16x16x32_bf16 a[88:91], v[68:71], v[32:35], a[88:91]
    v_exp_f32 v19, v183
    v_mfma_f32_16x16x32_bf16 a[88:91], v[84:87], v[36:39], a[88:91]
    v_cvt_pk_bf16_f32 v180, v16, v17
    v_fma_f32 v156, v156, v49, v51
    v_mfma_f32_16x16x32_bf16 a[136:139], v[72:75], v[32:35], a[136:139]
    ds_read_b128 v[28:31], v3 offset:0
    v_mfma_f32_16x16x32_bf16 a[136:139], v[88:91], v[36:39], a[136:139]
    v_exp_f32 v16, v116
    v_mfma_f32_16x16x32_bf16 a[184:187], v[76:79], v[32:35], a[184:187]
    v_add_f32 v6, v6, v18
    v_add_f32 v6, v6, v19
    v_mfma_f32_16x16x32_bf16 a[184:187], v[92:95], v[36:39], a[184:187]
    s_waitcnt lgkmcnt(2)
    v_exp_f32 v17, v117
    v_mfma_f32_16x16x32_bf16 a[44:47], v[64:67], v[40:43], a[44:47]
    ds_read_b128 v[32:35], v2 offset:6144
    v_cvt_pk_bf16_f32 v181, v18, v19
    v_mfma_f32_16x16x32_bf16 a[44:47], v[80:83], v[44:47], a[44:47]
    v_exp_f32 v18, v118
    v_mfma_f32_16x16x32_bf16 a[92:95], v[68:71], v[40:43], a[92:95]
    v_add_f32 v6, v6, v16
    v_add_f32 v6, v6, v17
    v_mfma_f32_16x16x32_bf16 a[92:95], v[84:87], v[44:47], a[92:95]
    v_exp_f32 v19, v119
    v_mfma_f32_16x16x32_bf16 a[140:143], v[72:75], v[40:43], a[140:143]
    ds_read_b128 v[36:39], v3 offset:6144
    v_cvt_pk_bf16_f32 v182, v16, v17
    v_mfma_f32_16x16x32_bf16 a[140:143], v[88:91], v[44:47], a[140:143]
    v_add_f32 v6, v6, v18
    v_add_f32 v6, v6, v19
    v_mfma_f32_16x16x32_bf16 a[188:191], v[76:79], v[40:43], a[188:191]
    v_cvt_pk_bf16_f32 v183, v18, v19
    v_mfma_f32_16x16x32_bf16 a[188:191], v[92:95], v[44:47], a[188:191]
    s_waitcnt lgkmcnt(2)
    v_mfma_f32_16x16x32_bf16 v[64:67], v[24:27], a[192:195], v[128:131]
    s_mov_b32 m0, s56
    ds_read_b128 v[40:43], v2 offset:128
    v_cvt_f32_i32 v153, v153
    v_mfma_f32_16x16x32_bf16 v[64:67], v[28:31], a[196:199], v[64:67]
    buffer_load_dwordx4 v4, s[4:7], s27 offen offset:0 sc1 lds
    v_mfma_f32_16x16x32_bf16 v[68:71], v[24:27], a[216:219], v[132:135]
    v_exp_f32 v16, v184
    v_mfma_f32_16x16x32_bf16 v[68:71], v[28:31], a[220:223], v[68:71]
    v_exp_f32 v17, v185
    v_mfma_f32_16x16x32_bf16 v[72:75], v[24:27], a[240:243], v[136:139]
    ds_read_b128 v[44:47], v3 offset:128
    v_cvt_f32_i32 v157, v157
    v_mfma_f32_16x16x32_bf16 v[72:75], v[28:31], a[244:247], v[72:75]
    v_exp_f32 v18, v186
    v_mfma_f32_16x16x32_bf16 v[76:79], v[24:27], v[200:203], v[140:143]
    v_add_f32 v7, v7, v16
    v_add_f32 v7, v7, v17
    v_mfma_f32_16x16x32_bf16 v[76:79], v[28:31], v[204:207], v[76:79]
    s_waitcnt lgkmcnt(2)
    v_exp_f32 v19, v187
    v_mfma_f32_16x16x32_bf16 v[96:99], v[32:35], a[192:195], v[128:131]
    ds_read_b128 v[24:27], v2 offset:6272
    v_fma_f32 v153, v153, v48, v50
    v_mfma_f32_16x16x32_bf16 v[96:99], v[36:39], a[196:199], v[96:99]
    v_cvt_pk_bf16_f32 v184, v16, v17
    v_fma_f32 v157, v157, v49, v51
    v_mfma_f32_16x16x32_bf16 v[100:103], v[32:35], a[216:219], v[132:135]
    v_exp_f32 v16, v120
    v_mfma_f32_16x16x32_bf16 v[100:103], v[36:39], a[220:223], v[100:103]
    buffer_load_dwordx4 v4, s[4:7], s27 offen offset:1024 sc1 lds
    v_mfma_f32_16x16x32_bf16 v[104:107], v[32:35], a[240:243], v[136:139]
    ds_read_b128 v[28:31], v3 offset:6272
    v_add_f32 v7, v7, v18
    v_mfma_f32_16x16x32_bf16 v[104:107], v[36:39], a[244:247], v[104:107]
    v_add_f32 v7, v7, v19
    v_cvt_f32_i32 v154, v154
    v_mfma_f32_16x16x32_bf16 v[108:111], v[32:35], v[200:203], v[140:143]
    v_exp_f32 v17, v121
    v_mfma_f32_16x16x32_bf16 v[108:111], v[36:39], v[204:207], v[108:111]
    s_waitcnt lgkmcnt(2)
    v_cvt_pk_bf16_f32 v185, v18, v19
    v_cvt_f32_i32 v158, v158
    v_mfma_f32_16x16x32_bf16 v[64:67], v[40:43], a[200:203], v[64:67]
    ds_read_b128 v[32:35], v2 offset:256
    v_fma_f32 v154, v154, v48, v50
    v_mfma_f32_16x16x32_bf16 v[64:67], v[44:47], a[204:207], v[64:67]
    v_exp_f32 v18, v122
    v_mfma_f32_16x16x32_bf16 v[68:71], v[40:43], a[224:227], v[68:71]
    v_add_f32 v7, v7, v16
    v_add_f32 v7, v7, v17
    v_mfma_f32_16x16x32_bf16 v[68:71], v[44:47], a[228:231], v[68:71]
    v_exp_f32 v19, v123
    v_mfma_f32_16x16x32_bf16 v[72:75], v[40:43], a[248:251], v[72:75]
    ds_read_b128 v[36:39], v3 offset:256
    v_cvt_pk_bf16_f32 v186, v16, v17
    v_mfma_f32_16x16x32_bf16 v[72:75], v[44:47], a[252:255], v[72:75]
    v_exp_f32 v16, v188
    v_mfma_f32_16x16x32_bf16 v[76:79], v[40:43], v[208:211], v[76:79]
    v_add_f32 v7, v7, v18
    v_fma_f32 v158, v158, v49, v51
    v_mfma_f32_16x16x32_bf16 v[76:79], v[44:47], v[212:215], v[76:79]
    s_waitcnt lgkmcnt(2)
    buffer_load_dwordx4 v4, s[4:7], s27 offen offset:2048 sc1 lds
    v_mfma_f32_16x16x32_bf16 v[96:99], v[24:27], a[200:203], v[96:99]
    ds_read_b128 v[40:43], v2 offset:6400
    v_add_f32 v7, v7, v19
    v_mfma_f32_16x16x32_bf16 v[96:99], v[28:31], a[204:207], v[96:99]
    v_exp_f32 v17, v189
    v_mfma_f32_16x16x32_bf16 v[100:103], v[24:27], a[224:227], v[100:103]
    v_cvt_pk_bf16_f32 v187, v18, v19
    v_cvt_pk_bf16_f32 v144, v144, v148
    v_mfma_f32_16x16x32_bf16 v[100:103], v[28:31], a[228:231], v[100:103]
    v_exp_f32 v18, v190
    v_mfma_f32_16x16x32_bf16 v[104:107], v[24:27], a[248:251], v[104:107]
    ds_read_b128 v[44:47], v3 offset:6400
    v_add_f32 v8, v8, v16
    v_mfma_f32_16x16x32_bf16 v[104:107], v[28:31], a[252:255], v[104:107]
    v_add_f32 v8, v8, v17
    v_cvt_pk_bf16_f32 v148, v145, v149
    v_mfma_f32_16x16x32_bf16 v[108:111], v[24:27], v[208:211], v[108:111]
    s_add_u32 s29, s30, 49152
    v_exp_f32 v19, v191
    v_mfma_f32_16x16x32_bf16 v[108:111], v[28:31], v[212:215], v[108:111]
    s_waitcnt lgkmcnt(2)
    v_cvt_pk_bf16_f32 v188, v16, v17
    s_sub_u32 s3, s29, 147456
    v_mfma_f32_16x16x32_bf16 v[64:67], v[32:35], a[208:211], v[64:67]
    s_add_u32 s27, s27, 24576
    ds_read_b128 v[24:27], v2 offset:12288
    v_cvt_pk_bf16_f32 v145, v152, v156
    v_mfma_f32_16x16x32_bf16 v[64:67], v[36:39], a[212:215], v[64:67]
    s_min_u32 s29, s29, s3
    v_exp_f32 v16, v124
    v_mfma_f32_16x16x32_bf16 v[68:71], v[32:35], a[232:235], v[68:71]
    v_add_f32 v8, v8, v18
    v_add_f32 v8, v8, v19
    v_mfma_f32_16x16x32_bf16 v[68:71], v[36:39], a[236:239], v[68:71]
    v_exp_f32 v17, v125
    v_mfma_f32_16x16x32_bf16 v[72:75], v[32:35], v[192:195], v[72:75]
    s_add_u32 s56, s56, 12288
    ds_read_b128 v[28:31], v3 offset:12288
    v_cvt_pk_bf16_f32 v149, v153, v157
    v_mfma_f32_16x16x32_bf16 v[72:75], v[36:39], v[196:199], v[72:75]
    v_cvt_pk_bf16_f32 v189, v18, v19
    v_mfma_f32_16x16x32_bf16 v[76:79], v[32:35], v[216:219], v[76:79]
    v_exp_f32 v18, v126
    v_mfma_f32_16x16x32_bf16 v[76:79], v[36:39], v[220:223], v[76:79]
    s_waitcnt lgkmcnt(2)
    v_add_f32 v8, v8, v16
    v_cvt_pk_bf16_f32 v152, v146, v150
    v_mfma_f32_16x16x32_bf16 v[96:99], v[40:43], a[208:211], v[96:99]
    ds_read_b128 v[32:35], v2 offset:18432
    v_add_f32 v8, v8, v17
    v_mfma_f32_16x16x32_bf16 v[96:99], v[44:47], a[212:215], v[96:99]
    s_sub_u32 s3, s29, s30
    v_exp_f32 v19, v127
    v_mfma_f32_16x16x32_bf16 v[100:103], v[40:43], a[232:235], v[100:103]
    s_mov_b32 m0, s56
    v_cvt_pk_bf16_f32 v153, v154, v158
    v_mfma_f32_16x16x32_bf16 v[100:103], v[44:47], a[236:239], v[100:103]
    v_cvt_pk_bf16_f32 v190, v16, v17
    v_mfma_f32_16x16x32_bf16 v[104:107], v[40:43], v[192:195], v[104:107]
    ds_read_b128 v[36:39], v3 offset:18432
    v_add_f32 v8, v8, v18
    v_mfma_f32_16x16x32_bf16 v[104:107], v[44:47], v[196:199], v[104:107]
    v_add_f32 v8, v8, v19
    v_cvt_pk_bf16_f32 v191, v18, v19
    v_mfma_f32_16x16x32_bf16 v[108:111], v[40:43], v[216:219], v[108:111]
    v_mfma_f32_16x16x32_bf16 v[108:111], v[44:47], v[220:223], v[108:111]
    s_waitcnt lgkmcnt(2)
    v_exp_f32 v16, v64
    v_mfma_f32_16x16x32_bf16 v[80:83], v[24:27], a[192:195], v[128:131]
    ds_read_b128 v[40:43], v2 offset:12416
    v_mfma_f32_16x16x32_bf16 v[80:83], v[28:31], a[196:199], v[80:83]
    s_mov_b32 s30, s29
    v_exp_f32 v17, v65
    v_mfma_f32_16x16x32_bf16 v[84:87], v[24:27], a[216:219], v[132:135]
    v_exp_f32 v18, v66
    v_mfma_f32_16x16x32_bf16 v[84:87], v[28:31], a[220:223], v[84:87]
    s_waitcnt vmcnt(14)
    buffer_load_dwordx4 v4, s[4:7], s27 offen offset:0 sc1 lds
    v_mfma_f32_16x16x32_bf16 v[88:91], v[24:27], a[240:243], v[136:139]
    ds_read_b128 v[44:47], v3 offset:12416
    v_add_f32 v5, v5, v16
    v_mfma_f32_16x16x32_bf16 v[88:91], v[28:31], a[244:247], v[88:91]
    v_add_f32 v5, v5, v17
    v_lshlrev_b32 v48, 16, v60
    v_mfma_f32_16x16x32_bf16 v[92:95], v[24:27], v[200:203], v[140:143]
    v_exp_f32 v19, v67
    v_mfma_f32_16x16x32_bf16 v[92:95], v[28:31], v[204:207], v[92:95]
    s_waitcnt lgkmcnt(2)
    v_cvt_pk_bf16_f32 v64, v16, v17
    v_and_b32 v49, s97, v60
    v_mfma_f32_16x16x32_bf16 v[112:115], v[32:35], a[192:195], v[128:131]
    ds_read_b128 v[24:27], v2 offset:18560
    v_mfma_f32_16x16x32_bf16 v[112:115], v[36:39], a[196:199], v[112:115]
    v_exp_f32 v16, v96
    v_mfma_f32_16x16x32_bf16 v[116:119], v[32:35], a[216:219], v[132:135]
    v_add_f32 v5, v5, v18
    v_add_f32 v5, v5, v19
    v_mfma_f32_16x16x32_bf16 v[116:119], v[36:39], a[220:223], v[116:119]
    v_exp_f32 v17, v97
    v_mfma_f32_16x16x32_bf16 v[120:123], v[32:35], a[240:243], v[136:139]
    ds_read_b128 v[28:31], v3 offset:18560
    v_lshlrev_b32 v50, 16, v62
    v_mfma_f32_16x16x32_bf16 v[120:123], v[36:39], a[244:247], v[120:123]
    v_cvt_pk_bf16_f32 v65, v18, v19
    v_add_u32 v1, s3, v1
    v_mfma_f32_16x16x32_bf16 v[124:127], v[32:35], v[200:203], v[140:143]
    v_exp_f32 v18, v98
    v_mfma_f32_16x16x32_bf16 v[124:127], v[36:39], v[204:207], v[124:127]
    s_waitcnt lgkmcnt(2)
    buffer_load_dwordx4 v4, s[4:7], s27 offen offset:1024 sc1 lds
    v_mfma_f32_16x16x32_bf16 v[80:83], v[40:43], a[200:203], v[80:83]
    ds_read_b128 v[32:35], v2 offset:12544
    v_add_f32 v5, v5, v16
    v_mfma_f32_16x16x32_bf16 v[80:83], v[44:47], a[204:207], v[80:83]
    v_add_f32 v5, v5, v17
    v_and_b32 v51, s97, v62
    v_mfma_f32_16x16x32_bf16 v[84:87], v[40:43], a[224:227], v[84:87]
    v_exp_f32 v19, v99
    v_mfma_f32_16x16x32_bf16 v[84:87], v[44:47], a[228:231], v[84:87]
    v_cvt_pk_bf16_f32 v66, v16, v17
    v_mfma_f32_16x16x32_bf16 v[88:91], v[40:43], a[248:251], v[88:91]
    ds_read_b128 v[36:39], v3 offset:12544
    v_mul_f32_e64 v50, -v50, v48
    v_mfma_f32_16x16x32_bf16 v[88:91], v[44:47], a[252:255], v[88:91]
    v_exp_f32 v16, v68
    v_mfma_f32_16x16x32_bf16 v[92:95], v[40:43], v[208:211], v[92:95]
    v_add_f32 v5, v5, v18
    v_add_f32 v5, v5, v19
    v_mfma_f32_16x16x32_bf16 v[92:95], v[44:47], v[212:215], v[92:95]
    s_waitcnt lgkmcnt(2)
    v_exp_f32 v17, v69
    v_mfma_f32_16x16x32_bf16 v[112:115], v[24:27], a[200:203], v[112:115]
    ds_read_b128 v[40:43], v2 offset:18688
    v_mfma_f32_16x16x32_bf16 v[112:115], v[28:31], a[204:207], v[112:115]
    buffer_load_dwordx4 v4, s[4:7], s27 offen offset:2048 sc1 lds
    v_mfma_f32_16x16x32_bf16 v[116:119], v[24:27], a[224:227], v[116:119]
    v_cvt_pk_bf16_f32 v67, v18, v19
    v_mul_f32_e64 v51, -v51, v49
    v_mfma_f32_16x16x32_bf16 v[116:119], v[28:31], a[228:231], v[116:119]
    v_exp_f32 v18, v70
    v_mfma_f32_16x16x32_bf16 v[120:123], v[24:27], a[248:251], v[120:123]
    ds_read_b128 v[44:47], v3 offset:18688
    v_add_f32 v6, v6, v16
    v_mfma_f32_16x16x32_bf16 v[120:123], v[28:31], a[252:255], v[120:123]
    s_waitcnt lgkmcnt(2)
    v_add_f32 v6, v6, v17
    v_mfma_f32_16x16x32_bf16 v[124:127], v[24:27], v[208:211], v[124:127]
    s_waitcnt vmcnt(7)
    v_exp_f32 v19, v71
    v_mfma_f32_16x16x32_bf16 v[124:127], v[28:31], v[212:215], v[124:127]
    s_barrier
    v_cvt_pk_bf16_f32 v68, v16, v17
    v_mfma_f32_16x16x32_bf16 v[80:83], v[32:35], a[208:211], v[80:83]
    ds_read_b128 v[24:27], v1 offset:0
    v_cvt_f32_i32 v240, v240
    v_mfma_f32_16x16x32_bf16 v[80:83], v[36:39], a[212:215], v[80:83]
    v_exp_f32 v16, v100
    v_mfma_f32_16x16x32_bf16 v[84:87], v[32:35], a[232:235], v[84:87]
    v_add_f32 v6, v6, v18
    v_add_f32 v6, v6, v19
    v_mfma_f32_16x16x32_bf16 v[84:87], v[36:39], a[236:239], v[84:87]
    v_exp_f32 v17, v101
    v_mfma_f32_16x16x32_bf16 v[88:91], v[32:35], v[192:195], v[88:91]
    ds_read_b128 v[28:31], v1 offset:12288
    v_cvt_f32_i32 v244, v244
    v_mfma_f32_16x16x32_bf16 v[88:91], v[36:39], v[196:199], v[88:91]
    v_cvt_pk_bf16_f32 v69, v18, v19
    v_mfma_f32_16x16x32_bf16 v[92:95], v[32:35], v[216:219], v[92:95]
    v_exp_f32 v18, v102
    v_mfma_f32_16x16x32_bf16 v[92:95], v[36:39], v[220:223], v[92:95]
    s_waitcnt lgkmcnt(2)
    v_add_f32 v6, v6, v16
    v_mfma_f32_16x16x32_bf16 v[112:115], v[40:43], a[208:211], v[112:115]
    ds_read_b128 v[32:35], v1 offset:1024
    v_add_f32 v6, v6, v17
    v_mfma_f32_16x16x32_bf16 v[112:115], v[44:47], a[212:215], v[112:115]
    v_exp_f32 v19, v103
    v_mfma_f32_16x16x32_bf16 v[116:119], v[40:43], a[232:235], v[116:119]
    v_mfma_f32_16x16x32_bf16 v[116:119], v[44:47], a[236:239], v[116:119]
    s_add_u32 s27, s27, 24576
    s_add_u32 s56, s56, 36864
    v_cvt_pk_bf16_f32 v70, v16, v17
    v_mfma_f32_16x16x32_bf16 v[120:123], v[40:43], v[192:195], v[120:123]
    s_sub_u32 s58, s56, 147456
    ds_read_b128 v[36:39], v1 offset:13312
    v_add_f32 v6, v6, v18
    v_mfma_f32_16x16x32_bf16 v[120:123], v[44:47], v[196:199], v[120:123]
    s_min_u32 s56, s56, s58
    v_add_f32 v6, v6, v19
    v_cvt_pk_bf16_f32 v71, v18, v19
    v_mfma_f32_16x16x32_bf16 v[124:127], v[40:43], v[216:219], v[124:127]
    v_mfma_f32_16x16x32_bf16 v[124:127], v[44:47], v[220:223], v[124:127]
    s_waitcnt lgkmcnt(2)
    v_mfma_f32_16x16x32_bf16 a[0:3], v[160:163], v[24:27], a[0:3]
    s_mov_b32 m0, s56
    ds_read_b128 v[40:43], v1 offset:2048
    v_fma_f32 v240, v240, v48, v50
    v_mfma_f32_16x16x32_bf16 a[0:3], v[176:179], v[28:31], a[0:3]
    buffer_load_dwordx4 v4, s[4:7], s27 offen offset:0 sc1 lds
    v_mfma_f32_16x16x32_bf16 a[48:51], v[164:167], v[24:27], a[48:51]
    v_exp_f32 v16, v72
    v_mfma_f32_16x16x32_bf16 a[48:51], v[180:183], v[28:31], a[48:51]
    v_exp_f32 v17, v73
    v_mfma_f32_16x16x32_bf16 a[96:99], v[168:171], v[24:27], a[96:99]
    ds_read_b128 v[44:47], v1 offset:14336
    v_fma_f32 v244, v244, v49, v51
    v_mfma_f32_16x16x32_bf16 a[96:99], v[184:187], v[28:31], a[96:99]
    v_exp_f32 v18, v74
    v_mfma_f32_16x16x32_bf16 a[144:147], v[172:175], v[24:27], a[144:147]
    v_add_f32 v7, v7, v16
    v_add_f32 v7, v7, v17
    v_mfma_f32_16x16x32_bf16 a[144:147], v[188:191], v[28:31], a[144:147]
    s_waitcnt lgkmcnt(2)
    v_exp_f32 v19, v75
    v_mfma_f32_16x16x32_bf16 a[4:7], v[160:163], v[32:35], a[4:7]
    ds_read_b128 v[24:27], v1 offset:3072
    v_cvt_f32_i32 v241, v241
    v_mfma_f32_16x16x32_bf16 a[4:7], v[176:179], v[36:39], a[4:7]
    buffer_load_dwordx4 v4, s[4:7], s27 offen offset:1024 sc1 lds
    v_mfma_f32_16x16x32_bf16 a[52:55], v[164:167], v[32:35], a[52:55]
    v_cvt_pk_bf16_f32 v72, v16, v17
    v_cvt_f32_i32 v245, v245
    v_mfma_f32_16x16x32_bf16 a[52:55], v[180:183], v[36:39], a[52:55]
    v_exp_f32 v16, v104
    v_mfma_f32_16x16x32_bf16 a[100:103], v[168:171], v[32:35], a[100:103]
    ds_read_b128 v[28:31], v1 offset:15360
    v_add_f32 v7, v7, v18
    v_mfma_f32_16x16x32_bf16 a[100:103], v[184:187], v[36:39], a[100:103]
    v_add_f32 v7, v7, v19
    v_bfe_u32 v53, v4, 4, 6
    v_mfma_f32_16x16x32_bf16 a[148:151], v[172:175], v[32:35], a[148:151]
    v_exp_f32 v17, v105
    v_mfma_f32_16x16x32_bf16 a[148:151], v[188:191], v[36:39], a[148:151]
    s_waitcnt lgkmcnt(2)
    v_cvt_pk_bf16_f32 v73, v18, v19
    v_fma_f32 v241, v241, v48, v50
    v_mfma_f32_16x16x32_bf16 a[8:11], v[160:163], v[40:43], a[8:11]
    ds_read_b128 v[32:35], v1 offset:4096
    v_lshlrev_b32 v53, 2, v53
    v_mfma_f32_16x16x32_bf16 a[8:11], v[176:179], v[44:47], a[8:11]
    buffer_load_dword v52, v53, s[20:23], s44 offen sc1
    v_mfma_f32_16x16x32_bf16 a[56:59], v[164:167], v[40:43], a[56:59]
    v_exp_f32 v18, v106
    v_mfma_f32_16x16x32_bf16 a[56:59], v[180:183], v[44:47], a[56:59]
    v_add_f32 v7, v7, v16
    v_add_f32 v7, v7, v17
    v_mfma_f32_16x16x32_bf16 a[104:107], v[168:171], v[40:43], a[104:107]
    ds_read_b128 v[36:39], v1 offset:16384
    v_fma_f32 v245, v245, v49, v51
    v_mfma_f32_16x16x32_bf16 a[104:107], v[184:187], v[44:47], a[104:107]
    buffer_load_dwordx4 v4, s[4:7], s27 offen offset:2048 sc1 lds
    v_mfma_f32_16x16x32_bf16 a[152:155], v[172:175], v[40:43], a[152:155]
    v_exp_f32 v19, v107
    v_mfma_f32_16x16x32_bf16 a[152:155], v[188:191], v[44:47], a[152:155]
    s_waitcnt lgkmcnt(2)
    v_cvt_pk_bf16_f32 v74, v16, v17
    v_cvt_f32_i32 v242, v242
    v_mfma_f32_16x16x32_bf16 a[12:15], v[160:163], v[24:27], a[12:15]
    ds_read_b128 v[40:43], v1 offset:5120
    v_cvt_f32_i32 v246, v246
    v_mfma_f32_16x16x32_bf16 a[12:15], v[176:179], v[28:31], a[12:15]
    s_add_u32 s27, s27, 24576
    v_exp_f32 v16, v76
    v_mfma_f32_16x16x32_bf16 a[60:63], v[164:167], v[24:27], a[60:63]
    v_add_f32 v7, v7, v18
    v_add_f32 v7, v7, v19
    v_mfma_f32_16x16x32_bf16 a[60:63], v[180:183], v[28:31], a[60:63]
    v_exp_f32 v17, v77
    v_mfma_f32_16x16x32_bf16 a[108:111], v[168:171], v[24:27], a[108:111]
    ds_read_b128 v[44:47], v1 offset:17408
    v_cvt_pk_bf16_f32 v75, v18, v19
    v_mfma_f32_16x16x32_bf16 a[108:111], v[184:187], v[28:31], a[108:111]
    v_exp_f32 v18, v78
    v_mfma_f32_16x16x32_bf16 a[156:159], v[172:175], v[24:27], a[156:159]
    s_add_u32 s29, s28, 49152
    v_fma_f32 v242, v242, v48, v50
    v_add_f32 v8, v8, v16
    v_mfma_f32_16x16x32_bf16 a[156:159], v[188:191], v[28:31], a[156:159]
    s_waitcnt lgkmcnt(2)
    v_add_f32 v8, v8, v17
    v_fma_f32 v246, v246, v49, v51
    v_mfma_f32_16x16x32_bf16 a[16:19], v[160:163], v[32:35], a[16:19]
    s_sub_u32 s3, s29, 147456
    ds_read_b128 v[24:27], v1 offset:6144
    v_lshlrev_b32 v48, 16, v61
    v_mfma_f32_16x16x32_bf16 a[16:19], v[176:179], v[36:39], a[16:19]
    s_add_u32 s56, s56, 12288
    v_exp_f32 v19, v79
    v_mfma_f32_16x16x32_bf16 a[64:67], v[164:167], v[32:35], a[64:67]
    s_min_u32 s29, s29, s3
    v_cvt_pk_bf16_f32 v76, v16, v17
    v_and_b32 v49, s97, v61
    v_mfma_f32_16x16x32_bf16 a[64:67], v[180:183], v[36:39], a[64:67]
    s_mov_b32 m0, s56
    v_exp_f32 v16, v108
    v_mfma_f32_16x16x32_bf16 a[112:115], v[168:171], v[32:35], a[112:115]
    ds_read_b128 v[28:31], v1 offset:18432
    v_add_f32 v8, v8, v18
    v_mfma_f32_16x16x32_bf16 a[112:115], v[184:187], v[36:39], a[112:115]
    v_add_f32 v8, v8, v19
    v_lshlrev_b32 v50, 16, v63
    v_mfma_f32_16x16x32_bf16 a[160:163], v[172:175], v[32:35], a[160:163]
    v_exp_f32 v17, v109
    v_mfma_f32_16x16x32_bf16 a[160:163], v[188:191], v[36:39], a[160:163]
    s_waitcnt lgkmcnt(2)
    v_cvt_pk_bf16_f32 v77, v18, v19
    v_and_b32 v51, s97, v63
    v_mfma_f32_16x16x32_bf16 a[20:23], v[160:163], v[40:43], a[20:23]
    s_sub_u32 s3, s29, s28
    ds_read_b128 v[32:35], v1 offset:7168
    v_mul_f32_e64 v50, -v50, v48
    v_mfma_f32_16x16x32_bf16 a[20:23], v[176:179], v[44:47], a[20:23]
    v_exp_f32 v18, v110
    v_mfma_f32_16x16x32_bf16 a[68:71], v[164:167], v[40:43], a[68:71]
    v_add_f32 v8, v8, v16
    v_add_f32 v8, v8, v17
    v_mfma_f32_16x16x32_bf16 a[68:71], v[180:183], v[44:47], a[68:71]
    buffer_load_dwordx4 v4, s[4:7], s27 offen offset:0 sc1 lds
    v_mfma_f32_16x16x32_bf16 a[116:119], v[168:171], v[40:43], a[116:119]
    ds_read_b128 v[36:39], v1 offset:19456
    v_mul_f32_e64 v51, -v51, v49
    v_mfma_f32_16x16x32_bf16 a[116:119], v[184:187], v[44:47], a[116:119]
    v_exp_f32 v19, v111
    v_mfma_f32_16x16x32_bf16 a[164:167], v[172:175], v[40:43], a[164:167]
    s_mov_b32 s28, s29
    v_cvt_pk_bf16_f32 v78, v16, v17
    v_add_f32 v8, v8, v18
    v_mfma_f32_16x16x32_bf16 a[164:167], v[188:191], v[44:47], a[164:167]
    s_waitcnt lgkmcnt(2)
    v_add_f32 v8, v8, v19
    v_cvt_pk_bf16_f32 v79, v18, v19
    v_mfma_f32_16x16x32_bf16 a[24:27], v[160:163], v[24:27], a[24:27]
    ds_read_b128 v[40:43], v1 offset:8192
    v_cvt_f32_i32 v248, v248
    v_mfma_f32_16x16x32_bf16 a[24:27], v[176:179], v[28:31], a[24:27]
    v_exp_f32 v16, v80
    v_mfma_f32_16x16x32_bf16 a[72:75], v[164:167], v[24:27], a[72:75]
    v_exp_f32 v17, v81
    v_mfma_f32_16x16x32_bf16 a[72:75], v[180:183], v[28:31], a[72:75]
    buffer_load_dwordx4 v4, s[4:7], s27 offen offset:1024 sc1 lds
    v_mfma_f32_16x16x32_bf16 a[120:123], v[168:171], v[24:27], a[120:123]
    ds_read_b128 v[44:47], v1 offset:20480
    v_cvt_f32_i32 v252, v252
    v_mfma_f32_16x16x32_bf16 a[120:123], v[184:187], v[28:31], a[120:123]
    v_exp_f32 v18, v82
    v_mfma_f32_16x16x32_bf16 a[168:171], v[172:175], v[24:27], a[168:171]
    v_add_f32 v5, v5, v16
    v_fma_f32 v248, v248, v48, v50
    v_mfma_f32_16x16x32_bf16 a[168:171], v[188:191], v[28:31], a[168:171]
    s_waitcnt lgkmcnt(2)
    v_add_f32 v5, v5, v17
    v_fma_f32 v252, v252, v49, v51
    v_mfma_f32_16x16x32_bf16 a[28:31], v[160:163], v[32:35], a[28:31]
    ds_read_b128 v[24:27], v1 offset:9216
    v_cvt_f32_i32 v249, v249
    v_mfma_f32_16x16x32_bf16 a[28:31], v[176:179], v[36:39], a[28:31]
    v_exp_f32 v19, v83
    v_mfma_f32_16x16x32_bf16 a[76:79], v[164:167], v[32:35], a[76:79]
    v_cvt_pk_bf16_f32 v80, v16, v17
    v_cvt_f32_i32 v253, v253
    v_mfma_f32_16x16x32_bf16 a[76:79], v[180:183], v[36:39], a[76:79]
    v_exp_f32 v16, v112
    v_mfma_f32_16x16x32_bf16 a[124:127], v[168:171], v[32:35], a[124:127]
    ds_read_b128 v[28:31], v1 offset:21504
    v_add_f32 v5, v5, v18
    v_mfma_f32_16x16x32_bf16 a[124:127], v[184:187], v[36:39], a[124:127]
    buffer_load_dwordx4 v4, s[4:7], s27 offen offset:2048 sc1 lds
    v_mfma_f32_16x16x32_bf16 a[172:175], v[172:175], v[32:35], a[172:175]
    v_add_f32 v5, v5, v19
    v_fma_f32 v249, v249, v48, v50
    v_mfma_f32_16x16x32_bf16 a[172:175], v[188:191], v[36:39], a[172:175]
    s_waitcnt lgkmcnt(2)
    v_exp_f32 v17, v113
    v_mfma_f32_16x16x32_bf16 a[32:35], v[160:163], v[40:43], a[32:35]
    ds_read_b128 v[32:35], v1 offset:10240
    v_cvt_pk_bf16_f32 v81, v18, v19
    v_mfma_f32_16x16x32_bf16 a[32:35], v[176:179], v[44:47], a[32:35]
    v_exp_f32 v18, v114
    v_mfma_f32_16x16x32_bf16 a[80:83], v[164:167], v[40:43], a[80:83]
    v_add_f32 v5, v5, v16
    v_add_f32 v5, v5, v17
    v_mfma_f32_16x16x32_bf16 a[80:83], v[180:183], v[44:47], a[80:83]
    v_exp_f32 v19, v115
    v_mfma_f32_16x16x32_bf16 a[128:131], v[168:171], v[40:43], a[128:131]
    ds_read_b128 v[36:39], v1 offset:22528
    v_fma_f32 v253, v253, v49, v51
    v_mfma_f32_16x16x32_bf16 a[128:131], v[184:187], v[44:47], a[128:131]
    v_add_u32 v2, s3, v2
    v_cvt_pk_bf16_f32 v82, v16, v17
    v_mfma_f32_16x16x32_bf16 a[176:179], v[172:175], v[40:43], a[176:179]
    v_exp_f32 v16, v84
    v_mfma_f32_16x16x32_bf16 a[176:179], v[188:191], v[44:47], a[176:179]
    s_waitcnt lgkmcnt(2)
    v_cvt_f32_i32 v250, v250
    v_add_f32 v5, v5, v18
    v_mfma_f32_16x16x32_bf16 a[36:39], v[160:163], v[24:27], a[36:39]
    ds_read_b128 v[40:43], v1 offset:11264
    v_add_f32 v5, v5, v19
    v_mfma_f32_16x16x32_bf16 a[36:39], v[176:179], v[28:31], a[36:39]
    v_exp_f32 v17, v85
    v_mfma_f32_16x16x32_bf16 a[84:87], v[164:167], v[24:27], a[84:87]
    v_add_u32 v3, s3, v3
    v_cvt_f32_i32 v254, v254
    v_mfma_f32_16x16x32_bf16 a[84:87], v[180:183], v[28:31], a[84:87]
    s_add_u32 s27, s27, 24576
    v_cvt_pk_bf16_f32 v83, v18, v19
    v_fma_f32 v250, v250, v48, v50
    v_mfma_f32_16x16x32_bf16 a[132:135], v[168:171], v[24:27], a[132:135]
    s_add_u32 s56, s56, 36864
    ds_read_b128 v[44:47], v1 offset:23552
    v_fma_f32 v254, v254, v49, v51
    v_mfma_f32_16x16x32_bf16 a[132:135], v[184:187], v[28:31], a[132:135]
    s_sub_u32 s58, s56, 147456
    v_exp_f32 v18, v86
    v_mfma_f32_16x16x32_bf16 a[180:183], v[172:175], v[24:27], a[180:183]
    v_add_f32 v6, v6, v16
    v_add_f32 v6, v6, v17
    v_mfma_f32_16x16x32_bf16 a[180:183], v[188:191], v[28:31], a[180:183]
    s_waitcnt lgkmcnt(2)
    v_exp_f32 v19, v87
    v_mfma_f32_16x16x32_bf16 a[40:43], v[160:163], v[32:35], a[40:43]
    s_min_u32 s56, s56, s58
    ds_read_b128 v[24:27], v2 offset:0
    v_cvt_pk_bf16_f32 v146, v240, v244
    v_mfma_f32_16x16x32_bf16 a[40:43], v[176:179], v[36:39], a[40:43]
    v_cvt_pk_bf16_f32 v84, v16, v17
    v_cvt_pk_bf16_f32 v150, v241, v245
    v_mfma_f32_16x16x32_bf16 a[88:91], v[164:167], v[32:35], a[88:91]
    v_exp_f32 v16, v116
    v_mfma_f32_16x16x32_bf16 a[88:91], v[180:183], v[36:39], a[88:91]
    v_add_f32 v6, v6, v18
    v_add_f32 v6, v6, v19
    v_mfma_f32_16x16x32_bf16 a[136:139], v[168:171], v[32:35], a[136:139]
    ds_read_b128 v[28:31], v3 offset:0
    v_cvt_pk_bf16_f32 v147, v248, v252
    v_mfma_f32_16x16x32_bf16 a[136:139], v[184:187], v[36:39], a[136:139]
    v_exp_f32 v17, v117
    v_mfma_f32_16x16x32_bf16 a[184:187], v[172:175], v[32:35], a[184:187]
    v_cvt_pk_bf16_f32 v85, v18, v19
    v_cvt_pk_bf16_f32 v151, v249, v253
    v_mfma_f32_16x16x32_bf16 a[184:187], v[188:191], v[36:39], a[184:187]
    s_waitcnt lgkmcnt(2)
    v_exp_f32 v18, v118
    v_mfma_f32_16x16x32_bf16 a[44:47], v[160:163], v[40:43], a[44:47]
    ds_read_b128 v[32:35], v2 offset:6144
    v_add_f32 v6, v6, v16
    v_mfma_f32_16x16x32_bf16 a[44:47], v[176:179], v[44:47], a[44:47]
    v_add_f32 v6, v6, v17
    v_cvt_pk_bf16_f32 v154, v242, v246
    v_mfma_f32_16x16x32_bf16 a[92:95], v[164:167], v[40:43], a[92:95]
    v_exp_f32 v19, v119
    v_mfma_f32_16x16x32_bf16 a[92:95], v[180:183], v[44:47], a[92:95]
    v_cvt_pk_bf16_f32 v155, v250, v254
    v_cvt_pk_bf16_f32 v86, v16, v17
    v_mfma_f32_16x16x32_bf16 a[140:143], v[168:171], v[40:43], a[140:143]
    ds_read_b128 v[36:39], v3 offset:6144
    v_add_f32 v6, v6, v18
    v_mfma_f32_16x16x32_bf16 a[140:143], v[184:187], v[44:47], a[140:143]
    v_add_f32 v6, v6, v19
    v_cvt_pk_bf16_f32 v87, v18, v19
    v_mfma_f32_16x16x32_bf16 a[188:191], v[172:175], v[40:43], a[188:191]
    v_mfma_f32_16x16x32_bf16 a[188:191], v[188:191], v[44:47], a[188:191]
    s_waitcnt lgkmcnt(2)
    v_mfma_f32_16x16x32_bf16 v[160:163], v[24:27], a[192:195], v[128:131]
    ds_read_b128 v[40:43], v2 offset:128
    v_mfma_f32_16x16x32_bf16 v[160:163], v[28:31], a[196:199], v[160:163]
    s_waitcnt vmcnt(4)
    v_subrev_u32 v52, s92, v52
    v_cmp_lt_u32 vcc, 15, v52
    v_mfma_f32_16x16x32_bf16 v[164:167], v[24:27], a[216:219], v[132:135]
    v_exp_f32 v16, v88
    v_mfma_f32_16x16x32_bf16 v[164:167], v[28:31], a[220:223], v[164:167]
    v_exp_f32 v17, v89
    v_mfma_f32_16x16x32_bf16 v[168:171], v[24:27], a[240:243], v[136:139]
    s_and_b32 s59, vcc_lo, 0xff
    ds_read_b128 v[44:47], v3 offset:128
    v_mfma_f32_16x16x32_bf16 v[168:171], v[28:31], a[244:247], v[168:171]
    s_cbranch_scc1 L_pollslow3
L_pollok3:
    v_mfma_f32_16x16x32_bf16 v[172:175], v[24:27], v[200:203], v[140:143]
    s_add_u32 s92, s92, 1
    v_exp_f32 v18, v90
    v_mfma_f32_16x16x32_bf16 v[172:175], v[28:31], v[204:207], v[172:175]
    s_waitcnt lgkmcnt(2)
    v_add_f32 v7, v7, v16
    v_add_f32 v7, v7, v17
    v_mfma_f32_16x16x32_bf16 v[96:99], v[32:35], a[192:195], v[128:131]
    ds_read_b128 v[24:27], v2 offset:6272
    v_mfma_f32_16x16x32_bf16 v[96:99], v[36:39], a[196:199], v[96:99]
    buffer_store_dwordx4 v[144:147], v15, s[4:7], s35 offen offset:0 sc1
    v_mfma_f32_16x16x32_bf16 v[100:103], v[32:35], a[216:219], v[132:135]
    v_exp_f32 v19, v91
    v_mfma_f32_16x16x32_bf16 v[100:103], v[36:39], a[220:223], v[100:103]
    v_cvt_pk_bf16_f32 v88, v16, v17
    v_mfma_f32_16x16x32_bf16 v[104:107], v[32:35], a[240:243], v[136:139]
    ds_read_b128 v[28:31], v3 offset:6272
    v_mfma_f32_16x16x32_bf16 v[104:107], v[36:39], a[244:247], v[104:107]
    v_exp_f32 v16, v120
    v_mfma_f32_16x16x32_bf16 v[108:111], v[32:35], v[200:203], v[140:143]
    v_add_f32 v7, v7, v18
    v_add_f32 v7, v7, v19
    v_mfma_f32_16x16x32_bf16 v[108:111], v[36:39], v[204:207], v[108:111]
    s_waitcnt lgkmcnt(2)
    v_exp_f32 v17, v121
    v_mfma_f32_16x16x32_bf16 v[160:163], v[40:43], a[200:203], v[160:163]
    ds_read_b128 v[32:35], v2 offset:256
    v_cvt_pk_bf16_f32 v89, v18, v19
    v_mfma_f32_16x16x32_bf16 v[160:163], v[44:47], a[204:207], v[160:163]
    buffer_store_dwordx4 v[148:151], v15, s[4:7], s35 offen offset:1024 sc1
    v_mfma_f32_16x16x32_bf16 v[164:167], v[40:43], a[224:227], v[164:167]
    v_exp_f32 v18, v122
    v_mfma_f32_16x16x32_bf16 v[164:167], v[44:47], a[228:231], v[164:167]
L_pg9:
    s_cbranch_execz L_pg13
    v_add_f32 v7, v7, v16
    v_add_f32 v7, v7, v17
    v_mfma_f32_16x16x32_bf16 v[168:171], v[40:43], a[248:251], v[168:171]
    ds_read_b128 v[36:39], v3 offset:256
    v_mfma_f32_16x16x32_bf16 v[168:171], v[44:47], a[252:255], v[168:171]
    v_exp_f32 v19, v123
    v_mfma_f32_16x16x32_bf16 v[172:175], v[40:43], v[208:211], v[172:175]
    v_cvt_pk_bf16_f32 v90, v16, v17
    v_mfma_f32_16x16x32_bf16 v[172:175], v[44:47], v[212:215], v[172:175]
    s_waitcnt lgkmcnt(2)
    v_exp_f32 v16, v92
    v_mfma_f32_16x16x32_bf16 v[96:99], v[24:27], a[200:203], v[96:99]
    ds_read_b128 v[40:43], v2 offset:6400
    v_add_f32 v7, v7, v18
    v_mfma_f32_16x16x32_bf16 v[96:99], v[28:31], a[204:207], v[96:99]
    buffer_store_dwordx4 v[152:155], v15, s[4:7], s35 offen offset:2048 sc1
    v_mfma_f32_16x16x32_bf16 v[100:103], v[24:27], a[224:227], v[100:103]
    v_add_f32 v7, v7, v19
    v_mfma_f32_16x16x32_bf16 v[100:103], v[28:31], a[228:231], v[100:103]
    v_exp_f32 v17, v93
    v_mfma_f32_16x16x32_bf16 v[104:107], v[24:27], a[248:251], v[104:107]
    ds_read_b128 v[44:47], v3 offset:6400
    v_cvt_pk_bf16_f32 v91, v18, v19
    v_mfma_f32_16x16x32_bf16 v[104:107], v[28:31], a[252:255], v[104:107]
    v_exp_f32 v18, v94
    v_mfma_f32_16x16x32_bf16 v[108:111], v[24:27], v[208:211], v[108:111]
    s_add_u32 s29, s30, 49152
    v_add_f32 v8, v8, v16
    v_add_f32 v8, v8, v17
    v_mfma_f32_16x16x32_bf16 v[108:111], v[28:31], v[212:215], v[108:111]
    s_waitcnt lgkmcnt(2)
    v_exp_f32 v19, v95
    v_mfma_f32_16x16x32_bf16 v[160:163], v[32:35], a[208:211], v[160:163]
    s_sub_u32 s3, s29, 147456
    ds_read_b128 v[24:27], v2 offset:12288
    v_cvt_pk_bf16_f32 v92, v16, v17
    v_mfma_f32_16x16x32_bf16 v[160:163], v[36:39], a[212:215], v[160:163]
    s_min_u32 s29, s29, s3
    v_exp_f32 v16, v124
    v_mfma_f32_16x16x32_bf16 v[164:167], v[32:35], a[232:235], v[164:167]
    v_add_f32 v8, v8, v18
    v_add_f32 v8, v8, v19
    v_mfma_f32_16x16x32_bf16 v[164:167], v[36:39], a[236:239], v[164:167]
    v_exp_f32 v17, v125
    v_mfma_f32_16x16x32_bf16 v[168:171], v[32:35], v[192:195], v[168:171]
    ds_read_b128 v[28:31], v3 offset:12288
    v_mfma_f32_16x16x32_bf16 v[168:171], v[36:39], v[196:199], v[168:171]
    v_cvt_pk_bf16_f32 v93, v18, v19
    v_mfma_f32_16x16x32_bf16 v[172:175], v[32:35], v[216:219], v[172:175]
    v_exp_f32 v18, v126
    v_mfma_f32_16x16x32_bf16 v[172:175], v[36:39], v[220:223], v[172:175]
    s_waitcnt lgkmcnt(2)
    v_add_f32 v8, v8, v16
    v_mfma_f32_16x16x32_bf16 v[96:99], v[40:43], a[208:211], v[96:99]
    ds_read_b128 v[32:35], v2 offset:18432
    v_add_f32 v8, v8, v17
    v_mfma_f32_16x16x32_bf16 v[96:99], v[44:47], a[212:215], v[96:99]
    s_mov_b32 m0, s26
    v_exp_f32 v19, v127
    v_mfma_f32_16x16x32_bf16 v[100:103], v[40:43], a[232:235], v[100:103]
    s_sub_u32 s3, s29, s30
    v_mfma_f32_16x16x32_bf16 v[100:103], v[44:47], a[236:239], v[100:103]
    buffer_load_dwordx4 v4, s[4:7], s32 offen offset:0 sc1 lds
    v_mfma_f32_16x16x32_bf16 v[104:107], v[40:43], v[192:195], v[104:107]
    ds_read_b128 v[36:39], v3 offset:18432
    v_cvt_pk_bf16_f32 v94, v16, v17
    v_mfma_f32_16x16x32_bf16 v[104:107], v[44:47], v[196:199], v[104:107]
    v_add_f32 v8, v8, v18
    v_add_f32 v8, v8, v19
    v_mfma_f32_16x16x32_bf16 v[108:111], v[40:43], v[216:219], v[108:111]
    v_cvt_pk_bf16_f32 v95, v18, v19
    v_mfma_f32_16x16x32_bf16 v[108:111], v[44:47], v[220:223], v[108:111]
    s_waitcnt lgkmcnt(2)
    buffer_load_dwordx4 v4, s[4:7], s32 offen offset:1024 sc1 lds
    v_mfma_f32_16x16x32_bf16 v[176:179], v[24:27], a[192:195], v[128:131]
    ds_read_b128 v[40:43], v2 offset:12416
    v_mfma_f32_16x16x32_bf16 v[176:179], v[28:31], a[196:199], v[176:179]
    s_mov_b32 s30, s29
    v_exp_f32 v16, v160
    v_mfma_f32_16x16x32_bf16 v[180:183], v[24:27], a[216:219], v[132:135]
    v_exp_f32 v17, v161
    v_mfma_f32_16x16x32_bf16 v[180:183], v[28:31], a[220:223], v[180:183]
    buffer_load_dwordx4 v4, s[4:7], s32 offen offset:2048 sc1 lds
    v_mfma_f32_16x16x32_bf16 v[184:187], v[24:27], a[240:243], v[136:139]
    s_add_u32 s32, s32, 24576
    ds_read_b128 v[44:47], v3 offset:12416
    v_mfma_f32_16x16x32_bf16 v[184:187], v[28:31], a[244:247], v[184:187]
    v_exp_f32 v18, v162
    v_mfma_f32_16x16x32_bf16 v[188:191], v[24:27], v[200:203], v[140:143]
    s_add_u32 s26, s26, 12288
    v_add_f32 v5, v5, v16
    v_add_f32 v5, v5, v17
    v_mfma_f32_16x16x32_bf16 v[188:191], v[28:31], v[204:207], v[188:191]
    s_waitcnt lgkmcnt(2)
    v_exp_f32 v19, v163
    v_mfma_f32_16x16x32_bf16 v[112:115], v[32:35], a[192:195], v[128:131]
    s_mov_b32 m0, s26
    ds_read_b128 v[24:27], v2 offset:18560
    v_cvt_pk_bf16_f32 v160, v16, v17
    v_mfma_f32_16x16x32_bf16 v[112:115], v[36:39], a[196:199], v[112:115]
    v_exp_f32 v16, v96
    v_mfma_f32_16x16x32_bf16 v[116:119], v[32:35], a[216:219], v[132:135]
    v_add_f32 v5, v5, v18
    v_add_f32 v5, v5, v19
    v_mfma_f32_16x16x32_bf16 v[116:119], v[36:39], a[220:223], v[116:119]
    v_exp_f32 v17, v97
    v_mfma_f32_16x16x32_bf16 v[120:123], v[32:35], a[240:243], v[136:139]
    ds_read_b128 v[28:31], v3 offset:18560
    v_add_u32 v1, s3, v1
    v_mfma_f32_16x16x32_bf16 v[120:123], v[36:39], a[244:247], v[120:123]
    buffer_load_dwordx4 v4, s[4:7], s32 offen offset:0 sc1 lds
    v_mfma_f32_16x16x32_bf16 v[124:127], v[32:35], v[200:203], v[140:143]
    v_cvt_pk_bf16_f32 v161, v18, v19
    v_mfma_f32_16x16x32_bf16 v[124:127], v[36:39], v[204:207], v[124:127]
    s_waitcnt lgkmcnt(2)
    v_exp_f32 v18, v98
    v_mfma_f32_16x16x32_bf16 v[176:179], v[40:43], a[200:203], v[176:179]
    ds_read_b128 v[32:35], v2 offset:12544
    v_add_f32 v5, v5, v16
    v_mfma_f32_16x16x32_bf16 v[176:179], v[44:47], a[204:207], v[176:179]
    buffer_load_dwordx4 v4, s[4:7], s32 offen offset:1024 sc1 lds
    v_mfma_f32_16x16x32_bf16 v[180:183], v[40:43], a[224:227], v[180:183]
    v_add_f32 v5, v5, v17
    v_mfma_f32_16x16x32_bf16 v[180:183], v[44:47], a[228:231], v[180:183]
    v_exp_f32 v19, v99
    v_mfma_f32_16x16x32_bf16 v[184:187], v[40:43], a[248:251], v[184:187]
    ds_read_b128 v[36:39], v3 offset:12544
    v_cvt_pk_bf16_f32 v162, v16, v17
    v_mfma_f32_16x16x32_bf16 v[184:187], v[44:47], a[252:255], v[184:187]
    buffer_load_dwordx4 v4, s[4:7], s32 offen offset:2048 sc1 lds
    v_mfma_f32_16x16x32_bf16 v[188:191], v[40:43], v[208:211], v[188:191]
    v_exp_f32 v16, v164
    v_mfma_f32_16x16x32_bf16 v[188:191], v[44:47], v[212:215], v[188:191]
    s_waitcnt lgkmcnt(2)
    v_add_f32 v5, v5, v18
    v_add_f32 v5, v5, v19
    v_mfma_f32_16x16x32_bf16 v[112:115], v[24:27], a[200:203], v[112:115]
    ds_read_b128 v[40:43], v2 offset:18688
    v_mfma_f32_16x16x32_bf16 v[112:115], v[28:31], a[204:207], v[112:115]
    v_exp_f32 v17, v165
    v_mfma_f32_16x16x32_bf16 v[116:119], v[24:27], a[224:227], v[116:119]
    v_cvt_pk_bf16_f32 v163, v18, v19
    v_mfma_f32_16x16x32_bf16 v[116:119], v[28:31], a[228:231], v[116:119]
    s_add_u32 s32, s32, 24576
    v_exp_f32 v18, v166
    v_mfma_f32_16x16x32_bf16 v[120:123], v[24:27], a[248:251], v[120:123]
    s_add_u32 s26, s26, 36864
    ds_read_b128 v[44:47], v3 offset:18688
    v_add_f32 v6, v6, v16
    v_mfma_f32_16x16x32_bf16 v[120:123], v[28:31], a[252:255], v[120:123]
    s_waitcnt lgkmcnt(2)
    v_add_f32 v6, v6, v17
    s_sub_u32 s57, s26, 147456
    v_mfma_f32_16x16x32_bf16 v[124:127], v[24:27], v[208:211], v[124:127]
    s_waitcnt vmcnt(6)
    v_exp_f32 v19, v167
    v_mfma_f32_16x16x32_bf16 v[124:127], v[28:31], v[212:215], v[124:127]
    s_barrier
    v_cvt_pk_bf16_f32 v164, v16, v17
    v_mfma_f32_16x16x32_bf16 v[176:179], v[32:35], a[208:211], v[176:179]
    s_min_u32 s26, s26, s57
    ds_read_b128 v[24:27], v1 offset:0
    v_add_u32 v0, 1, v0
    v_mfma_f32_16x16x32_bf16 v[176:179], v[36:39], a[212:215], v[176:179]
    buffer_store_dword v0, v13, s[20:23], 0 offen offset:32 sc1
    v_mfma_f32_16x16x32_bf16 v[180:183], v[32:35], a[232:235], v[180:183]
    v_exp_f32 v16, v100
    v_mfma_f32_16x16x32_bf16 v[180:183], v[36:39], a[236:239], v[180:183]
    v_add_f32 v6, v6, v18
    v_add_f32 v6, v6, v19
    v_mfma_f32_16x16x32_bf16 v[184:187], v[32:35], v[192:195], v[184:187]
    ds_read_b128 v[28:31], v1 offset:12288
    v_mfma_f32_16x16x32_bf16 v[184:187], v[36:39], v[196:199], v[184:187]
    v_exp_f32 v17, v101
    v_mfma_f32_16x16x32_bf16 v[188:191], v[32:35], v[216:219], v[188:191]
    v_cvt_pk_bf16_f32 v165, v18, v19
    v_mfma_f32_16x16x32_bf16 v[188:191], v[36:39], v[220:223], v[188:191]
    s_waitcnt lgkmcnt(2)
    v_exp_f32 v18, v102
    v_mfma_f32_16x16x32_bf16 v[112:115], v[40:43], a[208:211], v[112:115]
    ds_read_b128 v[32:35], v1 offset:1024
    v_add_f32 v6, v6, v16
    v_mfma_f32_16x16x32_bf16 v[112:115], v[44:47], a[212:215], v[112:115]
    v_add_f32 v6, v6, v17
    v_mfma_f32_16x16x32_bf16 v[116:119], v[40:43], a[232:235], v[116:119]
    v_exp_f32 v19, v103
    v_mfma_f32_16x16x32_bf16 v[116:119], v[44:47], a[236:239], v[116:119]
    v_cvt_pk_bf16_f32 v166, v16, v17
    v_mfma_f32_16x16x32_bf16 v[120:123], v[40:43], v[192:195], v[120:123]
    ds_read_b128 v[36:39], v1 offset:13312
    v_add_f32 v6, v6, v18
    v_mfma_f32_16x16x32_bf16 v[120:123], v[44:47], v[196:199], v[120:123]
    v_add_f32 v6, v6, v19
    v_cvt_pk_bf16_f32 v167, v18, v19
    v_mfma_f32_16x16x32_bf16 v[124:127], v[40:43], v[216:219], v[124:127]
    v_mfma_f32_16x16x32_bf16 v[124:127], v[44:47], v[220:223], v[124:127]
    s_waitcnt lgkmcnt(2)
    v_mfma_f32_16x16x32_bf16 a[0:3], v[64:67], v[24:27], a[0:3]
    s_mov_b32 m0, s26
    ds_read_b128 v[40:43], v1 offset:2048
    v_mfma_f32_16x16x32_bf16 a[0:3], v[80:83], v[28:31], a[0:3]
    buffer_load_dwordx4 v4, s[4:7], s32 offen offset:0 sc1 lds
    v_mfma_f32_16x16x32_bf16 a[48:51], v[68:71], v[24:27], a[48:51]
    v_exp_f32 v16, v168
    v_mfma_f32_16x16x32_bf16 a[48:51], v[84:87], v[28:31], a[48:51]
    v_exp_f32 v17, v169
    v_mfma_f32_16x16x32_bf16 a[96:99], v[72:75], v[24:27], a[96:99]
    ds_read_b128 v[44:47], v1 offset:14336
    v_mfma_f32_16x16x32_bf16 a[96:99], v[88:91], v[28:31], a[96:99]
    v_exp_f32 v18, v170
    v_mfma_f32_16x16x32_bf16 a[144:147], v[76:79], v[24:27], a[144:147]
    v_add_f32 v7, v7, v16
    v_add_f32 v7, v7, v17
    v_mfma_f32_16x16x32_bf16 a[144:147], v[92:95], v[28:31], a[144:147]
    s_waitcnt lgkmcnt(2)
    v_exp_f32 v19, v171
    v_mfma_f32_16x16x32_bf16 a[4:7], v[64:67], v[32:35], a[4:7]
    ds_read_b128 v[24:27], v1 offset:3072
    v_cvt_pk_bf16_f32 v168, v16, v17
    v_mfma_f32_16x16x32_bf16 a[4:7], v[80:83], v[36:39], a[4:7]
    v_exp_f32 v16, v104
    v_mfma_f32_16x16x32_bf16 a[52:55], v[68:71], v[32:35], a[52:55]
    v_add_f32 v7, v7, v18
    v_add_f32 v7, v7, v19
    v_mfma_f32_16x16x32_bf16 a[52:55], v[84:87], v[36:39], a[52:55]
    buffer_load_dwordx4 v4, s[4:7], s32 offen offset:1024 sc1 lds
    v_mfma_f32_16x16x32_bf16 a[100:103], v[72:75], v[32:35], a[100:103]
    ds_read_b128 v[28:31], v1 offset:15360
    v_mfma_f32_16x16x32_bf16 a[100:103], v[88:91], v[36:39], a[100:103]
    v_exp_f32 v17, v105
    v_mfma_f32_16x16x32_bf16 a[148:151], v[76:79], v[32:35], a[148:151]
    v_cvt_pk_bf16_f32 v169, v18, v19
    v_mfma_f32_16x16x32_bf16 a[148:151], v[92:95], v[36:39], a[148:151]
    s_waitcnt lgkmcnt(2)
    v_exp_f32 v18, v106
    v_mfma_f32_16x16x32_bf16 a[8:11], v[64:67], v[40:43], a[8:11]
    ds_read_b128 v[32:35], v1 offset:4096
    v_add_f32 v7, v7, v16
    v_mfma_f32_16x16x32_bf16 a[8:11], v[80:83], v[44:47], a[8:11]
    v_add_f32 v7, v7, v17
    v_mfma_f32_16x16x32_bf16 a[56:59], v[68:71], v[40:43], a[56:59]
    v_exp_f32 v19, v107
    v_mfma_f32_16x16x32_bf16 a[56:59], v[84:87], v[44:47], a[56:59]
    v_cvt_pk_bf16_f32 v170, v16, v17
    v_mfma_f32_16x16x32_bf16 a[104:107], v[72:75], v[40:43], a[104:107]
    ds_read_b128 v[36:39], v1 offset:16384
    v_mfma_f32_16x16x32_bf16 a[104:107], v[88:91], v[44:47], a[104:107]
    v_exp_f32 v16, v172
    v_mfma_f32_16x16x32_bf16 a[152:155], v[76:79], v[40:43], a[152:155]
    v_add_f32 v7, v7, v18
    v_add_f32 v7, v7, v19
    v_mfma_f32_16x16x32_bf16 a[152:155], v[92:95], v[44:47], a[152:155]
    s_waitcnt lgkmcnt(2)
    buffer_load_dwordx4 v4, s[4:7], s32 offen offset:2048 sc1 lds
    v_mfma_f32_16x16x32_bf16 a[12:15], v[64:67], v[24:27], a[12:15]
    ds_read_b128 v[40:43], v1 offset:5120
    v_mfma_f32_16x16x32_bf16 a[12:15], v[80:83], v[28:31], a[12:15]
    v_exp_f32 v17, v173
    v_mfma_f32_16x16x32_bf16 a[60:63], v[68:71], v[24:27], a[60:63]
    v_cvt_pk_bf16_f32 v171, v18, v19
    v_mfma_f32_16x16x32_bf16 a[60:63], v[84:87], v[28:31], a[60:63]
    v_exp_f32 v18, v174
    v_mfma_f32_16x16x32_bf16 a[108:111], v[72:75], v[24:27], a[108:111]
    ds_read_b128 v[44:47], v1 offset:17408
    v_add_f32 v8, v8, v16
    v_mfma_f32_16x16x32_bf16 a[108:111], v[88:91], v[28:31], a[108:111]
    v_add_f32 v8, v8, v17
    v_mfma_f32_16x16x32_bf16 a[156:159], v[76:79], v[24:27], a[156:159]
    s_add_u32 s29, s28, 49152
    v_exp_f32 v19, v175
    v_mfma_f32_16x16x32_bf16 a[156:159], v[92:95], v[28:31], a[156:159]
    s_waitcnt lgkmcnt(2)
    v_cvt_pk_bf16_f32 v172, v16, v17
    s_sub_u32 s3, s29, 147456
    v_mfma_f32_16x16x32_bf16 a[16:19], v[64:67], v[32:35], a[16:19]
    s_add_u32 s32, s32, 24576
    ds_read_b128 v[24:27], v1 offset:6144
    v_mfma_f32_16x16x32_bf16 a[16:19], v[80:83], v[36:39], a[16:19]
    s_min_u32 s29, s29, s3
    v_exp_f32 v16, v108
    v_mfma_f32_16x16x32_bf16 a[64:67], v[68:71], v[32:35], a[64:67]
    v_add_f32 v8, v8, v18
    v_add_f32 v8, v8, v19
    v_mfma_f32_16x16x32_bf16 a[64:67], v[84:87], v[36:39], a[64:67]
    v_exp_f32 v17, v109
    v_mfma_f32_16x16x32_bf16 a[112:115], v[72:75], v[32:35], a[112:115]
    s_add_u32 s26, s26, 12288
    ds_read_b128 v[28:31], v1 offset:18432
    v_mfma_f32_16x16x32_bf16 a[112:115], v[88:91], v[36:39], a[112:115]
    v_cvt_pk_bf16_f32 v173, v18, v19
    v_mfma_f32_16x16x32_bf16 a[160:163], v[76:79], v[32:35], a[160:163]
    v_exp_f32 v18, v110
    v_mfma_f32_16x16x32_bf16 a[160:163], v[92:95], v[36:39], a[160:163]
    s_waitcnt lgkmcnt(2)
    v_add_f32 v8, v8, v16
    v_mfma_f32_16x16x32_bf16 a[20:23], v[64:67], v[40:43], a[20:23]
    s_sub_u32 s3, s29, s28
    ds_read_b128 v[32:35], v1 offset:7168
    v_add_f32 v8, v8, v17
    v_mfma_f32_16x16x32_bf16 a[20:23], v[80:83], v[44:47], a[20:23]
    v_exp_f32 v19, v111
    v_mfma_f32_16x16x32_bf16 a[68:71], v[68:71], v[40:43], a[68:71]
    s_mov_b32 m0, s26
    v_mfma_f32_16x16x32_bf16 a[68:71], v[84:87], v[44:47], a[68:71]
    v_cvt_pk_bf16_f32 v174, v16, v17
    v_mfma_f32_16x16x32_bf16 a[116:119], v[72:75], v[40:43], a[116:119]
    ds_read_b128 v[36:39], v1 offset:19456
    v_add_f32 v8, v8, v18
    v_mfma_f32_16x16x32_bf16 a[116:119], v[88:91], v[44:47], a[116:119]
    v_add_f32 v8, v8, v19
    v_cvt_pk_bf16_f32 v175, v18, v19
    v_mfma_f32_16x16x32_bf16 a[164:167], v[76:79], v[40:43], a[164:167]
    s_mov_b32 s28, s29
    v_mfma_f32_16x16x32_bf16 a[164:167], v[92:95], v[44:47], a[164:167]
    s_waitcnt lgkmcnt(2)
    v_exp_f32 v16, v176
    v_mfma_f32_16x16x32_bf16 a[24:27], v[64:67], v[24:27], a[24:27]
    ds_read_b128 v[40:43], v1 offset:8192
    v_mfma_f32_16x16x32_bf16 a[24:27], v[80:83], v[28:31], a[24:27]
    v_exp_f32 v17, v177
    v_mfma_f32_16x16x32_bf16 a[72:75], v[68:71], v[24:27], a[72:75]
    v_exp_f32 v18, v178
    v_mfma_f32_16x16x32_bf16 a[72:75], v[84:87], v[28:31], a[72:75]
    buffer_load_dwordx4 v4, s[4:7], s32 offen offset:0 sc1 lds
    v_mfma_f32_16x16x32_bf16 a[120:123], v[72:75], v[24:27], a[120:123]
    ds_read_b128 v[44:47], v1 offset:20480
    v_add_f32 v5, v5, v16
    v_mfma_f32_16x16x32_bf16 a[120:123], v[88:91], v[28:31], a[120:123]
    v_add_f32 v5, v5, v17
    v_add_u32 v2, s3, v2
    v_mfma_f32_16x16x32_bf16 a[168:171], v[76:79], v[24:27], a[168:171]
    v_exp_f32 v19, v179
    v_mfma_f32_16x16x32_bf16 a[168:171], v[92:95], v[28:31], a[168:171]
    s_waitcnt lgkmcnt(2)
    v_cvt_pk_bf16_f32 v176, v16, v17
    v_mfma_f32_16x16x32_bf16 a[28:31], v[64:67], v[32:35], a[28:31]
    ds_read_b128 v[24:27], v1 offset:9216
    v_mfma_f32_16x16x32_bf16 a[28:31], v[80:83], v[36:39], a[28:31]
    v_exp_f32 v16, v112
    v_mfma_f32_16x16x32_bf16 a[76:79], v[68:71], v[32:35], a[76:79]
    v_add_f32 v5, v5, v18
    v_add_f32 v5, v5, v19
    v_mfma_f32_16x16x32_bf16 a[76:79], v[84:87], v[36:39], a[76:79]
    v_exp_f32 v17, v113
    v_mfma_f32_16x16x32_bf16 a[124:127], v[72:75], v[32:35], a[124:127]
    ds_read_b128 v[28:31], v1 offset:21504
    v_add_u32 v3, s3, v3
    v_mfma_f32_16x16x32_bf16 a[124:127], v[88:91], v[36:39], a[124:127]
    v_cvt_pk_bf16_f32 v177, v18, v19
    v_mfma_f32_16x16x32_bf16 a[172:175], v[76:79], v[32:35], a[172:175]
    v_exp_f32 v18, v114
    v_mfma_f32_16x16x32_bf16 a[172:175], v[92:95], v[36:39], a[172:175]
    s_waitcnt lgkmcnt(2)
    buffer_load_dwordx4 v4, s[4:7], s32 offen offset:1024 sc1 lds
    v_mfma_f32_16x16x32_bf16 a[32:35], v[64:67], v[40:43], a[32:35]
    ds_read_b128 v[32:35], v1 offset:10240
    v_add_f32 v5, v5, v16
    v_mfma_f32_16x16x32_bf16 a[32:35], v[80:83], v[44:47], a[32:35]
    v_add_f32 v5, v5, v17
    v_mfma_f32_16x16x32_bf16 a[80:83], v[68:71], v[40:43], a[80:83]
    v_exp_f32 v19, v115
    v_mfma_f32_16x16x32_bf16 a[80:83], v[84:87], v[44:47], a[80:83]
    v_cvt_pk_bf16_f32 v178, v16, v17
    v_mfma_f32_16x16x32_bf16 a[128:131], v[72:75], v[40:43], a[128:131]
    ds_read_b128 v[36:39], v1 offset:22528
    v_mfma_f32_16x16x32_bf16 a[128:131], v[88:91], v[44:47], a[128:131]
    v_exp_f32 v16, v180
    v_mfma_f32_16x16x32_bf16 a[176:179], v[76:79], v[40:43], a[176:179]
    v_add_f32 v5, v5, v18
    v_add_f32 v5, v5, v19
    v_mfma_f32_16x16x32_bf16 a[176:179], v[92:95], v[44:47], a[176:179]
    s_waitcnt lgkmcnt(2)
    v_exp_f32 v17, v181
    v_mfma_f32_16x16x32_bf16 a[36:39], v[64:67], v[24:27], a[36:39]
    ds_read_b128 v[40:43], v1 offset:11264
    v_mfma_f32_16x16x32_bf16 a[36:39], v[80:83], v[28:31], a[36:39]
    buffer_load_dwordx4 v4, s[4:7], s32 offen offset:2048 sc1 lds
    v_mfma_f32_16x16x32_bf16 a[84:87], v[68:71], v[24:27], a[84:87]
    v_cvt_pk_bf16_f32 v179, v18, v19
    v_mfma_f32_16x16x32_bf16 a[84:87], v[84:87], v[28:31], a[84:87]
    v_exp_f32 v18, v182
    v_mfma_f32_16x16x32_bf16 a[132:135], v[72:75], v[24:27], a[132:135]
    ds_read_b128 v[44:47], v1 offset:23552
    v_add_f32 v6, v6, v16
    v_mfma_f32_16x16x32_bf16 a[132:135], v[88:91], v[28:31], a[132:135]
    s_waitcnt lgkmcnt(2)
    v_add_f32 v6, v6, v17
    v_mfma_f32_16x16x32_bf16 a[180:183], v[76:79], v[24:27], a[180:183]
    s_waitcnt vmcnt(7)
    v_exp_f32 v19, v183
    v_mfma_f32_16x16x32_bf16 a[180:183], v[92:95], v[28:31], a[180:183]
    s_barrier
    v_cvt_pk_bf16_f32 v180, v16, v17
    v_mfma_f32_16x16x32_bf16 a[40:43], v[64:67], v[32:35], a[40:43]
    ds_read_b128 v[24:27], v2 offset:0
    v_mfma_f32_16x16x32_bf16 a[40:43], v[80:83], v[36:39], a[40:43]
    v_exp_f32 v16, v116
    v_mfma_f32_16x16x32_bf16 a[88:91], v[68:71], v[32:35], a[88:91]
    v_add_f32 v6, v6, v18
    v_add_f32 v6, v6, v19
    v_mfma_f32_16x16x32_bf16 a[88:91], v[84:87], v[36:39], a[88:91]
    v_exp_f32 v17, v117
    v_mfma_f32_16x16x32_bf16 a[136:139], v[72:75], v[32:35], a[136:139]
    ds_read_b128 v[28:31], v3 offset:0
    v_mfma_f32_16x16x32_bf16 a[136:139], v[88:91], v[36:39], a[136:139]
    v_cvt_pk_bf16_f32 v181, v18, v19
    v_mfma_f32_16x16x32_bf16 a[184:187], v[76:79], v[32:35], a[184:187]
    v_exp_f32 v18, v118
    v_mfma_f32_16x16x32_bf16 a[184:187], v[92:95], v[36:39], a[184:187]
    s_waitcnt lgkmcnt(2)
    v_add_f32 v6, v6, v16
    v_mfma_f32_16x16x32_bf16 a[44:47], v[64:67], v[40:43], a[44:47]
    ds_read_b128 v[32:35], v2 offset:6144
    v_add_f32 v6, v6, v17
    v_mfma_f32_16x16x32_bf16 a[44:47], v[80:83], v[44:47], a[44:47]
    v_exp_f32 v19, v119
    v_mfma_f32_16x16x32_bf16 a[92:95], v[68:71], v[40:43], a[92:95]
    v_mfma_f32_16x16x32_bf16 a[92:95], v[84:87], v[44:47], a[92:95]
    s_add_u32 s32, s32, 24576
    s_add_u32 s26, s26, 36864
    v_cvt_pk_bf16_f32 v182, v16, v17
    v_mfma_f32_16x16x32_bf16 a[140:143], v[72:75], v[40:43], a[140:143]
    s_sub_u32 s57, s26, 147456
    ds_read_b128 v[36:39], v3 offset:6144
    v_add_f32 v6, v6, v18
    v_mfma_f32_16x16x32_bf16 a[140:143], v[88:91], v[44:47], a[140:143]
    s_min_u32 s26, s26, s57
    v_add_f32 v6, v6, v19
    v_cvt_pk_bf16_f32 v183, v18, v19
    v_mfma_f32_16x16x32_bf16 a[188:191], v[76:79], v[40:43], a[188:191]
    v_mfma_f32_16x16x32_bf16 a[188:191], v[92:95], v[44:47], a[188:191]
    s_waitcnt lgkmcnt(2)
    v_mfma_f32_16x16x32_bf16 v[64:67], v[24:27], a[192:195], v[128:131]
    ds_read_b128 v[40:43], v2 offset:128
    v_mfma_f32_16x16x32_bf16 v[64:67], v[28:31], a[196:199], v[64:67]
    v_exp_f32 v16, v184
    v_mfma_f32_16x16x32_bf16 v[68:71], v[24:27], a[216:219], v[132:135]
    v_exp_f32 v17, v185
    v_mfma_f32_16x16x32_bf16 v[68:71], v[28:31], a[220:223], v[68:71]
    v_bfe_u32 v53, v4, 4, 6
    v_mfma_f32_16x16x32_bf16 v[72:75], v[24:27], a[240:243], v[136:139]
    ds_read_b128 v[44:47], v3 offset:128
    v_lshlrev_b32 v53, 2, v53
    v_mfma_f32_16x16x32_bf16 v[72:75], v[28:31], a[244:247], v[72:75]
    buffer_load_dword v52, v53, s[20:23], s44 offen sc1
    v_mfma_f32_16x16x32_bf16 v[76:79], v[24:27], v[200:203], v[140:143]
    v_exp_f32 v18, v186
    v_mfma_f32_16x16x32_bf16 v[76:79], v[28:31], v[204:207], v[76:79]
    s_waitcnt lgkmcnt(2)
    v_add_f32 v7, v7, v16
    v_add_f32 v7, v7, v17
    v_mfma_f32_16x16x32_bf16 v[96:99], v[32:35], a[192:195], v[128:131]
    ds_read_b128 v[24:27], v2 offset:6272
    v_mfma_f32_16x16x32_bf16 v[96:99], v[36:39], a[196:199], v[96:99]
    v_exp_f32 v19, v187
    v_mfma_f32_16x16x32_bf16 v[100:103], v[32:35], a[216:219], v[132:135]
    v_cvt_pk_bf16_f32 v184, v16, v17
    v_mfma_f32_16x16x32_bf16 v[100:103], v[36:39], a[220:223], v[100:103]
    s_mov_b32 m0, s26
    v_exp_f32 v16, v120
    v_mfma_f32_16x16x32_bf16 v[104:107], v[32:35], a[240:243], v[136:139]
    ds_read_b128 v[28:31], v3 offset:6272
    v_add_f32 v7, v7, v18
    v_mfma_f32_16x16x32_bf16 v[104:107], v[36:39], a[244:247], v[104:107]
    buffer_load_dwordx4 v4, s[4:7], s32 offen offset:0 sc1 lds
    v_mfma_f32_16x16x32_bf16 v[108:111], v[32:35], v[200:203], v[140:143]
    v_add_f32 v7, v7, v19
    v_mfma_f32_16x16x32_bf16 v[108:111], v[36:39], v[204:207], v[108:111]
    s_waitcnt lgkmcnt(2)
    v_exp_f32 v17, v121
    v_mfma_f32_16x16x32_bf16 v[64:67], v[40:43], a[200:203], v[64:67]
    ds_read_b128 v[32:35], v2 offset:256
    v_cvt_pk_bf16_f32 v185, v18, v19
    v_mfma_f32_16x16x32_bf16 v[64:67], v[44:47], a[204:207], v[64:67]
    v_exp_f32 v18, v122
    v_mfma_f32_16x16x32_bf16 v[68:71], v[40:43], a[224:227], v[68:71]
    v_add_f32 v7, v7, v16
    v_add_f32 v7, v7, v17
    v_mfma_f32_16x16x32_bf16 v[68:71], v[44:47], a[228:231], v[68:71]
    v_exp_f32 v19, v123
    v_mfma_f32_16x16x32_bf16 v[72:75], v[40:43], a[248:251], v[72:75]
    ds_read_b128 v[36:39], v3 offset:256
    v_cvt_pk_bf16_f32 v186, v16, v17
    v_mfma_f32_16x16x32_bf16 v[72:75], v[44:47], a[252:255], v[72:75]
    buffer_load_dwordx4 v4, s[4:7], s32 offen offset:1024 sc1 lds
    v_mfma_f32_16x16x32_bf16 v[76:79], v[40:43], v[208:211], v[76:79]
    v_exp_f32 v16, v188
    v_mfma_f32_16x16x32_bf16 v[76:79], v[44:47], v[212:215], v[76:79]
    s_waitcnt lgkmcnt(2)
    v_add_f32 v7, v7, v18
    v_add_f32 v7, v7, v19
    v_mfma_f32_16x16x32_bf16 v[96:99], v[24:27], a[200:203], v[96:99]
    ds_read_b128 v[40:43], v2 offset:6400
    v_mfma_f32_16x16x32_bf16 v[96:99], v[28:31], a[204:207], v[96:99]
    v_exp_f32 v17, v189
    v_mfma_f32_16x16x32_bf16 v[100:103], v[24:27], a[224:227], v[100:103]
    v_cvt_pk_bf16_f32 v187, v18, v19
    v_mfma_f32_16x16x32_bf16 v[100:103], v[28:31], a[228:231], v[100:103]
    v_exp_f32 v18, v190
    v_mfma_f32_16x16x32_bf16 v[104:107], v[24:27], a[248:251], v[104:107]
    ds_read_b128 v[44:47], v3 offset:6400
    v_add_f32 v8, v8, v16
    v_mfma_f32_16x16x32_bf16 v[104:107], v[28:31], a[252:255], v[104:107]
    v_add_f32 v8, v8, v17
    v_mfma_f32_16x16x32_bf16 v[108:111], v[24:27], v[208:211], v[108:111]
    s_add_u32 s29, s30, 49152
    v_exp_f32 v19, v191
    v_mfma_f32_16x16x32_bf16 v[108:111], v[28:31], v[212:215], v[108:111]
    s_waitcnt lgkmcnt(2)
    buffer_load_dwordx4 v4, s[4:7], s32 offen offset:2048 sc1 lds
    v_mfma_f32_16x16x32_bf16 v[64:67], v[32:35], a[208:211], v[64:67]
    s_sub_u32 s3, s29, 147456
    ds_read_b128 v[24:27], v2 offset:12288
    v_cvt_pk_bf16_f32 v188, v16, v17
    v_mfma_f32_16x16x32_bf16 v[64:67], v[36:39], a[212:215], v[64:67]
    s_min_u32 s29, s29, s3
    v_exp_f32 v16, v124
    v_mfma_f32_16x16x32_bf16 v[68:71], v[32:35], a[232:235], v[68:71]
    v_add_f32 v8, v8, v18
    v_add_f32 v8, v8, v19
    v_mfma_f32_16x16x32_bf16 v[68:71], v[36:39], a[236:239], v[68:71]
    v_exp_f32 v17, v125
    v_mfma_f32_16x16x32_bf16 v[72:75], v[32:35], v[192:195], v[72:75]
    ds_read_b128 v[28:31], v3 offset:12288
    v_mfma_f32_16x16x32_bf16 v[72:75], v[36:39], v[196:199], v[72:75]
    v_cvt_pk_bf16_f32 v189, v18, v19
    v_mfma_f32_16x16x32_bf16 v[76:79], v[32:35], v[216:219], v[76:79]
    v_exp_f32 v18, v126
    v_mfma_f32_16x16x32_bf16 v[76:79], v[36:39], v[220:223], v[76:79]
    s_waitcnt lgkmcnt(2)
    v_add_f32 v8, v8, v16
    s_add_u32 s32, s32, 24576
    v_mfma_f32_16x16x32_bf16 v[96:99], v[40:43], a[208:211], v[96:99]
    ds_read_b128 v[32:35], v2 offset:18432
    v_add_f32 v8, v8, v17
    v_mfma_f32_16x16x32_bf16 v[96:99], v[44:47], a[212:215], v[96:99]
    s_sub_u32 s3, s29, s30
    v_exp_f32 v19, v127
    v_mfma_f32_16x16x32_bf16 v[100:103], v[40:43], a[232:235], v[100:103]
    v_mfma_f32_16x16x32_bf16 v[100:103], v[44:47], a[236:239], v[100:103]
    v_cvt_pk_bf16_f32 v190, v16, v17
    v_mfma_f32_16x16x32_bf16 v[104:107], v[40:43], v[192:195], v[104:107]
    s_add_u32 s26, s26, 12288
    ds_read_b128 v[36:39], v3 offset:18432
    v_add_f32 v8, v8, v18
    v_mfma_f32_16x16x32_bf16 v[104:107], v[44:47], v[196:199], v[104:107]
    v_add_f32 v8, v8, v19
    v_cvt_pk_bf16_f32 v191, v18, v19
    v_mfma_f32_16x16x32_bf16 v[108:111], v[40:43], v[216:219], v[108:111]
    v_mfma_f32_16x16x32_bf16 v[108:111], v[44:47], v[220:223], v[108:111]
    s_waitcnt lgkmcnt(2)
    v_exp_f32 v16, v64
    v_mfma_f32_16x16x32_bf16 v[80:83], v[24:27], a[192:195], v[128:131]
    ds_read_b128 v[40:43], v2 offset:12416
    v_mfma_f32_16x16x32_bf16 v[80:83], v[28:31], a[196:199], v[80:83]
    s_mov_b32 m0, s26
    v_exp_f32 v17, v65
    v_mfma_f32_16x16x32_bf16 v[84:87], v[24:27], a[216:219], v[132:135]
    s_mov_b32 s30, s29
    v_exp_f32 v18, v66
    v_mfma_f32_16x16x32_bf16 v[84:87], v[28:31], a[220:223], v[84:87]
    v_add_f32 v5, v5, v16
    v_mfma_f32_16x16x32_bf16 v[88:91], v[24:27], a[240:243], v[136:139]
    ds_read_b128 v[44:47], v3 offset:12416
    v_add_f32 v5, v5, v17
    v_mfma_f32_16x16x32_bf16 v[88:91], v[28:31], a[244:247], v[88:91]
    v_exp_f32 v19, v67
    v_mfma_f32_16x16x32_bf16 v[92:95], v[24:27], v[200:203], v[140:143]
    v_mfma_f32_16x16x32_bf16 v[92:95], v[28:31], v[204:207], v[92:95]
    s_waitcnt lgkmcnt(2)
    v_cvt_pk_bf16_f32 v64, v16, v17
    v_mfma_f32_16x16x32_bf16 v[112:115], v[32:35], a[192:195], v[128:131]
    ds_read_b128 v[24:27], v2 offset:18560
    v_mfma_f32_16x16x32_bf16 v[112:115], v[36:39], a[196:199], v[112:115]
    buffer_load_dwordx4 v4, s[4:7], s32 offen offset:0 sc1 lds
    v_mfma_f32_16x16x32_bf16 v[116:119], v[32:35], a[216:219], v[132:135]
    v_exp_f32 v16, v96
    v_mfma_f32_16x16x32_bf16 v[116:119], v[36:39], a[220:223], v[116:119]
    v_add_f32 v5, v5, v18
    v_add_f32 v5, v5, v19
    v_mfma_f32_16x16x32_bf16 v[120:123], v[32:35], a[240:243], v[136:139]
    ds_read_b128 v[28:31], v3 offset:18560
    v_add_u32 v1, s3, v1
    v_mfma_f32_16x16x32_bf16 v[120:123], v[36:39], a[244:247], v[120:123]
    v_exp_f32 v17, v97
    v_mfma_f32_16x16x32_bf16 v[124:127], v[32:35], v[200:203], v[140:143]
    v_cvt_pk_bf16_f32 v65, v18, v19
    v_mfma_f32_16x16x32_bf16 v[124:127], v[36:39], v[204:207], v[124:127]
    s_waitcnt lgkmcnt(2)
    v_exp_f32 v18, v98
    v_mfma_f32_16x16x32_bf16 v[80:83], v[40:43], a[200:203], v[80:83]
    ds_read_b128 v[32:35], v2 offset:12544
    v_add_f32 v5, v5, v16
    v_mfma_f32_16x16x32_bf16 v[80:83], v[44:47], a[204:207], v[80:83]
    v_add_f32 v5, v5, v17
    v_mfma_f32_16x16x32_bf16 v[84:87], v[40:43], a[224:227], v[84:87]
    v_exp_f32 v19, v99
    v_mfma_f32_16x16x32_bf16 v[84:87], v[44:47], a[228:231], v[84:87]
    buffer_load_dwordx4 v4, s[4:7], s32 offen offset:1024 sc1 lds
    v_mfma_f32_16x16x32_bf16 v[88:91], v[40:43], a[248:251], v[88:91]
    ds_read_b128 v[36:39], v3 offset:12544
    v_cvt_pk_bf16_f32 v66, v16, v17
    v_mfma_f32_16x16x32_bf16 v[88:91], v[44:47], a[252:255], v[88:91]
    v_exp_f32 v16, v68
    v_mfma_f32_16x16x32_bf16 v[92:95], v[40:43], v[208:211], v[92:95]
    v_add_f32 v5, v5, v18
    v_add_f32 v5, v5, v19
    v_mfma_f32_16x16x32_bf16 v[92:95], v[44:47], v[212:215], v[92:95]
    s_waitcnt lgkmcnt(2)
    v_exp_f32 v17, v69
    v_mfma_f32_16x16x32_bf16 v[112:115], v[24:27], a[200:203], v[112:115]
    ds_read_b128 v[40:43], v2 offset:18688
    v_mfma_f32_16x16x32_bf16 v[112:115], v[28:31], a[204:207], v[112:115]
    v_cvt_pk_bf16_f32 v67, v18, v19
    v_mfma_f32_16x16x32_bf16 v[116:119], v[24:27], a[224:227], v[116:119]
    v_exp_f32 v18, v70
    v_mfma_f32_16x16x32_bf16 v[116:119], v[28:31], a[228:231], v[116:119]
    v_add_f32 v6, v6, v16
    v_mfma_f32_16x16x32_bf16 v[120:123], v[24:27], a[248:251], v[120:123]
    ds_read_b128 v[44:47], v3 offset:18688
    v_add_f32 v6, v6, v17
    v_mfma_f32_16x16x32_bf16 v[120:123], v[28:31], a[252:255], v[120:123]
    s_waitcnt lgkmcnt(2)
    buffer_load_dwordx4 v4, s[4:7], s32 offen offset:2048 sc1 lds
    v_mfma_f32_16x16x32_bf16 v[124:127], v[24:27], v[208:211], v[124:127]
    s_waitcnt vmcnt(7)
    v_exp_f32 v19, v71
    v_mfma_f32_16x16x32_bf16 v[124:127], v[28:31], v[212:215], v[124:127]
L_pg10:
    s_cbranch_execz L_iwret
    s_barrier
    v_cvt_pk_bf16_f32 v68, v16, v17
    v_mfma_f32_16x16x32_bf16 v[80:83], v[32:35], a[208:211], v[80:83]
    ds_read_b128 v[24:27], v1 offset:0
    v_mfma_f32_16x16x32_bf16 v[80:83], v[36:39], a[212:215], v[80:83]
    v_exp_f32 v16, v100
    v_mfma_f32_16x16x32_bf16 v[84:87], v[32:35], a[232:235], v[84:87]
    v_add_f32 v6, v6, v18
    v_add_f32 v6, v6, v19
    v_mfma_f32_16x16x32_bf16 v[84:87], v[36:39], a[236:239], v[84:87]
    v_exp_f32 v17, v101
    v_mfma_f32_16x16x32_bf16 v[88:91], v[32:35], v[192:195], v[88:91]
    ds_read_b128 v[28:31], v1 offset:12288
    v_mfma_f32_16x16x32_bf16 v[88:91], v[36:39], v[196:199], v[88:91]
    v_cvt_pk_bf16_f32 v69, v18, v19
    v_mfma_f32_16x16x32_bf16 v[92:95], v[32:35], v[216:219], v[92:95]
    v_exp_f32 v18, v102
    v_mfma_f32_16x16x32_bf16 v[92:95], v[36:39], v[220:223], v[92:95]
    s_waitcnt lgkmcnt(2)
    v_add_f32 v6, v6, v16
    v_mfma_f32_16x16x32_bf16 v[112:115], v[40:43], a[208:211], v[112:115]
    ds_read_b128 v[32:35], v1 offset:1024
    v_add_f32 v6, v6, v17
    v_mfma_f32_16x16x32_bf16 v[112:115], v[44:47], a[212:215], v[112:115]
    v_exp_f32 v19, v103
    v_mfma_f32_16x16x32_bf16 v[116:119], v[40:43], a[232:235], v[116:119]
    v_mfma_f32_16x16x32_bf16 v[116:119], v[44:47], a[236:239], v[116:119]
    v_cvt_pk_bf16_f32 v70, v16, v17
    v_mfma_f32_16x16x32_bf16 v[120:123], v[40:43], v[192:195], v[120:123]
    ds_read_b128 v[36:39], v1 offset:13312
    v_add_f32 v6, v6, v18
    v_mfma_f32_16x16x32_bf16 v[120:123], v[44:47], v[196:199], v[120:123]
    s_add_u32 s32, s32, 24576
    s_add_u32 s26, s26, 36864
    v_add_f32 v6, v6, v19
    v_mfma_f32_16x16x32_bf16 v[124:127], v[40:43], v[216:219], v[124:127]
    s_sub_u32 s57, s26, 147456
    v_cvt_pk_bf16_f32 v71, v18, v19
    s_min_u32 s26, s26, s57
    v_mfma_f32_16x16x32_bf16 v[124:127], v[44:47], v[220:223], v[124:127]
    s_waitcnt lgkmcnt(2)
    v_mfma_f32_16x16x32_bf16 a[0:3], v[160:163], v[24:27], a[0:3]
    ds_read_b128 v[40:43], v1 offset:2048
    v_mfma_f32_16x16x32_bf16 a[0:3], v[176:179], v[28:31], a[0:3]
    s_waitcnt vmcnt(6)
    v_subrev_u32 v52, s92, v52
    v_cmp_lt_u32 vcc, 15, v52
    v_mfma_f32_16x16x32_bf16 a[48:51], v[164:167], v[24:27], a[48:51]
    v_exp_f32 v16, v72
    v_mfma_f32_16x16x32_bf16 a[48:51], v[180:183], v[28:31], a[48:51]
    v_exp_f32 v17, v73
    v_mfma_f32_16x16x32_bf16 a[96:99], v[168:171], v[24:27], a[96:99]
    s_and_b32 s59, vcc_lo, 0xff
    ds_read_b128 v[44:47], v1 offset:14336
    v_mfma_f32_16x16x32_bf16 a[96:99], v[184:187], v[28:31], a[96:99]
    s_cbranch_scc1 L_pollslow4
L_pollok4:
    v_mfma_f32_16x16x32_bf16 a[144:147], v[172:175], v[24:27], a[144:147]
    s_add_u32 s92, s92, 1
    v_exp_f32 v18, v74
    v_mfma_f32_16x16x32_bf16 a[144:147], v[188:191], v[28:31], a[144:147]
    s_waitcnt lgkmcnt(2)
    v_add_f32 v7, v7, v16
    v_add_f32 v7, v7, v17
    v_mfma_f32_16x16x32_bf16 a[4:7], v[160:163], v[32:35], a[4:7]
    s_mov_b32 m0, s56
    ds_read_b128 v[24:27], v1 offset:3072
    v_mfma_f32_16x16x32_bf16 a[4:7], v[176:179], v[36:39], a[4:7]
    buffer_load_dwordx4 v4, s[4:7], s27 offen offset:0 sc1 lds
    v_mfma_f32_16x16x32_bf16 a[52:55], v[164:167], v[32:35], a[52:55]
    v_exp_f32 v19, v75
    v_mfma_f32_16x16x32_bf16 a[52:55], v[180:183], v[36:39], a[52:55]
    v_cvt_pk_bf16_f32 v72, v16, v17
    v_mfma_f32_16x16x32_bf16 a[100:103], v[168:171], v[32:35], a[100:103]
    ds_read_b128 v[28:31], v1 offset:15360
    v_mfma_f32_16x16x32_bf16 a[100:103], v[184:187], v[36:39], a[100:103]
    v_exp_f32 v16, v104
    v_mfma_f32_16x16x32_bf16 a[148:151], v[172:175], v[32:35], a[148:151]
    v_add_f32 v7, v7, v18
    v_add_f32 v7, v7, v19
    v_mfma_f32_16x16x32_bf16 a[148:151], v[188:191], v[36:39], a[148:151]
    s_waitcnt lgkmcnt(2)
    v_exp_f32 v17, v105
    v_mfma_f32_16x16x32_bf16 a[8:11], v[160:163], v[40:43], a[8:11]
    ds_read_b128 v[32:35], v1 offset:4096
    v_cvt_pk_bf16_f32 v73, v18, v19
    v_mfma_f32_16x16x32_bf16 a[8:11], v[176:179], v[44:47], a[8:11]
    buffer_load_dwordx4 v4, s[4:7], s27 offen offset:1024 sc1 lds
    v_mfma_f32_16x16x32_bf16 a[56:59], v[164:167], v[40:43], a[56:59]
    v_exp_f32 v18, v106
    v_mfma_f32_16x16x32_bf16 a[56:59], v[180:183], v[44:47], a[56:59]
    v_add_f32 v7, v7, v16
    v_add_f32 v7, v7, v17
    v_mfma_f32_16x16x32_bf16 a[104:107], v[168:171], v[40:43], a[104:107]
    ds_read_b128 v[36:39], v1 offset:16384
    v_mfma_f32_16x16x32_bf16 a[104:107], v[184:187], v[44:47], a[104:107]
    v_exp_f32 v19, v107
    v_mfma_f32_16x16x32_bf16 a[152:155], v[172:175], v[40:43], a[152:155]
    v_cvt_pk_bf16_f32 v74, v16, v17
    v_mfma_f32_16x16x32_bf16 a[152:155], v[188:191], v[44:47], a[152:155]
    s_waitcnt lgkmcnt(2)
    v_exp_f32 v16, v76
    v_mfma_f32_16x16x32_bf16 a[12:15], v[160:163], v[24:27], a[12:15]
    ds_read_b128 v[40:43], v1 offset:5120
    v_add_f32 v7, v7, v18
    v_mfma_f32_16x16x32_bf16 a[12:15], v[176:179], v[28:31], a[12:15]
    buffer_load_dwordx4 v4, s[4:7], s27 offen offset:2048 sc1 lds
    v_mfma_f32_16x16x32_bf16 a[60:63], v[164:167], v[24:27], a[60:63]
    v_add_f32 v7, v7, v19
    v_mfma_f32_16x16x32_bf16 a[60:63], v[180:183], v[28:31], a[60:63]
    v_exp_f32 v17, v77
    v_mfma_f32_16x16x32_bf16 a[108:111], v[168:171], v[24:27], a[108:111]
    ds_read_b128 v[44:47], v1 offset:17408
    v_cvt_pk_bf16_f32 v75, v18, v19
    v_mfma_f32_16x16x32_bf16 a[108:111], v[184:187], v[28:31], a[108:111]
    v_exp_f32 v18, v78
    v_mfma_f32_16x16x32_bf16 a[156:159], v[172:175], v[24:27], a[156:159]
    s_add_u32 s29, s28, 49152
    v_add_f32 v8, v8, v16
    v_add_f32 v8, v8, v17
    v_mfma_f32_16x16x32_bf16 a[156:159], v[188:191], v[28:31], a[156:159]
    s_waitcnt lgkmcnt(2)
    v_exp_f32 v19, v79
    v_mfma_f32_16x16x32_bf16 a[16:19], v[160:163], v[32:35], a[16:19]
    s_sub_u32 s3, s29, 147456
    ds_read_b128 v[24:27], v1 offset:6144
    v_cvt_pk_bf16_f32 v76, v16, v17
    v_mfma_f32_16x16x32_bf16 a[16:19], v[176:179], v[36:39], a[16:19]
    s_add_u32 s27, s27, 24576
    v_exp_f32 v16, v108
    v_mfma_f32_16x16x32_bf16 a[64:67], v[164:167], v[32:35], a[64:67]
    s_min_u32 s29, s29, s3
    v_add_f32 v8, v8, v18
    v_add_f32 v8, v8, v19
    v_mfma_f32_16x16x32_bf16 a[64:67], v[180:183], v[36:39], a[64:67]
    s_add_u32 s56, s56, 12288
    v_exp_f32 v17, v109
    v_mfma_f32_16x16x32_bf16 a[112:115], v[168:171], v[32:35], a[112:115]
    ds_read_b128 v[28:31], v1 offset:18432
    v_mfma_f32_16x16x32_bf16 a[112:115], v[184:187], v[36:39], a[112:115]
    v_cvt_pk_bf16_f32 v77, v18, v19
    v_mfma_f32_16x16x32_bf16 a[160:163], v[172:175], v[32:35], a[160:163]
    v_exp_f32 v18, v110
    v_mfma_f32_16x16x32_bf16 a[160:163], v[188:191], v[36:39], a[160:163]
    s_waitcnt lgkmcnt(2)
    v_add_f32 v8, v8, v16
    s_mov_b32 m0, s56
    v_mfma_f32_16x16x32_bf16 a[20:23], v[160:163], v[40:43], a[20:23]
    s_sub_u32 s3, s29, s28
    ds_read_b128 v[32:35], v1 offset:7168
    v_add_f32 v8, v8, v17
    v_mfma_f32_16x16x32_bf16 a[20:23], v[176:179], v[44:47], a[20:23]
    v_exp_f32 v19, v111
    v_mfma_f32_16x16x32_bf16 a[68:71], v[164:167], v[40:43], a[68:71]
    v_mfma_f32_16x16x32_bf16 a[68:71], v[180:183], v[44:47], a[68:71]
    v_cvt_pk_bf16_f32 v78, v16, v17
    v_mfma_f32_16x16x32_bf16 a[116:119], v[168:171], v[40:43], a[116:119]
    ds_read_b128 v[36:39], v1 offset:19456
    v_add_f32 v8, v8, v18
    v_mfma_f32_16x16x32_bf16 a[116:119], v[184:187], v[44:47], a[116:119]
    buffer_load_dwordx4 v4, s[4:7], s27 offen offset:0 sc1 lds
    v_mfma_f32_16x16x32_bf16 a[164:167], v[172:175], v[40:43], a[164:167]
    s_mov_b32 s28, s29
    v_add_f32 v8, v8, v19
    v_cvt_pk_bf16_f32 v79, v18, v19
    v_mfma_f32_16x16x32_bf16 a[164:167], v[188:191], v[44:47], a[164:167]
    s_waitcnt lgkmcnt(2)
    v_exp_f32 v16, v80
    v_mfma_f32_16x16x32_bf16 a[24:27], v[160:163], v[24:27], a[24:27]
    ds_read_b128 v[40:43], v1 offset:8192
    v_mfma_f32_16x16x32_bf16 a[24:27], v[176:179], v[28:31], a[24:27]
    v_exp_f32 v17, v81
    v_mfma_f32_16x16x32_bf16 a[72:75], v[164:167], v[24:27], a[72:75]
    v_exp_f32 v18, v82
    v_mfma_f32_16x16x32_bf16 a[72:75], v[180:183], v[28:31], a[72:75]
    v_add_f32 v5, v5, v16
    v_mfma_f32_16x16x32_bf16 a[120:123], v[168:171], v[24:27], a[120:123]
    ds_read_b128 v[44:47], v1 offset:20480
    v_add_f32 v5, v5, v17
    v_mfma_f32_16x16x32_bf16 a[120:123], v[184:187], v[28:31], a[120:123]
    v_exp_f32 v19, v83
    v_mfma_f32_16x16x32_bf16 a[168:171], v[172:175], v[24:27], a[168:171]
    v_add_u32 v2, s3, v2
    v_mfma_f32_16x16x32_bf16 a[168:171], v[188:191], v[28:31], a[168:171]
    s_waitcnt lgkmcnt(2)
    buffer_load_dwordx4 v4, s[4:7], s27 offen offset:1024 sc1 lds
    v_mfma_f32_16x16x32_bf16 a[28:31], v[160:163], v[32:35], a[28:31]
    ds_read_b128 v[24:27], v1 offset:9216
    v_cvt_pk_bf16_f32 v80, v16, v17
    v_mfma_f32_16x16x32_bf16 a[28:31], v[176:179], v[36:39], a[28:31]
    v_exp_f32 v16, v112
    v_mfma_f32_16x16x32_bf16 a[76:79], v[164:167], v[32:35], a[76:79]
    v_add_f32 v5, v5, v18
    v_add_f32 v5, v5, v19
    v_mfma_f32_16x16x32_bf16 a[76:79], v[180:183], v[36:39], a[76:79]
    v_exp_f32 v17, v113
    v_mfma_f32_16x16x32_bf16 a[124:127], v[168:171], v[32:35], a[124:127]
    ds_read_b128 v[28:31], v1 offset:21504
    v_add_u32 v3, s3, v3
    v_mfma_f32_16x16x32_bf16 a[124:127], v[184:187], v[36:39], a[124:127]
    v_cvt_pk_bf16_f32 v81, v18, v19
    v_mfma_f32_16x16x32_bf16 a[172:175], v[172:175], v[32:35], a[172:175]
    v_exp_f32 v18, v114
    v_mfma_f32_16x16x32_bf16 a[172:175], v[188:191], v[36:39], a[172:175]
    s_waitcnt lgkmcnt(2)
    buffer_load_dwordx4 v4, s[4:7], s27 offen offset:2048 sc1 lds
    v_mfma_f32_16x16x32_bf16 a[32:35], v[160:163], v[40:43], a[32:35]
    ds_read_b128 v[32:35], v1 offset:10240
    v_add_f32 v5, v5, v16
    v_mfma_f32_16x16x32_bf16 a[32:35], v[176:179], v[44:47], a[32:35]
    v_add_f32 v5, v5, v17
    v_mfma_f32_16x16x32_bf16 a[80:83], v[164:167], v[40:43], a[80:83]
    v_exp_f32 v19, v115
    v_mfma_f32_16x16x32_bf16 a[80:83], v[180:183], v[44:47], a[80:83]
    v_cvt_pk_bf16_f32 v82, v16, v17
    v_mfma_f32_16x16x32_bf16 a[128:131], v[168:171], v[40:43], a[128:131]
    ds_read_b128 v[36:39], v1 offset:22528
    v_mfma_f32_16x16x32_bf16 a[128:131], v[184:187], v[44:47], a[128:131]
    v_exp_f32 v16, v84
    v_mfma_f32_16x16x32_bf16 a[176:179], v[172:175], v[40:43], a[176:179]
    v_add_f32 v5, v5, v18
    v_add_f32 v5, v5, v19
    v_mfma_f32_16x16x32_bf16 a[176:179], v[188:191], v[44:47], a[176:179]
    s_waitcnt lgkmcnt(2)
    v_exp_f32 v17, v85
    v_mfma_f32_16x16x32_bf16 a[36:39], v[160:163], v[24:27], a[36:39]
    ds_read_b128 v[40:43], v1 offset:11264
    v_mfma_f32_16x16x32_bf16 a[36:39], v[176:179], v[28:31], a[36:39]
    v_cvt_pk_bf16_f32 v83, v18, v19
    v_mfma_f32_16x16x32_bf16 a[84:87], v[164:167], v[24:27], a[84:87]
    v_exp_f32 v18, v86
    v_mfma_f32_16x16x32_bf16 a[84:87], v[180:183], v[28:31], a[84:87]
    s_add_u32 s27, s27, 24576
    s_add_u32 s56, s56, 36864
    v_add_f32 v6, v6, v16
    v_mfma_f32_16x16x32_bf16 a[132:135], v[168:171], v[24:27], a[132:135]
    s_sub_u32 s58, s56, 147456
    ds_read_b128 v[44:47], v1 offset:23552
    v_add_f32 v6, v6, v17
    v_mfma_f32_16x16x32_bf16 a[132:135], v[184:187], v[28:31], a[132:135]
    v_exp_f32 v19, v87
    v_mfma_f32_16x16x32_bf16 a[180:183], v[172:175], v[24:27], a[180:183]
    v_mfma_f32_16x16x32_bf16 a[180:183], v[188:191], v[28:31], a[180:183]
    s_waitcnt lgkmcnt(2)
    v_cvt_pk_bf16_f32 v84, v16, v17
    s_min_u32 s56, s56, s58
    v_mfma_f32_16x16x32_bf16 a[40:43], v[160:163], v[32:35], a[40:43]
    ds_read_b128 v[24:27], v2 offset:0
    v_mfma_f32_16x16x32_bf16 a[40:43], v[176:179], v[36:39], a[40:43]
    v_exp_f32 v16, v116
    v_mfma_f32_16x16x32_bf16 a[88:91], v[164:167], v[32:35], a[88:91]
    v_add_f32 v6, v6, v18
    v_add_f32 v6, v6, v19
    v_mfma_f32_16x16x32_bf16 a[88:91], v[180:183], v[36:39], a[88:91]
    v_exp_f32 v17, v117
    v_mfma_f32_16x16x32_bf16 a[136:139], v[168:171], v[32:35], a[136:139]
    ds_read_b128 v[28:31], v3 offset:0
    v_mfma_f32_16x16x32_bf16 a[136:139], v[184:187], v[36:39], a[136:139]
    v_cvt_pk_bf16_f32 v85, v18, v19
    v_mfma_f32_16x16x32_bf16 a[184:187], v[172:175], v[32:35], a[184:187]
    v_exp_f32 v18, v118
    v_mfma_f32_16x16x32_bf16 a[184:187], v[188:191], v[36:39], a[184:187]
    s_waitcnt lgkmcnt(2)
    v_add_f32 v6, v6, v16
    v_mfma_f32_16x16x32_bf16 a[44:47], v[160:163], v[40:43], a[44:47]
    ds_read_b128 v[32:35], v2 offset:6144
    v_add_f32 v6, v6, v17
    v_mfma_f32_16x16x32_bf16 a[44:47], v[176:179], v[44:47], a[44:47]
    v_exp_f32 v19, v119
    v_mfma_f32_16x16x32_bf16 a[92:95], v[164:167], v[40:43], a[92:95]
    v_mfma_f32_16x16x32_bf16 a[92:95], v[180:183], v[44:47], a[92:95]
    v_cvt_pk_bf16_f32 v86, v16, v17
    v_mfma_f32_16x16x32_bf16 a[140:143], v[168:171], v[40:43], a[140:143]
    ds_read_b128 v[36:39], v3 offset:6144
    v_add_f32 v6, v6, v18
    v_mfma_f32_16x16x32_bf16 a[140:143], v[184:187], v[44:47], a[140:143]
    v_add_f32 v6, v6, v19
    v_cvt_pk_bf16_f32 v87, v18, v19
    v_mfma_f32_16x16x32_bf16 a[188:191], v[172:175], v[40:43], a[188:191]
    v_mfma_f32_16x16x32_bf16 a[188:191], v[188:191], v[44:47], a[188:191]
    s_waitcnt lgkmcnt(2)
    v_mfma_f32_16x16x32_bf16 v[160:163], v[24:27], a[192:195], v[128:131]
    ds_read_b128 v[40:43], v2 offset:128
    v_mfma_f32_16x16x32_bf16 v[160:163], v[28:31], a[196:199], v[160:163]
    v_exp_f32 v16, v88
    v_mfma_f32_16x16x32_bf16 v[164:167], v[24:27], a[216:219], v[132:135]
    ds_read_b128 v[44:47], v3 offset:128
    v_mfma_f32_16x16x32_bf16 v[164:167], v[28:31], a[220:223], v[164:167]
    s_waitcnt lgkmcnt(2)
    v_exp_f32 v17, v89
    v_mfma_f32_16x16x32_bf16 v[96:99], v[32:35], a[192:195], v[128:131]
    ds_read_b128 v[24:27], v2 offset:6272
    v_mfma_f32_16x16x32_bf16 v[96:99], v[36:39], a[196:199], v[96:99]
    s_waitcnt vmcnt(6)
    v_exp_f32 v18, v90
    v_mfma_f32_16x16x32_bf16 v[100:103], v[32:35], a[216:219], v[132:135]
    ds_read_b128 v[28:31], v3 offset:6272
    v_add_f32 v7, v7, v16
    v_mfma_f32_16x16x32_bf16 v[100:103], v[36:39], a[220:223], v[100:103]
    s_waitcnt lgkmcnt(2)
    s_barrier
    v_mfma_f32_16x16x32_bf16 v[160:163], v[40:43], a[200:203], v[160:163]
    s_mov_b32 m0, s26
    ds_read_b128 v[32:35], v2 offset:256
    v_add_f32 v7, v7, v17
    v_mfma_f32_16x16x32_bf16 v[160:163], v[44:47], a[204:207], v[160:163]
    buffer_load_dwordx4 v4, s[4:7], s32 offen offset:0 sc1 lds
    v_mfma_f32_16x16x32_bf16 v[164:167], v[40:43], a[224:227], v[164:167]
    ds_read_b128 v[36:39], v3 offset:256
    v_mfma_f32_16x16x32_bf16 v[164:167], v[44:47], a[228:231], v[164:167]
    s_waitcnt lgkmcnt(2)
    v_exp_f32 v19, v91
    v_mfma_f32_16x16x32_bf16 v[96:99], v[24:27], a[200:203], v[96:99]
    ds_read_b128 v[40:43], v2 offset:6400
    v_cvt_pk_bf16_f32 v88, v16, v17
    v_mfma_f32_16x16x32_bf16 v[96:99], v[28:31], a[204:207], v[96:99]
    v_exp_f32 v16, v120
    v_mfma_f32_16x16x32_bf16 v[100:103], v[24:27], a[224:227], v[100:103]
    ds_read_b128 v[44:47], v3 offset:6400
    v_add_f32 v7, v7, v18
    v_mfma_f32_16x16x32_bf16 v[100:103], v[28:31], a[228:231], v[100:103]
    s_waitcnt lgkmcnt(2)
    buffer_load_dwordx4 v4, s[4:7], s32 offen offset:1024 sc1 lds
    v_mfma_f32_16x16x32_bf16 v[160:163], v[32:35], a[208:211], v[160:163]
    ds_read_b128 v[24:27], v2 offset:12288
    v_add_f32 v7, v7, v19
    v_mfma_f32_16x16x32_bf16 v[160:163], v[36:39], a[212:215], v[160:163]
    v_exp_f32 v17, v121
    v_mfma_f32_16x16x32_bf16 v[164:167], v[32:35], a[232:235], v[164:167]
    ds_read_b128 v[28:31], v3 offset:12288
    v_cvt_pk_bf16_f32 v89, v18, v19
    v_mfma_f32_16x16x32_bf16 v[164:167], v[36:39], a[236:239], v[164:167]
    s_waitcnt lgkmcnt(2)
    v_exp_f32 v18, v122
    v_mfma_f32_16x16x32_bf16 v[96:99], v[40:43], a[208:211], v[96:99]
    ds_read_b128 v[32:35], v2 offset:18432
    v_add_f32 v7, v7, v16
    v_mfma_f32_16x16x32_bf16 v[96:99], v[44:47], a[212:215], v[96:99]
    buffer_load_dwordx4 v4, s[4:7], s32 offen offset:2048 sc1 lds
    v_mfma_f32_16x16x32_bf16 v[100:103], v[40:43], a[232:235], v[100:103]
    ds_read_b128 v[36:39], v3 offset:18432
    v_add_f32 v7, v7, v17
    v_mfma_f32_16x16x32_bf16 v[100:103], v[44:47], a[236:239], v[100:103]
    s_waitcnt lgkmcnt(2)
    v_exp_f32 v19, v123
    v_mfma_f32_16x16x32_bf16 v[168:171], v[24:27], a[192:195], v[128:131]
    ds_read_b128 v[40:43], v2 offset:12416
    v_cvt_pk_bf16_f32 v90, v16, v17
    v_mfma_f32_16x16x32_bf16 v[168:171], v[28:31], a[196:199], v[168:171]
    v_exp_f32 v16, v92
    v_mfma_f32_16x16x32_bf16 v[172:175], v[24:27], a[216:219], v[132:135]
    s_add_u32 s32, s32, 24576
    ds_read_b128 v[44:47], v3 offset:12416
    v_add_f32 v7, v7, v18
    v_mfma_f32_16x16x32_bf16 v[172:175], v[28:31], a[220:223], v[172:175]
    s_waitcnt lgkmcnt(2)
    v_add_f32 v7, v7, v19
    v_mfma_f32_16x16x32_bf16 v[104:107], v[32:35], a[192:195], v[128:131]
    ds_read_b128 v[24:27], v2 offset:18560
    v_mfma_f32_16x16x32_bf16 v[104:107], v[36:39], a[196:199], v[104:107]
    s_add_u32 s26, s26, 12288
    v_exp_f32 v17, v93
    v_mfma_f32_16x16x32_bf16 v[108:111], v[32:35], a[216:219], v[132:135]
    s_add_u32 s29, s30, 49152
    ds_read_b128 v[28:31], v3 offset:18560
    v_cvt_pk_bf16_f32 v91, v18, v19
    v_mfma_f32_16x16x32_bf16 v[108:111], v[36:39], a[220:223], v[108:111]
    s_waitcnt lgkmcnt(2)
    v_exp_f32 v18, v94
    v_mfma_f32_16x16x32_bf16 v[168:171], v[40:43], a[200:203], v[168:171]
    s_sub_u32 s3, s29, 147456
    ds_read_b128 v[32:35], v2 offset:12544
    v_add_f32 v8, v8, v16
    v_mfma_f32_16x16x32_bf16 v[168:171], v[44:47], a[204:207], v[168:171]
    s_mov_b32 m0, s26
    v_add_f32 v8, v8, v17
    s_min_u32 s29, s29, s3
    v_mfma_f32_16x16x32_bf16 v[172:175], v[40:43], a[224:227], v[172:175]
    ds_read_b128 v[36:39], v3 offset:12544
    v_mfma_f32_16x16x32_bf16 v[172:175], v[44:47], a[228:231], v[172:175]
    s_waitcnt lgkmcnt(2)
    v_exp_f32 v19, v95
    v_mfma_f32_16x16x32_bf16 v[104:107], v[24:27], a[200:203], v[104:107]
    ds_read_b128 v[40:43], v2 offset:18688
    v_cvt_pk_bf16_f32 v92, v16, v17
    v_mfma_f32_16x16x32_bf16 v[104:107], v[28:31], a[204:207], v[104:107]
    buffer_load_dwordx4 v4, s[4:7], s32 offen offset:0 sc1 lds
    v_mfma_f32_16x16x32_bf16 v[108:111], v[24:27], a[224:227], v[108:111]
    ds_read_b128 v[44:47], v3 offset:18688
    v_mfma_f32_16x16x32_bf16 v[108:111], v[28:31], a[228:231], v[108:111]
    s_waitcnt lgkmcnt(2)
    v_subrev_u32 v2, 98304, v2
    v_subrev_u32 v3, 98304, v3
    v_mfma_f32_16x16x32_bf16 v[168:171], v[32:35], a[208:211], v[168:171]
    ds_read_b128 v[24:27], v2 offset:0
    v_mfma_f32_16x16x32_bf16 v[168:171], v[36:39], a[212:215], v[168:171]
    v_exp_f32 v16, v124
    v_add_f32 v8, v8, v18
    v_mfma_f32_16x16x32_bf16 v[172:175], v[32:35], a[232:235], v[172:175]
    s_sub_u32 s3, s29, s30
    ds_read_b128 v[28:31], v3 offset:0
    v_add_f32 v8, v8, v19
    v_mfma_f32_16x16x32_bf16 v[172:175], v[36:39], a[236:239], v[172:175]
    s_waitcnt lgkmcnt(2)
    v_exp_f32 v17, v125
    v_cvt_pk_bf16_f32 v93, v18, v19
    v_mfma_f32_16x16x32_bf16 v[104:107], v[40:43], a[208:211], v[104:107]
    ds_read_b128 v[32:35], v2 offset:6144
    v_mfma_f32_16x16x32_bf16 v[104:107], v[44:47], a[212:215], v[104:107]
    buffer_load_dwordx4 v4, s[4:7], s32 offen offset:1024 sc1 lds
    v_mfma_f32_16x16x32_bf16 v[108:111], v[40:43], a[232:235], v[108:111]
    ds_read_b128 v[36:39], v3 offset:6144
    v_mfma_f32_16x16x32_bf16 v[108:111], v[44:47], a[236:239], v[108:111]
    s_waitcnt lgkmcnt(2)
    v_exp_f32 v18, v126
    v_add_f32 v8, v8, v16
    v_mfma_f32_16x16x32_bf16 v[176:179], v[24:27], a[192:195], v[128:131]
    ds_read_b128 v[40:43], v2 offset:128
    v_add_f32 v8, v8, v17
    v_mfma_f32_16x16x32_bf16 v[176:179], v[28:31], a[196:199], v[176:179]
    v_exp_f32 v19, v127
    v_cvt_pk_bf16_f32 v94, v16, v17
    v_mfma_f32_16x16x32_bf16 v[180:183], v[24:27], a[216:219], v[132:135]
    ds_read_b128 v[44:47], v3 offset:128
    v_add_f32 v8, v8, v18
    v_add_f32 v8, v8, v19
    v_cvt_pk_bf16_f32 v95, v18, v19
    v_mfma_f32_16x16x32_bf16 v[180:183], v[28:31], a[220:223], v[180:183]
    s_waitcnt lgkmcnt(2)
    buffer_load_dwordx4 v4, s[4:7], s32 offen offset:2048 sc1 lds
    v_mfma_f32_16x16x32_bf16 v[112:115], v[32:35], a[192:195], v[128:131]
    s_mov_b32 s30, s29
    ds_read_b128 v[24:27], v2 offset:6272
    v_mfma_f32_16x16x32_bf16 v[112:115], v[36:39], a[196:199], v[112:115]
    v_exp_f32 v16, v160
    v_mfma_f32_16x16x32_bf16 v[116:119], v[32:35], a[216:219], v[132:135]
    ds_read_b128 v[28:31], v3 offset:6272
    v_mfma_f32_16x16x32_bf16 v[116:119], v[36:39], a[220:223], v[116:119]
    s_waitcnt lgkmcnt(2)
    v_exp_f32 v17, v161
    v_mfma_f32_16x16x32_bf16 v[176:179], v[40:43], a[200:203], v[176:179]
    ds_read_b128 v[32:35], v2 offset:256
    v_mfma_f32_16x16x32_bf16 v[176:179], v[44:47], a[204:207], v[176:179]
    v_exp_f32 v18, v162
    v_mfma_f32_16x16x32_bf16 v[180:183], v[40:43], a[224:227], v[180:183]
    ds_read_b128 v[36:39], v3 offset:256
    v_add_f32 v5, v5, v16
    v_mfma_f32_16x16x32_bf16 v[180:183], v[44:47], a[228:231], v[180:183]
    s_waitcnt lgkmcnt(2)
    v_add_f32 v5, v5, v17
    v_add_u32 v1, s3, v1
    v_mfma_f32_16x16x32_bf16 v[112:115], v[24:27], a[200:203], v[112:115]
    ds_read_b128 v[40:43], v2 offset:6400
    v_mfma_f32_16x16x32_bf16 v[112:115], v[28:31], a[204:207], v[112:115]
    v_exp_f32 v19, v163
    v_cvt_pk_bf16_f32 v160, v16, v17
    v_mfma_f32_16x16x32_bf16 v[116:119], v[24:27], a[224:227], v[116:119]
    s_add_u32 s32, s32, 24576
    ds_read_b128 v[44:47], v3 offset:6400
    s_add_u32 s26, s26, 36864
    v_mfma_f32_16x16x32_bf16 v[116:119], v[28:31], a[228:231], v[116:119]
    s_waitcnt lgkmcnt(2)
    v_exp_f32 v16, v96
    v_mfma_f32_16x16x32_bf16 v[176:179], v[32:35], a[208:211], v[176:179]
    s_sub_u32 s57, s26, 147456
    ds_read_b128 v[24:27], v2 offset:12288
    v_add_f32 v5, v5, v18
    v_mfma_f32_16x16x32_bf16 v[176:179], v[36:39], a[212:215], v[176:179]
    s_min_u32 s26, s26, s57
    v_add_f32 v5, v5, v19
    v_mfma_f32_16x16x32_bf16 v[180:183], v[32:35], a[232:235], v[180:183]
    ds_read_b128 v[28:31], v3 offset:12288
    v_mfma_f32_16x16x32_bf16 v[180:183], v[36:39], a[236:239], v[180:183]
    s_waitcnt lgkmcnt(2)
    v_exp_f32 v17, v97
    v_cvt_pk_bf16_f32 v161, v18, v19
    v_mfma_f32_16x16x32_bf16 v[112:115], v[40:43], a[208:211], v[112:115]
    ds_read_b128 v[32:35], v2 offset:18432
    v_mfma_f32_16x16x32_bf16 v[112:115], v[44:47], a[212:215], v[112:115]
    v_exp_f32 v18, v98
    v_mfma_f32_16x16x32_bf16 v[116:119], v[40:43], a[232:235], v[116:119]
    ds_read_b128 v[36:39], v3 offset:18432
    v_add_f32 v5, v5, v16
    v_mfma_f32_16x16x32_bf16 v[116:119], v[44:47], a[236:239], v[116:119]
    s_waitcnt lgkmcnt(2)
    v_add_f32 v5, v5, v17
    v_mfma_f32_16x16x32_bf16 v[184:187], v[24:27], a[192:195], v[128:131]
    ds_read_b128 v[40:43], v2 offset:12416
    v_mfma_f32_16x16x32_bf16 v[184:187], v[28:31], a[196:199], v[184:187]
    v_exp_f32 v19, v99
    v_cvt_pk_bf16_f32 v162, v16, v17
    v_mfma_f32_16x16x32_bf16 v[188:191], v[24:27], a[216:219], v[132:135]
    ds_read_b128 v[44:47], v3 offset:12416
    v_mfma_f32_16x16x32_bf16 v[188:191], v[28:31], a[220:223], v[188:191]
    s_waitcnt lgkmcnt(2)
    v_exp_f32 v16, v164
    v_mfma_f32_16x16x32_bf16 v[120:123], v[32:35], a[192:195], v[128:131]
    ds_read_b128 v[24:27], v2 offset:18560
    v_add_f32 v5, v5, v18
    v_mfma_f32_16x16x32_bf16 v[120:123], v[36:39], a[196:199], v[120:123]
    s_waitcnt vmcnt(6)
    v_add_f32 v5, v5, v19
    v_mfma_f32_16x16x32_bf16 v[124:127], v[32:35], a[216:219], v[132:135]
    ds_read_b128 v[28:31], v3 offset:18560
    v_mfma_f32_16x16x32_bf16 v[124:127], v[36:39], a[220:223], v[124:127]
    s_waitcnt lgkmcnt(2)
    s_barrier
    v_mfma_f32_16x16x32_bf16 v[184:187], v[40:43], a[200:203], v[184:187]
    ds_read_b128 v[32:35], v2 offset:12544
    v_mfma_f32_16x16x32_bf16 v[184:187], v[44:47], a[204:207], v[184:187]
    v_exp_f32 v17, v165
    v_cvt_pk_bf16_f32 v163, v18, v19
    v_mfma_f32_16x16x32_bf16 v[188:191], v[40:43], a[224:227], v[188:191]
    ds_read_b128 v[36:39], v3 offset:12544
    v_mfma_f32_16x16x32_bf16 v[188:191], v[44:47], a[228:231], v[188:191]
    s_waitcnt lgkmcnt(2)
    v_exp_f32 v18, v166
    v_add_f32 v6, v6, v16
    v_mfma_f32_16x16x32_bf16 v[120:123], v[24:27], a[200:203], v[120:123]
    ds_read_b128 v[40:43], v2 offset:18688
    v_add_f32 v6, v6, v17
    v_mfma_f32_16x16x32_bf16 v[120:123], v[28:31], a[204:207], v[120:123]
    v_exp_f32 v19, v167
    v_cvt_pk_bf16_f32 v164, v16, v17
    v_mfma_f32_16x16x32_bf16 v[124:127], v[24:27], a[224:227], v[124:127]
    ds_read_b128 v[44:47], v3 offset:18688
    v_mfma_f32_16x16x32_bf16 v[124:127], v[28:31], a[228:231], v[124:127]
    s_waitcnt lgkmcnt(2)
    v_exp_f32 v16, v100
    v_mfma_f32_16x16x32_bf16 v[184:187], v[32:35], a[208:211], v[184:187]
    ds_read_b128 v[24:27], v1 offset:0
    v_add_f32 v6, v6, v18
    v_mfma_f32_16x16x32_bf16 v[184:187], v[36:39], a[212:215], v[184:187]
    v_add_f32 v6, v6, v19
    v_mfma_f32_16x16x32_bf16 v[188:191], v[32:35], a[232:235], v[188:191]
    ds_read_b128 v[28:31], v1 offset:12288
    v_mfma_f32_16x16x32_bf16 v[188:191], v[36:39], a[236:239], v[188:191]
    s_waitcnt lgkmcnt(2)
    v_exp_f32 v17, v101
    v_cvt_pk_bf16_f32 v165, v18, v19
    v_mfma_f32_16x16x32_bf16 v[120:123], v[40:43], a[208:211], v[120:123]
    ds_read_b128 v[32:35], v1 offset:1024
    v_mfma_f32_16x16x32_bf16 v[120:123], v[44:47], a[212:215], v[120:123]
    v_exp_f32 v18, v102
    v_mfma_f32_16x16x32_bf16 v[124:127], v[40:43], a[232:235], v[124:127]
    ds_read_b128 v[36:39], v1 offset:13312
    v_add_f32 v6, v6, v16
    v_mfma_f32_16x16x32_bf16 v[124:127], v[44:47], a[236:239], v[124:127]
    s_waitcnt lgkmcnt(2)
    v_add_f32 v6, v6, v17
    v_exp_f32 v19, v103
    v_cvt_pk_bf16_f32 v166, v16, v17
    v_add_f32 v6, v6, v18
    v_add_f32 v6, v6, v19
    v_cvt_pk_bf16_f32 v167, v18, v19
    v_mfma_f32_16x16x32_bf16 a[0:3], v[64:67], v[24:27], a[0:3]
    s_mov_b32 m0, s56
    ds_read_b128 v[40:43], v1 offset:2048
    v_bfe_u32 v57, v4, 8, 2
    v_mfma_f32_16x16x32_bf16 a[0:3], v[80:83], v[28:31], a[0:3]
    buffer_load_dwordx4 v4, s[4:7], s27 offen offset:0 sc1 lds
    v_mfma_f32_16x16x32_bf16 a[48:51], v[68:71], v[24:27], a[48:51]
    v_exp_f32 v16, v168
    v_mfma_f32_16x16x32_bf16 a[48:51], v[84:87], v[28:31], a[48:51]
    v_exp_f32 v17, v169
    v_mfma_f32_16x16x32_bf16 a[96:99], v[72:75], v[24:27], a[96:99]
    ds_read_b128 v[44:47], v1 offset:14336
    v_mul_u32_u24 v56, 1536, v57
    v_mfma_f32_16x16x32_bf16 a[96:99], v[88:91], v[28:31], a[96:99]
    buffer_load_dwordx4 v4, s[4:7], s27 offen offset:1024 sc1 lds
    v_mfma_f32_16x16x32_bf16 a[144:147], v[76:79], v[24:27], a[144:147]
    v_exp_f32 v18, v170
    v_mfma_f32_16x16x32_bf16 a[144:147], v[92:95], v[28:31], a[144:147]
    s_waitcnt lgkmcnt(2)
    v_add_f32 v5, v5, v16
    v_add_f32 v5, v5, v17
    v_mfma_f32_16x16x32_bf16 a[4:7], v[64:67], v[32:35], a[4:7]
    ds_read_b128 v[24:27], v1 offset:3072
    v_lshlrev_b32 v58, 4, v57
    v_mfma_f32_16x16x32_bf16 a[4:7], v[80:83], v[36:39], a[4:7]
    buffer_load_dwordx4 v4, s[4:7], s27 offen offset:2048 sc1 lds
    v_mfma_f32_16x16x32_bf16 a[52:55], v[68:71], v[32:35], a[52:55]
    v_exp_f32 v19, v171
    v_mfma_f32_16x16x32_bf16 a[52:55], v[84:87], v[36:39], a[52:55]
    s_add_u32 s27, s27, 24576
    v_cvt_pk_bf16_f32 v168, v16, v17
    v_bfe_u32 v57, v4, 4, 4
    v_mfma_f32_16x16x32_bf16 a[100:103], v[72:75], v[32:35], a[100:103]
    ds_read_b128 v[28:31], v1 offset:15360
    v_mfma_f32_16x16x32_bf16 a[100:103], v[88:91], v[36:39], a[100:103]
    s_add_u32 s56, s56, 12288
    v_exp_f32 v16, v104
    v_mfma_f32_16x16x32_bf16 a[148:151], v[76:79], v[32:35], a[148:151]
    v_add_f32 v5, v5, v18
    v_add_f32 v5, v5, v19
    v_mfma_f32_16x16x32_bf16 a[148:151], v[92:95], v[36:39], a[148:151]
    s_waitcnt lgkmcnt(2)
    v_exp_f32 v17, v105
    v_mfma_f32_16x16x32_bf16 a[8:11], v[64:67], v[40:43], a[8:11]
    s_mov_b32 m0, s56
    ds_read_b128 v[32:35], v1 offset:4096
    v_cvt_pk_bf16_f32 v169, v18, v19
    v_mfma_f32_16x16x32_bf16 a[8:11], v[80:83], v[44:47], a[8:11]
    v_exp_f32 v18, v106
    v_mfma_f32_16x16x32_bf16 a[56:59], v[68:71], v[40:43], a[56:59]
    v_add_f32 v5, v5, v16
    v_add_f32 v5, v5, v17
    v_mfma_f32_16x16x32_bf16 a[56:59], v[84:87], v[44:47], a[56:59]
    buffer_load_dwordx4 v4, s[4:7], s27 offen offset:0 sc1 lds
    v_mfma_f32_16x16x32_bf16 a[104:107], v[72:75], v[40:43], a[104:107]
    ds_read_b128 v[36:39], v1 offset:16384
    v_mul_u32_u24 v57, 12, v57
    v_mfma_f32_16x16x32_bf16 a[104:107], v[88:91], v[44:47], a[104:107]
    v_exp_f32 v19, v107
    v_mfma_f32_16x16x32_bf16 a[152:155], v[76:79], v[40:43], a[152:155]
    v_cvt_pk_bf16_f32 v170, v16, v17
    v_add_u32 v56, v56, v57
    v_mfma_f32_16x16x32_bf16 a[152:155], v[92:95], v[44:47], a[152:155]
    s_waitcnt lgkmcnt(2)
    buffer_load_dwordx4 v4, s[4:7], s27 offen offset:1024 sc1 lds
    v_mfma_f32_16x16x32_bf16 a[12:15], v[64:67], v[24:27], a[12:15]
    ds_read_b128 v[40:43], v1 offset:5120
    v_mfma_f32_16x16x32_bf16 a[12:15], v[80:83], v[28:31], a[12:15]
L_pg11:
    s_cbranch_execz L_iwret
    v_exp_f32 v16, v172
    v_mfma_f32_16x16x32_bf16 a[60:63], v[68:71], v[24:27], a[60:63]
    v_add_f32 v5, v5, v18
    v_add_f32 v5, v5, v19
    v_mfma_f32_16x16x32_bf16 a[60:63], v[84:87], v[28:31], a[60:63]
    buffer_load_dwordx4 v4, s[4:7], s27 offen offset:2048 sc1 lds
    v_mfma_f32_16x16x32_bf16 a[108:111], v[72:75], v[24:27], a[108:111]
    ds_read_b128 v[44:47], v1 offset:17408
    v_mov_b32 v57, 1.0
    v_mfma_f32_16x16x32_bf16 a[108:111], v[88:91], v[28:31], a[108:111]
    v_exp_f32 v17, v173
    v_mfma_f32_16x16x32_bf16 a[156:159], v[76:79], v[24:27], a[156:159]
    s_add_u32 s27, s27, 24576
    v_cvt_pk_bf16_f32 v171, v18, v19
    v_mfma_f32_16x16x32_bf16 a[156:159], v[92:95], v[28:31], a[156:159]
    s_waitcnt lgkmcnt(2)
    v_exp_f32 v18, v174
    v_mfma_f32_16x16x32_bf16 a[16:19], v[64:67], v[32:35], a[16:19]
    s_add_u32 s56, s56, 36864
    ds_read_b128 v[24:27], v1 offset:6144
    v_add_f32 v6, v6, v16
    v_mfma_f32_16x16x32_bf16 a[16:19], v[80:83], v[36:39], a[16:19]
    v_add_f32 v6, v6, v17
    v_mov_b32 v20, 0x3f803f80
    v_mfma_f32_16x16x32_bf16 a[64:67], v[68:71], v[32:35], a[64:67]
    s_sub_u32 s58, s56, 147456
    v_exp_f32 v19, v175
    v_mfma_f32_16x16x32_bf16 a[64:67], v[84:87], v[36:39], a[64:67]
    v_cvt_pk_bf16_f32 v172, v16, v17
    v_mfma_f32_16x16x32_bf16 a[112:115], v[72:75], v[32:35], a[112:115]
    s_min_u32 s56, s56, s58
    ds_read_b128 v[28:31], v1 offset:18432
    v_mov_b32 v21, 0x3f803f80
    v_mfma_f32_16x16x32_bf16 a[112:115], v[88:91], v[36:39], a[112:115]
    v_exp_f32 v16, v108
    v_mfma_f32_16x16x32_bf16 a[160:163], v[76:79], v[32:35], a[160:163]
    s_mov_b32 m0, s56
    v_add_f32 v6, v6, v18
    v_add_f32 v6, v6, v19
    v_mfma_f32_16x16x32_bf16 a[160:163], v[92:95], v[36:39], a[160:163]
    s_waitcnt lgkmcnt(2)
    v_exp_f32 v17, v109
    v_mfma_f32_16x16x32_bf16 a[20:23], v[64:67], v[40:43], a[20:23]
    ds_read_b128 v[32:35], v1 offset:7168
    v_cvt_pk_bf16_f32 v173, v18, v19
    v_mfma_f32_16x16x32_bf16 a[20:23], v[80:83], v[44:47], a[20:23]
    buffer_load_dwordx4 v4, s[4:7], s27 offen offset:0 sc1 lds
    v_mfma_f32_16x16x32_bf16 a[68:71], v[68:71], v[40:43], a[68:71]
    v_exp_f32 v18, v110
    v_mfma_f32_16x16x32_bf16 a[68:71], v[84:87], v[44:47], a[68:71]
    v_add_f32 v6, v6, v16
    v_add_f32 v6, v6, v17
    v_mfma_f32_16x16x32_bf16 a[116:119], v[72:75], v[40:43], a[116:119]
    ds_read_b128 v[36:39], v1 offset:19456
    v_mov_b32 v22, 0x3f803f80
    v_mfma_f32_16x16x32_bf16 a[116:119], v[88:91], v[44:47], a[116:119]
    buffer_load_dwordx4 v4, s[4:7], s27 offen offset:1024 sc1 lds
    v_mfma_f32_16x16x32_bf16 a[164:167], v[76:79], v[40:43], a[164:167]
    v_exp_f32 v19, v111
    v_mfma_f32_16x16x32_bf16 a[164:167], v[92:95], v[44:47], a[164:167]
    s_waitcnt lgkmcnt(2)
    v_cvt_pk_bf16_f32 v174, v16, v17
    v_add_f32 v6, v6, v18
    v_mfma_f32_16x16x32_bf16 a[24:27], v[64:67], v[24:27], a[24:27]
    ds_read_b128 v[40:43], v1 offset:8192
    v_add_f32 v6, v6, v19
    v_mfma_f32_16x16x32_bf16 a[24:27], v[80:83], v[28:31], a[24:27]
    buffer_load_dwordx4 v4, s[4:7], s27 offen offset:2048 sc1 lds
    v_mfma_f32_16x16x32_bf16 a[72:75], v[68:71], v[24:27], a[72:75]
    v_cvt_pk_bf16_f32 v175, v18, v19
    v_mov_b32 v23, 0x3f803f80
    v_mfma_f32_16x16x32_bf16 a[72:75], v[84:87], v[28:31], a[72:75]
    v_exp_f32 v16, v176
    v_mfma_f32_16x16x32_bf16 a[120:123], v[72:75], v[24:27], a[120:123]
    ds_read_b128 v[44:47], v1 offset:20480
    v_mfma_f32_16x16x32_bf16 a[120:123], v[88:91], v[28:31], a[120:123]
    s_lshl_b32 s24, s95, 2
    v_exp_f32 v17, v177
    v_mfma_f32_16x16x32_bf16 a[168:171], v[76:79], v[24:27], a[168:171]
    s_add_u32 s27, s27, 24576
    v_exp_f32 v18, v178
    v_mfma_f32_16x16x32_bf16 a[168:171], v[92:95], v[28:31], a[168:171]
    s_waitcnt lgkmcnt(2)
    v_add_f32 v5, v5, v16
    v_add_f32 v5, v5, v17
    v_mfma_f32_16x16x32_bf16 a[28:31], v[64:67], v[32:35], a[28:31]
    s_add_u32 s56, s56, 12288
    ds_read_b128 v[24:27], v1 offset:9216
    v_mfma_f32_16x16x32_bf16 a[28:31], v[80:83], v[36:39], a[28:31]
    s_mov_b32 m0, s56
    v_exp_f32 v19, v179
    v_mfma_f32_16x16x32_bf16 a[76:79], v[68:71], v[32:35], a[76:79]
    v_cvt_pk_bf16_f32 v176, v16, v17
    v_mfma_f32_16x16x32_bf16 a[76:79], v[84:87], v[36:39], a[76:79]
    s_add_u32 s24, s24, s25
    v_exp_f32 v16, v112
    v_mfma_f32_16x16x32_bf16 a[124:127], v[72:75], v[32:35], a[124:127]
    ds_read_b128 v[28:31], v1 offset:21504
    v_add_f32 v5, v5, v18
    v_mfma_f32_16x16x32_bf16 a[124:127], v[88:91], v[36:39], a[124:127]
    buffer_load_dwordx4 v4, s[4:7], s27 offen offset:0 sc1 lds
    v_mfma_f32_16x16x32_bf16 a[172:175], v[76:79], v[32:35], a[172:175]
    v_add_f32 v5, v5, v19
    v_mfma_f32_16x16x32_bf16 a[172:175], v[92:95], v[36:39], a[172:175]
    s_waitcnt lgkmcnt(2)
    v_exp_f32 v17, v113
    v_mfma_f32_16x16x32_bf16 a[32:35], v[64:67], v[40:43], a[32:35]
    s_mul_i32 s24, s24, 24576
    ds_read_b128 v[32:35], v1 offset:10240
    v_cvt_pk_bf16_f32 v177, v18, v19
    v_mfma_f32_16x16x32_bf16 a[32:35], v[80:83], v[44:47], a[32:35]
    buffer_load_dwordx4 v4, s[4:7], s27 offen offset:1024 sc1 lds
    v_mfma_f32_16x16x32_bf16 a[80:83], v[68:71], v[40:43], a[80:83]
    v_exp_f32 v18, v114
    v_mfma_f32_16x16x32_bf16 a[80:83], v[84:87], v[44:47], a[80:83]
    v_add_f32 v5, v5, v16
    v_add_f32 v5, v5, v17
    v_mfma_f32_16x16x32_bf16 a[128:131], v[72:75], v[40:43], a[128:131]
    ds_read_b128 v[36:39], v1 offset:22528
    v_mfma_f32_16x16x32_bf16 a[128:131], v[88:91], v[44:47], a[128:131]
    buffer_load_dwordx4 v4, s[4:7], s27 offen offset:2048 sc1 lds
    v_mfma_f32_16x16x32_bf16 a[176:179], v[76:79], v[40:43], a[176:179]
    s_add_u32 s40, s24, 6144
    v_exp_f32 v19, v115
    v_mfma_f32_16x16x32_bf16 a[176:179], v[92:95], v[44:47], a[176:179]
    s_waitcnt lgkmcnt(2)
    v_cvt_pk_bf16_f32 v178, v16, v17
    v_mfma_f32_16x16x32_bf16 a[36:39], v[64:67], v[24:27], a[36:39]
    ds_read_b128 v[40:43], v1 offset:11264
    v_mfma_f32_16x16x32_bf16 a[36:39], v[80:83], v[28:31], a[36:39]
    v_exp_f32 v16, v180
    v_mfma_f32_16x16x32_bf16 a[84:87], v[68:71], v[24:27], a[84:87]
    v_add_f32 v5, v5, v18
    v_add_f32 v5, v5, v19
    v_mfma_f32_16x16x32_bf16 a[84:87], v[84:87], v[28:31], a[84:87]
    s_add_u32 s27, s27, 24576
    v_exp_f32 v17, v181
    v_mfma_f32_16x16x32_bf16 a[132:135], v[72:75], v[24:27], a[132:135]
    s_add_u32 s56, s56, 36864
    ds_read_b128 v[44:47], v1 offset:23552
    v_cvt_pk_bf16_f32 v179, v18, v19
    v_mfma_f32_16x16x32_bf16 a[132:135], v[88:91], v[28:31], a[132:135]
    s_waitcnt lgkmcnt(2)
    v_exp_f32 v18, v182
    v_mfma_f32_16x16x32_bf16 a[180:183], v[76:79], v[24:27], a[180:183]
    s_waitcnt vmcnt(12)
    v_add_f32 v6, v6, v16
    v_add_f32 v6, v6, v17
    v_mfma_f32_16x16x32_bf16 a[180:183], v[92:95], v[28:31], a[180:183]
    s_barrier
    v_add_u32 v2, 49152, v2
    v_add_u32 v3, 49152, v3
    v_mfma_f32_16x16x32_bf16 a[40:43], v[64:67], v[32:35], a[40:43]
    s_sub_u32 s58, s56, 147456
    ds_read_b128 v[24:27], v2 offset:0
    s_add_u32 s41, s24, 12288
    v_mfma_f32_16x16x32_bf16 a[40:43], v[80:83], v[36:39], a[40:43]
    s_min_u32 s56, s56, s58
    v_exp_f32 v19, v183
    v_mfma_f32_16x16x32_bf16 a[88:91], v[68:71], v[32:35], a[88:91]
    s_add_u32 s42, s24, 18432
    v_cvt_pk_bf16_f32 v180, v16, v17
    v_mfma_f32_16x16x32_bf16 a[88:91], v[84:87], v[36:39], a[88:91]
    v_exp_f32 v16, v116
    v_mfma_f32_16x16x32_bf16 a[136:139], v[72:75], v[32:35], a[136:139]
    ds_read_b128 v[28:31], v3 offset:0
    v_add_f32 v6, v6, v18
    v_mfma_f32_16x16x32_bf16 a[136:139], v[88:91], v[36:39], a[136:139]
    v_add_f32 v6, v6, v19
    v_mfma_f32_16x16x32_bf16 a[184:187], v[76:79], v[32:35], a[184:187]
    v_exp_f32 v17, v117
    v_mfma_f32_16x16x32_bf16 a[184:187], v[92:95], v[36:39], a[184:187]
    s_waitcnt lgkmcnt(2)
    v_cvt_pk_bf16_f32 v181, v18, v19
    v_mfma_f32_16x16x32_bf16 a[44:47], v[64:67], v[40:43], a[44:47]
    ds_read_b128 v[32:35], v2 offset:6144
    v_mfma_f32_16x16x32_bf16 a[44:47], v[80:83], v[44:47], a[44:47]
    v_exp_f32 v18, v118
    v_mfma_f32_16x16x32_bf16 a[92:95], v[68:71], v[40:43], a[92:95]
    v_add_f32 v6, v6, v16
    v_add_f32 v6, v6, v17
    v_mfma_f32_16x16x32_bf16 a[92:95], v[84:87], v[44:47], a[92:95]
    v_exp_f32 v19, v119
    v_mfma_f32_16x16x32_bf16 a[140:143], v[72:75], v[40:43], a[140:143]
    ds_read_b128 v[36:39], v3 offset:6144
    v_cvt_pk_bf16_f32 v182, v16, v17
    v_mfma_f32_16x16x32_bf16 a[140:143], v[88:91], v[44:47], a[140:143]
    v_add_f32 v6, v6, v18
    v_add_f32 v6, v6, v19
    v_mfma_f32_16x16x32_bf16 a[188:191], v[76:79], v[40:43], a[188:191]
    v_cvt_pk_bf16_f32 v183, v18, v19
    v_mfma_f32_16x16x32_bf16 a[188:191], v[92:95], v[44:47], a[188:191]
    s_waitcnt lgkmcnt(2)
    v_mfma_f32_16x16x32_bf16 v[64:67], v[24:27], a[192:195], v[128:131]
    ds_read_b128 v[40:43], v2 offset:128
    v_mfma_f32_16x16x32_bf16 v[64:67], v[28:31], a[196:199], v[64:67]
    v_exp_f32 v16, v184
    v_mfma_f32_16x16x32_bf16 v[68:71], v[24:27], a[216:219], v[132:135]
    ds_read_b128 v[44:47], v3 offset:128
    v_mfma_f32_16x16x32_bf16 v[68:71], v[28:31], a[220:223], v[68:71]
    s_waitcnt lgkmcnt(2)
    v_exp_f32 v17, v185
    v_mfma_f32_16x16x32_bf16 v[96:99], v[32:35], a[192:195], v[128:131]
    ds_read_b128 v[24:27], v2 offset:6272
    v_mfma_f32_16x16x32_bf16 v[96:99], v[36:39], a[196:199], v[96:99]
    v_exp_f32 v18, v186
    v_mfma_f32_16x16x32_bf16 v[100:103], v[32:35], a[216:219], v[132:135]
    ds_read_b128 v[28:31], v3 offset:6272
    v_add_f32 v5, v5, v16
    v_mfma_f32_16x16x32_bf16 v[100:103], v[36:39], a[220:223], v[100:103]
    s_waitcnt lgkmcnt(2)
    v_add_f32 v5, v5, v17
    v_mfma_f32_16x16x32_bf16 v[64:67], v[40:43], a[200:203], v[64:67]
    ds_read_b128 v[32:35], v2 offset:256
    v_mfma_f32_16x16x32_bf16 v[64:67], v[44:47], a[204:207], v[64:67]
    v_exp_f32 v19, v187
    v_mfma_f32_16x16x32_bf16 v[68:71], v[40:43], a[224:227], v[68:71]
    ds_read_b128 v[36:39], v3 offset:256
    v_cvt_pk_bf16_f32 v184, v16, v17
    v_mfma_f32_16x16x32_bf16 v[68:71], v[44:47], a[228:231], v[68:71]
    s_waitcnt lgkmcnt(2)
    v_exp_f32 v16, v120
    v_mfma_f32_16x16x32_bf16 v[96:99], v[24:27], a[200:203], v[96:99]
    ds_read_b128 v[40:43], v2 offset:6400
    v_add_f32 v5, v5, v18
    v_mfma_f32_16x16x32_bf16 v[96:99], v[28:31], a[204:207], v[96:99]
    s_waitcnt vmcnt(0)
    v_add_f32 v5, v5, v19
    v_mfma_f32_16x16x32_bf16 v[100:103], v[24:27], a[224:227], v[100:103]
    ds_read_b128 v[44:47], v3 offset:6400
    v_mfma_f32_16x16x32_bf16 v[100:103], v[28:31], a[228:231], v[100:103]
    s_waitcnt lgkmcnt(2)
    s_barrier
    v_mfma_f32_16x16x32_bf16 v[64:67], v[32:35], a[208:211], v[64:67]
    s_mov_b32 m0, s56
    ds_read_b128 v[24:27], v2 offset:12288
    v_mfma_f32_16x16x32_bf16 v[64:67], v[36:39], a[212:215], v[64:67]
    buffer_load_dwordx4 v4, s[4:7], s27 offen offset:0 sc1 lds
    v_mfma_f32_16x16x32_bf16 v[68:71], v[32:35], a[232:235], v[68:71]
    ds_read_b128 v[28:31], v3 offset:12288
    v_mfma_f32_16x16x32_bf16 v[68:71], v[36:39], a[236:239], v[68:71]
    s_waitcnt lgkmcnt(2)
    v_exp_f32 v17, v121
    v_cvt_pk_bf16_f32 v185, v18, v19
    v_mfma_f32_16x16x32_bf16 v[96:99], v[40:43], a[208:211], v[96:99]
    ds_read_b128 v[32:35], v2 offset:18432
    v_mfma_f32_16x16x32_bf16 v[96:99], v[44:47], a[212:215], v[96:99]
    buffer_load_dwordx4 v4, s[4:7], s27 offen offset:1024 sc1 lds
    v_mfma_f32_16x16x32_bf16 v[100:103], v[40:43], a[232:235], v[100:103]
    ds_read_b128 v[36:39], v3 offset:18432
    v_mfma_f32_16x16x32_bf16 v[100:103], v[44:47], a[236:239], v[100:103]
    s_waitcnt lgkmcnt(2)
    v_exp_f32 v18, v122
    v_add_f32 v5, v5, v16
    v_mfma_f32_16x16x32_bf16 v[72:75], v[24:27], a[192:195], v[128:131]
    ds_read_b128 v[40:43], v2 offset:12416
    v_add_f32 v5, v5, v17
    v_mfma_f32_16x16x32_bf16 v[72:75], v[28:31], a[196:199], v[72:75]
    v_exp_f32 v19, v123
    v_cvt_pk_bf16_f32 v186, v16, v17
    v_mfma_f32_16x16x32_bf16 v[76:79], v[24:27], a[216:219], v[132:135]
    ds_read_b128 v[44:47], v3 offset:12416
    v_mfma_f32_16x16x32_bf16 v[76:79], v[28:31], a[220:223], v[76:79]
    s_waitcnt lgkmcnt(2)
    buffer_load_dwordx4 v4, s[4:7], s27 offen offset:2048 sc1 lds
    v_mfma_f32_16x16x32_bf16 v[104:107], v[32:35], a[192:195], v[128:131]
    ds_read_b128 v[24:27], v2 offset:18560
    v_mfma_f32_16x16x32_bf16 v[104:107], v[36:39], a[196:199], v[104:107]
    v_exp_f32 v16, v188
    v_add_f32 v5, v5, v18
    v_mfma_f32_16x16x32_bf16 v[108:111], v[32:35], a[216:219], v[132:135]
    ds_read_b128 v[28:31], v3 offset:18560
    v_add_f32 v5, v5, v19
    v_mfma_f32_16x16x32_bf16 v[108:111], v[36:39], a[220:223], v[108:111]
    s_waitcnt lgkmcnt(2)
    v_exp_f32 v17, v189
    v_cvt_pk_bf16_f32 v187, v18, v19
    v_mfma_f32_16x16x32_bf16 v[72:75], v[40:43], a[200:203], v[72:75]
    s_add_u32 s27, s27, 24576
    ds_read_b128 v[32:35], v2 offset:12544
    v_mfma_f32_16x16x32_bf16 v[72:75], v[44:47], a[204:207], v[72:75]
    v_exp_f32 v18, v190
    v_mfma_f32_16x16x32_bf16 v[76:79], v[40:43], a[224:227], v[76:79]
    s_add_u32 s56, s56, 12288
    ds_read_b128 v[36:39], v3 offset:12544
    v_add_f32 v6, v6, v16
    v_mfma_f32_16x16x32_bf16 v[76:79], v[44:47], a[228:231], v[76:79]
    s_waitcnt lgkmcnt(2)
    v_add_f32 v6, v6, v17
    v_mfma_f32_16x16x32_bf16 v[104:107], v[24:27], a[200:203], v[104:107]
    ds_read_b128 v[40:43], v2 offset:18688
    v_mfma_f32_16x16x32_bf16 v[104:107], v[28:31], a[204:207], v[104:107]
    v_exp_f32 v19, v191
    v_cvt_pk_bf16_f32 v188, v16, v17
    v_mfma_f32_16x16x32_bf16 v[108:111], v[24:27], a[224:227], v[108:111]
    s_mov_b32 m0, s56
    ds_read_b128 v[44:47], v3 offset:18688
    v_mfma_f32_16x16x32_bf16 v[108:111], v[28:31], a[228:231], v[108:111]
    s_waitcnt lgkmcnt(2)
    v_add_u32 v2, 49152, v2
    v_add_u32 v3, 49152, v3
    v_mfma_f32_16x16x32_bf16 v[72:75], v[32:35], a[208:211], v[72:75]
    ds_read_b128 v[24:27], v2 offset:0
    v_mfma_f32_16x16x32_bf16 v[72:75], v[36:39], a[212:215], v[72:75]
    buffer_load_dwordx4 v4, s[4:7], s27 offen offset:0 sc1 lds
    v_mfma_f32_16x16x32_bf16 v[76:79], v[32:35], a[232:235], v[76:79]
    ds_read_b128 v[28:31], v3 offset:0
    v_mfma_f32_16x16x32_bf16 v[76:79], v[36:39], a[236:239], v[76:79]
    s_waitcnt lgkmcnt(2)
    v_exp_f32 v16, v124
    v_add_f32 v6, v6, v18
    v_mfma_f32_16x16x32_bf16 v[104:107], v[40:43], a[208:211], v[104:107]
    ds_read_b128 v[32:35], v2 offset:6144
    v_add_f32 v6, v6, v19
    v_mfma_f32_16x16x32_bf16 v[104:107], v[44:47], a[212:215], v[104:107]
    v_exp_f32 v17, v125
    v_cvt_pk_bf16_f32 v189, v18, v19
    v_mfma_f32_16x16x32_bf16 v[108:111], v[40:43], a[232:235], v[108:111]
    ds_read_b128 v[36:39], v3 offset:6144
    v_mfma_f32_16x16x32_bf16 v[108:111], v[44:47], a[236:239], v[108:111]
    s_waitcnt lgkmcnt(2)
    buffer_load_dwordx4 v4, s[4:7], s27 offen offset:1024 sc1 lds
    v_mfma_f32_16x16x32_bf16 v[80:83], v[24:27], a[240:243], v[136:139]
    ds_read_b128 v[40:43], v2 offset:128
    v_mfma_f32_16x16x32_bf16 v[80:83], v[28:31], a[244:247], v[80:83]
    v_exp_f32 v18, v126
    v_add_f32 v6, v6, v16
    v_mfma_f32_16x16x32_bf16 v[84:87], v[24:27], v[200:203], v[140:143]
    ds_read_b128 v[44:47], v3 offset:128
    v_add_f32 v6, v6, v17
    v_exp_f32 v19, v127
    v_cvt_pk_bf16_f32 v190, v16, v17
    v_add_f32 v6, v6, v18
    v_add_f32 v6, v6, v19
    v_cvt_pk_bf16_f32 v191, v18, v19
    v_mfma_f32_16x16x32_bf16 v[84:87], v[28:31], v[204:207], v[84:87]
    s_waitcnt lgkmcnt(2)
    v_exp_f32 v16, v64
    v_mfma_f32_16x16x32_bf16 v[112:115], v[32:35], a[240:243], v[136:139]
    ds_read_b128 v[24:27], v2 offset:6272
    v_mfma_f32_16x16x32_bf16 v[112:115], v[36:39], a[244:247], v[112:115]
    buffer_load_dwordx4 v4, s[4:7], s27 offen offset:2048 sc1 lds
    v_mfma_f32_16x16x32_bf16 v[116:119], v[32:35], v[200:203], v[140:143]
    ds_read_b128 v[28:31], v3 offset:6272
    v_mfma_f32_16x16x32_bf16 v[116:119], v[36:39], v[204:207], v[116:119]
    s_waitcnt lgkmcnt(2)
    v_exp_f32 v17, v65
    v_mfma_f32_16x16x32_bf16 v[80:83], v[40:43], a[248:251], v[80:83]
    ds_read_b128 v[32:35], v2 offset:256
    v_mfma_f32_16x16x32_bf16 v[80:83], v[44:47], a[252:255], v[80:83]
    v_exp_f32 v18, v66
    v_mfma_f32_16x16x32_bf16 v[84:87], v[40:43], v[208:211], v[84:87]
    ds_read_b128 v[36:39], v3 offset:256
    v_add_f32 v5, v5, v16
    v_mfma_f32_16x16x32_bf16 v[84:87], v[44:47], v[212:215], v[84:87]
    s_waitcnt lgkmcnt(2)
    v_add_f32 v5, v5, v17
    v_mfma_f32_16x16x32_bf16 v[112:115], v[24:27], a[248:251], v[112:115]
    ds_read_b128 v[40:43], v2 offset:6400
    v_mfma_f32_16x16x32_bf16 v[112:115], v[28:31], a[252:255], v[112:115]
    v_exp_f32 v19, v67
    v_cvt_pk_bf16_f32 v64, v16, v17
    v_mfma_f32_16x16x32_bf16 v[116:119], v[24:27], v[208:211], v[116:119]
    s_add_u32 s27, s27, 24576
    ds_read_b128 v[44:47], v3 offset:6400
    s_add_u32 s56, s56, 36864
    v_mfma_f32_16x16x32_bf16 v[116:119], v[28:31], v[212:215], v[116:119]
    s_waitcnt lgkmcnt(2)
    v_exp_f32 v16, v96
    v_mfma_f32_16x16x32_bf16 v[80:83], v[32:35], v[192:195], v[80:83]
    s_sub_u32 s58, s56, 147456
    ds_read_b128 v[24:27], v2 offset:12288
    v_add_f32 v5, v5, v18
    v_mfma_f32_16x16x32_bf16 v[80:83], v[36:39], v[196:199], v[80:83]
    s_min_u32 s56, s56, s58
    v_add_f32 v5, v5, v19
    v_mfma_f32_16x16x32_bf16 v[84:87], v[32:35], v[216:219], v[84:87]
    ds_read_b128 v[28:31], v3 offset:12288
    v_mfma_f32_16x16x32_bf16 v[84:87], v[36:39], v[220:223], v[84:87]
    s_waitcnt lgkmcnt(2)
    v_exp_f32 v17, v97
    v_cvt_pk_bf16_f32 v65, v18, v19
    v_mfma_f32_16x16x32_bf16 v[112:115], v[40:43], v[192:195], v[112:115]
    ds_read_b128 v[32:35], v2 offset:18432
    v_mfma_f32_16x16x32_bf16 v[112:115], v[44:47], v[196:199], v[112:115]
    v_exp_f32 v18, v98
    v_mfma_f32_16x16x32_bf16 v[116:119], v[40:43], v[216:219], v[116:119]
    ds_read_b128 v[36:39], v3 offset:18432
    v_add_f32 v5, v5, v16
    v_mfma_f32_16x16x32_bf16 v[116:119], v[44:47], v[220:223], v[116:119]
    s_waitcnt lgkmcnt(2)
    v_add_f32 v5, v5, v17
    v_mfma_f32_16x16x32_bf16 v[88:91], v[24:27], a[240:243], v[136:139]
    ds_read_b128 v[40:43], v2 offset:12416
    v_mfma_f32_16x16x32_bf16 v[88:91], v[28:31], a[244:247], v[88:91]
    v_exp_f32 v19, v99
    v_cvt_pk_bf16_f32 v66, v16, v17
    v_mfma_f32_16x16x32_bf16 v[92:95], v[24:27], v[200:203], v[140:143]
    ds_read_b128 v[44:47], v3 offset:12416
    v_mfma_f32_16x16x32_bf16 v[92:95], v[28:31], v[204:207], v[92:95]
    s_waitcnt lgkmcnt(2)
    v_exp_f32 v16, v68
    v_mfma_f32_16x16x32_bf16 v[120:123], v[32:35], a[240:243], v[136:139]
    ds_read_b128 v[24:27], v2 offset:18560
    v_add_f32 v5, v5, v18
    v_mfma_f32_16x16x32_bf16 v[120:123], v[36:39], a[244:247], v[120:123]
    v_add_f32 v5, v5, v19
    v_mfma_f32_16x16x32_bf16 v[124:127], v[32:35], v[200:203], v[140:143]
    ds_read_b128 v[28:31], v3 offset:18560
    v_mfma_f32_16x16x32_bf16 v[124:127], v[36:39], v[204:207], v[124:127]
    s_waitcnt lgkmcnt(2)
    v_exp_f32 v17, v69
    v_cvt_pk_bf16_f32 v67, v18, v19
    v_mfma_f32_16x16x32_bf16 v[88:91], v[40:43], a[248:251], v[88:91]
    ds_read_b128 v[32:35], v2 offset:12544
    v_mfma_f32_16x16x32_bf16 v[88:91], v[44:47], a[252:255], v[88:91]
    v_exp_f32 v18, v70
    v_mfma_f32_16x16x32_bf16 v[92:95], v[40:43], v[208:211], v[92:95]
    ds_read_b128 v[36:39], v3 offset:12544
    v_add_f32 v6, v6, v16
    v_mfma_f32_16x16x32_bf16 v[92:95], v[44:47], v[212:215], v[92:95]
    s_waitcnt lgkmcnt(2)
    v_add_f32 v6, v6, v17
    v_mfma_f32_16x16x32_bf16 v[120:123], v[24:27], a[248:251], v[120:123]
    ds_read_b128 v[40:43], v2 offset:18688
    v_mfma_f32_16x16x32_bf16 v[120:123], v[28:31], a[252:255], v[120:123]
    v_exp_f32 v19, v71
    v_cvt_pk_bf16_f32 v68, v16, v17
    v_mfma_f32_16x16x32_bf16 v[124:127], v[24:27], v[208:211], v[124:127]
    ds_read_b128 v[44:47], v3 offset:18688
    v_mfma_f32_16x16x32_bf16 v[124:127], v[28:31], v[212:215], v[124:127]
    s_waitcnt lgkmcnt(2)
    v_add_u32 v1, 49152, v1
    v_exp_f32 v16, v100
    v_mfma_f32_16x16x32_bf16 v[88:91], v[32:35], v[192:195], v[88:91]
    ds_read_b128 v[24:27], v1 offset:0
    v_add_f32 v6, v6, v18
    v_mfma_f32_16x16x32_bf16 v[88:91], v[36:39], v[196:199], v[88:91]
    v_add_f32 v6, v6, v19
    v_mfma_f32_16x16x32_bf16 v[92:95], v[32:35], v[216:219], v[92:95]
    ds_read_b128 v[28:31], v1 offset:12288
    v_mfma_f32_16x16x32_bf16 v[92:95], v[36:39], v[220:223], v[92:95]
    s_waitcnt lgkmcnt(2)
    v_exp_f32 v17, v101
    v_cvt_pk_bf16_f32 v69, v18, v19
    v_mfma_f32_16x16x32_bf16 v[120:123], v[40:43], v[192:195], v[120:123]
    ds_read_b128 v[32:35], v1 offset:1024
    v_mfma_f32_16x16x32_bf16 v[120:123], v[44:47], v[196:199], v[120:123]
    v_exp_f32 v18, v102
    v_mfma_f32_16x16x32_bf16 v[124:127], v[40:43], v[216:219], v[124:127]
    ds_read_b128 v[36:39], v1 offset:13312
    v_add_f32 v6, v6, v16
    v_mfma_f32_16x16x32_bf16 v[124:127], v[44:47], v[220:223], v[124:127]
    s_waitcnt lgkmcnt(2)
    v_add_f32 v6, v6, v17
    v_exp_f32 v19, v103
    v_cvt_pk_bf16_f32 v70, v16, v17
    v_add_f32 v6, v6, v18
    v_add_f32 v6, v6, v19
    v_cvt_pk_bf16_f32 v71, v18, v19
    v_mfma_f32_16x16x32_bf16 a[0:3], v[160:163], v[24:27], a[0:3]
    ds_read_b128 v[40:43], v1 offset:2048
    v_mfma_f32_16x16x32_bf16 a[0:3], v[168:171], v[28:31], a[0:3]
    v_exp_f32 v16, v72
    v_mfma_f32_16x16x32_bf16 a[48:51], v[164:167], v[24:27], a[48:51]
    ds_read_b128 v[44:47], v1 offset:14336
    v_mfma_f32_16x16x32_bf16 a[48:51], v[172:175], v[28:31], a[48:51]
    s_waitcnt lgkmcnt(2)
    v_exp_f32 v17, v73
    v_mfma_f32_16x16x32_bf16 a[4:7], v[160:163], v[32:35], a[4:7]
    ds_read_b128 v[24:27], v1 offset:3072
    v_mfma_f32_16x16x32_bf16 a[4:7], v[168:171], v[36:39], a[4:7]
    v_exp_f32 v18, v74
    v_mfma_f32_16x16x32_bf16 a[52:55], v[164:167], v[32:35], a[52:55]
    ds_read_b128 v[28:31], v1 offset:15360
    v_add_f32 v5, v5, v16
    v_mfma_f32_16x16x32_bf16 a[52:55], v[172:175], v[36:39], a[52:55]
    s_waitcnt lgkmcnt(2)
    v_add_f32 v5, v5, v17
    v_mfma_f32_16x16x32_bf16 a[8:11], v[160:163], v[40:43], a[8:11]
    ds_read_b128 v[32:35], v1 offset:4096
    v_mfma_f32_16x16x32_bf16 a[8:11], v[168:171], v[44:47], a[8:11]
    v_exp_f32 v19, v75
    v_mfma_f32_16x16x32_bf16 a[56:59], v[164:167], v[40:43], a[56:59]
    ds_read_b128 v[36:39], v1 offset:16384
    v_cvt_pk_bf16_f32 v72, v16, v17
    v_mfma_f32_16x16x32_bf16 a[56:59], v[172:175], v[44:47], a[56:59]
    s_waitcnt lgkmcnt(2)
    v_exp_f32 v16, v104
    v_mfma_f32_16x16x32_bf16 a[12:15], v[160:163], v[24:27], a[12:15]
    ds_read_b128 v[40:43], v1 offset:5120
    v_add_f32 v5, v5, v18
    v_mfma_f32_16x16x32_bf16 a[12:15], v[168:171], v[28:31], a[12:15]
    v_add_f32 v5, v5, v19
    v_mfma_f32_16x16x32_bf16 a[60:63], v[164:167], v[24:27], a[60:63]
    ds_read_b128 v[44:47], v1 offset:17408
    v_mfma_f32_16x16x32_bf16 a[60:63], v[172:175], v[28:31], a[60:63]
    s_waitcnt lgkmcnt(2)
    v_exp_f32 v17, v105
    v_mfma_f32_16x16x32_bf16 a[16:19], v[160:163], v[32:35], a[16:19]
    ds_read_b128 v[24:27], v1 offset:6144
    v_cvt_pk_bf16_f32 v73, v18, v19
    v_mfma_f32_16x16x32_bf16 a[16:19], v[168:171], v[36:39], a[16:19]
    v_exp_f32 v18, v106
    v_mfma_f32_16x16x32_bf16 a[64:67], v[164:167], v[32:35], a[64:67]
    ds_read_b128 v[28:31], v1 offset:18432
    v_add_f32 v5, v5, v16
    v_mfma_f32_16x16x32_bf16 a[64:67], v[172:175], v[36:39], a[64:67]
    s_waitcnt lgkmcnt(2)
    v_add_f32 v5, v5, v17
    v_mfma_f32_16x16x32_bf16 a[20:23], v[160:163], v[40:43], a[20:23]
    ds_read_b128 v[32:35], v1 offset:7168
    v_mfma_f32_16x16x32_bf16 a[20:23], v[168:171], v[44:47], a[20:23]
    v_exp_f32 v19, v107
    v_mfma_f32_16x16x32_bf16 a[68:71], v[164:167], v[40:43], a[68:71]
    ds_read_b128 v[36:39], v1 offset:19456
    v_cvt_pk_bf16_f32 v74, v16, v17
    v_mfma_f32_16x16x32_bf16 a[68:71], v[172:175], v[44:47], a[68:71]
    s_waitcnt lgkmcnt(2)
    v_exp_f32 v16, v76
    v_mfma_f32_16x16x32_bf16 a[24:27], v[160:163], v[24:27], a[24:27]
    ds_read_b128 v[40:43], v1 offset:8192
    v_add_f32 v5, v5, v18
    v_mfma_f32_16x16x32_bf16 a[24:27], v[168:171], v[28:31], a[24:27]
    v_add_f32 v5, v5, v19
    v_mfma_f32_16x16x32_bf16 a[72:75], v[164:167], v[24:27], a[72:75]
    ds_read_b128 v[44:47], v1 offset:20480
    v_mfma_f32_16x16x32_bf16 a[72:75], v[172:175], v[28:31], a[72:75]
    s_waitcnt lgkmcnt(2)
    v_exp_f32 v17, v77
    v_mfma_f32_16x16x32_bf16 a[28:31], v[160:163], v[32:35], a[28:31]
    ds_read_b128 v[24:27], v1 offset:9216
    v_cvt_pk_bf16_f32 v75, v18, v19
    v_mfma_f32_16x16x32_bf16 a[28:31], v[168:171], v[36:39], a[28:31]
    v_exp_f32 v18, v78
    v_mfma_f32_16x16x32_bf16 a[76:79], v[164:167], v[32:35], a[76:79]
    ds_read_b128 v[28:31], v1 offset:21504
    v_add_f32 v6, v6, v16
    v_mfma_f32_16x16x32_bf16 a[76:79], v[172:175], v[36:39], a[76:79]
    s_waitcnt lgkmcnt(2)
    v_add_f32 v6, v6, v17
    v_mfma_f32_16x16x32_bf16 a[32:35], v[160:163], v[40:43], a[32:35]
    ds_read_b128 v[32:35], v1 offset:10240
    v_mfma_f32_16x16x32_bf16 a[32:35], v[168:171], v[44:47], a[32:35]
    v_exp_f32 v19, v79
    v_mfma_f32_16x16x32_bf16 a[80:83], v[164:167], v[40:43], a[80:83]
    ds_read_b128 v[36:39], v1 offset:22528
    v_cvt_pk_bf16_f32 v76, v16, v17
    v_mfma_f32_16x16x32_bf16 a[80:83], v[172:175], v[44:47], a[80:83]
    s_waitcnt lgkmcnt(2)
    v_exp_f32 v16, v108
    v_mfma_f32_16x16x32_bf16 a[36:39], v[160:163], v[24:27], a[36:39]
    ds_read_b128 v[40:43], v1 offset:11264
    v_add_f32 v6, v6, v18
    v_mfma_f32_16x16x32_bf16 a[36:39], v[168:171], v[28:31], a[36:39]
    v_add_f32 v6, v6, v19
    v_mfma_f32_16x16x32_bf16 a[84:87], v[164:167], v[24:27], a[84:87]
    ds_read_b128 v[44:47], v1 offset:23552
    v_mfma_f32_16x16x32_bf16 a[84:87], v[172:175], v[28:31], a[84:87]
    s_waitcnt lgkmcnt(2)
    v_subrev_u32 v1, 98304, v1
    v_mfma_f32_16x16x32_bf16 a[40:43], v[160:163], v[32:35], a[40:43]
    ds_read_b128 v[24:27], v1 offset:0
    v_mfma_f32_16x16x32_bf16 a[40:43], v[168:171], v[36:39], a[40:43]
    v_exp_f32 v17, v109
    v_mfma_f32_16x16x32_bf16 a[88:91], v[164:167], v[32:35], a[88:91]
    ds_read_b128 v[28:31], v1 offset:12288
    v_cvt_pk_bf16_f32 v77, v18, v19
    v_mfma_f32_16x16x32_bf16 a[88:91], v[172:175], v[36:39], a[88:91]
    s_waitcnt lgkmcnt(2)
    v_exp_f32 v18, v110
    v_mfma_f32_16x16x32_bf16 a[44:47], v[160:163], v[40:43], a[44:47]
    ds_read_b128 v[32:35], v1 offset:1024
    v_add_f32 v6, v6, v16
    v_mfma_f32_16x16x32_bf16 a[44:47], v[168:171], v[44:47], a[44:47]
    v_add_f32 v6, v6, v17
    v_mfma_f32_16x16x32_bf16 a[92:95], v[164:167], v[40:43], a[92:95]
    ds_read_b128 v[36:39], v1 offset:13312
    v_mfma_f32_16x16x32_bf16 a[92:95], v[172:175], v[44:47], a[92:95]
    s_waitcnt lgkmcnt(2)
    v_exp_f32 v19, v111
    v_mfma_f32_16x16x32_bf16 a[0:3], v[176:179], v[24:27], a[0:3]
    ds_read_b128 v[40:43], v1 offset:2048
    v_cvt_pk_bf16_f32 v78, v16, v17
    v_mfma_f32_16x16x32_bf16 a[0:3], v[184:187], v[28:31], a[0:3]
    v_add_f32 v6, v6, v18
    v_add_f32 v6, v6, v19
    v_mfma_f32_16x16x32_bf16 a[48:51], v[180:183], v[24:27], a[48:51]
    ds_read_b128 v[44:47], v1 offset:14336
    v_cvt_pk_bf16_f32 v79, v18, v19
    v_mfma_f32_16x16x32_bf16 a[48:51], v[188:191], v[28:31], a[48:51]
    s_waitcnt lgkmcnt(2)
    v_exp_f32 v16, v80
    v_mfma_f32_16x16x32_bf16 a[4:7], v[176:179], v[32:35], a[4:7]
    ds_read_b128 v[24:27], v1 offset:3072
    v_mfma_f32_16x16x32_bf16 a[4:7], v[184:187], v[36:39], a[4:7]
    v_exp_f32 v17, v81
    v_mfma_f32_16x16x32_bf16 a[52:55], v[180:183], v[32:35], a[52:55]
    ds_read_b128 v[28:31], v1 offset:15360
    v_mfma_f32_16x16x32_bf16 a[52:55], v[188:191], v[36:39], a[52:55]
    s_waitcnt lgkmcnt(2)
    v_exp_f32 v18, v82
    v_mfma_f32_16x16x32_bf16 a[8:11], v[176:179], v[40:43], a[8:11]
    ds_read_b128 v[32:35], v1 offset:4096
    v_add_f32 v7, v7, v16
    v_mfma_f32_16x16x32_bf16 a[8:11], v[184:187], v[44:47], a[8:11]
    v_add_f32 v7, v7, v17
    v_mfma_f32_16x16x32_bf16 a[56:59], v[180:183], v[40:43], a[56:59]
    ds_read_b128 v[36:39], v1 offset:16384
    v_mfma_f32_16x16x32_bf16 a[56:59], v[188:191], v[44:47], a[56:59]
    s_waitcnt lgkmcnt(2)
    v_exp_f32 v19, v83
    v_mfma_f32_16x16x32_bf16 a[12:15], v[176:179], v[24:27], a[12:15]
    ds_read_b128 v[40:43], v1 offset:5120
    v_cvt_pk_bf16_f32 v80, v16, v17
    v_mfma_f32_16x16x32_bf16 a[12:15], v[184:187], v[28:31], a[12:15]
    v_exp_f32 v16, v112
    v_mfma_f32_16x16x32_bf16 a[60:63], v[180:183], v[24:27], a[60:63]
    ds_read_b128 v[44:47], v1 offset:17408
    v_add_f32 v7, v7, v18
    v_mfma_f32_16x16x32_bf16 a[60:63], v[188:191], v[28:31], a[60:63]
L_pg12:
    s_cbranch_execz L_iwret
    s_waitcnt lgkmcnt(2)
    v_add_f32 v7, v7, v19
    v_mfma_f32_16x16x32_bf16 a[16:19], v[176:179], v[32:35], a[16:19]
    ds_read_b128 v[24:27], v1 offset:6144
    v_mfma_f32_16x16x32_bf16 a[16:19], v[184:187], v[36:39], a[16:19]
    v_exp_f32 v17, v113
    v_mfma_f32_16x16x32_bf16 a[64:67], v[180:183], v[32:35], a[64:67]
    ds_read_b128 v[28:31], v1 offset:18432
    v_cvt_pk_bf16_f32 v81, v18, v19
    v_mfma_f32_16x16x32_bf16 a[64:67], v[188:191], v[36:39], a[64:67]
    s_waitcnt lgkmcnt(2)
    v_exp_f32 v18, v114
    v_mfma_f32_16x16x32_bf16 a[20:23], v[176:179], v[40:43], a[20:23]
    ds_read_b128 v[32:35], v1 offset:7168
    v_add_f32 v7, v7, v16
    v_mfma_f32_16x16x32_bf16 a[20:23], v[184:187], v[44:47], a[20:23]
    v_add_f32 v7, v7, v17
    v_mfma_f32_16x16x32_bf16 a[68:71], v[180:183], v[40:43], a[68:71]
    ds_read_b128 v[36:39], v1 offset:19456
    v_mfma_f32_16x16x32_bf16 a[68:71], v[188:191], v[44:47], a[68:71]
    s_waitcnt lgkmcnt(2)
    v_exp_f32 v19, v115
    v_mfma_f32_16x16x32_bf16 a[24:27], v[176:179], v[24:27], a[24:27]
    ds_read_b128 v[40:43], v1 offset:8192
    v_cvt_pk_bf16_f32 v82, v16, v17
    v_mfma_f32_16x16x32_bf16 a[24:27], v[184:187], v[28:31], a[24:27]
    v_exp_f32 v16, v84
    v_mfma_f32_16x16x32_bf16 a[72:75], v[180:183], v[24:27], a[72:75]
    ds_read_b128 v[44:47], v1 offset:20480
    v_add_f32 v7, v7, v18
    v_mfma_f32_16x16x32_bf16 a[72:75], v[188:191], v[28:31], a[72:75]
    s_waitcnt lgkmcnt(2)
    v_add_f32 v7, v7, v19
    v_mfma_f32_16x16x32_bf16 a[28:31], v[176:179], v[32:35], a[28:31]
    ds_read_b128 v[24:27], v1 offset:9216
    v_mfma_f32_16x16x32_bf16 a[28:31], v[184:187], v[36:39], a[28:31]
    s_waitcnt vmcnt(0)
    v_exp_f32 v17, v85
    v_mfma_f32_16x16x32_bf16 a[76:79], v[180:183], v[32:35], a[76:79]
    ds_read_b128 v[28:31], v1 offset:21504
    v_cvt_pk_bf16_f32 v83, v18, v19
    v_mfma_f32_16x16x32_bf16 a[76:79], v[188:191], v[36:39], a[76:79]
    s_waitcnt lgkmcnt(2)
    s_barrier
    v_mfma_f32_16x16x32_bf16 a[32:35], v[176:179], v[40:43], a[32:35]
    ds_read_b128 v[32:35], v1 offset:10240
    v_mfma_f32_16x16x32_bf16 a[32:35], v[184:187], v[44:47], a[32:35]
    v_exp_f32 v18, v86
    v_mfma_f32_16x16x32_bf16 a[80:83], v[180:183], v[40:43], a[80:83]
    ds_read_b128 v[36:39], v1 offset:22528
    v_add_f32 v8, v8, v16
    v_mfma_f32_16x16x32_bf16 a[80:83], v[188:191], v[44:47], a[80:83]
    s_waitcnt lgkmcnt(2)
    v_add_f32 v8, v8, v17
    v_mfma_f32_16x16x32_bf16 a[36:39], v[176:179], v[24:27], a[36:39]
    ds_read_b128 v[40:43], v1 offset:11264
    v_mfma_f32_16x16x32_bf16 a[36:39], v[184:187], v[28:31], a[36:39]
    v_exp_f32 v19, v87
    v_cvt_pk_bf16_f32 v84, v16, v17
    v_mfma_f32_16x16x32_bf16 a[84:87], v[180:183], v[24:27], a[84:87]
    ds_read_b128 v[44:47], v1 offset:23552
    v_mfma_f32_16x16x32_bf16 a[84:87], v[188:191], v[28:31], a[84:87]
    s_waitcnt lgkmcnt(2)
    v_add_u32 v1, 49152, v1
    v_exp_f32 v16, v116
    v_mfma_f32_16x16x32_bf16 a[40:43], v[176:179], v[32:35], a[40:43]
    ds_read_b128 v[24:27], v1 offset:0
    v_add_f32 v8, v8, v18
    v_mfma_f32_16x16x32_bf16 a[40:43], v[184:187], v[36:39], a[40:43]
    v_add_f32 v8, v8, v19
    v_mfma_f32_16x16x32_bf16 a[88:91], v[180:183], v[32:35], a[88:91]
    ds_read_b128 v[28:31], v1 offset:12288
    v_mfma_f32_16x16x32_bf16 a[88:91], v[188:191], v[36:39], a[88:91]
    s_waitcnt lgkmcnt(2)
    v_exp_f32 v17, v117
    v_cvt_pk_bf16_f32 v85, v18, v19
    v_mfma_f32_16x16x32_bf16 a[44:47], v[176:179], v[40:43], a[44:47]
    ds_read_b128 v[32:35], v1 offset:1024
    v_mfma_f32_16x16x32_bf16 a[44:47], v[184:187], v[44:47], a[44:47]
    v_exp_f32 v18, v118
    v_mfma_f32_16x16x32_bf16 a[92:95], v[180:183], v[40:43], a[92:95]
    ds_read_b128 v[36:39], v1 offset:13312
    v_add_f32 v8, v8, v16
    v_mfma_f32_16x16x32_bf16 a[92:95], v[188:191], v[44:47], a[92:95]
    s_waitcnt lgkmcnt(2)
    v_add_f32 v8, v8, v17
    v_exp_f32 v19, v119
    v_cvt_pk_bf16_f32 v86, v16, v17
    v_add_f32 v8, v8, v18
    v_add_f32 v8, v8, v19
    v_cvt_pk_bf16_f32 v87, v18, v19
    v_mfma_f32_16x16x32_bf16 a[0:3], v[64:67], v[24:27], a[0:3]
    ds_read_b128 v[40:43], v1 offset:2048
    v_mfma_f32_16x16x32_bf16 a[0:3], v[72:75], v[28:31], a[0:3]
    v_exp_f32 v16, v88
    v_exp_f32 v17, v89
    v_exp_f32 v18, v90
    v_mfma_f32_16x16x4_f32 v[48:51], v5, v57, 0
    v_mfma_f32_16x16x32_bf16 a[48:51], v[68:71], v[24:27], a[48:51]
    ds_read_b128 v[44:47], v1 offset:14336
    v_mfma_f32_16x16x32_bf16 a[48:51], v[76:79], v[28:31], a[48:51]
    s_waitcnt lgkmcnt(2)
    v_exp_f32 v19, v91
    v_cvt_pk_bf16_f32 v88, v16, v17
    v_exp_f32 v16, v120
    v_mfma_f32_16x16x4_f32 v[52:55], v6, v57, 0
    v_mfma_f32_16x16x32_bf16 a[4:7], v[64:67], v[32:35], a[4:7]
    ds_read_b128 v[24:27], v1 offset:3072
    v_mfma_f32_16x16x32_bf16 a[4:7], v[72:75], v[36:39], a[4:7]
    v_exp_f32 v17, v121
    v_cvt_pk_bf16_f32 v89, v18, v19
    v_mfma_f32_16x16x32_bf16 a[52:55], v[68:71], v[32:35], a[52:55]
    ds_read_b128 v[28:31], v1 offset:15360
    v_mfma_f32_16x16x32_bf16 a[52:55], v[76:79], v[36:39], a[52:55]
    s_waitcnt lgkmcnt(2)
    v_exp_f32 v18, v122
    v_mfma_f32_16x16x32_bf16 a[8:11], v[64:67], v[40:43], a[8:11]
    ds_read_b128 v[32:35], v1 offset:4096
    v_mfma_f32_16x16x32_bf16 a[8:11], v[72:75], v[44:47], a[8:11]
    v_exp_f32 v19, v123
    v_mfma_f32_16x16x32_bf16 a[56:59], v[68:71], v[40:43], a[56:59]
    ds_read_b128 v[36:39], v1 offset:16384
    v_cvt_pk_bf16_f32 v90, v16, v17
    v_mfma_f32_16x16x32_bf16 a[56:59], v[76:79], v[44:47], a[56:59]
    s_waitcnt lgkmcnt(2)
    v_exp_f32 v16, v92
    v_mfma_f32_16x16x32_bf16 a[12:15], v[64:67], v[24:27], a[12:15]
    ds_read_b128 v[40:43], v1 offset:5120
    v_mfma_f32_16x16x32_bf16 a[12:15], v[72:75], v[28:31], a[12:15]
    v_exp_f32 v17, v93
    v_mfma_f32_16x16x32_bf16 a[60:63], v[68:71], v[24:27], a[60:63]
    ds_read_b128 v[44:47], v1 offset:17408
    v_cvt_pk_bf16_f32 v91, v18, v19
    v_mfma_f32_16x16x32_bf16 a[60:63], v[76:79], v[28:31], a[60:63]
    s_waitcnt lgkmcnt(2)
    v_exp_f32 v18, v94
    v_mfma_f32_16x16x32_bf16 a[16:19], v[64:67], v[32:35], a[16:19]
    ds_read_b128 v[24:27], v1 offset:6144
    v_mfma_f32_16x16x32_bf16 a[16:19], v[72:75], v[36:39], a[16:19]
    v_exp_f32 v19, v95
    v_mfma_f32_16x16x32_bf16 a[64:67], v[68:71], v[32:35], a[64:67]
    ds_read_b128 v[28:31], v1 offset:18432
    v_mfma_f32_16x16x32_bf16 a[64:67], v[76:79], v[36:39], a[64:67]
    s_waitcnt lgkmcnt(2)
    v_mfma_f32_16x16x32_bf16 v[128:131], v[88:91], v[20:23], 0
    v_mfma_f32_16x16x32_bf16 a[20:23], v[64:67], v[40:43], a[20:23]
    ds_read_b128 v[32:35], v1 offset:7168
    v_cvt_pk_bf16_f32 v92, v16, v17
    v_mfma_f32_16x16x32_bf16 a[20:23], v[72:75], v[44:47], a[20:23]
    v_exp_f32 v16, v124
    v_mfma_f32_16x16x32_bf16 a[68:71], v[68:71], v[40:43], a[68:71]
    ds_read_b128 v[36:39], v1 offset:19456
    v_mfma_f32_16x16x32_bf16 a[68:71], v[76:79], v[44:47], a[68:71]
    s_waitcnt lgkmcnt(2)
    v_exp_f32 v17, v125
    v_mfma_f32_16x16x32_bf16 a[24:27], v[64:67], v[24:27], a[24:27]
    ds_read_b128 v[40:43], v1 offset:8192
    v_cvt_pk_bf16_f32 v93, v18, v19
    v_mfma_f32_16x16x32_bf16 a[24:27], v[72:75], v[28:31], a[24:27]
    v_exp_f32 v18, v126
    v_mfma_f32_16x16x32_bf16 a[72:75], v[68:71], v[24:27], a[72:75]
    ds_read_b128 v[44:47], v1 offset:20480
    v_mfma_f32_16x16x32_bf16 a[72:75], v[76:79], v[28:31], a[72:75]
    s_waitcnt lgkmcnt(2)
    v_exp_f32 v19, v127
    v_mfma_f32_16x16x32_bf16 a[28:31], v[64:67], v[32:35], a[28:31]
    ds_read_b128 v[24:27], v1 offset:9216
    v_cvt_pk_bf16_f32 v94, v16, v17
    v_mfma_f32_16x16x32_bf16 a[28:31], v[72:75], v[36:39], a[28:31]
    v_cvt_pk_bf16_f32 v95, v18, v19
    s_nop 1
    v_mfma_f32_16x16x32_bf16 a[76:79], v[68:71], v[32:35], a[76:79]
    ds_read_b128 v[28:31], v1 offset:21504
    v_mfma_f32_16x16x32_bf16 a[76:79], v[76:79], v[36:39], a[76:79]
    s_waitcnt lgkmcnt(2)
    v_mfma_f32_16x16x32_bf16 v[132:135], v[92:95], v[20:23], 0
    v_mfma_f32_16x16x32_bf16 a[32:35], v[64:67], v[40:43], a[32:35]
    ds_read_b128 v[32:35], v1 offset:10240
    v_mfma_f32_16x16x32_bf16 a[32:35], v[72:75], v[44:47], a[32:35]
    v_rcp_f32 v48, v48
    v_mfma_f32_16x16x32_bf16 a[80:83], v[68:71], v[40:43], a[80:83]
    ds_read_b128 v[36:39], v1 offset:22528
    v_mfma_f32_16x16x32_bf16 a[80:83], v[76:79], v[44:47], a[80:83]
    s_waitcnt lgkmcnt(2)
    v_rcp_f32 v49, v49
    v_mfma_f32_16x16x32_bf16 a[36:39], v[64:67], v[24:27], a[36:39]
    ds_read_b128 v[40:43], v1 offset:11264
    v_mfma_f32_16x16x32_bf16 a[36:39], v[72:75], v[28:31], a[36:39]
    v_rcp_f32 v50, v50
    v_mfma_f32_16x16x32_bf16 a[84:87], v[68:71], v[24:27], a[84:87]
    ds_read_b128 v[44:47], v1 offset:23552
    v_mfma_f32_16x16x32_bf16 a[84:87], v[76:79], v[28:31], a[84:87]
    s_waitcnt lgkmcnt(2)
    v_subrev_u32 v2, 98304, v2
    v_subrev_u32 v3, 98304, v3
    v_mfma_f32_16x16x32_bf16 a[40:43], v[64:67], v[32:35], a[40:43]
    ds_read_b128 v[24:27], v2 offset:0
    v_mfma_f32_16x16x32_bf16 a[40:43], v[72:75], v[36:39], a[40:43]
    v_rcp_f32 v51, v51
    v_mfma_f32_16x16x32_bf16 a[88:91], v[68:71], v[32:35], a[88:91]
    ds_read_b128 v[28:31], v3 offset:0
    v_mfma_f32_16x16x32_bf16 a[88:91], v[76:79], v[36:39], a[88:91]
    s_waitcnt lgkmcnt(2)
    v_rcp_f32 v52, v52
    v_mfma_f32_16x16x32_bf16 a[44:47], v[64:67], v[40:43], a[44:47]
    ds_read_b128 v[32:35], v2 offset:6144
    v_mfma_f32_16x16x32_bf16 a[44:47], v[72:75], v[44:47], a[44:47]
    v_rcp_f32 v53, v53
    v_mfma_f32_16x16x32_bf16 a[92:95], v[68:71], v[40:43], a[92:95]
    ds_read_b128 v[36:39], v3 offset:6144
    v_mfma_f32_16x16x32_bf16 a[92:95], v[76:79], v[44:47], a[92:95]
    s_waitcnt lgkmcnt(2)
    v_rcp_f32 v54, v54
    v_mfma_f32_16x16x32_bf16 v[160:163], v[24:27], a[240:243], v[136:139]
    ds_read_b128 v[40:43], v2 offset:128
    v_mfma_f32_16x16x32_bf16 v[160:163], v[28:31], a[244:247], v[160:163]
    v_rcp_f32 v55, v55
    v_mfma_f32_16x16x32_bf16 v[164:167], v[24:27], v[200:203], v[140:143]
    ds_read_b128 v[44:47], v3 offset:128
    v_mfma_f32_16x16x32_bf16 v[164:167], v[28:31], v[204:207], v[164:167]
    s_waitcnt lgkmcnt(2)
    v_mfma_f32_16x16x32_bf16 v[96:99], v[32:35], a[240:243], v[136:139]
    ds_read_b128 v[24:27], v2 offset:6272
    v_accvgpr_read_b32 v224, a0
    v_mfma_f32_16x16x32_bf16 v[96:99], v[36:39], a[244:247], v[96:99]
    v_accvgpr_read_b32 v225, a4
    v_accvgpr_read_b32 v226, a8
    v_accvgpr_read_b32 v227, a12
    v_accvgpr_read_b32 v228, a16
    v_accvgpr_read_b32 v229, a20
    v_mfma_f32_16x16x32_bf16 v[100:103], v[32:35], v[200:203], v[140:143]
    ds_read_b128 v[28:31], v3 offset:6272
    v_mul_f32 v224, v224, v48
    v_mfma_f32_16x16x32_bf16 v[100:103], v[36:39], v[204:207], v[100:103]
    s_waitcnt lgkmcnt(2)
    v_mul_f32 v225, v225, v48
    v_mul_f32 v226, v226, v48
    v_mul_f32 v227, v227, v48
    v_mul_f32 v228, v228, v48
    v_mul_f32 v229, v229, v48
    v_mfma_f32_16x16x32_bf16 v[160:163], v[40:43], a[248:251], v[160:163]
    ds_read_b128 v[32:35], v2 offset:256
    v_cvt_pk_bf16_f32 v224, v224, v225
    v_mfma_f32_16x16x32_bf16 v[160:163], v[44:47], a[252:255], v[160:163]
    v_cvt_pk_bf16_f32 v225, v226, v227
    v_cvt_pk_bf16_f32 v226, v228, v229
    v_accvgpr_read_b32 v230, a1
    v_accvgpr_read_b32 v231, a5
    v_accvgpr_read_b32 v232, a9
    v_mfma_f32_16x16x32_bf16 v[164:167], v[40:43], v[208:211], v[164:167]
    ds_read_b128 v[36:39], v3 offset:256
    v_accvgpr_read_b32 v233, a13
    v_mfma_f32_16x16x32_bf16 v[164:167], v[44:47], v[212:215], v[164:167]
    s_waitcnt lgkmcnt(2)
    buffer_store_dwordx3 v[224:226], v56, s[12:15], s24 offen offset:0 sc0 sc1
    v_accvgpr_read_b32 v234, a17
    v_accvgpr_read_b32 v235, a21
    v_mfma_f32_16x16x32_bf16 v[96:99], v[24:27], a[248:251], v[96:99]
    ds_read_b128 v[40:43], v2 offset:6400
    v_mul_f32 v230, v230, v49
    v_mfma_f32_16x16x32_bf16 v[96:99], v[28:31], a[252:255], v[96:99]
    v_mul_f32 v231, v231, v49
    v_mul_f32 v232, v232, v49
    v_mul_f32 v233, v233, v49
    v_mul_f32 v234, v234, v49
    v_mul_f32 v235, v235, v49
    v_mfma_f32_16x16x32_bf16 v[100:103], v[24:27], v[208:211], v[100:103]
    ds_read_b128 v[44:47], v3 offset:6400
    v_cvt_pk_bf16_f32 v230, v230, v231
    v_mfma_f32_16x16x32_bf16 v[100:103], v[28:31], v[212:215], v[100:103]
    s_waitcnt lgkmcnt(2)
    v_cvt_pk_bf16_f32 v231, v232, v233
    v_cvt_pk_bf16_f32 v232, v234, v235
    v_accvgpr_read_b32 v236, a2
    v_accvgpr_read_b32 v237, a6
    v_accvgpr_read_b32 v238, a10
    v_mfma_f32_16x16x32_bf16 v[160:163], v[32:35], v[192:195], v[160:163]
    ds_read_b128 v[24:27], v2 offset:12288
    v_accvgpr_read_b32 v239, a14
    v_mfma_f32_16x16x32_bf16 v[160:163], v[36:39], v[196:199], v[160:163]
    buffer_store_dwordx3 v[230:232], v56, s[12:15], s24 offen offset:384 sc0 sc1
    v_accvgpr_read_b32 v240, a18
    v_accvgpr_read_b32 v241, a22
    v_mfma_f32_16x16x32_bf16 v[164:167], v[32:35], v[216:219], v[164:167]
    ds_read_b128 v[28:31], v3 offset:12288
    v_mul_f32 v236, v236, v50
    v_mfma_f32_16x16x32_bf16 v[164:167], v[36:39], v[220:223], v[164:167]
    s_waitcnt lgkmcnt(2)
    v_mul_f32 v237, v237, v50
    v_mul_f32 v238, v238, v50
    v_mul_f32 v239, v239, v50
    v_mul_f32 v240, v240, v50
    v_mul_f32 v241, v241, v50
    v_mfma_f32_16x16x32_bf16 v[96:99], v[40:43], v[192:195], v[96:99]
    ds_read_b128 v[32:35], v2 offset:18432
    v_cvt_pk_bf16_f32 v236, v236, v237
    v_mfma_f32_16x16x32_bf16 v[96:99], v[44:47], v[196:199], v[96:99]
    v_cvt_pk_bf16_f32 v237, v238, v239
    v_cvt_pk_bf16_f32 v238, v240, v241
    v_accvgpr_read_b32 v242, a3
    v_accvgpr_read_b32 v243, a7
    v_accvgpr_read_b32 v244, a11
    v_mfma_f32_16x16x32_bf16 v[100:103], v[40:43], v[216:219], v[100:103]
    ds_read_b128 v[36:39], v3 offset:18432
    v_accvgpr_read_b32 v245, a15
    v_mfma_f32_16x16x32_bf16 v[100:103], v[44:47], v[220:223], v[100:103]
    s_waitcnt lgkmcnt(2)
    buffer_store_dwordx3 v[236:238], v56, s[12:15], s24 offen offset:768 sc0 sc1
    v_accvgpr_read_b32 v246, a19
    v_accvgpr_read_b32 v247, a23
    v_mfma_f32_16x16x32_bf16 v[168:171], v[24:27], a[240:243], v[136:139]
    ds_read_b128 v[40:43], v2 offset:12416
    v_mul_f32 v242, v242, v51
    v_mfma_f32_16x16x32_bf16 v[168:171], v[28:31], a[244:247], v[168:171]
    v_mul_f32 v243, v243, v51
    v_mul_f32 v244, v244, v51
    v_mul_f32 v245, v245, v51
    v_mul_f32 v246, v246, v51
    v_mul_f32 v247, v247, v51
    v_mfma_f32_16x16x32_bf16 v[172:175], v[24:27], v[200:203], v[140:143]
    ds_read_b128 v[44:47], v3 offset:12416
    v_cvt_pk_bf16_f32 v242, v242, v243
    v_mfma_f32_16x16x32_bf16 v[172:175], v[28:31], v[204:207], v[172:175]
    s_waitcnt lgkmcnt(2)
    v_cvt_pk_bf16_f32 v243, v244, v245
    v_cvt_pk_bf16_f32 v244, v246, v247
    v_accvgpr_read_b32 v248, a24
    v_accvgpr_read_b32 v249, a28
    v_accvgpr_read_b32 v250, a32
    v_mfma_f32_16x16x32_bf16 v[104:107], v[32:35], a[240:243], v[136:139]
    ds_read_b128 v[24:27], v2 offset:18560
    v_accvgpr_read_b32 v251, a36
    v_mfma_f32_16x16x32_bf16 v[104:107], v[36:39], a[244:247], v[104:107]
    buffer_store_dwordx3 v[242:244], v56, s[12:15], s24 offen offset:1152 sc0 sc1
    v_accvgpr_read_b32 v252, a40
    v_accvgpr_read_b32 v253, a44
    v_mfma_f32_16x16x32_bf16 v[108:111], v[32:35], v[200:203], v[140:143]
    ds_read_b128 v[28:31], v3 offset:18560
    v_mul_f32 v248, v248, v48
    v_mfma_f32_16x16x32_bf16 v[108:111], v[36:39], v[204:207], v[108:111]
    s_waitcnt lgkmcnt(2)
    v_mul_f32 v249, v249, v48
    v_mul_f32 v250, v250, v48
    v_mul_f32 v251, v251, v48
    v_mul_f32 v252, v252, v48
    v_mul_f32 v253, v253, v48
    v_mfma_f32_16x16x32_bf16 v[168:171], v[40:43], a[248:251], v[168:171]
    ds_read_b128 v[32:35], v2 offset:12544
    v_cvt_pk_bf16_f32 v248, v248, v249
    v_mfma_f32_16x16x32_bf16 v[168:171], v[44:47], a[252:255], v[168:171]
    v_cvt_pk_bf16_f32 v249, v250, v251
    v_cvt_pk_bf16_f32 v250, v252, v253
    v_accvgpr_read_b32 v224, a25
    v_accvgpr_read_b32 v225, a29
    v_accvgpr_read_b32 v226, a33
    v_mfma_f32_16x16x32_bf16 v[172:175], v[40:43], v[208:211], v[172:175]
    ds_read_b128 v[36:39], v3 offset:12544
    v_accvgpr_read_b32 v227, a37
    v_mfma_f32_16x16x32_bf16 v[172:175], v[44:47], v[212:215], v[172:175]
    s_waitcnt lgkmcnt(2)
    buffer_store_dwordx3 v[248:250], v56, s[12:15], s24 offen offset:192 sc0 sc1
    v_accvgpr_read_b32 v228, a41
    v_mfma_f32_16x16x32_bf16 v[104:107], v[24:27], a[248:251], v[104:107]
    ds_read_b128 v[40:43], v2 offset:18688
    v_accvgpr_read_b32 v229, a45
    v_mfma_f32_16x16x32_bf16 v[104:107], v[28:31], a[252:255], v[104:107]
    v_mul_f32 v224, v224, v49
    v_mul_f32 v225, v225, v49
    v_mul_f32 v226, v226, v49
    v_mul_f32 v227, v227, v49
    v_mul_f32 v228, v228, v49
    v_mul_f32 v229, v229, v49
    v_mfma_f32_16x16x32_bf16 v[108:111], v[24:27], v[208:211], v[108:111]
    ds_read_b128 v[44:47], v3 offset:18688
    v_cvt_pk_bf16_f32 v224, v224, v225
    v_mfma_f32_16x16x32_bf16 v[108:111], v[28:31], v[212:215], v[108:111]
    s_waitcnt lgkmcnt(2)
    v_add_u32 v2, 49152, v2
    v_add_u32 v3, 49152, v3
    v_exp_f32 v16, v160
    v_cvt_pk_bf16_f32 v225, v226, v227
    v_mfma_f32_16x16x32_bf16 v[168:171], v[32:35], v[192:195], v[168:171]
    ds_read_b128 v[24:27], v2 offset:0
    v_cvt_pk_bf16_f32 v226, v228, v229
    v_mfma_f32_16x16x32_bf16 v[168:171], v[36:39], v[196:199], v[168:171]
    buffer_store_dwordx3 v[224:226], v56, s[12:15], s24 offen offset:576 sc0 sc1
    v_accvgpr_read_b32 v230, a26
    v_mfma_f32_16x16x32_bf16 v[172:175], v[32:35], v[216:219], v[172:175]
    ds_read_b128 v[28:31], v3 offset:0
    v_accvgpr_read_b32 v231, a30
    v_mfma_f32_16x16x32_bf16 v[172:175], v[36:39], v[220:223], v[172:175]
    s_waitcnt lgkmcnt(2)
    v_exp_f32 v17, v161
    v_exp_f32 v18, v162
    v_exp_f32 v19, v163
    v_mfma_f32_16x16x32_bf16 v[104:107], v[40:43], v[192:195], v[104:107]
    ds_read_b128 v[32:35], v2 offset:6144
    v_accvgpr_read_b32 v232, a34
    v_mfma_f32_16x16x32_bf16 v[104:107], v[44:47], v[196:199], v[104:107]
    v_cvt_pk_bf16_f32 v160, v16, v17
    v_accvgpr_read_b32 v233, a38
    v_accvgpr_read_b32 v234, a42
    v_exp_f32 v16, v96
    v_mfma_f32_16x16x32_bf16 v[108:111], v[40:43], v[216:219], v[108:111]
    ds_read_b128 v[36:39], v3 offset:6144
    v_accvgpr_read_b32 v235, a46
    v_mfma_f32_16x16x32_bf16 v[108:111], v[44:47], v[220:223], v[108:111]
    s_waitcnt lgkmcnt(2)
    v_mul_f32 v230, v230, v50
    v_exp_f32 v17, v97
    v_mul_f32 v231, v231, v50
    v_mul_f32 v232, v232, v50
    v_mfma_f32_16x16x32_bf16 v[176:179], v[24:27], a[240:243], v[136:139]
    ds_read_b128 v[40:43], v2 offset:128
    v_cvt_pk_bf16_f32 v161, v18, v19
    v_mfma_f32_16x16x32_bf16 v[176:179], v[28:31], a[244:247], v[176:179]
    v_mul_f32 v233, v233, v50
    v_exp_f32 v18, v98
    v_mul_f32 v234, v234, v50
    v_mul_f32 v235, v235, v50
    v_cvt_pk_bf16_f32 v230, v230, v231
    v_mfma_f32_16x16x32_bf16 v[180:183], v[24:27], v[200:203], v[140:143]
    ds_read_b128 v[44:47], v3 offset:128
    v_cvt_pk_bf16_f32 v231, v232, v233
    v_mfma_f32_16x16x32_bf16 v[180:183], v[28:31], v[204:207], v[180:183]
    s_waitcnt lgkmcnt(2)
    v_exp_f32 v19, v99
    v_cvt_pk_bf16_f32 v232, v234, v235
    v_accvgpr_read_b32 v236, a27
    v_cvt_pk_bf16_f32 v162, v16, v17
    v_mfma_f32_16x16x32_bf16 v[112:115], v[32:35], a[240:243], v[136:139]
    ds_read_b128 v[24:27], v2 offset:6272
    v_accvgpr_read_b32 v237, a31
    v_mfma_f32_16x16x32_bf16 v[112:115], v[36:39], a[244:247], v[112:115]
    buffer_store_dwordx3 v[230:232], v56, s[12:15], s24 offen offset:960 sc0 sc1
    v_accvgpr_read_b32 v238, a35
    v_mfma_f32_16x16x32_bf16 v[116:119], v[32:35], v[200:203], v[140:143]
    ds_read_b128 v[28:31], v3 offset:6272
    v_accvgpr_read_b32 v239, a39
    v_mfma_f32_16x16x32_bf16 v[116:119], v[36:39], v[204:207], v[116:119]
    s_waitcnt lgkmcnt(2)
    v_exp_f32 v16, v164
    v_exp_f32 v17, v165
    v_accvgpr_read_b32 v240, a43
    v_accvgpr_read_b32 v241, a47
    v_mfma_f32_16x16x32_bf16 v[176:179], v[40:43], a[248:251], v[176:179]
    ds_read_b128 v[32:35], v2 offset:256
    v_cvt_pk_bf16_f32 v163, v18, v19
    v_mfma_f32_16x16x32_bf16 v[176:179], v[44:47], a[252:255], v[176:179]
    v_exp_f32 v18, v166
    v_mul_f32 v236, v236, v51
    v_mul_f32 v237, v237, v51
    v_mul_f32 v238, v238, v51
    v_mfma_f32_16x16x32_bf16 v[180:183], v[40:43], v[208:211], v[180:183]
    ds_read_b128 v[36:39], v3 offset:256
    v_mul_f32 v239, v239, v51
    v_mfma_f32_16x16x32_bf16 v[180:183], v[44:47], v[212:215], v[180:183]
    s_waitcnt lgkmcnt(2)
    v_exp_f32 v19, v167
    v_mul_f32 v240, v240, v51
    v_mul_f32 v241, v241, v51
    v_cvt_pk_bf16_f32 v236, v236, v237
    v_mfma_f32_16x16x32_bf16 v[112:115], v[24:27], a[248:251], v[112:115]
    ds_read_b128 v[40:43], v2 offset:6400
    v_cvt_pk_bf16_f32 v237, v238, v239
    v_mfma_f32_16x16x32_bf16 v[112:115], v[28:31], a[252:255], v[112:115]
    v_mfma_f32_16x16x32_bf16 v[128:131], v[160:163], v[20:23], v[128:131]
    v_cvt_pk_bf16_f32 v164, v16, v17
    v_cvt_pk_bf16_f32 v238, v240, v241
    v_accvgpr_read_b32 v242, a48
    v_mfma_f32_16x16x32_bf16 v[116:119], v[24:27], v[208:211], v[116:119]
    ds_read_b128 v[44:47], v3 offset:6400
    v_accvgpr_read_b32 v243, a52
    v_mfma_f32_16x16x32_bf16 v[116:119], v[28:31], v[212:215], v[116:119]
    s_waitcnt lgkmcnt(2)
    buffer_store_dwordx3 v[236:238], v56, s[12:15], s24 offen offset:1344 sc0 sc1
    v_exp_f32 v16, v100
    v_mfma_f32_16x16x32_bf16 v[176:179], v[32:35], v[192:195], v[176:179]
    ds_read_b128 v[24:27], v2 offset:12288
    v_accvgpr_read_b32 v244, a56
    v_mfma_f32_16x16x32_bf16 v[176:179], v[36:39], v[196:199], v[176:179]
    v_exp_f32 v17, v101
    v_accvgpr_read_b32 v245, a60
    v_cvt_pk_bf16_f32 v165, v18, v19
    v_accvgpr_read_b32 v246, a64
    v_mfma_f32_16x16x32_bf16 v[180:183], v[32:35], v[216:219], v[180:183]
    ds_read_b128 v[28:31], v3 offset:12288
    v_accvgpr_read_b32 v247, a68
    v_mfma_f32_16x16x32_bf16 v[180:183], v[36:39], v[220:223], v[180:183]
    s_waitcnt lgkmcnt(2)
    v_exp_f32 v18, v102
    v_mul_f32 v242, v242, v52
    v_mul_f32 v243, v243, v52
    v_mul_f32 v244, v244, v52
    v_mfma_f32_16x16x32_bf16 v[112:115], v[40:43], v[192:195], v[112:115]
    ds_read_b128 v[32:35], v2 offset:18432
    v_mul_f32 v245, v245, v52
    v_mfma_f32_16x16x32_bf16 v[112:115], v[44:47], v[196:199], v[112:115]
    v_exp_f32 v19, v103
    v_cvt_pk_bf16_f32 v166, v16, v17
    v_mul_f32 v246, v246, v52
    v_mul_f32 v247, v247, v52
    v_cvt_pk_bf16_f32 v167, v18, v19
    v_mfma_f32_16x16x32_bf16 v[116:119], v[40:43], v[216:219], v[116:119]
    ds_read_b128 v[36:39], v3 offset:18432
    v_cvt_pk_bf16_f32 v242, v242, v243
    v_mfma_f32_16x16x32_bf16 v[116:119], v[44:47], v[220:223], v[116:119]
    s_waitcnt lgkmcnt(2)
    s_nop 1
    v_cvt_pk_bf16_f32 v243, v244, v245
    v_cvt_pk_bf16_f32 v244, v246, v247
    v_accvgpr_read_b32 v248, a49
    v_mfma_f32_16x16x32_bf16 v[184:187], v[24:27], a[240:243], v[136:139]
    ds_read_b128 v[40:43], v2 offset:12416
    v_accvgpr_read_b32 v249, a53
    v_mfma_f32_16x16x32_bf16 v[184:187], v[28:31], a[244:247], v[184:187]
    buffer_store_dwordx3 v[242:244], v56, s[12:15], s40 offen offset:0 sc0 sc1
    v_accvgpr_read_b32 v250, a57
    v_mfma_f32_16x16x32_bf16 v[188:191], v[24:27], v[200:203], v[140:143]
    ds_read_b128 v[44:47], v3 offset:12416
    v_accvgpr_read_b32 v251, a61
    v_mfma_f32_16x16x32_bf16 v[188:191], v[28:31], v[204:207], v[188:191]
    s_waitcnt lgkmcnt(2)
    v_mfma_f32_16x16x32_bf16 v[132:135], v[164:167], v[20:23], v[132:135]
    v_exp_f32 v16, v168
    v_accvgpr_read_b32 v252, a65
    v_accvgpr_read_b32 v253, a69
    v_mfma_f32_16x16x32_bf16 v[120:123], v[32:35], a[240:243], v[136:139]
    ds_read_b128 v[24:27], v2 offset:18560
    v_mul_f32 v248, v248, v53
    v_mfma_f32_16x16x32_bf16 v[120:123], v[36:39], a[244:247], v[120:123]
    v_exp_f32 v17, v169
    v_exp_f32 v18, v170
    v_mul_f32 v249, v249, v53
    v_mfma_f32_16x16x32_bf16 v[124:127], v[32:35], v[200:203], v[140:143]
    ds_read_b128 v[28:31], v3 offset:18560
    v_mul_f32 v250, v250, v53
    v_mfma_f32_16x16x32_bf16 v[124:127], v[36:39], v[204:207], v[124:127]
    s_waitcnt lgkmcnt(2)
    v_exp_f32 v19, v171
    v_mul_f32 v251, v251, v53
    v_mul_f32 v252, v252, v53
    v_mul_f32 v253, v253, v53
    v_mfma_f32_16x16x32_bf16 v[184:187], v[40:43], a[248:251], v[184:187]
    ds_read_b128 v[32:35], v2 offset:12544
    v_cvt_pk_bf16_f32 v168, v16, v17
    v_mfma_f32_16x16x32_bf16 v[184:187], v[44:47], a[252:255], v[184:187]
    v_cvt_pk_bf16_f32 v248, v248, v249
    v_exp_f32 v16, v104
    v_cvt_pk_bf16_f32 v249, v250, v251
    v_cvt_pk_bf16_f32 v250, v252, v253
    v_accvgpr_read_b32 v224, a50
    v_mfma_f32_16x16x32_bf16 v[188:191], v[40:43], v[208:211], v[188:191]
    ds_read_b128 v[36:39], v3 offset:12544
    v_accvgpr_read_b32 v225, a54
    v_mfma_f32_16x16x32_bf16 v[188:191], v[44:47], v[212:215], v[188:191]
    s_waitcnt lgkmcnt(2)
    buffer_store_dwordx3 v[248:250], v56, s[12:15], s40 offen offset:384 sc0 sc1
    v_accvgpr_read_b32 v226, a58
    v_mfma_f32_16x16x32_bf16 v[120:123], v[24:27], a[248:251], v[120:123]
    ds_read_b128 v[40:43], v2 offset:18688
    v_accvgpr_read_b32 v227, a62
    v_mfma_f32_16x16x32_bf16 v[120:123], v[28:31], a[252:255], v[120:123]
    v_exp_f32 v17, v105
    v_cvt_pk_bf16_f32 v169, v18, v19
    v_accvgpr_read_b32 v228, a66
    v_accvgpr_read_b32 v229, a70
    v_mfma_f32_16x16x32_bf16 v[124:127], v[24:27], v[208:211], v[124:127]
    ds_read_b128 v[44:47], v3 offset:18688
    v_mul_f32 v224, v224, v54
    v_mfma_f32_16x16x32_bf16 v[124:127], v[28:31], v[212:215], v[124:127]
    s_waitcnt lgkmcnt(2)
    v_add_u32 v60, 49152, v1
    v_mov_b32 v59, v1
    v_subrev_u32 v1, 49152, v1
    v_exp_f32 v18, v106
    v_mfma_f32_16x16x32_bf16 v[184:187], v[32:35], v[192:195], v[184:187]
    ds_read_b128 v[24:27], v60 offset:0
    v_mul_f32 v225, v225, v54
    v_mfma_f32_16x16x32_bf16 v[184:187], v[36:39], v[196:199], v[184:187]
    v_exp_f32 v19, v107
    v_mul_f32 v226, v226, v54
    v_cvt_pk_bf16_f32 v170, v16, v17
    v_mul_f32 v227, v227, v54
    v_mul_f32 v228, v228, v54
    v_mfma_f32_16x16x32_bf16 v[188:191], v[32:35], v[216:219], v[188:191]
    ds_read_b128 v[28:31], v60 offset:12288
    v_mul_f32 v229, v229, v54
    v_mfma_f32_16x16x32_bf16 v[188:191], v[36:39], v[220:223], v[188:191]
    s_waitcnt lgkmcnt(2)
    v_exp_f32 v16, v172
    v_cvt_pk_bf16_f32 v224, v224, v225
    v_cvt_pk_bf16_f32 v225, v226, v227
    v_cvt_pk_bf16_f32 v226, v228, v229
    v_mfma_f32_16x16x32_bf16 v[120:123], v[40:43], v[192:195], v[120:123]
    ds_read_b128 v[32:35], v60 offset:1024
    v_accvgpr_read_b32 v230, a51
    v_mfma_f32_16x16x32_bf16 v[120:123], v[44:47], v[196:199], v[120:123]
    buffer_store_dwordx3 v[224:226], v56, s[12:15], s40 offen offset:768 sc0 sc1
    v_accvgpr_read_b32 v231, a55
    v_mfma_f32_16x16x32_bf16 v[124:127], v[40:43], v[216:219], v[124:127]
    ds_read_b128 v[36:39], v60 offset:13312
    v_accvgpr_read_b32 v232, a59
    v_mfma_f32_16x16x32_bf16 v[124:127], v[44:47], v[220:223], v[124:127]
L_pg13:
    s_cbranch_execz L_iwret
    s_waitcnt lgkmcnt(2)
    v_exp_f32 v17, v173
    v_cvt_pk_bf16_f32 v171, v18, v19
    v_exp_f32 v18, v174
    v_accvgpr_read_b32 v233, a63
    v_mfma_f32_16x16x32_bf16 a[96:99], v[80:83], v[24:27], a[96:99]
    ds_read_b128 v[40:43], v60 offset:2048
    v_accvgpr_read_b32 v234, a67
    v_mfma_f32_16x16x32_bf16 a[96:99], v[88:91], v[28:31], a[96:99]
    v_exp_f32 v19, v175
    v_accvgpr_read_b32 v235, a71
    v_mul_f32 v230, v230, v55
    v_mul_f32 v231, v231, v55
    v_mfma_f32_16x16x32_bf16 a[144:147], v[84:87], v[24:27], a[144:147]
    ds_read_b128 v[44:47], v60 offset:14336
    v_mul_f32 v232, v232, v55
    v_mfma_f32_16x16x32_bf16 a[144:147], v[92:95], v[28:31], a[144:147]
    s_waitcnt lgkmcnt(2)
    v_mfma_f32_16x16x32_bf16 v[128:131], v[168:171], v[20:23], v[128:131]
    v_mul_f32 v233, v233, v55
    v_mul_f32 v234, v234, v55
    v_mul_f32 v235, v235, v55
    v_mfma_f32_16x16x32_bf16 a[100:103], v[80:83], v[32:35], a[100:103]
    ds_read_b128 v[24:27], v60 offset:3072
    v_cvt_pk_bf16_f32 v172, v16, v17
    v_mfma_f32_16x16x32_bf16 a[100:103], v[88:91], v[36:39], a[100:103]
    v_exp_f32 v16, v108
    v_cvt_pk_bf16_f32 v230, v230, v231
    v_cvt_pk_bf16_f32 v231, v232, v233
    v_cvt_pk_bf16_f32 v232, v234, v235
    v_accvgpr_read_b32 v236, a72
    v_mfma_f32_16x16x32_bf16 a[148:151], v[84:87], v[32:35], a[148:151]
    ds_read_b128 v[28:31], v60 offset:15360
    v_accvgpr_read_b32 v237, a76
    v_mfma_f32_16x16x32_bf16 a[148:151], v[92:95], v[36:39], a[148:151]
    s_waitcnt lgkmcnt(2)
    buffer_store_dwordx3 v[230:232], v56, s[12:15], s40 offen offset:1152 sc0 sc1
    v_accvgpr_read_b32 v238, a80
    v_mfma_f32_16x16x32_bf16 a[104:107], v[80:83], v[40:43], a[104:107]
    ds_read_b128 v[32:35], v60 offset:4096
    v_accvgpr_read_b32 v239, a84
    v_mfma_f32_16x16x32_bf16 a[104:107], v[88:91], v[44:47], a[104:107]
    v_exp_f32 v17, v109
    v_cvt_pk_bf16_f32 v173, v18, v19
    v_accvgpr_read_b32 v240, a88
    v_accvgpr_read_b32 v241, a92
    v_mfma_f32_16x16x32_bf16 a[152:155], v[84:87], v[40:43], a[152:155]
    ds_read_b128 v[36:39], v60 offset:16384
    v_mul_f32 v236, v236, v52
    v_mfma_f32_16x16x32_bf16 a[152:155], v[92:95], v[44:47], a[152:155]
    s_waitcnt lgkmcnt(2)
    v_exp_f32 v18, v110
    v_mul_f32 v237, v237, v52
    v_mul_f32 v238, v238, v52
    v_mul_f32 v239, v239, v52
    v_mul_f32 v240, v240, v52
    v_mfma_f32_16x16x32_bf16 a[108:111], v[80:83], v[24:27], a[108:111]
    ds_read_b128 v[40:43], v60 offset:5120
    v_mul_f32 v241, v241, v52
    v_mfma_f32_16x16x32_bf16 a[108:111], v[88:91], v[28:31], a[108:111]
    v_exp_f32 v19, v111
    v_cvt_pk_bf16_f32 v236, v236, v237
    v_cvt_pk_bf16_f32 v237, v238, v239
    v_cvt_pk_bf16_f32 v238, v240, v241
    v_mfma_f32_16x16x32_bf16 a[156:159], v[84:87], v[24:27], a[156:159]
    ds_read_b128 v[44:47], v60 offset:17408
    v_cvt_pk_bf16_f32 v174, v16, v17
    v_mfma_f32_16x16x32_bf16 a[156:159], v[92:95], v[28:31], a[156:159]
    s_waitcnt lgkmcnt(2)
    buffer_store_dwordx3 v[236:238], v56, s[12:15], s40 offen offset:192 sc0 sc1
    v_accvgpr_read_b32 v242, a73
    v_mfma_f32_16x16x32_bf16 a[112:115], v[80:83], v[32:35], a[112:115]
    ds_read_b128 v[24:27], v1 offset:0
    v_cvt_pk_bf16_f32 v175, v18, v19
    v_mfma_f32_16x16x32_bf16 a[112:115], v[88:91], v[36:39], a[112:115]
    s_nop 1
    v_accvgpr_read_b32 v243, a77
    v_accvgpr_read_b32 v244, a81
    v_accvgpr_read_b32 v245, a85
    v_accvgpr_read_b32 v246, a89
    v_mfma_f32_16x16x32_bf16 a[160:163], v[84:87], v[32:35], a[160:163]
    ds_read_b128 v[28:31], v1 offset:12288
    v_accvgpr_read_b32 v247, a93
    v_mfma_f32_16x16x32_bf16 a[160:163], v[92:95], v[36:39], a[160:163]
    s_waitcnt lgkmcnt(2)
    v_mul_f32 v242, v242, v53
    v_mfma_f32_16x16x32_bf16 v[132:135], v[172:175], v[20:23], v[132:135]
    v_exp_f32 v16, v176
    v_mul_f32 v243, v243, v53
    v_mfma_f32_16x16x32_bf16 a[116:119], v[80:83], v[40:43], a[116:119]
    ds_read_b128 v[32:35], v1 offset:1024
    v_mul_f32 v244, v244, v53
    v_mfma_f32_16x16x32_bf16 a[116:119], v[88:91], v[44:47], a[116:119]
    v_exp_f32 v17, v177
    v_exp_f32 v18, v178
    v_mul_f32 v245, v245, v53
    v_mfma_f32_16x16x32_bf16 a[164:167], v[84:87], v[40:43], a[164:167]
    ds_read_b128 v[36:39], v1 offset:13312
    v_mul_f32 v246, v246, v53
    v_mfma_f32_16x16x32_bf16 a[164:167], v[92:95], v[44:47], a[164:167]
    s_waitcnt lgkmcnt(2)
    v_exp_f32 v19, v179
    v_cvt_pk_bf16_f32 v176, v16, v17
    v_exp_f32 v16, v112
    v_mfma_f32_16x16x32_bf16 a[96:99], v[160:163], v[24:27], a[96:99]
    ds_read_b128 v[40:43], v1 offset:2048
    v_mul_f32 v247, v247, v53
    v_mfma_f32_16x16x32_bf16 a[96:99], v[168:171], v[28:31], a[96:99]
    v_exp_f32 v17, v113
    v_cvt_pk_bf16_f32 v177, v18, v19
    v_exp_f32 v18, v114
    v_cvt_pk_bf16_f32 v242, v242, v243
    v_mfma_f32_16x16x32_bf16 a[144:147], v[164:167], v[24:27], a[144:147]
    ds_read_b128 v[44:47], v1 offset:14336
    v_cvt_pk_bf16_f32 v243, v244, v245
    v_mfma_f32_16x16x32_bf16 a[144:147], v[172:175], v[28:31], a[144:147]
    s_waitcnt lgkmcnt(2)
    v_exp_f32 v19, v115
    v_cvt_pk_bf16_f32 v178, v16, v17
    v_exp_f32 v16, v180
    v_mfma_f32_16x16x32_bf16 a[100:103], v[160:163], v[32:35], a[100:103]
    ds_read_b128 v[24:27], v1 offset:3072
    v_cvt_pk_bf16_f32 v244, v246, v247
    v_mfma_f32_16x16x32_bf16 a[100:103], v[168:171], v[36:39], a[100:103]
    buffer_store_dwordx3 v[242:244], v56, s[12:15], s40 offen offset:576 sc0 sc1
    v_accvgpr_read_b32 v248, a74
    v_mfma_f32_16x16x32_bf16 a[148:151], v[164:167], v[32:35], a[148:151]
    ds_read_b128 v[28:31], v1 offset:15360
    v_accvgpr_read_b32 v249, a78
    v_mfma_f32_16x16x32_bf16 a[148:151], v[172:175], v[36:39], a[148:151]
    s_waitcnt lgkmcnt(2)
    v_exp_f32 v17, v181
    v_cvt_pk_bf16_f32 v179, v18, v19
    v_exp_f32 v18, v182
    v_accvgpr_read_b32 v250, a82
    v_mfma_f32_16x16x32_bf16 a[104:107], v[160:163], v[40:43], a[104:107]
    ds_read_b128 v[32:35], v1 offset:4096
    v_accvgpr_read_b32 v251, a86
    v_mfma_f32_16x16x32_bf16 a[104:107], v[168:171], v[44:47], a[104:107]
    v_exp_f32 v19, v183
    v_mfma_f32_16x16x32_bf16 v[128:131], v[176:179], v[20:23], v[128:131]
    v_cvt_pk_bf16_f32 v180, v16, v17
    v_mfma_f32_16x16x32_bf16 a[152:155], v[164:167], v[40:43], a[152:155]
    ds_read_b128 v[36:39], v1 offset:16384
    v_accvgpr_read_b32 v252, a90
    v_mfma_f32_16x16x32_bf16 a[152:155], v[172:175], v[44:47], a[152:155]
    s_waitcnt lgkmcnt(2)
    v_exp_f32 v16, v116
    v_exp_f32 v17, v117
    v_cvt_pk_bf16_f32 v181, v18, v19
    v_mfma_f32_16x16x32_bf16 a[108:111], v[160:163], v[24:27], a[108:111]
    ds_read_b128 v[40:43], v1 offset:5120
    v_accvgpr_read_b32 v253, a94
    v_mfma_f32_16x16x32_bf16 a[108:111], v[168:171], v[28:31], a[108:111]
    v_exp_f32 v18, v118
    v_exp_f32 v19, v119
    v_cvt_pk_bf16_f32 v182, v16, v17
    v_cvt_pk_bf16_f32 v183, v18, v19
    v_mfma_f32_16x16x32_bf16 a[156:159], v[164:167], v[24:27], a[156:159]
    s_nop 1
    ds_read_b128 v[44:47], v1 offset:17408
    v_mfma_f32_16x16x32_bf16 a[156:159], v[172:175], v[28:31], a[156:159]
    s_waitcnt lgkmcnt(2)
    v_mfma_f32_16x16x32_bf16 v[132:135], v[180:183], v[20:23], v[132:135]
    v_exp_f32 v16, v184
    v_mul_f32 v248, v248, v54
    v_mfma_f32_16x16x32_bf16 a[112:115], v[160:163], v[32:35], a[112:115]
    ds_read_b128 v[24:27], v59 offset:0
    v_mul_f32 v249, v249, v54
    v_mfma_f32_16x16x32_bf16 a[112:115], v[168:171], v[36:39], a[112:115]
    v_exp_f32 v17, v185
    v_exp_f32 v18, v186
    v_mul_f32 v250, v250, v54
    v_mfma_f32_16x16x32_bf16 a[160:163], v[164:167], v[32:35], a[160:163]
    ds_read_b128 v[28:31], v59 offset:12288
    v_mul_f32 v251, v251, v54
    v_mfma_f32_16x16x32_bf16 a[160:163], v[172:175], v[36:39], a[160:163]
    s_waitcnt lgkmcnt(2)
    v_exp_f32 v19, v187
    v_cvt_pk_bf16_f32 v184, v16, v17
    v_exp_f32 v16, v120
    v_exp_f32 v17, v121
    v_cvt_pk_bf16_f32 v185, v18, v19
    v_exp_f32 v18, v122
    v_exp_f32 v19, v123
    v_cvt_pk_bf16_f32 v186, v16, v17
    v_exp_f32 v16, v188
    v_exp_f32 v17, v189
    v_cvt_pk_bf16_f32 v187, v18, v19
    v_exp_f32 v18, v190
    v_exp_f32 v19, v191
    v_mfma_f32_16x16x32_bf16 v[128:131], v[184:187], v[20:23], v[128:131]
    v_cvt_pk_bf16_f32 v188, v16, v17
    v_exp_f32 v16, v124
    v_exp_f32 v17, v125
    v_cvt_pk_bf16_f32 v189, v18, v19
    v_exp_f32 v18, v126
    v_exp_f32 v19, v127
    v_cvt_pk_bf16_f32 v190, v16, v17
    v_cvt_pk_bf16_f32 v191, v18, v19
    s_nop 1
    v_mfma_f32_16x16x32_bf16 v[132:135], v[188:191], v[20:23], v[132:135]
    v_mfma_f32_16x16x32_bf16 a[116:119], v[160:163], v[40:43], a[116:119]
    ds_read_b128 v[32:35], v59 offset:1024
    v_mul_f32 v252, v252, v54
    v_mfma_f32_16x16x32_bf16 a[116:119], v[168:171], v[44:47], a[116:119]
    v_mul_f32 v253, v253, v54
    v_cvt_pk_bf16_f32 v248, v248, v249
    v_cvt_pk_bf16_f32 v249, v250, v251
    v_cvt_pk_bf16_f32 v250, v252, v253
    v_accvgpr_read_b32 v224, a75
    v_mfma_f32_16x16x32_bf16 a[164:167], v[164:167], v[40:43], a[164:167]
    ds_read_b128 v[36:39], v59 offset:13312
    v_accvgpr_read_b32 v225, a79
    v_mfma_f32_16x16x32_bf16 a[164:167], v[172:175], v[44:47], a[164:167]
    s_waitcnt lgkmcnt(2)
    buffer_store_dwordx3 v[248:250], v56, s[12:15], s40 offen offset:960 sc0 sc1
    v_accvgpr_read_b32 v226, a83
    v_accvgpr_read_b32 v227, a87
    v_mfma_f32_16x16x4_f32 v[128:131], v7, v57, v[128:131]
    v_mfma_f32_16x16x32_bf16 a[96:99], v[176:179], v[24:27], a[96:99]
    ds_read_b128 v[40:43], v59 offset:2048
    v_accvgpr_read_b32 v228, a91
    v_mfma_f32_16x16x32_bf16 a[96:99], v[184:187], v[28:31], a[96:99]
    v_accvgpr_read_b32 v229, a95
    v_mul_f32 v224, v224, v55
    v_mul_f32 v225, v225, v55
    v_mul_f32 v226, v226, v55
    v_mul_f32 v227, v227, v55
    v_mul_f32 v228, v228, v55
    v_mfma_f32_16x16x4_f32 v[132:135], v8, v57, v[132:135]
    v_mfma_f32_16x16x32_bf16 a[144:147], v[180:183], v[24:27], a[144:147]
    ds_read_b128 v[44:47], v59 offset:14336
    v_mul_f32 v229, v229, v55
    v_mfma_f32_16x16x32_bf16 a[144:147], v[188:191], v[28:31], a[144:147]
    s_waitcnt lgkmcnt(2)
    v_cvt_pk_bf16_f32 v224, v224, v225
    v_cvt_pk_bf16_f32 v225, v226, v227
    v_cvt_pk_bf16_f32 v226, v228, v229
    v_mfma_f32_16x16x32_bf16 a[100:103], v[176:179], v[32:35], a[100:103]
    ds_read_b128 v[24:27], v59 offset:3072
    v_mfma_f32_16x16x32_bf16 a[100:103], v[184:187], v[36:39], a[100:103]
    buffer_store_dwordx3 v[224:226], v56, s[12:15], s40 offen offset:1344 sc0 sc1
    v_mfma_f32_16x16x32_bf16 a[148:151], v[180:183], v[32:35], a[148:151]
    ds_read_b128 v[28:31], v59 offset:15360
    v_max3_f32 v18, v5, v6, v128
    v_mfma_f32_16x16x32_bf16 a[148:151], v[188:191], v[36:39], a[148:151]
    s_waitcnt lgkmcnt(2)
    v_max3_f32 v18, v18, v129, v130
    v_max3_f32 v18, v18, v131, v132
    v_max3_f32 v18, v18, v133, v134
    v_max_f32 v18, v18, v135
    s_mov_b32 s29, 0x5f800000
    v_cmp_lt_f32 s[48:49], s29, v18
    v_rcp_f32 v128, v128
    v_mfma_f32_16x16x32_bf16 a[104:107], v[176:179], v[40:43], a[104:107]
    ds_read_b128 v[32:35], v59 offset:4096
    v_mfma_f32_16x16x32_bf16 a[104:107], v[184:187], v[44:47], a[104:107]
    v_rcp_f32 v129, v129
    v_rcp_f32 v130, v130
    v_rcp_f32 v131, v131
    v_mfma_f32_16x16x32_bf16 a[152:155], v[180:183], v[40:43], a[152:155]
    ds_read_b128 v[36:39], v59 offset:16384
    v_mfma_f32_16x16x32_bf16 a[152:155], v[188:191], v[44:47], a[152:155]
    s_waitcnt lgkmcnt(2)
    v_rcp_f32 v132, v132
    v_rcp_f32 v133, v133
    v_mfma_f32_16x16x32_bf16 a[108:111], v[176:179], v[24:27], a[108:111]
    ds_read_b128 v[40:43], v59 offset:5120
    v_mfma_f32_16x16x32_bf16 a[108:111], v[184:187], v[28:31], a[108:111]
    v_rcp_f32 v134, v134
    v_rcp_f32 v135, v135
    v_mfma_f32_16x16x32_bf16 a[156:159], v[180:183], v[24:27], a[156:159]
    ds_read_b128 v[44:47], v59 offset:17408
    v_mfma_f32_16x16x32_bf16 a[156:159], v[188:191], v[28:31], a[156:159]
    s_waitcnt lgkmcnt(2)
    v_mfma_f32_16x16x32_bf16 a[112:115], v[176:179], v[32:35], a[112:115]
    ds_read_b128 v[24:27], v60 offset:6144
    v_mfma_f32_16x16x32_bf16 a[112:115], v[184:187], v[36:39], a[112:115]
    v_mfma_f32_16x16x32_bf16 a[160:163], v[180:183], v[32:35], a[160:163]
    ds_read_b128 v[28:31], v60 offset:18432
    v_mfma_f32_16x16x32_bf16 a[160:163], v[188:191], v[36:39], a[160:163]
    s_waitcnt lgkmcnt(2)
    s_cmp_lg_u64 s[48:49], 0
    s_cbranch_scc1 L_slow
    v_mfma_f32_16x16x32_bf16 a[116:119], v[176:179], v[40:43], a[116:119]
    ds_read_b128 v[32:35], v60 offset:7168
    v_mfma_f32_16x16x32_bf16 a[116:119], v[184:187], v[44:47], a[116:119]
    v_mfma_f32_16x16x32_bf16 a[164:167], v[180:183], v[40:43], a[164:167]
    ds_read_b128 v[36:39], v60 offset:19456
    v_mfma_f32_16x16x32_bf16 a[164:167], v[188:191], v[44:47], a[164:167]
    s_waitcnt lgkmcnt(2)
    v_mfma_f32_16x16x32_bf16 a[120:123], v[80:83], v[24:27], a[120:123]
    ds_read_b128 v[40:43], v60 offset:8192
    v_mfma_f32_16x16x32_bf16 a[120:123], v[88:91], v[28:31], a[120:123]
    v_mfma_f32_16x16x32_bf16 a[168:171], v[84:87], v[24:27], a[168:171]
    ds_read_b128 v[44:47], v60 offset:20480
    v_mfma_f32_16x16x32_bf16 a[168:171], v[92:95], v[28:31], a[168:171]
    s_waitcnt lgkmcnt(2)
    v_mfma_f32_16x16x32_bf16 a[124:127], v[80:83], v[32:35], a[124:127]
    ds_read_b128 v[24:27], v1 offset:6144
    v_accvgpr_read_b32 v230, a96
    v_mfma_f32_16x16x32_bf16 a[124:127], v[88:91], v[36:39], a[124:127]
    v_accvgpr_read_b32 v231, a100
    v_accvgpr_read_b32 v232, a104
    v_accvgpr_read_b32 v233, a108
    v_accvgpr_read_b32 v234, a112
    v_accvgpr_read_b32 v235, a116
    v_mul_f32 v230, v230, v128
    v_mul_f32 v231, v231, v128
    v_mul_f32 v232, v232, v128
    v_mul_f32 v233, v233, v128
    v_mul_f32 v234, v234, v128
    v_mul_f32 v235, v235, v128
    v_cvt_pk_bf16_f32 v230, v230, v231
    v_cvt_pk_bf16_f32 v231, v232, v233
    v_cvt_pk_bf16_f32 v232, v234, v235
    v_accvgpr_read_b32 v236, a97
    v_accvgpr_read_b32 v237, a101
    v_accvgpr_read_b32 v238, a105
    v_accvgpr_read_b32 v239, a109
    v_accvgpr_read_b32 v240, a113
    v_accvgpr_read_b32 v241, a117
    v_mul_f32 v236, v236, v129
    v_mul_f32 v237, v237, v129
    v_mul_f32 v238, v238, v129
    v_mul_f32 v239, v239, v129
    v_mul_f32 v240, v240, v129
    v_mul_f32 v241, v241, v129
    v_cvt_pk_bf16_f32 v236, v236, v237
    v_cvt_pk_bf16_f32 v237, v238, v239
    v_cvt_pk_bf16_f32 v238, v240, v241
    v_accvgpr_read_b32 v242, a98
    v_mfma_f32_16x16x32_bf16 a[172:175], v[84:87], v[32:35], a[172:175]
    ds_read_b128 v[28:31], v1 offset:18432
    v_accvgpr_read_b32 v243, a102
    v_mfma_f32_16x16x32_bf16 a[172:175], v[92:95], v[36:39], a[172:175]
    s_waitcnt lgkmcnt(2)
    buffer_store_dwordx3 v[230:232], v56, s[12:15], s41 offen offset:0 sc0 sc1
    v_accvgpr_read_b32 v244, a106
    v_mfma_f32_16x16x32_bf16 a[128:131], v[80:83], v[40:43], a[128:131]
    ds_read_b128 v[32:35], v1 offset:7168
    v_accvgpr_read_b32 v245, a110
    v_mfma_f32_16x16x32_bf16 a[128:131], v[88:91], v[44:47], a[128:131]
    buffer_store_dwordx3 v[236:238], v56, s[12:15], s41 offen offset:384 sc0 sc1
    v_accvgpr_read_b32 v246, a114
    v_mfma_f32_16x16x32_bf16 a[176:179], v[84:87], v[40:43], a[176:179]
    ds_read_b128 v[36:39], v1 offset:19456
    v_accvgpr_read_b32 v247, a118
    v_mfma_f32_16x16x32_bf16 a[176:179], v[92:95], v[44:47], a[176:179]
    s_waitcnt lgkmcnt(2)
    v_mul_f32 v242, v242, v130
    v_mul_f32 v243, v243, v130
    v_mul_f32 v244, v244, v130
    v_mul_f32 v245, v245, v130
    v_mul_f32 v246, v246, v130
    v_mul_f32 v247, v247, v130
    v_mfma_f32_16x16x32_bf16 a[120:123], v[160:163], v[24:27], a[120:123]
    ds_read_b128 v[40:43], v1 offset:8192
    v_cvt_pk_bf16_f32 v242, v242, v243
    v_mfma_f32_16x16x32_bf16 a[120:123], v[168:171], v[28:31], a[120:123]
    v_cvt_pk_bf16_f32 v243, v244, v245
    v_cvt_pk_bf16_f32 v244, v246, v247
    v_accvgpr_read_b32 v248, a99
    v_accvgpr_read_b32 v249, a103
    v_accvgpr_read_b32 v250, a107
    v_mfma_f32_16x16x32_bf16 a[168:171], v[164:167], v[24:27], a[168:171]
    ds_read_b128 v[44:47], v1 offset:20480
    v_accvgpr_read_b32 v251, a111
    v_mfma_f32_16x16x32_bf16 a[168:171], v[172:175], v[28:31], a[168:171]
    s_waitcnt lgkmcnt(2)
    buffer_store_dwordx3 v[242:244], v56, s[12:15], s41 offen offset:768 sc0 sc1
    v_accvgpr_read_b32 v252, a115
    v_mfma_f32_16x16x32_bf16 a[124:127], v[160:163], v[32:35], a[124:127]
    ds_read_b128 v[24:27], v59 offset:6144
    v_accvgpr_read_b32 v253, a119
    v_mfma_f32_16x16x32_bf16 a[124:127], v[168:171], v[36:39], a[124:127]
    v_mul_f32 v248, v248, v131
    v_mul_f32 v249, v249, v131
    v_mul_f32 v250, v250, v131
    v_mul_f32 v251, v251, v131
    v_mul_f32 v252, v252, v131
    v_mul_f32 v253, v253, v131
    v_mfma_f32_16x16x32_bf16 a[172:175], v[164:167], v[32:35], a[172:175]
    ds_read_b128 v[28:31], v59 offset:18432
    v_cvt_pk_bf16_f32 v248, v248, v249
    v_mfma_f32_16x16x32_bf16 a[172:175], v[172:175], v[36:39], a[172:175]
    s_waitcnt lgkmcnt(2)
    v_cvt_pk_bf16_f32 v249, v250, v251
    v_cvt_pk_bf16_f32 v250, v252, v253
    v_accvgpr_read_b32 v224, a144
    v_accvgpr_read_b32 v225, a148
    v_accvgpr_read_b32 v226, a152
    v_mfma_f32_16x16x32_bf16 a[128:131], v[160:163], v[40:43], a[128:131]
    ds_read_b128 v[32:35], v59 offset:7168
    v_accvgpr_read_b32 v227, a156
    v_mfma_f32_16x16x32_bf16 a[128:131], v[168:171], v[44:47], a[128:131]
    buffer_store_dwordx3 v[248:250], v56, s[12:15], s41 offen offset:1152 sc0 sc1
    v_accvgpr_read_b32 v228, a160
    v_mfma_f32_16x16x32_bf16 a[176:179], v[164:167], v[40:43], a[176:179]
    ds_read_b128 v[36:39], v59 offset:19456
    v_accvgpr_read_b32 v229, a164
    v_mfma_f32_16x16x32_bf16 a[176:179], v[172:175], v[44:47], a[176:179]
    s_waitcnt lgkmcnt(2)
    v_mul_f32 v224, v224, v132
    v_mul_f32 v225, v225, v132
    v_mul_f32 v226, v226, v132
    v_mul_f32 v227, v227, v132
    v_mul_f32 v228, v228, v132
    v_mul_f32 v229, v229, v132
    v_mfma_f32_16x16x32_bf16 a[120:123], v[176:179], v[24:27], a[120:123]
    ds_read_b128 v[40:43], v59 offset:8192
    v_cvt_pk_bf16_f32 v224, v224, v225
    v_mfma_f32_16x16x32_bf16 a[120:123], v[184:187], v[28:31], a[120:123]
    v_cvt_pk_bf16_f32 v225, v226, v227
    v_cvt_pk_bf16_f32 v226, v228, v229
    v_accvgpr_read_b32 v230, a145
    v_accvgpr_read_b32 v231, a149
    v_accvgpr_read_b32 v232, a153
    v_mfma_f32_16x16x32_bf16 a[168:171], v[180:183], v[24:27], a[168:171]
    ds_read_b128 v[44:47], v59 offset:20480
    v_accvgpr_read_b32 v233, a157
    v_mfma_f32_16x16x32_bf16 a[168:171], v[188:191], v[28:31], a[168:171]
    s_waitcnt lgkmcnt(2)
    buffer_store_dwordx3 v[224:226], v56, s[12:15], s42 offen offset:0 sc0 sc1
    v_accvgpr_read_b32 v234, a161
    v_mfma_f32_16x16x32_bf16 a[124:127], v[176:179], v[32:35], a[124:127]
    ds_read_b128 v[24:27], v60 offset:9216
    v_accvgpr_read_b32 v235, a165
    v_mfma_f32_16x16x32_bf16 a[124:127], v[184:187], v[36:39], a[124:127]
    v_mul_f32 v230, v230, v133
    v_mul_f32 v231, v231, v133
    v_mul_f32 v232, v232, v133
    v_mul_f32 v233, v233, v133
    v_mul_f32 v234, v234, v133
    v_mul_f32 v235, v235, v133
    v_mfma_f32_16x16x32_bf16 a[172:175], v[180:183], v[32:35], a[172:175]
    ds_read_b128 v[28:31], v60 offset:21504
    v_cvt_pk_bf16_f32 v230, v230, v231
    v_mfma_f32_16x16x32_bf16 a[172:175], v[188:191], v[36:39], a[172:175]
    s_waitcnt lgkmcnt(2)
    v_cvt_pk_bf16_f32 v231, v232, v233
    v_cvt_pk_bf16_f32 v232, v234, v235
    v_accvgpr_read_b32 v236, a146
    v_accvgpr_read_b32 v237, a150
    v_accvgpr_read_b32 v238, a154
    v_mfma_f32_16x16x32_bf16 a[128:131], v[176:179], v[40:43], a[128:131]
    ds_read_b128 v[32:35], v60 offset:10240
    v_accvgpr_read_b32 v239, a158
    v_mfma_f32_16x16x32_bf16 a[128:131], v[184:187], v[44:47], a[128:131]
    buffer_store_dwordx3 v[230:232], v56, s[12:15], s42 offen offset:384 sc0 sc1
    v_accvgpr_read_b32 v240, a162
    v_mfma_f32_16x16x32_bf16 a[176:179], v[180:183], v[40:43], a[176:179]
    ds_read_b128 v[36:39], v60 offset:22528
    v_accvgpr_read_b32 v241, a166
    v_mfma_f32_16x16x32_bf16 a[176:179], v[188:191], v[44:47], a[176:179]
    s_waitcnt lgkmcnt(2)
    v_mul_f32 v236, v236, v134
    v_mul_f32 v237, v237, v134
    v_mul_f32 v238, v238, v134
    v_mul_f32 v239, v239, v134
    v_mul_f32 v240, v240, v134
    v_mfma_f32_16x16x32_bf16 a[132:135], v[80:83], v[24:27], a[132:135]
    ds_read_b128 v[40:43], v60 offset:11264
    v_mul_f32 v241, v241, v134
    v_mfma_f32_16x16x32_bf16 a[132:135], v[88:91], v[28:31], a[132:135]
    v_cvt_pk_bf16_f32 v236, v236, v237
    v_cvt_pk_bf16_f32 v237, v238, v239
    v_cvt_pk_bf16_f32 v238, v240, v241
    v_accvgpr_read_b32 v242, a147
    v_accvgpr_read_b32 v243, a151
    v_accvgpr_read_b32 v244, a155
    v_mfma_f32_16x16x32_bf16 a[180:183], v[84:87], v[24:27], a[180:183]
    ds_read_b128 v[44:47], v60 offset:23552
    v_accvgpr_read_b32 v245, a159
    v_mfma_f32_16x16x32_bf16 a[180:183], v[92:95], v[28:31], a[180:183]
    s_waitcnt lgkmcnt(2)
    buffer_store_dwordx3 v[236:238], v56, s[12:15], s42 offen offset:768 sc0 sc1
    v_accvgpr_read_b32 v246, a163
    v_mfma_f32_16x16x32_bf16 a[136:139], v[80:83], v[32:35], a[136:139]
    ds_read_b128 v[24:27], v1 offset:9216
    v_accvgpr_read_b32 v96, a120
    v_mfma_f32_16x16x32_bf16 a[136:139], v[88:91], v[36:39], a[136:139]
    v_accvgpr_read_b32 v97, a124
    v_accvgpr_read_b32 v98, a128
    v_mul_f32 v96, v96, v128
    v_mul_f32 v97, v97, v128
    v_mul_f32 v98, v98, v128
    v_mfma_f32_16x16x32_bf16 a[184:187], v[84:87], v[32:35], a[184:187]
    ds_read_b128 v[28:31], v1 offset:21504
    v_accvgpr_read_b32 v102, a121
    v_mfma_f32_16x16x32_bf16 a[184:187], v[92:95], v[36:39], a[184:187]
    s_waitcnt lgkmcnt(2)
    v_accvgpr_read_b32 v103, a125
    v_accvgpr_read_b32 v104, a129
    v_mul_f32 v102, v102, v129
    v_mul_f32 v103, v103, v129
    v_mul_f32 v104, v104, v129
    v_accvgpr_read_b32 v108, a122
    v_mfma_f32_16x16x32_bf16 a[140:143], v[80:83], v[40:43], a[140:143]
    ds_read_b128 v[32:35], v1 offset:10240
    v_accvgpr_read_b32 v109, a126
    v_mfma_f32_16x16x32_bf16 a[140:143], v[88:91], v[44:47], a[140:143]
    v_accvgpr_read_b32 v110, a130
    v_mul_f32 v108, v108, v130
    v_mul_f32 v109, v109, v130
    v_mul_f32 v110, v110, v130
    v_accvgpr_read_b32 v114, a123
    v_mfma_f32_16x16x32_bf16 a[188:191], v[84:87], v[40:43], a[188:191]
    ds_read_b128 v[36:39], v1 offset:22528
    v_accvgpr_read_b32 v115, a127
    v_mfma_f32_16x16x32_bf16 a[188:191], v[92:95], v[44:47], a[188:191]
    s_waitcnt lgkmcnt(2)
    v_accvgpr_read_b32 v116, a131
    v_mul_f32 v114, v114, v131
    v_mul_f32 v115, v115, v131
    v_mul_f32 v116, v116, v131
    v_accvgpr_read_b32 v120, a168
    v_mfma_f32_16x16x32_bf16 a[132:135], v[160:163], v[24:27], a[132:135]
    ds_read_b128 v[40:43], v1 offset:11264
    v_accvgpr_read_b32 v121, a172
    v_mfma_f32_16x16x32_bf16 a[132:135], v[168:171], v[28:31], a[132:135]
    v_accvgpr_read_b32 v122, a176
    v_mul_f32 v120, v120, v132
    v_mul_f32 v121, v121, v132
    v_mul_f32 v122, v122, v132
    v_accvgpr_read_b32 v64, a169
    v_accvgpr_read_b32 v65, a173
    v_mfma_f32_16x16x32_bf16 a[180:183], v[164:167], v[24:27], a[180:183]
    ds_read_b128 v[44:47], v1 offset:23552
    v_accvgpr_read_b32 v66, a177
    v_mfma_f32_16x16x32_bf16 a[180:183], v[172:175], v[28:31], a[180:183]
    s_waitcnt lgkmcnt(2)
    v_mul_f32 v64, v64, v133
    v_mul_f32 v65, v65, v133
    v_mul_f32 v66, v66, v133
    v_accvgpr_read_b32 v70, a170
    v_accvgpr_read_b32 v71, a174
    v_mfma_f32_16x16x32_bf16 a[136:139], v[160:163], v[32:35], a[136:139]
    ds_read_b128 v[24:27], v59 offset:9216
    v_accvgpr_read_b32 v247, a167
    v_mfma_f32_16x16x32_bf16 a[136:139], v[168:171], v[36:39], a[136:139]
    v_accvgpr_read_b32 v72, a178
    v_mul_f32 v242, v242, v135
    v_mul_f32 v70, v70, v134
    v_mul_f32 v243, v243, v135
    v_mul_f32 v71, v71, v134
    v_mfma_f32_16x16x32_bf16 a[184:187], v[164:167], v[32:35], a[184:187]
    ds_read_b128 v[28:31], v59 offset:21504
    v_mul_f32 v244, v244, v135
    v_mfma_f32_16x16x32_bf16 a[184:187], v[172:175], v[36:39], a[184:187]
    s_waitcnt lgkmcnt(2)
    v_mul_f32 v72, v72, v134
    v_mul_f32 v245, v245, v135
    v_accvgpr_read_b32 v144, a171
    v_mul_f32 v246, v246, v135
    v_accvgpr_read_b32 v145, a175
    v_mul_f32 v247, v247, v135
    v_mfma_f32_16x16x32_bf16 a[140:143], v[160:163], v[40:43], a[140:143]
    ds_read_b128 v[32:35], v59 offset:10240
    v_accvgpr_read_b32 v146, a179
    v_mfma_f32_16x16x32_bf16 a[140:143], v[168:171], v[44:47], a[140:143]
    v_cvt_pk_bf16_f32 v242, v242, v243
    v_mul_f32 v144, v144, v135
    v_cvt_pk_bf16_f32 v243, v244, v245
    v_mul_f32 v145, v145, v135
    v_cvt_pk_bf16_f32 v244, v246, v247
    v_mfma_f32_16x16x32_bf16 a[188:191], v[164:167], v[40:43], a[188:191]
    ds_read_b128 v[36:39], v59 offset:22528
    v_mul_f32 v146, v146, v135
    v_mfma_f32_16x16x32_bf16 a[188:191], v[172:175], v[44:47], a[188:191]
    s_waitcnt lgkmcnt(2)
    buffer_store_dwordx3 v[242:244], v56, s[12:15], s42 offen offset:1152 sc0 sc1
    v_mfma_f32_16x16x32_bf16 a[132:135], v[176:179], v[24:27], a[132:135]
    ds_read_b128 v[40:43], v59 offset:11264
    v_mfma_f32_16x16x32_bf16 a[132:135], v[184:187], v[28:31], a[132:135]
    v_mfma_f32_16x16x32_bf16 a[180:183], v[180:183], v[24:27], a[180:183]
    ds_read_b128 v[44:47], v59 offset:23552
    v_mfma_f32_16x16x32_bf16 a[180:183], v[188:191], v[28:31], a[180:183]
    s_waitcnt lgkmcnt(2)
    v_mfma_f32_16x16x32_bf16 a[136:139], v[176:179], v[32:35], a[136:139]
    v_mfma_f32_16x16x32_bf16 a[136:139], v[184:187], v[36:39], a[136:139]
    v_mfma_f32_16x16x32_bf16 a[184:187], v[180:183], v[32:35], a[184:187]
    v_mfma_f32_16x16x32_bf16 a[184:187], v[188:191], v[36:39], a[184:187]
    s_waitcnt lgkmcnt(0)
    v_mfma_f32_16x16x32_bf16 a[140:143], v[176:179], v[40:43], a[140:143]
    v_mfma_f32_16x16x32_bf16 a[140:143], v[184:187], v[44:47], a[140:143]
    v_mfma_f32_16x16x32_bf16 a[188:191], v[180:183], v[40:43], a[188:191]
    v_mfma_f32_16x16x32_bf16 a[188:191], v[188:191], v[44:47], a[188:191]
    s_nop 7
    v_accvgpr_read_b32 v99, a132
    v_accvgpr_read_b32 v100, a136
    v_accvgpr_read_b32 v101, a140
    v_cvt_pk_bf16_f32 v96, v96, v97
    v_mul_f32 v99, v99, v128
    v_mul_f32 v100, v100, v128
    v_mul_f32 v101, v101, v128
    v_cvt_pk_bf16_f32 v97, v98, v99
    v_cvt_pk_bf16_f32 v98, v100, v101
    buffer_store_dwordx3 v[96:98], v56, s[12:15], s41 offen offset:192 sc0 sc1
    v_accvgpr_read_b32 v105, a133
    v_accvgpr_read_b32 v106, a137
    v_accvgpr_read_b32 v107, a141
    v_cvt_pk_bf16_f32 v102, v102, v103
    v_mul_f32 v105, v105, v129
    v_mul_f32 v106, v106, v129
    v_mul_f32 v107, v107, v129
    v_cvt_pk_bf16_f32 v103, v104, v105
    v_cvt_pk_bf16_f32 v104, v106, v107
    buffer_store_dwordx3 v[102:104], v56, s[12:15], s41 offen offset:576 sc0 sc1
    v_accvgpr_read_b32 v111, a134
    v_accvgpr_read_b32 v112, a138
    v_accvgpr_read_b32 v113, a142
    v_cvt_pk_bf16_f32 v108, v108, v109
    v_mul_f32 v111, v111, v130
    v_mul_f32 v112, v112, v130
    v_mul_f32 v113, v113, v130
    v_cvt_pk_bf16_f32 v109, v110, v111
    v_cvt_pk_bf16_f32 v110, v112, v113
    buffer_store_dwordx3 v[108:110], v56, s[12:15], s41 offen offset:960 sc0 sc1
    v_accvgpr_read_b32 v117, a135
    v_accvgpr_read_b32 v118, a139
    v_accvgpr_read_b32 v119, a143
    v_cvt_pk_bf16_f32 v114, v114, v115
    v_mul_f32 v117, v117, v131
    v_mul_f32 v118, v118, v131
    v_mul_f32 v119, v119, v131
    v_cvt_pk_bf16_f32 v115, v116, v117
    v_cvt_pk_bf16_f32 v116, v118, v119
    buffer_store_dwordx3 v[114:116], v56, s[12:15], s41 offen offset:1344 sc0 sc1
    v_accvgpr_read_b32 v123, a180
    v_accvgpr_read_b32 v124, a184
    v_accvgpr_read_b32 v125, a188
    v_cvt_pk_bf16_f32 v120, v120, v121
    v_mul_f32 v123, v123, v132
    v_mul_f32 v124, v124, v132
    v_mul_f32 v125, v125, v132
    v_cvt_pk_bf16_f32 v121, v122, v123
    v_cvt_pk_bf16_f32 v122, v124, v125
    buffer_store_dwordx3 v[120:122], v56, s[12:15], s42 offen offset:192 sc0 sc1
    v_accvgpr_read_b32 v67, a181
    v_accvgpr_read_b32 v68, a185
    v_accvgpr_read_b32 v69, a189
    v_cvt_pk_bf16_f32 v64, v64, v65
    v_mul_f32 v67, v67, v133
    v_mul_f32 v68, v68, v133
    v_mul_f32 v69, v69, v133
    v_cvt_pk_bf16_f32 v65, v66, v67
    v_cvt_pk_bf16_f32 v66, v68, v69
    buffer_store_dwordx3 v[64:66], v56, s[12:15], s42 offen offset:576 sc0 sc1
    v_accvgpr_read_b32 v73, a182
    v_accvgpr_read_b32 v74, a186
    v_accvgpr_read_b32 v75, a190
    v_cvt_pk_bf16_f32 v70, v70, v71
    v_mul_f32 v73, v73, v134
    v_mul_f32 v74, v74, v134
    v_mul_f32 v75, v75, v134
    v_cvt_pk_bf16_f32 v71, v72, v73
    v_cvt_pk_bf16_f32 v72, v74, v75
    buffer_store_dwordx3 v[70:72], v56, s[12:15], s42 offen offset:960 sc0 sc1
    v_accvgpr_read_b32 v147, a183
    v_accvgpr_read_b32 v148, a187
    v_accvgpr_read_b32 v149, a191
    v_cvt_pk_bf16_f32 v144, v144, v145
    v_mul_f32 v147, v147, v135
    v_mul_f32 v148, v148, v135
    v_mul_f32 v149, v149, v135
    v_cvt_pk_bf16_f32 v145, v146, v147
    v_cvt_pk_bf16_f32 v146, v148, v149
    buffer_store_dwordx3 v[144:146], v56, s[12:15], s42 offen offset:1344 sc0 sc1
L_fin:
L_done:
    s_endpgm
L_pollslow0:
    s_mov_b32 s59, 60
L_pollsm0:
    s_buffer_load_dwordx8 s[48:55], s[20:23], s44 glc
    s_waitcnt lgkmcnt(0)
    s_sub_u32 s48, s48, s92
    s_sub_u32 s49, s49, s92
    s_sub_u32 s50, s50, s92
    s_sub_u32 s51, s51, s92
    s_sub_u32 s52, s52, s92
    s_sub_u32 s53, s53, s92
    s_sub_u32 s54, s54, s92
    s_sub_u32 s55, s55, s92
    s_max_u32 s48, s48, s49
    s_max_u32 s48, s48, s50
    s_max_u32 s48, s48, s51
    s_max_u32 s48, s48, s52
    s_max_u32 s48, s48, s53
    s_max_u32 s48, s48, s54
    s_max_u32 s48, s48, s55
    s_cmp_lt_u32 s48, 16
    s_cbranch_scc1 L_pollok0
    s_sub_u32 s59, s59, 1
    s_cbranch_scc1 L_pollvec0
    s_sleep 1
    s_branch L_pollsm0
L_pollvec0:
    v_bfe_u32 v53, v4, 4, 6
    v_lshlrev_b32 v53, 2, v53
    s_sub_u32 s96, s96, 1
    s_cbranch_scc1 L_pollgiveup0
    s_sleep 2
    buffer_load_dword v52, v53, s[20:23], s44 offen sc1
    s_waitcnt vmcnt(0)
    s_bitcmp1_b32 s92, 9
    s_cbranch_scc1 L_nomix
    v_xor_b32 v53, s92, v52
    v_lshrrev_b32 v53, 5, v53
    v_add_u32 v53, -1, v53
    v_cmp_gt_u32 vcc, 31, v53
    s_nop 1
    s_and_b32 s59, vcc_lo, 0xff
    s_cbranch_scc0 L_nomix
    buffer_store_dwordx4 v[224:227], v11, s[4:7], s33 offen offset:0 sc1
    v_xor_b32 v55, 16, v11
    buffer_store_dwordx4 v[228:231], v55, s[4:7], s33 offen offset:768 sc1
    v_xor_b32 v54, 32, v11
    buffer_store_dwordx4 v[232:235], v54, s[4:7], s33 offen offset:1536 sc1
    v_xor_b32 v55, 48, v11
    buffer_store_dwordx4 v[236:239], v55, s[4:7], s33 offen offset:2304 sc1
    buffer_store_dwordx4 v[112:115], v15, s[4:7], s35 offen offset:0 sc1
    buffer_store_dwordx4 v[116:119], v15, s[4:7], s35 offen offset:1024 sc1
    buffer_store_dwordx4 v[120:123], v15, s[4:7], s35 offen offset:2048 sc1
    s_waitcnt vmcnt(0)
    s_barrier
    s_and_b32 s92, s92, 0xfffffc00
    s_add_u32 s92, s92, 512
    v_mov_b32 v0, s92
    s_add_u32 s92, s92, 1
    s_mov_b32 s44, 32
    v_add_u32 v0, 1, v0
    buffer_store_dword v0, v13, s[20:23], 0 offen offset:32 sc1
    s_branch L_pollvec0
L_nomix:
    v_subrev_u32 v52, s92, v52
    v_cmp_lt_u32 vcc, 15, v52
    s_nop 0
    s_and_b32 s59, vcc_lo, 0xff
    s_cbranch_scc1 L_pollvec0
    s_branch L_pollok0
L_pollgiveup0:
    s_mov_b32 s96, 0
    s_branch L_pollok0
L_pollslow1:
    s_mov_b32 s59, 200
L_pollsm1:
    s_buffer_load_dwordx8 s[48:55], s[20:23], s44 glc
    s_waitcnt lgkmcnt(0)
    s_sub_u32 s48, s48, s92
    s_sub_u32 s49, s49, s92
    s_sub_u32 s50, s50, s92
    s_sub_u32 s51, s51, s92
    s_sub_u32 s52, s52, s92
    s_sub_u32 s53, s53, s92
    s_sub_u32 s54, s54, s92
    s_sub_u32 s55, s55, s92
    s_max_u32 s48, s48, s49
    s_max_u32 s48, s48, s50
    s_max_u32 s48, s48, s51
    s_max_u32 s48, s48, s52
    s_max_u32 s48, s48, s53
    s_max_u32 s48, s48, s54
    s_max_u32 s48, s48, s55
    s_cmp_lt_u32 s48, 16
    s_cbranch_scc1 L_pollok1
    s_sub_u32 s59, s59, 1
    s_cbranch_scc1 L_pollvec1
    s_sleep 1
    s_branch L_pollsm1
L_pollvec1:
    v_bfe_u32 v53, v4, 4, 6
    v_lshlrev_b32 v53, 2, v53
    s_sub_u32 s96, s96, 1
    s_cbranch_scc1 L_pollgiveup1
    s_sleep 2
    buffer_load_dword v52, v53, s[20:23], s44 offen sc1
    s_waitcnt vmcnt(0)
    v_subrev_u32 v52, s92, v52
    v_cmp_lt_u32 vcc, 15, v52
    s_nop 0
    s_and_b32 s59, vcc_lo, 0xff
    s_cbranch_scc1 L_pollvec1
    s_branch L_pollok1
L_pollgiveup1:
    s_mov_b32 s96, 0
    s_branch L_pollok1
L_pollslow2:
    s_mov_b32 s59, 200
L_pollsm2:
    s_buffer_load_dwordx8 s[48:55], s[20:23], s44 glc
    s_waitcnt lgkmcnt(0)
    s_sub_u32 s48, s48, s92
    s_sub_u32 s49, s49, s92
    s_sub_u32 s50, s50, s92
    s_sub_u32 s51, s51, s92
    s_sub_u32 s52, s52, s92
    s_sub_u32 s53, s53, s92
    s_sub_u32 s54, s54, s92
    s_sub_u32 s55, s55, s92
    s_max_u32 s48, s48, s49
    s_max_u32 s48, s48, s50
    s_max_u32 s48, s48, s51
    s_max_u32 s48, s48, s52
    s_max_u32 s48, s48, s53
    s_max_u32 s48, s48, s54
    s_max_u32 s48, s48, s55
    s_cmp_lt_u32 s48, 16
    s_cbranch_scc1 L_pollok2
    s_sub_u32 s59, s59, 1
    s_cbranch_scc1 L_pollvec2
    s_sleep 1
    s_branch L_pollsm2
L_pollvec2:
    v_bfe_u32 v53, v4, 4, 6
    v_lshlrev_b32 v53, 2, v53
    s_sub_u32 s96, s96, 1
    s_cbranch_scc1 L_pollgiveup2
    s_sleep 2
    buffer_load_dword v52, v53, s[20:23], s44 offen sc1
    s_waitcnt vmcnt(0)
    v_subrev_u32 v52, s92, v52
    v_cmp_lt_u32 vcc, 15, v52
    s_nop 0
    s_and_b32 s59, vcc_lo, 0xff
    s_cbranch_scc1 L_pollvec2
    s_branch L_pollok2
L_pollgiveup2:
    s_mov_b32 s96, 0
    s_branch L_pollok2
L_pollslow3:
    s_mov_b32 s59, 200
L_pollsm3:
    s_buffer_load_dwordx8 s[48:55], s[20:23], s44 glc
    s_waitcnt lgkmcnt(0)
    s_sub_u32 s48, s48, s92
    s_sub_u32 s49, s49, s92
    s_sub_u32 s50, s50, s92
    s_sub_u32 s51, s51, s92
    s_sub_u32 s52, s52, s92
    s_sub_u32 s53, s53, s92
    s_sub_u32 s54, s54, s92
    s_sub_u32 s55, s55, s92
    s_max_u32 s48, s48, s49
    s_max_u32 s48, s48, s50
    s_max_u32 s48, s48, s51
    s_max_u32 s48, s48, s52
    s_max_u32 s48, s48, s53
    s_max_u32 s48, s48, s54
    s_max_u32 s48, s48, s55
    s_cmp_lt_u32 s48, 16
    s_cbranch_scc1 L_pollok3
    s_sub_u32 s59, s59, 1
    s_cbranch_scc1 L_pollvec3
    s_sleep 1
    s_branch L_pollsm3
L_pollvec3:
    v_bfe_u32 v53, v4, 4, 6
    v_lshlrev_b32 v53, 2, v53
    s_sub_u32 s96, s96, 1
    s_cbranch_scc1 L_pollgiveup3
    s_sleep 2
    buffer_load_dword v52, v53, s[20:23], s44 offen sc1
    s_waitcnt vmcnt(0)
    v_subrev_u32 v52, s92, v52
    v_cmp_lt_u32 vcc, 15, v52
    s_nop 0
    s_and_b32 s59, vcc_lo, 0xff
    s_cbranch_scc1 L_pollvec3
    s_branch L_pollok3
L_pollgiveup3:
    s_mov_b32 s96, 0
    s_branch L_pollok3
L_pollslow4:
    s_mov_b32 s59, 200
L_pollsm4:
    s_buffer_load_dwordx8 s[48:55], s[20:23], s44 glc
    s_waitcnt lgkmcnt(0)
    s_sub_u32 s48, s48, s92
    s_sub_u32 s49, s49, s92
    s_sub_u32 s50, s50, s92
    s_sub_u32 s51, s51, s92
    s_sub_u32 s52, s52, s92
    s_sub_u32 s53, s53, s92
    s_sub_u32 s54, s54, s92
    s_sub_u32 s55, s55, s92
    s_max_u32 s48, s48, s49
    s_max_u32 s48, s48, s50
    s_max_u32 s48, s48, s51
    s_max_u32 s48, s48, s52
    s_max_u32 s48, s48, s53
    s_max_u32 s48, s48, s54
    s_max_u32 s48, s48, s55
    s_cmp_lt_u32 s48, 16
    s_cbranch_scc1 L_pollok4
    s_sub_u32 s59, s59, 1
    s_cbranch_scc1 L_pollvec4
    s_sleep 1
    s_branch L_pollsm4
L_pollvec4:
    v_bfe_u32 v53, v4, 4, 6
    v_lshlrev_b32 v53, 2, v53
    s_sub_u32 s96, s96, 1
    s_cbranch_scc1 L_pollgiveup4
    s_sleep 2
    buffer_load_dword v52, v53, s[20:23], s44 offen sc1
    s_waitcnt vmcnt(0)
    v_subrev_u32 v52, s92, v52
    v_cmp_lt_u32 vcc, 15, v52
    s_nop 0
    s_and_b32 s59, vcc_lo, 0xff
    s_cbranch_scc1 L_pollvec4
    s_branch L_pollok4
L_pollgiveup4:
    s_mov_b32 s96, 0
    s_branch L_pollok4
L_tagslow:
    s_sub_u32 s96, s96, 1
    s_cbranch_scc1 L_taggiveup
    s_sleep 2
    buffer_load_dword v0, off, s[88:91], s93 sc1
    s_waitcnt vmcnt(0)
    v_readfirstlane_b32 s42, v0
    s_nop 0
    s_cmp_eq_u32 s42, s46
    s_cbranch_scc1 L_tagslow
    s_cmp_eq_u32 s42, 0
    s_cbranch_scc1 L_tagslow
    s_branch L_tagok
L_taggiveup:
    s_mov_b32 s96, 0
    s_branch L_tagok
L_slow:
    s_waitcnt vmcnt(0) lgkmcnt(0)
    s_nop 15
    v_accvgpr_write_b32 a0, 0
    v_accvgpr_write_b32 a1, 0
    v_accvgpr_write_b32 a2, 0
    v_accvgpr_write_b32 a3, 0
    v_accvgpr_write_b32 a4, 0
    v_accvgpr_write_b32 a5, 0
    v_accvgpr_write_b32 a6, 0
    v_accvgpr_write_b32 a7, 0
    v_accvgpr_write_b32 a8, 0
    v_accvgpr_write_b32 a9, 0
    v_accvgpr_write_b32 a10, 0
    v_accvgpr_write_b32 a11, 0
    v_accvgpr_write_b32 a12, 0
    v_accvgpr_write_b32 a13, 0
    v_accvgpr_write_b32 a14, 0
    v_accvgpr_write_b32 a15, 0
    v_accvgpr_write_b32 a16, 0
    v_accvgpr_write_b32 a17, 0
    v_accvgpr_write_b32 a18, 0
    v_accvgpr_write_b32 a19, 0
    v_accvgpr_write_b32 a20, 0
    v_accvgpr_write_b32 a21, 0
    v_accvgpr_write_b32 a22, 0
    v_accvgpr_write_b32 a23, 0
    v_accvgpr_write_b32 a24, 0
    v_accvgpr_write_b32 a25, 0
    v_accvgpr_write_b32 a26, 0
    v_accvgpr_write_b32 a27, 0
    v_accvgpr_write_b32 a28, 0
    v_accvgpr_write_b32 a29, 0
    v_accvgpr_write_b32 a30, 0
    v_accvgpr_write_b32 a31, 0
    v_accvgpr_write_b32 a32, 0
    v_accvgpr_write_b32 a33, 0
    v_accvgpr_write_b32 a34, 0
    v_accvgpr_write_b32 a35, 0
    v_accvgpr_write_b32 a36, 0
    v_accvgpr_write_b32 a37, 0
    v_accvgpr_write_b32 a38, 0
    v_accvgpr_write_b32 a39, 0
    v_accvgpr_write_b32 a40, 0
    v_accvgpr_write_b32 a41, 0
    v_accvgpr_write_b32 a42, 0
    v_accvgpr_write_b32 a43, 0
    v_accvgpr_write_b32 a44, 0
    v_accvgpr_write_b32 a45, 0
    v_accvgpr_write_b32 a46, 0
    v_accvgpr_write_b32 a47, 0
    v_accvgpr_write_b32 a48, 0
    v_accvgpr_write_b32 a49, 0
    v_accvgpr_write_b32 a50, 0
    v_accvgpr_write_b32 a51, 0
    v_accvgpr_write_b32 a52, 0
    v_accvgpr_write_b32 a53, 0
    v_accvgpr_write_b32 a54, 0
    v_accvgpr_write_b32 a55, 0
    v_accvgpr_write_b32 a56, 0
    v_accvgpr_write_b32 a57, 0
    v_accvgpr_write_b32 a58, 0
    v_accvgpr_write_b32 a59, 0
    v_accvgpr_write_b32 a60, 0
    v_accvgpr_write_b32 a61, 0
    v_accvgpr_write_b32 a62, 0
    v_accvgpr_write_b32 a63, 0
    v_accvgpr_write_b32 a64, 0
    v_accvgpr_write_b32 a65, 0
    v_accvgpr_write_b32 a66, 0
    v_accvgpr_write_b32 a67, 0
    v_accvgpr_write_b32 a68, 0
    v_accvgpr_write_b32 a69, 0
    v_accvgpr_write_b32 a70, 0
    v_accvgpr_write_b32 a71, 0
    v_accvgpr_write_b32 a72, 0
    v_accvgpr_write_b32 a73, 0
    v_accvgpr_write_b32 a74, 0
    v_accvgpr_write_b32 a75, 0
    v_accvgpr_write_b32 a76, 0
    v_accvgpr_write_b32 a77, 0
    v_accvgpr_write_b32 a78, 0
    v_accvgpr_write_b32 a79, 0
    v_accvgpr_write_b32 a80, 0
    v_accvgpr_write_b32 a81, 0
    v_accvgpr_write_b32 a82, 0
    v_accvgpr_write_b32 a83, 0
    v_accvgpr_write_b32 a84, 0
    v_accvgpr_write_b32 a85, 0
    v_accvgpr_write_b32 a86, 0
    v_accvgpr_write_b32 a87, 0
    v_accvgpr_write_b32 a88, 0
    v_accvgpr_write_b32 a89, 0
    v_accvgpr_write_b32 a90, 0
    v_accvgpr_write_b32 a91, 0
    v_accvgpr_write_b32 a92, 0
    v_accvgpr_write_b32 a93, 0
    v_accvgpr_write_b32 a94, 0
    v_accvgpr_write_b32 a95, 0
    v_accvgpr_write_b32 a96, 0
    v_accvgpr_write_b32 a97, 0
    v_accvgpr_write_b32 a98, 0
    v_accvgpr_write_b32 a99, 0
    v_accvgpr_write_b32 a100, 0
    v_accvgpr_write_b32 a101, 0
    v_accvgpr_write_b32 a102, 0
    v_accvgpr_write_b32 a103, 0
    v_accvgpr_write_b32 a104, 0
    v_accvgpr_write_b32 a105, 0
    v_accvgpr_write_b32 a106, 0
    v_accvgpr_write_b32 a107, 0
    v_accvgpr_write_b32 a108, 0
    v_accvgpr_write_b32 a109, 0
    v_accvgpr_write_b32 a110, 0
    v_accvgpr_write_b32 a111, 0
    v_accvgpr_write_b32 a112, 0
    v_accvgpr_write_b32 a113, 0
    v_accvgpr_write_b32 a114, 0
    v_accvgpr_write_b32 a115, 0
    v_accvgpr_write_b32 a116, 0
    v_accvgpr_write_b32 a117, 0
    v_accvgpr_write_b32 a118, 0
    v_accvgpr_write_b32 a119, 0
    v_accvgpr_write_b32 a120, 0
    v_accvgpr_write_b32 a121, 0
    v_accvgpr_write_b32 a122, 0
    v_accvgpr_write_b32 a123, 0
    v_accvgpr_write_b32 a124, 0
    v_accvgpr_write_b32 a125, 0
    v_accvgpr_write_b32 a126, 0
    v_accvgpr_write_b32 a127, 0
    v_accvgpr_write_b32 a128, 0
    v_accvgpr_write_b32 a129, 0
    v_accvgpr_write_b32 a130, 0
    v_accvgpr_write_b32 a131, 0
    v_accvgpr_write_b32 a132, 0
    v_accvgpr_write_b32 a133, 0
    v_accvgpr_write_b32 a134, 0
    v_accvgpr_write_b32 a135, 0
    v_accvgpr_write_b32 a136, 0
    v_accvgpr_write_b32 a137, 0
    v_accvgpr_write_b32 a138, 0
    v_accvgpr_write_b32 a139, 0
    v_accvgpr_write_b32 a140, 0
    v_accvgpr_write_b32 a141, 0
    v_accvgpr_write_b32 a142, 0
    v_accvgpr_write_b32 a143, 0
    v_accvgpr_write_b32 a144, 0
    v_accvgpr_write_b32 a145, 0
    v_accvgpr_write_b32 a146, 0
    v_accvgpr_write_b32 a147, 0
    v_accvgpr_write_b32 a148, 0
    v_accvgpr_write_b32 a149, 0
    v_accvgpr_write_b32 a150, 0
    v_accvgpr_write_b32 a151, 0
    v_accvgpr_write_b32 a152, 0
    v_accvgpr_write_b32 a153, 0
    v_accvgpr_write_b32 a154, 0
    v_accvgpr_write_b32 a155, 0
    v_accvgpr_write_b32 a156, 0
    v_accvgpr_write_b32 a157, 0
    v_accvgpr_write_b32 a158, 0
    v_accvgpr_write_b32 a159, 0
    v_accvgpr_write_b32 a160, 0
    v_accvgpr_write_b32 a161, 0
    v_accvgpr_write_b32 a162, 0
    v_accvgpr_write_b32 a163, 0
    v_accvgpr_write_b32 a164, 0
    v_accvgpr_write_b32 a165, 0
    v_accvgpr_write_b32 a166, 0
    v_accvgpr_write_b32 a167, 0
    v_accvgpr_write_b32 a168, 0
    v_accvgpr_write_b32 a169, 0
    v_accvgpr_write_b32 a170, 0
    v_accvgpr_write_b32 a171, 0
    v_accvgpr_write_b32 a172, 0
    v_accvgpr_write_b32 a173, 0
    v_accvgpr_write_b32 a174, 0
    v_accvgpr_write_b32 a175, 0
    v_accvgpr_write_b32 a176, 0
    v_accvgpr_write_b32 a177, 0
    v_accvgpr_write_b32 a178, 0
    v_accvgpr_write_b32 a179, 0
    v_accvgpr_write_b32 a180, 0
    v_accvgpr_write_b32 a181, 0
    v_accvgpr_write_b32 a182, 0
    v_accvgpr_write_b32 a183, 0
    v_accvgpr_write_b32 a184, 0
    v_accvgpr_write_b32 a185, 0
    v_accvgpr_write_b32 a186, 0
    v_accvgpr_write_b32 a187, 0
    v_accvgpr_write_b32 a188, 0
    v_accvgpr_write_b32 a189, 0
    v_accvgpr_write_b32 a190, 0
    v_accvgpr_write_b32 a191, 0
    v_mov_b32 v5, 0
    v_mov_b32 v240, 0xff7fffff
    v_mov_b32 v6, 0
    v_mov_b32 v241, 0xff7fffff
    v_mov_b32 v7, 0
    v_mov_b32 v242, 0xff7fffff
    v_mov_b32 v8, 0
    v_mov_b32 v243, 0xff7fffff
    v_subrev_u32 v244, 49152, v2
    v_subrev_u32 v245, 49152, v3
    v_subrev_u32 v246, 24576, v1
    s_mov_b32 s48, 0
L_slowloop:
    s_add_u32 s49, s48, 6144
    s_add_u32 s50, s48, 12288
    s_add_u32 s51, s48, 16384
    s_add_u32 s52, s48, 20480
    buffer_load_dwordx4 v[64:67], v244, s[4:7], s48 offen offset:0 sc1
    buffer_load_dwordx4 v[68:71], v245, s[4:7], s48 offen offset:0 sc1
    buffer_load_dwordx4 v[72:75], v244, s[4:7], s49 offen offset:0 sc1
    buffer_load_dwordx4 v[76:79], v245, s[4:7], s49 offen offset:0 sc1
    buffer_load_dwordx4 v[80:83], v244, s[4:7], s48 offen offset:128 sc1
    buffer_load_dwordx4 v[84:87], v245, s[4:7], s48 offen offset:128 sc1
    buffer_load_dwordx4 v[88:91], v244, s[4:7], s49 offen offset:128 sc1
    buffer_load_dwordx4 v[92:95], v245, s[4:7], s49 offen offset:128 sc1
    buffer_load_dwordx4 v[96:99], v244, s[4:7], s48 offen offset:256 sc1
    buffer_load_dwordx4 v[100:103], v245, s[4:7], s48 offen offset:256 sc1
    buffer_load_dwordx4 v[104:107], v244, s[4:7], s49 offen offset:256 sc1
    buffer_load_dwordx4 v[108:111], v245, s[4:7], s49 offen offset:256 sc1
    buffer_load_dwordx4 v[112:115], v246, s[4:7], s50 offen offset:0 sc1
    buffer_load_dwordx4 v[116:119], v246, s[4:7], s50 offen offset:1024 sc1
    buffer_load_dwordx4 v[120:123], v246, s[4:7], s50 offen offset:2048 sc1
    buffer_load_dwordx4 v[124:127], v246, s[4:7], s50 offen offset:3072 sc1
    buffer_load_dwordx4 v[128:131], v246, s[4:7], s51 offen offset:0 sc1
    buffer_load_dwordx4 v[132:135], v246, s[4:7], s51 offen offset:1024 sc1
    buffer_load_dwordx4 v[136:139], v246, s[4:7], s51 offen offset:2048 sc1
    buffer_load_dwordx4 v[140:143], v246, s[4:7], s51 offen offset:3072 sc1
    buffer_load_dwordx4 v[144:147], v246, s[4:7], s52 offen offset:0 sc1
    buffer_load_dwordx4 v[148:151], v246, s[4:7], s52 offen offset:1024 sc1
    buffer_load_dwordx4 v[152:155], v246, s[4:7], s52 offen offset:2048 sc1
    buffer_load_dwordx4 v[156:159], v246, s[4:7], s52 offen offset:3072 sc1
    s_waitcnt vmcnt(12)
    v_mfma_f32_16x16x32_bf16 v[160:163], v[64:67], a[192:195], 0
    v_mfma_f32_16x16x32_bf16 v[168:171], v[64:67], a[216:219], 0
    v_mfma_f32_16x16x32_bf16 v[176:179], v[64:67], a[240:243], 0
    v_mfma_f32_16x16x32_bf16 v[184:187], v[64:67], v[200:203], 0
    v_mfma_f32_16x16x32_bf16 v[160:163], v[68:71], a[196:199], v[160:163]
    v_mfma_f32_16x16x32_bf16 v[168:171], v[68:71], a[220:223], v[168:171]
    v_mfma_f32_16x16x32_bf16 v[176:179], v[68:71], a[244:247], v[176:179]
    v_mfma_f32_16x16x32_bf16 v[184:187], v[68:71], v[204:207], v[184:187]
    v_mfma_f32_16x16x32_bf16 v[164:167], v[72:75], a[192:195], 0
    v_mfma_f32_16x16x32_bf16 v[172:175], v[72:75], a[216:219], 0
    v_mfma_f32_16x16x32_bf16 v[180:183], v[72:75], a[240:243], 0
    v_mfma_f32_16x16x32_bf16 v[188:191], v[72:75], v[200:203], 0
    v_mfma_f32_16x16x32_bf16 v[164:167], v[76:79], a[196:199], v[164:167]
    v_mfma_f32_16x16x32_bf16 v[172:175], v[76:79], a[220:223], v[172:175]
    v_mfma_f32_16x16x32_bf16 v[180:183], v[76:79], a[244:247], v[180:183]
    v_mfma_f32_16x16x32_bf16 v[188:191], v[76:79], v[204:207], v[188:191]
    v_mfma_f32_16x16x32_bf16 v[160:163], v[80:83], a[200:203], v[160:163]
    v_mfma_f32_16x16x32_bf16 v[168:171], v[80:83], a[224:227], v[168:171]
    v_mfma_f32_16x16x32_bf16 v[176:179], v[80:83], a[248:251], v[176:179]
    v_mfma_f32_16x16x32_bf16 v[184:187], v[80:83], v[208:211], v[184:187]
    v_mfma_f32_16x16x32_bf16 v[160:163], v[84:87], a[204:207], v[160:163]
    v_mfma_f32_16x16x32_bf16 v[168:171], v[84:87], a[228:231], v[168:171]
    v_mfma_f32_16x16x32_bf16 v[176:179], v[84:87], a[252:255], v[176:179]
    v_mfma_f32_16x16x32_bf16 v[184:187], v[84:87], v[212:215], v[184:187]
    v_mfma_f32_16x16x32_bf16 v[164:167], v[88:91], a[200:203], v[164:167]
    v_mfma_f32_16x16x32_bf16 v[172:175], v[88:91], a[224:227], v[172:175]
    v_mfma_f32_16x16x32_bf16 v[180:183], v[88:91], a[248:251], v[180:183]
    v_mfma_f32_16x16x32_bf16 v[188:191], v[88:91], v[208:211], v[188:191]
    v_mfma_f32_16x16x32_bf16 v[164:167], v[92:95], a[204:207], v[164:167]
    v_mfma_f32_16x16x32_bf16 v[172:175], v[92:95], a[228:231], v[172:175]
    v_mfma_f32_16x16x32_bf16 v[180:183], v[92:95], a[252:255], v[180:183]
    v_mfma_f32_16x16x32_bf16 v[188:191], v[92:95], v[212:215], v[188:191]
    v_mfma_f32_16x16x32_bf16 v[160:163], v[96:99], a[208:211], v[160:163]
    v_mfma_f32_16x16x32_bf16 v[168:171], v[96:99], a[232:235], v[168:171]
    v_mfma_f32_16x16x32_bf16 v[176:179], v[96:99], v[192:195], v[176:179]
    v_mfma_f32_16x16x32_bf16 v[184:187], v[96:99], v[216:219], v[184:187]
    v_mfma_f32_16x16x32_bf16 v[160:163], v[100:103], a[212:215], v[160:163]
    v_mfma_f32_16x16x32_bf16 v[168:171], v[100:103], a[236:239], v[168:171]
    v_mfma_f32_16x16x32_bf16 v[176:179], v[100:103], v[196:199], v[176:179]
    v_mfma_f32_16x16x32_bf16 v[184:187], v[100:103], v[220:223], v[184:187]
    v_mfma_f32_16x16x32_bf16 v[164:167], v[104:107], a[208:211], v[164:167]
    v_mfma_f32_16x16x32_bf16 v[172:175], v[104:107], a[232:235], v[172:175]
    v_mfma_f32_16x16x32_bf16 v[180:183], v[104:107], v[192:195], v[180:183]
    v_mfma_f32_16x16x32_bf16 v[188:191], v[104:107], v[216:219], v[188:191]
    v_mfma_f32_16x16x32_bf16 v[164:167], v[108:111], a[212:215], v[164:167]
    v_mfma_f32_16x16x32_bf16 v[172:175], v[108:111], a[236:239], v[172:175]
    v_mfma_f32_16x16x32_bf16 v[180:183], v[108:111], v[196:199], v[180:183]
    v_mfma_f32_16x16x32_bf16 v[188:191], v[108:111], v[220:223], v[188:191]
    s_nop 9
    v_max3_f32 v16, v160, v161, v162
    v_max3_f32 v16, v16, v163, v164
    v_max3_f32 v16, v16, v165, v166
    v_max3_f32 v16, v16, v167, v240
    v_mov_b32 v17, v16
    s_nop 1
    v_permlane16_swap_b32 v16, v17
    s_nop 1
    v_max_f32 v16, v16, v17
    v_mov_b32 v17, v16
    s_nop 1
    v_permlane32_swap_b32 v16, v17
    s_nop 1
    v_max_f32 v16, v16, v17
    v_sub_f32 v17, v240, v16
    v_exp_f32 v17, v17
    v_mov_b32 v240, v16
    v_sub_f32 v160, v160, v16
    v_sub_f32 v161, v161, v16
    v_sub_f32 v162, v162, v16
    v_sub_f32 v163, v163, v16
    v_sub_f32 v164, v164, v16
    v_sub_f32 v165, v165, v16
    v_sub_f32 v166, v166, v16
    v_sub_f32 v167, v167, v16
    v_exp_f32 v160, v160
    v_exp_f32 v161, v161
    v_exp_f32 v162, v162
    v_exp_f32 v163, v163
    v_exp_f32 v164, v164
    v_exp_f32 v165, v165
    v_exp_f32 v166, v166
    v_exp_f32 v167, v167
    v_mul_f32 v5, v5, v17
    v_add_f32 v5, v5, v160
    v_add_f32 v5, v5, v161
    v_add_f32 v5, v5, v162
    v_add_f32 v5, v5, v163
    v_add_f32 v5, v5, v164
    v_add_f32 v5, v5, v165
    v_add_f32 v5, v5, v166
    v_add_f32 v5, v5, v167
    v_cvt_pk_bf16_f32 v224, v160, v161
    v_cvt_pk_bf16_f32 v225, v162, v163
    v_cvt_pk_bf16_f32 v226, v164, v165
    v_cvt_pk_bf16_f32 v227, v166, v167
    ds_bpermute_b32 v248, v58, v17 offset:0
    ds_bpermute_b32 v249, v58, v17 offset:4
    ds_bpermute_b32 v250, v58, v17 offset:8
    ds_bpermute_b32 v251, v58, v17 offset:12
    s_waitcnt lgkmcnt(0)
    v_accvgpr_read_b32 v18, a0
    v_mul_f32 v18, v18, v248
    v_accvgpr_write_b32 a0, v18
    v_accvgpr_read_b32 v19, a1
    v_mul_f32 v19, v19, v249
    v_accvgpr_write_b32 a1, v19
    v_accvgpr_read_b32 v18, a2
    v_mul_f32 v18, v18, v250
    v_accvgpr_write_b32 a2, v18
    v_accvgpr_read_b32 v19, a3
    v_mul_f32 v19, v19, v251
    v_accvgpr_write_b32 a3, v19
    v_accvgpr_read_b32 v18, a4
    v_mul_f32 v18, v18, v248
    v_accvgpr_write_b32 a4, v18
    v_accvgpr_read_b32 v19, a5
    v_mul_f32 v19, v19, v249
    v_accvgpr_write_b32 a5, v19
    v_accvgpr_read_b32 v18, a6
    v_mul_f32 v18, v18, v250
    v_accvgpr_write_b32 a6, v18
    v_accvgpr_read_b32 v19, a7
    v_mul_f32 v19, v19, v251
    v_accvgpr_write_b32 a7, v19
    v_accvgpr_read_b32 v18, a8
    v_mul_f32 v18, v18, v248
    v_accvgpr_write_b32 a8, v18
    v_accvgpr_read_b32 v19, a9
    v_mul_f32 v19, v19, v249
    v_accvgpr_write_b32 a9, v19
    v_accvgpr_read_b32 v18, a10
    v_mul_f32 v18, v18, v250
    v_accvgpr_write_b32 a10, v18
    v_accvgpr_read_b32 v19, a11
    v_mul_f32 v19, v19, v251
    v_accvgpr_write_b32 a11, v19
    v_accvgpr_read_b32 v18, a12
    v_mul_f32 v18, v18, v248
    v_accvgpr_write_b32 a12, v18
    v_accvgpr_read_b32 v19, a13
    v_mul_f32 v19, v19, v249
    v_accvgpr_write_b32 a13, v19
    v_accvgpr_read_b32 v18, a14
    v_mul_f32 v18, v18, v250
    v_accvgpr_write_b32 a14, v18
    v_accvgpr_read_b32 v19, a15
    v_mul_f32 v19, v19, v251
    v_accvgpr_write_b32 a15, v19
    v_accvgpr_read_b32 v18, a16
    v_mul_f32 v18, v18, v248
    v_accvgpr_write_b32 a16, v18
    v_accvgpr_read_b32 v19, a17
    v_mul_f32 v19, v19, v249
    v_accvgpr_write_b32 a17, v19
    v_accvgpr_read_b32 v18, a18
    v_mul_f32 v18, v18, v250
    v_accvgpr_write_b32 a18, v18
    v_accvgpr_read_b32 v19, a19
    v_mul_f32 v19, v19, v251
    v_accvgpr_write_b32 a19, v19
    v_accvgpr_read_b32 v18, a20
    v_mul_f32 v18, v18, v248
    v_accvgpr_write_b32 a20, v18
    v_accvgpr_read_b32 v19, a21
    v_mul_f32 v19, v19, v249
    v_accvgpr_write_b32 a21, v19
    v_accvgpr_read_b32 v18, a22
    v_mul_f32 v18, v18, v250
    v_accvgpr_write_b32 a22, v18
    v_accvgpr_read_b32 v19, a23
    v_mul_f32 v19, v19, v251
    v_accvgpr_write_b32 a23, v19
    v_accvgpr_read_b32 v18, a24
    v_mul_f32 v18, v18, v248
    v_accvgpr_write_b32 a24, v18
    v_accvgpr_read_b32 v19, a25
    v_mul_f32 v19, v19, v249
    v_accvgpr_write_b32 a25, v19
    v_accvgpr_read_b32 v18, a26
    v_mul_f32 v18, v18, v250
    v_accvgpr_write_b32 a26, v18
    v_accvgpr_read_b32 v19, a27
    v_mul_f32 v19, v19, v251
    v_accvgpr_write_b32 a27, v19
    v_accvgpr_read_b32 v18, a28
    v_mul_f32 v18, v18, v248
    v_accvgpr_write_b32 a28, v18
    v_accvgpr_read_b32 v19, a29
    v_mul_f32 v19, v19, v249
    v_accvgpr_write_b32 a29, v19
    v_accvgpr_read_b32 v18, a30
    v_mul_f32 v18, v18, v250
    v_accvgpr_write_b32 a30, v18
    v_accvgpr_read_b32 v19, a31
    v_mul_f32 v19, v19, v251
    v_accvgpr_write_b32 a31, v19
    v_accvgpr_read_b32 v18, a32
    v_mul_f32 v18, v18, v248
    v_accvgpr_write_b32 a32, v18
    v_accvgpr_read_b32 v19, a33
    v_mul_f32 v19, v19, v249
    v_accvgpr_write_b32 a33, v19
    v_accvgpr_read_b32 v18, a34
    v_mul_f32 v18, v18, v250
    v_accvgpr_write_b32 a34, v18
    v_accvgpr_read_b32 v19, a35
    v_mul_f32 v19, v19, v251
    v_accvgpr_write_b32 a35, v19
    v_accvgpr_read_b32 v18, a36
    v_mul_f32 v18, v18, v248
    v_accvgpr_write_b32 a36, v18
    v_accvgpr_read_b32 v19, a37
    v_mul_f32 v19, v19, v249
    v_accvgpr_write_b32 a37, v19
    v_accvgpr_read_b32 v18, a38
    v_mul_f32 v18, v18, v250
    v_accvgpr_write_b32 a38, v18
    v_accvgpr_read_b32 v19, a39
    v_mul_f32 v19, v19, v251
    v_accvgpr_write_b32 a39, v19
    v_accvgpr_read_b32 v18, a40
    v_mul_f32 v18, v18, v248
    v_accvgpr_write_b32 a40, v18
    v_accvgpr_read_b32 v19, a41
    v_mul_f32 v19, v19, v249
    v_accvgpr_write_b32 a41, v19
    v_accvgpr_read_b32 v18, a42
    v_mul_f32 v18, v18, v250
    v_accvgpr_write_b32 a42, v18
    v_accvgpr_read_b32 v19, a43
    v_mul_f32 v19, v19, v251
    v_accvgpr_write_b32 a43, v19
    v_accvgpr_read_b32 v18, a44
    v_mul_f32 v18, v18, v248
    v_accvgpr_write_b32 a44, v18
    v_accvgpr_read_b32 v19, a45
    v_mul_f32 v19, v19, v249
    v_accvgpr_write_b32 a45, v19
    v_accvgpr_read_b32 v18, a46
    v_mul_f32 v18, v18, v250
    v_accvgpr_write_b32 a46, v18
    v_accvgpr_read_b32 v19, a47
    v_mul_f32 v19, v19, v251
    v_accvgpr_write_b32 a47, v19
    v_max3_f32 v16, v168, v169, v170
    v_max3_f32 v16, v16, v171, v172
    v_max3_f32 v16, v16, v173, v174
    v_max3_f32 v16, v16, v175, v241
    v_mov_b32 v17, v16
    s_nop 1
    v_permlane16_swap_b32 v16, v17
    s_nop 1
    v_max_f32 v16, v16, v17
    v_mov_b32 v17, v16
    s_nop 1
    v_permlane32_swap_b32 v16, v17
    s_nop 1
    v_max_f32 v16, v16, v17
    v_sub_f32 v17, v241, v16
    v_exp_f32 v17, v17
    v_mov_b32 v241, v16
    v_sub_f32 v168, v168, v16
    v_sub_f32 v169, v169, v16
    v_sub_f32 v170, v170, v16
    v_sub_f32 v171, v171, v16
    v_sub_f32 v172, v172, v16
    v_sub_f32 v173, v173, v16
    v_sub_f32 v174, v174, v16
    v_sub_f32 v175, v175, v16
    v_exp_f32 v168, v168
    v_exp_f32 v169, v169
    v_exp_f32 v170, v170
    v_exp_f32 v171, v171
    v_exp_f32 v172, v172
    v_exp_f32 v173, v173
    v_exp_f32 v174, v174
    v_exp_f32 v175, v175
    v_mul_f32 v6, v6, v17
    v_add_f32 v6, v6, v168
    v_add_f32 v6, v6, v169
    v_add_f32 v6, v6, v170
    v_add_f32 v6, v6, v171
    v_add_f32 v6, v6, v172
    v_add_f32 v6, v6, v173
    v_add_f32 v6, v6, v174
    v_add_f32 v6, v6, v175
    v_cvt_pk_bf16_f32 v228, v168, v169
    v_cvt_pk_bf16_f32 v229, v170, v171
    v_cvt_pk_bf16_f32 v230, v172, v173
    v_cvt_pk_bf16_f32 v231, v174, v175
    ds_bpermute_b32 v248, v58, v17 offset:0
    ds_bpermute_b32 v249, v58, v17 offset:4
    ds_bpermute_b32 v250, v58, v17 offset:8
    ds_bpermute_b32 v251, v58, v17 offset:12
    s_waitcnt lgkmcnt(0)
    v_accvgpr_read_b32 v18, a48
    v_mul_f32 v18, v18, v248
    v_accvgpr_write_b32 a48, v18
    v_accvgpr_read_b32 v19, a49
    v_mul_f32 v19, v19, v249
    v_accvgpr_write_b32 a49, v19
    v_accvgpr_read_b32 v18, a50
    v_mul_f32 v18, v18, v250
    v_accvgpr_write_b32 a50, v18
    v_accvgpr_read_b32 v19, a51
    v_mul_f32 v19, v19, v251
    v_accvgpr_write_b32 a51, v19
    v_accvgpr_read_b32 v18, a52
    v_mul_f32 v18, v18, v248
    v_accvgpr_write_b32 a52, v18
    v_accvgpr_read_b32 v19, a53
    v_mul_f32 v19, v19, v249
    v_accvgpr_write_b32 a53, v19
    v_accvgpr_read_b32 v18, a54
    v_mul_f32 v18, v18, v250
    v_accvgpr_write_b32 a54, v18
    v_accvgpr_read_b32 v19, a55
    v_mul_f32 v19, v19, v251
    v_accvgpr_write_b32 a55, v19
    v_accvgpr_read_b32 v18, a56
    v_mul_f32 v18, v18, v248
    v_accvgpr_write_b32 a56, v18
    v_accvgpr_read_b32 v19, a57
    v_mul_f32 v19, v19, v249
    v_accvgpr_write_b32 a57, v19
    v_accvgpr_read_b32 v18, a58
    v_mul_f32 v18, v18, v250
    v_accvgpr_write_b32 a58, v18
    v_accvgpr_read_b32 v19, a59
    v_mul_f32 v19, v19, v251
    v_accvgpr_write_b32 a59, v19
    v_accvgpr_read_b32 v18, a60
    v_mul_f32 v18, v18, v248
    v_accvgpr_write_b32 a60, v18
    v_accvgpr_read_b32 v19, a61
    v_mul_f32 v19, v19, v249
    v_accvgpr_write_b32 a61, v19
    v_accvgpr_read_b32 v18, a62
    v_mul_f32 v18, v18, v250
    v_accvgpr_write_b32 a62, v18
    v_accvgpr_read_b32 v19, a63
    v_mul_f32 v19, v19, v251
    v_accvgpr_write_b32 a63, v19
    v_accvgpr_read_b32 v18, a64
    v_mul_f32 v18, v18, v248
    v_accvgpr_write_b32 a64, v18
    v_accvgpr_read_b32 v19, a65
    v_mul_f32 v19, v19, v249
    v_accvgpr_write_b32 a65, v19
    v_accvgpr_read_b32 v18, a66
    v_mul_f32 v18, v18, v250
    v_accvgpr_write_b32 a66, v18
    v_accvgpr_read_b32 v19, a67
    v_mul_f32 v19, v19, v251
    v_accvgpr_write_b32 a67, v19
    v_accvgpr_read_b32 v18, a68
    v_mul_f32 v18, v18, v248
    v_accvgpr_write_b32 a68, v18
    v_accvgpr_read_b32 v19, a69
    v_mul_f32 v19, v19, v249
    v_accvgpr_write_b32 a69, v19
    v_accvgpr_read_b32 v18, a70
    v_mul_f32 v18, v18, v250
    v_accvgpr_write_b32 a70, v18
    v_accvgpr_read_b32 v19, a71
    v_mul_f32 v19, v19, v251
    v_accvgpr_write_b32 a71, v19
    v_accvgpr_read_b32 v18, a72
    v_mul_f32 v18, v18, v248
    v_accvgpr_write_b32 a72, v18
    v_accvgpr_read_b32 v19, a73
    v_mul_f32 v19, v19, v249
    v_accvgpr_write_b32 a73, v19
    v_accvgpr_read_b32 v18, a74
    v_mul_f32 v18, v18, v250
    v_accvgpr_write_b32 a74, v18
    v_accvgpr_read_b32 v19, a75
    v_mul_f32 v19, v19, v251
    v_accvgpr_write_b32 a75, v19
    v_accvgpr_read_b32 v18, a76
    v_mul_f32 v18, v18, v248
    v_accvgpr_write_b32 a76, v18
    v_accvgpr_read_b32 v19, a77
    v_mul_f32 v19, v19, v249
    v_accvgpr_write_b32 a77, v19
    v_accvgpr_read_b32 v18, a78
    v_mul_f32 v18, v18, v250
    v_accvgpr_write_b32 a78, v18
    v_accvgpr_read_b32 v19, a79
    v_mul_f32 v19, v19, v251
    v_accvgpr_write_b32 a79, v19
    v_accvgpr_read_b32 v18, a80
    v_mul_f32 v18, v18, v248
    v_accvgpr_write_b32 a80, v18
    v_accvgpr_read_b32 v19, a81
    v_mul_f32 v19, v19, v249
    v_accvgpr_write_b32 a81, v19
    v_accvgpr_read_b32 v18, a82
    v_mul_f32 v18, v18, v250
    v_accvgpr_write_b32 a82, v18
    v_accvgpr_read_b32 v19, a83
    v_mul_f32 v19, v19, v251
    v_accvgpr_write_b32 a83, v19
    v_accvgpr_read_b32 v18, a84
    v_mul_f32 v18, v18, v248
    v_accvgpr_write_b32 a84, v18
    v_accvgpr_read_b32 v19, a85
    v_mul_f32 v19, v19, v249
    v_accvgpr_write_b32 a85, v19
    v_accvgpr_read_b32 v18, a86
    v_mul_f32 v18, v18, v250
    v_accvgpr_write_b32 a86, v18
    v_accvgpr_read_b32 v19, a87
    v_mul_f32 v19, v19, v251
    v_accvgpr_write_b32 a87, v19
    v_accvgpr_read_b32 v18, a88
    v_mul_f32 v18, v18, v248
    v_accvgpr_write_b32 a88, v18
    v_accvgpr_read_b32 v19, a89
    v_mul_f32 v19, v19, v249
    v_accvgpr_write_b32 a89, v19
    v_accvgpr_read_b32 v18, a90
    v_mul_f32 v18, v18, v250
    v_accvgpr_write_b32 a90, v18
    v_accvgpr_read_b32 v19, a91
    v_mul_f32 v19, v19, v251
    v_accvgpr_write_b32 a91, v19
    v_accvgpr_read_b32 v18, a92
    v_mul_f32 v18, v18, v248
    v_accvgpr_write_b32 a92, v18
    v_accvgpr_read_b32 v19, a93
    v_mul_f32 v19, v19, v249
    v_accvgpr_write_b32 a93, v19
    v_accvgpr_read_b32 v18, a94
    v_mul_f32 v18, v18, v250
    v_accvgpr_write_b32 a94, v18
    v_accvgpr_read_b32 v19, a95
    v_mul_f32 v19, v19, v251
    v_accvgpr_write_b32 a95, v19
    v_max3_f32 v16, v176, v177, v178
    v_max3_f32 v16, v16, v179, v180
    v_max3_f32 v16, v16, v181, v182
    v_max3_f32 v16, v16, v183, v242
    v_mov_b32 v17, v16
    s_nop 1
    v_permlane16_swap_b32 v16, v17
    s_nop 1
    v_max_f32 v16, v16, v17
    v_mov_b32 v17, v16
    s_nop 1
    v_permlane32_swap_b32 v16, v17
    s_nop 1
    v_max_f32 v16, v16, v17
    v_sub_f32 v17, v242, v16
    v_exp_f32 v17, v17
    v_mov_b32 v242, v16
    v_sub_f32 v176, v176, v16
    v_sub_f32 v177, v177, v16
    v_sub_f32 v178, v178, v16
    v_sub_f32 v179, v179, v16
    v_sub_f32 v180, v180, v16
    v_sub_f32 v181, v181, v16
    v_sub_f32 v182, v182, v16
    v_sub_f32 v183, v183, v16
    v_exp_f32 v176, v176
    v_exp_f32 v177, v177
    v_exp_f32 v178, v178
    v_exp_f32 v179, v179
    v_exp_f32 v180, v180
    v_exp_f32 v181, v181
    v_exp_f32 v182, v182
    v_exp_f32 v183, v183
    v_mul_f32 v7, v7, v17
    v_add_f32 v7, v7, v176
    v_add_f32 v7, v7, v177
    v_add_f32 v7, v7, v178
    v_add_f32 v7, v7, v179
    v_add_f32 v7, v7, v180
    v_add_f32 v7, v7, v181
    v_add_f32 v7, v7, v182
    v_add_f32 v7, v7, v183
    v_cvt_pk_bf16_f32 v232, v176, v177
    v_cvt_pk_bf16_f32 v233, v178, v179
    v_cvt_pk_bf16_f32 v234, v180, v181
    v_cvt_pk_bf16_f32 v235, v182, v183
    ds_bpermute_b32 v248, v58, v17 offset:0
    ds_bpermute_b32 v249, v58, v17 offset:4
    ds_bpermute_b32 v250, v58, v17 offset:8
    ds_bpermute_b32 v251, v58, v17 offset:12
    s_waitcnt lgkmcnt(0)
    v_accvgpr_read_b32 v18, a96
    v_mul_f32 v18, v18, v248
    v_accvgpr_write_b32 a96, v18
    v_accvgpr_read_b32 v19, a97
    v_mul_f32 v19, v19, v249
    v_accvgpr_write_b32 a97, v19
    v_accvgpr_read_b32 v18, a98
    v_mul_f32 v18, v18, v250
    v_accvgpr_write_b32 a98, v18
    v_accvgpr_read_b32 v19, a99
    v_mul_f32 v19, v19, v251
    v_accvgpr_write_b32 a99, v19
    v_accvgpr_read_b32 v18, a100
    v_mul_f32 v18, v18, v248
    v_accvgpr_write_b32 a100, v18
    v_accvgpr_read_b32 v19, a101
    v_mul_f32 v19, v19, v249
    v_accvgpr_write_b32 a101, v19
    v_accvgpr_read_b32 v18, a102
    v_mul_f32 v18, v18, v250
    v_accvgpr_write_b32 a102, v18
    v_accvgpr_read_b32 v19, a103
    v_mul_f32 v19, v19, v251
    v_accvgpr_write_b32 a103, v19
    v_accvgpr_read_b32 v18, a104
    v_mul_f32 v18, v18, v248
    v_accvgpr_write_b32 a104, v18
    v_accvgpr_read_b32 v19, a105
    v_mul_f32 v19, v19, v249
    v_accvgpr_write_b32 a105, v19
    v_accvgpr_read_b32 v18, a106
    v_mul_f32 v18, v18, v250
    v_accvgpr_write_b32 a106, v18
    v_accvgpr_read_b32 v19, a107
    v_mul_f32 v19, v19, v251
    v_accvgpr_write_b32 a107, v19
    v_accvgpr_read_b32 v18, a108
    v_mul_f32 v18, v18, v248
    v_accvgpr_write_b32 a108, v18
    v_accvgpr_read_b32 v19, a109
    v_mul_f32 v19, v19, v249
    v_accvgpr_write_b32 a109, v19
    v_accvgpr_read_b32 v18, a110
    v_mul_f32 v18, v18, v250
    v_accvgpr_write_b32 a110, v18
    v_accvgpr_read_b32 v19, a111
    v_mul_f32 v19, v19, v251
    v_accvgpr_write_b32 a111, v19
    v_accvgpr_read_b32 v18, a112
    v_mul_f32 v18, v18, v248
    v_accvgpr_write_b32 a112, v18
    v_accvgpr_read_b32 v19, a113
    v_mul_f32 v19, v19, v249
    v_accvgpr_write_b32 a113, v19
    v_accvgpr_read_b32 v18, a114
    v_mul_f32 v18, v18, v250
    v_accvgpr_write_b32 a114, v18
    v_accvgpr_read_b32 v19, a115
    v_mul_f32 v19, v19, v251
    v_accvgpr_write_b32 a115, v19
    v_accvgpr_read_b32 v18, a116
    v_mul_f32 v18, v18, v248
    v_accvgpr_write_b32 a116, v18
    v_accvgpr_read_b32 v19, a117
    v_mul_f32 v19, v19, v249
    v_accvgpr_write_b32 a117, v19
    v_accvgpr_read_b32 v18, a118
    v_mul_f32 v18, v18, v250
    v_accvgpr_write_b32 a118, v18
    v_accvgpr_read_b32 v19, a119
    v_mul_f32 v19, v19, v251
    v_accvgpr_write_b32 a119, v19
    v_accvgpr_read_b32 v18, a120
    v_mul_f32 v18, v18, v248
    v_accvgpr_write_b32 a120, v18
    v_accvgpr_read_b32 v19, a121
    v_mul_f32 v19, v19, v249
    v_accvgpr_write_b32 a121, v19
    v_accvgpr_read_b32 v18, a122
    v_mul_f32 v18, v18, v250
    v_accvgpr_write_b32 a122, v18
    v_accvgpr_read_b32 v19, a123
    v_mul_f32 v19, v19, v251
    v_accvgpr_write_b32 a123, v19
    v_accvgpr_read_b32 v18, a124
    v_mul_f32 v18, v18, v248
    v_accvgpr_write_b32 a124, v18
    v_accvgpr_read_b32 v19, a125
    v_mul_f32 v19, v19, v249
    v_accvgpr_write_b32 a125, v19
    v_accvgpr_read_b32 v18, a126
    v_mul_f32 v18, v18, v250
    v_accvgpr_write_b32 a126, v18
    v_accvgpr_read_b32 v19, a127
    v_mul_f32 v19, v19, v251
    v_accvgpr_write_b32 a127, v19
    v_accvgpr_read_b32 v18, a128
    v_mul_f32 v18, v18, v248
    v_accvgpr_write_b32 a128, v18
    v_accvgpr_read_b32 v19, a129
    v_mul_f32 v19, v19, v249
    v_accvgpr_write_b32 a129, v19
    v_accvgpr_read_b32 v18, a130
    v_mul_f32 v18, v18, v250
    v_accvgpr_write_b32 a130, v18
    v_accvgpr_read_b32 v19, a131
    v_mul_f32 v19, v19, v251
    v_accvgpr_write_b32 a131, v19
    v_accvgpr_read_b32 v18, a132
    v_mul_f32 v18, v18, v248
    v_accvgpr_write_b32 a132, v18
    v_accvgpr_read_b32 v19, a133
    v_mul_f32 v19, v19, v249
    v_accvgpr_write_b32 a133, v19
    v_accvgpr_read_b32 v18, a134
    v_mul_f32 v18, v18, v250
    v_accvgpr_write_b32 a134, v18
    v_accvgpr_read_b32 v19, a135
    v_mul_f32 v19, v19, v251
    v_accvgpr_write_b32 a135, v19
    v_accvgpr_read_b32 v18, a136
    v_mul_f32 v18, v18, v248
    v_accvgpr_write_b32 a136, v18
    v_accvgpr_read_b32 v19, a137
    v_mul_f32 v19, v19, v249
    v_accvgpr_write_b32 a137, v19
    v_accvgpr_read_b32 v18, a138
    v_mul_f32 v18, v18, v250
    v_accvgpr_write_b32 a138, v18
    v_accvgpr_read_b32 v19, a139
    v_mul_f32 v19, v19, v251
    v_accvgpr_write_b32 a139, v19
    v_accvgpr_read_b32 v18, a140
    v_mul_f32 v18, v18, v248
    v_accvgpr_write_b32 a140, v18
    v_accvgpr_read_b32 v19, a141
    v_mul_f32 v19, v19, v249
    v_accvgpr_write_b32 a141, v19
    v_accvgpr_read_b32 v18, a142
    v_mul_f32 v18, v18, v250
    v_accvgpr_write_b32 a142, v18
    v_accvgpr_read_b32 v19, a143
    v_mul_f32 v19, v19, v251
    v_accvgpr_write_b32 a143, v19
    v_max3_f32 v16, v184, v185, v186
    v_max3_f32 v16, v16, v187, v188
    v_max3_f32 v16, v16, v189, v190
    v_max3_f32 v16, v16, v191, v243
    v_mov_b32 v17, v16
    s_nop 1
    v_permlane16_swap_b32 v16, v17
    s_nop 1
    v_max_f32 v16, v16, v17
    v_mov_b32 v17, v16
    s_nop 1
    v_permlane32_swap_b32 v16, v17
    s_nop 1
    v_max_f32 v16, v16, v17
    v_sub_f32 v17, v243, v16
    v_exp_f32 v17, v17
    v_mov_b32 v243, v16
    v_sub_f32 v184, v184, v16
    v_sub_f32 v185, v185, v16
    v_sub_f32 v186, v186, v16
    v_sub_f32 v187, v187, v16
    v_sub_f32 v188, v188, v16
    v_sub_f32 v189, v189, v16
    v_sub_f32 v190, v190, v16
    v_sub_f32 v191, v191, v16
    v_exp_f32 v184, v184
    v_exp_f32 v185, v185
    v_exp_f32 v186, v186
    v_exp_f32 v187, v187
    v_exp_f32 v188, v188
    v_exp_f32 v189, v189
    v_exp_f32 v190, v190
    v_exp_f32 v191, v191
    v_mul_f32 v8, v8, v17
    v_add_f32 v8, v8, v184
    v_add_f32 v8, v8, v185
    v_add_f32 v8, v8, v186
    v_add_f32 v8, v8, v187
    v_add_f32 v8, v8, v188
    v_add_f32 v8, v8, v189
    v_add_f32 v8, v8, v190
    v_add_f32 v8, v8, v191
    v_cvt_pk_bf16_f32 v236, v184, v185
    v_cvt_pk_bf16_f32 v237, v186, v187
    v_cvt_pk_bf16_f32 v238, v188, v189
    v_cvt_pk_bf16_f32 v239, v190, v191
    ds_bpermute_b32 v248, v58, v17 offset:0
    ds_bpermute_b32 v249, v58, v17 offset:4
    ds_bpermute_b32 v250, v58, v17 offset:8
    ds_bpermute_b32 v251, v58, v17 offset:12
    s_waitcnt lgkmcnt(0)
    v_accvgpr_read_b32 v18, a144
    v_mul_f32 v18, v18, v248
    v_accvgpr_write_b32 a144, v18
    v_accvgpr_read_b32 v19, a145
    v_mul_f32 v19, v19, v249
    v_accvgpr_write_b32 a145, v19
    v_accvgpr_read_b32 v18, a146
    v_mul_f32 v18, v18, v250
    v_accvgpr_write_b32 a146, v18
    v_accvgpr_read_b32 v19, a147
    v_mul_f32 v19, v19, v251
    v_accvgpr_write_b32 a147, v19
    v_accvgpr_read_b32 v18, a148
    v_mul_f32 v18, v18, v248
    v_accvgpr_write_b32 a148, v18
    v_accvgpr_read_b32 v19, a149
    v_mul_f32 v19, v19, v249
    v_accvgpr_write_b32 a149, v19
    v_accvgpr_read_b32 v18, a150
    v_mul_f32 v18, v18, v250
    v_accvgpr_write_b32 a150, v18
    v_accvgpr_read_b32 v19, a151
    v_mul_f32 v19, v19, v251
    v_accvgpr_write_b32 a151, v19
    v_accvgpr_read_b32 v18, a152
    v_mul_f32 v18, v18, v248
    v_accvgpr_write_b32 a152, v18
    v_accvgpr_read_b32 v19, a153
    v_mul_f32 v19, v19, v249
    v_accvgpr_write_b32 a153, v19
    v_accvgpr_read_b32 v18, a154
    v_mul_f32 v18, v18, v250
    v_accvgpr_write_b32 a154, v18
    v_accvgpr_read_b32 v19, a155
    v_mul_f32 v19, v19, v251
    v_accvgpr_write_b32 a155, v19
    v_accvgpr_read_b32 v18, a156
    v_mul_f32 v18, v18, v248
    v_accvgpr_write_b32 a156, v18
    v_accvgpr_read_b32 v19, a157
    v_mul_f32 v19, v19, v249
    v_accvgpr_write_b32 a157, v19
    v_accvgpr_read_b32 v18, a158
    v_mul_f32 v18, v18, v250
    v_accvgpr_write_b32 a158, v18
    v_accvgpr_read_b32 v19, a159
    v_mul_f32 v19, v19, v251
    v_accvgpr_write_b32 a159, v19
    v_accvgpr_read_b32 v18, a160
    v_mul_f32 v18, v18, v248
    v_accvgpr_write_b32 a160, v18
    v_accvgpr_read_b32 v19, a161
    v_mul_f32 v19, v19, v249
    v_accvgpr_write_b32 a161, v19
    v_accvgpr_read_b32 v18, a162
    v_mul_f32 v18, v18, v250
    v_accvgpr_write_b32 a162, v18
    v_accvgpr_read_b32 v19, a163
    v_mul_f32 v19, v19, v251
    v_accvgpr_write_b32 a163, v19
    v_accvgpr_read_b32 v18, a164
    v_mul_f32 v18, v18, v248
    v_accvgpr_write_b32 a164, v18
    v_accvgpr_read_b32 v19, a165
    v_mul_f32 v19, v19, v249
    v_accvgpr_write_b32 a165, v19
    v_accvgpr_read_b32 v18, a166
    v_mul_f32 v18, v18, v250
    v_accvgpr_write_b32 a166, v18
    v_accvgpr_read_b32 v19, a167
    v_mul_f32 v19, v19, v251
    v_accvgpr_write_b32 a167, v19
    v_accvgpr_read_b32 v18, a168
    v_mul_f32 v18, v18, v248
    v_accvgpr_write_b32 a168, v18
    v_accvgpr_read_b32 v19, a169
    v_mul_f32 v19, v19, v249
    v_accvgpr_write_b32 a169, v19
    v_accvgpr_read_b32 v18, a170
    v_mul_f32 v18, v18, v250
    v_accvgpr_write_b32 a170, v18
    v_accvgpr_read_b32 v19, a171
    v_mul_f32 v19, v19, v251
    v_accvgpr_write_b32 a171, v19
    v_accvgpr_read_b32 v18, a172
    v_mul_f32 v18, v18, v248
    v_accvgpr_write_b32 a172, v18
    v_accvgpr_read_b32 v19, a173
    v_mul_f32 v19, v19, v249
    v_accvgpr_write_b32 a173, v19
    v_accvgpr_read_b32 v18, a174
    v_mul_f32 v18, v18, v250
    v_accvgpr_write_b32 a174, v18
    v_accvgpr_read_b32 v19, a175
    v_mul_f32 v19, v19, v251
    v_accvgpr_write_b32 a175, v19
    v_accvgpr_read_b32 v18, a176
    v_mul_f32 v18, v18, v248
    v_accvgpr_write_b32 a176, v18
    v_accvgpr_read_b32 v19, a177
    v_mul_f32 v19, v19, v249
    v_accvgpr_write_b32 a177, v19
    v_accvgpr_read_b32 v18, a178
    v_mul_f32 v18, v18, v250
    v_accvgpr_write_b32 a178, v18
    v_accvgpr_read_b32 v19, a179
    v_mul_f32 v19, v19, v251
    v_accvgpr_write_b32 a179, v19
    v_accvgpr_read_b32 v18, a180
    v_mul_f32 v18, v18, v248
    v_accvgpr_write_b32 a180, v18
    v_accvgpr_read_b32 v19, a181
    v_mul_f32 v19, v19, v249
    v_accvgpr_write_b32 a181, v19
    v_accvgpr_read_b32 v18, a182
    v_mul_f32 v18, v18, v250
    v_accvgpr_write_b32 a182, v18
    v_accvgpr_read_b32 v19, a183
    v_mul_f32 v19, v19, v251
    v_accvgpr_write_b32 a183, v19
    v_accvgpr_read_b32 v18, a184
    v_mul_f32 v18, v18, v248
    v_accvgpr_write_b32 a184, v18
    v_accvgpr_read_b32 v19, a185
    v_mul_f32 v19, v19, v249
    v_accvgpr_write_b32 a185, v19
    v_accvgpr_read_b32 v18, a186
    v_mul_f32 v18, v18, v250
    v_accvgpr_write_b32 a186, v18
    v_accvgpr_read_b32 v19, a187
    v_mul_f32 v19, v19, v251
    v_accvgpr_write_b32 a187, v19
    v_accvgpr_read_b32 v18, a188
    v_mul_f32 v18, v18, v248
    v_accvgpr_write_b32 a188, v18
    v_accvgpr_read_b32 v19, a189
    v_mul_f32 v19, v19, v249
    v_accvgpr_write_b32 a189, v19
    v_accvgpr_read_b32 v18, a190
    v_mul_f32 v18, v18, v250
    v_accvgpr_write_b32 a190, v18
    v_accvgpr_read_b32 v19, a191
    v_mul_f32 v19, v19, v251
    v_accvgpr_write_b32 a191, v19
    s_waitcnt vmcnt(0)
    s_nop 1
    v_mfma_f32_16x16x32_bf16 a[0:3], v[224:227], v[112:115], a[0:3]
    v_mfma_f32_16x16x32_bf16 a[48:51], v[228:231], v[112:115], a[48:51]
    v_mfma_f32_16x16x32_bf16 a[96:99], v[232:235], v[112:115], a[96:99]
    v_mfma_f32_16x16x32_bf16 a[144:147], v[236:239], v[112:115], a[144:147]
    v_mfma_f32_16x16x32_bf16 a[4:7], v[224:227], v[116:119], a[4:7]
    v_mfma_f32_16x16x32_bf16 a[52:55], v[228:231], v[116:119], a[52:55]
    v_mfma_f32_16x16x32_bf16 a[100:103], v[232:235], v[116:119], a[100:103]
    v_mfma_f32_16x16x32_bf16 a[148:151], v[236:239], v[116:119], a[148:151]
    v_mfma_f32_16x16x32_bf16 a[8:11], v[224:227], v[120:123], a[8:11]
    v_mfma_f32_16x16x32_bf16 a[56:59], v[228:231], v[120:123], a[56:59]
    v_mfma_f32_16x16x32_bf16 a[104:107], v[232:235], v[120:123], a[104:107]
    v_mfma_f32_16x16x32_bf16 a[152:155], v[236:239], v[120:123], a[152:155]
    v_mfma_f32_16x16x32_bf16 a[12:15], v[224:227], v[124:127], a[12:15]
    v_mfma_f32_16x16x32_bf16 a[60:63], v[228:231], v[124:127], a[60:63]
    v_mfma_f32_16x16x32_bf16 a[108:111], v[232:235], v[124:127], a[108:111]
    v_mfma_f32_16x16x32_bf16 a[156:159], v[236:239], v[124:127], a[156:159]
    v_mfma_f32_16x16x32_bf16 a[16:19], v[224:227], v[128:131], a[16:19]
    v_mfma_f32_16x16x32_bf16 a[64:67], v[228:231], v[128:131], a[64:67]
    v_mfma_f32_16x16x32_bf16 a[112:115], v[232:235], v[128:131], a[112:115]
    v_mfma_f32_16x16x32_bf16 a[160:163], v[236:239], v[128:131], a[160:163]
    v_mfma_f32_16x16x32_bf16 a[20:23], v[224:227], v[132:135], a[20:23]
    v_mfma_f32_16x16x32_bf16 a[68:71], v[228:231], v[132:135], a[68:71]
    v_mfma_f32_16x16x32_bf16 a[116:119], v[232:235], v[132:135], a[116:119]
    v_mfma_f32_16x16x32_bf16 a[164:167], v[236:239], v[132:135], a[164:167]
    v_mfma_f32_16x16x32_bf16 a[24:27], v[224:227], v[136:139], a[24:27]
    v_mfma_f32_16x16x32_bf16 a[72:75], v[228:231], v[136:139], a[72:75]
    v_mfma_f32_16x16x32_bf16 a[120:123], v[232:235], v[136:139], a[120:123]
    v_mfma_f32_16x16x32_bf16 a[168:171], v[236:239], v[136:139], a[168:171]
    v_mfma_f32_16x16x32_bf16 a[28:31], v[224:227], v[140:143], a[28:31]
    v_mfma_f32_16x16x32_bf16 a[76:79], v[228:231], v[140:143], a[76:79]
    v_mfma_f32_16x16x32_bf16 a[124:127], v[232:235], v[140:143], a[124:127]
    v_mfma_f32_16x16x32_bf16 a[172:175], v[236:239], v[140:143], a[172:175]
    v_mfma_f32_16x16x32_bf16 a[32:35], v[224:227], v[144:147], a[32:35]
    v_mfma_f32_16x16x32_bf16 a[80:83], v[228:231], v[144:147], a[80:83]
    v_mfma_f32_16x16x32_bf16 a[128:131], v[232:235], v[144:147], a[128:131]
    v_mfma_f32_16x16x32_bf16 a[176:179], v[236:239], v[144:147], a[176:179]
    v_mfma_f32_16x16x32_bf16 a[36:39], v[224:227], v[148:151], a[36:39]
    v_mfma_f32_16x16x32_bf16 a[84:87], v[228:231], v[148:151], a[84:87]
    v_mfma_f32_16x16x32_bf16 a[132:135], v[232:235], v[148:151], a[132:135]
    v_mfma_f32_16x16x32_bf16 a[180:183], v[236:239], v[148:151], a[180:183]
    v_mfma_f32_16x16x32_bf16 a[40:43], v[224:227], v[152:155], a[40:43]
    v_mfma_f32_16x16x32_bf16 a[88:91], v[228:231], v[152:155], a[88:91]
    v_mfma_f32_16x16x32_bf16 a[136:139], v[232:235], v[152:155], a[136:139]
    v_mfma_f32_16x16x32_bf16 a[184:187], v[236:239], v[152:155], a[184:187]
    v_mfma_f32_16x16x32_bf16 a[44:47], v[224:227], v[156:159], a[44:47]
    v_mfma_f32_16x16x32_bf16 a[92:95], v[228:231], v[156:159], a[92:95]
    v_mfma_f32_16x16x32_bf16 a[140:143], v[232:235], v[156:159], a[140:143]
    v_mfma_f32_16x16x32_bf16 a[188:191], v[236:239], v[156:159], a[188:191]
    s_add_u32 s48, s48, 24576
    s_cmp_lt_u32 s48, 1572864
    s_nop 7
    s_cbranch_scc1 L_slowloop
    s_nop 1
    v_mfma_f32_16x16x4_f32 v[48:51], v5, v57, 0
    v_mfma_f32_16x16x4_f32 v[52:55], v6, v57, 0
    s_nop 7
    s_nop 1
    v_rcp_f32 v48, v48
    v_rcp_f32 v49, v49
    v_rcp_f32 v50, v50
    v_rcp_f32 v51, v51
    v_rcp_f32 v52, v52
    v_rcp_f32 v53, v53
    v_rcp_f32 v54, v54
    v_rcp_f32 v55, v55
    v_mfma_f32_16x16x4_f32 v[128:131], v7, v57, 0
    v_mfma_f32_16x16x4_f32 v[132:135], v8, v57, 0
    s_nop 7
    s_nop 1
    v_rcp_f32 v128, v128
    v_rcp_f32 v129, v129
    v_rcp_f32 v130, v130
    v_rcp_f32 v131, v131
    v_rcp_f32 v132, v132
    v_rcp_f32 v133, v133
    v_rcp_f32 v134, v134
    v_rcp_f32 v135, v135
    s_nop 0
    v_accvgpr_read_b32 v64, a0
    v_accvgpr_read_b32 v65, a4
    v_accvgpr_read_b32 v66, a8
    v_accvgpr_read_b32 v67, a12
    v_accvgpr_read_b32 v68, a16
    v_accvgpr_read_b32 v69, a20
    v_pk_mul_f32 v[64:65], v[64:65], v[48:49] op_sel_hi:[1,0]
    v_pk_mul_f32 v[66:67], v[66:67], v[48:49] op_sel_hi:[1,0]
    v_pk_mul_f32 v[68:69], v[68:69], v[48:49] op_sel_hi:[1,0]
    v_cvt_pk_bf16_f32 v64, v64, v65
    v_cvt_pk_bf16_f32 v65, v66, v67
    v_cvt_pk_bf16_f32 v66, v68, v69
    v_accvgpr_read_b32 v70, a1
    v_accvgpr_read_b32 v71, a5
    v_accvgpr_read_b32 v72, a9
    v_accvgpr_read_b32 v73, a13
    v_accvgpr_read_b32 v74, a17
    v_accvgpr_read_b32 v75, a21
    v_pk_mul_f32 v[70:71], v[70:71], v[48:49] op_sel:[0,1] op_sel_hi:[1,1]
    v_pk_mul_f32 v[72:73], v[72:73], v[48:49] op_sel:[0,1] op_sel_hi:[1,1]
    v_pk_mul_f32 v[74:75], v[74:75], v[48:49] op_sel:[0,1] op_sel_hi:[1,1]
    v_cvt_pk_bf16_f32 v70, v70, v71
    v_cvt_pk_bf16_f32 v71, v72, v73
    v_cvt_pk_bf16_f32 v72, v74, v75
    buffer_store_dwordx3 v[64:66], v56, s[12:15], s24 offen offset:0 sc0 sc1
    v_accvgpr_read_b32 v76, a2
    v_accvgpr_read_b32 v77, a6
    v_accvgpr_read_b32 v78, a10
    v_accvgpr_read_b32 v79, a14
    v_accvgpr_read_b32 v80, a18
    v_accvgpr_read_b32 v81, a22
    v_pk_mul_f32 v[76:77], v[76:77], v[50:51] op_sel_hi:[1,0]
    v_pk_mul_f32 v[78:79], v[78:79], v[50:51] op_sel_hi:[1,0]
    v_pk_mul_f32 v[80:81], v[80:81], v[50:51] op_sel_hi:[1,0]
    v_cvt_pk_bf16_f32 v76, v76, v77
    v_cvt_pk_bf16_f32 v77, v78, v79
    v_cvt_pk_bf16_f32 v78, v80, v81
    buffer_store_dwordx3 v[70:72], v56, s[12:15], s24 offen offset:384 sc0 sc1
    v_accvgpr_read_b32 v82, a3
    v_accvgpr_read_b32 v83, a7
    v_accvgpr_read_b32 v84, a11
    v_accvgpr_read_b32 v85, a15
    v_accvgpr_read_b32 v86, a19
    v_accvgpr_read_b32 v87, a23
    v_pk_mul_f32 v[82:83], v[82:83], v[50:51] op_sel:[0,1] op_sel_hi:[1,1]
    v_pk_mul_f32 v[84:85], v[84:85], v[50:51] op_sel:[0,1] op_sel_hi:[1,1]
    v_pk_mul_f32 v[86:87], v[86:87], v[50:51] op_sel:[0,1] op_sel_hi:[1,1]
    v_cvt_pk_bf16_f32 v82, v82, v83
    v_cvt_pk_bf16_f32 v83, v84, v85
    v_cvt_pk_bf16_f32 v84, v86, v87
    buffer_store_dwordx3 v[76:78], v56, s[12:15], s24 offen offset:768 sc0 sc1
    v_accvgpr_read_b32 v88, a24
    v_accvgpr_read_b32 v89, a28
    v_accvgpr_read_b32 v90, a32
    v_accvgpr_read_b32 v91, a36
    v_accvgpr_read_b32 v92, a40
    v_accvgpr_read_b32 v93, a44
    v_pk_mul_f32 v[88:89], v[88:89], v[48:49] op_sel_hi:[1,0]
    v_pk_mul_f32 v[90:91], v[90:91], v[48:49] op_sel_hi:[1,0]
    v_pk_mul_f32 v[92:93], v[92:93], v[48:49] op_sel_hi:[1,0]
    v_cvt_pk_bf16_f32 v88, v88, v89
    v_cvt_pk_bf16_f32 v89, v90, v91
    v_cvt_pk_bf16_f32 v90, v92, v93
    buffer_store_dwordx3 v[82:84], v56, s[12:15], s24 offen offset:1152 sc0 sc1
    v_accvgpr_read_b32 v94, a25
    v_accvgpr_read_b32 v95, a29
    v_accvgpr_read_b32 v96, a33
    v_accvgpr_read_b32 v97, a37
    v_accvgpr_read_b32 v98, a41
    v_accvgpr_read_b32 v99, a45
    v_pk_mul_f32 v[94:95], v[94:95], v[48:49] op_sel:[0,1] op_sel_hi:[1,1]
    v_pk_mul_f32 v[96:97], v[96:97], v[48:49] op_sel:[0,1] op_sel_hi:[1,1]
    v_pk_mul_f32 v[98:99], v[98:99], v[48:49] op_sel:[0,1] op_sel_hi:[1,1]
    v_cvt_pk_bf16_f32 v94, v94, v95
    v_cvt_pk_bf16_f32 v95, v96, v97
    v_cvt_pk_bf16_f32 v96, v98, v99
    buffer_store_dwordx3 v[88:90], v56, s[12:15], s24 offen offset:192 sc0 sc1
    v_accvgpr_read_b32 v100, a26
    v_accvgpr_read_b32 v101, a30
    v_accvgpr_read_b32 v102, a34
    v_accvgpr_read_b32 v103, a38
    v_accvgpr_read_b32 v104, a42
    v_accvgpr_read_b32 v105, a46
    v_pk_mul_f32 v[100:101], v[100:101], v[50:51] op_sel_hi:[1,0]
    v_pk_mul_f32 v[102:103], v[102:103], v[50:51] op_sel_hi:[1,0]
    v_pk_mul_f32 v[104:105], v[104:105], v[50:51] op_sel_hi:[1,0]
    v_cvt_pk_bf16_f32 v100, v100, v101
    v_cvt_pk_bf16_f32 v101, v102, v103
    v_cvt_pk_bf16_f32 v102, v104, v105
    buffer_store_dwordx3 v[94:96], v56, s[12:15], s24 offen offset:576 sc0 sc1
    v_accvgpr_read_b32 v106, a27
    v_accvgpr_read_b32 v107, a31
    v_accvgpr_read_b32 v108, a35
    v_accvgpr_read_b32 v109, a39
    v_accvgpr_read_b32 v110, a43
    v_accvgpr_read_b32 v111, a47
    v_pk_mul_f32 v[106:107], v[106:107], v[50:51] op_sel:[0,1] op_sel_hi:[1,1]
    v_pk_mul_f32 v[108:109], v[108:109], v[50:51] op_sel:[0,1] op_sel_hi:[1,1]
    v_pk_mul_f32 v[110:111], v[110:111], v[50:51] op_sel:[0,1] op_sel_hi:[1,1]
    v_cvt_pk_bf16_f32 v106, v106, v107
    v_cvt_pk_bf16_f32 v107, v108, v109
    v_cvt_pk_bf16_f32 v108, v110, v111
    buffer_store_dwordx3 v[100:102], v56, s[12:15], s24 offen offset:960 sc0 sc1
    v_accvgpr_read_b32 v64, a48
    v_accvgpr_read_b32 v65, a52
    v_accvgpr_read_b32 v66, a56
    v_accvgpr_read_b32 v67, a60
    v_accvgpr_read_b32 v68, a64
    v_accvgpr_read_b32 v69, a68
    v_pk_mul_f32 v[64:65], v[64:65], v[52:53] op_sel_hi:[1,0]
    v_pk_mul_f32 v[66:67], v[66:67], v[52:53] op_sel_hi:[1,0]
    v_pk_mul_f32 v[68:69], v[68:69], v[52:53] op_sel_hi:[1,0]
    v_cvt_pk_bf16_f32 v64, v64, v65
    v_cvt_pk_bf16_f32 v65, v66, v67
    v_cvt_pk_bf16_f32 v66, v68, v69
    buffer_store_dwordx3 v[106:108], v56, s[12:15], s24 offen offset:1344 sc0 sc1
    v_accvgpr_read_b32 v70, a49
    v_accvgpr_read_b32 v71, a53
    v_accvgpr_read_b32 v72, a57
    v_accvgpr_read_b32 v73, a61
    v_accvgpr_read_b32 v74, a65
    v_accvgpr_read_b32 v75, a69
    v_pk_mul_f32 v[70:71], v[70:71], v[52:53] op_sel:[0,1] op_sel_hi:[1,1]
    v_pk_mul_f32 v[72:73], v[72:73], v[52:53] op_sel:[0,1] op_sel_hi:[1,1]
    v_pk_mul_f32 v[74:75], v[74:75], v[52:53] op_sel:[0,1] op_sel_hi:[1,1]
    v_cvt_pk_bf16_f32 v70, v70, v71
    v_cvt_pk_bf16_f32 v71, v72, v73
    v_cvt_pk_bf16_f32 v72, v74, v75
    buffer_store_dwordx3 v[64:66], v56, s[12:15], s40 offen offset:0 sc0 sc1
    v_accvgpr_read_b32 v76, a50
    v_accvgpr_read_b32 v77, a54
    v_accvgpr_read_b32 v78, a58
    v_accvgpr_read_b32 v79, a62
    v_accvgpr_read_b32 v80, a66
    v_accvgpr_read_b32 v81, a70
    v_pk_mul_f32 v[76:77], v[76:77], v[54:55] op_sel_hi:[1,0]
    v_pk_mul_f32 v[78:79], v[78:79], v[54:55] op_sel_hi:[1,0]
    v_pk_mul_f32 v[80:81], v[80:81], v[54:55] op_sel_hi:[1,0]
    v_cvt_pk_bf16_f32 v76, v76, v77
    v_cvt_pk_bf16_f32 v77, v78, v79
    v_cvt_pk_bf16_f32 v78, v80, v81
    buffer_store_dwordx3 v[70:72], v56, s[12:15], s40 offen offset:384 sc0 sc1
    v_accvgpr_read_b32 v82, a51
    v_accvgpr_read_b32 v83, a55
    v_accvgpr_read_b32 v84, a59
    v_accvgpr_read_b32 v85, a63
    v_accvgpr_read_b32 v86, a67
    v_accvgpr_read_b32 v87, a71
    v_pk_mul_f32 v[82:83], v[82:83], v[54:55] op_sel:[0,1] op_sel_hi:[1,1]
    v_pk_mul_f32 v[84:85], v[84:85], v[54:55] op_sel:[0,1] op_sel_hi:[1,1]
    v_pk_mul_f32 v[86:87], v[86:87], v[54:55] op_sel:[0,1] op_sel_hi:[1,1]
    v_cvt_pk_bf16_f32 v82, v82, v83
    v_cvt_pk_bf16_f32 v83, v84, v85
    v_cvt_pk_bf16_f32 v84, v86, v87
    buffer_store_dwordx3 v[76:78], v56, s[12:15], s40 offen offset:768 sc0 sc1
    v_accvgpr_read_b32 v88, a72
    v_accvgpr_read_b32 v89, a76
    v_accvgpr_read_b32 v90, a80
    v_accvgpr_read_b32 v91, a84
    v_accvgpr_read_b32 v92, a88
    v_accvgpr_read_b32 v93, a92
    v_pk_mul_f32 v[88:89], v[88:89], v[52:53] op_sel_hi:[1,0]
    v_pk_mul_f32 v[90:91], v[90:91], v[52:53] op_sel_hi:[1,0]
    v_pk_mul_f32 v[92:93], v[92:93], v[52:53] op_sel_hi:[1,0]
    v_cvt_pk_bf16_f32 v88, v88, v89
    v_cvt_pk_bf16_f32 v89, v90, v91
    v_cvt_pk_bf16_f32 v90, v92, v93
    buffer_store_dwordx3 v[82:84], v56, s[12:15], s40 offen offset:1152 sc0 sc1
    v_accvgpr_read_b32 v94, a73
    v_accvgpr_read_b32 v95, a77
    v_accvgpr_read_b32 v96, a81
    v_accvgpr_read_b32 v97, a85
    v_accvgpr_read_b32 v98, a89
    v_accvgpr_read_b32 v99, a93
    v_pk_mul_f32 v[94:95], v[94:95], v[52:53] op_sel:[0,1] op_sel_hi:[1,1]
    v_pk_mul_f32 v[96:97], v[96:97], v[52:53] op_sel:[0,1] op_sel_hi:[1,1]
    v_pk_mul_f32 v[98:99], v[98:99], v[52:53] op_sel:[0,1] op_sel_hi:[1,1]
    v_cvt_pk_bf16_f32 v94, v94, v95
    v_cvt_pk_bf16_f32 v95, v96, v97
    v_cvt_pk_bf16_f32 v96, v98, v99
    buffer_store_dwordx3 v[88:90], v56, s[12:15], s40 offen offset:192 sc0 sc1
    v_accvgpr_read_b32 v100, a74
    v_accvgpr_read_b32 v101, a78
    v_accvgpr_read_b32 v102, a82
    v_accvgpr_read_b32 v103, a86
    v_accvgpr_read_b32 v104, a90
    v_accvgpr_read_b32 v105, a94
    v_pk_mul_f32 v[100:101], v[100:101], v[54:55] op_sel_hi:[1,0]
    v_pk_mul_f32 v[102:103], v[102:103], v[54:55] op_sel_hi:[1,0]
    v_pk_mul_f32 v[104:105], v[104:105], v[54:55] op_sel_hi:[1,0]
    v_cvt_pk_bf16_f32 v100, v100, v101
    v_cvt_pk_bf16_f32 v101, v102, v103
    v_cvt_pk_bf16_f32 v102, v104, v105
    buffer_store_dwordx3 v[94:96], v56, s[12:15], s40 offen offset:576 sc0 sc1
    v_accvgpr_read_b32 v106, a75
    v_accvgpr_read_b32 v107, a79
    v_accvgpr_read_b32 v108, a83
    v_accvgpr_read_b32 v109, a87
    v_accvgpr_read_b32 v110, a91
    v_accvgpr_read_b32 v111, a95
    v_pk_mul_f32 v[106:107], v[106:107], v[54:55] op_sel:[0,1] op_sel_hi:[1,1]
    v_pk_mul_f32 v[108:109], v[108:109], v[54:55] op_sel:[0,1] op_sel_hi:[1,1]
    v_pk_mul_f32 v[110:111], v[110:111], v[54:55] op_sel:[0,1] op_sel_hi:[1,1]
    v_cvt_pk_bf16_f32 v106, v106, v107
    v_cvt_pk_bf16_f32 v107, v108, v109
    v_cvt_pk_bf16_f32 v108, v110, v111
    buffer_store_dwordx3 v[100:102], v56, s[12:15], s40 offen offset:960 sc0 sc1
    v_accvgpr_read_b32 v64, a96
    v_accvgpr_read_b32 v65, a100
    v_accvgpr_read_b32 v66, a104
    v_accvgpr_read_b32 v67, a108
    v_accvgpr_read_b32 v68, a112
    v_accvgpr_read_b32 v69, a116
    v_pk_mul_f32 v[64:65], v[64:65], v[128:129] op_sel_hi:[1,0]
    v_pk_mul_f32 v[66:67], v[66:67], v[128:129] op_sel_hi:[1,0]
    v_pk_mul_f32 v[68:69], v[68:69], v[128:129] op_sel_hi:[1,0]
    v_cvt_pk_bf16_f32 v64, v64, v65
    v_cvt_pk_bf16_f32 v65, v66, v67
    v_cvt_pk_bf16_f32 v66, v68, v69
    buffer_store_dwordx3 v[106:108], v56, s[12:15], s40 offen offset:1344 sc0 sc1
    v_accvgpr_read_b32 v70, a97
    v_accvgpr_read_b32 v71, a101
    v_accvgpr_read_b32 v72, a105
    v_accvgpr_read_b32 v73, a109
    v_accvgpr_read_b32 v74, a113
    v_accvgpr_read_b32 v75, a117
    v_pk_mul_f32 v[70:71], v[70:71], v[128:129] op_sel:[0,1] op_sel_hi:[1,1]
    v_pk_mul_f32 v[72:73], v[72:73], v[128:129] op_sel:[0,1] op_sel_hi:[1,1]
    v_pk_mul_f32 v[74:75], v[74:75], v[128:129] op_sel:[0,1] op_sel_hi:[1,1]
    v_cvt_pk_bf16_f32 v70, v70, v71
    v_cvt_pk_bf16_f32 v71, v72, v73
    v_cvt_pk_bf16_f32 v72, v74, v75
    buffer_store_dwordx3 v[64:66], v56, s[12:15], s41 offen offset:0 sc0 sc1
    v_accvgpr_read_b32 v76, a98
    v_accvgpr_read_b32 v77, a102
    v_accvgpr_read_b32 v78, a106
    v_accvgpr_read_b32 v79, a110
    v_accvgpr_read_b32 v80, a114
    v_accvgpr_read_b32 v81, a118
    v_pk_mul_f32 v[76:77], v[76:77], v[130:131] op_sel_hi:[1,0]
    v_pk_mul_f32 v[78:79], v[78:79], v[130:131] op_sel_hi:[1,0]
    v_pk_mul_f32 v[80:81], v[80:81], v[130:131] op_sel_hi:[1,0]
    v_cvt_pk_bf16_f32 v76, v76, v77
    v_cvt_pk_bf16_f32 v77, v78, v79
    v_cvt_pk_bf16_f32 v78, v80, v81
    buffer_store_dwordx3 v[70:72], v56, s[12:15], s41 offen offset:384 sc0 sc1
    v_accvgpr_read_b32 v82, a99
    v_accvgpr_read_b32 v83, a103
    v_accvgpr_read_b32 v84, a107
    v_accvgpr_read_b32 v85, a111
    v_accvgpr_read_b32 v86, a115
    v_accvgpr_read_b32 v87, a119
    v_pk_mul_f32 v[82:83], v[82:83], v[130:131] op_sel:[0,1] op_sel_hi:[1,1]
    v_pk_mul_f32 v[84:85], v[84:85], v[130:131] op_sel:[0,1] op_sel_hi:[1,1]
    v_pk_mul_f32 v[86:87], v[86:87], v[130:131] op_sel:[0,1] op_sel_hi:[1,1]
    v_cvt_pk_bf16_f32 v82, v82, v83
    v_cvt_pk_bf16_f32 v83, v84, v85
    v_cvt_pk_bf16_f32 v84, v86, v87
    buffer_store_dwordx3 v[76:78], v56, s[12:15], s41 offen offset:768 sc0 sc1
    v_accvgpr_read_b32 v88, a120
    v_accvgpr_read_b32 v89, a124
    v_accvgpr_read_b32 v90, a128
    v_accvgpr_read_b32 v91, a132
    v_accvgpr_read_b32 v92, a136
    v_accvgpr_read_b32 v93, a140
    v_pk_mul_f32 v[88:89], v[88:89], v[128:129] op_sel_hi:[1,0]
    v_pk_mul_f32 v[90:91], v[90:91], v[128:129] op_sel_hi:[1,0]
    v_pk_mul_f32 v[92:93], v[92:93], v[128:129] op_sel_hi:[1,0]
    v_cvt_pk_bf16_f32 v88, v88, v89
    v_cvt_pk_bf16_f32 v89, v90, v91
    v_cvt_pk_bf16_f32 v90, v92, v93
    buffer_store_dwordx3 v[82:84], v56, s[12:15], s41 offen offset:1152 sc0 sc1
    v_accvgpr_read_b32 v94, a121
    v_accvgpr_read_b32 v95, a125
    v_accvgpr_read_b32 v96, a129
    v_accvgpr_read_b32 v97, a133
    v_accvgpr_read_b32 v98, a137
    v_accvgpr_read_b32 v99, a141
    v_pk_mul_f32 v[94:95], v[94:95], v[128:129] op_sel:[0,1] op_sel_hi:[1,1]
    v_pk_mul_f32 v[96:97], v[96:97], v[128:129] op_sel:[0,1] op_sel_hi:[1,1]
    v_pk_mul_f32 v[98:99], v[98:99], v[128:129] op_sel:[0,1] op_sel_hi:[1,1]
    v_cvt_pk_bf16_f32 v94, v94, v95
    v_cvt_pk_bf16_f32 v95, v96, v97
    v_cvt_pk_bf16_f32 v96, v98, v99
    buffer_store_dwordx3 v[88:90], v56, s[12:15], s41 offen offset:192 sc0 sc1
    v_accvgpr_read_b32 v100, a122
    v_accvgpr_read_b32 v101, a126
    v_accvgpr_read_b32 v102, a130
    v_accvgpr_read_b32 v103, a134
    v_accvgpr_read_b32 v104, a138
    v_accvgpr_read_b32 v105, a142
    v_pk_mul_f32 v[100:101], v[100:101], v[130:131] op_sel_hi:[1,0]
    v_pk_mul_f32 v[102:103], v[102:103], v[130:131] op_sel_hi:[1,0]
    v_pk_mul_f32 v[104:105], v[104:105], v[130:131] op_sel_hi:[1,0]
    v_cvt_pk_bf16_f32 v100, v100, v101
    v_cvt_pk_bf16_f32 v101, v102, v103
    v_cvt_pk_bf16_f32 v102, v104, v105
    buffer_store_dwordx3 v[94:96], v56, s[12:15], s41 offen offset:576 sc0 sc1
    v_accvgpr_read_b32 v106, a123
    v_accvgpr_read_b32 v107, a127
    v_accvgpr_read_b32 v108, a131
    v_accvgpr_read_b32 v109, a135
    v_accvgpr_read_b32 v110, a139
    v_accvgpr_read_b32 v111, a143
    v_pk_mul_f32 v[106:107], v[106:107], v[130:131] op_sel:[0,1] op_sel_hi:[1,1]
    v_pk_mul_f32 v[108:109], v[108:109], v[130:131] op_sel:[0,1] op_sel_hi:[1,1]
    v_pk_mul_f32 v[110:111], v[110:111], v[130:131] op_sel:[0,1] op_sel_hi:[1,1]
    v_cvt_pk_bf16_f32 v106, v106, v107
    v_cvt_pk_bf16_f32 v107, v108, v109
    v_cvt_pk_bf16_f32 v108, v110, v111
    buffer_store_dwordx3 v[100:102], v56, s[12:15], s41 offen offset:960 sc0 sc1
    v_accvgpr_read_b32 v64, a144
    v_accvgpr_read_b32 v65, a148
    v_accvgpr_read_b32 v66, a152
    v_accvgpr_read_b32 v67, a156
    v_accvgpr_read_b32 v68, a160
    v_accvgpr_read_b32 v69, a164
    v_pk_mul_f32 v[64:65], v[64:65], v[132:133] op_sel_hi:[1,0]
    v_pk_mul_f32 v[66:67], v[66:67], v[132:133] op_sel_hi:[1,0]
    v_pk_mul_f32 v[68:69], v[68:69], v[132:133] op_sel_hi:[1,0]
    v_cvt_pk_bf16_f32 v64, v64, v65
    v_cvt_pk_bf16_f32 v65, v66, v67
    v_cvt_pk_bf16_f32 v66, v68, v69
    buffer_store_dwordx3 v[106:108], v56, s[12:15], s41 offen offset:1344 sc0 sc1
    v_accvgpr_read_b32 v70, a145
    v_accvgpr_read_b32 v71, a149
    v_accvgpr_read_b32 v72, a153
    v_accvgpr_read_b32 v73, a157
    v_accvgpr_read_b32 v74, a161
    v_accvgpr_read_b32 v75, a165
    v_pk_mul_f32 v[70:71], v[70:71], v[132:133] op_sel:[0,1] op_sel_hi:[1,1]
    v_pk_mul_f32 v[72:73], v[72:73], v[132:133] op_sel:[0,1] op_sel_hi:[1,1]
    v_pk_mul_f32 v[74:75], v[74:75], v[132:133] op_sel:[0,1] op_sel_hi:[1,1]
    v_cvt_pk_bf16_f32 v70, v70, v71
    v_cvt_pk_bf16_f32 v71, v72, v73
    v_cvt_pk_bf16_f32 v72, v74, v75
    buffer_store_dwordx3 v[64:66], v56, s[12:15], s42 offen offset:0 sc0 sc1
    v_accvgpr_read_b32 v76, a146
    v_accvgpr_read_b32 v77, a150
    v_accvgpr_read_b32 v78, a154
    v_accvgpr_read_b32 v79, a158
    v_accvgpr_read_b32 v80, a162
    v_accvgpr_read_b32 v81, a166
    v_pk_mul_f32 v[76:77], v[76:77], v[134:135] op_sel_hi:[1,0]
    v_pk_mul_f32 v[78:79], v[78:79], v[134:135] op_sel_hi:[1,0]
    v_pk_mul_f32 v[80:81], v[80:81], v[134:135] op_sel_hi:[1,0]
    v_cvt_pk_bf16_f32 v76, v76, v77
    v_cvt_pk_bf16_f32 v77, v78, v79
    v_cvt_pk_bf16_f32 v78, v80, v81
    buffer_store_dwordx3 v[70:72], v56, s[12:15], s42 offen offset:384 sc0 sc1
    v_accvgpr_read_b32 v82, a147
    v_accvgpr_read_b32 v83, a151
    v_accvgpr_read_b32 v84, a155
    v_accvgpr_read_b32 v85, a159
    v_accvgpr_read_b32 v86, a163
    v_accvgpr_read_b32 v87, a167
    v_pk_mul_f32 v[82:83], v[82:83], v[134:135] op_sel:[0,1] op_sel_hi:[1,1]
    v_pk_mul_f32 v[84:85], v[84:85], v[134:135] op_sel:[0,1] op_sel_hi:[1,1]
    v_pk_mul_f32 v[86:87], v[86:87], v[134:135] op_sel:[0,1] op_sel_hi:[1,1]
    v_cvt_pk_bf16_f32 v82, v82, v83
    v_cvt_pk_bf16_f32 v83, v84, v85
    v_cvt_pk_bf16_f32 v84, v86, v87
    buffer_store_dwordx3 v[76:78], v56, s[12:15], s42 offen offset:768 sc0 sc1
    v_accvgpr_read_b32 v88, a168
    v_accvgpr_read_b32 v89, a172
    v_accvgpr_read_b32 v90, a176
    v_accvgpr_read_b32 v91, a180
    v_accvgpr_read_b32 v92, a184
    v_accvgpr_read_b32 v93, a188
    v_pk_mul_f32 v[88:89], v[88:89], v[132:133] op_sel_hi:[1,0]
    v_pk_mul_f32 v[90:91], v[90:91], v[132:133] op_sel_hi:[1,0]
    v_pk_mul_f32 v[92:93], v[92:93], v[132:133] op_sel_hi:[1,0]
    v_cvt_pk_bf16_f32 v88, v88, v89
    v_cvt_pk_bf16_f32 v89, v90, v91
    v_cvt_pk_bf16_f32 v90, v92, v93
    buffer_store_dwordx3 v[82:84], v56, s[12:15], s42 offen offset:1152 sc0 sc1
    v_accvgpr_read_b32 v94, a169
    v_accvgpr_read_b32 v95, a173
    v_accvgpr_read_b32 v96, a177
    v_accvgpr_read_b32 v97, a181
    v_accvgpr_read_b32 v98, a185
    v_accvgpr_read_b32 v99, a189
    v_pk_mul_f32 v[94:95], v[94:95], v[132:133] op_sel:[0,1] op_sel_hi:[1,1]
    v_pk_mul_f32 v[96:97], v[96:97], v[132:133] op_sel:[0,1] op_sel_hi:[1,1]
    v_pk_mul_f32 v[98:99], v[98:99], v[132:133] op_sel:[0,1] op_sel_hi:[1,1]
    v_cvt_pk_bf16_f32 v94, v94, v95
    v_cvt_pk_bf16_f32 v95, v96, v97
    v_cvt_pk_bf16_f32 v96, v98, v99
    buffer_store_dwordx3 v[88:90], v56, s[12:15], s42 offen offset:192 sc0 sc1
    v_accvgpr_read_b32 v100, a170
    v_accvgpr_read_b32 v101, a174
    v_accvgpr_read_b32 v102, a178
    v_accvgpr_read_b32 v103, a182
    v_accvgpr_read_b32 v104, a186
    v_accvgpr_read_b32 v105, a190
    v_pk_mul_f32 v[100:101], v[100:101], v[134:135] op_sel_hi:[1,0]
    v_pk_mul_f32 v[102:103], v[102:103], v[134:135] op_sel_hi:[1,0]
    v_pk_mul_f32 v[104:105], v[104:105], v[134:135] op_sel_hi:[1,0]
    v_cvt_pk_bf16_f32 v100, v100, v101
    v_cvt_pk_bf16_f32 v101, v102, v103
    v_cvt_pk_bf16_f32 v102, v104, v105
    buffer_store_dwordx3 v[94:96], v56, s[12:15], s42 offen offset:576 sc0 sc1
    v_accvgpr_read_b32 v106, a171
    v_accvgpr_read_b32 v107, a175
    v_accvgpr_read_b32 v108, a179
    v_accvgpr_read_b32 v109, a183
    v_accvgpr_read_b32 v110, a187
    v_accvgpr_read_b32 v111, a191
    v_pk_mul_f32 v[106:107], v[106:107], v[134:135] op_sel:[0,1] op_sel_hi:[1,1]
    v_pk_mul_f32 v[108:109], v[108:109], v[134:135] op_sel:[0,1] op_sel_hi:[1,1]
    v_pk_mul_f32 v[110:111], v[110:111], v[134:135] op_sel:[0,1] op_sel_hi:[1,1]
    v_cvt_pk_bf16_f32 v106, v106, v107
    v_cvt_pk_bf16_f32 v107, v108, v109
    v_cvt_pk_bf16_f32 v108, v110, v111
    buffer_store_dwordx3 v[100:102], v56, s[12:15], s42 offen offset:960 sc0 sc1
    buffer_store_dwordx3 v[106:108], v56, s[12:15], s42 offen offset:1344 sc0 sc1
    s_branch L_fin
.section .rodata,"a"
.p2align 6
.amdhsa_kernel standalone__kv_cache_quant_int4_int2_kv_with_per_channel_or_per_token_scales__prompt_kernel
  .amdhsa_next_free_vgpr 512
  .amdhsa_next_free_sgpr 102
  .amdhsa_accum_offset 256
  .amdhsa_group_segment_fixed_size 0
  .amdhsa_kernarg_size 80
  .amdhsa_user_sgpr_count 2
  .amdhsa_user_sgpr_kernarg_segment_ptr 1
  .amdhsa_system_sgpr_workgroup_id_x 1
.end_amdhsa_kernel
```

```asm
; @launch grid=(256,1,1) block=(256,1,1) lds=147584
.amdgcn_target "amdgcn-amd-amdhsa--gfx950"
.text
.globl standalone__kv_cache_quant_int4_int2_kv_with_per_channel_or_per_token_scales__prompt_kernel
.p2align 8
.type standalone__kv_cache_quant_int4_int2_kv_with_per_channel_or_per_token_scales__prompt_kernel,@function
standalone__kv_cache_quant_int4_int2_kv_with_per_channel_or_per_token_scales__prompt_kernel:
    s_cmp_ge_u32 s2, 256
    s_cbranch_scc1 L_done
    s_load_dwordx16 s[40:55], s[0:1], 0
    s_load_dwordx4 s[16:19], s[0:1], 64
    s_and_b32 s94, s2, 7
    s_lshr_b32 s95, s2, 3
    s_lshr_b32 s24, s95, 3
    s_lshl_b32 s94, s94, 2
    s_add_u32 s94, s94, s24
    s_and_b32 s95, s95, 7
    s_getpc_b64 s[60:61]
L_pc:
    s_sub_u32 s60, s60, L_pc-standalone__kv_cache_quant_int4_int2_kv_with_per_channel_or_per_token_scales__prompt_kernel
    s_subb_u32 s61, s61, 0
    s_mov_b32 s62, L_slow-standalone__kv_cache_quant_int4_int2_kv_with_per_channel_or_per_token_scales__prompt_kernel
    s_mov_b32 s63, 0x20000
    s_lshr_b32 s22, s2, 3
    s_lshl_b32 s22, s22, 12
    v_lshlrev_b32 v30, 4, v0
    buffer_load_dwordx4 v[128:131], v30, s[60:63], s22 offen
    v_lshrrev_b32 v24, 6, v0
    v_and_b32 v25, 63, v0
    v_readfirstlane_b32 s25, v24
    v_lshlrev_b32 v1, 4, v25
    v_mul_u32_u24 v26, 43, v25
    v_lshrrev_b32 v26, 10, v26
    v_mul_u32_u24 v27, 24, v26
    v_sub_u32 v27, v25, v27
    v_lshrrev_b32 v28, 1, v24
    v_and_b32 v29, 1, v24
    v_lshlrev_b32 v30, 4, v29
    v_lshl_add_u32 v30, v28, 2, v30
    v_add_u32 v30, v30, v26
    v_mul_u32_u24 v30, 768, v30
    v_lshrrev_b32 v48, 1, v26
    v_lshlrev_b32 v48, 30, v48
    v_lshl_add_u32 v30, v27, 4, v30
    v_or_b32 v9, v30, v48
    v_lshl_or_b32 v10, v27, 3, v48
    v_mul_u32_u24 v30, 6144, v24
    v_mul_u32_u24 v31, 12, v25
    v_add_u32 v12, v30, v31
    s_mov_b32 s66, 1572864
    s_mov_b32 s67, 0x20000
    s_mov_b32 s70, 1572864
    s_mov_b32 s71, 0x20000
    s_mov_b32 s74, 12288
    s_mov_b32 s75, 0x20000
    s_mov_b32 s78, 12288
    s_mov_b32 s79, 0x20000
    s_mov_b32 s82, 4096
    s_mov_b32 s83, 0x20000
    s_mov_b32 s86, 4096
    s_mov_b32 s87, 0x20000
    s_mov_b32 s22, 64
    s_mov_b32 s23, 0x20000
    s_mul_i32 s33, s95, 24576
    s_add_u32 s34, s33, 6144
    s_mov_b32 s35, s33
    s_lshr_b32 s36, s95, 1
    s_mul_i32 s36, s36, 384
    s_lshl_b32 s37, s95, 6
    s_lshl_b32 s24, s25, 4
    s_add_u32 s37, s37, s24
    s_mul_i32 s24, s94, 1572864
    s_mul_i32 s56, s94, 12288
    s_lshl_b32 s57, s94, 12
    s_lshl_b32 s58, s94, 10
    s_add_u32 s58, s58, 51380320
    s_or_b32 s39, s95, s25
    s_waitcnt lgkmcnt(0)
    s_add_u32 s64, s42, s24
    s_addc_u32 s65, s43, 0
    s_add_u32 s72, s46, s56
    s_addc_u32 s73, s47, 0
    s_add_u32 s76, s48, s56
    s_addc_u32 s77, s49, 0
    buffer_load_dwordx4 v[224:227], v9, s[64:67], s33 offen offset:0 nt
    buffer_load_dwordx4 v[228:231], v9, s[64:67], s33 offen offset:1536 nt
    buffer_load_dwordx4 v[232:235], v9, s[64:67], s34 offen offset:0 nt
    buffer_load_dwordx4 v[236:239], v9, s[64:67], s34 offen offset:1536 nt
    buffer_load_dwordx2 v[32:33], v10, s[72:75], s36 offen offset:0
    buffer_load_dwordx2 v[34:35], v10, s[76:79], s36 offen offset:0
    buffer_load_dwordx2 v[36:37], v10, s[72:75], s36 offen offset:192
    buffer_load_dwordx2 v[38:39], v10, s[76:79], s36 offen offset:192
    s_add_u32 s20, s18, s58
    s_addc_u32 s21, s19, 0
    s_add_u32 s80, s50, s57
    s_addc_u32 s81, s51, 0
    s_add_u32 s84, s52, s57
    s_addc_u32 s85, s53, 0
    s_add_u32 s68, s44, s24
    s_addc_u32 s69, s45, 0
    s_mul_i32 s59, s94, 786432
    s_add_u32 s12, s54, s59
    s_addc_u32 s13, s55, 0
    s_add_u32 s8, s40, s59
    s_addc_u32 s9, s41, 0
    s_cmp_lg_u32 s39, 0
    s_cbranch_scc1 L_notleader0
    s_buffer_load_dwordx16 s[40:55], s[20:23], 0 glc
L_notleader0:
    buffer_load_dwordx4 v[240:243], v9, s[64:67], s33 offen offset:384 nt
    buffer_load_dwordx4 v[244:247], v9, s[64:67], s33 offen offset:1920 nt
    buffer_load_dwordx4 v[248:251], v9, s[64:67], s34 offen offset:384 nt
    buffer_load_dwordx4 v[252:255], v9, s[64:67], s34 offen offset:1920 nt
    s_add_u32 s4, s18, s24
    s_addc_u32 s5, s19, 0
    s_mov_b32 s6, 1572864
    s_mov_b32 s7, 0x20000
    s_mov_b32 s10, 786432
    s_mov_b32 s11, 0x20000
    s_mov_b32 s88, s16
    s_mov_b32 s89, s17
    s_add_u32 s16, s33, 3072
    s_add_u32 s17, s33, 6144
    s_mov_b32 s90, 256
    s_mov_b32 s91, 0x20000
    s_lshl_b32 s93, s94, 3
    s_cmp_lg_u32 s39, 0
    s_cbranch_scc1 L_notleader
    s_waitcnt lgkmcnt(0)
    s_mov_b32 s59, 1
    s_lshr_b32 s40, s40, 10
    s_min_u32 s40, s40, 31
    s_bitset1_b32 s59, s40
    s_lshr_b32 s41, s41, 10
    s_min_u32 s41, s41, 31
    s_bitset1_b32 s59, s41
    s_lshr_b32 s42, s42, 10
    s_min_u32 s42, s42, 31
    s_bitset1_b32 s59, s42
    s_lshr_b32 s43, s43, 10
    s_min_u32 s43, s43, 31
    s_bitset1_b32 s59, s43
    s_lshr_b32 s44, s44, 10
    s_min_u32 s44, s44, 31
    s_bitset1_b32 s59, s44
    s_lshr_b32 s45, s45, 10
    s_min_u32 s45, s45, 31
    s_bitset1_b32 s59, s45
    s_lshr_b32 s46, s46, 10
    s_min_u32 s46, s46, 31
    s_bitset1_b32 s59, s46
    s_lshr_b32 s47, s47, 10
    s_min_u32 s47, s47, 31
    s_bitset1_b32 s59, s47
    s_lshr_b32 s48, s48, 10
    s_min_u32 s48, s48, 31
    s_bitset1_b32 s59, s48
    s_lshr_b32 s49, s49, 10
    s_min_u32 s49, s49, 31
    s_bitset1_b32 s59, s49
    s_lshr_b32 s50, s50, 10
    s_min_u32 s50, s50, 31
    s_bitset1_b32 s59, s50
    s_lshr_b32 s51, s51, 10
    s_min_u32 s51, s51, 31
    s_bitset1_b32 s59, s51
    s_lshr_b32 s52, s52, 10
    s_min_u32 s52, s52, 31
    s_bitset1_b32 s59, s52
    s_lshr_b32 s53, s53, 10
    s_min_u32 s53, s53, 31
    s_bitset1_b32 s59, s53
    s_lshr_b32 s54, s54, 10
    s_min_u32 s54, s54, 31
    s_bitset1_b32 s59, s54
    s_lshr_b32 s55, s55, 10
    s_min_u32 s55, s55, 31
    s_bitset1_b32 s59, s55
    s_ff0_i32_b32 s59, s59
    s_lshl_b32 s59, s59, 10
    v_mov_b32 v52, s59
    s_mov_b64 exec, 1
    buffer_store_dword v52, off, s[88:91], s93 sc1
    s_mov_b64 exec, -1
L_notleader:
    s_lshl_b32 s24, s95, 2
    s_add_u32 s24, s24, 32
    s_buffer_load_dword s46, s[20:23], s24 glc
    s_getreg_b32 s45, hwreg(HW_REG_XCC_ID, 0, 4)
    s_lshl_b32 s45, s45, 5
    s_mov_b32 s44, 32
    buffer_load_dwordx3 v[112:114], v12, s[68:71], s35 offen offset:0 nt
    buffer_load_dwordx3 v[116:118], v12, s[68:71], s35 offen offset:768 nt
    buffer_load_dwordx3 v[120:122], v12, s[68:71], s35 offen offset:1536 nt
    buffer_load_dwordx3 v[124:126], v12, s[68:71], s35 offen offset:2304 nt
    buffer_load_dwordx2 v[40:41], off, s[80:83], s37 offset:0
    buffer_load_dwordx2 v[42:43], off, s[84:87], s37 offset:0
    buffer_load_dwordx2 v[44:45], off, s[80:83], s37 offset:8
    buffer_load_dwordx2 v[46:47], off, s[84:87], s37 offset:8
    s_mov_b32 s14, 786432
    s_mov_b32 s15, 0x20000
    s_lshl_b32 s24, s25, 8
    s_add_u32 s93, s93, s24
    v_mul_u32_u24 v30, 3072, v24
    v_add_u32 v4, v30, v1
    v_lshl_add_u32 v30, v24, 3, v26
    v_mul_u32_u24 v30, 384, v30
    v_lshlrev_b32 v31, 2, v29
    v_xor_b32 v31, v27, v31
    v_lshl_add_u32 v30, v31, 4, v30
    v_or_b32 v11, v30, v48
    v_lshlrev_b32 v30, 8, v24
    v_add_u32 v30, 12288, v30
    v_lshrrev_b32 v31, 5, v25
    v_mul_u32_u24 v31, 6144, v31
    v_add_u32 v30, v30, v31
    v_and_b32 v31, 1, v25
    v_mul_u32_u24 v31, 3072, v31
    v_add_u32 v30, v30, v31
    v_bfe_u32 v31, v25, 1, 4
    v_lshl_add_u32 v15, v31, 4, v30
    s_lshl_b32 s24, s95, 2
    v_lshl_add_u32 v13, v0, 2, s24
    v_cmp_lt_u32 vcc, 0, v0
    v_mov_b32 v30, 0x40000000
    s_nop 0
    v_cndmask_b32 v13, v13, v30, vcc
    s_mul_i32 s26, s25, 3072
    s_add_u32 s26, s26, 12288
    s_add_u32 s56, s26, 24576
    s_add_u32 s24, s95, 1
    s_and_b32 s24, s24, 7
    s_mul_i32 s32, s24, 24576
    s_add_u32 s27, s32, 12288
    s_mov_b32 s28, 98304
    s_mov_b32 s30, 73728
    v_add_u32 v1, 24576, v1
    s_mov_b32 s38, 0x3dd53b95
    s_mov_b32 s97, 0xffff0000
    s_mov_b32 s96, 100000
    v_and_b32 v26, 15, v25
    v_lshrrev_b32 v27, 4, v25
    v_bfe_u32 v28, v25, 1, 3
    v_xor_b32 v29, v27, v28
    v_mul_u32_u24 v30, 384, v26
    v_lshl_add_u32 v2, v29, 4, v30
    v_xor_b32 v3, 64, v2
    s_mul_i32 s40, s25, 6144
    s_add_u32 s40, s40, 73728
    v_lshrrev_b32 v29, 1, v27
    v_xor_b32 v29, v29, v28
    v_lshl_add_u32 v31, v29, 4, v30
    v_and_b32 v29, 1, v27
    v_lshl_add_u32 v31, v29, 3, v31
    v_xor_b32 v22, 0, v31
    v_add_u32 v22, s40, v22
    v_xor_b32 v23, 32, v31
    v_add_u32 v23, s40, v23
    v_xor_b32 v142, 64, v31
    v_add_u32 v142, s40, v142
    v_xor_b32 v143, 96, v31
    v_add_u32 v143, s40, v143
    s_lshl_b32 s24, s95, 2
    s_add_u32 s24, s24, s25
    s_mul_i32 s24, s24, 24576
    v_add_u32 v26, 0, v25
    v_mul_u32_u24 v27, 2731, v26
    v_lshrrev_b32 v27, 17, v27
    v_and_b32 v27, 7, v27
    v_xor_b32 v26, v26, v27
    v_lshlrev_b32 v136, 4, v26
    v_add_u32 v136, s24, v136
    v_add_u32 v26, 64, v25
    v_mul_u32_u24 v27, 2731, v26
    v_lshrrev_b32 v27, 17, v27
    v_and_b32 v27, 7, v27
    v_xor_b32 v26, v26, v27
    v_lshlrev_b32 v137, 4, v26
    v_add_u32 v137, s24, v137
    v_add_u32 v26, 128, v25
    v_mul_u32_u24 v27, 2731, v26
    v_lshrrev_b32 v27, 17, v27
    v_and_b32 v27, 7, v27
    v_xor_b32 v26, v26, v27
    v_lshlrev_b32 v138, 4, v26
    v_add_u32 v138, s24, v138
    v_add_u32 v26, 192, v25
    v_mul_u32_u24 v27, 2731, v26
    v_lshrrev_b32 v27, 17, v27
    v_and_b32 v27, 7, v27
    v_xor_b32 v26, v26, v27
    v_lshlrev_b32 v139, 4, v26
    v_add_u32 v139, s24, v139
    v_add_u32 v26, 256, v25
    v_mul_u32_u24 v27, 2731, v26
    v_lshrrev_b32 v27, 17, v27
    v_and_b32 v27, 7, v27
    v_xor_b32 v26, v26, v27
    v_lshlrev_b32 v140, 4, v26
    v_add_u32 v140, s24, v140
    v_add_u32 v26, 320, v25
    v_mul_u32_u24 v27, 2731, v26
    v_lshrrev_b32 v27, 17, v27
    v_and_b32 v27, 7, v27
    v_xor_b32 v26, v26, v27
    v_lshlrev_b32 v141, 4, v26
    v_add_u32 v141, s24, v141
    v_mov_b32 v5, 0
    v_mov_b32 v6, 0
    v_mov_b32 v7, 0
    v_mov_b32 v8, 0
    s_mov_b32 s62, -1
    s_mov_b32 s63, 0xffff
    s_waitcnt vmcnt(12)
    buffer_load_dwordx3 v[80:82], v12, s[68:71], s16 offen offset:0 nt
    buffer_load_dwordx3 v[84:86], v12, s[68:71], s16 offen offset:768 nt
    buffer_load_dwordx3 v[88:90], v12, s[68:71], s16 offen offset:1536 nt
    buffer_load_dwordx3 v[92:94], v12, s[68:71], s16 offen offset:2304 nt
    v_lshlrev_b32 v48, 16, v32
    v_and_b32 v49, s97, v32
    v_lshlrev_b32 v50, 16, v34
    v_and_b32 v51, s97, v34
    v_mul_f32 v48, s38, v48
    v_mul_f32 v49, s38, v49
    v_mul_f32_e64 v50, -v50, v48
    v_mul_f32_e64 v51, -v51, v49
    v_cvt_f32_i32 v224, v224
    v_cvt_f32_i32 v225, v225
    v_fma_f32 v224, v224, v48, v50
    v_fma_f32 v225, v225, v49, v51
    v_cvt_pk_bf16_f32 v224, v224, v225
    v_cvt_f32_i32 v228, v228
    v_cvt_f32_i32 v229, v229
    v_fma_f32 v228, v228, v48, v50
    v_fma_f32 v229, v229, v49, v51
    v_cvt_pk_bf16_f32 v228, v228, v229
    v_cvt_f32_i32 v232, v232
    v_cvt_f32_i32 v233, v233
    v_fma_f32 v232, v232, v48, v50
    v_fma_f32 v233, v233, v49, v51
    v_cvt_pk_bf16_f32 v232, v232, v233
    v_cvt_f32_i32 v236, v236
    v_cvt_f32_i32 v237, v237
    v_fma_f32 v236, v236, v48, v50
    v_fma_f32 v237, v237, v49, v51
    v_cvt_pk_bf16_f32 v236, v236, v237
    v_lshlrev_b32 v48, 16, v33
    v_and_b32 v49, s97, v33
    v_lshlrev_b32 v50, 16, v35
    v_and_b32 v51, s97, v35
    v_mul_f32 v48, s38, v48
    v_mul_f32 v49, s38, v49
    v_mul_f32_e64 v50, -v50, v48
    v_mul_f32_e64 v51, -v51, v49
    v_cvt_f32_i32 v226, v226
    v_cvt_f32_i32 v227, v227
    v_fma_f32 v226, v226, v48, v50
    v_fma_f32 v227, v227, v49, v51
    v_cvt_pk_bf16_f32 v225, v226, v227
    v_cvt_f32_i32 v230, v230
    v_cvt_f32_i32 v231, v231
    v_fma_f32 v230, v230, v48, v50
    v_fma_f32 v231, v231, v49, v51
    v_cvt_pk_bf16_f32 v229, v230, v231
    v_cvt_f32_i32 v234, v234
    v_cvt_f32_i32 v235, v235
    v_fma_f32 v234, v234, v48, v50
    v_fma_f32 v235, v235, v49, v51
    v_cvt_pk_bf16_f32 v233, v234, v235
    v_cvt_f32_i32 v238, v238
    v_cvt_f32_i32 v239, v239
    v_fma_f32 v238, v238, v48, v50
    v_fma_f32 v239, v239, v49, v51
    v_cvt_pk_bf16_f32 v237, v238, v239
    s_waitcnt vmcnt(12)
    v_lshlrev_b32 v48, 16, v36
    v_and_b32 v49, s97, v36
    v_lshlrev_b32 v50, 16, v38
    v_and_b32 v51, s97, v38
    v_mul_f32 v48, s38, v48
    v_mul_f32 v49, s38, v49
    v_mul_f32_e64 v50, -v50, v48
    v_mul_f32_e64 v51, -v51, v49
    v_cvt_f32_i32 v240, v240
    v_cvt_f32_i32 v241, v241
    v_fma_f32 v240, v240, v48, v50
    v_fma_f32 v241, v241, v49, v51
    v_cvt_pk_bf16_f32 v226, v240, v241
    v_cvt_f32_i32 v244, v244
    v_cvt_f32_i32 v245, v245
    v_fma_f32 v244, v244, v48, v50
    v_fma_f32 v245, v245, v49, v51
    v_cvt_pk_bf16_f32 v230, v244, v245
    v_cvt_f32_i32 v248, v248
    v_cvt_f32_i32 v249, v249
    v_fma_f32 v248, v248, v48, v50
    v_fma_f32 v249, v249, v49, v51
    v_cvt_pk_bf16_f32 v234, v248, v249
    v_cvt_f32_i32 v252, v252
    v_cvt_f32_i32 v253, v253
    v_fma_f32 v252, v252, v48, v50
    v_fma_f32 v253, v253, v49, v51
    v_cvt_pk_bf16_f32 v238, v252, v253
    v_lshlrev_b32 v48, 16, v37
    v_and_b32 v49, s97, v37
    v_lshlrev_b32 v50, 16, v39
    v_and_b32 v51, s97, v39
    v_mul_f32 v48, s38, v48
    v_mul_f32 v49, s38, v49
    v_mul_f32_e64 v50, -v50, v48
    v_mul_f32_e64 v51, -v51, v49
    v_cvt_f32_i32 v242, v242
    v_cvt_f32_i32 v243, v243
    v_fma_f32 v242, v242, v48, v50
    v_fma_f32 v243, v243, v49, v51
    v_cvt_pk_bf16_f32 v227, v242, v243
    v_cvt_f32_i32 v246, v246
    v_cvt_f32_i32 v247, v247
    v_fma_f32 v246, v246, v48, v50
    v_fma_f32 v247, v247, v49, v51
    v_cvt_pk_bf16_f32 v231, v246, v247
    v_cvt_f32_i32 v250, v250
    v_cvt_f32_i32 v251, v251
    v_fma_f32 v250, v250, v48, v50
    v_fma_f32 v251, v251, v49, v51
    v_cvt_pk_bf16_f32 v235, v250, v251
    v_cvt_f32_i32 v254, v254
    v_cvt_f32_i32 v255, v255
    v_fma_f32 v254, v254, v48, v50
    v_fma_f32 v255, v255, v49, v51
    v_cvt_pk_bf16_f32 v239, v254, v255
    buffer_store_dwordx4 v[224:227], v11, s[4:7], s33 offen offset:0
    s_mov_b64 exec, s[62:63]
    ds_write_b128 v11, v[224:227] offset:0
    s_mov_b64 exec, -1
    v_xor_b32 v55, 16, v11
    buffer_store_dwordx4 v[228:231], v55, s[4:7], s33 offen offset:768
    s_mov_b64 exec, s[62:63]
    ds_write_b128 v55, v[228:231] offset:768
    s_mov_b64 exec, -1
    v_xor_b32 v54, 32, v11
    buffer_store_dwordx4 v[232:235], v54, s[4:7], s33 offen offset:1536
    s_mov_b64 exec, s[62:63]
    ds_write_b128 v54, v[232:235] offset:1536
    s_mov_b64 exec, -1
    v_xor_b32 v55, 48, v11
    buffer_store_dwordx4 v[236:239], v55, s[4:7], s33 offen offset:2304
    s_mov_b64 exec, s[62:63]
    ds_write_b128 v55, v[236:239] offset:2304
    s_mov_b64 exec, -1
    s_mov_b32 s41, 0
    s_add_u32 m0, s40, 24576
    s_nop 0
    buffer_load_dwordx4 v136, s[8:11], s41 offen nt lds
    s_add_u32 m0, s40, 25600
    s_nop 0
    buffer_load_dwordx4 v137, s[8:11], s41 offen nt lds
    s_add_u32 m0, s40, 26624
    s_nop 0
    buffer_load_dwordx4 v138, s[8:11], s41 offen nt lds
    s_add_u32 m0, s40, 27648
    s_nop 0
    buffer_load_dwordx4 v139, s[8:11], s41 offen nt lds
    s_add_u32 m0, s40, 28672
    s_nop 0
    buffer_load_dwordx4 v140, s[8:11], s41 offen nt lds
    s_add_u32 m0, s40, 29696
    s_waitcnt vmcnt(20)
    buffer_load_dwordx4 v141, s[8:11], s41 offen nt lds
    s_waitcnt vmcnt(14)
    v_lshlrev_b32 v48, 16, v40
    v_and_b32 v49, s97, v40
    v_lshlrev_b32 v50, 16, v42
    v_and_b32 v51, s97, v42
    v_mul_f32_e64 v50, -v50, v48
    v_mul_f32_e64 v51, -v51, v49
    v_cvt_f32_i32 v112, v112
    v_cvt_f32_i32 v116, v116
    v_fma_f32 v112, v112, v48, v50
    v_fma_f32 v116, v116, v49, v51
    v_cvt_f32_i32 v113, v113
    v_cvt_f32_i32 v117, v117
    v_fma_f32 v113, v113, v48, v50
    v_fma_f32 v117, v117, v49, v51
    v_cvt_f32_i32 v114, v114
    v_cvt_f32_i32 v118, v118
    v_fma_f32 v114, v114, v48, v50
    v_fma_f32 v118, v118, v49, v51
    v_lshlrev_b32 v48, 16, v41
    v_and_b32 v49, s97, v41
    v_lshlrev_b32 v50, 16, v43
    v_and_b32 v51, s97, v43
    v_mul_f32_e64 v50, -v50, v48
    v_mul_f32_e64 v51, -v51, v49
    v_cvt_f32_i32 v120, v120
    v_cvt_f32_i32 v124, v124
    v_fma_f32 v120, v120, v48, v50
    v_fma_f32 v124, v124, v49, v51
    v_cvt_f32_i32 v121, v121
    v_cvt_f32_i32 v125, v125
    v_fma_f32 v121, v121, v48, v50
    v_fma_f32 v125, v125, v49, v51
    v_cvt_f32_i32 v122, v122
    v_cvt_f32_i32 v126, v126
    v_fma_f32 v122, v122, v48, v50
    v_fma_f32 v126, v126, v49, v51
    v_cvt_pk_bf16_f32 v112, v112, v116
    v_cvt_pk_bf16_f32 v116, v113, v117
    v_cvt_pk_bf16_f32 v113, v120, v124
    v_cvt_pk_bf16_f32 v117, v121, v125
    v_cvt_pk_bf16_f32 v120, v114, v118
    v_cvt_pk_bf16_f32 v121, v122, v126
    s_waitcnt vmcnt(10)
    v_lshlrev_b32 v48, 16, v44
    v_and_b32 v49, s97, v44
    v_lshlrev_b32 v50, 16, v46
    v_and_b32 v51, s97, v46
    v_mul_f32_e64 v50, -v50, v48
    v_mul_f32_e64 v51, -v51, v49
    v_cvt_f32_i32 v80, v80
    v_cvt_f32_i32 v84, v84
    v_fma_f32 v80, v80, v48, v50
    v_fma_f32 v84, v84, v49, v51
    v_cvt_f32_i32 v81, v81
    v_cvt_f32_i32 v85, v85
    v_fma_f32 v81, v81, v48, v50
    v_fma_f32 v85, v85, v49, v51
    v_cvt_f32_i32 v82, v82
    v_cvt_f32_i32 v86, v86
    v_fma_f32 v82, v82, v48, v50
    v_fma_f32 v86, v86, v49, v51
    v_lshlrev_b32 v48, 16, v45
    v_and_b32 v49, s97, v45
    v_lshlrev_b32 v50, 16, v47
    v_and_b32 v51, s97, v47
    v_mul_f32_e64 v50, -v50, v48
    v_mul_f32_e64 v51, -v51, v49
    v_cvt_f32_i32 v88, v88
    v_cvt_f32_i32 v92, v92
    v_fma_f32 v88, v88, v48, v50
    v_fma_f32 v92, v92, v49, v51
    v_cvt_f32_i32 v89, v89
    v_cvt_f32_i32 v93, v93
    v_fma_f32 v89, v89, v48, v50
    v_fma_f32 v93, v93, v49, v51
    v_cvt_f32_i32 v90, v90
    v_cvt_f32_i32 v94, v94
    v_fma_f32 v90, v90, v48, v50
    v_fma_f32 v94, v94, v49, v51
    v_cvt_pk_bf16_f32 v114, v80, v84
    v_cvt_pk_bf16_f32 v118, v81, v85
    v_cvt_pk_bf16_f32 v115, v88, v92
    v_cvt_pk_bf16_f32 v119, v89, v93
    v_cvt_pk_bf16_f32 v122, v82, v86
    v_cvt_pk_bf16_f32 v123, v90, v94
    buffer_store_dwordx4 v[112:115], v15, s[4:7], s35 offen offset:0
    buffer_store_dwordx4 v[116:119], v15, s[4:7], s35 offen offset:1024
    buffer_store_dwordx4 v[120:123], v15, s[4:7], s35 offen offset:2048
    ds_write_b128 v15, v[112:115] offset:12288
    ds_write_b128 v15, v[116:119] offset:13312
    ds_write_b128 v15, v[120:123] offset:14336
    buffer_load_dword v0, off, s[88:91], s93 sc1
    s_mov_b32 s41, 6144
    s_add_u32 m0, s40, 0
    s_nop 0
    buffer_load_dwordx4 v136, s[8:11], s41 offen nt lds
    s_add_u32 m0, s40, 1024
    s_nop 0
    buffer_load_dwordx4 v137, s[8:11], s41 offen nt lds
    s_add_u32 m0, s40, 2048
    s_nop 0
    buffer_load_dwordx4 v138, s[8:11], s41 offen nt lds
    s_add_u32 m0, s40, 3072
    s_nop 0
    buffer_load_dwordx4 v139, s[8:11], s41 offen nt lds
    s_add_u32 m0, s40, 4096
    s_nop 0
    buffer_load_dwordx4 v140, s[8:11], s41 offen nt lds
    s_add_u32 m0, s40, 5120
    s_waitcnt vmcnt(14)
    buffer_load_dwordx4 v141, s[8:11], s41 offen nt lds
    s_mov_b32 s41, 12288
    s_add_u32 m0, s40, 49152
    s_waitcnt vmcnt(14)
    buffer_load_dwordx4 v136, s[8:11], s41 offen nt lds
    s_add_u32 m0, s40, 50176
    s_waitcnt vmcnt(14)
    buffer_load_dwordx4 v137, s[8:11], s41 offen nt lds
    s_add_u32 m0, s40, 51200
    s_waitcnt vmcnt(14)
    buffer_load_dwordx4 v138, s[8:11], s41 offen nt lds
    s_add_u32 m0, s40, 52224
    s_waitcnt vmcnt(14)
    buffer_load_dwordx4 v139, s[8:11], s41 offen nt lds
    s_add_u32 m0, s40, 53248
    s_waitcnt vmcnt(14)
    buffer_load_dwordx4 v140, s[8:11], s41 offen nt lds
    s_add_u32 m0, s40, 54272
    s_waitcnt vmcnt(11)
    buffer_load_dwordx4 v141, s[8:11], s41 offen nt lds
    s_mov_b64 exec, 0
    s_cmp_eq_u32 s25, 0
    s_cbranch_scc1 L_iw0
    s_cmp_eq_u32 s25, 1
    s_cbranch_scc1 L_iw1
    s_cmp_eq_u32 s25, 2
    s_cbranch_scc1 L_iw2
    s_branch L_iw3
L_iwret:
    s_mov_b64 exec, -1
    s_waitcnt vmcnt(12)
    s_cmp_lg_u32 s25, 0
    s_cbranch_scc1 L_tagdone
    v_readfirstlane_b32 s42, v0
    s_mov_b32 s39, 100
    s_waitcnt lgkmcnt(0)
    s_and_b32 s46, s46, 0xfffffc00
L_tagretry:
    s_cmp_eq_u32 s42, s46
    s_cselect_b32 s42, 0, s42
    s_cmp_lg_u32 s42, 0
    s_cbranch_scc1 L_tagok
    s_sub_u32 s39, s39, 1
    s_cbranch_scc1 L_tagslow
    s_sleep 4
    s_buffer_load_dword s42, s[88:91], s93 glc
    s_waitcnt lgkmcnt(0)
    s_branch L_tagretry
L_tagok:
    s_add_u32 s42, s42, s45
    v_mov_b32 v0, s42
    v_mov_b32 v16, 147456
    ds_write_b32 v16, v0
L_tagdone:
    s_waitcnt lgkmcnt(0)
    s_barrier
    v_add_u32 v0, 1, v0
    buffer_store_dword v0, v13, s[20:23], 0 offen offset:32 sc1
    v_mov_b32 v16, 147456
    ds_read_b32 v17, v16
    s_mov_b32 s88, s60
    s_mov_b32 s89, s61
    s_mov_b32 s90, L_slow-standalone__kv_cache_quant_int4_int2_kv_with_per_channel_or_per_token_scales__prompt_kernel
    s_lshr_b32 s24, s2, 3
    s_mul_i32 s93, s24, 43
    s_lshr_b32 s93, s93, 7
    s_mul_i32 s39, s93, 3
    s_sub_u32 s24, s24, s39
    s_lshl_b32 s24, s24, 10
    s_mul_i32 s93, s93, 12288
    s_add_u32 s93, s93, s24
    ds_read_b128 v[144:147], v2 offset:0
    ds_read_b128 v[148:151], v3 offset:0
    ds_read_b128 v[152:155], v2 offset:6144
    ds_read_b128 v[156:159], v3 offset:6144
    ds_read_b128 v[160:163], v2 offset:128
    ds_read_b128 v[164:167], v3 offset:128
    ds_read_b128 v[168:171], v2 offset:6272
    ds_read_b128 v[172:175], v3 offset:6272
    ds_read_b128 v[176:179], v2 offset:256
    ds_read_b128 v[180:183], v3 offset:256
    ds_read_b128 v[184:187], v2 offset:6400
    ds_read_b128 v[188:191], v3 offset:6400
    s_waitcnt vmcnt(17)
    ds_read_b64 a[192:193], v22 offset:24576
    ds_read_b64 a[194:195], v142 offset:24704
    ds_read_b64 a[196:197], v23 offset:24576
    ds_read_b64 a[198:199], v143 offset:24704
    ds_read_b64 a[200:201], v142 offset:24576
    ds_read_b64 a[202:203], v22 offset:24832
    ds_read_b64 a[204:205], v143 offset:24576
    ds_read_b64 a[206:207], v23 offset:24832
    ds_read_b64 a[208:209], v22 offset:24704
    ds_read_b64 a[210:211], v142 offset:24832
    ds_read_b64 a[212:213], v23 offset:24704
    ds_read_b64 a[214:215], v143 offset:24832
    s_waitcnt lgkmcnt(15)
    v_readfirstlane_b32 s92, v17
    s_add_u32 s92, s92, 1
    s_waitcnt lgkmcnt(0)
    s_mov_b32 s41, 18432
    s_add_u32 m0, s40, 24576
    s_waitcnt vmcnt(12)
    buffer_load_dwordx4 v136, s[8:11], s41 offen nt lds
    s_add_u32 m0, s40, 25600
    s_waitcnt vmcnt(12)
    buffer_load_dwordx4 v137, s[8:11], s41 offen nt lds
    s_add_u32 m0, s40, 26624
    s_waitcnt vmcnt(12)
    buffer_load_dwordx4 v138, s[8:11], s41 offen nt lds
    v_mfma_f32_16x16x32_bf16 v[64:67], v[144:147], a[192:195], 0
    v_mfma_f32_16x16x32_bf16 v[64:67], v[148:151], a[196:199], v[64:67]
    v_mfma_f32_16x16x32_bf16 v[64:67], v[160:163], a[200:203], v[64:67]
    v_mfma_f32_16x16x32_bf16 v[64:67], v[164:167], a[204:207], v[64:67]
    v_mfma_f32_16x16x32_bf16 v[64:67], v[176:179], a[208:211], v[64:67]
    v_mfma_f32_16x16x32_bf16 v[64:67], v[180:183], a[212:215], v[64:67]
    v_mfma_f32_16x16x32_bf16 v[96:99], v[152:155], a[192:195], 0
    v_mfma_f32_16x16x32_bf16 v[96:99], v[156:159], a[196:199], v[96:99]
    v_mfma_f32_16x16x32_bf16 v[96:99], v[168:171], a[200:203], v[96:99]
    v_mfma_f32_16x16x32_bf16 v[96:99], v[172:175], a[204:207], v[96:99]
    v_mfma_f32_16x16x32_bf16 v[96:99], v[184:187], a[208:211], v[96:99]
    v_mfma_f32_16x16x32_bf16 v[96:99], v[188:191], a[212:215], v[96:99]
    s_nop 7
    v_max3_f32 v48, v64, v65, v66
    v_max3_f32 v50, v67, v96, v97
    v_max3_f32 v48, v48, v98, v99
    v_max_f32 v48, v48, v50
    v_mov_b32 v49, v48
    s_nop 1
    v_permlane16_swap_b32 v48, v49
    s_nop 1
    v_max_f32 v48, v48, v49
    v_mov_b32 v49, v48
    s_nop 1
    v_permlane32_swap_b32 v48, v49
    s_nop 1
    v_max_f32 v48, v48, v49
    v_sub_f32 v64, v64, v48
    v_sub_f32 v65, v65, v48
L_iw0:
L_pg0:
    s_cbranch_execz L_pg4
    v_sub_f32 v66, v66, v48
    v_sub_f32 v67, v67, v48
    v_sub_f32 v96, v96, v48
    v_sub_f32 v97, v97, v48
    v_sub_f32 v98, v98, v48
    v_sub_f32 v99, v99, v48
    v_exp_f32 v64, v64
    v_exp_f32 v65, v65
    v_exp_f32 v66, v66
    v_exp_f32 v67, v67
    v_exp_f32 v96, v96
    v_exp_f32 v97, v97
    v_exp_f32 v98, v98
    v_exp_f32 v99, v99
    v_sub_f32 v128, 0, v48
    v_sub_f32 v129, 0, v48
    v_sub_f32 v130, 0, v48
    v_sub_f32 v131, 0, v48
    v_add_f32 v5, v5, v64
    v_add_f32 v5, v5, v65
    v_add_f32 v5, v5, v66
    v_add_f32 v5, v5, v67
    v_add_f32 v5, v5, v96
    v_add_f32 v5, v5, v97
    v_add_f32 v5, v5, v98
    v_add_f32 v5, v5, v99
    v_cvt_pk_bf16_f32 v64, v64, v65
    v_cvt_pk_bf16_f32 v65, v66, v67
    v_cvt_pk_bf16_f32 v66, v96, v97
    v_cvt_pk_bf16_f32 v67, v98, v99
    s_waitcnt vmcnt(10)
    ds_read_b64 a[216:217], v22 offset:0
    ds_read_b64 a[218:219], v142 offset:128
    ds_read_b64 a[220:221], v23 offset:0
    ds_read_b64 a[222:223], v143 offset:128
    ds_read_b64 a[224:225], v142 offset:0
    ds_read_b64 a[226:227], v22 offset:256
    ds_read_b64 a[228:229], v143 offset:0
    ds_read_b64 a[230:231], v23 offset:256
    ds_read_b64 a[232:233], v22 offset:128
    ds_read_b64 a[234:235], v142 offset:256
    ds_read_b64 a[236:237], v23 offset:128
    ds_read_b64 a[238:239], v143 offset:256
    s_waitcnt lgkmcnt(0)
    s_mov_b32 s41, 18432
    s_add_u32 m0, s40, 27648
    s_nop 0
    buffer_load_dwordx4 v139, s[8:11], s41 offen nt lds
    s_add_u32 m0, s40, 28672
    s_nop 0
    buffer_load_dwordx4 v140, s[8:11], s41 offen nt lds
    s_add_u32 m0, s40, 29696
    s_nop 0
    buffer_load_dwordx4 v141, s[8:11], s41 offen nt lds
    v_mfma_f32_16x16x32_bf16 v[68:71], v[144:147], a[216:219], 0
    v_mfma_f32_16x16x32_bf16 v[68:71], v[148:151], a[220:223], v[68:71]
    v_mfma_f32_16x16x32_bf16 v[68:71], v[160:163], a[224:227], v[68:71]
    v_mfma_f32_16x16x32_bf16 v[68:71], v[164:167], a[228:231], v[68:71]
    v_mfma_f32_16x16x32_bf16 v[68:71], v[176:179], a[232:235], v[68:71]
    v_mfma_f32_16x16x32_bf16 v[68:71], v[180:183], a[236:239], v[68:71]
    v_mfma_f32_16x16x32_bf16 v[100:103], v[152:155], a[216:219], 0
    v_mfma_f32_16x16x32_bf16 v[100:103], v[156:159], a[220:223], v[100:103]
    v_mfma_f32_16x16x32_bf16 v[100:103], v[168:171], a[224:227], v[100:103]
    v_mfma_f32_16x16x32_bf16 v[100:103], v[172:175], a[228:231], v[100:103]
    v_mfma_f32_16x16x32_bf16 v[100:103], v[184:187], a[232:235], v[100:103]
    v_mfma_f32_16x16x32_bf16 v[100:103], v[188:191], a[236:239], v[100:103]
    s_nop 7
    v_max3_f32 v48, v68, v69, v70
    v_max3_f32 v50, v71, v100, v101
    v_max3_f32 v48, v48, v102, v103
    v_max_f32 v48, v48, v50
    v_mov_b32 v49, v48
    s_nop 1
    v_permlane16_swap_b32 v48, v49
    s_nop 1
    v_max_f32 v48, v48, v49
    v_mov_b32 v49, v48
    s_nop 1
    v_permlane32_swap_b32 v48, v49
    s_nop 1
    v_max_f32 v48, v48, v49
    v_sub_f32 v68, v68, v48
    v_sub_f32 v69, v69, v48
    v_sub_f32 v70, v70, v48
    v_sub_f32 v71, v71, v48
    v_sub_f32 v100, v100, v48
    v_sub_f32 v101, v101, v48
    v_sub_f32 v102, v102, v48
    v_sub_f32 v103, v103, v48
    v_exp_f32 v68, v68
    v_exp_f32 v69, v69
    v_exp_f32 v70, v70
    v_exp_f32 v71, v71
    v_exp_f32 v100, v100
    v_exp_f32 v101, v101
    v_exp_f32 v102, v102
    v_exp_f32 v103, v103
    v_sub_f32 v132, 0, v48
    v_sub_f32 v133, 0, v48
    v_sub_f32 v134, 0, v48
    v_sub_f32 v135, 0, v48
    v_add_f32 v6, v6, v68
    v_add_f32 v6, v6, v69
    v_add_f32 v6, v6, v70
    v_add_f32 v6, v6, v71
    v_add_f32 v6, v6, v100
    v_add_f32 v6, v6, v101
    v_add_f32 v6, v6, v102
    v_add_f32 v6, v6, v103
    v_cvt_pk_bf16_f32 v68, v68, v69
    v_cvt_pk_bf16_f32 v69, v70, v71
    v_cvt_pk_bf16_f32 v70, v100, v101
    v_cvt_pk_bf16_f32 v71, v102, v103
    s_waitcnt vmcnt(7)
    ds_read_b64 a[240:241], v22 offset:49152
    ds_read_b64 a[242:243], v142 offset:49280
    ds_read_b64 a[244:245], v23 offset:49152
    ds_read_b64 a[246:247], v143 offset:49280
    ds_read_b64 a[248:249], v142 offset:49152
    ds_read_b64 a[250:251], v22 offset:49408
    ds_read_b64 a[252:253], v143 offset:49152
    ds_read_b64 a[254:255], v23 offset:49408
    ds_read_b64 v[192:193], v22 offset:49280
    ds_read_b64 v[194:195], v142 offset:49408
    ds_read_b64 v[196:197], v23 offset:49280
    ds_read_b64 v[198:199], v143 offset:49408
    s_buffer_load_dwordx8 s[48:55], s[20:23], s44 glc
    s_waitcnt lgkmcnt(0)
    v_mfma_f32_16x16x32_bf16 v[72:75], v[144:147], a[240:243], 0
    v_mfma_f32_16x16x32_bf16 v[72:75], v[148:151], a[244:247], v[72:75]
    v_mfma_f32_16x16x32_bf16 v[72:75], v[160:163], a[248:251], v[72:75]
    v_mfma_f32_16x16x32_bf16 v[72:75], v[164:167], a[252:255], v[72:75]
    v_mfma_f32_16x16x32_bf16 v[72:75], v[176:179], v[192:195], v[72:75]
    v_mfma_f32_16x16x32_bf16 v[72:75], v[180:183], v[196:199], v[72:75]
    v_mfma_f32_16x16x32_bf16 v[104:107], v[152:155], a[240:243], 0
    v_mfma_f32_16x16x32_bf16 v[104:107], v[156:159], a[244:247], v[104:107]
    v_mfma_f32_16x16x32_bf16 v[104:107], v[168:171], a[248:251], v[104:107]
    v_mfma_f32_16x16x32_bf16 v[104:107], v[172:175], a[252:255], v[104:107]
    v_mfma_f32_16x16x32_bf16 v[104:107], v[184:187], v[192:195], v[104:107]
    v_mfma_f32_16x16x32_bf16 v[104:107], v[188:191], v[196:199], v[104:107]
    s_waitcnt lgkmcnt(0)
    s_sub_u32 s48, s48, s92
    s_sub_u32 s49, s49, s92
    s_sub_u32 s50, s50, s92
    s_sub_u32 s51, s51, s92
    s_sub_u32 s52, s52, s92
    s_sub_u32 s53, s53, s92
    s_sub_u32 s54, s54, s92
    s_sub_u32 s55, s55, s92
    s_max_u32 s48, s48, s49
    s_max_u32 s48, s48, s50
    s_max_u32 s48, s48, s51
    s_max_u32 s48, s48, s52
    s_max_u32 s48, s48, s53
    s_max_u32 s48, s48, s54
    s_max_u32 s48, s48, s55
    s_cmp_ge_u32 s48, 16
    s_cbranch_scc1 L_pollslow0
L_pollok0:
    s_add_u32 s92, s92, 1
    s_mov_b32 m0, s26
    s_nop 0
    buffer_load_dwordx4 v4, s[4:7], s32 offen offset:0 sc1 lds
    buffer_load_dwordx4 v4, s[4:7], s32 offen offset:1024 sc1 lds
    buffer_load_dwordx4 v4, s[4:7], s32 offen offset:2048 sc1 lds
    s_add_u32 s32, s32, 24576
    s_sub_u32 s57, s32, 196608
    s_min_u32 s32, s32, s57
    s_add_u32 s26, s26, 36864
    s_sub_u32 s57, s26, 147456
    s_min_u32 s26, s26, s57
    s_mov_b32 m0, s26
    s_nop 0
    buffer_load_dwordx4 v4, s[4:7], s32 offen offset:0 sc1 lds
    buffer_load_dwordx4 v4, s[4:7], s32 offen offset:1024 sc1 lds
    buffer_load_dwordx4 v4, s[4:7], s32 offen offset:2048 sc1 lds
    s_add_u32 s32, s32, 24576
    s_sub_u32 s57, s32, 196608
    s_min_u32 s32, s32, s57
    s_add_u32 s26, s26, 12288
    s_mov_b32 m0, s26
    s_waitcnt vmcnt(11)
    buffer_load_dwordx4 v4, s[4:7], s32 offen offset:0 sc1 lds
    s_waitcnt vmcnt(11)
    buffer_load_dwordx4 v4, s[4:7], s32 offen offset:1024 sc1 lds
    s_waitcnt vmcnt(11)
    buffer_load_dwordx4 v4, s[4:7], s32 offen offset:2048 sc1 lds
    s_add_u32 s32, s32, 24576
    s_sub_u32 s57, s32, 196608
    s_min_u32 s32, s32, s57
    s_add_u32 s26, s26, 36864
    s_sub_u32 s57, s26, 147456
    s_min_u32 s26, s26, s57
    s_mov_b32 m0, s56
    s_waitcnt vmcnt(11)
    buffer_load_dwordx4 v4, s[4:7], s27 offen offset:0 sc1 lds
    s_waitcnt vmcnt(11)
    buffer_load_dwordx4 v4, s[4:7], s27 offen offset:1024 sc1 lds
    s_waitcnt vmcnt(11)
    buffer_load_dwordx4 v4, s[4:7], s27 offen offset:2048 sc1 lds
    s_add_u32 s27, s27, 24576
    s_sub_u32 s58, s27, 196608
    s_min_u32 s27, s27, s58
    s_add_u32 s56, s56, 36864
    s_sub_u32 s58, s56, 147456
    s_min_u32 s56, s56, s58
    s_add_u32 s33, s33, 196608
    s_add_u32 s34, s34, 196608
    s_add_u32 s36, s36, 1536
    s_add_u32 s35, s35, 196608
    s_add_u32 s16, s16, 196608
    s_add_u32 s17, s17, 196608
    s_add_u32 s37, s37, 512
    v_max3_f32 v48, v72, v73, v74
    v_max3_f32 v50, v75, v104, v105
    v_max3_f32 v48, v48, v106, v107
    v_max_f32 v48, v48, v50
    v_mov_b32 v49, v48
    s_nop 1
    v_permlane16_swap_b32 v48, v49
    s_nop 1
    v_max_f32 v48, v48, v49
    v_mov_b32 v49, v48
    s_nop 1
    v_permlane32_swap_b32 v48, v49
    s_nop 1
    v_max_f32 v48, v48, v49
    v_sub_f32 v72, v72, v48
    v_sub_f32 v73, v73, v48
    v_sub_f32 v74, v74, v48
    v_sub_f32 v75, v75, v48
    v_sub_f32 v104, v104, v48
    v_sub_f32 v105, v105, v48
    v_sub_f32 v106, v106, v48
    v_sub_f32 v107, v107, v48
    v_exp_f32 v72, v72
    v_exp_f32 v73, v73
    v_exp_f32 v74, v74
    v_exp_f32 v75, v75
    v_exp_f32 v104, v104
    v_exp_f32 v105, v105
    v_exp_f32 v106, v106
    v_exp_f32 v107, v107
    v_sub_f32 v136, 0, v48
    v_sub_f32 v137, 0, v48
    v_sub_f32 v138, 0, v48
    v_sub_f32 v139, 0, v48
    v_add_f32 v7, v7, v72
    v_add_f32 v7, v7, v73
    v_add_f32 v7, v7, v74
    v_add_f32 v7, v7, v75
    v_add_f32 v7, v7, v104
    v_add_f32 v7, v7, v105
    v_add_f32 v7, v7, v106
    v_add_f32 v7, v7, v107
    v_cvt_pk_bf16_f32 v72, v72, v73
    v_cvt_pk_bf16_f32 v73, v74, v75
    v_cvt_pk_bf16_f32 v74, v104, v105
    v_cvt_pk_bf16_f32 v75, v106, v107
    ds_read_b128 v[24:27], v1 offset:0
    ds_read_b128 v[28:31], v1 offset:1024
    ds_read_b128 v[32:35], v1 offset:2048
    ds_read_b128 v[36:39], v1 offset:3072
    s_waitcnt lgkmcnt(2)
    v_mfma_f32_16x16x32_bf16 a[0:3], v[64:67], v[24:27], 0
    ds_read_b128 v[40:43], v1 offset:4096
    v_mfma_f32_16x16x32_bf16 a[4:7], v[64:67], v[28:31], 0
    s_waitcnt vmcnt(11)
    buffer_load_dwordx2 v[56:57], v10, s[72:75], s36 offen offset:0
    v_mfma_f32_16x16x32_bf16 a[48:51], v[68:71], v[24:27], 0
    v_mfma_f32_16x16x32_bf16 a[52:55], v[68:71], v[28:31], 0
    ds_read_b128 v[44:47], v1 offset:5120
    v_mfma_f32_16x16x32_bf16 a[96:99], v[72:75], v[24:27], 0
    v_mfma_f32_16x16x32_bf16 a[100:103], v[72:75], v[28:31], 0
    s_waitcnt lgkmcnt(2)
    buffer_load_dwordx2 v[58:59], v10, s[76:79], s36 offen offset:0
    v_mfma_f32_16x16x32_bf16 a[8:11], v[64:67], v[32:35], 0
    ds_read_b128 v[24:27], v1 offset:6144
    v_mfma_f32_16x16x32_bf16 a[12:15], v[64:67], v[36:39], 0
    s_waitcnt vmcnt(12)
    buffer_load_dwordx4 v[224:227], v9, s[64:67], s33 offen offset:0 nt
    v_mfma_f32_16x16x32_bf16 a[56:59], v[68:71], v[32:35], 0
    v_mfma_f32_16x16x32_bf16 a[60:63], v[68:71], v[36:39], 0
    ds_read_b128 v[28:31], v1 offset:7168
    v_mfma_f32_16x16x32_bf16 a[104:107], v[72:75], v[32:35], 0
    v_mfma_f32_16x16x32_bf16 a[108:111], v[72:75], v[36:39], 0
    s_waitcnt lgkmcnt(2)
    s_waitcnt vmcnt(12)
    buffer_load_dwordx4 v[228:231], v9, s[64:67], s33 offen offset:1536 nt
    v_mfma_f32_16x16x32_bf16 a[16:19], v[64:67], v[40:43], 0
    ds_read_b128 v[32:35], v1 offset:8192
    v_mfma_f32_16x16x32_bf16 a[20:23], v[64:67], v[44:47], 0
    buffer_load_dwordx4 v[232:235], v9, s[64:67], s34 offen offset:0 nt
    v_mfma_f32_16x16x32_bf16 a[64:67], v[68:71], v[40:43], 0
    v_mfma_f32_16x16x32_bf16 a[68:71], v[68:71], v[44:47], 0
    ds_read_b128 v[36:39], v1 offset:9216
    v_mfma_f32_16x16x32_bf16 a[112:115], v[72:75], v[40:43], 0
    s_waitcnt vmcnt(13)
    buffer_load_dwordx4 v[236:239], v9, s[64:67], s34 offen offset:1536 nt
    v_mfma_f32_16x16x32_bf16 a[116:119], v[72:75], v[44:47], 0
    s_waitcnt lgkmcnt(2)
    v_mfma_f32_16x16x32_bf16 a[24:27], v[64:67], v[24:27], 0
    ds_read_b128 v[40:43], v1 offset:10240
    v_mfma_f32_16x16x32_bf16 a[28:31], v[64:67], v[28:31], 0
    s_waitcnt vmcnt(13)
    buffer_load_dwordx2 v[60:61], v10, s[72:75], s36 offen offset:192
    v_mfma_f32_16x16x32_bf16 a[72:75], v[68:71], v[24:27], 0
    v_mfma_f32_16x16x32_bf16 a[76:79], v[68:71], v[28:31], 0
    ds_read_b128 v[44:47], v1 offset:11264
    v_mfma_f32_16x16x32_bf16 a[120:123], v[72:75], v[24:27], 0
    v_mfma_f32_16x16x32_bf16 a[124:127], v[72:75], v[28:31], 0
    s_waitcnt lgkmcnt(2)
    buffer_load_dwordx2 v[62:63], v10, s[76:79], s36 offen offset:192
    v_mfma_f32_16x16x32_bf16 a[32:35], v[64:67], v[32:35], 0
    v_mfma_f32_16x16x32_bf16 a[36:39], v[64:67], v[36:39], 0
    s_waitcnt vmcnt(14)
    buffer_load_dwordx4 v[240:243], v9, s[64:67], s33 offen offset:384 nt
    v_mfma_f32_16x16x32_bf16 a[80:83], v[68:71], v[32:35], 0
    v_mfma_f32_16x16x32_bf16 a[84:87], v[68:71], v[36:39], 0
    buffer_load_dwordx4 v[244:247], v9, s[64:67], s33 offen offset:1920 nt
    v_mfma_f32_16x16x32_bf16 a[128:131], v[72:75], v[32:35], 0
    v_mfma_f32_16x16x32_bf16 a[132:135], v[72:75], v[36:39], 0
    s_waitcnt lgkmcnt(0)
    s_waitcnt vmcnt(15)
    buffer_load_dwordx4 v[248:251], v9, s[64:67], s34 offen offset:384 nt
    v_mfma_f32_16x16x32_bf16 a[40:43], v[64:67], v[40:43], 0
    v_mfma_f32_16x16x32_bf16 a[44:47], v[64:67], v[44:47], 0
    s_waitcnt vmcnt(15)
    buffer_load_dwordx4 v[252:255], v9, s[64:67], s34 offen offset:1920 nt
    v_mfma_f32_16x16x32_bf16 a[88:91], v[68:71], v[40:43], 0
    v_mfma_f32_16x16x32_bf16 a[92:95], v[68:71], v[44:47], 0
    v_mfma_f32_16x16x32_bf16 a[136:139], v[72:75], v[40:43], 0
    v_mfma_f32_16x16x32_bf16 a[140:143], v[72:75], v[44:47], 0
    s_waitcnt vmcnt(24)
    ds_read_b64 v[200:201], v22 offset:24576
    ds_read_b64 v[202:203], v142 offset:24704
    ds_read_b64 v[204:205], v23 offset:24576
    ds_read_b64 v[206:207], v143 offset:24704
    ds_read_b64 v[208:209], v142 offset:24576
    ds_read_b64 v[210:211], v22 offset:24832
    ds_read_b64 v[212:213], v143 offset:24576
    ds_read_b64 v[214:215], v23 offset:24832
    ds_read_b64 v[216:217], v22 offset:24704
    ds_read_b64 v[218:219], v142 offset:24832
    ds_read_b64 v[220:221], v23 offset:24704
    ds_read_b64 v[222:223], v143 offset:24832
    s_waitcnt lgkmcnt(0)
    v_mfma_f32_16x16x32_bf16 v[76:79], v[144:147], v[200:203], 0
    v_mfma_f32_16x16x32_bf16 v[76:79], v[148:151], v[204:207], v[76:79]
    v_mfma_f32_16x16x32_bf16 v[76:79], v[160:163], v[208:211], v[76:79]
    v_mfma_f32_16x16x32_bf16 v[76:79], v[164:167], v[212:215], v[76:79]
    v_mfma_f32_16x16x32_bf16 v[76:79], v[176:179], v[216:219], v[76:79]
    v_mfma_f32_16x16x32_bf16 v[76:79], v[180:183], v[220:223], v[76:79]
    v_mfma_f32_16x16x32_bf16 v[108:111], v[152:155], v[200:203], 0
    v_mfma_f32_16x16x32_bf16 v[108:111], v[156:159], v[204:207], v[108:111]
    v_mfma_f32_16x16x32_bf16 v[108:111], v[168:171], v[208:211], v[108:111]
    v_mfma_f32_16x16x32_bf16 v[108:111], v[172:175], v[212:215], v[108:111]
    v_mfma_f32_16x16x32_bf16 v[108:111], v[184:187], v[216:219], v[108:111]
    v_mfma_f32_16x16x32_bf16 v[108:111], v[188:191], v[220:223], v[108:111]
    s_nop 7
    v_max3_f32 v48, v76, v77, v78
    v_max3_f32 v50, v79, v108, v109
    v_max3_f32 v48, v48, v110, v111
    v_max_f32 v48, v48, v50
    v_mov_b32 v49, v48
    s_nop 1
    v_permlane16_swap_b32 v48, v49
    s_nop 1
    v_max_f32 v48, v48, v49
    v_mov_b32 v49, v48
    s_nop 1
    v_permlane32_swap_b32 v48, v49
    s_nop 1
    v_max_f32 v48, v48, v49
    v_sub_f32 v76, v76, v48
    v_sub_f32 v77, v77, v48
    v_sub_f32 v78, v78, v48
    v_sub_f32 v79, v79, v48
    v_sub_f32 v108, v108, v48
    v_sub_f32 v109, v109, v48
    v_sub_f32 v110, v110, v48
    v_sub_f32 v111, v111, v48
    v_exp_f32 v76, v76
    v_exp_f32 v77, v77
    v_exp_f32 v78, v78
    v_exp_f32 v79, v79
    v_exp_f32 v108, v108
    v_exp_f32 v109, v109
    v_exp_f32 v110, v110
    v_exp_f32 v111, v111
    v_sub_f32 v140, 0, v48
    v_sub_f32 v141, 0, v48
    v_sub_f32 v142, 0, v48
    v_sub_f32 v143, 0, v48
    v_add_f32 v8, v8, v76
    v_add_f32 v8, v8, v77
    v_add_f32 v8, v8, v78
    v_add_f32 v8, v8, v79
    v_add_f32 v8, v8, v108
    v_add_f32 v8, v8, v109
    v_add_f32 v8, v8, v110
    v_add_f32 v8, v8, v111
    v_cvt_pk_bf16_f32 v76, v76, v77
    v_cvt_pk_bf16_f32 v77, v78, v79
    v_cvt_pk_bf16_f32 v78, v108, v109
    v_cvt_pk_bf16_f32 v79, v110, v111
    s_waitcnt vmcnt(21)
    s_barrier
    ds_read_b128 v[24:27], v2 offset:12288
    ds_read_b128 v[28:31], v3 offset:12288
    ds_read_b128 v[32:35], v2 offset:18432
    ds_read_b128 v[36:39], v3 offset:18432
    s_waitcnt lgkmcnt(2)
    v_mfma_f32_16x16x32_bf16 v[80:83], v[24:27], a[192:195], v[128:131]
    ds_read_b128 v[40:43], v2 offset:12416
    v_mfma_f32_16x16x32_bf16 v[80:83], v[28:31], a[196:199], v[80:83]
    v_mfma_f32_16x16x32_bf16 v[84:87], v[24:27], a[216:219], v[132:135]
    v_mfma_f32_16x16x32_bf16 v[84:87], v[28:31], a[220:223], v[84:87]
    v_mfma_f32_16x16x32_bf16 v[88:91], v[24:27], a[240:243], v[136:139]
    ds_read_b128 v[44:47], v3 offset:12416
    v_mfma_f32_16x16x32_bf16 v[88:91], v[28:31], a[244:247], v[88:91]
    v_mfma_f32_16x16x32_bf16 v[92:95], v[24:27], v[200:203], v[140:143]
    v_mfma_f32_16x16x32_bf16 v[92:95], v[28:31], v[204:207], v[92:95]
    s_waitcnt lgkmcnt(2)
    v_mfma_f32_16x16x32_bf16 v[112:115], v[32:35], a[192:195], v[128:131]
    ds_read_b128 v[24:27], v2 offset:18560
    v_mfma_f32_16x16x32_bf16 v[112:115], v[36:39], a[196:199], v[112:115]
    v_mfma_f32_16x16x32_bf16 v[116:119], v[32:35], a[216:219], v[132:135]
    v_mfma_f32_16x16x32_bf16 v[116:119], v[36:39], a[220:223], v[116:119]
    v_mfma_f32_16x16x32_bf16 v[120:123], v[32:35], a[240:243], v[136:139]
    ds_read_b128 v[28:31], v3 offset:18560
    v_mfma_f32_16x16x32_bf16 v[120:123], v[36:39], a[244:247], v[120:123]
    v_mfma_f32_16x16x32_bf16 v[124:127], v[32:35], v[200:203], v[140:143]
    v_mfma_f32_16x16x32_bf16 v[124:127], v[36:39], v[204:207], v[124:127]
    s_waitcnt lgkmcnt(2)
    v_mfma_f32_16x16x32_bf16 v[80:83], v[40:43], a[200:203], v[80:83]
    ds_read_b128 v[32:35], v2 offset:12544
    v_mfma_f32_16x16x32_bf16 v[80:83], v[44:47], a[204:207], v[80:83]
    v_mfma_f32_16x16x32_bf16 v[84:87], v[40:43], a[224:227], v[84:87]
    v_mfma_f32_16x16x32_bf16 v[84:87], v[44:47], a[228:231], v[84:87]
    v_mfma_f32_16x16x32_bf16 v[88:91], v[40:43], a[248:251], v[88:91]
    ds_read_b128 v[36:39], v3 offset:12544
    v_mfma_f32_16x16x32_bf16 v[88:91], v[44:47], a[252:255], v[88:91]
    v_mfma_f32_16x16x32_bf16 v[92:95], v[40:43], v[208:211], v[92:95]
    v_mfma_f32_16x16x32_bf16 v[92:95], v[44:47], v[212:215], v[92:95]
    s_waitcnt lgkmcnt(2)
    v_mfma_f32_16x16x32_bf16 v[112:115], v[24:27], a[200:203], v[112:115]
    ds_read_b128 v[40:43], v2 offset:18688
    v_mfma_f32_16x16x32_bf16 v[112:115], v[28:31], a[204:207], v[112:115]
    v_mfma_f32_16x16x32_bf16 v[116:119], v[24:27], a[224:227], v[116:119]
    v_mfma_f32_16x16x32_bf16 v[116:119], v[28:31], a[228:231], v[116:119]
    v_mfma_f32_16x16x32_bf16 v[120:123], v[24:27], a[248:251], v[120:123]
    ds_read_b128 v[44:47], v3 offset:18688
    v_mfma_f32_16x16x32_bf16 v[120:123], v[28:31], a[252:255], v[120:123]
    s_waitcnt lgkmcnt(2)
    v_mfma_f32_16x16x32_bf16 v[124:127], v[24:27], v[208:211], v[124:127]
    s_waitcnt vmcnt(15)
    v_mfma_f32_16x16x32_bf16 v[124:127], v[28:31], v[212:215], v[124:127]
    s_barrier
    v_add_u32 v2, 49152, v2
    v_add_u32 v3, 49152, v3
    v_mfma_f32_16x16x32_bf16 v[80:83], v[32:35], a[208:211], v[80:83]
    s_mov_b32 m0, s26
    ds_read_b128 v[24:27], v2 offset:0
    v_mfma_f32_16x16x32_bf16 v[80:83], v[36:39], a[212:215], v[80:83]
    buffer_load_dwordx4 v4, s[4:7], s32 offen offset:0 sc1 lds
    v_mfma_f32_16x16x32_bf16 v[84:87], v[32:35], a[232:235], v[84:87]
    v_mfma_f32_16x16x32_bf16 v[84:87], v[36:39], a[236:239], v[84:87]
    s_waitcnt vmcnt(15)
    buffer_load_dwordx4 v4, s[4:7], s32 offen offset:1024 sc1 lds
    v_mfma_f32_16x16x32_bf16 v[88:91], v[32:35], v[192:195], v[88:91]
    ds_read_b128 v[28:31], v3 offset:0
    v_mfma_f32_16x16x32_bf16 v[88:91], v[36:39], v[196:199], v[88:91]
    s_waitcnt vmcnt(15)
    buffer_load_dwordx4 v4, s[4:7], s32 offen offset:2048 sc1 lds
    v_mfma_f32_16x16x32_bf16 v[92:95], v[32:35], v[216:219], v[92:95]
    s_add_u32 s32, s32, 24576
    s_sub_u32 s57, s32, 196608
    v_mfma_f32_16x16x32_bf16 v[92:95], v[36:39], v[220:223], v[92:95]
    s_waitcnt lgkmcnt(2)
    s_min_u32 s32, s32, s57
    s_add_u32 s26, s26, 12288
    v_mfma_f32_16x16x32_bf16 v[112:115], v[40:43], a[208:211], v[112:115]
    s_mov_b32 m0, s26
    ds_read_b128 v[32:35], v2 offset:6144
    v_mfma_f32_16x16x32_bf16 v[112:115], v[44:47], a[212:215], v[112:115]
    s_waitcnt vmcnt(15)
    buffer_load_dwordx4 v4, s[4:7], s32 offen offset:0 sc1 lds
    v_mfma_f32_16x16x32_bf16 v[116:119], v[40:43], a[232:235], v[116:119]
    v_mfma_f32_16x16x32_bf16 v[116:119], v[44:47], a[236:239], v[116:119]
    s_waitcnt vmcnt(14)
    buffer_load_dwordx4 v4, s[4:7], s32 offen offset:1024 sc1 lds
    v_mfma_f32_16x16x32_bf16 v[120:123], v[40:43], v[192:195], v[120:123]
    ds_read_b128 v[36:39], v3 offset:6144
    v_mfma_f32_16x16x32_bf16 v[120:123], v[44:47], v[196:199], v[120:123]
    s_waitcnt vmcnt(14)
    buffer_load_dwordx4 v4, s[4:7], s32 offen offset:2048 sc1 lds
    v_mfma_f32_16x16x32_bf16 v[124:127], v[40:43], v[216:219], v[124:127]
    v_mfma_f32_16x16x32_bf16 v[124:127], v[44:47], v[220:223], v[124:127]
    s_waitcnt lgkmcnt(2)
    s_add_u32 s32, s32, 24576
    s_sub_u32 s57, s32, 196608
    s_min_u32 s32, s32, s57
    s_add_u32 s26, s26, 36864
    s_sub_u32 s57, s26, 147456
    s_min_u32 s26, s26, s57
    v_mfma_f32_16x16x32_bf16 v[160:163], v[24:27], a[192:195], v[128:131]
    s_mov_b32 m0, s56
    ds_read_b128 v[40:43], v2 offset:128
    v_mfma_f32_16x16x32_bf16 v[160:163], v[28:31], a[196:199], v[160:163]
    s_waitcnt vmcnt(13)
    buffer_load_dwordx4 v4, s[4:7], s27 offen offset:0 sc1 lds
    v_mfma_f32_16x16x32_bf16 v[164:167], v[24:27], a[216:219], v[132:135]
    v_exp_f32 v16, v80
    v_mfma_f32_16x16x32_bf16 v[164:167], v[28:31], a[220:223], v[164:167]
    s_waitcnt vmcnt(13)
    buffer_load_dwordx4 v4, s[4:7], s27 offen offset:1024 sc1 lds
    v_exp_f32 v17, v81
    v_exp_f32 v18, v82
    v_add_f32 v5, v5, v16
    v_add_f32 v5, v5, v17
    v_mfma_f32_16x16x32_bf16 v[168:171], v[24:27], a[240:243], v[136:139]
    ds_read_b128 v[44:47], v3 offset:128
    v_mfma_f32_16x16x32_bf16 v[168:171], v[28:31], a[244:247], v[168:171]
    s_waitcnt vmcnt(12)
    buffer_load_dwordx4 v4, s[4:7], s27 offen offset:2048 sc1 lds
    v_exp_f32 v19, v83
    v_cvt_pk_bf16_f32 v80, v16, v17
    v_mfma_f32_16x16x32_bf16 v[172:175], v[24:27], v[200:203], v[140:143]
    s_add_u32 s27, s27, 24576
    v_exp_f32 v16, v112
    v_mfma_f32_16x16x32_bf16 v[172:175], v[28:31], v[204:207], v[172:175]
    s_waitcnt lgkmcnt(2)
    v_add_f32 v5, v5, v18
    v_add_f32 v5, v5, v19
    v_exp_f32 v17, v113
    v_cvt_pk_bf16_f32 v81, v18, v19
    s_sub_u32 s58, s27, 196608
    v_mfma_f32_16x16x32_bf16 v[96:99], v[32:35], a[192:195], v[128:131]
    s_min_u32 s27, s27, s58
    ds_read_b128 v[24:27], v2 offset:6272
    s_add_u32 s56, s56, 12288
    v_mfma_f32_16x16x32_bf16 v[96:99], v[36:39], a[196:199], v[96:99]
    s_mov_b32 m0, s56
    v_exp_f32 v18, v114
    v_add_f32 v5, v5, v16
    v_add_f32 v5, v5, v17
    v_mfma_f32_16x16x32_bf16 v[100:103], v[32:35], a[216:219], v[132:135]
    v_exp_f32 v19, v115
    v_mfma_f32_16x16x32_bf16 v[100:103], v[36:39], a[220:223], v[100:103]
    s_waitcnt vmcnt(11)
    buffer_load_dwordx4 v4, s[4:7], s27 offen offset:0 sc1 lds
    v_cvt_pk_bf16_f32 v82, v16, v17
    v_exp_f32 v16, v84
    v_add_f32 v5, v5, v18
    v_mfma_f32_16x16x32_bf16 v[104:107], v[32:35], a[240:243], v[136:139]
    ds_read_b128 v[28:31], v3 offset:6272
    v_add_f32 v5, v5, v19
    v_mfma_f32_16x16x32_bf16 v[104:107], v[36:39], a[244:247], v[104:107]
    s_waitcnt vmcnt(11)
    buffer_load_dwordx4 v4, s[4:7], s27 offen offset:1024 sc1 lds
    v_exp_f32 v17, v85
    v_cvt_pk_bf16_f32 v83, v18, v19
    v_mfma_f32_16x16x32_bf16 v[108:111], v[32:35], v[200:203], v[140:143]
    v_exp_f32 v18, v86
    v_mfma_f32_16x16x32_bf16 v[108:111], v[36:39], v[204:207], v[108:111]
    s_waitcnt lgkmcnt(2)
    s_waitcnt vmcnt(11)
    buffer_load_dwordx4 v4, s[4:7], s27 offen offset:2048 sc1 lds
    v_add_f32 v6, v6, v16
    v_add_f32 v6, v6, v17
    v_exp_f32 v19, v87
    v_mfma_f32_16x16x32_bf16 v[160:163], v[40:43], a[200:203], v[160:163]
    ds_read_b128 v[32:35], v2 offset:256
    v_cvt_pk_bf16_f32 v84, v16, v17
    v_mfma_f32_16x16x32_bf16 v[160:163], v[44:47], a[204:207], v[160:163]
    v_exp_f32 v16, v116
    v_add_f32 v6, v6, v18
    v_add_f32 v6, v6, v19
    v_mfma_f32_16x16x32_bf16 v[164:167], v[40:43], a[224:227], v[164:167]
    v_exp_f32 v17, v117
    v_mfma_f32_16x16x32_bf16 v[164:167], v[44:47], a[228:231], v[164:167]
    s_add_u32 s27, s27, 24576
    v_cvt_pk_bf16_f32 v85, v18, v19
    v_exp_f32 v18, v118
    v_add_f32 v6, v6, v16
    v_add_f32 v6, v6, v17
    s_sub_u32 s58, s27, 196608
    v_mfma_f32_16x16x32_bf16 v[168:171], v[40:43], a[248:251], v[168:171]
    s_waitcnt vmcnt(18)
    ds_read_b128 v[36:39], v3 offset:256
    v_lshlrev_b32 v48, 16, v56
    v_mfma_f32_16x16x32_bf16 v[168:171], v[44:47], a[252:255], v[168:171]
    s_waitcnt vmcnt(11)
    buffer_load_dwordx3 v[144:146], v12, s[68:71], s35 offen offset:0 nt
    v_exp_f32 v19, v119
    v_cvt_pk_bf16_f32 v86, v16, v17
    v_mfma_f32_16x16x32_bf16 v[172:175], v[40:43], v[208:211], v[172:175]
    s_min_u32 s27, s27, s58
    v_add_f32 v6, v6, v18
    v_add_f32 v6, v6, v19
    v_mfma_f32_16x16x32_bf16 v[172:175], v[44:47], v[212:215], v[172:175]
    s_waitcnt lgkmcnt(2)
    s_waitcnt vmcnt(11)
    buffer_load_dwordx3 v[148:150], v12, s[68:71], s35 offen offset:768 nt
    v_cvt_pk_bf16_f32 v87, v18, v19
    v_exp_f32 v16, v88
    v_and_b32 v49, s97, v56
    v_mfma_f32_16x16x32_bf16 v[96:99], v[24:27], a[200:203], v[96:99]
    s_add_u32 s56, s56, 36864
    ds_read_b128 v[40:43], v2 offset:6400
    v_lshlrev_b32 v50, 16, v58
    v_mfma_f32_16x16x32_bf16 v[96:99], v[28:31], a[204:207], v[96:99]
    s_waitcnt vmcnt(11)
    buffer_load_dwordx3 v[152:154], v12, s[68:71], s35 offen offset:1536 nt
    v_exp_f32 v17, v89
    v_and_b32 v51, s97, v58
    v_mfma_f32_16x16x32_bf16 v[100:103], v[24:27], a[224:227], v[100:103]
    s_sub_u32 s58, s56, 147456
    v_exp_f32 v18, v90
    v_mfma_f32_16x16x32_bf16 v[100:103], v[28:31], a[228:231], v[100:103]
    buffer_load_dwordx3 v[156:158], v12, s[68:71], s35 offen offset:2304 nt
    v_add_f32 v7, v7, v16
    v_add_f32 v7, v7, v17
    v_mul_f32 v48, s38, v48
    v_mfma_f32_16x16x32_bf16 v[104:107], v[24:27], a[248:251], v[104:107]
    s_min_u32 s56, s56, s58
    ds_read_b128 v[44:47], v3 offset:6400
    v_mul_f32 v49, s38, v49
    v_mfma_f32_16x16x32_bf16 v[104:107], v[28:31], a[252:255], v[104:107]
    v_exp_f32 v19, v91
    v_cvt_pk_bf16_f32 v88, v16, v17
    v_exp_f32 v16, v120
    v_mfma_f32_16x16x32_bf16 v[108:111], v[24:27], v[208:211], v[108:111]
    v_add_f32 v7, v7, v18
    v_add_f32 v7, v7, v19
    v_mfma_f32_16x16x32_bf16 v[108:111], v[28:31], v[212:215], v[108:111]
    s_waitcnt lgkmcnt(2)
    v_exp_f32 v17, v121
    v_mul_f32_e64 v50, -v50, v48
    v_mul_f32_e64 v51, -v51, v49
    v_cvt_pk_bf16_f32 v89, v18, v19
    v_cvt_f32_i32 v224, v224
    v_mfma_f32_16x16x32_bf16 v[160:163], v[32:35], a[208:211], v[160:163]
    ds_read_b128 v[24:27], v2 offset:12288
    v_cvt_f32_i32 v225, v225
    v_mfma_f32_16x16x32_bf16 v[160:163], v[36:39], a[212:215], v[160:163]
    v_exp_f32 v18, v122
    v_fma_f32 v224, v224, v48, v50
    v_add_f32 v7, v7, v16
    v_fma_f32 v225, v225, v49, v51
    v_mfma_f32_16x16x32_bf16 v[164:167], v[32:35], a[232:235], v[164:167]
    v_add_f32 v7, v7, v17
    v_cvt_pk_bf16_f32 v224, v224, v225
    v_mfma_f32_16x16x32_bf16 v[164:167], v[36:39], a[236:239], v[164:167]
    v_exp_f32 v19, v123
    v_cvt_f32_i32 v228, v228
    v_cvt_f32_i32 v229, v229
    v_cvt_pk_bf16_f32 v90, v16, v17
    v_mfma_f32_16x16x32_bf16 v[168:171], v[32:35], v[192:195], v[168:171]
    ds_read_b128 v[28:31], v3 offset:12288
    v_fma_f32 v228, v228, v48, v50
    v_mfma_f32_16x16x32_bf16 v[168:171], v[36:39], v[196:199], v[168:171]
    v_exp_f32 v16, v92
    v_fma_f32 v229, v229, v49, v51
    v_cvt_pk_bf16_f32 v228, v228, v229
    v_add_f32 v7, v7, v18
    v_mfma_f32_16x16x32_bf16 v[172:175], v[32:35], v[216:219], v[172:175]
L_iw1:
L_pg1:
    s_cbranch_execz L_pg5
    v_cvt_f32_i32 v232, v232
    v_add_f32 v7, v7, v19
    v_mfma_f32_16x16x32_bf16 v[172:175], v[36:39], v[220:223], v[172:175]
    s_waitcnt lgkmcnt(2)
    v_exp_f32 v17, v93
    v_cvt_f32_i32 v233, v233
    v_fma_f32 v232, v232, v48, v50
    v_fma_f32 v233, v233, v49, v51
    v_cvt_pk_bf16_f32 v91, v18, v19
    v_mfma_f32_16x16x32_bf16 v[96:99], v[40:43], a[208:211], v[96:99]
    ds_read_b128 v[32:35], v2 offset:18432
    v_cvt_pk_bf16_f32 v232, v232, v233
    v_mfma_f32_16x16x32_bf16 v[96:99], v[44:47], a[212:215], v[96:99]
    v_exp_f32 v18, v94
    v_cvt_f32_i32 v236, v236
    v_cvt_f32_i32 v237, v237
    v_add_f32 v8, v8, v16
    v_mfma_f32_16x16x32_bf16 v[100:103], v[40:43], a[232:235], v[100:103]
    v_fma_f32 v236, v236, v48, v50
    v_add_f32 v8, v8, v17
    v_mfma_f32_16x16x32_bf16 v[100:103], v[44:47], a[236:239], v[100:103]
    v_exp_f32 v19, v95
    v_fma_f32 v237, v237, v49, v51
    v_cvt_pk_bf16_f32 v236, v236, v237
    v_lshlrev_b32 v48, 16, v57
    v_mfma_f32_16x16x32_bf16 v[104:107], v[40:43], v[192:195], v[104:107]
    ds_read_b128 v[36:39], v3 offset:18432
    v_cvt_pk_bf16_f32 v92, v16, v17
    v_mfma_f32_16x16x32_bf16 v[104:107], v[44:47], v[196:199], v[104:107]
    v_exp_f32 v16, v124
    v_and_b32 v49, s97, v57
    v_lshlrev_b32 v50, 16, v59
    v_and_b32 v51, s97, v59
    v_mfma_f32_16x16x32_bf16 v[108:111], v[40:43], v[216:219], v[108:111]
    v_add_f32 v8, v8, v18
    v_mul_f32 v48, s38, v48
    v_mfma_f32_16x16x32_bf16 v[108:111], v[44:47], v[220:223], v[108:111]
    s_waitcnt lgkmcnt(2)
    v_add_f32 v8, v8, v19
    v_mul_f32 v49, s38, v49
    v_exp_f32 v17, v125
    v_mul_f32_e64 v50, -v50, v48
    v_mul_f32_e64 v51, -v51, v49
    v_mfma_f32_16x16x32_bf16 v[176:179], v[24:27], a[192:195], v[128:131]
    ds_read_b128 v[40:43], v2 offset:12416
    v_cvt_pk_bf16_f32 v93, v18, v19
    v_mfma_f32_16x16x32_bf16 v[176:179], v[28:31], a[196:199], v[176:179]
    v_exp_f32 v18, v126
    v_cvt_f32_i32 v226, v226
    v_cvt_f32_i32 v227, v227
    v_fma_f32 v226, v226, v48, v50
    v_mfma_f32_16x16x32_bf16 v[180:183], v[24:27], a[216:219], v[132:135]
    v_add_f32 v8, v8, v16
    v_fma_f32 v227, v227, v49, v51
    v_mfma_f32_16x16x32_bf16 v[180:183], v[28:31], a[220:223], v[180:183]
    v_add_f32 v8, v8, v17
    v_cvt_pk_bf16_f32 v225, v226, v227
    v_exp_f32 v19, v127
    v_cvt_f32_i32 v230, v230
    v_mfma_f32_16x16x32_bf16 v[184:187], v[24:27], a[240:243], v[136:139]
    ds_read_b128 v[44:47], v3 offset:12416
    v_cvt_f32_i32 v231, v231
    v_mfma_f32_16x16x32_bf16 v[184:187], v[28:31], a[244:247], v[184:187]
    v_cvt_pk_bf16_f32 v94, v16, v17
    v_fma_f32 v230, v230, v48, v50
    v_add_f32 v8, v8, v18
    v_fma_f32 v231, v231, v49, v51
    v_cvt_pk_bf16_f32 v229, v230, v231
    v_mfma_f32_16x16x32_bf16 v[188:191], v[24:27], v[200:203], v[140:143]
    v_add_f32 v8, v8, v19
    v_cvt_pk_bf16_f32 v95, v18, v19
    v_mfma_f32_16x16x32_bf16 v[188:191], v[28:31], v[204:207], v[188:191]
    s_waitcnt lgkmcnt(2)
    v_cvt_f32_i32 v234, v234
    v_cvt_f32_i32 v235, v235
    v_exp_f32 v16, v160
    v_fma_f32 v234, v234, v48, v50
    v_fma_f32 v235, v235, v49, v51
    v_mfma_f32_16x16x32_bf16 v[112:115], v[32:35], a[192:195], v[128:131]
    ds_read_b128 v[24:27], v2 offset:18560
    v_cvt_pk_bf16_f32 v233, v234, v235
    v_mfma_f32_16x16x32_bf16 v[112:115], v[36:39], a[196:199], v[112:115]
    v_exp_f32 v17, v161
    v_exp_f32 v18, v162
    v_add_f32 v5, v5, v16
    v_mfma_f32_16x16x32_bf16 v[116:119], v[32:35], a[216:219], v[132:135]
    v_cvt_f32_i32 v238, v238
    v_cvt_f32_i32 v239, v239
    v_mfma_f32_16x16x32_bf16 v[116:119], v[36:39], a[220:223], v[116:119]
    v_fma_f32 v238, v238, v48, v50
    v_add_f32 v5, v5, v17
    v_exp_f32 v19, v163
    v_cvt_pk_bf16_f32 v160, v16, v17
    v_mfma_f32_16x16x32_bf16 v[120:123], v[32:35], a[240:243], v[136:139]
    ds_read_b128 v[28:31], v3 offset:18560
    v_fma_f32 v239, v239, v49, v51
    v_cvt_pk_bf16_f32 v237, v238, v239
    v_mfma_f32_16x16x32_bf16 v[120:123], v[36:39], a[244:247], v[120:123]
    s_waitcnt vmcnt(16)
    v_lshlrev_b32 v48, 16, v60
    v_and_b32 v49, s97, v60
    v_lshlrev_b32 v50, 16, v62
    v_and_b32 v51, s97, v62
    v_mul_f32 v48, s38, v48
    v_mfma_f32_16x16x32_bf16 v[124:127], v[32:35], v[200:203], v[140:143]
    v_mul_f32 v49, s38, v49
    v_mul_f32_e64 v50, -v50, v48
    v_mfma_f32_16x16x32_bf16 v[124:127], v[36:39], v[204:207], v[124:127]
    s_waitcnt lgkmcnt(2)
    s_waitcnt vmcnt(12)
    buffer_load_dwordx2 v[56:57], off, s[80:83], s37 offset:0
    v_mul_f32_e64 v51, -v51, v49
    v_cvt_f32_i32 v240, v240
    v_cvt_f32_i32 v241, v241
    v_mfma_f32_16x16x32_bf16 v[176:179], v[40:43], a[200:203], v[176:179]
    ds_read_b128 v[32:35], v2 offset:12544
    v_fma_f32 v240, v240, v48, v50
    v_mfma_f32_16x16x32_bf16 v[176:179], v[44:47], a[204:207], v[176:179]
    buffer_load_dwordx2 v[58:59], off, s[84:87], s37 offset:0
    v_exp_f32 v16, v96
    v_fma_f32 v241, v241, v49, v51
    v_mfma_f32_16x16x32_bf16 v[180:183], v[40:43], a[224:227], v[180:183]
    v_cvt_pk_bf16_f32 v226, v240, v241
    v_add_f32 v5, v5, v18
    v_mfma_f32_16x16x32_bf16 v[180:183], v[44:47], a[228:231], v[180:183]
    v_cvt_f32_i32 v244, v244
    v_add_f32 v5, v5, v19
    v_cvt_f32_i32 v245, v245
    v_exp_f32 v17, v97
    v_fma_f32 v244, v244, v48, v50
    v_mfma_f32_16x16x32_bf16 v[184:187], v[40:43], a[248:251], v[184:187]
    ds_read_b128 v[36:39], v3 offset:12544
    v_fma_f32 v245, v245, v49, v51
    v_mfma_f32_16x16x32_bf16 v[184:187], v[44:47], a[252:255], v[184:187]
    v_cvt_pk_bf16_f32 v161, v18, v19
    v_cvt_pk_bf16_f32 v230, v244, v245
    v_exp_f32 v18, v98
    v_cvt_f32_i32 v248, v248
    v_mfma_f32_16x16x32_bf16 v[188:191], v[40:43], v[208:211], v[188:191]
    v_cvt_f32_i32 v249, v249
    v_add_f32 v5, v5, v16
    v_mfma_f32_16x16x32_bf16 v[188:191], v[44:47], v[212:215], v[188:191]
    s_waitcnt lgkmcnt(2)
    v_fma_f32 v248, v248, v48, v50
    v_add_f32 v5, v5, v17
    v_fma_f32 v249, v249, v49, v51
    v_exp_f32 v19, v99
    v_mfma_f32_16x16x32_bf16 v[112:115], v[24:27], a[200:203], v[112:115]
    ds_read_b128 v[40:43], v2 offset:18688
    v_cvt_pk_bf16_f32 v234, v248, v249
    v_mfma_f32_16x16x32_bf16 v[112:115], v[28:31], a[204:207], v[112:115]
    v_cvt_f32_i32 v252, v252
    v_cvt_pk_bf16_f32 v162, v16, v17
    v_cvt_f32_i32 v253, v253
    v_exp_f32 v16, v164
    v_mfma_f32_16x16x32_bf16 v[116:119], v[24:27], a[224:227], v[116:119]
    v_fma_f32 v252, v252, v48, v50
    v_fma_f32 v253, v253, v49, v51
    v_mfma_f32_16x16x32_bf16 v[116:119], v[28:31], a[228:231], v[116:119]
    v_add_f32 v5, v5, v18
    v_cvt_pk_bf16_f32 v238, v252, v253
    v_add_f32 v5, v5, v19
    v_lshlrev_b32 v48, 16, v61
    v_exp_f32 v17, v165
    v_mfma_f32_16x16x32_bf16 v[120:123], v[24:27], a[248:251], v[120:123]
    ds_read_b128 v[44:47], v3 offset:18688
    v_and_b32 v49, s97, v61
    v_mfma_f32_16x16x32_bf16 v[120:123], v[28:31], a[252:255], v[120:123]
    s_waitcnt lgkmcnt(2)
    v_lshlrev_b32 v50, 16, v63
    v_cvt_pk_bf16_f32 v163, v18, v19
    v_and_b32 v51, s97, v63
    v_exp_f32 v18, v166
    v_mfma_f32_16x16x32_bf16 v[124:127], v[24:27], v[208:211], v[124:127]
    s_waitcnt vmcnt(30)
    v_mul_f32 v48, s38, v48
    v_mul_f32 v49, s38, v49
    v_mfma_f32_16x16x32_bf16 v[124:127], v[28:31], v[212:215], v[124:127]
    s_barrier
    v_add_f32 v6, v6, v16
    v_mul_f32_e64 v50, -v50, v48
    v_add_f32 v6, v6, v17
    v_mul_f32_e64 v51, -v51, v49
    v_mfma_f32_16x16x32_bf16 v[176:179], v[32:35], a[208:211], v[176:179]
    ds_read_b128 v[24:27], v1 offset:0
    v_cvt_f32_i32 v242, v242
    v_mfma_f32_16x16x32_bf16 v[176:179], v[36:39], a[212:215], v[176:179]
    v_exp_f32 v19, v167
    v_cvt_f32_i32 v243, v243
    v_cvt_pk_bf16_f32 v164, v16, v17
    v_fma_f32 v242, v242, v48, v50
    v_mfma_f32_16x16x32_bf16 v[180:183], v[32:35], a[232:235], v[180:183]
    v_exp_f32 v16, v100
    v_mfma_f32_16x16x32_bf16 v[180:183], v[36:39], a[236:239], v[180:183]
    v_fma_f32 v243, v243, v49, v51
    v_cvt_pk_bf16_f32 v227, v242, v243
    v_add_f32 v6, v6, v18
    v_cvt_f32_i32 v246, v246
    v_add_f32 v6, v6, v19
    v_cvt_f32_i32 v247, v247
    v_mfma_f32_16x16x32_bf16 v[184:187], v[32:35], v[192:195], v[184:187]
    ds_read_b128 v[28:31], v1 offset:12288
    v_fma_f32 v246, v246, v48, v50
    v_mfma_f32_16x16x32_bf16 v[184:187], v[36:39], v[196:199], v[184:187]
    v_exp_f32 v17, v101
    v_fma_f32 v247, v247, v49, v51
    v_cvt_pk_bf16_f32 v165, v18, v19
    v_cvt_pk_bf16_f32 v231, v246, v247
    v_mfma_f32_16x16x32_bf16 v[188:191], v[32:35], v[216:219], v[188:191]
    v_exp_f32 v18, v102
    v_mfma_f32_16x16x32_bf16 v[188:191], v[36:39], v[220:223], v[188:191]
    s_waitcnt lgkmcnt(2)
    v_cvt_f32_i32 v250, v250
    v_cvt_f32_i32 v251, v251
    v_add_f32 v6, v6, v16
    v_fma_f32 v250, v250, v48, v50
    v_add_f32 v6, v6, v17
    v_mfma_f32_16x16x32_bf16 v[112:115], v[40:43], a[208:211], v[112:115]
    ds_read_b128 v[32:35], v1 offset:1024
    v_fma_f32 v251, v251, v49, v51
    v_mfma_f32_16x16x32_bf16 v[112:115], v[44:47], a[212:215], v[112:115]
    v_exp_f32 v19, v103
    v_cvt_pk_bf16_f32 v235, v250, v251
    v_cvt_f32_i32 v254, v254
    v_cvt_pk_bf16_f32 v166, v16, v17
    v_mfma_f32_16x16x32_bf16 v[116:119], v[40:43], a[232:235], v[116:119]
    v_cvt_f32_i32 v255, v255
    v_add_f32 v6, v6, v18
    v_mfma_f32_16x16x32_bf16 v[116:119], v[44:47], a[236:239], v[116:119]
    v_fma_f32 v254, v254, v48, v50
    v_add_f32 v6, v6, v19
    v_fma_f32 v255, v255, v49, v51
    v_cvt_pk_bf16_f32 v167, v18, v19
    v_cvt_pk_bf16_f32 v239, v254, v255
    v_mfma_f32_16x16x32_bf16 v[120:123], v[40:43], v[192:195], v[120:123]
    ds_read_b128 v[36:39], v1 offset:13312
    v_mfma_f32_16x16x32_bf16 v[120:123], v[44:47], v[196:199], v[120:123]
    v_mfma_f32_16x16x32_bf16 v[124:127], v[40:43], v[216:219], v[124:127]
    v_mfma_f32_16x16x32_bf16 v[124:127], v[44:47], v[220:223], v[124:127]
    s_waitcnt lgkmcnt(2)
    v_mfma_f32_16x16x32_bf16 a[144:147], v[76:79], v[24:27], 0
    ds_read_b128 v[40:43], v1 offset:2048
    v_mfma_f32_16x16x32_bf16 a[144:147], v[92:95], v[28:31], a[144:147]
    buffer_store_dwordx4 v[224:227], v11, s[4:7], s33 offen offset:0 sc1
    v_mfma_f32_16x16x32_bf16 a[0:3], v[80:83], v[28:31], a[0:3]
    ds_read_b128 v[44:47], v1 offset:14336
    v_mfma_f32_16x16x32_bf16 a[48:51], v[84:87], v[28:31], a[48:51]
    v_exp_f32 v16, v168
    v_mfma_f32_16x16x32_bf16 a[96:99], v[88:91], v[28:31], a[96:99]
    s_waitcnt lgkmcnt(2)
    v_exp_f32 v17, v169
    v_mfma_f32_16x16x32_bf16 a[148:151], v[76:79], v[32:35], 0
    ds_read_b128 v[24:27], v1 offset:3072
    v_exp_f32 v18, v170
    v_mfma_f32_16x16x32_bf16 a[148:151], v[92:95], v[36:39], a[148:151]
    v_add_f32 v7, v7, v16
    v_add_f32 v7, v7, v17
    v_mfma_f32_16x16x32_bf16 a[4:7], v[80:83], v[36:39], a[4:7]
    ds_read_b128 v[28:31], v1 offset:15360
    v_exp_f32 v19, v171
    v_mfma_f32_16x16x32_bf16 a[52:55], v[84:87], v[36:39], a[52:55]
    v_cvt_pk_bf16_f32 v168, v16, v17
    v_xor_b32 v55, 16, v11
    v_mfma_f32_16x16x32_bf16 a[100:103], v[88:91], v[36:39], a[100:103]
    s_waitcnt lgkmcnt(2)
    v_exp_f32 v16, v104
    v_mfma_f32_16x16x32_bf16 a[152:155], v[76:79], v[40:43], 0
    ds_read_b128 v[32:35], v1 offset:4096
    v_add_f32 v7, v7, v18
    v_mfma_f32_16x16x32_bf16 a[152:155], v[92:95], v[44:47], a[152:155]
    buffer_store_dwordx4 v[228:231], v55, s[4:7], s33 offen offset:768 sc1
    v_mfma_f32_16x16x32_bf16 a[8:11], v[80:83], v[44:47], a[8:11]
    ds_read_b128 v[36:39], v1 offset:16384
    v_add_f32 v7, v7, v19
    v_mfma_f32_16x16x32_bf16 a[56:59], v[84:87], v[44:47], a[56:59]
    v_exp_f32 v17, v105
    v_cvt_pk_bf16_f32 v169, v18, v19
    v_mfma_f32_16x16x32_bf16 a[104:107], v[88:91], v[44:47], a[104:107]
    s_waitcnt lgkmcnt(2)
    v_exp_f32 v18, v106
    v_mfma_f32_16x16x32_bf16 a[156:159], v[76:79], v[24:27], 0
    ds_read_b128 v[40:43], v1 offset:5120
    v_add_f32 v7, v7, v16
    v_add_f32 v7, v7, v17
    v_mfma_f32_16x16x32_bf16 a[156:159], v[92:95], v[28:31], a[156:159]
    v_exp_f32 v19, v107
    v_mfma_f32_16x16x32_bf16 a[12:15], v[80:83], v[28:31], a[12:15]
    ds_read_b128 v[44:47], v1 offset:17408
    v_cvt_pk_bf16_f32 v170, v16, v17
    v_mfma_f32_16x16x32_bf16 a[60:63], v[84:87], v[28:31], a[60:63]
    v_exp_f32 v16, v172
    v_mfma_f32_16x16x32_bf16 a[108:111], v[88:91], v[28:31], a[108:111]
    s_waitcnt lgkmcnt(2)
    v_add_f32 v7, v7, v18
    v_add_f32 v7, v7, v19
    v_mfma_f32_16x16x32_bf16 a[160:163], v[76:79], v[32:35], 0
    ds_read_b128 v[24:27], v1 offset:6144
    v_xor_b32 v54, 32, v11
    v_mfma_f32_16x16x32_bf16 a[160:163], v[92:95], v[36:39], a[160:163]
    buffer_store_dwordx4 v[232:235], v54, s[4:7], s33 offen offset:1536 sc1
    v_mfma_f32_16x16x32_bf16 a[16:19], v[80:83], v[36:39], a[16:19]
    ds_read_b128 v[28:31], v1 offset:18432
    v_mfma_f32_16x16x32_bf16 a[64:67], v[84:87], v[36:39], a[64:67]
    v_exp_f32 v17, v173
    v_cvt_pk_bf16_f32 v171, v18, v19
    v_mfma_f32_16x16x32_bf16 a[112:115], v[88:91], v[36:39], a[112:115]
    s_waitcnt lgkmcnt(2)
    v_exp_f32 v18, v174
    v_mfma_f32_16x16x32_bf16 a[164:167], v[76:79], v[40:43], 0
    ds_read_b128 v[32:35], v1 offset:7168
    v_add_f32 v8, v8, v16
    v_add_f32 v8, v8, v17
    v_mfma_f32_16x16x32_bf16 a[164:167], v[92:95], v[44:47], a[164:167]
    v_exp_f32 v19, v175
    v_mfma_f32_16x16x32_bf16 a[20:23], v[80:83], v[44:47], a[20:23]
    ds_read_b128 v[36:39], v1 offset:19456
    v_cvt_pk_bf16_f32 v172, v16, v17
    v_mfma_f32_16x16x32_bf16 a[68:71], v[84:87], v[44:47], a[68:71]
    v_exp_f32 v16, v108
    v_mfma_f32_16x16x32_bf16 a[116:119], v[88:91], v[44:47], a[116:119]
    s_waitcnt lgkmcnt(2)
    v_add_f32 v8, v8, v18
    v_add_f32 v8, v8, v19
    v_mfma_f32_16x16x32_bf16 a[168:171], v[76:79], v[24:27], 0
    ds_read_b128 v[40:43], v1 offset:8192
    v_xor_b32 v55, 48, v11
    v_mfma_f32_16x16x32_bf16 a[168:171], v[92:95], v[28:31], a[168:171]
    buffer_store_dwordx4 v[236:239], v55, s[4:7], s33 offen offset:2304 sc1
    v_mfma_f32_16x16x32_bf16 a[24:27], v[80:83], v[28:31], a[24:27]
    ds_read_b128 v[44:47], v1 offset:20480
    v_mfma_f32_16x16x32_bf16 a[72:75], v[84:87], v[28:31], a[72:75]
    v_exp_f32 v17, v109
    v_cvt_pk_bf16_f32 v173, v18, v19
    v_mfma_f32_16x16x32_bf16 a[120:123], v[88:91], v[28:31], a[120:123]
    s_waitcnt lgkmcnt(2)
    v_exp_f32 v18, v110
    v_mfma_f32_16x16x32_bf16 a[172:175], v[76:79], v[32:35], 0
    ds_read_b128 v[24:27], v1 offset:9216
    v_add_f32 v8, v8, v16
    v_add_f32 v8, v8, v17
    v_mfma_f32_16x16x32_bf16 a[172:175], v[92:95], v[36:39], a[172:175]
    v_exp_f32 v19, v111
    v_mfma_f32_16x16x32_bf16 a[28:31], v[80:83], v[36:39], a[28:31]
    ds_read_b128 v[28:31], v1 offset:21504
    v_cvt_pk_bf16_f32 v174, v16, v17
    v_add_f32 v8, v8, v18
    v_mfma_f32_16x16x32_bf16 a[76:79], v[84:87], v[36:39], a[76:79]
    v_add_f32 v8, v8, v19
    v_cvt_pk_bf16_f32 v175, v18, v19
    v_mfma_f32_16x16x32_bf16 a[124:127], v[88:91], v[36:39], a[124:127]
    s_waitcnt lgkmcnt(2)
    buffer_load_dwordx2 v[60:61], off, s[80:83], s37 offset:8
    v_mfma_f32_16x16x32_bf16 a[176:179], v[76:79], v[40:43], 0
    ds_read_b128 v[32:35], v1 offset:10240
    v_mfma_f32_16x16x32_bf16 a[176:179], v[92:95], v[44:47], a[176:179]
    buffer_load_dwordx2 v[62:63], off, s[84:87], s37 offset:8
    v_mfma_f32_16x16x32_bf16 a[32:35], v[80:83], v[44:47], a[32:35]
    ds_read_b128 v[36:39], v1 offset:22528
    v_mfma_f32_16x16x32_bf16 a[80:83], v[84:87], v[44:47], a[80:83]
    s_waitcnt vmcnt(19)
    buffer_load_dwordx3 v[240:242], v12, s[68:71], s16 offen offset:0 nt
    v_mfma_f32_16x16x32_bf16 a[128:131], v[88:91], v[44:47], a[128:131]
    s_waitcnt lgkmcnt(2)
    v_exp_f32 v16, v176
    v_mfma_f32_16x16x32_bf16 a[180:183], v[76:79], v[24:27], 0
    ds_read_b128 v[40:43], v1 offset:11264
    v_exp_f32 v17, v177
    v_mfma_f32_16x16x32_bf16 a[180:183], v[92:95], v[28:31], a[180:183]
    v_exp_f32 v18, v178
    v_mfma_f32_16x16x32_bf16 a[36:39], v[80:83], v[28:31], a[36:39]
    s_waitcnt vmcnt(19)
    ds_read_b128 v[44:47], v1 offset:23552
    v_add_f32 v5, v5, v16
    v_add_f32 v5, v5, v17
    v_mfma_f32_16x16x32_bf16 a[84:87], v[84:87], v[28:31], a[84:87]
    v_exp_f32 v19, v179
    v_mfma_f32_16x16x32_bf16 a[132:135], v[88:91], v[28:31], a[132:135]
    s_waitcnt lgkmcnt(2)
    s_barrier
    v_add_u32 v2, 49152, v2
    v_add_u32 v3, 49152, v3
    v_mfma_f32_16x16x32_bf16 a[184:187], v[76:79], v[32:35], 0
    ds_read_b128 v[24:27], v2 offset:0
    v_cvt_pk_bf16_f32 v176, v16, v17
    v_mfma_f32_16x16x32_bf16 a[184:187], v[92:95], v[36:39], a[184:187]
    buffer_load_dwordx3 v[244:246], v12, s[68:71], s16 offen offset:768 nt
    v_mfma_f32_16x16x32_bf16 a[40:43], v[80:83], v[36:39], a[40:43]
    ds_read_b128 v[28:31], v3 offset:0
    v_mfma_f32_16x16x32_bf16 a[88:91], v[84:87], v[36:39], a[88:91]
    buffer_load_dwordx3 v[248:250], v12, s[68:71], s16 offen offset:1536 nt
    v_mfma_f32_16x16x32_bf16 a[136:139], v[88:91], v[36:39], a[136:139]
    s_waitcnt lgkmcnt(2)
    v_exp_f32 v16, v112
    v_mfma_f32_16x16x32_bf16 a[188:191], v[76:79], v[40:43], 0
    ds_read_b128 v[32:35], v2 offset:6144
    v_add_f32 v5, v5, v18
    v_add_f32 v5, v5, v19
    v_mfma_f32_16x16x32_bf16 a[188:191], v[92:95], v[44:47], a[188:191]
    v_exp_f32 v17, v113
    v_mfma_f32_16x16x32_bf16 a[44:47], v[80:83], v[44:47], a[44:47]
    ds_read_b128 v[36:39], v3 offset:6144
    v_cvt_pk_bf16_f32 v177, v18, v19
    v_mfma_f32_16x16x32_bf16 a[92:95], v[84:87], v[44:47], a[92:95]
    v_exp_f32 v18, v114
    v_mfma_f32_16x16x32_bf16 a[140:143], v[88:91], v[44:47], a[140:143]
    s_waitcnt lgkmcnt(2)
    s_waitcnt vmcnt(20)
    buffer_load_dwordx3 v[252:254], v12, s[68:71], s16 offen offset:2304 nt
    v_add_f32 v5, v5, v16
    v_add_f32 v5, v5, v17
    v_exp_f32 v19, v115
    v_cvt_pk_bf16_f32 v178, v16, v17
    v_exp_f32 v16, v180
    v_add_f32 v5, v5, v18
    v_add_f32 v5, v5, v19
    v_exp_f32 v17, v181
    v_cvt_pk_bf16_f32 v179, v18, v19
    v_exp_f32 v18, v182
    v_add_f32 v6, v6, v16
    v_add_f32 v6, v6, v17
    v_exp_f32 v19, v183
    v_cvt_pk_bf16_f32 v180, v16, v17
    v_exp_f32 v16, v116
    v_add_f32 v6, v6, v18
    v_add_f32 v6, v6, v19
    v_exp_f32 v17, v117
    v_cvt_pk_bf16_f32 v181, v18, v19
    v_exp_f32 v18, v118
    v_add_f32 v6, v6, v16
    v_add_f32 v6, v6, v17
    v_exp_f32 v19, v119
    v_cvt_pk_bf16_f32 v182, v16, v17
    v_add_f32 v6, v6, v18
    v_add_f32 v6, v6, v19
    v_cvt_pk_bf16_f32 v183, v18, v19
    v_mfma_f32_16x16x32_bf16 v[64:67], v[24:27], a[192:195], v[128:131]
    s_waitcnt vmcnt(10)
    ds_read_b128 v[40:43], v2 offset:128
    v_lshlrev_b32 v48, 16, v56
    v_mfma_f32_16x16x32_bf16 v[64:67], v[28:31], a[196:199], v[64:67]
    v_exp_f32 v16, v184
    v_mfma_f32_16x16x32_bf16 v[68:71], v[24:27], a[216:219], v[132:135]
    v_exp_f32 v17, v185
    v_mfma_f32_16x16x32_bf16 v[68:71], v[28:31], a[220:223], v[68:71]
    v_exp_f32 v18, v186
    v_mfma_f32_16x16x32_bf16 v[72:75], v[24:27], a[240:243], v[136:139]
    ds_read_b128 v[44:47], v3 offset:128
    v_and_b32 v49, s97, v56
    v_mfma_f32_16x16x32_bf16 v[72:75], v[28:31], a[244:247], v[72:75]
    v_add_f32 v7, v7, v16
    v_add_f32 v7, v7, v17
    v_mfma_f32_16x16x32_bf16 v[76:79], v[24:27], v[200:203], v[140:143]
    v_exp_f32 v19, v187
    v_mfma_f32_16x16x32_bf16 v[76:79], v[28:31], v[204:207], v[76:79]
    s_waitcnt lgkmcnt(2)
    v_lshlrev_b32 v50, 16, v58
    v_and_b32 v51, s97, v58
    v_mfma_f32_16x16x32_bf16 v[96:99], v[32:35], a[192:195], v[128:131]
    ds_read_b128 v[24:27], v2 offset:6272
    v_cvt_pk_bf16_f32 v184, v16, v17
    v_mfma_f32_16x16x32_bf16 v[96:99], v[36:39], a[196:199], v[96:99]
    v_exp_f32 v16, v120
    v_mfma_f32_16x16x32_bf16 v[100:103], v[32:35], a[216:219], v[132:135]
    v_mul_f32_e64 v50, -v50, v48
    v_add_f32 v7, v7, v18
    v_mfma_f32_16x16x32_bf16 v[100:103], v[36:39], a[220:223], v[100:103]
    v_add_f32 v7, v7, v19
    v_mul_f32_e64 v51, -v51, v49
    v_mfma_f32_16x16x32_bf16 v[104:107], v[32:35], a[240:243], v[136:139]
    ds_read_b128 v[28:31], v3 offset:6272
    v_cvt_f32_i32 v144, v144
    v_mfma_f32_16x16x32_bf16 v[104:107], v[36:39], a[244:247], v[104:107]
    s_waitcnt lgkmcnt(2)
    v_exp_f32 v17, v121
    v_mfma_f32_16x16x32_bf16 v[108:111], v[32:35], v[200:203], v[140:143]
    s_waitcnt vmcnt(6)
    v_cvt_pk_bf16_f32 v185, v18, v19
    v_cvt_f32_i32 v148, v148
    v_mfma_f32_16x16x32_bf16 v[108:111], v[36:39], v[204:207], v[108:111]
    s_barrier
    v_mfma_f32_16x16x32_bf16 v[64:67], v[40:43], a[200:203], v[64:67]
    ds_read_b128 v[32:35], v2 offset:256
    v_add_u32 v0, 1, v0
    v_mfma_f32_16x16x32_bf16 v[64:67], v[44:47], a[204:207], v[64:67]
    buffer_store_dword v0, v13, s[20:23], 0 offen offset:32 sc1
    v_mfma_f32_16x16x32_bf16 v[68:71], v[40:43], a[224:227], v[68:71]
    s_mov_b32 m0, s26
    v_exp_f32 v18, v122
    v_mfma_f32_16x16x32_bf16 v[68:71], v[44:47], a[228:231], v[68:71]
    v_add_f32 v7, v7, v16
    v_add_f32 v7, v7, v17
    v_mfma_f32_16x16x32_bf16 v[72:75], v[40:43], a[248:251], v[72:75]
    ds_read_b128 v[36:39], v3 offset:256
    v_fma_f32 v144, v144, v48, v50
    v_mfma_f32_16x16x32_bf16 v[72:75], v[44:47], a[252:255], v[72:75]
    buffer_load_dwordx4 v4, s[4:7], s32 offen offset:0 sc1 lds
    v_mfma_f32_16x16x32_bf16 v[76:79], v[40:43], v[208:211], v[76:79]
    v_exp_f32 v19, v123
    v_mfma_f32_16x16x32_bf16 v[76:79], v[44:47], v[212:215], v[76:79]
    s_waitcnt lgkmcnt(2)
    v_cvt_pk_bf16_f32 v186, v16, v17
    v_fma_f32 v148, v148, v49, v51
    v_mfma_f32_16x16x32_bf16 v[96:99], v[24:27], a[200:203], v[96:99]
    ds_read_b128 v[40:43], v2 offset:6400
    v_cvt_f32_i32 v145, v145
    v_mfma_f32_16x16x32_bf16 v[96:99], v[28:31], a[204:207], v[96:99]
    buffer_load_dwordx4 v4, s[4:7], s32 offen offset:1024 sc1 lds
    v_mfma_f32_16x16x32_bf16 v[100:103], v[24:27], a[224:227], v[100:103]
    v_exp_f32 v16, v188
    v_mfma_f32_16x16x32_bf16 v[100:103], v[28:31], a[228:231], v[100:103]
    v_add_f32 v7, v7, v18
    v_add_f32 v7, v7, v19
    v_mfma_f32_16x16x32_bf16 v[104:107], v[24:27], a[248:251], v[104:107]
    ds_read_b128 v[44:47], v3 offset:6400
    v_cvt_f32_i32 v149, v149
    v_mfma_f32_16x16x32_bf16 v[104:107], v[28:31], a[252:255], v[104:107]
    buffer_load_dwordx4 v4, s[4:7], s32 offen offset:2048 sc1 lds
    v_mfma_f32_16x16x32_bf16 v[108:111], v[24:27], v[208:211], v[108:111]
    s_add_u32 s32, s32, 24576
    v_exp_f32 v17, v189
    v_mfma_f32_16x16x32_bf16 v[108:111], v[28:31], v[212:215], v[108:111]
    s_waitcnt lgkmcnt(2)
    v_cvt_pk_bf16_f32 v187, v18, v19
    v_fma_f32 v145, v145, v48, v50
    v_mfma_f32_16x16x32_bf16 v[64:67], v[32:35], a[208:211], v[64:67]
    s_sub_u32 s57, s32, 196608
    ds_read_b128 v[24:27], v2 offset:12288
    v_fma_f32 v149, v149, v49, v51
    v_mfma_f32_16x16x32_bf16 v[64:67], v[36:39], a[212:215], v[64:67]
    s_min_u32 s32, s32, s57
    v_exp_f32 v18, v190
    v_mfma_f32_16x16x32_bf16 v[68:71], v[32:35], a[232:235], v[68:71]
    s_add_u32 s26, s26, 12288
    v_add_f32 v8, v8, v16
    v_add_f32 v8, v8, v17
    v_mfma_f32_16x16x32_bf16 v[68:71], v[36:39], a[236:239], v[68:71]
    s_mov_b32 m0, s26
    v_exp_f32 v19, v191
    v_mfma_f32_16x16x32_bf16 v[72:75], v[32:35], v[192:195], v[72:75]
    ds_read_b128 v[28:31], v3 offset:12288
    v_cvt_pk_bf16_f32 v188, v16, v17
    v_mfma_f32_16x16x32_bf16 v[72:75], v[36:39], v[196:199], v[72:75]
    v_exp_f32 v16, v124
    v_mfma_f32_16x16x32_bf16 v[76:79], v[32:35], v[216:219], v[76:79]
    v_add_f32 v8, v8, v18
    v_add_f32 v8, v8, v19
    v_mfma_f32_16x16x32_bf16 v[76:79], v[36:39], v[220:223], v[76:79]
    s_waitcnt lgkmcnt(2)
    buffer_load_dwordx4 v4, s[4:7], s32 offen offset:0 sc1 lds
    v_mfma_f32_16x16x32_bf16 v[96:99], v[40:43], a[208:211], v[96:99]
    ds_read_b128 v[32:35], v2 offset:18432
    v_cvt_f32_i32 v146, v146
    v_mfma_f32_16x16x32_bf16 v[96:99], v[44:47], a[212:215], v[96:99]
    v_exp_f32 v17, v125
    v_mfma_f32_16x16x32_bf16 v[100:103], v[40:43], a[232:235], v[100:103]
    v_cvt_pk_bf16_f32 v189, v18, v19
    v_cvt_f32_i32 v150, v150
    v_mfma_f32_16x16x32_bf16 v[100:103], v[44:47], a[236:239], v[100:103]
    buffer_load_dwordx4 v4, s[4:7], s32 offen offset:1024 sc1 lds
    v_mfma_f32_16x16x32_bf16 v[104:107], v[40:43], v[192:195], v[104:107]
    ds_read_b128 v[36:39], v3 offset:18432
    v_fma_f32 v146, v146, v48, v50
    v_mfma_f32_16x16x32_bf16 v[104:107], v[44:47], v[196:199], v[104:107]
    v_exp_f32 v18, v126
    v_mfma_f32_16x16x32_bf16 v[108:111], v[40:43], v[216:219], v[108:111]
    v_add_f32 v8, v8, v16
    v_add_f32 v8, v8, v17
    v_mfma_f32_16x16x32_bf16 v[108:111], v[44:47], v[220:223], v[108:111]
    s_waitcnt lgkmcnt(2)
    buffer_load_dwordx4 v4, s[4:7], s32 offen offset:2048 sc1 lds
    v_mfma_f32_16x16x32_bf16 v[80:83], v[24:27], a[192:195], v[128:131]
    s_mov_b32 s32, 196608
    ds_read_b128 v[40:43], v2 offset:12416
    v_fma_f32 v150, v150, v49, v51
    v_mfma_f32_16x16x32_bf16 v[80:83], v[28:31], a[196:199], v[80:83]
    v_exp_f32 v19, v127
    v_cvt_pk_bf16_f32 v190, v16, v17
    v_mfma_f32_16x16x32_bf16 v[84:87], v[24:27], a[216:219], v[132:135]
    s_add_u32 s26, s26, 36864
    v_add_f32 v8, v8, v18
    v_add_f32 v8, v8, v19
    v_mfma_f32_16x16x32_bf16 v[84:87], v[28:31], a[220:223], v[84:87]
    s_sub_u32 s57, s26, 147456
    v_cvt_pk_bf16_f32 v191, v18, v19
    v_lshlrev_b32 v48, 16, v57
    v_mfma_f32_16x16x32_bf16 v[88:91], v[24:27], a[240:243], v[136:139]
    ds_read_b128 v[44:47], v3 offset:12416
    v_and_b32 v49, s97, v57
    v_mfma_f32_16x16x32_bf16 v[88:91], v[28:31], a[244:247], v[88:91]
    s_min_u32 s26, s26, s57
    v_exp_f32 v16, v64
    v_mfma_f32_16x16x32_bf16 v[92:95], v[24:27], v[200:203], v[140:143]
    v_exp_f32 v17, v65
    v_mfma_f32_16x16x32_bf16 v[92:95], v[28:31], v[204:207], v[92:95]
    s_waitcnt lgkmcnt(2)
    v_exp_f32 v18, v66
    v_mfma_f32_16x16x32_bf16 v[112:115], v[32:35], a[192:195], v[128:131]
    s_mov_b32 m0, s56
    ds_read_b128 v[24:27], v2 offset:18560
    v_lshlrev_b32 v50, 16, v59
    v_mfma_f32_16x16x32_bf16 v[112:115], v[36:39], a[196:199], v[112:115]
    v_add_f32 v5, v5, v16
    v_add_f32 v5, v5, v17
    v_mfma_f32_16x16x32_bf16 v[116:119], v[32:35], a[216:219], v[132:135]
    v_exp_f32 v19, v67
    v_mfma_f32_16x16x32_bf16 v[116:119], v[36:39], a[220:223], v[116:119]
    buffer_load_dwordx4 v4, s[4:7], s27 offen offset:0 sc1 lds
    v_mfma_f32_16x16x32_bf16 v[120:123], v[32:35], a[240:243], v[136:139]
    ds_read_b128 v[28:31], v3 offset:18560
    v_and_b32 v51, s97, v59
    v_mfma_f32_16x16x32_bf16 v[120:123], v[36:39], a[244:247], v[120:123]
    v_cvt_pk_bf16_f32 v64, v16, v17
    v_mul_f32_e64 v50, -v50, v48
    v_mfma_f32_16x16x32_bf16 v[124:127], v[32:35], v[200:203], v[140:143]
    v_exp_f32 v16, v96
    v_mfma_f32_16x16x32_bf16 v[124:127], v[36:39], v[204:207], v[124:127]
    s_waitcnt lgkmcnt(2)
    buffer_load_dwordx4 v4, s[4:7], s27 offen offset:1024 sc1 lds
    v_mfma_f32_16x16x32_bf16 v[80:83], v[40:43], a[200:203], v[80:83]
    ds_read_b128 v[32:35], v2 offset:12544
    v_add_f32 v5, v5, v18
    v_mfma_f32_16x16x32_bf16 v[80:83], v[44:47], a[204:207], v[80:83]
    v_add_f32 v5, v5, v19
    v_mul_f32_e64 v51, -v51, v49
    v_mfma_f32_16x16x32_bf16 v[84:87], v[40:43], a[224:227], v[84:87]
    v_exp_f32 v17, v97
    v_mfma_f32_16x16x32_bf16 v[84:87], v[44:47], a[228:231], v[84:87]
    s_waitcnt vmcnt(13)
    buffer_load_dwordx4 v4, s[4:7], s27 offen offset:2048 sc1 lds
    v_cvt_pk_bf16_f32 v65, v18, v19
    v_mfma_f32_16x16x32_bf16 v[88:91], v[40:43], a[248:251], v[88:91]
    s_add_u32 s27, s27, 24576
    ds_read_b128 v[36:39], v3 offset:12544
    v_cvt_f32_i32 v152, v152
    v_mfma_f32_16x16x32_bf16 v[88:91], v[44:47], a[252:255], v[88:91]
    v_exp_f32 v18, v98
    v_mfma_f32_16x16x32_bf16 v[92:95], v[40:43], v[208:211], v[92:95]
    s_sub_u32 s58, s27, 196608
    v_add_f32 v5, v5, v16
    v_add_f32 v5, v5, v17
    v_mfma_f32_16x16x32_bf16 v[92:95], v[44:47], v[212:215], v[92:95]
    s_waitcnt lgkmcnt(2)
    v_cvt_f32_i32 v156, v156
    v_fma_f32 v152, v152, v48, v50
    v_mfma_f32_16x16x32_bf16 v[112:115], v[24:27], a[200:203], v[112:115]
L_iw2:
L_pg2:
    s_cbranch_execz L_pg6
    s_min_u32 s27, s27, s58
    ds_read_b128 v[40:43], v2 offset:18688
    v_fma_f32 v156, v156, v49, v51
    v_mfma_f32_16x16x32_bf16 v[112:115], v[28:31], a[204:207], v[112:115]
    v_exp_f32 v19, v99
    v_cvt_pk_bf16_f32 v66, v16, v17
    v_mfma_f32_16x16x32_bf16 v[116:119], v[24:27], a[224:227], v[116:119]
    s_add_u32 s56, s56, 12288
    v_exp_f32 v16, v68
    v_mfma_f32_16x16x32_bf16 v[116:119], v[28:31], a[228:231], v[116:119]
    s_mov_b32 m0, s56
    v_add_f32 v5, v5, v18
    v_cvt_f32_i32 v153, v153
    v_mfma_f32_16x16x32_bf16 v[120:123], v[24:27], a[248:251], v[120:123]
    ds_read_b128 v[44:47], v3 offset:18688
    v_add_f32 v5, v5, v19
    v_mfma_f32_16x16x32_bf16 v[120:123], v[28:31], a[252:255], v[120:123]
    s_waitcnt lgkmcnt(2)
    v_exp_f32 v17, v69
    v_mfma_f32_16x16x32_bf16 v[124:127], v[24:27], v[208:211], v[124:127]
    s_waitcnt vmcnt(26)
    v_cvt_f32_i32 v157, v157
    v_cvt_pk_bf16_f32 v67, v18, v19
    v_mfma_f32_16x16x32_bf16 v[124:127], v[28:31], v[212:215], v[124:127]
    s_barrier
    v_add_u32 v1, 49152, v1
    v_mfma_f32_16x16x32_bf16 v[80:83], v[32:35], a[208:211], v[80:83]
    ds_read_b128 v[24:27], v1 offset:0
    v_fma_f32 v153, v153, v48, v50
    v_mfma_f32_16x16x32_bf16 v[80:83], v[36:39], a[212:215], v[80:83]
    s_waitcnt vmcnt(12)
    buffer_load_dwordx4 v4, s[4:7], s27 offen offset:0 sc1 lds
    v_mfma_f32_16x16x32_bf16 v[84:87], v[32:35], a[232:235], v[84:87]
    v_exp_f32 v18, v70
    v_mfma_f32_16x16x32_bf16 v[84:87], v[36:39], a[236:239], v[84:87]
    v_add_f32 v6, v6, v16
    v_add_f32 v6, v6, v17
    v_mfma_f32_16x16x32_bf16 v[88:91], v[32:35], v[192:195], v[88:91]
    ds_read_b128 v[28:31], v1 offset:12288
    v_fma_f32 v157, v157, v49, v51
    v_mfma_f32_16x16x32_bf16 v[88:91], v[36:39], v[196:199], v[88:91]
    s_waitcnt vmcnt(12)
    buffer_load_dwordx4 v4, s[4:7], s27 offen offset:1024 sc1 lds
    v_mfma_f32_16x16x32_bf16 v[92:95], v[32:35], v[216:219], v[92:95]
    v_exp_f32 v19, v71
    v_mfma_f32_16x16x32_bf16 v[92:95], v[36:39], v[220:223], v[92:95]
    s_waitcnt lgkmcnt(2)
    v_cvt_pk_bf16_f32 v68, v16, v17
    v_exp_f32 v16, v100
    v_mfma_f32_16x16x32_bf16 v[112:115], v[40:43], a[208:211], v[112:115]
    ds_read_b128 v[32:35], v1 offset:1024
    v_cvt_f32_i32 v154, v154
    v_mfma_f32_16x16x32_bf16 v[112:115], v[44:47], a[212:215], v[112:115]
    s_waitcnt vmcnt(12)
    buffer_load_dwordx4 v4, s[4:7], s27 offen offset:2048 sc1 lds
    v_add_f32 v6, v6, v18
    v_mfma_f32_16x16x32_bf16 v[116:119], v[40:43], a[232:235], v[116:119]
    v_add_f32 v6, v6, v19
    v_cvt_f32_i32 v158, v158
    v_mfma_f32_16x16x32_bf16 v[116:119], v[44:47], a[236:239], v[116:119]
    v_exp_f32 v17, v101
    v_cvt_pk_bf16_f32 v69, v18, v19
    v_mfma_f32_16x16x32_bf16 v[120:123], v[40:43], v[192:195], v[120:123]
    s_add_u32 s27, s27, 24576
    ds_read_b128 v[36:39], v1 offset:13312
    v_fma_f32 v154, v154, v48, v50
    v_mfma_f32_16x16x32_bf16 v[120:123], v[44:47], v[196:199], v[120:123]
    v_exp_f32 v18, v102
    v_fma_f32 v158, v158, v49, v51
    v_mfma_f32_16x16x32_bf16 v[124:127], v[40:43], v[216:219], v[124:127]
    s_sub_u32 s58, s27, 196608
    v_add_f32 v6, v6, v16
    v_add_f32 v6, v6, v17
    v_mfma_f32_16x16x32_bf16 v[124:127], v[44:47], v[220:223], v[124:127]
    s_waitcnt lgkmcnt(2)
    v_exp_f32 v19, v103
    v_cvt_pk_bf16_f32 v144, v144, v148
    v_cvt_pk_bf16_f32 v148, v145, v149
    v_cvt_pk_bf16_f32 v70, v16, v17
    s_min_u32 s27, s27, s58
    v_cvt_pk_bf16_f32 v145, v152, v156
    v_add_f32 v6, v6, v18
    s_add_u32 s56, s56, 36864
    v_cvt_pk_bf16_f32 v149, v153, v157
    v_add_f32 v6, v6, v19
    s_sub_u32 s58, s56, 147456
    v_cvt_pk_bf16_f32 v152, v146, v150
    v_cvt_pk_bf16_f32 v71, v18, v19
    s_min_u32 s56, s56, s58
    v_cvt_pk_bf16_f32 v153, v154, v158
    s_mov_b32 s31, 6
    v_mfma_f32_16x16x32_bf16 a[0:3], v[160:163], v[24:27], a[0:3]
    s_add_u32 s33, s33, 196608
    ds_read_b128 v[40:43], v1 offset:2048
    v_mfma_f32_16x16x32_bf16 a[0:3], v[176:179], v[28:31], a[0:3]
    s_add_u32 s34, s34, 196608
    v_exp_f32 v16, v72
    v_mfma_f32_16x16x32_bf16 a[48:51], v[164:167], v[24:27], a[48:51]
    s_add_u32 s36, s36, 1536
    v_exp_f32 v17, v73
    v_mfma_f32_16x16x32_bf16 a[48:51], v[180:183], v[28:31], a[48:51]
    v_exp_f32 v18, v74
    v_mfma_f32_16x16x32_bf16 a[96:99], v[168:171], v[24:27], a[96:99]
    ds_read_b128 v[44:47], v1 offset:14336
    v_add_f32 v7, v7, v16
    v_mfma_f32_16x16x32_bf16 a[96:99], v[184:187], v[28:31], a[96:99]
    s_waitcnt vmcnt(11)
    buffer_load_dwordx2 v[56:57], v10, s[72:75], s36 offen offset:0
    v_mfma_f32_16x16x32_bf16 a[144:147], v[172:175], v[24:27], a[144:147]
    v_add_f32 v7, v7, v17
    v_mfma_f32_16x16x32_bf16 a[144:147], v[188:191], v[28:31], a[144:147]
    s_waitcnt lgkmcnt(2)
    v_exp_f32 v19, v75
    v_mfma_f32_16x16x32_bf16 a[4:7], v[160:163], v[32:35], a[4:7]
    ds_read_b128 v[24:27], v1 offset:3072
    v_cvt_pk_bf16_f32 v72, v16, v17
    v_mfma_f32_16x16x32_bf16 a[4:7], v[176:179], v[36:39], a[4:7]
    buffer_load_dwordx2 v[58:59], v10, s[76:79], s36 offen offset:0
    v_mfma_f32_16x16x32_bf16 a[52:55], v[164:167], v[32:35], a[52:55]
    v_exp_f32 v16, v104
    v_mfma_f32_16x16x32_bf16 a[52:55], v[180:183], v[36:39], a[52:55]
    v_add_f32 v7, v7, v18
    v_add_f32 v7, v7, v19
    v_mfma_f32_16x16x32_bf16 a[100:103], v[168:171], v[32:35], a[100:103]
    ds_read_b128 v[28:31], v1 offset:15360
    v_mfma_f32_16x16x32_bf16 a[100:103], v[184:187], v[36:39], a[100:103]
    s_waitcnt vmcnt(12)
    buffer_load_dwordx4 v[224:227], v9, s[64:67], s33 offen offset:0 nt
    v_mfma_f32_16x16x32_bf16 a[148:151], v[172:175], v[32:35], a[148:151]
    v_exp_f32 v17, v105
    v_mfma_f32_16x16x32_bf16 a[148:151], v[188:191], v[36:39], a[148:151]
    s_waitcnt lgkmcnt(2)
    v_cvt_pk_bf16_f32 v73, v18, v19
    v_mfma_f32_16x16x32_bf16 a[8:11], v[160:163], v[40:43], a[8:11]
    ds_read_b128 v[32:35], v1 offset:4096
    v_mfma_f32_16x16x32_bf16 a[8:11], v[176:179], v[44:47], a[8:11]
    s_waitcnt vmcnt(12)
    buffer_load_dwordx4 v[228:231], v9, s[64:67], s33 offen offset:1536 nt
    v_mfma_f32_16x16x32_bf16 a[56:59], v[164:167], v[40:43], a[56:59]
    v_exp_f32 v18, v106
    v_mfma_f32_16x16x32_bf16 a[56:59], v[180:183], v[44:47], a[56:59]
    v_add_f32 v7, v7, v16
    v_add_f32 v7, v7, v17
    v_mfma_f32_16x16x32_bf16 a[104:107], v[168:171], v[40:43], a[104:107]
    s_waitcnt vmcnt(17)
    ds_read_b128 v[36:39], v1 offset:16384
    v_lshlrev_b32 v48, 16, v60
    v_mfma_f32_16x16x32_bf16 a[104:107], v[184:187], v[44:47], a[104:107]
    buffer_load_dwordx4 v[232:235], v9, s[64:67], s34 offen offset:0 nt
    v_mfma_f32_16x16x32_bf16 a[152:155], v[172:175], v[40:43], a[152:155]
    v_exp_f32 v19, v107
    v_mfma_f32_16x16x32_bf16 a[152:155], v[188:191], v[44:47], a[152:155]
    s_waitcnt lgkmcnt(2)
    v_cvt_pk_bf16_f32 v74, v16, v17
    v_and_b32 v49, s97, v60
    v_mfma_f32_16x16x32_bf16 a[12:15], v[160:163], v[24:27], a[12:15]
    ds_read_b128 v[40:43], v1 offset:5120
    v_lshlrev_b32 v50, 16, v62
    v_mfma_f32_16x16x32_bf16 a[12:15], v[176:179], v[28:31], a[12:15]
    s_waitcnt vmcnt(13)
    buffer_load_dwordx4 v[236:239], v9, s[64:67], s34 offen offset:1536 nt
    v_mfma_f32_16x16x32_bf16 a[60:63], v[164:167], v[24:27], a[60:63]
    v_exp_f32 v16, v76
    v_mfma_f32_16x16x32_bf16 a[60:63], v[180:183], v[28:31], a[60:63]
    v_add_f32 v7, v7, v18
    v_add_f32 v7, v7, v19
    v_mfma_f32_16x16x32_bf16 a[108:111], v[168:171], v[24:27], a[108:111]
    ds_read_b128 v[44:47], v1 offset:17408
    v_and_b32 v51, s97, v62
    v_mfma_f32_16x16x32_bf16 a[108:111], v[184:187], v[28:31], a[108:111]
    v_exp_f32 v17, v77
    v_mfma_f32_16x16x32_bf16 a[156:159], v[172:175], v[24:27], a[156:159]
    s_add_u32 s29, s28, 49152
    v_cvt_pk_bf16_f32 v75, v18, v19
    v_mul_f32_e64 v50, -v50, v48
    v_mfma_f32_16x16x32_bf16 a[156:159], v[188:191], v[28:31], a[156:159]
    s_waitcnt lgkmcnt(2)
    v_exp_f32 v18, v78
    v_mfma_f32_16x16x32_bf16 a[16:19], v[160:163], v[32:35], a[16:19]
    s_mov_b32 m0, s56
    ds_read_b128 v[24:27], v1 offset:6144
    v_add_f32 v8, v8, v16
    v_mfma_f32_16x16x32_bf16 a[16:19], v[176:179], v[36:39], a[16:19]
    s_sub_u32 s3, s29, 147456
    s_waitcnt vmcnt(13)
    buffer_load_dwordx4 v4, s[4:7], s27 offen offset:0 sc1 lds
    v_mfma_f32_16x16x32_bf16 a[64:67], v[164:167], v[32:35], a[64:67]
    s_min_u32 s29, s29, s3
    v_add_f32 v8, v8, v17
    v_mul_f32_e64 v51, -v51, v49
    v_mfma_f32_16x16x32_bf16 a[64:67], v[180:183], v[36:39], a[64:67]
    v_exp_f32 v19, v79
    v_mfma_f32_16x16x32_bf16 a[112:115], v[168:171], v[32:35], a[112:115]
    ds_read_b128 v[28:31], v1 offset:18432
    v_cvt_pk_bf16_f32 v76, v16, v17
    v_mfma_f32_16x16x32_bf16 a[112:115], v[184:187], v[36:39], a[112:115]
    s_waitcnt vmcnt(13)
    buffer_load_dwordx4 v4, s[4:7], s27 offen offset:1024 sc1 lds
    v_mfma_f32_16x16x32_bf16 a[160:163], v[172:175], v[32:35], a[160:163]
    s_sub_u32 s3, s29, s28
    v_exp_f32 v16, v108
    v_mfma_f32_16x16x32_bf16 a[160:163], v[188:191], v[36:39], a[160:163]
    s_waitcnt lgkmcnt(2)
    v_add_f32 v8, v8, v18
    v_add_f32 v8, v8, v19
    v_mfma_f32_16x16x32_bf16 a[20:23], v[160:163], v[40:43], a[20:23]
    ds_read_b128 v[32:35], v1 offset:7168
    v_cvt_f32_i32 v240, v240
    v_mfma_f32_16x16x32_bf16 a[20:23], v[176:179], v[44:47], a[20:23]
    s_waitcnt vmcnt(13)
    buffer_load_dwordx4 v4, s[4:7], s27 offen offset:2048 sc1 lds
    v_mfma_f32_16x16x32_bf16 a[68:71], v[164:167], v[40:43], a[68:71]
    v_exp_f32 v17, v109
    v_mfma_f32_16x16x32_bf16 a[68:71], v[180:183], v[44:47], a[68:71]
    v_cvt_pk_bf16_f32 v77, v18, v19
    v_cvt_f32_i32 v244, v244
    v_mfma_f32_16x16x32_bf16 a[116:119], v[168:171], v[40:43], a[116:119]
    s_mov_b32 s28, s29
    ds_read_b128 v[36:39], v1 offset:19456
    v_bfe_u32 v53, v4, 4, 6
    v_mfma_f32_16x16x32_bf16 a[116:119], v[184:187], v[44:47], a[116:119]
    v_exp_f32 v18, v110
    v_add_f32 v8, v8, v16
    v_mfma_f32_16x16x32_bf16 a[164:167], v[172:175], v[40:43], a[164:167]
    s_add_u32 s27, s27, 24576
    v_lshlrev_b32 v53, 2, v53
    v_fma_f32 v240, v240, v48, v50
    v_mfma_f32_16x16x32_bf16 a[164:167], v[188:191], v[44:47], a[164:167]
    s_waitcnt lgkmcnt(2)
    buffer_load_dword v52, v53, s[20:23], s44 offen sc1
    v_add_f32 v8, v8, v17
    v_mfma_f32_16x16x32_bf16 a[24:27], v[160:163], v[24:27], a[24:27]
    s_sub_u32 s58, s27, 196608
    ds_read_b128 v[40:43], v1 offset:8192
    v_fma_f32 v244, v244, v49, v51
    v_mfma_f32_16x16x32_bf16 a[24:27], v[176:179], v[28:31], a[24:27]
    v_exp_f32 v19, v111
    v_cvt_pk_bf16_f32 v78, v16, v17
    v_mfma_f32_16x16x32_bf16 a[72:75], v[164:167], v[24:27], a[72:75]
    s_min_u32 s27, s27, s58
    v_add_f32 v8, v8, v18
    v_cvt_f32_i32 v241, v241
    v_mfma_f32_16x16x32_bf16 a[72:75], v[180:183], v[28:31], a[72:75]
    v_add_f32 v8, v8, v19
    v_cvt_f32_i32 v245, v245
    v_cvt_pk_bf16_f32 v79, v18, v19
    v_mfma_f32_16x16x32_bf16 a[120:123], v[168:171], v[24:27], a[120:123]
    s_add_u32 s56, s56, 12288
    ds_read_b128 v[44:47], v1 offset:20480
    v_fma_f32 v241, v241, v48, v50
    v_mfma_f32_16x16x32_bf16 a[120:123], v[184:187], v[28:31], a[120:123]
    v_exp_f32 v16, v80
    v_mfma_f32_16x16x32_bf16 a[168:171], v[172:175], v[24:27], a[168:171]
    s_mov_b32 m0, s56
    v_exp_f32 v17, v81
    v_mfma_f32_16x16x32_bf16 a[168:171], v[188:191], v[28:31], a[168:171]
    s_waitcnt lgkmcnt(2)
    v_fma_f32 v245, v245, v49, v51
    v_exp_f32 v18, v82
    v_mfma_f32_16x16x32_bf16 a[28:31], v[160:163], v[32:35], a[28:31]
    ds_read_b128 v[24:27], v1 offset:9216
    v_cvt_f32_i32 v242, v242
    v_mfma_f32_16x16x32_bf16 a[28:31], v[176:179], v[36:39], a[28:31]
    v_add_f32 v5, v5, v16
    v_cvt_f32_i32 v246, v246
    v_mfma_f32_16x16x32_bf16 a[76:79], v[164:167], v[32:35], a[76:79]
    v_add_f32 v5, v5, v17
    v_fma_f32 v242, v242, v48, v50
    v_mfma_f32_16x16x32_bf16 a[76:79], v[180:183], v[36:39], a[76:79]
    s_waitcnt vmcnt(14)
    buffer_load_dwordx4 v4, s[4:7], s27 offen offset:0 sc1 lds
    v_mfma_f32_16x16x32_bf16 a[124:127], v[168:171], v[32:35], a[124:127]
    ds_read_b128 v[28:31], v1 offset:21504
    v_fma_f32 v246, v246, v49, v51
    v_mfma_f32_16x16x32_bf16 a[124:127], v[184:187], v[36:39], a[124:127]
    v_exp_f32 v19, v83
    v_cvt_pk_bf16_f32 v80, v16, v17
    v_mfma_f32_16x16x32_bf16 a[172:175], v[172:175], v[32:35], a[172:175]
    v_exp_f32 v16, v112
    v_mfma_f32_16x16x32_bf16 a[172:175], v[188:191], v[36:39], a[172:175]
    s_waitcnt lgkmcnt(2)
    s_waitcnt vmcnt(14)
    buffer_load_dwordx4 v4, s[4:7], s27 offen offset:1024 sc1 lds
    v_add_f32 v5, v5, v18
    v_mfma_f32_16x16x32_bf16 a[32:35], v[160:163], v[40:43], a[32:35]
    ds_read_b128 v[32:35], v1 offset:10240
    v_lshlrev_b32 v48, 16, v61
    v_mfma_f32_16x16x32_bf16 a[32:35], v[176:179], v[44:47], a[32:35]
    v_add_f32 v5, v5, v19
    v_exp_f32 v17, v113
    v_mfma_f32_16x16x32_bf16 a[80:83], v[164:167], v[40:43], a[80:83]
    v_and_b32 v49, s97, v61
    v_cvt_pk_bf16_f32 v81, v18, v19
    v_mfma_f32_16x16x32_bf16 a[80:83], v[180:183], v[44:47], a[80:83]
    s_waitcnt vmcnt(14)
    buffer_load_dwordx4 v4, s[4:7], s27 offen offset:2048 sc1 lds
    v_lshlrev_b32 v50, 16, v63
    v_mfma_f32_16x16x32_bf16 a[128:131], v[168:171], v[40:43], a[128:131]
    ds_read_b128 v[36:39], v1 offset:22528
    v_and_b32 v51, s97, v63
    v_mfma_f32_16x16x32_bf16 a[128:131], v[184:187], v[44:47], a[128:131]
    v_exp_f32 v18, v114
    v_add_f32 v5, v5, v16
    v_mfma_f32_16x16x32_bf16 a[176:179], v[172:175], v[40:43], a[176:179]
    v_add_u32 v2, s3, v2
    v_add_u32 v3, s3, v3
    v_mfma_f32_16x16x32_bf16 a[176:179], v[188:191], v[44:47], a[176:179]
    s_waitcnt lgkmcnt(2)
    v_add_f32 v5, v5, v17
    v_exp_f32 v19, v115
    v_mfma_f32_16x16x32_bf16 a[36:39], v[160:163], v[24:27], a[36:39]
    ds_read_b128 v[40:43], v1 offset:11264
    v_mul_f32_e64 v50, -v50, v48
    v_mfma_f32_16x16x32_bf16 a[36:39], v[176:179], v[28:31], a[36:39]
    v_cvt_pk_bf16_f32 v82, v16, v17
    v_mul_f32_e64 v51, -v51, v49
    v_mfma_f32_16x16x32_bf16 a[84:87], v[164:167], v[24:27], a[84:87]
    v_exp_f32 v16, v84
    v_mfma_f32_16x16x32_bf16 a[84:87], v[180:183], v[28:31], a[84:87]
    v_cvt_f32_i32 v248, v248
    v_add_f32 v5, v5, v18
    v_cvt_f32_i32 v252, v252
    v_mfma_f32_16x16x32_bf16 a[132:135], v[168:171], v[24:27], a[132:135]
    s_mov_b32 s27, 208896
    ds_read_b128 v[44:47], v1 offset:23552
    v_add_f32 v5, v5, v19
    v_mfma_f32_16x16x32_bf16 a[132:135], v[184:187], v[28:31], a[132:135]
    s_waitcnt lgkmcnt(2)
    v_exp_f32 v17, v85
    v_fma_f32 v248, v248, v48, v50
    v_mfma_f32_16x16x32_bf16 a[180:183], v[172:175], v[24:27], a[180:183]
    s_waitcnt vmcnt(19)
    v_cvt_pk_bf16_f32 v83, v18, v19
    v_fma_f32 v252, v252, v49, v51
    v_mfma_f32_16x16x32_bf16 a[180:183], v[188:191], v[28:31], a[180:183]
    s_barrier
    v_exp_f32 v18, v86
    v_mfma_f32_16x16x32_bf16 a[40:43], v[160:163], v[32:35], a[40:43]
    s_add_u32 s56, s56, 36864
    ds_read_b128 v[24:27], v2 offset:0
    v_cvt_f32_i32 v249, v249
    v_mfma_f32_16x16x32_bf16 a[40:43], v[176:179], v[36:39], a[40:43]
    s_sub_u32 s58, s56, 147456
    v_add_f32 v6, v6, v16
    v_add_f32 v6, v6, v17
    v_mfma_f32_16x16x32_bf16 a[88:91], v[164:167], v[32:35], a[88:91]
    s_min_u32 s56, s56, s58
    v_cvt_f32_i32 v253, v253
    v_fma_f32 v249, v249, v48, v50
    v_mfma_f32_16x16x32_bf16 a[88:91], v[180:183], v[36:39], a[88:91]
    v_exp_f32 v19, v87
    v_mfma_f32_16x16x32_bf16 a[136:139], v[168:171], v[32:35], a[136:139]
    ds_read_b128 v[28:31], v3 offset:0
    v_cvt_pk_bf16_f32 v84, v16, v17
    v_mfma_f32_16x16x32_bf16 a[136:139], v[184:187], v[36:39], a[136:139]
    v_exp_f32 v16, v116
    v_mfma_f32_16x16x32_bf16 a[184:187], v[172:175], v[32:35], a[184:187]
    v_fma_f32 v253, v253, v49, v51
    v_add_f32 v6, v6, v18
    v_mfma_f32_16x16x32_bf16 a[184:187], v[188:191], v[36:39], a[184:187]
    s_waitcnt lgkmcnt(2)
    v_cvt_f32_i32 v250, v250
    v_add_f32 v6, v6, v19
    v_mfma_f32_16x16x32_bf16 a[44:47], v[160:163], v[40:43], a[44:47]
    ds_read_b128 v[32:35], v2 offset:6144
    v_cvt_f32_i32 v254, v254
    v_mfma_f32_16x16x32_bf16 a[44:47], v[176:179], v[44:47], a[44:47]
    v_exp_f32 v17, v117
    v_mfma_f32_16x16x32_bf16 a[92:95], v[164:167], v[40:43], a[92:95]
    v_cvt_pk_bf16_f32 v85, v18, v19
    v_fma_f32 v250, v250, v48, v50
    v_mfma_f32_16x16x32_bf16 a[92:95], v[180:183], v[44:47], a[92:95]
    v_exp_f32 v18, v118
    v_mfma_f32_16x16x32_bf16 a[140:143], v[168:171], v[40:43], a[140:143]
    s_nop 0
    ds_read_b128 v[36:39], v3 offset:6144
    v_fma_f32 v254, v254, v49, v51
    v_mfma_f32_16x16x32_bf16 a[140:143], v[184:187], v[44:47], a[140:143]
    v_add_f32 v6, v6, v16
    v_add_f32 v6, v6, v17
    v_mfma_f32_16x16x32_bf16 a[188:191], v[172:175], v[40:43], a[188:191]
    s_waitcnt lgkmcnt(2)
    v_exp_f32 v19, v119
    v_cvt_pk_bf16_f32 v146, v240, v244
    v_cvt_pk_bf16_f32 v150, v241, v245
    v_cvt_pk_bf16_f32 v86, v16, v17
    v_cvt_pk_bf16_f32 v147, v248, v252
    v_add_f32 v6, v6, v18
    v_cvt_pk_bf16_f32 v151, v249, v253
    v_add_f32 v6, v6, v19
    v_cvt_pk_bf16_f32 v154, v242, v246
    v_cvt_pk_bf16_f32 v87, v18, v19
    v_cvt_pk_bf16_f32 v155, v250, v254
    v_mfma_f32_16x16x32_bf16 a[188:191], v[188:191], v[44:47], a[188:191]
    s_branch L_join
.p2align 6
L_loop:
    v_mfma_f32_16x16x32_bf16 v[160:163], v[24:27], a[192:195], v[128:131]
    s_mov_b32 m0, s56
    ds_read_b128 v[40:43], v2 offset:128
    v_cvt_pk_bf16_f32 v227, v242, v243
    v_mfma_f32_16x16x32_bf16 v[160:163], v[28:31], a[196:199], v[160:163]
    buffer_load_dwordx4 v4, s[4:7], s27 offen offset:0 sc1 lds
    v_mfma_f32_16x16x32_bf16 v[164:167], v[24:27], a[216:219], v[132:135]
    v_exp_f32 v16, v88
    v_mfma_f32_16x16x32_bf16 v[164:167], v[28:31], a[220:223], v[164:167]
    v_exp_f32 v17, v89
    v_mfma_f32_16x16x32_bf16 v[168:171], v[24:27], a[240:243], v[136:139]
    ds_read_b128 v[44:47], v3 offset:128
    v_cvt_f32_i32 v246, v246
    v_mfma_f32_16x16x32_bf16 v[168:171], v[28:31], a[244:247], v[168:171]
    v_exp_f32 v18, v90
    v_mfma_f32_16x16x32_bf16 v[172:175], v[24:27], v[200:203], v[140:143]
    v_cvt_f32_i32 v247, v247
    v_add_f32 v7, v7, v16
    v_mfma_f32_16x16x32_bf16 v[172:175], v[28:31], v[204:207], v[172:175]
    s_waitcnt lgkmcnt(2)
    v_add_f32 v7, v7, v17
    v_fma_f32 v246, v246, v48, v50
    v_mfma_f32_16x16x32_bf16 v[96:99], v[32:35], a[192:195], v[128:131]
    ds_read_b128 v[24:27], v2 offset:6272
    v_fma_f32 v247, v247, v49, v51
    v_mfma_f32_16x16x32_bf16 v[96:99], v[36:39], a[196:199], v[96:99]
    buffer_load_dwordx4 v4, s[4:7], s27 offen offset:1024 sc1 lds
    v_mfma_f32_16x16x32_bf16 v[100:103], v[32:35], a[216:219], v[132:135]
    v_exp_f32 v19, v91
    v_mfma_f32_16x16x32_bf16 v[100:103], v[36:39], a[220:223], v[100:103]
    v_cvt_pk_bf16_f32 v88, v16, v17
    v_cvt_pk_bf16_f32 v231, v246, v247
    v_mfma_f32_16x16x32_bf16 v[104:107], v[32:35], a[240:243], v[136:139]
    ds_read_b128 v[28:31], v3 offset:6272
    v_cvt_f32_i32 v250, v250
    v_mfma_f32_16x16x32_bf16 v[104:107], v[36:39], a[244:247], v[104:107]
    v_exp_f32 v16, v120
    v_mfma_f32_16x16x32_bf16 v[108:111], v[32:35], v[200:203], v[140:143]
    v_add_f32 v7, v7, v18
    v_add_f32 v7, v7, v19
    v_mfma_f32_16x16x32_bf16 v[108:111], v[36:39], v[204:207], v[108:111]
    s_waitcnt lgkmcnt(2)
    v_exp_f32 v17, v121
    v_mfma_f32_16x16x32_bf16 v[160:163], v[40:43], a[200:203], v[160:163]
    ds_read_b128 v[32:35], v2 offset:256
    v_cvt_f32_i32 v251, v251
    v_mfma_f32_16x16x32_bf16 v[160:163], v[44:47], a[204:207], v[160:163]
    v_cvt_pk_bf16_f32 v89, v18, v19
    v_fma_f32 v250, v250, v48, v50
    v_mfma_f32_16x16x32_bf16 v[164:167], v[40:43], a[224:227], v[164:167]
    v_exp_f32 v18, v122
    v_mfma_f32_16x16x32_bf16 v[164:167], v[44:47], a[228:231], v[164:167]
    buffer_load_dwordx4 v4, s[4:7], s27 offen offset:2048 sc1 lds
    v_mfma_f32_16x16x32_bf16 v[168:171], v[40:43], a[248:251], v[168:171]
    ds_read_b128 v[36:39], v3 offset:256
    v_fma_f32 v251, v251, v49, v51
    v_mfma_f32_16x16x32_bf16 v[168:171], v[44:47], a[252:255], v[168:171]
    v_add_f32 v7, v7, v16
    v_add_f32 v7, v7, v17
    v_mfma_f32_16x16x32_bf16 v[172:175], v[40:43], v[208:211], v[172:175]
    v_cvt_pk_bf16_f32 v235, v250, v251
    v_cvt_f32_i32 v254, v254
    v_mfma_f32_16x16x32_bf16 v[172:175], v[44:47], v[212:215], v[172:175]
    s_waitcnt lgkmcnt(2)
    v_exp_f32 v19, v123
    v_mfma_f32_16x16x32_bf16 v[96:99], v[24:27], a[200:203], v[96:99]
    ds_read_b128 v[40:43], v2 offset:6400
    v_cvt_pk_bf16_f32 v90, v16, v17
    v_mfma_f32_16x16x32_bf16 v[96:99], v[28:31], a[204:207], v[96:99]
    s_add_u32 s27, s27, 24576
    v_exp_f32 v16, v92
    v_mfma_f32_16x16x32_bf16 v[100:103], v[24:27], a[224:227], v[100:103]
    v_cvt_f32_i32 v255, v255
    v_add_f32 v7, v7, v18
    v_mfma_f32_16x16x32_bf16 v[100:103], v[28:31], a[228:231], v[100:103]
    v_fma_f32 v254, v254, v48, v50
    v_add_f32 v7, v7, v19
    v_mfma_f32_16x16x32_bf16 v[104:107], v[24:27], a[248:251], v[104:107]
    ds_read_b128 v[44:47], v3 offset:6400
    v_fma_f32 v255, v255, v49, v51
    v_mfma_f32_16x16x32_bf16 v[104:107], v[28:31], a[252:255], v[104:107]
    v_exp_f32 v17, v93
    v_mfma_f32_16x16x32_bf16 v[108:111], v[24:27], v[208:211], v[108:111]
    s_add_u32 s29, s30, 49152
    v_cvt_pk_bf16_f32 v239, v254, v255
    v_cvt_pk_bf16_f32 v91, v18, v19
    v_mfma_f32_16x16x32_bf16 v[108:111], v[28:31], v[212:215], v[108:111]
    s_waitcnt lgkmcnt(2)
    v_exp_f32 v18, v94
    v_mfma_f32_16x16x32_bf16 v[160:163], v[32:35], a[208:211], v[160:163]
    s_waitcnt vmcnt(11)
    ds_read_b128 v[24:27], v2 offset:12288
    v_add_f32 v8, v8, v16
    v_mfma_f32_16x16x32_bf16 v[160:163], v[36:39], a[212:215], v[160:163]
    s_sub_u32 s3, s29, 147456
    buffer_load_dwordx2 v[60:61], off, s[80:83], s37 offset:8
    v_mfma_f32_16x16x32_bf16 v[164:167], v[32:35], a[232:235], v[164:167]
    s_add_u32 s56, s56, 12288
    v_add_f32 v8, v8, v17
    v_lshlrev_b32 v48, 16, v56
    v_mfma_f32_16x16x32_bf16 v[164:167], v[36:39], a[236:239], v[164:167]
    s_min_u32 s29, s29, s3
    v_exp_f32 v19, v95
    v_mfma_f32_16x16x32_bf16 v[168:171], v[32:35], v[192:195], v[168:171]
    s_mov_b32 m0, s56
    ds_read_b128 v[28:31], v3 offset:12288
    v_cvt_pk_bf16_f32 v92, v16, v17
    v_mfma_f32_16x16x32_bf16 v[168:171], v[36:39], v[196:199], v[168:171]
    buffer_load_dwordx2 v[62:63], off, s[84:87], s37 offset:8
    v_mfma_f32_16x16x32_bf16 v[172:175], v[32:35], v[216:219], v[172:175]
    v_exp_f32 v16, v124
    v_mfma_f32_16x16x32_bf16 v[172:175], v[36:39], v[220:223], v[172:175]
    s_waitcnt lgkmcnt(2)
    v_add_f32 v8, v8, v18
    v_add_f32 v8, v8, v19
    v_mfma_f32_16x16x32_bf16 v[96:99], v[40:43], a[208:211], v[96:99]
    ds_read_b128 v[32:35], v2 offset:18432
    v_and_b32 v49, s97, v56
    v_mfma_f32_16x16x32_bf16 v[96:99], v[44:47], a[212:215], v[96:99]
    s_sub_u32 s3, s29, s30
    v_exp_f32 v17, v125
    v_mfma_f32_16x16x32_bf16 v[100:103], v[40:43], a[232:235], v[100:103]
    v_cvt_pk_bf16_f32 v93, v18, v19
    v_lshlrev_b32 v50, 16, v58
    v_mfma_f32_16x16x32_bf16 v[100:103], v[44:47], a[236:239], v[100:103]
    buffer_load_dwordx4 v4, s[4:7], s27 offen offset:0 sc1 lds
    v_mfma_f32_16x16x32_bf16 v[104:107], v[40:43], v[192:195], v[104:107]
    ds_read_b128 v[36:39], v3 offset:18432
    v_mfma_f32_16x16x32_bf16 v[104:107], v[44:47], v[196:199], v[104:107]
    v_exp_f32 v18, v126
    v_mfma_f32_16x16x32_bf16 v[108:111], v[40:43], v[216:219], v[108:111]
    v_add_f32 v8, v8, v16
    v_add_f32 v8, v8, v17
    v_mfma_f32_16x16x32_bf16 v[108:111], v[44:47], v[220:223], v[108:111]
    s_waitcnt lgkmcnt(2)
    buffer_load_dwordx3 v[240:242], v12, s[68:71], s16 offen offset:0 nt
    v_mfma_f32_16x16x32_bf16 v[176:179], v[24:27], a[192:195], v[128:131]
    ds_read_b128 v[40:43], v2 offset:12416
    v_mfma_f32_16x16x32_bf16 v[176:179], v[28:31], a[196:199], v[176:179]
    v_exp_f32 v19, v127
    v_cvt_pk_bf16_f32 v94, v16, v17
    v_mfma_f32_16x16x32_bf16 v[180:183], v[24:27], a[216:219], v[132:135]
    s_mov_b32 s30, s29
    v_add_f32 v8, v8, v18
    v_add_f32 v8, v8, v19
    v_mfma_f32_16x16x32_bf16 v[180:183], v[28:31], a[220:223], v[180:183]
    buffer_load_dwordx4 v4, s[4:7], s27 offen offset:1024 sc1 lds
    v_mfma_f32_16x16x32_bf16 v[184:187], v[24:27], a[240:243], v[136:139]
    ds_read_b128 v[44:47], v3 offset:12416
    v_cvt_pk_bf16_f32 v95, v18, v19
    v_mfma_f32_16x16x32_bf16 v[184:187], v[28:31], a[244:247], v[184:187]
    v_exp_f32 v16, v160
    v_mfma_f32_16x16x32_bf16 v[188:191], v[24:27], v[200:203], v[140:143]
    v_exp_f32 v17, v161
    v_mfma_f32_16x16x32_bf16 v[188:191], v[28:31], v[204:207], v[188:191]
    s_waitcnt lgkmcnt(2)
    buffer_load_dwordx3 v[244:246], v12, s[68:71], s16 offen offset:768 nt
    v_mfma_f32_16x16x32_bf16 v[112:115], v[32:35], a[192:195], v[128:131]
    ds_read_b128 v[24:27], v2 offset:18560
    v_and_b32 v51, s97, v58
    v_mfma_f32_16x16x32_bf16 v[112:115], v[36:39], a[196:199], v[112:115]
    v_exp_f32 v18, v162
    v_mfma_f32_16x16x32_bf16 v[116:119], v[32:35], a[216:219], v[132:135]
    v_add_f32 v5, v5, v16
    v_add_f32 v5, v5, v17
    v_mfma_f32_16x16x32_bf16 v[116:119], v[36:39], a[220:223], v[116:119]
    v_exp_f32 v19, v163
    v_mfma_f32_16x16x32_bf16 v[120:123], v[32:35], a[240:243], v[136:139]
    ds_read_b128 v[28:31], v3 offset:18560
    v_cvt_pk_bf16_f32 v160, v16, v17
    v_mfma_f32_16x16x32_bf16 v[120:123], v[36:39], a[244:247], v[120:123]
    buffer_load_dwordx3 v[248:250], v12, s[68:71], s16 offen offset:1536 nt
    v_mfma_f32_16x16x32_bf16 v[124:127], v[32:35], v[200:203], v[140:143]
    v_exp_f32 v16, v96
    v_mfma_f32_16x16x32_bf16 v[124:127], v[36:39], v[204:207], v[124:127]
    s_waitcnt lgkmcnt(2)
    v_add_f32 v5, v5, v18
    v_add_f32 v5, v5, v19
    v_mfma_f32_16x16x32_bf16 v[176:179], v[40:43], a[200:203], v[176:179]
    ds_read_b128 v[32:35], v2 offset:12544
    v_mul_f32_e64 v50, -v50, v48
    v_mfma_f32_16x16x32_bf16 v[176:179], v[44:47], a[204:207], v[176:179]
    buffer_load_dwordx4 v4, s[4:7], s27 offen offset:2048 sc1 lds
    v_mfma_f32_16x16x32_bf16 v[180:183], v[40:43], a[224:227], v[180:183]
    v_exp_f32 v17, v97
    v_mfma_f32_16x16x32_bf16 v[180:183], v[44:47], a[228:231], v[180:183]
    v_cvt_pk_bf16_f32 v161, v18, v19
    v_add_u32 v1, s3, v1
    v_mfma_f32_16x16x32_bf16 v[184:187], v[40:43], a[248:251], v[184:187]
    ds_read_b128 v[36:39], v3 offset:12544
    v_mul_f32_e64 v51, -v51, v49
    v_mfma_f32_16x16x32_bf16 v[184:187], v[44:47], a[252:255], v[184:187]
    buffer_load_dwordx3 v[252:254], v12, s[68:71], s16 offen offset:2304 nt
    v_mfma_f32_16x16x32_bf16 v[188:191], v[40:43], v[208:211], v[188:191]
    v_exp_f32 v18, v98
    v_mfma_f32_16x16x32_bf16 v[188:191], v[44:47], v[212:215], v[188:191]
    s_waitcnt lgkmcnt(2)
    v_add_f32 v5, v5, v16
    v_add_f32 v5, v5, v17
    v_mfma_f32_16x16x32_bf16 v[112:115], v[24:27], a[200:203], v[112:115]
    ds_read_b128 v[40:43], v2 offset:18688
    v_cvt_f32_i32 v144, v144
    v_mfma_f32_16x16x32_bf16 v[112:115], v[28:31], a[204:207], v[112:115]
    v_exp_f32 v19, v99
    v_cvt_pk_bf16_f32 v162, v16, v17
    v_mfma_f32_16x16x32_bf16 v[116:119], v[24:27], a[224:227], v[116:119]
    v_exp_f32 v16, v164
    v_mfma_f32_16x16x32_bf16 v[116:119], v[28:31], a[228:231], v[116:119]
    s_add_u32 s27, s27, 24576
    v_add_f32 v5, v5, v18
    v_add_f32 v5, v5, v19
    v_mfma_f32_16x16x32_bf16 v[120:123], v[24:27], a[248:251], v[120:123]
    s_add_u32 s56, s56, 36864
    ds_read_b128 v[44:47], v3 offset:18688
    s_sub_u32 s58, s56, 147456
    v_mfma_f32_16x16x32_bf16 v[120:123], v[28:31], a[252:255], v[120:123]
    s_waitcnt lgkmcnt(2)
    v_exp_f32 v17, v165
    v_mfma_f32_16x16x32_bf16 v[124:127], v[24:27], v[208:211], v[124:127]
    s_waitcnt vmcnt(12)
    v_cvt_pk_bf16_f32 v163, v18, v19
    v_cvt_f32_i32 v148, v148
    v_mfma_f32_16x16x32_bf16 v[124:127], v[28:31], v[212:215], v[124:127]
    s_barrier
    s_min_u32 s56, s56, s58
    v_mfma_f32_16x16x32_bf16 v[176:179], v[32:35], a[208:211], v[176:179]
    ds_read_b128 v[24:27], v1 offset:0
    v_mfma_f32_16x16x32_bf16 v[176:179], v[36:39], a[212:215], v[176:179]
    v_exp_f32 v18, v166
    v_mfma_f32_16x16x32_bf16 v[180:183], v[32:35], a[232:235], v[180:183]
    v_add_f32 v6, v6, v16
    v_add_f32 v6, v6, v17
    v_mfma_f32_16x16x32_bf16 v[180:183], v[36:39], a[236:239], v[180:183]
    v_exp_f32 v19, v167
    v_mfma_f32_16x16x32_bf16 v[184:187], v[32:35], v[192:195], v[184:187]
L_iw3:
L_pg3:
    s_cbranch_execz L_pg7
    ds_read_b128 v[28:31], v1 offset:12288
    v_cvt_pk_bf16_f32 v164, v16, v17
    v_mfma_f32_16x16x32_bf16 v[184:187], v[36:39], v[196:199], v[184:187]
    v_exp_f32 v16, v100
    v_mfma_f32_16x16x32_bf16 v[188:191], v[32:35], v[216:219], v[188:191]
    v_add_f32 v6, v6, v18
    v_add_f32 v6, v6, v19
    v_mfma_f32_16x16x32_bf16 v[188:191], v[36:39], v[220:223], v[188:191]
    s_waitcnt lgkmcnt(2)
    v_exp_f32 v17, v101
    v_mfma_f32_16x16x32_bf16 v[112:115], v[40:43], a[208:211], v[112:115]
    ds_read_b128 v[32:35], v1 offset:1024
    v_cvt_pk_bf16_f32 v165, v18, v19
    v_mfma_f32_16x16x32_bf16 v[112:115], v[44:47], a[212:215], v[112:115]
    v_exp_f32 v18, v102
    v_mfma_f32_16x16x32_bf16 v[116:119], v[40:43], a[232:235], v[116:119]
    v_add_f32 v6, v6, v16
    v_add_f32 v6, v6, v17
    v_mfma_f32_16x16x32_bf16 v[116:119], v[44:47], a[236:239], v[116:119]
    v_exp_f32 v19, v103
    v_mfma_f32_16x16x32_bf16 v[120:123], v[40:43], v[192:195], v[120:123]
    ds_read_b128 v[36:39], v1 offset:13312
    v_cvt_pk_bf16_f32 v166, v16, v17
    v_mfma_f32_16x16x32_bf16 v[120:123], v[44:47], v[196:199], v[120:123]
    v_add_f32 v6, v6, v18
    v_add_f32 v6, v6, v19
    v_mfma_f32_16x16x32_bf16 v[124:127], v[40:43], v[216:219], v[124:127]
    v_cvt_pk_bf16_f32 v167, v18, v19
    v_mfma_f32_16x16x32_bf16 v[124:127], v[44:47], v[220:223], v[124:127]
    s_waitcnt lgkmcnt(2)
    v_mfma_f32_16x16x32_bf16 a[0:3], v[64:67], v[24:27], a[0:3]
    ds_read_b128 v[40:43], v1 offset:2048
    v_fma_f32 v144, v144, v48, v50
    v_mfma_f32_16x16x32_bf16 a[0:3], v[80:83], v[28:31], a[0:3]
    buffer_store_dwordx4 v[224:227], v11, s[4:7], s33 offen offset:0 sc1
    v_mfma_f32_16x16x32_bf16 a[48:51], v[68:71], v[24:27], a[48:51]
    v_exp_f32 v16, v168
    v_mfma_f32_16x16x32_bf16 a[48:51], v[84:87], v[28:31], a[48:51]
    v_exp_f32 v17, v169
    v_mfma_f32_16x16x32_bf16 a[96:99], v[72:75], v[24:27], a[96:99]
    ds_read_b128 v[44:47], v1 offset:14336
    v_xor_b32 v55, 16, v11
    v_mfma_f32_16x16x32_bf16 a[96:99], v[88:91], v[28:31], a[96:99]
    v_exp_f32 v18, v170
    v_mfma_f32_16x16x32_bf16 a[144:147], v[76:79], v[24:27], a[144:147]
    v_add_f32 v7, v7, v16
    v_add_f32 v7, v7, v17
    v_mfma_f32_16x16x32_bf16 a[144:147], v[92:95], v[28:31], a[144:147]
    s_waitcnt lgkmcnt(2)
    v_exp_f32 v19, v171
    v_mfma_f32_16x16x32_bf16 a[4:7], v[64:67], v[32:35], a[4:7]
    ds_read_b128 v[24:27], v1 offset:3072
    v_fma_f32 v148, v148, v49, v51
    v_mfma_f32_16x16x32_bf16 a[4:7], v[80:83], v[36:39], a[4:7]
    buffer_store_dwordx4 v[228:231], v55, s[4:7], s33 offen offset:768 sc1
    v_mfma_f32_16x16x32_bf16 a[52:55], v[68:71], v[32:35], a[52:55]
    v_cvt_pk_bf16_f32 v168, v16, v17
    v_cvt_f32_i32 v145, v145
    v_mfma_f32_16x16x32_bf16 a[52:55], v[84:87], v[36:39], a[52:55]
    v_exp_f32 v16, v104
    v_mfma_f32_16x16x32_bf16 a[100:103], v[72:75], v[32:35], a[100:103]
    ds_read_b128 v[28:31], v1 offset:15360
    v_add_f32 v7, v7, v18
    v_mfma_f32_16x16x32_bf16 a[100:103], v[88:91], v[36:39], a[100:103]
    v_add_f32 v7, v7, v19
    v_xor_b32 v54, 32, v11
    v_mfma_f32_16x16x32_bf16 a[148:151], v[76:79], v[32:35], a[148:151]
    v_exp_f32 v17, v105
    v_mfma_f32_16x16x32_bf16 a[148:151], v[92:95], v[36:39], a[148:151]
    s_waitcnt lgkmcnt(2)
    v_cvt_pk_bf16_f32 v169, v18, v19
    v_cvt_f32_i32 v149, v149
    v_mfma_f32_16x16x32_bf16 a[8:11], v[64:67], v[40:43], a[8:11]
    ds_read_b128 v[32:35], v1 offset:4096
    v_fma_f32 v145, v145, v48, v50
    v_mfma_f32_16x16x32_bf16 a[8:11], v[80:83], v[44:47], a[8:11]
    buffer_store_dwordx4 v[232:235], v54, s[4:7], s33 offen offset:1536 sc1
    v_mfma_f32_16x16x32_bf16 a[56:59], v[68:71], v[40:43], a[56:59]
    v_exp_f32 v18, v106
    v_mfma_f32_16x16x32_bf16 a[56:59], v[84:87], v[44:47], a[56:59]
    v_add_f32 v7, v7, v16
    v_add_f32 v7, v7, v17
    v_mfma_f32_16x16x32_bf16 a[104:107], v[72:75], v[40:43], a[104:107]
    ds_read_b128 v[36:39], v1 offset:16384
    v_xor_b32 v55, 48, v11
    v_mfma_f32_16x16x32_bf16 a[104:107], v[88:91], v[44:47], a[104:107]
    v_exp_f32 v19, v107
    v_mfma_f32_16x16x32_bf16 a[152:155], v[76:79], v[40:43], a[152:155]
    v_cvt_pk_bf16_f32 v170, v16, v17
    v_fma_f32 v149, v149, v49, v51
    v_mfma_f32_16x16x32_bf16 a[152:155], v[92:95], v[44:47], a[152:155]
    s_waitcnt lgkmcnt(2)
    v_exp_f32 v16, v172
    v_mfma_f32_16x16x32_bf16 a[12:15], v[64:67], v[24:27], a[12:15]
    ds_read_b128 v[40:43], v1 offset:5120
    v_add_f32 v7, v7, v18
    v_mfma_f32_16x16x32_bf16 a[12:15], v[80:83], v[28:31], a[12:15]
    buffer_store_dwordx4 v[236:239], v55, s[4:7], s33 offen offset:2304 sc1
    v_mfma_f32_16x16x32_bf16 a[60:63], v[68:71], v[24:27], a[60:63]
    v_add_f32 v7, v7, v19
    v_cvt_f32_i32 v146, v146
    v_mfma_f32_16x16x32_bf16 a[60:63], v[84:87], v[28:31], a[60:63]
    v_exp_f32 v17, v173
    v_mfma_f32_16x16x32_bf16 a[108:111], v[72:75], v[24:27], a[108:111]
    ds_read_b128 v[44:47], v1 offset:17408
    v_cvt_pk_bf16_f32 v171, v18, v19
    v_mfma_f32_16x16x32_bf16 a[108:111], v[88:91], v[28:31], a[108:111]
    v_exp_f32 v18, v174
    v_mfma_f32_16x16x32_bf16 a[156:159], v[76:79], v[24:27], a[156:159]
    s_add_u32 s29, s28, 49152
    v_add_f32 v8, v8, v16
    v_add_f32 v8, v8, v17
    v_mfma_f32_16x16x32_bf16 a[156:159], v[92:95], v[28:31], a[156:159]
    s_waitcnt lgkmcnt(2)
    v_exp_f32 v19, v175
    v_mfma_f32_16x16x32_bf16 a[16:19], v[64:67], v[32:35], a[16:19]
    s_sub_u32 s3, s29, 147456
    ds_read_b128 v[24:27], v1 offset:6144
    v_cvt_pk_bf16_f32 v172, v16, v17
    v_mfma_f32_16x16x32_bf16 a[16:19], v[80:83], v[36:39], a[16:19]
    s_mov_b32 m0, s26
    v_exp_f32 v16, v108
    v_mfma_f32_16x16x32_bf16 a[64:67], v[68:71], v[32:35], a[64:67]
    s_min_u32 s29, s29, s3
    v_cvt_f32_i32 v150, v150
    v_add_f32 v8, v8, v18
    v_mfma_f32_16x16x32_bf16 a[64:67], v[84:87], v[36:39], a[64:67]
    buffer_load_dwordx4 v4, s[4:7], s32 offen offset:0 sc1 lds
    v_mfma_f32_16x16x32_bf16 a[112:115], v[72:75], v[32:35], a[112:115]
    ds_read_b128 v[28:31], v1 offset:18432
    v_add_f32 v8, v8, v19
    v_mfma_f32_16x16x32_bf16 a[112:115], v[88:91], v[36:39], a[112:115]
    v_exp_f32 v17, v109
    v_mfma_f32_16x16x32_bf16 a[160:163], v[76:79], v[32:35], a[160:163]
    v_cvt_pk_bf16_f32 v173, v18, v19
    v_fma_f32 v146, v146, v48, v50
    v_mfma_f32_16x16x32_bf16 a[160:163], v[92:95], v[36:39], a[160:163]
    s_waitcnt lgkmcnt(2)
    buffer_load_dwordx4 v4, s[4:7], s32 offen offset:1024 sc1 lds
    v_mfma_f32_16x16x32_bf16 a[20:23], v[64:67], v[40:43], a[20:23]
    s_sub_u32 s3, s29, s28
    ds_read_b128 v[32:35], v1 offset:7168
    v_fma_f32 v150, v150, v49, v51
    v_mfma_f32_16x16x32_bf16 a[20:23], v[80:83], v[44:47], a[20:23]
    v_exp_f32 v18, v110
    v_mfma_f32_16x16x32_bf16 a[68:71], v[68:71], v[40:43], a[68:71]
    v_add_f32 v8, v8, v16
    v_add_f32 v8, v8, v17
    v_mfma_f32_16x16x32_bf16 a[68:71], v[84:87], v[44:47], a[68:71]
    buffer_load_dwordx4 v4, s[4:7], s32 offen offset:2048 sc1 lds
    v_mfma_f32_16x16x32_bf16 a[116:119], v[72:75], v[40:43], a[116:119]
    ds_read_b128 v[36:39], v1 offset:19456
    v_lshlrev_b32 v48, 16, v57
    v_mfma_f32_16x16x32_bf16 a[116:119], v[88:91], v[44:47], a[116:119]
    v_exp_f32 v19, v111
    v_mfma_f32_16x16x32_bf16 a[164:167], v[76:79], v[40:43], a[164:167]
    s_mov_b32 s28, s29
    v_cvt_pk_bf16_f32 v174, v16, v17
    v_add_f32 v8, v8, v18
    v_mfma_f32_16x16x32_bf16 a[164:167], v[92:95], v[44:47], a[164:167]
    s_waitcnt lgkmcnt(2)
    v_add_f32 v8, v8, v19
    v_cvt_pk_bf16_f32 v175, v18, v19
    v_mfma_f32_16x16x32_bf16 a[24:27], v[64:67], v[24:27], a[24:27]
    s_add_u32 s32, s32, 24576
    ds_read_b128 v[40:43], v1 offset:8192
    v_and_b32 v49, s97, v57
    v_mfma_f32_16x16x32_bf16 a[24:27], v[80:83], v[28:31], a[24:27]
    v_exp_f32 v16, v176
    v_mfma_f32_16x16x32_bf16 a[72:75], v[68:71], v[24:27], a[72:75]
    s_add_u32 s26, s26, 12288
    v_exp_f32 v17, v177
    v_mfma_f32_16x16x32_bf16 a[72:75], v[84:87], v[28:31], a[72:75]
    v_exp_f32 v18, v178
    v_mfma_f32_16x16x32_bf16 a[120:123], v[72:75], v[24:27], a[120:123]
    s_mov_b32 m0, s26
    ds_read_b128 v[44:47], v1 offset:20480
    v_add_f32 v5, v5, v16
    v_mfma_f32_16x16x32_bf16 a[120:123], v[88:91], v[28:31], a[120:123]
    v_add_f32 v5, v5, v17
    v_lshlrev_b32 v50, 16, v59
    v_mfma_f32_16x16x32_bf16 a[168:171], v[76:79], v[24:27], a[168:171]
    v_exp_f32 v19, v179
    v_mfma_f32_16x16x32_bf16 a[168:171], v[92:95], v[28:31], a[168:171]
    s_waitcnt lgkmcnt(2)
    v_cvt_pk_bf16_f32 v176, v16, v17
    v_and_b32 v51, s97, v59
    v_mfma_f32_16x16x32_bf16 a[28:31], v[64:67], v[32:35], a[28:31]
    ds_read_b128 v[24:27], v1 offset:9216
    v_add_u32 v2, s3, v2
    v_mfma_f32_16x16x32_bf16 a[28:31], v[80:83], v[36:39], a[28:31]
    buffer_load_dwordx4 v4, s[4:7], s32 offen offset:0 sc1 lds
    v_mfma_f32_16x16x32_bf16 a[76:79], v[68:71], v[32:35], a[76:79]
    v_exp_f32 v16, v112
    v_mfma_f32_16x16x32_bf16 a[76:79], v[84:87], v[36:39], a[76:79]
    v_add_f32 v5, v5, v18
    v_add_f32 v5, v5, v19
    v_mfma_f32_16x16x32_bf16 a[124:127], v[72:75], v[32:35], a[124:127]
    ds_read_b128 v[28:31], v1 offset:21504
    v_mul_f32_e64 v50, -v50, v48
    v_mfma_f32_16x16x32_bf16 a[124:127], v[88:91], v[36:39], a[124:127]
    buffer_load_dwordx4 v4, s[4:7], s32 offen offset:1024 sc1 lds
    v_mfma_f32_16x16x32_bf16 a[172:175], v[76:79], v[32:35], a[172:175]
    v_exp_f32 v17, v113
    v_mfma_f32_16x16x32_bf16 a[172:175], v[92:95], v[36:39], a[172:175]
    s_waitcnt lgkmcnt(2)
    v_cvt_pk_bf16_f32 v177, v18, v19
    v_add_u32 v3, s3, v3
    v_mfma_f32_16x16x32_bf16 a[32:35], v[64:67], v[40:43], a[32:35]
    ds_read_b128 v[32:35], v1 offset:10240
    v_mul_f32_e64 v51, -v51, v49
    v_mfma_f32_16x16x32_bf16 a[32:35], v[80:83], v[44:47], a[32:35]
    v_exp_f32 v18, v114
    v_mfma_f32_16x16x32_bf16 a[80:83], v[68:71], v[40:43], a[80:83]
    v_add_f32 v5, v5, v16
    v_add_f32 v5, v5, v17
    v_mfma_f32_16x16x32_bf16 a[80:83], v[84:87], v[44:47], a[80:83]
    buffer_load_dwordx4 v4, s[4:7], s32 offen offset:2048 sc1 lds
    v_mfma_f32_16x16x32_bf16 a[128:131], v[72:75], v[40:43], a[128:131]
    ds_read_b128 v[36:39], v1 offset:22528
    v_mfma_f32_16x16x32_bf16 a[128:131], v[88:91], v[44:47], a[128:131]
    v_exp_f32 v19, v115
    v_mfma_f32_16x16x32_bf16 a[176:179], v[76:79], v[40:43], a[176:179]
    v_cvt_pk_bf16_f32 v178, v16, v17
    v_cvt_f32_i32 v152, v152
    v_mfma_f32_16x16x32_bf16 a[176:179], v[92:95], v[44:47], a[176:179]
    s_waitcnt lgkmcnt(2)
    v_exp_f32 v16, v180
    v_mfma_f32_16x16x32_bf16 a[36:39], v[64:67], v[24:27], a[36:39]
    ds_read_b128 v[40:43], v1 offset:11264
    v_add_f32 v5, v5, v18
    v_mfma_f32_16x16x32_bf16 a[36:39], v[80:83], v[28:31], a[36:39]
    v_add_f32 v5, v5, v19
    v_mfma_f32_16x16x32_bf16 a[84:87], v[68:71], v[24:27], a[84:87]
    v_exp_f32 v17, v181
    v_mfma_f32_16x16x32_bf16 a[84:87], v[84:87], v[28:31], a[84:87]
    s_add_u32 s32, s32, 24576
    v_cvt_pk_bf16_f32 v179, v18, v19
    s_add_u32 s26, s26, 36864
    v_mfma_f32_16x16x32_bf16 a[132:135], v[72:75], v[24:27], a[132:135]
    s_sub_u32 s57, s26, 147456
    ds_read_b128 v[44:47], v1 offset:23552
    v_cvt_f32_i32 v156, v156
    v_mfma_f32_16x16x32_bf16 a[132:135], v[88:91], v[28:31], a[132:135]
    s_waitcnt lgkmcnt(2)
    v_exp_f32 v18, v182
    v_mfma_f32_16x16x32_bf16 a[180:183], v[76:79], v[24:27], a[180:183]
    s_waitcnt vmcnt(6)
    v_add_f32 v6, v6, v16
    v_add_f32 v6, v6, v17
    v_mfma_f32_16x16x32_bf16 a[180:183], v[92:95], v[28:31], a[180:183]
    s_barrier
    v_fma_f32 v152, v152, v48, v50
    v_mfma_f32_16x16x32_bf16 a[40:43], v[64:67], v[32:35], a[40:43]
    s_min_u32 s26, s26, s57
    ds_read_b128 v[24:27], v2 offset:0
    v_add_u32 v0, 1, v0
    v_mfma_f32_16x16x32_bf16 a[40:43], v[80:83], v[36:39], a[40:43]
    buffer_store_dword v0, v13, s[20:23], 0 offen offset:32 sc1
    v_mfma_f32_16x16x32_bf16 a[88:91], v[68:71], v[32:35], a[88:91]
    v_exp_f32 v19, v183
    v_mfma_f32_16x16x32_bf16 a[88:91], v[84:87], v[36:39], a[88:91]
    v_cvt_pk_bf16_f32 v180, v16, v17
    v_fma_f32 v156, v156, v49, v51
    v_mfma_f32_16x16x32_bf16 a[136:139], v[72:75], v[32:35], a[136:139]
    ds_read_b128 v[28:31], v3 offset:0
    v_mfma_f32_16x16x32_bf16 a[136:139], v[88:91], v[36:39], a[136:139]
    v_exp_f32 v16, v116
    v_mfma_f32_16x16x32_bf16 a[184:187], v[76:79], v[32:35], a[184:187]
    v_add_f32 v6, v6, v18
    v_add_f32 v6, v6, v19
    v_mfma_f32_16x16x32_bf16 a[184:187], v[92:95], v[36:39], a[184:187]
    s_waitcnt lgkmcnt(2)
    v_exp_f32 v17, v117
    v_mfma_f32_16x16x32_bf16 a[44:47], v[64:67], v[40:43], a[44:47]
    ds_read_b128 v[32:35], v2 offset:6144
    v_cvt_pk_bf16_f32 v181, v18, v19
    v_mfma_f32_16x16x32_bf16 a[44:47], v[80:83], v[44:47], a[44:47]
    v_exp_f32 v18, v118
    v_mfma_f32_16x16x32_bf16 a[92:95], v[68:71], v[40:43], a[92:95]
    v_add_f32 v6, v6, v16
    v_add_f32 v6, v6, v17
    v_mfma_f32_16x16x32_bf16 a[92:95], v[84:87], v[44:47], a[92:95]
    v_exp_f32 v19, v119
    v_mfma_f32_16x16x32_bf16 a[140:143], v[72:75], v[40:43], a[140:143]
    ds_read_b128 v[36:39], v3 offset:6144
    v_cvt_pk_bf16_f32 v182, v16, v17
    v_mfma_f32_16x16x32_bf16 a[140:143], v[88:91], v[44:47], a[140:143]
    v_add_f32 v6, v6, v18
    v_add_f32 v6, v6, v19
    v_mfma_f32_16x16x32_bf16 a[188:191], v[76:79], v[40:43], a[188:191]
    v_cvt_pk_bf16_f32 v183, v18, v19
    v_mfma_f32_16x16x32_bf16 a[188:191], v[92:95], v[44:47], a[188:191]
    s_waitcnt lgkmcnt(2)
    v_mfma_f32_16x16x32_bf16 v[64:67], v[24:27], a[192:195], v[128:131]
    s_add_u32 s33, s33, 196608
    ds_read_b128 v[40:43], v2 offset:128
    v_cvt_f32_i32 v153, v153
    v_mfma_f32_16x16x32_bf16 v[64:67], v[28:31], a[196:199], v[64:67]
    s_mov_b32 m0, s56
    v_exp_f32 v16, v184
    v_mfma_f32_16x16x32_bf16 v[68:71], v[24:27], a[216:219], v[132:135]
    s_add_u32 s34, s34, 196608
    v_exp_f32 v17, v185
    v_mfma_f32_16x16x32_bf16 v[68:71], v[28:31], a[220:223], v[68:71]
    s_add_u32 s36, s36, 1536
    buffer_load_dwordx4 v4, s[4:7], s27 offen offset:0 sc1 lds
    v_mfma_f32_16x16x32_bf16 v[72:75], v[24:27], a[240:243], v[136:139]
    ds_read_b128 v[44:47], v3 offset:128
    v_cvt_f32_i32 v157, v157
    v_mfma_f32_16x16x32_bf16 v[72:75], v[28:31], a[244:247], v[72:75]
    v_exp_f32 v18, v186
    v_mfma_f32_16x16x32_bf16 v[76:79], v[24:27], v[200:203], v[140:143]
    v_add_f32 v7, v7, v16
    v_add_f32 v7, v7, v17
    v_mfma_f32_16x16x32_bf16 v[76:79], v[28:31], v[204:207], v[76:79]
    s_waitcnt lgkmcnt(2)
    buffer_load_dwordx2 v[56:57], v10, s[72:75], s36 offen offset:0
    v_mfma_f32_16x16x32_bf16 v[96:99], v[32:35], a[192:195], v[128:131]
    ds_read_b128 v[24:27], v2 offset:6272
    v_fma_f32 v153, v153, v48, v50
    v_mfma_f32_16x16x32_bf16 v[96:99], v[36:39], a[196:199], v[96:99]
    v_exp_f32 v19, v187
    v_mfma_f32_16x16x32_bf16 v[100:103], v[32:35], a[216:219], v[132:135]
    v_cvt_pk_bf16_f32 v184, v16, v17
    v_fma_f32 v157, v157, v49, v51
    v_mfma_f32_16x16x32_bf16 v[100:103], v[36:39], a[220:223], v[100:103]
    buffer_load_dwordx4 v4, s[4:7], s27 offen offset:1024 sc1 lds
    v_mfma_f32_16x16x32_bf16 v[104:107], v[32:35], a[240:243], v[136:139]
    ds_read_b128 v[28:31], v3 offset:6272
    v_cvt_f32_i32 v154, v154
    v_mfma_f32_16x16x32_bf16 v[104:107], v[36:39], a[244:247], v[104:107]
    v_exp_f32 v16, v120
    v_mfma_f32_16x16x32_bf16 v[108:111], v[32:35], v[200:203], v[140:143]
    v_add_f32 v7, v7, v18
    v_add_f32 v7, v7, v19
    v_mfma_f32_16x16x32_bf16 v[108:111], v[36:39], v[204:207], v[108:111]
    s_waitcnt lgkmcnt(2)
    buffer_load_dwordx2 v[58:59], v10, s[76:79], s36 offen offset:0
    v_mfma_f32_16x16x32_bf16 v[64:67], v[40:43], a[200:203], v[64:67]
    ds_read_b128 v[32:35], v2 offset:256
    v_cvt_f32_i32 v158, v158
    v_mfma_f32_16x16x32_bf16 v[64:67], v[44:47], a[204:207], v[64:67]
    v_exp_f32 v17, v121
    v_mfma_f32_16x16x32_bf16 v[68:71], v[40:43], a[224:227], v[68:71]
    v_cvt_pk_bf16_f32 v185, v18, v19
    v_fma_f32 v154, v154, v48, v50
    v_mfma_f32_16x16x32_bf16 v[68:71], v[44:47], a[228:231], v[68:71]
    buffer_load_dwordx4 v[224:227], v9, s[64:67], s33 offen offset:0 nt
    v_mfma_f32_16x16x32_bf16 v[72:75], v[40:43], a[248:251], v[72:75]
    ds_read_b128 v[36:39], v3 offset:256
    v_fma_f32 v158, v158, v49, v51
    v_mfma_f32_16x16x32_bf16 v[72:75], v[44:47], a[252:255], v[72:75]
    v_exp_f32 v18, v122
    v_mfma_f32_16x16x32_bf16 v[76:79], v[40:43], v[208:211], v[76:79]
    v_add_f32 v7, v7, v16
    v_add_f32 v7, v7, v17
    v_mfma_f32_16x16x32_bf16 v[76:79], v[44:47], v[212:215], v[76:79]
    s_waitcnt lgkmcnt(2)
    buffer_load_dwordx4 v4, s[4:7], s27 offen offset:2048 sc1 lds
    v_mfma_f32_16x16x32_bf16 v[96:99], v[24:27], a[200:203], v[96:99]
    ds_read_b128 v[40:43], v2 offset:6400
    v_cvt_pk_bf16_f32 v144, v144, v148
    v_mfma_f32_16x16x32_bf16 v[96:99], v[28:31], a[204:207], v[96:99]
    v_exp_f32 v19, v123
    v_cvt_pk_bf16_f32 v186, v16, v17
    v_mfma_f32_16x16x32_bf16 v[100:103], v[24:27], a[224:227], v[100:103]
    v_exp_f32 v16, v188
    v_mfma_f32_16x16x32_bf16 v[100:103], v[28:31], a[228:231], v[100:103]
    buffer_load_dwordx4 v[228:231], v9, s[64:67], s33 offen offset:1536 nt
    v_mfma_f32_16x16x32_bf16 v[104:107], v[24:27], a[248:251], v[104:107]
    ds_read_b128 v[44:47], v3 offset:6400
    v_add_f32 v7, v7, v18
    v_mfma_f32_16x16x32_bf16 v[104:107], v[28:31], a[252:255], v[104:107]
    v_add_f32 v7, v7, v19
    v_cvt_pk_bf16_f32 v148, v145, v149
    v_mfma_f32_16x16x32_bf16 v[108:111], v[24:27], v[208:211], v[108:111]
    s_add_u32 s29, s30, 49152
    v_exp_f32 v17, v189
    v_mfma_f32_16x16x32_bf16 v[108:111], v[28:31], v[212:215], v[108:111]
    s_waitcnt lgkmcnt(2)
    buffer_load_dwordx4 v[232:235], v9, s[64:67], s34 offen offset:0 nt
    v_cvt_pk_bf16_f32 v187, v18, v19
    v_mfma_f32_16x16x32_bf16 v[64:67], v[32:35], a[208:211], v[64:67]
    s_sub_u32 s3, s29, 147456
    ds_read_b128 v[24:27], v2 offset:12288
    s_add_u32 s27, s27, 24576
    v_mfma_f32_16x16x32_bf16 v[64:67], v[36:39], a[212:215], v[64:67]
    s_min_u32 s29, s29, s3
    v_exp_f32 v18, v190
    v_mfma_f32_16x16x32_bf16 v[68:71], v[32:35], a[232:235], v[68:71]
    v_add_f32 v8, v8, v16
    v_add_f32 v8, v8, v17
    v_mfma_f32_16x16x32_bf16 v[68:71], v[36:39], a[236:239], v[68:71]
    buffer_load_dwordx4 v[236:239], v9, s[64:67], s34 offen offset:1536 nt
    v_mfma_f32_16x16x32_bf16 v[72:75], v[32:35], v[192:195], v[72:75]
    s_add_u32 s56, s56, 12288
    ds_read_b128 v[28:31], v3 offset:12288
    v_cvt_pk_bf16_f32 v145, v152, v156
    v_mfma_f32_16x16x32_bf16 v[72:75], v[36:39], v[196:199], v[72:75]
    v_exp_f32 v19, v191
    v_cvt_pk_bf16_f32 v188, v16, v17
    v_mfma_f32_16x16x32_bf16 v[76:79], v[32:35], v[216:219], v[76:79]
    v_exp_f32 v16, v124
    v_mfma_f32_16x16x32_bf16 v[76:79], v[36:39], v[220:223], v[76:79]
    s_waitcnt lgkmcnt(2)
    v_add_f32 v8, v8, v18
    v_add_f32 v8, v8, v19
    v_mfma_f32_16x16x32_bf16 v[96:99], v[40:43], a[208:211], v[96:99]
    ds_read_b128 v[32:35], v2 offset:18432
    v_cvt_pk_bf16_f32 v149, v153, v157
    v_mfma_f32_16x16x32_bf16 v[96:99], v[44:47], a[212:215], v[96:99]
    s_sub_u32 s3, s29, s30
    v_exp_f32 v17, v125
    v_mfma_f32_16x16x32_bf16 v[100:103], v[40:43], a[232:235], v[100:103]
    s_mov_b32 m0, s56
    v_cvt_pk_bf16_f32 v189, v18, v19
    v_cvt_pk_bf16_f32 v152, v146, v150
    v_mfma_f32_16x16x32_bf16 v[100:103], v[44:47], a[236:239], v[100:103]
    v_exp_f32 v18, v126
    v_mfma_f32_16x16x32_bf16 v[104:107], v[40:43], v[192:195], v[104:107]
    ds_read_b128 v[36:39], v3 offset:18432
    v_add_f32 v8, v8, v16
    v_mfma_f32_16x16x32_bf16 v[104:107], v[44:47], v[196:199], v[104:107]
    v_add_f32 v8, v8, v17
    v_cvt_pk_bf16_f32 v153, v154, v158
    v_mfma_f32_16x16x32_bf16 v[108:111], v[40:43], v[216:219], v[108:111]
    v_exp_f32 v19, v127
    v_mfma_f32_16x16x32_bf16 v[108:111], v[44:47], v[220:223], v[108:111]
    s_waitcnt lgkmcnt(2)
    v_cvt_pk_bf16_f32 v190, v16, v17
    v_add_f32 v8, v8, v18
    v_mfma_f32_16x16x32_bf16 v[80:83], v[24:27], a[192:195], v[128:131]
    ds_read_b128 v[40:43], v2 offset:12416
    v_add_f32 v8, v8, v19
    v_mfma_f32_16x16x32_bf16 v[80:83], v[28:31], a[196:199], v[80:83]
    s_mov_b32 s30, s29
    v_cvt_pk_bf16_f32 v191, v18, v19
    v_mfma_f32_16x16x32_bf16 v[84:87], v[24:27], a[216:219], v[132:135]
    v_exp_f32 v16, v64
    v_mfma_f32_16x16x32_bf16 v[84:87], v[28:31], a[220:223], v[84:87]
    s_waitcnt vmcnt(20)
    buffer_load_dwordx4 v4, s[4:7], s27 offen offset:0 sc1 lds
    v_mfma_f32_16x16x32_bf16 v[88:91], v[24:27], a[240:243], v[136:139]
    ds_read_b128 v[44:47], v3 offset:12416
    v_lshlrev_b32 v48, 16, v60
    v_mfma_f32_16x16x32_bf16 v[88:91], v[28:31], a[244:247], v[88:91]
    v_exp_f32 v17, v65
    v_mfma_f32_16x16x32_bf16 v[92:95], v[24:27], v[200:203], v[140:143]
    v_exp_f32 v18, v66
    v_mfma_f32_16x16x32_bf16 v[92:95], v[28:31], v[204:207], v[92:95]
    s_waitcnt lgkmcnt(2)
    v_add_f32 v5, v5, v16
    v_add_f32 v5, v5, v17
    v_mfma_f32_16x16x32_bf16 v[112:115], v[32:35], a[192:195], v[128:131]
    ds_read_b128 v[24:27], v2 offset:18560
    v_and_b32 v49, s97, v60
    v_mfma_f32_16x16x32_bf16 v[112:115], v[36:39], a[196:199], v[112:115]
    v_exp_f32 v19, v67
    v_mfma_f32_16x16x32_bf16 v[116:119], v[32:35], a[216:219], v[132:135]
    v_cvt_pk_bf16_f32 v64, v16, v17
    v_lshlrev_b32 v50, 16, v62
    v_mfma_f32_16x16x32_bf16 v[116:119], v[36:39], a[220:223], v[116:119]
    v_exp_f32 v16, v96
    v_mfma_f32_16x16x32_bf16 v[120:123], v[32:35], a[240:243], v[136:139]
    ds_read_b128 v[28:31], v3 offset:18560
    v_add_f32 v5, v5, v18
    v_mfma_f32_16x16x32_bf16 v[120:123], v[36:39], a[244:247], v[120:123]
    v_add_f32 v5, v5, v19
    v_add_u32 v1, s3, v1
    v_mfma_f32_16x16x32_bf16 v[124:127], v[32:35], v[200:203], v[140:143]
    v_exp_f32 v17, v97
    v_mfma_f32_16x16x32_bf16 v[124:127], v[36:39], v[204:207], v[124:127]
    s_waitcnt lgkmcnt(2)
    buffer_load_dwordx4 v4, s[4:7], s27 offen offset:1024 sc1 lds
    v_mfma_f32_16x16x32_bf16 v[80:83], v[40:43], a[200:203], v[80:83]
    ds_read_b128 v[32:35], v2 offset:12544
    v_cvt_pk_bf16_f32 v65, v18, v19
    v_mfma_f32_16x16x32_bf16 v[80:83], v[44:47], a[204:207], v[80:83]
    v_exp_f32 v18, v98
    v_mfma_f32_16x16x32_bf16 v[84:87], v[40:43], a[224:227], v[84:87]
    v_add_f32 v5, v5, v16
    v_add_f32 v5, v5, v17
    v_mfma_f32_16x16x32_bf16 v[84:87], v[44:47], a[228:231], v[84:87]
    v_exp_f32 v19, v99
    v_mfma_f32_16x16x32_bf16 v[88:91], v[40:43], a[248:251], v[88:91]
    ds_read_b128 v[36:39], v3 offset:12544
    v_cvt_pk_bf16_f32 v66, v16, v17
    v_mfma_f32_16x16x32_bf16 v[88:91], v[44:47], a[252:255], v[88:91]
    v_exp_f32 v16, v68
    v_mfma_f32_16x16x32_bf16 v[92:95], v[40:43], v[208:211], v[92:95]
    v_and_b32 v51, s97, v62
    v_add_f32 v5, v5, v18
    v_mfma_f32_16x16x32_bf16 v[92:95], v[44:47], v[212:215], v[92:95]
    s_waitcnt lgkmcnt(2)
    v_add_f32 v5, v5, v19
    v_mul_f32_e64 v50, -v50, v48
    v_mfma_f32_16x16x32_bf16 v[112:115], v[24:27], a[200:203], v[112:115]
    ds_read_b128 v[40:43], v2 offset:18688
    v_mfma_f32_16x16x32_bf16 v[112:115], v[28:31], a[204:207], v[112:115]
    buffer_load_dwordx4 v4, s[4:7], s27 offen offset:2048 sc1 lds
    v_mfma_f32_16x16x32_bf16 v[116:119], v[24:27], a[224:227], v[116:119]
    v_exp_f32 v17, v69
    v_mfma_f32_16x16x32_bf16 v[116:119], v[28:31], a[228:231], v[116:119]
    v_cvt_pk_bf16_f32 v67, v18, v19
    v_mul_f32_e64 v51, -v51, v49
    v_mfma_f32_16x16x32_bf16 v[120:123], v[24:27], a[248:251], v[120:123]
    ds_read_b128 v[44:47], v3 offset:18688
    v_mfma_f32_16x16x32_bf16 v[120:123], v[28:31], a[252:255], v[120:123]
    s_waitcnt lgkmcnt(2)
    v_exp_f32 v18, v70
    v_mfma_f32_16x16x32_bf16 v[124:127], v[24:27], v[208:211], v[124:127]
    s_waitcnt vmcnt(13)
    v_add_f32 v6, v6, v16
    v_add_f32 v6, v6, v17
    v_mfma_f32_16x16x32_bf16 v[124:127], v[28:31], v[212:215], v[124:127]
    s_barrier
    v_cvt_f32_i32 v240, v240
    v_mfma_f32_16x16x32_bf16 v[80:83], v[32:35], a[208:211], v[80:83]
    ds_read_b128 v[24:27], v1 offset:0
    v_mfma_f32_16x16x32_bf16 v[80:83], v[36:39], a[212:215], v[80:83]
    v_exp_f32 v19, v71
    v_mfma_f32_16x16x32_bf16 v[84:87], v[32:35], a[232:235], v[84:87]
    v_cvt_pk_bf16_f32 v68, v16, v17
    v_mfma_f32_16x16x32_bf16 v[84:87], v[36:39], a[236:239], v[84:87]
    v_exp_f32 v16, v100
    v_mfma_f32_16x16x32_bf16 v[88:91], v[32:35], v[192:195], v[88:91]
    ds_read_b128 v[28:31], v1 offset:12288
    v_add_f32 v6, v6, v18
    v_mfma_f32_16x16x32_bf16 v[88:91], v[36:39], v[196:199], v[88:91]
    v_add_f32 v6, v6, v19
    v_cvt_f32_i32 v244, v244
    v_mfma_f32_16x16x32_bf16 v[92:95], v[32:35], v[216:219], v[92:95]
    v_exp_f32 v17, v101
    v_mfma_f32_16x16x32_bf16 v[92:95], v[36:39], v[220:223], v[92:95]
    s_waitcnt lgkmcnt(2)
    v_cvt_pk_bf16_f32 v69, v18, v19
    v_mfma_f32_16x16x32_bf16 v[112:115], v[40:43], a[208:211], v[112:115]
    ds_read_b128 v[32:35], v1 offset:1024
    v_mfma_f32_16x16x32_bf16 v[112:115], v[44:47], a[212:215], v[112:115]
    v_exp_f32 v18, v102
    v_mfma_f32_16x16x32_bf16 v[116:119], v[40:43], a[232:235], v[116:119]
    v_add_f32 v6, v6, v16
    v_add_f32 v6, v6, v17
    v_mfma_f32_16x16x32_bf16 v[116:119], v[44:47], a[236:239], v[116:119]
    s_add_u32 s27, s27, 24576
    v_exp_f32 v19, v103
    v_mfma_f32_16x16x32_bf16 v[120:123], v[40:43], v[192:195], v[120:123]
    s_add_u32 s56, s56, 36864
    ds_read_b128 v[36:39], v1 offset:13312
    v_cvt_pk_bf16_f32 v70, v16, v17
    v_mfma_f32_16x16x32_bf16 v[120:123], v[44:47], v[196:199], v[120:123]
    s_sub_u32 s58, s56, 147456
    v_add_f32 v6, v6, v18
    v_add_f32 v6, v6, v19
    v_mfma_f32_16x16x32_bf16 v[124:127], v[40:43], v[216:219], v[124:127]
    s_min_u32 s56, s56, s58
    v_cvt_pk_bf16_f32 v71, v18, v19
    v_mfma_f32_16x16x32_bf16 v[124:127], v[44:47], v[220:223], v[124:127]
    s_waitcnt lgkmcnt(2)
    v_mfma_f32_16x16x32_bf16 a[0:3], v[160:163], v[24:27], a[0:3]
    s_mov_b32 m0, s56
    ds_read_b128 v[40:43], v1 offset:2048
    v_fma_f32 v240, v240, v48, v50
    v_mfma_f32_16x16x32_bf16 a[0:3], v[176:179], v[28:31], a[0:3]
    buffer_load_dwordx4 v4, s[4:7], s27 offen offset:0 sc1 lds
    v_mfma_f32_16x16x32_bf16 a[48:51], v[164:167], v[24:27], a[48:51]
    v_exp_f32 v16, v72
    v_mfma_f32_16x16x32_bf16 a[48:51], v[180:183], v[28:31], a[48:51]
    v_exp_f32 v17, v73
    v_mfma_f32_16x16x32_bf16 a[96:99], v[168:171], v[24:27], a[96:99]
    ds_read_b128 v[44:47], v1 offset:14336
    v_fma_f32 v244, v244, v49, v51
    v_mfma_f32_16x16x32_bf16 a[96:99], v[184:187], v[28:31], a[96:99]
    v_exp_f32 v18, v74
    v_mfma_f32_16x16x32_bf16 a[144:147], v[172:175], v[24:27], a[144:147]
    v_add_f32 v7, v7, v16
    v_add_f32 v7, v7, v17
    v_mfma_f32_16x16x32_bf16 a[144:147], v[188:191], v[28:31], a[144:147]
    s_waitcnt lgkmcnt(2)
    v_exp_f32 v19, v75
    v_mfma_f32_16x16x32_bf16 a[4:7], v[160:163], v[32:35], a[4:7]
    ds_read_b128 v[24:27], v1 offset:3072
    v_cvt_f32_i32 v241, v241
    v_mfma_f32_16x16x32_bf16 a[4:7], v[176:179], v[36:39], a[4:7]
    buffer_load_dwordx4 v4, s[4:7], s27 offen offset:1024 sc1 lds
    v_mfma_f32_16x16x32_bf16 a[52:55], v[164:167], v[32:35], a[52:55]
    v_cvt_pk_bf16_f32 v72, v16, v17
    v_cvt_f32_i32 v245, v245
    v_mfma_f32_16x16x32_bf16 a[52:55], v[180:183], v[36:39], a[52:55]
    v_exp_f32 v16, v104
    v_mfma_f32_16x16x32_bf16 a[100:103], v[168:171], v[32:35], a[100:103]
    ds_read_b128 v[28:31], v1 offset:15360
    v_add_f32 v7, v7, v18
    v_mfma_f32_16x16x32_bf16 a[100:103], v[184:187], v[36:39], a[100:103]
    v_add_f32 v7, v7, v19
    v_bfe_u32 v53, v4, 4, 6
    v_mfma_f32_16x16x32_bf16 a[148:151], v[172:175], v[32:35], a[148:151]
    v_exp_f32 v17, v105
    v_mfma_f32_16x16x32_bf16 a[148:151], v[188:191], v[36:39], a[148:151]
    s_waitcnt lgkmcnt(2)
    v_cvt_pk_bf16_f32 v73, v18, v19
    v_fma_f32 v241, v241, v48, v50
    v_mfma_f32_16x16x32_bf16 a[8:11], v[160:163], v[40:43], a[8:11]
    ds_read_b128 v[32:35], v1 offset:4096
    v_lshlrev_b32 v53, 2, v53
    v_mfma_f32_16x16x32_bf16 a[8:11], v[176:179], v[44:47], a[8:11]
    buffer_load_dword v52, v53, s[20:23], s44 offen sc1
    v_mfma_f32_16x16x32_bf16 a[56:59], v[164:167], v[40:43], a[56:59]
    v_exp_f32 v18, v106
    v_mfma_f32_16x16x32_bf16 a[56:59], v[180:183], v[44:47], a[56:59]
    v_add_f32 v7, v7, v16
    v_add_f32 v7, v7, v17
    v_mfma_f32_16x16x32_bf16 a[104:107], v[168:171], v[40:43], a[104:107]
    ds_read_b128 v[36:39], v1 offset:16384
    v_fma_f32 v245, v245, v49, v51
    v_mfma_f32_16x16x32_bf16 a[104:107], v[184:187], v[44:47], a[104:107]
    buffer_load_dwordx4 v4, s[4:7], s27 offen offset:2048 sc1 lds
    v_mfma_f32_16x16x32_bf16 a[152:155], v[172:175], v[40:43], a[152:155]
    v_exp_f32 v19, v107
    v_mfma_f32_16x16x32_bf16 a[152:155], v[188:191], v[44:47], a[152:155]
    s_waitcnt lgkmcnt(2)
    v_cvt_pk_bf16_f32 v74, v16, v17
    v_cvt_f32_i32 v242, v242
    v_mfma_f32_16x16x32_bf16 a[12:15], v[160:163], v[24:27], a[12:15]
    ds_read_b128 v[40:43], v1 offset:5120
    v_cvt_f32_i32 v246, v246
    v_mfma_f32_16x16x32_bf16 a[12:15], v[176:179], v[28:31], a[12:15]
L_pg4:
    s_cbranch_execz L_pg8
    s_add_u32 s27, s27, 24576
    v_exp_f32 v16, v76
    v_mfma_f32_16x16x32_bf16 a[60:63], v[164:167], v[24:27], a[60:63]
    v_add_f32 v7, v7, v18
    v_add_f32 v7, v7, v19
    v_mfma_f32_16x16x32_bf16 a[60:63], v[180:183], v[28:31], a[60:63]
    v_exp_f32 v17, v77
    v_mfma_f32_16x16x32_bf16 a[108:111], v[168:171], v[24:27], a[108:111]
    ds_read_b128 v[44:47], v1 offset:17408
    v_cvt_pk_bf16_f32 v75, v18, v19
    v_mfma_f32_16x16x32_bf16 a[108:111], v[184:187], v[28:31], a[108:111]
    v_exp_f32 v18, v78
    v_mfma_f32_16x16x32_bf16 a[156:159], v[172:175], v[24:27], a[156:159]
    s_add_u32 s29, s28, 49152
    v_fma_f32 v242, v242, v48, v50
    v_add_f32 v8, v8, v16
    v_mfma_f32_16x16x32_bf16 a[156:159], v[188:191], v[28:31], a[156:159]
    s_waitcnt lgkmcnt(2)
    v_add_f32 v8, v8, v17
    v_fma_f32 v246, v246, v49, v51
    v_mfma_f32_16x16x32_bf16 a[16:19], v[160:163], v[32:35], a[16:19]
    s_sub_u32 s3, s29, 147456
    ds_read_b128 v[24:27], v1 offset:6144
    v_lshlrev_b32 v48, 16, v61
    v_mfma_f32_16x16x32_bf16 a[16:19], v[176:179], v[36:39], a[16:19]
    s_add_u32 s56, s56, 12288
    v_exp_f32 v19, v79
    v_mfma_f32_16x16x32_bf16 a[64:67], v[164:167], v[32:35], a[64:67]
    s_min_u32 s29, s29, s3
    v_cvt_pk_bf16_f32 v76, v16, v17
    v_and_b32 v49, s97, v61
    v_mfma_f32_16x16x32_bf16 a[64:67], v[180:183], v[36:39], a[64:67]
    s_mov_b32 m0, s56
    v_exp_f32 v16, v108
    v_mfma_f32_16x16x32_bf16 a[112:115], v[168:171], v[32:35], a[112:115]
    ds_read_b128 v[28:31], v1 offset:18432
    v_add_f32 v8, v8, v18
    v_mfma_f32_16x16x32_bf16 a[112:115], v[184:187], v[36:39], a[112:115]
    v_add_f32 v8, v8, v19
    v_lshlrev_b32 v50, 16, v63
    v_mfma_f32_16x16x32_bf16 a[160:163], v[172:175], v[32:35], a[160:163]
    v_exp_f32 v17, v109
    v_mfma_f32_16x16x32_bf16 a[160:163], v[188:191], v[36:39], a[160:163]
    s_waitcnt lgkmcnt(2)
    v_cvt_pk_bf16_f32 v77, v18, v19
    v_and_b32 v51, s97, v63
    v_mfma_f32_16x16x32_bf16 a[20:23], v[160:163], v[40:43], a[20:23]
    s_sub_u32 s3, s29, s28
    ds_read_b128 v[32:35], v1 offset:7168
    v_mul_f32_e64 v50, -v50, v48
    v_mfma_f32_16x16x32_bf16 a[20:23], v[176:179], v[44:47], a[20:23]
    v_exp_f32 v18, v110
    v_mfma_f32_16x16x32_bf16 a[68:71], v[164:167], v[40:43], a[68:71]
    v_add_f32 v8, v8, v16
    v_add_f32 v8, v8, v17
    v_mfma_f32_16x16x32_bf16 a[68:71], v[180:183], v[44:47], a[68:71]
    buffer_load_dwordx4 v4, s[4:7], s27 offen offset:0 sc1 lds
    v_mfma_f32_16x16x32_bf16 a[116:119], v[168:171], v[40:43], a[116:119]
    ds_read_b128 v[36:39], v1 offset:19456
    v_mul_f32_e64 v51, -v51, v49
    v_mfma_f32_16x16x32_bf16 a[116:119], v[184:187], v[44:47], a[116:119]
    v_exp_f32 v19, v111
    v_mfma_f32_16x16x32_bf16 a[164:167], v[172:175], v[40:43], a[164:167]
    s_mov_b32 s28, s29
    v_cvt_pk_bf16_f32 v78, v16, v17
    v_add_f32 v8, v8, v18
    v_mfma_f32_16x16x32_bf16 a[164:167], v[188:191], v[44:47], a[164:167]
    s_waitcnt lgkmcnt(2)
    v_add_f32 v8, v8, v19
    v_cvt_pk_bf16_f32 v79, v18, v19
    v_mfma_f32_16x16x32_bf16 a[24:27], v[160:163], v[24:27], a[24:27]
    ds_read_b128 v[40:43], v1 offset:8192
    v_cvt_f32_i32 v248, v248
    v_mfma_f32_16x16x32_bf16 a[24:27], v[176:179], v[28:31], a[24:27]
    v_exp_f32 v16, v80
    v_mfma_f32_16x16x32_bf16 a[72:75], v[164:167], v[24:27], a[72:75]
    v_exp_f32 v17, v81
    v_mfma_f32_16x16x32_bf16 a[72:75], v[180:183], v[28:31], a[72:75]
    buffer_load_dwordx4 v4, s[4:7], s27 offen offset:1024 sc1 lds
    v_mfma_f32_16x16x32_bf16 a[120:123], v[168:171], v[24:27], a[120:123]
    ds_read_b128 v[44:47], v1 offset:20480
    v_cvt_f32_i32 v252, v252
    v_mfma_f32_16x16x32_bf16 a[120:123], v[184:187], v[28:31], a[120:123]
    v_exp_f32 v18, v82
    v_mfma_f32_16x16x32_bf16 a[168:171], v[172:175], v[24:27], a[168:171]
    v_add_f32 v5, v5, v16
    v_fma_f32 v248, v248, v48, v50
    v_mfma_f32_16x16x32_bf16 a[168:171], v[188:191], v[28:31], a[168:171]
    s_waitcnt lgkmcnt(2)
    v_add_f32 v5, v5, v17
    v_fma_f32 v252, v252, v49, v51
    v_mfma_f32_16x16x32_bf16 a[28:31], v[160:163], v[32:35], a[28:31]
    ds_read_b128 v[24:27], v1 offset:9216
    v_cvt_f32_i32 v249, v249
    v_mfma_f32_16x16x32_bf16 a[28:31], v[176:179], v[36:39], a[28:31]
    v_exp_f32 v19, v83
    v_mfma_f32_16x16x32_bf16 a[76:79], v[164:167], v[32:35], a[76:79]
    v_cvt_pk_bf16_f32 v80, v16, v17
    v_cvt_f32_i32 v253, v253
    v_mfma_f32_16x16x32_bf16 a[76:79], v[180:183], v[36:39], a[76:79]
    v_exp_f32 v16, v112
    v_mfma_f32_16x16x32_bf16 a[124:127], v[168:171], v[32:35], a[124:127]
    ds_read_b128 v[28:31], v1 offset:21504
    v_add_f32 v5, v5, v18
    v_mfma_f32_16x16x32_bf16 a[124:127], v[184:187], v[36:39], a[124:127]
    buffer_load_dwordx4 v4, s[4:7], s27 offen offset:2048 sc1 lds
    v_mfma_f32_16x16x32_bf16 a[172:175], v[172:175], v[32:35], a[172:175]
    v_add_f32 v5, v5, v19
    v_fma_f32 v249, v249, v48, v50
    v_mfma_f32_16x16x32_bf16 a[172:175], v[188:191], v[36:39], a[172:175]
    s_waitcnt lgkmcnt(2)
    v_exp_f32 v17, v113
    v_mfma_f32_16x16x32_bf16 a[32:35], v[160:163], v[40:43], a[32:35]
    ds_read_b128 v[32:35], v1 offset:10240
    v_cvt_pk_bf16_f32 v81, v18, v19
    v_mfma_f32_16x16x32_bf16 a[32:35], v[176:179], v[44:47], a[32:35]
    v_exp_f32 v18, v114
    v_mfma_f32_16x16x32_bf16 a[80:83], v[164:167], v[40:43], a[80:83]
    v_add_f32 v5, v5, v16
    v_add_f32 v5, v5, v17
    v_mfma_f32_16x16x32_bf16 a[80:83], v[180:183], v[44:47], a[80:83]
    v_exp_f32 v19, v115
    v_mfma_f32_16x16x32_bf16 a[128:131], v[168:171], v[40:43], a[128:131]
    ds_read_b128 v[36:39], v1 offset:22528
    v_fma_f32 v253, v253, v49, v51
    v_mfma_f32_16x16x32_bf16 a[128:131], v[184:187], v[44:47], a[128:131]
    v_add_u32 v2, s3, v2
    v_cvt_pk_bf16_f32 v82, v16, v17
    v_mfma_f32_16x16x32_bf16 a[176:179], v[172:175], v[40:43], a[176:179]
    v_exp_f32 v16, v84
    v_mfma_f32_16x16x32_bf16 a[176:179], v[188:191], v[44:47], a[176:179]
    s_waitcnt lgkmcnt(2)
    v_cvt_f32_i32 v250, v250
    v_add_f32 v5, v5, v18
    v_mfma_f32_16x16x32_bf16 a[36:39], v[160:163], v[24:27], a[36:39]
    ds_read_b128 v[40:43], v1 offset:11264
    v_add_f32 v5, v5, v19
    v_mfma_f32_16x16x32_bf16 a[36:39], v[176:179], v[28:31], a[36:39]
    v_exp_f32 v17, v85
    v_mfma_f32_16x16x32_bf16 a[84:87], v[164:167], v[24:27], a[84:87]
    v_add_u32 v3, s3, v3
    v_cvt_f32_i32 v254, v254
    v_mfma_f32_16x16x32_bf16 a[84:87], v[180:183], v[28:31], a[84:87]
    s_add_u32 s27, s27, 24576
    v_cvt_pk_bf16_f32 v83, v18, v19
    v_fma_f32 v250, v250, v48, v50
    v_mfma_f32_16x16x32_bf16 a[132:135], v[168:171], v[24:27], a[132:135]
    s_add_u32 s56, s56, 36864
    ds_read_b128 v[44:47], v1 offset:23552
    v_fma_f32 v254, v254, v49, v51
    v_mfma_f32_16x16x32_bf16 a[132:135], v[184:187], v[28:31], a[132:135]
    s_sub_u32 s58, s56, 147456
    v_exp_f32 v18, v86
    v_mfma_f32_16x16x32_bf16 a[180:183], v[172:175], v[24:27], a[180:183]
    v_add_f32 v6, v6, v16
    v_add_f32 v6, v6, v17
    v_mfma_f32_16x16x32_bf16 a[180:183], v[188:191], v[28:31], a[180:183]
    s_waitcnt lgkmcnt(2)
    v_exp_f32 v19, v87
    v_mfma_f32_16x16x32_bf16 a[40:43], v[160:163], v[32:35], a[40:43]
    s_min_u32 s56, s56, s58
    ds_read_b128 v[24:27], v2 offset:0
    v_cvt_pk_bf16_f32 v146, v240, v244
    v_mfma_f32_16x16x32_bf16 a[40:43], v[176:179], v[36:39], a[40:43]
    buffer_load_dword v20, v4, s[88:91], s93 offen
    v_mfma_f32_16x16x32_bf16 a[88:91], v[164:167], v[32:35], a[88:91]
    v_cvt_pk_bf16_f32 v84, v16, v17
    v_cvt_pk_bf16_f32 v150, v241, v245
    v_mfma_f32_16x16x32_bf16 a[88:91], v[180:183], v[36:39], a[88:91]
    v_exp_f32 v16, v116
    v_mfma_f32_16x16x32_bf16 a[136:139], v[168:171], v[32:35], a[136:139]
    ds_read_b128 v[28:31], v3 offset:0
    v_add_f32 v6, v6, v18
    v_mfma_f32_16x16x32_bf16 a[136:139], v[184:187], v[36:39], a[136:139]
    v_add_f32 v6, v6, v19
    v_cvt_pk_bf16_f32 v147, v248, v252
    v_mfma_f32_16x16x32_bf16 a[184:187], v[172:175], v[32:35], a[184:187]
    v_exp_f32 v17, v117
    v_mfma_f32_16x16x32_bf16 a[184:187], v[188:191], v[36:39], a[184:187]
    s_waitcnt lgkmcnt(2)
    v_cvt_pk_bf16_f32 v85, v18, v19
    v_cvt_pk_bf16_f32 v151, v249, v253
    v_mfma_f32_16x16x32_bf16 a[44:47], v[160:163], v[40:43], a[44:47]
    ds_read_b128 v[32:35], v2 offset:6144
    v_cvt_pk_bf16_f32 v154, v242, v246
    v_mfma_f32_16x16x32_bf16 a[44:47], v[176:179], v[44:47], a[44:47]
    v_exp_f32 v18, v118
    v_mfma_f32_16x16x32_bf16 a[92:95], v[164:167], v[40:43], a[92:95]
    v_add_f32 v6, v6, v16
    v_add_f32 v6, v6, v17
    v_mfma_f32_16x16x32_bf16 a[92:95], v[180:183], v[44:47], a[92:95]
    v_exp_f32 v19, v119
    v_mfma_f32_16x16x32_bf16 a[140:143], v[168:171], v[40:43], a[140:143]
    ds_read_b128 v[36:39], v3 offset:6144
    v_cvt_pk_bf16_f32 v86, v16, v17
    v_mfma_f32_16x16x32_bf16 a[140:143], v[184:187], v[44:47], a[140:143]
    v_add_f32 v6, v6, v18
    v_cvt_pk_bf16_f32 v155, v250, v254
    v_mfma_f32_16x16x32_bf16 a[188:191], v[172:175], v[40:43], a[188:191]
    v_add_f32 v6, v6, v19
    v_cvt_pk_bf16_f32 v87, v18, v19
    v_mfma_f32_16x16x32_bf16 a[188:191], v[188:191], v[44:47], a[188:191]
    s_waitcnt lgkmcnt(2)
L_join:
    v_mfma_f32_16x16x32_bf16 v[160:163], v[24:27], a[192:195], v[128:131]
L_pg5:
    s_cbranch_execz L_pg9
    s_waitcnt vmcnt(7)
    ds_read_b128 v[40:43], v2 offset:128
    v_lshlrev_b32 v48, 16, v56
    v_mfma_f32_16x16x32_bf16 v[160:163], v[28:31], a[196:199], v[160:163]
    s_waitcnt vmcnt(3)
    v_subrev_u32 v52, s92, v52
    v_cmp_lt_u32 vcc, 15, v52
    v_mfma_f32_16x16x32_bf16 v[164:167], v[24:27], a[216:219], v[132:135]
    v_exp_f32 v16, v88
    v_mfma_f32_16x16x32_bf16 v[164:167], v[28:31], a[220:223], v[164:167]
    v_exp_f32 v17, v89
    v_mfma_f32_16x16x32_bf16 v[168:171], v[24:27], a[240:243], v[136:139]
    s_and_b32 s59, vcc_lo, 0xff
    ds_read_b128 v[44:47], v3 offset:128
    v_and_b32 v49, s97, v56
    v_mfma_f32_16x16x32_bf16 v[168:171], v[28:31], a[244:247], v[168:171]
    s_cbranch_scc1 L_pollslow1
L_pollok1:
    v_mfma_f32_16x16x32_bf16 v[172:175], v[24:27], v[200:203], v[140:143]
    s_add_u32 s92, s92, 1
    v_exp_f32 v18, v90
    v_mfma_f32_16x16x32_bf16 v[172:175], v[28:31], v[204:207], v[172:175]
    s_waitcnt lgkmcnt(2)
    v_add_f32 v7, v7, v16
    v_add_f32 v7, v7, v17
    v_mfma_f32_16x16x32_bf16 v[96:99], v[32:35], a[192:195], v[128:131]
    ds_read_b128 v[24:27], v2 offset:6272
    v_lshlrev_b32 v50, 16, v58
    v_mfma_f32_16x16x32_bf16 v[96:99], v[36:39], a[196:199], v[96:99]
    buffer_store_dwordx4 v[144:147], v15, s[4:7], s35 offen offset:0 sc1
    v_mfma_f32_16x16x32_bf16 v[100:103], v[32:35], a[216:219], v[132:135]
    v_exp_f32 v19, v91
    v_mfma_f32_16x16x32_bf16 v[100:103], v[36:39], a[220:223], v[100:103]
    v_cvt_pk_bf16_f32 v88, v16, v17
    v_and_b32 v51, s97, v58
    v_mfma_f32_16x16x32_bf16 v[104:107], v[32:35], a[240:243], v[136:139]
    ds_read_b128 v[28:31], v3 offset:6272
    v_mfma_f32_16x16x32_bf16 v[104:107], v[36:39], a[244:247], v[104:107]
    v_exp_f32 v16, v120
    v_mfma_f32_16x16x32_bf16 v[108:111], v[32:35], v[200:203], v[140:143]
    v_add_f32 v7, v7, v18
    v_add_f32 v7, v7, v19
    v_mfma_f32_16x16x32_bf16 v[108:111], v[36:39], v[204:207], v[108:111]
    s_waitcnt lgkmcnt(2)
    v_exp_f32 v17, v121
    v_mfma_f32_16x16x32_bf16 v[160:163], v[40:43], a[200:203], v[160:163]
    ds_read_b128 v[32:35], v2 offset:256
    v_cvt_pk_bf16_f32 v89, v18, v19
    v_mfma_f32_16x16x32_bf16 v[160:163], v[44:47], a[204:207], v[160:163]
    buffer_store_dwordx4 v[148:151], v15, s[4:7], s35 offen offset:1024 sc1
    v_mfma_f32_16x16x32_bf16 v[164:167], v[40:43], a[224:227], v[164:167]
    v_exp_f32 v18, v122
    v_mfma_f32_16x16x32_bf16 v[164:167], v[44:47], a[228:231], v[164:167]
    v_add_f32 v7, v7, v16
    v_add_f32 v7, v7, v17
    v_mfma_f32_16x16x32_bf16 v[168:171], v[40:43], a[248:251], v[168:171]
    ds_read_b128 v[36:39], v3 offset:256
    v_mul_f32 v48, s38, v48
    v_mfma_f32_16x16x32_bf16 v[168:171], v[44:47], a[252:255], v[168:171]
    v_exp_f32 v19, v123
    v_mfma_f32_16x16x32_bf16 v[172:175], v[40:43], v[208:211], v[172:175]
    v_cvt_pk_bf16_f32 v90, v16, v17
    v_mul_f32 v49, s38, v49
    v_mfma_f32_16x16x32_bf16 v[172:175], v[44:47], v[212:215], v[172:175]
    s_waitcnt lgkmcnt(2)
    v_exp_f32 v16, v92
    v_mfma_f32_16x16x32_bf16 v[96:99], v[24:27], a[200:203], v[96:99]
    ds_read_b128 v[40:43], v2 offset:6400
    v_add_f32 v7, v7, v18
    v_mfma_f32_16x16x32_bf16 v[96:99], v[28:31], a[204:207], v[96:99]
    buffer_store_dwordx4 v[152:155], v15, s[4:7], s35 offen offset:2048 sc1
    v_mfma_f32_16x16x32_bf16 v[100:103], v[24:27], a[224:227], v[100:103]
    v_add_f32 v7, v7, v19
    v_mul_f32_e64 v50, -v50, v48
    v_mfma_f32_16x16x32_bf16 v[100:103], v[28:31], a[228:231], v[100:103]
    v_exp_f32 v17, v93
    v_mfma_f32_16x16x32_bf16 v[104:107], v[24:27], a[248:251], v[104:107]
    ds_read_b128 v[44:47], v3 offset:6400
    v_cvt_pk_bf16_f32 v91, v18, v19
    v_mfma_f32_16x16x32_bf16 v[104:107], v[28:31], a[252:255], v[104:107]
    v_exp_f32 v18, v94
    v_mfma_f32_16x16x32_bf16 v[108:111], v[24:27], v[208:211], v[108:111]
    s_add_u32 s29, s30, 49152
    v_add_f32 v8, v8, v16
    v_add_f32 v8, v8, v17
    v_mfma_f32_16x16x32_bf16 v[108:111], v[28:31], v[212:215], v[108:111]
    s_waitcnt lgkmcnt(2)
    v_exp_f32 v19, v95
    v_mfma_f32_16x16x32_bf16 v[160:163], v[32:35], a[208:211], v[160:163]
    s_sub_u32 s3, s29, 147456
    ds_read_b128 v[24:27], v2 offset:12288
    v_cvt_pk_bf16_f32 v92, v16, v17
    v_mfma_f32_16x16x32_bf16 v[160:163], v[36:39], a[212:215], v[160:163]
    s_min_u32 s29, s29, s3
    v_exp_f32 v16, v124
    v_mfma_f32_16x16x32_bf16 v[164:167], v[32:35], a[232:235], v[164:167]
    v_add_f32 v8, v8, v18
    v_mul_f32_e64 v51, -v51, v49
    v_mfma_f32_16x16x32_bf16 v[164:167], v[36:39], a[236:239], v[164:167]
    v_add_f32 v8, v8, v19
    v_cvt_f32_i32 v224, v224
    v_mfma_f32_16x16x32_bf16 v[168:171], v[32:35], v[192:195], v[168:171]
    ds_read_b128 v[28:31], v3 offset:12288
    v_mfma_f32_16x16x32_bf16 v[168:171], v[36:39], v[196:199], v[168:171]
    v_exp_f32 v17, v125
    v_mfma_f32_16x16x32_bf16 v[172:175], v[32:35], v[216:219], v[172:175]
    v_cvt_pk_bf16_f32 v93, v18, v19
    v_cvt_f32_i32 v225, v225
    v_mfma_f32_16x16x32_bf16 v[172:175], v[36:39], v[220:223], v[172:175]
    s_waitcnt lgkmcnt(2)
    v_exp_f32 v18, v126
    v_mfma_f32_16x16x32_bf16 v[96:99], v[40:43], a[208:211], v[96:99]
    ds_read_b128 v[32:35], v2 offset:18432
    v_add_f32 v8, v8, v16
    v_mfma_f32_16x16x32_bf16 v[96:99], v[44:47], a[212:215], v[96:99]
    s_mov_b32 m0, s26
    v_add_f32 v8, v8, v17
    s_sub_u32 s3, s29, s30
    v_mfma_f32_16x16x32_bf16 v[100:103], v[40:43], a[232:235], v[100:103]
    v_exp_f32 v19, v127
    v_mfma_f32_16x16x32_bf16 v[100:103], v[44:47], a[236:239], v[100:103]
    buffer_load_dwordx4 v4, s[4:7], s32 offen offset:0 sc1 lds
    v_mfma_f32_16x16x32_bf16 v[104:107], v[40:43], v[192:195], v[104:107]
    ds_read_b128 v[36:39], v3 offset:18432
    v_cvt_pk_bf16_f32 v94, v16, v17
    v_mfma_f32_16x16x32_bf16 v[104:107], v[44:47], v[196:199], v[104:107]
    v_add_f32 v8, v8, v18
    v_add_f32 v8, v8, v19
    v_mfma_f32_16x16x32_bf16 v[108:111], v[40:43], v[216:219], v[108:111]
    v_cvt_pk_bf16_f32 v95, v18, v19
    v_fma_f32 v224, v224, v48, v50
    v_mfma_f32_16x16x32_bf16 v[108:111], v[44:47], v[220:223], v[108:111]
    s_waitcnt lgkmcnt(2)
    buffer_load_dwordx4 v4, s[4:7], s32 offen offset:1024 sc1 lds
    v_mfma_f32_16x16x32_bf16 v[176:179], v[24:27], a[192:195], v[128:131]
    ds_read_b128 v[40:43], v2 offset:12416
    v_fma_f32 v225, v225, v49, v51
    v_mfma_f32_16x16x32_bf16 v[176:179], v[28:31], a[196:199], v[176:179]
    s_mov_b32 s30, s29
    v_exp_f32 v16, v160
    v_mfma_f32_16x16x32_bf16 v[180:183], v[24:27], a[216:219], v[132:135]
    v_exp_f32 v17, v161
    v_mfma_f32_16x16x32_bf16 v[180:183], v[28:31], a[220:223], v[180:183]
    buffer_load_dwordx4 v4, s[4:7], s32 offen offset:2048 sc1 lds
    v_mfma_f32_16x16x32_bf16 v[184:187], v[24:27], a[240:243], v[136:139]
    s_add_u32 s32, s32, 24576
    ds_read_b128 v[44:47], v3 offset:12416
    v_cvt_pk_bf16_f32 v224, v224, v225
    v_mfma_f32_16x16x32_bf16 v[184:187], v[28:31], a[244:247], v[184:187]
    v_exp_f32 v18, v162
    v_mfma_f32_16x16x32_bf16 v[188:191], v[24:27], v[200:203], v[140:143]
    s_add_u32 s26, s26, 12288
    v_add_f32 v5, v5, v16
    v_add_f32 v5, v5, v17
    v_mfma_f32_16x16x32_bf16 v[188:191], v[28:31], v[204:207], v[188:191]
    s_waitcnt lgkmcnt(2)
    v_exp_f32 v19, v163
    v_mfma_f32_16x16x32_bf16 v[112:115], v[32:35], a[192:195], v[128:131]
    s_mov_b32 m0, s26
    ds_read_b128 v[24:27], v2 offset:18560
    v_cvt_pk_bf16_f32 v160, v16, v17
    v_mfma_f32_16x16x32_bf16 v[112:115], v[36:39], a[196:199], v[112:115]
    v_exp_f32 v16, v96
    v_mfma_f32_16x16x32_bf16 v[116:119], v[32:35], a[216:219], v[132:135]
    v_add_f32 v5, v5, v18
    v_cvt_f32_i32 v228, v228
    v_mfma_f32_16x16x32_bf16 v[116:119], v[36:39], a[220:223], v[116:119]
    v_add_f32 v5, v5, v19
    v_add_u32 v1, s3, v1
    v_mfma_f32_16x16x32_bf16 v[120:123], v[32:35], a[240:243], v[136:139]
    ds_read_b128 v[28:31], v3 offset:18560
    v_mfma_f32_16x16x32_bf16 v[120:123], v[36:39], a[244:247], v[120:123]
    buffer_load_dwordx4 v4, s[4:7], s32 offen offset:0 sc1 lds
    v_mfma_f32_16x16x32_bf16 v[124:127], v[32:35], v[200:203], v[140:143]
    v_exp_f32 v17, v97
    v_mfma_f32_16x16x32_bf16 v[124:127], v[36:39], v[204:207], v[124:127]
    s_waitcnt lgkmcnt(2)
    v_cvt_pk_bf16_f32 v161, v18, v19
    v_cvt_f32_i32 v229, v229
    v_mfma_f32_16x16x32_bf16 v[176:179], v[40:43], a[200:203], v[176:179]
    ds_read_b128 v[32:35], v2 offset:12544
    v_mfma_f32_16x16x32_bf16 v[176:179], v[44:47], a[204:207], v[176:179]
    buffer_load_dwordx4 v4, s[4:7], s32 offen offset:1024 sc1 lds
    v_mfma_f32_16x16x32_bf16 v[180:183], v[40:43], a[224:227], v[180:183]
    v_exp_f32 v18, v98
    v_mfma_f32_16x16x32_bf16 v[180:183], v[44:47], a[228:231], v[180:183]
    v_add_f32 v5, v5, v16
    v_add_f32 v5, v5, v17
    v_mfma_f32_16x16x32_bf16 v[184:187], v[40:43], a[248:251], v[184:187]
    ds_read_b128 v[36:39], v3 offset:12544
    v_fma_f32 v228, v228, v48, v50
    v_mfma_f32_16x16x32_bf16 v[184:187], v[44:47], a[252:255], v[184:187]
    buffer_load_dwordx4 v4, s[4:7], s32 offen offset:2048 sc1 lds
    v_mfma_f32_16x16x32_bf16 v[188:191], v[40:43], v[208:211], v[188:191]
    v_exp_f32 v19, v99
    v_mfma_f32_16x16x32_bf16 v[188:191], v[44:47], v[212:215], v[188:191]
    s_waitcnt lgkmcnt(2)
    v_cvt_pk_bf16_f32 v162, v16, v17
    v_fma_f32 v229, v229, v49, v51
    v_mfma_f32_16x16x32_bf16 v[112:115], v[24:27], a[200:203], v[112:115]
    ds_read_b128 v[40:43], v2 offset:18688
    v_mfma_f32_16x16x32_bf16 v[112:115], v[28:31], a[204:207], v[112:115]
    v_exp_f32 v16, v164
    v_mfma_f32_16x16x32_bf16 v[116:119], v[24:27], a[224:227], v[116:119]
    v_add_f32 v5, v5, v18
    v_add_f32 v5, v5, v19
    v_mfma_f32_16x16x32_bf16 v[116:119], v[28:31], a[228:231], v[116:119]
    s_add_u32 s32, s32, 24576
    v_exp_f32 v17, v165
    v_mfma_f32_16x16x32_bf16 v[120:123], v[24:27], a[248:251], v[120:123]
    s_add_u32 s26, s26, 36864
    ds_read_b128 v[44:47], v3 offset:18688
    v_cvt_pk_bf16_f32 v163, v18, v19
    v_mfma_f32_16x16x32_bf16 v[120:123], v[28:31], a[252:255], v[120:123]
    s_waitcnt lgkmcnt(2)
    v_exp_f32 v18, v166
    v_mfma_f32_16x16x32_bf16 v[124:127], v[24:27], v[208:211], v[124:127]
    s_waitcnt vmcnt(6)
    v_add_f32 v6, v6, v16
    v_add_f32 v6, v6, v17
    v_mfma_f32_16x16x32_bf16 v[124:127], v[28:31], v[212:215], v[124:127]
    s_barrier
    s_sub_u32 s57, s26, 147456
    v_mfma_f32_16x16x32_bf16 v[176:179], v[32:35], a[208:211], v[176:179]
    s_min_u32 s26, s26, s57
    ds_read_b128 v[24:27], v1 offset:0
    v_add_u32 v0, 1, v0
    v_mfma_f32_16x16x32_bf16 v[176:179], v[36:39], a[212:215], v[176:179]
    buffer_store_dword v0, v13, s[20:23], 0 offen offset:32 sc1
    v_mfma_f32_16x16x32_bf16 v[180:183], v[32:35], a[232:235], v[180:183]
    v_exp_f32 v19, v167
    v_mfma_f32_16x16x32_bf16 v[180:183], v[36:39], a[236:239], v[180:183]
    v_cvt_pk_bf16_f32 v164, v16, v17
    v_cvt_pk_bf16_f32 v228, v228, v229
    v_mfma_f32_16x16x32_bf16 v[184:187], v[32:35], v[192:195], v[184:187]
    ds_read_b128 v[28:31], v1 offset:12288
    v_cvt_f32_i32 v232, v232
    v_mfma_f32_16x16x32_bf16 v[184:187], v[36:39], v[196:199], v[184:187]
    v_exp_f32 v16, v100
    v_mfma_f32_16x16x32_bf16 v[188:191], v[32:35], v[216:219], v[188:191]
    v_add_f32 v6, v6, v18
    v_add_f32 v6, v6, v19
    v_mfma_f32_16x16x32_bf16 v[188:191], v[36:39], v[220:223], v[188:191]
    s_waitcnt lgkmcnt(2)
    v_exp_f32 v17, v101
    v_mfma_f32_16x16x32_bf16 v[112:115], v[40:43], a[208:211], v[112:115]
    ds_read_b128 v[32:35], v1 offset:1024
    v_cvt_pk_bf16_f32 v165, v18, v19
    v_mfma_f32_16x16x32_bf16 v[112:115], v[44:47], a[212:215], v[112:115]
    v_exp_f32 v18, v102
    v_mfma_f32_16x16x32_bf16 v[116:119], v[40:43], a[232:235], v[116:119]
    v_add_f32 v6, v6, v16
    v_add_f32 v6, v6, v17
    v_mfma_f32_16x16x32_bf16 v[116:119], v[44:47], a[236:239], v[116:119]
    v_exp_f32 v19, v103
    v_mfma_f32_16x16x32_bf16 v[120:123], v[40:43], v[192:195], v[120:123]
    ds_read_b128 v[36:39], v1 offset:13312
    v_cvt_pk_bf16_f32 v166, v16, v17
    v_mfma_f32_16x16x32_bf16 v[120:123], v[44:47], v[196:199], v[120:123]
    v_add_f32 v6, v6, v18
    v_cvt_f32_i32 v233, v233
    v_mfma_f32_16x16x32_bf16 v[124:127], v[40:43], v[216:219], v[124:127]
    v_add_f32 v6, v6, v19
    v_cvt_pk_bf16_f32 v167, v18, v19
    v_mfma_f32_16x16x32_bf16 v[124:127], v[44:47], v[220:223], v[124:127]
    s_waitcnt lgkmcnt(2)
    v_mfma_f32_16x16x32_bf16 a[0:3], v[64:67], v[24:27], a[0:3]
    s_mov_b32 m0, s26
    ds_read_b128 v[40:43], v1 offset:2048
    v_fma_f32 v232, v232, v48, v50
    v_mfma_f32_16x16x32_bf16 a[0:3], v[80:83], v[28:31], a[0:3]
    buffer_load_dwordx2 v[60:61], v10, s[72:75], s36 offen offset:192
    v_mfma_f32_16x16x32_bf16 a[48:51], v[68:71], v[24:27], a[48:51]
    v_exp_f32 v16, v168
    v_mfma_f32_16x16x32_bf16 a[48:51], v[84:87], v[28:31], a[48:51]
    v_exp_f32 v17, v169
    v_mfma_f32_16x16x32_bf16 a[96:99], v[72:75], v[24:27], a[96:99]
    ds_read_b128 v[44:47], v1 offset:14336
    v_fma_f32 v233, v233, v49, v51
    v_mfma_f32_16x16x32_bf16 a[96:99], v[88:91], v[28:31], a[96:99]
    buffer_load_dwordx4 v4, s[4:7], s32 offen offset:0 sc1 lds
    v_mfma_f32_16x16x32_bf16 a[144:147], v[76:79], v[24:27], a[144:147]
    v_exp_f32 v18, v170
    v_mfma_f32_16x16x32_bf16 a[144:147], v[92:95], v[28:31], a[144:147]
    s_waitcnt lgkmcnt(2)
    v_add_f32 v7, v7, v16
    v_add_f32 v7, v7, v17
    v_mfma_f32_16x16x32_bf16 a[4:7], v[64:67], v[32:35], a[4:7]
    ds_read_b128 v[24:27], v1 offset:3072
    v_cvt_pk_bf16_f32 v232, v232, v233
    v_mfma_f32_16x16x32_bf16 a[4:7], v[80:83], v[36:39], a[4:7]
    buffer_load_dwordx2 v[62:63], v10, s[76:79], s36 offen offset:192
    v_mfma_f32_16x16x32_bf16 a[52:55], v[68:71], v[32:35], a[52:55]
    v_exp_f32 v19, v171
    v_mfma_f32_16x16x32_bf16 a[52:55], v[84:87], v[36:39], a[52:55]
    v_cvt_pk_bf16_f32 v168, v16, v17
    v_cvt_f32_i32 v236, v236
    v_mfma_f32_16x16x32_bf16 a[100:103], v[72:75], v[32:35], a[100:103]
    ds_read_b128 v[28:31], v1 offset:15360
    v_cvt_f32_i32 v237, v237
    v_mfma_f32_16x16x32_bf16 a[100:103], v[88:91], v[36:39], a[100:103]
    buffer_load_dwordx4 v[240:243], v9, s[64:67], s33 offen offset:384 nt
    v_mfma_f32_16x16x32_bf16 a[148:151], v[76:79], v[32:35], a[148:151]
    v_exp_f32 v16, v104
    v_mfma_f32_16x16x32_bf16 a[148:151], v[92:95], v[36:39], a[148:151]
    s_waitcnt lgkmcnt(2)
    v_add_f32 v7, v7, v18
    v_add_f32 v7, v7, v19
    v_mfma_f32_16x16x32_bf16 a[8:11], v[64:67], v[40:43], a[8:11]
    ds_read_b128 v[32:35], v1 offset:4096
    v_fma_f32 v236, v236, v48, v50
    v_mfma_f32_16x16x32_bf16 a[8:11], v[80:83], v[44:47], a[8:11]
    buffer_load_dwordx4 v4, s[4:7], s32 offen offset:1024 sc1 lds
    v_mfma_f32_16x16x32_bf16 a[56:59], v[68:71], v[40:43], a[56:59]
    v_exp_f32 v17, v105
    v_mfma_f32_16x16x32_bf16 a[56:59], v[84:87], v[44:47], a[56:59]
    v_cvt_pk_bf16_f32 v169, v18, v19
    v_fma_f32 v237, v237, v49, v51
    v_mfma_f32_16x16x32_bf16 a[104:107], v[72:75], v[40:43], a[104:107]
    ds_read_b128 v[36:39], v1 offset:16384
    v_mfma_f32_16x16x32_bf16 a[104:107], v[88:91], v[44:47], a[104:107]
    buffer_load_dwordx4 v[244:247], v9, s[64:67], s33 offen offset:1920 nt
    v_mfma_f32_16x16x32_bf16 a[152:155], v[76:79], v[40:43], a[152:155]
    v_exp_f32 v18, v106
    v_mfma_f32_16x16x32_bf16 a[152:155], v[92:95], v[44:47], a[152:155]
    s_waitcnt lgkmcnt(2)
    v_add_f32 v7, v7, v16
    v_add_f32 v7, v7, v17
    v_mfma_f32_16x16x32_bf16 a[12:15], v[64:67], v[24:27], a[12:15]
    ds_read_b128 v[40:43], v1 offset:5120
    v_cvt_pk_bf16_f32 v236, v236, v237
    v_mfma_f32_16x16x32_bf16 a[12:15], v[80:83], v[28:31], a[12:15]
    buffer_load_dwordx4 v4, s[4:7], s32 offen offset:2048 sc1 lds
    v_mfma_f32_16x16x32_bf16 a[60:63], v[68:71], v[24:27], a[60:63]
    v_exp_f32 v19, v107
    v_mfma_f32_16x16x32_bf16 a[60:63], v[84:87], v[28:31], a[60:63]
    v_cvt_pk_bf16_f32 v170, v16, v17
    v_exp_f32 v16, v172
    v_mfma_f32_16x16x32_bf16 a[108:111], v[72:75], v[24:27], a[108:111]
    ds_read_b128 v[44:47], v1 offset:17408
    v_add_f32 v7, v7, v18
    v_mfma_f32_16x16x32_bf16 a[108:111], v[88:91], v[28:31], a[108:111]
    buffer_load_dwordx4 v[248:251], v9, s[64:67], s34 offen offset:384 nt
    v_add_f32 v7, v7, v19
    v_mfma_f32_16x16x32_bf16 a[156:159], v[76:79], v[24:27], a[156:159]
    s_add_u32 s29, s28, 49152
    v_exp_f32 v17, v173
    v_mfma_f32_16x16x32_bf16 a[156:159], v[92:95], v[28:31], a[156:159]
    s_waitcnt lgkmcnt(2)
    v_cvt_pk_bf16_f32 v171, v18, v19
    v_lshlrev_b32 v48, 16, v57
    v_mfma_f32_16x16x32_bf16 a[16:19], v[64:67], v[32:35], a[16:19]
    s_sub_u32 s3, s29, 147456
    ds_read_b128 v[24:27], v1 offset:6144
    v_and_b32 v49, s97, v57
    v_mfma_f32_16x16x32_bf16 a[16:19], v[80:83], v[36:39], a[16:19]
    s_add_u32 s32, s32, 24576
    buffer_load_dwordx4 v[252:255], v9, s[64:67], s34 offen offset:1920 nt
    v_mfma_f32_16x16x32_bf16 a[64:67], v[68:71], v[32:35], a[64:67]
    s_min_u32 s29, s29, s3
    v_exp_f32 v18, v174
    v_mfma_f32_16x16x32_bf16 a[64:67], v[84:87], v[36:39], a[64:67]
    v_add_f32 v8, v8, v16
    v_add_f32 v8, v8, v17
    v_mfma_f32_16x16x32_bf16 a[112:115], v[72:75], v[32:35], a[112:115]
    s_add_u32 s26, s26, 12288
    ds_read_b128 v[28:31], v1 offset:18432
    v_lshlrev_b32 v50, 16, v59
    v_mfma_f32_16x16x32_bf16 a[112:115], v[88:91], v[36:39], a[112:115]
    v_exp_f32 v19, v175
    v_cvt_pk_bf16_f32 v172, v16, v17
    v_mfma_f32_16x16x32_bf16 a[160:163], v[76:79], v[32:35], a[160:163]
    v_exp_f32 v16, v108
    v_mfma_f32_16x16x32_bf16 a[160:163], v[92:95], v[36:39], a[160:163]
    s_waitcnt lgkmcnt(2)
    v_add_f32 v8, v8, v18
    v_add_f32 v8, v8, v19
    v_mfma_f32_16x16x32_bf16 a[20:23], v[64:67], v[40:43], a[20:23]
    s_sub_u32 s3, s29, s28
    ds_read_b128 v[32:35], v1 offset:7168
    v_and_b32 v51, s97, v59
    v_mfma_f32_16x16x32_bf16 a[20:23], v[80:83], v[44:47], a[20:23]
    v_exp_f32 v17, v109
    v_mfma_f32_16x16x32_bf16 a[68:71], v[68:71], v[40:43], a[68:71]
    s_mov_b32 m0, s26
    v_cvt_pk_bf16_f32 v173, v18, v19
    v_mul_f32 v48, s38, v48
    v_mfma_f32_16x16x32_bf16 a[68:71], v[84:87], v[44:47], a[68:71]
    v_exp_f32 v18, v110
    v_mfma_f32_16x16x32_bf16 a[116:119], v[72:75], v[40:43], a[116:119]
    ds_read_b128 v[36:39], v1 offset:19456
    v_add_f32 v8, v8, v16
    v_mfma_f32_16x16x32_bf16 a[116:119], v[88:91], v[44:47], a[116:119]
    v_add_f32 v8, v8, v17
    v_mul_f32 v49, s38, v49
    v_mfma_f32_16x16x32_bf16 a[164:167], v[76:79], v[40:43], a[164:167]
    s_mov_b32 s28, s29
    v_exp_f32 v19, v111
    v_mfma_f32_16x16x32_bf16 a[164:167], v[92:95], v[44:47], a[164:167]
    s_waitcnt lgkmcnt(2)
    v_cvt_pk_bf16_f32 v174, v16, v17
    v_add_f32 v8, v8, v18
    v_mfma_f32_16x16x32_bf16 a[24:27], v[64:67], v[24:27], a[24:27]
    ds_read_b128 v[40:43], v1 offset:8192
    v_add_f32 v8, v8, v19
    v_mfma_f32_16x16x32_bf16 a[24:27], v[80:83], v[28:31], a[24:27]
    v_cvt_pk_bf16_f32 v175, v18, v19
    v_mul_f32_e64 v50, -v50, v48
    v_mfma_f32_16x16x32_bf16 a[72:75], v[68:71], v[24:27], a[72:75]
    v_exp_f32 v16, v176
    v_mfma_f32_16x16x32_bf16 a[72:75], v[84:87], v[28:31], a[72:75]
    buffer_load_dwordx4 v4, s[4:7], s32 offen offset:0 sc1 lds
    v_mfma_f32_16x16x32_bf16 a[120:123], v[72:75], v[24:27], a[120:123]
    ds_read_b128 v[44:47], v1 offset:20480
    v_mfma_f32_16x16x32_bf16 a[120:123], v[88:91], v[28:31], a[120:123]
    v_exp_f32 v17, v177
    v_mfma_f32_16x16x32_bf16 a[168:171], v[76:79], v[24:27], a[168:171]
    v_exp_f32 v18, v178
    v_mfma_f32_16x16x32_bf16 a[168:171], v[92:95], v[28:31], a[168:171]
    s_waitcnt lgkmcnt(2)
    v_add_f32 v5, v5, v16
    v_add_f32 v5, v5, v17
    v_mfma_f32_16x16x32_bf16 a[28:31], v[64:67], v[32:35], a[28:31]
    ds_read_b128 v[24:27], v1 offset:9216
    v_mul_f32_e64 v51, -v51, v49
    v_mfma_f32_16x16x32_bf16 a[28:31], v[80:83], v[36:39], a[28:31]
L_pg6:
    s_cbranch_execz L_pg10
    v_exp_f32 v19, v179
    v_mfma_f32_16x16x32_bf16 a[76:79], v[68:71], v[32:35], a[76:79]
    v_cvt_pk_bf16_f32 v176, v16, v17
    v_add_u32 v2, s3, v2
    v_mfma_f32_16x16x32_bf16 a[76:79], v[84:87], v[36:39], a[76:79]
    v_exp_f32 v16, v112
    v_mfma_f32_16x16x32_bf16 a[124:127], v[72:75], v[32:35], a[124:127]
    ds_read_b128 v[28:31], v1 offset:21504
    v_add_f32 v5, v5, v18
    v_mfma_f32_16x16x32_bf16 a[124:127], v[88:91], v[36:39], a[124:127]
    v_add_f32 v5, v5, v19
    v_cvt_f32_i32 v226, v226
    v_mfma_f32_16x16x32_bf16 a[172:175], v[76:79], v[32:35], a[172:175]
    v_exp_f32 v17, v113
    v_mfma_f32_16x16x32_bf16 a[172:175], v[92:95], v[36:39], a[172:175]
    s_waitcnt lgkmcnt(2)
    buffer_load_dwordx4 v4, s[4:7], s32 offen offset:1024 sc1 lds
    v_mfma_f32_16x16x32_bf16 a[32:35], v[64:67], v[40:43], a[32:35]
    ds_read_b128 v[32:35], v1 offset:10240
    v_cvt_pk_bf16_f32 v177, v18, v19
    v_mfma_f32_16x16x32_bf16 a[32:35], v[80:83], v[44:47], a[32:35]
    v_exp_f32 v18, v114
    v_mfma_f32_16x16x32_bf16 a[80:83], v[68:71], v[40:43], a[80:83]
    v_add_f32 v5, v5, v16
    v_add_f32 v5, v5, v17
    v_mfma_f32_16x16x32_bf16 a[80:83], v[84:87], v[44:47], a[80:83]
    v_exp_f32 v19, v115
    v_mfma_f32_16x16x32_bf16 a[128:131], v[72:75], v[40:43], a[128:131]
    ds_read_b128 v[36:39], v1 offset:22528
    v_cvt_pk_bf16_f32 v178, v16, v17
    v_mfma_f32_16x16x32_bf16 a[128:131], v[88:91], v[44:47], a[128:131]
    v_exp_f32 v16, v180
    v_mfma_f32_16x16x32_bf16 a[176:179], v[76:79], v[40:43], a[176:179]
    v_cvt_f32_i32 v227, v227
    v_add_u32 v3, s3, v3
    v_mfma_f32_16x16x32_bf16 a[176:179], v[92:95], v[44:47], a[176:179]
    s_waitcnt lgkmcnt(2)
    v_add_f32 v5, v5, v18
    v_add_f32 v5, v5, v19
    v_mfma_f32_16x16x32_bf16 a[36:39], v[64:67], v[24:27], a[36:39]
    ds_read_b128 v[40:43], v1 offset:11264
    v_fma_f32 v226, v226, v48, v50
    v_mfma_f32_16x16x32_bf16 a[36:39], v[80:83], v[28:31], a[36:39]
    buffer_load_dwordx4 v4, s[4:7], s32 offen offset:2048 sc1 lds
    v_mfma_f32_16x16x32_bf16 a[84:87], v[68:71], v[24:27], a[84:87]
    v_exp_f32 v17, v181
    v_mfma_f32_16x16x32_bf16 a[84:87], v[84:87], v[28:31], a[84:87]
    v_cvt_pk_bf16_f32 v179, v18, v19
    v_fma_f32 v227, v227, v49, v51
    v_mfma_f32_16x16x32_bf16 a[132:135], v[72:75], v[24:27], a[132:135]
    ds_read_b128 v[44:47], v1 offset:23552
    v_cvt_pk_bf16_f32 v225, v226, v227
    v_mfma_f32_16x16x32_bf16 a[132:135], v[88:91], v[28:31], a[132:135]
    s_waitcnt lgkmcnt(2)
    v_exp_f32 v18, v182
    v_mfma_f32_16x16x32_bf16 a[180:183], v[76:79], v[24:27], a[180:183]
    s_waitcnt vmcnt(13)
    v_add_f32 v6, v6, v16
    v_add_f32 v6, v6, v17
    v_mfma_f32_16x16x32_bf16 a[180:183], v[92:95], v[28:31], a[180:183]
    s_barrier
    v_cvt_f32_i32 v230, v230
    v_mfma_f32_16x16x32_bf16 a[40:43], v[64:67], v[32:35], a[40:43]
    ds_read_b128 v[24:27], v2 offset:0
    v_mfma_f32_16x16x32_bf16 a[40:43], v[80:83], v[36:39], a[40:43]
    v_exp_f32 v19, v183
    v_mfma_f32_16x16x32_bf16 a[88:91], v[68:71], v[32:35], a[88:91]
    v_cvt_pk_bf16_f32 v180, v16, v17
    v_cvt_f32_i32 v231, v231
    v_mfma_f32_16x16x32_bf16 a[88:91], v[84:87], v[36:39], a[88:91]
    v_exp_f32 v16, v116
    v_mfma_f32_16x16x32_bf16 a[136:139], v[72:75], v[32:35], a[136:139]
    ds_read_b128 v[28:31], v3 offset:0
    v_add_f32 v6, v6, v18
    v_mfma_f32_16x16x32_bf16 a[136:139], v[88:91], v[36:39], a[136:139]
    v_add_f32 v6, v6, v19
    v_fma_f32 v230, v230, v48, v50
    v_mfma_f32_16x16x32_bf16 a[184:187], v[76:79], v[32:35], a[184:187]
    v_exp_f32 v17, v117
    v_mfma_f32_16x16x32_bf16 a[184:187], v[92:95], v[36:39], a[184:187]
    s_waitcnt lgkmcnt(2)
    v_cvt_pk_bf16_f32 v181, v18, v19
    v_mfma_f32_16x16x32_bf16 a[44:47], v[64:67], v[40:43], a[44:47]
    ds_read_b128 v[32:35], v2 offset:6144
    v_mfma_f32_16x16x32_bf16 a[44:47], v[80:83], v[44:47], a[44:47]
    v_exp_f32 v18, v118
    v_mfma_f32_16x16x32_bf16 a[92:95], v[68:71], v[40:43], a[92:95]
    v_add_f32 v6, v6, v16
    v_add_f32 v6, v6, v17
    v_mfma_f32_16x16x32_bf16 a[92:95], v[84:87], v[44:47], a[92:95]
    s_add_u32 s32, s32, 24576
    v_exp_f32 v19, v119
    v_mfma_f32_16x16x32_bf16 a[140:143], v[72:75], v[40:43], a[140:143]
    s_add_u32 s26, s26, 36864
    ds_read_b128 v[36:39], v3 offset:6144
    v_cvt_pk_bf16_f32 v182, v16, v17
    v_mfma_f32_16x16x32_bf16 a[140:143], v[88:91], v[44:47], a[140:143]
    s_sub_u32 s57, s26, 147456
    v_add_f32 v6, v6, v18
    v_add_f32 v6, v6, v19
    v_mfma_f32_16x16x32_bf16 a[188:191], v[76:79], v[40:43], a[188:191]
    s_min_u32 s26, s26, s57
    v_cvt_pk_bf16_f32 v183, v18, v19
    v_mfma_f32_16x16x32_bf16 a[188:191], v[92:95], v[44:47], a[188:191]
    s_waitcnt lgkmcnt(2)
    v_mfma_f32_16x16x32_bf16 v[64:67], v[24:27], a[192:195], v[128:131]
    ds_read_b128 v[40:43], v2 offset:128
    v_fma_f32 v231, v231, v49, v51
    v_mfma_f32_16x16x32_bf16 v[64:67], v[28:31], a[196:199], v[64:67]
    v_exp_f32 v16, v184
    v_mfma_f32_16x16x32_bf16 v[68:71], v[24:27], a[216:219], v[132:135]
    v_exp_f32 v17, v185
    v_mfma_f32_16x16x32_bf16 v[68:71], v[28:31], a[220:223], v[68:71]
    v_bfe_u32 v53, v4, 4, 6
    v_cvt_pk_bf16_f32 v229, v230, v231
    v_mfma_f32_16x16x32_bf16 v[72:75], v[24:27], a[240:243], v[136:139]
    ds_read_b128 v[44:47], v3 offset:128
    v_lshlrev_b32 v53, 2, v53
    v_mfma_f32_16x16x32_bf16 v[72:75], v[28:31], a[244:247], v[72:75]
    buffer_load_dword v52, v53, s[20:23], s44 offen sc1
    v_mfma_f32_16x16x32_bf16 v[76:79], v[24:27], v[200:203], v[140:143]
    v_exp_f32 v18, v186
    v_mfma_f32_16x16x32_bf16 v[76:79], v[28:31], v[204:207], v[76:79]
    s_waitcnt lgkmcnt(2)
    v_add_f32 v7, v7, v16
    v_add_f32 v7, v7, v17
    v_mfma_f32_16x16x32_bf16 v[96:99], v[32:35], a[192:195], v[128:131]
    ds_read_b128 v[24:27], v2 offset:6272
    v_cvt_f32_i32 v234, v234
    v_mfma_f32_16x16x32_bf16 v[96:99], v[36:39], a[196:199], v[96:99]
    v_exp_f32 v19, v187
    v_mfma_f32_16x16x32_bf16 v[100:103], v[32:35], a[216:219], v[132:135]
    v_cvt_pk_bf16_f32 v184, v16, v17
    v_cvt_f32_i32 v235, v235
    v_mfma_f32_16x16x32_bf16 v[100:103], v[36:39], a[220:223], v[100:103]
    s_add_u32 s35, s35, 196608
    v_exp_f32 v16, v120
    v_mfma_f32_16x16x32_bf16 v[104:107], v[32:35], a[240:243], v[136:139]
    s_mov_b32 m0, s26
    ds_read_b128 v[28:31], v3 offset:6272
    v_add_f32 v7, v7, v18
    v_mfma_f32_16x16x32_bf16 v[104:107], v[36:39], a[244:247], v[104:107]
    s_add_u32 s16, s16, 196608
    buffer_load_dwordx4 v4, s[4:7], s32 offen offset:0 sc1 lds
    v_mfma_f32_16x16x32_bf16 v[108:111], v[32:35], v[200:203], v[140:143]
    s_add_u32 s17, s17, 196608
    v_add_f32 v7, v7, v19
    v_fma_f32 v234, v234, v48, v50
    v_mfma_f32_16x16x32_bf16 v[108:111], v[36:39], v[204:207], v[108:111]
    s_waitcnt lgkmcnt(2)
    v_exp_f32 v17, v121
    v_mfma_f32_16x16x32_bf16 v[64:67], v[40:43], a[200:203], v[64:67]
    s_add_u32 s37, s37, 512
    ds_read_b128 v[32:35], v2 offset:256
    v_cvt_pk_bf16_f32 v185, v18, v19
    v_mfma_f32_16x16x32_bf16 v[64:67], v[44:47], a[204:207], v[64:67]
    v_exp_f32 v18, v122
    v_mfma_f32_16x16x32_bf16 v[68:71], v[40:43], a[224:227], v[68:71]
    v_add_f32 v7, v7, v16
    v_add_f32 v7, v7, v17
    v_mfma_f32_16x16x32_bf16 v[68:71], v[44:47], a[228:231], v[68:71]
    v_exp_f32 v19, v123
    v_mfma_f32_16x16x32_bf16 v[72:75], v[40:43], a[248:251], v[72:75]
    ds_read_b128 v[36:39], v3 offset:256
    v_cvt_pk_bf16_f32 v186, v16, v17
    v_mfma_f32_16x16x32_bf16 v[72:75], v[44:47], a[252:255], v[72:75]
    buffer_load_dwordx4 v4, s[4:7], s32 offen offset:1024 sc1 lds
    v_mfma_f32_16x16x32_bf16 v[76:79], v[40:43], v[208:211], v[76:79]
    v_exp_f32 v16, v188
    v_mfma_f32_16x16x32_bf16 v[76:79], v[44:47], v[212:215], v[76:79]
    s_waitcnt lgkmcnt(2)
    v_add_f32 v7, v7, v18
    v_add_f32 v7, v7, v19
    v_mfma_f32_16x16x32_bf16 v[96:99], v[24:27], a[200:203], v[96:99]
    ds_read_b128 v[40:43], v2 offset:6400
    v_fma_f32 v235, v235, v49, v51
    v_mfma_f32_16x16x32_bf16 v[96:99], v[28:31], a[204:207], v[96:99]
    buffer_load_dwordx2 v[56:57], off, s[80:83], s37 offset:0
    v_mfma_f32_16x16x32_bf16 v[100:103], v[24:27], a[224:227], v[100:103]
    v_exp_f32 v17, v189
    v_mfma_f32_16x16x32_bf16 v[100:103], v[28:31], a[228:231], v[100:103]
    v_cvt_pk_bf16_f32 v187, v18, v19
    v_cvt_pk_bf16_f32 v233, v234, v235
    v_mfma_f32_16x16x32_bf16 v[104:107], v[24:27], a[248:251], v[104:107]
    ds_read_b128 v[44:47], v3 offset:6400
    v_cvt_f32_i32 v238, v238
    v_mfma_f32_16x16x32_bf16 v[104:107], v[28:31], a[252:255], v[104:107]
    buffer_load_dwordx2 v[58:59], off, s[84:87], s37 offset:0
    v_mfma_f32_16x16x32_bf16 v[108:111], v[24:27], v[208:211], v[108:111]
    s_add_u32 s29, s30, 49152
    v_exp_f32 v18, v190
    v_mfma_f32_16x16x32_bf16 v[108:111], v[28:31], v[212:215], v[108:111]
    s_waitcnt lgkmcnt(2)
    v_add_f32 v8, v8, v16
    v_add_f32 v8, v8, v17
    v_mfma_f32_16x16x32_bf16 v[64:67], v[32:35], a[208:211], v[64:67]
    s_sub_u32 s3, s29, 147456
    ds_read_b128 v[24:27], v2 offset:12288
    v_mfma_f32_16x16x32_bf16 v[64:67], v[36:39], a[212:215], v[64:67]
    s_min_u32 s29, s29, s3
    buffer_load_dwordx4 v4, s[4:7], s32 offen offset:2048 sc1 lds
    v_mfma_f32_16x16x32_bf16 v[68:71], v[32:35], a[232:235], v[68:71]
    v_exp_f32 v19, v191
    v_mfma_f32_16x16x32_bf16 v[68:71], v[36:39], a[236:239], v[68:71]
    v_cvt_pk_bf16_f32 v188, v16, v17
    v_cvt_f32_i32 v239, v239
    v_mfma_f32_16x16x32_bf16 v[72:75], v[32:35], v[192:195], v[72:75]
    ds_read_b128 v[28:31], v3 offset:12288
    v_mfma_f32_16x16x32_bf16 v[72:75], v[36:39], v[196:199], v[72:75]
    buffer_load_dwordx3 v[144:146], v12, s[68:71], s35 offen offset:0 nt
    v_mfma_f32_16x16x32_bf16 v[76:79], v[32:35], v[216:219], v[76:79]
    v_exp_f32 v16, v124
    v_mfma_f32_16x16x32_bf16 v[76:79], v[36:39], v[220:223], v[76:79]
    s_waitcnt lgkmcnt(2)
    v_add_f32 v8, v8, v18
    v_add_f32 v8, v8, v19
    v_mfma_f32_16x16x32_bf16 v[96:99], v[40:43], a[208:211], v[96:99]
    s_add_u32 s32, s32, 24576
    ds_read_b128 v[32:35], v2 offset:18432
    v_fma_f32 v238, v238, v48, v50
    v_mfma_f32_16x16x32_bf16 v[96:99], v[44:47], a[212:215], v[96:99]
    s_sub_u32 s3, s29, s30
    v_exp_f32 v17, v125
    v_mfma_f32_16x16x32_bf16 v[100:103], v[40:43], a[232:235], v[100:103]
    v_cvt_pk_bf16_f32 v189, v18, v19
    v_mfma_f32_16x16x32_bf16 v[100:103], v[44:47], a[236:239], v[100:103]
    v_exp_f32 v18, v126
    v_mfma_f32_16x16x32_bf16 v[104:107], v[40:43], v[192:195], v[104:107]
    s_add_u32 s26, s26, 12288
    ds_read_b128 v[36:39], v3 offset:18432
    v_add_f32 v8, v8, v16
    v_mfma_f32_16x16x32_bf16 v[104:107], v[44:47], v[196:199], v[104:107]
    buffer_load_dwordx3 v[148:150], v12, s[68:71], s35 offen offset:768 nt
    v_mfma_f32_16x16x32_bf16 v[108:111], v[40:43], v[216:219], v[108:111]
    v_add_f32 v8, v8, v17
    v_fma_f32 v239, v239, v49, v51
    v_mfma_f32_16x16x32_bf16 v[108:111], v[44:47], v[220:223], v[108:111]
    s_waitcnt lgkmcnt(2)
    v_exp_f32 v19, v127
    v_mfma_f32_16x16x32_bf16 v[80:83], v[24:27], a[192:195], v[128:131]
    ds_read_b128 v[40:43], v2 offset:12416
    v_cvt_pk_bf16_f32 v190, v16, v17
    v_mfma_f32_16x16x32_bf16 v[80:83], v[28:31], a[196:199], v[80:83]
    s_mov_b32 m0, s26
    v_add_f32 v8, v8, v18
    v_add_f32 v8, v8, v19
    v_mfma_f32_16x16x32_bf16 v[84:87], v[24:27], a[216:219], v[132:135]
    s_mov_b32 s30, s29
    v_cvt_pk_bf16_f32 v191, v18, v19
    v_cvt_pk_bf16_f32 v237, v238, v239
    v_mfma_f32_16x16x32_bf16 v[84:87], v[28:31], a[220:223], v[84:87]
    v_exp_f32 v16, v64
    v_mfma_f32_16x16x32_bf16 v[88:91], v[24:27], a[240:243], v[136:139]
    ds_read_b128 v[44:47], v3 offset:12416
    v_mfma_f32_16x16x32_bf16 v[88:91], v[28:31], a[244:247], v[88:91]
    buffer_load_dwordx3 v[152:154], v12, s[68:71], s35 offen offset:1536 nt
    v_mfma_f32_16x16x32_bf16 v[92:95], v[24:27], v[200:203], v[140:143]
    v_exp_f32 v17, v65
    v_mfma_f32_16x16x32_bf16 v[92:95], v[28:31], v[204:207], v[92:95]
    s_waitcnt lgkmcnt(2)
    v_exp_f32 v18, v66
    v_mfma_f32_16x16x32_bf16 v[112:115], v[32:35], a[192:195], v[128:131]
    ds_read_b128 v[24:27], v2 offset:18560
    v_add_f32 v5, v5, v16
    v_mfma_f32_16x16x32_bf16 v[112:115], v[36:39], a[196:199], v[112:115]
    buffer_load_dwordx4 v4, s[4:7], s32 offen offset:0 sc1 lds
    v_mfma_f32_16x16x32_bf16 v[116:119], v[32:35], a[216:219], v[132:135]
    v_add_f32 v5, v5, v17
    v_add_u32 v1, s3, v1
    v_mfma_f32_16x16x32_bf16 v[116:119], v[36:39], a[220:223], v[116:119]
    v_exp_f32 v19, v67
    v_mfma_f32_16x16x32_bf16 v[120:123], v[32:35], a[240:243], v[136:139]
    ds_read_b128 v[28:31], v3 offset:18560
    v_cvt_pk_bf16_f32 v64, v16, v17
    v_mfma_f32_16x16x32_bf16 v[120:123], v[36:39], a[244:247], v[120:123]
    s_waitcnt vmcnt(13)
    buffer_load_dwordx3 v[156:158], v12, s[68:71], s35 offen offset:2304 nt
    v_mfma_f32_16x16x32_bf16 v[124:127], v[32:35], v[200:203], v[140:143]
    v_exp_f32 v16, v96
    v_mfma_f32_16x16x32_bf16 v[124:127], v[36:39], v[204:207], v[124:127]
    s_waitcnt lgkmcnt(2)
    v_add_f32 v5, v5, v18
    v_add_f32 v5, v5, v19
    v_mfma_f32_16x16x32_bf16 v[80:83], v[40:43], a[200:203], v[80:83]
    ds_read_b128 v[32:35], v2 offset:12544
    v_lshlrev_b32 v48, 16, v60
    v_mfma_f32_16x16x32_bf16 v[80:83], v[44:47], a[204:207], v[80:83]
    v_exp_f32 v17, v97
    v_mfma_f32_16x16x32_bf16 v[84:87], v[40:43], a[224:227], v[84:87]
    v_cvt_pk_bf16_f32 v65, v18, v19
    v_and_b32 v49, s97, v60
    v_mfma_f32_16x16x32_bf16 v[84:87], v[44:47], a[228:231], v[84:87]
    buffer_load_dwordx4 v4, s[4:7], s32 offen offset:1024 sc1 lds
    v_mfma_f32_16x16x32_bf16 v[88:91], v[40:43], a[248:251], v[88:91]
    ds_read_b128 v[36:39], v3 offset:12544
    v_mfma_f32_16x16x32_bf16 v[88:91], v[44:47], a[252:255], v[88:91]
    v_exp_f32 v18, v98
    v_mfma_f32_16x16x32_bf16 v[92:95], v[40:43], v[208:211], v[92:95]
    v_add_f32 v5, v5, v16
    v_add_f32 v5, v5, v17
    v_mfma_f32_16x16x32_bf16 v[92:95], v[44:47], v[212:215], v[92:95]
    s_waitcnt lgkmcnt(2)
    v_exp_f32 v19, v99
    v_mfma_f32_16x16x32_bf16 v[112:115], v[24:27], a[200:203], v[112:115]
    ds_read_b128 v[40:43], v2 offset:18688
    v_cvt_pk_bf16_f32 v66, v16, v17
    v_mfma_f32_16x16x32_bf16 v[112:115], v[28:31], a[204:207], v[112:115]
    v_exp_f32 v16, v68
    v_mfma_f32_16x16x32_bf16 v[116:119], v[24:27], a[224:227], v[116:119]
    v_add_f32 v5, v5, v18
    v_add_f32 v5, v5, v19
    v_mfma_f32_16x16x32_bf16 v[116:119], v[28:31], a[228:231], v[116:119]
    v_exp_f32 v17, v69
    v_mfma_f32_16x16x32_bf16 v[120:123], v[24:27], a[248:251], v[120:123]
    ds_read_b128 v[44:47], v3 offset:18688
    v_cvt_pk_bf16_f32 v67, v18, v19
    v_mfma_f32_16x16x32_bf16 v[120:123], v[28:31], a[252:255], v[120:123]
    s_waitcnt lgkmcnt(2)
    buffer_load_dwordx4 v4, s[4:7], s32 offen offset:2048 sc1 lds
    v_mfma_f32_16x16x32_bf16 v[124:127], v[24:27], v[208:211], v[124:127]
    s_waitcnt vmcnt(13)
    v_exp_f32 v18, v70
    v_mfma_f32_16x16x32_bf16 v[124:127], v[28:31], v[212:215], v[124:127]
    s_barrier
    v_add_f32 v6, v6, v16
    v_mfma_f32_16x16x32_bf16 v[80:83], v[32:35], a[208:211], v[80:83]
    ds_read_b128 v[24:27], v1 offset:0
    v_add_f32 v6, v6, v17
    v_mfma_f32_16x16x32_bf16 v[80:83], v[36:39], a[212:215], v[80:83]
    v_exp_f32 v19, v71
    v_mfma_f32_16x16x32_bf16 v[84:87], v[32:35], a[232:235], v[84:87]
    v_cvt_pk_bf16_f32 v68, v16, v17
    v_lshlrev_b32 v50, 16, v62
    v_mfma_f32_16x16x32_bf16 v[84:87], v[36:39], a[236:239], v[84:87]
    v_exp_f32 v16, v100
    v_mfma_f32_16x16x32_bf16 v[88:91], v[32:35], v[192:195], v[88:91]
    ds_read_b128 v[28:31], v1 offset:12288
    v_add_f32 v6, v6, v18
    v_mfma_f32_16x16x32_bf16 v[88:91], v[36:39], v[196:199], v[88:91]
    v_add_f32 v6, v6, v19
    v_and_b32 v51, s97, v62
    v_mfma_f32_16x16x32_bf16 v[92:95], v[32:35], v[216:219], v[92:95]
    v_exp_f32 v17, v101
    v_mfma_f32_16x16x32_bf16 v[92:95], v[36:39], v[220:223], v[92:95]
    s_waitcnt lgkmcnt(2)
    v_cvt_pk_bf16_f32 v69, v18, v19
    v_mfma_f32_16x16x32_bf16 v[112:115], v[40:43], a[208:211], v[112:115]
    ds_read_b128 v[32:35], v1 offset:1024
    v_mfma_f32_16x16x32_bf16 v[112:115], v[44:47], a[212:215], v[112:115]
    v_exp_f32 v18, v102
    v_mfma_f32_16x16x32_bf16 v[116:119], v[40:43], a[232:235], v[116:119]
    v_add_f32 v6, v6, v16
    v_add_f32 v6, v6, v17
    v_mfma_f32_16x16x32_bf16 v[116:119], v[44:47], a[236:239], v[116:119]
    v_exp_f32 v19, v103
    v_mfma_f32_16x16x32_bf16 v[120:123], v[40:43], v[192:195], v[120:123]
    ds_read_b128 v[36:39], v1 offset:13312
    v_cvt_pk_bf16_f32 v70, v16, v17
    v_mfma_f32_16x16x32_bf16 v[120:123], v[44:47], v[196:199], v[120:123]
    s_add_u32 s32, s32, 24576
    v_add_f32 v6, v6, v18
    s_add_u32 s26, s26, 36864
    v_mfma_f32_16x16x32_bf16 v[124:127], v[40:43], v[216:219], v[124:127]
    s_sub_u32 s57, s26, 147456
    v_add_f32 v6, v6, v19
    v_cvt_pk_bf16_f32 v71, v18, v19
    v_mfma_f32_16x16x32_bf16 v[124:127], v[44:47], v[220:223], v[124:127]
    s_waitcnt lgkmcnt(2)
    s_min_u32 s26, s26, s57
    v_mfma_f32_16x16x32_bf16 a[0:3], v[160:163], v[24:27], a[0:3]
    ds_read_b128 v[40:43], v1 offset:2048
    v_mul_f32 v48, s38, v48
    v_mfma_f32_16x16x32_bf16 a[0:3], v[176:179], v[28:31], a[0:3]
    s_waitcnt vmcnt(12)
    v_subrev_u32 v52, s92, v52
    v_cmp_lt_u32 vcc, 15, v52
    v_mfma_f32_16x16x32_bf16 a[48:51], v[164:167], v[24:27], a[48:51]
    v_exp_f32 v16, v72
    v_mfma_f32_16x16x32_bf16 a[48:51], v[180:183], v[28:31], a[48:51]
    v_exp_f32 v17, v73
    v_mfma_f32_16x16x32_bf16 a[96:99], v[168:171], v[24:27], a[96:99]
    s_and_b32 s59, vcc_lo, 0xff
    ds_read_b128 v[44:47], v1 offset:14336
    v_mul_f32 v49, s38, v49
    v_mfma_f32_16x16x32_bf16 a[96:99], v[184:187], v[28:31], a[96:99]
    s_cbranch_scc1 L_pollslow2
L_pollok2:
    v_mfma_f32_16x16x32_bf16 a[144:147], v[172:175], v[24:27], a[144:147]
    s_add_u32 s92, s92, 1
    v_exp_f32 v18, v74
    v_mfma_f32_16x16x32_bf16 a[144:147], v[188:191], v[28:31], a[144:147]
    s_waitcnt lgkmcnt(2)
    v_add_f32 v7, v7, v16
    v_add_f32 v7, v7, v17
    v_mfma_f32_16x16x32_bf16 a[4:7], v[160:163], v[32:35], a[4:7]
    s_mov_b32 m0, s56
    ds_read_b128 v[24:27], v1 offset:3072
    v_mul_f32_e64 v50, -v50, v48
    v_mfma_f32_16x16x32_bf16 a[4:7], v[176:179], v[36:39], a[4:7]
    buffer_load_dwordx4 v4, s[4:7], s27 offen offset:0 sc1 lds
    v_mfma_f32_16x16x32_bf16 a[52:55], v[164:167], v[32:35], a[52:55]
    v_exp_f32 v19, v75
    v_mfma_f32_16x16x32_bf16 a[52:55], v[180:183], v[36:39], a[52:55]
    v_cvt_pk_bf16_f32 v72, v16, v17
    v_mul_f32_e64 v51, -v51, v49
    v_mfma_f32_16x16x32_bf16 a[100:103], v[168:171], v[32:35], a[100:103]
    ds_read_b128 v[28:31], v1 offset:15360
    v_cvt_f32_i32 v240, v240
    v_mfma_f32_16x16x32_bf16 a[100:103], v[184:187], v[36:39], a[100:103]
    v_exp_f32 v16, v104
    v_mfma_f32_16x16x32_bf16 a[148:151], v[172:175], v[32:35], a[148:151]
    v_add_f32 v7, v7, v18
    v_add_f32 v7, v7, v19
    v_mfma_f32_16x16x32_bf16 a[148:151], v[188:191], v[36:39], a[148:151]
    s_waitcnt lgkmcnt(2)
    v_exp_f32 v17, v105
    v_mfma_f32_16x16x32_bf16 a[8:11], v[160:163], v[40:43], a[8:11]
    ds_read_b128 v[32:35], v1 offset:4096
    v_cvt_pk_bf16_f32 v73, v18, v19
    v_mfma_f32_16x16x32_bf16 a[8:11], v[176:179], v[44:47], a[8:11]
    buffer_load_dwordx4 v4, s[4:7], s27 offen offset:1024 sc1 lds
    v_mfma_f32_16x16x32_bf16 a[56:59], v[164:167], v[40:43], a[56:59]
    v_exp_f32 v18, v106
    v_mfma_f32_16x16x32_bf16 a[56:59], v[180:183], v[44:47], a[56:59]
    v_add_f32 v7, v7, v16
    v_cvt_f32_i32 v241, v241
    v_mfma_f32_16x16x32_bf16 a[104:107], v[168:171], v[40:43], a[104:107]
    ds_read_b128 v[36:39], v1 offset:16384
    v_add_f32 v7, v7, v17
    v_mfma_f32_16x16x32_bf16 a[104:107], v[184:187], v[44:47], a[104:107]
    v_exp_f32 v19, v107
    v_mfma_f32_16x16x32_bf16 a[152:155], v[172:175], v[40:43], a[152:155]
    v_cvt_pk_bf16_f32 v74, v16, v17
    v_fma_f32 v240, v240, v48, v50
    v_mfma_f32_16x16x32_bf16 a[152:155], v[188:191], v[44:47], a[152:155]
    s_waitcnt lgkmcnt(2)
    v_exp_f32 v16, v76
    v_mfma_f32_16x16x32_bf16 a[12:15], v[160:163], v[24:27], a[12:15]
    ds_read_b128 v[40:43], v1 offset:5120
    v_add_f32 v7, v7, v18
    v_mfma_f32_16x16x32_bf16 a[12:15], v[176:179], v[28:31], a[12:15]
    buffer_load_dwordx4 v4, s[4:7], s27 offen offset:2048 sc1 lds
    v_mfma_f32_16x16x32_bf16 a[60:63], v[164:167], v[24:27], a[60:63]
    v_add_f32 v7, v7, v19
    v_fma_f32 v241, v241, v49, v51
    v_mfma_f32_16x16x32_bf16 a[60:63], v[180:183], v[28:31], a[60:63]
    v_exp_f32 v17, v77
    v_mfma_f32_16x16x32_bf16 a[108:111], v[168:171], v[24:27], a[108:111]
    ds_read_b128 v[44:47], v1 offset:17408
    v_cvt_pk_bf16_f32 v75, v18, v19
    v_mfma_f32_16x16x32_bf16 a[108:111], v[184:187], v[28:31], a[108:111]
    v_exp_f32 v18, v78
    v_mfma_f32_16x16x32_bf16 a[156:159], v[172:175], v[24:27], a[156:159]
    s_add_u32 s29, s28, 49152
    v_cvt_pk_bf16_f32 v226, v240, v241
    v_cvt_f32_i32 v244, v244
    v_mfma_f32_16x16x32_bf16 a[156:159], v[188:191], v[28:31], a[156:159]
    s_waitcnt lgkmcnt(2)
    v_add_f32 v8, v8, v16
    v_add_f32 v8, v8, v17
    v_mfma_f32_16x16x32_bf16 a[16:19], v[160:163], v[32:35], a[16:19]
    s_sub_u32 s3, s29, 147456
    ds_read_b128 v[24:27], v1 offset:6144
    v_cvt_f32_i32 v245, v245
    v_mfma_f32_16x16x32_bf16 a[16:19], v[176:179], v[36:39], a[16:19]
    s_add_u32 s27, s27, 24576
    v_exp_f32 v19, v79
    v_mfma_f32_16x16x32_bf16 a[64:67], v[164:167], v[32:35], a[64:67]
    s_min_u32 s29, s29, s3
    v_cvt_pk_bf16_f32 v76, v16, v17
    v_fma_f32 v244, v244, v48, v50
    v_mfma_f32_16x16x32_bf16 a[64:67], v[180:183], v[36:39], a[64:67]
    s_add_u32 s56, s56, 12288
    v_exp_f32 v16, v108
    v_mfma_f32_16x16x32_bf16 a[112:115], v[168:171], v[32:35], a[112:115]
    ds_read_b128 v[28:31], v1 offset:18432
    v_add_f32 v8, v8, v18
    v_mfma_f32_16x16x32_bf16 a[112:115], v[184:187], v[36:39], a[112:115]
    v_add_f32 v8, v8, v19
    v_fma_f32 v245, v245, v49, v51
    v_mfma_f32_16x16x32_bf16 a[160:163], v[172:175], v[32:35], a[160:163]
    v_exp_f32 v17, v109
    v_mfma_f32_16x16x32_bf16 a[160:163], v[188:191], v[36:39], a[160:163]
    s_waitcnt lgkmcnt(2)
    v_cvt_pk_bf16_f32 v230, v244, v245
    v_cvt_pk_bf16_f32 v77, v18, v19
    v_mfma_f32_16x16x32_bf16 a[20:23], v[160:163], v[40:43], a[20:23]
    s_mov_b32 m0, s56
    ds_read_b128 v[32:35], v1 offset:7168
    v_cvt_f32_i32 v248, v248
    v_mfma_f32_16x16x32_bf16 a[20:23], v[176:179], v[44:47], a[20:23]
    s_sub_u32 s3, s29, s28
    v_exp_f32 v18, v110
    v_mfma_f32_16x16x32_bf16 a[68:71], v[164:167], v[40:43], a[68:71]
    v_add_f32 v8, v8, v16
    v_add_f32 v8, v8, v17
    v_mfma_f32_16x16x32_bf16 a[68:71], v[180:183], v[44:47], a[68:71]
    v_exp_f32 v19, v111
    v_mfma_f32_16x16x32_bf16 a[116:119], v[168:171], v[40:43], a[116:119]
    ds_read_b128 v[36:39], v1 offset:19456
    v_cvt_f32_i32 v249, v249
    v_mfma_f32_16x16x32_bf16 a[116:119], v[184:187], v[44:47], a[116:119]
    buffer_load_dwordx4 v4, s[4:7], s27 offen offset:0 sc1 lds
    v_mfma_f32_16x16x32_bf16 a[164:167], v[172:175], v[40:43], a[164:167]
    s_mov_b32 s28, s29
    v_cvt_pk_bf16_f32 v78, v16, v17
    v_add_f32 v8, v8, v18
    v_mfma_f32_16x16x32_bf16 a[164:167], v[188:191], v[44:47], a[164:167]
    s_waitcnt lgkmcnt(2)
    v_add_f32 v8, v8, v19
    v_fma_f32 v248, v248, v48, v50
    v_mfma_f32_16x16x32_bf16 a[24:27], v[160:163], v[24:27], a[24:27]
    ds_read_b128 v[40:43], v1 offset:8192
    v_cvt_pk_bf16_f32 v79, v18, v19
    v_mfma_f32_16x16x32_bf16 a[24:27], v[176:179], v[28:31], a[24:27]
    v_exp_f32 v16, v80
    v_mfma_f32_16x16x32_bf16 a[72:75], v[164:167], v[24:27], a[72:75]
    v_fma_f32 v249, v249, v49, v51
    v_cvt_pk_bf16_f32 v234, v248, v249
    v_mfma_f32_16x16x32_bf16 a[72:75], v[180:183], v[28:31], a[72:75]
    v_exp_f32 v17, v81
    v_mfma_f32_16x16x32_bf16 a[120:123], v[168:171], v[24:27], a[120:123]
    ds_read_b128 v[44:47], v1 offset:20480
    v_cvt_f32_i32 v252, v252
    v_mfma_f32_16x16x32_bf16 a[120:123], v[184:187], v[28:31], a[120:123]
    v_exp_f32 v18, v82
    v_mfma_f32_16x16x32_bf16 a[168:171], v[172:175], v[24:27], a[168:171]
    v_add_f32 v5, v5, v16
    v_add_f32 v5, v5, v17
    v_mfma_f32_16x16x32_bf16 a[168:171], v[188:191], v[28:31], a[168:171]
    s_waitcnt lgkmcnt(2)
    buffer_load_dwordx4 v4, s[4:7], s27 offen offset:1024 sc1 lds
    v_mfma_f32_16x16x32_bf16 a[28:31], v[160:163], v[32:35], a[28:31]
    ds_read_b128 v[24:27], v1 offset:9216
    v_cvt_f32_i32 v253, v253
    v_mfma_f32_16x16x32_bf16 a[28:31], v[176:179], v[36:39], a[28:31]
    v_exp_f32 v19, v83
    v_mfma_f32_16x16x32_bf16 a[76:79], v[164:167], v[32:35], a[76:79]
    v_cvt_pk_bf16_f32 v80, v16, v17
    v_fma_f32 v252, v252, v48, v50
    v_mfma_f32_16x16x32_bf16 a[76:79], v[180:183], v[36:39], a[76:79]
    v_exp_f32 v16, v112
    v_mfma_f32_16x16x32_bf16 a[124:127], v[168:171], v[32:35], a[124:127]
    ds_read_b128 v[28:31], v1 offset:21504
    v_add_f32 v5, v5, v18
    v_mfma_f32_16x16x32_bf16 a[124:127], v[184:187], v[36:39], a[124:127]
    v_add_f32 v5, v5, v19
    v_fma_f32 v253, v253, v49, v51
    v_mfma_f32_16x16x32_bf16 a[172:175], v[172:175], v[32:35], a[172:175]
    v_exp_f32 v17, v113
    v_mfma_f32_16x16x32_bf16 a[172:175], v[188:191], v[36:39], a[172:175]
    s_waitcnt lgkmcnt(2)
    buffer_load_dwordx4 v4, s[4:7], s27 offen offset:2048 sc1 lds
    v_mfma_f32_16x16x32_bf16 a[32:35], v[160:163], v[40:43], a[32:35]
    ds_read_b128 v[32:35], v1 offset:10240
    v_cvt_pk_bf16_f32 v81, v18, v19
    v_mfma_f32_16x16x32_bf16 a[32:35], v[176:179], v[44:47], a[32:35]
    v_exp_f32 v18, v114
    v_mfma_f32_16x16x32_bf16 a[80:83], v[164:167], v[40:43], a[80:83]
    v_add_f32 v5, v5, v16
    v_cvt_pk_bf16_f32 v238, v252, v253
    v_mfma_f32_16x16x32_bf16 a[80:83], v[180:183], v[44:47], a[80:83]
    v_add_f32 v5, v5, v17
    v_lshlrev_b32 v48, 16, v61
    v_mfma_f32_16x16x32_bf16 a[128:131], v[168:171], v[40:43], a[128:131]
    ds_read_b128 v[36:39], v1 offset:22528
    v_add_u32 v2, s3, v2
    v_mfma_f32_16x16x32_bf16 a[128:131], v[184:187], v[44:47], a[128:131]
    v_exp_f32 v19, v115
    v_mfma_f32_16x16x32_bf16 a[176:179], v[172:175], v[40:43], a[176:179]
    v_cvt_pk_bf16_f32 v82, v16, v17
    v_and_b32 v49, s97, v61
    v_mfma_f32_16x16x32_bf16 a[176:179], v[188:191], v[44:47], a[176:179]
    s_waitcnt lgkmcnt(2)
    v_exp_f32 v16, v84
    v_mfma_f32_16x16x32_bf16 a[36:39], v[160:163], v[24:27], a[36:39]
    ds_read_b128 v[40:43], v1 offset:11264
    v_add_f32 v5, v5, v18
    v_mfma_f32_16x16x32_bf16 a[36:39], v[176:179], v[28:31], a[36:39]
    v_add_f32 v5, v5, v19
    v_lshlrev_b32 v50, 16, v63
    v_mfma_f32_16x16x32_bf16 a[84:87], v[164:167], v[24:27], a[84:87]
    v_exp_f32 v17, v85
    v_mfma_f32_16x16x32_bf16 a[84:87], v[180:183], v[28:31], a[84:87]
    s_add_u32 s27, s27, 24576
    v_add_u32 v3, s3, v3
    v_cvt_pk_bf16_f32 v83, v18, v19
    v_mfma_f32_16x16x32_bf16 a[132:135], v[168:171], v[24:27], a[132:135]
    s_add_u32 s56, s56, 36864
    ds_read_b128 v[44:47], v1 offset:23552
    v_and_b32 v51, s97, v63
    v_mfma_f32_16x16x32_bf16 a[132:135], v[184:187], v[28:31], a[132:135]
    s_sub_u32 s58, s56, 147456
    v_exp_f32 v18, v86
    v_mfma_f32_16x16x32_bf16 a[180:183], v[172:175], v[24:27], a[180:183]
    v_add_f32 v6, v6, v16
    v_add_f32 v6, v6, v17
    v_mfma_f32_16x16x32_bf16 a[180:183], v[188:191], v[28:31], a[180:183]
    s_waitcnt lgkmcnt(2)
    v_mul_f32 v48, s38, v48
    v_mul_f32 v49, s38, v49
    v_mfma_f32_16x16x32_bf16 a[40:43], v[160:163], v[32:35], a[40:43]
    s_min_u32 s56, s56, s58
    ds_read_b128 v[24:27], v2 offset:0
    v_mul_f32_e64 v50, -v50, v48
    v_mfma_f32_16x16x32_bf16 a[40:43], v[176:179], v[36:39], a[40:43]
    v_exp_f32 v19, v87
    v_mfma_f32_16x16x32_bf16 a[88:91], v[164:167], v[32:35], a[88:91]
    v_cvt_pk_bf16_f32 v84, v16, v17
    v_mul_f32_e64 v51, -v51, v49
    v_mfma_f32_16x16x32_bf16 a[88:91], v[180:183], v[36:39], a[88:91]
    v_exp_f32 v16, v116
    v_mfma_f32_16x16x32_bf16 a[136:139], v[168:171], v[32:35], a[136:139]
    ds_read_b128 v[28:31], v3 offset:0
    v_add_f32 v6, v6, v18
    v_mfma_f32_16x16x32_bf16 a[136:139], v[184:187], v[36:39], a[136:139]
    v_add_f32 v6, v6, v19
    v_cvt_f32_i32 v242, v242
    v_mfma_f32_16x16x32_bf16 a[184:187], v[172:175], v[32:35], a[184:187]
    v_exp_f32 v17, v117
    v_mfma_f32_16x16x32_bf16 a[184:187], v[188:191], v[36:39], a[184:187]
    s_waitcnt lgkmcnt(2)
    v_cvt_pk_bf16_f32 v85, v18, v19
    v_cvt_f32_i32 v243, v243
    v_mfma_f32_16x16x32_bf16 a[44:47], v[160:163], v[40:43], a[44:47]
    ds_read_b128 v[32:35], v2 offset:6144
    v_fma_f32 v242, v242, v48, v50
    v_mfma_f32_16x16x32_bf16 a[44:47], v[176:179], v[44:47], a[44:47]
    v_exp_f32 v18, v118
    v_mfma_f32_16x16x32_bf16 a[92:95], v[164:167], v[40:43], a[92:95]
    v_add_f32 v6, v6, v16
    v_add_f32 v6, v6, v17
    v_mfma_f32_16x16x32_bf16 a[92:95], v[180:183], v[44:47], a[92:95]
L_pg7:
    s_cbranch_execz L_pg11
    v_exp_f32 v19, v119
    v_mfma_f32_16x16x32_bf16 a[140:143], v[168:171], v[40:43], a[140:143]
    s_sub_u32 s31, s31, 1
    ds_read_b128 v[36:39], v3 offset:6144
    v_cvt_pk_bf16_f32 v86, v16, v17
    v_mfma_f32_16x16x32_bf16 a[140:143], v[184:187], v[44:47], a[140:143]
    v_add_f32 v6, v6, v18
    v_add_f32 v6, v6, v19
    v_mfma_f32_16x16x32_bf16 a[188:191], v[172:175], v[40:43], a[188:191]
    s_waitcnt lgkmcnt(2)
    s_cmp_lg_u32 s31, 0
    v_cvt_pk_bf16_f32 v87, v18, v19
    v_fma_f32 v243, v243, v49, v51
    v_mfma_f32_16x16x32_bf16 a[188:191], v[188:191], v[44:47], a[188:191]
    s_cbranch_scc1 L_loop
    v_mfma_f32_16x16x32_bf16 v[160:163], v[24:27], a[192:195], v[128:131]
    s_mov_b32 m0, s56
    ds_read_b128 v[40:43], v2 offset:128
    v_cvt_pk_bf16_f32 v227, v242, v243
    v_mfma_f32_16x16x32_bf16 v[160:163], v[28:31], a[196:199], v[160:163]
    buffer_load_dwordx4 v4, s[4:7], s27 offen offset:0 sc1 lds
    v_mfma_f32_16x16x32_bf16 v[164:167], v[24:27], a[216:219], v[132:135]
    v_exp_f32 v16, v88
    v_mfma_f32_16x16x32_bf16 v[164:167], v[28:31], a[220:223], v[164:167]
    v_exp_f32 v17, v89
    v_mfma_f32_16x16x32_bf16 v[168:171], v[24:27], a[240:243], v[136:139]
    ds_read_b128 v[44:47], v3 offset:128
    v_cvt_f32_i32 v246, v246
    v_mfma_f32_16x16x32_bf16 v[168:171], v[28:31], a[244:247], v[168:171]
    v_exp_f32 v18, v90
    v_mfma_f32_16x16x32_bf16 v[172:175], v[24:27], v[200:203], v[140:143]
    v_cvt_f32_i32 v247, v247
    v_add_f32 v7, v7, v16
    v_mfma_f32_16x16x32_bf16 v[172:175], v[28:31], v[204:207], v[172:175]
    s_waitcnt lgkmcnt(2)
    v_add_f32 v7, v7, v17
    v_fma_f32 v246, v246, v48, v50
    v_mfma_f32_16x16x32_bf16 v[96:99], v[32:35], a[192:195], v[128:131]
    ds_read_b128 v[24:27], v2 offset:6272
    v_fma_f32 v247, v247, v49, v51
    v_mfma_f32_16x16x32_bf16 v[96:99], v[36:39], a[196:199], v[96:99]
    buffer_load_dwordx4 v4, s[4:7], s27 offen offset:1024 sc1 lds
    v_mfma_f32_16x16x32_bf16 v[100:103], v[32:35], a[216:219], v[132:135]
    v_exp_f32 v19, v91
    v_mfma_f32_16x16x32_bf16 v[100:103], v[36:39], a[220:223], v[100:103]
    v_cvt_pk_bf16_f32 v88, v16, v17
    v_cvt_pk_bf16_f32 v231, v246, v247
    v_mfma_f32_16x16x32_bf16 v[104:107], v[32:35], a[240:243], v[136:139]
    ds_read_b128 v[28:31], v3 offset:6272
    v_cvt_f32_i32 v250, v250
    v_mfma_f32_16x16x32_bf16 v[104:107], v[36:39], a[244:247], v[104:107]
    v_exp_f32 v16, v120
    v_mfma_f32_16x16x32_bf16 v[108:111], v[32:35], v[200:203], v[140:143]
    v_add_f32 v7, v7, v18
    v_add_f32 v7, v7, v19
    v_mfma_f32_16x16x32_bf16 v[108:111], v[36:39], v[204:207], v[108:111]
    s_waitcnt lgkmcnt(2)
    v_exp_f32 v17, v121
    v_mfma_f32_16x16x32_bf16 v[160:163], v[40:43], a[200:203], v[160:163]
    ds_read_b128 v[32:35], v2 offset:256
    v_cvt_f32_i32 v251, v251
    v_mfma_f32_16x16x32_bf16 v[160:163], v[44:47], a[204:207], v[160:163]
    v_cvt_pk_bf16_f32 v89, v18, v19
    v_fma_f32 v250, v250, v48, v50
    v_mfma_f32_16x16x32_bf16 v[164:167], v[40:43], a[224:227], v[164:167]
    v_exp_f32 v18, v122
    v_mfma_f32_16x16x32_bf16 v[164:167], v[44:47], a[228:231], v[164:167]
    buffer_load_dwordx4 v4, s[4:7], s27 offen offset:2048 sc1 lds
    v_mfma_f32_16x16x32_bf16 v[168:171], v[40:43], a[248:251], v[168:171]
    ds_read_b128 v[36:39], v3 offset:256
    v_fma_f32 v251, v251, v49, v51
    v_mfma_f32_16x16x32_bf16 v[168:171], v[44:47], a[252:255], v[168:171]
    v_add_f32 v7, v7, v16
    v_add_f32 v7, v7, v17
    v_mfma_f32_16x16x32_bf16 v[172:175], v[40:43], v[208:211], v[172:175]
    v_cvt_pk_bf16_f32 v235, v250, v251
    v_cvt_f32_i32 v254, v254
    v_mfma_f32_16x16x32_bf16 v[172:175], v[44:47], v[212:215], v[172:175]
    s_waitcnt lgkmcnt(2)
    v_exp_f32 v19, v123
    v_mfma_f32_16x16x32_bf16 v[96:99], v[24:27], a[200:203], v[96:99]
    ds_read_b128 v[40:43], v2 offset:6400
    v_cvt_pk_bf16_f32 v90, v16, v17
    v_mfma_f32_16x16x32_bf16 v[96:99], v[28:31], a[204:207], v[96:99]
    s_add_u32 s27, s27, 24576
    v_exp_f32 v16, v92
    v_mfma_f32_16x16x32_bf16 v[100:103], v[24:27], a[224:227], v[100:103]
    v_cvt_f32_i32 v255, v255
    v_add_f32 v7, v7, v18
    v_mfma_f32_16x16x32_bf16 v[100:103], v[28:31], a[228:231], v[100:103]
    v_fma_f32 v254, v254, v48, v50
    v_add_f32 v7, v7, v19
    v_mfma_f32_16x16x32_bf16 v[104:107], v[24:27], a[248:251], v[104:107]
    ds_read_b128 v[44:47], v3 offset:6400
    v_fma_f32 v255, v255, v49, v51
    v_mfma_f32_16x16x32_bf16 v[104:107], v[28:31], a[252:255], v[104:107]
    v_exp_f32 v17, v93
    v_mfma_f32_16x16x32_bf16 v[108:111], v[24:27], v[208:211], v[108:111]
    s_add_u32 s29, s30, 49152
    v_cvt_pk_bf16_f32 v239, v254, v255
    v_cvt_pk_bf16_f32 v91, v18, v19
    v_mfma_f32_16x16x32_bf16 v[108:111], v[28:31], v[212:215], v[108:111]
    s_waitcnt lgkmcnt(2)
    v_exp_f32 v18, v94
    v_mfma_f32_16x16x32_bf16 v[160:163], v[32:35], a[208:211], v[160:163]
    s_waitcnt vmcnt(11)
    ds_read_b128 v[24:27], v2 offset:12288
    v_add_f32 v8, v8, v16
    v_mfma_f32_16x16x32_bf16 v[160:163], v[36:39], a[212:215], v[160:163]
    s_sub_u32 s3, s29, 147456
    buffer_load_dwordx2 v[60:61], off, s[80:83], s37 offset:8
    v_mfma_f32_16x16x32_bf16 v[164:167], v[32:35], a[232:235], v[164:167]
    s_add_u32 s56, s56, 12288
    v_add_f32 v8, v8, v17
    v_lshlrev_b32 v48, 16, v56
    v_mfma_f32_16x16x32_bf16 v[164:167], v[36:39], a[236:239], v[164:167]
    s_min_u32 s29, s29, s3
    v_exp_f32 v19, v95
    v_mfma_f32_16x16x32_bf16 v[168:171], v[32:35], v[192:195], v[168:171]
    s_mov_b32 m0, s56
    ds_read_b128 v[28:31], v3 offset:12288
    v_cvt_pk_bf16_f32 v92, v16, v17
    v_mfma_f32_16x16x32_bf16 v[168:171], v[36:39], v[196:199], v[168:171]
    buffer_load_dwordx2 v[62:63], off, s[84:87], s37 offset:8
    v_mfma_f32_16x16x32_bf16 v[172:175], v[32:35], v[216:219], v[172:175]
    v_exp_f32 v16, v124
    v_mfma_f32_16x16x32_bf16 v[172:175], v[36:39], v[220:223], v[172:175]
    s_waitcnt lgkmcnt(2)
    v_add_f32 v8, v8, v18
    v_add_f32 v8, v8, v19
    v_mfma_f32_16x16x32_bf16 v[96:99], v[40:43], a[208:211], v[96:99]
    ds_read_b128 v[32:35], v2 offset:18432
    v_and_b32 v49, s97, v56
    v_mfma_f32_16x16x32_bf16 v[96:99], v[44:47], a[212:215], v[96:99]
    s_sub_u32 s3, s29, s30
    v_exp_f32 v17, v125
    v_mfma_f32_16x16x32_bf16 v[100:103], v[40:43], a[232:235], v[100:103]
    v_cvt_pk_bf16_f32 v93, v18, v19
    v_lshlrev_b32 v50, 16, v58
    v_mfma_f32_16x16x32_bf16 v[100:103], v[44:47], a[236:239], v[100:103]
    buffer_load_dwordx4 v4, s[4:7], s27 offen offset:0 sc1 lds
    v_mfma_f32_16x16x32_bf16 v[104:107], v[40:43], v[192:195], v[104:107]
    ds_read_b128 v[36:39], v3 offset:18432
    v_mfma_f32_16x16x32_bf16 v[104:107], v[44:47], v[196:199], v[104:107]
    v_exp_f32 v18, v126
    v_mfma_f32_16x16x32_bf16 v[108:111], v[40:43], v[216:219], v[108:111]
    v_add_f32 v8, v8, v16
    v_add_f32 v8, v8, v17
    v_mfma_f32_16x16x32_bf16 v[108:111], v[44:47], v[220:223], v[108:111]
    s_waitcnt lgkmcnt(2)
    buffer_load_dwordx3 v[240:242], v12, s[68:71], s16 offen offset:0 nt
    v_mfma_f32_16x16x32_bf16 v[176:179], v[24:27], a[192:195], v[128:131]
    ds_read_b128 v[40:43], v2 offset:12416
    v_mfma_f32_16x16x32_bf16 v[176:179], v[28:31], a[196:199], v[176:179]
    v_exp_f32 v19, v127
    v_cvt_pk_bf16_f32 v94, v16, v17
    v_mfma_f32_16x16x32_bf16 v[180:183], v[24:27], a[216:219], v[132:135]
    s_mov_b32 s30, s29
    v_add_f32 v8, v8, v18
    v_add_f32 v8, v8, v19
    v_mfma_f32_16x16x32_bf16 v[180:183], v[28:31], a[220:223], v[180:183]
    buffer_load_dwordx4 v4, s[4:7], s27 offen offset:1024 sc1 lds
    v_mfma_f32_16x16x32_bf16 v[184:187], v[24:27], a[240:243], v[136:139]
    ds_read_b128 v[44:47], v3 offset:12416
    v_cvt_pk_bf16_f32 v95, v18, v19
    v_mfma_f32_16x16x32_bf16 v[184:187], v[28:31], a[244:247], v[184:187]
    v_exp_f32 v16, v160
    v_mfma_f32_16x16x32_bf16 v[188:191], v[24:27], v[200:203], v[140:143]
    v_exp_f32 v17, v161
    v_mfma_f32_16x16x32_bf16 v[188:191], v[28:31], v[204:207], v[188:191]
    s_waitcnt lgkmcnt(2)
    buffer_load_dwordx3 v[244:246], v12, s[68:71], s16 offen offset:768 nt
    v_mfma_f32_16x16x32_bf16 v[112:115], v[32:35], a[192:195], v[128:131]
    ds_read_b128 v[24:27], v2 offset:18560
    v_and_b32 v51, s97, v58
    v_mfma_f32_16x16x32_bf16 v[112:115], v[36:39], a[196:199], v[112:115]
    v_exp_f32 v18, v162
    v_mfma_f32_16x16x32_bf16 v[116:119], v[32:35], a[216:219], v[132:135]
    v_add_f32 v5, v5, v16
    v_add_f32 v5, v5, v17
    v_mfma_f32_16x16x32_bf16 v[116:119], v[36:39], a[220:223], v[116:119]
    v_exp_f32 v19, v163
    v_mfma_f32_16x16x32_bf16 v[120:123], v[32:35], a[240:243], v[136:139]
    ds_read_b128 v[28:31], v3 offset:18560
    v_cvt_pk_bf16_f32 v160, v16, v17
    v_mfma_f32_16x16x32_bf16 v[120:123], v[36:39], a[244:247], v[120:123]
    buffer_load_dwordx3 v[248:250], v12, s[68:71], s16 offen offset:1536 nt
    v_mfma_f32_16x16x32_bf16 v[124:127], v[32:35], v[200:203], v[140:143]
    v_exp_f32 v16, v96
    v_mfma_f32_16x16x32_bf16 v[124:127], v[36:39], v[204:207], v[124:127]
    s_waitcnt lgkmcnt(2)
    v_add_f32 v5, v5, v18
    v_add_f32 v5, v5, v19
    v_mfma_f32_16x16x32_bf16 v[176:179], v[40:43], a[200:203], v[176:179]
    ds_read_b128 v[32:35], v2 offset:12544
    v_mul_f32_e64 v50, -v50, v48
    v_mfma_f32_16x16x32_bf16 v[176:179], v[44:47], a[204:207], v[176:179]
    buffer_load_dwordx4 v4, s[4:7], s27 offen offset:2048 sc1 lds
    v_mfma_f32_16x16x32_bf16 v[180:183], v[40:43], a[224:227], v[180:183]
    v_exp_f32 v17, v97
    v_mfma_f32_16x16x32_bf16 v[180:183], v[44:47], a[228:231], v[180:183]
    v_cvt_pk_bf16_f32 v161, v18, v19
    v_add_u32 v1, s3, v1
    v_mfma_f32_16x16x32_bf16 v[184:187], v[40:43], a[248:251], v[184:187]
    ds_read_b128 v[36:39], v3 offset:12544
    v_mul_f32_e64 v51, -v51, v49
    v_mfma_f32_16x16x32_bf16 v[184:187], v[44:47], a[252:255], v[184:187]
    buffer_load_dwordx3 v[252:254], v12, s[68:71], s16 offen offset:2304 nt
    v_mfma_f32_16x16x32_bf16 v[188:191], v[40:43], v[208:211], v[188:191]
    v_exp_f32 v18, v98
    v_mfma_f32_16x16x32_bf16 v[188:191], v[44:47], v[212:215], v[188:191]
    s_waitcnt lgkmcnt(2)
    v_add_f32 v5, v5, v16
    v_add_f32 v5, v5, v17
    v_mfma_f32_16x16x32_bf16 v[112:115], v[24:27], a[200:203], v[112:115]
    ds_read_b128 v[40:43], v2 offset:18688
    v_cvt_f32_i32 v144, v144
    v_mfma_f32_16x16x32_bf16 v[112:115], v[28:31], a[204:207], v[112:115]
    v_exp_f32 v19, v99
    v_cvt_pk_bf16_f32 v162, v16, v17
    v_mfma_f32_16x16x32_bf16 v[116:119], v[24:27], a[224:227], v[116:119]
    v_exp_f32 v16, v164
    v_mfma_f32_16x16x32_bf16 v[116:119], v[28:31], a[228:231], v[116:119]
    s_add_u32 s27, s27, 24576
    v_add_f32 v5, v5, v18
    v_add_f32 v5, v5, v19
    v_mfma_f32_16x16x32_bf16 v[120:123], v[24:27], a[248:251], v[120:123]
    s_add_u32 s56, s56, 36864
    ds_read_b128 v[44:47], v3 offset:18688
    s_sub_u32 s58, s56, 147456
    v_mfma_f32_16x16x32_bf16 v[120:123], v[28:31], a[252:255], v[120:123]
    s_waitcnt lgkmcnt(2)
    v_exp_f32 v17, v165
    v_mfma_f32_16x16x32_bf16 v[124:127], v[24:27], v[208:211], v[124:127]
    s_waitcnt vmcnt(12)
    v_cvt_pk_bf16_f32 v163, v18, v19
    v_cvt_f32_i32 v148, v148
    v_mfma_f32_16x16x32_bf16 v[124:127], v[28:31], v[212:215], v[124:127]
    s_barrier
    s_min_u32 s56, s56, s58
    v_mfma_f32_16x16x32_bf16 v[176:179], v[32:35], a[208:211], v[176:179]
    ds_read_b128 v[24:27], v1 offset:0
    v_mfma_f32_16x16x32_bf16 v[176:179], v[36:39], a[212:215], v[176:179]
    v_exp_f32 v18, v166
    v_mfma_f32_16x16x32_bf16 v[180:183], v[32:35], a[232:235], v[180:183]
    v_add_f32 v6, v6, v16
    v_add_f32 v6, v6, v17
    v_mfma_f32_16x16x32_bf16 v[180:183], v[36:39], a[236:239], v[180:183]
    v_exp_f32 v19, v167
    v_mfma_f32_16x16x32_bf16 v[184:187], v[32:35], v[192:195], v[184:187]
    ds_read_b128 v[28:31], v1 offset:12288
    v_cvt_pk_bf16_f32 v164, v16, v17
    v_mfma_f32_16x16x32_bf16 v[184:187], v[36:39], v[196:199], v[184:187]
    v_exp_f32 v16, v100
    v_mfma_f32_16x16x32_bf16 v[188:191], v[32:35], v[216:219], v[188:191]
    v_add_f32 v6, v6, v18
    v_add_f32 v6, v6, v19
    v_mfma_f32_16x16x32_bf16 v[188:191], v[36:39], v[220:223], v[188:191]
    s_waitcnt lgkmcnt(2)
    v_exp_f32 v17, v101
    v_mfma_f32_16x16x32_bf16 v[112:115], v[40:43], a[208:211], v[112:115]
    ds_read_b128 v[32:35], v1 offset:1024
    v_cvt_pk_bf16_f32 v165, v18, v19
    v_mfma_f32_16x16x32_bf16 v[112:115], v[44:47], a[212:215], v[112:115]
    v_exp_f32 v18, v102
    v_mfma_f32_16x16x32_bf16 v[116:119], v[40:43], a[232:235], v[116:119]
    v_add_f32 v6, v6, v16
    v_add_f32 v6, v6, v17
    v_mfma_f32_16x16x32_bf16 v[116:119], v[44:47], a[236:239], v[116:119]
    v_exp_f32 v19, v103
    v_mfma_f32_16x16x32_bf16 v[120:123], v[40:43], v[192:195], v[120:123]
    ds_read_b128 v[36:39], v1 offset:13312
    v_cvt_pk_bf16_f32 v166, v16, v17
    v_mfma_f32_16x16x32_bf16 v[120:123], v[44:47], v[196:199], v[120:123]
    v_add_f32 v6, v6, v18
    v_add_f32 v6, v6, v19
    v_mfma_f32_16x16x32_bf16 v[124:127], v[40:43], v[216:219], v[124:127]
    v_cvt_pk_bf16_f32 v167, v18, v19
    v_mfma_f32_16x16x32_bf16 v[124:127], v[44:47], v[220:223], v[124:127]
    s_waitcnt lgkmcnt(2)
    v_mfma_f32_16x16x32_bf16 a[0:3], v[64:67], v[24:27], a[0:3]
    ds_read_b128 v[40:43], v1 offset:2048
    v_fma_f32 v144, v144, v48, v50
    v_mfma_f32_16x16x32_bf16 a[0:3], v[80:83], v[28:31], a[0:3]
    buffer_store_dwordx4 v[224:227], v11, s[4:7], s33 offen offset:0 sc1
    v_mfma_f32_16x16x32_bf16 a[48:51], v[68:71], v[24:27], a[48:51]
    v_exp_f32 v16, v168
    v_mfma_f32_16x16x32_bf16 a[48:51], v[84:87], v[28:31], a[48:51]
    v_exp_f32 v17, v169
    v_mfma_f32_16x16x32_bf16 a[96:99], v[72:75], v[24:27], a[96:99]
    ds_read_b128 v[44:47], v1 offset:14336
    v_xor_b32 v55, 16, v11
    v_mfma_f32_16x16x32_bf16 a[96:99], v[88:91], v[28:31], a[96:99]
    v_exp_f32 v18, v170
    v_mfma_f32_16x16x32_bf16 a[144:147], v[76:79], v[24:27], a[144:147]
    v_add_f32 v7, v7, v16
    v_add_f32 v7, v7, v17
    v_mfma_f32_16x16x32_bf16 a[144:147], v[92:95], v[28:31], a[144:147]
    s_waitcnt lgkmcnt(2)
    v_exp_f32 v19, v171
    v_mfma_f32_16x16x32_bf16 a[4:7], v[64:67], v[32:35], a[4:7]
    ds_read_b128 v[24:27], v1 offset:3072
    v_fma_f32 v148, v148, v49, v51
    v_mfma_f32_16x16x32_bf16 a[4:7], v[80:83], v[36:39], a[4:7]
    buffer_store_dwordx4 v[228:231], v55, s[4:7], s33 offen offset:768 sc1
    v_mfma_f32_16x16x32_bf16 a[52:55], v[68:71], v[32:35], a[52:55]
    v_cvt_pk_bf16_f32 v168, v16, v17
    v_cvt_f32_i32 v145, v145
    v_mfma_f32_16x16x32_bf16 a[52:55], v[84:87], v[36:39], a[52:55]
    v_exp_f32 v16, v104
    v_mfma_f32_16x16x32_bf16 a[100:103], v[72:75], v[32:35], a[100:103]
    ds_read_b128 v[28:31], v1 offset:15360
    v_add_f32 v7, v7, v18
    v_mfma_f32_16x16x32_bf16 a[100:103], v[88:91], v[36:39], a[100:103]
    v_add_f32 v7, v7, v19
    v_xor_b32 v54, 32, v11
    v_mfma_f32_16x16x32_bf16 a[148:151], v[76:79], v[32:35], a[148:151]
    v_exp_f32 v17, v105
    v_mfma_f32_16x16x32_bf16 a[148:151], v[92:95], v[36:39], a[148:151]
    s_waitcnt lgkmcnt(2)
    v_cvt_pk_bf16_f32 v169, v18, v19
    v_cvt_f32_i32 v149, v149
    v_mfma_f32_16x16x32_bf16 a[8:11], v[64:67], v[40:43], a[8:11]
    ds_read_b128 v[32:35], v1 offset:4096
    v_fma_f32 v145, v145, v48, v50
    v_mfma_f32_16x16x32_bf16 a[8:11], v[80:83], v[44:47], a[8:11]
    buffer_store_dwordx4 v[232:235], v54, s[4:7], s33 offen offset:1536 sc1
    v_mfma_f32_16x16x32_bf16 a[56:59], v[68:71], v[40:43], a[56:59]
    v_exp_f32 v18, v106
    v_mfma_f32_16x16x32_bf16 a[56:59], v[84:87], v[44:47], a[56:59]
    v_add_f32 v7, v7, v16
    v_add_f32 v7, v7, v17
    v_mfma_f32_16x16x32_bf16 a[104:107], v[72:75], v[40:43], a[104:107]
    ds_read_b128 v[36:39], v1 offset:16384
    v_xor_b32 v55, 48, v11
    v_mfma_f32_16x16x32_bf16 a[104:107], v[88:91], v[44:47], a[104:107]
    v_exp_f32 v19, v107
    v_mfma_f32_16x16x32_bf16 a[152:155], v[76:79], v[40:43], a[152:155]
    v_cvt_pk_bf16_f32 v170, v16, v17
    v_fma_f32 v149, v149, v49, v51
    v_mfma_f32_16x16x32_bf16 a[152:155], v[92:95], v[44:47], a[152:155]
    s_waitcnt lgkmcnt(2)
    v_exp_f32 v16, v172
    v_mfma_f32_16x16x32_bf16 a[12:15], v[64:67], v[24:27], a[12:15]
    ds_read_b128 v[40:43], v1 offset:5120
    v_add_f32 v7, v7, v18
    v_mfma_f32_16x16x32_bf16 a[12:15], v[80:83], v[28:31], a[12:15]
    buffer_store_dwordx4 v[236:239], v55, s[4:7], s33 offen offset:2304 sc1
    v_mfma_f32_16x16x32_bf16 a[60:63], v[68:71], v[24:27], a[60:63]
    v_add_f32 v7, v7, v19
    v_cvt_f32_i32 v146, v146
    v_mfma_f32_16x16x32_bf16 a[60:63], v[84:87], v[28:31], a[60:63]
    v_exp_f32 v17, v173
    v_mfma_f32_16x16x32_bf16 a[108:111], v[72:75], v[24:27], a[108:111]
    ds_read_b128 v[44:47], v1 offset:17408
    v_cvt_pk_bf16_f32 v171, v18, v19
    v_mfma_f32_16x16x32_bf16 a[108:111], v[88:91], v[28:31], a[108:111]
    v_exp_f32 v18, v174
    v_mfma_f32_16x16x32_bf16 a[156:159], v[76:79], v[24:27], a[156:159]
    s_add_u32 s29, s28, 49152
    v_add_f32 v8, v8, v16
    v_add_f32 v8, v8, v17
    v_mfma_f32_16x16x32_bf16 a[156:159], v[92:95], v[28:31], a[156:159]
    s_waitcnt lgkmcnt(2)
    v_exp_f32 v19, v175
    v_mfma_f32_16x16x32_bf16 a[16:19], v[64:67], v[32:35], a[16:19]
    s_sub_u32 s3, s29, 147456
    ds_read_b128 v[24:27], v1 offset:6144
    v_cvt_pk_bf16_f32 v172, v16, v17
    v_mfma_f32_16x16x32_bf16 a[16:19], v[80:83], v[36:39], a[16:19]
    s_mov_b32 m0, s26
    v_exp_f32 v16, v108
    v_mfma_f32_16x16x32_bf16 a[64:67], v[68:71], v[32:35], a[64:67]
    s_min_u32 s29, s29, s3
    v_cvt_f32_i32 v150, v150
    v_add_f32 v8, v8, v18
    v_mfma_f32_16x16x32_bf16 a[64:67], v[84:87], v[36:39], a[64:67]
    buffer_load_dwordx4 v4, s[4:7], s32 offen offset:0 sc1 lds
    v_mfma_f32_16x16x32_bf16 a[112:115], v[72:75], v[32:35], a[112:115]
    ds_read_b128 v[28:31], v1 offset:18432
    v_add_f32 v8, v8, v19
    v_mfma_f32_16x16x32_bf16 a[112:115], v[88:91], v[36:39], a[112:115]
    v_exp_f32 v17, v109
    v_mfma_f32_16x16x32_bf16 a[160:163], v[76:79], v[32:35], a[160:163]
    v_cvt_pk_bf16_f32 v173, v18, v19
    v_fma_f32 v146, v146, v48, v50
    v_mfma_f32_16x16x32_bf16 a[160:163], v[92:95], v[36:39], a[160:163]
    s_waitcnt lgkmcnt(2)
    buffer_load_dwordx4 v4, s[4:7], s32 offen offset:1024 sc1 lds
    v_mfma_f32_16x16x32_bf16 a[20:23], v[64:67], v[40:43], a[20:23]
    s_sub_u32 s3, s29, s28
    ds_read_b128 v[32:35], v1 offset:7168
    v_fma_f32 v150, v150, v49, v51
    v_mfma_f32_16x16x32_bf16 a[20:23], v[80:83], v[44:47], a[20:23]
    v_exp_f32 v18, v110
    v_mfma_f32_16x16x32_bf16 a[68:71], v[68:71], v[40:43], a[68:71]
    v_add_f32 v8, v8, v16
    v_add_f32 v8, v8, v17
    v_mfma_f32_16x16x32_bf16 a[68:71], v[84:87], v[44:47], a[68:71]
    buffer_load_dwordx4 v4, s[4:7], s32 offen offset:2048 sc1 lds
    v_mfma_f32_16x16x32_bf16 a[116:119], v[72:75], v[40:43], a[116:119]
    ds_read_b128 v[36:39], v1 offset:19456
    v_lshlrev_b32 v48, 16, v57
    v_mfma_f32_16x16x32_bf16 a[116:119], v[88:91], v[44:47], a[116:119]
    v_exp_f32 v19, v111
    v_mfma_f32_16x16x32_bf16 a[164:167], v[76:79], v[40:43], a[164:167]
    s_mov_b32 s28, s29
    v_cvt_pk_bf16_f32 v174, v16, v17
    v_add_f32 v8, v8, v18
    v_mfma_f32_16x16x32_bf16 a[164:167], v[92:95], v[44:47], a[164:167]
    s_waitcnt lgkmcnt(2)
    v_add_f32 v8, v8, v19
    v_cvt_pk_bf16_f32 v175, v18, v19
    v_mfma_f32_16x16x32_bf16 a[24:27], v[64:67], v[24:27], a[24:27]
    s_add_u32 s32, s32, 24576
    ds_read_b128 v[40:43], v1 offset:8192
    v_and_b32 v49, s97, v57
    v_mfma_f32_16x16x32_bf16 a[24:27], v[80:83], v[28:31], a[24:27]
    v_exp_f32 v16, v176
    v_mfma_f32_16x16x32_bf16 a[72:75], v[68:71], v[24:27], a[72:75]
    s_add_u32 s26, s26, 12288
    v_exp_f32 v17, v177
    v_mfma_f32_16x16x32_bf16 a[72:75], v[84:87], v[28:31], a[72:75]
    v_exp_f32 v18, v178
    v_mfma_f32_16x16x32_bf16 a[120:123], v[72:75], v[24:27], a[120:123]
    s_mov_b32 m0, s26
    ds_read_b128 v[44:47], v1 offset:20480
    v_add_f32 v5, v5, v16
    v_mfma_f32_16x16x32_bf16 a[120:123], v[88:91], v[28:31], a[120:123]
    v_add_f32 v5, v5, v17
    v_lshlrev_b32 v50, 16, v59
    v_mfma_f32_16x16x32_bf16 a[168:171], v[76:79], v[24:27], a[168:171]
    v_exp_f32 v19, v179
    v_mfma_f32_16x16x32_bf16 a[168:171], v[92:95], v[28:31], a[168:171]
    s_waitcnt lgkmcnt(2)
    v_cvt_pk_bf16_f32 v176, v16, v17
    v_and_b32 v51, s97, v59
    v_mfma_f32_16x16x32_bf16 a[28:31], v[64:67], v[32:35], a[28:31]
    ds_read_b128 v[24:27], v1 offset:9216
    v_add_u32 v2, s3, v2
    v_mfma_f32_16x16x32_bf16 a[28:31], v[80:83], v[36:39], a[28:31]
    buffer_load_dwordx4 v4, s[4:7], s32 offen offset:0 sc1 lds
    v_mfma_f32_16x16x32_bf16 a[76:79], v[68:71], v[32:35], a[76:79]
    v_exp_f32 v16, v112
    v_mfma_f32_16x16x32_bf16 a[76:79], v[84:87], v[36:39], a[76:79]
    v_add_f32 v5, v5, v18
    v_add_f32 v5, v5, v19
    v_mfma_f32_16x16x32_bf16 a[124:127], v[72:75], v[32:35], a[124:127]
    ds_read_b128 v[28:31], v1 offset:21504
    v_mul_f32_e64 v50, -v50, v48
    v_mfma_f32_16x16x32_bf16 a[124:127], v[88:91], v[36:39], a[124:127]
    buffer_load_dwordx4 v4, s[4:7], s32 offen offset:1024 sc1 lds
    v_mfma_f32_16x16x32_bf16 a[172:175], v[76:79], v[32:35], a[172:175]
    v_exp_f32 v17, v113
    v_mfma_f32_16x16x32_bf16 a[172:175], v[92:95], v[36:39], a[172:175]
    s_waitcnt lgkmcnt(2)
    v_cvt_pk_bf16_f32 v177, v18, v19
    v_add_u32 v3, s3, v3
    v_mfma_f32_16x16x32_bf16 a[32:35], v[64:67], v[40:43], a[32:35]
    ds_read_b128 v[32:35], v1 offset:10240
    v_mul_f32_e64 v51, -v51, v49
    v_mfma_f32_16x16x32_bf16 a[32:35], v[80:83], v[44:47], a[32:35]
    v_exp_f32 v18, v114
    v_mfma_f32_16x16x32_bf16 a[80:83], v[68:71], v[40:43], a[80:83]
    v_add_f32 v5, v5, v16
    v_add_f32 v5, v5, v17
    v_mfma_f32_16x16x32_bf16 a[80:83], v[84:87], v[44:47], a[80:83]
    buffer_load_dwordx4 v4, s[4:7], s32 offen offset:2048 sc1 lds
    v_mfma_f32_16x16x32_bf16 a[128:131], v[72:75], v[40:43], a[128:131]
    ds_read_b128 v[36:39], v1 offset:22528
    v_mfma_f32_16x16x32_bf16 a[128:131], v[88:91], v[44:47], a[128:131]
    v_exp_f32 v19, v115
    v_mfma_f32_16x16x32_bf16 a[176:179], v[76:79], v[40:43], a[176:179]
    v_cvt_pk_bf16_f32 v178, v16, v17
    v_cvt_f32_i32 v152, v152
    v_mfma_f32_16x16x32_bf16 a[176:179], v[92:95], v[44:47], a[176:179]
    s_waitcnt lgkmcnt(2)
    v_exp_f32 v16, v180
    v_mfma_f32_16x16x32_bf16 a[36:39], v[64:67], v[24:27], a[36:39]
    ds_read_b128 v[40:43], v1 offset:11264
    v_add_f32 v5, v5, v18
    v_mfma_f32_16x16x32_bf16 a[36:39], v[80:83], v[28:31], a[36:39]
    v_add_f32 v5, v5, v19
    v_mfma_f32_16x16x32_bf16 a[84:87], v[68:71], v[24:27], a[84:87]
    v_exp_f32 v17, v181
    v_mfma_f32_16x16x32_bf16 a[84:87], v[84:87], v[28:31], a[84:87]
    s_add_u32 s32, s32, 24576
    v_cvt_pk_bf16_f32 v179, v18, v19
    s_add_u32 s26, s26, 36864
    v_mfma_f32_16x16x32_bf16 a[132:135], v[72:75], v[24:27], a[132:135]
    s_sub_u32 s57, s26, 147456
    ds_read_b128 v[44:47], v1 offset:23552
    v_cvt_f32_i32 v156, v156
    v_mfma_f32_16x16x32_bf16 a[132:135], v[88:91], v[28:31], a[132:135]
    s_waitcnt lgkmcnt(2)
    v_exp_f32 v18, v182
    v_mfma_f32_16x16x32_bf16 a[180:183], v[76:79], v[24:27], a[180:183]
    s_waitcnt vmcnt(6)
    v_add_f32 v6, v6, v16
    v_add_f32 v6, v6, v17
    v_mfma_f32_16x16x32_bf16 a[180:183], v[92:95], v[28:31], a[180:183]
    s_barrier
    v_fma_f32 v152, v152, v48, v50
    v_mfma_f32_16x16x32_bf16 a[40:43], v[64:67], v[32:35], a[40:43]
    s_min_u32 s26, s26, s57
    ds_read_b128 v[24:27], v2 offset:0
    v_add_u32 v0, 1, v0
    v_mfma_f32_16x16x32_bf16 a[40:43], v[80:83], v[36:39], a[40:43]
    buffer_store_dword v0, v13, s[20:23], 0 offen offset:32 sc1
    v_mfma_f32_16x16x32_bf16 a[88:91], v[68:71], v[32:35], a[88:91]
    v_exp_f32 v19, v183
    v_mfma_f32_16x16x32_bf16 a[88:91], v[84:87], v[36:39], a[88:91]
    v_cvt_pk_bf16_f32 v180, v16, v17
    v_fma_f32 v156, v156, v49, v51
    v_mfma_f32_16x16x32_bf16 a[136:139], v[72:75], v[32:35], a[136:139]
    ds_read_b128 v[28:31], v3 offset:0
    v_mfma_f32_16x16x32_bf16 a[136:139], v[88:91], v[36:39], a[136:139]
    v_exp_f32 v16, v116
    v_mfma_f32_16x16x32_bf16 a[184:187], v[76:79], v[32:35], a[184:187]
    v_add_f32 v6, v6, v18
    v_add_f32 v6, v6, v19
    v_mfma_f32_16x16x32_bf16 a[184:187], v[92:95], v[36:39], a[184:187]
    s_waitcnt lgkmcnt(2)
    v_exp_f32 v17, v117
    v_mfma_f32_16x16x32_bf16 a[44:47], v[64:67], v[40:43], a[44:47]
    ds_read_b128 v[32:35], v2 offset:6144
    v_cvt_pk_bf16_f32 v181, v18, v19
    v_mfma_f32_16x16x32_bf16 a[44:47], v[80:83], v[44:47], a[44:47]
    v_exp_f32 v18, v118
    v_mfma_f32_16x16x32_bf16 a[92:95], v[68:71], v[40:43], a[92:95]
    v_add_f32 v6, v6, v16
    v_add_f32 v6, v6, v17
    v_mfma_f32_16x16x32_bf16 a[92:95], v[84:87], v[44:47], a[92:95]
    v_exp_f32 v19, v119
    v_mfma_f32_16x16x32_bf16 a[140:143], v[72:75], v[40:43], a[140:143]
    ds_read_b128 v[36:39], v3 offset:6144
    v_cvt_pk_bf16_f32 v182, v16, v17
    v_mfma_f32_16x16x32_bf16 a[140:143], v[88:91], v[44:47], a[140:143]
    v_add_f32 v6, v6, v18
    v_add_f32 v6, v6, v19
    v_mfma_f32_16x16x32_bf16 a[188:191], v[76:79], v[40:43], a[188:191]
    v_cvt_pk_bf16_f32 v183, v18, v19
    v_mfma_f32_16x16x32_bf16 a[188:191], v[92:95], v[44:47], a[188:191]
    s_waitcnt lgkmcnt(2)
    v_mfma_f32_16x16x32_bf16 v[64:67], v[24:27], a[192:195], v[128:131]
    s_mov_b32 m0, s56
    ds_read_b128 v[40:43], v2 offset:128
    v_cvt_f32_i32 v153, v153
    v_mfma_f32_16x16x32_bf16 v[64:67], v[28:31], a[196:199], v[64:67]
    buffer_load_dwordx4 v4, s[4:7], s27 offen offset:0 sc1 lds
    v_mfma_f32_16x16x32_bf16 v[68:71], v[24:27], a[216:219], v[132:135]
    v_exp_f32 v16, v184
    v_mfma_f32_16x16x32_bf16 v[68:71], v[28:31], a[220:223], v[68:71]
    v_exp_f32 v17, v185
    v_mfma_f32_16x16x32_bf16 v[72:75], v[24:27], a[240:243], v[136:139]
    ds_read_b128 v[44:47], v3 offset:128
    v_cvt_f32_i32 v157, v157
    v_mfma_f32_16x16x32_bf16 v[72:75], v[28:31], a[244:247], v[72:75]
    v_exp_f32 v18, v186
    v_mfma_f32_16x16x32_bf16 v[76:79], v[24:27], v[200:203], v[140:143]
    v_add_f32 v7, v7, v16
    v_add_f32 v7, v7, v17
    v_mfma_f32_16x16x32_bf16 v[76:79], v[28:31], v[204:207], v[76:79]
    s_waitcnt lgkmcnt(2)
    v_exp_f32 v19, v187
    v_mfma_f32_16x16x32_bf16 v[96:99], v[32:35], a[192:195], v[128:131]
    ds_read_b128 v[24:27], v2 offset:6272
    v_fma_f32 v153, v153, v48, v50
    v_mfma_f32_16x16x32_bf16 v[96:99], v[36:39], a[196:199], v[96:99]
    v_cvt_pk_bf16_f32 v184, v16, v17
    v_fma_f32 v157, v157, v49, v51
    v_mfma_f32_16x16x32_bf16 v[100:103], v[32:35], a[216:219], v[132:135]
    v_exp_f32 v16, v120
    v_mfma_f32_16x16x32_bf16 v[100:103], v[36:39], a[220:223], v[100:103]
    buffer_load_dwordx4 v4, s[4:7], s27 offen offset:1024 sc1 lds
    v_mfma_f32_16x16x32_bf16 v[104:107], v[32:35], a[240:243], v[136:139]
    ds_read_b128 v[28:31], v3 offset:6272
    v_add_f32 v7, v7, v18
    v_mfma_f32_16x16x32_bf16 v[104:107], v[36:39], a[244:247], v[104:107]
    v_add_f32 v7, v7, v19
    v_cvt_f32_i32 v154, v154
    v_mfma_f32_16x16x32_bf16 v[108:111], v[32:35], v[200:203], v[140:143]
    v_exp_f32 v17, v121
    v_mfma_f32_16x16x32_bf16 v[108:111], v[36:39], v[204:207], v[108:111]
    s_waitcnt lgkmcnt(2)
    v_cvt_pk_bf16_f32 v185, v18, v19
    v_cvt_f32_i32 v158, v158
    v_mfma_f32_16x16x32_bf16 v[64:67], v[40:43], a[200:203], v[64:67]
    ds_read_b128 v[32:35], v2 offset:256
    v_fma_f32 v154, v154, v48, v50
    v_mfma_f32_16x16x32_bf16 v[64:67], v[44:47], a[204:207], v[64:67]
    v_exp_f32 v18, v122
    v_mfma_f32_16x16x32_bf16 v[68:71], v[40:43], a[224:227], v[68:71]
    v_add_f32 v7, v7, v16
    v_add_f32 v7, v7, v17
    v_mfma_f32_16x16x32_bf16 v[68:71], v[44:47], a[228:231], v[68:71]
    v_exp_f32 v19, v123
    v_mfma_f32_16x16x32_bf16 v[72:75], v[40:43], a[248:251], v[72:75]
    ds_read_b128 v[36:39], v3 offset:256
    v_cvt_pk_bf16_f32 v186, v16, v17
    v_mfma_f32_16x16x32_bf16 v[72:75], v[44:47], a[252:255], v[72:75]
    v_exp_f32 v16, v188
    v_mfma_f32_16x16x32_bf16 v[76:79], v[40:43], v[208:211], v[76:79]
    v_add_f32 v7, v7, v18
    v_fma_f32 v158, v158, v49, v51
    v_mfma_f32_16x16x32_bf16 v[76:79], v[44:47], v[212:215], v[76:79]
    s_waitcnt lgkmcnt(2)
    buffer_load_dwordx4 v4, s[4:7], s27 offen offset:2048 sc1 lds
    v_mfma_f32_16x16x32_bf16 v[96:99], v[24:27], a[200:203], v[96:99]
    ds_read_b128 v[40:43], v2 offset:6400
    v_add_f32 v7, v7, v19
    v_mfma_f32_16x16x32_bf16 v[96:99], v[28:31], a[204:207], v[96:99]
    v_exp_f32 v17, v189
    v_mfma_f32_16x16x32_bf16 v[100:103], v[24:27], a[224:227], v[100:103]
    v_cvt_pk_bf16_f32 v187, v18, v19
    v_cvt_pk_bf16_f32 v144, v144, v148
    v_mfma_f32_16x16x32_bf16 v[100:103], v[28:31], a[228:231], v[100:103]
    v_exp_f32 v18, v190
    v_mfma_f32_16x16x32_bf16 v[104:107], v[24:27], a[248:251], v[104:107]
    ds_read_b128 v[44:47], v3 offset:6400
    v_add_f32 v8, v8, v16
    v_mfma_f32_16x16x32_bf16 v[104:107], v[28:31], a[252:255], v[104:107]
    v_add_f32 v8, v8, v17
    v_cvt_pk_bf16_f32 v148, v145, v149
    v_mfma_f32_16x16x32_bf16 v[108:111], v[24:27], v[208:211], v[108:111]
    s_add_u32 s29, s30, 49152
    v_exp_f32 v19, v191
    v_mfma_f32_16x16x32_bf16 v[108:111], v[28:31], v[212:215], v[108:111]
L_pg8:
    s_cbranch_execz L_pg12
    s_waitcnt lgkmcnt(2)
    v_cvt_pk_bf16_f32 v188, v16, v17
    s_sub_u32 s3, s29, 147456
    v_mfma_f32_16x16x32_bf16 v[64:67], v[32:35], a[208:211], v[64:67]
    s_add_u32 s27, s27, 24576
    ds_read_b128 v[24:27], v2 offset:12288
    v_cvt_pk_bf16_f32 v145, v152, v156
    v_mfma_f32_16x16x32_bf16 v[64:67], v[36:39], a[212:215], v[64:67]
    s_min_u32 s29, s29, s3
    v_exp_f32 v16, v124
    v_mfma_f32_16x16x32_bf16 v[68:71], v[32:35], a[232:235], v[68:71]
    v_add_f32 v8, v8, v18
    v_add_f32 v8, v8, v19
    v_mfma_f32_16x16x32_bf16 v[68:71], v[36:39], a[236:239], v[68:71]
    v_exp_f32 v17, v125
    v_mfma_f32_16x16x32_bf16 v[72:75], v[32:35], v[192:195], v[72:75]
    s_add_u32 s56, s56, 12288
    ds_read_b128 v[28:31], v3 offset:12288
    v_cvt_pk_bf16_f32 v149, v153, v157
    v_mfma_f32_16x16x32_bf16 v[72:75], v[36:39], v[196:199], v[72:75]
    v_cvt_pk_bf16_f32 v189, v18, v19
    v_mfma_f32_16x16x32_bf16 v[76:79], v[32:35], v[216:219], v[76:79]
    v_exp_f32 v18, v126
    v_mfma_f32_16x16x32_bf16 v[76:79], v[36:39], v[220:223], v[76:79]
    s_waitcnt lgkmcnt(2)
    v_add_f32 v8, v8, v16
    v_cvt_pk_bf16_f32 v152, v146, v150
    v_mfma_f32_16x16x32_bf16 v[96:99], v[40:43], a[208:211], v[96:99]
    ds_read_b128 v[32:35], v2 offset:18432
    v_add_f32 v8, v8, v17
    v_mfma_f32_16x16x32_bf16 v[96:99], v[44:47], a[212:215], v[96:99]
    s_sub_u32 s3, s29, s30
    v_exp_f32 v19, v127
    v_mfma_f32_16x16x32_bf16 v[100:103], v[40:43], a[232:235], v[100:103]
    s_mov_b32 m0, s56
    v_cvt_pk_bf16_f32 v153, v154, v158
    v_mfma_f32_16x16x32_bf16 v[100:103], v[44:47], a[236:239], v[100:103]
    v_cvt_pk_bf16_f32 v190, v16, v17
    v_mfma_f32_16x16x32_bf16 v[104:107], v[40:43], v[192:195], v[104:107]
    ds_read_b128 v[36:39], v3 offset:18432
    v_add_f32 v8, v8, v18
    v_mfma_f32_16x16x32_bf16 v[104:107], v[44:47], v[196:199], v[104:107]
    v_add_f32 v8, v8, v19
    v_cvt_pk_bf16_f32 v191, v18, v19
    v_mfma_f32_16x16x32_bf16 v[108:111], v[40:43], v[216:219], v[108:111]
    v_mfma_f32_16x16x32_bf16 v[108:111], v[44:47], v[220:223], v[108:111]
    s_waitcnt lgkmcnt(2)
    v_exp_f32 v16, v64
    v_mfma_f32_16x16x32_bf16 v[80:83], v[24:27], a[192:195], v[128:131]
    ds_read_b128 v[40:43], v2 offset:12416
    v_mfma_f32_16x16x32_bf16 v[80:83], v[28:31], a[196:199], v[80:83]
    s_mov_b32 s30, s29
    v_exp_f32 v17, v65
    v_mfma_f32_16x16x32_bf16 v[84:87], v[24:27], a[216:219], v[132:135]
    v_exp_f32 v18, v66
    v_mfma_f32_16x16x32_bf16 v[84:87], v[28:31], a[220:223], v[84:87]
    s_waitcnt vmcnt(14)
    buffer_load_dwordx4 v4, s[4:7], s27 offen offset:0 sc1 lds
    v_mfma_f32_16x16x32_bf16 v[88:91], v[24:27], a[240:243], v[136:139]
    ds_read_b128 v[44:47], v3 offset:12416
    v_add_f32 v5, v5, v16
    v_mfma_f32_16x16x32_bf16 v[88:91], v[28:31], a[244:247], v[88:91]
    v_add_f32 v5, v5, v17
    v_lshlrev_b32 v48, 16, v60
    v_mfma_f32_16x16x32_bf16 v[92:95], v[24:27], v[200:203], v[140:143]
    v_exp_f32 v19, v67
    v_mfma_f32_16x16x32_bf16 v[92:95], v[28:31], v[204:207], v[92:95]
    s_waitcnt lgkmcnt(2)
    v_cvt_pk_bf16_f32 v64, v16, v17
    v_and_b32 v49, s97, v60
    v_mfma_f32_16x16x32_bf16 v[112:115], v[32:35], a[192:195], v[128:131]
    ds_read_b128 v[24:27], v2 offset:18560
    v_mfma_f32_16x16x32_bf16 v[112:115], v[36:39], a[196:199], v[112:115]
    v_exp_f32 v16, v96
    v_mfma_f32_16x16x32_bf16 v[116:119], v[32:35], a[216:219], v[132:135]
    v_add_f32 v5, v5, v18
    v_add_f32 v5, v5, v19
    v_mfma_f32_16x16x32_bf16 v[116:119], v[36:39], a[220:223], v[116:119]
    v_exp_f32 v17, v97
    v_mfma_f32_16x16x32_bf16 v[120:123], v[32:35], a[240:243], v[136:139]
    ds_read_b128 v[28:31], v3 offset:18560
    v_lshlrev_b32 v50, 16, v62
    v_mfma_f32_16x16x32_bf16 v[120:123], v[36:39], a[244:247], v[120:123]
    v_cvt_pk_bf16_f32 v65, v18, v19
    v_add_u32 v1, s3, v1
    v_mfma_f32_16x16x32_bf16 v[124:127], v[32:35], v[200:203], v[140:143]
    v_exp_f32 v18, v98
    v_mfma_f32_16x16x32_bf16 v[124:127], v[36:39], v[204:207], v[124:127]
    s_waitcnt lgkmcnt(2)
    buffer_load_dwordx4 v4, s[4:7], s27 offen offset:1024 sc1 lds
    v_mfma_f32_16x16x32_bf16 v[80:83], v[40:43], a[200:203], v[80:83]
    ds_read_b128 v[32:35], v2 offset:12544
    v_add_f32 v5, v5, v16
    v_mfma_f32_16x16x32_bf16 v[80:83], v[44:47], a[204:207], v[80:83]
    v_add_f32 v5, v5, v17
    v_and_b32 v51, s97, v62
    v_mfma_f32_16x16x32_bf16 v[84:87], v[40:43], a[224:227], v[84:87]
    v_exp_f32 v19, v99
    v_mfma_f32_16x16x32_bf16 v[84:87], v[44:47], a[228:231], v[84:87]
    v_cvt_pk_bf16_f32 v66, v16, v17
    v_mfma_f32_16x16x32_bf16 v[88:91], v[40:43], a[248:251], v[88:91]
    ds_read_b128 v[36:39], v3 offset:12544
    v_mul_f32_e64 v50, -v50, v48
    v_mfma_f32_16x16x32_bf16 v[88:91], v[44:47], a[252:255], v[88:91]
    v_exp_f32 v16, v68
    v_mfma_f32_16x16x32_bf16 v[92:95], v[40:43], v[208:211], v[92:95]
    v_add_f32 v5, v5, v18
    v_add_f32 v5, v5, v19
    v_mfma_f32_16x16x32_bf16 v[92:95], v[44:47], v[212:215], v[92:95]
    s_waitcnt lgkmcnt(2)
    v_exp_f32 v17, v69
    v_mfma_f32_16x16x32_bf16 v[112:115], v[24:27], a[200:203], v[112:115]
    ds_read_b128 v[40:43], v2 offset:18688
    v_mfma_f32_16x16x32_bf16 v[112:115], v[28:31], a[204:207], v[112:115]
    buffer_load_dwordx4 v4, s[4:7], s27 offen offset:2048 sc1 lds
    v_mfma_f32_16x16x32_bf16 v[116:119], v[24:27], a[224:227], v[116:119]
    v_cvt_pk_bf16_f32 v67, v18, v19
    v_mul_f32_e64 v51, -v51, v49
    v_mfma_f32_16x16x32_bf16 v[116:119], v[28:31], a[228:231], v[116:119]
    v_exp_f32 v18, v70
    v_mfma_f32_16x16x32_bf16 v[120:123], v[24:27], a[248:251], v[120:123]
    ds_read_b128 v[44:47], v3 offset:18688
    v_add_f32 v6, v6, v16
    v_mfma_f32_16x16x32_bf16 v[120:123], v[28:31], a[252:255], v[120:123]
    s_waitcnt lgkmcnt(2)
    v_add_f32 v6, v6, v17
    v_mfma_f32_16x16x32_bf16 v[124:127], v[24:27], v[208:211], v[124:127]
    s_waitcnt vmcnt(7)
    v_exp_f32 v19, v71
    v_mfma_f32_16x16x32_bf16 v[124:127], v[28:31], v[212:215], v[124:127]
    s_barrier
    v_cvt_pk_bf16_f32 v68, v16, v17
    v_mfma_f32_16x16x32_bf16 v[80:83], v[32:35], a[208:211], v[80:83]
    ds_read_b128 v[24:27], v1 offset:0
    v_cvt_f32_i32 v240, v240
    v_mfma_f32_16x16x32_bf16 v[80:83], v[36:39], a[212:215], v[80:83]
    v_exp_f32 v16, v100
    v_mfma_f32_16x16x32_bf16 v[84:87], v[32:35], a[232:235], v[84:87]
    v_add_f32 v6, v6, v18
    v_add_f32 v6, v6, v19
    v_mfma_f32_16x16x32_bf16 v[84:87], v[36:39], a[236:239], v[84:87]
    v_exp_f32 v17, v101
    v_mfma_f32_16x16x32_bf16 v[88:91], v[32:35], v[192:195], v[88:91]
    ds_read_b128 v[28:31], v1 offset:12288
    v_cvt_f32_i32 v244, v244
    v_mfma_f32_16x16x32_bf16 v[88:91], v[36:39], v[196:199], v[88:91]
    v_cvt_pk_bf16_f32 v69, v18, v19
    v_mfma_f32_16x16x32_bf16 v[92:95], v[32:35], v[216:219], v[92:95]
    v_exp_f32 v18, v102
    v_mfma_f32_16x16x32_bf16 v[92:95], v[36:39], v[220:223], v[92:95]
    s_waitcnt lgkmcnt(2)
    v_add_f32 v6, v6, v16
    v_mfma_f32_16x16x32_bf16 v[112:115], v[40:43], a[208:211], v[112:115]
    ds_read_b128 v[32:35], v1 offset:1024
    v_add_f32 v6, v6, v17
    v_mfma_f32_16x16x32_bf16 v[112:115], v[44:47], a[212:215], v[112:115]
    v_exp_f32 v19, v103
    v_mfma_f32_16x16x32_bf16 v[116:119], v[40:43], a[232:235], v[116:119]
    v_mfma_f32_16x16x32_bf16 v[116:119], v[44:47], a[236:239], v[116:119]
    s_add_u32 s27, s27, 24576
    s_add_u32 s56, s56, 36864
    v_cvt_pk_bf16_f32 v70, v16, v17
    v_mfma_f32_16x16x32_bf16 v[120:123], v[40:43], v[192:195], v[120:123]
    s_sub_u32 s58, s56, 147456
    ds_read_b128 v[36:39], v1 offset:13312
    v_add_f32 v6, v6, v18
    v_mfma_f32_16x16x32_bf16 v[120:123], v[44:47], v[196:199], v[120:123]
    s_min_u32 s56, s56, s58
    v_add_f32 v6, v6, v19
    v_cvt_pk_bf16_f32 v71, v18, v19
    v_mfma_f32_16x16x32_bf16 v[124:127], v[40:43], v[216:219], v[124:127]
    v_mfma_f32_16x16x32_bf16 v[124:127], v[44:47], v[220:223], v[124:127]
    s_waitcnt lgkmcnt(2)
    v_mfma_f32_16x16x32_bf16 a[0:3], v[160:163], v[24:27], a[0:3]
    s_mov_b32 m0, s56
    ds_read_b128 v[40:43], v1 offset:2048
    v_fma_f32 v240, v240, v48, v50
    v_mfma_f32_16x16x32_bf16 a[0:3], v[176:179], v[28:31], a[0:3]
    buffer_load_dwordx4 v4, s[4:7], s27 offen offset:0 sc1 lds
    v_mfma_f32_16x16x32_bf16 a[48:51], v[164:167], v[24:27], a[48:51]
    v_exp_f32 v16, v72
    v_mfma_f32_16x16x32_bf16 a[48:51], v[180:183], v[28:31], a[48:51]
    v_exp_f32 v17, v73
    v_mfma_f32_16x16x32_bf16 a[96:99], v[168:171], v[24:27], a[96:99]
    ds_read_b128 v[44:47], v1 offset:14336
    v_fma_f32 v244, v244, v49, v51
    v_mfma_f32_16x16x32_bf16 a[96:99], v[184:187], v[28:31], a[96:99]
    v_exp_f32 v18, v74
    v_mfma_f32_16x16x32_bf16 a[144:147], v[172:175], v[24:27], a[144:147]
    v_add_f32 v7, v7, v16
    v_add_f32 v7, v7, v17
    v_mfma_f32_16x16x32_bf16 a[144:147], v[188:191], v[28:31], a[144:147]
    s_waitcnt lgkmcnt(2)
    v_exp_f32 v19, v75
    v_mfma_f32_16x16x32_bf16 a[4:7], v[160:163], v[32:35], a[4:7]
    ds_read_b128 v[24:27], v1 offset:3072
    v_cvt_f32_i32 v241, v241
    v_mfma_f32_16x16x32_bf16 a[4:7], v[176:179], v[36:39], a[4:7]
    buffer_load_dwordx4 v4, s[4:7], s27 offen offset:1024 sc1 lds
    v_mfma_f32_16x16x32_bf16 a[52:55], v[164:167], v[32:35], a[52:55]
    v_cvt_pk_bf16_f32 v72, v16, v17
    v_cvt_f32_i32 v245, v245
    v_mfma_f32_16x16x32_bf16 a[52:55], v[180:183], v[36:39], a[52:55]
    v_exp_f32 v16, v104
    v_mfma_f32_16x16x32_bf16 a[100:103], v[168:171], v[32:35], a[100:103]
    ds_read_b128 v[28:31], v1 offset:15360
    v_add_f32 v7, v7, v18
    v_mfma_f32_16x16x32_bf16 a[100:103], v[184:187], v[36:39], a[100:103]
    v_add_f32 v7, v7, v19
    v_bfe_u32 v53, v4, 4, 6
    v_mfma_f32_16x16x32_bf16 a[148:151], v[172:175], v[32:35], a[148:151]
    v_exp_f32 v17, v105
    v_mfma_f32_16x16x32_bf16 a[148:151], v[188:191], v[36:39], a[148:151]
    s_waitcnt lgkmcnt(2)
    v_cvt_pk_bf16_f32 v73, v18, v19
    v_fma_f32 v241, v241, v48, v50
    v_mfma_f32_16x16x32_bf16 a[8:11], v[160:163], v[40:43], a[8:11]
    ds_read_b128 v[32:35], v1 offset:4096
    v_lshlrev_b32 v53, 2, v53
    v_mfma_f32_16x16x32_bf16 a[8:11], v[176:179], v[44:47], a[8:11]
    buffer_load_dword v52, v53, s[20:23], s44 offen sc1
    v_mfma_f32_16x16x32_bf16 a[56:59], v[164:167], v[40:43], a[56:59]
    v_exp_f32 v18, v106
    v_mfma_f32_16x16x32_bf16 a[56:59], v[180:183], v[44:47], a[56:59]
    v_add_f32 v7, v7, v16
    v_add_f32 v7, v7, v17
    v_mfma_f32_16x16x32_bf16 a[104:107], v[168:171], v[40:43], a[104:107]
    ds_read_b128 v[36:39], v1 offset:16384
    v_fma_f32 v245, v245, v49, v51
    v_mfma_f32_16x16x32_bf16 a[104:107], v[184:187], v[44:47], a[104:107]
    buffer_load_dwordx4 v4, s[4:7], s27 offen offset:2048 sc1 lds
    v_mfma_f32_16x16x32_bf16 a[152:155], v[172:175], v[40:43], a[152:155]
    v_exp_f32 v19, v107
    v_mfma_f32_16x16x32_bf16 a[152:155], v[188:191], v[44:47], a[152:155]
    s_waitcnt lgkmcnt(2)
    v_cvt_pk_bf16_f32 v74, v16, v17
    v_cvt_f32_i32 v242, v242
    v_mfma_f32_16x16x32_bf16 a[12:15], v[160:163], v[24:27], a[12:15]
    ds_read_b128 v[40:43], v1 offset:5120
    v_cvt_f32_i32 v246, v246
    v_mfma_f32_16x16x32_bf16 a[12:15], v[176:179], v[28:31], a[12:15]
    s_add_u32 s27, s27, 24576
    v_exp_f32 v16, v76
    v_mfma_f32_16x16x32_bf16 a[60:63], v[164:167], v[24:27], a[60:63]
    v_add_f32 v7, v7, v18
    v_add_f32 v7, v7, v19
    v_mfma_f32_16x16x32_bf16 a[60:63], v[180:183], v[28:31], a[60:63]
    v_exp_f32 v17, v77
    v_mfma_f32_16x16x32_bf16 a[108:111], v[168:171], v[24:27], a[108:111]
    ds_read_b128 v[44:47], v1 offset:17408
    v_cvt_pk_bf16_f32 v75, v18, v19
    v_mfma_f32_16x16x32_bf16 a[108:111], v[184:187], v[28:31], a[108:111]
    v_exp_f32 v18, v78
    v_mfma_f32_16x16x32_bf16 a[156:159], v[172:175], v[24:27], a[156:159]
    s_add_u32 s29, s28, 49152
    v_fma_f32 v242, v242, v48, v50
    v_add_f32 v8, v8, v16
    v_mfma_f32_16x16x32_bf16 a[156:159], v[188:191], v[28:31], a[156:159]
    s_waitcnt lgkmcnt(2)
    v_add_f32 v8, v8, v17
    v_fma_f32 v246, v246, v49, v51
    v_mfma_f32_16x16x32_bf16 a[16:19], v[160:163], v[32:35], a[16:19]
    s_sub_u32 s3, s29, 147456
    ds_read_b128 v[24:27], v1 offset:6144
    v_lshlrev_b32 v48, 16, v61
    v_mfma_f32_16x16x32_bf16 a[16:19], v[176:179], v[36:39], a[16:19]
    s_add_u32 s56, s56, 12288
    v_exp_f32 v19, v79
    v_mfma_f32_16x16x32_bf16 a[64:67], v[164:167], v[32:35], a[64:67]
    s_min_u32 s29, s29, s3
    v_cvt_pk_bf16_f32 v76, v16, v17
    v_and_b32 v49, s97, v61
    v_mfma_f32_16x16x32_bf16 a[64:67], v[180:183], v[36:39], a[64:67]
    s_mov_b32 m0, s56
    v_exp_f32 v16, v108
    v_mfma_f32_16x16x32_bf16 a[112:115], v[168:171], v[32:35], a[112:115]
    ds_read_b128 v[28:31], v1 offset:18432
    v_add_f32 v8, v8, v18
    v_mfma_f32_16x16x32_bf16 a[112:115], v[184:187], v[36:39], a[112:115]
    v_add_f32 v8, v8, v19
    v_lshlrev_b32 v50, 16, v63
    v_mfma_f32_16x16x32_bf16 a[160:163], v[172:175], v[32:35], a[160:163]
    v_exp_f32 v17, v109
    v_mfma_f32_16x16x32_bf16 a[160:163], v[188:191], v[36:39], a[160:163]
    s_waitcnt lgkmcnt(2)
    v_cvt_pk_bf16_f32 v77, v18, v19
    v_and_b32 v51, s97, v63
    v_mfma_f32_16x16x32_bf16 a[20:23], v[160:163], v[40:43], a[20:23]
    s_sub_u32 s3, s29, s28
    ds_read_b128 v[32:35], v1 offset:7168
    v_mul_f32_e64 v50, -v50, v48
    v_mfma_f32_16x16x32_bf16 a[20:23], v[176:179], v[44:47], a[20:23]
    v_exp_f32 v18, v110
    v_mfma_f32_16x16x32_bf16 a[68:71], v[164:167], v[40:43], a[68:71]
    v_add_f32 v8, v8, v16
    v_add_f32 v8, v8, v17
    v_mfma_f32_16x16x32_bf16 a[68:71], v[180:183], v[44:47], a[68:71]
    buffer_load_dwordx4 v4, s[4:7], s27 offen offset:0 sc1 lds
    v_mfma_f32_16x16x32_bf16 a[116:119], v[168:171], v[40:43], a[116:119]
    ds_read_b128 v[36:39], v1 offset:19456
    v_mul_f32_e64 v51, -v51, v49
    v_mfma_f32_16x16x32_bf16 a[116:119], v[184:187], v[44:47], a[116:119]
    v_exp_f32 v19, v111
    v_mfma_f32_16x16x32_bf16 a[164:167], v[172:175], v[40:43], a[164:167]
    s_mov_b32 s28, s29
    v_cvt_pk_bf16_f32 v78, v16, v17
    v_add_f32 v8, v8, v18
    v_mfma_f32_16x16x32_bf16 a[164:167], v[188:191], v[44:47], a[164:167]
    s_waitcnt lgkmcnt(2)
    v_add_f32 v8, v8, v19
    v_cvt_pk_bf16_f32 v79, v18, v19
    v_mfma_f32_16x16x32_bf16 a[24:27], v[160:163], v[24:27], a[24:27]
    ds_read_b128 v[40:43], v1 offset:8192
    v_cvt_f32_i32 v248, v248
    v_mfma_f32_16x16x32_bf16 a[24:27], v[176:179], v[28:31], a[24:27]
    v_exp_f32 v16, v80
    v_mfma_f32_16x16x32_bf16 a[72:75], v[164:167], v[24:27], a[72:75]
    v_exp_f32 v17, v81
    v_mfma_f32_16x16x32_bf16 a[72:75], v[180:183], v[28:31], a[72:75]
    buffer_load_dwordx4 v4, s[4:7], s27 offen offset:1024 sc1 lds
    v_mfma_f32_16x16x32_bf16 a[120:123], v[168:171], v[24:27], a[120:123]
    ds_read_b128 v[44:47], v1 offset:20480
    v_cvt_f32_i32 v252, v252
    v_mfma_f32_16x16x32_bf16 a[120:123], v[184:187], v[28:31], a[120:123]
    v_exp_f32 v18, v82
    v_mfma_f32_16x16x32_bf16 a[168:171], v[172:175], v[24:27], a[168:171]
    v_add_f32 v5, v5, v16
    v_fma_f32 v248, v248, v48, v50
    v_mfma_f32_16x16x32_bf16 a[168:171], v[188:191], v[28:31], a[168:171]
    s_waitcnt lgkmcnt(2)
    v_add_f32 v5, v5, v17
    v_fma_f32 v252, v252, v49, v51
    v_mfma_f32_16x16x32_bf16 a[28:31], v[160:163], v[32:35], a[28:31]
    ds_read_b128 v[24:27], v1 offset:9216
    v_cvt_f32_i32 v249, v249
    v_mfma_f32_16x16x32_bf16 a[28:31], v[176:179], v[36:39], a[28:31]
    v_exp_f32 v19, v83
    v_mfma_f32_16x16x32_bf16 a[76:79], v[164:167], v[32:35], a[76:79]
    v_cvt_pk_bf16_f32 v80, v16, v17
    v_cvt_f32_i32 v253, v253
    v_mfma_f32_16x16x32_bf16 a[76:79], v[180:183], v[36:39], a[76:79]
    v_exp_f32 v16, v112
    v_mfma_f32_16x16x32_bf16 a[124:127], v[168:171], v[32:35], a[124:127]
    ds_read_b128 v[28:31], v1 offset:21504
    v_add_f32 v5, v5, v18
    v_mfma_f32_16x16x32_bf16 a[124:127], v[184:187], v[36:39], a[124:127]
    buffer_load_dwordx4 v4, s[4:7], s27 offen offset:2048 sc1 lds
    v_mfma_f32_16x16x32_bf16 a[172:175], v[172:175], v[32:35], a[172:175]
    v_add_f32 v5, v5, v19
    v_fma_f32 v249, v249, v48, v50
    v_mfma_f32_16x16x32_bf16 a[172:175], v[188:191], v[36:39], a[172:175]
    s_waitcnt lgkmcnt(2)
    v_exp_f32 v17, v113
    v_mfma_f32_16x16x32_bf16 a[32:35], v[160:163], v[40:43], a[32:35]
    ds_read_b128 v[32:35], v1 offset:10240
    v_cvt_pk_bf16_f32 v81, v18, v19
    v_mfma_f32_16x16x32_bf16 a[32:35], v[176:179], v[44:47], a[32:35]
    v_exp_f32 v18, v114
    v_mfma_f32_16x16x32_bf16 a[80:83], v[164:167], v[40:43], a[80:83]
    v_add_f32 v5, v5, v16
    v_add_f32 v5, v5, v17
    v_mfma_f32_16x16x32_bf16 a[80:83], v[180:183], v[44:47], a[80:83]
    v_exp_f32 v19, v115
    v_mfma_f32_16x16x32_bf16 a[128:131], v[168:171], v[40:43], a[128:131]
    ds_read_b128 v[36:39], v1 offset:22528
    v_fma_f32 v253, v253, v49, v51
    v_mfma_f32_16x16x32_bf16 a[128:131], v[184:187], v[44:47], a[128:131]
    v_add_u32 v2, s3, v2
    v_cvt_pk_bf16_f32 v82, v16, v17
    v_mfma_f32_16x16x32_bf16 a[176:179], v[172:175], v[40:43], a[176:179]
    v_exp_f32 v16, v84
    v_mfma_f32_16x16x32_bf16 a[176:179], v[188:191], v[44:47], a[176:179]
    s_waitcnt lgkmcnt(2)
    v_cvt_f32_i32 v250, v250
    v_add_f32 v5, v5, v18
    v_mfma_f32_16x16x32_bf16 a[36:39], v[160:163], v[24:27], a[36:39]
    ds_read_b128 v[40:43], v1 offset:11264
    v_add_f32 v5, v5, v19
    v_mfma_f32_16x16x32_bf16 a[36:39], v[176:179], v[28:31], a[36:39]
    v_exp_f32 v17, v85
    v_mfma_f32_16x16x32_bf16 a[84:87], v[164:167], v[24:27], a[84:87]
    v_add_u32 v3, s3, v3
    v_cvt_f32_i32 v254, v254
    v_mfma_f32_16x16x32_bf16 a[84:87], v[180:183], v[28:31], a[84:87]
    s_add_u32 s27, s27, 24576
    v_cvt_pk_bf16_f32 v83, v18, v19
    v_fma_f32 v250, v250, v48, v50
    v_mfma_f32_16x16x32_bf16 a[132:135], v[168:171], v[24:27], a[132:135]
    s_add_u32 s56, s56, 36864
    ds_read_b128 v[44:47], v1 offset:23552
    v_fma_f32 v254, v254, v49, v51
    v_mfma_f32_16x16x32_bf16 a[132:135], v[184:187], v[28:31], a[132:135]
    s_sub_u32 s58, s56, 147456
    v_exp_f32 v18, v86
    v_mfma_f32_16x16x32_bf16 a[180:183], v[172:175], v[24:27], a[180:183]
    v_add_f32 v6, v6, v16
    v_add_f32 v6, v6, v17
    v_mfma_f32_16x16x32_bf16 a[180:183], v[188:191], v[28:31], a[180:183]
    s_waitcnt lgkmcnt(2)
    v_exp_f32 v19, v87
    v_mfma_f32_16x16x32_bf16 a[40:43], v[160:163], v[32:35], a[40:43]
    s_min_u32 s56, s56, s58
    ds_read_b128 v[24:27], v2 offset:0
    v_cvt_pk_bf16_f32 v146, v240, v244
    v_mfma_f32_16x16x32_bf16 a[40:43], v[176:179], v[36:39], a[40:43]
    v_cvt_pk_bf16_f32 v84, v16, v17
    v_cvt_pk_bf16_f32 v150, v241, v245
    v_mfma_f32_16x16x32_bf16 a[88:91], v[164:167], v[32:35], a[88:91]
    v_exp_f32 v16, v116
    v_mfma_f32_16x16x32_bf16 a[88:91], v[180:183], v[36:39], a[88:91]
    v_add_f32 v6, v6, v18
    v_add_f32 v6, v6, v19
    v_mfma_f32_16x16x32_bf16 a[136:139], v[168:171], v[32:35], a[136:139]
    ds_read_b128 v[28:31], v3 offset:0
    v_cvt_pk_bf16_f32 v147, v248, v252
    v_mfma_f32_16x16x32_bf16 a[136:139], v[184:187], v[36:39], a[136:139]
    v_exp_f32 v17, v117
    v_mfma_f32_16x16x32_bf16 a[184:187], v[172:175], v[32:35], a[184:187]
    v_cvt_pk_bf16_f32 v85, v18, v19
    v_cvt_pk_bf16_f32 v151, v249, v253
    v_mfma_f32_16x16x32_bf16 a[184:187], v[188:191], v[36:39], a[184:187]
    s_waitcnt lgkmcnt(2)
    v_exp_f32 v18, v118
    v_mfma_f32_16x16x32_bf16 a[44:47], v[160:163], v[40:43], a[44:47]
    ds_read_b128 v[32:35], v2 offset:6144
    v_add_f32 v6, v6, v16
    v_mfma_f32_16x16x32_bf16 a[44:47], v[176:179], v[44:47], a[44:47]
    v_add_f32 v6, v6, v17
    v_cvt_pk_bf16_f32 v154, v242, v246
    v_mfma_f32_16x16x32_bf16 a[92:95], v[164:167], v[40:43], a[92:95]
    v_exp_f32 v19, v119
    v_mfma_f32_16x16x32_bf16 a[92:95], v[180:183], v[44:47], a[92:95]
    v_cvt_pk_bf16_f32 v155, v250, v254
    v_cvt_pk_bf16_f32 v86, v16, v17
    v_mfma_f32_16x16x32_bf16 a[140:143], v[168:171], v[40:43], a[140:143]
    ds_read_b128 v[36:39], v3 offset:6144
    v_add_f32 v6, v6, v18
    v_mfma_f32_16x16x32_bf16 a[140:143], v[184:187], v[44:47], a[140:143]
    v_add_f32 v6, v6, v19
    v_cvt_pk_bf16_f32 v87, v18, v19
    v_mfma_f32_16x16x32_bf16 a[188:191], v[172:175], v[40:43], a[188:191]
    v_mfma_f32_16x16x32_bf16 a[188:191], v[188:191], v[44:47], a[188:191]
    s_waitcnt lgkmcnt(2)
    v_mfma_f32_16x16x32_bf16 v[160:163], v[24:27], a[192:195], v[128:131]
    ds_read_b128 v[40:43], v2 offset:128
    v_mfma_f32_16x16x32_bf16 v[160:163], v[28:31], a[196:199], v[160:163]
    s_waitcnt vmcnt(4)
    v_subrev_u32 v52, s92, v52
    v_cmp_lt_u32 vcc, 15, v52
    v_mfma_f32_16x16x32_bf16 v[164:167], v[24:27], a[216:219], v[132:135]
    v_exp_f32 v16, v88
    v_mfma_f32_16x16x32_bf16 v[164:167], v[28:31], a[220:223], v[164:167]
    v_exp_f32 v17, v89
    v_mfma_f32_16x16x32_bf16 v[168:171], v[24:27], a[240:243], v[136:139]
    s_and_b32 s59, vcc_lo, 0xff
    ds_read_b128 v[44:47], v3 offset:128
    v_mfma_f32_16x16x32_bf16 v[168:171], v[28:31], a[244:247], v[168:171]
    s_cbranch_scc1 L_pollslow3
L_pollok3:
    v_mfma_f32_16x16x32_bf16 v[172:175], v[24:27], v[200:203], v[140:143]
    s_add_u32 s92, s92, 1
    v_exp_f32 v18, v90
    v_mfma_f32_16x16x32_bf16 v[172:175], v[28:31], v[204:207], v[172:175]
    s_waitcnt lgkmcnt(2)
    v_add_f32 v7, v7, v16
    v_add_f32 v7, v7, v17
    v_mfma_f32_16x16x32_bf16 v[96:99], v[32:35], a[192:195], v[128:131]
    ds_read_b128 v[24:27], v2 offset:6272
    v_mfma_f32_16x16x32_bf16 v[96:99], v[36:39], a[196:199], v[96:99]
    buffer_store_dwordx4 v[144:147], v15, s[4:7], s35 offen offset:0 sc1
    v_mfma_f32_16x16x32_bf16 v[100:103], v[32:35], a[216:219], v[132:135]
    v_exp_f32 v19, v91
    v_mfma_f32_16x16x32_bf16 v[100:103], v[36:39], a[220:223], v[100:103]
    v_cvt_pk_bf16_f32 v88, v16, v17
    v_mfma_f32_16x16x32_bf16 v[104:107], v[32:35], a[240:243], v[136:139]
    ds_read_b128 v[28:31], v3 offset:6272
    v_mfma_f32_16x16x32_bf16 v[104:107], v[36:39], a[244:247], v[104:107]
    v_exp_f32 v16, v120
    v_mfma_f32_16x16x32_bf16 v[108:111], v[32:35], v[200:203], v[140:143]
    v_add_f32 v7, v7, v18
    v_add_f32 v7, v7, v19
    v_mfma_f32_16x16x32_bf16 v[108:111], v[36:39], v[204:207], v[108:111]
    s_waitcnt lgkmcnt(2)
    v_exp_f32 v17, v121
    v_mfma_f32_16x16x32_bf16 v[160:163], v[40:43], a[200:203], v[160:163]
    ds_read_b128 v[32:35], v2 offset:256
    v_cvt_pk_bf16_f32 v89, v18, v19
    v_mfma_f32_16x16x32_bf16 v[160:163], v[44:47], a[204:207], v[160:163]
    buffer_store_dwordx4 v[148:151], v15, s[4:7], s35 offen offset:1024 sc1
    v_mfma_f32_16x16x32_bf16 v[164:167], v[40:43], a[224:227], v[164:167]
    v_exp_f32 v18, v122
    v_mfma_f32_16x16x32_bf16 v[164:167], v[44:47], a[228:231], v[164:167]
    v_add_f32 v7, v7, v16
    v_add_f32 v7, v7, v17
    v_mfma_f32_16x16x32_bf16 v[168:171], v[40:43], a[248:251], v[168:171]
    ds_read_b128 v[36:39], v3 offset:256
    v_mfma_f32_16x16x32_bf16 v[168:171], v[44:47], a[252:255], v[168:171]
    v_exp_f32 v19, v123
    v_mfma_f32_16x16x32_bf16 v[172:175], v[40:43], v[208:211], v[172:175]
    v_cvt_pk_bf16_f32 v90, v16, v17
    v_mfma_f32_16x16x32_bf16 v[172:175], v[44:47], v[212:215], v[172:175]
    s_waitcnt lgkmcnt(2)
    v_exp_f32 v16, v92
    v_mfma_f32_16x16x32_bf16 v[96:99], v[24:27], a[200:203], v[96:99]
    ds_read_b128 v[40:43], v2 offset:6400
    v_add_f32 v7, v7, v18
    v_mfma_f32_16x16x32_bf16 v[96:99], v[28:31], a[204:207], v[96:99]
    buffer_store_dwordx4 v[152:155], v15, s[4:7], s35 offen offset:2048 sc1
    v_mfma_f32_16x16x32_bf16 v[100:103], v[24:27], a[224:227], v[100:103]
    v_add_f32 v7, v7, v19
    v_mfma_f32_16x16x32_bf16 v[100:103], v[28:31], a[228:231], v[100:103]
    v_exp_f32 v17, v93
    v_mfma_f32_16x16x32_bf16 v[104:107], v[24:27], a[248:251], v[104:107]
    ds_read_b128 v[44:47], v3 offset:6400
    v_cvt_pk_bf16_f32 v91, v18, v19
    v_mfma_f32_16x16x32_bf16 v[104:107], v[28:31], a[252:255], v[104:107]
    v_exp_f32 v18, v94
    v_mfma_f32_16x16x32_bf16 v[108:111], v[24:27], v[208:211], v[108:111]
    s_add_u32 s29, s30, 49152
    v_add_f32 v8, v8, v16
    v_add_f32 v8, v8, v17
    v_mfma_f32_16x16x32_bf16 v[108:111], v[28:31], v[212:215], v[108:111]
    s_waitcnt lgkmcnt(2)
    v_exp_f32 v19, v95
    v_mfma_f32_16x16x32_bf16 v[160:163], v[32:35], a[208:211], v[160:163]
    s_sub_u32 s3, s29, 147456
    ds_read_b128 v[24:27], v2 offset:12288
    v_cvt_pk_bf16_f32 v92, v16, v17
    v_mfma_f32_16x16x32_bf16 v[160:163], v[36:39], a[212:215], v[160:163]
    s_min_u32 s29, s29, s3
    v_exp_f32 v16, v124
    v_mfma_f32_16x16x32_bf16 v[164:167], v[32:35], a[232:235], v[164:167]
    v_add_f32 v8, v8, v18
    v_add_f32 v8, v8, v19
    v_mfma_f32_16x16x32_bf16 v[164:167], v[36:39], a[236:239], v[164:167]
    v_exp_f32 v17, v125
    v_mfma_f32_16x16x32_bf16 v[168:171], v[32:35], v[192:195], v[168:171]
    ds_read_b128 v[28:31], v3 offset:12288
    v_mfma_f32_16x16x32_bf16 v[168:171], v[36:39], v[196:199], v[168:171]
    v_cvt_pk_bf16_f32 v93, v18, v19
    v_mfma_f32_16x16x32_bf16 v[172:175], v[32:35], v[216:219], v[172:175]
    v_exp_f32 v18, v126
    v_mfma_f32_16x16x32_bf16 v[172:175], v[36:39], v[220:223], v[172:175]
    s_waitcnt lgkmcnt(2)
    v_add_f32 v8, v8, v16
    v_mfma_f32_16x16x32_bf16 v[96:99], v[40:43], a[208:211], v[96:99]
    ds_read_b128 v[32:35], v2 offset:18432
    v_add_f32 v8, v8, v17
    v_mfma_f32_16x16x32_bf16 v[96:99], v[44:47], a[212:215], v[96:99]
    s_mov_b32 m0, s26
    v_exp_f32 v19, v127
    v_mfma_f32_16x16x32_bf16 v[100:103], v[40:43], a[232:235], v[100:103]
    s_sub_u32 s3, s29, s30
    v_mfma_f32_16x16x32_bf16 v[100:103], v[44:47], a[236:239], v[100:103]
    buffer_load_dwordx4 v4, s[4:7], s32 offen offset:0 sc1 lds
    v_mfma_f32_16x16x32_bf16 v[104:107], v[40:43], v[192:195], v[104:107]
    ds_read_b128 v[36:39], v3 offset:18432
    v_cvt_pk_bf16_f32 v94, v16, v17
    v_mfma_f32_16x16x32_bf16 v[104:107], v[44:47], v[196:199], v[104:107]
    v_add_f32 v8, v8, v18
    v_add_f32 v8, v8, v19
    v_mfma_f32_16x16x32_bf16 v[108:111], v[40:43], v[216:219], v[108:111]
    v_cvt_pk_bf16_f32 v95, v18, v19
    v_mfma_f32_16x16x32_bf16 v[108:111], v[44:47], v[220:223], v[108:111]
    s_waitcnt lgkmcnt(2)
    buffer_load_dwordx4 v4, s[4:7], s32 offen offset:1024 sc1 lds
    v_mfma_f32_16x16x32_bf16 v[176:179], v[24:27], a[192:195], v[128:131]
    ds_read_b128 v[40:43], v2 offset:12416
    v_mfma_f32_16x16x32_bf16 v[176:179], v[28:31], a[196:199], v[176:179]
    s_mov_b32 s30, s29
    v_exp_f32 v16, v160
    v_mfma_f32_16x16x32_bf16 v[180:183], v[24:27], a[216:219], v[132:135]
    v_exp_f32 v17, v161
    v_mfma_f32_16x16x32_bf16 v[180:183], v[28:31], a[220:223], v[180:183]
    buffer_load_dwordx4 v4, s[4:7], s32 offen offset:2048 sc1 lds
    v_mfma_f32_16x16x32_bf16 v[184:187], v[24:27], a[240:243], v[136:139]
    s_add_u32 s32, s32, 24576
    ds_read_b128 v[44:47], v3 offset:12416
    v_mfma_f32_16x16x32_bf16 v[184:187], v[28:31], a[244:247], v[184:187]
    v_exp_f32 v18, v162
    v_mfma_f32_16x16x32_bf16 v[188:191], v[24:27], v[200:203], v[140:143]
    s_add_u32 s26, s26, 12288
    v_add_f32 v5, v5, v16
    v_add_f32 v5, v5, v17
    v_mfma_f32_16x16x32_bf16 v[188:191], v[28:31], v[204:207], v[188:191]
    s_waitcnt lgkmcnt(2)
    v_exp_f32 v19, v163
    v_mfma_f32_16x16x32_bf16 v[112:115], v[32:35], a[192:195], v[128:131]
    s_mov_b32 m0, s26
    ds_read_b128 v[24:27], v2 offset:18560
    v_cvt_pk_bf16_f32 v160, v16, v17
    v_mfma_f32_16x16x32_bf16 v[112:115], v[36:39], a[196:199], v[112:115]
    v_exp_f32 v16, v96
    v_mfma_f32_16x16x32_bf16 v[116:119], v[32:35], a[216:219], v[132:135]
    v_add_f32 v5, v5, v18
    v_add_f32 v5, v5, v19
    v_mfma_f32_16x16x32_bf16 v[116:119], v[36:39], a[220:223], v[116:119]
    v_exp_f32 v17, v97
    v_mfma_f32_16x16x32_bf16 v[120:123], v[32:35], a[240:243], v[136:139]
    ds_read_b128 v[28:31], v3 offset:18560
    v_add_u32 v1, s3, v1
    v_mfma_f32_16x16x32_bf16 v[120:123], v[36:39], a[244:247], v[120:123]
    buffer_load_dwordx4 v4, s[4:7], s32 offen offset:0 sc1 lds
    v_mfma_f32_16x16x32_bf16 v[124:127], v[32:35], v[200:203], v[140:143]
    v_cvt_pk_bf16_f32 v161, v18, v19
    v_mfma_f32_16x16x32_bf16 v[124:127], v[36:39], v[204:207], v[124:127]
    s_waitcnt lgkmcnt(2)
    v_exp_f32 v18, v98
    v_mfma_f32_16x16x32_bf16 v[176:179], v[40:43], a[200:203], v[176:179]
    ds_read_b128 v[32:35], v2 offset:12544
    v_add_f32 v5, v5, v16
    v_mfma_f32_16x16x32_bf16 v[176:179], v[44:47], a[204:207], v[176:179]
    buffer_load_dwordx4 v4, s[4:7], s32 offen offset:1024 sc1 lds
    v_mfma_f32_16x16x32_bf16 v[180:183], v[40:43], a[224:227], v[180:183]
    v_add_f32 v5, v5, v17
    v_mfma_f32_16x16x32_bf16 v[180:183], v[44:47], a[228:231], v[180:183]
    v_exp_f32 v19, v99
    v_mfma_f32_16x16x32_bf16 v[184:187], v[40:43], a[248:251], v[184:187]
    ds_read_b128 v[36:39], v3 offset:12544
    v_cvt_pk_bf16_f32 v162, v16, v17
    v_mfma_f32_16x16x32_bf16 v[184:187], v[44:47], a[252:255], v[184:187]
    buffer_load_dwordx4 v4, s[4:7], s32 offen offset:2048 sc1 lds
    v_mfma_f32_16x16x32_bf16 v[188:191], v[40:43], v[208:211], v[188:191]
    v_exp_f32 v16, v164
    v_mfma_f32_16x16x32_bf16 v[188:191], v[44:47], v[212:215], v[188:191]
    s_waitcnt lgkmcnt(2)
    v_add_f32 v5, v5, v18
    v_add_f32 v5, v5, v19
    v_mfma_f32_16x16x32_bf16 v[112:115], v[24:27], a[200:203], v[112:115]
L_pg9:
    s_cbranch_execz L_pg13
    ds_read_b128 v[40:43], v2 offset:18688
    v_mfma_f32_16x16x32_bf16 v[112:115], v[28:31], a[204:207], v[112:115]
    v_exp_f32 v17, v165
    v_mfma_f32_16x16x32_bf16 v[116:119], v[24:27], a[224:227], v[116:119]
    v_cvt_pk_bf16_f32 v163, v18, v19
    v_mfma_f32_16x16x32_bf16 v[116:119], v[28:31], a[228:231], v[116:119]
    s_add_u32 s32, s32, 24576
    v_exp_f32 v18, v166
    v_mfma_f32_16x16x32_bf16 v[120:123], v[24:27], a[248:251], v[120:123]
    s_add_u32 s26, s26, 36864
    ds_read_b128 v[44:47], v3 offset:18688
    v_add_f32 v6, v6, v16
    v_mfma_f32_16x16x32_bf16 v[120:123], v[28:31], a[252:255], v[120:123]
    s_waitcnt lgkmcnt(2)
    v_add_f32 v6, v6, v17
    s_sub_u32 s57, s26, 147456
    v_mfma_f32_16x16x32_bf16 v[124:127], v[24:27], v[208:211], v[124:127]
    s_waitcnt vmcnt(6)
    v_exp_f32 v19, v167
    v_mfma_f32_16x16x32_bf16 v[124:127], v[28:31], v[212:215], v[124:127]
    s_barrier
    v_cvt_pk_bf16_f32 v164, v16, v17
    v_mfma_f32_16x16x32_bf16 v[176:179], v[32:35], a[208:211], v[176:179]
    s_min_u32 s26, s26, s57
    ds_read_b128 v[24:27], v1 offset:0
    v_add_u32 v0, 1, v0
    v_mfma_f32_16x16x32_bf16 v[176:179], v[36:39], a[212:215], v[176:179]
    buffer_store_dword v0, v13, s[20:23], 0 offen offset:32 sc1
    v_mfma_f32_16x16x32_bf16 v[180:183], v[32:35], a[232:235], v[180:183]
    v_exp_f32 v16, v100
    v_mfma_f32_16x16x32_bf16 v[180:183], v[36:39], a[236:239], v[180:183]
    v_add_f32 v6, v6, v18
    v_add_f32 v6, v6, v19
    v_mfma_f32_16x16x32_bf16 v[184:187], v[32:35], v[192:195], v[184:187]
    ds_read_b128 v[28:31], v1 offset:12288
    v_mfma_f32_16x16x32_bf16 v[184:187], v[36:39], v[196:199], v[184:187]
    v_exp_f32 v17, v101
    v_mfma_f32_16x16x32_bf16 v[188:191], v[32:35], v[216:219], v[188:191]
    v_cvt_pk_bf16_f32 v165, v18, v19
    v_mfma_f32_16x16x32_bf16 v[188:191], v[36:39], v[220:223], v[188:191]
    s_waitcnt lgkmcnt(2)
    v_exp_f32 v18, v102
    v_mfma_f32_16x16x32_bf16 v[112:115], v[40:43], a[208:211], v[112:115]
    ds_read_b128 v[32:35], v1 offset:1024
    v_add_f32 v6, v6, v16
    v_mfma_f32_16x16x32_bf16 v[112:115], v[44:47], a[212:215], v[112:115]
    v_add_f32 v6, v6, v17
    v_mfma_f32_16x16x32_bf16 v[116:119], v[40:43], a[232:235], v[116:119]
    v_exp_f32 v19, v103
    v_mfma_f32_16x16x32_bf16 v[116:119], v[44:47], a[236:239], v[116:119]
    v_cvt_pk_bf16_f32 v166, v16, v17
    v_mfma_f32_16x16x32_bf16 v[120:123], v[40:43], v[192:195], v[120:123]
    ds_read_b128 v[36:39], v1 offset:13312
    v_add_f32 v6, v6, v18
    v_mfma_f32_16x16x32_bf16 v[120:123], v[44:47], v[196:199], v[120:123]
    v_add_f32 v6, v6, v19
    v_cvt_pk_bf16_f32 v167, v18, v19
    v_mfma_f32_16x16x32_bf16 v[124:127], v[40:43], v[216:219], v[124:127]
    v_mfma_f32_16x16x32_bf16 v[124:127], v[44:47], v[220:223], v[124:127]
    s_waitcnt lgkmcnt(2)
    v_mfma_f32_16x16x32_bf16 a[0:3], v[64:67], v[24:27], a[0:3]
    s_mov_b32 m0, s26
    ds_read_b128 v[40:43], v1 offset:2048
    v_mfma_f32_16x16x32_bf16 a[0:3], v[80:83], v[28:31], a[0:3]
    buffer_load_dwordx4 v4, s[4:7], s32 offen offset:0 sc1 lds
    v_mfma_f32_16x16x32_bf16 a[48:51], v[68:71], v[24:27], a[48:51]
    v_exp_f32 v16, v168
    v_mfma_f32_16x16x32_bf16 a[48:51], v[84:87], v[28:31], a[48:51]
    v_exp_f32 v17, v169
    v_mfma_f32_16x16x32_bf16 a[96:99], v[72:75], v[24:27], a[96:99]
    ds_read_b128 v[44:47], v1 offset:14336
    v_mfma_f32_16x16x32_bf16 a[96:99], v[88:91], v[28:31], a[96:99]
    v_exp_f32 v18, v170
    v_mfma_f32_16x16x32_bf16 a[144:147], v[76:79], v[24:27], a[144:147]
    v_add_f32 v7, v7, v16
    v_add_f32 v7, v7, v17
    v_mfma_f32_16x16x32_bf16 a[144:147], v[92:95], v[28:31], a[144:147]
    s_waitcnt lgkmcnt(2)
    v_exp_f32 v19, v171
    v_mfma_f32_16x16x32_bf16 a[4:7], v[64:67], v[32:35], a[4:7]
    ds_read_b128 v[24:27], v1 offset:3072
    v_cvt_pk_bf16_f32 v168, v16, v17
    v_mfma_f32_16x16x32_bf16 a[4:7], v[80:83], v[36:39], a[4:7]
    v_exp_f32 v16, v104
    v_mfma_f32_16x16x32_bf16 a[52:55], v[68:71], v[32:35], a[52:55]
    v_add_f32 v7, v7, v18
    v_add_f32 v7, v7, v19
    v_mfma_f32_16x16x32_bf16 a[52:55], v[84:87], v[36:39], a[52:55]
    buffer_load_dwordx4 v4, s[4:7], s32 offen offset:1024 sc1 lds
    v_mfma_f32_16x16x32_bf16 a[100:103], v[72:75], v[32:35], a[100:103]
    ds_read_b128 v[28:31], v1 offset:15360
    v_mfma_f32_16x16x32_bf16 a[100:103], v[88:91], v[36:39], a[100:103]
    v_exp_f32 v17, v105
    v_mfma_f32_16x16x32_bf16 a[148:151], v[76:79], v[32:35], a[148:151]
    v_cvt_pk_bf16_f32 v169, v18, v19
    v_mfma_f32_16x16x32_bf16 a[148:151], v[92:95], v[36:39], a[148:151]
    s_waitcnt lgkmcnt(2)
    v_exp_f32 v18, v106
    v_mfma_f32_16x16x32_bf16 a[8:11], v[64:67], v[40:43], a[8:11]
    ds_read_b128 v[32:35], v1 offset:4096
    v_add_f32 v7, v7, v16
    v_mfma_f32_16x16x32_bf16 a[8:11], v[80:83], v[44:47], a[8:11]
    v_add_f32 v7, v7, v17
    v_mfma_f32_16x16x32_bf16 a[56:59], v[68:71], v[40:43], a[56:59]
    v_exp_f32 v19, v107
    v_mfma_f32_16x16x32_bf16 a[56:59], v[84:87], v[44:47], a[56:59]
    v_cvt_pk_bf16_f32 v170, v16, v17
    v_mfma_f32_16x16x32_bf16 a[104:107], v[72:75], v[40:43], a[104:107]
    ds_read_b128 v[36:39], v1 offset:16384
    v_mfma_f32_16x16x32_bf16 a[104:107], v[88:91], v[44:47], a[104:107]
    v_exp_f32 v16, v172
    v_mfma_f32_16x16x32_bf16 a[152:155], v[76:79], v[40:43], a[152:155]
    v_add_f32 v7, v7, v18
    v_add_f32 v7, v7, v19
    v_mfma_f32_16x16x32_bf16 a[152:155], v[92:95], v[44:47], a[152:155]
    s_waitcnt lgkmcnt(2)
    buffer_load_dwordx4 v4, s[4:7], s32 offen offset:2048 sc1 lds
    v_mfma_f32_16x16x32_bf16 a[12:15], v[64:67], v[24:27], a[12:15]
    ds_read_b128 v[40:43], v1 offset:5120
    v_mfma_f32_16x16x32_bf16 a[12:15], v[80:83], v[28:31], a[12:15]
    v_exp_f32 v17, v173
    v_mfma_f32_16x16x32_bf16 a[60:63], v[68:71], v[24:27], a[60:63]
    v_cvt_pk_bf16_f32 v171, v18, v19
    v_mfma_f32_16x16x32_bf16 a[60:63], v[84:87], v[28:31], a[60:63]
    v_exp_f32 v18, v174
    v_mfma_f32_16x16x32_bf16 a[108:111], v[72:75], v[24:27], a[108:111]
    ds_read_b128 v[44:47], v1 offset:17408
    v_add_f32 v8, v8, v16
    v_mfma_f32_16x16x32_bf16 a[108:111], v[88:91], v[28:31], a[108:111]
    v_add_f32 v8, v8, v17
    v_mfma_f32_16x16x32_bf16 a[156:159], v[76:79], v[24:27], a[156:159]
    s_add_u32 s29, s28, 49152
    v_exp_f32 v19, v175
    v_mfma_f32_16x16x32_bf16 a[156:159], v[92:95], v[28:31], a[156:159]
    s_waitcnt lgkmcnt(2)
    v_cvt_pk_bf16_f32 v172, v16, v17
    s_sub_u32 s3, s29, 147456
    v_mfma_f32_16x16x32_bf16 a[16:19], v[64:67], v[32:35], a[16:19]
    s_add_u32 s32, s32, 24576
    ds_read_b128 v[24:27], v1 offset:6144
    v_mfma_f32_16x16x32_bf16 a[16:19], v[80:83], v[36:39], a[16:19]
    s_min_u32 s29, s29, s3
    v_exp_f32 v16, v108
    v_mfma_f32_16x16x32_bf16 a[64:67], v[68:71], v[32:35], a[64:67]
    v_add_f32 v8, v8, v18
    v_add_f32 v8, v8, v19
    v_mfma_f32_16x16x32_bf16 a[64:67], v[84:87], v[36:39], a[64:67]
    v_exp_f32 v17, v109
    v_mfma_f32_16x16x32_bf16 a[112:115], v[72:75], v[32:35], a[112:115]
    s_add_u32 s26, s26, 12288
    ds_read_b128 v[28:31], v1 offset:18432
    v_mfma_f32_16x16x32_bf16 a[112:115], v[88:91], v[36:39], a[112:115]
    v_cvt_pk_bf16_f32 v173, v18, v19
    v_mfma_f32_16x16x32_bf16 a[160:163], v[76:79], v[32:35], a[160:163]
    v_exp_f32 v18, v110
    v_mfma_f32_16x16x32_bf16 a[160:163], v[92:95], v[36:39], a[160:163]
    s_waitcnt lgkmcnt(2)
    v_add_f32 v8, v8, v16
    v_mfma_f32_16x16x32_bf16 a[20:23], v[64:67], v[40:43], a[20:23]
    s_sub_u32 s3, s29, s28
    ds_read_b128 v[32:35], v1 offset:7168
    v_add_f32 v8, v8, v17
    v_mfma_f32_16x16x32_bf16 a[20:23], v[80:83], v[44:47], a[20:23]
    v_exp_f32 v19, v111
    v_mfma_f32_16x16x32_bf16 a[68:71], v[68:71], v[40:43], a[68:71]
    s_mov_b32 m0, s26
    v_mfma_f32_16x16x32_bf16 a[68:71], v[84:87], v[44:47], a[68:71]
    v_cvt_pk_bf16_f32 v174, v16, v17
    v_mfma_f32_16x16x32_bf16 a[116:119], v[72:75], v[40:43], a[116:119]
    ds_read_b128 v[36:39], v1 offset:19456
    v_add_f32 v8, v8, v18
    v_mfma_f32_16x16x32_bf16 a[116:119], v[88:91], v[44:47], a[116:119]
    v_add_f32 v8, v8, v19
    v_cvt_pk_bf16_f32 v175, v18, v19
    v_mfma_f32_16x16x32_bf16 a[164:167], v[76:79], v[40:43], a[164:167]
    s_mov_b32 s28, s29
    v_mfma_f32_16x16x32_bf16 a[164:167], v[92:95], v[44:47], a[164:167]
    s_waitcnt lgkmcnt(2)
    v_exp_f32 v16, v176
    v_mfma_f32_16x16x32_bf16 a[24:27], v[64:67], v[24:27], a[24:27]
    ds_read_b128 v[40:43], v1 offset:8192
    v_mfma_f32_16x16x32_bf16 a[24:27], v[80:83], v[28:31], a[24:27]
    v_exp_f32 v17, v177
    v_mfma_f32_16x16x32_bf16 a[72:75], v[68:71], v[24:27], a[72:75]
    v_exp_f32 v18, v178
    v_mfma_f32_16x16x32_bf16 a[72:75], v[84:87], v[28:31], a[72:75]
    buffer_load_dwordx4 v4, s[4:7], s32 offen offset:0 sc1 lds
    v_mfma_f32_16x16x32_bf16 a[120:123], v[72:75], v[24:27], a[120:123]
    ds_read_b128 v[44:47], v1 offset:20480
    v_add_f32 v5, v5, v16
    v_mfma_f32_16x16x32_bf16 a[120:123], v[88:91], v[28:31], a[120:123]
    v_add_f32 v5, v5, v17
    v_add_u32 v2, s3, v2
    v_mfma_f32_16x16x32_bf16 a[168:171], v[76:79], v[24:27], a[168:171]
    v_exp_f32 v19, v179
    v_mfma_f32_16x16x32_bf16 a[168:171], v[92:95], v[28:31], a[168:171]
    s_waitcnt lgkmcnt(2)
    v_cvt_pk_bf16_f32 v176, v16, v17
    v_mfma_f32_16x16x32_bf16 a[28:31], v[64:67], v[32:35], a[28:31]
    ds_read_b128 v[24:27], v1 offset:9216
    v_mfma_f32_16x16x32_bf16 a[28:31], v[80:83], v[36:39], a[28:31]
    v_exp_f32 v16, v112
    v_mfma_f32_16x16x32_bf16 a[76:79], v[68:71], v[32:35], a[76:79]
    v_add_f32 v5, v5, v18
    v_add_f32 v5, v5, v19
    v_mfma_f32_16x16x32_bf16 a[76:79], v[84:87], v[36:39], a[76:79]
    v_exp_f32 v17, v113
    v_mfma_f32_16x16x32_bf16 a[124:127], v[72:75], v[32:35], a[124:127]
    ds_read_b128 v[28:31], v1 offset:21504
    v_add_u32 v3, s3, v3
    v_mfma_f32_16x16x32_bf16 a[124:127], v[88:91], v[36:39], a[124:127]
    v_cvt_pk_bf16_f32 v177, v18, v19
    v_mfma_f32_16x16x32_bf16 a[172:175], v[76:79], v[32:35], a[172:175]
    v_exp_f32 v18, v114
    v_mfma_f32_16x16x32_bf16 a[172:175], v[92:95], v[36:39], a[172:175]
    s_waitcnt lgkmcnt(2)
    buffer_load_dwordx4 v4, s[4:7], s32 offen offset:1024 sc1 lds
    v_mfma_f32_16x16x32_bf16 a[32:35], v[64:67], v[40:43], a[32:35]
    ds_read_b128 v[32:35], v1 offset:10240
    v_add_f32 v5, v5, v16
    v_mfma_f32_16x16x32_bf16 a[32:35], v[80:83], v[44:47], a[32:35]
    v_add_f32 v5, v5, v17
    v_mfma_f32_16x16x32_bf16 a[80:83], v[68:71], v[40:43], a[80:83]
    v_exp_f32 v19, v115
    v_mfma_f32_16x16x32_bf16 a[80:83], v[84:87], v[44:47], a[80:83]
    v_cvt_pk_bf16_f32 v178, v16, v17
    v_mfma_f32_16x16x32_bf16 a[128:131], v[72:75], v[40:43], a[128:131]
    ds_read_b128 v[36:39], v1 offset:22528
    v_mfma_f32_16x16x32_bf16 a[128:131], v[88:91], v[44:47], a[128:131]
    v_exp_f32 v16, v180
    v_mfma_f32_16x16x32_bf16 a[176:179], v[76:79], v[40:43], a[176:179]
    v_add_f32 v5, v5, v18
    v_add_f32 v5, v5, v19
    v_mfma_f32_16x16x32_bf16 a[176:179], v[92:95], v[44:47], a[176:179]
    s_waitcnt lgkmcnt(2)
    v_exp_f32 v17, v181
    v_mfma_f32_16x16x32_bf16 a[36:39], v[64:67], v[24:27], a[36:39]
    ds_read_b128 v[40:43], v1 offset:11264
    v_mfma_f32_16x16x32_bf16 a[36:39], v[80:83], v[28:31], a[36:39]
    buffer_load_dwordx4 v4, s[4:7], s32 offen offset:2048 sc1 lds
    v_mfma_f32_16x16x32_bf16 a[84:87], v[68:71], v[24:27], a[84:87]
    v_cvt_pk_bf16_f32 v179, v18, v19
    v_mfma_f32_16x16x32_bf16 a[84:87], v[84:87], v[28:31], a[84:87]
    v_exp_f32 v18, v182
    v_mfma_f32_16x16x32_bf16 a[132:135], v[72:75], v[24:27], a[132:135]
    ds_read_b128 v[44:47], v1 offset:23552
    v_add_f32 v6, v6, v16
    v_mfma_f32_16x16x32_bf16 a[132:135], v[88:91], v[28:31], a[132:135]
    s_waitcnt lgkmcnt(2)
    v_add_f32 v6, v6, v17
    v_mfma_f32_16x16x32_bf16 a[180:183], v[76:79], v[24:27], a[180:183]
    s_waitcnt vmcnt(7)
    v_exp_f32 v19, v183
    v_mfma_f32_16x16x32_bf16 a[180:183], v[92:95], v[28:31], a[180:183]
    s_barrier
    v_cvt_pk_bf16_f32 v180, v16, v17
    v_mfma_f32_16x16x32_bf16 a[40:43], v[64:67], v[32:35], a[40:43]
    ds_read_b128 v[24:27], v2 offset:0
    v_mfma_f32_16x16x32_bf16 a[40:43], v[80:83], v[36:39], a[40:43]
    v_exp_f32 v16, v116
    v_mfma_f32_16x16x32_bf16 a[88:91], v[68:71], v[32:35], a[88:91]
    v_add_f32 v6, v6, v18
    v_add_f32 v6, v6, v19
    v_mfma_f32_16x16x32_bf16 a[88:91], v[84:87], v[36:39], a[88:91]
    v_exp_f32 v17, v117
    v_mfma_f32_16x16x32_bf16 a[136:139], v[72:75], v[32:35], a[136:139]
    ds_read_b128 v[28:31], v3 offset:0
    v_mfma_f32_16x16x32_bf16 a[136:139], v[88:91], v[36:39], a[136:139]
    v_cvt_pk_bf16_f32 v181, v18, v19
    v_mfma_f32_16x16x32_bf16 a[184:187], v[76:79], v[32:35], a[184:187]
    v_exp_f32 v18, v118
    v_mfma_f32_16x16x32_bf16 a[184:187], v[92:95], v[36:39], a[184:187]
    s_waitcnt lgkmcnt(2)
    v_add_f32 v6, v6, v16
    v_mfma_f32_16x16x32_bf16 a[44:47], v[64:67], v[40:43], a[44:47]
    ds_read_b128 v[32:35], v2 offset:6144
    v_add_f32 v6, v6, v17
    v_mfma_f32_16x16x32_bf16 a[44:47], v[80:83], v[44:47], a[44:47]
    v_exp_f32 v19, v119
    v_mfma_f32_16x16x32_bf16 a[92:95], v[68:71], v[40:43], a[92:95]
    v_mfma_f32_16x16x32_bf16 a[92:95], v[84:87], v[44:47], a[92:95]
    s_add_u32 s32, s32, 24576
    s_add_u32 s26, s26, 36864
    v_cvt_pk_bf16_f32 v182, v16, v17
    v_mfma_f32_16x16x32_bf16 a[140:143], v[72:75], v[40:43], a[140:143]
    s_sub_u32 s57, s26, 147456
    ds_read_b128 v[36:39], v3 offset:6144
    v_add_f32 v6, v6, v18
    v_mfma_f32_16x16x32_bf16 a[140:143], v[88:91], v[44:47], a[140:143]
    s_min_u32 s26, s26, s57
    v_add_f32 v6, v6, v19
    v_cvt_pk_bf16_f32 v183, v18, v19
    v_mfma_f32_16x16x32_bf16 a[188:191], v[76:79], v[40:43], a[188:191]
    v_mfma_f32_16x16x32_bf16 a[188:191], v[92:95], v[44:47], a[188:191]
    s_waitcnt lgkmcnt(2)
    v_mfma_f32_16x16x32_bf16 v[64:67], v[24:27], a[192:195], v[128:131]
    ds_read_b128 v[40:43], v2 offset:128
    v_mfma_f32_16x16x32_bf16 v[64:67], v[28:31], a[196:199], v[64:67]
    v_exp_f32 v16, v184
    v_mfma_f32_16x16x32_bf16 v[68:71], v[24:27], a[216:219], v[132:135]
    v_exp_f32 v17, v185
    v_mfma_f32_16x16x32_bf16 v[68:71], v[28:31], a[220:223], v[68:71]
    v_bfe_u32 v53, v4, 4, 6
    v_mfma_f32_16x16x32_bf16 v[72:75], v[24:27], a[240:243], v[136:139]
    ds_read_b128 v[44:47], v3 offset:128
    v_lshlrev_b32 v53, 2, v53
    v_mfma_f32_16x16x32_bf16 v[72:75], v[28:31], a[244:247], v[72:75]
    buffer_load_dword v52, v53, s[20:23], s44 offen sc1
    v_mfma_f32_16x16x32_bf16 v[76:79], v[24:27], v[200:203], v[140:143]
    v_exp_f32 v18, v186
    v_mfma_f32_16x16x32_bf16 v[76:79], v[28:31], v[204:207], v[76:79]
    s_waitcnt lgkmcnt(2)
    v_add_f32 v7, v7, v16
    v_add_f32 v7, v7, v17
    v_mfma_f32_16x16x32_bf16 v[96:99], v[32:35], a[192:195], v[128:131]
    ds_read_b128 v[24:27], v2 offset:6272
    v_mfma_f32_16x16x32_bf16 v[96:99], v[36:39], a[196:199], v[96:99]
    v_exp_f32 v19, v187
    v_mfma_f32_16x16x32_bf16 v[100:103], v[32:35], a[216:219], v[132:135]
    v_cvt_pk_bf16_f32 v184, v16, v17
    v_mfma_f32_16x16x32_bf16 v[100:103], v[36:39], a[220:223], v[100:103]
    s_mov_b32 m0, s26
    v_exp_f32 v16, v120
    v_mfma_f32_16x16x32_bf16 v[104:107], v[32:35], a[240:243], v[136:139]
    ds_read_b128 v[28:31], v3 offset:6272
    v_add_f32 v7, v7, v18
    v_mfma_f32_16x16x32_bf16 v[104:107], v[36:39], a[244:247], v[104:107]
    buffer_load_dwordx4 v4, s[4:7], s32 offen offset:0 sc1 lds
    v_mfma_f32_16x16x32_bf16 v[108:111], v[32:35], v[200:203], v[140:143]
    v_add_f32 v7, v7, v19
    v_mfma_f32_16x16x32_bf16 v[108:111], v[36:39], v[204:207], v[108:111]
    s_waitcnt lgkmcnt(2)
    v_exp_f32 v17, v121
    v_mfma_f32_16x16x32_bf16 v[64:67], v[40:43], a[200:203], v[64:67]
    ds_read_b128 v[32:35], v2 offset:256
    v_cvt_pk_bf16_f32 v185, v18, v19
    v_mfma_f32_16x16x32_bf16 v[64:67], v[44:47], a[204:207], v[64:67]
    v_exp_f32 v18, v122
    v_mfma_f32_16x16x32_bf16 v[68:71], v[40:43], a[224:227], v[68:71]
    v_add_f32 v7, v7, v16
    v_add_f32 v7, v7, v17
    v_mfma_f32_16x16x32_bf16 v[68:71], v[44:47], a[228:231], v[68:71]
    v_exp_f32 v19, v123
    v_mfma_f32_16x16x32_bf16 v[72:75], v[40:43], a[248:251], v[72:75]
    ds_read_b128 v[36:39], v3 offset:256
    v_cvt_pk_bf16_f32 v186, v16, v17
    v_mfma_f32_16x16x32_bf16 v[72:75], v[44:47], a[252:255], v[72:75]
    buffer_load_dwordx4 v4, s[4:7], s32 offen offset:1024 sc1 lds
    v_mfma_f32_16x16x32_bf16 v[76:79], v[40:43], v[208:211], v[76:79]
    v_exp_f32 v16, v188
    v_mfma_f32_16x16x32_bf16 v[76:79], v[44:47], v[212:215], v[76:79]
    s_waitcnt lgkmcnt(2)
    v_add_f32 v7, v7, v18
    v_add_f32 v7, v7, v19
    v_mfma_f32_16x16x32_bf16 v[96:99], v[24:27], a[200:203], v[96:99]
    ds_read_b128 v[40:43], v2 offset:6400
    v_mfma_f32_16x16x32_bf16 v[96:99], v[28:31], a[204:207], v[96:99]
    v_exp_f32 v17, v189
    v_mfma_f32_16x16x32_bf16 v[100:103], v[24:27], a[224:227], v[100:103]
    v_cvt_pk_bf16_f32 v187, v18, v19
    v_mfma_f32_16x16x32_bf16 v[100:103], v[28:31], a[228:231], v[100:103]
    v_exp_f32 v18, v190
    v_mfma_f32_16x16x32_bf16 v[104:107], v[24:27], a[248:251], v[104:107]
    ds_read_b128 v[44:47], v3 offset:6400
    v_add_f32 v8, v8, v16
    v_mfma_f32_16x16x32_bf16 v[104:107], v[28:31], a[252:255], v[104:107]
    v_add_f32 v8, v8, v17
    v_mfma_f32_16x16x32_bf16 v[108:111], v[24:27], v[208:211], v[108:111]
    s_add_u32 s29, s30, 49152
    v_exp_f32 v19, v191
    v_mfma_f32_16x16x32_bf16 v[108:111], v[28:31], v[212:215], v[108:111]
    s_waitcnt lgkmcnt(2)
    buffer_load_dwordx4 v4, s[4:7], s32 offen offset:2048 sc1 lds
    v_mfma_f32_16x16x32_bf16 v[64:67], v[32:35], a[208:211], v[64:67]
    s_sub_u32 s3, s29, 147456
    ds_read_b128 v[24:27], v2 offset:12288
    v_cvt_pk_bf16_f32 v188, v16, v17
    v_mfma_f32_16x16x32_bf16 v[64:67], v[36:39], a[212:215], v[64:67]
    s_min_u32 s29, s29, s3
    v_exp_f32 v16, v124
    v_mfma_f32_16x16x32_bf16 v[68:71], v[32:35], a[232:235], v[68:71]
    v_add_f32 v8, v8, v18
    v_add_f32 v8, v8, v19
    v_mfma_f32_16x16x32_bf16 v[68:71], v[36:39], a[236:239], v[68:71]
    v_exp_f32 v17, v125
    v_mfma_f32_16x16x32_bf16 v[72:75], v[32:35], v[192:195], v[72:75]
    ds_read_b128 v[28:31], v3 offset:12288
    v_mfma_f32_16x16x32_bf16 v[72:75], v[36:39], v[196:199], v[72:75]
    v_cvt_pk_bf16_f32 v189, v18, v19
    v_mfma_f32_16x16x32_bf16 v[76:79], v[32:35], v[216:219], v[76:79]
    v_exp_f32 v18, v126
    v_mfma_f32_16x16x32_bf16 v[76:79], v[36:39], v[220:223], v[76:79]
    s_waitcnt lgkmcnt(2)
    v_add_f32 v8, v8, v16
    s_add_u32 s32, s32, 24576
    v_mfma_f32_16x16x32_bf16 v[96:99], v[40:43], a[208:211], v[96:99]
    ds_read_b128 v[32:35], v2 offset:18432
    v_add_f32 v8, v8, v17
    v_mfma_f32_16x16x32_bf16 v[96:99], v[44:47], a[212:215], v[96:99]
    s_sub_u32 s3, s29, s30
    v_exp_f32 v19, v127
    v_mfma_f32_16x16x32_bf16 v[100:103], v[40:43], a[232:235], v[100:103]
    v_mfma_f32_16x16x32_bf16 v[100:103], v[44:47], a[236:239], v[100:103]
    v_cvt_pk_bf16_f32 v190, v16, v17
    v_mfma_f32_16x16x32_bf16 v[104:107], v[40:43], v[192:195], v[104:107]
    s_add_u32 s26, s26, 12288
    ds_read_b128 v[36:39], v3 offset:18432
    v_add_f32 v8, v8, v18
    v_mfma_f32_16x16x32_bf16 v[104:107], v[44:47], v[196:199], v[104:107]
    v_add_f32 v8, v8, v19
    v_cvt_pk_bf16_f32 v191, v18, v19
    v_mfma_f32_16x16x32_bf16 v[108:111], v[40:43], v[216:219], v[108:111]
    v_mfma_f32_16x16x32_bf16 v[108:111], v[44:47], v[220:223], v[108:111]
    s_waitcnt lgkmcnt(2)
    v_exp_f32 v16, v64
    v_mfma_f32_16x16x32_bf16 v[80:83], v[24:27], a[192:195], v[128:131]
    ds_read_b128 v[40:43], v2 offset:12416
    v_mfma_f32_16x16x32_bf16 v[80:83], v[28:31], a[196:199], v[80:83]
    s_mov_b32 m0, s26
    v_exp_f32 v17, v65
    v_mfma_f32_16x16x32_bf16 v[84:87], v[24:27], a[216:219], v[132:135]
    s_mov_b32 s30, s29
    v_exp_f32 v18, v66
    v_mfma_f32_16x16x32_bf16 v[84:87], v[28:31], a[220:223], v[84:87]
    v_add_f32 v5, v5, v16
    v_mfma_f32_16x16x32_bf16 v[88:91], v[24:27], a[240:243], v[136:139]
    ds_read_b128 v[44:47], v3 offset:12416
    v_add_f32 v5, v5, v17
    v_mfma_f32_16x16x32_bf16 v[88:91], v[28:31], a[244:247], v[88:91]
    v_exp_f32 v19, v67
    v_mfma_f32_16x16x32_bf16 v[92:95], v[24:27], v[200:203], v[140:143]
    v_mfma_f32_16x16x32_bf16 v[92:95], v[28:31], v[204:207], v[92:95]
    s_waitcnt lgkmcnt(2)
    v_cvt_pk_bf16_f32 v64, v16, v17
    v_mfma_f32_16x16x32_bf16 v[112:115], v[32:35], a[192:195], v[128:131]
    ds_read_b128 v[24:27], v2 offset:18560
    v_mfma_f32_16x16x32_bf16 v[112:115], v[36:39], a[196:199], v[112:115]
    buffer_load_dwordx4 v4, s[4:7], s32 offen offset:0 sc1 lds
    v_mfma_f32_16x16x32_bf16 v[116:119], v[32:35], a[216:219], v[132:135]
    v_exp_f32 v16, v96
    v_mfma_f32_16x16x32_bf16 v[116:119], v[36:39], a[220:223], v[116:119]
    v_add_f32 v5, v5, v18
    v_add_f32 v5, v5, v19
    v_mfma_f32_16x16x32_bf16 v[120:123], v[32:35], a[240:243], v[136:139]
    ds_read_b128 v[28:31], v3 offset:18560
    v_add_u32 v1, s3, v1
    v_mfma_f32_16x16x32_bf16 v[120:123], v[36:39], a[244:247], v[120:123]
    v_exp_f32 v17, v97
    v_mfma_f32_16x16x32_bf16 v[124:127], v[32:35], v[200:203], v[140:143]
    v_cvt_pk_bf16_f32 v65, v18, v19
    v_mfma_f32_16x16x32_bf16 v[124:127], v[36:39], v[204:207], v[124:127]
    s_waitcnt lgkmcnt(2)
    v_exp_f32 v18, v98
    v_mfma_f32_16x16x32_bf16 v[80:83], v[40:43], a[200:203], v[80:83]
    ds_read_b128 v[32:35], v2 offset:12544
    v_add_f32 v5, v5, v16
    v_mfma_f32_16x16x32_bf16 v[80:83], v[44:47], a[204:207], v[80:83]
    v_add_f32 v5, v5, v17
    v_mfma_f32_16x16x32_bf16 v[84:87], v[40:43], a[224:227], v[84:87]
    v_exp_f32 v19, v99
    v_mfma_f32_16x16x32_bf16 v[84:87], v[44:47], a[228:231], v[84:87]
    buffer_load_dwordx4 v4, s[4:7], s32 offen offset:1024 sc1 lds
    v_mfma_f32_16x16x32_bf16 v[88:91], v[40:43], a[248:251], v[88:91]
    ds_read_b128 v[36:39], v3 offset:12544
    v_cvt_pk_bf16_f32 v66, v16, v17
    v_mfma_f32_16x16x32_bf16 v[88:91], v[44:47], a[252:255], v[88:91]
    v_exp_f32 v16, v68
    v_mfma_f32_16x16x32_bf16 v[92:95], v[40:43], v[208:211], v[92:95]
    v_add_f32 v5, v5, v18
    v_add_f32 v5, v5, v19
    v_mfma_f32_16x16x32_bf16 v[92:95], v[44:47], v[212:215], v[92:95]
    s_waitcnt lgkmcnt(2)
    v_exp_f32 v17, v69
    v_mfma_f32_16x16x32_bf16 v[112:115], v[24:27], a[200:203], v[112:115]
    ds_read_b128 v[40:43], v2 offset:18688
    v_mfma_f32_16x16x32_bf16 v[112:115], v[28:31], a[204:207], v[112:115]
    v_cvt_pk_bf16_f32 v67, v18, v19
    v_mfma_f32_16x16x32_bf16 v[116:119], v[24:27], a[224:227], v[116:119]
    v_exp_f32 v18, v70
    v_mfma_f32_16x16x32_bf16 v[116:119], v[28:31], a[228:231], v[116:119]
    v_add_f32 v6, v6, v16
    v_mfma_f32_16x16x32_bf16 v[120:123], v[24:27], a[248:251], v[120:123]
    ds_read_b128 v[44:47], v3 offset:18688
    v_add_f32 v6, v6, v17
    v_mfma_f32_16x16x32_bf16 v[120:123], v[28:31], a[252:255], v[120:123]
    s_waitcnt lgkmcnt(2)
    buffer_load_dwordx4 v4, s[4:7], s32 offen offset:2048 sc1 lds
    v_mfma_f32_16x16x32_bf16 v[124:127], v[24:27], v[208:211], v[124:127]
    s_waitcnt vmcnt(7)
    v_exp_f32 v19, v71
    v_mfma_f32_16x16x32_bf16 v[124:127], v[28:31], v[212:215], v[124:127]
    s_barrier
    v_cvt_pk_bf16_f32 v68, v16, v17
    v_mfma_f32_16x16x32_bf16 v[80:83], v[32:35], a[208:211], v[80:83]
    ds_read_b128 v[24:27], v1 offset:0
    v_mfma_f32_16x16x32_bf16 v[80:83], v[36:39], a[212:215], v[80:83]
    v_exp_f32 v16, v100
    v_mfma_f32_16x16x32_bf16 v[84:87], v[32:35], a[232:235], v[84:87]
    v_add_f32 v6, v6, v18
    v_add_f32 v6, v6, v19
    v_mfma_f32_16x16x32_bf16 v[84:87], v[36:39], a[236:239], v[84:87]
    v_exp_f32 v17, v101
    v_mfma_f32_16x16x32_bf16 v[88:91], v[32:35], v[192:195], v[88:91]
    ds_read_b128 v[28:31], v1 offset:12288
    v_mfma_f32_16x16x32_bf16 v[88:91], v[36:39], v[196:199], v[88:91]
    v_cvt_pk_bf16_f32 v69, v18, v19
    v_mfma_f32_16x16x32_bf16 v[92:95], v[32:35], v[216:219], v[92:95]
    v_exp_f32 v18, v102
    v_mfma_f32_16x16x32_bf16 v[92:95], v[36:39], v[220:223], v[92:95]
    s_waitcnt lgkmcnt(2)
    v_add_f32 v6, v6, v16
    v_mfma_f32_16x16x32_bf16 v[112:115], v[40:43], a[208:211], v[112:115]
    ds_read_b128 v[32:35], v1 offset:1024
    v_add_f32 v6, v6, v17
    v_mfma_f32_16x16x32_bf16 v[112:115], v[44:47], a[212:215], v[112:115]
    v_exp_f32 v19, v103
    v_mfma_f32_16x16x32_bf16 v[116:119], v[40:43], a[232:235], v[116:119]
    v_mfma_f32_16x16x32_bf16 v[116:119], v[44:47], a[236:239], v[116:119]
    v_cvt_pk_bf16_f32 v70, v16, v17
    v_mfma_f32_16x16x32_bf16 v[120:123], v[40:43], v[192:195], v[120:123]
    ds_read_b128 v[36:39], v1 offset:13312
    v_add_f32 v6, v6, v18
    v_mfma_f32_16x16x32_bf16 v[120:123], v[44:47], v[196:199], v[120:123]
    s_add_u32 s32, s32, 24576
    s_add_u32 s26, s26, 36864
    v_add_f32 v6, v6, v19
    v_mfma_f32_16x16x32_bf16 v[124:127], v[40:43], v[216:219], v[124:127]
    s_sub_u32 s57, s26, 147456
    v_cvt_pk_bf16_f32 v71, v18, v19
    s_min_u32 s26, s26, s57
    v_mfma_f32_16x16x32_bf16 v[124:127], v[44:47], v[220:223], v[124:127]
    s_waitcnt lgkmcnt(2)
    v_mfma_f32_16x16x32_bf16 a[0:3], v[160:163], v[24:27], a[0:3]
    ds_read_b128 v[40:43], v1 offset:2048
    v_mfma_f32_16x16x32_bf16 a[0:3], v[176:179], v[28:31], a[0:3]
    s_waitcnt vmcnt(6)
    v_subrev_u32 v52, s92, v52
    v_cmp_lt_u32 vcc, 15, v52
    v_mfma_f32_16x16x32_bf16 a[48:51], v[164:167], v[24:27], a[48:51]
    v_exp_f32 v16, v72
    v_mfma_f32_16x16x32_bf16 a[48:51], v[180:183], v[28:31], a[48:51]
    v_exp_f32 v17, v73
    v_mfma_f32_16x16x32_bf16 a[96:99], v[168:171], v[24:27], a[96:99]
    s_and_b32 s59, vcc_lo, 0xff
    ds_read_b128 v[44:47], v1 offset:14336
    v_mfma_f32_16x16x32_bf16 a[96:99], v[184:187], v[28:31], a[96:99]
    s_cbranch_scc1 L_pollslow4
L_pollok4:
    v_mfma_f32_16x16x32_bf16 a[144:147], v[172:175], v[24:27], a[144:147]
    s_add_u32 s92, s92, 1
    v_exp_f32 v18, v74
    v_mfma_f32_16x16x32_bf16 a[144:147], v[188:191], v[28:31], a[144:147]
    s_waitcnt lgkmcnt(2)
    v_add_f32 v7, v7, v16
    v_add_f32 v7, v7, v17
    v_mfma_f32_16x16x32_bf16 a[4:7], v[160:163], v[32:35], a[4:7]
    s_mov_b32 m0, s56
    ds_read_b128 v[24:27], v1 offset:3072
    v_mfma_f32_16x16x32_bf16 a[4:7], v[176:179], v[36:39], a[4:7]
    buffer_load_dwordx4 v4, s[4:7], s27 offen offset:0 sc1 lds
    v_mfma_f32_16x16x32_bf16 a[52:55], v[164:167], v[32:35], a[52:55]
    v_exp_f32 v19, v75
    v_mfma_f32_16x16x32_bf16 a[52:55], v[180:183], v[36:39], a[52:55]
    v_cvt_pk_bf16_f32 v72, v16, v17
    v_mfma_f32_16x16x32_bf16 a[100:103], v[168:171], v[32:35], a[100:103]
    ds_read_b128 v[28:31], v1 offset:15360
    v_mfma_f32_16x16x32_bf16 a[100:103], v[184:187], v[36:39], a[100:103]
    v_exp_f32 v16, v104
    v_mfma_f32_16x16x32_bf16 a[148:151], v[172:175], v[32:35], a[148:151]
    v_add_f32 v7, v7, v18
    v_add_f32 v7, v7, v19
    v_mfma_f32_16x16x32_bf16 a[148:151], v[188:191], v[36:39], a[148:151]
    s_waitcnt lgkmcnt(2)
    v_exp_f32 v17, v105
    v_mfma_f32_16x16x32_bf16 a[8:11], v[160:163], v[40:43], a[8:11]
    ds_read_b128 v[32:35], v1 offset:4096
    v_cvt_pk_bf16_f32 v73, v18, v19
    v_mfma_f32_16x16x32_bf16 a[8:11], v[176:179], v[44:47], a[8:11]
    buffer_load_dwordx4 v4, s[4:7], s27 offen offset:1024 sc1 lds
    v_mfma_f32_16x16x32_bf16 a[56:59], v[164:167], v[40:43], a[56:59]
    v_exp_f32 v18, v106
    v_mfma_f32_16x16x32_bf16 a[56:59], v[180:183], v[44:47], a[56:59]
    v_add_f32 v7, v7, v16
    v_add_f32 v7, v7, v17
    v_mfma_f32_16x16x32_bf16 a[104:107], v[168:171], v[40:43], a[104:107]
    ds_read_b128 v[36:39], v1 offset:16384
    v_mfma_f32_16x16x32_bf16 a[104:107], v[184:187], v[44:47], a[104:107]
    v_exp_f32 v19, v107
    v_mfma_f32_16x16x32_bf16 a[152:155], v[172:175], v[40:43], a[152:155]
    v_cvt_pk_bf16_f32 v74, v16, v17
    v_mfma_f32_16x16x32_bf16 a[152:155], v[188:191], v[44:47], a[152:155]
    s_waitcnt lgkmcnt(2)
    v_exp_f32 v16, v76
    v_mfma_f32_16x16x32_bf16 a[12:15], v[160:163], v[24:27], a[12:15]
    ds_read_b128 v[40:43], v1 offset:5120
    v_add_f32 v7, v7, v18
    v_mfma_f32_16x16x32_bf16 a[12:15], v[176:179], v[28:31], a[12:15]
    buffer_load_dwordx4 v4, s[4:7], s27 offen offset:2048 sc1 lds
    v_mfma_f32_16x16x32_bf16 a[60:63], v[164:167], v[24:27], a[60:63]
    v_add_f32 v7, v7, v19
    v_mfma_f32_16x16x32_bf16 a[60:63], v[180:183], v[28:31], a[60:63]
    v_exp_f32 v17, v77
    v_mfma_f32_16x16x32_bf16 a[108:111], v[168:171], v[24:27], a[108:111]
    ds_read_b128 v[44:47], v1 offset:17408
    v_cvt_pk_bf16_f32 v75, v18, v19
    v_mfma_f32_16x16x32_bf16 a[108:111], v[184:187], v[28:31], a[108:111]
    v_exp_f32 v18, v78
    v_mfma_f32_16x16x32_bf16 a[156:159], v[172:175], v[24:27], a[156:159]
    s_add_u32 s29, s28, 49152
    v_add_f32 v8, v8, v16
    v_add_f32 v8, v8, v17
    v_mfma_f32_16x16x32_bf16 a[156:159], v[188:191], v[28:31], a[156:159]
    s_waitcnt lgkmcnt(2)
    v_exp_f32 v19, v79
    v_mfma_f32_16x16x32_bf16 a[16:19], v[160:163], v[32:35], a[16:19]
    s_sub_u32 s3, s29, 147456
    ds_read_b128 v[24:27], v1 offset:6144
    v_cvt_pk_bf16_f32 v76, v16, v17
    v_mfma_f32_16x16x32_bf16 a[16:19], v[176:179], v[36:39], a[16:19]
    s_add_u32 s27, s27, 24576
    v_exp_f32 v16, v108
    v_mfma_f32_16x16x32_bf16 a[64:67], v[164:167], v[32:35], a[64:67]
    s_min_u32 s29, s29, s3
    v_add_f32 v8, v8, v18
    v_add_f32 v8, v8, v19
    v_mfma_f32_16x16x32_bf16 a[64:67], v[180:183], v[36:39], a[64:67]
    s_add_u32 s56, s56, 12288
    v_exp_f32 v17, v109
    v_mfma_f32_16x16x32_bf16 a[112:115], v[168:171], v[32:35], a[112:115]
L_pg10:
    s_cbranch_execz L_iwret
    ds_read_b128 v[28:31], v1 offset:18432
    v_mfma_f32_16x16x32_bf16 a[112:115], v[184:187], v[36:39], a[112:115]
    v_cvt_pk_bf16_f32 v77, v18, v19
    v_mfma_f32_16x16x32_bf16 a[160:163], v[172:175], v[32:35], a[160:163]
    v_exp_f32 v18, v110
    v_mfma_f32_16x16x32_bf16 a[160:163], v[188:191], v[36:39], a[160:163]
    s_waitcnt lgkmcnt(2)
    v_add_f32 v8, v8, v16
    s_mov_b32 m0, s56
    v_mfma_f32_16x16x32_bf16 a[20:23], v[160:163], v[40:43], a[20:23]
    s_sub_u32 s3, s29, s28
    ds_read_b128 v[32:35], v1 offset:7168
    v_add_f32 v8, v8, v17
    v_mfma_f32_16x16x32_bf16 a[20:23], v[176:179], v[44:47], a[20:23]
    v_exp_f32 v19, v111
    v_mfma_f32_16x16x32_bf16 a[68:71], v[164:167], v[40:43], a[68:71]
    v_mfma_f32_16x16x32_bf16 a[68:71], v[180:183], v[44:47], a[68:71]
    v_cvt_pk_bf16_f32 v78, v16, v17
    v_mfma_f32_16x16x32_bf16 a[116:119], v[168:171], v[40:43], a[116:119]
    ds_read_b128 v[36:39], v1 offset:19456
    v_add_f32 v8, v8, v18
    v_mfma_f32_16x16x32_bf16 a[116:119], v[184:187], v[44:47], a[116:119]
    buffer_load_dwordx4 v4, s[4:7], s27 offen offset:0 sc1 lds
    v_mfma_f32_16x16x32_bf16 a[164:167], v[172:175], v[40:43], a[164:167]
    s_mov_b32 s28, s29
    v_add_f32 v8, v8, v19
    v_cvt_pk_bf16_f32 v79, v18, v19
    v_mfma_f32_16x16x32_bf16 a[164:167], v[188:191], v[44:47], a[164:167]
    s_waitcnt lgkmcnt(2)
    v_exp_f32 v16, v80
    v_mfma_f32_16x16x32_bf16 a[24:27], v[160:163], v[24:27], a[24:27]
    ds_read_b128 v[40:43], v1 offset:8192
    v_mfma_f32_16x16x32_bf16 a[24:27], v[176:179], v[28:31], a[24:27]
    v_exp_f32 v17, v81
    v_mfma_f32_16x16x32_bf16 a[72:75], v[164:167], v[24:27], a[72:75]
    v_exp_f32 v18, v82
    v_mfma_f32_16x16x32_bf16 a[72:75], v[180:183], v[28:31], a[72:75]
    v_add_f32 v5, v5, v16
    v_mfma_f32_16x16x32_bf16 a[120:123], v[168:171], v[24:27], a[120:123]
    ds_read_b128 v[44:47], v1 offset:20480
    v_add_f32 v5, v5, v17
    v_mfma_f32_16x16x32_bf16 a[120:123], v[184:187], v[28:31], a[120:123]
    v_exp_f32 v19, v83
    v_mfma_f32_16x16x32_bf16 a[168:171], v[172:175], v[24:27], a[168:171]
    v_add_u32 v2, s3, v2
    v_mfma_f32_16x16x32_bf16 a[168:171], v[188:191], v[28:31], a[168:171]
    s_waitcnt lgkmcnt(2)
    buffer_load_dwordx4 v4, s[4:7], s27 offen offset:1024 sc1 lds
    v_mfma_f32_16x16x32_bf16 a[28:31], v[160:163], v[32:35], a[28:31]
    ds_read_b128 v[24:27], v1 offset:9216
    v_cvt_pk_bf16_f32 v80, v16, v17
    v_mfma_f32_16x16x32_bf16 a[28:31], v[176:179], v[36:39], a[28:31]
    v_exp_f32 v16, v112
    v_mfma_f32_16x16x32_bf16 a[76:79], v[164:167], v[32:35], a[76:79]
    v_add_f32 v5, v5, v18
    v_add_f32 v5, v5, v19
    v_mfma_f32_16x16x32_bf16 a[76:79], v[180:183], v[36:39], a[76:79]
    v_exp_f32 v17, v113
    v_mfma_f32_16x16x32_bf16 a[124:127], v[168:171], v[32:35], a[124:127]
    ds_read_b128 v[28:31], v1 offset:21504
    v_add_u32 v3, s3, v3
    v_mfma_f32_16x16x32_bf16 a[124:127], v[184:187], v[36:39], a[124:127]
    v_cvt_pk_bf16_f32 v81, v18, v19
    v_mfma_f32_16x16x32_bf16 a[172:175], v[172:175], v[32:35], a[172:175]
    v_exp_f32 v18, v114
    v_mfma_f32_16x16x32_bf16 a[172:175], v[188:191], v[36:39], a[172:175]
    s_waitcnt lgkmcnt(2)
    buffer_load_dwordx4 v4, s[4:7], s27 offen offset:2048 sc1 lds
    v_mfma_f32_16x16x32_bf16 a[32:35], v[160:163], v[40:43], a[32:35]
    ds_read_b128 v[32:35], v1 offset:10240
    v_add_f32 v5, v5, v16
    v_mfma_f32_16x16x32_bf16 a[32:35], v[176:179], v[44:47], a[32:35]
    v_add_f32 v5, v5, v17
    v_mfma_f32_16x16x32_bf16 a[80:83], v[164:167], v[40:43], a[80:83]
    v_exp_f32 v19, v115
    v_mfma_f32_16x16x32_bf16 a[80:83], v[180:183], v[44:47], a[80:83]
    v_cvt_pk_bf16_f32 v82, v16, v17
    v_mfma_f32_16x16x32_bf16 a[128:131], v[168:171], v[40:43], a[128:131]
    ds_read_b128 v[36:39], v1 offset:22528
    v_mfma_f32_16x16x32_bf16 a[128:131], v[184:187], v[44:47], a[128:131]
    v_exp_f32 v16, v84
    v_mfma_f32_16x16x32_bf16 a[176:179], v[172:175], v[40:43], a[176:179]
    v_add_f32 v5, v5, v18
    v_add_f32 v5, v5, v19
    v_mfma_f32_16x16x32_bf16 a[176:179], v[188:191], v[44:47], a[176:179]
    s_waitcnt lgkmcnt(2)
    v_exp_f32 v17, v85
    v_mfma_f32_16x16x32_bf16 a[36:39], v[160:163], v[24:27], a[36:39]
    ds_read_b128 v[40:43], v1 offset:11264
    v_mfma_f32_16x16x32_bf16 a[36:39], v[176:179], v[28:31], a[36:39]
    v_cvt_pk_bf16_f32 v83, v18, v19
    v_mfma_f32_16x16x32_bf16 a[84:87], v[164:167], v[24:27], a[84:87]
    v_exp_f32 v18, v86
    v_mfma_f32_16x16x32_bf16 a[84:87], v[180:183], v[28:31], a[84:87]
    s_add_u32 s27, s27, 24576
    s_add_u32 s56, s56, 36864
    v_add_f32 v6, v6, v16
    v_mfma_f32_16x16x32_bf16 a[132:135], v[168:171], v[24:27], a[132:135]
    s_sub_u32 s58, s56, 147456
    ds_read_b128 v[44:47], v1 offset:23552
    v_add_f32 v6, v6, v17
    v_mfma_f32_16x16x32_bf16 a[132:135], v[184:187], v[28:31], a[132:135]
    v_exp_f32 v19, v87
    v_mfma_f32_16x16x32_bf16 a[180:183], v[172:175], v[24:27], a[180:183]
    v_mfma_f32_16x16x32_bf16 a[180:183], v[188:191], v[28:31], a[180:183]
    s_waitcnt lgkmcnt(2)
    v_cvt_pk_bf16_f32 v84, v16, v17
    s_min_u32 s56, s56, s58
    v_mfma_f32_16x16x32_bf16 a[40:43], v[160:163], v[32:35], a[40:43]
    ds_read_b128 v[24:27], v2 offset:0
    v_mfma_f32_16x16x32_bf16 a[40:43], v[176:179], v[36:39], a[40:43]
    v_exp_f32 v16, v116
    v_mfma_f32_16x16x32_bf16 a[88:91], v[164:167], v[32:35], a[88:91]
    v_add_f32 v6, v6, v18
    v_add_f32 v6, v6, v19
    v_mfma_f32_16x16x32_bf16 a[88:91], v[180:183], v[36:39], a[88:91]
    v_exp_f32 v17, v117
    v_mfma_f32_16x16x32_bf16 a[136:139], v[168:171], v[32:35], a[136:139]
    ds_read_b128 v[28:31], v3 offset:0
    v_mfma_f32_16x16x32_bf16 a[136:139], v[184:187], v[36:39], a[136:139]
    v_cvt_pk_bf16_f32 v85, v18, v19
    v_mfma_f32_16x16x32_bf16 a[184:187], v[172:175], v[32:35], a[184:187]
    v_exp_f32 v18, v118
    v_mfma_f32_16x16x32_bf16 a[184:187], v[188:191], v[36:39], a[184:187]
    s_waitcnt lgkmcnt(2)
    v_add_f32 v6, v6, v16
    v_mfma_f32_16x16x32_bf16 a[44:47], v[160:163], v[40:43], a[44:47]
    ds_read_b128 v[32:35], v2 offset:6144
    v_add_f32 v6, v6, v17
    v_mfma_f32_16x16x32_bf16 a[44:47], v[176:179], v[44:47], a[44:47]
    v_exp_f32 v19, v119
    v_mfma_f32_16x16x32_bf16 a[92:95], v[164:167], v[40:43], a[92:95]
    v_mfma_f32_16x16x32_bf16 a[92:95], v[180:183], v[44:47], a[92:95]
    v_cvt_pk_bf16_f32 v86, v16, v17
    v_mfma_f32_16x16x32_bf16 a[140:143], v[168:171], v[40:43], a[140:143]
    ds_read_b128 v[36:39], v3 offset:6144
    v_add_f32 v6, v6, v18
    v_mfma_f32_16x16x32_bf16 a[140:143], v[184:187], v[44:47], a[140:143]
    v_add_f32 v6, v6, v19
    v_cvt_pk_bf16_f32 v87, v18, v19
    v_mfma_f32_16x16x32_bf16 a[188:191], v[172:175], v[40:43], a[188:191]
    v_mfma_f32_16x16x32_bf16 a[188:191], v[188:191], v[44:47], a[188:191]
    s_waitcnt lgkmcnt(2)
    v_mfma_f32_16x16x32_bf16 v[160:163], v[24:27], a[192:195], v[128:131]
    ds_read_b128 v[40:43], v2 offset:128
    v_mfma_f32_16x16x32_bf16 v[160:163], v[28:31], a[196:199], v[160:163]
    v_exp_f32 v16, v88
    v_mfma_f32_16x16x32_bf16 v[164:167], v[24:27], a[216:219], v[132:135]
    ds_read_b128 v[44:47], v3 offset:128
    v_mfma_f32_16x16x32_bf16 v[164:167], v[28:31], a[220:223], v[164:167]
    s_waitcnt lgkmcnt(2)
    v_exp_f32 v17, v89
    v_mfma_f32_16x16x32_bf16 v[96:99], v[32:35], a[192:195], v[128:131]
    ds_read_b128 v[24:27], v2 offset:6272
    v_mfma_f32_16x16x32_bf16 v[96:99], v[36:39], a[196:199], v[96:99]
    s_waitcnt vmcnt(6)
    v_exp_f32 v18, v90
    v_mfma_f32_16x16x32_bf16 v[100:103], v[32:35], a[216:219], v[132:135]
    ds_read_b128 v[28:31], v3 offset:6272
    v_add_f32 v7, v7, v16
    v_mfma_f32_16x16x32_bf16 v[100:103], v[36:39], a[220:223], v[100:103]
    s_waitcnt lgkmcnt(2)
    s_barrier
    v_mfma_f32_16x16x32_bf16 v[160:163], v[40:43], a[200:203], v[160:163]
    s_mov_b32 m0, s26
    ds_read_b128 v[32:35], v2 offset:256
    v_add_f32 v7, v7, v17
    v_mfma_f32_16x16x32_bf16 v[160:163], v[44:47], a[204:207], v[160:163]
    buffer_load_dwordx4 v4, s[4:7], s32 offen offset:0 sc1 lds
    v_mfma_f32_16x16x32_bf16 v[164:167], v[40:43], a[224:227], v[164:167]
    ds_read_b128 v[36:39], v3 offset:256
    v_mfma_f32_16x16x32_bf16 v[164:167], v[44:47], a[228:231], v[164:167]
    s_waitcnt lgkmcnt(2)
    v_exp_f32 v19, v91
    v_mfma_f32_16x16x32_bf16 v[96:99], v[24:27], a[200:203], v[96:99]
    ds_read_b128 v[40:43], v2 offset:6400
    v_cvt_pk_bf16_f32 v88, v16, v17
    v_mfma_f32_16x16x32_bf16 v[96:99], v[28:31], a[204:207], v[96:99]
    v_exp_f32 v16, v120
    v_mfma_f32_16x16x32_bf16 v[100:103], v[24:27], a[224:227], v[100:103]
    ds_read_b128 v[44:47], v3 offset:6400
    v_add_f32 v7, v7, v18
    v_mfma_f32_16x16x32_bf16 v[100:103], v[28:31], a[228:231], v[100:103]
    s_waitcnt lgkmcnt(2)
    buffer_load_dwordx4 v4, s[4:7], s32 offen offset:1024 sc1 lds
    v_mfma_f32_16x16x32_bf16 v[160:163], v[32:35], a[208:211], v[160:163]
    ds_read_b128 v[24:27], v2 offset:12288
    v_add_f32 v7, v7, v19
    v_mfma_f32_16x16x32_bf16 v[160:163], v[36:39], a[212:215], v[160:163]
    v_exp_f32 v17, v121
    v_mfma_f32_16x16x32_bf16 v[164:167], v[32:35], a[232:235], v[164:167]
    ds_read_b128 v[28:31], v3 offset:12288
    v_cvt_pk_bf16_f32 v89, v18, v19
    v_mfma_f32_16x16x32_bf16 v[164:167], v[36:39], a[236:239], v[164:167]
    s_waitcnt lgkmcnt(2)
    v_exp_f32 v18, v122
    v_mfma_f32_16x16x32_bf16 v[96:99], v[40:43], a[208:211], v[96:99]
    ds_read_b128 v[32:35], v2 offset:18432
    v_add_f32 v7, v7, v16
    v_mfma_f32_16x16x32_bf16 v[96:99], v[44:47], a[212:215], v[96:99]
    buffer_load_dwordx4 v4, s[4:7], s32 offen offset:2048 sc1 lds
    v_mfma_f32_16x16x32_bf16 v[100:103], v[40:43], a[232:235], v[100:103]
    ds_read_b128 v[36:39], v3 offset:18432
    v_add_f32 v7, v7, v17
    v_mfma_f32_16x16x32_bf16 v[100:103], v[44:47], a[236:239], v[100:103]
    s_waitcnt lgkmcnt(2)
    v_exp_f32 v19, v123
    v_mfma_f32_16x16x32_bf16 v[168:171], v[24:27], a[192:195], v[128:131]
    ds_read_b128 v[40:43], v2 offset:12416
    v_cvt_pk_bf16_f32 v90, v16, v17
    v_mfma_f32_16x16x32_bf16 v[168:171], v[28:31], a[196:199], v[168:171]
    v_exp_f32 v16, v92
    v_mfma_f32_16x16x32_bf16 v[172:175], v[24:27], a[216:219], v[132:135]
    s_add_u32 s32, s32, 24576
    ds_read_b128 v[44:47], v3 offset:12416
    v_add_f32 v7, v7, v18
    v_mfma_f32_16x16x32_bf16 v[172:175], v[28:31], a[220:223], v[172:175]
    s_waitcnt lgkmcnt(2)
    v_add_f32 v7, v7, v19
    v_mfma_f32_16x16x32_bf16 v[104:107], v[32:35], a[192:195], v[128:131]
    ds_read_b128 v[24:27], v2 offset:18560
    v_mfma_f32_16x16x32_bf16 v[104:107], v[36:39], a[196:199], v[104:107]
    s_add_u32 s26, s26, 12288
    v_exp_f32 v17, v93
    v_mfma_f32_16x16x32_bf16 v[108:111], v[32:35], a[216:219], v[132:135]
    s_add_u32 s29, s30, 49152
    ds_read_b128 v[28:31], v3 offset:18560
    v_cvt_pk_bf16_f32 v91, v18, v19
    v_mfma_f32_16x16x32_bf16 v[108:111], v[36:39], a[220:223], v[108:111]
    s_waitcnt lgkmcnt(2)
    v_exp_f32 v18, v94
    v_mfma_f32_16x16x32_bf16 v[168:171], v[40:43], a[200:203], v[168:171]
    s_sub_u32 s3, s29, 147456
    ds_read_b128 v[32:35], v2 offset:12544
    v_add_f32 v8, v8, v16
    v_mfma_f32_16x16x32_bf16 v[168:171], v[44:47], a[204:207], v[168:171]
    s_mov_b32 m0, s26
    v_add_f32 v8, v8, v17
    s_min_u32 s29, s29, s3
    v_mfma_f32_16x16x32_bf16 v[172:175], v[40:43], a[224:227], v[172:175]
    ds_read_b128 v[36:39], v3 offset:12544
    v_mfma_f32_16x16x32_bf16 v[172:175], v[44:47], a[228:231], v[172:175]
    s_waitcnt lgkmcnt(2)
    v_exp_f32 v19, v95
    v_mfma_f32_16x16x32_bf16 v[104:107], v[24:27], a[200:203], v[104:107]
    ds_read_b128 v[40:43], v2 offset:18688
    v_cvt_pk_bf16_f32 v92, v16, v17
    v_mfma_f32_16x16x32_bf16 v[104:107], v[28:31], a[204:207], v[104:107]
    buffer_load_dwordx4 v4, s[4:7], s32 offen offset:0 sc1 lds
    v_mfma_f32_16x16x32_bf16 v[108:111], v[24:27], a[224:227], v[108:111]
    ds_read_b128 v[44:47], v3 offset:18688
    v_mfma_f32_16x16x32_bf16 v[108:111], v[28:31], a[228:231], v[108:111]
    s_waitcnt lgkmcnt(2)
    v_subrev_u32 v2, 98304, v2
    v_subrev_u32 v3, 98304, v3
    v_mfma_f32_16x16x32_bf16 v[168:171], v[32:35], a[208:211], v[168:171]
    ds_read_b128 v[24:27], v2 offset:0
    v_mfma_f32_16x16x32_bf16 v[168:171], v[36:39], a[212:215], v[168:171]
    v_exp_f32 v16, v124
    v_add_f32 v8, v8, v18
    v_mfma_f32_16x16x32_bf16 v[172:175], v[32:35], a[232:235], v[172:175]
    s_sub_u32 s3, s29, s30
    ds_read_b128 v[28:31], v3 offset:0
    v_add_f32 v8, v8, v19
    v_mfma_f32_16x16x32_bf16 v[172:175], v[36:39], a[236:239], v[172:175]
    s_waitcnt lgkmcnt(2)
    v_exp_f32 v17, v125
    v_cvt_pk_bf16_f32 v93, v18, v19
    v_mfma_f32_16x16x32_bf16 v[104:107], v[40:43], a[208:211], v[104:107]
    ds_read_b128 v[32:35], v2 offset:6144
    v_mfma_f32_16x16x32_bf16 v[104:107], v[44:47], a[212:215], v[104:107]
    buffer_load_dwordx4 v4, s[4:7], s32 offen offset:1024 sc1 lds
    v_mfma_f32_16x16x32_bf16 v[108:111], v[40:43], a[232:235], v[108:111]
    ds_read_b128 v[36:39], v3 offset:6144
    v_mfma_f32_16x16x32_bf16 v[108:111], v[44:47], a[236:239], v[108:111]
    s_waitcnt lgkmcnt(2)
    v_exp_f32 v18, v126
    v_add_f32 v8, v8, v16
    v_mfma_f32_16x16x32_bf16 v[176:179], v[24:27], a[192:195], v[128:131]
    ds_read_b128 v[40:43], v2 offset:128
    v_add_f32 v8, v8, v17
    v_mfma_f32_16x16x32_bf16 v[176:179], v[28:31], a[196:199], v[176:179]
    v_exp_f32 v19, v127
    v_cvt_pk_bf16_f32 v94, v16, v17
    v_mfma_f32_16x16x32_bf16 v[180:183], v[24:27], a[216:219], v[132:135]
    ds_read_b128 v[44:47], v3 offset:128
    v_add_f32 v8, v8, v18
    v_add_f32 v8, v8, v19
    v_cvt_pk_bf16_f32 v95, v18, v19
    v_mfma_f32_16x16x32_bf16 v[180:183], v[28:31], a[220:223], v[180:183]
    s_waitcnt lgkmcnt(2)
    buffer_load_dwordx4 v4, s[4:7], s32 offen offset:2048 sc1 lds
    v_mfma_f32_16x16x32_bf16 v[112:115], v[32:35], a[192:195], v[128:131]
    s_mov_b32 s30, s29
    ds_read_b128 v[24:27], v2 offset:6272
    v_mfma_f32_16x16x32_bf16 v[112:115], v[36:39], a[196:199], v[112:115]
    v_exp_f32 v16, v160
    v_mfma_f32_16x16x32_bf16 v[116:119], v[32:35], a[216:219], v[132:135]
    ds_read_b128 v[28:31], v3 offset:6272
    v_mfma_f32_16x16x32_bf16 v[116:119], v[36:39], a[220:223], v[116:119]
    s_waitcnt lgkmcnt(2)
    v_exp_f32 v17, v161
    v_mfma_f32_16x16x32_bf16 v[176:179], v[40:43], a[200:203], v[176:179]
    ds_read_b128 v[32:35], v2 offset:256
    v_mfma_f32_16x16x32_bf16 v[176:179], v[44:47], a[204:207], v[176:179]
    v_exp_f32 v18, v162
    v_mfma_f32_16x16x32_bf16 v[180:183], v[40:43], a[224:227], v[180:183]
    ds_read_b128 v[36:39], v3 offset:256
    v_add_f32 v5, v5, v16
    v_mfma_f32_16x16x32_bf16 v[180:183], v[44:47], a[228:231], v[180:183]
    s_waitcnt lgkmcnt(2)
    v_add_f32 v5, v5, v17
    v_add_u32 v1, s3, v1
    v_mfma_f32_16x16x32_bf16 v[112:115], v[24:27], a[200:203], v[112:115]
    ds_read_b128 v[40:43], v2 offset:6400
    v_mfma_f32_16x16x32_bf16 v[112:115], v[28:31], a[204:207], v[112:115]
    v_exp_f32 v19, v163
    v_cvt_pk_bf16_f32 v160, v16, v17
    v_mfma_f32_16x16x32_bf16 v[116:119], v[24:27], a[224:227], v[116:119]
    s_add_u32 s32, s32, 24576
    ds_read_b128 v[44:47], v3 offset:6400
    s_add_u32 s26, s26, 36864
    v_mfma_f32_16x16x32_bf16 v[116:119], v[28:31], a[228:231], v[116:119]
    s_waitcnt lgkmcnt(2)
    v_exp_f32 v16, v96
    v_mfma_f32_16x16x32_bf16 v[176:179], v[32:35], a[208:211], v[176:179]
    s_sub_u32 s57, s26, 147456
    ds_read_b128 v[24:27], v2 offset:12288
    v_add_f32 v5, v5, v18
    v_mfma_f32_16x16x32_bf16 v[176:179], v[36:39], a[212:215], v[176:179]
    s_min_u32 s26, s26, s57
    v_add_f32 v5, v5, v19
    v_mfma_f32_16x16x32_bf16 v[180:183], v[32:35], a[232:235], v[180:183]
    ds_read_b128 v[28:31], v3 offset:12288
    v_mfma_f32_16x16x32_bf16 v[180:183], v[36:39], a[236:239], v[180:183]
    s_waitcnt lgkmcnt(2)
    v_exp_f32 v17, v97
    v_cvt_pk_bf16_f32 v161, v18, v19
    v_mfma_f32_16x16x32_bf16 v[112:115], v[40:43], a[208:211], v[112:115]
    ds_read_b128 v[32:35], v2 offset:18432
    v_mfma_f32_16x16x32_bf16 v[112:115], v[44:47], a[212:215], v[112:115]
    v_exp_f32 v18, v98
    v_mfma_f32_16x16x32_bf16 v[116:119], v[40:43], a[232:235], v[116:119]
    ds_read_b128 v[36:39], v3 offset:18432
    v_add_f32 v5, v5, v16
    v_mfma_f32_16x16x32_bf16 v[116:119], v[44:47], a[236:239], v[116:119]
    s_waitcnt lgkmcnt(2)
    v_add_f32 v5, v5, v17
    v_mfma_f32_16x16x32_bf16 v[184:187], v[24:27], a[192:195], v[128:131]
    ds_read_b128 v[40:43], v2 offset:12416
    v_mfma_f32_16x16x32_bf16 v[184:187], v[28:31], a[196:199], v[184:187]
    v_exp_f32 v19, v99
    v_cvt_pk_bf16_f32 v162, v16, v17
    v_mfma_f32_16x16x32_bf16 v[188:191], v[24:27], a[216:219], v[132:135]
    ds_read_b128 v[44:47], v3 offset:12416
    v_mfma_f32_16x16x32_bf16 v[188:191], v[28:31], a[220:223], v[188:191]
    s_waitcnt lgkmcnt(2)
    v_exp_f32 v16, v164
    v_mfma_f32_16x16x32_bf16 v[120:123], v[32:35], a[192:195], v[128:131]
    ds_read_b128 v[24:27], v2 offset:18560
    v_add_f32 v5, v5, v18
    v_mfma_f32_16x16x32_bf16 v[120:123], v[36:39], a[196:199], v[120:123]
    s_waitcnt vmcnt(6)
    v_add_f32 v5, v5, v19
    v_mfma_f32_16x16x32_bf16 v[124:127], v[32:35], a[216:219], v[132:135]
    ds_read_b128 v[28:31], v3 offset:18560
    v_mfma_f32_16x16x32_bf16 v[124:127], v[36:39], a[220:223], v[124:127]
    s_waitcnt lgkmcnt(2)
    s_barrier
    v_mfma_f32_16x16x32_bf16 v[184:187], v[40:43], a[200:203], v[184:187]
    ds_read_b128 v[32:35], v2 offset:12544
    v_mfma_f32_16x16x32_bf16 v[184:187], v[44:47], a[204:207], v[184:187]
    v_exp_f32 v17, v165
    v_cvt_pk_bf16_f32 v163, v18, v19
    v_mfma_f32_16x16x32_bf16 v[188:191], v[40:43], a[224:227], v[188:191]
    ds_read_b128 v[36:39], v3 offset:12544
    v_mfma_f32_16x16x32_bf16 v[188:191], v[44:47], a[228:231], v[188:191]
    s_waitcnt lgkmcnt(2)
    v_exp_f32 v18, v166
    v_add_f32 v6, v6, v16
    v_mfma_f32_16x16x32_bf16 v[120:123], v[24:27], a[200:203], v[120:123]
    ds_read_b128 v[40:43], v2 offset:18688
    v_add_f32 v6, v6, v17
    v_mfma_f32_16x16x32_bf16 v[120:123], v[28:31], a[204:207], v[120:123]
    v_exp_f32 v19, v167
    v_cvt_pk_bf16_f32 v164, v16, v17
    v_mfma_f32_16x16x32_bf16 v[124:127], v[24:27], a[224:227], v[124:127]
    ds_read_b128 v[44:47], v3 offset:18688
    v_mfma_f32_16x16x32_bf16 v[124:127], v[28:31], a[228:231], v[124:127]
    s_waitcnt lgkmcnt(2)
    v_exp_f32 v16, v100
    v_mfma_f32_16x16x32_bf16 v[184:187], v[32:35], a[208:211], v[184:187]
    ds_read_b128 v[24:27], v1 offset:0
    v_add_f32 v6, v6, v18
    v_mfma_f32_16x16x32_bf16 v[184:187], v[36:39], a[212:215], v[184:187]
    v_add_f32 v6, v6, v19
    v_mfma_f32_16x16x32_bf16 v[188:191], v[32:35], a[232:235], v[188:191]
    ds_read_b128 v[28:31], v1 offset:12288
    v_mfma_f32_16x16x32_bf16 v[188:191], v[36:39], a[236:239], v[188:191]
    s_waitcnt lgkmcnt(2)
    v_exp_f32 v17, v101
    v_cvt_pk_bf16_f32 v165, v18, v19
    v_mfma_f32_16x16x32_bf16 v[120:123], v[40:43], a[208:211], v[120:123]
    ds_read_b128 v[32:35], v1 offset:1024
    v_mfma_f32_16x16x32_bf16 v[120:123], v[44:47], a[212:215], v[120:123]
    v_exp_f32 v18, v102
    v_mfma_f32_16x16x32_bf16 v[124:127], v[40:43], a[232:235], v[124:127]
    ds_read_b128 v[36:39], v1 offset:13312
    v_add_f32 v6, v6, v16
    v_mfma_f32_16x16x32_bf16 v[124:127], v[44:47], a[236:239], v[124:127]
    s_waitcnt lgkmcnt(2)
    v_add_f32 v6, v6, v17
    v_exp_f32 v19, v103
    v_cvt_pk_bf16_f32 v166, v16, v17
    v_add_f32 v6, v6, v18
    v_add_f32 v6, v6, v19
    v_cvt_pk_bf16_f32 v167, v18, v19
    v_mfma_f32_16x16x32_bf16 a[0:3], v[64:67], v[24:27], a[0:3]
    s_mov_b32 m0, s56
    ds_read_b128 v[40:43], v1 offset:2048
    v_bfe_u32 v57, v4, 8, 2
    v_mfma_f32_16x16x32_bf16 a[0:3], v[80:83], v[28:31], a[0:3]
    buffer_load_dwordx4 v4, s[4:7], s27 offen offset:0 sc1 lds
    v_mfma_f32_16x16x32_bf16 a[48:51], v[68:71], v[24:27], a[48:51]
    v_exp_f32 v16, v168
    v_mfma_f32_16x16x32_bf16 a[48:51], v[84:87], v[28:31], a[48:51]
    v_exp_f32 v17, v169
    v_mfma_f32_16x16x32_bf16 a[96:99], v[72:75], v[24:27], a[96:99]
    ds_read_b128 v[44:47], v1 offset:14336
    v_mul_u32_u24 v56, 1536, v57
    v_mfma_f32_16x16x32_bf16 a[96:99], v[88:91], v[28:31], a[96:99]
    buffer_load_dwordx4 v4, s[4:7], s27 offen offset:1024 sc1 lds
    v_mfma_f32_16x16x32_bf16 a[144:147], v[76:79], v[24:27], a[144:147]
    v_exp_f32 v18, v170
    v_mfma_f32_16x16x32_bf16 a[144:147], v[92:95], v[28:31], a[144:147]
    s_waitcnt lgkmcnt(2)
    v_add_f32 v5, v5, v16
    v_add_f32 v5, v5, v17
    v_mfma_f32_16x16x32_bf16 a[4:7], v[64:67], v[32:35], a[4:7]
    ds_read_b128 v[24:27], v1 offset:3072
    v_lshlrev_b32 v58, 4, v57
    v_mfma_f32_16x16x32_bf16 a[4:7], v[80:83], v[36:39], a[4:7]
    buffer_load_dwordx4 v4, s[4:7], s27 offen offset:2048 sc1 lds
    v_mfma_f32_16x16x32_bf16 a[52:55], v[68:71], v[32:35], a[52:55]
    v_exp_f32 v19, v171
    v_mfma_f32_16x16x32_bf16 a[52:55], v[84:87], v[36:39], a[52:55]
    s_add_u32 s27, s27, 24576
    v_cvt_pk_bf16_f32 v168, v16, v17
    v_bfe_u32 v57, v4, 4, 4
    v_mfma_f32_16x16x32_bf16 a[100:103], v[72:75], v[32:35], a[100:103]
    ds_read_b128 v[28:31], v1 offset:15360
    v_mfma_f32_16x16x32_bf16 a[100:103], v[88:91], v[36:39], a[100:103]
    s_add_u32 s56, s56, 12288
    v_exp_f32 v16, v104
    v_mfma_f32_16x16x32_bf16 a[148:151], v[76:79], v[32:35], a[148:151]
    v_add_f32 v5, v5, v18
    v_add_f32 v5, v5, v19
    v_mfma_f32_16x16x32_bf16 a[148:151], v[92:95], v[36:39], a[148:151]
    s_waitcnt lgkmcnt(2)
    v_exp_f32 v17, v105
    v_mfma_f32_16x16x32_bf16 a[8:11], v[64:67], v[40:43], a[8:11]
    s_mov_b32 m0, s56
    ds_read_b128 v[32:35], v1 offset:4096
    v_cvt_pk_bf16_f32 v169, v18, v19
    v_mfma_f32_16x16x32_bf16 a[8:11], v[80:83], v[44:47], a[8:11]
    v_exp_f32 v18, v106
    v_mfma_f32_16x16x32_bf16 a[56:59], v[68:71], v[40:43], a[56:59]
    v_add_f32 v5, v5, v16
    v_add_f32 v5, v5, v17
    v_mfma_f32_16x16x32_bf16 a[56:59], v[84:87], v[44:47], a[56:59]
    buffer_load_dwordx4 v4, s[4:7], s27 offen offset:0 sc1 lds
    v_mfma_f32_16x16x32_bf16 a[104:107], v[72:75], v[40:43], a[104:107]
    ds_read_b128 v[36:39], v1 offset:16384
    v_mul_u32_u24 v57, 12, v57
    v_mfma_f32_16x16x32_bf16 a[104:107], v[88:91], v[44:47], a[104:107]
    v_exp_f32 v19, v107
    v_mfma_f32_16x16x32_bf16 a[152:155], v[76:79], v[40:43], a[152:155]
    v_cvt_pk_bf16_f32 v170, v16, v17
    v_add_u32 v56, v56, v57
    v_mfma_f32_16x16x32_bf16 a[152:155], v[92:95], v[44:47], a[152:155]
    s_waitcnt lgkmcnt(2)
    buffer_load_dwordx4 v4, s[4:7], s27 offen offset:1024 sc1 lds
    v_mfma_f32_16x16x32_bf16 a[12:15], v[64:67], v[24:27], a[12:15]
    ds_read_b128 v[40:43], v1 offset:5120
    v_mfma_f32_16x16x32_bf16 a[12:15], v[80:83], v[28:31], a[12:15]
    v_exp_f32 v16, v172
    v_mfma_f32_16x16x32_bf16 a[60:63], v[68:71], v[24:27], a[60:63]
    v_add_f32 v5, v5, v18
    v_add_f32 v5, v5, v19
    v_mfma_f32_16x16x32_bf16 a[60:63], v[84:87], v[28:31], a[60:63]
    buffer_load_dwordx4 v4, s[4:7], s27 offen offset:2048 sc1 lds
    v_mfma_f32_16x16x32_bf16 a[108:111], v[72:75], v[24:27], a[108:111]
    ds_read_b128 v[44:47], v1 offset:17408
    v_mov_b32 v57, 1.0
    v_mfma_f32_16x16x32_bf16 a[108:111], v[88:91], v[28:31], a[108:111]
    v_exp_f32 v17, v173
    v_mfma_f32_16x16x32_bf16 a[156:159], v[76:79], v[24:27], a[156:159]
    s_add_u32 s27, s27, 24576
    v_cvt_pk_bf16_f32 v171, v18, v19
    v_mfma_f32_16x16x32_bf16 a[156:159], v[92:95], v[28:31], a[156:159]
    s_waitcnt lgkmcnt(2)
    v_exp_f32 v18, v174
    v_mfma_f32_16x16x32_bf16 a[16:19], v[64:67], v[32:35], a[16:19]
    s_add_u32 s56, s56, 36864
    ds_read_b128 v[24:27], v1 offset:6144
    v_add_f32 v6, v6, v16
    v_mfma_f32_16x16x32_bf16 a[16:19], v[80:83], v[36:39], a[16:19]
    v_add_f32 v6, v6, v17
    v_mov_b32 v20, 0x3f803f80
    v_mfma_f32_16x16x32_bf16 a[64:67], v[68:71], v[32:35], a[64:67]
    s_sub_u32 s58, s56, 147456
    v_exp_f32 v19, v175
    v_mfma_f32_16x16x32_bf16 a[64:67], v[84:87], v[36:39], a[64:67]
    v_cvt_pk_bf16_f32 v172, v16, v17
    v_mfma_f32_16x16x32_bf16 a[112:115], v[72:75], v[32:35], a[112:115]
    s_min_u32 s56, s56, s58
    ds_read_b128 v[28:31], v1 offset:18432
    v_mov_b32 v21, 0x3f803f80
    v_mfma_f32_16x16x32_bf16 a[112:115], v[88:91], v[36:39], a[112:115]
    v_exp_f32 v16, v108
    v_mfma_f32_16x16x32_bf16 a[160:163], v[76:79], v[32:35], a[160:163]
    s_mov_b32 m0, s56
    v_add_f32 v6, v6, v18
    v_add_f32 v6, v6, v19
    v_mfma_f32_16x16x32_bf16 a[160:163], v[92:95], v[36:39], a[160:163]
    s_waitcnt lgkmcnt(2)
    v_exp_f32 v17, v109
    v_mfma_f32_16x16x32_bf16 a[20:23], v[64:67], v[40:43], a[20:23]
    ds_read_b128 v[32:35], v1 offset:7168
    v_cvt_pk_bf16_f32 v173, v18, v19
    v_mfma_f32_16x16x32_bf16 a[20:23], v[80:83], v[44:47], a[20:23]
    buffer_load_dwordx4 v4, s[4:7], s27 offen offset:0 sc1 lds
    v_mfma_f32_16x16x32_bf16 a[68:71], v[68:71], v[40:43], a[68:71]
    v_exp_f32 v18, v110
    v_mfma_f32_16x16x32_bf16 a[68:71], v[84:87], v[44:47], a[68:71]
    v_add_f32 v6, v6, v16
    v_add_f32 v6, v6, v17
    v_mfma_f32_16x16x32_bf16 a[116:119], v[72:75], v[40:43], a[116:119]
    ds_read_b128 v[36:39], v1 offset:19456
    v_mov_b32 v22, 0x3f803f80
    v_mfma_f32_16x16x32_bf16 a[116:119], v[88:91], v[44:47], a[116:119]
    buffer_load_dwordx4 v4, s[4:7], s27 offen offset:1024 sc1 lds
    v_mfma_f32_16x16x32_bf16 a[164:167], v[76:79], v[40:43], a[164:167]
    v_exp_f32 v19, v111
    v_mfma_f32_16x16x32_bf16 a[164:167], v[92:95], v[44:47], a[164:167]
    s_waitcnt lgkmcnt(2)
    v_cvt_pk_bf16_f32 v174, v16, v17
    v_add_f32 v6, v6, v18
    v_mfma_f32_16x16x32_bf16 a[24:27], v[64:67], v[24:27], a[24:27]
    ds_read_b128 v[40:43], v1 offset:8192
    v_add_f32 v6, v6, v19
    v_mfma_f32_16x16x32_bf16 a[24:27], v[80:83], v[28:31], a[24:27]
    buffer_load_dwordx4 v4, s[4:7], s27 offen offset:2048 sc1 lds
    v_mfma_f32_16x16x32_bf16 a[72:75], v[68:71], v[24:27], a[72:75]
    v_cvt_pk_bf16_f32 v175, v18, v19
    v_mov_b32 v23, 0x3f803f80
    v_mfma_f32_16x16x32_bf16 a[72:75], v[84:87], v[28:31], a[72:75]
    v_exp_f32 v16, v176
    v_mfma_f32_16x16x32_bf16 a[120:123], v[72:75], v[24:27], a[120:123]
    ds_read_b128 v[44:47], v1 offset:20480
    v_mfma_f32_16x16x32_bf16 a[120:123], v[88:91], v[28:31], a[120:123]
    s_lshl_b32 s24, s95, 2
    v_exp_f32 v17, v177
    v_mfma_f32_16x16x32_bf16 a[168:171], v[76:79], v[24:27], a[168:171]
    s_add_u32 s27, s27, 24576
    v_exp_f32 v18, v178
    v_mfma_f32_16x16x32_bf16 a[168:171], v[92:95], v[28:31], a[168:171]
    s_waitcnt lgkmcnt(2)
    v_add_f32 v5, v5, v16
    v_add_f32 v5, v5, v17
    v_mfma_f32_16x16x32_bf16 a[28:31], v[64:67], v[32:35], a[28:31]
    s_add_u32 s56, s56, 12288
    ds_read_b128 v[24:27], v1 offset:9216
    v_mfma_f32_16x16x32_bf16 a[28:31], v[80:83], v[36:39], a[28:31]
    s_mov_b32 m0, s56
    v_exp_f32 v19, v179
    v_mfma_f32_16x16x32_bf16 a[76:79], v[68:71], v[32:35], a[76:79]
    v_cvt_pk_bf16_f32 v176, v16, v17
    v_mfma_f32_16x16x32_bf16 a[76:79], v[84:87], v[36:39], a[76:79]
    s_add_u32 s24, s24, s25
    v_exp_f32 v16, v112
    v_mfma_f32_16x16x32_bf16 a[124:127], v[72:75], v[32:35], a[124:127]
    ds_read_b128 v[28:31], v1 offset:21504
    v_add_f32 v5, v5, v18
    v_mfma_f32_16x16x32_bf16 a[124:127], v[88:91], v[36:39], a[124:127]
    buffer_load_dwordx4 v4, s[4:7], s27 offen offset:0 sc1 lds
    v_mfma_f32_16x16x32_bf16 a[172:175], v[76:79], v[32:35], a[172:175]
    v_add_f32 v5, v5, v19
    v_mfma_f32_16x16x32_bf16 a[172:175], v[92:95], v[36:39], a[172:175]
    s_waitcnt lgkmcnt(2)
    v_exp_f32 v17, v113
    v_mfma_f32_16x16x32_bf16 a[32:35], v[64:67], v[40:43], a[32:35]
    s_mul_i32 s24, s24, 24576
    ds_read_b128 v[32:35], v1 offset:10240
    v_cvt_pk_bf16_f32 v177, v18, v19
    v_mfma_f32_16x16x32_bf16 a[32:35], v[80:83], v[44:47], a[32:35]
    buffer_load_dwordx4 v4, s[4:7], s27 offen offset:1024 sc1 lds
    v_mfma_f32_16x16x32_bf16 a[80:83], v[68:71], v[40:43], a[80:83]
    v_exp_f32 v18, v114
    v_mfma_f32_16x16x32_bf16 a[80:83], v[84:87], v[44:47], a[80:83]
    v_add_f32 v5, v5, v16
    v_add_f32 v5, v5, v17
    v_mfma_f32_16x16x32_bf16 a[128:131], v[72:75], v[40:43], a[128:131]
    ds_read_b128 v[36:39], v1 offset:22528
    v_mfma_f32_16x16x32_bf16 a[128:131], v[88:91], v[44:47], a[128:131]
    buffer_load_dwordx4 v4, s[4:7], s27 offen offset:2048 sc1 lds
    v_mfma_f32_16x16x32_bf16 a[176:179], v[76:79], v[40:43], a[176:179]
    s_add_u32 s40, s24, 6144
    v_exp_f32 v19, v115
    v_mfma_f32_16x16x32_bf16 a[176:179], v[92:95], v[44:47], a[176:179]
    s_waitcnt lgkmcnt(2)
    v_cvt_pk_bf16_f32 v178, v16, v17
    v_mfma_f32_16x16x32_bf16 a[36:39], v[64:67], v[24:27], a[36:39]
    ds_read_b128 v[40:43], v1 offset:11264
    v_mfma_f32_16x16x32_bf16 a[36:39], v[80:83], v[28:31], a[36:39]
    v_exp_f32 v16, v180
    v_mfma_f32_16x16x32_bf16 a[84:87], v[68:71], v[24:27], a[84:87]
    v_add_f32 v5, v5, v18
    v_add_f32 v5, v5, v19
    v_mfma_f32_16x16x32_bf16 a[84:87], v[84:87], v[28:31], a[84:87]
    s_add_u32 s27, s27, 24576
    v_exp_f32 v17, v181
    v_mfma_f32_16x16x32_bf16 a[132:135], v[72:75], v[24:27], a[132:135]
L_pg11:
    s_cbranch_execz L_iwret
    s_add_u32 s56, s56, 36864
    ds_read_b128 v[44:47], v1 offset:23552
    v_cvt_pk_bf16_f32 v179, v18, v19
    v_mfma_f32_16x16x32_bf16 a[132:135], v[88:91], v[28:31], a[132:135]
    s_waitcnt lgkmcnt(2)
    v_exp_f32 v18, v182
    v_mfma_f32_16x16x32_bf16 a[180:183], v[76:79], v[24:27], a[180:183]
    s_waitcnt vmcnt(12)
    v_add_f32 v6, v6, v16
    v_add_f32 v6, v6, v17
    v_mfma_f32_16x16x32_bf16 a[180:183], v[92:95], v[28:31], a[180:183]
    s_barrier
    v_add_u32 v2, 49152, v2
    v_add_u32 v3, 49152, v3
    v_mfma_f32_16x16x32_bf16 a[40:43], v[64:67], v[32:35], a[40:43]
    s_sub_u32 s58, s56, 147456
    ds_read_b128 v[24:27], v2 offset:0
    s_add_u32 s41, s24, 12288
    v_mfma_f32_16x16x32_bf16 a[40:43], v[80:83], v[36:39], a[40:43]
    s_min_u32 s56, s56, s58
    v_exp_f32 v19, v183
    v_mfma_f32_16x16x32_bf16 a[88:91], v[68:71], v[32:35], a[88:91]
    s_add_u32 s42, s24, 18432
    v_cvt_pk_bf16_f32 v180, v16, v17
    v_mfma_f32_16x16x32_bf16 a[88:91], v[84:87], v[36:39], a[88:91]
    v_exp_f32 v16, v116
    v_mfma_f32_16x16x32_bf16 a[136:139], v[72:75], v[32:35], a[136:139]
    ds_read_b128 v[28:31], v3 offset:0
    v_add_f32 v6, v6, v18
    v_mfma_f32_16x16x32_bf16 a[136:139], v[88:91], v[36:39], a[136:139]
    v_add_f32 v6, v6, v19
    v_mfma_f32_16x16x32_bf16 a[184:187], v[76:79], v[32:35], a[184:187]
    v_exp_f32 v17, v117
    v_mfma_f32_16x16x32_bf16 a[184:187], v[92:95], v[36:39], a[184:187]
    s_waitcnt lgkmcnt(2)
    v_cvt_pk_bf16_f32 v181, v18, v19
    v_mfma_f32_16x16x32_bf16 a[44:47], v[64:67], v[40:43], a[44:47]
    ds_read_b128 v[32:35], v2 offset:6144
    v_mfma_f32_16x16x32_bf16 a[44:47], v[80:83], v[44:47], a[44:47]
    v_exp_f32 v18, v118
    v_mfma_f32_16x16x32_bf16 a[92:95], v[68:71], v[40:43], a[92:95]
    v_add_f32 v6, v6, v16
    v_add_f32 v6, v6, v17
    v_mfma_f32_16x16x32_bf16 a[92:95], v[84:87], v[44:47], a[92:95]
    v_exp_f32 v19, v119
    v_mfma_f32_16x16x32_bf16 a[140:143], v[72:75], v[40:43], a[140:143]
    ds_read_b128 v[36:39], v3 offset:6144
    v_cvt_pk_bf16_f32 v182, v16, v17
    v_mfma_f32_16x16x32_bf16 a[140:143], v[88:91], v[44:47], a[140:143]
    v_add_f32 v6, v6, v18
    v_add_f32 v6, v6, v19
    v_mfma_f32_16x16x32_bf16 a[188:191], v[76:79], v[40:43], a[188:191]
    v_cvt_pk_bf16_f32 v183, v18, v19
    v_mfma_f32_16x16x32_bf16 a[188:191], v[92:95], v[44:47], a[188:191]
    s_waitcnt lgkmcnt(2)
    v_mfma_f32_16x16x32_bf16 v[64:67], v[24:27], a[192:195], v[128:131]
    ds_read_b128 v[40:43], v2 offset:128
    v_mfma_f32_16x16x32_bf16 v[64:67], v[28:31], a[196:199], v[64:67]
    v_exp_f32 v16, v184
    v_mfma_f32_16x16x32_bf16 v[68:71], v[24:27], a[216:219], v[132:135]
    ds_read_b128 v[44:47], v3 offset:128
    v_mfma_f32_16x16x32_bf16 v[68:71], v[28:31], a[220:223], v[68:71]
    s_waitcnt lgkmcnt(2)
    v_exp_f32 v17, v185
    v_mfma_f32_16x16x32_bf16 v[96:99], v[32:35], a[192:195], v[128:131]
    ds_read_b128 v[24:27], v2 offset:6272
    v_mfma_f32_16x16x32_bf16 v[96:99], v[36:39], a[196:199], v[96:99]
    v_exp_f32 v18, v186
    v_mfma_f32_16x16x32_bf16 v[100:103], v[32:35], a[216:219], v[132:135]
    ds_read_b128 v[28:31], v3 offset:6272
    v_add_f32 v5, v5, v16
    v_mfma_f32_16x16x32_bf16 v[100:103], v[36:39], a[220:223], v[100:103]
    s_waitcnt lgkmcnt(2)
    v_add_f32 v5, v5, v17
    v_mfma_f32_16x16x32_bf16 v[64:67], v[40:43], a[200:203], v[64:67]
    ds_read_b128 v[32:35], v2 offset:256
    v_mfma_f32_16x16x32_bf16 v[64:67], v[44:47], a[204:207], v[64:67]
    v_exp_f32 v19, v187
    v_mfma_f32_16x16x32_bf16 v[68:71], v[40:43], a[224:227], v[68:71]
    ds_read_b128 v[36:39], v3 offset:256
    v_cvt_pk_bf16_f32 v184, v16, v17
    v_mfma_f32_16x16x32_bf16 v[68:71], v[44:47], a[228:231], v[68:71]
    s_waitcnt lgkmcnt(2)
    v_exp_f32 v16, v120
    v_mfma_f32_16x16x32_bf16 v[96:99], v[24:27], a[200:203], v[96:99]
    ds_read_b128 v[40:43], v2 offset:6400
    v_add_f32 v5, v5, v18
    v_mfma_f32_16x16x32_bf16 v[96:99], v[28:31], a[204:207], v[96:99]
    s_waitcnt vmcnt(0)
    v_add_f32 v5, v5, v19
    v_mfma_f32_16x16x32_bf16 v[100:103], v[24:27], a[224:227], v[100:103]
    ds_read_b128 v[44:47], v3 offset:6400
    v_mfma_f32_16x16x32_bf16 v[100:103], v[28:31], a[228:231], v[100:103]
    s_waitcnt lgkmcnt(2)
    s_barrier
    v_mfma_f32_16x16x32_bf16 v[64:67], v[32:35], a[208:211], v[64:67]
    s_mov_b32 m0, s56
    ds_read_b128 v[24:27], v2 offset:12288
    v_mfma_f32_16x16x32_bf16 v[64:67], v[36:39], a[212:215], v[64:67]
    buffer_load_dwordx4 v4, s[4:7], s27 offen offset:0 sc1 lds
    v_mfma_f32_16x16x32_bf16 v[68:71], v[32:35], a[232:235], v[68:71]
    ds_read_b128 v[28:31], v3 offset:12288
    v_mfma_f32_16x16x32_bf16 v[68:71], v[36:39], a[236:239], v[68:71]
    s_waitcnt lgkmcnt(2)
    v_exp_f32 v17, v121
    v_cvt_pk_bf16_f32 v185, v18, v19
    v_mfma_f32_16x16x32_bf16 v[96:99], v[40:43], a[208:211], v[96:99]
    ds_read_b128 v[32:35], v2 offset:18432
    v_mfma_f32_16x16x32_bf16 v[96:99], v[44:47], a[212:215], v[96:99]
    buffer_load_dwordx4 v4, s[4:7], s27 offen offset:1024 sc1 lds
    v_mfma_f32_16x16x32_bf16 v[100:103], v[40:43], a[232:235], v[100:103]
    ds_read_b128 v[36:39], v3 offset:18432
    v_mfma_f32_16x16x32_bf16 v[100:103], v[44:47], a[236:239], v[100:103]
    s_waitcnt lgkmcnt(2)
    v_exp_f32 v18, v122
    v_add_f32 v5, v5, v16
    v_mfma_f32_16x16x32_bf16 v[72:75], v[24:27], a[192:195], v[128:131]
    ds_read_b128 v[40:43], v2 offset:12416
    v_add_f32 v5, v5, v17
    v_mfma_f32_16x16x32_bf16 v[72:75], v[28:31], a[196:199], v[72:75]
    v_exp_f32 v19, v123
    v_cvt_pk_bf16_f32 v186, v16, v17
    v_mfma_f32_16x16x32_bf16 v[76:79], v[24:27], a[216:219], v[132:135]
    ds_read_b128 v[44:47], v3 offset:12416
    v_mfma_f32_16x16x32_bf16 v[76:79], v[28:31], a[220:223], v[76:79]
    s_waitcnt lgkmcnt(2)
    buffer_load_dwordx4 v4, s[4:7], s27 offen offset:2048 sc1 lds
    v_mfma_f32_16x16x32_bf16 v[104:107], v[32:35], a[192:195], v[128:131]
    ds_read_b128 v[24:27], v2 offset:18560
    v_mfma_f32_16x16x32_bf16 v[104:107], v[36:39], a[196:199], v[104:107]
    v_exp_f32 v16, v188
    v_add_f32 v5, v5, v18
    v_mfma_f32_16x16x32_bf16 v[108:111], v[32:35], a[216:219], v[132:135]
    ds_read_b128 v[28:31], v3 offset:18560
    v_add_f32 v5, v5, v19
    v_mfma_f32_16x16x32_bf16 v[108:111], v[36:39], a[220:223], v[108:111]
    s_waitcnt lgkmcnt(2)
    v_exp_f32 v17, v189
    v_cvt_pk_bf16_f32 v187, v18, v19
    v_mfma_f32_16x16x32_bf16 v[72:75], v[40:43], a[200:203], v[72:75]
    s_add_u32 s27, s27, 24576
    ds_read_b128 v[32:35], v2 offset:12544
    v_mfma_f32_16x16x32_bf16 v[72:75], v[44:47], a[204:207], v[72:75]
    v_exp_f32 v18, v190
    v_mfma_f32_16x16x32_bf16 v[76:79], v[40:43], a[224:227], v[76:79]
    s_add_u32 s56, s56, 12288
    ds_read_b128 v[36:39], v3 offset:12544
    v_add_f32 v6, v6, v16
    v_mfma_f32_16x16x32_bf16 v[76:79], v[44:47], a[228:231], v[76:79]
    s_waitcnt lgkmcnt(2)
    v_add_f32 v6, v6, v17
    v_mfma_f32_16x16x32_bf16 v[104:107], v[24:27], a[200:203], v[104:107]
    ds_read_b128 v[40:43], v2 offset:18688
    v_mfma_f32_16x16x32_bf16 v[104:107], v[28:31], a[204:207], v[104:107]
    v_exp_f32 v19, v191
    v_cvt_pk_bf16_f32 v188, v16, v17
    v_mfma_f32_16x16x32_bf16 v[108:111], v[24:27], a[224:227], v[108:111]
    s_mov_b32 m0, s56
    ds_read_b128 v[44:47], v3 offset:18688
    v_mfma_f32_16x16x32_bf16 v[108:111], v[28:31], a[228:231], v[108:111]
    s_waitcnt lgkmcnt(2)
    v_add_u32 v2, 49152, v2
    v_add_u32 v3, 49152, v3
    v_mfma_f32_16x16x32_bf16 v[72:75], v[32:35], a[208:211], v[72:75]
    ds_read_b128 v[24:27], v2 offset:0
    v_mfma_f32_16x16x32_bf16 v[72:75], v[36:39], a[212:215], v[72:75]
    buffer_load_dwordx4 v4, s[4:7], s27 offen offset:0 sc1 lds
    v_mfma_f32_16x16x32_bf16 v[76:79], v[32:35], a[232:235], v[76:79]
    ds_read_b128 v[28:31], v3 offset:0
    v_mfma_f32_16x16x32_bf16 v[76:79], v[36:39], a[236:239], v[76:79]
    s_waitcnt lgkmcnt(2)
    v_exp_f32 v16, v124
    v_add_f32 v6, v6, v18
    v_mfma_f32_16x16x32_bf16 v[104:107], v[40:43], a[208:211], v[104:107]
    ds_read_b128 v[32:35], v2 offset:6144
    v_add_f32 v6, v6, v19
    v_mfma_f32_16x16x32_bf16 v[104:107], v[44:47], a[212:215], v[104:107]
    v_exp_f32 v17, v125
    v_cvt_pk_bf16_f32 v189, v18, v19
    v_mfma_f32_16x16x32_bf16 v[108:111], v[40:43], a[232:235], v[108:111]
    ds_read_b128 v[36:39], v3 offset:6144
    v_mfma_f32_16x16x32_bf16 v[108:111], v[44:47], a[236:239], v[108:111]
    s_waitcnt lgkmcnt(2)
    buffer_load_dwordx4 v4, s[4:7], s27 offen offset:1024 sc1 lds
    v_mfma_f32_16x16x32_bf16 v[80:83], v[24:27], a[240:243], v[136:139]
    ds_read_b128 v[40:43], v2 offset:128
    v_mfma_f32_16x16x32_bf16 v[80:83], v[28:31], a[244:247], v[80:83]
    v_exp_f32 v18, v126
    v_add_f32 v6, v6, v16
    v_mfma_f32_16x16x32_bf16 v[84:87], v[24:27], v[200:203], v[140:143]
    ds_read_b128 v[44:47], v3 offset:128
    v_add_f32 v6, v6, v17
    v_exp_f32 v19, v127
    v_cvt_pk_bf16_f32 v190, v16, v17
    v_add_f32 v6, v6, v18
    v_add_f32 v6, v6, v19
    v_cvt_pk_bf16_f32 v191, v18, v19
    v_mfma_f32_16x16x32_bf16 v[84:87], v[28:31], v[204:207], v[84:87]
    s_waitcnt lgkmcnt(2)
    v_exp_f32 v16, v64
    v_mfma_f32_16x16x32_bf16 v[112:115], v[32:35], a[240:243], v[136:139]
    ds_read_b128 v[24:27], v2 offset:6272
    v_mfma_f32_16x16x32_bf16 v[112:115], v[36:39], a[244:247], v[112:115]
    buffer_load_dwordx4 v4, s[4:7], s27 offen offset:2048 sc1 lds
    v_mfma_f32_16x16x32_bf16 v[116:119], v[32:35], v[200:203], v[140:143]
    ds_read_b128 v[28:31], v3 offset:6272
    v_mfma_f32_16x16x32_bf16 v[116:119], v[36:39], v[204:207], v[116:119]
    s_waitcnt lgkmcnt(2)
    v_exp_f32 v17, v65
    v_mfma_f32_16x16x32_bf16 v[80:83], v[40:43], a[248:251], v[80:83]
    ds_read_b128 v[32:35], v2 offset:256
    v_mfma_f32_16x16x32_bf16 v[80:83], v[44:47], a[252:255], v[80:83]
    v_exp_f32 v18, v66
    v_mfma_f32_16x16x32_bf16 v[84:87], v[40:43], v[208:211], v[84:87]
    ds_read_b128 v[36:39], v3 offset:256
    v_add_f32 v5, v5, v16
    v_mfma_f32_16x16x32_bf16 v[84:87], v[44:47], v[212:215], v[84:87]
    s_waitcnt lgkmcnt(2)
    v_add_f32 v5, v5, v17
    v_mfma_f32_16x16x32_bf16 v[112:115], v[24:27], a[248:251], v[112:115]
    ds_read_b128 v[40:43], v2 offset:6400
    v_mfma_f32_16x16x32_bf16 v[112:115], v[28:31], a[252:255], v[112:115]
    v_exp_f32 v19, v67
    v_cvt_pk_bf16_f32 v64, v16, v17
    v_mfma_f32_16x16x32_bf16 v[116:119], v[24:27], v[208:211], v[116:119]
    s_add_u32 s27, s27, 24576
    ds_read_b128 v[44:47], v3 offset:6400
    s_add_u32 s56, s56, 36864
    v_mfma_f32_16x16x32_bf16 v[116:119], v[28:31], v[212:215], v[116:119]
    s_waitcnt lgkmcnt(2)
    v_exp_f32 v16, v96
    v_mfma_f32_16x16x32_bf16 v[80:83], v[32:35], v[192:195], v[80:83]
    s_sub_u32 s58, s56, 147456
    ds_read_b128 v[24:27], v2 offset:12288
    v_add_f32 v5, v5, v18
    v_mfma_f32_16x16x32_bf16 v[80:83], v[36:39], v[196:199], v[80:83]
    s_min_u32 s56, s56, s58
    v_add_f32 v5, v5, v19
    v_mfma_f32_16x16x32_bf16 v[84:87], v[32:35], v[216:219], v[84:87]
    ds_read_b128 v[28:31], v3 offset:12288
    v_mfma_f32_16x16x32_bf16 v[84:87], v[36:39], v[220:223], v[84:87]
    s_waitcnt lgkmcnt(2)
    v_exp_f32 v17, v97
    v_cvt_pk_bf16_f32 v65, v18, v19
    v_mfma_f32_16x16x32_bf16 v[112:115], v[40:43], v[192:195], v[112:115]
    ds_read_b128 v[32:35], v2 offset:18432
    v_mfma_f32_16x16x32_bf16 v[112:115], v[44:47], v[196:199], v[112:115]
    v_exp_f32 v18, v98
    v_mfma_f32_16x16x32_bf16 v[116:119], v[40:43], v[216:219], v[116:119]
    ds_read_b128 v[36:39], v3 offset:18432
    v_add_f32 v5, v5, v16
    v_mfma_f32_16x16x32_bf16 v[116:119], v[44:47], v[220:223], v[116:119]
    s_waitcnt lgkmcnt(2)
    v_add_f32 v5, v5, v17
    v_mfma_f32_16x16x32_bf16 v[88:91], v[24:27], a[240:243], v[136:139]
    ds_read_b128 v[40:43], v2 offset:12416
    v_mfma_f32_16x16x32_bf16 v[88:91], v[28:31], a[244:247], v[88:91]
    v_exp_f32 v19, v99
    v_cvt_pk_bf16_f32 v66, v16, v17
    v_mfma_f32_16x16x32_bf16 v[92:95], v[24:27], v[200:203], v[140:143]
    ds_read_b128 v[44:47], v3 offset:12416
    v_mfma_f32_16x16x32_bf16 v[92:95], v[28:31], v[204:207], v[92:95]
    s_waitcnt lgkmcnt(2)
    v_exp_f32 v16, v68
    v_mfma_f32_16x16x32_bf16 v[120:123], v[32:35], a[240:243], v[136:139]
    ds_read_b128 v[24:27], v2 offset:18560
    v_add_f32 v5, v5, v18
    v_mfma_f32_16x16x32_bf16 v[120:123], v[36:39], a[244:247], v[120:123]
    v_add_f32 v5, v5, v19
    v_mfma_f32_16x16x32_bf16 v[124:127], v[32:35], v[200:203], v[140:143]
    ds_read_b128 v[28:31], v3 offset:18560
    v_mfma_f32_16x16x32_bf16 v[124:127], v[36:39], v[204:207], v[124:127]
    s_waitcnt lgkmcnt(2)
    v_exp_f32 v17, v69
    v_cvt_pk_bf16_f32 v67, v18, v19
    v_mfma_f32_16x16x32_bf16 v[88:91], v[40:43], a[248:251], v[88:91]
    ds_read_b128 v[32:35], v2 offset:12544
    v_mfma_f32_16x16x32_bf16 v[88:91], v[44:47], a[252:255], v[88:91]
    v_exp_f32 v18, v70
    v_mfma_f32_16x16x32_bf16 v[92:95], v[40:43], v[208:211], v[92:95]
    ds_read_b128 v[36:39], v3 offset:12544
    v_add_f32 v6, v6, v16
    v_mfma_f32_16x16x32_bf16 v[92:95], v[44:47], v[212:215], v[92:95]
    s_waitcnt lgkmcnt(2)
    v_add_f32 v6, v6, v17
    v_mfma_f32_16x16x32_bf16 v[120:123], v[24:27], a[248:251], v[120:123]
    ds_read_b128 v[40:43], v2 offset:18688
    v_mfma_f32_16x16x32_bf16 v[120:123], v[28:31], a[252:255], v[120:123]
    v_exp_f32 v19, v71
    v_cvt_pk_bf16_f32 v68, v16, v17
    v_mfma_f32_16x16x32_bf16 v[124:127], v[24:27], v[208:211], v[124:127]
    ds_read_b128 v[44:47], v3 offset:18688
    v_mfma_f32_16x16x32_bf16 v[124:127], v[28:31], v[212:215], v[124:127]
    s_waitcnt lgkmcnt(2)
    v_add_u32 v1, 49152, v1
    v_exp_f32 v16, v100
    v_mfma_f32_16x16x32_bf16 v[88:91], v[32:35], v[192:195], v[88:91]
    ds_read_b128 v[24:27], v1 offset:0
    v_add_f32 v6, v6, v18
    v_mfma_f32_16x16x32_bf16 v[88:91], v[36:39], v[196:199], v[88:91]
    v_add_f32 v6, v6, v19
    v_mfma_f32_16x16x32_bf16 v[92:95], v[32:35], v[216:219], v[92:95]
    ds_read_b128 v[28:31], v1 offset:12288
    v_mfma_f32_16x16x32_bf16 v[92:95], v[36:39], v[220:223], v[92:95]
    s_waitcnt lgkmcnt(2)
    v_exp_f32 v17, v101
    v_cvt_pk_bf16_f32 v69, v18, v19
    v_mfma_f32_16x16x32_bf16 v[120:123], v[40:43], v[192:195], v[120:123]
    ds_read_b128 v[32:35], v1 offset:1024
    v_mfma_f32_16x16x32_bf16 v[120:123], v[44:47], v[196:199], v[120:123]
    v_exp_f32 v18, v102
    v_mfma_f32_16x16x32_bf16 v[124:127], v[40:43], v[216:219], v[124:127]
    ds_read_b128 v[36:39], v1 offset:13312
    v_add_f32 v6, v6, v16
    v_mfma_f32_16x16x32_bf16 v[124:127], v[44:47], v[220:223], v[124:127]
    s_waitcnt lgkmcnt(2)
    v_add_f32 v6, v6, v17
    v_exp_f32 v19, v103
    v_cvt_pk_bf16_f32 v70, v16, v17
    v_add_f32 v6, v6, v18
    v_add_f32 v6, v6, v19
    v_cvt_pk_bf16_f32 v71, v18, v19
    v_mfma_f32_16x16x32_bf16 a[0:3], v[160:163], v[24:27], a[0:3]
    ds_read_b128 v[40:43], v1 offset:2048
    v_mfma_f32_16x16x32_bf16 a[0:3], v[168:171], v[28:31], a[0:3]
    v_exp_f32 v16, v72
    v_mfma_f32_16x16x32_bf16 a[48:51], v[164:167], v[24:27], a[48:51]
    ds_read_b128 v[44:47], v1 offset:14336
    v_mfma_f32_16x16x32_bf16 a[48:51], v[172:175], v[28:31], a[48:51]
    s_waitcnt lgkmcnt(2)
    v_exp_f32 v17, v73
    v_mfma_f32_16x16x32_bf16 a[4:7], v[160:163], v[32:35], a[4:7]
    ds_read_b128 v[24:27], v1 offset:3072
    v_mfma_f32_16x16x32_bf16 a[4:7], v[168:171], v[36:39], a[4:7]
    v_exp_f32 v18, v74
    v_mfma_f32_16x16x32_bf16 a[52:55], v[164:167], v[32:35], a[52:55]
    ds_read_b128 v[28:31], v1 offset:15360
    v_add_f32 v5, v5, v16
    v_mfma_f32_16x16x32_bf16 a[52:55], v[172:175], v[36:39], a[52:55]
    s_waitcnt lgkmcnt(2)
    v_add_f32 v5, v5, v17
    v_mfma_f32_16x16x32_bf16 a[8:11], v[160:163], v[40:43], a[8:11]
    ds_read_b128 v[32:35], v1 offset:4096
    v_mfma_f32_16x16x32_bf16 a[8:11], v[168:171], v[44:47], a[8:11]
    v_exp_f32 v19, v75
    v_mfma_f32_16x16x32_bf16 a[56:59], v[164:167], v[40:43], a[56:59]
    ds_read_b128 v[36:39], v1 offset:16384
    v_cvt_pk_bf16_f32 v72, v16, v17
    v_mfma_f32_16x16x32_bf16 a[56:59], v[172:175], v[44:47], a[56:59]
    s_waitcnt lgkmcnt(2)
    v_exp_f32 v16, v104
    v_mfma_f32_16x16x32_bf16 a[12:15], v[160:163], v[24:27], a[12:15]
    ds_read_b128 v[40:43], v1 offset:5120
    v_add_f32 v5, v5, v18
    v_mfma_f32_16x16x32_bf16 a[12:15], v[168:171], v[28:31], a[12:15]
    v_add_f32 v5, v5, v19
    v_mfma_f32_16x16x32_bf16 a[60:63], v[164:167], v[24:27], a[60:63]
    ds_read_b128 v[44:47], v1 offset:17408
    v_mfma_f32_16x16x32_bf16 a[60:63], v[172:175], v[28:31], a[60:63]
    s_waitcnt lgkmcnt(2)
    v_exp_f32 v17, v105
    v_mfma_f32_16x16x32_bf16 a[16:19], v[160:163], v[32:35], a[16:19]
    ds_read_b128 v[24:27], v1 offset:6144
    v_cvt_pk_bf16_f32 v73, v18, v19
    v_mfma_f32_16x16x32_bf16 a[16:19], v[168:171], v[36:39], a[16:19]
    v_exp_f32 v18, v106
    v_mfma_f32_16x16x32_bf16 a[64:67], v[164:167], v[32:35], a[64:67]
    ds_read_b128 v[28:31], v1 offset:18432
    v_add_f32 v5, v5, v16
    v_mfma_f32_16x16x32_bf16 a[64:67], v[172:175], v[36:39], a[64:67]
    s_waitcnt lgkmcnt(2)
    v_add_f32 v5, v5, v17
    v_mfma_f32_16x16x32_bf16 a[20:23], v[160:163], v[40:43], a[20:23]
    ds_read_b128 v[32:35], v1 offset:7168
    v_mfma_f32_16x16x32_bf16 a[20:23], v[168:171], v[44:47], a[20:23]
    v_exp_f32 v19, v107
    v_mfma_f32_16x16x32_bf16 a[68:71], v[164:167], v[40:43], a[68:71]
    ds_read_b128 v[36:39], v1 offset:19456
    v_cvt_pk_bf16_f32 v74, v16, v17
    v_mfma_f32_16x16x32_bf16 a[68:71], v[172:175], v[44:47], a[68:71]
    s_waitcnt lgkmcnt(2)
    v_exp_f32 v16, v76
    v_mfma_f32_16x16x32_bf16 a[24:27], v[160:163], v[24:27], a[24:27]
    ds_read_b128 v[40:43], v1 offset:8192
    v_add_f32 v5, v5, v18
    v_mfma_f32_16x16x32_bf16 a[24:27], v[168:171], v[28:31], a[24:27]
    v_add_f32 v5, v5, v19
    v_mfma_f32_16x16x32_bf16 a[72:75], v[164:167], v[24:27], a[72:75]
    ds_read_b128 v[44:47], v1 offset:20480
    v_mfma_f32_16x16x32_bf16 a[72:75], v[172:175], v[28:31], a[72:75]
    s_waitcnt lgkmcnt(2)
    v_exp_f32 v17, v77
    v_mfma_f32_16x16x32_bf16 a[28:31], v[160:163], v[32:35], a[28:31]
    ds_read_b128 v[24:27], v1 offset:9216
    v_cvt_pk_bf16_f32 v75, v18, v19
    v_mfma_f32_16x16x32_bf16 a[28:31], v[168:171], v[36:39], a[28:31]
    v_exp_f32 v18, v78
    v_mfma_f32_16x16x32_bf16 a[76:79], v[164:167], v[32:35], a[76:79]
    ds_read_b128 v[28:31], v1 offset:21504
    v_add_f32 v6, v6, v16
    v_mfma_f32_16x16x32_bf16 a[76:79], v[172:175], v[36:39], a[76:79]
    s_waitcnt lgkmcnt(2)
    v_add_f32 v6, v6, v17
    v_mfma_f32_16x16x32_bf16 a[32:35], v[160:163], v[40:43], a[32:35]
    ds_read_b128 v[32:35], v1 offset:10240
    v_mfma_f32_16x16x32_bf16 a[32:35], v[168:171], v[44:47], a[32:35]
    v_exp_f32 v19, v79
    v_mfma_f32_16x16x32_bf16 a[80:83], v[164:167], v[40:43], a[80:83]
    ds_read_b128 v[36:39], v1 offset:22528
    v_cvt_pk_bf16_f32 v76, v16, v17
    v_mfma_f32_16x16x32_bf16 a[80:83], v[172:175], v[44:47], a[80:83]
    s_waitcnt lgkmcnt(2)
    v_exp_f32 v16, v108
    v_mfma_f32_16x16x32_bf16 a[36:39], v[160:163], v[24:27], a[36:39]
    ds_read_b128 v[40:43], v1 offset:11264
    v_add_f32 v6, v6, v18
    v_mfma_f32_16x16x32_bf16 a[36:39], v[168:171], v[28:31], a[36:39]
    v_add_f32 v6, v6, v19
    v_mfma_f32_16x16x32_bf16 a[84:87], v[164:167], v[24:27], a[84:87]
    ds_read_b128 v[44:47], v1 offset:23552
    v_mfma_f32_16x16x32_bf16 a[84:87], v[172:175], v[28:31], a[84:87]
    s_waitcnt lgkmcnt(2)
    v_subrev_u32 v1, 98304, v1
    v_mfma_f32_16x16x32_bf16 a[40:43], v[160:163], v[32:35], a[40:43]
    ds_read_b128 v[24:27], v1 offset:0
    v_mfma_f32_16x16x32_bf16 a[40:43], v[168:171], v[36:39], a[40:43]
    v_exp_f32 v17, v109
    v_mfma_f32_16x16x32_bf16 a[88:91], v[164:167], v[32:35], a[88:91]
    ds_read_b128 v[28:31], v1 offset:12288
    v_cvt_pk_bf16_f32 v77, v18, v19
    v_mfma_f32_16x16x32_bf16 a[88:91], v[172:175], v[36:39], a[88:91]
    s_waitcnt lgkmcnt(2)
    v_exp_f32 v18, v110
    v_mfma_f32_16x16x32_bf16 a[44:47], v[160:163], v[40:43], a[44:47]
    ds_read_b128 v[32:35], v1 offset:1024
    v_add_f32 v6, v6, v16
    v_mfma_f32_16x16x32_bf16 a[44:47], v[168:171], v[44:47], a[44:47]
    v_add_f32 v6, v6, v17
    v_mfma_f32_16x16x32_bf16 a[92:95], v[164:167], v[40:43], a[92:95]
    ds_read_b128 v[36:39], v1 offset:13312
    v_mfma_f32_16x16x32_bf16 a[92:95], v[172:175], v[44:47], a[92:95]
    s_waitcnt lgkmcnt(2)
    v_exp_f32 v19, v111
    v_mfma_f32_16x16x32_bf16 a[0:3], v[176:179], v[24:27], a[0:3]
    ds_read_b128 v[40:43], v1 offset:2048
    v_cvt_pk_bf16_f32 v78, v16, v17
    v_mfma_f32_16x16x32_bf16 a[0:3], v[184:187], v[28:31], a[0:3]
    v_add_f32 v6, v6, v18
    v_add_f32 v6, v6, v19
    v_mfma_f32_16x16x32_bf16 a[48:51], v[180:183], v[24:27], a[48:51]
    ds_read_b128 v[44:47], v1 offset:14336
    v_cvt_pk_bf16_f32 v79, v18, v19
    v_mfma_f32_16x16x32_bf16 a[48:51], v[188:191], v[28:31], a[48:51]
    s_waitcnt lgkmcnt(2)
    v_exp_f32 v16, v80
    v_mfma_f32_16x16x32_bf16 a[4:7], v[176:179], v[32:35], a[4:7]
    ds_read_b128 v[24:27], v1 offset:3072
    v_mfma_f32_16x16x32_bf16 a[4:7], v[184:187], v[36:39], a[4:7]
    v_exp_f32 v17, v81
    v_mfma_f32_16x16x32_bf16 a[52:55], v[180:183], v[32:35], a[52:55]
    ds_read_b128 v[28:31], v1 offset:15360
    v_mfma_f32_16x16x32_bf16 a[52:55], v[188:191], v[36:39], a[52:55]
    s_waitcnt lgkmcnt(2)
    v_exp_f32 v18, v82
    v_mfma_f32_16x16x32_bf16 a[8:11], v[176:179], v[40:43], a[8:11]
    ds_read_b128 v[32:35], v1 offset:4096
    v_add_f32 v7, v7, v16
    v_mfma_f32_16x16x32_bf16 a[8:11], v[184:187], v[44:47], a[8:11]
    v_add_f32 v7, v7, v17
    v_mfma_f32_16x16x32_bf16 a[56:59], v[180:183], v[40:43], a[56:59]
    ds_read_b128 v[36:39], v1 offset:16384
    v_mfma_f32_16x16x32_bf16 a[56:59], v[188:191], v[44:47], a[56:59]
    s_waitcnt lgkmcnt(2)
    v_exp_f32 v19, v83
    v_mfma_f32_16x16x32_bf16 a[12:15], v[176:179], v[24:27], a[12:15]
    ds_read_b128 v[40:43], v1 offset:5120
    v_cvt_pk_bf16_f32 v80, v16, v17
    v_mfma_f32_16x16x32_bf16 a[12:15], v[184:187], v[28:31], a[12:15]
    v_exp_f32 v16, v112
    v_mfma_f32_16x16x32_bf16 a[60:63], v[180:183], v[24:27], a[60:63]
    ds_read_b128 v[44:47], v1 offset:17408
    v_add_f32 v7, v7, v18
    v_mfma_f32_16x16x32_bf16 a[60:63], v[188:191], v[28:31], a[60:63]
    s_waitcnt lgkmcnt(2)
    v_add_f32 v7, v7, v19
    v_mfma_f32_16x16x32_bf16 a[16:19], v[176:179], v[32:35], a[16:19]
    ds_read_b128 v[24:27], v1 offset:6144
    v_mfma_f32_16x16x32_bf16 a[16:19], v[184:187], v[36:39], a[16:19]
    v_exp_f32 v17, v113
    v_mfma_f32_16x16x32_bf16 a[64:67], v[180:183], v[32:35], a[64:67]
    ds_read_b128 v[28:31], v1 offset:18432
    v_cvt_pk_bf16_f32 v81, v18, v19
    v_mfma_f32_16x16x32_bf16 a[64:67], v[188:191], v[36:39], a[64:67]
    s_waitcnt lgkmcnt(2)
    v_exp_f32 v18, v114
    v_mfma_f32_16x16x32_bf16 a[20:23], v[176:179], v[40:43], a[20:23]
    ds_read_b128 v[32:35], v1 offset:7168
    v_add_f32 v7, v7, v16
    v_mfma_f32_16x16x32_bf16 a[20:23], v[184:187], v[44:47], a[20:23]
    v_add_f32 v7, v7, v17
    v_mfma_f32_16x16x32_bf16 a[68:71], v[180:183], v[40:43], a[68:71]
    ds_read_b128 v[36:39], v1 offset:19456
    v_mfma_f32_16x16x32_bf16 a[68:71], v[188:191], v[44:47], a[68:71]
    s_waitcnt lgkmcnt(2)
    v_exp_f32 v19, v115
    v_mfma_f32_16x16x32_bf16 a[24:27], v[176:179], v[24:27], a[24:27]
    ds_read_b128 v[40:43], v1 offset:8192
    v_cvt_pk_bf16_f32 v82, v16, v17
    v_mfma_f32_16x16x32_bf16 a[24:27], v[184:187], v[28:31], a[24:27]
    v_exp_f32 v16, v84
    v_mfma_f32_16x16x32_bf16 a[72:75], v[180:183], v[24:27], a[72:75]
    ds_read_b128 v[44:47], v1 offset:20480
    v_add_f32 v7, v7, v18
    v_mfma_f32_16x16x32_bf16 a[72:75], v[188:191], v[28:31], a[72:75]
    s_waitcnt lgkmcnt(2)
    v_add_f32 v7, v7, v19
    v_mfma_f32_16x16x32_bf16 a[28:31], v[176:179], v[32:35], a[28:31]
    ds_read_b128 v[24:27], v1 offset:9216
    v_mfma_f32_16x16x32_bf16 a[28:31], v[184:187], v[36:39], a[28:31]
    s_waitcnt vmcnt(0)
    v_exp_f32 v17, v85
    v_mfma_f32_16x16x32_bf16 a[76:79], v[180:183], v[32:35], a[76:79]
    ds_read_b128 v[28:31], v1 offset:21504
    v_cvt_pk_bf16_f32 v83, v18, v19
    v_mfma_f32_16x16x32_bf16 a[76:79], v[188:191], v[36:39], a[76:79]
    s_waitcnt lgkmcnt(2)
    s_barrier
    v_mfma_f32_16x16x32_bf16 a[32:35], v[176:179], v[40:43], a[32:35]
    ds_read_b128 v[32:35], v1 offset:10240
    v_mfma_f32_16x16x32_bf16 a[32:35], v[184:187], v[44:47], a[32:35]
    v_exp_f32 v18, v86
    v_mfma_f32_16x16x32_bf16 a[80:83], v[180:183], v[40:43], a[80:83]
    ds_read_b128 v[36:39], v1 offset:22528
    v_add_f32 v8, v8, v16
    v_mfma_f32_16x16x32_bf16 a[80:83], v[188:191], v[44:47], a[80:83]
    s_waitcnt lgkmcnt(2)
    v_add_f32 v8, v8, v17
    v_mfma_f32_16x16x32_bf16 a[36:39], v[176:179], v[24:27], a[36:39]
    ds_read_b128 v[40:43], v1 offset:11264
    v_mfma_f32_16x16x32_bf16 a[36:39], v[184:187], v[28:31], a[36:39]
    v_exp_f32 v19, v87
    v_cvt_pk_bf16_f32 v84, v16, v17
    v_mfma_f32_16x16x32_bf16 a[84:87], v[180:183], v[24:27], a[84:87]
    ds_read_b128 v[44:47], v1 offset:23552
    v_mfma_f32_16x16x32_bf16 a[84:87], v[188:191], v[28:31], a[84:87]
    s_waitcnt lgkmcnt(2)
    v_add_u32 v1, 49152, v1
    v_exp_f32 v16, v116
    v_mfma_f32_16x16x32_bf16 a[40:43], v[176:179], v[32:35], a[40:43]
    ds_read_b128 v[24:27], v1 offset:0
    v_add_f32 v8, v8, v18
    v_mfma_f32_16x16x32_bf16 a[40:43], v[184:187], v[36:39], a[40:43]
    v_add_f32 v8, v8, v19
    v_mfma_f32_16x16x32_bf16 a[88:91], v[180:183], v[32:35], a[88:91]
    ds_read_b128 v[28:31], v1 offset:12288
    v_mfma_f32_16x16x32_bf16 a[88:91], v[188:191], v[36:39], a[88:91]
    s_waitcnt lgkmcnt(2)
    v_exp_f32 v17, v117
    v_cvt_pk_bf16_f32 v85, v18, v19
    v_mfma_f32_16x16x32_bf16 a[44:47], v[176:179], v[40:43], a[44:47]
    ds_read_b128 v[32:35], v1 offset:1024
    v_mfma_f32_16x16x32_bf16 a[44:47], v[184:187], v[44:47], a[44:47]
    v_exp_f32 v18, v118
    v_mfma_f32_16x16x32_bf16 a[92:95], v[180:183], v[40:43], a[92:95]
    ds_read_b128 v[36:39], v1 offset:13312
    v_add_f32 v8, v8, v16
    v_mfma_f32_16x16x32_bf16 a[92:95], v[188:191], v[44:47], a[92:95]
    s_waitcnt lgkmcnt(2)
    v_add_f32 v8, v8, v17
    v_exp_f32 v19, v119
    v_cvt_pk_bf16_f32 v86, v16, v17
    v_add_f32 v8, v8, v18
    v_add_f32 v8, v8, v19
    v_cvt_pk_bf16_f32 v87, v18, v19
    v_mfma_f32_16x16x32_bf16 a[0:3], v[64:67], v[24:27], a[0:3]
    ds_read_b128 v[40:43], v1 offset:2048
    v_mfma_f32_16x16x32_bf16 a[0:3], v[72:75], v[28:31], a[0:3]
    v_exp_f32 v16, v88
    v_exp_f32 v17, v89
    v_exp_f32 v18, v90
    v_mfma_f32_16x16x4_f32 v[48:51], v5, v57, 0
    v_mfma_f32_16x16x32_bf16 a[48:51], v[68:71], v[24:27], a[48:51]
    ds_read_b128 v[44:47], v1 offset:14336
    v_mfma_f32_16x16x32_bf16 a[48:51], v[76:79], v[28:31], a[48:51]
    s_waitcnt lgkmcnt(2)
    v_exp_f32 v19, v91
    v_cvt_pk_bf16_f32 v88, v16, v17
    v_exp_f32 v16, v120
    v_mfma_f32_16x16x4_f32 v[52:55], v6, v57, 0
    v_mfma_f32_16x16x32_bf16 a[4:7], v[64:67], v[32:35], a[4:7]
    ds_read_b128 v[24:27], v1 offset:3072
    v_mfma_f32_16x16x32_bf16 a[4:7], v[72:75], v[36:39], a[4:7]
    v_exp_f32 v17, v121
    v_cvt_pk_bf16_f32 v89, v18, v19
    v_mfma_f32_16x16x32_bf16 a[52:55], v[68:71], v[32:35], a[52:55]
    ds_read_b128 v[28:31], v1 offset:15360
    v_mfma_f32_16x16x32_bf16 a[52:55], v[76:79], v[36:39], a[52:55]
    s_waitcnt lgkmcnt(2)
    v_exp_f32 v18, v122
    v_mfma_f32_16x16x32_bf16 a[8:11], v[64:67], v[40:43], a[8:11]
    ds_read_b128 v[32:35], v1 offset:4096
    v_mfma_f32_16x16x32_bf16 a[8:11], v[72:75], v[44:47], a[8:11]
    v_exp_f32 v19, v123
    v_mfma_f32_16x16x32_bf16 a[56:59], v[68:71], v[40:43], a[56:59]
    ds_read_b128 v[36:39], v1 offset:16384
    v_cvt_pk_bf16_f32 v90, v16, v17
    v_mfma_f32_16x16x32_bf16 a[56:59], v[76:79], v[44:47], a[56:59]
    s_waitcnt lgkmcnt(2)
    v_exp_f32 v16, v92
    v_mfma_f32_16x16x32_bf16 a[12:15], v[64:67], v[24:27], a[12:15]
    ds_read_b128 v[40:43], v1 offset:5120
    v_mfma_f32_16x16x32_bf16 a[12:15], v[72:75], v[28:31], a[12:15]
    v_exp_f32 v17, v93
    v_mfma_f32_16x16x32_bf16 a[60:63], v[68:71], v[24:27], a[60:63]
    ds_read_b128 v[44:47], v1 offset:17408
    v_cvt_pk_bf16_f32 v91, v18, v19
    v_mfma_f32_16x16x32_bf16 a[60:63], v[76:79], v[28:31], a[60:63]
    s_waitcnt lgkmcnt(2)
    v_exp_f32 v18, v94
    v_mfma_f32_16x16x32_bf16 a[16:19], v[64:67], v[32:35], a[16:19]
L_pg12:
    s_cbranch_execz L_iwret
    ds_read_b128 v[24:27], v1 offset:6144
    v_mfma_f32_16x16x32_bf16 a[16:19], v[72:75], v[36:39], a[16:19]
    v_exp_f32 v19, v95
    v_mfma_f32_16x16x32_bf16 a[64:67], v[68:71], v[32:35], a[64:67]
    ds_read_b128 v[28:31], v1 offset:18432
    v_mfma_f32_16x16x32_bf16 a[64:67], v[76:79], v[36:39], a[64:67]
    s_waitcnt lgkmcnt(2)
    v_mfma_f32_16x16x32_bf16 v[128:131], v[88:91], v[20:23], 0
    v_mfma_f32_16x16x32_bf16 a[20:23], v[64:67], v[40:43], a[20:23]
    ds_read_b128 v[32:35], v1 offset:7168
    v_cvt_pk_bf16_f32 v92, v16, v17
    v_mfma_f32_16x16x32_bf16 a[20:23], v[72:75], v[44:47], a[20:23]
    v_exp_f32 v16, v124
    v_mfma_f32_16x16x32_bf16 a[68:71], v[68:71], v[40:43], a[68:71]
    ds_read_b128 v[36:39], v1 offset:19456
    v_mfma_f32_16x16x32_bf16 a[68:71], v[76:79], v[44:47], a[68:71]
    s_waitcnt lgkmcnt(2)
    v_exp_f32 v17, v125
    v_mfma_f32_16x16x32_bf16 a[24:27], v[64:67], v[24:27], a[24:27]
    ds_read_b128 v[40:43], v1 offset:8192
    v_cvt_pk_bf16_f32 v93, v18, v19
    v_mfma_f32_16x16x32_bf16 a[24:27], v[72:75], v[28:31], a[24:27]
    v_exp_f32 v18, v126
    v_mfma_f32_16x16x32_bf16 a[72:75], v[68:71], v[24:27], a[72:75]
    ds_read_b128 v[44:47], v1 offset:20480
    v_mfma_f32_16x16x32_bf16 a[72:75], v[76:79], v[28:31], a[72:75]
    s_waitcnt lgkmcnt(2)
    v_exp_f32 v19, v127
    v_mfma_f32_16x16x32_bf16 a[28:31], v[64:67], v[32:35], a[28:31]
    ds_read_b128 v[24:27], v1 offset:9216
    v_cvt_pk_bf16_f32 v94, v16, v17
    v_mfma_f32_16x16x32_bf16 a[28:31], v[72:75], v[36:39], a[28:31]
    v_cvt_pk_bf16_f32 v95, v18, v19
    s_nop 1
    v_mfma_f32_16x16x32_bf16 a[76:79], v[68:71], v[32:35], a[76:79]
    ds_read_b128 v[28:31], v1 offset:21504
    v_mfma_f32_16x16x32_bf16 a[76:79], v[76:79], v[36:39], a[76:79]
    s_waitcnt lgkmcnt(2)
    v_mfma_f32_16x16x32_bf16 v[132:135], v[92:95], v[20:23], 0
    v_mfma_f32_16x16x32_bf16 a[32:35], v[64:67], v[40:43], a[32:35]
    ds_read_b128 v[32:35], v1 offset:10240
    v_mfma_f32_16x16x32_bf16 a[32:35], v[72:75], v[44:47], a[32:35]
    v_rcp_f32 v48, v48
    v_mfma_f32_16x16x32_bf16 a[80:83], v[68:71], v[40:43], a[80:83]
    ds_read_b128 v[36:39], v1 offset:22528
    v_mfma_f32_16x16x32_bf16 a[80:83], v[76:79], v[44:47], a[80:83]
    s_waitcnt lgkmcnt(2)
    v_rcp_f32 v49, v49
    v_mfma_f32_16x16x32_bf16 a[36:39], v[64:67], v[24:27], a[36:39]
    ds_read_b128 v[40:43], v1 offset:11264
    v_mfma_f32_16x16x32_bf16 a[36:39], v[72:75], v[28:31], a[36:39]
    v_rcp_f32 v50, v50
    v_mfma_f32_16x16x32_bf16 a[84:87], v[68:71], v[24:27], a[84:87]
    ds_read_b128 v[44:47], v1 offset:23552
    v_mfma_f32_16x16x32_bf16 a[84:87], v[76:79], v[28:31], a[84:87]
    s_waitcnt lgkmcnt(2)
    v_subrev_u32 v2, 98304, v2
    v_subrev_u32 v3, 98304, v3
    v_mfma_f32_16x16x32_bf16 a[40:43], v[64:67], v[32:35], a[40:43]
    ds_read_b128 v[24:27], v2 offset:0
    v_mfma_f32_16x16x32_bf16 a[40:43], v[72:75], v[36:39], a[40:43]
    v_rcp_f32 v51, v51
    v_mfma_f32_16x16x32_bf16 a[88:91], v[68:71], v[32:35], a[88:91]
    ds_read_b128 v[28:31], v3 offset:0
    v_mfma_f32_16x16x32_bf16 a[88:91], v[76:79], v[36:39], a[88:91]
    s_waitcnt lgkmcnt(2)
    v_rcp_f32 v52, v52
    v_mfma_f32_16x16x32_bf16 a[44:47], v[64:67], v[40:43], a[44:47]
    ds_read_b128 v[32:35], v2 offset:6144
    v_mfma_f32_16x16x32_bf16 a[44:47], v[72:75], v[44:47], a[44:47]
    v_rcp_f32 v53, v53
    v_mfma_f32_16x16x32_bf16 a[92:95], v[68:71], v[40:43], a[92:95]
    ds_read_b128 v[36:39], v3 offset:6144
    v_mfma_f32_16x16x32_bf16 a[92:95], v[76:79], v[44:47], a[92:95]
    s_waitcnt lgkmcnt(2)
    v_rcp_f32 v54, v54
    v_mfma_f32_16x16x32_bf16 v[160:163], v[24:27], a[240:243], v[136:139]
    ds_read_b128 v[40:43], v2 offset:128
    v_mfma_f32_16x16x32_bf16 v[160:163], v[28:31], a[244:247], v[160:163]
    v_rcp_f32 v55, v55
    v_mfma_f32_16x16x32_bf16 v[164:167], v[24:27], v[200:203], v[140:143]
    ds_read_b128 v[44:47], v3 offset:128
    v_mfma_f32_16x16x32_bf16 v[164:167], v[28:31], v[204:207], v[164:167]
    s_waitcnt lgkmcnt(2)
    v_mfma_f32_16x16x32_bf16 v[96:99], v[32:35], a[240:243], v[136:139]
    ds_read_b128 v[24:27], v2 offset:6272
    v_accvgpr_read_b32 v224, a0
    v_mfma_f32_16x16x32_bf16 v[96:99], v[36:39], a[244:247], v[96:99]
    v_accvgpr_read_b32 v225, a4
    v_accvgpr_read_b32 v226, a8
    v_accvgpr_read_b32 v227, a12
    v_accvgpr_read_b32 v228, a16
    v_accvgpr_read_b32 v229, a20
    v_mfma_f32_16x16x32_bf16 v[100:103], v[32:35], v[200:203], v[140:143]
    ds_read_b128 v[28:31], v3 offset:6272
    v_mul_f32 v224, v224, v48
    v_mfma_f32_16x16x32_bf16 v[100:103], v[36:39], v[204:207], v[100:103]
    s_waitcnt lgkmcnt(2)
    v_mul_f32 v225, v225, v48
    v_mul_f32 v226, v226, v48
    v_mul_f32 v227, v227, v48
    v_mul_f32 v228, v228, v48
    v_mul_f32 v229, v229, v48
    v_mfma_f32_16x16x32_bf16 v[160:163], v[40:43], a[248:251], v[160:163]
    ds_read_b128 v[32:35], v2 offset:256
    v_cvt_pk_bf16_f32 v224, v224, v225
    v_mfma_f32_16x16x32_bf16 v[160:163], v[44:47], a[252:255], v[160:163]
    v_cvt_pk_bf16_f32 v225, v226, v227
    v_cvt_pk_bf16_f32 v226, v228, v229
    v_accvgpr_read_b32 v230, a1
    v_accvgpr_read_b32 v231, a5
    v_accvgpr_read_b32 v232, a9
    v_mfma_f32_16x16x32_bf16 v[164:167], v[40:43], v[208:211], v[164:167]
    ds_read_b128 v[36:39], v3 offset:256
    v_accvgpr_read_b32 v233, a13
    v_mfma_f32_16x16x32_bf16 v[164:167], v[44:47], v[212:215], v[164:167]
    s_waitcnt lgkmcnt(2)
    buffer_store_dwordx3 v[224:226], v56, s[12:15], s24 offen offset:0 sc0 sc1
    v_accvgpr_read_b32 v234, a17
    v_accvgpr_read_b32 v235, a21
    v_mfma_f32_16x16x32_bf16 v[96:99], v[24:27], a[248:251], v[96:99]
    ds_read_b128 v[40:43], v2 offset:6400
    v_mul_f32 v230, v230, v49
    v_mfma_f32_16x16x32_bf16 v[96:99], v[28:31], a[252:255], v[96:99]
    v_mul_f32 v231, v231, v49
    v_mul_f32 v232, v232, v49
    v_mul_f32 v233, v233, v49
    v_mul_f32 v234, v234, v49
    v_mul_f32 v235, v235, v49
    v_mfma_f32_16x16x32_bf16 v[100:103], v[24:27], v[208:211], v[100:103]
    ds_read_b128 v[44:47], v3 offset:6400
    v_cvt_pk_bf16_f32 v230, v230, v231
    v_mfma_f32_16x16x32_bf16 v[100:103], v[28:31], v[212:215], v[100:103]
    s_waitcnt lgkmcnt(2)
    v_cvt_pk_bf16_f32 v231, v232, v233
    v_cvt_pk_bf16_f32 v232, v234, v235
    v_accvgpr_read_b32 v236, a2
    v_accvgpr_read_b32 v237, a6
    v_accvgpr_read_b32 v238, a10
    v_mfma_f32_16x16x32_bf16 v[160:163], v[32:35], v[192:195], v[160:163]
    ds_read_b128 v[24:27], v2 offset:12288
    v_accvgpr_read_b32 v239, a14
    v_mfma_f32_16x16x32_bf16 v[160:163], v[36:39], v[196:199], v[160:163]
    buffer_store_dwordx3 v[230:232], v56, s[12:15], s24 offen offset:384 sc0 sc1
    v_accvgpr_read_b32 v240, a18
    v_accvgpr_read_b32 v241, a22
    v_mfma_f32_16x16x32_bf16 v[164:167], v[32:35], v[216:219], v[164:167]
    ds_read_b128 v[28:31], v3 offset:12288
    v_mul_f32 v236, v236, v50
    v_mfma_f32_16x16x32_bf16 v[164:167], v[36:39], v[220:223], v[164:167]
    s_waitcnt lgkmcnt(2)
    v_mul_f32 v237, v237, v50
    v_mul_f32 v238, v238, v50
    v_mul_f32 v239, v239, v50
    v_mul_f32 v240, v240, v50
    v_mul_f32 v241, v241, v50
    v_mfma_f32_16x16x32_bf16 v[96:99], v[40:43], v[192:195], v[96:99]
    ds_read_b128 v[32:35], v2 offset:18432
    v_cvt_pk_bf16_f32 v236, v236, v237
    v_mfma_f32_16x16x32_bf16 v[96:99], v[44:47], v[196:199], v[96:99]
    v_cvt_pk_bf16_f32 v237, v238, v239
    v_cvt_pk_bf16_f32 v238, v240, v241
    v_accvgpr_read_b32 v242, a3
    v_accvgpr_read_b32 v243, a7
    v_accvgpr_read_b32 v244, a11
    v_mfma_f32_16x16x32_bf16 v[100:103], v[40:43], v[216:219], v[100:103]
    ds_read_b128 v[36:39], v3 offset:18432
    v_accvgpr_read_b32 v245, a15
    v_mfma_f32_16x16x32_bf16 v[100:103], v[44:47], v[220:223], v[100:103]
    s_waitcnt lgkmcnt(2)
    buffer_store_dwordx3 v[236:238], v56, s[12:15], s24 offen offset:768 sc0 sc1
    v_accvgpr_read_b32 v246, a19
    v_accvgpr_read_b32 v247, a23
    v_mfma_f32_16x16x32_bf16 v[168:171], v[24:27], a[240:243], v[136:139]
    ds_read_b128 v[40:43], v2 offset:12416
    v_mul_f32 v242, v242, v51
    v_mfma_f32_16x16x32_bf16 v[168:171], v[28:31], a[244:247], v[168:171]
    v_mul_f32 v243, v243, v51
    v_mul_f32 v244, v244, v51
    v_mul_f32 v245, v245, v51
    v_mul_f32 v246, v246, v51
    v_mul_f32 v247, v247, v51
    v_mfma_f32_16x16x32_bf16 v[172:175], v[24:27], v[200:203], v[140:143]
    ds_read_b128 v[44:47], v3 offset:12416
    v_cvt_pk_bf16_f32 v242, v242, v243
    v_mfma_f32_16x16x32_bf16 v[172:175], v[28:31], v[204:207], v[172:175]
    s_waitcnt lgkmcnt(2)
    v_cvt_pk_bf16_f32 v243, v244, v245
    v_cvt_pk_bf16_f32 v244, v246, v247
    v_accvgpr_read_b32 v248, a24
    v_accvgpr_read_b32 v249, a28
    v_accvgpr_read_b32 v250, a32
    v_mfma_f32_16x16x32_bf16 v[104:107], v[32:35], a[240:243], v[136:139]
    ds_read_b128 v[24:27], v2 offset:18560
    v_accvgpr_read_b32 v251, a36
    v_mfma_f32_16x16x32_bf16 v[104:107], v[36:39], a[244:247], v[104:107]
    buffer_store_dwordx3 v[242:244], v56, s[12:15], s24 offen offset:1152 sc0 sc1
    v_accvgpr_read_b32 v252, a40
    v_accvgpr_read_b32 v253, a44
    v_mfma_f32_16x16x32_bf16 v[108:111], v[32:35], v[200:203], v[140:143]
    ds_read_b128 v[28:31], v3 offset:18560
    v_mul_f32 v248, v248, v48
    v_mfma_f32_16x16x32_bf16 v[108:111], v[36:39], v[204:207], v[108:111]
    s_waitcnt lgkmcnt(2)
    v_mul_f32 v249, v249, v48
    v_mul_f32 v250, v250, v48
    v_mul_f32 v251, v251, v48
    v_mul_f32 v252, v252, v48
    v_mul_f32 v253, v253, v48
    v_mfma_f32_16x16x32_bf16 v[168:171], v[40:43], a[248:251], v[168:171]
    ds_read_b128 v[32:35], v2 offset:12544
    v_cvt_pk_bf16_f32 v248, v248, v249
    v_mfma_f32_16x16x32_bf16 v[168:171], v[44:47], a[252:255], v[168:171]
    v_cvt_pk_bf16_f32 v249, v250, v251
    v_cvt_pk_bf16_f32 v250, v252, v253
    v_accvgpr_read_b32 v224, a25
    v_accvgpr_read_b32 v225, a29
    v_accvgpr_read_b32 v226, a33
    v_mfma_f32_16x16x32_bf16 v[172:175], v[40:43], v[208:211], v[172:175]
    ds_read_b128 v[36:39], v3 offset:12544
    v_accvgpr_read_b32 v227, a37
    v_mfma_f32_16x16x32_bf16 v[172:175], v[44:47], v[212:215], v[172:175]
    s_waitcnt lgkmcnt(2)
    buffer_store_dwordx3 v[248:250], v56, s[12:15], s24 offen offset:192 sc0 sc1
    v_accvgpr_read_b32 v228, a41
    v_mfma_f32_16x16x32_bf16 v[104:107], v[24:27], a[248:251], v[104:107]
    ds_read_b128 v[40:43], v2 offset:18688
    v_accvgpr_read_b32 v229, a45
    v_mfma_f32_16x16x32_bf16 v[104:107], v[28:31], a[252:255], v[104:107]
    v_mul_f32 v224, v224, v49
    v_mul_f32 v225, v225, v49
    v_mul_f32 v226, v226, v49
    v_mul_f32 v227, v227, v49
    v_mul_f32 v228, v228, v49
    v_mul_f32 v229, v229, v49
    v_mfma_f32_16x16x32_bf16 v[108:111], v[24:27], v[208:211], v[108:111]
    ds_read_b128 v[44:47], v3 offset:18688
    v_cvt_pk_bf16_f32 v224, v224, v225
    v_mfma_f32_16x16x32_bf16 v[108:111], v[28:31], v[212:215], v[108:111]
    s_waitcnt lgkmcnt(2)
    v_add_u32 v2, 49152, v2
    v_add_u32 v3, 49152, v3
    v_exp_f32 v16, v160
    v_cvt_pk_bf16_f32 v225, v226, v227
    v_mfma_f32_16x16x32_bf16 v[168:171], v[32:35], v[192:195], v[168:171]
    ds_read_b128 v[24:27], v2 offset:0
    v_cvt_pk_bf16_f32 v226, v228, v229
    v_mfma_f32_16x16x32_bf16 v[168:171], v[36:39], v[196:199], v[168:171]
    buffer_store_dwordx3 v[224:226], v56, s[12:15], s24 offen offset:576 sc0 sc1
    v_accvgpr_read_b32 v230, a26
    v_mfma_f32_16x16x32_bf16 v[172:175], v[32:35], v[216:219], v[172:175]
    ds_read_b128 v[28:31], v3 offset:0
    v_accvgpr_read_b32 v231, a30
    v_mfma_f32_16x16x32_bf16 v[172:175], v[36:39], v[220:223], v[172:175]
    s_waitcnt lgkmcnt(2)
    v_exp_f32 v17, v161
    v_exp_f32 v18, v162
    v_exp_f32 v19, v163
    v_mfma_f32_16x16x32_bf16 v[104:107], v[40:43], v[192:195], v[104:107]
    ds_read_b128 v[32:35], v2 offset:6144
    v_accvgpr_read_b32 v232, a34
    v_mfma_f32_16x16x32_bf16 v[104:107], v[44:47], v[196:199], v[104:107]
    v_cvt_pk_bf16_f32 v160, v16, v17
    v_accvgpr_read_b32 v233, a38
    v_accvgpr_read_b32 v234, a42
    v_exp_f32 v16, v96
    v_mfma_f32_16x16x32_bf16 v[108:111], v[40:43], v[216:219], v[108:111]
    ds_read_b128 v[36:39], v3 offset:6144
    v_accvgpr_read_b32 v235, a46
    v_mfma_f32_16x16x32_bf16 v[108:111], v[44:47], v[220:223], v[108:111]
    s_waitcnt lgkmcnt(2)
    v_mul_f32 v230, v230, v50
    v_exp_f32 v17, v97
    v_mul_f32 v231, v231, v50
    v_mul_f32 v232, v232, v50
    v_mfma_f32_16x16x32_bf16 v[176:179], v[24:27], a[240:243], v[136:139]
    ds_read_b128 v[40:43], v2 offset:128
    v_cvt_pk_bf16_f32 v161, v18, v19
    v_mfma_f32_16x16x32_bf16 v[176:179], v[28:31], a[244:247], v[176:179]
    v_mul_f32 v233, v233, v50
    v_exp_f32 v18, v98
    v_mul_f32 v234, v234, v50
    v_mul_f32 v235, v235, v50
    v_cvt_pk_bf16_f32 v230, v230, v231
    v_mfma_f32_16x16x32_bf16 v[180:183], v[24:27], v[200:203], v[140:143]
    ds_read_b128 v[44:47], v3 offset:128
    v_cvt_pk_bf16_f32 v231, v232, v233
    v_mfma_f32_16x16x32_bf16 v[180:183], v[28:31], v[204:207], v[180:183]
    s_waitcnt lgkmcnt(2)
    v_exp_f32 v19, v99
    v_cvt_pk_bf16_f32 v232, v234, v235
    v_accvgpr_read_b32 v236, a27
    v_cvt_pk_bf16_f32 v162, v16, v17
    v_mfma_f32_16x16x32_bf16 v[112:115], v[32:35], a[240:243], v[136:139]
    ds_read_b128 v[24:27], v2 offset:6272
    v_accvgpr_read_b32 v237, a31
    v_mfma_f32_16x16x32_bf16 v[112:115], v[36:39], a[244:247], v[112:115]
    buffer_store_dwordx3 v[230:232], v56, s[12:15], s24 offen offset:960 sc0 sc1
    v_accvgpr_read_b32 v238, a35
    v_mfma_f32_16x16x32_bf16 v[116:119], v[32:35], v[200:203], v[140:143]
    ds_read_b128 v[28:31], v3 offset:6272
    v_accvgpr_read_b32 v239, a39
    v_mfma_f32_16x16x32_bf16 v[116:119], v[36:39], v[204:207], v[116:119]
    s_waitcnt lgkmcnt(2)
    v_exp_f32 v16, v164
    v_exp_f32 v17, v165
    v_accvgpr_read_b32 v240, a43
    v_accvgpr_read_b32 v241, a47
    v_mfma_f32_16x16x32_bf16 v[176:179], v[40:43], a[248:251], v[176:179]
    ds_read_b128 v[32:35], v2 offset:256
    v_cvt_pk_bf16_f32 v163, v18, v19
    v_mfma_f32_16x16x32_bf16 v[176:179], v[44:47], a[252:255], v[176:179]
    v_exp_f32 v18, v166
    v_mul_f32 v236, v236, v51
    v_mul_f32 v237, v237, v51
    v_mul_f32 v238, v238, v51
    v_mfma_f32_16x16x32_bf16 v[180:183], v[40:43], v[208:211], v[180:183]
    ds_read_b128 v[36:39], v3 offset:256
    v_mul_f32 v239, v239, v51
    v_mfma_f32_16x16x32_bf16 v[180:183], v[44:47], v[212:215], v[180:183]
    s_waitcnt lgkmcnt(2)
    v_exp_f32 v19, v167
    v_mul_f32 v240, v240, v51
    v_mul_f32 v241, v241, v51
    v_cvt_pk_bf16_f32 v236, v236, v237
    v_mfma_f32_16x16x32_bf16 v[112:115], v[24:27], a[248:251], v[112:115]
    ds_read_b128 v[40:43], v2 offset:6400
    v_cvt_pk_bf16_f32 v237, v238, v239
    v_mfma_f32_16x16x32_bf16 v[112:115], v[28:31], a[252:255], v[112:115]
    v_mfma_f32_16x16x32_bf16 v[128:131], v[160:163], v[20:23], v[128:131]
    v_cvt_pk_bf16_f32 v164, v16, v17
    v_cvt_pk_bf16_f32 v238, v240, v241
    v_accvgpr_read_b32 v242, a48
    v_mfma_f32_16x16x32_bf16 v[116:119], v[24:27], v[208:211], v[116:119]
    ds_read_b128 v[44:47], v3 offset:6400
    v_accvgpr_read_b32 v243, a52
    v_mfma_f32_16x16x32_bf16 v[116:119], v[28:31], v[212:215], v[116:119]
    s_waitcnt lgkmcnt(2)
    buffer_store_dwordx3 v[236:238], v56, s[12:15], s24 offen offset:1344 sc0 sc1
    v_exp_f32 v16, v100
    v_mfma_f32_16x16x32_bf16 v[176:179], v[32:35], v[192:195], v[176:179]
    ds_read_b128 v[24:27], v2 offset:12288
    v_accvgpr_read_b32 v244, a56
    v_mfma_f32_16x16x32_bf16 v[176:179], v[36:39], v[196:199], v[176:179]
    v_exp_f32 v17, v101
    v_accvgpr_read_b32 v245, a60
    v_cvt_pk_bf16_f32 v165, v18, v19
    v_accvgpr_read_b32 v246, a64
    v_mfma_f32_16x16x32_bf16 v[180:183], v[32:35], v[216:219], v[180:183]
    ds_read_b128 v[28:31], v3 offset:12288
    v_accvgpr_read_b32 v247, a68
    v_mfma_f32_16x16x32_bf16 v[180:183], v[36:39], v[220:223], v[180:183]
    s_waitcnt lgkmcnt(2)
    v_exp_f32 v18, v102
    v_mul_f32 v242, v242, v52
    v_mul_f32 v243, v243, v52
    v_mul_f32 v244, v244, v52
    v_mfma_f32_16x16x32_bf16 v[112:115], v[40:43], v[192:195], v[112:115]
    ds_read_b128 v[32:35], v2 offset:18432
    v_mul_f32 v245, v245, v52
    v_mfma_f32_16x16x32_bf16 v[112:115], v[44:47], v[196:199], v[112:115]
    v_exp_f32 v19, v103
    v_cvt_pk_bf16_f32 v166, v16, v17
    v_mul_f32 v246, v246, v52
    v_mul_f32 v247, v247, v52
    v_cvt_pk_bf16_f32 v167, v18, v19
    v_mfma_f32_16x16x32_bf16 v[116:119], v[40:43], v[216:219], v[116:119]
    ds_read_b128 v[36:39], v3 offset:18432
    v_cvt_pk_bf16_f32 v242, v242, v243
    v_mfma_f32_16x16x32_bf16 v[116:119], v[44:47], v[220:223], v[116:119]
    s_waitcnt lgkmcnt(2)
    s_nop 1
    v_cvt_pk_bf16_f32 v243, v244, v245
    v_cvt_pk_bf16_f32 v244, v246, v247
    v_accvgpr_read_b32 v248, a49
    v_mfma_f32_16x16x32_bf16 v[184:187], v[24:27], a[240:243], v[136:139]
    ds_read_b128 v[40:43], v2 offset:12416
    v_accvgpr_read_b32 v249, a53
    v_mfma_f32_16x16x32_bf16 v[184:187], v[28:31], a[244:247], v[184:187]
    buffer_store_dwordx3 v[242:244], v56, s[12:15], s40 offen offset:0 sc0 sc1
    v_accvgpr_read_b32 v250, a57
    v_mfma_f32_16x16x32_bf16 v[188:191], v[24:27], v[200:203], v[140:143]
    ds_read_b128 v[44:47], v3 offset:12416
    v_accvgpr_read_b32 v251, a61
    v_mfma_f32_16x16x32_bf16 v[188:191], v[28:31], v[204:207], v[188:191]
    s_waitcnt lgkmcnt(2)
    v_mfma_f32_16x16x32_bf16 v[132:135], v[164:167], v[20:23], v[132:135]
    v_exp_f32 v16, v168
    v_accvgpr_read_b32 v252, a65
    v_accvgpr_read_b32 v253, a69
    v_mfma_f32_16x16x32_bf16 v[120:123], v[32:35], a[240:243], v[136:139]
    ds_read_b128 v[24:27], v2 offset:18560
    v_mul_f32 v248, v248, v53
    v_mfma_f32_16x16x32_bf16 v[120:123], v[36:39], a[244:247], v[120:123]
    v_exp_f32 v17, v169
    v_exp_f32 v18, v170
    v_mul_f32 v249, v249, v53
    v_mfma_f32_16x16x32_bf16 v[124:127], v[32:35], v[200:203], v[140:143]
    ds_read_b128 v[28:31], v3 offset:18560
    v_mul_f32 v250, v250, v53
    v_mfma_f32_16x16x32_bf16 v[124:127], v[36:39], v[204:207], v[124:127]
    s_waitcnt lgkmcnt(2)
    v_exp_f32 v19, v171
    v_mul_f32 v251, v251, v53
    v_mul_f32 v252, v252, v53
    v_mul_f32 v253, v253, v53
    v_mfma_f32_16x16x32_bf16 v[184:187], v[40:43], a[248:251], v[184:187]
    ds_read_b128 v[32:35], v2 offset:12544
    v_cvt_pk_bf16_f32 v168, v16, v17
    v_mfma_f32_16x16x32_bf16 v[184:187], v[44:47], a[252:255], v[184:187]
    v_cvt_pk_bf16_f32 v248, v248, v249
    v_exp_f32 v16, v104
    v_cvt_pk_bf16_f32 v249, v250, v251
    v_cvt_pk_bf16_f32 v250, v252, v253
    v_accvgpr_read_b32 v224, a50
    v_mfma_f32_16x16x32_bf16 v[188:191], v[40:43], v[208:211], v[188:191]
    ds_read_b128 v[36:39], v3 offset:12544
    v_accvgpr_read_b32 v225, a54
    v_mfma_f32_16x16x32_bf16 v[188:191], v[44:47], v[212:215], v[188:191]
    s_waitcnt lgkmcnt(2)
    buffer_store_dwordx3 v[248:250], v56, s[12:15], s40 offen offset:384 sc0 sc1
    v_accvgpr_read_b32 v226, a58
    v_mfma_f32_16x16x32_bf16 v[120:123], v[24:27], a[248:251], v[120:123]
    ds_read_b128 v[40:43], v2 offset:18688
    v_accvgpr_read_b32 v227, a62
    v_mfma_f32_16x16x32_bf16 v[120:123], v[28:31], a[252:255], v[120:123]
    v_exp_f32 v17, v105
    v_cvt_pk_bf16_f32 v169, v18, v19
    v_accvgpr_read_b32 v228, a66
    v_accvgpr_read_b32 v229, a70
    v_mfma_f32_16x16x32_bf16 v[124:127], v[24:27], v[208:211], v[124:127]
    ds_read_b128 v[44:47], v3 offset:18688
    v_mul_f32 v224, v224, v54
    v_mfma_f32_16x16x32_bf16 v[124:127], v[28:31], v[212:215], v[124:127]
    s_waitcnt lgkmcnt(2)
    v_add_u32 v60, 49152, v1
    v_mov_b32 v59, v1
    v_subrev_u32 v1, 49152, v1
    v_exp_f32 v18, v106
    v_mfma_f32_16x16x32_bf16 v[184:187], v[32:35], v[192:195], v[184:187]
    ds_read_b128 v[24:27], v60 offset:0
    v_mul_f32 v225, v225, v54
    v_mfma_f32_16x16x32_bf16 v[184:187], v[36:39], v[196:199], v[184:187]
    v_exp_f32 v19, v107
    v_mul_f32 v226, v226, v54
    v_cvt_pk_bf16_f32 v170, v16, v17
    v_mul_f32 v227, v227, v54
    v_mul_f32 v228, v228, v54
    v_mfma_f32_16x16x32_bf16 v[188:191], v[32:35], v[216:219], v[188:191]
    ds_read_b128 v[28:31], v60 offset:12288
    v_mul_f32 v229, v229, v54
    v_mfma_f32_16x16x32_bf16 v[188:191], v[36:39], v[220:223], v[188:191]
    s_waitcnt lgkmcnt(2)
    v_exp_f32 v16, v172
    v_cvt_pk_bf16_f32 v224, v224, v225
    v_cvt_pk_bf16_f32 v225, v226, v227
    v_cvt_pk_bf16_f32 v226, v228, v229
    v_mfma_f32_16x16x32_bf16 v[120:123], v[40:43], v[192:195], v[120:123]
    ds_read_b128 v[32:35], v60 offset:1024
    v_accvgpr_read_b32 v230, a51
    v_mfma_f32_16x16x32_bf16 v[120:123], v[44:47], v[196:199], v[120:123]
    buffer_store_dwordx3 v[224:226], v56, s[12:15], s40 offen offset:768 sc0 sc1
    v_accvgpr_read_b32 v231, a55
    v_mfma_f32_16x16x32_bf16 v[124:127], v[40:43], v[216:219], v[124:127]
    ds_read_b128 v[36:39], v60 offset:13312
    v_accvgpr_read_b32 v232, a59
    v_mfma_f32_16x16x32_bf16 v[124:127], v[44:47], v[220:223], v[124:127]
    s_waitcnt lgkmcnt(2)
    v_exp_f32 v17, v173
    v_cvt_pk_bf16_f32 v171, v18, v19
    v_exp_f32 v18, v174
    v_accvgpr_read_b32 v233, a63
    v_mfma_f32_16x16x32_bf16 a[96:99], v[80:83], v[24:27], a[96:99]
    ds_read_b128 v[40:43], v60 offset:2048
    v_accvgpr_read_b32 v234, a67
    v_mfma_f32_16x16x32_bf16 a[96:99], v[88:91], v[28:31], a[96:99]
    v_exp_f32 v19, v175
    v_accvgpr_read_b32 v235, a71
    v_mul_f32 v230, v230, v55
    v_mul_f32 v231, v231, v55
    v_mfma_f32_16x16x32_bf16 a[144:147], v[84:87], v[24:27], a[144:147]
    ds_read_b128 v[44:47], v60 offset:14336
    v_mul_f32 v232, v232, v55
    v_mfma_f32_16x16x32_bf16 a[144:147], v[92:95], v[28:31], a[144:147]
    s_waitcnt lgkmcnt(2)
    v_mfma_f32_16x16x32_bf16 v[128:131], v[168:171], v[20:23], v[128:131]
    v_mul_f32 v233, v233, v55
    v_mul_f32 v234, v234, v55
    v_mul_f32 v235, v235, v55
    v_mfma_f32_16x16x32_bf16 a[100:103], v[80:83], v[32:35], a[100:103]
    ds_read_b128 v[24:27], v60 offset:3072
    v_cvt_pk_bf16_f32 v172, v16, v17
    v_mfma_f32_16x16x32_bf16 a[100:103], v[88:91], v[36:39], a[100:103]
    v_exp_f32 v16, v108
    v_cvt_pk_bf16_f32 v230, v230, v231
    v_cvt_pk_bf16_f32 v231, v232, v233
    v_cvt_pk_bf16_f32 v232, v234, v235
    v_accvgpr_read_b32 v236, a72
    v_mfma_f32_16x16x32_bf16 a[148:151], v[84:87], v[32:35], a[148:151]
    ds_read_b128 v[28:31], v60 offset:15360
    v_accvgpr_read_b32 v237, a76
    v_mfma_f32_16x16x32_bf16 a[148:151], v[92:95], v[36:39], a[148:151]
    s_waitcnt lgkmcnt(2)
    buffer_store_dwordx3 v[230:232], v56, s[12:15], s40 offen offset:1152 sc0 sc1
    v_accvgpr_read_b32 v238, a80
    v_mfma_f32_16x16x32_bf16 a[104:107], v[80:83], v[40:43], a[104:107]
    ds_read_b128 v[32:35], v60 offset:4096
    v_accvgpr_read_b32 v239, a84
    v_mfma_f32_16x16x32_bf16 a[104:107], v[88:91], v[44:47], a[104:107]
    v_exp_f32 v17, v109
    v_cvt_pk_bf16_f32 v173, v18, v19
    v_accvgpr_read_b32 v240, a88
    v_accvgpr_read_b32 v241, a92
    v_mfma_f32_16x16x32_bf16 a[152:155], v[84:87], v[40:43], a[152:155]
    ds_read_b128 v[36:39], v60 offset:16384
    v_mul_f32 v236, v236, v52
    v_mfma_f32_16x16x32_bf16 a[152:155], v[92:95], v[44:47], a[152:155]
    s_waitcnt lgkmcnt(2)
    v_exp_f32 v18, v110
    v_mul_f32 v237, v237, v52
    v_mul_f32 v238, v238, v52
    v_mul_f32 v239, v239, v52
    v_mul_f32 v240, v240, v52
    v_mfma_f32_16x16x32_bf16 a[108:111], v[80:83], v[24:27], a[108:111]
    ds_read_b128 v[40:43], v60 offset:5120
    v_mul_f32 v241, v241, v52
    v_mfma_f32_16x16x32_bf16 a[108:111], v[88:91], v[28:31], a[108:111]
    v_exp_f32 v19, v111
    v_cvt_pk_bf16_f32 v236, v236, v237
    v_cvt_pk_bf16_f32 v237, v238, v239
    v_cvt_pk_bf16_f32 v238, v240, v241
    v_mfma_f32_16x16x32_bf16 a[156:159], v[84:87], v[24:27], a[156:159]
    ds_read_b128 v[44:47], v60 offset:17408
    v_cvt_pk_bf16_f32 v174, v16, v17
    v_mfma_f32_16x16x32_bf16 a[156:159], v[92:95], v[28:31], a[156:159]
    s_waitcnt lgkmcnt(2)
    buffer_store_dwordx3 v[236:238], v56, s[12:15], s40 offen offset:192 sc0 sc1
    v_accvgpr_read_b32 v242, a73
    v_mfma_f32_16x16x32_bf16 a[112:115], v[80:83], v[32:35], a[112:115]
    ds_read_b128 v[24:27], v1 offset:0
    v_cvt_pk_bf16_f32 v175, v18, v19
    v_mfma_f32_16x16x32_bf16 a[112:115], v[88:91], v[36:39], a[112:115]
    s_nop 1
    v_accvgpr_read_b32 v243, a77
    v_accvgpr_read_b32 v244, a81
    v_accvgpr_read_b32 v245, a85
    v_accvgpr_read_b32 v246, a89
    v_mfma_f32_16x16x32_bf16 a[160:163], v[84:87], v[32:35], a[160:163]
    ds_read_b128 v[28:31], v1 offset:12288
    v_accvgpr_read_b32 v247, a93
    v_mfma_f32_16x16x32_bf16 a[160:163], v[92:95], v[36:39], a[160:163]
    s_waitcnt lgkmcnt(2)
    v_mul_f32 v242, v242, v53
    v_mfma_f32_16x16x32_bf16 v[132:135], v[172:175], v[20:23], v[132:135]
    v_exp_f32 v16, v176
    v_mul_f32 v243, v243, v53
    v_mfma_f32_16x16x32_bf16 a[116:119], v[80:83], v[40:43], a[116:119]
    ds_read_b128 v[32:35], v1 offset:1024
    v_mul_f32 v244, v244, v53
    v_mfma_f32_16x16x32_bf16 a[116:119], v[88:91], v[44:47], a[116:119]
    v_exp_f32 v17, v177
    v_exp_f32 v18, v178
    v_mul_f32 v245, v245, v53
    v_mfma_f32_16x16x32_bf16 a[164:167], v[84:87], v[40:43], a[164:167]
    ds_read_b128 v[36:39], v1 offset:13312
    v_mul_f32 v246, v246, v53
    v_mfma_f32_16x16x32_bf16 a[164:167], v[92:95], v[44:47], a[164:167]
    s_waitcnt lgkmcnt(2)
    v_exp_f32 v19, v179
    v_cvt_pk_bf16_f32 v176, v16, v17
    v_exp_f32 v16, v112
    v_mfma_f32_16x16x32_bf16 a[96:99], v[160:163], v[24:27], a[96:99]
    ds_read_b128 v[40:43], v1 offset:2048
    v_mul_f32 v247, v247, v53
    v_mfma_f32_16x16x32_bf16 a[96:99], v[168:171], v[28:31], a[96:99]
    v_exp_f32 v17, v113
    v_cvt_pk_bf16_f32 v177, v18, v19
    v_exp_f32 v18, v114
    v_cvt_pk_bf16_f32 v242, v242, v243
    v_mfma_f32_16x16x32_bf16 a[144:147], v[164:167], v[24:27], a[144:147]
    ds_read_b128 v[44:47], v1 offset:14336
    v_cvt_pk_bf16_f32 v243, v244, v245
    v_mfma_f32_16x16x32_bf16 a[144:147], v[172:175], v[28:31], a[144:147]
    s_waitcnt lgkmcnt(2)
    v_exp_f32 v19, v115
    v_cvt_pk_bf16_f32 v178, v16, v17
    v_exp_f32 v16, v180
    v_mfma_f32_16x16x32_bf16 a[100:103], v[160:163], v[32:35], a[100:103]
    ds_read_b128 v[24:27], v1 offset:3072
    v_cvt_pk_bf16_f32 v244, v246, v247
    v_mfma_f32_16x16x32_bf16 a[100:103], v[168:171], v[36:39], a[100:103]
    buffer_store_dwordx3 v[242:244], v56, s[12:15], s40 offen offset:576 sc0 sc1
    v_accvgpr_read_b32 v248, a74
    v_mfma_f32_16x16x32_bf16 a[148:151], v[164:167], v[32:35], a[148:151]
    ds_read_b128 v[28:31], v1 offset:15360
    v_accvgpr_read_b32 v249, a78
    v_mfma_f32_16x16x32_bf16 a[148:151], v[172:175], v[36:39], a[148:151]
    s_waitcnt lgkmcnt(2)
    v_exp_f32 v17, v181
    v_cvt_pk_bf16_f32 v179, v18, v19
    v_exp_f32 v18, v182
    v_accvgpr_read_b32 v250, a82
    v_mfma_f32_16x16x32_bf16 a[104:107], v[160:163], v[40:43], a[104:107]
L_pg13:
    s_cbranch_execz L_iwret
    ds_read_b128 v[32:35], v1 offset:4096
    v_accvgpr_read_b32 v251, a86
    v_mfma_f32_16x16x32_bf16 a[104:107], v[168:171], v[44:47], a[104:107]
    v_exp_f32 v19, v183
    v_mfma_f32_16x16x32_bf16 v[128:131], v[176:179], v[20:23], v[128:131]
    v_cvt_pk_bf16_f32 v180, v16, v17
    v_mfma_f32_16x16x32_bf16 a[152:155], v[164:167], v[40:43], a[152:155]
    ds_read_b128 v[36:39], v1 offset:16384
    v_accvgpr_read_b32 v252, a90
    v_mfma_f32_16x16x32_bf16 a[152:155], v[172:175], v[44:47], a[152:155]
    s_waitcnt lgkmcnt(2)
    v_exp_f32 v16, v116
    v_exp_f32 v17, v117
    v_cvt_pk_bf16_f32 v181, v18, v19
    v_mfma_f32_16x16x32_bf16 a[108:111], v[160:163], v[24:27], a[108:111]
    ds_read_b128 v[40:43], v1 offset:5120
    v_accvgpr_read_b32 v253, a94
    v_mfma_f32_16x16x32_bf16 a[108:111], v[168:171], v[28:31], a[108:111]
    v_exp_f32 v18, v118
    v_exp_f32 v19, v119
    v_cvt_pk_bf16_f32 v182, v16, v17
    v_cvt_pk_bf16_f32 v183, v18, v19
    v_mfma_f32_16x16x32_bf16 a[156:159], v[164:167], v[24:27], a[156:159]
    s_nop 1
    ds_read_b128 v[44:47], v1 offset:17408
    v_mfma_f32_16x16x32_bf16 a[156:159], v[172:175], v[28:31], a[156:159]
    s_waitcnt lgkmcnt(2)
    v_mfma_f32_16x16x32_bf16 v[132:135], v[180:183], v[20:23], v[132:135]
    v_exp_f32 v16, v184
    v_mul_f32 v248, v248, v54
    v_mfma_f32_16x16x32_bf16 a[112:115], v[160:163], v[32:35], a[112:115]
    ds_read_b128 v[24:27], v59 offset:0
    v_mul_f32 v249, v249, v54
    v_mfma_f32_16x16x32_bf16 a[112:115], v[168:171], v[36:39], a[112:115]
    v_exp_f32 v17, v185
    v_exp_f32 v18, v186
    v_mul_f32 v250, v250, v54
    v_mfma_f32_16x16x32_bf16 a[160:163], v[164:167], v[32:35], a[160:163]
    ds_read_b128 v[28:31], v59 offset:12288
    v_mul_f32 v251, v251, v54
    v_mfma_f32_16x16x32_bf16 a[160:163], v[172:175], v[36:39], a[160:163]
    s_waitcnt lgkmcnt(2)
    v_exp_f32 v19, v187
    v_cvt_pk_bf16_f32 v184, v16, v17
    v_exp_f32 v16, v120
    v_exp_f32 v17, v121
    v_cvt_pk_bf16_f32 v185, v18, v19
    v_exp_f32 v18, v122
    v_exp_f32 v19, v123
    v_cvt_pk_bf16_f32 v186, v16, v17
    v_exp_f32 v16, v188
    v_exp_f32 v17, v189
    v_cvt_pk_bf16_f32 v187, v18, v19
    v_exp_f32 v18, v190
    v_exp_f32 v19, v191
    v_mfma_f32_16x16x32_bf16 v[128:131], v[184:187], v[20:23], v[128:131]
    v_cvt_pk_bf16_f32 v188, v16, v17
    v_exp_f32 v16, v124
    v_exp_f32 v17, v125
    v_cvt_pk_bf16_f32 v189, v18, v19
    v_exp_f32 v18, v126
    v_exp_f32 v19, v127
    v_cvt_pk_bf16_f32 v190, v16, v17
    v_cvt_pk_bf16_f32 v191, v18, v19
    s_nop 1
    v_mfma_f32_16x16x32_bf16 v[132:135], v[188:191], v[20:23], v[132:135]
    v_mfma_f32_16x16x32_bf16 a[116:119], v[160:163], v[40:43], a[116:119]
    ds_read_b128 v[32:35], v59 offset:1024
    v_mul_f32 v252, v252, v54
    v_mfma_f32_16x16x32_bf16 a[116:119], v[168:171], v[44:47], a[116:119]
    v_mul_f32 v253, v253, v54
    v_cvt_pk_bf16_f32 v248, v248, v249
    v_cvt_pk_bf16_f32 v249, v250, v251
    v_cvt_pk_bf16_f32 v250, v252, v253
    v_accvgpr_read_b32 v224, a75
    v_mfma_f32_16x16x32_bf16 a[164:167], v[164:167], v[40:43], a[164:167]
    ds_read_b128 v[36:39], v59 offset:13312
    v_accvgpr_read_b32 v225, a79
    v_mfma_f32_16x16x32_bf16 a[164:167], v[172:175], v[44:47], a[164:167]
    s_waitcnt lgkmcnt(2)
    buffer_store_dwordx3 v[248:250], v56, s[12:15], s40 offen offset:960 sc0 sc1
    v_accvgpr_read_b32 v226, a83
    v_accvgpr_read_b32 v227, a87
    v_mfma_f32_16x16x4_f32 v[128:131], v7, v57, v[128:131]
    v_mfma_f32_16x16x32_bf16 a[96:99], v[176:179], v[24:27], a[96:99]
    ds_read_b128 v[40:43], v59 offset:2048
    v_accvgpr_read_b32 v228, a91
    v_mfma_f32_16x16x32_bf16 a[96:99], v[184:187], v[28:31], a[96:99]
    v_accvgpr_read_b32 v229, a95
    v_mul_f32 v224, v224, v55
    v_mul_f32 v225, v225, v55
    v_mul_f32 v226, v226, v55
    v_mul_f32 v227, v227, v55
    v_mul_f32 v228, v228, v55
    v_mfma_f32_16x16x4_f32 v[132:135], v8, v57, v[132:135]
    v_mfma_f32_16x16x32_bf16 a[144:147], v[180:183], v[24:27], a[144:147]
    ds_read_b128 v[44:47], v59 offset:14336
    v_mul_f32 v229, v229, v55
    v_mfma_f32_16x16x32_bf16 a[144:147], v[188:191], v[28:31], a[144:147]
    s_waitcnt lgkmcnt(2)
    v_cvt_pk_bf16_f32 v224, v224, v225
    v_cvt_pk_bf16_f32 v225, v226, v227
    v_cvt_pk_bf16_f32 v226, v228, v229
    v_mfma_f32_16x16x32_bf16 a[100:103], v[176:179], v[32:35], a[100:103]
    ds_read_b128 v[24:27], v59 offset:3072
    v_mfma_f32_16x16x32_bf16 a[100:103], v[184:187], v[36:39], a[100:103]
    buffer_store_dwordx3 v[224:226], v56, s[12:15], s40 offen offset:1344 sc0 sc1
    v_mfma_f32_16x16x32_bf16 a[148:151], v[180:183], v[32:35], a[148:151]
    ds_read_b128 v[28:31], v59 offset:15360
    v_max3_f32 v18, v5, v6, v128
    v_mfma_f32_16x16x32_bf16 a[148:151], v[188:191], v[36:39], a[148:151]
    s_waitcnt lgkmcnt(2)
    v_max3_f32 v18, v18, v129, v130
    v_max3_f32 v18, v18, v131, v132
    v_max3_f32 v18, v18, v133, v134
    v_max_f32 v18, v18, v135
    s_mov_b32 s29, 0x5f800000
    v_cmp_lt_f32 s[48:49], s29, v18
    v_rcp_f32 v128, v128
    v_mfma_f32_16x16x32_bf16 a[104:107], v[176:179], v[40:43], a[104:107]
    ds_read_b128 v[32:35], v59 offset:4096
    v_mfma_f32_16x16x32_bf16 a[104:107], v[184:187], v[44:47], a[104:107]
    v_rcp_f32 v129, v129
    v_rcp_f32 v130, v130
    v_rcp_f32 v131, v131
    v_mfma_f32_16x16x32_bf16 a[152:155], v[180:183], v[40:43], a[152:155]
    ds_read_b128 v[36:39], v59 offset:16384
    v_mfma_f32_16x16x32_bf16 a[152:155], v[188:191], v[44:47], a[152:155]
    s_waitcnt lgkmcnt(2)
    v_rcp_f32 v132, v132
    v_rcp_f32 v133, v133
    v_mfma_f32_16x16x32_bf16 a[108:111], v[176:179], v[24:27], a[108:111]
    ds_read_b128 v[40:43], v59 offset:5120
    v_mfma_f32_16x16x32_bf16 a[108:111], v[184:187], v[28:31], a[108:111]
    v_rcp_f32 v134, v134
    v_rcp_f32 v135, v135
    v_mfma_f32_16x16x32_bf16 a[156:159], v[180:183], v[24:27], a[156:159]
    ds_read_b128 v[44:47], v59 offset:17408
    v_mfma_f32_16x16x32_bf16 a[156:159], v[188:191], v[28:31], a[156:159]
    s_waitcnt lgkmcnt(2)
    v_mfma_f32_16x16x32_bf16 a[112:115], v[176:179], v[32:35], a[112:115]
    ds_read_b128 v[24:27], v60 offset:6144
    v_mfma_f32_16x16x32_bf16 a[112:115], v[184:187], v[36:39], a[112:115]
    v_mfma_f32_16x16x32_bf16 a[160:163], v[180:183], v[32:35], a[160:163]
    ds_read_b128 v[28:31], v60 offset:18432
    v_mfma_f32_16x16x32_bf16 a[160:163], v[188:191], v[36:39], a[160:163]
    s_waitcnt lgkmcnt(2)
    s_cmp_lg_u64 s[48:49], 0
    s_cbranch_scc1 L_slow
    v_mfma_f32_16x16x32_bf16 a[116:119], v[176:179], v[40:43], a[116:119]
    ds_read_b128 v[32:35], v60 offset:7168
    v_mfma_f32_16x16x32_bf16 a[116:119], v[184:187], v[44:47], a[116:119]
    v_mfma_f32_16x16x32_bf16 a[164:167], v[180:183], v[40:43], a[164:167]
    ds_read_b128 v[36:39], v60 offset:19456
    v_mfma_f32_16x16x32_bf16 a[164:167], v[188:191], v[44:47], a[164:167]
    s_waitcnt lgkmcnt(2)
    v_mfma_f32_16x16x32_bf16 a[120:123], v[80:83], v[24:27], a[120:123]
    ds_read_b128 v[40:43], v60 offset:8192
    v_mfma_f32_16x16x32_bf16 a[120:123], v[88:91], v[28:31], a[120:123]
    v_mfma_f32_16x16x32_bf16 a[168:171], v[84:87], v[24:27], a[168:171]
    ds_read_b128 v[44:47], v60 offset:20480
    v_mfma_f32_16x16x32_bf16 a[168:171], v[92:95], v[28:31], a[168:171]
    s_waitcnt lgkmcnt(2)
    v_mfma_f32_16x16x32_bf16 a[124:127], v[80:83], v[32:35], a[124:127]
    ds_read_b128 v[24:27], v1 offset:6144
    v_accvgpr_read_b32 v230, a96
    v_mfma_f32_16x16x32_bf16 a[124:127], v[88:91], v[36:39], a[124:127]
    v_accvgpr_read_b32 v231, a100
    v_accvgpr_read_b32 v232, a104
    v_accvgpr_read_b32 v233, a108
    v_accvgpr_read_b32 v234, a112
    v_accvgpr_read_b32 v235, a116
    v_mul_f32 v230, v230, v128
    v_mul_f32 v231, v231, v128
    v_mul_f32 v232, v232, v128
    v_mul_f32 v233, v233, v128
    v_mul_f32 v234, v234, v128
    v_mul_f32 v235, v235, v128
    v_cvt_pk_bf16_f32 v230, v230, v231
    v_cvt_pk_bf16_f32 v231, v232, v233
    v_cvt_pk_bf16_f32 v232, v234, v235
    v_accvgpr_read_b32 v236, a97
    v_accvgpr_read_b32 v237, a101
    v_accvgpr_read_b32 v238, a105
    v_accvgpr_read_b32 v239, a109
    v_accvgpr_read_b32 v240, a113
    v_accvgpr_read_b32 v241, a117
    v_mul_f32 v236, v236, v129
    v_mul_f32 v237, v237, v129
    v_mul_f32 v238, v238, v129
    v_mul_f32 v239, v239, v129
    v_mul_f32 v240, v240, v129
    v_mul_f32 v241, v241, v129
    v_cvt_pk_bf16_f32 v236, v236, v237
    v_cvt_pk_bf16_f32 v237, v238, v239
    v_cvt_pk_bf16_f32 v238, v240, v241
    v_accvgpr_read_b32 v242, a98
    v_mfma_f32_16x16x32_bf16 a[172:175], v[84:87], v[32:35], a[172:175]
    ds_read_b128 v[28:31], v1 offset:18432
    v_accvgpr_read_b32 v243, a102
    v_mfma_f32_16x16x32_bf16 a[172:175], v[92:95], v[36:39], a[172:175]
    s_waitcnt lgkmcnt(2)
    buffer_store_dwordx3 v[230:232], v56, s[12:15], s41 offen offset:0 sc0 sc1
    v_accvgpr_read_b32 v244, a106
    v_mfma_f32_16x16x32_bf16 a[128:131], v[80:83], v[40:43], a[128:131]
    ds_read_b128 v[32:35], v1 offset:7168
    v_accvgpr_read_b32 v245, a110
    v_mfma_f32_16x16x32_bf16 a[128:131], v[88:91], v[44:47], a[128:131]
    buffer_store_dwordx3 v[236:238], v56, s[12:15], s41 offen offset:384 sc0 sc1
    v_accvgpr_read_b32 v246, a114
    v_mfma_f32_16x16x32_bf16 a[176:179], v[84:87], v[40:43], a[176:179]
    ds_read_b128 v[36:39], v1 offset:19456
    v_accvgpr_read_b32 v247, a118
    v_mfma_f32_16x16x32_bf16 a[176:179], v[92:95], v[44:47], a[176:179]
    s_waitcnt lgkmcnt(2)
    v_mul_f32 v242, v242, v130
    v_mul_f32 v243, v243, v130
    v_mul_f32 v244, v244, v130
    v_mul_f32 v245, v245, v130
    v_mul_f32 v246, v246, v130
    v_mul_f32 v247, v247, v130
    v_mfma_f32_16x16x32_bf16 a[120:123], v[160:163], v[24:27], a[120:123]
    ds_read_b128 v[40:43], v1 offset:8192
    v_cvt_pk_bf16_f32 v242, v242, v243
    v_mfma_f32_16x16x32_bf16 a[120:123], v[168:171], v[28:31], a[120:123]
    v_cvt_pk_bf16_f32 v243, v244, v245
    v_cvt_pk_bf16_f32 v244, v246, v247
    v_accvgpr_read_b32 v248, a99
    v_accvgpr_read_b32 v249, a103
    v_accvgpr_read_b32 v250, a107
    v_mfma_f32_16x16x32_bf16 a[168:171], v[164:167], v[24:27], a[168:171]
    ds_read_b128 v[44:47], v1 offset:20480
    v_accvgpr_read_b32 v251, a111
    v_mfma_f32_16x16x32_bf16 a[168:171], v[172:175], v[28:31], a[168:171]
    s_waitcnt lgkmcnt(2)
    buffer_store_dwordx3 v[242:244], v56, s[12:15], s41 offen offset:768 sc0 sc1
    v_accvgpr_read_b32 v252, a115
    v_mfma_f32_16x16x32_bf16 a[124:127], v[160:163], v[32:35], a[124:127]
    ds_read_b128 v[24:27], v59 offset:6144
    v_accvgpr_read_b32 v253, a119
    v_mfma_f32_16x16x32_bf16 a[124:127], v[168:171], v[36:39], a[124:127]
    v_mul_f32 v248, v248, v131
    v_mul_f32 v249, v249, v131
    v_mul_f32 v250, v250, v131
    v_mul_f32 v251, v251, v131
    v_mul_f32 v252, v252, v131
    v_mul_f32 v253, v253, v131
    v_mfma_f32_16x16x32_bf16 a[172:175], v[164:167], v[32:35], a[172:175]
    ds_read_b128 v[28:31], v59 offset:18432
    v_cvt_pk_bf16_f32 v248, v248, v249
    v_mfma_f32_16x16x32_bf16 a[172:175], v[172:175], v[36:39], a[172:175]
    s_waitcnt lgkmcnt(2)
    v_cvt_pk_bf16_f32 v249, v250, v251
    v_cvt_pk_bf16_f32 v250, v252, v253
    v_accvgpr_read_b32 v224, a144
    v_accvgpr_read_b32 v225, a148
    v_accvgpr_read_b32 v226, a152
    v_mfma_f32_16x16x32_bf16 a[128:131], v[160:163], v[40:43], a[128:131]
    ds_read_b128 v[32:35], v59 offset:7168
    v_accvgpr_read_b32 v227, a156
    v_mfma_f32_16x16x32_bf16 a[128:131], v[168:171], v[44:47], a[128:131]
    buffer_store_dwordx3 v[248:250], v56, s[12:15], s41 offen offset:1152 sc0 sc1
    v_accvgpr_read_b32 v228, a160
    v_mfma_f32_16x16x32_bf16 a[176:179], v[164:167], v[40:43], a[176:179]
    ds_read_b128 v[36:39], v59 offset:19456
    v_accvgpr_read_b32 v229, a164
    v_mfma_f32_16x16x32_bf16 a[176:179], v[172:175], v[44:47], a[176:179]
    s_waitcnt lgkmcnt(2)
    v_mul_f32 v224, v224, v132
    v_mul_f32 v225, v225, v132
    v_mul_f32 v226, v226, v132
    v_mul_f32 v227, v227, v132
    v_mul_f32 v228, v228, v132
    v_mul_f32 v229, v229, v132
    v_mfma_f32_16x16x32_bf16 a[120:123], v[176:179], v[24:27], a[120:123]
    ds_read_b128 v[40:43], v59 offset:8192
    v_cvt_pk_bf16_f32 v224, v224, v225
    v_mfma_f32_16x16x32_bf16 a[120:123], v[184:187], v[28:31], a[120:123]
    v_cvt_pk_bf16_f32 v225, v226, v227
    v_cvt_pk_bf16_f32 v226, v228, v229
    v_accvgpr_read_b32 v230, a145
    v_accvgpr_read_b32 v231, a149
    v_accvgpr_read_b32 v232, a153
    v_mfma_f32_16x16x32_bf16 a[168:171], v[180:183], v[24:27], a[168:171]
    ds_read_b128 v[44:47], v59 offset:20480
    v_accvgpr_read_b32 v233, a157
    v_mfma_f32_16x16x32_bf16 a[168:171], v[188:191], v[28:31], a[168:171]
    s_waitcnt lgkmcnt(2)
    buffer_store_dwordx3 v[224:226], v56, s[12:15], s42 offen offset:0 sc0 sc1
    v_accvgpr_read_b32 v234, a161
    v_mfma_f32_16x16x32_bf16 a[124:127], v[176:179], v[32:35], a[124:127]
    ds_read_b128 v[24:27], v60 offset:9216
    v_accvgpr_read_b32 v235, a165
    v_mfma_f32_16x16x32_bf16 a[124:127], v[184:187], v[36:39], a[124:127]
    v_mul_f32 v230, v230, v133
    v_mul_f32 v231, v231, v133
    v_mul_f32 v232, v232, v133
    v_mul_f32 v233, v233, v133
    v_mul_f32 v234, v234, v133
    v_mul_f32 v235, v235, v133
    v_mfma_f32_16x16x32_bf16 a[172:175], v[180:183], v[32:35], a[172:175]
    ds_read_b128 v[28:31], v60 offset:21504
    v_cvt_pk_bf16_f32 v230, v230, v231
    v_mfma_f32_16x16x32_bf16 a[172:175], v[188:191], v[36:39], a[172:175]
    s_waitcnt lgkmcnt(2)
    v_cvt_pk_bf16_f32 v231, v232, v233
    v_cvt_pk_bf16_f32 v232, v234, v235
    v_accvgpr_read_b32 v236, a146
    v_accvgpr_read_b32 v237, a150
    v_accvgpr_read_b32 v238, a154
    v_mfma_f32_16x16x32_bf16 a[128:131], v[176:179], v[40:43], a[128:131]
    ds_read_b128 v[32:35], v60 offset:10240
    v_accvgpr_read_b32 v239, a158
    v_mfma_f32_16x16x32_bf16 a[128:131], v[184:187], v[44:47], a[128:131]
    buffer_store_dwordx3 v[230:232], v56, s[12:15], s42 offen offset:384 sc0 sc1
    v_accvgpr_read_b32 v240, a162
    v_mfma_f32_16x16x32_bf16 a[176:179], v[180:183], v[40:43], a[176:179]
    ds_read_b128 v[36:39], v60 offset:22528
    v_accvgpr_read_b32 v241, a166
    v_mfma_f32_16x16x32_bf16 a[176:179], v[188:191], v[44:47], a[176:179]
    s_waitcnt lgkmcnt(2)
    v_mul_f32 v236, v236, v134
    v_mul_f32 v237, v237, v134
    v_mul_f32 v238, v238, v134
    v_mul_f32 v239, v239, v134
    v_mul_f32 v240, v240, v134
    v_mfma_f32_16x16x32_bf16 a[132:135], v[80:83], v[24:27], a[132:135]
    ds_read_b128 v[40:43], v60 offset:11264
    v_mul_f32 v241, v241, v134
    v_mfma_f32_16x16x32_bf16 a[132:135], v[88:91], v[28:31], a[132:135]
    v_cvt_pk_bf16_f32 v236, v236, v237
    v_cvt_pk_bf16_f32 v237, v238, v239
    v_cvt_pk_bf16_f32 v238, v240, v241
    v_accvgpr_read_b32 v242, a147
    v_accvgpr_read_b32 v243, a151
    v_accvgpr_read_b32 v244, a155
    v_mfma_f32_16x16x32_bf16 a[180:183], v[84:87], v[24:27], a[180:183]
    ds_read_b128 v[44:47], v60 offset:23552
    v_accvgpr_read_b32 v245, a159
    v_mfma_f32_16x16x32_bf16 a[180:183], v[92:95], v[28:31], a[180:183]
    s_waitcnt lgkmcnt(2)
    buffer_store_dwordx3 v[236:238], v56, s[12:15], s42 offen offset:768 sc0 sc1
    v_accvgpr_read_b32 v246, a163
    v_mfma_f32_16x16x32_bf16 a[136:139], v[80:83], v[32:35], a[136:139]
    ds_read_b128 v[24:27], v1 offset:9216
    v_accvgpr_read_b32 v96, a120
    v_mfma_f32_16x16x32_bf16 a[136:139], v[88:91], v[36:39], a[136:139]
    v_accvgpr_read_b32 v97, a124
    v_accvgpr_read_b32 v98, a128
    v_mul_f32 v96, v96, v128
    v_mul_f32 v97, v97, v128
    v_mul_f32 v98, v98, v128
    v_mfma_f32_16x16x32_bf16 a[184:187], v[84:87], v[32:35], a[184:187]
    ds_read_b128 v[28:31], v1 offset:21504
    v_accvgpr_read_b32 v102, a121
    v_mfma_f32_16x16x32_bf16 a[184:187], v[92:95], v[36:39], a[184:187]
    s_waitcnt lgkmcnt(2)
    v_accvgpr_read_b32 v103, a125
    v_accvgpr_read_b32 v104, a129
    v_mul_f32 v102, v102, v129
    v_mul_f32 v103, v103, v129
    v_mul_f32 v104, v104, v129
    v_accvgpr_read_b32 v108, a122
    v_mfma_f32_16x16x32_bf16 a[140:143], v[80:83], v[40:43], a[140:143]
    ds_read_b128 v[32:35], v1 offset:10240
    v_accvgpr_read_b32 v109, a126
    v_mfma_f32_16x16x32_bf16 a[140:143], v[88:91], v[44:47], a[140:143]
    v_accvgpr_read_b32 v110, a130
    v_mul_f32 v108, v108, v130
    v_mul_f32 v109, v109, v130
    v_mul_f32 v110, v110, v130
    v_accvgpr_read_b32 v114, a123
    v_mfma_f32_16x16x32_bf16 a[188:191], v[84:87], v[40:43], a[188:191]
    ds_read_b128 v[36:39], v1 offset:22528
    v_accvgpr_read_b32 v115, a127
    v_mfma_f32_16x16x32_bf16 a[188:191], v[92:95], v[44:47], a[188:191]
    s_waitcnt lgkmcnt(2)
    v_accvgpr_read_b32 v116, a131
    v_mul_f32 v114, v114, v131
    v_mul_f32 v115, v115, v131
    v_mul_f32 v116, v116, v131
    v_accvgpr_read_b32 v120, a168
    v_mfma_f32_16x16x32_bf16 a[132:135], v[160:163], v[24:27], a[132:135]
    ds_read_b128 v[40:43], v1 offset:11264
    v_accvgpr_read_b32 v121, a172
    v_mfma_f32_16x16x32_bf16 a[132:135], v[168:171], v[28:31], a[132:135]
    v_accvgpr_read_b32 v122, a176
    v_mul_f32 v120, v120, v132
    v_mul_f32 v121, v121, v132
    v_mul_f32 v122, v122, v132
    v_accvgpr_read_b32 v64, a169
    v_accvgpr_read_b32 v65, a173
    v_mfma_f32_16x16x32_bf16 a[180:183], v[164:167], v[24:27], a[180:183]
    ds_read_b128 v[44:47], v1 offset:23552
    v_accvgpr_read_b32 v66, a177
    v_mfma_f32_16x16x32_bf16 a[180:183], v[172:175], v[28:31], a[180:183]
    s_waitcnt lgkmcnt(2)
    v_mul_f32 v64, v64, v133
    v_mul_f32 v65, v65, v133
    v_mul_f32 v66, v66, v133
    v_accvgpr_read_b32 v70, a170
    v_accvgpr_read_b32 v71, a174
    v_mfma_f32_16x16x32_bf16 a[136:139], v[160:163], v[32:35], a[136:139]
    ds_read_b128 v[24:27], v59 offset:9216
    v_accvgpr_read_b32 v247, a167
    v_mfma_f32_16x16x32_bf16 a[136:139], v[168:171], v[36:39], a[136:139]
    v_accvgpr_read_b32 v72, a178
    v_mul_f32 v242, v242, v135
    v_mul_f32 v70, v70, v134
    v_mul_f32 v243, v243, v135
    v_mul_f32 v71, v71, v134
    v_mfma_f32_16x16x32_bf16 a[184:187], v[164:167], v[32:35], a[184:187]
    ds_read_b128 v[28:31], v59 offset:21504
    v_mul_f32 v244, v244, v135
    v_mfma_f32_16x16x32_bf16 a[184:187], v[172:175], v[36:39], a[184:187]
    s_waitcnt lgkmcnt(2)
    v_mul_f32 v72, v72, v134
    v_mul_f32 v245, v245, v135
    v_accvgpr_read_b32 v144, a171
    v_mul_f32 v246, v246, v135
    v_accvgpr_read_b32 v145, a175
    v_mul_f32 v247, v247, v135
    v_mfma_f32_16x16x32_bf16 a[140:143], v[160:163], v[40:43], a[140:143]
    ds_read_b128 v[32:35], v59 offset:10240
    v_accvgpr_read_b32 v146, a179
    v_mfma_f32_16x16x32_bf16 a[140:143], v[168:171], v[44:47], a[140:143]
    v_cvt_pk_bf16_f32 v242, v242, v243
    v_mul_f32 v144, v144, v135
    v_cvt_pk_bf16_f32 v243, v244, v245
    v_mul_f32 v145, v145, v135
    v_cvt_pk_bf16_f32 v244, v246, v247
    v_mfma_f32_16x16x32_bf16 a[188:191], v[164:167], v[40:43], a[188:191]
    ds_read_b128 v[36:39], v59 offset:22528
    v_mul_f32 v146, v146, v135
    v_mfma_f32_16x16x32_bf16 a[188:191], v[172:175], v[44:47], a[188:191]
    s_waitcnt lgkmcnt(2)
    buffer_store_dwordx3 v[242:244], v56, s[12:15], s42 offen offset:1152 sc0 sc1
    v_mfma_f32_16x16x32_bf16 a[132:135], v[176:179], v[24:27], a[132:135]
    ds_read_b128 v[40:43], v59 offset:11264
    v_mfma_f32_16x16x32_bf16 a[132:135], v[184:187], v[28:31], a[132:135]
    v_mfma_f32_16x16x32_bf16 a[180:183], v[180:183], v[24:27], a[180:183]
    ds_read_b128 v[44:47], v59 offset:23552
    v_mfma_f32_16x16x32_bf16 a[180:183], v[188:191], v[28:31], a[180:183]
    s_waitcnt lgkmcnt(2)
    v_mfma_f32_16x16x32_bf16 a[136:139], v[176:179], v[32:35], a[136:139]
    v_mfma_f32_16x16x32_bf16 a[136:139], v[184:187], v[36:39], a[136:139]
    v_mfma_f32_16x16x32_bf16 a[184:187], v[180:183], v[32:35], a[184:187]
    v_mfma_f32_16x16x32_bf16 a[184:187], v[188:191], v[36:39], a[184:187]
    s_waitcnt lgkmcnt(0)
    v_mfma_f32_16x16x32_bf16 a[140:143], v[176:179], v[40:43], a[140:143]
    v_mfma_f32_16x16x32_bf16 a[140:143], v[184:187], v[44:47], a[140:143]
    v_mfma_f32_16x16x32_bf16 a[188:191], v[180:183], v[40:43], a[188:191]
    v_mfma_f32_16x16x32_bf16 a[188:191], v[188:191], v[44:47], a[188:191]
    s_nop 7
    v_accvgpr_read_b32 v99, a132
    v_accvgpr_read_b32 v100, a136
    v_accvgpr_read_b32 v101, a140
    v_cvt_pk_bf16_f32 v96, v96, v97
    v_mul_f32 v99, v99, v128
    v_mul_f32 v100, v100, v128
    v_mul_f32 v101, v101, v128
    v_cvt_pk_bf16_f32 v97, v98, v99
    v_cvt_pk_bf16_f32 v98, v100, v101
    buffer_store_dwordx3 v[96:98], v56, s[12:15], s41 offen offset:192 sc0 sc1
    v_accvgpr_read_b32 v105, a133
    v_accvgpr_read_b32 v106, a137
    v_accvgpr_read_b32 v107, a141
    v_cvt_pk_bf16_f32 v102, v102, v103
    v_mul_f32 v105, v105, v129
    v_mul_f32 v106, v106, v129
    v_mul_f32 v107, v107, v129
    v_cvt_pk_bf16_f32 v103, v104, v105
    v_cvt_pk_bf16_f32 v104, v106, v107
    buffer_store_dwordx3 v[102:104], v56, s[12:15], s41 offen offset:576 sc0 sc1
    v_accvgpr_read_b32 v111, a134
    v_accvgpr_read_b32 v112, a138
    v_accvgpr_read_b32 v113, a142
    v_cvt_pk_bf16_f32 v108, v108, v109
    v_mul_f32 v111, v111, v130
    v_mul_f32 v112, v112, v130
    v_mul_f32 v113, v113, v130
    v_cvt_pk_bf16_f32 v109, v110, v111
    v_cvt_pk_bf16_f32 v110, v112, v113
    buffer_store_dwordx3 v[108:110], v56, s[12:15], s41 offen offset:960 sc0 sc1
    v_accvgpr_read_b32 v117, a135
    v_accvgpr_read_b32 v118, a139
    v_accvgpr_read_b32 v119, a143
    v_cvt_pk_bf16_f32 v114, v114, v115
    v_mul_f32 v117, v117, v131
    v_mul_f32 v118, v118, v131
    v_mul_f32 v119, v119, v131
    v_cvt_pk_bf16_f32 v115, v116, v117
    v_cvt_pk_bf16_f32 v116, v118, v119
    buffer_store_dwordx3 v[114:116], v56, s[12:15], s41 offen offset:1344 sc0 sc1
    v_accvgpr_read_b32 v123, a180
    v_accvgpr_read_b32 v124, a184
    v_accvgpr_read_b32 v125, a188
    v_cvt_pk_bf16_f32 v120, v120, v121
    v_mul_f32 v123, v123, v132
    v_mul_f32 v124, v124, v132
    v_mul_f32 v125, v125, v132
    v_cvt_pk_bf16_f32 v121, v122, v123
    v_cvt_pk_bf16_f32 v122, v124, v125
    buffer_store_dwordx3 v[120:122], v56, s[12:15], s42 offen offset:192 sc0 sc1
    v_accvgpr_read_b32 v67, a181
    v_accvgpr_read_b32 v68, a185
    v_accvgpr_read_b32 v69, a189
    v_cvt_pk_bf16_f32 v64, v64, v65
    v_mul_f32 v67, v67, v133
    v_mul_f32 v68, v68, v133
    v_mul_f32 v69, v69, v133
    v_cvt_pk_bf16_f32 v65, v66, v67
    v_cvt_pk_bf16_f32 v66, v68, v69
    buffer_store_dwordx3 v[64:66], v56, s[12:15], s42 offen offset:576 sc0 sc1
    v_accvgpr_read_b32 v73, a182
    v_accvgpr_read_b32 v74, a186
    v_accvgpr_read_b32 v75, a190
    v_cvt_pk_bf16_f32 v70, v70, v71
    v_mul_f32 v73, v73, v134
    v_mul_f32 v74, v74, v134
    v_mul_f32 v75, v75, v134
    v_cvt_pk_bf16_f32 v71, v72, v73
    v_cvt_pk_bf16_f32 v72, v74, v75
    buffer_store_dwordx3 v[70:72], v56, s[12:15], s42 offen offset:960 sc0 sc1
    v_accvgpr_read_b32 v147, a183
    v_accvgpr_read_b32 v148, a187
    v_accvgpr_read_b32 v149, a191
    v_cvt_pk_bf16_f32 v144, v144, v145
    v_mul_f32 v147, v147, v135
    v_mul_f32 v148, v148, v135
    v_mul_f32 v149, v149, v135
    v_cvt_pk_bf16_f32 v145, v146, v147
    v_cvt_pk_bf16_f32 v146, v148, v149
    buffer_store_dwordx3 v[144:146], v56, s[12:15], s42 offen offset:1344 sc0 sc1
L_fin:
L_done:
    s_endpgm
L_pollslow0:
    s_mov_b32 s59, 60
L_pollsm0:
    s_buffer_load_dwordx8 s[48:55], s[20:23], s44 glc
    s_waitcnt lgkmcnt(0)
    s_sub_u32 s48, s48, s92
    s_sub_u32 s49, s49, s92
    s_sub_u32 s50, s50, s92
    s_sub_u32 s51, s51, s92
    s_sub_u32 s52, s52, s92
    s_sub_u32 s53, s53, s92
    s_sub_u32 s54, s54, s92
    s_sub_u32 s55, s55, s92
    s_max_u32 s48, s48, s49
    s_max_u32 s48, s48, s50
    s_max_u32 s48, s48, s51
    s_max_u32 s48, s48, s52
    s_max_u32 s48, s48, s53
    s_max_u32 s48, s48, s54
    s_max_u32 s48, s48, s55
    s_cmp_lt_u32 s48, 16
    s_cbranch_scc1 L_pollok0
    s_sub_u32 s59, s59, 1
    s_cbranch_scc1 L_pollvec0
    s_sleep 1
    s_branch L_pollsm0
L_pollvec0:
    v_bfe_u32 v53, v4, 4, 6
    v_lshlrev_b32 v53, 2, v53
    s_sub_u32 s96, s96, 1
    s_cbranch_scc1 L_pollgiveup0
    s_sleep 2
    buffer_load_dword v52, v53, s[20:23], s44 offen sc1
    s_waitcnt vmcnt(0)
    s_bitcmp1_b32 s92, 9
    s_cbranch_scc1 L_nomix
    v_xor_b32 v53, s92, v52
    v_lshrrev_b32 v53, 5, v53
    v_add_u32 v53, -1, v53
    v_cmp_gt_u32 vcc, 31, v53
    s_nop 1
    s_and_b32 s59, vcc_lo, 0xff
    s_cbranch_scc0 L_nomix
    buffer_store_dwordx4 v[224:227], v11, s[4:7], s33 offen offset:0 sc1
    v_xor_b32 v55, 16, v11
    buffer_store_dwordx4 v[228:231], v55, s[4:7], s33 offen offset:768 sc1
    v_xor_b32 v54, 32, v11
    buffer_store_dwordx4 v[232:235], v54, s[4:7], s33 offen offset:1536 sc1
    v_xor_b32 v55, 48, v11
    buffer_store_dwordx4 v[236:239], v55, s[4:7], s33 offen offset:2304 sc1
    buffer_store_dwordx4 v[112:115], v15, s[4:7], s35 offen offset:0 sc1
    buffer_store_dwordx4 v[116:119], v15, s[4:7], s35 offen offset:1024 sc1
    buffer_store_dwordx4 v[120:123], v15, s[4:7], s35 offen offset:2048 sc1
    s_waitcnt vmcnt(0)
    s_barrier
    s_and_b32 s92, s92, 0xfffffc00
    s_add_u32 s92, s92, 512
    v_mov_b32 v0, s92
    s_add_u32 s92, s92, 1
    s_mov_b32 s44, 32
    v_add_u32 v0, 1, v0
    buffer_store_dword v0, v13, s[20:23], 0 offen offset:32 sc1
    s_branch L_pollvec0
L_nomix:
    v_subrev_u32 v52, s92, v52
    v_cmp_lt_u32 vcc, 15, v52
    s_nop 0
    s_and_b32 s59, vcc_lo, 0xff
    s_cbranch_scc1 L_pollvec0
    s_branch L_pollok0
L_pollgiveup0:
    s_mov_b32 s96, 0
    s_branch L_pollok0
L_pollslow1:
    s_mov_b32 s59, 200
L_pollsm1:
    s_buffer_load_dwordx8 s[48:55], s[20:23], s44 glc
    s_waitcnt lgkmcnt(0)
    s_sub_u32 s48, s48, s92
    s_sub_u32 s49, s49, s92
    s_sub_u32 s50, s50, s92
    s_sub_u32 s51, s51, s92
    s_sub_u32 s52, s52, s92
    s_sub_u32 s53, s53, s92
    s_sub_u32 s54, s54, s92
    s_sub_u32 s55, s55, s92
    s_max_u32 s48, s48, s49
    s_max_u32 s48, s48, s50
    s_max_u32 s48, s48, s51
    s_max_u32 s48, s48, s52
    s_max_u32 s48, s48, s53
    s_max_u32 s48, s48, s54
    s_max_u32 s48, s48, s55
    s_cmp_lt_u32 s48, 16
    s_cbranch_scc1 L_pollok1
    s_sub_u32 s59, s59, 1
    s_cbranch_scc1 L_pollvec1
    s_sleep 1
    s_branch L_pollsm1
L_pollvec1:
    v_bfe_u32 v53, v4, 4, 6
    v_lshlrev_b32 v53, 2, v53
    s_sub_u32 s96, s96, 1
    s_cbranch_scc1 L_pollgiveup1
    s_sleep 2
    buffer_load_dword v52, v53, s[20:23], s44 offen sc1
    s_waitcnt vmcnt(0)
    v_subrev_u32 v52, s92, v52
    v_cmp_lt_u32 vcc, 15, v52
    s_nop 0
    s_and_b32 s59, vcc_lo, 0xff
    s_cbranch_scc1 L_pollvec1
    s_branch L_pollok1
L_pollgiveup1:
    s_mov_b32 s96, 0
    s_branch L_pollok1
L_pollslow2:
    s_mov_b32 s59, 200
L_pollsm2:
    s_buffer_load_dwordx8 s[48:55], s[20:23], s44 glc
    s_waitcnt lgkmcnt(0)
    s_sub_u32 s48, s48, s92
    s_sub_u32 s49, s49, s92
    s_sub_u32 s50, s50, s92
    s_sub_u32 s51, s51, s92
    s_sub_u32 s52, s52, s92
    s_sub_u32 s53, s53, s92
    s_sub_u32 s54, s54, s92
    s_sub_u32 s55, s55, s92
    s_max_u32 s48, s48, s49
    s_max_u32 s48, s48, s50
    s_max_u32 s48, s48, s51
    s_max_u32 s48, s48, s52
    s_max_u32 s48, s48, s53
    s_max_u32 s48, s48, s54
    s_max_u32 s48, s48, s55
    s_cmp_lt_u32 s48, 16
    s_cbranch_scc1 L_pollok2
    s_sub_u32 s59, s59, 1
    s_cbranch_scc1 L_pollvec2
    s_sleep 1
    s_branch L_pollsm2
L_pollvec2:
    v_bfe_u32 v53, v4, 4, 6
    v_lshlrev_b32 v53, 2, v53
    s_sub_u32 s96, s96, 1
    s_cbranch_scc1 L_pollgiveup2
    s_sleep 2
    buffer_load_dword v52, v53, s[20:23], s44 offen sc1
    s_waitcnt vmcnt(0)
    v_subrev_u32 v52, s92, v52
    v_cmp_lt_u32 vcc, 15, v52
    s_nop 0
    s_and_b32 s59, vcc_lo, 0xff
    s_cbranch_scc1 L_pollvec2
    s_branch L_pollok2
L_pollgiveup2:
    s_mov_b32 s96, 0
    s_branch L_pollok2
L_pollslow3:
    s_mov_b32 s59, 200
L_pollsm3:
    s_buffer_load_dwordx8 s[48:55], s[20:23], s44 glc
    s_waitcnt lgkmcnt(0)
    s_sub_u32 s48, s48, s92
    s_sub_u32 s49, s49, s92
    s_sub_u32 s50, s50, s92
    s_sub_u32 s51, s51, s92
    s_sub_u32 s52, s52, s92
    s_sub_u32 s53, s53, s92
    s_sub_u32 s54, s54, s92
    s_sub_u32 s55, s55, s92
    s_max_u32 s48, s48, s49
    s_max_u32 s48, s48, s50
    s_max_u32 s48, s48, s51
    s_max_u32 s48, s48, s52
    s_max_u32 s48, s48, s53
    s_max_u32 s48, s48, s54
    s_max_u32 s48, s48, s55
    s_cmp_lt_u32 s48, 16
    s_cbranch_scc1 L_pollok3
    s_sub_u32 s59, s59, 1
    s_cbranch_scc1 L_pollvec3
    s_sleep 1
    s_branch L_pollsm3
L_pollvec3:
    v_bfe_u32 v53, v4, 4, 6
    v_lshlrev_b32 v53, 2, v53
    s_sub_u32 s96, s96, 1
    s_cbranch_scc1 L_pollgiveup3
    s_sleep 2
    buffer_load_dword v52, v53, s[20:23], s44 offen sc1
    s_waitcnt vmcnt(0)
    v_subrev_u32 v52, s92, v52
    v_cmp_lt_u32 vcc, 15, v52
    s_nop 0
    s_and_b32 s59, vcc_lo, 0xff
    s_cbranch_scc1 L_pollvec3
    s_branch L_pollok3
L_pollgiveup3:
    s_mov_b32 s96, 0
    s_branch L_pollok3
L_pollslow4:
    s_mov_b32 s59, 200
L_pollsm4:
    s_buffer_load_dwordx8 s[48:55], s[20:23], s44 glc
    s_waitcnt lgkmcnt(0)
    s_sub_u32 s48, s48, s92
    s_sub_u32 s49, s49, s92
    s_sub_u32 s50, s50, s92
    s_sub_u32 s51, s51, s92
    s_sub_u32 s52, s52, s92
    s_sub_u32 s53, s53, s92
    s_sub_u32 s54, s54, s92
    s_sub_u32 s55, s55, s92
    s_max_u32 s48, s48, s49
    s_max_u32 s48, s48, s50
    s_max_u32 s48, s48, s51
    s_max_u32 s48, s48, s52
    s_max_u32 s48, s48, s53
    s_max_u32 s48, s48, s54
    s_max_u32 s48, s48, s55
    s_cmp_lt_u32 s48, 16
    s_cbranch_scc1 L_pollok4
    s_sub_u32 s59, s59, 1
    s_cbranch_scc1 L_pollvec4
    s_sleep 1
    s_branch L_pollsm4
L_pollvec4:
    v_bfe_u32 v53, v4, 4, 6
    v_lshlrev_b32 v53, 2, v53
    s_sub_u32 s96, s96, 1
    s_cbranch_scc1 L_pollgiveup4
    s_sleep 2
    buffer_load_dword v52, v53, s[20:23], s44 offen sc1
    s_waitcnt vmcnt(0)
    v_subrev_u32 v52, s92, v52
    v_cmp_lt_u32 vcc, 15, v52
    s_nop 0
    s_and_b32 s59, vcc_lo, 0xff
    s_cbranch_scc1 L_pollvec4
    s_branch L_pollok4
L_pollgiveup4:
    s_mov_b32 s96, 0
    s_branch L_pollok4
L_tagslow:
    s_sub_u32 s96, s96, 1
    s_cbranch_scc1 L_taggiveup
    s_sleep 2
    buffer_load_dword v0, off, s[88:91], s93 sc1
    s_waitcnt vmcnt(0)
    v_readfirstlane_b32 s42, v0
    s_nop 0
    s_cmp_eq_u32 s42, s46
    s_cbranch_scc1 L_tagslow
    s_cmp_eq_u32 s42, 0
    s_cbranch_scc1 L_tagslow
    s_branch L_tagok
L_taggiveup:
    s_mov_b32 s96, 0
    s_branch L_tagok
L_slow:
    s_waitcnt vmcnt(0) lgkmcnt(0)
    s_nop 15
    v_accvgpr_write_b32 a0, 0
    v_accvgpr_write_b32 a1, 0
    v_accvgpr_write_b32 a2, 0
    v_accvgpr_write_b32 a3, 0
    v_accvgpr_write_b32 a4, 0
    v_accvgpr_write_b32 a5, 0
    v_accvgpr_write_b32 a6, 0
    v_accvgpr_write_b32 a7, 0
    v_accvgpr_write_b32 a8, 0
    v_accvgpr_write_b32 a9, 0
    v_accvgpr_write_b32 a10, 0
    v_accvgpr_write_b32 a11, 0
    v_accvgpr_write_b32 a12, 0
    v_accvgpr_write_b32 a13, 0
    v_accvgpr_write_b32 a14, 0
    v_accvgpr_write_b32 a15, 0
    v_accvgpr_write_b32 a16, 0
    v_accvgpr_write_b32 a17, 0
    v_accvgpr_write_b32 a18, 0
    v_accvgpr_write_b32 a19, 0
    v_accvgpr_write_b32 a20, 0
    v_accvgpr_write_b32 a21, 0
    v_accvgpr_write_b32 a22, 0
    v_accvgpr_write_b32 a23, 0
    v_accvgpr_write_b32 a24, 0
    v_accvgpr_write_b32 a25, 0
    v_accvgpr_write_b32 a26, 0
    v_accvgpr_write_b32 a27, 0
    v_accvgpr_write_b32 a28, 0
    v_accvgpr_write_b32 a29, 0
    v_accvgpr_write_b32 a30, 0
    v_accvgpr_write_b32 a31, 0
    v_accvgpr_write_b32 a32, 0
    v_accvgpr_write_b32 a33, 0
    v_accvgpr_write_b32 a34, 0
    v_accvgpr_write_b32 a35, 0
    v_accvgpr_write_b32 a36, 0
    v_accvgpr_write_b32 a37, 0
    v_accvgpr_write_b32 a38, 0
    v_accvgpr_write_b32 a39, 0
    v_accvgpr_write_b32 a40, 0
    v_accvgpr_write_b32 a41, 0
    v_accvgpr_write_b32 a42, 0
    v_accvgpr_write_b32 a43, 0
    v_accvgpr_write_b32 a44, 0
    v_accvgpr_write_b32 a45, 0
    v_accvgpr_write_b32 a46, 0
    v_accvgpr_write_b32 a47, 0
    v_accvgpr_write_b32 a48, 0
    v_accvgpr_write_b32 a49, 0
    v_accvgpr_write_b32 a50, 0
    v_accvgpr_write_b32 a51, 0
    v_accvgpr_write_b32 a52, 0
    v_accvgpr_write_b32 a53, 0
    v_accvgpr_write_b32 a54, 0
    v_accvgpr_write_b32 a55, 0
    v_accvgpr_write_b32 a56, 0
    v_accvgpr_write_b32 a57, 0
    v_accvgpr_write_b32 a58, 0
    v_accvgpr_write_b32 a59, 0
    v_accvgpr_write_b32 a60, 0
    v_accvgpr_write_b32 a61, 0
    v_accvgpr_write_b32 a62, 0
    v_accvgpr_write_b32 a63, 0
    v_accvgpr_write_b32 a64, 0
    v_accvgpr_write_b32 a65, 0
    v_accvgpr_write_b32 a66, 0
    v_accvgpr_write_b32 a67, 0
    v_accvgpr_write_b32 a68, 0
    v_accvgpr_write_b32 a69, 0
    v_accvgpr_write_b32 a70, 0
    v_accvgpr_write_b32 a71, 0
    v_accvgpr_write_b32 a72, 0
    v_accvgpr_write_b32 a73, 0
    v_accvgpr_write_b32 a74, 0
    v_accvgpr_write_b32 a75, 0
    v_accvgpr_write_b32 a76, 0
    v_accvgpr_write_b32 a77, 0
    v_accvgpr_write_b32 a78, 0
    v_accvgpr_write_b32 a79, 0
    v_accvgpr_write_b32 a80, 0
    v_accvgpr_write_b32 a81, 0
    v_accvgpr_write_b32 a82, 0
    v_accvgpr_write_b32 a83, 0
    v_accvgpr_write_b32 a84, 0
    v_accvgpr_write_b32 a85, 0
    v_accvgpr_write_b32 a86, 0
    v_accvgpr_write_b32 a87, 0
    v_accvgpr_write_b32 a88, 0
    v_accvgpr_write_b32 a89, 0
    v_accvgpr_write_b32 a90, 0
    v_accvgpr_write_b32 a91, 0
    v_accvgpr_write_b32 a92, 0
    v_accvgpr_write_b32 a93, 0
    v_accvgpr_write_b32 a94, 0
    v_accvgpr_write_b32 a95, 0
    v_accvgpr_write_b32 a96, 0
    v_accvgpr_write_b32 a97, 0
    v_accvgpr_write_b32 a98, 0
    v_accvgpr_write_b32 a99, 0
    v_accvgpr_write_b32 a100, 0
    v_accvgpr_write_b32 a101, 0
    v_accvgpr_write_b32 a102, 0
    v_accvgpr_write_b32 a103, 0
    v_accvgpr_write_b32 a104, 0
    v_accvgpr_write_b32 a105, 0
    v_accvgpr_write_b32 a106, 0
    v_accvgpr_write_b32 a107, 0
    v_accvgpr_write_b32 a108, 0
    v_accvgpr_write_b32 a109, 0
    v_accvgpr_write_b32 a110, 0
    v_accvgpr_write_b32 a111, 0
    v_accvgpr_write_b32 a112, 0
    v_accvgpr_write_b32 a113, 0
    v_accvgpr_write_b32 a114, 0
    v_accvgpr_write_b32 a115, 0
    v_accvgpr_write_b32 a116, 0
    v_accvgpr_write_b32 a117, 0
    v_accvgpr_write_b32 a118, 0
    v_accvgpr_write_b32 a119, 0
    v_accvgpr_write_b32 a120, 0
    v_accvgpr_write_b32 a121, 0
    v_accvgpr_write_b32 a122, 0
    v_accvgpr_write_b32 a123, 0
    v_accvgpr_write_b32 a124, 0
    v_accvgpr_write_b32 a125, 0
    v_accvgpr_write_b32 a126, 0
    v_accvgpr_write_b32 a127, 0
    v_accvgpr_write_b32 a128, 0
    v_accvgpr_write_b32 a129, 0
    v_accvgpr_write_b32 a130, 0
    v_accvgpr_write_b32 a131, 0
    v_accvgpr_write_b32 a132, 0
    v_accvgpr_write_b32 a133, 0
    v_accvgpr_write_b32 a134, 0
    v_accvgpr_write_b32 a135, 0
    v_accvgpr_write_b32 a136, 0
    v_accvgpr_write_b32 a137, 0
    v_accvgpr_write_b32 a138, 0
    v_accvgpr_write_b32 a139, 0
    v_accvgpr_write_b32 a140, 0
    v_accvgpr_write_b32 a141, 0
    v_accvgpr_write_b32 a142, 0
    v_accvgpr_write_b32 a143, 0
    v_accvgpr_write_b32 a144, 0
    v_accvgpr_write_b32 a145, 0
    v_accvgpr_write_b32 a146, 0
    v_accvgpr_write_b32 a147, 0
    v_accvgpr_write_b32 a148, 0
    v_accvgpr_write_b32 a149, 0
    v_accvgpr_write_b32 a150, 0
    v_accvgpr_write_b32 a151, 0
    v_accvgpr_write_b32 a152, 0
    v_accvgpr_write_b32 a153, 0
    v_accvgpr_write_b32 a154, 0
    v_accvgpr_write_b32 a155, 0
    v_accvgpr_write_b32 a156, 0
    v_accvgpr_write_b32 a157, 0
    v_accvgpr_write_b32 a158, 0
    v_accvgpr_write_b32 a159, 0
    v_accvgpr_write_b32 a160, 0
    v_accvgpr_write_b32 a161, 0
    v_accvgpr_write_b32 a162, 0
    v_accvgpr_write_b32 a163, 0
    v_accvgpr_write_b32 a164, 0
    v_accvgpr_write_b32 a165, 0
    v_accvgpr_write_b32 a166, 0
    v_accvgpr_write_b32 a167, 0
    v_accvgpr_write_b32 a168, 0
    v_accvgpr_write_b32 a169, 0
    v_accvgpr_write_b32 a170, 0
    v_accvgpr_write_b32 a171, 0
    v_accvgpr_write_b32 a172, 0
    v_accvgpr_write_b32 a173, 0
    v_accvgpr_write_b32 a174, 0
    v_accvgpr_write_b32 a175, 0
    v_accvgpr_write_b32 a176, 0
    v_accvgpr_write_b32 a177, 0
    v_accvgpr_write_b32 a178, 0
    v_accvgpr_write_b32 a179, 0
    v_accvgpr_write_b32 a180, 0
    v_accvgpr_write_b32 a181, 0
    v_accvgpr_write_b32 a182, 0
    v_accvgpr_write_b32 a183, 0
    v_accvgpr_write_b32 a184, 0
    v_accvgpr_write_b32 a185, 0
    v_accvgpr_write_b32 a186, 0
    v_accvgpr_write_b32 a187, 0
    v_accvgpr_write_b32 a188, 0
    v_accvgpr_write_b32 a189, 0
    v_accvgpr_write_b32 a190, 0
    v_accvgpr_write_b32 a191, 0
    v_mov_b32 v5, 0
    v_mov_b32 v240, 0xff7fffff
    v_mov_b32 v6, 0
    v_mov_b32 v241, 0xff7fffff
    v_mov_b32 v7, 0
    v_mov_b32 v242, 0xff7fffff
    v_mov_b32 v8, 0
    v_mov_b32 v243, 0xff7fffff
    v_subrev_u32 v244, 49152, v2
    v_subrev_u32 v245, 49152, v3
    v_subrev_u32 v246, 24576, v1
    s_mov_b32 s48, 0
L_slowloop:
    s_add_u32 s49, s48, 6144
    s_add_u32 s50, s48, 12288
    s_add_u32 s51, s48, 16384
    s_add_u32 s52, s48, 20480
    buffer_load_dwordx4 v[64:67], v244, s[4:7], s48 offen offset:0 sc1
    buffer_load_dwordx4 v[68:71], v245, s[4:7], s48 offen offset:0 sc1
    buffer_load_dwordx4 v[72:75], v244, s[4:7], s49 offen offset:0 sc1
    buffer_load_dwordx4 v[76:79], v245, s[4:7], s49 offen offset:0 sc1
    buffer_load_dwordx4 v[80:83], v244, s[4:7], s48 offen offset:128 sc1
    buffer_load_dwordx4 v[84:87], v245, s[4:7], s48 offen offset:128 sc1
    buffer_load_dwordx4 v[88:91], v244, s[4:7], s49 offen offset:128 sc1
    buffer_load_dwordx4 v[92:95], v245, s[4:7], s49 offen offset:128 sc1
    buffer_load_dwordx4 v[96:99], v244, s[4:7], s48 offen offset:256 sc1
    buffer_load_dwordx4 v[100:103], v245, s[4:7], s48 offen offset:256 sc1
    buffer_load_dwordx4 v[104:107], v244, s[4:7], s49 offen offset:256 sc1
    buffer_load_dwordx4 v[108:111], v245, s[4:7], s49 offen offset:256 sc1
    buffer_load_dwordx4 v[112:115], v246, s[4:7], s50 offen offset:0 sc1
    buffer_load_dwordx4 v[116:119], v246, s[4:7], s50 offen offset:1024 sc1
    buffer_load_dwordx4 v[120:123], v246, s[4:7], s50 offen offset:2048 sc1
    buffer_load_dwordx4 v[124:127], v246, s[4:7], s50 offen offset:3072 sc1
    buffer_load_dwordx4 v[128:131], v246, s[4:7], s51 offen offset:0 sc1
    buffer_load_dwordx4 v[132:135], v246, s[4:7], s51 offen offset:1024 sc1
    buffer_load_dwordx4 v[136:139], v246, s[4:7], s51 offen offset:2048 sc1
    buffer_load_dwordx4 v[140:143], v246, s[4:7], s51 offen offset:3072 sc1
    buffer_load_dwordx4 v[144:147], v246, s[4:7], s52 offen offset:0 sc1
    buffer_load_dwordx4 v[148:151], v246, s[4:7], s52 offen offset:1024 sc1
    buffer_load_dwordx4 v[152:155], v246, s[4:7], s52 offen offset:2048 sc1
    buffer_load_dwordx4 v[156:159], v246, s[4:7], s52 offen offset:3072 sc1
    s_waitcnt vmcnt(12)
    v_mfma_f32_16x16x32_bf16 v[160:163], v[64:67], a[192:195], 0
    v_mfma_f32_16x16x32_bf16 v[168:171], v[64:67], a[216:219], 0
    v_mfma_f32_16x16x32_bf16 v[176:179], v[64:67], a[240:243], 0
    v_mfma_f32_16x16x32_bf16 v[184:187], v[64:67], v[200:203], 0
    v_mfma_f32_16x16x32_bf16 v[160:163], v[68:71], a[196:199], v[160:163]
    v_mfma_f32_16x16x32_bf16 v[168:171], v[68:71], a[220:223], v[168:171]
    v_mfma_f32_16x16x32_bf16 v[176:179], v[68:71], a[244:247], v[176:179]
    v_mfma_f32_16x16x32_bf16 v[184:187], v[68:71], v[204:207], v[184:187]
    v_mfma_f32_16x16x32_bf16 v[164:167], v[72:75], a[192:195], 0
    v_mfma_f32_16x16x32_bf16 v[172:175], v[72:75], a[216:219], 0
    v_mfma_f32_16x16x32_bf16 v[180:183], v[72:75], a[240:243], 0
    v_mfma_f32_16x16x32_bf16 v[188:191], v[72:75], v[200:203], 0
    v_mfma_f32_16x16x32_bf16 v[164:167], v[76:79], a[196:199], v[164:167]
    v_mfma_f32_16x16x32_bf16 v[172:175], v[76:79], a[220:223], v[172:175]
    v_mfma_f32_16x16x32_bf16 v[180:183], v[76:79], a[244:247], v[180:183]
    v_mfma_f32_16x16x32_bf16 v[188:191], v[76:79], v[204:207], v[188:191]
    v_mfma_f32_16x16x32_bf16 v[160:163], v[80:83], a[200:203], v[160:163]
    v_mfma_f32_16x16x32_bf16 v[168:171], v[80:83], a[224:227], v[168:171]
    v_mfma_f32_16x16x32_bf16 v[176:179], v[80:83], a[248:251], v[176:179]
    v_mfma_f32_16x16x32_bf16 v[184:187], v[80:83], v[208:211], v[184:187]
    v_mfma_f32_16x16x32_bf16 v[160:163], v[84:87], a[204:207], v[160:163]
    v_mfma_f32_16x16x32_bf16 v[168:171], v[84:87], a[228:231], v[168:171]
    v_mfma_f32_16x16x32_bf16 v[176:179], v[84:87], a[252:255], v[176:179]
    v_mfma_f32_16x16x32_bf16 v[184:187], v[84:87], v[212:215], v[184:187]
    v_mfma_f32_16x16x32_bf16 v[164:167], v[88:91], a[200:203], v[164:167]
    v_mfma_f32_16x16x32_bf16 v[172:175], v[88:91], a[224:227], v[172:175]
    v_mfma_f32_16x16x32_bf16 v[180:183], v[88:91], a[248:251], v[180:183]
    v_mfma_f32_16x16x32_bf16 v[188:191], v[88:91], v[208:211], v[188:191]
    v_mfma_f32_16x16x32_bf16 v[164:167], v[92:95], a[204:207], v[164:167]
    v_mfma_f32_16x16x32_bf16 v[172:175], v[92:95], a[228:231], v[172:175]
    v_mfma_f32_16x16x32_bf16 v[180:183], v[92:95], a[252:255], v[180:183]
    v_mfma_f32_16x16x32_bf16 v[188:191], v[92:95], v[212:215], v[188:191]
    v_mfma_f32_16x16x32_bf16 v[160:163], v[96:99], a[208:211], v[160:163]
    v_mfma_f32_16x16x32_bf16 v[168:171], v[96:99], a[232:235], v[168:171]
    v_mfma_f32_16x16x32_bf16 v[176:179], v[96:99], v[192:195], v[176:179]
    v_mfma_f32_16x16x32_bf16 v[184:187], v[96:99], v[216:219], v[184:187]
    v_mfma_f32_16x16x32_bf16 v[160:163], v[100:103], a[212:215], v[160:163]
    v_mfma_f32_16x16x32_bf16 v[168:171], v[100:103], a[236:239], v[168:171]
    v_mfma_f32_16x16x32_bf16 v[176:179], v[100:103], v[196:199], v[176:179]
    v_mfma_f32_16x16x32_bf16 v[184:187], v[100:103], v[220:223], v[184:187]
    v_mfma_f32_16x16x32_bf16 v[164:167], v[104:107], a[208:211], v[164:167]
    v_mfma_f32_16x16x32_bf16 v[172:175], v[104:107], a[232:235], v[172:175]
    v_mfma_f32_16x16x32_bf16 v[180:183], v[104:107], v[192:195], v[180:183]
    v_mfma_f32_16x16x32_bf16 v[188:191], v[104:107], v[216:219], v[188:191]
    v_mfma_f32_16x16x32_bf16 v[164:167], v[108:111], a[212:215], v[164:167]
    v_mfma_f32_16x16x32_bf16 v[172:175], v[108:111], a[236:239], v[172:175]
    v_mfma_f32_16x16x32_bf16 v[180:183], v[108:111], v[196:199], v[180:183]
    v_mfma_f32_16x16x32_bf16 v[188:191], v[108:111], v[220:223], v[188:191]
    s_nop 9
    v_max3_f32 v16, v160, v161, v162
    v_max3_f32 v16, v16, v163, v164
    v_max3_f32 v16, v16, v165, v166
    v_max3_f32 v16, v16, v167, v240
    v_mov_b32 v17, v16
    s_nop 1
    v_permlane16_swap_b32 v16, v17
    s_nop 1
    v_max_f32 v16, v16, v17
    v_mov_b32 v17, v16
    s_nop 1
    v_permlane32_swap_b32 v16, v17
    s_nop 1
    v_max_f32 v16, v16, v17
    v_sub_f32 v17, v240, v16
    v_exp_f32 v17, v17
    v_mov_b32 v240, v16
    v_sub_f32 v160, v160, v16
    v_sub_f32 v161, v161, v16
    v_sub_f32 v162, v162, v16
    v_sub_f32 v163, v163, v16
    v_sub_f32 v164, v164, v16
    v_sub_f32 v165, v165, v16
    v_sub_f32 v166, v166, v16
    v_sub_f32 v167, v167, v16
    v_exp_f32 v160, v160
    v_exp_f32 v161, v161
    v_exp_f32 v162, v162
    v_exp_f32 v163, v163
    v_exp_f32 v164, v164
    v_exp_f32 v165, v165
    v_exp_f32 v166, v166
    v_exp_f32 v167, v167
    v_mul_f32 v5, v5, v17
    v_add_f32 v5, v5, v160
    v_add_f32 v5, v5, v161
    v_add_f32 v5, v5, v162
    v_add_f32 v5, v5, v163
    v_add_f32 v5, v5, v164
    v_add_f32 v5, v5, v165
    v_add_f32 v5, v5, v166
    v_add_f32 v5, v5, v167
    v_cvt_pk_bf16_f32 v224, v160, v161
    v_cvt_pk_bf16_f32 v225, v162, v163
    v_cvt_pk_bf16_f32 v226, v164, v165
    v_cvt_pk_bf16_f32 v227, v166, v167
    ds_bpermute_b32 v248, v58, v17 offset:0
    ds_bpermute_b32 v249, v58, v17 offset:4
    ds_bpermute_b32 v250, v58, v17 offset:8
    ds_bpermute_b32 v251, v58, v17 offset:12
    s_waitcnt lgkmcnt(0)
    v_accvgpr_read_b32 v18, a0
    v_mul_f32 v18, v18, v248
    v_accvgpr_write_b32 a0, v18
    v_accvgpr_read_b32 v19, a1
    v_mul_f32 v19, v19, v249
    v_accvgpr_write_b32 a1, v19
    v_accvgpr_read_b32 v18, a2
    v_mul_f32 v18, v18, v250
    v_accvgpr_write_b32 a2, v18
    v_accvgpr_read_b32 v19, a3
    v_mul_f32 v19, v19, v251
    v_accvgpr_write_b32 a3, v19
    v_accvgpr_read_b32 v18, a4
    v_mul_f32 v18, v18, v248
    v_accvgpr_write_b32 a4, v18
    v_accvgpr_read_b32 v19, a5
    v_mul_f32 v19, v19, v249
    v_accvgpr_write_b32 a5, v19
    v_accvgpr_read_b32 v18, a6
    v_mul_f32 v18, v18, v250
    v_accvgpr_write_b32 a6, v18
    v_accvgpr_read_b32 v19, a7
    v_mul_f32 v19, v19, v251
    v_accvgpr_write_b32 a7, v19
    v_accvgpr_read_b32 v18, a8
    v_mul_f32 v18, v18, v248
    v_accvgpr_write_b32 a8, v18
    v_accvgpr_read_b32 v19, a9
    v_mul_f32 v19, v19, v249
    v_accvgpr_write_b32 a9, v19
    v_accvgpr_read_b32 v18, a10
    v_mul_f32 v18, v18, v250
    v_accvgpr_write_b32 a10, v18
    v_accvgpr_read_b32 v19, a11
    v_mul_f32 v19, v19, v251
    v_accvgpr_write_b32 a11, v19
    v_accvgpr_read_b32 v18, a12
    v_mul_f32 v18, v18, v248
    v_accvgpr_write_b32 a12, v18
    v_accvgpr_read_b32 v19, a13
    v_mul_f32 v19, v19, v249
    v_accvgpr_write_b32 a13, v19
    v_accvgpr_read_b32 v18, a14
    v_mul_f32 v18, v18, v250
    v_accvgpr_write_b32 a14, v18
    v_accvgpr_read_b32 v19, a15
    v_mul_f32 v19, v19, v251
    v_accvgpr_write_b32 a15, v19
    v_accvgpr_read_b32 v18, a16
    v_mul_f32 v18, v18, v248
    v_accvgpr_write_b32 a16, v18
    v_accvgpr_read_b32 v19, a17
    v_mul_f32 v19, v19, v249
    v_accvgpr_write_b32 a17, v19
    v_accvgpr_read_b32 v18, a18
    v_mul_f32 v18, v18, v250
    v_accvgpr_write_b32 a18, v18
    v_accvgpr_read_b32 v19, a19
    v_mul_f32 v19, v19, v251
    v_accvgpr_write_b32 a19, v19
    v_accvgpr_read_b32 v18, a20
    v_mul_f32 v18, v18, v248
    v_accvgpr_write_b32 a20, v18
    v_accvgpr_read_b32 v19, a21
    v_mul_f32 v19, v19, v249
    v_accvgpr_write_b32 a21, v19
    v_accvgpr_read_b32 v18, a22
    v_mul_f32 v18, v18, v250
    v_accvgpr_write_b32 a22, v18
    v_accvgpr_read_b32 v19, a23
    v_mul_f32 v19, v19, v251
    v_accvgpr_write_b32 a23, v19
    v_accvgpr_read_b32 v18, a24
    v_mul_f32 v18, v18, v248
    v_accvgpr_write_b32 a24, v18
    v_accvgpr_read_b32 v19, a25
    v_mul_f32 v19, v19, v249
    v_accvgpr_write_b32 a25, v19
    v_accvgpr_read_b32 v18, a26
    v_mul_f32 v18, v18, v250
    v_accvgpr_write_b32 a26, v18
    v_accvgpr_read_b32 v19, a27
    v_mul_f32 v19, v19, v251
    v_accvgpr_write_b32 a27, v19
    v_accvgpr_read_b32 v18, a28
    v_mul_f32 v18, v18, v248
    v_accvgpr_write_b32 a28, v18
    v_accvgpr_read_b32 v19, a29
    v_mul_f32 v19, v19, v249
    v_accvgpr_write_b32 a29, v19
    v_accvgpr_read_b32 v18, a30
    v_mul_f32 v18, v18, v250
    v_accvgpr_write_b32 a30, v18
    v_accvgpr_read_b32 v19, a31
    v_mul_f32 v19, v19, v251
    v_accvgpr_write_b32 a31, v19
    v_accvgpr_read_b32 v18, a32
    v_mul_f32 v18, v18, v248
    v_accvgpr_write_b32 a32, v18
    v_accvgpr_read_b32 v19, a33
    v_mul_f32 v19, v19, v249
    v_accvgpr_write_b32 a33, v19
    v_accvgpr_read_b32 v18, a34
    v_mul_f32 v18, v18, v250
    v_accvgpr_write_b32 a34, v18
    v_accvgpr_read_b32 v19, a35
    v_mul_f32 v19, v19, v251
    v_accvgpr_write_b32 a35, v19
    v_accvgpr_read_b32 v18, a36
    v_mul_f32 v18, v18, v248
    v_accvgpr_write_b32 a36, v18
    v_accvgpr_read_b32 v19, a37
    v_mul_f32 v19, v19, v249
    v_accvgpr_write_b32 a37, v19
    v_accvgpr_read_b32 v18, a38
    v_mul_f32 v18, v18, v250
    v_accvgpr_write_b32 a38, v18
    v_accvgpr_read_b32 v19, a39
    v_mul_f32 v19, v19, v251
    v_accvgpr_write_b32 a39, v19
    v_accvgpr_read_b32 v18, a40
    v_mul_f32 v18, v18, v248
    v_accvgpr_write_b32 a40, v18
    v_accvgpr_read_b32 v19, a41
    v_mul_f32 v19, v19, v249
    v_accvgpr_write_b32 a41, v19
    v_accvgpr_read_b32 v18, a42
    v_mul_f32 v18, v18, v250
    v_accvgpr_write_b32 a42, v18
    v_accvgpr_read_b32 v19, a43
    v_mul_f32 v19, v19, v251
    v_accvgpr_write_b32 a43, v19
    v_accvgpr_read_b32 v18, a44
    v_mul_f32 v18, v18, v248
    v_accvgpr_write_b32 a44, v18
    v_accvgpr_read_b32 v19, a45
    v_mul_f32 v19, v19, v249
    v_accvgpr_write_b32 a45, v19
    v_accvgpr_read_b32 v18, a46
    v_mul_f32 v18, v18, v250
    v_accvgpr_write_b32 a46, v18
    v_accvgpr_read_b32 v19, a47
    v_mul_f32 v19, v19, v251
    v_accvgpr_write_b32 a47, v19
    v_max3_f32 v16, v168, v169, v170
    v_max3_f32 v16, v16, v171, v172
    v_max3_f32 v16, v16, v173, v174
    v_max3_f32 v16, v16, v175, v241
    v_mov_b32 v17, v16
    s_nop 1
    v_permlane16_swap_b32 v16, v17
    s_nop 1
    v_max_f32 v16, v16, v17
    v_mov_b32 v17, v16
    s_nop 1
    v_permlane32_swap_b32 v16, v17
    s_nop 1
    v_max_f32 v16, v16, v17
    v_sub_f32 v17, v241, v16
    v_exp_f32 v17, v17
    v_mov_b32 v241, v16
    v_sub_f32 v168, v168, v16
    v_sub_f32 v169, v169, v16
    v_sub_f32 v170, v170, v16
    v_sub_f32 v171, v171, v16
    v_sub_f32 v172, v172, v16
    v_sub_f32 v173, v173, v16
    v_sub_f32 v174, v174, v16
    v_sub_f32 v175, v175, v16
    v_exp_f32 v168, v168
    v_exp_f32 v169, v169
    v_exp_f32 v170, v170
    v_exp_f32 v171, v171
    v_exp_f32 v172, v172
    v_exp_f32 v173, v173
    v_exp_f32 v174, v174
    v_exp_f32 v175, v175
    v_mul_f32 v6, v6, v17
    v_add_f32 v6, v6, v168
    v_add_f32 v6, v6, v169
    v_add_f32 v6, v6, v170
    v_add_f32 v6, v6, v171
    v_add_f32 v6, v6, v172
    v_add_f32 v6, v6, v173
    v_add_f32 v6, v6, v174
    v_add_f32 v6, v6, v175
    v_cvt_pk_bf16_f32 v228, v168, v169
    v_cvt_pk_bf16_f32 v229, v170, v171
    v_cvt_pk_bf16_f32 v230, v172, v173
    v_cvt_pk_bf16_f32 v231, v174, v175
    ds_bpermute_b32 v248, v58, v17 offset:0
    ds_bpermute_b32 v249, v58, v17 offset:4
    ds_bpermute_b32 v250, v58, v17 offset:8
    ds_bpermute_b32 v251, v58, v17 offset:12
    s_waitcnt lgkmcnt(0)
    v_accvgpr_read_b32 v18, a48
    v_mul_f32 v18, v18, v248
    v_accvgpr_write_b32 a48, v18
    v_accvgpr_read_b32 v19, a49
    v_mul_f32 v19, v19, v249
    v_accvgpr_write_b32 a49, v19
    v_accvgpr_read_b32 v18, a50
    v_mul_f32 v18, v18, v250
    v_accvgpr_write_b32 a50, v18
    v_accvgpr_read_b32 v19, a51
    v_mul_f32 v19, v19, v251
    v_accvgpr_write_b32 a51, v19
    v_accvgpr_read_b32 v18, a52
    v_mul_f32 v18, v18, v248
    v_accvgpr_write_b32 a52, v18
    v_accvgpr_read_b32 v19, a53
    v_mul_f32 v19, v19, v249
    v_accvgpr_write_b32 a53, v19
    v_accvgpr_read_b32 v18, a54
    v_mul_f32 v18, v18, v250
    v_accvgpr_write_b32 a54, v18
    v_accvgpr_read_b32 v19, a55
    v_mul_f32 v19, v19, v251
    v_accvgpr_write_b32 a55, v19
    v_accvgpr_read_b32 v18, a56
    v_mul_f32 v18, v18, v248
    v_accvgpr_write_b32 a56, v18
    v_accvgpr_read_b32 v19, a57
    v_mul_f32 v19, v19, v249
    v_accvgpr_write_b32 a57, v19
    v_accvgpr_read_b32 v18, a58
    v_mul_f32 v18, v18, v250
    v_accvgpr_write_b32 a58, v18
    v_accvgpr_read_b32 v19, a59
    v_mul_f32 v19, v19, v251
    v_accvgpr_write_b32 a59, v19
    v_accvgpr_read_b32 v18, a60
    v_mul_f32 v18, v18, v248
    v_accvgpr_write_b32 a60, v18
    v_accvgpr_read_b32 v19, a61
    v_mul_f32 v19, v19, v249
    v_accvgpr_write_b32 a61, v19
    v_accvgpr_read_b32 v18, a62
    v_mul_f32 v18, v18, v250
    v_accvgpr_write_b32 a62, v18
    v_accvgpr_read_b32 v19, a63
    v_mul_f32 v19, v19, v251
    v_accvgpr_write_b32 a63, v19
    v_accvgpr_read_b32 v18, a64
    v_mul_f32 v18, v18, v248
    v_accvgpr_write_b32 a64, v18
    v_accvgpr_read_b32 v19, a65
    v_mul_f32 v19, v19, v249
    v_accvgpr_write_b32 a65, v19
    v_accvgpr_read_b32 v18, a66
    v_mul_f32 v18, v18, v250
    v_accvgpr_write_b32 a66, v18
    v_accvgpr_read_b32 v19, a67
    v_mul_f32 v19, v19, v251
    v_accvgpr_write_b32 a67, v19
    v_accvgpr_read_b32 v18, a68
    v_mul_f32 v18, v18, v248
    v_accvgpr_write_b32 a68, v18
    v_accvgpr_read_b32 v19, a69
    v_mul_f32 v19, v19, v249
    v_accvgpr_write_b32 a69, v19
    v_accvgpr_read_b32 v18, a70
    v_mul_f32 v18, v18, v250
    v_accvgpr_write_b32 a70, v18
    v_accvgpr_read_b32 v19, a71
    v_mul_f32 v19, v19, v251
    v_accvgpr_write_b32 a71, v19
    v_accvgpr_read_b32 v18, a72
    v_mul_f32 v18, v18, v248
    v_accvgpr_write_b32 a72, v18
    v_accvgpr_read_b32 v19, a73
    v_mul_f32 v19, v19, v249
    v_accvgpr_write_b32 a73, v19
    v_accvgpr_read_b32 v18, a74
    v_mul_f32 v18, v18, v250
    v_accvgpr_write_b32 a74, v18
    v_accvgpr_read_b32 v19, a75
    v_mul_f32 v19, v19, v251
    v_accvgpr_write_b32 a75, v19
    v_accvgpr_read_b32 v18, a76
    v_mul_f32 v18, v18, v248
    v_accvgpr_write_b32 a76, v18
    v_accvgpr_read_b32 v19, a77
    v_mul_f32 v19, v19, v249
    v_accvgpr_write_b32 a77, v19
    v_accvgpr_read_b32 v18, a78
    v_mul_f32 v18, v18, v250
    v_accvgpr_write_b32 a78, v18
    v_accvgpr_read_b32 v19, a79
    v_mul_f32 v19, v19, v251
    v_accvgpr_write_b32 a79, v19
    v_accvgpr_read_b32 v18, a80
    v_mul_f32 v18, v18, v248
    v_accvgpr_write_b32 a80, v18
    v_accvgpr_read_b32 v19, a81
    v_mul_f32 v19, v19, v249
    v_accvgpr_write_b32 a81, v19
    v_accvgpr_read_b32 v18, a82
    v_mul_f32 v18, v18, v250
    v_accvgpr_write_b32 a82, v18
    v_accvgpr_read_b32 v19, a83
    v_mul_f32 v19, v19, v251
    v_accvgpr_write_b32 a83, v19
    v_accvgpr_read_b32 v18, a84
    v_mul_f32 v18, v18, v248
    v_accvgpr_write_b32 a84, v18
    v_accvgpr_read_b32 v19, a85
    v_mul_f32 v19, v19, v249
    v_accvgpr_write_b32 a85, v19
    v_accvgpr_read_b32 v18, a86
    v_mul_f32 v18, v18, v250
    v_accvgpr_write_b32 a86, v18
    v_accvgpr_read_b32 v19, a87
    v_mul_f32 v19, v19, v251
    v_accvgpr_write_b32 a87, v19
    v_accvgpr_read_b32 v18, a88
    v_mul_f32 v18, v18, v248
    v_accvgpr_write_b32 a88, v18
    v_accvgpr_read_b32 v19, a89
    v_mul_f32 v19, v19, v249
    v_accvgpr_write_b32 a89, v19
    v_accvgpr_read_b32 v18, a90
    v_mul_f32 v18, v18, v250
    v_accvgpr_write_b32 a90, v18
    v_accvgpr_read_b32 v19, a91
    v_mul_f32 v19, v19, v251
    v_accvgpr_write_b32 a91, v19
    v_accvgpr_read_b32 v18, a92
    v_mul_f32 v18, v18, v248
    v_accvgpr_write_b32 a92, v18
    v_accvgpr_read_b32 v19, a93
    v_mul_f32 v19, v19, v249
    v_accvgpr_write_b32 a93, v19
    v_accvgpr_read_b32 v18, a94
    v_mul_f32 v18, v18, v250
    v_accvgpr_write_b32 a94, v18
    v_accvgpr_read_b32 v19, a95
    v_mul_f32 v19, v19, v251
    v_accvgpr_write_b32 a95, v19
    v_max3_f32 v16, v176, v177, v178
    v_max3_f32 v16, v16, v179, v180
    v_max3_f32 v16, v16, v181, v182
    v_max3_f32 v16, v16, v183, v242
    v_mov_b32 v17, v16
    s_nop 1
    v_permlane16_swap_b32 v16, v17
    s_nop 1
    v_max_f32 v16, v16, v17
    v_mov_b32 v17, v16
    s_nop 1
    v_permlane32_swap_b32 v16, v17
    s_nop 1
    v_max_f32 v16, v16, v17
    v_sub_f32 v17, v242, v16
    v_exp_f32 v17, v17
    v_mov_b32 v242, v16
    v_sub_f32 v176, v176, v16
    v_sub_f32 v177, v177, v16
    v_sub_f32 v178, v178, v16
    v_sub_f32 v179, v179, v16
    v_sub_f32 v180, v180, v16
    v_sub_f32 v181, v181, v16
    v_sub_f32 v182, v182, v16
    v_sub_f32 v183, v183, v16
    v_exp_f32 v176, v176
    v_exp_f32 v177, v177
    v_exp_f32 v178, v178
    v_exp_f32 v179, v179
    v_exp_f32 v180, v180
    v_exp_f32 v181, v181
    v_exp_f32 v182, v182
    v_exp_f32 v183, v183
    v_mul_f32 v7, v7, v17
    v_add_f32 v7, v7, v176
    v_add_f32 v7, v7, v177
    v_add_f32 v7, v7, v178
    v_add_f32 v7, v7, v179
    v_add_f32 v7, v7, v180
    v_add_f32 v7, v7, v181
    v_add_f32 v7, v7, v182
    v_add_f32 v7, v7, v183
    v_cvt_pk_bf16_f32 v232, v176, v177
    v_cvt_pk_bf16_f32 v233, v178, v179
    v_cvt_pk_bf16_f32 v234, v180, v181
    v_cvt_pk_bf16_f32 v235, v182, v183
    ds_bpermute_b32 v248, v58, v17 offset:0
    ds_bpermute_b32 v249, v58, v17 offset:4
    ds_bpermute_b32 v250, v58, v17 offset:8
    ds_bpermute_b32 v251, v58, v17 offset:12
    s_waitcnt lgkmcnt(0)
    v_accvgpr_read_b32 v18, a96
    v_mul_f32 v18, v18, v248
    v_accvgpr_write_b32 a96, v18
    v_accvgpr_read_b32 v19, a97
    v_mul_f32 v19, v19, v249
    v_accvgpr_write_b32 a97, v19
    v_accvgpr_read_b32 v18, a98
    v_mul_f32 v18, v18, v250
    v_accvgpr_write_b32 a98, v18
    v_accvgpr_read_b32 v19, a99
    v_mul_f32 v19, v19, v251
    v_accvgpr_write_b32 a99, v19
    v_accvgpr_read_b32 v18, a100
    v_mul_f32 v18, v18, v248
    v_accvgpr_write_b32 a100, v18
    v_accvgpr_read_b32 v19, a101
    v_mul_f32 v19, v19, v249
    v_accvgpr_write_b32 a101, v19
    v_accvgpr_read_b32 v18, a102
    v_mul_f32 v18, v18, v250
    v_accvgpr_write_b32 a102, v18
    v_accvgpr_read_b32 v19, a103
    v_mul_f32 v19, v19, v251
    v_accvgpr_write_b32 a103, v19
    v_accvgpr_read_b32 v18, a104
    v_mul_f32 v18, v18, v248
    v_accvgpr_write_b32 a104, v18
    v_accvgpr_read_b32 v19, a105
    v_mul_f32 v19, v19, v249
    v_accvgpr_write_b32 a105, v19
    v_accvgpr_read_b32 v18, a106
    v_mul_f32 v18, v18, v250
    v_accvgpr_write_b32 a106, v18
    v_accvgpr_read_b32 v19, a107
    v_mul_f32 v19, v19, v251
    v_accvgpr_write_b32 a107, v19
    v_accvgpr_read_b32 v18, a108
    v_mul_f32 v18, v18, v248
    v_accvgpr_write_b32 a108, v18
    v_accvgpr_read_b32 v19, a109
    v_mul_f32 v19, v19, v249
    v_accvgpr_write_b32 a109, v19
    v_accvgpr_read_b32 v18, a110
    v_mul_f32 v18, v18, v250
    v_accvgpr_write_b32 a110, v18
    v_accvgpr_read_b32 v19, a111
    v_mul_f32 v19, v19, v251
    v_accvgpr_write_b32 a111, v19
    v_accvgpr_read_b32 v18, a112
    v_mul_f32 v18, v18, v248
    v_accvgpr_write_b32 a112, v18
    v_accvgpr_read_b32 v19, a113
    v_mul_f32 v19, v19, v249
    v_accvgpr_write_b32 a113, v19
    v_accvgpr_read_b32 v18, a114
    v_mul_f32 v18, v18, v250
    v_accvgpr_write_b32 a114, v18
    v_accvgpr_read_b32 v19, a115
    v_mul_f32 v19, v19, v251
    v_accvgpr_write_b32 a115, v19
    v_accvgpr_read_b32 v18, a116
    v_mul_f32 v18, v18, v248
    v_accvgpr_write_b32 a116, v18
    v_accvgpr_read_b32 v19, a117
    v_mul_f32 v19, v19, v249
    v_accvgpr_write_b32 a117, v19
    v_accvgpr_read_b32 v18, a118
    v_mul_f32 v18, v18, v250
    v_accvgpr_write_b32 a118, v18
    v_accvgpr_read_b32 v19, a119
    v_mul_f32 v19, v19, v251
    v_accvgpr_write_b32 a119, v19
    v_accvgpr_read_b32 v18, a120
    v_mul_f32 v18, v18, v248
    v_accvgpr_write_b32 a120, v18
    v_accvgpr_read_b32 v19, a121
    v_mul_f32 v19, v19, v249
    v_accvgpr_write_b32 a121, v19
    v_accvgpr_read_b32 v18, a122
    v_mul_f32 v18, v18, v250
    v_accvgpr_write_b32 a122, v18
    v_accvgpr_read_b32 v19, a123
    v_mul_f32 v19, v19, v251
    v_accvgpr_write_b32 a123, v19
    v_accvgpr_read_b32 v18, a124
    v_mul_f32 v18, v18, v248
    v_accvgpr_write_b32 a124, v18
    v_accvgpr_read_b32 v19, a125
    v_mul_f32 v19, v19, v249
    v_accvgpr_write_b32 a125, v19
    v_accvgpr_read_b32 v18, a126
    v_mul_f32 v18, v18, v250
    v_accvgpr_write_b32 a126, v18
    v_accvgpr_read_b32 v19, a127
    v_mul_f32 v19, v19, v251
    v_accvgpr_write_b32 a127, v19
    v_accvgpr_read_b32 v18, a128
    v_mul_f32 v18, v18, v248
    v_accvgpr_write_b32 a128, v18
    v_accvgpr_read_b32 v19, a129
    v_mul_f32 v19, v19, v249
    v_accvgpr_write_b32 a129, v19
    v_accvgpr_read_b32 v18, a130
    v_mul_f32 v18, v18, v250
    v_accvgpr_write_b32 a130, v18
    v_accvgpr_read_b32 v19, a131
    v_mul_f32 v19, v19, v251
    v_accvgpr_write_b32 a131, v19
    v_accvgpr_read_b32 v18, a132
    v_mul_f32 v18, v18, v248
    v_accvgpr_write_b32 a132, v18
    v_accvgpr_read_b32 v19, a133
    v_mul_f32 v19, v19, v249
    v_accvgpr_write_b32 a133, v19
    v_accvgpr_read_b32 v18, a134
    v_mul_f32 v18, v18, v250
    v_accvgpr_write_b32 a134, v18
    v_accvgpr_read_b32 v19, a135
    v_mul_f32 v19, v19, v251
    v_accvgpr_write_b32 a135, v19
    v_accvgpr_read_b32 v18, a136
    v_mul_f32 v18, v18, v248
    v_accvgpr_write_b32 a136, v18
    v_accvgpr_read_b32 v19, a137
    v_mul_f32 v19, v19, v249
    v_accvgpr_write_b32 a137, v19
    v_accvgpr_read_b32 v18, a138
    v_mul_f32 v18, v18, v250
    v_accvgpr_write_b32 a138, v18
    v_accvgpr_read_b32 v19, a139
    v_mul_f32 v19, v19, v251
    v_accvgpr_write_b32 a139, v19
    v_accvgpr_read_b32 v18, a140
    v_mul_f32 v18, v18, v248
    v_accvgpr_write_b32 a140, v18
    v_accvgpr_read_b32 v19, a141
    v_mul_f32 v19, v19, v249
    v_accvgpr_write_b32 a141, v19
    v_accvgpr_read_b32 v18, a142
    v_mul_f32 v18, v18, v250
    v_accvgpr_write_b32 a142, v18
    v_accvgpr_read_b32 v19, a143
    v_mul_f32 v19, v19, v251
    v_accvgpr_write_b32 a143, v19
    v_max3_f32 v16, v184, v185, v186
    v_max3_f32 v16, v16, v187, v188
    v_max3_f32 v16, v16, v189, v190
    v_max3_f32 v16, v16, v191, v243
    v_mov_b32 v17, v16
    s_nop 1
    v_permlane16_swap_b32 v16, v17
    s_nop 1
    v_max_f32 v16, v16, v17
    v_mov_b32 v17, v16
    s_nop 1
    v_permlane32_swap_b32 v16, v17
    s_nop 1
    v_max_f32 v16, v16, v17
    v_sub_f32 v17, v243, v16
    v_exp_f32 v17, v17
    v_mov_b32 v243, v16
    v_sub_f32 v184, v184, v16
    v_sub_f32 v185, v185, v16
    v_sub_f32 v186, v186, v16
    v_sub_f32 v187, v187, v16
    v_sub_f32 v188, v188, v16
    v_sub_f32 v189, v189, v16
    v_sub_f32 v190, v190, v16
    v_sub_f32 v191, v191, v16
    v_exp_f32 v184, v184
    v_exp_f32 v185, v185
    v_exp_f32 v186, v186
    v_exp_f32 v187, v187
    v_exp_f32 v188, v188
    v_exp_f32 v189, v189
    v_exp_f32 v190, v190
    v_exp_f32 v191, v191
    v_mul_f32 v8, v8, v17
    v_add_f32 v8, v8, v184
    v_add_f32 v8, v8, v185
    v_add_f32 v8, v8, v186
    v_add_f32 v8, v8, v187
    v_add_f32 v8, v8, v188
    v_add_f32 v8, v8, v189
    v_add_f32 v8, v8, v190
    v_add_f32 v8, v8, v191
    v_cvt_pk_bf16_f32 v236, v184, v185
    v_cvt_pk_bf16_f32 v237, v186, v187
    v_cvt_pk_bf16_f32 v238, v188, v189
    v_cvt_pk_bf16_f32 v239, v190, v191
    ds_bpermute_b32 v248, v58, v17 offset:0
    ds_bpermute_b32 v249, v58, v17 offset:4
    ds_bpermute_b32 v250, v58, v17 offset:8
    ds_bpermute_b32 v251, v58, v17 offset:12
    s_waitcnt lgkmcnt(0)
    v_accvgpr_read_b32 v18, a144
    v_mul_f32 v18, v18, v248
    v_accvgpr_write_b32 a144, v18
    v_accvgpr_read_b32 v19, a145
    v_mul_f32 v19, v19, v249
    v_accvgpr_write_b32 a145, v19
    v_accvgpr_read_b32 v18, a146
    v_mul_f32 v18, v18, v250
    v_accvgpr_write_b32 a146, v18
    v_accvgpr_read_b32 v19, a147
    v_mul_f32 v19, v19, v251
    v_accvgpr_write_b32 a147, v19
    v_accvgpr_read_b32 v18, a148
    v_mul_f32 v18, v18, v248
    v_accvgpr_write_b32 a148, v18
    v_accvgpr_read_b32 v19, a149
    v_mul_f32 v19, v19, v249
    v_accvgpr_write_b32 a149, v19
    v_accvgpr_read_b32 v18, a150
    v_mul_f32 v18, v18, v250
    v_accvgpr_write_b32 a150, v18
    v_accvgpr_read_b32 v19, a151
    v_mul_f32 v19, v19, v251
    v_accvgpr_write_b32 a151, v19
    v_accvgpr_read_b32 v18, a152
    v_mul_f32 v18, v18, v248
    v_accvgpr_write_b32 a152, v18
    v_accvgpr_read_b32 v19, a153
    v_mul_f32 v19, v19, v249
    v_accvgpr_write_b32 a153, v19
    v_accvgpr_read_b32 v18, a154
    v_mul_f32 v18, v18, v250
    v_accvgpr_write_b32 a154, v18
    v_accvgpr_read_b32 v19, a155
    v_mul_f32 v19, v19, v251
    v_accvgpr_write_b32 a155, v19
    v_accvgpr_read_b32 v18, a156
    v_mul_f32 v18, v18, v248
    v_accvgpr_write_b32 a156, v18
    v_accvgpr_read_b32 v19, a157
    v_mul_f32 v19, v19, v249
    v_accvgpr_write_b32 a157, v19
    v_accvgpr_read_b32 v18, a158
    v_mul_f32 v18, v18, v250
    v_accvgpr_write_b32 a158, v18
    v_accvgpr_read_b32 v19, a159
    v_mul_f32 v19, v19, v251
    v_accvgpr_write_b32 a159, v19
    v_accvgpr_read_b32 v18, a160
    v_mul_f32 v18, v18, v248
    v_accvgpr_write_b32 a160, v18
    v_accvgpr_read_b32 v19, a161
    v_mul_f32 v19, v19, v249
    v_accvgpr_write_b32 a161, v19
    v_accvgpr_read_b32 v18, a162
    v_mul_f32 v18, v18, v250
    v_accvgpr_write_b32 a162, v18
    v_accvgpr_read_b32 v19, a163
    v_mul_f32 v19, v19, v251
    v_accvgpr_write_b32 a163, v19
    v_accvgpr_read_b32 v18, a164
    v_mul_f32 v18, v18, v248
    v_accvgpr_write_b32 a164, v18
    v_accvgpr_read_b32 v19, a165
    v_mul_f32 v19, v19, v249
    v_accvgpr_write_b32 a165, v19
    v_accvgpr_read_b32 v18, a166
    v_mul_f32 v18, v18, v250
    v_accvgpr_write_b32 a166, v18
    v_accvgpr_read_b32 v19, a167
    v_mul_f32 v19, v19, v251
    v_accvgpr_write_b32 a167, v19
    v_accvgpr_read_b32 v18, a168
    v_mul_f32 v18, v18, v248
    v_accvgpr_write_b32 a168, v18
    v_accvgpr_read_b32 v19, a169
    v_mul_f32 v19, v19, v249
    v_accvgpr_write_b32 a169, v19
    v_accvgpr_read_b32 v18, a170
    v_mul_f32 v18, v18, v250
    v_accvgpr_write_b32 a170, v18
    v_accvgpr_read_b32 v19, a171
    v_mul_f32 v19, v19, v251
    v_accvgpr_write_b32 a171, v19
    v_accvgpr_read_b32 v18, a172
    v_mul_f32 v18, v18, v248
    v_accvgpr_write_b32 a172, v18
    v_accvgpr_read_b32 v19, a173
    v_mul_f32 v19, v19, v249
    v_accvgpr_write_b32 a173, v19
    v_accvgpr_read_b32 v18, a174
    v_mul_f32 v18, v18, v250
    v_accvgpr_write_b32 a174, v18
    v_accvgpr_read_b32 v19, a175
    v_mul_f32 v19, v19, v251
    v_accvgpr_write_b32 a175, v19
    v_accvgpr_read_b32 v18, a176
    v_mul_f32 v18, v18, v248
    v_accvgpr_write_b32 a176, v18
    v_accvgpr_read_b32 v19, a177
    v_mul_f32 v19, v19, v249
    v_accvgpr_write_b32 a177, v19
    v_accvgpr_read_b32 v18, a178
    v_mul_f32 v18, v18, v250
    v_accvgpr_write_b32 a178, v18
    v_accvgpr_read_b32 v19, a179
    v_mul_f32 v19, v19, v251
    v_accvgpr_write_b32 a179, v19
    v_accvgpr_read_b32 v18, a180
    v_mul_f32 v18, v18, v248
    v_accvgpr_write_b32 a180, v18
    v_accvgpr_read_b32 v19, a181
    v_mul_f32 v19, v19, v249
    v_accvgpr_write_b32 a181, v19
    v_accvgpr_read_b32 v18, a182
    v_mul_f32 v18, v18, v250
    v_accvgpr_write_b32 a182, v18
    v_accvgpr_read_b32 v19, a183
    v_mul_f32 v19, v19, v251
    v_accvgpr_write_b32 a183, v19
    v_accvgpr_read_b32 v18, a184
    v_mul_f32 v18, v18, v248
    v_accvgpr_write_b32 a184, v18
    v_accvgpr_read_b32 v19, a185
    v_mul_f32 v19, v19, v249
    v_accvgpr_write_b32 a185, v19
    v_accvgpr_read_b32 v18, a186
    v_mul_f32 v18, v18, v250
    v_accvgpr_write_b32 a186, v18
    v_accvgpr_read_b32 v19, a187
    v_mul_f32 v19, v19, v251
    v_accvgpr_write_b32 a187, v19
    v_accvgpr_read_b32 v18, a188
    v_mul_f32 v18, v18, v248
    v_accvgpr_write_b32 a188, v18
    v_accvgpr_read_b32 v19, a189
    v_mul_f32 v19, v19, v249
    v_accvgpr_write_b32 a189, v19
    v_accvgpr_read_b32 v18, a190
    v_mul_f32 v18, v18, v250
    v_accvgpr_write_b32 a190, v18
    v_accvgpr_read_b32 v19, a191
    v_mul_f32 v19, v19, v251
    v_accvgpr_write_b32 a191, v19
    s_waitcnt vmcnt(0)
    s_nop 1
    v_mfma_f32_16x16x32_bf16 a[0:3], v[224:227], v[112:115], a[0:3]
    v_mfma_f32_16x16x32_bf16 a[48:51], v[228:231], v[112:115], a[48:51]
    v_mfma_f32_16x16x32_bf16 a[96:99], v[232:235], v[112:115], a[96:99]
    v_mfma_f32_16x16x32_bf16 a[144:147], v[236:239], v[112:115], a[144:147]
    v_mfma_f32_16x16x32_bf16 a[4:7], v[224:227], v[116:119], a[4:7]
    v_mfma_f32_16x16x32_bf16 a[52:55], v[228:231], v[116:119], a[52:55]
    v_mfma_f32_16x16x32_bf16 a[100:103], v[232:235], v[116:119], a[100:103]
    v_mfma_f32_16x16x32_bf16 a[148:151], v[236:239], v[116:119], a[148:151]
    v_mfma_f32_16x16x32_bf16 a[8:11], v[224:227], v[120:123], a[8:11]
    v_mfma_f32_16x16x32_bf16 a[56:59], v[228:231], v[120:123], a[56:59]
    v_mfma_f32_16x16x32_bf16 a[104:107], v[232:235], v[120:123], a[104:107]
    v_mfma_f32_16x16x32_bf16 a[152:155], v[236:239], v[120:123], a[152:155]
    v_mfma_f32_16x16x32_bf16 a[12:15], v[224:227], v[124:127], a[12:15]
    v_mfma_f32_16x16x32_bf16 a[60:63], v[228:231], v[124:127], a[60:63]
    v_mfma_f32_16x16x32_bf16 a[108:111], v[232:235], v[124:127], a[108:111]
    v_mfma_f32_16x16x32_bf16 a[156:159], v[236:239], v[124:127], a[156:159]
    v_mfma_f32_16x16x32_bf16 a[16:19], v[224:227], v[128:131], a[16:19]
    v_mfma_f32_16x16x32_bf16 a[64:67], v[228:231], v[128:131], a[64:67]
    v_mfma_f32_16x16x32_bf16 a[112:115], v[232:235], v[128:131], a[112:115]
    v_mfma_f32_16x16x32_bf16 a[160:163], v[236:239], v[128:131], a[160:163]
    v_mfma_f32_16x16x32_bf16 a[20:23], v[224:227], v[132:135], a[20:23]
    v_mfma_f32_16x16x32_bf16 a[68:71], v[228:231], v[132:135], a[68:71]
    v_mfma_f32_16x16x32_bf16 a[116:119], v[232:235], v[132:135], a[116:119]
    v_mfma_f32_16x16x32_bf16 a[164:167], v[236:239], v[132:135], a[164:167]
    v_mfma_f32_16x16x32_bf16 a[24:27], v[224:227], v[136:139], a[24:27]
    v_mfma_f32_16x16x32_bf16 a[72:75], v[228:231], v[136:139], a[72:75]
    v_mfma_f32_16x16x32_bf16 a[120:123], v[232:235], v[136:139], a[120:123]
    v_mfma_f32_16x16x32_bf16 a[168:171], v[236:239], v[136:139], a[168:171]
    v_mfma_f32_16x16x32_bf16 a[28:31], v[224:227], v[140:143], a[28:31]
    v_mfma_f32_16x16x32_bf16 a[76:79], v[228:231], v[140:143], a[76:79]
    v_mfma_f32_16x16x32_bf16 a[124:127], v[232:235], v[140:143], a[124:127]
    v_mfma_f32_16x16x32_bf16 a[172:175], v[236:239], v[140:143], a[172:175]
    v_mfma_f32_16x16x32_bf16 a[32:35], v[224:227], v[144:147], a[32:35]
    v_mfma_f32_16x16x32_bf16 a[80:83], v[228:231], v[144:147], a[80:83]
    v_mfma_f32_16x16x32_bf16 a[128:131], v[232:235], v[144:147], a[128:131]
    v_mfma_f32_16x16x32_bf16 a[176:179], v[236:239], v[144:147], a[176:179]
    v_mfma_f32_16x16x32_bf16 a[36:39], v[224:227], v[148:151], a[36:39]
    v_mfma_f32_16x16x32_bf16 a[84:87], v[228:231], v[148:151], a[84:87]
    v_mfma_f32_16x16x32_bf16 a[132:135], v[232:235], v[148:151], a[132:135]
    v_mfma_f32_16x16x32_bf16 a[180:183], v[236:239], v[148:151], a[180:183]
    v_mfma_f32_16x16x32_bf16 a[40:43], v[224:227], v[152:155], a[40:43]
    v_mfma_f32_16x16x32_bf16 a[88:91], v[228:231], v[152:155], a[88:91]
    v_mfma_f32_16x16x32_bf16 a[136:139], v[232:235], v[152:155], a[136:139]
    v_mfma_f32_16x16x32_bf16 a[184:187], v[236:239], v[152:155], a[184:187]
    v_mfma_f32_16x16x32_bf16 a[44:47], v[224:227], v[156:159], a[44:47]
    v_mfma_f32_16x16x32_bf16 a[92:95], v[228:231], v[156:159], a[92:95]
    v_mfma_f32_16x16x32_bf16 a[140:143], v[232:235], v[156:159], a[140:143]
    v_mfma_f32_16x16x32_bf16 a[188:191], v[236:239], v[156:159], a[188:191]
    s_add_u32 s48, s48, 24576
    s_cmp_lt_u32 s48, 1572864
    s_nop 7
    s_cbranch_scc1 L_slowloop
    s_nop 1
    v_mfma_f32_16x16x4_f32 v[48:51], v5, v57, 0
    v_mfma_f32_16x16x4_f32 v[52:55], v6, v57, 0
    s_nop 7
    s_nop 1
    v_rcp_f32 v48, v48
    v_rcp_f32 v49, v49
    v_rcp_f32 v50, v50
    v_rcp_f32 v51, v51
    v_rcp_f32 v52, v52
    v_rcp_f32 v53, v53
    v_rcp_f32 v54, v54
    v_rcp_f32 v55, v55
    v_mfma_f32_16x16x4_f32 v[128:131], v7, v57, 0
    v_mfma_f32_16x16x4_f32 v[132:135], v8, v57, 0
    s_nop 7
    s_nop 1
    v_rcp_f32 v128, v128
    v_rcp_f32 v129, v129
    v_rcp_f32 v130, v130
    v_rcp_f32 v131, v131
    v_rcp_f32 v132, v132
    v_rcp_f32 v133, v133
    v_rcp_f32 v134, v134
    v_rcp_f32 v135, v135
    s_nop 0
    v_accvgpr_read_b32 v64, a0
    v_accvgpr_read_b32 v65, a4
    v_accvgpr_read_b32 v66, a8
    v_accvgpr_read_b32 v67, a12
    v_accvgpr_read_b32 v68, a16
    v_accvgpr_read_b32 v69, a20
    v_pk_mul_f32 v[64:65], v[64:65], v[48:49] op_sel_hi:[1,0]
    v_pk_mul_f32 v[66:67], v[66:67], v[48:49] op_sel_hi:[1,0]
    v_pk_mul_f32 v[68:69], v[68:69], v[48:49] op_sel_hi:[1,0]
    v_cvt_pk_bf16_f32 v64, v64, v65
    v_cvt_pk_bf16_f32 v65, v66, v67
    v_cvt_pk_bf16_f32 v66, v68, v69
    v_accvgpr_read_b32 v70, a1
    v_accvgpr_read_b32 v71, a5
    v_accvgpr_read_b32 v72, a9
    v_accvgpr_read_b32 v73, a13
    v_accvgpr_read_b32 v74, a17
    v_accvgpr_read_b32 v75, a21
    v_pk_mul_f32 v[70:71], v[70:71], v[48:49] op_sel:[0,1] op_sel_hi:[1,1]
    v_pk_mul_f32 v[72:73], v[72:73], v[48:49] op_sel:[0,1] op_sel_hi:[1,1]
    v_pk_mul_f32 v[74:75], v[74:75], v[48:49] op_sel:[0,1] op_sel_hi:[1,1]
    v_cvt_pk_bf16_f32 v70, v70, v71
    v_cvt_pk_bf16_f32 v71, v72, v73
    v_cvt_pk_bf16_f32 v72, v74, v75
    buffer_store_dwordx3 v[64:66], v56, s[12:15], s24 offen offset:0 sc0 sc1
    v_accvgpr_read_b32 v76, a2
    v_accvgpr_read_b32 v77, a6
    v_accvgpr_read_b32 v78, a10
    v_accvgpr_read_b32 v79, a14
    v_accvgpr_read_b32 v80, a18
    v_accvgpr_read_b32 v81, a22
    v_pk_mul_f32 v[76:77], v[76:77], v[50:51] op_sel_hi:[1,0]
    v_pk_mul_f32 v[78:79], v[78:79], v[50:51] op_sel_hi:[1,0]
    v_pk_mul_f32 v[80:81], v[80:81], v[50:51] op_sel_hi:[1,0]
    v_cvt_pk_bf16_f32 v76, v76, v77
    v_cvt_pk_bf16_f32 v77, v78, v79
    v_cvt_pk_bf16_f32 v78, v80, v81
    buffer_store_dwordx3 v[70:72], v56, s[12:15], s24 offen offset:384 sc0 sc1
    v_accvgpr_read_b32 v82, a3
    v_accvgpr_read_b32 v83, a7
    v_accvgpr_read_b32 v84, a11
    v_accvgpr_read_b32 v85, a15
    v_accvgpr_read_b32 v86, a19
    v_accvgpr_read_b32 v87, a23
    v_pk_mul_f32 v[82:83], v[82:83], v[50:51] op_sel:[0,1] op_sel_hi:[1,1]
    v_pk_mul_f32 v[84:85], v[84:85], v[50:51] op_sel:[0,1] op_sel_hi:[1,1]
    v_pk_mul_f32 v[86:87], v[86:87], v[50:51] op_sel:[0,1] op_sel_hi:[1,1]
    v_cvt_pk_bf16_f32 v82, v82, v83
    v_cvt_pk_bf16_f32 v83, v84, v85
    v_cvt_pk_bf16_f32 v84, v86, v87
    buffer_store_dwordx3 v[76:78], v56, s[12:15], s24 offen offset:768 sc0 sc1
    v_accvgpr_read_b32 v88, a24
    v_accvgpr_read_b32 v89, a28
    v_accvgpr_read_b32 v90, a32
    v_accvgpr_read_b32 v91, a36
    v_accvgpr_read_b32 v92, a40
    v_accvgpr_read_b32 v93, a44
    v_pk_mul_f32 v[88:89], v[88:89], v[48:49] op_sel_hi:[1,0]
    v_pk_mul_f32 v[90:91], v[90:91], v[48:49] op_sel_hi:[1,0]
    v_pk_mul_f32 v[92:93], v[92:93], v[48:49] op_sel_hi:[1,0]
    v_cvt_pk_bf16_f32 v88, v88, v89
    v_cvt_pk_bf16_f32 v89, v90, v91
    v_cvt_pk_bf16_f32 v90, v92, v93
    buffer_store_dwordx3 v[82:84], v56, s[12:15], s24 offen offset:1152 sc0 sc1
    v_accvgpr_read_b32 v94, a25
    v_accvgpr_read_b32 v95, a29
    v_accvgpr_read_b32 v96, a33
    v_accvgpr_read_b32 v97, a37
    v_accvgpr_read_b32 v98, a41
    v_accvgpr_read_b32 v99, a45
    v_pk_mul_f32 v[94:95], v[94:95], v[48:49] op_sel:[0,1] op_sel_hi:[1,1]
    v_pk_mul_f32 v[96:97], v[96:97], v[48:49] op_sel:[0,1] op_sel_hi:[1,1]
    v_pk_mul_f32 v[98:99], v[98:99], v[48:49] op_sel:[0,1] op_sel_hi:[1,1]
    v_cvt_pk_bf16_f32 v94, v94, v95
    v_cvt_pk_bf16_f32 v95, v96, v97
    v_cvt_pk_bf16_f32 v96, v98, v99
    buffer_store_dwordx3 v[88:90], v56, s[12:15], s24 offen offset:192 sc0 sc1
    v_accvgpr_read_b32 v100, a26
    v_accvgpr_read_b32 v101, a30
    v_accvgpr_read_b32 v102, a34
    v_accvgpr_read_b32 v103, a38
    v_accvgpr_read_b32 v104, a42
    v_accvgpr_read_b32 v105, a46
    v_pk_mul_f32 v[100:101], v[100:101], v[50:51] op_sel_hi:[1,0]
    v_pk_mul_f32 v[102:103], v[102:103], v[50:51] op_sel_hi:[1,0]
    v_pk_mul_f32 v[104:105], v[104:105], v[50:51] op_sel_hi:[1,0]
    v_cvt_pk_bf16_f32 v100, v100, v101
    v_cvt_pk_bf16_f32 v101, v102, v103
    v_cvt_pk_bf16_f32 v102, v104, v105
    buffer_store_dwordx3 v[94:96], v56, s[12:15], s24 offen offset:576 sc0 sc1
    v_accvgpr_read_b32 v106, a27
    v_accvgpr_read_b32 v107, a31
    v_accvgpr_read_b32 v108, a35
    v_accvgpr_read_b32 v109, a39
    v_accvgpr_read_b32 v110, a43
    v_accvgpr_read_b32 v111, a47
    v_pk_mul_f32 v[106:107], v[106:107], v[50:51] op_sel:[0,1] op_sel_hi:[1,1]
    v_pk_mul_f32 v[108:109], v[108:109], v[50:51] op_sel:[0,1] op_sel_hi:[1,1]
    v_pk_mul_f32 v[110:111], v[110:111], v[50:51] op_sel:[0,1] op_sel_hi:[1,1]
    v_cvt_pk_bf16_f32 v106, v106, v107
    v_cvt_pk_bf16_f32 v107, v108, v109
    v_cvt_pk_bf16_f32 v108, v110, v111
    buffer_store_dwordx3 v[100:102], v56, s[12:15], s24 offen offset:960 sc0 sc1
    v_accvgpr_read_b32 v64, a48
    v_accvgpr_read_b32 v65, a52
    v_accvgpr_read_b32 v66, a56
    v_accvgpr_read_b32 v67, a60
    v_accvgpr_read_b32 v68, a64
    v_accvgpr_read_b32 v69, a68
    v_pk_mul_f32 v[64:65], v[64:65], v[52:53] op_sel_hi:[1,0]
    v_pk_mul_f32 v[66:67], v[66:67], v[52:53] op_sel_hi:[1,0]
    v_pk_mul_f32 v[68:69], v[68:69], v[52:53] op_sel_hi:[1,0]
    v_cvt_pk_bf16_f32 v64, v64, v65
    v_cvt_pk_bf16_f32 v65, v66, v67
    v_cvt_pk_bf16_f32 v66, v68, v69
    buffer_store_dwordx3 v[106:108], v56, s[12:15], s24 offen offset:1344 sc0 sc1
    v_accvgpr_read_b32 v70, a49
    v_accvgpr_read_b32 v71, a53
    v_accvgpr_read_b32 v72, a57
    v_accvgpr_read_b32 v73, a61
    v_accvgpr_read_b32 v74, a65
    v_accvgpr_read_b32 v75, a69
    v_pk_mul_f32 v[70:71], v[70:71], v[52:53] op_sel:[0,1] op_sel_hi:[1,1]
    v_pk_mul_f32 v[72:73], v[72:73], v[52:53] op_sel:[0,1] op_sel_hi:[1,1]
    v_pk_mul_f32 v[74:75], v[74:75], v[52:53] op_sel:[0,1] op_sel_hi:[1,1]
    v_cvt_pk_bf16_f32 v70, v70, v71
    v_cvt_pk_bf16_f32 v71, v72, v73
    v_cvt_pk_bf16_f32 v72, v74, v75
    buffer_store_dwordx3 v[64:66], v56, s[12:15], s40 offen offset:0 sc0 sc1
    v_accvgpr_read_b32 v76, a50
    v_accvgpr_read_b32 v77, a54
    v_accvgpr_read_b32 v78, a58
    v_accvgpr_read_b32 v79, a62
    v_accvgpr_read_b32 v80, a66
    v_accvgpr_read_b32 v81, a70
    v_pk_mul_f32 v[76:77], v[76:77], v[54:55] op_sel_hi:[1,0]
    v_pk_mul_f32 v[78:79], v[78:79], v[54:55] op_sel_hi:[1,0]
    v_pk_mul_f32 v[80:81], v[80:81], v[54:55] op_sel_hi:[1,0]
    v_cvt_pk_bf16_f32 v76, v76, v77
    v_cvt_pk_bf16_f32 v77, v78, v79
    v_cvt_pk_bf16_f32 v78, v80, v81
    buffer_store_dwordx3 v[70:72], v56, s[12:15], s40 offen offset:384 sc0 sc1
    v_accvgpr_read_b32 v82, a51
    v_accvgpr_read_b32 v83, a55
    v_accvgpr_read_b32 v84, a59
    v_accvgpr_read_b32 v85, a63
    v_accvgpr_read_b32 v86, a67
    v_accvgpr_read_b32 v87, a71
    v_pk_mul_f32 v[82:83], v[82:83], v[54:55] op_sel:[0,1] op_sel_hi:[1,1]
    v_pk_mul_f32 v[84:85], v[84:85], v[54:55] op_sel:[0,1] op_sel_hi:[1,1]
    v_pk_mul_f32 v[86:87], v[86:87], v[54:55] op_sel:[0,1] op_sel_hi:[1,1]
    v_cvt_pk_bf16_f32 v82, v82, v83
    v_cvt_pk_bf16_f32 v83, v84, v85
    v_cvt_pk_bf16_f32 v84, v86, v87
    buffer_store_dwordx3 v[76:78], v56, s[12:15], s40 offen offset:768 sc0 sc1
    v_accvgpr_read_b32 v88, a72
    v_accvgpr_read_b32 v89, a76
    v_accvgpr_read_b32 v90, a80
    v_accvgpr_read_b32 v91, a84
    v_accvgpr_read_b32 v92, a88
    v_accvgpr_read_b32 v93, a92
    v_pk_mul_f32 v[88:89], v[88:89], v[52:53] op_sel_hi:[1,0]
    v_pk_mul_f32 v[90:91], v[90:91], v[52:53] op_sel_hi:[1,0]
    v_pk_mul_f32 v[92:93], v[92:93], v[52:53] op_sel_hi:[1,0]
    v_cvt_pk_bf16_f32 v88, v88, v89
    v_cvt_pk_bf16_f32 v89, v90, v91
    v_cvt_pk_bf16_f32 v90, v92, v93
    buffer_store_dwordx3 v[82:84], v56, s[12:15], s40 offen offset:1152 sc0 sc1
    v_accvgpr_read_b32 v94, a73
    v_accvgpr_read_b32 v95, a77
    v_accvgpr_read_b32 v96, a81
    v_accvgpr_read_b32 v97, a85
    v_accvgpr_read_b32 v98, a89
    v_accvgpr_read_b32 v99, a93
    v_pk_mul_f32 v[94:95], v[94:95], v[52:53] op_sel:[0,1] op_sel_hi:[1,1]
    v_pk_mul_f32 v[96:97], v[96:97], v[52:53] op_sel:[0,1] op_sel_hi:[1,1]
    v_pk_mul_f32 v[98:99], v[98:99], v[52:53] op_sel:[0,1] op_sel_hi:[1,1]
    v_cvt_pk_bf16_f32 v94, v94, v95
    v_cvt_pk_bf16_f32 v95, v96, v97
    v_cvt_pk_bf16_f32 v96, v98, v99
    buffer_store_dwordx3 v[88:90], v56, s[12:15], s40 offen offset:192 sc0 sc1
    v_accvgpr_read_b32 v100, a74
    v_accvgpr_read_b32 v101, a78
    v_accvgpr_read_b32 v102, a82
    v_accvgpr_read_b32 v103, a86
    v_accvgpr_read_b32 v104, a90
    v_accvgpr_read_b32 v105, a94
    v_pk_mul_f32 v[100:101], v[100:101], v[54:55] op_sel_hi:[1,0]
    v_pk_mul_f32 v[102:103], v[102:103], v[54:55] op_sel_hi:[1,0]
    v_pk_mul_f32 v[104:105], v[104:105], v[54:55] op_sel_hi:[1,0]
    v_cvt_pk_bf16_f32 v100, v100, v101
    v_cvt_pk_bf16_f32 v101, v102, v103
    v_cvt_pk_bf16_f32 v102, v104, v105
    buffer_store_dwordx3 v[94:96], v56, s[12:15], s40 offen offset:576 sc0 sc1
    v_accvgpr_read_b32 v106, a75
    v_accvgpr_read_b32 v107, a79
    v_accvgpr_read_b32 v108, a83
    v_accvgpr_read_b32 v109, a87
    v_accvgpr_read_b32 v110, a91
    v_accvgpr_read_b32 v111, a95
    v_pk_mul_f32 v[106:107], v[106:107], v[54:55] op_sel:[0,1] op_sel_hi:[1,1]
    v_pk_mul_f32 v[108:109], v[108:109], v[54:55] op_sel:[0,1] op_sel_hi:[1,1]
    v_pk_mul_f32 v[110:111], v[110:111], v[54:55] op_sel:[0,1] op_sel_hi:[1,1]
    v_cvt_pk_bf16_f32 v106, v106, v107
    v_cvt_pk_bf16_f32 v107, v108, v109
    v_cvt_pk_bf16_f32 v108, v110, v111
    buffer_store_dwordx3 v[100:102], v56, s[12:15], s40 offen offset:960 sc0 sc1
    v_accvgpr_read_b32 v64, a96
    v_accvgpr_read_b32 v65, a100
    v_accvgpr_read_b32 v66, a104
    v_accvgpr_read_b32 v67, a108
    v_accvgpr_read_b32 v68, a112
    v_accvgpr_read_b32 v69, a116
    v_pk_mul_f32 v[64:65], v[64:65], v[128:129] op_sel_hi:[1,0]
    v_pk_mul_f32 v[66:67], v[66:67], v[128:129] op_sel_hi:[1,0]
    v_pk_mul_f32 v[68:69], v[68:69], v[128:129] op_sel_hi:[1,0]
    v_cvt_pk_bf16_f32 v64, v64, v65
    v_cvt_pk_bf16_f32 v65, v66, v67
    v_cvt_pk_bf16_f32 v66, v68, v69
    buffer_store_dwordx3 v[106:108], v56, s[12:15], s40 offen offset:1344 sc0 sc1
    v_accvgpr_read_b32 v70, a97
    v_accvgpr_read_b32 v71, a101
    v_accvgpr_read_b32 v72, a105
    v_accvgpr_read_b32 v73, a109
    v_accvgpr_read_b32 v74, a113
    v_accvgpr_read_b32 v75, a117
    v_pk_mul_f32 v[70:71], v[70:71], v[128:129] op_sel:[0,1] op_sel_hi:[1,1]
    v_pk_mul_f32 v[72:73], v[72:73], v[128:129] op_sel:[0,1] op_sel_hi:[1,1]
    v_pk_mul_f32 v[74:75], v[74:75], v[128:129] op_sel:[0,1] op_sel_hi:[1,1]
    v_cvt_pk_bf16_f32 v70, v70, v71
    v_cvt_pk_bf16_f32 v71, v72, v73
    v_cvt_pk_bf16_f32 v72, v74, v75
    buffer_store_dwordx3 v[64:66], v56, s[12:15], s41 offen offset:0 sc0 sc1
    v_accvgpr_read_b32 v76, a98
    v_accvgpr_read_b32 v77, a102
    v_accvgpr_read_b32 v78, a106
    v_accvgpr_read_b32 v79, a110
    v_accvgpr_read_b32 v80, a114
    v_accvgpr_read_b32 v81, a118
    v_pk_mul_f32 v[76:77], v[76:77], v[130:131] op_sel_hi:[1,0]
    v_pk_mul_f32 v[78:79], v[78:79], v[130:131] op_sel_hi:[1,0]
    v_pk_mul_f32 v[80:81], v[80:81], v[130:131] op_sel_hi:[1,0]
    v_cvt_pk_bf16_f32 v76, v76, v77
    v_cvt_pk_bf16_f32 v77, v78, v79
    v_cvt_pk_bf16_f32 v78, v80, v81
    buffer_store_dwordx3 v[70:72], v56, s[12:15], s41 offen offset:384 sc0 sc1
    v_accvgpr_read_b32 v82, a99
    v_accvgpr_read_b32 v83, a103
    v_accvgpr_read_b32 v84, a107
    v_accvgpr_read_b32 v85, a111
    v_accvgpr_read_b32 v86, a115
    v_accvgpr_read_b32 v87, a119
    v_pk_mul_f32 v[82:83], v[82:83], v[130:131] op_sel:[0,1] op_sel_hi:[1,1]
    v_pk_mul_f32 v[84:85], v[84:85], v[130:131] op_sel:[0,1] op_sel_hi:[1,1]
    v_pk_mul_f32 v[86:87], v[86:87], v[130:131] op_sel:[0,1] op_sel_hi:[1,1]
    v_cvt_pk_bf16_f32 v82, v82, v83
    v_cvt_pk_bf16_f32 v83, v84, v85
    v_cvt_pk_bf16_f32 v84, v86, v87
    buffer_store_dwordx3 v[76:78], v56, s[12:15], s41 offen offset:768 sc0 sc1
    v_accvgpr_read_b32 v88, a120
    v_accvgpr_read_b32 v89, a124
    v_accvgpr_read_b32 v90, a128
    v_accvgpr_read_b32 v91, a132
    v_accvgpr_read_b32 v92, a136
    v_accvgpr_read_b32 v93, a140
    v_pk_mul_f32 v[88:89], v[88:89], v[128:129] op_sel_hi:[1,0]
    v_pk_mul_f32 v[90:91], v[90:91], v[128:129] op_sel_hi:[1,0]
    v_pk_mul_f32 v[92:93], v[92:93], v[128:129] op_sel_hi:[1,0]
    v_cvt_pk_bf16_f32 v88, v88, v89
    v_cvt_pk_bf16_f32 v89, v90, v91
    v_cvt_pk_bf16_f32 v90, v92, v93
    buffer_store_dwordx3 v[82:84], v56, s[12:15], s41 offen offset:1152 sc0 sc1
    v_accvgpr_read_b32 v94, a121
    v_accvgpr_read_b32 v95, a125
    v_accvgpr_read_b32 v96, a129
    v_accvgpr_read_b32 v97, a133
    v_accvgpr_read_b32 v98, a137
    v_accvgpr_read_b32 v99, a141
    v_pk_mul_f32 v[94:95], v[94:95], v[128:129] op_sel:[0,1] op_sel_hi:[1,1]
    v_pk_mul_f32 v[96:97], v[96:97], v[128:129] op_sel:[0,1] op_sel_hi:[1,1]
    v_pk_mul_f32 v[98:99], v[98:99], v[128:129] op_sel:[0,1] op_sel_hi:[1,1]
    v_cvt_pk_bf16_f32 v94, v94, v95
    v_cvt_pk_bf16_f32 v95, v96, v97
    v_cvt_pk_bf16_f32 v96, v98, v99
    buffer_store_dwordx3 v[88:90], v56, s[12:15], s41 offen offset:192 sc0 sc1
    v_accvgpr_read_b32 v100, a122
    v_accvgpr_read_b32 v101, a126
    v_accvgpr_read_b32 v102, a130
    v_accvgpr_read_b32 v103, a134
    v_accvgpr_read_b32 v104, a138
    v_accvgpr_read_b32 v105, a142
    v_pk_mul_f32 v[100:101], v[100:101], v[130:131] op_sel_hi:[1,0]
    v_pk_mul_f32 v[102:103], v[102:103], v[130:131] op_sel_hi:[1,0]
    v_pk_mul_f32 v[104:105], v[104:105], v[130:131] op_sel_hi:[1,0]
    v_cvt_pk_bf16_f32 v100, v100, v101
    v_cvt_pk_bf16_f32 v101, v102, v103
    v_cvt_pk_bf16_f32 v102, v104, v105
    buffer_store_dwordx3 v[94:96], v56, s[12:15], s41 offen offset:576 sc0 sc1
    v_accvgpr_read_b32 v106, a123
    v_accvgpr_read_b32 v107, a127
    v_accvgpr_read_b32 v108, a131
    v_accvgpr_read_b32 v109, a135
    v_accvgpr_read_b32 v110, a139
    v_accvgpr_read_b32 v111, a143
    v_pk_mul_f32 v[106:107], v[106:107], v[130:131] op_sel:[0,1] op_sel_hi:[1,1]
    v_pk_mul_f32 v[108:109], v[108:109], v[130:131] op_sel:[0,1] op_sel_hi:[1,1]
    v_pk_mul_f32 v[110:111], v[110:111], v[130:131] op_sel:[0,1] op_sel_hi:[1,1]
    v_cvt_pk_bf16_f32 v106, v106, v107
    v_cvt_pk_bf16_f32 v107, v108, v109
    v_cvt_pk_bf16_f32 v108, v110, v111
    buffer_store_dwordx3 v[100:102], v56, s[12:15], s41 offen offset:960 sc0 sc1
    v_accvgpr_read_b32 v64, a144
    v_accvgpr_read_b32 v65, a148
    v_accvgpr_read_b32 v66, a152
    v_accvgpr_read_b32 v67, a156
    v_accvgpr_read_b32 v68, a160
    v_accvgpr_read_b32 v69, a164
    v_pk_mul_f32 v[64:65], v[64:65], v[132:133] op_sel_hi:[1,0]
    v_pk_mul_f32 v[66:67], v[66:67], v[132:133] op_sel_hi:[1,0]
    v_pk_mul_f32 v[68:69], v[68:69], v[132:133] op_sel_hi:[1,0]
    v_cvt_pk_bf16_f32 v64, v64, v65
    v_cvt_pk_bf16_f32 v65, v66, v67
    v_cvt_pk_bf16_f32 v66, v68, v69
    buffer_store_dwordx3 v[106:108], v56, s[12:15], s41 offen offset:1344 sc0 sc1
    v_accvgpr_read_b32 v70, a145
    v_accvgpr_read_b32 v71, a149
    v_accvgpr_read_b32 v72, a153
    v_accvgpr_read_b32 v73, a157
    v_accvgpr_read_b32 v74, a161
    v_accvgpr_read_b32 v75, a165
    v_pk_mul_f32 v[70:71], v[70:71], v[132:133] op_sel:[0,1] op_sel_hi:[1,1]
    v_pk_mul_f32 v[72:73], v[72:73], v[132:133] op_sel:[0,1] op_sel_hi:[1,1]
    v_pk_mul_f32 v[74:75], v[74:75], v[132:133] op_sel:[0,1] op_sel_hi:[1,1]
    v_cvt_pk_bf16_f32 v70, v70, v71
    v_cvt_pk_bf16_f32 v71, v72, v73
    v_cvt_pk_bf16_f32 v72, v74, v75
    buffer_store_dwordx3 v[64:66], v56, s[12:15], s42 offen offset:0 sc0 sc1
    v_accvgpr_read_b32 v76, a146
    v_accvgpr_read_b32 v77, a150
    v_accvgpr_read_b32 v78, a154
    v_accvgpr_read_b32 v79, a158
    v_accvgpr_read_b32 v80, a162
    v_accvgpr_read_b32 v81, a166
    v_pk_mul_f32 v[76:77], v[76:77], v[134:135] op_sel_hi:[1,0]
    v_pk_mul_f32 v[78:79], v[78:79], v[134:135] op_sel_hi:[1,0]
    v_pk_mul_f32 v[80:81], v[80:81], v[134:135] op_sel_hi:[1,0]
    v_cvt_pk_bf16_f32 v76, v76, v77
    v_cvt_pk_bf16_f32 v77, v78, v79
    v_cvt_pk_bf16_f32 v78, v80, v81
    buffer_store_dwordx3 v[70:72], v56, s[12:15], s42 offen offset:384 sc0 sc1
    v_accvgpr_read_b32 v82, a147
    v_accvgpr_read_b32 v83, a151
    v_accvgpr_read_b32 v84, a155
    v_accvgpr_read_b32 v85, a159
    v_accvgpr_read_b32 v86, a163
    v_accvgpr_read_b32 v87, a167
    v_pk_mul_f32 v[82:83], v[82:83], v[134:135] op_sel:[0,1] op_sel_hi:[1,1]
    v_pk_mul_f32 v[84:85], v[84:85], v[134:135] op_sel:[0,1] op_sel_hi:[1,1]
    v_pk_mul_f32 v[86:87], v[86:87], v[134:135] op_sel:[0,1] op_sel_hi:[1,1]
    v_cvt_pk_bf16_f32 v82, v82, v83
    v_cvt_pk_bf16_f32 v83, v84, v85
    v_cvt_pk_bf16_f32 v84, v86, v87
    buffer_store_dwordx3 v[76:78], v56, s[12:15], s42 offen offset:768 sc0 sc1
    v_accvgpr_read_b32 v88, a168
    v_accvgpr_read_b32 v89, a172
    v_accvgpr_read_b32 v90, a176
    v_accvgpr_read_b32 v91, a180
    v_accvgpr_read_b32 v92, a184
    v_accvgpr_read_b32 v93, a188
    v_pk_mul_f32 v[88:89], v[88:89], v[132:133] op_sel_hi:[1,0]
    v_pk_mul_f32 v[90:91], v[90:91], v[132:133] op_sel_hi:[1,0]
    v_pk_mul_f32 v[92:93], v[92:93], v[132:133] op_sel_hi:[1,0]
    v_cvt_pk_bf16_f32 v88, v88, v89
    v_cvt_pk_bf16_f32 v89, v90, v91
    v_cvt_pk_bf16_f32 v90, v92, v93
    buffer_store_dwordx3 v[82:84], v56, s[12:15], s42 offen offset:1152 sc0 sc1
    v_accvgpr_read_b32 v94, a169
    v_accvgpr_read_b32 v95, a173
    v_accvgpr_read_b32 v96, a177
    v_accvgpr_read_b32 v97, a181
    v_accvgpr_read_b32 v98, a185
    v_accvgpr_read_b32 v99, a189
    v_pk_mul_f32 v[94:95], v[94:95], v[132:133] op_sel:[0,1] op_sel_hi:[1,1]
    v_pk_mul_f32 v[96:97], v[96:97], v[132:133] op_sel:[0,1] op_sel_hi:[1,1]
    v_pk_mul_f32 v[98:99], v[98:99], v[132:133] op_sel:[0,1] op_sel_hi:[1,1]
    v_cvt_pk_bf16_f32 v94, v94, v95
    v_cvt_pk_bf16_f32 v95, v96, v97
    v_cvt_pk_bf16_f32 v96, v98, v99
    buffer_store_dwordx3 v[88:90], v56, s[12:15], s42 offen offset:192 sc0 sc1
    v_accvgpr_read_b32 v100, a170
    v_accvgpr_read_b32 v101, a174
    v_accvgpr_read_b32 v102, a178
    v_accvgpr_read_b32 v103, a182
    v_accvgpr_read_b32 v104, a186
    v_accvgpr_read_b32 v105, a190
    v_pk_mul_f32 v[100:101], v[100:101], v[134:135] op_sel_hi:[1,0]
    v_pk_mul_f32 v[102:103], v[102:103], v[134:135] op_sel_hi:[1,0]
    v_pk_mul_f32 v[104:105], v[104:105], v[134:135] op_sel_hi:[1,0]
    v_cvt_pk_bf16_f32 v100, v100, v101
    v_cvt_pk_bf16_f32 v101, v102, v103
    v_cvt_pk_bf16_f32 v102, v104, v105
    buffer_store_dwordx3 v[94:96], v56, s[12:15], s42 offen offset:576 sc0 sc1
    v_accvgpr_read_b32 v106, a171
    v_accvgpr_read_b32 v107, a175
    v_accvgpr_read_b32 v108, a179
    v_accvgpr_read_b32 v109, a183
    v_accvgpr_read_b32 v110, a187
    v_accvgpr_read_b32 v111, a191
    v_pk_mul_f32 v[106:107], v[106:107], v[134:135] op_sel:[0,1] op_sel_hi:[1,1]
    v_pk_mul_f32 v[108:109], v[108:109], v[134:135] op_sel:[0,1] op_sel_hi:[1,1]
    v_pk_mul_f32 v[110:111], v[110:111], v[134:135] op_sel:[0,1] op_sel_hi:[1,1]
    v_cvt_pk_bf16_f32 v106, v106, v107
    v_cvt_pk_bf16_f32 v107, v108, v109
    v_cvt_pk_bf16_f32 v108, v110, v111
    buffer_store_dwordx3 v[100:102], v56, s[12:15], s42 offen offset:960 sc0 sc1
    buffer_store_dwordx3 v[106:108], v56, s[12:15], s42 offen offset:1344 sc0 sc1
    s_branch L_fin
.section .rodata,"a"
.p2align 6
.amdhsa_kernel standalone__kv_cache_quant_int4_int2_kv_with_per_channel_or_per_token_scales__prompt_kernel
  .amdhsa_next_free_vgpr 512
  .amdhsa_next_free_sgpr 102
  .amdhsa_accum_offset 256
  .amdhsa_group_segment_fixed_size 0
  .amdhsa_kernarg_size 80
  .amdhsa_user_sgpr_count 2
  .amdhsa_user_sgpr_kernarg_segment_ptr 1
  .amdhsa_system_sgpr_workgroup_id_x 1
.end_amdhsa_kernel
```

```asm
; @launch grid=(256,1,1) block=(256,1,1) lds=147584
.amdgcn_target "amdgcn-amd-amdhsa--gfx950"
.text
.globl standalone__kv_cache_quant_int4_int2_kv_with_per_channel_or_per_token_scales__prompt_kernel
.p2align 8
.type standalone__kv_cache_quant_int4_int2_kv_with_per_channel_or_per_token_scales__prompt_kernel,@function
standalone__kv_cache_quant_int4_int2_kv_with_per_channel_or_per_token_scales__prompt_kernel:
    s_cmp_ge_u32 s2, 256
    s_cbranch_scc1 L_done
    s_load_dwordx16 s[40:55], s[0:1], 0
    s_load_dwordx4 s[16:19], s[0:1], 64
    s_and_b32 s94, s2, 7
    s_lshr_b32 s95, s2, 3
    s_lshr_b32 s24, s95, 3
    s_lshl_b32 s94, s94, 2
    s_add_u32 s94, s94, s24
    s_and_b32 s95, s95, 7
    s_getpc_b64 s[60:61]
L_pc:
    s_sub_u32 s60, s60, L_pc-standalone__kv_cache_quant_int4_int2_kv_with_per_channel_or_per_token_scales__prompt_kernel
    s_subb_u32 s61, s61, 0
    s_mov_b32 s62, L_slow-standalone__kv_cache_quant_int4_int2_kv_with_per_channel_or_per_token_scales__prompt_kernel
    s_mov_b32 s63, 0x20000
    s_lshr_b32 s22, s2, 3
    s_lshl_b32 s22, s22, 12
    v_lshlrev_b32 v30, 4, v0
    buffer_load_dwordx4 v[128:131], v30, s[60:63], s22 offen
    v_lshrrev_b32 v24, 6, v0
    v_and_b32 v25, 63, v0
    v_readfirstlane_b32 s25, v24
    v_lshlrev_b32 v1, 4, v25
    v_mul_u32_u24 v26, 43, v25
    v_lshrrev_b32 v26, 10, v26
    v_mul_u32_u24 v27, 24, v26
    v_sub_u32 v27, v25, v27
    v_lshrrev_b32 v28, 1, v24
    v_and_b32 v29, 1, v24
    v_lshlrev_b32 v30, 4, v29
    v_lshl_add_u32 v30, v28, 2, v30
    v_add_u32 v30, v30, v26
    v_mul_u32_u24 v30, 768, v30
    v_lshrrev_b32 v48, 1, v26
    v_lshlrev_b32 v48, 30, v48
    v_lshl_add_u32 v30, v27, 4, v30
    v_or_b32 v9, v30, v48
    v_lshl_or_b32 v10, v27, 3, v48
    v_mul_u32_u24 v30, 6144, v24
    v_mul_u32_u24 v31, 12, v25
    v_add_u32 v12, v30, v31
    s_mov_b32 s66, 1572864
    s_mov_b32 s67, 0x20000
    s_mov_b32 s70, 1572864
    s_mov_b32 s71, 0x20000
    s_mov_b32 s74, 12288
    s_mov_b32 s75, 0x20000
    s_mov_b32 s78, 12288
    s_mov_b32 s79, 0x20000
    s_mov_b32 s82, 4096
    s_mov_b32 s83, 0x20000
    s_mov_b32 s86, 4096
    s_mov_b32 s87, 0x20000
    s_mov_b32 s22, 64
    s_mov_b32 s23, 0x20000
    s_mul_i32 s33, s95, 24576
    s_add_u32 s34, s33, 6144
    s_mov_b32 s35, s33
    s_lshr_b32 s36, s95, 1
    s_mul_i32 s36, s36, 384
    s_lshl_b32 s37, s95, 6
    s_lshl_b32 s24, s25, 4
    s_add_u32 s37, s37, s24
    s_mul_i32 s24, s94, 1572864
    s_mul_i32 s56, s94, 12288
    s_lshl_b32 s57, s94, 12
    s_lshl_b32 s58, s94, 10
    s_add_u32 s58, s58, 51380320
    s_or_b32 s39, s95, s25
    s_waitcnt lgkmcnt(0)
    s_add_u32 s64, s42, s24
    s_addc_u32 s65, s43, 0
    s_add_u32 s72, s46, s56
    s_addc_u32 s73, s47, 0
    s_add_u32 s76, s48, s56
    s_addc_u32 s77, s49, 0
    buffer_load_dwordx4 v[224:227], v9, s[64:67], s33 offen offset:0 nt
    buffer_load_dwordx4 v[228:231], v9, s[64:67], s33 offen offset:1536 nt
    buffer_load_dwordx4 v[232:235], v9, s[64:67], s34 offen offset:0 nt
    buffer_load_dwordx4 v[236:239], v9, s[64:67], s34 offen offset:1536 nt
    buffer_load_dwordx2 v[32:33], v10, s[72:75], s36 offen offset:0
    buffer_load_dwordx2 v[34:35], v10, s[76:79], s36 offen offset:0
    buffer_load_dwordx2 v[36:37], v10, s[72:75], s36 offen offset:192
    buffer_load_dwordx2 v[38:39], v10, s[76:79], s36 offen offset:192
    s_add_u32 s20, s18, s58
    s_addc_u32 s21, s19, 0
    s_add_u32 s80, s50, s57
    s_addc_u32 s81, s51, 0
    s_add_u32 s84, s52, s57
    s_addc_u32 s85, s53, 0
    s_add_u32 s68, s44, s24
    s_addc_u32 s69, s45, 0
    s_mul_i32 s59, s94, 786432
    s_add_u32 s12, s54, s59
    s_addc_u32 s13, s55, 0
    s_add_u32 s8, s40, s59
    s_addc_u32 s9, s41, 0
    s_cmp_lg_u32 s39, 0
    s_cbranch_scc1 L_notleader0
    s_buffer_load_dwordx16 s[40:55], s[20:23], 0 glc
L_notleader0:
    buffer_load_dwordx4 v[240:243], v9, s[64:67], s33 offen offset:384 nt
    buffer_load_dwordx4 v[244:247], v9, s[64:67], s33 offen offset:1920 nt
    buffer_load_dwordx4 v[248:251], v9, s[64:67], s34 offen offset:384 nt
    buffer_load_dwordx4 v[252:255], v9, s[64:67], s34 offen offset:1920 nt
    s_add_u32 s4, s18, s24
    s_addc_u32 s5, s19, 0
    s_mov_b32 s6, 1572864
    s_mov_b32 s7, 0x20000
    s_mov_b32 s10, 786432
    s_mov_b32 s11, 0x20000
    s_mov_b32 s88, s16
    s_mov_b32 s89, s17
    s_add_u32 s16, s33, 3072
    s_add_u32 s17, s33, 6144
    s_mov_b32 s90, 256
    s_mov_b32 s91, 0x20000
    s_lshl_b32 s93, s94, 3
    s_cmp_lg_u32 s39, 0
    s_cbranch_scc1 L_notleader
    s_waitcnt lgkmcnt(0)
    s_mov_b32 s59, 1
    s_lshr_b32 s40, s40, 10
    s_min_u32 s40, s40, 31
    s_bitset1_b32 s59, s40
    s_lshr_b32 s41, s41, 10
    s_min_u32 s41, s41, 31
    s_bitset1_b32 s59, s41
    s_lshr_b32 s42, s42, 10
    s_min_u32 s42, s42, 31
    s_bitset1_b32 s59, s42
    s_lshr_b32 s43, s43, 10
    s_min_u32 s43, s43, 31
    s_bitset1_b32 s59, s43
    s_lshr_b32 s44, s44, 10
    s_min_u32 s44, s44, 31
    s_bitset1_b32 s59, s44
    s_lshr_b32 s45, s45, 10
    s_min_u32 s45, s45, 31
    s_bitset1_b32 s59, s45
    s_lshr_b32 s46, s46, 10
    s_min_u32 s46, s46, 31
    s_bitset1_b32 s59, s46
    s_lshr_b32 s47, s47, 10
    s_min_u32 s47, s47, 31
    s_bitset1_b32 s59, s47
    s_lshr_b32 s48, s48, 10
    s_min_u32 s48, s48, 31
    s_bitset1_b32 s59, s48
    s_lshr_b32 s49, s49, 10
    s_min_u32 s49, s49, 31
    s_bitset1_b32 s59, s49
    s_lshr_b32 s50, s50, 10
    s_min_u32 s50, s50, 31
    s_bitset1_b32 s59, s50
    s_lshr_b32 s51, s51, 10
    s_min_u32 s51, s51, 31
    s_bitset1_b32 s59, s51
    s_lshr_b32 s52, s52, 10
    s_min_u32 s52, s52, 31
    s_bitset1_b32 s59, s52
    s_lshr_b32 s53, s53, 10
    s_min_u32 s53, s53, 31
    s_bitset1_b32 s59, s53
    s_lshr_b32 s54, s54, 10
    s_min_u32 s54, s54, 31
    s_bitset1_b32 s59, s54
    s_lshr_b32 s55, s55, 10
    s_min_u32 s55, s55, 31
    s_bitset1_b32 s59, s55
    s_ff0_i32_b32 s59, s59
    s_lshl_b32 s59, s59, 10
    v_mov_b32 v52, s59
    s_mov_b64 exec, 1
    buffer_store_dword v52, off, s[88:91], s93 sc1
    s_mov_b64 exec, -1
L_notleader:
    s_lshl_b32 s24, s95, 2
    s_add_u32 s24, s24, 32
    s_buffer_load_dword s46, s[20:23], s24 glc
    s_getreg_b32 s45, hwreg(HW_REG_XCC_ID, 0, 4)
    s_lshl_b32 s45, s45, 5
    s_mov_b32 s44, 32
    buffer_load_dwordx3 v[112:114], v12, s[68:71], s35 offen offset:0 nt
    buffer_load_dwordx3 v[116:118], v12, s[68:71], s35 offen offset:768 nt
    buffer_load_dwordx3 v[120:122], v12, s[68:71], s35 offen offset:1536 nt
    buffer_load_dwordx3 v[124:126], v12, s[68:71], s35 offen offset:2304 nt
    buffer_load_dwordx2 v[40:41], off, s[80:83], s37 offset:0
    buffer_load_dwordx2 v[42:43], off, s[84:87], s37 offset:0
    buffer_load_dwordx2 v[44:45], off, s[80:83], s37 offset:8
    buffer_load_dwordx2 v[46:47], off, s[84:87], s37 offset:8
    s_mov_b32 s14, 786432
    s_mov_b32 s15, 0x20000
    s_lshl_b32 s24, s25, 8
    s_add_u32 s93, s93, s24
    v_mul_u32_u24 v30, 3072, v24
    v_add_u32 v4, v30, v1
    v_lshl_add_u32 v30, v24, 3, v26
    v_mul_u32_u24 v30, 384, v30
    v_lshlrev_b32 v31, 2, v29
    v_xor_b32 v31, v27, v31
    v_lshl_add_u32 v30, v31, 4, v30
    v_or_b32 v11, v30, v48
    v_lshlrev_b32 v30, 8, v24
    v_add_u32 v30, 12288, v30
    v_lshrrev_b32 v31, 5, v25
    v_mul_u32_u24 v31, 6144, v31
    v_add_u32 v30, v30, v31
    v_and_b32 v31, 1, v25
    v_mul_u32_u24 v31, 3072, v31
    v_add_u32 v30, v30, v31
    v_bfe_u32 v31, v25, 1, 4
    v_lshl_add_u32 v15, v31, 4, v30
    s_lshl_b32 s24, s95, 2
    v_lshl_add_u32 v13, v0, 2, s24
    v_cmp_lt_u32 vcc, 0, v0
    v_mov_b32 v30, 0x40000000
    s_nop 0
    v_cndmask_b32 v13, v13, v30, vcc
    s_mul_i32 s26, s25, 3072
    s_add_u32 s26, s26, 12288
    s_add_u32 s56, s26, 24576
    s_add_u32 s24, s95, 1
    s_and_b32 s24, s24, 7
    s_mul_i32 s32, s24, 24576
    s_add_u32 s27, s32, 12288
    s_mov_b32 s28, 98304
    s_mov_b32 s30, 73728
    v_add_u32 v1, 24576, v1
    s_mov_b32 s38, 0x3dd53b95
    s_mov_b32 s97, 0xffff0000
    s_mov_b32 s96, 100000
    v_and_b32 v26, 15, v25
    v_lshrrev_b32 v27, 4, v25
    v_bfe_u32 v28, v25, 1, 3
    v_xor_b32 v29, v27, v28
    v_mul_u32_u24 v30, 384, v26
    v_lshl_add_u32 v2, v29, 4, v30
    v_xor_b32 v3, 64, v2
    s_mul_i32 s40, s25, 6144
    s_add_u32 s40, s40, 73728
    v_lshrrev_b32 v29, 1, v27
    v_xor_b32 v29, v29, v28
    v_lshl_add_u32 v31, v29, 4, v30
    v_and_b32 v29, 1, v27
    v_lshl_add_u32 v31, v29, 3, v31
    v_xor_b32 v22, 0, v31
    v_add_u32 v22, s40, v22
    v_xor_b32 v23, 32, v31
    v_add_u32 v23, s40, v23
    v_xor_b32 v142, 64, v31
    v_add_u32 v142, s40, v142
    v_xor_b32 v143, 96, v31
    v_add_u32 v143, s40, v143
    s_lshl_b32 s24, s95, 2
    s_add_u32 s24, s24, s25
    s_mul_i32 s24, s24, 24576
    v_add_u32 v26, 0, v25
    v_mul_u32_u24 v27, 2731, v26
    v_lshrrev_b32 v27, 17, v27
    v_and_b32 v27, 7, v27
    v_xor_b32 v26, v26, v27
    v_lshlrev_b32 v136, 4, v26
    v_add_u32 v136, s24, v136
    v_add_u32 v26, 64, v25
    v_mul_u32_u24 v27, 2731, v26
    v_lshrrev_b32 v27, 17, v27
    v_and_b32 v27, 7, v27
    v_xor_b32 v26, v26, v27
    v_lshlrev_b32 v137, 4, v26
    v_add_u32 v137, s24, v137
    v_add_u32 v26, 128, v25
    v_mul_u32_u24 v27, 2731, v26
    v_lshrrev_b32 v27, 17, v27
    v_and_b32 v27, 7, v27
    v_xor_b32 v26, v26, v27
    v_lshlrev_b32 v138, 4, v26
    v_add_u32 v138, s24, v138
    v_add_u32 v26, 192, v25
    v_mul_u32_u24 v27, 2731, v26
    v_lshrrev_b32 v27, 17, v27
    v_and_b32 v27, 7, v27
    v_xor_b32 v26, v26, v27
    v_lshlrev_b32 v139, 4, v26
    v_add_u32 v139, s24, v139
    v_add_u32 v26, 256, v25
    v_mul_u32_u24 v27, 2731, v26
    v_lshrrev_b32 v27, 17, v27
    v_and_b32 v27, 7, v27
    v_xor_b32 v26, v26, v27
    v_lshlrev_b32 v140, 4, v26
    v_add_u32 v140, s24, v140
    v_add_u32 v26, 320, v25
    v_mul_u32_u24 v27, 2731, v26
    v_lshrrev_b32 v27, 17, v27
    v_and_b32 v27, 7, v27
    v_xor_b32 v26, v26, v27
    v_lshlrev_b32 v141, 4, v26
    v_add_u32 v141, s24, v141
    v_mov_b32 v5, 0
    v_mov_b32 v6, 0
    v_mov_b32 v7, 0
    v_mov_b32 v8, 0
    s_mov_b32 s62, -1
    s_mov_b32 s63, 0xffff
    s_waitcnt vmcnt(12)
    buffer_load_dwordx3 v[80:82], v12, s[68:71], s16 offen offset:0 nt
    buffer_load_dwordx3 v[84:86], v12, s[68:71], s16 offen offset:768 nt
    buffer_load_dwordx3 v[88:90], v12, s[68:71], s16 offen offset:1536 nt
    buffer_load_dwordx3 v[92:94], v12, s[68:71], s16 offen offset:2304 nt
    v_lshlrev_b32 v48, 16, v32
    v_and_b32 v49, s97, v32
    v_lshlrev_b32 v50, 16, v34
    v_and_b32 v51, s97, v34
    v_mul_f32 v48, s38, v48
    v_mul_f32 v49, s38, v49
    v_mul_f32_e64 v50, -v50, v48
    v_mul_f32_e64 v51, -v51, v49
    v_cvt_f32_i32 v224, v224
    v_cvt_f32_i32 v225, v225
    v_fma_f32 v224, v224, v48, v50
    v_fma_f32 v225, v225, v49, v51
    v_cvt_pk_bf16_f32 v224, v224, v225
    v_cvt_f32_i32 v228, v228
    v_cvt_f32_i32 v229, v229
    v_fma_f32 v228, v228, v48, v50
    v_fma_f32 v229, v229, v49, v51
    v_cvt_pk_bf16_f32 v228, v228, v229
    v_cvt_f32_i32 v232, v232
    v_cvt_f32_i32 v233, v233
    v_fma_f32 v232, v232, v48, v50
    v_fma_f32 v233, v233, v49, v51
    v_cvt_pk_bf16_f32 v232, v232, v233
    v_cvt_f32_i32 v236, v236
    v_cvt_f32_i32 v237, v237
    v_fma_f32 v236, v236, v48, v50
    v_fma_f32 v237, v237, v49, v51
    v_cvt_pk_bf16_f32 v236, v236, v237
    v_lshlrev_b32 v48, 16, v33
    v_and_b32 v49, s97, v33
    v_lshlrev_b32 v50, 16, v35
    v_and_b32 v51, s97, v35
    v_mul_f32 v48, s38, v48
    v_mul_f32 v49, s38, v49
    v_mul_f32_e64 v50, -v50, v48
    v_mul_f32_e64 v51, -v51, v49
    v_cvt_f32_i32 v226, v226
    v_cvt_f32_i32 v227, v227
    v_fma_f32 v226, v226, v48, v50
    v_fma_f32 v227, v227, v49, v51
    v_cvt_pk_bf16_f32 v225, v226, v227
    v_cvt_f32_i32 v230, v230
    v_cvt_f32_i32 v231, v231
    v_fma_f32 v230, v230, v48, v50
    v_fma_f32 v231, v231, v49, v51
    v_cvt_pk_bf16_f32 v229, v230, v231
    v_cvt_f32_i32 v234, v234
    v_cvt_f32_i32 v235, v235
    v_fma_f32 v234, v234, v48, v50
    v_fma_f32 v235, v235, v49, v51
    v_cvt_pk_bf16_f32 v233, v234, v235
    v_cvt_f32_i32 v238, v238
    v_cvt_f32_i32 v239, v239
    v_fma_f32 v238, v238, v48, v50
    v_fma_f32 v239, v239, v49, v51
    v_cvt_pk_bf16_f32 v237, v238, v239
    s_waitcnt vmcnt(12)
    v_lshlrev_b32 v48, 16, v36
    v_and_b32 v49, s97, v36
    v_lshlrev_b32 v50, 16, v38
    v_and_b32 v51, s97, v38
    v_mul_f32 v48, s38, v48
    v_mul_f32 v49, s38, v49
    v_mul_f32_e64 v50, -v50, v48
    v_mul_f32_e64 v51, -v51, v49
    v_cvt_f32_i32 v240, v240
    v_cvt_f32_i32 v241, v241
    v_fma_f32 v240, v240, v48, v50
    v_fma_f32 v241, v241, v49, v51
    v_cvt_pk_bf16_f32 v226, v240, v241
    v_cvt_f32_i32 v244, v244
    v_cvt_f32_i32 v245, v245
    v_fma_f32 v244, v244, v48, v50
    v_fma_f32 v245, v245, v49, v51
    v_cvt_pk_bf16_f32 v230, v244, v245
    v_cvt_f32_i32 v248, v248
    v_cvt_f32_i32 v249, v249
    v_fma_f32 v248, v248, v48, v50
    v_fma_f32 v249, v249, v49, v51
    v_cvt_pk_bf16_f32 v234, v248, v249
    v_cvt_f32_i32 v252, v252
    v_cvt_f32_i32 v253, v253
    v_fma_f32 v252, v252, v48, v50
    v_fma_f32 v253, v253, v49, v51
    v_cvt_pk_bf16_f32 v238, v252, v253
    v_lshlrev_b32 v48, 16, v37
    v_and_b32 v49, s97, v37
    v_lshlrev_b32 v50, 16, v39
    v_and_b32 v51, s97, v39
    v_mul_f32 v48, s38, v48
    v_mul_f32 v49, s38, v49
    v_mul_f32_e64 v50, -v50, v48
    v_mul_f32_e64 v51, -v51, v49
    v_cvt_f32_i32 v242, v242
    v_cvt_f32_i32 v243, v243
    v_fma_f32 v242, v242, v48, v50
    v_fma_f32 v243, v243, v49, v51
    v_cvt_pk_bf16_f32 v227, v242, v243
    v_cvt_f32_i32 v246, v246
    v_cvt_f32_i32 v247, v247
    v_fma_f32 v246, v246, v48, v50
    v_fma_f32 v247, v247, v49, v51
    v_cvt_pk_bf16_f32 v231, v246, v247
    v_cvt_f32_i32 v250, v250
    v_cvt_f32_i32 v251, v251
    v_fma_f32 v250, v250, v48, v50
    v_fma_f32 v251, v251, v49, v51
    v_cvt_pk_bf16_f32 v235, v250, v251
    v_cvt_f32_i32 v254, v254
    v_cvt_f32_i32 v255, v255
    v_fma_f32 v254, v254, v48, v50
    v_fma_f32 v255, v255, v49, v51
    v_cvt_pk_bf16_f32 v239, v254, v255
    buffer_store_dwordx4 v[224:227], v11, s[4:7], s33 offen offset:0
    s_mov_b64 exec, s[62:63]
    ds_write_b128 v11, v[224:227] offset:0
    s_mov_b64 exec, -1
    v_xor_b32 v55, 16, v11
    buffer_store_dwordx4 v[228:231], v55, s[4:7], s33 offen offset:768
    s_mov_b64 exec, s[62:63]
    ds_write_b128 v55, v[228:231] offset:768
    s_mov_b64 exec, -1
    v_xor_b32 v54, 32, v11
    buffer_store_dwordx4 v[232:235], v54, s[4:7], s33 offen offset:1536
    s_mov_b64 exec, s[62:63]
    ds_write_b128 v54, v[232:235] offset:1536
    s_mov_b64 exec, -1
    v_xor_b32 v55, 48, v11
    buffer_store_dwordx4 v[236:239], v55, s[4:7], s33 offen offset:2304
    s_mov_b64 exec, s[62:63]
    ds_write_b128 v55, v[236:239] offset:2304
    s_mov_b64 exec, -1
    s_mov_b32 s41, 0
    s_add_u32 m0, s40, 24576
    s_nop 0
    buffer_load_dwordx4 v136, s[8:11], s41 offen nt lds
    s_add_u32 m0, s40, 25600
    s_nop 0
    buffer_load_dwordx4 v137, s[8:11], s41 offen nt lds
    s_add_u32 m0, s40, 26624
    s_nop 0
    buffer_load_dwordx4 v138, s[8:11], s41 offen nt lds
    s_add_u32 m0, s40, 27648
    s_nop 0
    buffer_load_dwordx4 v139, s[8:11], s41 offen nt lds
    s_add_u32 m0, s40, 28672
    s_nop 0
    buffer_load_dwordx4 v140, s[8:11], s41 offen nt lds
    s_add_u32 m0, s40, 29696
    s_waitcnt vmcnt(20)
    buffer_load_dwordx4 v141, s[8:11], s41 offen nt lds
    s_waitcnt vmcnt(14)
    v_lshlrev_b32 v48, 16, v40
    v_and_b32 v49, s97, v40
    v_lshlrev_b32 v50, 16, v42
    v_and_b32 v51, s97, v42
    v_mul_f32_e64 v50, -v50, v48
    v_mul_f32_e64 v51, -v51, v49
    v_cvt_f32_i32 v112, v112
    v_cvt_f32_i32 v116, v116
    v_fma_f32 v112, v112, v48, v50
    v_fma_f32 v116, v116, v49, v51
    v_cvt_f32_i32 v113, v113
    v_cvt_f32_i32 v117, v117
    v_fma_f32 v113, v113, v48, v50
    v_fma_f32 v117, v117, v49, v51
    v_cvt_f32_i32 v114, v114
    v_cvt_f32_i32 v118, v118
    v_fma_f32 v114, v114, v48, v50
    v_fma_f32 v118, v118, v49, v51
    v_lshlrev_b32 v48, 16, v41
    v_and_b32 v49, s97, v41
    v_lshlrev_b32 v50, 16, v43
    v_and_b32 v51, s97, v43
    v_mul_f32_e64 v50, -v50, v48
    v_mul_f32_e64 v51, -v51, v49
    v_cvt_f32_i32 v120, v120
    v_cvt_f32_i32 v124, v124
    v_fma_f32 v120, v120, v48, v50
    v_fma_f32 v124, v124, v49, v51
    v_cvt_f32_i32 v121, v121
    v_cvt_f32_i32 v125, v125
    v_fma_f32 v121, v121, v48, v50
    v_fma_f32 v125, v125, v49, v51
    v_cvt_f32_i32 v122, v122
    v_cvt_f32_i32 v126, v126
    v_fma_f32 v122, v122, v48, v50
    v_fma_f32 v126, v126, v49, v51
    v_cvt_pk_bf16_f32 v112, v112, v116
    v_cvt_pk_bf16_f32 v116, v113, v117
    v_cvt_pk_bf16_f32 v113, v120, v124
    v_cvt_pk_bf16_f32 v117, v121, v125
    v_cvt_pk_bf16_f32 v120, v114, v118
    v_cvt_pk_bf16_f32 v121, v122, v126
    s_waitcnt vmcnt(10)
    v_lshlrev_b32 v48, 16, v44
    v_and_b32 v49, s97, v44
    v_lshlrev_b32 v50, 16, v46
    v_and_b32 v51, s97, v46
    v_mul_f32_e64 v50, -v50, v48
    v_mul_f32_e64 v51, -v51, v49
    v_cvt_f32_i32 v80, v80
    v_cvt_f32_i32 v84, v84
    v_fma_f32 v80, v80, v48, v50
    v_fma_f32 v84, v84, v49, v51
    v_cvt_f32_i32 v81, v81
    v_cvt_f32_i32 v85, v85
    v_fma_f32 v81, v81, v48, v50
    v_fma_f32 v85, v85, v49, v51
    v_cvt_f32_i32 v82, v82
    v_cvt_f32_i32 v86, v86
    v_fma_f32 v82, v82, v48, v50
    v_fma_f32 v86, v86, v49, v51
    v_lshlrev_b32 v48, 16, v45
    v_and_b32 v49, s97, v45
    v_lshlrev_b32 v50, 16, v47
    v_and_b32 v51, s97, v47
    v_mul_f32_e64 v50, -v50, v48
    v_mul_f32_e64 v51, -v51, v49
    v_cvt_f32_i32 v88, v88
    v_cvt_f32_i32 v92, v92
    v_fma_f32 v88, v88, v48, v50
    v_fma_f32 v92, v92, v49, v51
    v_cvt_f32_i32 v89, v89
    v_cvt_f32_i32 v93, v93
    v_fma_f32 v89, v89, v48, v50
    v_fma_f32 v93, v93, v49, v51
    v_cvt_f32_i32 v90, v90
    v_cvt_f32_i32 v94, v94
    v_fma_f32 v90, v90, v48, v50
    v_fma_f32 v94, v94, v49, v51
    v_cvt_pk_bf16_f32 v114, v80, v84
    v_cvt_pk_bf16_f32 v118, v81, v85
    v_cvt_pk_bf16_f32 v115, v88, v92
    v_cvt_pk_bf16_f32 v119, v89, v93
    v_cvt_pk_bf16_f32 v122, v82, v86
    v_cvt_pk_bf16_f32 v123, v90, v94
    buffer_store_dwordx4 v[112:115], v15, s[4:7], s35 offen offset:0
    buffer_store_dwordx4 v[116:119], v15, s[4:7], s35 offen offset:1024
    buffer_store_dwordx4 v[120:123], v15, s[4:7], s35 offen offset:2048
    ds_write_b128 v15, v[112:115] offset:12288
    ds_write_b128 v15, v[116:119] offset:13312
    ds_write_b128 v15, v[120:123] offset:14336
    buffer_load_dword v0, off, s[88:91], s93 sc1
    s_mov_b32 s41, 6144
    s_add_u32 m0, s40, 0
    s_nop 0
    buffer_load_dwordx4 v136, s[8:11], s41 offen nt lds
    s_add_u32 m0, s40, 1024
    s_nop 0
    buffer_load_dwordx4 v137, s[8:11], s41 offen nt lds
    s_add_u32 m0, s40, 2048
    s_nop 0
    buffer_load_dwordx4 v138, s[8:11], s41 offen nt lds
    s_add_u32 m0, s40, 3072
    s_nop 0
    buffer_load_dwordx4 v139, s[8:11], s41 offen nt lds
    s_add_u32 m0, s40, 4096
    s_nop 0
    buffer_load_dwordx4 v140, s[8:11], s41 offen nt lds
    s_add_u32 m0, s40, 5120
    s_waitcnt vmcnt(14)
    buffer_load_dwordx4 v141, s[8:11], s41 offen nt lds
    s_mov_b32 s41, 12288
    s_add_u32 m0, s40, 49152
    s_waitcnt vmcnt(14)
    buffer_load_dwordx4 v136, s[8:11], s41 offen nt lds
    s_add_u32 m0, s40, 50176
    s_waitcnt vmcnt(14)
    buffer_load_dwordx4 v137, s[8:11], s41 offen nt lds
    s_add_u32 m0, s40, 51200
    s_waitcnt vmcnt(14)
    buffer_load_dwordx4 v138, s[8:11], s41 offen nt lds
    s_add_u32 m0, s40, 52224
    s_waitcnt vmcnt(14)
    buffer_load_dwordx4 v139, s[8:11], s41 offen nt lds
    s_add_u32 m0, s40, 53248
    s_waitcnt vmcnt(14)
    buffer_load_dwordx4 v140, s[8:11], s41 offen nt lds
    s_add_u32 m0, s40, 54272
    s_waitcnt vmcnt(11)
    buffer_load_dwordx4 v141, s[8:11], s41 offen nt lds
    s_mov_b64 exec, 0
    s_cmp_eq_u32 s25, 0
    s_cbranch_scc1 L_iw0
    s_cmp_eq_u32 s25, 1
    s_cbranch_scc1 L_iw1
    s_cmp_eq_u32 s25, 2
    s_cbranch_scc1 L_iw2
    s_branch L_iw3
L_iwret:
    s_mov_b64 exec, -1
    s_waitcnt vmcnt(12)
    s_cmp_lg_u32 s25, 0
    s_cbranch_scc1 L_tagdone
    v_readfirstlane_b32 s42, v0
    s_mov_b32 s39, 100
    s_waitcnt lgkmcnt(0)
    s_and_b32 s46, s46, 0xfffffc00
L_tagretry:
    s_cmp_eq_u32 s42, s46
    s_cselect_b32 s42, 0, s42
    s_cmp_lg_u32 s42, 0
    s_cbranch_scc1 L_tagok
    s_sub_u32 s39, s39, 1
    s_cbranch_scc1 L_tagslow
    s_sleep 4
    s_buffer_load_dword s42, s[88:91], s93 glc
    s_waitcnt lgkmcnt(0)
    s_branch L_tagretry
L_tagok:
    s_add_u32 s42, s42, s45
    v_mov_b32 v0, s42
    v_mov_b32 v16, 147456
    ds_write_b32 v16, v0
L_tagdone:
    s_waitcnt lgkmcnt(0)
    s_barrier
    v_add_u32 v0, 1, v0
    buffer_store_dword v0, v13, s[20:23], 0 offen offset:32 sc1
    v_mov_b32 v16, 147456
    ds_read_b32 v17, v16
    ds_read_b128 v[144:147], v2 offset:0
    ds_read_b128 v[148:151], v3 offset:0
    ds_read_b128 v[152:155], v2 offset:6144
    ds_read_b128 v[156:159], v3 offset:6144
    ds_read_b128 v[160:163], v2 offset:128
    ds_read_b128 v[164:167], v3 offset:128
    ds_read_b128 v[168:171], v2 offset:6272
    ds_read_b128 v[172:175], v3 offset:6272
    ds_read_b128 v[176:179], v2 offset:256
    ds_read_b128 v[180:183], v3 offset:256
    ds_read_b128 v[184:187], v2 offset:6400
    ds_read_b128 v[188:191], v3 offset:6400
    s_waitcnt vmcnt(17)
    ds_read_b64 a[192:193], v22 offset:24576
    ds_read_b64 a[194:195], v142 offset:24704
    ds_read_b64 a[196:197], v23 offset:24576
    ds_read_b64 a[198:199], v143 offset:24704
    ds_read_b64 a[200:201], v142 offset:24576
    ds_read_b64 a[202:203], v22 offset:24832
    ds_read_b64 a[204:205], v143 offset:24576
    ds_read_b64 a[206:207], v23 offset:24832
    ds_read_b64 a[208:209], v22 offset:24704
    ds_read_b64 a[210:211], v142 offset:24832
    ds_read_b64 a[212:213], v23 offset:24704
    ds_read_b64 a[214:215], v143 offset:24832
    s_waitcnt lgkmcnt(15)
    v_readfirstlane_b32 s92, v17
    s_add_u32 s92, s92, 1
    s_waitcnt lgkmcnt(0)
    s_mov_b32 s41, 18432
    s_add_u32 m0, s40, 24576
    s_waitcnt vmcnt(12)
    buffer_load_dwordx4 v136, s[8:11], s41 offen nt lds
    s_add_u32 m0, s40, 25600
    s_waitcnt vmcnt(12)
    buffer_load_dwordx4 v137, s[8:11], s41 offen nt lds
    s_add_u32 m0, s40, 26624
    s_waitcnt vmcnt(12)
    buffer_load_dwordx4 v138, s[8:11], s41 offen nt lds
    v_mfma_f32_16x16x32_bf16 v[64:67], v[144:147], a[192:195], 0
    v_mfma_f32_16x16x32_bf16 v[64:67], v[148:151], a[196:199], v[64:67]
    v_mfma_f32_16x16x32_bf16 v[64:67], v[160:163], a[200:203], v[64:67]
    v_mfma_f32_16x16x32_bf16 v[64:67], v[164:167], a[204:207], v[64:67]
    v_mfma_f32_16x16x32_bf16 v[64:67], v[176:179], a[208:211], v[64:67]
    v_mfma_f32_16x16x32_bf16 v[64:67], v[180:183], a[212:215], v[64:67]
    v_mfma_f32_16x16x32_bf16 v[96:99], v[152:155], a[192:195], 0
    v_mfma_f32_16x16x32_bf16 v[96:99], v[156:159], a[196:199], v[96:99]
    v_mfma_f32_16x16x32_bf16 v[96:99], v[168:171], a[200:203], v[96:99]
    v_mfma_f32_16x16x32_bf16 v[96:99], v[172:175], a[204:207], v[96:99]
    v_mfma_f32_16x16x32_bf16 v[96:99], v[184:187], a[208:211], v[96:99]
    v_mfma_f32_16x16x32_bf16 v[96:99], v[188:191], a[212:215], v[96:99]
    s_nop 7
    v_max3_f32 v48, v64, v65, v66
    v_max3_f32 v50, v67, v96, v97
    v_max3_f32 v48, v48, v98, v99
    v_max_f32 v48, v48, v50
    v_mov_b32 v49, v48
    s_nop 1
    v_permlane16_swap_b32 v48, v49
    s_nop 1
    v_max_f32 v48, v48, v49
    v_mov_b32 v49, v48
    s_nop 1
    v_permlane32_swap_b32 v48, v49
    s_nop 1
    v_max_f32 v48, v48, v49
    v_sub_f32 v64, v64, v48
    v_sub_f32 v65, v65, v48
    v_sub_f32 v66, v66, v48
    v_sub_f32 v67, v67, v48
    v_sub_f32 v96, v96, v48
    v_sub_f32 v97, v97, v48
    v_sub_f32 v98, v98, v48
    v_sub_f32 v99, v99, v48
    v_exp_f32 v64, v64
    v_exp_f32 v65, v65
    v_exp_f32 v66, v66
    v_exp_f32 v67, v67
    v_exp_f32 v96, v96
    v_exp_f32 v97, v97
    v_exp_f32 v98, v98
L_iw0:
L_pg0:
    s_cbranch_execz L_pg4
    v_exp_f32 v99, v99
    v_sub_f32 v128, 0, v48
    v_sub_f32 v129, 0, v48
    v_sub_f32 v130, 0, v48
    v_sub_f32 v131, 0, v48
    v_add_f32 v5, v5, v64
    v_add_f32 v5, v5, v65
    v_add_f32 v5, v5, v66
    v_add_f32 v5, v5, v67
    v_add_f32 v5, v5, v96
    v_add_f32 v5, v5, v97
    v_add_f32 v5, v5, v98
    v_add_f32 v5, v5, v99
    v_cvt_pk_bf16_f32 v64, v64, v65
    v_cvt_pk_bf16_f32 v65, v66, v67
    v_cvt_pk_bf16_f32 v66, v96, v97
    v_cvt_pk_bf16_f32 v67, v98, v99
    s_waitcnt vmcnt(10)
    ds_read_b64 a[216:217], v22 offset:0
    ds_read_b64 a[218:219], v142 offset:128
    ds_read_b64 a[220:221], v23 offset:0
    ds_read_b64 a[222:223], v143 offset:128
    ds_read_b64 a[224:225], v142 offset:0
    ds_read_b64 a[226:227], v22 offset:256
    ds_read_b64 a[228:229], v143 offset:0
    ds_read_b64 a[230:231], v23 offset:256
    ds_read_b64 a[232:233], v22 offset:128
    ds_read_b64 a[234:235], v142 offset:256
    ds_read_b64 a[236:237], v23 offset:128
    ds_read_b64 a[238:239], v143 offset:256
    s_waitcnt lgkmcnt(0)
    s_mov_b32 s41, 18432
    s_add_u32 m0, s40, 27648
    s_nop 0
    buffer_load_dwordx4 v139, s[8:11], s41 offen nt lds
    s_add_u32 m0, s40, 28672
    s_nop 0
    buffer_load_dwordx4 v140, s[8:11], s41 offen nt lds
    s_add_u32 m0, s40, 29696
    s_nop 0
    buffer_load_dwordx4 v141, s[8:11], s41 offen nt lds
    v_mfma_f32_16x16x32_bf16 v[68:71], v[144:147], a[216:219], 0
    v_mfma_f32_16x16x32_bf16 v[68:71], v[148:151], a[220:223], v[68:71]
    v_mfma_f32_16x16x32_bf16 v[68:71], v[160:163], a[224:227], v[68:71]
    v_mfma_f32_16x16x32_bf16 v[68:71], v[164:167], a[228:231], v[68:71]
    v_mfma_f32_16x16x32_bf16 v[68:71], v[176:179], a[232:235], v[68:71]
    v_mfma_f32_16x16x32_bf16 v[68:71], v[180:183], a[236:239], v[68:71]
    v_mfma_f32_16x16x32_bf16 v[100:103], v[152:155], a[216:219], 0
    v_mfma_f32_16x16x32_bf16 v[100:103], v[156:159], a[220:223], v[100:103]
    v_mfma_f32_16x16x32_bf16 v[100:103], v[168:171], a[224:227], v[100:103]
    v_mfma_f32_16x16x32_bf16 v[100:103], v[172:175], a[228:231], v[100:103]
    v_mfma_f32_16x16x32_bf16 v[100:103], v[184:187], a[232:235], v[100:103]
    v_mfma_f32_16x16x32_bf16 v[100:103], v[188:191], a[236:239], v[100:103]
    s_nop 7
    v_max3_f32 v48, v68, v69, v70
    v_max3_f32 v50, v71, v100, v101
    v_max3_f32 v48, v48, v102, v103
    v_max_f32 v48, v48, v50
    v_mov_b32 v49, v48
    s_nop 1
    v_permlane16_swap_b32 v48, v49
    s_nop 1
    v_max_f32 v48, v48, v49
    v_mov_b32 v49, v48
    s_nop 1
    v_permlane32_swap_b32 v48, v49
    s_nop 1
    v_max_f32 v48, v48, v49
    v_sub_f32 v68, v68, v48
    v_sub_f32 v69, v69, v48
    v_sub_f32 v70, v70, v48
    v_sub_f32 v71, v71, v48
    v_sub_f32 v100, v100, v48
    v_sub_f32 v101, v101, v48
    v_sub_f32 v102, v102, v48
    v_sub_f32 v103, v103, v48
    v_exp_f32 v68, v68
    v_exp_f32 v69, v69
    v_exp_f32 v70, v70
    v_exp_f32 v71, v71
    v_exp_f32 v100, v100
    v_exp_f32 v101, v101
    v_exp_f32 v102, v102
    v_exp_f32 v103, v103
    v_sub_f32 v132, 0, v48
    v_sub_f32 v133, 0, v48
    v_sub_f32 v134, 0, v48
    v_sub_f32 v135, 0, v48
    v_add_f32 v6, v6, v68
    v_add_f32 v6, v6, v69
    v_add_f32 v6, v6, v70
    v_add_f32 v6, v6, v71
    v_add_f32 v6, v6, v100
    v_add_f32 v6, v6, v101
    v_add_f32 v6, v6, v102
    v_add_f32 v6, v6, v103
    v_cvt_pk_bf16_f32 v68, v68, v69
    v_cvt_pk_bf16_f32 v69, v70, v71
    v_cvt_pk_bf16_f32 v70, v100, v101
    v_cvt_pk_bf16_f32 v71, v102, v103
    s_waitcnt vmcnt(7)
    ds_read_b64 a[240:241], v22 offset:49152
    ds_read_b64 a[242:243], v142 offset:49280
    ds_read_b64 a[244:245], v23 offset:49152
    ds_read_b64 a[246:247], v143 offset:49280
    ds_read_b64 a[248:249], v142 offset:49152
    ds_read_b64 a[250:251], v22 offset:49408
    ds_read_b64 a[252:253], v143 offset:49152
    ds_read_b64 a[254:255], v23 offset:49408
    ds_read_b64 v[192:193], v22 offset:49280
    ds_read_b64 v[194:195], v142 offset:49408
    ds_read_b64 v[196:197], v23 offset:49280
    ds_read_b64 v[198:199], v143 offset:49408
    s_buffer_load_dwordx8 s[48:55], s[20:23], s44 glc
    s_waitcnt lgkmcnt(0)
    v_mfma_f32_16x16x32_bf16 v[72:75], v[144:147], a[240:243], 0
    v_mfma_f32_16x16x32_bf16 v[72:75], v[148:151], a[244:247], v[72:75]
    v_mfma_f32_16x16x32_bf16 v[72:75], v[160:163], a[248:251], v[72:75]
    v_mfma_f32_16x16x32_bf16 v[72:75], v[164:167], a[252:255], v[72:75]
    v_mfma_f32_16x16x32_bf16 v[72:75], v[176:179], v[192:195], v[72:75]
    v_mfma_f32_16x16x32_bf16 v[72:75], v[180:183], v[196:199], v[72:75]
    v_mfma_f32_16x16x32_bf16 v[104:107], v[152:155], a[240:243], 0
    v_mfma_f32_16x16x32_bf16 v[104:107], v[156:159], a[244:247], v[104:107]
    v_mfma_f32_16x16x32_bf16 v[104:107], v[168:171], a[248:251], v[104:107]
    v_mfma_f32_16x16x32_bf16 v[104:107], v[172:175], a[252:255], v[104:107]
    v_mfma_f32_16x16x32_bf16 v[104:107], v[184:187], v[192:195], v[104:107]
    v_mfma_f32_16x16x32_bf16 v[104:107], v[188:191], v[196:199], v[104:107]
    s_waitcnt lgkmcnt(0)
    s_sub_u32 s48, s48, s92
    s_sub_u32 s49, s49, s92
    s_sub_u32 s50, s50, s92
    s_sub_u32 s51, s51, s92
    s_sub_u32 s52, s52, s92
    s_sub_u32 s53, s53, s92
    s_sub_u32 s54, s54, s92
    s_sub_u32 s55, s55, s92
    s_max_u32 s48, s48, s49
    s_max_u32 s48, s48, s50
    s_max_u32 s48, s48, s51
    s_max_u32 s48, s48, s52
    s_max_u32 s48, s48, s53
    s_max_u32 s48, s48, s54
    s_max_u32 s48, s48, s55
    s_cmp_ge_u32 s48, 16
    s_cbranch_scc1 L_pollslow0
L_pollok0:
    s_add_u32 s92, s92, 1
    s_mov_b32 m0, s26
    s_nop 0
    buffer_load_dwordx4 v4, s[4:7], s32 offen offset:0 sc1 lds
    buffer_load_dwordx4 v4, s[4:7], s32 offen offset:1024 sc1 lds
    buffer_load_dwordx4 v4, s[4:7], s32 offen offset:2048 sc1 lds
    s_add_u32 s32, s32, 24576
    s_sub_u32 s57, s32, 196608
    s_min_u32 s32, s32, s57
    s_add_u32 s26, s26, 36864
    s_sub_u32 s57, s26, 147456
    s_min_u32 s26, s26, s57
    s_mov_b32 m0, s26
    s_nop 0
    buffer_load_dwordx4 v4, s[4:7], s32 offen offset:0 sc1 lds
    buffer_load_dwordx4 v4, s[4:7], s32 offen offset:1024 sc1 lds
    buffer_load_dwordx4 v4, s[4:7], s32 offen offset:2048 sc1 lds
    s_add_u32 s32, s32, 24576
    s_sub_u32 s57, s32, 196608
    s_min_u32 s32, s32, s57
    s_add_u32 s26, s26, 12288
    s_mov_b32 m0, s26
    s_waitcnt vmcnt(11)
    buffer_load_dwordx4 v4, s[4:7], s32 offen offset:0 sc1 lds
    s_waitcnt vmcnt(11)
    buffer_load_dwordx4 v4, s[4:7], s32 offen offset:1024 sc1 lds
    s_waitcnt vmcnt(11)
    buffer_load_dwordx4 v4, s[4:7], s32 offen offset:2048 sc1 lds
    s_add_u32 s32, s32, 24576
    s_sub_u32 s57, s32, 196608
    s_min_u32 s32, s32, s57
    s_add_u32 s26, s26, 36864
    s_sub_u32 s57, s26, 147456
    s_min_u32 s26, s26, s57
    s_mov_b32 m0, s56
    s_waitcnt vmcnt(11)
    buffer_load_dwordx4 v4, s[4:7], s27 offen offset:0 sc1 lds
    s_waitcnt vmcnt(11)
    buffer_load_dwordx4 v4, s[4:7], s27 offen offset:1024 sc1 lds
    s_waitcnt vmcnt(11)
    buffer_load_dwordx4 v4, s[4:7], s27 offen offset:2048 sc1 lds
    s_add_u32 s27, s27, 24576
    s_sub_u32 s58, s27, 196608
    s_min_u32 s27, s27, s58
    s_add_u32 s56, s56, 36864
    s_sub_u32 s58, s56, 147456
    s_min_u32 s56, s56, s58
    s_add_u32 s33, s33, 196608
    s_add_u32 s34, s34, 196608
    s_add_u32 s36, s36, 1536
    s_add_u32 s35, s35, 196608
    s_add_u32 s16, s16, 196608
    s_add_u32 s17, s17, 196608
    s_add_u32 s37, s37, 512
    v_max3_f32 v48, v72, v73, v74
    v_max3_f32 v50, v75, v104, v105
    v_max3_f32 v48, v48, v106, v107
    v_max_f32 v48, v48, v50
    v_mov_b32 v49, v48
    s_nop 1
    v_permlane16_swap_b32 v48, v49
    s_nop 1
    v_max_f32 v48, v48, v49
    v_mov_b32 v49, v48
    s_nop 1
    v_permlane32_swap_b32 v48, v49
    s_nop 1
    v_max_f32 v48, v48, v49
    v_sub_f32 v72, v72, v48
    v_sub_f32 v73, v73, v48
    v_sub_f32 v74, v74, v48
    v_sub_f32 v75, v75, v48
    v_sub_f32 v104, v104, v48
    v_sub_f32 v105, v105, v48
    v_sub_f32 v106, v106, v48
    v_sub_f32 v107, v107, v48
    v_exp_f32 v72, v72
    v_exp_f32 v73, v73
    v_exp_f32 v74, v74
    v_exp_f32 v75, v75
    v_exp_f32 v104, v104
    v_exp_f32 v105, v105
    v_exp_f32 v106, v106
    v_exp_f32 v107, v107
    v_sub_f32 v136, 0, v48
    v_sub_f32 v137, 0, v48
    v_sub_f32 v138, 0, v48
    v_sub_f32 v139, 0, v48
    v_add_f32 v7, v7, v72
    v_add_f32 v7, v7, v73
    v_add_f32 v7, v7, v74
    v_add_f32 v7, v7, v75
    v_add_f32 v7, v7, v104
    v_add_f32 v7, v7, v105
    v_add_f32 v7, v7, v106
    v_add_f32 v7, v7, v107
    v_cvt_pk_bf16_f32 v72, v72, v73
    v_cvt_pk_bf16_f32 v73, v74, v75
    v_cvt_pk_bf16_f32 v74, v104, v105
    v_cvt_pk_bf16_f32 v75, v106, v107
    ds_read_b128 v[24:27], v1 offset:0
    ds_read_b128 v[28:31], v1 offset:1024
    ds_read_b128 v[32:35], v1 offset:2048
    ds_read_b128 v[36:39], v1 offset:3072
    s_waitcnt lgkmcnt(2)
    v_mfma_f32_16x16x32_bf16 a[0:3], v[64:67], v[24:27], 0
    ds_read_b128 v[40:43], v1 offset:4096
    v_mfma_f32_16x16x32_bf16 a[4:7], v[64:67], v[28:31], 0
    s_waitcnt vmcnt(11)
    buffer_load_dwordx2 v[56:57], v10, s[72:75], s36 offen offset:0
    v_mfma_f32_16x16x32_bf16 a[48:51], v[68:71], v[24:27], 0
    v_mfma_f32_16x16x32_bf16 a[52:55], v[68:71], v[28:31], 0
    ds_read_b128 v[44:47], v1 offset:5120
    v_mfma_f32_16x16x32_bf16 a[96:99], v[72:75], v[24:27], 0
    v_mfma_f32_16x16x32_bf16 a[100:103], v[72:75], v[28:31], 0
    s_waitcnt lgkmcnt(2)
    buffer_load_dwordx2 v[58:59], v10, s[76:79], s36 offen offset:0
    v_mfma_f32_16x16x32_bf16 a[8:11], v[64:67], v[32:35], 0
    ds_read_b128 v[24:27], v1 offset:6144
    v_mfma_f32_16x16x32_bf16 a[12:15], v[64:67], v[36:39], 0
    s_waitcnt vmcnt(12)
    buffer_load_dwordx4 v[224:227], v9, s[64:67], s33 offen offset:0 nt
    v_mfma_f32_16x16x32_bf16 a[56:59], v[68:71], v[32:35], 0
    v_mfma_f32_16x16x32_bf16 a[60:63], v[68:71], v[36:39], 0
    ds_read_b128 v[28:31], v1 offset:7168
    v_mfma_f32_16x16x32_bf16 a[104:107], v[72:75], v[32:35], 0
    v_mfma_f32_16x16x32_bf16 a[108:111], v[72:75], v[36:39], 0
    s_waitcnt lgkmcnt(2)
    s_waitcnt vmcnt(12)
    buffer_load_dwordx4 v[228:231], v9, s[64:67], s33 offen offset:1536 nt
    v_mfma_f32_16x16x32_bf16 a[16:19], v[64:67], v[40:43], 0
    ds_read_b128 v[32:35], v1 offset:8192
    v_mfma_f32_16x16x32_bf16 a[20:23], v[64:67], v[44:47], 0
    buffer_load_dwordx4 v[232:235], v9, s[64:67], s34 offen offset:0 nt
    v_mfma_f32_16x16x32_bf16 a[64:67], v[68:71], v[40:43], 0
    v_mfma_f32_16x16x32_bf16 a[68:71], v[68:71], v[44:47], 0
    ds_read_b128 v[36:39], v1 offset:9216
    v_mfma_f32_16x16x32_bf16 a[112:115], v[72:75], v[40:43], 0
    s_waitcnt vmcnt(13)
    buffer_load_dwordx4 v[236:239], v9, s[64:67], s34 offen offset:1536 nt
    v_mfma_f32_16x16x32_bf16 a[116:119], v[72:75], v[44:47], 0
    s_waitcnt lgkmcnt(2)
    v_mfma_f32_16x16x32_bf16 a[24:27], v[64:67], v[24:27], 0
    ds_read_b128 v[40:43], v1 offset:10240
    v_mfma_f32_16x16x32_bf16 a[28:31], v[64:67], v[28:31], 0
    s_waitcnt vmcnt(13)
    buffer_load_dwordx2 v[60:61], v10, s[72:75], s36 offen offset:192
    v_mfma_f32_16x16x32_bf16 a[72:75], v[68:71], v[24:27], 0
    v_mfma_f32_16x16x32_bf16 a[76:79], v[68:71], v[28:31], 0
    ds_read_b128 v[44:47], v1 offset:11264
    v_mfma_f32_16x16x32_bf16 a[120:123], v[72:75], v[24:27], 0
    v_mfma_f32_16x16x32_bf16 a[124:127], v[72:75], v[28:31], 0
    s_waitcnt lgkmcnt(2)
    buffer_load_dwordx2 v[62:63], v10, s[76:79], s36 offen offset:192
    v_mfma_f32_16x16x32_bf16 a[32:35], v[64:67], v[32:35], 0
    v_mfma_f32_16x16x32_bf16 a[36:39], v[64:67], v[36:39], 0
    s_waitcnt vmcnt(14)
    buffer_load_dwordx4 v[240:243], v9, s[64:67], s33 offen offset:384 nt
    v_mfma_f32_16x16x32_bf16 a[80:83], v[68:71], v[32:35], 0
    v_mfma_f32_16x16x32_bf16 a[84:87], v[68:71], v[36:39], 0
    buffer_load_dwordx4 v[244:247], v9, s[64:67], s33 offen offset:1920 nt
    v_mfma_f32_16x16x32_bf16 a[128:131], v[72:75], v[32:35], 0
    v_mfma_f32_16x16x32_bf16 a[132:135], v[72:75], v[36:39], 0
    s_waitcnt lgkmcnt(0)
    s_waitcnt vmcnt(15)
    buffer_load_dwordx4 v[248:251], v9, s[64:67], s34 offen offset:384 nt
    v_mfma_f32_16x16x32_bf16 a[40:43], v[64:67], v[40:43], 0
    v_mfma_f32_16x16x32_bf16 a[44:47], v[64:67], v[44:47], 0
    s_waitcnt vmcnt(15)
    buffer_load_dwordx4 v[252:255], v9, s[64:67], s34 offen offset:1920 nt
    v_mfma_f32_16x16x32_bf16 a[88:91], v[68:71], v[40:43], 0
    v_mfma_f32_16x16x32_bf16 a[92:95], v[68:71], v[44:47], 0
    v_mfma_f32_16x16x32_bf16 a[136:139], v[72:75], v[40:43], 0
    v_mfma_f32_16x16x32_bf16 a[140:143], v[72:75], v[44:47], 0
    s_waitcnt vmcnt(24)
    ds_read_b64 v[200:201], v22 offset:24576
    ds_read_b64 v[202:203], v142 offset:24704
    ds_read_b64 v[204:205], v23 offset:24576
    ds_read_b64 v[206:207], v143 offset:24704
    ds_read_b64 v[208:209], v142 offset:24576
    ds_read_b64 v[210:211], v22 offset:24832
    ds_read_b64 v[212:213], v143 offset:24576
    ds_read_b64 v[214:215], v23 offset:24832
    ds_read_b64 v[216:217], v22 offset:24704
    ds_read_b64 v[218:219], v142 offset:24832
    ds_read_b64 v[220:221], v23 offset:24704
    ds_read_b64 v[222:223], v143 offset:24832
    s_waitcnt lgkmcnt(0)
    v_mfma_f32_16x16x32_bf16 v[76:79], v[144:147], v[200:203], 0
    v_mfma_f32_16x16x32_bf16 v[76:79], v[148:151], v[204:207], v[76:79]
    v_mfma_f32_16x16x32_bf16 v[76:79], v[160:163], v[208:211], v[76:79]
    v_mfma_f32_16x16x32_bf16 v[76:79], v[164:167], v[212:215], v[76:79]
    v_mfma_f32_16x16x32_bf16 v[76:79], v[176:179], v[216:219], v[76:79]
    v_mfma_f32_16x16x32_bf16 v[76:79], v[180:183], v[220:223], v[76:79]
    v_mfma_f32_16x16x32_bf16 v[108:111], v[152:155], v[200:203], 0
    v_mfma_f32_16x16x32_bf16 v[108:111], v[156:159], v[204:207], v[108:111]
    v_mfma_f32_16x16x32_bf16 v[108:111], v[168:171], v[208:211], v[108:111]
    v_mfma_f32_16x16x32_bf16 v[108:111], v[172:175], v[212:215], v[108:111]
    v_mfma_f32_16x16x32_bf16 v[108:111], v[184:187], v[216:219], v[108:111]
    v_mfma_f32_16x16x32_bf16 v[108:111], v[188:191], v[220:223], v[108:111]
    s_nop 7
    v_max3_f32 v48, v76, v77, v78
    v_max3_f32 v50, v79, v108, v109
    v_max3_f32 v48, v48, v110, v111
    v_max_f32 v48, v48, v50
    v_mov_b32 v49, v48
    s_nop 1
    v_permlane16_swap_b32 v48, v49
    s_nop 1
    v_max_f32 v48, v48, v49
    v_mov_b32 v49, v48
    s_nop 1
    v_permlane32_swap_b32 v48, v49
    s_nop 1
    v_max_f32 v48, v48, v49
    v_sub_f32 v76, v76, v48
    v_sub_f32 v77, v77, v48
    v_sub_f32 v78, v78, v48
    v_sub_f32 v79, v79, v48
    v_sub_f32 v108, v108, v48
    v_sub_f32 v109, v109, v48
    v_sub_f32 v110, v110, v48
    v_sub_f32 v111, v111, v48
    v_exp_f32 v76, v76
    v_exp_f32 v77, v77
    v_exp_f32 v78, v78
    v_exp_f32 v79, v79
    v_exp_f32 v108, v108
    v_exp_f32 v109, v109
    v_exp_f32 v110, v110
    v_exp_f32 v111, v111
    v_sub_f32 v140, 0, v48
    v_sub_f32 v141, 0, v48
    v_sub_f32 v142, 0, v48
    v_sub_f32 v143, 0, v48
    v_add_f32 v8, v8, v76
    v_add_f32 v8, v8, v77
    v_add_f32 v8, v8, v78
    v_add_f32 v8, v8, v79
    v_add_f32 v8, v8, v108
    v_add_f32 v8, v8, v109
    v_add_f32 v8, v8, v110
    v_add_f32 v8, v8, v111
    v_cvt_pk_bf16_f32 v76, v76, v77
    v_cvt_pk_bf16_f32 v77, v78, v79
    v_cvt_pk_bf16_f32 v78, v108, v109
    v_cvt_pk_bf16_f32 v79, v110, v111
    s_waitcnt vmcnt(21)
    s_barrier
    ds_read_b128 v[24:27], v2 offset:12288
    ds_read_b128 v[28:31], v3 offset:12288
    ds_read_b128 v[32:35], v2 offset:18432
    ds_read_b128 v[36:39], v3 offset:18432
    s_waitcnt lgkmcnt(2)
    v_mfma_f32_16x16x32_bf16 v[80:83], v[24:27], a[192:195], v[128:131]
    ds_read_b128 v[40:43], v2 offset:12416
    v_bfe_u32 v20, v4, 4, 6
    v_mfma_f32_16x16x32_bf16 v[80:83], v[28:31], a[196:199], v[80:83]
    v_lshlrev_b32 v20, 2, v20
    v_mfma_f32_16x16x32_bf16 v[84:87], v[24:27], a[216:219], v[132:135]
    v_mfma_f32_16x16x32_bf16 v[84:87], v[28:31], a[220:223], v[84:87]
    v_xor_b32 v21, 16, v11
    v_mfma_f32_16x16x32_bf16 v[88:91], v[24:27], a[240:243], v[136:139]
    ds_read_b128 v[44:47], v3 offset:12416
    v_mfma_f32_16x16x32_bf16 v[88:91], v[28:31], a[244:247], v[88:91]
    v_mfma_f32_16x16x32_bf16 v[92:95], v[24:27], v[200:203], v[140:143]
    v_mfma_f32_16x16x32_bf16 v[92:95], v[28:31], v[204:207], v[92:95]
    s_waitcnt lgkmcnt(2)
    v_mfma_f32_16x16x32_bf16 v[112:115], v[32:35], a[192:195], v[128:131]
    ds_read_b128 v[24:27], v2 offset:18560
    v_mfma_f32_16x16x32_bf16 v[112:115], v[36:39], a[196:199], v[112:115]
    v_xor_b32 v22, 32, v11
    v_mfma_f32_16x16x32_bf16 v[116:119], v[32:35], a[216:219], v[132:135]
    v_mfma_f32_16x16x32_bf16 v[116:119], v[36:39], a[220:223], v[116:119]
    v_mfma_f32_16x16x32_bf16 v[120:123], v[32:35], a[240:243], v[136:139]
    ds_read_b128 v[28:31], v3 offset:18560
    v_mfma_f32_16x16x32_bf16 v[120:123], v[36:39], a[244:247], v[120:123]
    v_mfma_f32_16x16x32_bf16 v[124:127], v[32:35], v[200:203], v[140:143]
    v_mfma_f32_16x16x32_bf16 v[124:127], v[36:39], v[204:207], v[124:127]
    s_waitcnt lgkmcnt(2)
    v_xor_b32 v23, 48, v11
    v_mfma_f32_16x16x32_bf16 v[80:83], v[40:43], a[200:203], v[80:83]
    ds_read_b128 v[32:35], v2 offset:12544
    v_mfma_f32_16x16x32_bf16 v[80:83], v[44:47], a[204:207], v[80:83]
    v_mfma_f32_16x16x32_bf16 v[84:87], v[40:43], a[224:227], v[84:87]
    v_mfma_f32_16x16x32_bf16 v[84:87], v[44:47], a[228:231], v[84:87]
    v_mfma_f32_16x16x32_bf16 v[88:91], v[40:43], a[248:251], v[88:91]
    ds_read_b128 v[36:39], v3 offset:12544
    v_mfma_f32_16x16x32_bf16 v[88:91], v[44:47], a[252:255], v[88:91]
    v_mfma_f32_16x16x32_bf16 v[92:95], v[40:43], v[208:211], v[92:95]
    v_mfma_f32_16x16x32_bf16 v[92:95], v[44:47], v[212:215], v[92:95]
    s_waitcnt lgkmcnt(2)
    v_mfma_f32_16x16x32_bf16 v[112:115], v[24:27], a[200:203], v[112:115]
    ds_read_b128 v[40:43], v2 offset:18688
    v_mfma_f32_16x16x32_bf16 v[112:115], v[28:31], a[204:207], v[112:115]
    v_mfma_f32_16x16x32_bf16 v[116:119], v[24:27], a[224:227], v[116:119]
    v_mfma_f32_16x16x32_bf16 v[116:119], v[28:31], a[228:231], v[116:119]
    v_mfma_f32_16x16x32_bf16 v[120:123], v[24:27], a[248:251], v[120:123]
    ds_read_b128 v[44:47], v3 offset:18688
    v_mfma_f32_16x16x32_bf16 v[120:123], v[28:31], a[252:255], v[120:123]
    s_waitcnt lgkmcnt(2)
    v_mfma_f32_16x16x32_bf16 v[124:127], v[24:27], v[208:211], v[124:127]
    s_waitcnt vmcnt(15)
    v_mfma_f32_16x16x32_bf16 v[124:127], v[28:31], v[212:215], v[124:127]
    s_barrier
    v_add_u32 v2, 49152, v2
    v_add_u32 v3, 49152, v3
    v_mfma_f32_16x16x32_bf16 v[80:83], v[32:35], a[208:211], v[80:83]
    s_mov_b32 m0, s26
    ds_read_b128 v[24:27], v2 offset:0
    v_mfma_f32_16x16x32_bf16 v[80:83], v[36:39], a[212:215], v[80:83]
    buffer_load_dwordx4 v4, s[4:7], s32 offen offset:0 sc1 lds
    v_mfma_f32_16x16x32_bf16 v[84:87], v[32:35], a[232:235], v[84:87]
    v_mfma_f32_16x16x32_bf16 v[84:87], v[36:39], a[236:239], v[84:87]
    s_waitcnt vmcnt(15)
    buffer_load_dwordx4 v4, s[4:7], s32 offen offset:1024 sc1 lds
    v_mfma_f32_16x16x32_bf16 v[88:91], v[32:35], v[192:195], v[88:91]
    ds_read_b128 v[28:31], v3 offset:0
    v_mfma_f32_16x16x32_bf16 v[88:91], v[36:39], v[196:199], v[88:91]
    s_waitcnt vmcnt(15)
    buffer_load_dwordx4 v4, s[4:7], s32 offen offset:2048 sc1 lds
    v_mfma_f32_16x16x32_bf16 v[92:95], v[32:35], v[216:219], v[92:95]
    s_add_u32 s32, s32, 24576
    s_sub_u32 s57, s32, 196608
    v_mfma_f32_16x16x32_bf16 v[92:95], v[36:39], v[220:223], v[92:95]
    s_waitcnt lgkmcnt(2)
    s_min_u32 s32, s32, s57
    s_add_u32 s26, s26, 12288
    v_mfma_f32_16x16x32_bf16 v[112:115], v[40:43], a[208:211], v[112:115]
    s_mov_b32 m0, s26
    ds_read_b128 v[32:35], v2 offset:6144
    v_mfma_f32_16x16x32_bf16 v[112:115], v[44:47], a[212:215], v[112:115]
    s_waitcnt vmcnt(15)
    buffer_load_dwordx4 v4, s[4:7], s32 offen offset:0 sc1 lds
    v_mfma_f32_16x16x32_bf16 v[116:119], v[40:43], a[232:235], v[116:119]
    v_mfma_f32_16x16x32_bf16 v[116:119], v[44:47], a[236:239], v[116:119]
    s_waitcnt vmcnt(14)
    buffer_load_dwordx4 v4, s[4:7], s32 offen offset:1024 sc1 lds
    v_mfma_f32_16x16x32_bf16 v[120:123], v[40:43], v[192:195], v[120:123]
    ds_read_b128 v[36:39], v3 offset:6144
    v_mfma_f32_16x16x32_bf16 v[120:123], v[44:47], v[196:199], v[120:123]
    s_waitcnt vmcnt(14)
    buffer_load_dwordx4 v4, s[4:7], s32 offen offset:2048 sc1 lds
    v_mfma_f32_16x16x32_bf16 v[124:127], v[40:43], v[216:219], v[124:127]
    v_mfma_f32_16x16x32_bf16 v[124:127], v[44:47], v[220:223], v[124:127]
    s_waitcnt lgkmcnt(2)
    s_add_u32 s32, s32, 24576
    s_sub_u32 s57, s32, 196608
    s_min_u32 s32, s32, s57
    s_add_u32 s26, s26, 36864
    s_sub_u32 s57, s26, 147456
    s_min_u32 s26, s26, s57
    v_mfma_f32_16x16x32_bf16 v[160:163], v[24:27], a[192:195], v[128:131]
    s_mov_b32 m0, s56
    ds_read_b128 v[40:43], v2 offset:128
    v_mfma_f32_16x16x32_bf16 v[160:163], v[28:31], a[196:199], v[160:163]
    s_waitcnt vmcnt(13)
    buffer_load_dwordx4 v4, s[4:7], s27 offen offset:0 sc1 lds
    v_mfma_f32_16x16x32_bf16 v[164:167], v[24:27], a[216:219], v[132:135]
    v_exp_f32 v16, v80
    v_mfma_f32_16x16x32_bf16 v[164:167], v[28:31], a[220:223], v[164:167]
    s_waitcnt vmcnt(13)
    buffer_load_dwordx4 v4, s[4:7], s27 offen offset:1024 sc1 lds
    v_exp_f32 v17, v81
    v_exp_f32 v18, v82
    v_add_f32 v5, v5, v16
    v_add_f32 v5, v5, v17
    v_mfma_f32_16x16x32_bf16 v[168:171], v[24:27], a[240:243], v[136:139]
    ds_read_b128 v[44:47], v3 offset:128
    v_mfma_f32_16x16x32_bf16 v[168:171], v[28:31], a[244:247], v[168:171]
    s_waitcnt vmcnt(12)
    buffer_load_dwordx4 v4, s[4:7], s27 offen offset:2048 sc1 lds
    v_exp_f32 v19, v83
    v_cvt_pk_bf16_f32 v80, v16, v17
    v_mfma_f32_16x16x32_bf16 v[172:175], v[24:27], v[200:203], v[140:143]
    s_add_u32 s27, s27, 24576
    v_exp_f32 v16, v112
    v_mfma_f32_16x16x32_bf16 v[172:175], v[28:31], v[204:207], v[172:175]
    s_waitcnt lgkmcnt(2)
    v_add_f32 v5, v5, v18
    v_add_f32 v5, v5, v19
    v_exp_f32 v17, v113
    v_cvt_pk_bf16_f32 v81, v18, v19
    s_sub_u32 s58, s27, 196608
    v_mfma_f32_16x16x32_bf16 v[96:99], v[32:35], a[192:195], v[128:131]
    s_min_u32 s27, s27, s58
    ds_read_b128 v[24:27], v2 offset:6272
    s_add_u32 s56, s56, 12288
    v_mfma_f32_16x16x32_bf16 v[96:99], v[36:39], a[196:199], v[96:99]
    s_mov_b32 m0, s56
    v_exp_f32 v18, v114
    v_add_f32 v5, v5, v16
    v_add_f32 v5, v5, v17
    v_mfma_f32_16x16x32_bf16 v[100:103], v[32:35], a[216:219], v[132:135]
    v_exp_f32 v19, v115
    v_mfma_f32_16x16x32_bf16 v[100:103], v[36:39], a[220:223], v[100:103]
    s_waitcnt vmcnt(11)
    buffer_load_dwordx4 v4, s[4:7], s27 offen offset:0 sc1 lds
    v_cvt_pk_bf16_f32 v82, v16, v17
    v_exp_f32 v16, v84
    v_add_f32 v5, v5, v18
    v_mfma_f32_16x16x32_bf16 v[104:107], v[32:35], a[240:243], v[136:139]
    ds_read_b128 v[28:31], v3 offset:6272
    v_add_f32 v5, v5, v19
    v_mfma_f32_16x16x32_bf16 v[104:107], v[36:39], a[244:247], v[104:107]
    s_waitcnt vmcnt(11)
    buffer_load_dwordx4 v4, s[4:7], s27 offen offset:1024 sc1 lds
    v_exp_f32 v17, v85
    v_cvt_pk_bf16_f32 v83, v18, v19
    v_mfma_f32_16x16x32_bf16 v[108:111], v[32:35], v[200:203], v[140:143]
    v_exp_f32 v18, v86
    v_mfma_f32_16x16x32_bf16 v[108:111], v[36:39], v[204:207], v[108:111]
    s_waitcnt lgkmcnt(2)
    s_waitcnt vmcnt(11)
    buffer_load_dwordx4 v4, s[4:7], s27 offen offset:2048 sc1 lds
    v_add_f32 v6, v6, v16
    v_add_f32 v6, v6, v17
    v_exp_f32 v19, v87
    v_mfma_f32_16x16x32_bf16 v[160:163], v[40:43], a[200:203], v[160:163]
    ds_read_b128 v[32:35], v2 offset:256
    v_cvt_pk_bf16_f32 v84, v16, v17
    v_mfma_f32_16x16x32_bf16 v[160:163], v[44:47], a[204:207], v[160:163]
    v_exp_f32 v16, v116
    v_add_f32 v6, v6, v18
    v_add_f32 v6, v6, v19
    v_mfma_f32_16x16x32_bf16 v[164:167], v[40:43], a[224:227], v[164:167]
    v_exp_f32 v17, v117
    v_mfma_f32_16x16x32_bf16 v[164:167], v[44:47], a[228:231], v[164:167]
    s_add_u32 s27, s27, 24576
    v_cvt_pk_bf16_f32 v85, v18, v19
    v_exp_f32 v18, v118
    v_add_f32 v6, v6, v16
    v_add_f32 v6, v6, v17
    s_sub_u32 s58, s27, 196608
    v_mfma_f32_16x16x32_bf16 v[168:171], v[40:43], a[248:251], v[168:171]
    s_waitcnt vmcnt(18)
    ds_read_b128 v[36:39], v3 offset:256
    v_lshlrev_b32 v48, 16, v56
    v_mfma_f32_16x16x32_bf16 v[168:171], v[44:47], a[252:255], v[168:171]
    s_waitcnt vmcnt(11)
    buffer_load_dwordx3 v[144:146], v12, s[68:71], s35 offen offset:0 nt
    v_exp_f32 v19, v119
    v_cvt_pk_bf16_f32 v86, v16, v17
    v_mfma_f32_16x16x32_bf16 v[172:175], v[40:43], v[208:211], v[172:175]
    s_min_u32 s27, s27, s58
    v_add_f32 v6, v6, v18
    v_add_f32 v6, v6, v19
    v_mfma_f32_16x16x32_bf16 v[172:175], v[44:47], v[212:215], v[172:175]
    s_waitcnt lgkmcnt(2)
    s_waitcnt vmcnt(11)
    buffer_load_dwordx3 v[148:150], v12, s[68:71], s35 offen offset:768 nt
    v_cvt_pk_bf16_f32 v87, v18, v19
    v_exp_f32 v16, v88
    v_and_b32 v49, s97, v56
    v_mfma_f32_16x16x32_bf16 v[96:99], v[24:27], a[200:203], v[96:99]
    s_add_u32 s56, s56, 36864
    ds_read_b128 v[40:43], v2 offset:6400
    v_lshlrev_b32 v50, 16, v58
    v_mfma_f32_16x16x32_bf16 v[96:99], v[28:31], a[204:207], v[96:99]
    s_waitcnt vmcnt(11)
    buffer_load_dwordx3 v[152:154], v12, s[68:71], s35 offen offset:1536 nt
    v_exp_f32 v17, v89
    v_and_b32 v51, s97, v58
    v_mfma_f32_16x16x32_bf16 v[100:103], v[24:27], a[224:227], v[100:103]
    s_sub_u32 s58, s56, 147456
    v_exp_f32 v18, v90
    v_mfma_f32_16x16x32_bf16 v[100:103], v[28:31], a[228:231], v[100:103]
    buffer_load_dwordx3 v[156:158], v12, s[68:71], s35 offen offset:2304 nt
    v_add_f32 v7, v7, v16
    v_add_f32 v7, v7, v17
    v_mul_f32 v48, s38, v48
    v_mfma_f32_16x16x32_bf16 v[104:107], v[24:27], a[248:251], v[104:107]
    s_min_u32 s56, s56, s58
    ds_read_b128 v[44:47], v3 offset:6400
    v_mul_f32 v49, s38, v49
    v_mfma_f32_16x16x32_bf16 v[104:107], v[28:31], a[252:255], v[104:107]
    v_exp_f32 v19, v91
    v_cvt_pk_bf16_f32 v88, v16, v17
    v_exp_f32 v16, v120
    v_mfma_f32_16x16x32_bf16 v[108:111], v[24:27], v[208:211], v[108:111]
    v_add_f32 v7, v7, v18
    v_add_f32 v7, v7, v19
    v_mfma_f32_16x16x32_bf16 v[108:111], v[28:31], v[212:215], v[108:111]
    s_waitcnt lgkmcnt(2)
    v_exp_f32 v17, v121
    v_mul_f32_e64 v50, -v50, v48
    v_mul_f32_e64 v51, -v51, v49
    v_cvt_pk_bf16_f32 v89, v18, v19
    v_cvt_f32_i32 v224, v224
    v_mfma_f32_16x16x32_bf16 v[160:163], v[32:35], a[208:211], v[160:163]
    ds_read_b128 v[24:27], v2 offset:12288
    v_cvt_f32_i32 v225, v225
    v_mfma_f32_16x16x32_bf16 v[160:163], v[36:39], a[212:215], v[160:163]
    v_exp_f32 v18, v122
    v_fma_f32 v224, v224, v48, v50
    v_add_f32 v7, v7, v16
    v_fma_f32 v225, v225, v49, v51
    v_mfma_f32_16x16x32_bf16 v[164:167], v[32:35], a[232:235], v[164:167]
    v_add_f32 v7, v7, v17
    v_cvt_pk_bf16_f32 v224, v224, v225
    v_mfma_f32_16x16x32_bf16 v[164:167], v[36:39], a[236:239], v[164:167]
    v_exp_f32 v19, v123
    v_cvt_f32_i32 v228, v228
    v_cvt_f32_i32 v229, v229
    v_cvt_pk_bf16_f32 v90, v16, v17
    v_mfma_f32_16x16x32_bf16 v[168:171], v[32:35], v[192:195], v[168:171]
    ds_read_b128 v[28:31], v3 offset:12288
    v_fma_f32 v228, v228, v48, v50
    v_mfma_f32_16x16x32_bf16 v[168:171], v[36:39], v[196:199], v[168:171]
    v_exp_f32 v16, v92
    v_fma_f32 v229, v229, v49, v51
    v_cvt_pk_bf16_f32 v228, v228, v229
    v_add_f32 v7, v7, v18
    v_mfma_f32_16x16x32_bf16 v[172:175], v[32:35], v[216:219], v[172:175]
    v_cvt_f32_i32 v232, v232
    v_add_f32 v7, v7, v19
    v_mfma_f32_16x16x32_bf16 v[172:175], v[36:39], v[220:223], v[172:175]
L_iw1:
L_pg1:
    s_cbranch_execz L_pg5
    s_waitcnt lgkmcnt(2)
    v_exp_f32 v17, v93
    v_cvt_f32_i32 v233, v233
    v_fma_f32 v232, v232, v48, v50
    v_fma_f32 v233, v233, v49, v51
    v_cvt_pk_bf16_f32 v91, v18, v19
    v_mfma_f32_16x16x32_bf16 v[96:99], v[40:43], a[208:211], v[96:99]
    ds_read_b128 v[32:35], v2 offset:18432
    v_cvt_pk_bf16_f32 v232, v232, v233
    v_mfma_f32_16x16x32_bf16 v[96:99], v[44:47], a[212:215], v[96:99]
    v_exp_f32 v18, v94
    v_cvt_f32_i32 v236, v236
    v_cvt_f32_i32 v237, v237
    v_add_f32 v8, v8, v16
    v_mfma_f32_16x16x32_bf16 v[100:103], v[40:43], a[232:235], v[100:103]
    v_fma_f32 v236, v236, v48, v50
    v_add_f32 v8, v8, v17
    v_mfma_f32_16x16x32_bf16 v[100:103], v[44:47], a[236:239], v[100:103]
    v_exp_f32 v19, v95
    v_fma_f32 v237, v237, v49, v51
    v_cvt_pk_bf16_f32 v236, v236, v237
    v_lshlrev_b32 v48, 16, v57
    v_mfma_f32_16x16x32_bf16 v[104:107], v[40:43], v[192:195], v[104:107]
    ds_read_b128 v[36:39], v3 offset:18432
    v_cvt_pk_bf16_f32 v92, v16, v17
    v_mfma_f32_16x16x32_bf16 v[104:107], v[44:47], v[196:199], v[104:107]
    v_exp_f32 v16, v124
    v_and_b32 v49, s97, v57
    v_lshlrev_b32 v50, 16, v59
    v_and_b32 v51, s97, v59
    v_mfma_f32_16x16x32_bf16 v[108:111], v[40:43], v[216:219], v[108:111]
    v_add_f32 v8, v8, v18
    v_mul_f32 v48, s38, v48
    v_mfma_f32_16x16x32_bf16 v[108:111], v[44:47], v[220:223], v[108:111]
    s_waitcnt lgkmcnt(2)
    v_add_f32 v8, v8, v19
    v_mul_f32 v49, s38, v49
    v_exp_f32 v17, v125
    v_mul_f32_e64 v50, -v50, v48
    v_mul_f32_e64 v51, -v51, v49
    v_mfma_f32_16x16x32_bf16 v[176:179], v[24:27], a[192:195], v[128:131]
    ds_read_b128 v[40:43], v2 offset:12416
    v_cvt_pk_bf16_f32 v93, v18, v19
    v_mfma_f32_16x16x32_bf16 v[176:179], v[28:31], a[196:199], v[176:179]
    v_exp_f32 v18, v126
    v_cvt_f32_i32 v226, v226
    v_cvt_f32_i32 v227, v227
    v_fma_f32 v226, v226, v48, v50
    v_mfma_f32_16x16x32_bf16 v[180:183], v[24:27], a[216:219], v[132:135]
    v_add_f32 v8, v8, v16
    v_fma_f32 v227, v227, v49, v51
    v_mfma_f32_16x16x32_bf16 v[180:183], v[28:31], a[220:223], v[180:183]
    v_add_f32 v8, v8, v17
    v_cvt_pk_bf16_f32 v225, v226, v227
    v_exp_f32 v19, v127
    v_cvt_f32_i32 v230, v230
    v_mfma_f32_16x16x32_bf16 v[184:187], v[24:27], a[240:243], v[136:139]
    ds_read_b128 v[44:47], v3 offset:12416
    v_cvt_f32_i32 v231, v231
    v_mfma_f32_16x16x32_bf16 v[184:187], v[28:31], a[244:247], v[184:187]
    v_cvt_pk_bf16_f32 v94, v16, v17
    v_fma_f32 v230, v230, v48, v50
    v_add_f32 v8, v8, v18
    v_fma_f32 v231, v231, v49, v51
    v_cvt_pk_bf16_f32 v229, v230, v231
    v_mfma_f32_16x16x32_bf16 v[188:191], v[24:27], v[200:203], v[140:143]
    v_add_f32 v8, v8, v19
    v_cvt_pk_bf16_f32 v95, v18, v19
    v_mfma_f32_16x16x32_bf16 v[188:191], v[28:31], v[204:207], v[188:191]
    s_waitcnt lgkmcnt(2)
    v_cvt_f32_i32 v234, v234
    v_cvt_f32_i32 v235, v235
    v_exp_f32 v16, v160
    v_fma_f32 v234, v234, v48, v50
    v_fma_f32 v235, v235, v49, v51
    v_mfma_f32_16x16x32_bf16 v[112:115], v[32:35], a[192:195], v[128:131]
    ds_read_b128 v[24:27], v2 offset:18560
    v_cvt_pk_bf16_f32 v233, v234, v235
    v_mfma_f32_16x16x32_bf16 v[112:115], v[36:39], a[196:199], v[112:115]
    v_exp_f32 v17, v161
    v_exp_f32 v18, v162
    v_add_f32 v5, v5, v16
    v_mfma_f32_16x16x32_bf16 v[116:119], v[32:35], a[216:219], v[132:135]
    v_cvt_f32_i32 v238, v238
    v_cvt_f32_i32 v239, v239
    v_mfma_f32_16x16x32_bf16 v[116:119], v[36:39], a[220:223], v[116:119]
    v_fma_f32 v238, v238, v48, v50
    v_add_f32 v5, v5, v17
    v_exp_f32 v19, v163
    v_cvt_pk_bf16_f32 v160, v16, v17
    v_mfma_f32_16x16x32_bf16 v[120:123], v[32:35], a[240:243], v[136:139]
    ds_read_b128 v[28:31], v3 offset:18560
    v_fma_f32 v239, v239, v49, v51
    v_cvt_pk_bf16_f32 v237, v238, v239
    v_mfma_f32_16x16x32_bf16 v[120:123], v[36:39], a[244:247], v[120:123]
    s_waitcnt vmcnt(16)
    v_lshlrev_b32 v48, 16, v60
    v_and_b32 v49, s97, v60
    v_lshlrev_b32 v50, 16, v62
    v_and_b32 v51, s97, v62
    v_mul_f32 v48, s38, v48
    v_mfma_f32_16x16x32_bf16 v[124:127], v[32:35], v[200:203], v[140:143]
    v_mul_f32 v49, s38, v49
    v_mul_f32_e64 v50, -v50, v48
    v_mfma_f32_16x16x32_bf16 v[124:127], v[36:39], v[204:207], v[124:127]
    s_waitcnt lgkmcnt(2)
    s_waitcnt vmcnt(12)
    buffer_load_dwordx2 v[56:57], off, s[80:83], s37 offset:0
    v_mul_f32_e64 v51, -v51, v49
    v_cvt_f32_i32 v240, v240
    v_cvt_f32_i32 v241, v241
    v_mfma_f32_16x16x32_bf16 v[176:179], v[40:43], a[200:203], v[176:179]
    ds_read_b128 v[32:35], v2 offset:12544
    v_fma_f32 v240, v240, v48, v50
    v_mfma_f32_16x16x32_bf16 v[176:179], v[44:47], a[204:207], v[176:179]
    buffer_load_dwordx2 v[58:59], off, s[84:87], s37 offset:0
    v_exp_f32 v16, v96
    v_fma_f32 v241, v241, v49, v51
    v_mfma_f32_16x16x32_bf16 v[180:183], v[40:43], a[224:227], v[180:183]
    v_cvt_pk_bf16_f32 v226, v240, v241
    v_add_f32 v5, v5, v18
    v_mfma_f32_16x16x32_bf16 v[180:183], v[44:47], a[228:231], v[180:183]
    v_cvt_f32_i32 v244, v244
    v_add_f32 v5, v5, v19
    v_cvt_f32_i32 v245, v245
    v_exp_f32 v17, v97
    v_fma_f32 v244, v244, v48, v50
    v_mfma_f32_16x16x32_bf16 v[184:187], v[40:43], a[248:251], v[184:187]
    ds_read_b128 v[36:39], v3 offset:12544
    v_fma_f32 v245, v245, v49, v51
    v_mfma_f32_16x16x32_bf16 v[184:187], v[44:47], a[252:255], v[184:187]
    v_cvt_pk_bf16_f32 v161, v18, v19
    v_cvt_pk_bf16_f32 v230, v244, v245
    v_exp_f32 v18, v98
    v_cvt_f32_i32 v248, v248
    v_mfma_f32_16x16x32_bf16 v[188:191], v[40:43], v[208:211], v[188:191]
    v_cvt_f32_i32 v249, v249
    v_add_f32 v5, v5, v16
    v_mfma_f32_16x16x32_bf16 v[188:191], v[44:47], v[212:215], v[188:191]
    s_waitcnt lgkmcnt(2)
    v_fma_f32 v248, v248, v48, v50
    v_add_f32 v5, v5, v17
    v_fma_f32 v249, v249, v49, v51
    v_exp_f32 v19, v99
    v_mfma_f32_16x16x32_bf16 v[112:115], v[24:27], a[200:203], v[112:115]
    ds_read_b128 v[40:43], v2 offset:18688
    v_cvt_pk_bf16_f32 v234, v248, v249
    v_mfma_f32_16x16x32_bf16 v[112:115], v[28:31], a[204:207], v[112:115]
    v_cvt_f32_i32 v252, v252
    v_cvt_pk_bf16_f32 v162, v16, v17
    v_cvt_f32_i32 v253, v253
    v_exp_f32 v16, v164
    v_mfma_f32_16x16x32_bf16 v[116:119], v[24:27], a[224:227], v[116:119]
    v_fma_f32 v252, v252, v48, v50
    v_fma_f32 v253, v253, v49, v51
    v_mfma_f32_16x16x32_bf16 v[116:119], v[28:31], a[228:231], v[116:119]
    v_add_f32 v5, v5, v18
    v_cvt_pk_bf16_f32 v238, v252, v253
    v_add_f32 v5, v5, v19
    v_lshlrev_b32 v48, 16, v61
    v_exp_f32 v17, v165
    v_mfma_f32_16x16x32_bf16 v[120:123], v[24:27], a[248:251], v[120:123]
    ds_read_b128 v[44:47], v3 offset:18688
    v_and_b32 v49, s97, v61
    v_mfma_f32_16x16x32_bf16 v[120:123], v[28:31], a[252:255], v[120:123]
    s_waitcnt lgkmcnt(2)
    v_lshlrev_b32 v50, 16, v63
    v_cvt_pk_bf16_f32 v163, v18, v19
    v_and_b32 v51, s97, v63
    v_exp_f32 v18, v166
    v_mfma_f32_16x16x32_bf16 v[124:127], v[24:27], v[208:211], v[124:127]
    s_waitcnt vmcnt(30)
    v_mul_f32 v48, s38, v48
    v_mul_f32 v49, s38, v49
    v_mfma_f32_16x16x32_bf16 v[124:127], v[28:31], v[212:215], v[124:127]
    s_barrier
    v_add_f32 v6, v6, v16
    v_mul_f32_e64 v50, -v50, v48
    v_add_f32 v6, v6, v17
    v_mul_f32_e64 v51, -v51, v49
    v_mfma_f32_16x16x32_bf16 v[176:179], v[32:35], a[208:211], v[176:179]
    ds_read_b128 v[24:27], v1 offset:0
    v_cvt_f32_i32 v242, v242
    v_mfma_f32_16x16x32_bf16 v[176:179], v[36:39], a[212:215], v[176:179]
    v_exp_f32 v19, v167
    v_cvt_f32_i32 v243, v243
    v_cvt_pk_bf16_f32 v164, v16, v17
    v_fma_f32 v242, v242, v48, v50
    v_mfma_f32_16x16x32_bf16 v[180:183], v[32:35], a[232:235], v[180:183]
    v_exp_f32 v16, v100
    v_mfma_f32_16x16x32_bf16 v[180:183], v[36:39], a[236:239], v[180:183]
    v_fma_f32 v243, v243, v49, v51
    v_cvt_pk_bf16_f32 v227, v242, v243
    v_add_f32 v6, v6, v18
    v_cvt_f32_i32 v246, v246
    v_add_f32 v6, v6, v19
    v_cvt_f32_i32 v247, v247
    v_mfma_f32_16x16x32_bf16 v[184:187], v[32:35], v[192:195], v[184:187]
    ds_read_b128 v[28:31], v1 offset:12288
    v_fma_f32 v246, v246, v48, v50
    v_mfma_f32_16x16x32_bf16 v[184:187], v[36:39], v[196:199], v[184:187]
    v_exp_f32 v17, v101
    v_fma_f32 v247, v247, v49, v51
    v_cvt_pk_bf16_f32 v165, v18, v19
    v_cvt_pk_bf16_f32 v231, v246, v247
    v_mfma_f32_16x16x32_bf16 v[188:191], v[32:35], v[216:219], v[188:191]
    v_exp_f32 v18, v102
    v_mfma_f32_16x16x32_bf16 v[188:191], v[36:39], v[220:223], v[188:191]
    s_waitcnt lgkmcnt(2)
    v_cvt_f32_i32 v250, v250
    v_cvt_f32_i32 v251, v251
    v_add_f32 v6, v6, v16
    v_fma_f32 v250, v250, v48, v50
    v_add_f32 v6, v6, v17
    v_mfma_f32_16x16x32_bf16 v[112:115], v[40:43], a[208:211], v[112:115]
    ds_read_b128 v[32:35], v1 offset:1024
    v_fma_f32 v251, v251, v49, v51
    v_mfma_f32_16x16x32_bf16 v[112:115], v[44:47], a[212:215], v[112:115]
    v_exp_f32 v19, v103
    v_cvt_pk_bf16_f32 v235, v250, v251
    v_cvt_f32_i32 v254, v254
    v_cvt_pk_bf16_f32 v166, v16, v17
    v_mfma_f32_16x16x32_bf16 v[116:119], v[40:43], a[232:235], v[116:119]
    v_cvt_f32_i32 v255, v255
    v_add_f32 v6, v6, v18
    v_mfma_f32_16x16x32_bf16 v[116:119], v[44:47], a[236:239], v[116:119]
    v_fma_f32 v254, v254, v48, v50
    v_add_f32 v6, v6, v19
    v_fma_f32 v255, v255, v49, v51
    v_cvt_pk_bf16_f32 v167, v18, v19
    v_cvt_pk_bf16_f32 v239, v254, v255
    v_mfma_f32_16x16x32_bf16 v[120:123], v[40:43], v[192:195], v[120:123]
    ds_read_b128 v[36:39], v1 offset:13312
    v_mfma_f32_16x16x32_bf16 v[120:123], v[44:47], v[196:199], v[120:123]
    v_mfma_f32_16x16x32_bf16 v[124:127], v[40:43], v[216:219], v[124:127]
    v_mfma_f32_16x16x32_bf16 v[124:127], v[44:47], v[220:223], v[124:127]
    s_waitcnt lgkmcnt(2)
    v_mfma_f32_16x16x32_bf16 a[144:147], v[76:79], v[24:27], 0
    ds_read_b128 v[40:43], v1 offset:2048
    v_mfma_f32_16x16x32_bf16 a[144:147], v[92:95], v[28:31], a[144:147]
    buffer_store_dwordx4 v[224:227], v11, s[4:7], s33 offen offset:0 sc1
    v_mfma_f32_16x16x32_bf16 a[0:3], v[80:83], v[28:31], a[0:3]
    ds_read_b128 v[44:47], v1 offset:14336
    v_mfma_f32_16x16x32_bf16 a[48:51], v[84:87], v[28:31], a[48:51]
    v_exp_f32 v16, v168
    v_mfma_f32_16x16x32_bf16 a[96:99], v[88:91], v[28:31], a[96:99]
    s_waitcnt lgkmcnt(2)
    v_exp_f32 v17, v169
    v_mfma_f32_16x16x32_bf16 a[148:151], v[76:79], v[32:35], 0
    ds_read_b128 v[24:27], v1 offset:3072
    v_exp_f32 v18, v170
    v_mfma_f32_16x16x32_bf16 a[148:151], v[92:95], v[36:39], a[148:151]
    v_add_f32 v7, v7, v16
    v_add_f32 v7, v7, v17
    v_mfma_f32_16x16x32_bf16 a[4:7], v[80:83], v[36:39], a[4:7]
    ds_read_b128 v[28:31], v1 offset:15360
    v_exp_f32 v19, v171
    v_mfma_f32_16x16x32_bf16 a[52:55], v[84:87], v[36:39], a[52:55]
    v_cvt_pk_bf16_f32 v168, v16, v17
    v_mfma_f32_16x16x32_bf16 a[100:103], v[88:91], v[36:39], a[100:103]
    s_waitcnt lgkmcnt(2)
    v_exp_f32 v16, v104
    v_mfma_f32_16x16x32_bf16 a[152:155], v[76:79], v[40:43], 0
    ds_read_b128 v[32:35], v1 offset:4096
    v_add_f32 v7, v7, v18
    v_mfma_f32_16x16x32_bf16 a[152:155], v[92:95], v[44:47], a[152:155]
    buffer_store_dwordx4 v[228:231], v21, s[4:7], s33 offen offset:768 sc1
    v_mfma_f32_16x16x32_bf16 a[8:11], v[80:83], v[44:47], a[8:11]
    ds_read_b128 v[36:39], v1 offset:16384
    v_add_f32 v7, v7, v19
    v_mfma_f32_16x16x32_bf16 a[56:59], v[84:87], v[44:47], a[56:59]
    v_exp_f32 v17, v105
    v_cvt_pk_bf16_f32 v169, v18, v19
    v_mfma_f32_16x16x32_bf16 a[104:107], v[88:91], v[44:47], a[104:107]
    s_waitcnt lgkmcnt(2)
    v_exp_f32 v18, v106
    v_mfma_f32_16x16x32_bf16 a[156:159], v[76:79], v[24:27], 0
    ds_read_b128 v[40:43], v1 offset:5120
    v_add_f32 v7, v7, v16
    v_add_f32 v7, v7, v17
    v_mfma_f32_16x16x32_bf16 a[156:159], v[92:95], v[28:31], a[156:159]
    v_exp_f32 v19, v107
    v_mfma_f32_16x16x32_bf16 a[12:15], v[80:83], v[28:31], a[12:15]
    ds_read_b128 v[44:47], v1 offset:17408
    v_cvt_pk_bf16_f32 v170, v16, v17
    v_mfma_f32_16x16x32_bf16 a[60:63], v[84:87], v[28:31], a[60:63]
    v_exp_f32 v16, v172
    v_mfma_f32_16x16x32_bf16 a[108:111], v[88:91], v[28:31], a[108:111]
    s_waitcnt lgkmcnt(2)
    v_add_f32 v7, v7, v18
    v_add_f32 v7, v7, v19
    v_mfma_f32_16x16x32_bf16 a[160:163], v[76:79], v[32:35], 0
    ds_read_b128 v[24:27], v1 offset:6144
    v_mfma_f32_16x16x32_bf16 a[160:163], v[92:95], v[36:39], a[160:163]
    buffer_store_dwordx4 v[232:235], v22, s[4:7], s33 offen offset:1536 sc1
    v_mfma_f32_16x16x32_bf16 a[16:19], v[80:83], v[36:39], a[16:19]
    ds_read_b128 v[28:31], v1 offset:18432
    v_mfma_f32_16x16x32_bf16 a[64:67], v[84:87], v[36:39], a[64:67]
    v_exp_f32 v17, v173
    v_cvt_pk_bf16_f32 v171, v18, v19
    v_mfma_f32_16x16x32_bf16 a[112:115], v[88:91], v[36:39], a[112:115]
    s_waitcnt lgkmcnt(2)
    v_exp_f32 v18, v174
    v_mfma_f32_16x16x32_bf16 a[164:167], v[76:79], v[40:43], 0
    ds_read_b128 v[32:35], v1 offset:7168
    v_add_f32 v8, v8, v16
    v_add_f32 v8, v8, v17
    v_mfma_f32_16x16x32_bf16 a[164:167], v[92:95], v[44:47], a[164:167]
    v_exp_f32 v19, v175
    v_mfma_f32_16x16x32_bf16 a[20:23], v[80:83], v[44:47], a[20:23]
    ds_read_b128 v[36:39], v1 offset:19456
    v_cvt_pk_bf16_f32 v172, v16, v17
    v_mfma_f32_16x16x32_bf16 a[68:71], v[84:87], v[44:47], a[68:71]
    v_exp_f32 v16, v108
    v_mfma_f32_16x16x32_bf16 a[116:119], v[88:91], v[44:47], a[116:119]
    s_waitcnt lgkmcnt(2)
    v_add_f32 v8, v8, v18
    v_add_f32 v8, v8, v19
    v_mfma_f32_16x16x32_bf16 a[168:171], v[76:79], v[24:27], 0
    ds_read_b128 v[40:43], v1 offset:8192
    v_mfma_f32_16x16x32_bf16 a[168:171], v[92:95], v[28:31], a[168:171]
    buffer_store_dwordx4 v[236:239], v23, s[4:7], s33 offen offset:2304 sc1
    v_mfma_f32_16x16x32_bf16 a[24:27], v[80:83], v[28:31], a[24:27]
    ds_read_b128 v[44:47], v1 offset:20480
    v_mfma_f32_16x16x32_bf16 a[72:75], v[84:87], v[28:31], a[72:75]
    v_exp_f32 v17, v109
    v_cvt_pk_bf16_f32 v173, v18, v19
    v_mfma_f32_16x16x32_bf16 a[120:123], v[88:91], v[28:31], a[120:123]
    s_waitcnt lgkmcnt(2)
    v_exp_f32 v18, v110
    v_mfma_f32_16x16x32_bf16 a[172:175], v[76:79], v[32:35], 0
    ds_read_b128 v[24:27], v1 offset:9216
    v_add_f32 v8, v8, v16
    v_add_f32 v8, v8, v17
    v_mfma_f32_16x16x32_bf16 a[172:175], v[92:95], v[36:39], a[172:175]
    v_exp_f32 v19, v111
    v_mfma_f32_16x16x32_bf16 a[28:31], v[80:83], v[36:39], a[28:31]
    ds_read_b128 v[28:31], v1 offset:21504
    v_cvt_pk_bf16_f32 v174, v16, v17
    v_add_f32 v8, v8, v18
    v_mfma_f32_16x16x32_bf16 a[76:79], v[84:87], v[36:39], a[76:79]
    v_add_f32 v8, v8, v19
    v_cvt_pk_bf16_f32 v175, v18, v19
    v_mfma_f32_16x16x32_bf16 a[124:127], v[88:91], v[36:39], a[124:127]
    s_waitcnt lgkmcnt(2)
    buffer_load_dwordx2 v[60:61], off, s[80:83], s37 offset:8
    v_mfma_f32_16x16x32_bf16 a[176:179], v[76:79], v[40:43], 0
    ds_read_b128 v[32:35], v1 offset:10240
    v_mfma_f32_16x16x32_bf16 a[176:179], v[92:95], v[44:47], a[176:179]
    buffer_load_dwordx2 v[62:63], off, s[84:87], s37 offset:8
    v_mfma_f32_16x16x32_bf16 a[32:35], v[80:83], v[44:47], a[32:35]
    ds_read_b128 v[36:39], v1 offset:22528
    v_mfma_f32_16x16x32_bf16 a[80:83], v[84:87], v[44:47], a[80:83]
    s_waitcnt vmcnt(19)
    buffer_load_dwordx3 v[240:242], v12, s[68:71], s16 offen offset:0 nt
    v_mfma_f32_16x16x32_bf16 a[128:131], v[88:91], v[44:47], a[128:131]
    s_waitcnt lgkmcnt(2)
    v_exp_f32 v16, v176
    v_mfma_f32_16x16x32_bf16 a[180:183], v[76:79], v[24:27], 0
    ds_read_b128 v[40:43], v1 offset:11264
    v_exp_f32 v17, v177
    v_mfma_f32_16x16x32_bf16 a[180:183], v[92:95], v[28:31], a[180:183]
    v_exp_f32 v18, v178
    v_mfma_f32_16x16x32_bf16 a[36:39], v[80:83], v[28:31], a[36:39]
    s_waitcnt vmcnt(19)
    ds_read_b128 v[44:47], v1 offset:23552
    v_add_f32 v5, v5, v16
    v_add_f32 v5, v5, v17
    v_mfma_f32_16x16x32_bf16 a[84:87], v[84:87], v[28:31], a[84:87]
    v_exp_f32 v19, v179
    v_mfma_f32_16x16x32_bf16 a[132:135], v[88:91], v[28:31], a[132:135]
    s_waitcnt lgkmcnt(2)
    s_barrier
    v_add_u32 v2, 49152, v2
    v_add_u32 v3, 49152, v3
    v_mfma_f32_16x16x32_bf16 a[184:187], v[76:79], v[32:35], 0
    ds_read_b128 v[24:27], v2 offset:0
    v_cvt_pk_bf16_f32 v176, v16, v17
    v_mfma_f32_16x16x32_bf16 a[184:187], v[92:95], v[36:39], a[184:187]
    buffer_load_dwordx3 v[244:246], v12, s[68:71], s16 offen offset:768 nt
    v_mfma_f32_16x16x32_bf16 a[40:43], v[80:83], v[36:39], a[40:43]
    ds_read_b128 v[28:31], v3 offset:0
    v_mfma_f32_16x16x32_bf16 a[88:91], v[84:87], v[36:39], a[88:91]
    buffer_load_dwordx3 v[248:250], v12, s[68:71], s16 offen offset:1536 nt
    v_mfma_f32_16x16x32_bf16 a[136:139], v[88:91], v[36:39], a[136:139]
    s_waitcnt lgkmcnt(2)
    v_exp_f32 v16, v112
    v_mfma_f32_16x16x32_bf16 a[188:191], v[76:79], v[40:43], 0
    ds_read_b128 v[32:35], v2 offset:6144
    v_add_f32 v5, v5, v18
    v_add_f32 v5, v5, v19
    v_mfma_f32_16x16x32_bf16 a[188:191], v[92:95], v[44:47], a[188:191]
    v_exp_f32 v17, v113
    v_mfma_f32_16x16x32_bf16 a[44:47], v[80:83], v[44:47], a[44:47]
    ds_read_b128 v[36:39], v3 offset:6144
    v_cvt_pk_bf16_f32 v177, v18, v19
    v_mfma_f32_16x16x32_bf16 a[92:95], v[84:87], v[44:47], a[92:95]
    v_exp_f32 v18, v114
    v_mfma_f32_16x16x32_bf16 a[140:143], v[88:91], v[44:47], a[140:143]
    s_waitcnt lgkmcnt(2)
    s_waitcnt vmcnt(20)
    buffer_load_dwordx3 v[252:254], v12, s[68:71], s16 offen offset:2304 nt
    v_add_f32 v5, v5, v16
    v_add_f32 v5, v5, v17
    v_exp_f32 v19, v115
    v_cvt_pk_bf16_f32 v178, v16, v17
    v_exp_f32 v16, v180
    v_add_f32 v5, v5, v18
    v_add_f32 v5, v5, v19
    v_exp_f32 v17, v181
    v_cvt_pk_bf16_f32 v179, v18, v19
    v_exp_f32 v18, v182
    v_add_f32 v6, v6, v16
    v_add_f32 v6, v6, v17
    v_exp_f32 v19, v183
    v_cvt_pk_bf16_f32 v180, v16, v17
    v_exp_f32 v16, v116
    v_add_f32 v6, v6, v18
    v_add_f32 v6, v6, v19
    v_exp_f32 v17, v117
    v_cvt_pk_bf16_f32 v181, v18, v19
    v_exp_f32 v18, v118
    v_add_f32 v6, v6, v16
    v_add_f32 v6, v6, v17
    v_exp_f32 v19, v119
    v_cvt_pk_bf16_f32 v182, v16, v17
    v_add_f32 v6, v6, v18
    v_add_f32 v6, v6, v19
    v_cvt_pk_bf16_f32 v183, v18, v19
    v_mfma_f32_16x16x32_bf16 v[64:67], v[24:27], a[192:195], v[128:131]
    s_waitcnt vmcnt(10)
    ds_read_b128 v[40:43], v2 offset:128
    v_lshlrev_b32 v48, 16, v56
    v_mfma_f32_16x16x32_bf16 v[64:67], v[28:31], a[196:199], v[64:67]
    v_exp_f32 v16, v184
    v_mfma_f32_16x16x32_bf16 v[68:71], v[24:27], a[216:219], v[132:135]
    v_exp_f32 v17, v185
    v_mfma_f32_16x16x32_bf16 v[68:71], v[28:31], a[220:223], v[68:71]
    v_exp_f32 v18, v186
    v_mfma_f32_16x16x32_bf16 v[72:75], v[24:27], a[240:243], v[136:139]
    ds_read_b128 v[44:47], v3 offset:128
    v_and_b32 v49, s97, v56
    v_mfma_f32_16x16x32_bf16 v[72:75], v[28:31], a[244:247], v[72:75]
    v_add_f32 v7, v7, v16
    v_add_f32 v7, v7, v17
    v_mfma_f32_16x16x32_bf16 v[76:79], v[24:27], v[200:203], v[140:143]
    v_exp_f32 v19, v187
    v_mfma_f32_16x16x32_bf16 v[76:79], v[28:31], v[204:207], v[76:79]
    s_waitcnt lgkmcnt(2)
    v_lshlrev_b32 v50, 16, v58
    v_and_b32 v51, s97, v58
    v_mfma_f32_16x16x32_bf16 v[96:99], v[32:35], a[192:195], v[128:131]
    ds_read_b128 v[24:27], v2 offset:6272
    v_cvt_pk_bf16_f32 v184, v16, v17
    v_mfma_f32_16x16x32_bf16 v[96:99], v[36:39], a[196:199], v[96:99]
    v_exp_f32 v16, v120
    v_mfma_f32_16x16x32_bf16 v[100:103], v[32:35], a[216:219], v[132:135]
    v_mul_f32_e64 v50, -v50, v48
    v_add_f32 v7, v7, v18
    v_mfma_f32_16x16x32_bf16 v[100:103], v[36:39], a[220:223], v[100:103]
    v_add_f32 v7, v7, v19
    v_mul_f32_e64 v51, -v51, v49
    v_mfma_f32_16x16x32_bf16 v[104:107], v[32:35], a[240:243], v[136:139]
    ds_read_b128 v[28:31], v3 offset:6272
    v_cvt_f32_i32 v144, v144
    v_mfma_f32_16x16x32_bf16 v[104:107], v[36:39], a[244:247], v[104:107]
    s_waitcnt lgkmcnt(2)
    v_exp_f32 v17, v121
    v_mfma_f32_16x16x32_bf16 v[108:111], v[32:35], v[200:203], v[140:143]
    s_waitcnt vmcnt(6)
    v_cvt_pk_bf16_f32 v185, v18, v19
    v_cvt_f32_i32 v148, v148
    v_mfma_f32_16x16x32_bf16 v[108:111], v[36:39], v[204:207], v[108:111]
    s_barrier
    v_mfma_f32_16x16x32_bf16 v[64:67], v[40:43], a[200:203], v[64:67]
    ds_read_b128 v[32:35], v2 offset:256
    v_add_u32 v0, 1, v0
    v_mfma_f32_16x16x32_bf16 v[64:67], v[44:47], a[204:207], v[64:67]
    buffer_store_dword v0, v13, s[20:23], 0 offen offset:32 sc1
    v_mfma_f32_16x16x32_bf16 v[68:71], v[40:43], a[224:227], v[68:71]
    s_mov_b32 m0, s26
    v_exp_f32 v18, v122
    v_mfma_f32_16x16x32_bf16 v[68:71], v[44:47], a[228:231], v[68:71]
    v_add_f32 v7, v7, v16
    v_add_f32 v7, v7, v17
    v_mfma_f32_16x16x32_bf16 v[72:75], v[40:43], a[248:251], v[72:75]
    ds_read_b128 v[36:39], v3 offset:256
    v_fma_f32 v144, v144, v48, v50
    v_mfma_f32_16x16x32_bf16 v[72:75], v[44:47], a[252:255], v[72:75]
    buffer_load_dwordx4 v4, s[4:7], s32 offen offset:0 sc1 lds
    v_mfma_f32_16x16x32_bf16 v[76:79], v[40:43], v[208:211], v[76:79]
    v_exp_f32 v19, v123
    v_mfma_f32_16x16x32_bf16 v[76:79], v[44:47], v[212:215], v[76:79]
    s_waitcnt lgkmcnt(2)
    v_cvt_pk_bf16_f32 v186, v16, v17
    v_fma_f32 v148, v148, v49, v51
    v_mfma_f32_16x16x32_bf16 v[96:99], v[24:27], a[200:203], v[96:99]
    ds_read_b128 v[40:43], v2 offset:6400
    v_cvt_f32_i32 v145, v145
    v_mfma_f32_16x16x32_bf16 v[96:99], v[28:31], a[204:207], v[96:99]
    buffer_load_dwordx4 v4, s[4:7], s32 offen offset:1024 sc1 lds
    v_mfma_f32_16x16x32_bf16 v[100:103], v[24:27], a[224:227], v[100:103]
    v_exp_f32 v16, v188
    v_mfma_f32_16x16x32_bf16 v[100:103], v[28:31], a[228:231], v[100:103]
    v_add_f32 v7, v7, v18
    v_add_f32 v7, v7, v19
    v_mfma_f32_16x16x32_bf16 v[104:107], v[24:27], a[248:251], v[104:107]
    ds_read_b128 v[44:47], v3 offset:6400
    v_cvt_f32_i32 v149, v149
    v_mfma_f32_16x16x32_bf16 v[104:107], v[28:31], a[252:255], v[104:107]
    buffer_load_dwordx4 v4, s[4:7], s32 offen offset:2048 sc1 lds
    v_mfma_f32_16x16x32_bf16 v[108:111], v[24:27], v[208:211], v[108:111]
    s_add_u32 s32, s32, 24576
    v_exp_f32 v17, v189
    v_mfma_f32_16x16x32_bf16 v[108:111], v[28:31], v[212:215], v[108:111]
    s_waitcnt lgkmcnt(2)
    v_cvt_pk_bf16_f32 v187, v18, v19
    v_fma_f32 v145, v145, v48, v50
    v_mfma_f32_16x16x32_bf16 v[64:67], v[32:35], a[208:211], v[64:67]
    s_sub_u32 s57, s32, 196608
    ds_read_b128 v[24:27], v2 offset:12288
    v_fma_f32 v149, v149, v49, v51
    v_mfma_f32_16x16x32_bf16 v[64:67], v[36:39], a[212:215], v[64:67]
    s_min_u32 s32, s32, s57
    v_exp_f32 v18, v190
    v_mfma_f32_16x16x32_bf16 v[68:71], v[32:35], a[232:235], v[68:71]
    s_add_u32 s26, s26, 12288
    v_add_f32 v8, v8, v16
    v_add_f32 v8, v8, v17
    v_mfma_f32_16x16x32_bf16 v[68:71], v[36:39], a[236:239], v[68:71]
    s_mov_b32 m0, s26
    v_exp_f32 v19, v191
    v_mfma_f32_16x16x32_bf16 v[72:75], v[32:35], v[192:195], v[72:75]
    ds_read_b128 v[28:31], v3 offset:12288
    v_cvt_pk_bf16_f32 v188, v16, v17
    v_mfma_f32_16x16x32_bf16 v[72:75], v[36:39], v[196:199], v[72:75]
    v_exp_f32 v16, v124
    v_mfma_f32_16x16x32_bf16 v[76:79], v[32:35], v[216:219], v[76:79]
    v_add_f32 v8, v8, v18
    v_add_f32 v8, v8, v19
    v_mfma_f32_16x16x32_bf16 v[76:79], v[36:39], v[220:223], v[76:79]
    s_waitcnt lgkmcnt(2)
    buffer_load_dwordx4 v4, s[4:7], s32 offen offset:0 sc1 lds
    v_mfma_f32_16x16x32_bf16 v[96:99], v[40:43], a[208:211], v[96:99]
    ds_read_b128 v[32:35], v2 offset:18432
    v_cvt_f32_i32 v146, v146
    v_mfma_f32_16x16x32_bf16 v[96:99], v[44:47], a[212:215], v[96:99]
    v_exp_f32 v17, v125
    v_mfma_f32_16x16x32_bf16 v[100:103], v[40:43], a[232:235], v[100:103]
    v_cvt_pk_bf16_f32 v189, v18, v19
    v_cvt_f32_i32 v150, v150
    v_mfma_f32_16x16x32_bf16 v[100:103], v[44:47], a[236:239], v[100:103]
    buffer_load_dwordx4 v4, s[4:7], s32 offen offset:1024 sc1 lds
    v_mfma_f32_16x16x32_bf16 v[104:107], v[40:43], v[192:195], v[104:107]
    ds_read_b128 v[36:39], v3 offset:18432
    v_fma_f32 v146, v146, v48, v50
    v_mfma_f32_16x16x32_bf16 v[104:107], v[44:47], v[196:199], v[104:107]
    v_exp_f32 v18, v126
    v_mfma_f32_16x16x32_bf16 v[108:111], v[40:43], v[216:219], v[108:111]
    v_add_f32 v8, v8, v16
    v_add_f32 v8, v8, v17
    v_mfma_f32_16x16x32_bf16 v[108:111], v[44:47], v[220:223], v[108:111]
    s_waitcnt lgkmcnt(2)
    buffer_load_dwordx4 v4, s[4:7], s32 offen offset:2048 sc1 lds
    v_mfma_f32_16x16x32_bf16 v[80:83], v[24:27], a[192:195], v[128:131]
    s_mov_b32 s32, 196608
    ds_read_b128 v[40:43], v2 offset:12416
    v_fma_f32 v150, v150, v49, v51
    v_mfma_f32_16x16x32_bf16 v[80:83], v[28:31], a[196:199], v[80:83]
    v_exp_f32 v19, v127
    v_cvt_pk_bf16_f32 v190, v16, v17
    v_mfma_f32_16x16x32_bf16 v[84:87], v[24:27], a[216:219], v[132:135]
    s_add_u32 s26, s26, 36864
    v_add_f32 v8, v8, v18
    v_add_f32 v8, v8, v19
    v_mfma_f32_16x16x32_bf16 v[84:87], v[28:31], a[220:223], v[84:87]
    s_sub_u32 s57, s26, 147456
    v_cvt_pk_bf16_f32 v191, v18, v19
    v_lshlrev_b32 v48, 16, v57
    v_mfma_f32_16x16x32_bf16 v[88:91], v[24:27], a[240:243], v[136:139]
    ds_read_b128 v[44:47], v3 offset:12416
    v_and_b32 v49, s97, v57
    v_mfma_f32_16x16x32_bf16 v[88:91], v[28:31], a[244:247], v[88:91]
    s_min_u32 s26, s26, s57
    v_exp_f32 v16, v64
    v_mfma_f32_16x16x32_bf16 v[92:95], v[24:27], v[200:203], v[140:143]
    v_exp_f32 v17, v65
    v_mfma_f32_16x16x32_bf16 v[92:95], v[28:31], v[204:207], v[92:95]
    s_waitcnt lgkmcnt(2)
    v_exp_f32 v18, v66
    v_mfma_f32_16x16x32_bf16 v[112:115], v[32:35], a[192:195], v[128:131]
    s_mov_b32 m0, s56
    ds_read_b128 v[24:27], v2 offset:18560
    v_lshlrev_b32 v50, 16, v59
    v_mfma_f32_16x16x32_bf16 v[112:115], v[36:39], a[196:199], v[112:115]
    v_add_f32 v5, v5, v16
    v_add_f32 v5, v5, v17
    v_mfma_f32_16x16x32_bf16 v[116:119], v[32:35], a[216:219], v[132:135]
    v_exp_f32 v19, v67
    v_mfma_f32_16x16x32_bf16 v[116:119], v[36:39], a[220:223], v[116:119]
    buffer_load_dwordx4 v4, s[4:7], s27 offen offset:0 sc1 lds
    v_mfma_f32_16x16x32_bf16 v[120:123], v[32:35], a[240:243], v[136:139]
    ds_read_b128 v[28:31], v3 offset:18560
    v_and_b32 v51, s97, v59
    v_mfma_f32_16x16x32_bf16 v[120:123], v[36:39], a[244:247], v[120:123]
    v_cvt_pk_bf16_f32 v64, v16, v17
    v_mul_f32_e64 v50, -v50, v48
    v_mfma_f32_16x16x32_bf16 v[124:127], v[32:35], v[200:203], v[140:143]
    v_exp_f32 v16, v96
    v_mfma_f32_16x16x32_bf16 v[124:127], v[36:39], v[204:207], v[124:127]
    s_waitcnt lgkmcnt(2)
    buffer_load_dwordx4 v4, s[4:7], s27 offen offset:1024 sc1 lds
    v_mfma_f32_16x16x32_bf16 v[80:83], v[40:43], a[200:203], v[80:83]
    ds_read_b128 v[32:35], v2 offset:12544
    v_add_f32 v5, v5, v18
    v_mfma_f32_16x16x32_bf16 v[80:83], v[44:47], a[204:207], v[80:83]
    v_add_f32 v5, v5, v19
    v_mul_f32_e64 v51, -v51, v49
    v_mfma_f32_16x16x32_bf16 v[84:87], v[40:43], a[224:227], v[84:87]
    v_exp_f32 v17, v97
    v_mfma_f32_16x16x32_bf16 v[84:87], v[44:47], a[228:231], v[84:87]
    s_waitcnt vmcnt(13)
    buffer_load_dwordx4 v4, s[4:7], s27 offen offset:2048 sc1 lds
    v_cvt_pk_bf16_f32 v65, v18, v19
    v_mfma_f32_16x16x32_bf16 v[88:91], v[40:43], a[248:251], v[88:91]
    s_add_u32 s27, s27, 24576
    ds_read_b128 v[36:39], v3 offset:12544
    v_cvt_f32_i32 v152, v152
    v_mfma_f32_16x16x32_bf16 v[88:91], v[44:47], a[252:255], v[88:91]
    v_exp_f32 v18, v98
    v_mfma_f32_16x16x32_bf16 v[92:95], v[40:43], v[208:211], v[92:95]
    s_sub_u32 s58, s27, 196608
    v_add_f32 v5, v5, v16
    v_add_f32 v5, v5, v17
    v_mfma_f32_16x16x32_bf16 v[92:95], v[44:47], v[212:215], v[92:95]
    s_waitcnt lgkmcnt(2)
    v_cvt_f32_i32 v156, v156
    v_fma_f32 v152, v152, v48, v50
    v_mfma_f32_16x16x32_bf16 v[112:115], v[24:27], a[200:203], v[112:115]
    s_min_u32 s27, s27, s58
    ds_read_b128 v[40:43], v2 offset:18688
    v_fma_f32 v156, v156, v49, v51
    v_mfma_f32_16x16x32_bf16 v[112:115], v[28:31], a[204:207], v[112:115]
L_iw2:
L_pg2:
    s_cbranch_execz L_pg6
    v_exp_f32 v19, v99
    v_cvt_pk_bf16_f32 v66, v16, v17
    v_mfma_f32_16x16x32_bf16 v[116:119], v[24:27], a[224:227], v[116:119]
    s_add_u32 s56, s56, 12288
    v_exp_f32 v16, v68
    v_mfma_f32_16x16x32_bf16 v[116:119], v[28:31], a[228:231], v[116:119]
    s_mov_b32 m0, s56
    v_add_f32 v5, v5, v18
    v_cvt_f32_i32 v153, v153
    v_mfma_f32_16x16x32_bf16 v[120:123], v[24:27], a[248:251], v[120:123]
    ds_read_b128 v[44:47], v3 offset:18688
    v_add_f32 v5, v5, v19
    v_mfma_f32_16x16x32_bf16 v[120:123], v[28:31], a[252:255], v[120:123]
    s_waitcnt lgkmcnt(2)
    v_exp_f32 v17, v69
    v_mfma_f32_16x16x32_bf16 v[124:127], v[24:27], v[208:211], v[124:127]
    s_waitcnt vmcnt(26)
    v_cvt_f32_i32 v157, v157
    v_cvt_pk_bf16_f32 v67, v18, v19
    v_mfma_f32_16x16x32_bf16 v[124:127], v[28:31], v[212:215], v[124:127]
    s_barrier
    v_add_u32 v1, 49152, v1
    v_mfma_f32_16x16x32_bf16 v[80:83], v[32:35], a[208:211], v[80:83]
    ds_read_b128 v[24:27], v1 offset:0
    v_fma_f32 v153, v153, v48, v50
    v_mfma_f32_16x16x32_bf16 v[80:83], v[36:39], a[212:215], v[80:83]
    s_waitcnt vmcnt(12)
    buffer_load_dwordx4 v4, s[4:7], s27 offen offset:0 sc1 lds
    v_mfma_f32_16x16x32_bf16 v[84:87], v[32:35], a[232:235], v[84:87]
    v_exp_f32 v18, v70
    v_mfma_f32_16x16x32_bf16 v[84:87], v[36:39], a[236:239], v[84:87]
    v_add_f32 v6, v6, v16
    v_add_f32 v6, v6, v17
    v_mfma_f32_16x16x32_bf16 v[88:91], v[32:35], v[192:195], v[88:91]
    ds_read_b128 v[28:31], v1 offset:12288
    v_fma_f32 v157, v157, v49, v51
    v_mfma_f32_16x16x32_bf16 v[88:91], v[36:39], v[196:199], v[88:91]
    s_waitcnt vmcnt(12)
    buffer_load_dwordx4 v4, s[4:7], s27 offen offset:1024 sc1 lds
    v_mfma_f32_16x16x32_bf16 v[92:95], v[32:35], v[216:219], v[92:95]
    v_exp_f32 v19, v71
    v_mfma_f32_16x16x32_bf16 v[92:95], v[36:39], v[220:223], v[92:95]
    s_waitcnt lgkmcnt(2)
    v_cvt_pk_bf16_f32 v68, v16, v17
    v_exp_f32 v16, v100
    v_mfma_f32_16x16x32_bf16 v[112:115], v[40:43], a[208:211], v[112:115]
    ds_read_b128 v[32:35], v1 offset:1024
    v_cvt_f32_i32 v154, v154
    v_mfma_f32_16x16x32_bf16 v[112:115], v[44:47], a[212:215], v[112:115]
    s_waitcnt vmcnt(12)
    buffer_load_dwordx4 v4, s[4:7], s27 offen offset:2048 sc1 lds
    v_add_f32 v6, v6, v18
    v_mfma_f32_16x16x32_bf16 v[116:119], v[40:43], a[232:235], v[116:119]
    v_add_f32 v6, v6, v19
    v_cvt_f32_i32 v158, v158
    v_mfma_f32_16x16x32_bf16 v[116:119], v[44:47], a[236:239], v[116:119]
    v_exp_f32 v17, v101
    v_cvt_pk_bf16_f32 v69, v18, v19
    v_mfma_f32_16x16x32_bf16 v[120:123], v[40:43], v[192:195], v[120:123]
    s_add_u32 s27, s27, 24576
    ds_read_b128 v[36:39], v1 offset:13312
    v_fma_f32 v154, v154, v48, v50
    v_mfma_f32_16x16x32_bf16 v[120:123], v[44:47], v[196:199], v[120:123]
    v_exp_f32 v18, v102
    v_fma_f32 v158, v158, v49, v51
    v_mfma_f32_16x16x32_bf16 v[124:127], v[40:43], v[216:219], v[124:127]
    s_sub_u32 s58, s27, 196608
    v_add_f32 v6, v6, v16
    v_add_f32 v6, v6, v17
    v_mfma_f32_16x16x32_bf16 v[124:127], v[44:47], v[220:223], v[124:127]
    s_waitcnt lgkmcnt(2)
    v_exp_f32 v19, v103
    v_cvt_pk_bf16_f32 v144, v144, v148
    v_cvt_pk_bf16_f32 v148, v145, v149
    v_cvt_pk_bf16_f32 v70, v16, v17
    s_min_u32 s27, s27, s58
    v_cvt_pk_bf16_f32 v145, v152, v156
    v_add_f32 v6, v6, v18
    s_add_u32 s56, s56, 36864
    v_cvt_pk_bf16_f32 v149, v153, v157
    v_add_f32 v6, v6, v19
    s_sub_u32 s58, s56, 147456
    v_cvt_pk_bf16_f32 v152, v146, v150
    v_cvt_pk_bf16_f32 v71, v18, v19
    s_min_u32 s56, s56, s58
    v_cvt_pk_bf16_f32 v153, v154, v158
    s_mov_b32 s31, 6
    v_mfma_f32_16x16x32_bf16 a[0:3], v[160:163], v[24:27], a[0:3]
    s_add_u32 s33, s33, 196608
    ds_read_b128 v[40:43], v1 offset:2048
    v_mfma_f32_16x16x32_bf16 a[0:3], v[176:179], v[28:31], a[0:3]
    s_add_u32 s34, s34, 196608
    v_exp_f32 v16, v72
    v_mfma_f32_16x16x32_bf16 a[48:51], v[164:167], v[24:27], a[48:51]
    s_add_u32 s36, s36, 1536
    v_exp_f32 v17, v73
    v_mfma_f32_16x16x32_bf16 a[48:51], v[180:183], v[28:31], a[48:51]
    v_exp_f32 v18, v74
    v_mfma_f32_16x16x32_bf16 a[96:99], v[168:171], v[24:27], a[96:99]
    ds_read_b128 v[44:47], v1 offset:14336
    v_add_f32 v7, v7, v16
    v_mfma_f32_16x16x32_bf16 a[96:99], v[184:187], v[28:31], a[96:99]
    s_waitcnt vmcnt(11)
    buffer_load_dwordx2 v[56:57], v10, s[72:75], s36 offen offset:0
    v_mfma_f32_16x16x32_bf16 a[144:147], v[172:175], v[24:27], a[144:147]
    v_add_f32 v7, v7, v17
    v_mfma_f32_16x16x32_bf16 a[144:147], v[188:191], v[28:31], a[144:147]
    s_waitcnt lgkmcnt(2)
    v_exp_f32 v19, v75
    v_mfma_f32_16x16x32_bf16 a[4:7], v[160:163], v[32:35], a[4:7]
    ds_read_b128 v[24:27], v1 offset:3072
    v_cvt_pk_bf16_f32 v72, v16, v17
    v_mfma_f32_16x16x32_bf16 a[4:7], v[176:179], v[36:39], a[4:7]
    buffer_load_dwordx2 v[58:59], v10, s[76:79], s36 offen offset:0
    v_mfma_f32_16x16x32_bf16 a[52:55], v[164:167], v[32:35], a[52:55]
    v_exp_f32 v16, v104
    v_mfma_f32_16x16x32_bf16 a[52:55], v[180:183], v[36:39], a[52:55]
    v_add_f32 v7, v7, v18
    v_add_f32 v7, v7, v19
    v_mfma_f32_16x16x32_bf16 a[100:103], v[168:171], v[32:35], a[100:103]
    ds_read_b128 v[28:31], v1 offset:15360
    v_mfma_f32_16x16x32_bf16 a[100:103], v[184:187], v[36:39], a[100:103]
    s_waitcnt vmcnt(12)
    buffer_load_dwordx4 v[224:227], v9, s[64:67], s33 offen offset:0 nt
    v_mfma_f32_16x16x32_bf16 a[148:151], v[172:175], v[32:35], a[148:151]
    v_exp_f32 v17, v105
    v_mfma_f32_16x16x32_bf16 a[148:151], v[188:191], v[36:39], a[148:151]
    s_waitcnt lgkmcnt(2)
    v_cvt_pk_bf16_f32 v73, v18, v19
    v_mfma_f32_16x16x32_bf16 a[8:11], v[160:163], v[40:43], a[8:11]
    ds_read_b128 v[32:35], v1 offset:4096
    v_mfma_f32_16x16x32_bf16 a[8:11], v[176:179], v[44:47], a[8:11]
    s_waitcnt vmcnt(12)
    buffer_load_dwordx4 v[228:231], v9, s[64:67], s33 offen offset:1536 nt
    v_mfma_f32_16x16x32_bf16 a[56:59], v[164:167], v[40:43], a[56:59]
    v_exp_f32 v18, v106
    v_mfma_f32_16x16x32_bf16 a[56:59], v[180:183], v[44:47], a[56:59]
    v_add_f32 v7, v7, v16
    v_add_f32 v7, v7, v17
    v_mfma_f32_16x16x32_bf16 a[104:107], v[168:171], v[40:43], a[104:107]
    s_waitcnt vmcnt(17)
    ds_read_b128 v[36:39], v1 offset:16384
    v_lshlrev_b32 v48, 16, v60
    v_mfma_f32_16x16x32_bf16 a[104:107], v[184:187], v[44:47], a[104:107]
    buffer_load_dwordx4 v[232:235], v9, s[64:67], s34 offen offset:0 nt
    v_mfma_f32_16x16x32_bf16 a[152:155], v[172:175], v[40:43], a[152:155]
    v_exp_f32 v19, v107
    v_mfma_f32_16x16x32_bf16 a[152:155], v[188:191], v[44:47], a[152:155]
    s_waitcnt lgkmcnt(2)
    v_cvt_pk_bf16_f32 v74, v16, v17
    v_and_b32 v49, s97, v60
    v_mfma_f32_16x16x32_bf16 a[12:15], v[160:163], v[24:27], a[12:15]
    ds_read_b128 v[40:43], v1 offset:5120
    v_lshlrev_b32 v50, 16, v62
    v_mfma_f32_16x16x32_bf16 a[12:15], v[176:179], v[28:31], a[12:15]
    s_waitcnt vmcnt(13)
    buffer_load_dwordx4 v[236:239], v9, s[64:67], s34 offen offset:1536 nt
    v_mfma_f32_16x16x32_bf16 a[60:63], v[164:167], v[24:27], a[60:63]
    v_exp_f32 v16, v76
    v_mfma_f32_16x16x32_bf16 a[60:63], v[180:183], v[28:31], a[60:63]
    v_add_f32 v7, v7, v18
    v_add_f32 v7, v7, v19
    v_mfma_f32_16x16x32_bf16 a[108:111], v[168:171], v[24:27], a[108:111]
    ds_read_b128 v[44:47], v1 offset:17408
    v_and_b32 v51, s97, v62
    v_mfma_f32_16x16x32_bf16 a[108:111], v[184:187], v[28:31], a[108:111]
    v_exp_f32 v17, v77
    v_mfma_f32_16x16x32_bf16 a[156:159], v[172:175], v[24:27], a[156:159]
    s_add_u32 s29, s28, 49152
    v_cvt_pk_bf16_f32 v75, v18, v19
    v_mul_f32_e64 v50, -v50, v48
    v_mfma_f32_16x16x32_bf16 a[156:159], v[188:191], v[28:31], a[156:159]
    s_waitcnt lgkmcnt(2)
    v_exp_f32 v18, v78
    v_mfma_f32_16x16x32_bf16 a[16:19], v[160:163], v[32:35], a[16:19]
    s_mov_b32 m0, s56
    ds_read_b128 v[24:27], v1 offset:6144
    v_add_f32 v8, v8, v16
    v_mfma_f32_16x16x32_bf16 a[16:19], v[176:179], v[36:39], a[16:19]
    s_sub_u32 s3, s29, 147456
    s_waitcnt vmcnt(13)
    buffer_load_dwordx4 v4, s[4:7], s27 offen offset:0 sc1 lds
    v_mfma_f32_16x16x32_bf16 a[64:67], v[164:167], v[32:35], a[64:67]
    s_min_u32 s29, s29, s3
    v_add_f32 v8, v8, v17
    v_mul_f32_e64 v51, -v51, v49
    v_mfma_f32_16x16x32_bf16 a[64:67], v[180:183], v[36:39], a[64:67]
    v_exp_f32 v19, v79
    v_mfma_f32_16x16x32_bf16 a[112:115], v[168:171], v[32:35], a[112:115]
    ds_read_b128 v[28:31], v1 offset:18432
    v_cvt_pk_bf16_f32 v76, v16, v17
    v_mfma_f32_16x16x32_bf16 a[112:115], v[184:187], v[36:39], a[112:115]
    s_waitcnt vmcnt(13)
    buffer_load_dwordx4 v4, s[4:7], s27 offen offset:1024 sc1 lds
    v_mfma_f32_16x16x32_bf16 a[160:163], v[172:175], v[32:35], a[160:163]
    s_sub_u32 s3, s29, s28
    v_exp_f32 v16, v108
    v_mfma_f32_16x16x32_bf16 a[160:163], v[188:191], v[36:39], a[160:163]
    s_waitcnt lgkmcnt(2)
    v_add_f32 v8, v8, v18
    v_add_f32 v8, v8, v19
    v_mfma_f32_16x16x32_bf16 a[20:23], v[160:163], v[40:43], a[20:23]
    ds_read_b128 v[32:35], v1 offset:7168
    v_cvt_f32_i32 v240, v240
    v_mfma_f32_16x16x32_bf16 a[20:23], v[176:179], v[44:47], a[20:23]
    buffer_load_dword v52, v20, s[20:23], s44 offen sc1
    v_mfma_f32_16x16x32_bf16 a[68:71], v[164:167], v[40:43], a[68:71]
    v_exp_f32 v17, v109
    v_mfma_f32_16x16x32_bf16 a[68:71], v[180:183], v[44:47], a[68:71]
    v_cvt_pk_bf16_f32 v77, v18, v19
    v_cvt_f32_i32 v244, v244
    v_mfma_f32_16x16x32_bf16 a[116:119], v[168:171], v[40:43], a[116:119]
    s_mov_b32 s28, s29
    ds_read_b128 v[36:39], v1 offset:19456
    v_fma_f32 v240, v240, v48, v50
    v_mfma_f32_16x16x32_bf16 a[116:119], v[184:187], v[44:47], a[116:119]
    s_waitcnt vmcnt(14)
    buffer_load_dwordx4 v4, s[4:7], s27 offen offset:2048 sc1 lds
    v_mfma_f32_16x16x32_bf16 a[164:167], v[172:175], v[40:43], a[164:167]
    s_add_u32 s27, s27, 24576
    v_exp_f32 v18, v110
    v_mfma_f32_16x16x32_bf16 a[164:167], v[188:191], v[44:47], a[164:167]
    s_waitcnt lgkmcnt(2)
    v_add_f32 v8, v8, v16
    v_add_f32 v8, v8, v17
    v_fma_f32 v244, v244, v49, v51
    v_mfma_f32_16x16x32_bf16 a[24:27], v[160:163], v[24:27], a[24:27]
    s_sub_u32 s58, s27, 196608
    ds_read_b128 v[40:43], v1 offset:8192
    v_cvt_f32_i32 v241, v241
    v_mfma_f32_16x16x32_bf16 a[24:27], v[176:179], v[28:31], a[24:27]
    v_exp_f32 v19, v111
    v_cvt_pk_bf16_f32 v78, v16, v17
    v_mfma_f32_16x16x32_bf16 a[72:75], v[164:167], v[24:27], a[72:75]
    s_min_u32 s27, s27, s58
    v_add_f32 v8, v8, v18
    v_add_f32 v8, v8, v19
    v_mfma_f32_16x16x32_bf16 a[72:75], v[180:183], v[28:31], a[72:75]
    v_cvt_f32_i32 v245, v245
    v_cvt_pk_bf16_f32 v79, v18, v19
    v_mfma_f32_16x16x32_bf16 a[120:123], v[168:171], v[24:27], a[120:123]
    s_add_u32 s56, s56, 12288
    ds_read_b128 v[44:47], v1 offset:20480
    v_fma_f32 v241, v241, v48, v50
    v_mfma_f32_16x16x32_bf16 a[120:123], v[184:187], v[28:31], a[120:123]
    v_exp_f32 v16, v80
    v_mfma_f32_16x16x32_bf16 a[168:171], v[172:175], v[24:27], a[168:171]
    s_mov_b32 m0, s56
    v_exp_f32 v17, v81
    v_mfma_f32_16x16x32_bf16 a[168:171], v[188:191], v[28:31], a[168:171]
    s_waitcnt lgkmcnt(2)
    v_fma_f32 v245, v245, v49, v51
    v_exp_f32 v18, v82
    v_mfma_f32_16x16x32_bf16 a[28:31], v[160:163], v[32:35], a[28:31]
    ds_read_b128 v[24:27], v1 offset:9216
    v_cvt_f32_i32 v242, v242
    v_mfma_f32_16x16x32_bf16 a[28:31], v[176:179], v[36:39], a[28:31]
    v_add_f32 v5, v5, v16
    v_cvt_f32_i32 v246, v246
    v_mfma_f32_16x16x32_bf16 a[76:79], v[164:167], v[32:35], a[76:79]
    v_add_f32 v5, v5, v17
    v_fma_f32 v242, v242, v48, v50
    v_mfma_f32_16x16x32_bf16 a[76:79], v[180:183], v[36:39], a[76:79]
    s_waitcnt vmcnt(14)
    buffer_load_dwordx4 v4, s[4:7], s27 offen offset:0 sc1 lds
    v_mfma_f32_16x16x32_bf16 a[124:127], v[168:171], v[32:35], a[124:127]
    ds_read_b128 v[28:31], v1 offset:21504
    v_fma_f32 v246, v246, v49, v51
    v_mfma_f32_16x16x32_bf16 a[124:127], v[184:187], v[36:39], a[124:127]
    v_exp_f32 v19, v83
    v_cvt_pk_bf16_f32 v80, v16, v17
    v_mfma_f32_16x16x32_bf16 a[172:175], v[172:175], v[32:35], a[172:175]
    v_exp_f32 v16, v112
    v_mfma_f32_16x16x32_bf16 a[172:175], v[188:191], v[36:39], a[172:175]
    s_waitcnt lgkmcnt(2)
    s_waitcnt vmcnt(14)
    buffer_load_dwordx4 v4, s[4:7], s27 offen offset:1024 sc1 lds
    v_add_f32 v5, v5, v18
    v_mfma_f32_16x16x32_bf16 a[32:35], v[160:163], v[40:43], a[32:35]
    ds_read_b128 v[32:35], v1 offset:10240
    v_lshlrev_b32 v48, 16, v61
    v_mfma_f32_16x16x32_bf16 a[32:35], v[176:179], v[44:47], a[32:35]
    v_add_f32 v5, v5, v19
    v_exp_f32 v17, v113
    v_mfma_f32_16x16x32_bf16 a[80:83], v[164:167], v[40:43], a[80:83]
    v_and_b32 v49, s97, v61
    v_cvt_pk_bf16_f32 v81, v18, v19
    v_mfma_f32_16x16x32_bf16 a[80:83], v[180:183], v[44:47], a[80:83]
    s_waitcnt vmcnt(14)
    buffer_load_dwordx4 v4, s[4:7], s27 offen offset:2048 sc1 lds
    v_lshlrev_b32 v50, 16, v63
    v_mfma_f32_16x16x32_bf16 a[128:131], v[168:171], v[40:43], a[128:131]
    ds_read_b128 v[36:39], v1 offset:22528
    v_and_b32 v51, s97, v63
    v_mfma_f32_16x16x32_bf16 a[128:131], v[184:187], v[44:47], a[128:131]
    v_exp_f32 v18, v114
    v_add_f32 v5, v5, v16
    v_mfma_f32_16x16x32_bf16 a[176:179], v[172:175], v[40:43], a[176:179]
    v_add_u32 v2, s3, v2
    v_add_u32 v3, s3, v3
    v_mfma_f32_16x16x32_bf16 a[176:179], v[188:191], v[44:47], a[176:179]
    s_waitcnt lgkmcnt(2)
    v_add_f32 v5, v5, v17
    v_exp_f32 v19, v115
    v_mfma_f32_16x16x32_bf16 a[36:39], v[160:163], v[24:27], a[36:39]
    ds_read_b128 v[40:43], v1 offset:11264
    v_mul_f32_e64 v50, -v50, v48
    v_mfma_f32_16x16x32_bf16 a[36:39], v[176:179], v[28:31], a[36:39]
    v_cvt_pk_bf16_f32 v82, v16, v17
    v_mul_f32_e64 v51, -v51, v49
    v_mfma_f32_16x16x32_bf16 a[84:87], v[164:167], v[24:27], a[84:87]
    v_exp_f32 v16, v84
    v_mfma_f32_16x16x32_bf16 a[84:87], v[180:183], v[28:31], a[84:87]
    v_cvt_f32_i32 v248, v248
    v_add_f32 v5, v5, v18
    v_cvt_f32_i32 v252, v252
    v_mfma_f32_16x16x32_bf16 a[132:135], v[168:171], v[24:27], a[132:135]
    s_mov_b32 s27, 208896
    ds_read_b128 v[44:47], v1 offset:23552
    v_add_f32 v5, v5, v19
    v_mfma_f32_16x16x32_bf16 a[132:135], v[184:187], v[28:31], a[132:135]
    s_waitcnt lgkmcnt(2)
    v_exp_f32 v17, v85
    v_fma_f32 v248, v248, v48, v50
    v_mfma_f32_16x16x32_bf16 a[180:183], v[172:175], v[24:27], a[180:183]
    s_waitcnt vmcnt(19)
    v_cvt_pk_bf16_f32 v83, v18, v19
    v_fma_f32 v252, v252, v49, v51
    v_mfma_f32_16x16x32_bf16 a[180:183], v[188:191], v[28:31], a[180:183]
    s_barrier
    v_exp_f32 v18, v86
    v_mfma_f32_16x16x32_bf16 a[40:43], v[160:163], v[32:35], a[40:43]
    s_add_u32 s56, s56, 36864
    ds_read_b128 v[24:27], v2 offset:0
    v_cvt_f32_i32 v249, v249
    v_mfma_f32_16x16x32_bf16 a[40:43], v[176:179], v[36:39], a[40:43]
    s_sub_u32 s58, s56, 147456
    v_add_f32 v6, v6, v16
    v_add_f32 v6, v6, v17
    v_mfma_f32_16x16x32_bf16 a[88:91], v[164:167], v[32:35], a[88:91]
    s_min_u32 s56, s56, s58
    v_cvt_f32_i32 v253, v253
    v_fma_f32 v249, v249, v48, v50
    v_mfma_f32_16x16x32_bf16 a[88:91], v[180:183], v[36:39], a[88:91]
    v_exp_f32 v19, v87
    v_mfma_f32_16x16x32_bf16 a[136:139], v[168:171], v[32:35], a[136:139]
    ds_read_b128 v[28:31], v3 offset:0
    v_cvt_pk_bf16_f32 v84, v16, v17
    v_mfma_f32_16x16x32_bf16 a[136:139], v[184:187], v[36:39], a[136:139]
    v_exp_f32 v16, v116
    v_mfma_f32_16x16x32_bf16 a[184:187], v[172:175], v[32:35], a[184:187]
    v_fma_f32 v253, v253, v49, v51
    v_add_f32 v6, v6, v18
    v_mfma_f32_16x16x32_bf16 a[184:187], v[188:191], v[36:39], a[184:187]
    s_waitcnt lgkmcnt(2)
    v_cvt_f32_i32 v250, v250
    v_add_f32 v6, v6, v19
    v_mfma_f32_16x16x32_bf16 a[44:47], v[160:163], v[40:43], a[44:47]
    ds_read_b128 v[32:35], v2 offset:6144
    v_cvt_f32_i32 v254, v254
    v_mfma_f32_16x16x32_bf16 a[44:47], v[176:179], v[44:47], a[44:47]
    v_exp_f32 v17, v117
    v_mfma_f32_16x16x32_bf16 a[92:95], v[164:167], v[40:43], a[92:95]
    v_cvt_pk_bf16_f32 v85, v18, v19
    v_fma_f32 v250, v250, v48, v50
    v_mfma_f32_16x16x32_bf16 a[92:95], v[180:183], v[44:47], a[92:95]
    v_exp_f32 v18, v118
    v_mfma_f32_16x16x32_bf16 a[140:143], v[168:171], v[40:43], a[140:143]
    s_nop 0
    ds_read_b128 v[36:39], v3 offset:6144
    v_fma_f32 v254, v254, v49, v51
    v_mfma_f32_16x16x32_bf16 a[140:143], v[184:187], v[44:47], a[140:143]
    v_add_f32 v6, v6, v16
    v_add_f32 v6, v6, v17
    v_mfma_f32_16x16x32_bf16 a[188:191], v[172:175], v[40:43], a[188:191]
    s_waitcnt lgkmcnt(2)
    v_exp_f32 v19, v119
    v_cvt_pk_bf16_f32 v146, v240, v244
    v_cvt_pk_bf16_f32 v150, v241, v245
    v_cvt_pk_bf16_f32 v86, v16, v17
    v_cvt_pk_bf16_f32 v147, v248, v252
    v_add_f32 v6, v6, v18
    v_cvt_pk_bf16_f32 v151, v249, v253
    v_add_f32 v6, v6, v19
    v_cvt_pk_bf16_f32 v154, v242, v246
    v_cvt_pk_bf16_f32 v87, v18, v19
    v_cvt_pk_bf16_f32 v155, v250, v254
    v_mfma_f32_16x16x32_bf16 a[188:191], v[188:191], v[44:47], a[188:191]
    s_branch L_join
.p2align 6
L_loop:
    v_mfma_f32_16x16x32_bf16 v[160:163], v[24:27], a[192:195], v[128:131]
    s_mov_b32 m0, s56
    ds_read_b128 v[40:43], v2 offset:128
    v_cvt_f32_i32 v247, v247
    v_mfma_f32_16x16x32_bf16 v[160:163], v[28:31], a[196:199], v[160:163]
    buffer_load_dwordx4 v4, s[4:7], s27 offen offset:0 sc1 lds
    v_mfma_f32_16x16x32_bf16 v[164:167], v[24:27], a[216:219], v[132:135]
    v_exp_f32 v16, v88
    v_mfma_f32_16x16x32_bf16 v[164:167], v[28:31], a[220:223], v[164:167]
    v_exp_f32 v17, v89
    v_mfma_f32_16x16x32_bf16 v[168:171], v[24:27], a[240:243], v[136:139]
    ds_read_b128 v[44:47], v3 offset:128
    v_fma_f32 v246, v246, v48, v50
    v_mfma_f32_16x16x32_bf16 v[168:171], v[28:31], a[244:247], v[168:171]
    v_exp_f32 v18, v90
    v_mfma_f32_16x16x32_bf16 v[172:175], v[24:27], v[200:203], v[140:143]
    v_fma_f32 v247, v247, v49, v51
    v_add_f32 v7, v7, v16
    v_mfma_f32_16x16x32_bf16 v[172:175], v[28:31], v[204:207], v[172:175]
    s_waitcnt lgkmcnt(2)
    v_add_f32 v7, v7, v17
    v_cvt_pk_bf16_f32 v231, v246, v247
    v_mfma_f32_16x16x32_bf16 v[96:99], v[32:35], a[192:195], v[128:131]
    ds_read_b128 v[24:27], v2 offset:6272
    v_cvt_f32_i32 v250, v250
    v_mfma_f32_16x16x32_bf16 v[96:99], v[36:39], a[196:199], v[96:99]
    buffer_load_dwordx4 v4, s[4:7], s27 offen offset:1024 sc1 lds
    v_mfma_f32_16x16x32_bf16 v[100:103], v[32:35], a[216:219], v[132:135]
    v_exp_f32 v19, v91
    v_mfma_f32_16x16x32_bf16 v[100:103], v[36:39], a[220:223], v[100:103]
    v_cvt_pk_bf16_f32 v88, v16, v17
    v_cvt_f32_i32 v251, v251
    v_mfma_f32_16x16x32_bf16 v[104:107], v[32:35], a[240:243], v[136:139]
    ds_read_b128 v[28:31], v3 offset:6272
    v_fma_f32 v250, v250, v48, v50
    v_mfma_f32_16x16x32_bf16 v[104:107], v[36:39], a[244:247], v[104:107]
    v_exp_f32 v16, v120
    v_mfma_f32_16x16x32_bf16 v[108:111], v[32:35], v[200:203], v[140:143]
    v_add_f32 v7, v7, v18
    v_add_f32 v7, v7, v19
    v_mfma_f32_16x16x32_bf16 v[108:111], v[36:39], v[204:207], v[108:111]
    s_waitcnt lgkmcnt(2)
    v_exp_f32 v17, v121
    v_mfma_f32_16x16x32_bf16 v[160:163], v[40:43], a[200:203], v[160:163]
    ds_read_b128 v[32:35], v2 offset:256
    v_cvt_pk_bf16_f32 v89, v18, v19
    v_mfma_f32_16x16x32_bf16 v[160:163], v[44:47], a[204:207], v[160:163]
    v_exp_f32 v18, v122
    v_mfma_f32_16x16x32_bf16 v[164:167], v[40:43], a[224:227], v[164:167]
    v_fma_f32 v251, v251, v49, v51
    v_add_f32 v7, v7, v16
    v_mfma_f32_16x16x32_bf16 v[164:167], v[44:47], a[228:231], v[164:167]
    buffer_load_dwordx4 v4, s[4:7], s27 offen offset:2048 sc1 lds
    v_mfma_f32_16x16x32_bf16 v[168:171], v[40:43], a[248:251], v[168:171]
    ds_read_b128 v[36:39], v3 offset:256
    v_cvt_pk_bf16_f32 v235, v250, v251
    v_mfma_f32_16x16x32_bf16 v[168:171], v[44:47], a[252:255], v[168:171]
    v_add_f32 v7, v7, v17
    v_cvt_f32_i32 v254, v254
    v_mfma_f32_16x16x32_bf16 v[172:175], v[40:43], v[208:211], v[172:175]
    v_exp_f32 v19, v123
    v_mfma_f32_16x16x32_bf16 v[172:175], v[44:47], v[212:215], v[172:175]
    s_waitcnt lgkmcnt(2)
    v_cvt_pk_bf16_f32 v90, v16, v17
    v_cvt_f32_i32 v255, v255
    v_mfma_f32_16x16x32_bf16 v[96:99], v[24:27], a[200:203], v[96:99]
    ds_read_b128 v[40:43], v2 offset:6400
    v_fma_f32 v254, v254, v48, v50
    v_mfma_f32_16x16x32_bf16 v[96:99], v[28:31], a[204:207], v[96:99]
    s_add_u32 s27, s27, 24576
    v_exp_f32 v16, v92
    v_mfma_f32_16x16x32_bf16 v[100:103], v[24:27], a[224:227], v[100:103]
    v_add_f32 v7, v7, v18
    v_add_f32 v7, v7, v19
    v_mfma_f32_16x16x32_bf16 v[100:103], v[28:31], a[228:231], v[100:103]
    v_exp_f32 v17, v93
    v_mfma_f32_16x16x32_bf16 v[104:107], v[24:27], a[248:251], v[104:107]
    ds_read_b128 v[44:47], v3 offset:6400
    v_fma_f32 v255, v255, v49, v51
    v_mfma_f32_16x16x32_bf16 v[104:107], v[28:31], a[252:255], v[104:107]
    v_cvt_pk_bf16_f32 v91, v18, v19
    v_cvt_pk_bf16_f32 v239, v254, v255
    v_mfma_f32_16x16x32_bf16 v[108:111], v[24:27], v[208:211], v[108:111]
    s_add_u32 s29, s30, 49152
    v_exp_f32 v18, v94
    v_mfma_f32_16x16x32_bf16 v[108:111], v[28:31], v[212:215], v[108:111]
    s_waitcnt lgkmcnt(2)
    v_add_f32 v8, v8, v16
    v_add_f32 v8, v8, v17
    v_mfma_f32_16x16x32_bf16 v[160:163], v[32:35], a[208:211], v[160:163]
    s_waitcnt vmcnt(11)
    ds_read_b128 v[24:27], v2 offset:12288
    v_lshlrev_b32 v48, 16, v56
    v_mfma_f32_16x16x32_bf16 v[160:163], v[36:39], a[212:215], v[160:163]
    s_sub_u32 s3, s29, 147456
    buffer_load_dwordx2 v[60:61], off, s[80:83], s37 offset:8
    v_mfma_f32_16x16x32_bf16 v[164:167], v[32:35], a[232:235], v[164:167]
    s_add_u32 s56, s56, 12288
    v_exp_f32 v19, v95
    v_mfma_f32_16x16x32_bf16 v[164:167], v[36:39], a[236:239], v[164:167]
    s_min_u32 s29, s29, s3
    v_cvt_pk_bf16_f32 v92, v16, v17
    v_and_b32 v49, s97, v56
    v_mfma_f32_16x16x32_bf16 v[168:171], v[32:35], v[192:195], v[168:171]
    s_mov_b32 m0, s56
    ds_read_b128 v[28:31], v3 offset:12288
    v_mfma_f32_16x16x32_bf16 v[168:171], v[36:39], v[196:199], v[168:171]
    buffer_load_dwordx2 v[62:63], off, s[84:87], s37 offset:8
    v_mfma_f32_16x16x32_bf16 v[172:175], v[32:35], v[216:219], v[172:175]
    v_exp_f32 v16, v124
    v_mfma_f32_16x16x32_bf16 v[172:175], v[36:39], v[220:223], v[172:175]
    s_waitcnt lgkmcnt(2)
    v_add_f32 v8, v8, v18
    v_add_f32 v8, v8, v19
    v_mfma_f32_16x16x32_bf16 v[96:99], v[40:43], a[208:211], v[96:99]
    ds_read_b128 v[32:35], v2 offset:18432
    v_lshlrev_b32 v50, 16, v58
    v_mfma_f32_16x16x32_bf16 v[96:99], v[44:47], a[212:215], v[96:99]
    s_sub_u32 s3, s29, s30
    v_exp_f32 v17, v125
    v_mfma_f32_16x16x32_bf16 v[100:103], v[40:43], a[232:235], v[100:103]
    v_cvt_pk_bf16_f32 v93, v18, v19
    v_mfma_f32_16x16x32_bf16 v[100:103], v[44:47], a[236:239], v[100:103]
    buffer_load_dwordx4 v4, s[4:7], s27 offen offset:0 sc1 lds
    v_mfma_f32_16x16x32_bf16 v[104:107], v[40:43], v[192:195], v[104:107]
    ds_read_b128 v[36:39], v3 offset:18432
    v_mfma_f32_16x16x32_bf16 v[104:107], v[44:47], v[196:199], v[104:107]
    v_exp_f32 v18, v126
    v_mfma_f32_16x16x32_bf16 v[108:111], v[40:43], v[216:219], v[108:111]
    v_add_f32 v8, v8, v16
    v_add_f32 v8, v8, v17
    v_mfma_f32_16x16x32_bf16 v[108:111], v[44:47], v[220:223], v[108:111]
    s_waitcnt lgkmcnt(2)
    buffer_load_dwordx3 v[240:242], v12, s[68:71], s16 offen offset:0 nt
    v_mfma_f32_16x16x32_bf16 v[176:179], v[24:27], a[192:195], v[128:131]
    ds_read_b128 v[40:43], v2 offset:12416
    v_and_b32 v51, s97, v58
    v_mfma_f32_16x16x32_bf16 v[176:179], v[28:31], a[196:199], v[176:179]
    v_exp_f32 v19, v127
    v_cvt_pk_bf16_f32 v94, v16, v17
    v_mfma_f32_16x16x32_bf16 v[180:183], v[24:27], a[216:219], v[132:135]
    s_mov_b32 s30, s29
    v_add_f32 v8, v8, v18
    v_add_f32 v8, v8, v19
    v_mfma_f32_16x16x32_bf16 v[180:183], v[28:31], a[220:223], v[180:183]
    buffer_load_dwordx4 v4, s[4:7], s27 offen offset:1024 sc1 lds
    v_mfma_f32_16x16x32_bf16 v[184:187], v[24:27], a[240:243], v[136:139]
    ds_read_b128 v[44:47], v3 offset:12416
    v_cvt_pk_bf16_f32 v95, v18, v19
    v_mfma_f32_16x16x32_bf16 v[184:187], v[28:31], a[244:247], v[184:187]
    v_exp_f32 v16, v160
    v_mfma_f32_16x16x32_bf16 v[188:191], v[24:27], v[200:203], v[140:143]
    v_exp_f32 v17, v161
    v_mfma_f32_16x16x32_bf16 v[188:191], v[28:31], v[204:207], v[188:191]
    s_waitcnt lgkmcnt(2)
    buffer_load_dwordx3 v[244:246], v12, s[68:71], s16 offen offset:768 nt
    v_mfma_f32_16x16x32_bf16 v[112:115], v[32:35], a[192:195], v[128:131]
    ds_read_b128 v[24:27], v2 offset:18560
    v_mul_f32_e64 v50, -v50, v48
    v_mfma_f32_16x16x32_bf16 v[112:115], v[36:39], a[196:199], v[112:115]
    v_exp_f32 v18, v162
    v_mfma_f32_16x16x32_bf16 v[116:119], v[32:35], a[216:219], v[132:135]
    v_add_f32 v5, v5, v16
    v_add_f32 v5, v5, v17
    v_mfma_f32_16x16x32_bf16 v[116:119], v[36:39], a[220:223], v[116:119]
    v_exp_f32 v19, v163
    v_mfma_f32_16x16x32_bf16 v[120:123], v[32:35], a[240:243], v[136:139]
    ds_read_b128 v[28:31], v3 offset:18560
    v_cvt_pk_bf16_f32 v160, v16, v17
    v_mfma_f32_16x16x32_bf16 v[120:123], v[36:39], a[244:247], v[120:123]
    buffer_load_dwordx3 v[248:250], v12, s[68:71], s16 offen offset:1536 nt
    v_mfma_f32_16x16x32_bf16 v[124:127], v[32:35], v[200:203], v[140:143]
    v_exp_f32 v16, v96
    v_mfma_f32_16x16x32_bf16 v[124:127], v[36:39], v[204:207], v[124:127]
    s_waitcnt lgkmcnt(2)
    v_add_f32 v5, v5, v18
    v_add_f32 v5, v5, v19
    v_mfma_f32_16x16x32_bf16 v[176:179], v[40:43], a[200:203], v[176:179]
    ds_read_b128 v[32:35], v2 offset:12544
    v_mul_f32_e64 v51, -v51, v49
    v_mfma_f32_16x16x32_bf16 v[176:179], v[44:47], a[204:207], v[176:179]
    buffer_load_dwordx4 v4, s[4:7], s27 offen offset:2048 sc1 lds
    v_mfma_f32_16x16x32_bf16 v[180:183], v[40:43], a[224:227], v[180:183]
    v_exp_f32 v17, v97
    v_mfma_f32_16x16x32_bf16 v[180:183], v[44:47], a[228:231], v[180:183]
    v_cvt_pk_bf16_f32 v161, v18, v19
    v_add_u32 v1, s3, v1
    v_mfma_f32_16x16x32_bf16 v[184:187], v[40:43], a[248:251], v[184:187]
    ds_read_b128 v[36:39], v3 offset:12544
    v_cvt_f32_i32 v144, v144
    v_mfma_f32_16x16x32_bf16 v[184:187], v[44:47], a[252:255], v[184:187]
    buffer_load_dwordx3 v[252:254], v12, s[68:71], s16 offen offset:2304 nt
    v_mfma_f32_16x16x32_bf16 v[188:191], v[40:43], v[208:211], v[188:191]
    v_exp_f32 v18, v98
    v_mfma_f32_16x16x32_bf16 v[188:191], v[44:47], v[212:215], v[188:191]
    s_waitcnt lgkmcnt(2)
    v_add_f32 v5, v5, v16
    v_add_f32 v5, v5, v17
    v_mfma_f32_16x16x32_bf16 v[112:115], v[24:27], a[200:203], v[112:115]
    ds_read_b128 v[40:43], v2 offset:18688
    v_cvt_f32_i32 v148, v148
    v_mfma_f32_16x16x32_bf16 v[112:115], v[28:31], a[204:207], v[112:115]
    v_exp_f32 v19, v99
    v_cvt_pk_bf16_f32 v162, v16, v17
    v_mfma_f32_16x16x32_bf16 v[116:119], v[24:27], a[224:227], v[116:119]
    v_exp_f32 v16, v164
    v_mfma_f32_16x16x32_bf16 v[116:119], v[28:31], a[228:231], v[116:119]
    s_add_u32 s27, s27, 24576
    v_add_f32 v5, v5, v18
    v_add_f32 v5, v5, v19
    v_mfma_f32_16x16x32_bf16 v[120:123], v[24:27], a[248:251], v[120:123]
    s_add_u32 s56, s56, 36864
    ds_read_b128 v[44:47], v3 offset:18688
    v_fma_f32 v144, v144, v48, v50
    v_mfma_f32_16x16x32_bf16 v[120:123], v[28:31], a[252:255], v[120:123]
    s_waitcnt lgkmcnt(2)
    v_exp_f32 v17, v165
    v_mfma_f32_16x16x32_bf16 v[124:127], v[24:27], v[208:211], v[124:127]
    s_waitcnt vmcnt(12)
    v_cvt_pk_bf16_f32 v163, v18, v19
    s_sub_u32 s58, s56, 147456
    v_mfma_f32_16x16x32_bf16 v[124:127], v[28:31], v[212:215], v[124:127]
    s_barrier
    s_min_u32 s56, s56, s58
    v_mfma_f32_16x16x32_bf16 v[176:179], v[32:35], a[208:211], v[176:179]
    ds_read_b128 v[24:27], v1 offset:0
    v_mfma_f32_16x16x32_bf16 v[176:179], v[36:39], a[212:215], v[176:179]
    v_exp_f32 v18, v166
    v_mfma_f32_16x16x32_bf16 v[180:183], v[32:35], a[232:235], v[180:183]
    v_add_f32 v6, v6, v16
    v_add_f32 v6, v6, v17
    v_mfma_f32_16x16x32_bf16 v[180:183], v[36:39], a[236:239], v[180:183]
    v_exp_f32 v19, v167
    v_mfma_f32_16x16x32_bf16 v[184:187], v[32:35], v[192:195], v[184:187]
    ds_read_b128 v[28:31], v1 offset:12288
    v_cvt_pk_bf16_f32 v164, v16, v17
    v_mfma_f32_16x16x32_bf16 v[184:187], v[36:39], v[196:199], v[184:187]
L_iw3:
L_pg3:
    s_cbranch_execz L_pg7
    v_exp_f32 v16, v100
    v_mfma_f32_16x16x32_bf16 v[188:191], v[32:35], v[216:219], v[188:191]
    v_add_f32 v6, v6, v18
    v_add_f32 v6, v6, v19
    v_mfma_f32_16x16x32_bf16 v[188:191], v[36:39], v[220:223], v[188:191]
    s_waitcnt lgkmcnt(2)
    v_exp_f32 v17, v101
    v_mfma_f32_16x16x32_bf16 v[112:115], v[40:43], a[208:211], v[112:115]
    ds_read_b128 v[32:35], v1 offset:1024
    v_cvt_pk_bf16_f32 v165, v18, v19
    v_mfma_f32_16x16x32_bf16 v[112:115], v[44:47], a[212:215], v[112:115]
    v_exp_f32 v18, v102
    v_mfma_f32_16x16x32_bf16 v[116:119], v[40:43], a[232:235], v[116:119]
    v_add_f32 v6, v6, v16
    v_add_f32 v6, v6, v17
    v_mfma_f32_16x16x32_bf16 v[116:119], v[44:47], a[236:239], v[116:119]
    v_exp_f32 v19, v103
    v_mfma_f32_16x16x32_bf16 v[120:123], v[40:43], v[192:195], v[120:123]
    ds_read_b128 v[36:39], v1 offset:13312
    v_cvt_pk_bf16_f32 v166, v16, v17
    v_mfma_f32_16x16x32_bf16 v[120:123], v[44:47], v[196:199], v[120:123]
    v_add_f32 v6, v6, v18
    v_fma_f32 v148, v148, v49, v51
    v_mfma_f32_16x16x32_bf16 v[124:127], v[40:43], v[216:219], v[124:127]
    v_add_f32 v6, v6, v19
    v_cvt_pk_bf16_f32 v167, v18, v19
    v_mfma_f32_16x16x32_bf16 v[124:127], v[44:47], v[220:223], v[124:127]
    s_waitcnt lgkmcnt(2)
    v_mfma_f32_16x16x32_bf16 a[0:3], v[64:67], v[24:27], a[0:3]
    ds_read_b128 v[40:43], v1 offset:2048
    v_cvt_f32_i32 v145, v145
    v_mfma_f32_16x16x32_bf16 a[0:3], v[80:83], v[28:31], a[0:3]
    buffer_store_dwordx4 v[224:227], v11, s[4:7], s33 offen offset:0 sc1
    v_mfma_f32_16x16x32_bf16 a[48:51], v[68:71], v[24:27], a[48:51]
    v_exp_f32 v16, v168
    v_mfma_f32_16x16x32_bf16 a[48:51], v[84:87], v[28:31], a[48:51]
    v_exp_f32 v17, v169
    v_mfma_f32_16x16x32_bf16 a[96:99], v[72:75], v[24:27], a[96:99]
    ds_read_b128 v[44:47], v1 offset:14336
    v_cvt_f32_i32 v149, v149
    v_mfma_f32_16x16x32_bf16 a[96:99], v[88:91], v[28:31], a[96:99]
    v_exp_f32 v18, v170
    v_mfma_f32_16x16x32_bf16 a[144:147], v[76:79], v[24:27], a[144:147]
    v_add_f32 v7, v7, v16
    v_add_f32 v7, v7, v17
    v_mfma_f32_16x16x32_bf16 a[144:147], v[92:95], v[28:31], a[144:147]
    s_waitcnt lgkmcnt(2)
    v_exp_f32 v19, v171
    v_mfma_f32_16x16x32_bf16 a[4:7], v[64:67], v[32:35], a[4:7]
    ds_read_b128 v[24:27], v1 offset:3072
    v_cvt_pk_bf16_f32 v168, v16, v17
    v_mfma_f32_16x16x32_bf16 a[4:7], v[80:83], v[36:39], a[4:7]
    buffer_store_dwordx4 v[228:231], v21, s[4:7], s33 offen offset:768 sc1
    v_mfma_f32_16x16x32_bf16 a[52:55], v[68:71], v[32:35], a[52:55]
    v_exp_f32 v16, v104
    v_mfma_f32_16x16x32_bf16 a[52:55], v[84:87], v[36:39], a[52:55]
    v_add_f32 v7, v7, v18
    v_fma_f32 v145, v145, v48, v50
    v_mfma_f32_16x16x32_bf16 a[100:103], v[72:75], v[32:35], a[100:103]
    ds_read_b128 v[28:31], v1 offset:15360
    v_add_f32 v7, v7, v19
    v_mfma_f32_16x16x32_bf16 a[100:103], v[88:91], v[36:39], a[100:103]
    v_exp_f32 v17, v105
    v_mfma_f32_16x16x32_bf16 a[148:151], v[76:79], v[32:35], a[148:151]
    v_cvt_pk_bf16_f32 v169, v18, v19
    v_fma_f32 v149, v149, v49, v51
    v_mfma_f32_16x16x32_bf16 a[148:151], v[92:95], v[36:39], a[148:151]
    s_waitcnt lgkmcnt(2)
    v_exp_f32 v18, v106
    v_mfma_f32_16x16x32_bf16 a[8:11], v[64:67], v[40:43], a[8:11]
    ds_read_b128 v[32:35], v1 offset:4096
    v_add_f32 v7, v7, v16
    v_mfma_f32_16x16x32_bf16 a[8:11], v[80:83], v[44:47], a[8:11]
    buffer_store_dwordx4 v[232:235], v22, s[4:7], s33 offen offset:1536 sc1
    v_mfma_f32_16x16x32_bf16 a[56:59], v[68:71], v[40:43], a[56:59]
    v_add_f32 v7, v7, v17
    v_cvt_f32_i32 v146, v146
    v_mfma_f32_16x16x32_bf16 a[56:59], v[84:87], v[44:47], a[56:59]
    v_exp_f32 v19, v107
    v_mfma_f32_16x16x32_bf16 a[104:107], v[72:75], v[40:43], a[104:107]
    ds_read_b128 v[36:39], v1 offset:16384
    v_cvt_pk_bf16_f32 v170, v16, v17
    v_mfma_f32_16x16x32_bf16 a[104:107], v[88:91], v[44:47], a[104:107]
    v_exp_f32 v16, v172
    v_mfma_f32_16x16x32_bf16 a[152:155], v[76:79], v[40:43], a[152:155]
    v_add_f32 v7, v7, v18
    v_cvt_f32_i32 v150, v150
    v_mfma_f32_16x16x32_bf16 a[152:155], v[92:95], v[44:47], a[152:155]
    s_waitcnt lgkmcnt(2)
    v_add_f32 v7, v7, v19
    v_fma_f32 v146, v146, v48, v50
    v_mfma_f32_16x16x32_bf16 a[12:15], v[64:67], v[24:27], a[12:15]
    ds_read_b128 v[40:43], v1 offset:5120
    v_mfma_f32_16x16x32_bf16 a[12:15], v[80:83], v[28:31], a[12:15]
    buffer_store_dwordx4 v[236:239], v23, s[4:7], s33 offen offset:2304 sc1
    v_mfma_f32_16x16x32_bf16 a[60:63], v[68:71], v[24:27], a[60:63]
    v_exp_f32 v17, v173
    v_mfma_f32_16x16x32_bf16 a[60:63], v[84:87], v[28:31], a[60:63]
    v_cvt_pk_bf16_f32 v171, v18, v19
    v_fma_f32 v150, v150, v49, v51
    v_mfma_f32_16x16x32_bf16 a[108:111], v[72:75], v[24:27], a[108:111]
    ds_read_b128 v[44:47], v1 offset:17408
    v_mfma_f32_16x16x32_bf16 a[108:111], v[88:91], v[28:31], a[108:111]
    v_exp_f32 v18, v174
    v_mfma_f32_16x16x32_bf16 a[156:159], v[76:79], v[24:27], a[156:159]
    s_add_u32 s29, s28, 49152
    v_add_f32 v8, v8, v16
    v_add_f32 v8, v8, v17
    v_mfma_f32_16x16x32_bf16 a[156:159], v[92:95], v[28:31], a[156:159]
    s_waitcnt lgkmcnt(2)
    v_exp_f32 v19, v175
    v_mfma_f32_16x16x32_bf16 a[16:19], v[64:67], v[32:35], a[16:19]
    s_sub_u32 s3, s29, 147456
    ds_read_b128 v[24:27], v1 offset:6144
    v_cvt_pk_bf16_f32 v172, v16, v17
    v_mfma_f32_16x16x32_bf16 a[16:19], v[80:83], v[36:39], a[16:19]
    s_mov_b32 m0, s26
    v_exp_f32 v16, v108
    v_mfma_f32_16x16x32_bf16 a[64:67], v[68:71], v[32:35], a[64:67]
    s_min_u32 s29, s29, s3
    v_add_f32 v8, v8, v18
    v_lshlrev_b32 v48, 16, v57
    v_mfma_f32_16x16x32_bf16 a[64:67], v[84:87], v[36:39], a[64:67]
    buffer_load_dwordx4 v4, s[4:7], s32 offen offset:0 sc1 lds
    v_mfma_f32_16x16x32_bf16 a[112:115], v[72:75], v[32:35], a[112:115]
    ds_read_b128 v[28:31], v1 offset:18432
    v_add_f32 v8, v8, v19
    v_mfma_f32_16x16x32_bf16 a[112:115], v[88:91], v[36:39], a[112:115]
    v_exp_f32 v17, v109
    v_mfma_f32_16x16x32_bf16 a[160:163], v[76:79], v[32:35], a[160:163]
    v_cvt_pk_bf16_f32 v173, v18, v19
    v_and_b32 v49, s97, v57
    v_mfma_f32_16x16x32_bf16 a[160:163], v[92:95], v[36:39], a[160:163]
    s_waitcnt lgkmcnt(2)
    buffer_load_dwordx4 v4, s[4:7], s32 offen offset:1024 sc1 lds
    v_mfma_f32_16x16x32_bf16 a[20:23], v[64:67], v[40:43], a[20:23]
    s_sub_u32 s3, s29, s28
    ds_read_b128 v[32:35], v1 offset:7168
    v_lshlrev_b32 v50, 16, v59
    v_mfma_f32_16x16x32_bf16 a[20:23], v[80:83], v[44:47], a[20:23]
    v_exp_f32 v18, v110
    v_mfma_f32_16x16x32_bf16 a[68:71], v[68:71], v[40:43], a[68:71]
    v_add_f32 v8, v8, v16
    v_add_f32 v8, v8, v17
    v_mfma_f32_16x16x32_bf16 a[68:71], v[84:87], v[44:47], a[68:71]
    buffer_load_dwordx4 v4, s[4:7], s32 offen offset:2048 sc1 lds
    v_mfma_f32_16x16x32_bf16 a[116:119], v[72:75], v[40:43], a[116:119]
    ds_read_b128 v[36:39], v1 offset:19456
    v_mfma_f32_16x16x32_bf16 a[116:119], v[88:91], v[44:47], a[116:119]
    v_exp_f32 v19, v111
    v_mfma_f32_16x16x32_bf16 a[164:167], v[76:79], v[40:43], a[164:167]
    s_mov_b32 s28, s29
    v_cvt_pk_bf16_f32 v174, v16, v17
    v_add_f32 v8, v8, v18
    v_mfma_f32_16x16x32_bf16 a[164:167], v[92:95], v[44:47], a[164:167]
    s_waitcnt lgkmcnt(2)
    v_add_f32 v8, v8, v19
    v_cvt_pk_bf16_f32 v175, v18, v19
    v_mfma_f32_16x16x32_bf16 a[24:27], v[64:67], v[24:27], a[24:27]
    s_add_u32 s32, s32, 24576
    ds_read_b128 v[40:43], v1 offset:8192
    v_and_b32 v51, s97, v59
    v_mfma_f32_16x16x32_bf16 a[24:27], v[80:83], v[28:31], a[24:27]
    v_exp_f32 v16, v176
    v_mfma_f32_16x16x32_bf16 a[72:75], v[68:71], v[24:27], a[72:75]
    s_add_u32 s26, s26, 12288
    v_exp_f32 v17, v177
    v_mfma_f32_16x16x32_bf16 a[72:75], v[84:87], v[28:31], a[72:75]
    v_exp_f32 v18, v178
    v_mfma_f32_16x16x32_bf16 a[120:123], v[72:75], v[24:27], a[120:123]
    s_mov_b32 m0, s26
    ds_read_b128 v[44:47], v1 offset:20480
    v_add_f32 v5, v5, v16
    v_mfma_f32_16x16x32_bf16 a[120:123], v[88:91], v[28:31], a[120:123]
    v_add_f32 v5, v5, v17
    v_mul_f32_e64 v50, -v50, v48
    v_mfma_f32_16x16x32_bf16 a[168:171], v[76:79], v[24:27], a[168:171]
    v_exp_f32 v19, v179
    v_mfma_f32_16x16x32_bf16 a[168:171], v[92:95], v[28:31], a[168:171]
    s_waitcnt lgkmcnt(2)
    v_cvt_pk_bf16_f32 v176, v16, v17
    v_mul_f32_e64 v51, -v51, v49
    v_mfma_f32_16x16x32_bf16 a[28:31], v[64:67], v[32:35], a[28:31]
    ds_read_b128 v[24:27], v1 offset:9216
    v_add_u32 v2, s3, v2
    v_mfma_f32_16x16x32_bf16 a[28:31], v[80:83], v[36:39], a[28:31]
    buffer_load_dwordx4 v4, s[4:7], s32 offen offset:0 sc1 lds
    v_mfma_f32_16x16x32_bf16 a[76:79], v[68:71], v[32:35], a[76:79]
    v_exp_f32 v16, v112
    v_mfma_f32_16x16x32_bf16 a[76:79], v[84:87], v[36:39], a[76:79]
    v_add_f32 v5, v5, v18
    v_add_f32 v5, v5, v19
    v_mfma_f32_16x16x32_bf16 a[124:127], v[72:75], v[32:35], a[124:127]
    ds_read_b128 v[28:31], v1 offset:21504
    v_cvt_f32_i32 v152, v152
    v_mfma_f32_16x16x32_bf16 a[124:127], v[88:91], v[36:39], a[124:127]
    buffer_load_dwordx4 v4, s[4:7], s32 offen offset:1024 sc1 lds
    v_mfma_f32_16x16x32_bf16 a[172:175], v[76:79], v[32:35], a[172:175]
    v_exp_f32 v17, v113
    v_mfma_f32_16x16x32_bf16 a[172:175], v[92:95], v[36:39], a[172:175]
    s_waitcnt lgkmcnt(2)
    v_cvt_pk_bf16_f32 v177, v18, v19
    v_add_u32 v3, s3, v3
    v_mfma_f32_16x16x32_bf16 a[32:35], v[64:67], v[40:43], a[32:35]
    ds_read_b128 v[32:35], v1 offset:10240
    v_cvt_f32_i32 v156, v156
    v_mfma_f32_16x16x32_bf16 a[32:35], v[80:83], v[44:47], a[32:35]
    v_exp_f32 v18, v114
    v_mfma_f32_16x16x32_bf16 a[80:83], v[68:71], v[40:43], a[80:83]
    v_add_f32 v5, v5, v16
    v_add_f32 v5, v5, v17
    v_mfma_f32_16x16x32_bf16 a[80:83], v[84:87], v[44:47], a[80:83]
    buffer_load_dwordx4 v4, s[4:7], s32 offen offset:2048 sc1 lds
    v_mfma_f32_16x16x32_bf16 a[128:131], v[72:75], v[40:43], a[128:131]
    ds_read_b128 v[36:39], v1 offset:22528
    v_mfma_f32_16x16x32_bf16 a[128:131], v[88:91], v[44:47], a[128:131]
    v_exp_f32 v19, v115
    v_mfma_f32_16x16x32_bf16 a[176:179], v[76:79], v[40:43], a[176:179]
    v_cvt_pk_bf16_f32 v178, v16, v17
    v_fma_f32 v152, v152, v48, v50
    v_mfma_f32_16x16x32_bf16 a[176:179], v[92:95], v[44:47], a[176:179]
    s_waitcnt lgkmcnt(2)
    v_exp_f32 v16, v180
    v_mfma_f32_16x16x32_bf16 a[36:39], v[64:67], v[24:27], a[36:39]
    ds_read_b128 v[40:43], v1 offset:11264
    v_add_f32 v5, v5, v18
    v_mfma_f32_16x16x32_bf16 a[36:39], v[80:83], v[28:31], a[36:39]
    v_add_f32 v5, v5, v19
    v_mfma_f32_16x16x32_bf16 a[84:87], v[68:71], v[24:27], a[84:87]
    v_exp_f32 v17, v181
    v_mfma_f32_16x16x32_bf16 a[84:87], v[84:87], v[28:31], a[84:87]
    s_add_u32 s32, s32, 24576
    v_cvt_pk_bf16_f32 v179, v18, v19
    s_add_u32 s26, s26, 36864
    v_mfma_f32_16x16x32_bf16 a[132:135], v[72:75], v[24:27], a[132:135]
    s_sub_u32 s57, s26, 147456
    ds_read_b128 v[44:47], v1 offset:23552
    v_fma_f32 v156, v156, v49, v51
    v_mfma_f32_16x16x32_bf16 a[132:135], v[88:91], v[28:31], a[132:135]
    s_waitcnt lgkmcnt(2)
    v_exp_f32 v18, v182
    v_mfma_f32_16x16x32_bf16 a[180:183], v[76:79], v[24:27], a[180:183]
    s_waitcnt vmcnt(6)
    v_add_f32 v6, v6, v16
    v_add_f32 v6, v6, v17
    v_mfma_f32_16x16x32_bf16 a[180:183], v[92:95], v[28:31], a[180:183]
    s_barrier
    v_cvt_f32_i32 v153, v153
    v_mfma_f32_16x16x32_bf16 a[40:43], v[64:67], v[32:35], a[40:43]
    s_min_u32 s26, s26, s57
    ds_read_b128 v[24:27], v2 offset:0
    v_add_u32 v0, 1, v0
    v_mfma_f32_16x16x32_bf16 a[40:43], v[80:83], v[36:39], a[40:43]
    buffer_store_dword v0, v13, s[20:23], 0 offen offset:32 sc1
    v_mfma_f32_16x16x32_bf16 a[88:91], v[68:71], v[32:35], a[88:91]
    v_exp_f32 v19, v183
    v_mfma_f32_16x16x32_bf16 a[88:91], v[84:87], v[36:39], a[88:91]
    v_cvt_pk_bf16_f32 v180, v16, v17
    v_cvt_f32_i32 v157, v157
    v_mfma_f32_16x16x32_bf16 a[136:139], v[72:75], v[32:35], a[136:139]
    ds_read_b128 v[28:31], v3 offset:0
    v_mfma_f32_16x16x32_bf16 a[136:139], v[88:91], v[36:39], a[136:139]
    v_exp_f32 v16, v116
    v_mfma_f32_16x16x32_bf16 a[184:187], v[76:79], v[32:35], a[184:187]
    v_add_f32 v6, v6, v18
    v_add_f32 v6, v6, v19
    v_mfma_f32_16x16x32_bf16 a[184:187], v[92:95], v[36:39], a[184:187]
    s_waitcnt lgkmcnt(2)
    v_exp_f32 v17, v117
    v_mfma_f32_16x16x32_bf16 a[44:47], v[64:67], v[40:43], a[44:47]
    ds_read_b128 v[32:35], v2 offset:6144
    v_cvt_pk_bf16_f32 v181, v18, v19
    v_mfma_f32_16x16x32_bf16 a[44:47], v[80:83], v[44:47], a[44:47]
    v_exp_f32 v18, v118
    v_mfma_f32_16x16x32_bf16 a[92:95], v[68:71], v[40:43], a[92:95]
    v_add_f32 v6, v6, v16
    v_add_f32 v6, v6, v17
    v_mfma_f32_16x16x32_bf16 a[92:95], v[84:87], v[44:47], a[92:95]
    v_exp_f32 v19, v119
    v_mfma_f32_16x16x32_bf16 a[140:143], v[72:75], v[40:43], a[140:143]
    ds_read_b128 v[36:39], v3 offset:6144
    v_cvt_pk_bf16_f32 v182, v16, v17
    v_mfma_f32_16x16x32_bf16 a[140:143], v[88:91], v[44:47], a[140:143]
    v_add_f32 v6, v6, v18
    v_add_f32 v6, v6, v19
    v_mfma_f32_16x16x32_bf16 a[188:191], v[76:79], v[40:43], a[188:191]
    v_cvt_pk_bf16_f32 v183, v18, v19
    v_mfma_f32_16x16x32_bf16 a[188:191], v[92:95], v[44:47], a[188:191]
    s_waitcnt lgkmcnt(2)
    v_mfma_f32_16x16x32_bf16 v[64:67], v[24:27], a[192:195], v[128:131]
    s_add_u32 s33, s33, 196608
    ds_read_b128 v[40:43], v2 offset:128
    v_fma_f32 v153, v153, v48, v50
    v_mfma_f32_16x16x32_bf16 v[64:67], v[28:31], a[196:199], v[64:67]
    s_mov_b32 m0, s56
    v_exp_f32 v16, v184
    v_mfma_f32_16x16x32_bf16 v[68:71], v[24:27], a[216:219], v[132:135]
    s_add_u32 s34, s34, 196608
    v_exp_f32 v17, v185
    v_mfma_f32_16x16x32_bf16 v[68:71], v[28:31], a[220:223], v[68:71]
    s_add_u32 s36, s36, 1536
    buffer_load_dwordx4 v4, s[4:7], s27 offen offset:0 sc1 lds
    v_mfma_f32_16x16x32_bf16 v[72:75], v[24:27], a[240:243], v[136:139]
    ds_read_b128 v[44:47], v3 offset:128
    v_fma_f32 v157, v157, v49, v51
    v_mfma_f32_16x16x32_bf16 v[72:75], v[28:31], a[244:247], v[72:75]
    v_exp_f32 v18, v186
    v_mfma_f32_16x16x32_bf16 v[76:79], v[24:27], v[200:203], v[140:143]
    v_add_f32 v7, v7, v16
    v_add_f32 v7, v7, v17
    v_mfma_f32_16x16x32_bf16 v[76:79], v[28:31], v[204:207], v[76:79]
    s_waitcnt lgkmcnt(2)
    buffer_load_dwordx2 v[56:57], v10, s[72:75], s36 offen offset:0
    v_mfma_f32_16x16x32_bf16 v[96:99], v[32:35], a[192:195], v[128:131]
    ds_read_b128 v[24:27], v2 offset:6272
    v_cvt_f32_i32 v154, v154
    v_mfma_f32_16x16x32_bf16 v[96:99], v[36:39], a[196:199], v[96:99]
    v_exp_f32 v19, v187
    v_mfma_f32_16x16x32_bf16 v[100:103], v[32:35], a[216:219], v[132:135]
    v_cvt_pk_bf16_f32 v184, v16, v17
    v_cvt_f32_i32 v158, v158
    v_mfma_f32_16x16x32_bf16 v[100:103], v[36:39], a[220:223], v[100:103]
    buffer_load_dwordx4 v4, s[4:7], s27 offen offset:1024 sc1 lds
    v_mfma_f32_16x16x32_bf16 v[104:107], v[32:35], a[240:243], v[136:139]
    ds_read_b128 v[28:31], v3 offset:6272
    v_fma_f32 v154, v154, v48, v50
    v_mfma_f32_16x16x32_bf16 v[104:107], v[36:39], a[244:247], v[104:107]
    v_exp_f32 v16, v120
    v_mfma_f32_16x16x32_bf16 v[108:111], v[32:35], v[200:203], v[140:143]
    v_add_f32 v7, v7, v18
    v_add_f32 v7, v7, v19
    v_mfma_f32_16x16x32_bf16 v[108:111], v[36:39], v[204:207], v[108:111]
    s_waitcnt lgkmcnt(2)
    buffer_load_dwordx2 v[58:59], v10, s[76:79], s36 offen offset:0
    v_mfma_f32_16x16x32_bf16 v[64:67], v[40:43], a[200:203], v[64:67]
    ds_read_b128 v[32:35], v2 offset:256
    v_fma_f32 v158, v158, v49, v51
    v_mfma_f32_16x16x32_bf16 v[64:67], v[44:47], a[204:207], v[64:67]
    v_exp_f32 v17, v121
    v_mfma_f32_16x16x32_bf16 v[68:71], v[40:43], a[224:227], v[68:71]
    v_cvt_pk_bf16_f32 v185, v18, v19
    v_mfma_f32_16x16x32_bf16 v[68:71], v[44:47], a[228:231], v[68:71]
    buffer_load_dwordx4 v[224:227], v9, s[64:67], s33 offen offset:0 nt
    v_mfma_f32_16x16x32_bf16 v[72:75], v[40:43], a[248:251], v[72:75]
    ds_read_b128 v[36:39], v3 offset:256
    v_cvt_pk_bf16_f32 v144, v144, v148
    v_mfma_f32_16x16x32_bf16 v[72:75], v[44:47], a[252:255], v[72:75]
    v_exp_f32 v18, v122
    v_mfma_f32_16x16x32_bf16 v[76:79], v[40:43], v[208:211], v[76:79]
    v_add_f32 v7, v7, v16
    v_add_f32 v7, v7, v17
    v_mfma_f32_16x16x32_bf16 v[76:79], v[44:47], v[212:215], v[76:79]
    s_waitcnt lgkmcnt(2)
    buffer_load_dwordx4 v4, s[4:7], s27 offen offset:2048 sc1 lds
    v_mfma_f32_16x16x32_bf16 v[96:99], v[24:27], a[200:203], v[96:99]
    ds_read_b128 v[40:43], v2 offset:6400
    v_cvt_pk_bf16_f32 v148, v145, v149
    v_mfma_f32_16x16x32_bf16 v[96:99], v[28:31], a[204:207], v[96:99]
    v_exp_f32 v19, v123
    v_cvt_pk_bf16_f32 v186, v16, v17
    v_mfma_f32_16x16x32_bf16 v[100:103], v[24:27], a[224:227], v[100:103]
    v_exp_f32 v16, v188
    v_mfma_f32_16x16x32_bf16 v[100:103], v[28:31], a[228:231], v[100:103]
    buffer_load_dwordx4 v[228:231], v9, s[64:67], s33 offen offset:1536 nt
    v_mfma_f32_16x16x32_bf16 v[104:107], v[24:27], a[248:251], v[104:107]
    ds_read_b128 v[44:47], v3 offset:6400
    v_add_f32 v7, v7, v18
    v_mfma_f32_16x16x32_bf16 v[104:107], v[28:31], a[252:255], v[104:107]
    v_add_f32 v7, v7, v19
    v_cvt_pk_bf16_f32 v145, v152, v156
    v_mfma_f32_16x16x32_bf16 v[108:111], v[24:27], v[208:211], v[108:111]
    s_add_u32 s29, s30, 49152
    v_exp_f32 v17, v189
    v_mfma_f32_16x16x32_bf16 v[108:111], v[28:31], v[212:215], v[108:111]
    s_waitcnt lgkmcnt(2)
    buffer_load_dwordx4 v[232:235], v9, s[64:67], s34 offen offset:0 nt
    v_cvt_pk_bf16_f32 v187, v18, v19
    v_mfma_f32_16x16x32_bf16 v[64:67], v[32:35], a[208:211], v[64:67]
    s_sub_u32 s3, s29, 147456
    ds_read_b128 v[24:27], v2 offset:12288
    s_add_u32 s27, s27, 24576
    v_mfma_f32_16x16x32_bf16 v[64:67], v[36:39], a[212:215], v[64:67]
    s_min_u32 s29, s29, s3
    v_exp_f32 v18, v190
    v_mfma_f32_16x16x32_bf16 v[68:71], v[32:35], a[232:235], v[68:71]
    v_add_f32 v8, v8, v16
    v_add_f32 v8, v8, v17
    v_mfma_f32_16x16x32_bf16 v[68:71], v[36:39], a[236:239], v[68:71]
    buffer_load_dwordx4 v[236:239], v9, s[64:67], s34 offen offset:1536 nt
    v_mfma_f32_16x16x32_bf16 v[72:75], v[32:35], v[192:195], v[72:75]
    s_add_u32 s56, s56, 12288
    ds_read_b128 v[28:31], v3 offset:12288
    v_cvt_pk_bf16_f32 v149, v153, v157
    v_mfma_f32_16x16x32_bf16 v[72:75], v[36:39], v[196:199], v[72:75]
    v_exp_f32 v19, v191
    v_cvt_pk_bf16_f32 v188, v16, v17
    v_mfma_f32_16x16x32_bf16 v[76:79], v[32:35], v[216:219], v[76:79]
    v_exp_f32 v16, v124
    v_mfma_f32_16x16x32_bf16 v[76:79], v[36:39], v[220:223], v[76:79]
    s_waitcnt lgkmcnt(2)
    v_add_f32 v8, v8, v18
    v_add_f32 v8, v8, v19
    v_mfma_f32_16x16x32_bf16 v[96:99], v[40:43], a[208:211], v[96:99]
    ds_read_b128 v[32:35], v2 offset:18432
    v_cvt_pk_bf16_f32 v152, v146, v150
    v_mfma_f32_16x16x32_bf16 v[96:99], v[44:47], a[212:215], v[96:99]
    s_sub_u32 s3, s29, s30
    v_exp_f32 v17, v125
    v_mfma_f32_16x16x32_bf16 v[100:103], v[40:43], a[232:235], v[100:103]
    s_mov_b32 m0, s56
    v_cvt_pk_bf16_f32 v189, v18, v19
    v_cvt_pk_bf16_f32 v153, v154, v158
    v_mfma_f32_16x16x32_bf16 v[100:103], v[44:47], a[236:239], v[100:103]
    v_exp_f32 v18, v126
    v_mfma_f32_16x16x32_bf16 v[104:107], v[40:43], v[192:195], v[104:107]
    ds_read_b128 v[36:39], v3 offset:18432
    v_add_f32 v8, v8, v16
    v_mfma_f32_16x16x32_bf16 v[104:107], v[44:47], v[196:199], v[104:107]
    v_add_f32 v8, v8, v17
    v_mfma_f32_16x16x32_bf16 v[108:111], v[40:43], v[216:219], v[108:111]
    v_exp_f32 v19, v127
    v_mfma_f32_16x16x32_bf16 v[108:111], v[44:47], v[220:223], v[108:111]
    s_waitcnt lgkmcnt(2)
    v_cvt_pk_bf16_f32 v190, v16, v17
    v_add_f32 v8, v8, v18
    v_mfma_f32_16x16x32_bf16 v[80:83], v[24:27], a[192:195], v[128:131]
    ds_read_b128 v[40:43], v2 offset:12416
    v_add_f32 v8, v8, v19
    v_mfma_f32_16x16x32_bf16 v[80:83], v[28:31], a[196:199], v[80:83]
    s_mov_b32 s30, s29
    v_cvt_pk_bf16_f32 v191, v18, v19
    v_mfma_f32_16x16x32_bf16 v[84:87], v[24:27], a[216:219], v[132:135]
    v_exp_f32 v16, v64
    v_mfma_f32_16x16x32_bf16 v[84:87], v[28:31], a[220:223], v[84:87]
    s_waitcnt vmcnt(20)
    buffer_load_dwordx4 v4, s[4:7], s27 offen offset:0 sc1 lds
    v_mfma_f32_16x16x32_bf16 v[88:91], v[24:27], a[240:243], v[136:139]
    ds_read_b128 v[44:47], v3 offset:12416
    v_lshlrev_b32 v48, 16, v60
    v_mfma_f32_16x16x32_bf16 v[88:91], v[28:31], a[244:247], v[88:91]
    v_exp_f32 v17, v65
    v_mfma_f32_16x16x32_bf16 v[92:95], v[24:27], v[200:203], v[140:143]
    v_exp_f32 v18, v66
    v_mfma_f32_16x16x32_bf16 v[92:95], v[28:31], v[204:207], v[92:95]
    s_waitcnt lgkmcnt(2)
    v_add_f32 v5, v5, v16
    v_add_f32 v5, v5, v17
    v_mfma_f32_16x16x32_bf16 v[112:115], v[32:35], a[192:195], v[128:131]
    ds_read_b128 v[24:27], v2 offset:18560
    v_and_b32 v49, s97, v60
    v_mfma_f32_16x16x32_bf16 v[112:115], v[36:39], a[196:199], v[112:115]
    v_exp_f32 v19, v67
    v_mfma_f32_16x16x32_bf16 v[116:119], v[32:35], a[216:219], v[132:135]
    v_cvt_pk_bf16_f32 v64, v16, v17
    v_lshlrev_b32 v50, 16, v62
    v_mfma_f32_16x16x32_bf16 v[116:119], v[36:39], a[220:223], v[116:119]
    v_exp_f32 v16, v96
    v_mfma_f32_16x16x32_bf16 v[120:123], v[32:35], a[240:243], v[136:139]
    ds_read_b128 v[28:31], v3 offset:18560
    v_add_f32 v5, v5, v18
    v_mfma_f32_16x16x32_bf16 v[120:123], v[36:39], a[244:247], v[120:123]
    v_add_f32 v5, v5, v19
    v_and_b32 v51, s97, v62
    v_mfma_f32_16x16x32_bf16 v[124:127], v[32:35], v[200:203], v[140:143]
    v_exp_f32 v17, v97
    v_mfma_f32_16x16x32_bf16 v[124:127], v[36:39], v[204:207], v[124:127]
    s_waitcnt lgkmcnt(2)
    buffer_load_dwordx4 v4, s[4:7], s27 offen offset:1024 sc1 lds
    v_mfma_f32_16x16x32_bf16 v[80:83], v[40:43], a[200:203], v[80:83]
    ds_read_b128 v[32:35], v2 offset:12544
    v_cvt_pk_bf16_f32 v65, v18, v19
    v_mfma_f32_16x16x32_bf16 v[80:83], v[44:47], a[204:207], v[80:83]
    v_exp_f32 v18, v98
    v_mfma_f32_16x16x32_bf16 v[84:87], v[40:43], a[224:227], v[84:87]
    v_add_f32 v5, v5, v16
    v_add_f32 v5, v5, v17
    v_mfma_f32_16x16x32_bf16 v[84:87], v[44:47], a[228:231], v[84:87]
    v_exp_f32 v19, v99
    v_mfma_f32_16x16x32_bf16 v[88:91], v[40:43], a[248:251], v[88:91]
    ds_read_b128 v[36:39], v3 offset:12544
    v_cvt_pk_bf16_f32 v66, v16, v17
    v_mfma_f32_16x16x32_bf16 v[88:91], v[44:47], a[252:255], v[88:91]
    v_exp_f32 v16, v68
    v_mfma_f32_16x16x32_bf16 v[92:95], v[40:43], v[208:211], v[92:95]
    v_add_u32 v1, s3, v1
    v_mul_f32_e64 v50, -v50, v48
    v_mfma_f32_16x16x32_bf16 v[92:95], v[44:47], v[212:215], v[92:95]
    s_waitcnt lgkmcnt(2)
    v_add_f32 v5, v5, v18
    v_add_f32 v5, v5, v19
    v_mfma_f32_16x16x32_bf16 v[112:115], v[24:27], a[200:203], v[112:115]
    ds_read_b128 v[40:43], v2 offset:18688
    v_mul_f32_e64 v51, -v51, v49
    v_mfma_f32_16x16x32_bf16 v[112:115], v[28:31], a[204:207], v[112:115]
    buffer_load_dwordx4 v4, s[4:7], s27 offen offset:2048 sc1 lds
    v_mfma_f32_16x16x32_bf16 v[116:119], v[24:27], a[224:227], v[116:119]
    v_exp_f32 v17, v69
    v_mfma_f32_16x16x32_bf16 v[116:119], v[28:31], a[228:231], v[116:119]
    v_cvt_pk_bf16_f32 v67, v18, v19
    v_cvt_f32_i32 v240, v240
    v_mfma_f32_16x16x32_bf16 v[120:123], v[24:27], a[248:251], v[120:123]
    ds_read_b128 v[44:47], v3 offset:18688
    v_mfma_f32_16x16x32_bf16 v[120:123], v[28:31], a[252:255], v[120:123]
    s_waitcnt lgkmcnt(2)
    v_exp_f32 v18, v70
    v_mfma_f32_16x16x32_bf16 v[124:127], v[24:27], v[208:211], v[124:127]
    s_waitcnt vmcnt(13)
    v_add_f32 v6, v6, v16
    v_add_f32 v6, v6, v17
    v_mfma_f32_16x16x32_bf16 v[124:127], v[28:31], v[212:215], v[124:127]
    s_barrier
    v_cvt_f32_i32 v244, v244
    v_mfma_f32_16x16x32_bf16 v[80:83], v[32:35], a[208:211], v[80:83]
    ds_read_b128 v[24:27], v1 offset:0
    v_mfma_f32_16x16x32_bf16 v[80:83], v[36:39], a[212:215], v[80:83]
    v_exp_f32 v19, v71
    v_mfma_f32_16x16x32_bf16 v[84:87], v[32:35], a[232:235], v[84:87]
    v_cvt_pk_bf16_f32 v68, v16, v17
    v_fma_f32 v240, v240, v48, v50
    v_mfma_f32_16x16x32_bf16 v[84:87], v[36:39], a[236:239], v[84:87]
    v_exp_f32 v16, v100
    v_mfma_f32_16x16x32_bf16 v[88:91], v[32:35], v[192:195], v[88:91]
    ds_read_b128 v[28:31], v1 offset:12288
    v_add_f32 v6, v6, v18
    v_mfma_f32_16x16x32_bf16 v[88:91], v[36:39], v[196:199], v[88:91]
    v_add_f32 v6, v6, v19
    v_fma_f32 v244, v244, v49, v51
    v_mfma_f32_16x16x32_bf16 v[92:95], v[32:35], v[216:219], v[92:95]
    v_exp_f32 v17, v101
    v_mfma_f32_16x16x32_bf16 v[92:95], v[36:39], v[220:223], v[92:95]
    s_waitcnt lgkmcnt(2)
    v_cvt_pk_bf16_f32 v69, v18, v19
    v_mfma_f32_16x16x32_bf16 v[112:115], v[40:43], a[208:211], v[112:115]
    ds_read_b128 v[32:35], v1 offset:1024
    v_mfma_f32_16x16x32_bf16 v[112:115], v[44:47], a[212:215], v[112:115]
    v_exp_f32 v18, v102
    v_mfma_f32_16x16x32_bf16 v[116:119], v[40:43], a[232:235], v[116:119]
    v_add_f32 v6, v6, v16
    v_add_f32 v6, v6, v17
    v_mfma_f32_16x16x32_bf16 v[116:119], v[44:47], a[236:239], v[116:119]
    s_add_u32 s27, s27, 24576
    v_exp_f32 v19, v103
    v_mfma_f32_16x16x32_bf16 v[120:123], v[40:43], v[192:195], v[120:123]
    s_add_u32 s56, s56, 36864
    ds_read_b128 v[36:39], v1 offset:13312
    v_cvt_pk_bf16_f32 v70, v16, v17
    v_mfma_f32_16x16x32_bf16 v[120:123], v[44:47], v[196:199], v[120:123]
    s_sub_u32 s58, s56, 147456
    v_add_f32 v6, v6, v18
    v_add_f32 v6, v6, v19
    v_mfma_f32_16x16x32_bf16 v[124:127], v[40:43], v[216:219], v[124:127]
    s_min_u32 s56, s56, s58
    v_cvt_pk_bf16_f32 v71, v18, v19
    v_mfma_f32_16x16x32_bf16 v[124:127], v[44:47], v[220:223], v[124:127]
    s_waitcnt lgkmcnt(2)
    v_mfma_f32_16x16x32_bf16 a[0:3], v[160:163], v[24:27], a[0:3]
    s_mov_b32 m0, s56
    ds_read_b128 v[40:43], v1 offset:2048
    v_cvt_f32_i32 v241, v241
    v_mfma_f32_16x16x32_bf16 a[0:3], v[176:179], v[28:31], a[0:3]
    buffer_load_dwordx4 v4, s[4:7], s27 offen offset:0 sc1 lds
    v_mfma_f32_16x16x32_bf16 a[48:51], v[164:167], v[24:27], a[48:51]
    v_exp_f32 v16, v72
    v_mfma_f32_16x16x32_bf16 a[48:51], v[180:183], v[28:31], a[48:51]
    v_exp_f32 v17, v73
    v_mfma_f32_16x16x32_bf16 a[96:99], v[168:171], v[24:27], a[96:99]
    ds_read_b128 v[44:47], v1 offset:14336
    v_cvt_f32_i32 v245, v245
    v_mfma_f32_16x16x32_bf16 a[96:99], v[184:187], v[28:31], a[96:99]
    v_exp_f32 v18, v74
    v_mfma_f32_16x16x32_bf16 a[144:147], v[172:175], v[24:27], a[144:147]
    v_add_f32 v7, v7, v16
    v_add_f32 v7, v7, v17
    v_mfma_f32_16x16x32_bf16 a[144:147], v[188:191], v[28:31], a[144:147]
    s_waitcnt lgkmcnt(2)
    v_exp_f32 v19, v75
    v_mfma_f32_16x16x32_bf16 a[4:7], v[160:163], v[32:35], a[4:7]
    ds_read_b128 v[24:27], v1 offset:3072
    v_fma_f32 v241, v241, v48, v50
    v_mfma_f32_16x16x32_bf16 a[4:7], v[176:179], v[36:39], a[4:7]
    buffer_load_dwordx4 v4, s[4:7], s27 offen offset:1024 sc1 lds
    v_mfma_f32_16x16x32_bf16 a[52:55], v[164:167], v[32:35], a[52:55]
    v_cvt_pk_bf16_f32 v72, v16, v17
    v_fma_f32 v245, v245, v49, v51
    v_mfma_f32_16x16x32_bf16 a[52:55], v[180:183], v[36:39], a[52:55]
    v_exp_f32 v16, v104
    v_mfma_f32_16x16x32_bf16 a[100:103], v[168:171], v[32:35], a[100:103]
    ds_read_b128 v[28:31], v1 offset:15360
    v_add_f32 v7, v7, v18
    v_mfma_f32_16x16x32_bf16 a[100:103], v[184:187], v[36:39], a[100:103]
    buffer_load_dword v52, v20, s[20:23], s44 offen sc1
    v_mfma_f32_16x16x32_bf16 a[148:151], v[172:175], v[32:35], a[148:151]
    v_add_f32 v7, v7, v19
    v_cvt_f32_i32 v242, v242
    v_mfma_f32_16x16x32_bf16 a[148:151], v[188:191], v[36:39], a[148:151]
    s_waitcnt lgkmcnt(2)
    v_exp_f32 v17, v105
    v_mfma_f32_16x16x32_bf16 a[8:11], v[160:163], v[40:43], a[8:11]
    ds_read_b128 v[32:35], v1 offset:4096
    v_cvt_pk_bf16_f32 v73, v18, v19
    v_mfma_f32_16x16x32_bf16 a[8:11], v[176:179], v[44:47], a[8:11]
    v_exp_f32 v18, v106
    v_mfma_f32_16x16x32_bf16 a[56:59], v[164:167], v[40:43], a[56:59]
    v_add_f32 v7, v7, v16
    v_cvt_f32_i32 v246, v246
    v_mfma_f32_16x16x32_bf16 a[56:59], v[180:183], v[44:47], a[56:59]
    buffer_load_dwordx4 v4, s[4:7], s27 offen offset:2048 sc1 lds
    v_mfma_f32_16x16x32_bf16 a[104:107], v[168:171], v[40:43], a[104:107]
    ds_read_b128 v[36:39], v1 offset:16384
    v_add_f32 v7, v7, v17
    v_mfma_f32_16x16x32_bf16 a[104:107], v[184:187], v[44:47], a[104:107]
    v_exp_f32 v19, v107
    v_mfma_f32_16x16x32_bf16 a[152:155], v[172:175], v[40:43], a[152:155]
    v_cvt_pk_bf16_f32 v74, v16, v17
    v_fma_f32 v242, v242, v48, v50
    v_mfma_f32_16x16x32_bf16 a[152:155], v[188:191], v[44:47], a[152:155]
    s_waitcnt lgkmcnt(2)
    v_exp_f32 v16, v76
    v_mfma_f32_16x16x32_bf16 a[12:15], v[160:163], v[24:27], a[12:15]
    ds_read_b128 v[40:43], v1 offset:5120
    v_add_f32 v7, v7, v18
    v_mfma_f32_16x16x32_bf16 a[12:15], v[176:179], v[28:31], a[12:15]
    s_add_u32 s27, s27, 24576
    v_add_f32 v7, v7, v19
    v_fma_f32 v246, v246, v49, v51
    v_mfma_f32_16x16x32_bf16 a[60:63], v[164:167], v[24:27], a[60:63]
L_pg4:
    s_cbranch_execz L_pg8
    v_exp_f32 v17, v77
    v_mfma_f32_16x16x32_bf16 a[60:63], v[180:183], v[28:31], a[60:63]
    v_cvt_pk_bf16_f32 v75, v18, v19
    v_lshlrev_b32 v48, 16, v61
    v_mfma_f32_16x16x32_bf16 a[108:111], v[168:171], v[24:27], a[108:111]
    ds_read_b128 v[44:47], v1 offset:17408
    v_and_b32 v49, s97, v61
    v_mfma_f32_16x16x32_bf16 a[108:111], v[184:187], v[28:31], a[108:111]
    v_exp_f32 v18, v78
    v_mfma_f32_16x16x32_bf16 a[156:159], v[172:175], v[24:27], a[156:159]
    s_add_u32 s29, s28, 49152
    v_add_f32 v8, v8, v16
    v_add_f32 v8, v8, v17
    v_mfma_f32_16x16x32_bf16 a[156:159], v[188:191], v[28:31], a[156:159]
    s_waitcnt lgkmcnt(2)
    v_exp_f32 v19, v79
    v_mfma_f32_16x16x32_bf16 a[16:19], v[160:163], v[32:35], a[16:19]
    s_sub_u32 s3, s29, 147456
    ds_read_b128 v[24:27], v1 offset:6144
    v_lshlrev_b32 v50, 16, v63
    v_mfma_f32_16x16x32_bf16 a[16:19], v[176:179], v[36:39], a[16:19]
    s_add_u32 s56, s56, 12288
    v_cvt_pk_bf16_f32 v76, v16, v17
    v_and_b32 v51, s97, v63
    v_mfma_f32_16x16x32_bf16 a[64:67], v[164:167], v[32:35], a[64:67]
    s_min_u32 s29, s29, s3
    v_exp_f32 v16, v108
    v_mfma_f32_16x16x32_bf16 a[64:67], v[180:183], v[36:39], a[64:67]
    s_mov_b32 m0, s56
    v_add_f32 v8, v8, v18
    v_add_f32 v8, v8, v19
    v_mfma_f32_16x16x32_bf16 a[112:115], v[168:171], v[32:35], a[112:115]
    ds_read_b128 v[28:31], v1 offset:18432
    v_mul_f32_e64 v50, -v50, v48
    v_mfma_f32_16x16x32_bf16 a[112:115], v[184:187], v[36:39], a[112:115]
    v_exp_f32 v17, v109
    v_mfma_f32_16x16x32_bf16 a[160:163], v[172:175], v[32:35], a[160:163]
    v_cvt_pk_bf16_f32 v77, v18, v19
    v_mul_f32_e64 v51, -v51, v49
    v_mfma_f32_16x16x32_bf16 a[160:163], v[188:191], v[36:39], a[160:163]
    s_waitcnt lgkmcnt(2)
    v_exp_f32 v18, v110
    v_mfma_f32_16x16x32_bf16 a[20:23], v[160:163], v[40:43], a[20:23]
    s_sub_u32 s3, s29, s28
    ds_read_b128 v[32:35], v1 offset:7168
    v_add_f32 v8, v8, v16
    v_mfma_f32_16x16x32_bf16 a[20:23], v[176:179], v[44:47], a[20:23]
    v_add_f32 v8, v8, v17
    v_cvt_f32_i32 v248, v248
    v_mfma_f32_16x16x32_bf16 a[68:71], v[164:167], v[40:43], a[68:71]
    v_exp_f32 v19, v111
    v_mfma_f32_16x16x32_bf16 a[68:71], v[180:183], v[44:47], a[68:71]
    buffer_load_dwordx4 v4, s[4:7], s27 offen offset:0 sc1 lds
    v_mfma_f32_16x16x32_bf16 a[116:119], v[168:171], v[40:43], a[116:119]
    ds_read_b128 v[36:39], v1 offset:19456
    v_cvt_pk_bf16_f32 v78, v16, v17
    v_mfma_f32_16x16x32_bf16 a[116:119], v[184:187], v[44:47], a[116:119]
    v_add_f32 v8, v8, v18
    v_cvt_f32_i32 v252, v252
    v_mfma_f32_16x16x32_bf16 a[164:167], v[172:175], v[40:43], a[164:167]
    s_mov_b32 s28, s29
    v_add_f32 v8, v8, v19
    v_cvt_pk_bf16_f32 v79, v18, v19
    v_mfma_f32_16x16x32_bf16 a[164:167], v[188:191], v[44:47], a[164:167]
    s_waitcnt lgkmcnt(2)
    v_exp_f32 v16, v80
    v_mfma_f32_16x16x32_bf16 a[24:27], v[160:163], v[24:27], a[24:27]
    ds_read_b128 v[40:43], v1 offset:8192
    v_fma_f32 v248, v248, v48, v50
    v_mfma_f32_16x16x32_bf16 a[24:27], v[176:179], v[28:31], a[24:27]
    v_exp_f32 v17, v81
    v_mfma_f32_16x16x32_bf16 a[72:75], v[164:167], v[24:27], a[72:75]
    v_fma_f32 v252, v252, v49, v51
    v_cvt_f32_i32 v249, v249
    v_mfma_f32_16x16x32_bf16 a[72:75], v[180:183], v[28:31], a[72:75]
    buffer_load_dwordx4 v4, s[4:7], s27 offen offset:1024 sc1 lds
    v_mfma_f32_16x16x32_bf16 a[120:123], v[168:171], v[24:27], a[120:123]
    ds_read_b128 v[44:47], v1 offset:20480
    v_cvt_f32_i32 v253, v253
    v_mfma_f32_16x16x32_bf16 a[120:123], v[184:187], v[28:31], a[120:123]
    v_exp_f32 v18, v82
    v_mfma_f32_16x16x32_bf16 a[168:171], v[172:175], v[24:27], a[168:171]
    v_add_f32 v5, v5, v16
    v_add_f32 v5, v5, v17
    v_mfma_f32_16x16x32_bf16 a[168:171], v[188:191], v[28:31], a[168:171]
    s_waitcnt lgkmcnt(2)
    v_exp_f32 v19, v83
    v_mfma_f32_16x16x32_bf16 a[28:31], v[160:163], v[32:35], a[28:31]
    ds_read_b128 v[24:27], v1 offset:9216
    v_cvt_pk_bf16_f32 v80, v16, v17
    v_mfma_f32_16x16x32_bf16 a[28:31], v[176:179], v[36:39], a[28:31]
    v_exp_f32 v16, v112
    v_mfma_f32_16x16x32_bf16 a[76:79], v[164:167], v[32:35], a[76:79]
    v_add_f32 v5, v5, v18
    v_fma_f32 v249, v249, v48, v50
    v_mfma_f32_16x16x32_bf16 a[76:79], v[180:183], v[36:39], a[76:79]
    v_add_f32 v5, v5, v19
    v_add_u32 v2, s3, v2
    v_mfma_f32_16x16x32_bf16 a[124:127], v[168:171], v[32:35], a[124:127]
    ds_read_b128 v[28:31], v1 offset:21504
    v_fma_f32 v253, v253, v49, v51
    v_mfma_f32_16x16x32_bf16 a[124:127], v[184:187], v[36:39], a[124:127]
    buffer_load_dwordx4 v4, s[4:7], s27 offen offset:2048 sc1 lds
    v_mfma_f32_16x16x32_bf16 a[172:175], v[172:175], v[32:35], a[172:175]
    v_exp_f32 v17, v113
    v_mfma_f32_16x16x32_bf16 a[172:175], v[188:191], v[36:39], a[172:175]
    s_waitcnt lgkmcnt(2)
    v_cvt_pk_bf16_f32 v81, v18, v19
    v_cvt_f32_i32 v250, v250
    v_mfma_f32_16x16x32_bf16 a[32:35], v[160:163], v[40:43], a[32:35]
    ds_read_b128 v[32:35], v1 offset:10240
    v_add_u32 v3, s3, v3
    v_mfma_f32_16x16x32_bf16 a[32:35], v[176:179], v[44:47], a[32:35]
    v_exp_f32 v18, v114
    v_mfma_f32_16x16x32_bf16 a[80:83], v[164:167], v[40:43], a[80:83]
    v_add_f32 v5, v5, v16
    v_add_f32 v5, v5, v17
    v_mfma_f32_16x16x32_bf16 a[80:83], v[180:183], v[44:47], a[80:83]
    v_exp_f32 v19, v115
    v_mfma_f32_16x16x32_bf16 a[128:131], v[168:171], v[40:43], a[128:131]
    ds_read_b128 v[36:39], v1 offset:22528
    v_cvt_pk_bf16_f32 v82, v16, v17
    v_mfma_f32_16x16x32_bf16 a[128:131], v[184:187], v[44:47], a[128:131]
    v_exp_f32 v16, v84
    v_mfma_f32_16x16x32_bf16 a[176:179], v[172:175], v[40:43], a[176:179]
    v_cvt_f32_i32 v254, v254
    v_add_f32 v5, v5, v18
    v_mfma_f32_16x16x32_bf16 a[176:179], v[188:191], v[44:47], a[176:179]
    s_waitcnt lgkmcnt(2)
    v_add_f32 v5, v5, v19
    v_fma_f32 v250, v250, v48, v50
    v_mfma_f32_16x16x32_bf16 a[36:39], v[160:163], v[24:27], a[36:39]
    ds_read_b128 v[40:43], v1 offset:11264
    v_fma_f32 v254, v254, v49, v51
    v_mfma_f32_16x16x32_bf16 a[36:39], v[176:179], v[28:31], a[36:39]
    v_exp_f32 v17, v85
    v_mfma_f32_16x16x32_bf16 a[84:87], v[164:167], v[24:27], a[84:87]
    v_cvt_pk_bf16_f32 v83, v18, v19
    v_cvt_pk_bf16_f32 v146, v240, v244
    v_mfma_f32_16x16x32_bf16 a[84:87], v[180:183], v[28:31], a[84:87]
    s_add_u32 s27, s27, 24576
    v_exp_f32 v18, v86
    v_mfma_f32_16x16x32_bf16 a[132:135], v[168:171], v[24:27], a[132:135]
    s_add_u32 s56, s56, 36864
    ds_read_b128 v[44:47], v1 offset:23552
    v_add_f32 v6, v6, v16
    v_mfma_f32_16x16x32_bf16 a[132:135], v[184:187], v[28:31], a[132:135]
    s_sub_u32 s58, s56, 147456
    v_add_f32 v6, v6, v17
    v_cvt_pk_bf16_f32 v150, v241, v245
    v_mfma_f32_16x16x32_bf16 a[180:183], v[172:175], v[24:27], a[180:183]
    v_exp_f32 v19, v87
    v_mfma_f32_16x16x32_bf16 a[180:183], v[188:191], v[28:31], a[180:183]
    s_waitcnt lgkmcnt(2)
    v_cvt_pk_bf16_f32 v84, v16, v17
    v_cvt_pk_bf16_f32 v147, v248, v252
    v_mfma_f32_16x16x32_bf16 a[40:43], v[160:163], v[32:35], a[40:43]
    s_min_u32 s56, s56, s58
    ds_read_b128 v[24:27], v2 offset:0
    v_mfma_f32_16x16x32_bf16 a[40:43], v[176:179], v[36:39], a[40:43]
    v_exp_f32 v16, v116
    v_mfma_f32_16x16x32_bf16 a[88:91], v[164:167], v[32:35], a[88:91]
    v_add_f32 v6, v6, v18
    v_add_f32 v6, v6, v19
    v_mfma_f32_16x16x32_bf16 a[88:91], v[180:183], v[36:39], a[88:91]
    v_exp_f32 v17, v117
    v_mfma_f32_16x16x32_bf16 a[136:139], v[168:171], v[32:35], a[136:139]
    ds_read_b128 v[28:31], v3 offset:0
    v_cvt_pk_bf16_f32 v151, v249, v253
    v_mfma_f32_16x16x32_bf16 a[136:139], v[184:187], v[36:39], a[136:139]
    v_cvt_pk_bf16_f32 v85, v18, v19
    v_cvt_pk_bf16_f32 v154, v242, v246
    v_mfma_f32_16x16x32_bf16 a[184:187], v[172:175], v[32:35], a[184:187]
    v_exp_f32 v18, v118
    v_mfma_f32_16x16x32_bf16 a[184:187], v[188:191], v[36:39], a[184:187]
    s_waitcnt lgkmcnt(2)
    v_add_f32 v6, v6, v16
    v_mfma_f32_16x16x32_bf16 a[44:47], v[160:163], v[40:43], a[44:47]
    ds_read_b128 v[32:35], v2 offset:6144
    v_add_f32 v6, v6, v17
    v_mfma_f32_16x16x32_bf16 a[44:47], v[176:179], v[44:47], a[44:47]
    v_exp_f32 v19, v119
    v_mfma_f32_16x16x32_bf16 a[92:95], v[164:167], v[40:43], a[92:95]
    v_cvt_pk_bf16_f32 v155, v250, v254
    v_mfma_f32_16x16x32_bf16 a[92:95], v[180:183], v[44:47], a[92:95]
    v_cvt_pk_bf16_f32 v86, v16, v17
    v_mfma_f32_16x16x32_bf16 a[140:143], v[168:171], v[40:43], a[140:143]
    ds_read_b128 v[36:39], v3 offset:6144
    v_add_f32 v6, v6, v18
    v_mfma_f32_16x16x32_bf16 a[140:143], v[184:187], v[44:47], a[140:143]
    v_add_f32 v6, v6, v19
    v_cvt_pk_bf16_f32 v87, v18, v19
    v_mfma_f32_16x16x32_bf16 a[188:191], v[172:175], v[40:43], a[188:191]
    v_mfma_f32_16x16x32_bf16 a[188:191], v[188:191], v[44:47], a[188:191]
    s_waitcnt lgkmcnt(2)
L_join:
    v_mfma_f32_16x16x32_bf16 v[160:163], v[24:27], a[192:195], v[128:131]
L_pg5:
    s_cbranch_execz L_pg9
    s_waitcnt vmcnt(7)
    ds_read_b128 v[40:43], v2 offset:128
    v_lshlrev_b32 v48, 16, v56
    v_mfma_f32_16x16x32_bf16 v[160:163], v[28:31], a[196:199], v[160:163]
    s_waitcnt vmcnt(4)
    v_subrev_u32 v52, s92, v52
    v_cmp_lt_u32 vcc, 15, v52
    v_mfma_f32_16x16x32_bf16 v[164:167], v[24:27], a[216:219], v[132:135]
    v_exp_f32 v16, v88
    v_mfma_f32_16x16x32_bf16 v[164:167], v[28:31], a[220:223], v[164:167]
    v_exp_f32 v17, v89
    v_mfma_f32_16x16x32_bf16 v[168:171], v[24:27], a[240:243], v[136:139]
    s_and_b32 s59, vcc_lo, 0xff
    ds_read_b128 v[44:47], v3 offset:128
    v_and_b32 v49, s97, v56
    v_mfma_f32_16x16x32_bf16 v[168:171], v[28:31], a[244:247], v[168:171]
    s_cbranch_scc1 L_pollslow1
L_pollok1:
    v_mfma_f32_16x16x32_bf16 v[172:175], v[24:27], v[200:203], v[140:143]
    s_add_u32 s92, s92, 1
    v_exp_f32 v18, v90
    v_mfma_f32_16x16x32_bf16 v[172:175], v[28:31], v[204:207], v[172:175]
    s_waitcnt lgkmcnt(2)
    v_add_f32 v7, v7, v16
    v_add_f32 v7, v7, v17
    v_mfma_f32_16x16x32_bf16 v[96:99], v[32:35], a[192:195], v[128:131]
    ds_read_b128 v[24:27], v2 offset:6272
    v_lshlrev_b32 v50, 16, v58
    v_mfma_f32_16x16x32_bf16 v[96:99], v[36:39], a[196:199], v[96:99]
    buffer_store_dwordx4 v[144:147], v15, s[4:7], s35 offen offset:0 sc1
    v_mfma_f32_16x16x32_bf16 v[100:103], v[32:35], a[216:219], v[132:135]
    v_exp_f32 v19, v91
    v_mfma_f32_16x16x32_bf16 v[100:103], v[36:39], a[220:223], v[100:103]
    v_cvt_pk_bf16_f32 v88, v16, v17
    v_and_b32 v51, s97, v58
    v_mfma_f32_16x16x32_bf16 v[104:107], v[32:35], a[240:243], v[136:139]
    ds_read_b128 v[28:31], v3 offset:6272
    v_mfma_f32_16x16x32_bf16 v[104:107], v[36:39], a[244:247], v[104:107]
    v_exp_f32 v16, v120
    v_mfma_f32_16x16x32_bf16 v[108:111], v[32:35], v[200:203], v[140:143]
    v_add_f32 v7, v7, v18
    v_add_f32 v7, v7, v19
    v_mfma_f32_16x16x32_bf16 v[108:111], v[36:39], v[204:207], v[108:111]
    s_waitcnt lgkmcnt(2)
    v_exp_f32 v17, v121
    v_mfma_f32_16x16x32_bf16 v[160:163], v[40:43], a[200:203], v[160:163]
    ds_read_b128 v[32:35], v2 offset:256
    v_cvt_pk_bf16_f32 v89, v18, v19
    v_mfma_f32_16x16x32_bf16 v[160:163], v[44:47], a[204:207], v[160:163]
    buffer_store_dwordx4 v[148:151], v15, s[4:7], s35 offen offset:1024 sc1
    v_mfma_f32_16x16x32_bf16 v[164:167], v[40:43], a[224:227], v[164:167]
    v_exp_f32 v18, v122
    v_mfma_f32_16x16x32_bf16 v[164:167], v[44:47], a[228:231], v[164:167]
    v_add_f32 v7, v7, v16
    v_add_f32 v7, v7, v17
    v_mfma_f32_16x16x32_bf16 v[168:171], v[40:43], a[248:251], v[168:171]
    ds_read_b128 v[36:39], v3 offset:256
    v_mul_f32 v48, s38, v48
    v_mfma_f32_16x16x32_bf16 v[168:171], v[44:47], a[252:255], v[168:171]
    v_exp_f32 v19, v123
    v_mfma_f32_16x16x32_bf16 v[172:175], v[40:43], v[208:211], v[172:175]
    v_cvt_pk_bf16_f32 v90, v16, v17
    v_mul_f32 v49, s38, v49
    v_mfma_f32_16x16x32_bf16 v[172:175], v[44:47], v[212:215], v[172:175]
    s_waitcnt lgkmcnt(2)
    v_exp_f32 v16, v92
    v_mfma_f32_16x16x32_bf16 v[96:99], v[24:27], a[200:203], v[96:99]
    ds_read_b128 v[40:43], v2 offset:6400
    v_add_f32 v7, v7, v18
    v_mfma_f32_16x16x32_bf16 v[96:99], v[28:31], a[204:207], v[96:99]
    buffer_store_dwordx4 v[152:155], v15, s[4:7], s35 offen offset:2048 sc1
    v_mfma_f32_16x16x32_bf16 v[100:103], v[24:27], a[224:227], v[100:103]
    v_add_f32 v7, v7, v19
    v_mul_f32_e64 v50, -v50, v48
    v_mfma_f32_16x16x32_bf16 v[100:103], v[28:31], a[228:231], v[100:103]
    v_exp_f32 v17, v93
    v_mfma_f32_16x16x32_bf16 v[104:107], v[24:27], a[248:251], v[104:107]
    ds_read_b128 v[44:47], v3 offset:6400
    v_cvt_pk_bf16_f32 v91, v18, v19
    v_mfma_f32_16x16x32_bf16 v[104:107], v[28:31], a[252:255], v[104:107]
    v_exp_f32 v18, v94
    v_mfma_f32_16x16x32_bf16 v[108:111], v[24:27], v[208:211], v[108:111]
    s_add_u32 s29, s30, 49152
    v_add_f32 v8, v8, v16
    v_add_f32 v8, v8, v17
    v_mfma_f32_16x16x32_bf16 v[108:111], v[28:31], v[212:215], v[108:111]
    s_waitcnt lgkmcnt(2)
    v_exp_f32 v19, v95
    v_mfma_f32_16x16x32_bf16 v[160:163], v[32:35], a[208:211], v[160:163]
    s_sub_u32 s3, s29, 147456
    ds_read_b128 v[24:27], v2 offset:12288
    v_cvt_pk_bf16_f32 v92, v16, v17
    v_mfma_f32_16x16x32_bf16 v[160:163], v[36:39], a[212:215], v[160:163]
    s_min_u32 s29, s29, s3
    v_exp_f32 v16, v124
    v_mfma_f32_16x16x32_bf16 v[164:167], v[32:35], a[232:235], v[164:167]
    v_mul_f32_e64 v51, -v51, v49
    v_add_f32 v8, v8, v18
    v_mfma_f32_16x16x32_bf16 v[164:167], v[36:39], a[236:239], v[164:167]
    v_add_f32 v8, v8, v19
    v_cvt_f32_i32 v224, v224
    v_mfma_f32_16x16x32_bf16 v[168:171], v[32:35], v[192:195], v[168:171]
    ds_read_b128 v[28:31], v3 offset:12288
    v_cvt_f32_i32 v225, v225
    v_mfma_f32_16x16x32_bf16 v[168:171], v[36:39], v[196:199], v[168:171]
    v_exp_f32 v17, v125
    v_mfma_f32_16x16x32_bf16 v[172:175], v[32:35], v[216:219], v[172:175]
    v_cvt_pk_bf16_f32 v93, v18, v19
    v_mfma_f32_16x16x32_bf16 v[172:175], v[36:39], v[220:223], v[172:175]
    s_waitcnt lgkmcnt(2)
    v_exp_f32 v18, v126
    v_mfma_f32_16x16x32_bf16 v[96:99], v[40:43], a[208:211], v[96:99]
    ds_read_b128 v[32:35], v2 offset:18432
    v_add_f32 v8, v8, v16
    v_mfma_f32_16x16x32_bf16 v[96:99], v[44:47], a[212:215], v[96:99]
    s_mov_b32 m0, s26
    v_add_f32 v8, v8, v17
    v_fma_f32 v224, v224, v48, v50
    v_mfma_f32_16x16x32_bf16 v[100:103], v[40:43], a[232:235], v[100:103]
    s_sub_u32 s3, s29, s30
    v_exp_f32 v19, v127
    v_mfma_f32_16x16x32_bf16 v[100:103], v[44:47], a[236:239], v[100:103]
    buffer_load_dwordx4 v4, s[4:7], s32 offen offset:0 sc1 lds
    v_mfma_f32_16x16x32_bf16 v[104:107], v[40:43], v[192:195], v[104:107]
    ds_read_b128 v[36:39], v3 offset:18432
    v_cvt_pk_bf16_f32 v94, v16, v17
    v_mfma_f32_16x16x32_bf16 v[104:107], v[44:47], v[196:199], v[104:107]
    v_add_f32 v8, v8, v18
    v_add_f32 v8, v8, v19
    v_mfma_f32_16x16x32_bf16 v[108:111], v[40:43], v[216:219], v[108:111]
    v_cvt_pk_bf16_f32 v95, v18, v19
    v_fma_f32 v225, v225, v49, v51
    v_mfma_f32_16x16x32_bf16 v[108:111], v[44:47], v[220:223], v[108:111]
    s_waitcnt lgkmcnt(2)
    buffer_load_dwordx4 v4, s[4:7], s32 offen offset:1024 sc1 lds
    v_mfma_f32_16x16x32_bf16 v[176:179], v[24:27], a[192:195], v[128:131]
    ds_read_b128 v[40:43], v2 offset:12416
    v_cvt_pk_bf16_f32 v224, v224, v225
    v_mfma_f32_16x16x32_bf16 v[176:179], v[28:31], a[196:199], v[176:179]
    s_mov_b32 s30, s29
    v_exp_f32 v16, v160
    v_mfma_f32_16x16x32_bf16 v[180:183], v[24:27], a[216:219], v[132:135]
    v_exp_f32 v17, v161
    v_mfma_f32_16x16x32_bf16 v[180:183], v[28:31], a[220:223], v[180:183]
    buffer_load_dwordx4 v4, s[4:7], s32 offen offset:2048 sc1 lds
    v_mfma_f32_16x16x32_bf16 v[184:187], v[24:27], a[240:243], v[136:139]
    s_add_u32 s32, s32, 24576
    ds_read_b128 v[44:47], v3 offset:12416
    v_cvt_f32_i32 v228, v228
    v_mfma_f32_16x16x32_bf16 v[184:187], v[28:31], a[244:247], v[184:187]
    v_exp_f32 v18, v162
    v_mfma_f32_16x16x32_bf16 v[188:191], v[24:27], v[200:203], v[140:143]
    s_add_u32 s26, s26, 12288
    v_add_f32 v5, v5, v16
    v_add_f32 v5, v5, v17
    v_mfma_f32_16x16x32_bf16 v[188:191], v[28:31], v[204:207], v[188:191]
    s_waitcnt lgkmcnt(2)
    v_exp_f32 v19, v163
    v_mfma_f32_16x16x32_bf16 v[112:115], v[32:35], a[192:195], v[128:131]
    s_mov_b32 m0, s26
    ds_read_b128 v[24:27], v2 offset:18560
    v_cvt_pk_bf16_f32 v160, v16, v17
    v_mfma_f32_16x16x32_bf16 v[112:115], v[36:39], a[196:199], v[112:115]
    v_exp_f32 v16, v96
    v_mfma_f32_16x16x32_bf16 v[116:119], v[32:35], a[216:219], v[132:135]
    v_add_f32 v5, v5, v18
    v_cvt_f32_i32 v229, v229
    v_mfma_f32_16x16x32_bf16 v[116:119], v[36:39], a[220:223], v[116:119]
    v_add_f32 v5, v5, v19
    v_add_u32 v1, s3, v1
    v_mfma_f32_16x16x32_bf16 v[120:123], v[32:35], a[240:243], v[136:139]
    ds_read_b128 v[28:31], v3 offset:18560
    v_fma_f32 v228, v228, v48, v50
    v_mfma_f32_16x16x32_bf16 v[120:123], v[36:39], a[244:247], v[120:123]
    buffer_load_dwordx4 v4, s[4:7], s32 offen offset:0 sc1 lds
    v_mfma_f32_16x16x32_bf16 v[124:127], v[32:35], v[200:203], v[140:143]
    v_exp_f32 v17, v97
    v_mfma_f32_16x16x32_bf16 v[124:127], v[36:39], v[204:207], v[124:127]
    s_waitcnt lgkmcnt(2)
    v_cvt_pk_bf16_f32 v161, v18, v19
    v_mfma_f32_16x16x32_bf16 v[176:179], v[40:43], a[200:203], v[176:179]
    ds_read_b128 v[32:35], v2 offset:12544
    v_fma_f32 v229, v229, v49, v51
    v_mfma_f32_16x16x32_bf16 v[176:179], v[44:47], a[204:207], v[176:179]
    buffer_load_dwordx4 v4, s[4:7], s32 offen offset:1024 sc1 lds
    v_mfma_f32_16x16x32_bf16 v[180:183], v[40:43], a[224:227], v[180:183]
    v_exp_f32 v18, v98
    v_mfma_f32_16x16x32_bf16 v[180:183], v[44:47], a[228:231], v[180:183]
    v_add_f32 v5, v5, v16
    v_add_f32 v5, v5, v17
    v_mfma_f32_16x16x32_bf16 v[184:187], v[40:43], a[248:251], v[184:187]
    ds_read_b128 v[36:39], v3 offset:12544
    v_cvt_pk_bf16_f32 v228, v228, v229
    v_mfma_f32_16x16x32_bf16 v[184:187], v[44:47], a[252:255], v[184:187]
    buffer_load_dwordx4 v4, s[4:7], s32 offen offset:2048 sc1 lds
    v_mfma_f32_16x16x32_bf16 v[188:191], v[40:43], v[208:211], v[188:191]
    v_exp_f32 v19, v99
    v_mfma_f32_16x16x32_bf16 v[188:191], v[44:47], v[212:215], v[188:191]
    s_waitcnt lgkmcnt(2)
    v_cvt_pk_bf16_f32 v162, v16, v17
    v_mfma_f32_16x16x32_bf16 v[112:115], v[24:27], a[200:203], v[112:115]
    ds_read_b128 v[40:43], v2 offset:18688
    v_mfma_f32_16x16x32_bf16 v[112:115], v[28:31], a[204:207], v[112:115]
    v_exp_f32 v16, v164
    v_mfma_f32_16x16x32_bf16 v[116:119], v[24:27], a[224:227], v[116:119]
    v_add_f32 v5, v5, v18
    v_add_f32 v5, v5, v19
    v_mfma_f32_16x16x32_bf16 v[116:119], v[28:31], a[228:231], v[116:119]
    s_add_u32 s32, s32, 24576
    v_exp_f32 v17, v165
    v_mfma_f32_16x16x32_bf16 v[120:123], v[24:27], a[248:251], v[120:123]
    s_add_u32 s26, s26, 36864
    ds_read_b128 v[44:47], v3 offset:18688
    v_cvt_pk_bf16_f32 v163, v18, v19
    v_mfma_f32_16x16x32_bf16 v[120:123], v[28:31], a[252:255], v[120:123]
    s_waitcnt lgkmcnt(2)
    v_exp_f32 v18, v166
    v_mfma_f32_16x16x32_bf16 v[124:127], v[24:27], v[208:211], v[124:127]
    s_waitcnt vmcnt(6)
    v_add_f32 v6, v6, v16
    v_add_f32 v6, v6, v17
    v_mfma_f32_16x16x32_bf16 v[124:127], v[28:31], v[212:215], v[124:127]
    s_barrier
    v_cvt_f32_i32 v232, v232
    v_mfma_f32_16x16x32_bf16 v[176:179], v[32:35], a[208:211], v[176:179]
    s_sub_u32 s57, s26, 147456
    ds_read_b128 v[24:27], v1 offset:0
    v_add_u32 v0, 1, v0
    v_mfma_f32_16x16x32_bf16 v[176:179], v[36:39], a[212:215], v[176:179]
    s_min_u32 s26, s26, s57
    buffer_store_dword v0, v13, s[20:23], 0 offen offset:32 sc1
    v_mfma_f32_16x16x32_bf16 v[180:183], v[32:35], a[232:235], v[180:183]
    v_exp_f32 v19, v167
    v_mfma_f32_16x16x32_bf16 v[180:183], v[36:39], a[236:239], v[180:183]
    v_cvt_pk_bf16_f32 v164, v16, v17
    v_cvt_f32_i32 v233, v233
    v_mfma_f32_16x16x32_bf16 v[184:187], v[32:35], v[192:195], v[184:187]
    ds_read_b128 v[28:31], v1 offset:12288
    v_fma_f32 v232, v232, v48, v50
    v_mfma_f32_16x16x32_bf16 v[184:187], v[36:39], v[196:199], v[184:187]
    v_exp_f32 v16, v100
    v_mfma_f32_16x16x32_bf16 v[188:191], v[32:35], v[216:219], v[188:191]
    v_add_f32 v6, v6, v18
    v_add_f32 v6, v6, v19
    v_mfma_f32_16x16x32_bf16 v[188:191], v[36:39], v[220:223], v[188:191]
    s_waitcnt lgkmcnt(2)
    v_exp_f32 v17, v101
    v_mfma_f32_16x16x32_bf16 v[112:115], v[40:43], a[208:211], v[112:115]
    ds_read_b128 v[32:35], v1 offset:1024
    v_cvt_pk_bf16_f32 v165, v18, v19
    v_mfma_f32_16x16x32_bf16 v[112:115], v[44:47], a[212:215], v[112:115]
    v_exp_f32 v18, v102
    v_mfma_f32_16x16x32_bf16 v[116:119], v[40:43], a[232:235], v[116:119]
    v_add_f32 v6, v6, v16
    v_add_f32 v6, v6, v17
    v_mfma_f32_16x16x32_bf16 v[116:119], v[44:47], a[236:239], v[116:119]
    v_exp_f32 v19, v103
    v_mfma_f32_16x16x32_bf16 v[120:123], v[40:43], v[192:195], v[120:123]
    ds_read_b128 v[36:39], v1 offset:13312
    v_cvt_pk_bf16_f32 v166, v16, v17
    v_mfma_f32_16x16x32_bf16 v[120:123], v[44:47], v[196:199], v[120:123]
    v_add_f32 v6, v6, v18
    v_fma_f32 v233, v233, v49, v51
    v_mfma_f32_16x16x32_bf16 v[124:127], v[40:43], v[216:219], v[124:127]
    v_add_f32 v6, v6, v19
    v_cvt_pk_bf16_f32 v167, v18, v19
    v_mfma_f32_16x16x32_bf16 v[124:127], v[44:47], v[220:223], v[124:127]
    s_waitcnt lgkmcnt(2)
    v_mfma_f32_16x16x32_bf16 a[0:3], v[64:67], v[24:27], a[0:3]
    s_mov_b32 m0, s26
    ds_read_b128 v[40:43], v1 offset:2048
    v_cvt_pk_bf16_f32 v232, v232, v233
    v_mfma_f32_16x16x32_bf16 a[0:3], v[80:83], v[28:31], a[0:3]
    buffer_load_dwordx2 v[60:61], v10, s[72:75], s36 offen offset:192
    v_mfma_f32_16x16x32_bf16 a[48:51], v[68:71], v[24:27], a[48:51]
    v_exp_f32 v16, v168
    v_mfma_f32_16x16x32_bf16 a[48:51], v[84:87], v[28:31], a[48:51]
    v_exp_f32 v17, v169
    v_mfma_f32_16x16x32_bf16 a[96:99], v[72:75], v[24:27], a[96:99]
    ds_read_b128 v[44:47], v1 offset:14336
    v_cvt_f32_i32 v236, v236
    v_mfma_f32_16x16x32_bf16 a[96:99], v[88:91], v[28:31], a[96:99]
    buffer_load_dwordx4 v4, s[4:7], s32 offen offset:0 sc1 lds
    v_mfma_f32_16x16x32_bf16 a[144:147], v[76:79], v[24:27], a[144:147]
    v_exp_f32 v18, v170
    v_mfma_f32_16x16x32_bf16 a[144:147], v[92:95], v[28:31], a[144:147]
    s_waitcnt lgkmcnt(2)
    v_add_f32 v7, v7, v16
    v_add_f32 v7, v7, v17
    v_mfma_f32_16x16x32_bf16 a[4:7], v[64:67], v[32:35], a[4:7]
    ds_read_b128 v[24:27], v1 offset:3072
    v_cvt_f32_i32 v237, v237
    v_mfma_f32_16x16x32_bf16 a[4:7], v[80:83], v[36:39], a[4:7]
    buffer_load_dwordx2 v[62:63], v10, s[76:79], s36 offen offset:192
    v_mfma_f32_16x16x32_bf16 a[52:55], v[68:71], v[32:35], a[52:55]
    v_exp_f32 v19, v171
    v_mfma_f32_16x16x32_bf16 a[52:55], v[84:87], v[36:39], a[52:55]
    v_cvt_pk_bf16_f32 v168, v16, v17
    v_fma_f32 v236, v236, v48, v50
    v_mfma_f32_16x16x32_bf16 a[100:103], v[72:75], v[32:35], a[100:103]
    ds_read_b128 v[28:31], v1 offset:15360
    v_fma_f32 v237, v237, v49, v51
    v_mfma_f32_16x16x32_bf16 a[100:103], v[88:91], v[36:39], a[100:103]
    buffer_load_dwordx4 v[240:243], v9, s[64:67], s33 offen offset:384 nt
    v_mfma_f32_16x16x32_bf16 a[148:151], v[76:79], v[32:35], a[148:151]
    v_exp_f32 v16, v104
    v_mfma_f32_16x16x32_bf16 a[148:151], v[92:95], v[36:39], a[148:151]
    s_waitcnt lgkmcnt(2)
    v_add_f32 v7, v7, v18
    v_add_f32 v7, v7, v19
    v_mfma_f32_16x16x32_bf16 a[8:11], v[64:67], v[40:43], a[8:11]
    ds_read_b128 v[32:35], v1 offset:4096
    v_cvt_pk_bf16_f32 v236, v236, v237
    v_mfma_f32_16x16x32_bf16 a[8:11], v[80:83], v[44:47], a[8:11]
    buffer_load_dwordx4 v4, s[4:7], s32 offen offset:1024 sc1 lds
    v_mfma_f32_16x16x32_bf16 a[56:59], v[68:71], v[40:43], a[56:59]
    v_exp_f32 v17, v105
    v_mfma_f32_16x16x32_bf16 a[56:59], v[84:87], v[44:47], a[56:59]
    v_cvt_pk_bf16_f32 v169, v18, v19
    v_lshlrev_b32 v48, 16, v57
    v_mfma_f32_16x16x32_bf16 a[104:107], v[72:75], v[40:43], a[104:107]
    ds_read_b128 v[36:39], v1 offset:16384
    v_mfma_f32_16x16x32_bf16 a[104:107], v[88:91], v[44:47], a[104:107]
    buffer_load_dwordx4 v[244:247], v9, s[64:67], s33 offen offset:1920 nt
    v_mfma_f32_16x16x32_bf16 a[152:155], v[76:79], v[40:43], a[152:155]
    v_exp_f32 v18, v106
    v_mfma_f32_16x16x32_bf16 a[152:155], v[92:95], v[44:47], a[152:155]
    s_waitcnt lgkmcnt(2)
    v_add_f32 v7, v7, v16
    v_add_f32 v7, v7, v17
    v_mfma_f32_16x16x32_bf16 a[12:15], v[64:67], v[24:27], a[12:15]
    ds_read_b128 v[40:43], v1 offset:5120
    v_and_b32 v49, s97, v57
    v_mfma_f32_16x16x32_bf16 a[12:15], v[80:83], v[28:31], a[12:15]
    buffer_load_dwordx4 v4, s[4:7], s32 offen offset:2048 sc1 lds
    v_mfma_f32_16x16x32_bf16 a[60:63], v[68:71], v[24:27], a[60:63]
    v_exp_f32 v19, v107
    v_mfma_f32_16x16x32_bf16 a[60:63], v[84:87], v[28:31], a[60:63]
    v_cvt_pk_bf16_f32 v170, v16, v17
    v_exp_f32 v16, v172
    v_mfma_f32_16x16x32_bf16 a[108:111], v[72:75], v[24:27], a[108:111]
    ds_read_b128 v[44:47], v1 offset:17408
    v_add_f32 v7, v7, v18
    v_mfma_f32_16x16x32_bf16 a[108:111], v[88:91], v[28:31], a[108:111]
    buffer_load_dwordx4 v[248:251], v9, s[64:67], s34 offen offset:384 nt
    v_add_f32 v7, v7, v19
    v_mfma_f32_16x16x32_bf16 a[156:159], v[76:79], v[24:27], a[156:159]
    s_add_u32 s29, s28, 49152
    v_exp_f32 v17, v173
    v_mfma_f32_16x16x32_bf16 a[156:159], v[92:95], v[28:31], a[156:159]
    s_waitcnt lgkmcnt(2)
    v_cvt_pk_bf16_f32 v171, v18, v19
    v_lshlrev_b32 v50, 16, v59
    v_mfma_f32_16x16x32_bf16 a[16:19], v[64:67], v[32:35], a[16:19]
    s_sub_u32 s3, s29, 147456
    ds_read_b128 v[24:27], v1 offset:6144
    v_and_b32 v51, s97, v59
    v_mfma_f32_16x16x32_bf16 a[16:19], v[80:83], v[36:39], a[16:19]
    s_add_u32 s32, s32, 24576
    buffer_load_dwordx4 v[252:255], v9, s[64:67], s34 offen offset:1920 nt
    v_mfma_f32_16x16x32_bf16 a[64:67], v[68:71], v[32:35], a[64:67]
    s_min_u32 s29, s29, s3
    v_exp_f32 v18, v174
    v_mfma_f32_16x16x32_bf16 a[64:67], v[84:87], v[36:39], a[64:67]
    v_add_f32 v8, v8, v16
    v_add_f32 v8, v8, v17
    v_mfma_f32_16x16x32_bf16 a[112:115], v[72:75], v[32:35], a[112:115]
    s_add_u32 s26, s26, 12288
    ds_read_b128 v[28:31], v1 offset:18432
    v_mul_f32 v48, s38, v48
    v_mfma_f32_16x16x32_bf16 a[112:115], v[88:91], v[36:39], a[112:115]
    v_exp_f32 v19, v175
    v_cvt_pk_bf16_f32 v172, v16, v17
    v_mfma_f32_16x16x32_bf16 a[160:163], v[76:79], v[32:35], a[160:163]
    v_exp_f32 v16, v108
    v_mfma_f32_16x16x32_bf16 a[160:163], v[92:95], v[36:39], a[160:163]
    s_waitcnt lgkmcnt(2)
    v_add_f32 v8, v8, v18
    v_add_f32 v8, v8, v19
    v_mfma_f32_16x16x32_bf16 a[20:23], v[64:67], v[40:43], a[20:23]
    s_sub_u32 s3, s29, s28
    ds_read_b128 v[32:35], v1 offset:7168
    v_mul_f32 v49, s38, v49
    v_mfma_f32_16x16x32_bf16 a[20:23], v[80:83], v[44:47], a[20:23]
    v_exp_f32 v17, v109
    v_mfma_f32_16x16x32_bf16 a[68:71], v[68:71], v[40:43], a[68:71]
    s_mov_b32 m0, s26
    v_cvt_pk_bf16_f32 v173, v18, v19
    v_mul_f32_e64 v50, -v50, v48
    v_mfma_f32_16x16x32_bf16 a[68:71], v[84:87], v[44:47], a[68:71]
    v_exp_f32 v18, v110
    v_mfma_f32_16x16x32_bf16 a[116:119], v[72:75], v[40:43], a[116:119]
    ds_read_b128 v[36:39], v1 offset:19456
    v_add_f32 v8, v8, v16
    v_mfma_f32_16x16x32_bf16 a[116:119], v[88:91], v[44:47], a[116:119]
    v_add_f32 v8, v8, v17
    v_mul_f32_e64 v51, -v51, v49
    v_mfma_f32_16x16x32_bf16 a[164:167], v[76:79], v[40:43], a[164:167]
    s_mov_b32 s28, s29
    v_exp_f32 v19, v111
    v_mfma_f32_16x16x32_bf16 a[164:167], v[92:95], v[44:47], a[164:167]
    s_waitcnt lgkmcnt(2)
    v_cvt_pk_bf16_f32 v174, v16, v17
    v_add_f32 v8, v8, v18
    v_mfma_f32_16x16x32_bf16 a[24:27], v[64:67], v[24:27], a[24:27]
    ds_read_b128 v[40:43], v1 offset:8192
    v_add_f32 v8, v8, v19
    v_mfma_f32_16x16x32_bf16 a[24:27], v[80:83], v[28:31], a[24:27]
    v_cvt_pk_bf16_f32 v175, v18, v19
    v_cvt_f32_i32 v226, v226
    v_mfma_f32_16x16x32_bf16 a[72:75], v[68:71], v[24:27], a[72:75]
    v_exp_f32 v16, v176
    v_mfma_f32_16x16x32_bf16 a[72:75], v[84:87], v[28:31], a[72:75]
    buffer_load_dwordx4 v4, s[4:7], s32 offen offset:0 sc1 lds
    v_mfma_f32_16x16x32_bf16 a[120:123], v[72:75], v[24:27], a[120:123]
    ds_read_b128 v[44:47], v1 offset:20480
    v_mfma_f32_16x16x32_bf16 a[120:123], v[88:91], v[28:31], a[120:123]
    v_exp_f32 v17, v177
    v_mfma_f32_16x16x32_bf16 a[168:171], v[76:79], v[24:27], a[168:171]
    v_exp_f32 v18, v178
    v_mfma_f32_16x16x32_bf16 a[168:171], v[92:95], v[28:31], a[168:171]
    s_waitcnt lgkmcnt(2)
    v_add_f32 v5, v5, v16
    v_add_f32 v5, v5, v17
    v_mfma_f32_16x16x32_bf16 a[28:31], v[64:67], v[32:35], a[28:31]
    ds_read_b128 v[24:27], v1 offset:9216
    v_cvt_f32_i32 v227, v227
    v_mfma_f32_16x16x32_bf16 a[28:31], v[80:83], v[36:39], a[28:31]
    v_exp_f32 v19, v179
    v_mfma_f32_16x16x32_bf16 a[76:79], v[68:71], v[32:35], a[76:79]
    v_cvt_pk_bf16_f32 v176, v16, v17
    v_add_u32 v2, s3, v2
    v_mfma_f32_16x16x32_bf16 a[76:79], v[84:87], v[36:39], a[76:79]
L_pg6:
    s_cbranch_execz L_pg10
    v_exp_f32 v16, v112
    v_mfma_f32_16x16x32_bf16 a[124:127], v[72:75], v[32:35], a[124:127]
    ds_read_b128 v[28:31], v1 offset:21504
    v_add_f32 v5, v5, v18
    v_mfma_f32_16x16x32_bf16 a[124:127], v[88:91], v[36:39], a[124:127]
    v_add_f32 v5, v5, v19
    v_fma_f32 v226, v226, v48, v50
    v_mfma_f32_16x16x32_bf16 a[172:175], v[76:79], v[32:35], a[172:175]
    v_exp_f32 v17, v113
    v_mfma_f32_16x16x32_bf16 a[172:175], v[92:95], v[36:39], a[172:175]
    s_waitcnt lgkmcnt(2)
    buffer_load_dwordx4 v4, s[4:7], s32 offen offset:1024 sc1 lds
    v_mfma_f32_16x16x32_bf16 a[32:35], v[64:67], v[40:43], a[32:35]
    ds_read_b128 v[32:35], v1 offset:10240
    v_cvt_pk_bf16_f32 v177, v18, v19
    v_mfma_f32_16x16x32_bf16 a[32:35], v[80:83], v[44:47], a[32:35]
    v_exp_f32 v18, v114
    v_mfma_f32_16x16x32_bf16 a[80:83], v[68:71], v[40:43], a[80:83]
    v_add_f32 v5, v5, v16
    v_add_f32 v5, v5, v17
    v_mfma_f32_16x16x32_bf16 a[80:83], v[84:87], v[44:47], a[80:83]
    v_exp_f32 v19, v115
    v_mfma_f32_16x16x32_bf16 a[128:131], v[72:75], v[40:43], a[128:131]
    ds_read_b128 v[36:39], v1 offset:22528
    v_cvt_pk_bf16_f32 v178, v16, v17
    v_mfma_f32_16x16x32_bf16 a[128:131], v[88:91], v[44:47], a[128:131]
    v_exp_f32 v16, v180
    v_mfma_f32_16x16x32_bf16 a[176:179], v[76:79], v[40:43], a[176:179]
    v_fma_f32 v227, v227, v49, v51
    v_add_u32 v3, s3, v3
    v_mfma_f32_16x16x32_bf16 a[176:179], v[92:95], v[44:47], a[176:179]
    s_waitcnt lgkmcnt(2)
    v_add_f32 v5, v5, v18
    v_add_f32 v5, v5, v19
    v_mfma_f32_16x16x32_bf16 a[36:39], v[64:67], v[24:27], a[36:39]
    ds_read_b128 v[40:43], v1 offset:11264
    v_cvt_pk_bf16_f32 v225, v226, v227
    v_mfma_f32_16x16x32_bf16 a[36:39], v[80:83], v[28:31], a[36:39]
    buffer_load_dwordx4 v4, s[4:7], s32 offen offset:2048 sc1 lds
    v_mfma_f32_16x16x32_bf16 a[84:87], v[68:71], v[24:27], a[84:87]
    v_exp_f32 v17, v181
    v_mfma_f32_16x16x32_bf16 a[84:87], v[84:87], v[28:31], a[84:87]
    v_cvt_pk_bf16_f32 v179, v18, v19
    v_cvt_f32_i32 v230, v230
    v_mfma_f32_16x16x32_bf16 a[132:135], v[72:75], v[24:27], a[132:135]
    ds_read_b128 v[44:47], v1 offset:23552
    v_cvt_f32_i32 v231, v231
    v_mfma_f32_16x16x32_bf16 a[132:135], v[88:91], v[28:31], a[132:135]
    s_waitcnt lgkmcnt(2)
    v_exp_f32 v18, v182
    v_mfma_f32_16x16x32_bf16 a[180:183], v[76:79], v[24:27], a[180:183]
    s_waitcnt vmcnt(13)
    v_add_f32 v6, v6, v16
    v_add_f32 v6, v6, v17
    v_mfma_f32_16x16x32_bf16 a[180:183], v[92:95], v[28:31], a[180:183]
    s_barrier
    v_fma_f32 v230, v230, v48, v50
    v_mfma_f32_16x16x32_bf16 a[40:43], v[64:67], v[32:35], a[40:43]
    ds_read_b128 v[24:27], v2 offset:0
    v_mfma_f32_16x16x32_bf16 a[40:43], v[80:83], v[36:39], a[40:43]
    v_exp_f32 v19, v183
    v_mfma_f32_16x16x32_bf16 a[88:91], v[68:71], v[32:35], a[88:91]
    v_cvt_pk_bf16_f32 v180, v16, v17
    v_fma_f32 v231, v231, v49, v51
    v_mfma_f32_16x16x32_bf16 a[88:91], v[84:87], v[36:39], a[88:91]
    v_exp_f32 v16, v116
    v_mfma_f32_16x16x32_bf16 a[136:139], v[72:75], v[32:35], a[136:139]
    ds_read_b128 v[28:31], v3 offset:0
    v_add_f32 v6, v6, v18
    v_mfma_f32_16x16x32_bf16 a[136:139], v[88:91], v[36:39], a[136:139]
    v_add_f32 v6, v6, v19
    v_cvt_pk_bf16_f32 v229, v230, v231
    v_mfma_f32_16x16x32_bf16 a[184:187], v[76:79], v[32:35], a[184:187]
    v_exp_f32 v17, v117
    v_mfma_f32_16x16x32_bf16 a[184:187], v[92:95], v[36:39], a[184:187]
    s_waitcnt lgkmcnt(2)
    v_cvt_pk_bf16_f32 v181, v18, v19
    v_mfma_f32_16x16x32_bf16 a[44:47], v[64:67], v[40:43], a[44:47]
    ds_read_b128 v[32:35], v2 offset:6144
    v_mfma_f32_16x16x32_bf16 a[44:47], v[80:83], v[44:47], a[44:47]
    v_exp_f32 v18, v118
    v_mfma_f32_16x16x32_bf16 a[92:95], v[68:71], v[40:43], a[92:95]
    v_add_f32 v6, v6, v16
    v_add_f32 v6, v6, v17
    v_mfma_f32_16x16x32_bf16 a[92:95], v[84:87], v[44:47], a[92:95]
    s_add_u32 s32, s32, 24576
    v_exp_f32 v19, v119
    v_mfma_f32_16x16x32_bf16 a[140:143], v[72:75], v[40:43], a[140:143]
    s_add_u32 s26, s26, 36864
    ds_read_b128 v[36:39], v3 offset:6144
    v_cvt_pk_bf16_f32 v182, v16, v17
    v_mfma_f32_16x16x32_bf16 a[140:143], v[88:91], v[44:47], a[140:143]
    s_sub_u32 s57, s26, 147456
    v_add_f32 v6, v6, v18
    v_add_f32 v6, v6, v19
    v_mfma_f32_16x16x32_bf16 a[188:191], v[76:79], v[40:43], a[188:191]
    s_min_u32 s26, s26, s57
    v_cvt_pk_bf16_f32 v183, v18, v19
    v_mfma_f32_16x16x32_bf16 a[188:191], v[92:95], v[44:47], a[188:191]
    s_waitcnt lgkmcnt(2)
    v_mfma_f32_16x16x32_bf16 v[64:67], v[24:27], a[192:195], v[128:131]
    ds_read_b128 v[40:43], v2 offset:128
    v_cvt_f32_i32 v234, v234
    v_mfma_f32_16x16x32_bf16 v[64:67], v[28:31], a[196:199], v[64:67]
    v_exp_f32 v16, v184
    v_mfma_f32_16x16x32_bf16 v[68:71], v[24:27], a[216:219], v[132:135]
    v_exp_f32 v17, v185
    v_mfma_f32_16x16x32_bf16 v[68:71], v[28:31], a[220:223], v[68:71]
    buffer_load_dword v52, v20, s[20:23], s44 offen sc1
    v_mfma_f32_16x16x32_bf16 v[72:75], v[24:27], a[240:243], v[136:139]
    ds_read_b128 v[44:47], v3 offset:128
    v_cvt_f32_i32 v235, v235
    v_mfma_f32_16x16x32_bf16 v[72:75], v[28:31], a[244:247], v[72:75]
    v_exp_f32 v18, v186
    v_mfma_f32_16x16x32_bf16 v[76:79], v[24:27], v[200:203], v[140:143]
    v_add_f32 v7, v7, v16
    v_add_f32 v7, v7, v17
    v_mfma_f32_16x16x32_bf16 v[76:79], v[28:31], v[204:207], v[76:79]
    s_waitcnt lgkmcnt(2)
    v_exp_f32 v19, v187
    v_mfma_f32_16x16x32_bf16 v[96:99], v[32:35], a[192:195], v[128:131]
    ds_read_b128 v[24:27], v2 offset:6272
    v_cvt_pk_bf16_f32 v184, v16, v17
    v_mfma_f32_16x16x32_bf16 v[96:99], v[36:39], a[196:199], v[96:99]
    v_exp_f32 v16, v120
    v_mfma_f32_16x16x32_bf16 v[100:103], v[32:35], a[216:219], v[132:135]
    v_add_f32 v7, v7, v18
    v_fma_f32 v234, v234, v48, v50
    v_mfma_f32_16x16x32_bf16 v[100:103], v[36:39], a[220:223], v[100:103]
    s_add_u32 s35, s35, 196608
    s_mov_b32 m0, s26
    v_add_f32 v7, v7, v19
    v_mfma_f32_16x16x32_bf16 v[104:107], v[32:35], a[240:243], v[136:139]
    s_add_u32 s16, s16, 196608
    ds_read_b128 v[28:31], v3 offset:6272
    v_fma_f32 v235, v235, v49, v51
    v_mfma_f32_16x16x32_bf16 v[104:107], v[36:39], a[244:247], v[104:107]
    s_add_u32 s17, s17, 196608
    buffer_load_dwordx4 v4, s[4:7], s32 offen offset:0 sc1 lds
    v_mfma_f32_16x16x32_bf16 v[108:111], v[32:35], v[200:203], v[140:143]
    v_exp_f32 v17, v121
    v_mfma_f32_16x16x32_bf16 v[108:111], v[36:39], v[204:207], v[108:111]
    s_waitcnt lgkmcnt(2)
    v_cvt_pk_bf16_f32 v185, v18, v19
    v_cvt_pk_bf16_f32 v233, v234, v235
    v_mfma_f32_16x16x32_bf16 v[64:67], v[40:43], a[200:203], v[64:67]
    s_add_u32 s37, s37, 512
    ds_read_b128 v[32:35], v2 offset:256
    v_mfma_f32_16x16x32_bf16 v[64:67], v[44:47], a[204:207], v[64:67]
    v_exp_f32 v18, v122
    v_mfma_f32_16x16x32_bf16 v[68:71], v[40:43], a[224:227], v[68:71]
    v_add_f32 v7, v7, v16
    v_add_f32 v7, v7, v17
    v_mfma_f32_16x16x32_bf16 v[68:71], v[44:47], a[228:231], v[68:71]
    v_exp_f32 v19, v123
    v_mfma_f32_16x16x32_bf16 v[72:75], v[40:43], a[248:251], v[72:75]
    ds_read_b128 v[36:39], v3 offset:256
    v_cvt_pk_bf16_f32 v186, v16, v17
    v_mfma_f32_16x16x32_bf16 v[72:75], v[44:47], a[252:255], v[72:75]
    buffer_load_dwordx4 v4, s[4:7], s32 offen offset:1024 sc1 lds
    v_mfma_f32_16x16x32_bf16 v[76:79], v[40:43], v[208:211], v[76:79]
    v_exp_f32 v16, v188
    v_mfma_f32_16x16x32_bf16 v[76:79], v[44:47], v[212:215], v[76:79]
    s_waitcnt lgkmcnt(2)
    v_add_f32 v7, v7, v18
    v_add_f32 v7, v7, v19
    v_mfma_f32_16x16x32_bf16 v[96:99], v[24:27], a[200:203], v[96:99]
    ds_read_b128 v[40:43], v2 offset:6400
    v_cvt_f32_i32 v238, v238
    v_mfma_f32_16x16x32_bf16 v[96:99], v[28:31], a[204:207], v[96:99]
    buffer_load_dwordx2 v[56:57], off, s[80:83], s37 offset:0
    v_mfma_f32_16x16x32_bf16 v[100:103], v[24:27], a[224:227], v[100:103]
    v_exp_f32 v17, v189
    v_mfma_f32_16x16x32_bf16 v[100:103], v[28:31], a[228:231], v[100:103]
    v_cvt_pk_bf16_f32 v187, v18, v19
    v_cvt_f32_i32 v239, v239
    v_mfma_f32_16x16x32_bf16 v[104:107], v[24:27], a[248:251], v[104:107]
    ds_read_b128 v[44:47], v3 offset:6400
    v_mfma_f32_16x16x32_bf16 v[104:107], v[28:31], a[252:255], v[104:107]
    buffer_load_dwordx2 v[58:59], off, s[84:87], s37 offset:0
    v_mfma_f32_16x16x32_bf16 v[108:111], v[24:27], v[208:211], v[108:111]
    s_add_u32 s29, s30, 49152
    v_exp_f32 v18, v190
    v_mfma_f32_16x16x32_bf16 v[108:111], v[28:31], v[212:215], v[108:111]
    s_waitcnt lgkmcnt(2)
    v_add_f32 v8, v8, v16
    v_add_f32 v8, v8, v17
    v_mfma_f32_16x16x32_bf16 v[64:67], v[32:35], a[208:211], v[64:67]
    s_sub_u32 s3, s29, 147456
    ds_read_b128 v[24:27], v2 offset:12288
    v_mfma_f32_16x16x32_bf16 v[64:67], v[36:39], a[212:215], v[64:67]
    s_min_u32 s29, s29, s3
    buffer_load_dwordx4 v4, s[4:7], s32 offen offset:2048 sc1 lds
    v_mfma_f32_16x16x32_bf16 v[68:71], v[32:35], a[232:235], v[68:71]
    v_exp_f32 v19, v191
    v_mfma_f32_16x16x32_bf16 v[68:71], v[36:39], a[236:239], v[68:71]
    v_cvt_pk_bf16_f32 v188, v16, v17
    v_fma_f32 v238, v238, v48, v50
    v_mfma_f32_16x16x32_bf16 v[72:75], v[32:35], v[192:195], v[72:75]
    ds_read_b128 v[28:31], v3 offset:12288
    v_mfma_f32_16x16x32_bf16 v[72:75], v[36:39], v[196:199], v[72:75]
    buffer_load_dwordx3 v[144:146], v12, s[68:71], s35 offen offset:0 nt
    v_mfma_f32_16x16x32_bf16 v[76:79], v[32:35], v[216:219], v[76:79]
    v_exp_f32 v16, v124
    v_mfma_f32_16x16x32_bf16 v[76:79], v[36:39], v[220:223], v[76:79]
    s_waitcnt lgkmcnt(2)
    v_add_f32 v8, v8, v18
    v_add_f32 v8, v8, v19
    v_mfma_f32_16x16x32_bf16 v[96:99], v[40:43], a[208:211], v[96:99]
    s_add_u32 s32, s32, 24576
    ds_read_b128 v[32:35], v2 offset:18432
    v_fma_f32 v239, v239, v49, v51
    v_mfma_f32_16x16x32_bf16 v[96:99], v[44:47], a[212:215], v[96:99]
    s_sub_u32 s3, s29, s30
    v_exp_f32 v17, v125
    v_mfma_f32_16x16x32_bf16 v[100:103], v[40:43], a[232:235], v[100:103]
    v_cvt_pk_bf16_f32 v189, v18, v19
    v_mfma_f32_16x16x32_bf16 v[100:103], v[44:47], a[236:239], v[100:103]
    v_exp_f32 v18, v126
    v_mfma_f32_16x16x32_bf16 v[104:107], v[40:43], v[192:195], v[104:107]
    s_add_u32 s26, s26, 12288
    ds_read_b128 v[36:39], v3 offset:18432
    v_add_f32 v8, v8, v16
    v_mfma_f32_16x16x32_bf16 v[104:107], v[44:47], v[196:199], v[104:107]
    buffer_load_dwordx3 v[148:150], v12, s[68:71], s35 offen offset:768 nt
    v_mfma_f32_16x16x32_bf16 v[108:111], v[40:43], v[216:219], v[108:111]
    v_add_f32 v8, v8, v17
    v_cvt_pk_bf16_f32 v237, v238, v239
    v_mfma_f32_16x16x32_bf16 v[108:111], v[44:47], v[220:223], v[108:111]
    s_waitcnt lgkmcnt(2)
    v_exp_f32 v19, v127
    v_mfma_f32_16x16x32_bf16 v[80:83], v[24:27], a[192:195], v[128:131]
    ds_read_b128 v[40:43], v2 offset:12416
    v_cvt_pk_bf16_f32 v190, v16, v17
    v_mfma_f32_16x16x32_bf16 v[80:83], v[28:31], a[196:199], v[80:83]
    s_mov_b32 m0, s26
    v_add_f32 v8, v8, v18
    v_add_f32 v8, v8, v19
    v_mfma_f32_16x16x32_bf16 v[84:87], v[24:27], a[216:219], v[132:135]
    s_mov_b32 s30, s29
    v_cvt_pk_bf16_f32 v191, v18, v19
    v_mfma_f32_16x16x32_bf16 v[84:87], v[28:31], a[220:223], v[84:87]
    v_exp_f32 v16, v64
    v_mfma_f32_16x16x32_bf16 v[88:91], v[24:27], a[240:243], v[136:139]
    ds_read_b128 v[44:47], v3 offset:12416
    v_mfma_f32_16x16x32_bf16 v[88:91], v[28:31], a[244:247], v[88:91]
    buffer_load_dwordx3 v[152:154], v12, s[68:71], s35 offen offset:1536 nt
    v_mfma_f32_16x16x32_bf16 v[92:95], v[24:27], v[200:203], v[140:143]
    v_exp_f32 v17, v65
    v_mfma_f32_16x16x32_bf16 v[92:95], v[28:31], v[204:207], v[92:95]
    s_waitcnt lgkmcnt(2)
    v_exp_f32 v18, v66
    v_mfma_f32_16x16x32_bf16 v[112:115], v[32:35], a[192:195], v[128:131]
    ds_read_b128 v[24:27], v2 offset:18560
    v_add_f32 v5, v5, v16
    v_mfma_f32_16x16x32_bf16 v[112:115], v[36:39], a[196:199], v[112:115]
    buffer_load_dwordx4 v4, s[4:7], s32 offen offset:0 sc1 lds
    v_mfma_f32_16x16x32_bf16 v[116:119], v[32:35], a[216:219], v[132:135]
    v_add_f32 v5, v5, v17
    v_add_u32 v1, s3, v1
    v_mfma_f32_16x16x32_bf16 v[116:119], v[36:39], a[220:223], v[116:119]
    v_exp_f32 v19, v67
    v_mfma_f32_16x16x32_bf16 v[120:123], v[32:35], a[240:243], v[136:139]
    ds_read_b128 v[28:31], v3 offset:18560
    v_cvt_pk_bf16_f32 v64, v16, v17
    v_mfma_f32_16x16x32_bf16 v[120:123], v[36:39], a[244:247], v[120:123]
    s_waitcnt vmcnt(13)
    buffer_load_dwordx3 v[156:158], v12, s[68:71], s35 offen offset:2304 nt
    v_mfma_f32_16x16x32_bf16 v[124:127], v[32:35], v[200:203], v[140:143]
    v_exp_f32 v16, v96
    v_mfma_f32_16x16x32_bf16 v[124:127], v[36:39], v[204:207], v[124:127]
    s_waitcnt lgkmcnt(2)
    v_add_f32 v5, v5, v18
    v_add_f32 v5, v5, v19
    v_mfma_f32_16x16x32_bf16 v[80:83], v[40:43], a[200:203], v[80:83]
    ds_read_b128 v[32:35], v2 offset:12544
    v_lshlrev_b32 v48, 16, v60
    v_mfma_f32_16x16x32_bf16 v[80:83], v[44:47], a[204:207], v[80:83]
    v_exp_f32 v17, v97
    v_mfma_f32_16x16x32_bf16 v[84:87], v[40:43], a[224:227], v[84:87]
    v_cvt_pk_bf16_f32 v65, v18, v19
    v_and_b32 v49, s97, v60
    v_mfma_f32_16x16x32_bf16 v[84:87], v[44:47], a[228:231], v[84:87]
    buffer_load_dwordx4 v4, s[4:7], s32 offen offset:1024 sc1 lds
    v_mfma_f32_16x16x32_bf16 v[88:91], v[40:43], a[248:251], v[88:91]
    ds_read_b128 v[36:39], v3 offset:12544
    v_lshlrev_b32 v50, 16, v62
    v_mfma_f32_16x16x32_bf16 v[88:91], v[44:47], a[252:255], v[88:91]
    v_exp_f32 v18, v98
    v_mfma_f32_16x16x32_bf16 v[92:95], v[40:43], v[208:211], v[92:95]
    v_add_f32 v5, v5, v16
    v_add_f32 v5, v5, v17
    v_mfma_f32_16x16x32_bf16 v[92:95], v[44:47], v[212:215], v[92:95]
    s_waitcnt lgkmcnt(2)
    v_exp_f32 v19, v99
    v_mfma_f32_16x16x32_bf16 v[112:115], v[24:27], a[200:203], v[112:115]
    ds_read_b128 v[40:43], v2 offset:18688
    v_cvt_pk_bf16_f32 v66, v16, v17
    v_mfma_f32_16x16x32_bf16 v[112:115], v[28:31], a[204:207], v[112:115]
    v_exp_f32 v16, v68
    v_mfma_f32_16x16x32_bf16 v[116:119], v[24:27], a[224:227], v[116:119]
    v_add_f32 v5, v5, v18
    v_add_f32 v5, v5, v19
    v_mfma_f32_16x16x32_bf16 v[116:119], v[28:31], a[228:231], v[116:119]
    v_exp_f32 v17, v69
    v_mfma_f32_16x16x32_bf16 v[120:123], v[24:27], a[248:251], v[120:123]
    ds_read_b128 v[44:47], v3 offset:18688
    v_cvt_pk_bf16_f32 v67, v18, v19
    v_mfma_f32_16x16x32_bf16 v[120:123], v[28:31], a[252:255], v[120:123]
    s_waitcnt lgkmcnt(2)
    buffer_load_dwordx4 v4, s[4:7], s32 offen offset:2048 sc1 lds
    v_mfma_f32_16x16x32_bf16 v[124:127], v[24:27], v[208:211], v[124:127]
    s_waitcnt vmcnt(13)
    v_exp_f32 v18, v70
    v_mfma_f32_16x16x32_bf16 v[124:127], v[28:31], v[212:215], v[124:127]
    s_barrier
    v_add_f32 v6, v6, v16
    v_mfma_f32_16x16x32_bf16 v[80:83], v[32:35], a[208:211], v[80:83]
    ds_read_b128 v[24:27], v1 offset:0
    v_add_f32 v6, v6, v17
    v_mfma_f32_16x16x32_bf16 v[80:83], v[36:39], a[212:215], v[80:83]
    v_exp_f32 v19, v71
    v_mfma_f32_16x16x32_bf16 v[84:87], v[32:35], a[232:235], v[84:87]
    v_cvt_pk_bf16_f32 v68, v16, v17
    v_and_b32 v51, s97, v62
    v_mfma_f32_16x16x32_bf16 v[84:87], v[36:39], a[236:239], v[84:87]
    v_exp_f32 v16, v100
    v_mfma_f32_16x16x32_bf16 v[88:91], v[32:35], v[192:195], v[88:91]
    ds_read_b128 v[28:31], v1 offset:12288
    v_add_f32 v6, v6, v18
    v_mfma_f32_16x16x32_bf16 v[88:91], v[36:39], v[196:199], v[88:91]
    v_add_f32 v6, v6, v19
    v_mul_f32 v48, s38, v48
    v_mfma_f32_16x16x32_bf16 v[92:95], v[32:35], v[216:219], v[92:95]
    v_exp_f32 v17, v101
    v_mfma_f32_16x16x32_bf16 v[92:95], v[36:39], v[220:223], v[92:95]
    s_waitcnt lgkmcnt(2)
    v_cvt_pk_bf16_f32 v69, v18, v19
    v_mul_f32 v49, s38, v49
    v_mfma_f32_16x16x32_bf16 v[112:115], v[40:43], a[208:211], v[112:115]
    ds_read_b128 v[32:35], v1 offset:1024
    v_mfma_f32_16x16x32_bf16 v[112:115], v[44:47], a[212:215], v[112:115]
    v_exp_f32 v18, v102
    v_mfma_f32_16x16x32_bf16 v[116:119], v[40:43], a[232:235], v[116:119]
    v_add_f32 v6, v6, v16
    v_add_f32 v6, v6, v17
    v_mfma_f32_16x16x32_bf16 v[116:119], v[44:47], a[236:239], v[116:119]
    v_exp_f32 v19, v103
    v_mfma_f32_16x16x32_bf16 v[120:123], v[40:43], v[192:195], v[120:123]
    ds_read_b128 v[36:39], v1 offset:13312
    v_cvt_pk_bf16_f32 v70, v16, v17
    v_mfma_f32_16x16x32_bf16 v[120:123], v[44:47], v[196:199], v[120:123]
    s_add_u32 s32, s32, 24576
    v_add_f32 v6, v6, v18
    s_add_u32 s26, s26, 36864
    v_mfma_f32_16x16x32_bf16 v[124:127], v[40:43], v[216:219], v[124:127]
    s_sub_u32 s57, s26, 147456
    v_add_f32 v6, v6, v19
    v_cvt_pk_bf16_f32 v71, v18, v19
    v_mfma_f32_16x16x32_bf16 v[124:127], v[44:47], v[220:223], v[124:127]
    s_waitcnt lgkmcnt(2)
    s_min_u32 s26, s26, s57
    v_mfma_f32_16x16x32_bf16 a[0:3], v[160:163], v[24:27], a[0:3]
    ds_read_b128 v[40:43], v1 offset:2048
    v_mul_f32_e64 v50, -v50, v48
    v_mfma_f32_16x16x32_bf16 a[0:3], v[176:179], v[28:31], a[0:3]
    s_waitcnt vmcnt(12)
    v_subrev_u32 v52, s92, v52
    v_cmp_lt_u32 vcc, 15, v52
    v_mfma_f32_16x16x32_bf16 a[48:51], v[164:167], v[24:27], a[48:51]
    v_exp_f32 v16, v72
    v_mfma_f32_16x16x32_bf16 a[48:51], v[180:183], v[28:31], a[48:51]
    v_exp_f32 v17, v73
    v_mfma_f32_16x16x32_bf16 a[96:99], v[168:171], v[24:27], a[96:99]
    s_and_b32 s59, vcc_lo, 0xff
    ds_read_b128 v[44:47], v1 offset:14336
    v_mul_f32_e64 v51, -v51, v49
    v_mfma_f32_16x16x32_bf16 a[96:99], v[184:187], v[28:31], a[96:99]
    s_cbranch_scc1 L_pollslow2
L_pollok2:
    v_mfma_f32_16x16x32_bf16 a[144:147], v[172:175], v[24:27], a[144:147]
    s_add_u32 s92, s92, 1
    v_exp_f32 v18, v74
    v_mfma_f32_16x16x32_bf16 a[144:147], v[188:191], v[28:31], a[144:147]
    s_waitcnt lgkmcnt(2)
    v_add_f32 v7, v7, v16
    v_add_f32 v7, v7, v17
    v_mfma_f32_16x16x32_bf16 a[4:7], v[160:163], v[32:35], a[4:7]
    s_mov_b32 m0, s56
    ds_read_b128 v[24:27], v1 offset:3072
    v_cvt_f32_i32 v240, v240
    v_mfma_f32_16x16x32_bf16 a[4:7], v[176:179], v[36:39], a[4:7]
    buffer_load_dwordx4 v4, s[4:7], s27 offen offset:0 sc1 lds
    v_mfma_f32_16x16x32_bf16 a[52:55], v[164:167], v[32:35], a[52:55]
    v_exp_f32 v19, v75
    v_mfma_f32_16x16x32_bf16 a[52:55], v[180:183], v[36:39], a[52:55]
    v_cvt_pk_bf16_f32 v72, v16, v17
    v_cvt_f32_i32 v241, v241
    v_mfma_f32_16x16x32_bf16 a[100:103], v[168:171], v[32:35], a[100:103]
    ds_read_b128 v[28:31], v1 offset:15360
    v_fma_f32 v240, v240, v48, v50
    v_mfma_f32_16x16x32_bf16 a[100:103], v[184:187], v[36:39], a[100:103]
    v_exp_f32 v16, v104
    v_mfma_f32_16x16x32_bf16 a[148:151], v[172:175], v[32:35], a[148:151]
    v_add_f32 v7, v7, v18
    v_add_f32 v7, v7, v19
    v_mfma_f32_16x16x32_bf16 a[148:151], v[188:191], v[36:39], a[148:151]
    s_waitcnt lgkmcnt(2)
    v_exp_f32 v17, v105
    v_mfma_f32_16x16x32_bf16 a[8:11], v[160:163], v[40:43], a[8:11]
    ds_read_b128 v[32:35], v1 offset:4096
    v_cvt_pk_bf16_f32 v73, v18, v19
    v_mfma_f32_16x16x32_bf16 a[8:11], v[176:179], v[44:47], a[8:11]
    buffer_load_dwordx4 v4, s[4:7], s27 offen offset:1024 sc1 lds
    v_mfma_f32_16x16x32_bf16 a[56:59], v[164:167], v[40:43], a[56:59]
    v_exp_f32 v18, v106
    v_mfma_f32_16x16x32_bf16 a[56:59], v[180:183], v[44:47], a[56:59]
    v_add_f32 v7, v7, v16
    v_fma_f32 v241, v241, v49, v51
    v_mfma_f32_16x16x32_bf16 a[104:107], v[168:171], v[40:43], a[104:107]
    ds_read_b128 v[36:39], v1 offset:16384
    v_add_f32 v7, v7, v17
    v_mfma_f32_16x16x32_bf16 a[104:107], v[184:187], v[44:47], a[104:107]
    v_exp_f32 v19, v107
    v_mfma_f32_16x16x32_bf16 a[152:155], v[172:175], v[40:43], a[152:155]
    v_cvt_pk_bf16_f32 v74, v16, v17
    v_cvt_pk_bf16_f32 v226, v240, v241
    v_mfma_f32_16x16x32_bf16 a[152:155], v[188:191], v[44:47], a[152:155]
    s_waitcnt lgkmcnt(2)
    v_exp_f32 v16, v76
    v_mfma_f32_16x16x32_bf16 a[12:15], v[160:163], v[24:27], a[12:15]
    ds_read_b128 v[40:43], v1 offset:5120
    v_add_f32 v7, v7, v18
    v_mfma_f32_16x16x32_bf16 a[12:15], v[176:179], v[28:31], a[12:15]
    buffer_load_dwordx4 v4, s[4:7], s27 offen offset:2048 sc1 lds
    v_mfma_f32_16x16x32_bf16 a[60:63], v[164:167], v[24:27], a[60:63]
    v_add_f32 v7, v7, v19
    v_cvt_f32_i32 v244, v244
    v_mfma_f32_16x16x32_bf16 a[60:63], v[180:183], v[28:31], a[60:63]
    v_exp_f32 v17, v77
    v_mfma_f32_16x16x32_bf16 a[108:111], v[168:171], v[24:27], a[108:111]
    ds_read_b128 v[44:47], v1 offset:17408
    v_cvt_pk_bf16_f32 v75, v18, v19
    v_mfma_f32_16x16x32_bf16 a[108:111], v[184:187], v[28:31], a[108:111]
    v_exp_f32 v18, v78
    v_mfma_f32_16x16x32_bf16 a[156:159], v[172:175], v[24:27], a[156:159]
    s_add_u32 s29, s28, 49152
    v_cvt_f32_i32 v245, v245
    v_fma_f32 v244, v244, v48, v50
    v_mfma_f32_16x16x32_bf16 a[156:159], v[188:191], v[28:31], a[156:159]
    s_waitcnt lgkmcnt(2)
    v_add_f32 v8, v8, v16
    v_add_f32 v8, v8, v17
    v_mfma_f32_16x16x32_bf16 a[16:19], v[160:163], v[32:35], a[16:19]
    s_sub_u32 s3, s29, 147456
    ds_read_b128 v[24:27], v1 offset:6144
    v_fma_f32 v245, v245, v49, v51
    v_mfma_f32_16x16x32_bf16 a[16:19], v[176:179], v[36:39], a[16:19]
    s_add_u32 s27, s27, 24576
    v_exp_f32 v19, v79
    v_mfma_f32_16x16x32_bf16 a[64:67], v[164:167], v[32:35], a[64:67]
    s_min_u32 s29, s29, s3
    v_cvt_pk_bf16_f32 v76, v16, v17
    v_cvt_pk_bf16_f32 v230, v244, v245
    v_mfma_f32_16x16x32_bf16 a[64:67], v[180:183], v[36:39], a[64:67]
    s_add_u32 s56, s56, 12288
    v_exp_f32 v16, v108
    v_mfma_f32_16x16x32_bf16 a[112:115], v[168:171], v[32:35], a[112:115]
    ds_read_b128 v[28:31], v1 offset:18432
    v_add_f32 v8, v8, v18
    v_mfma_f32_16x16x32_bf16 a[112:115], v[184:187], v[36:39], a[112:115]
    v_add_f32 v8, v8, v19
    v_cvt_f32_i32 v248, v248
    v_mfma_f32_16x16x32_bf16 a[160:163], v[172:175], v[32:35], a[160:163]
    v_exp_f32 v17, v109
    v_mfma_f32_16x16x32_bf16 a[160:163], v[188:191], v[36:39], a[160:163]
    s_waitcnt lgkmcnt(2)
    v_cvt_f32_i32 v249, v249
    v_cvt_pk_bf16_f32 v77, v18, v19
    v_mfma_f32_16x16x32_bf16 a[20:23], v[160:163], v[40:43], a[20:23]
    s_mov_b32 m0, s56
    ds_read_b128 v[32:35], v1 offset:7168
    v_fma_f32 v248, v248, v48, v50
    v_mfma_f32_16x16x32_bf16 a[20:23], v[176:179], v[44:47], a[20:23]
    s_sub_u32 s3, s29, s28
    v_exp_f32 v18, v110
    v_mfma_f32_16x16x32_bf16 a[68:71], v[164:167], v[40:43], a[68:71]
    v_add_f32 v8, v8, v16
    v_add_f32 v8, v8, v17
    v_mfma_f32_16x16x32_bf16 a[68:71], v[180:183], v[44:47], a[68:71]
    v_exp_f32 v19, v111
    v_mfma_f32_16x16x32_bf16 a[116:119], v[168:171], v[40:43], a[116:119]
    ds_read_b128 v[36:39], v1 offset:19456
    v_fma_f32 v249, v249, v49, v51
    v_mfma_f32_16x16x32_bf16 a[116:119], v[184:187], v[44:47], a[116:119]
    buffer_load_dwordx4 v4, s[4:7], s27 offen offset:0 sc1 lds
    v_mfma_f32_16x16x32_bf16 a[164:167], v[172:175], v[40:43], a[164:167]
    s_mov_b32 s28, s29
    v_cvt_pk_bf16_f32 v78, v16, v17
    v_add_f32 v8, v8, v18
    v_mfma_f32_16x16x32_bf16 a[164:167], v[188:191], v[44:47], a[164:167]
    s_waitcnt lgkmcnt(2)
    v_add_f32 v8, v8, v19
    v_cvt_pk_bf16_f32 v234, v248, v249
    v_mfma_f32_16x16x32_bf16 a[24:27], v[160:163], v[24:27], a[24:27]
    ds_read_b128 v[40:43], v1 offset:8192
    v_cvt_pk_bf16_f32 v79, v18, v19
    v_mfma_f32_16x16x32_bf16 a[24:27], v[176:179], v[28:31], a[24:27]
    v_exp_f32 v16, v80
    v_mfma_f32_16x16x32_bf16 a[72:75], v[164:167], v[24:27], a[72:75]
    v_cvt_f32_i32 v252, v252
    v_cvt_f32_i32 v253, v253
    v_mfma_f32_16x16x32_bf16 a[72:75], v[180:183], v[28:31], a[72:75]
    v_exp_f32 v17, v81
    v_mfma_f32_16x16x32_bf16 a[120:123], v[168:171], v[24:27], a[120:123]
    ds_read_b128 v[44:47], v1 offset:20480
    v_fma_f32 v252, v252, v48, v50
    v_mfma_f32_16x16x32_bf16 a[120:123], v[184:187], v[28:31], a[120:123]
    v_exp_f32 v18, v82
    v_mfma_f32_16x16x32_bf16 a[168:171], v[172:175], v[24:27], a[168:171]
    v_add_f32 v5, v5, v16
    v_add_f32 v5, v5, v17
    v_mfma_f32_16x16x32_bf16 a[168:171], v[188:191], v[28:31], a[168:171]
    s_waitcnt lgkmcnt(2)
    buffer_load_dwordx4 v4, s[4:7], s27 offen offset:1024 sc1 lds
    v_mfma_f32_16x16x32_bf16 a[28:31], v[160:163], v[32:35], a[28:31]
    ds_read_b128 v[24:27], v1 offset:9216
    v_fma_f32 v253, v253, v49, v51
    v_mfma_f32_16x16x32_bf16 a[28:31], v[176:179], v[36:39], a[28:31]
    v_exp_f32 v19, v83
    v_mfma_f32_16x16x32_bf16 a[76:79], v[164:167], v[32:35], a[76:79]
    v_cvt_pk_bf16_f32 v80, v16, v17
    v_cvt_pk_bf16_f32 v238, v252, v253
    v_mfma_f32_16x16x32_bf16 a[76:79], v[180:183], v[36:39], a[76:79]
    v_exp_f32 v16, v112
    v_mfma_f32_16x16x32_bf16 a[124:127], v[168:171], v[32:35], a[124:127]
    ds_read_b128 v[28:31], v1 offset:21504
    v_add_f32 v5, v5, v18
    v_mfma_f32_16x16x32_bf16 a[124:127], v[184:187], v[36:39], a[124:127]
    v_add_f32 v5, v5, v19
    v_lshlrev_b32 v48, 16, v61
    v_mfma_f32_16x16x32_bf16 a[172:175], v[172:175], v[32:35], a[172:175]
    v_exp_f32 v17, v113
    v_mfma_f32_16x16x32_bf16 a[172:175], v[188:191], v[36:39], a[172:175]
    s_waitcnt lgkmcnt(2)
    buffer_load_dwordx4 v4, s[4:7], s27 offen offset:2048 sc1 lds
    v_mfma_f32_16x16x32_bf16 a[32:35], v[160:163], v[40:43], a[32:35]
    ds_read_b128 v[32:35], v1 offset:10240
    v_cvt_pk_bf16_f32 v81, v18, v19
    v_mfma_f32_16x16x32_bf16 a[32:35], v[176:179], v[44:47], a[32:35]
    v_exp_f32 v18, v114
    v_mfma_f32_16x16x32_bf16 a[80:83], v[164:167], v[40:43], a[80:83]
    v_add_f32 v5, v5, v16
    v_and_b32 v49, s97, v61
    v_mfma_f32_16x16x32_bf16 a[80:83], v[180:183], v[44:47], a[80:83]
    v_add_f32 v5, v5, v17
    v_lshlrev_b32 v50, 16, v63
    v_mfma_f32_16x16x32_bf16 a[128:131], v[168:171], v[40:43], a[128:131]
    ds_read_b128 v[36:39], v1 offset:22528
    v_add_u32 v2, s3, v2
    v_mfma_f32_16x16x32_bf16 a[128:131], v[184:187], v[44:47], a[128:131]
    v_exp_f32 v19, v115
    v_mfma_f32_16x16x32_bf16 a[176:179], v[172:175], v[40:43], a[176:179]
    v_cvt_pk_bf16_f32 v82, v16, v17
    v_and_b32 v51, s97, v63
    v_mfma_f32_16x16x32_bf16 a[176:179], v[188:191], v[44:47], a[176:179]
    s_waitcnt lgkmcnt(2)
    v_exp_f32 v16, v84
    v_mfma_f32_16x16x32_bf16 a[36:39], v[160:163], v[24:27], a[36:39]
    ds_read_b128 v[40:43], v1 offset:11264
    v_add_f32 v5, v5, v18
    v_mfma_f32_16x16x32_bf16 a[36:39], v[176:179], v[28:31], a[36:39]
    v_add_f32 v5, v5, v19
    v_mul_f32 v48, s38, v48
    v_mfma_f32_16x16x32_bf16 a[84:87], v[164:167], v[24:27], a[84:87]
    v_exp_f32 v17, v85
    v_mfma_f32_16x16x32_bf16 a[84:87], v[180:183], v[28:31], a[84:87]
    s_add_u32 s27, s27, 24576
    v_add_u32 v3, s3, v3
    v_cvt_pk_bf16_f32 v83, v18, v19
    v_mfma_f32_16x16x32_bf16 a[132:135], v[168:171], v[24:27], a[132:135]
    s_add_u32 s56, s56, 36864
    ds_read_b128 v[44:47], v1 offset:23552
    v_mul_f32 v49, s38, v49
    v_mfma_f32_16x16x32_bf16 a[132:135], v[184:187], v[28:31], a[132:135]
    s_sub_u32 s58, s56, 147456
    v_exp_f32 v18, v86
    v_mfma_f32_16x16x32_bf16 a[180:183], v[172:175], v[24:27], a[180:183]
    v_add_f32 v6, v6, v16
    v_add_f32 v6, v6, v17
    v_mfma_f32_16x16x32_bf16 a[180:183], v[188:191], v[28:31], a[180:183]
    s_waitcnt lgkmcnt(2)
    v_mul_f32_e64 v50, -v50, v48
    v_mul_f32_e64 v51, -v51, v49
    v_mfma_f32_16x16x32_bf16 a[40:43], v[160:163], v[32:35], a[40:43]
    s_min_u32 s56, s56, s58
    ds_read_b128 v[24:27], v2 offset:0
    v_cvt_f32_i32 v242, v242
    v_mfma_f32_16x16x32_bf16 a[40:43], v[176:179], v[36:39], a[40:43]
    v_exp_f32 v19, v87
    v_mfma_f32_16x16x32_bf16 a[88:91], v[164:167], v[32:35], a[88:91]
    v_cvt_pk_bf16_f32 v84, v16, v17
    v_cvt_f32_i32 v243, v243
    v_mfma_f32_16x16x32_bf16 a[88:91], v[180:183], v[36:39], a[88:91]
    v_exp_f32 v16, v116
    v_mfma_f32_16x16x32_bf16 a[136:139], v[168:171], v[32:35], a[136:139]
    ds_read_b128 v[28:31], v3 offset:0
    v_add_f32 v6, v6, v18
    v_mfma_f32_16x16x32_bf16 a[136:139], v[184:187], v[36:39], a[136:139]
    v_add_f32 v6, v6, v19
    v_fma_f32 v242, v242, v48, v50
    v_mfma_f32_16x16x32_bf16 a[184:187], v[172:175], v[32:35], a[184:187]
    v_exp_f32 v17, v117
    v_mfma_f32_16x16x32_bf16 a[184:187], v[188:191], v[36:39], a[184:187]
    s_waitcnt lgkmcnt(2)
    v_cvt_pk_bf16_f32 v85, v18, v19
    v_fma_f32 v243, v243, v49, v51
    v_mfma_f32_16x16x32_bf16 a[44:47], v[160:163], v[40:43], a[44:47]
    ds_read_b128 v[32:35], v2 offset:6144
    v_cvt_pk_bf16_f32 v227, v242, v243
    v_mfma_f32_16x16x32_bf16 a[44:47], v[176:179], v[44:47], a[44:47]
    v_exp_f32 v18, v118
    v_mfma_f32_16x16x32_bf16 a[92:95], v[164:167], v[40:43], a[92:95]
    v_add_f32 v6, v6, v16
    v_add_f32 v6, v6, v17
    v_mfma_f32_16x16x32_bf16 a[92:95], v[180:183], v[44:47], a[92:95]
    v_exp_f32 v19, v119
    v_mfma_f32_16x16x32_bf16 a[140:143], v[168:171], v[40:43], a[140:143]
    s_sub_u32 s31, s31, 1
    ds_read_b128 v[36:39], v3 offset:6144
    v_cvt_pk_bf16_f32 v86, v16, v17
    v_mfma_f32_16x16x32_bf16 a[140:143], v[184:187], v[44:47], a[140:143]
L_pg7:
    s_cbranch_execz L_pg11
    v_add_f32 v6, v6, v18
    v_add_f32 v6, v6, v19
    v_mfma_f32_16x16x32_bf16 a[188:191], v[172:175], v[40:43], a[188:191]
    s_waitcnt lgkmcnt(2)
    s_cmp_lg_u32 s31, 0
    v_cvt_pk_bf16_f32 v87, v18, v19
    v_cvt_f32_i32 v246, v246
    v_mfma_f32_16x16x32_bf16 a[188:191], v[188:191], v[44:47], a[188:191]
    s_cbranch_scc1 L_loop
    v_mfma_f32_16x16x32_bf16 v[160:163], v[24:27], a[192:195], v[128:131]
    s_mov_b32 m0, s56
    ds_read_b128 v[40:43], v2 offset:128
    v_cvt_f32_i32 v247, v247
    v_mfma_f32_16x16x32_bf16 v[160:163], v[28:31], a[196:199], v[160:163]
    buffer_load_dwordx4 v4, s[4:7], s27 offen offset:0 sc1 lds
    v_mfma_f32_16x16x32_bf16 v[164:167], v[24:27], a[216:219], v[132:135]
    v_exp_f32 v16, v88
    v_mfma_f32_16x16x32_bf16 v[164:167], v[28:31], a[220:223], v[164:167]
    v_exp_f32 v17, v89
    v_mfma_f32_16x16x32_bf16 v[168:171], v[24:27], a[240:243], v[136:139]
    ds_read_b128 v[44:47], v3 offset:128
    v_fma_f32 v246, v246, v48, v50
    v_mfma_f32_16x16x32_bf16 v[168:171], v[28:31], a[244:247], v[168:171]
    v_exp_f32 v18, v90
    v_mfma_f32_16x16x32_bf16 v[172:175], v[24:27], v[200:203], v[140:143]
    v_fma_f32 v247, v247, v49, v51
    v_add_f32 v7, v7, v16
    v_mfma_f32_16x16x32_bf16 v[172:175], v[28:31], v[204:207], v[172:175]
    s_waitcnt lgkmcnt(2)
    v_add_f32 v7, v7, v17
    v_cvt_pk_bf16_f32 v231, v246, v247
    v_mfma_f32_16x16x32_bf16 v[96:99], v[32:35], a[192:195], v[128:131]
    ds_read_b128 v[24:27], v2 offset:6272
    v_cvt_f32_i32 v250, v250
    v_mfma_f32_16x16x32_bf16 v[96:99], v[36:39], a[196:199], v[96:99]
    buffer_load_dwordx4 v4, s[4:7], s27 offen offset:1024 sc1 lds
    v_mfma_f32_16x16x32_bf16 v[100:103], v[32:35], a[216:219], v[132:135]
    v_exp_f32 v19, v91
    v_mfma_f32_16x16x32_bf16 v[100:103], v[36:39], a[220:223], v[100:103]
    v_cvt_pk_bf16_f32 v88, v16, v17
    v_cvt_f32_i32 v251, v251
    v_mfma_f32_16x16x32_bf16 v[104:107], v[32:35], a[240:243], v[136:139]
    ds_read_b128 v[28:31], v3 offset:6272
    v_fma_f32 v250, v250, v48, v50
    v_mfma_f32_16x16x32_bf16 v[104:107], v[36:39], a[244:247], v[104:107]
    v_exp_f32 v16, v120
    v_mfma_f32_16x16x32_bf16 v[108:111], v[32:35], v[200:203], v[140:143]
    v_add_f32 v7, v7, v18
    v_add_f32 v7, v7, v19
    v_mfma_f32_16x16x32_bf16 v[108:111], v[36:39], v[204:207], v[108:111]
    s_waitcnt lgkmcnt(2)
    v_exp_f32 v17, v121
    v_mfma_f32_16x16x32_bf16 v[160:163], v[40:43], a[200:203], v[160:163]
    ds_read_b128 v[32:35], v2 offset:256
    v_cvt_pk_bf16_f32 v89, v18, v19
    v_mfma_f32_16x16x32_bf16 v[160:163], v[44:47], a[204:207], v[160:163]
    v_exp_f32 v18, v122
    v_mfma_f32_16x16x32_bf16 v[164:167], v[40:43], a[224:227], v[164:167]
    v_fma_f32 v251, v251, v49, v51
    v_add_f32 v7, v7, v16
    v_mfma_f32_16x16x32_bf16 v[164:167], v[44:47], a[228:231], v[164:167]
    buffer_load_dwordx4 v4, s[4:7], s27 offen offset:2048 sc1 lds
    v_mfma_f32_16x16x32_bf16 v[168:171], v[40:43], a[248:251], v[168:171]
    ds_read_b128 v[36:39], v3 offset:256
    v_cvt_pk_bf16_f32 v235, v250, v251
    v_mfma_f32_16x16x32_bf16 v[168:171], v[44:47], a[252:255], v[168:171]
    v_add_f32 v7, v7, v17
    v_cvt_f32_i32 v254, v254
    v_mfma_f32_16x16x32_bf16 v[172:175], v[40:43], v[208:211], v[172:175]
    v_exp_f32 v19, v123
    v_mfma_f32_16x16x32_bf16 v[172:175], v[44:47], v[212:215], v[172:175]
    s_waitcnt lgkmcnt(2)
    v_cvt_pk_bf16_f32 v90, v16, v17
    v_cvt_f32_i32 v255, v255
    v_mfma_f32_16x16x32_bf16 v[96:99], v[24:27], a[200:203], v[96:99]
    ds_read_b128 v[40:43], v2 offset:6400
    v_fma_f32 v254, v254, v48, v50
    v_mfma_f32_16x16x32_bf16 v[96:99], v[28:31], a[204:207], v[96:99]
    s_add_u32 s27, s27, 24576
    v_exp_f32 v16, v92
    v_mfma_f32_16x16x32_bf16 v[100:103], v[24:27], a[224:227], v[100:103]
    v_add_f32 v7, v7, v18
    v_add_f32 v7, v7, v19
    v_mfma_f32_16x16x32_bf16 v[100:103], v[28:31], a[228:231], v[100:103]
    v_exp_f32 v17, v93
    v_mfma_f32_16x16x32_bf16 v[104:107], v[24:27], a[248:251], v[104:107]
    ds_read_b128 v[44:47], v3 offset:6400
    v_fma_f32 v255, v255, v49, v51
    v_mfma_f32_16x16x32_bf16 v[104:107], v[28:31], a[252:255], v[104:107]
    v_cvt_pk_bf16_f32 v91, v18, v19
    v_cvt_pk_bf16_f32 v239, v254, v255
    v_mfma_f32_16x16x32_bf16 v[108:111], v[24:27], v[208:211], v[108:111]
    s_add_u32 s29, s30, 49152
    v_exp_f32 v18, v94
    v_mfma_f32_16x16x32_bf16 v[108:111], v[28:31], v[212:215], v[108:111]
    s_waitcnt lgkmcnt(2)
    v_add_f32 v8, v8, v16
    v_add_f32 v8, v8, v17
    v_mfma_f32_16x16x32_bf16 v[160:163], v[32:35], a[208:211], v[160:163]
    s_waitcnt vmcnt(11)
    ds_read_b128 v[24:27], v2 offset:12288
    v_lshlrev_b32 v48, 16, v56
    v_mfma_f32_16x16x32_bf16 v[160:163], v[36:39], a[212:215], v[160:163]
    s_sub_u32 s3, s29, 147456
    buffer_load_dwordx2 v[60:61], off, s[80:83], s37 offset:8
    v_mfma_f32_16x16x32_bf16 v[164:167], v[32:35], a[232:235], v[164:167]
    s_add_u32 s56, s56, 12288
    v_exp_f32 v19, v95
    v_mfma_f32_16x16x32_bf16 v[164:167], v[36:39], a[236:239], v[164:167]
    s_min_u32 s29, s29, s3
    v_cvt_pk_bf16_f32 v92, v16, v17
    v_and_b32 v49, s97, v56
    v_mfma_f32_16x16x32_bf16 v[168:171], v[32:35], v[192:195], v[168:171]
    s_mov_b32 m0, s56
    ds_read_b128 v[28:31], v3 offset:12288
    v_mfma_f32_16x16x32_bf16 v[168:171], v[36:39], v[196:199], v[168:171]
    buffer_load_dwordx2 v[62:63], off, s[84:87], s37 offset:8
    v_mfma_f32_16x16x32_bf16 v[172:175], v[32:35], v[216:219], v[172:175]
    v_exp_f32 v16, v124
    v_mfma_f32_16x16x32_bf16 v[172:175], v[36:39], v[220:223], v[172:175]
    s_waitcnt lgkmcnt(2)
    v_add_f32 v8, v8, v18
    v_add_f32 v8, v8, v19
    v_mfma_f32_16x16x32_bf16 v[96:99], v[40:43], a[208:211], v[96:99]
    ds_read_b128 v[32:35], v2 offset:18432
    v_lshlrev_b32 v50, 16, v58
    v_mfma_f32_16x16x32_bf16 v[96:99], v[44:47], a[212:215], v[96:99]
    s_sub_u32 s3, s29, s30
    v_exp_f32 v17, v125
    v_mfma_f32_16x16x32_bf16 v[100:103], v[40:43], a[232:235], v[100:103]
    v_cvt_pk_bf16_f32 v93, v18, v19
    v_mfma_f32_16x16x32_bf16 v[100:103], v[44:47], a[236:239], v[100:103]
    buffer_load_dwordx4 v4, s[4:7], s27 offen offset:0 sc1 lds
    v_mfma_f32_16x16x32_bf16 v[104:107], v[40:43], v[192:195], v[104:107]
    ds_read_b128 v[36:39], v3 offset:18432
    v_mfma_f32_16x16x32_bf16 v[104:107], v[44:47], v[196:199], v[104:107]
    v_exp_f32 v18, v126
    v_mfma_f32_16x16x32_bf16 v[108:111], v[40:43], v[216:219], v[108:111]
    v_add_f32 v8, v8, v16
    v_add_f32 v8, v8, v17
    v_mfma_f32_16x16x32_bf16 v[108:111], v[44:47], v[220:223], v[108:111]
    s_waitcnt lgkmcnt(2)
    buffer_load_dwordx3 v[240:242], v12, s[68:71], s16 offen offset:0 nt
    v_mfma_f32_16x16x32_bf16 v[176:179], v[24:27], a[192:195], v[128:131]
    ds_read_b128 v[40:43], v2 offset:12416
    v_and_b32 v51, s97, v58
    v_mfma_f32_16x16x32_bf16 v[176:179], v[28:31], a[196:199], v[176:179]
    v_exp_f32 v19, v127
    v_cvt_pk_bf16_f32 v94, v16, v17
    v_mfma_f32_16x16x32_bf16 v[180:183], v[24:27], a[216:219], v[132:135]
    s_mov_b32 s30, s29
    v_add_f32 v8, v8, v18
    v_add_f32 v8, v8, v19
    v_mfma_f32_16x16x32_bf16 v[180:183], v[28:31], a[220:223], v[180:183]
    buffer_load_dwordx4 v4, s[4:7], s27 offen offset:1024 sc1 lds
    v_mfma_f32_16x16x32_bf16 v[184:187], v[24:27], a[240:243], v[136:139]
    ds_read_b128 v[44:47], v3 offset:12416
    v_cvt_pk_bf16_f32 v95, v18, v19
    v_mfma_f32_16x16x32_bf16 v[184:187], v[28:31], a[244:247], v[184:187]
    v_exp_f32 v16, v160
    v_mfma_f32_16x16x32_bf16 v[188:191], v[24:27], v[200:203], v[140:143]
    v_exp_f32 v17, v161
    v_mfma_f32_16x16x32_bf16 v[188:191], v[28:31], v[204:207], v[188:191]
    s_waitcnt lgkmcnt(2)
    buffer_load_dwordx3 v[244:246], v12, s[68:71], s16 offen offset:768 nt
    v_mfma_f32_16x16x32_bf16 v[112:115], v[32:35], a[192:195], v[128:131]
    ds_read_b128 v[24:27], v2 offset:18560
    v_mul_f32_e64 v50, -v50, v48
    v_mfma_f32_16x16x32_bf16 v[112:115], v[36:39], a[196:199], v[112:115]
    v_exp_f32 v18, v162
    v_mfma_f32_16x16x32_bf16 v[116:119], v[32:35], a[216:219], v[132:135]
    v_add_f32 v5, v5, v16
    v_add_f32 v5, v5, v17
    v_mfma_f32_16x16x32_bf16 v[116:119], v[36:39], a[220:223], v[116:119]
    v_exp_f32 v19, v163
    v_mfma_f32_16x16x32_bf16 v[120:123], v[32:35], a[240:243], v[136:139]
    ds_read_b128 v[28:31], v3 offset:18560
    v_cvt_pk_bf16_f32 v160, v16, v17
    v_mfma_f32_16x16x32_bf16 v[120:123], v[36:39], a[244:247], v[120:123]
    buffer_load_dwordx3 v[248:250], v12, s[68:71], s16 offen offset:1536 nt
    v_mfma_f32_16x16x32_bf16 v[124:127], v[32:35], v[200:203], v[140:143]
    v_exp_f32 v16, v96
    v_mfma_f32_16x16x32_bf16 v[124:127], v[36:39], v[204:207], v[124:127]
    s_waitcnt lgkmcnt(2)
    v_add_f32 v5, v5, v18
    v_add_f32 v5, v5, v19
    v_mfma_f32_16x16x32_bf16 v[176:179], v[40:43], a[200:203], v[176:179]
    ds_read_b128 v[32:35], v2 offset:12544
    v_mul_f32_e64 v51, -v51, v49
    v_mfma_f32_16x16x32_bf16 v[176:179], v[44:47], a[204:207], v[176:179]
    buffer_load_dwordx4 v4, s[4:7], s27 offen offset:2048 sc1 lds
    v_mfma_f32_16x16x32_bf16 v[180:183], v[40:43], a[224:227], v[180:183]
    v_exp_f32 v17, v97
    v_mfma_f32_16x16x32_bf16 v[180:183], v[44:47], a[228:231], v[180:183]
    v_cvt_pk_bf16_f32 v161, v18, v19
    v_add_u32 v1, s3, v1
    v_mfma_f32_16x16x32_bf16 v[184:187], v[40:43], a[248:251], v[184:187]
    ds_read_b128 v[36:39], v3 offset:12544
    v_cvt_f32_i32 v144, v144
    v_mfma_f32_16x16x32_bf16 v[184:187], v[44:47], a[252:255], v[184:187]
    buffer_load_dwordx3 v[252:254], v12, s[68:71], s16 offen offset:2304 nt
    v_mfma_f32_16x16x32_bf16 v[188:191], v[40:43], v[208:211], v[188:191]
    v_exp_f32 v18, v98
    v_mfma_f32_16x16x32_bf16 v[188:191], v[44:47], v[212:215], v[188:191]
    s_waitcnt lgkmcnt(2)
    v_add_f32 v5, v5, v16
    v_add_f32 v5, v5, v17
    v_mfma_f32_16x16x32_bf16 v[112:115], v[24:27], a[200:203], v[112:115]
    ds_read_b128 v[40:43], v2 offset:18688
    v_cvt_f32_i32 v148, v148
    v_mfma_f32_16x16x32_bf16 v[112:115], v[28:31], a[204:207], v[112:115]
    v_exp_f32 v19, v99
    v_cvt_pk_bf16_f32 v162, v16, v17
    v_mfma_f32_16x16x32_bf16 v[116:119], v[24:27], a[224:227], v[116:119]
    v_exp_f32 v16, v164
    v_mfma_f32_16x16x32_bf16 v[116:119], v[28:31], a[228:231], v[116:119]
    s_add_u32 s27, s27, 24576
    v_add_f32 v5, v5, v18
    v_add_f32 v5, v5, v19
    v_mfma_f32_16x16x32_bf16 v[120:123], v[24:27], a[248:251], v[120:123]
    s_add_u32 s56, s56, 36864
    ds_read_b128 v[44:47], v3 offset:18688
    v_fma_f32 v144, v144, v48, v50
    v_mfma_f32_16x16x32_bf16 v[120:123], v[28:31], a[252:255], v[120:123]
    s_waitcnt lgkmcnt(2)
    v_exp_f32 v17, v165
    v_mfma_f32_16x16x32_bf16 v[124:127], v[24:27], v[208:211], v[124:127]
    s_waitcnt vmcnt(12)
    v_cvt_pk_bf16_f32 v163, v18, v19
    s_sub_u32 s58, s56, 147456
    v_mfma_f32_16x16x32_bf16 v[124:127], v[28:31], v[212:215], v[124:127]
    s_barrier
    s_min_u32 s56, s56, s58
    v_mfma_f32_16x16x32_bf16 v[176:179], v[32:35], a[208:211], v[176:179]
    ds_read_b128 v[24:27], v1 offset:0
    v_mfma_f32_16x16x32_bf16 v[176:179], v[36:39], a[212:215], v[176:179]
    v_exp_f32 v18, v166
    v_mfma_f32_16x16x32_bf16 v[180:183], v[32:35], a[232:235], v[180:183]
    v_add_f32 v6, v6, v16
    v_add_f32 v6, v6, v17
    v_mfma_f32_16x16x32_bf16 v[180:183], v[36:39], a[236:239], v[180:183]
    v_exp_f32 v19, v167
    v_mfma_f32_16x16x32_bf16 v[184:187], v[32:35], v[192:195], v[184:187]
    ds_read_b128 v[28:31], v1 offset:12288
    v_cvt_pk_bf16_f32 v164, v16, v17
    v_mfma_f32_16x16x32_bf16 v[184:187], v[36:39], v[196:199], v[184:187]
    v_exp_f32 v16, v100
    v_mfma_f32_16x16x32_bf16 v[188:191], v[32:35], v[216:219], v[188:191]
    v_add_f32 v6, v6, v18
    v_add_f32 v6, v6, v19
    v_mfma_f32_16x16x32_bf16 v[188:191], v[36:39], v[220:223], v[188:191]
    s_waitcnt lgkmcnt(2)
    v_exp_f32 v17, v101
    v_mfma_f32_16x16x32_bf16 v[112:115], v[40:43], a[208:211], v[112:115]
    ds_read_b128 v[32:35], v1 offset:1024
    v_cvt_pk_bf16_f32 v165, v18, v19
    v_mfma_f32_16x16x32_bf16 v[112:115], v[44:47], a[212:215], v[112:115]
    v_exp_f32 v18, v102
    v_mfma_f32_16x16x32_bf16 v[116:119], v[40:43], a[232:235], v[116:119]
    v_add_f32 v6, v6, v16
    v_add_f32 v6, v6, v17
    v_mfma_f32_16x16x32_bf16 v[116:119], v[44:47], a[236:239], v[116:119]
    v_exp_f32 v19, v103
    v_mfma_f32_16x16x32_bf16 v[120:123], v[40:43], v[192:195], v[120:123]
    ds_read_b128 v[36:39], v1 offset:13312
    v_cvt_pk_bf16_f32 v166, v16, v17
    v_mfma_f32_16x16x32_bf16 v[120:123], v[44:47], v[196:199], v[120:123]
    v_add_f32 v6, v6, v18
    v_fma_f32 v148, v148, v49, v51
    v_mfma_f32_16x16x32_bf16 v[124:127], v[40:43], v[216:219], v[124:127]
    v_add_f32 v6, v6, v19
    v_cvt_pk_bf16_f32 v167, v18, v19
    v_mfma_f32_16x16x32_bf16 v[124:127], v[44:47], v[220:223], v[124:127]
    s_waitcnt lgkmcnt(2)
    v_mfma_f32_16x16x32_bf16 a[0:3], v[64:67], v[24:27], a[0:3]
    ds_read_b128 v[40:43], v1 offset:2048
    v_cvt_f32_i32 v145, v145
    v_mfma_f32_16x16x32_bf16 a[0:3], v[80:83], v[28:31], a[0:3]
    buffer_store_dwordx4 v[224:227], v11, s[4:7], s33 offen offset:0 sc1
    v_mfma_f32_16x16x32_bf16 a[48:51], v[68:71], v[24:27], a[48:51]
    v_exp_f32 v16, v168
    v_mfma_f32_16x16x32_bf16 a[48:51], v[84:87], v[28:31], a[48:51]
    v_exp_f32 v17, v169
    v_mfma_f32_16x16x32_bf16 a[96:99], v[72:75], v[24:27], a[96:99]
    ds_read_b128 v[44:47], v1 offset:14336
    v_cvt_f32_i32 v149, v149
    v_mfma_f32_16x16x32_bf16 a[96:99], v[88:91], v[28:31], a[96:99]
    v_exp_f32 v18, v170
    v_mfma_f32_16x16x32_bf16 a[144:147], v[76:79], v[24:27], a[144:147]
    v_add_f32 v7, v7, v16
    v_add_f32 v7, v7, v17
    v_mfma_f32_16x16x32_bf16 a[144:147], v[92:95], v[28:31], a[144:147]
    s_waitcnt lgkmcnt(2)
    v_exp_f32 v19, v171
    v_mfma_f32_16x16x32_bf16 a[4:7], v[64:67], v[32:35], a[4:7]
    ds_read_b128 v[24:27], v1 offset:3072
    v_cvt_pk_bf16_f32 v168, v16, v17
    v_mfma_f32_16x16x32_bf16 a[4:7], v[80:83], v[36:39], a[4:7]
    buffer_store_dwordx4 v[228:231], v21, s[4:7], s33 offen offset:768 sc1
    v_mfma_f32_16x16x32_bf16 a[52:55], v[68:71], v[32:35], a[52:55]
    v_exp_f32 v16, v104
    v_mfma_f32_16x16x32_bf16 a[52:55], v[84:87], v[36:39], a[52:55]
    v_add_f32 v7, v7, v18
    v_fma_f32 v145, v145, v48, v50
    v_mfma_f32_16x16x32_bf16 a[100:103], v[72:75], v[32:35], a[100:103]
    ds_read_b128 v[28:31], v1 offset:15360
    v_add_f32 v7, v7, v19
    v_mfma_f32_16x16x32_bf16 a[100:103], v[88:91], v[36:39], a[100:103]
    v_exp_f32 v17, v105
    v_mfma_f32_16x16x32_bf16 a[148:151], v[76:79], v[32:35], a[148:151]
    v_cvt_pk_bf16_f32 v169, v18, v19
    v_fma_f32 v149, v149, v49, v51
    v_mfma_f32_16x16x32_bf16 a[148:151], v[92:95], v[36:39], a[148:151]
    s_waitcnt lgkmcnt(2)
    v_exp_f32 v18, v106
    v_mfma_f32_16x16x32_bf16 a[8:11], v[64:67], v[40:43], a[8:11]
    ds_read_b128 v[32:35], v1 offset:4096
    v_add_f32 v7, v7, v16
    v_mfma_f32_16x16x32_bf16 a[8:11], v[80:83], v[44:47], a[8:11]
    buffer_store_dwordx4 v[232:235], v22, s[4:7], s33 offen offset:1536 sc1
    v_mfma_f32_16x16x32_bf16 a[56:59], v[68:71], v[40:43], a[56:59]
    v_add_f32 v7, v7, v17
    v_cvt_f32_i32 v146, v146
    v_mfma_f32_16x16x32_bf16 a[56:59], v[84:87], v[44:47], a[56:59]
    v_exp_f32 v19, v107
    v_mfma_f32_16x16x32_bf16 a[104:107], v[72:75], v[40:43], a[104:107]
    ds_read_b128 v[36:39], v1 offset:16384
    v_cvt_pk_bf16_f32 v170, v16, v17
    v_mfma_f32_16x16x32_bf16 a[104:107], v[88:91], v[44:47], a[104:107]
    v_exp_f32 v16, v172
    v_mfma_f32_16x16x32_bf16 a[152:155], v[76:79], v[40:43], a[152:155]
    v_add_f32 v7, v7, v18
    v_cvt_f32_i32 v150, v150
    v_mfma_f32_16x16x32_bf16 a[152:155], v[92:95], v[44:47], a[152:155]
    s_waitcnt lgkmcnt(2)
    v_add_f32 v7, v7, v19
    v_fma_f32 v146, v146, v48, v50
    v_mfma_f32_16x16x32_bf16 a[12:15], v[64:67], v[24:27], a[12:15]
    ds_read_b128 v[40:43], v1 offset:5120
    v_mfma_f32_16x16x32_bf16 a[12:15], v[80:83], v[28:31], a[12:15]
    buffer_store_dwordx4 v[236:239], v23, s[4:7], s33 offen offset:2304 sc1
    v_mfma_f32_16x16x32_bf16 a[60:63], v[68:71], v[24:27], a[60:63]
    v_exp_f32 v17, v173
    v_mfma_f32_16x16x32_bf16 a[60:63], v[84:87], v[28:31], a[60:63]
    v_cvt_pk_bf16_f32 v171, v18, v19
    v_fma_f32 v150, v150, v49, v51
    v_mfma_f32_16x16x32_bf16 a[108:111], v[72:75], v[24:27], a[108:111]
    ds_read_b128 v[44:47], v1 offset:17408
    v_mfma_f32_16x16x32_bf16 a[108:111], v[88:91], v[28:31], a[108:111]
    v_exp_f32 v18, v174
    v_mfma_f32_16x16x32_bf16 a[156:159], v[76:79], v[24:27], a[156:159]
    s_add_u32 s29, s28, 49152
    v_add_f32 v8, v8, v16
    v_add_f32 v8, v8, v17
    v_mfma_f32_16x16x32_bf16 a[156:159], v[92:95], v[28:31], a[156:159]
    s_waitcnt lgkmcnt(2)
    v_exp_f32 v19, v175
    v_mfma_f32_16x16x32_bf16 a[16:19], v[64:67], v[32:35], a[16:19]
    s_sub_u32 s3, s29, 147456
    ds_read_b128 v[24:27], v1 offset:6144
    v_cvt_pk_bf16_f32 v172, v16, v17
    v_mfma_f32_16x16x32_bf16 a[16:19], v[80:83], v[36:39], a[16:19]
    s_mov_b32 m0, s26
    v_exp_f32 v16, v108
    v_mfma_f32_16x16x32_bf16 a[64:67], v[68:71], v[32:35], a[64:67]
    s_min_u32 s29, s29, s3
    v_add_f32 v8, v8, v18
    v_lshlrev_b32 v48, 16, v57
    v_mfma_f32_16x16x32_bf16 a[64:67], v[84:87], v[36:39], a[64:67]
    buffer_load_dwordx4 v4, s[4:7], s32 offen offset:0 sc1 lds
    v_mfma_f32_16x16x32_bf16 a[112:115], v[72:75], v[32:35], a[112:115]
    ds_read_b128 v[28:31], v1 offset:18432
    v_add_f32 v8, v8, v19
    v_mfma_f32_16x16x32_bf16 a[112:115], v[88:91], v[36:39], a[112:115]
    v_exp_f32 v17, v109
    v_mfma_f32_16x16x32_bf16 a[160:163], v[76:79], v[32:35], a[160:163]
    v_cvt_pk_bf16_f32 v173, v18, v19
    v_and_b32 v49, s97, v57
    v_mfma_f32_16x16x32_bf16 a[160:163], v[92:95], v[36:39], a[160:163]
    s_waitcnt lgkmcnt(2)
    buffer_load_dwordx4 v4, s[4:7], s32 offen offset:1024 sc1 lds
    v_mfma_f32_16x16x32_bf16 a[20:23], v[64:67], v[40:43], a[20:23]
    s_sub_u32 s3, s29, s28
    ds_read_b128 v[32:35], v1 offset:7168
    v_lshlrev_b32 v50, 16, v59
    v_mfma_f32_16x16x32_bf16 a[20:23], v[80:83], v[44:47], a[20:23]
    v_exp_f32 v18, v110
    v_mfma_f32_16x16x32_bf16 a[68:71], v[68:71], v[40:43], a[68:71]
    v_add_f32 v8, v8, v16
    v_add_f32 v8, v8, v17
    v_mfma_f32_16x16x32_bf16 a[68:71], v[84:87], v[44:47], a[68:71]
    buffer_load_dwordx4 v4, s[4:7], s32 offen offset:2048 sc1 lds
    v_mfma_f32_16x16x32_bf16 a[116:119], v[72:75], v[40:43], a[116:119]
    ds_read_b128 v[36:39], v1 offset:19456
    v_mfma_f32_16x16x32_bf16 a[116:119], v[88:91], v[44:47], a[116:119]
    v_exp_f32 v19, v111
    v_mfma_f32_16x16x32_bf16 a[164:167], v[76:79], v[40:43], a[164:167]
    s_mov_b32 s28, s29
    v_cvt_pk_bf16_f32 v174, v16, v17
    v_add_f32 v8, v8, v18
    v_mfma_f32_16x16x32_bf16 a[164:167], v[92:95], v[44:47], a[164:167]
    s_waitcnt lgkmcnt(2)
    v_add_f32 v8, v8, v19
    v_cvt_pk_bf16_f32 v175, v18, v19
    v_mfma_f32_16x16x32_bf16 a[24:27], v[64:67], v[24:27], a[24:27]
    s_add_u32 s32, s32, 24576
    ds_read_b128 v[40:43], v1 offset:8192
    v_and_b32 v51, s97, v59
    v_mfma_f32_16x16x32_bf16 a[24:27], v[80:83], v[28:31], a[24:27]
    v_exp_f32 v16, v176
    v_mfma_f32_16x16x32_bf16 a[72:75], v[68:71], v[24:27], a[72:75]
    s_add_u32 s26, s26, 12288
    v_exp_f32 v17, v177
    v_mfma_f32_16x16x32_bf16 a[72:75], v[84:87], v[28:31], a[72:75]
    v_exp_f32 v18, v178
    v_mfma_f32_16x16x32_bf16 a[120:123], v[72:75], v[24:27], a[120:123]
    s_mov_b32 m0, s26
    ds_read_b128 v[44:47], v1 offset:20480
    v_add_f32 v5, v5, v16
    v_mfma_f32_16x16x32_bf16 a[120:123], v[88:91], v[28:31], a[120:123]
    v_add_f32 v5, v5, v17
    v_mul_f32_e64 v50, -v50, v48
    v_mfma_f32_16x16x32_bf16 a[168:171], v[76:79], v[24:27], a[168:171]
    v_exp_f32 v19, v179
    v_mfma_f32_16x16x32_bf16 a[168:171], v[92:95], v[28:31], a[168:171]
    s_waitcnt lgkmcnt(2)
    v_cvt_pk_bf16_f32 v176, v16, v17
    v_mul_f32_e64 v51, -v51, v49
    v_mfma_f32_16x16x32_bf16 a[28:31], v[64:67], v[32:35], a[28:31]
    ds_read_b128 v[24:27], v1 offset:9216
    v_add_u32 v2, s3, v2
    v_mfma_f32_16x16x32_bf16 a[28:31], v[80:83], v[36:39], a[28:31]
    buffer_load_dwordx4 v4, s[4:7], s32 offen offset:0 sc1 lds
    v_mfma_f32_16x16x32_bf16 a[76:79], v[68:71], v[32:35], a[76:79]
    v_exp_f32 v16, v112
    v_mfma_f32_16x16x32_bf16 a[76:79], v[84:87], v[36:39], a[76:79]
    v_add_f32 v5, v5, v18
    v_add_f32 v5, v5, v19
    v_mfma_f32_16x16x32_bf16 a[124:127], v[72:75], v[32:35], a[124:127]
    ds_read_b128 v[28:31], v1 offset:21504
    v_cvt_f32_i32 v152, v152
    v_mfma_f32_16x16x32_bf16 a[124:127], v[88:91], v[36:39], a[124:127]
    buffer_load_dwordx4 v4, s[4:7], s32 offen offset:1024 sc1 lds
    v_mfma_f32_16x16x32_bf16 a[172:175], v[76:79], v[32:35], a[172:175]
    v_exp_f32 v17, v113
    v_mfma_f32_16x16x32_bf16 a[172:175], v[92:95], v[36:39], a[172:175]
    s_waitcnt lgkmcnt(2)
    v_cvt_pk_bf16_f32 v177, v18, v19
    v_add_u32 v3, s3, v3
    v_mfma_f32_16x16x32_bf16 a[32:35], v[64:67], v[40:43], a[32:35]
    ds_read_b128 v[32:35], v1 offset:10240
    v_cvt_f32_i32 v156, v156
    v_mfma_f32_16x16x32_bf16 a[32:35], v[80:83], v[44:47], a[32:35]
    v_exp_f32 v18, v114
    v_mfma_f32_16x16x32_bf16 a[80:83], v[68:71], v[40:43], a[80:83]
    v_add_f32 v5, v5, v16
    v_add_f32 v5, v5, v17
    v_mfma_f32_16x16x32_bf16 a[80:83], v[84:87], v[44:47], a[80:83]
    buffer_load_dwordx4 v4, s[4:7], s32 offen offset:2048 sc1 lds
    v_mfma_f32_16x16x32_bf16 a[128:131], v[72:75], v[40:43], a[128:131]
    ds_read_b128 v[36:39], v1 offset:22528
    v_mfma_f32_16x16x32_bf16 a[128:131], v[88:91], v[44:47], a[128:131]
    v_exp_f32 v19, v115
    v_mfma_f32_16x16x32_bf16 a[176:179], v[76:79], v[40:43], a[176:179]
    v_cvt_pk_bf16_f32 v178, v16, v17
    v_fma_f32 v152, v152, v48, v50
    v_mfma_f32_16x16x32_bf16 a[176:179], v[92:95], v[44:47], a[176:179]
    s_waitcnt lgkmcnt(2)
    v_exp_f32 v16, v180
    v_mfma_f32_16x16x32_bf16 a[36:39], v[64:67], v[24:27], a[36:39]
    ds_read_b128 v[40:43], v1 offset:11264
    v_add_f32 v5, v5, v18
    v_mfma_f32_16x16x32_bf16 a[36:39], v[80:83], v[28:31], a[36:39]
    v_add_f32 v5, v5, v19
    v_mfma_f32_16x16x32_bf16 a[84:87], v[68:71], v[24:27], a[84:87]
    v_exp_f32 v17, v181
    v_mfma_f32_16x16x32_bf16 a[84:87], v[84:87], v[28:31], a[84:87]
    s_add_u32 s32, s32, 24576
    v_cvt_pk_bf16_f32 v179, v18, v19
    s_add_u32 s26, s26, 36864
    v_mfma_f32_16x16x32_bf16 a[132:135], v[72:75], v[24:27], a[132:135]
    s_sub_u32 s57, s26, 147456
    ds_read_b128 v[44:47], v1 offset:23552
    v_fma_f32 v156, v156, v49, v51
    v_mfma_f32_16x16x32_bf16 a[132:135], v[88:91], v[28:31], a[132:135]
    s_waitcnt lgkmcnt(2)
    v_exp_f32 v18, v182
    v_mfma_f32_16x16x32_bf16 a[180:183], v[76:79], v[24:27], a[180:183]
    s_waitcnt vmcnt(6)
    v_add_f32 v6, v6, v16
    v_add_f32 v6, v6, v17
    v_mfma_f32_16x16x32_bf16 a[180:183], v[92:95], v[28:31], a[180:183]
    s_barrier
    v_cvt_f32_i32 v153, v153
    v_mfma_f32_16x16x32_bf16 a[40:43], v[64:67], v[32:35], a[40:43]
    s_min_u32 s26, s26, s57
    ds_read_b128 v[24:27], v2 offset:0
    v_add_u32 v0, 1, v0
    v_mfma_f32_16x16x32_bf16 a[40:43], v[80:83], v[36:39], a[40:43]
    buffer_store_dword v0, v13, s[20:23], 0 offen offset:32 sc1
    v_mfma_f32_16x16x32_bf16 a[88:91], v[68:71], v[32:35], a[88:91]
    v_exp_f32 v19, v183
    v_mfma_f32_16x16x32_bf16 a[88:91], v[84:87], v[36:39], a[88:91]
    v_cvt_pk_bf16_f32 v180, v16, v17
    v_cvt_f32_i32 v157, v157
    v_mfma_f32_16x16x32_bf16 a[136:139], v[72:75], v[32:35], a[136:139]
    ds_read_b128 v[28:31], v3 offset:0
    v_mfma_f32_16x16x32_bf16 a[136:139], v[88:91], v[36:39], a[136:139]
    v_exp_f32 v16, v116
    v_mfma_f32_16x16x32_bf16 a[184:187], v[76:79], v[32:35], a[184:187]
    v_add_f32 v6, v6, v18
    v_add_f32 v6, v6, v19
    v_mfma_f32_16x16x32_bf16 a[184:187], v[92:95], v[36:39], a[184:187]
    s_waitcnt lgkmcnt(2)
    v_exp_f32 v17, v117
    v_mfma_f32_16x16x32_bf16 a[44:47], v[64:67], v[40:43], a[44:47]
    ds_read_b128 v[32:35], v2 offset:6144
    v_cvt_pk_bf16_f32 v181, v18, v19
    v_mfma_f32_16x16x32_bf16 a[44:47], v[80:83], v[44:47], a[44:47]
    v_exp_f32 v18, v118
    v_mfma_f32_16x16x32_bf16 a[92:95], v[68:71], v[40:43], a[92:95]
    v_add_f32 v6, v6, v16
    v_add_f32 v6, v6, v17
    v_mfma_f32_16x16x32_bf16 a[92:95], v[84:87], v[44:47], a[92:95]
    v_exp_f32 v19, v119
    v_mfma_f32_16x16x32_bf16 a[140:143], v[72:75], v[40:43], a[140:143]
    ds_read_b128 v[36:39], v3 offset:6144
    v_cvt_pk_bf16_f32 v182, v16, v17
    v_mfma_f32_16x16x32_bf16 a[140:143], v[88:91], v[44:47], a[140:143]
    v_add_f32 v6, v6, v18
    v_add_f32 v6, v6, v19
    v_mfma_f32_16x16x32_bf16 a[188:191], v[76:79], v[40:43], a[188:191]
    v_cvt_pk_bf16_f32 v183, v18, v19
    v_mfma_f32_16x16x32_bf16 a[188:191], v[92:95], v[44:47], a[188:191]
    s_waitcnt lgkmcnt(2)
    v_mfma_f32_16x16x32_bf16 v[64:67], v[24:27], a[192:195], v[128:131]
    s_mov_b32 m0, s56
    ds_read_b128 v[40:43], v2 offset:128
    v_fma_f32 v153, v153, v48, v50
    v_mfma_f32_16x16x32_bf16 v[64:67], v[28:31], a[196:199], v[64:67]
    buffer_load_dwordx4 v4, s[4:7], s27 offen offset:0 sc1 lds
    v_mfma_f32_16x16x32_bf16 v[68:71], v[24:27], a[216:219], v[132:135]
    v_exp_f32 v16, v184
    v_mfma_f32_16x16x32_bf16 v[68:71], v[28:31], a[220:223], v[68:71]
    v_exp_f32 v17, v185
    v_mfma_f32_16x16x32_bf16 v[72:75], v[24:27], a[240:243], v[136:139]
    ds_read_b128 v[44:47], v3 offset:128
    v_fma_f32 v157, v157, v49, v51
    v_mfma_f32_16x16x32_bf16 v[72:75], v[28:31], a[244:247], v[72:75]
    v_exp_f32 v18, v186
    v_mfma_f32_16x16x32_bf16 v[76:79], v[24:27], v[200:203], v[140:143]
    v_add_f32 v7, v7, v16
    v_add_f32 v7, v7, v17
    v_mfma_f32_16x16x32_bf16 v[76:79], v[28:31], v[204:207], v[76:79]
    s_waitcnt lgkmcnt(2)
    v_exp_f32 v19, v187
    v_mfma_f32_16x16x32_bf16 v[96:99], v[32:35], a[192:195], v[128:131]
    ds_read_b128 v[24:27], v2 offset:6272
    v_cvt_pk_bf16_f32 v184, v16, v17
    v_mfma_f32_16x16x32_bf16 v[96:99], v[36:39], a[196:199], v[96:99]
    v_exp_f32 v16, v120
    v_mfma_f32_16x16x32_bf16 v[100:103], v[32:35], a[216:219], v[132:135]
    v_cvt_f32_i32 v154, v154
    v_add_f32 v7, v7, v18
    v_mfma_f32_16x16x32_bf16 v[100:103], v[36:39], a[220:223], v[100:103]
    buffer_load_dwordx4 v4, s[4:7], s27 offen offset:1024 sc1 lds
    v_mfma_f32_16x16x32_bf16 v[104:107], v[32:35], a[240:243], v[136:139]
    ds_read_b128 v[28:31], v3 offset:6272
    v_add_f32 v7, v7, v19
    v_mfma_f32_16x16x32_bf16 v[104:107], v[36:39], a[244:247], v[104:107]
    v_exp_f32 v17, v121
    v_mfma_f32_16x16x32_bf16 v[108:111], v[32:35], v[200:203], v[140:143]
    v_cvt_f32_i32 v158, v158
    v_cvt_pk_bf16_f32 v185, v18, v19
    v_mfma_f32_16x16x32_bf16 v[108:111], v[36:39], v[204:207], v[108:111]
    s_waitcnt lgkmcnt(2)
    v_exp_f32 v18, v122
    v_mfma_f32_16x16x32_bf16 v[64:67], v[40:43], a[200:203], v[64:67]
    ds_read_b128 v[32:35], v2 offset:256
    v_fma_f32 v154, v154, v48, v50
    v_mfma_f32_16x16x32_bf16 v[64:67], v[44:47], a[204:207], v[64:67]
    v_add_f32 v7, v7, v16
    v_add_f32 v7, v7, v17
    v_mfma_f32_16x16x32_bf16 v[68:71], v[40:43], a[224:227], v[68:71]
    v_exp_f32 v19, v123
    v_mfma_f32_16x16x32_bf16 v[68:71], v[44:47], a[228:231], v[68:71]
    v_fma_f32 v158, v158, v49, v51
    v_cvt_pk_bf16_f32 v186, v16, v17
    v_mfma_f32_16x16x32_bf16 v[72:75], v[40:43], a[248:251], v[72:75]
    ds_read_b128 v[36:39], v3 offset:256
    v_cvt_pk_bf16_f32 v144, v144, v148
    v_mfma_f32_16x16x32_bf16 v[72:75], v[44:47], a[252:255], v[72:75]
    v_exp_f32 v16, v188
    v_mfma_f32_16x16x32_bf16 v[76:79], v[40:43], v[208:211], v[76:79]
    v_add_f32 v7, v7, v18
    v_add_f32 v7, v7, v19
    v_mfma_f32_16x16x32_bf16 v[76:79], v[44:47], v[212:215], v[76:79]
    s_waitcnt lgkmcnt(2)
    buffer_load_dwordx4 v4, s[4:7], s27 offen offset:2048 sc1 lds
    v_mfma_f32_16x16x32_bf16 v[96:99], v[24:27], a[200:203], v[96:99]
    ds_read_b128 v[40:43], v2 offset:6400
    v_cvt_pk_bf16_f32 v148, v145, v149
    v_mfma_f32_16x16x32_bf16 v[96:99], v[28:31], a[204:207], v[96:99]
    v_exp_f32 v17, v189
    v_mfma_f32_16x16x32_bf16 v[100:103], v[24:27], a[224:227], v[100:103]
    v_cvt_pk_bf16_f32 v187, v18, v19
    v_mfma_f32_16x16x32_bf16 v[100:103], v[28:31], a[228:231], v[100:103]
    v_exp_f32 v18, v190
    v_mfma_f32_16x16x32_bf16 v[104:107], v[24:27], a[248:251], v[104:107]
    ds_read_b128 v[44:47], v3 offset:6400
    v_add_f32 v8, v8, v16
    v_mfma_f32_16x16x32_bf16 v[104:107], v[28:31], a[252:255], v[104:107]
    v_add_f32 v8, v8, v17
    v_cvt_pk_bf16_f32 v145, v152, v156
    v_mfma_f32_16x16x32_bf16 v[108:111], v[24:27], v[208:211], v[108:111]
    s_add_u32 s29, s30, 49152
    v_exp_f32 v19, v191
    v_mfma_f32_16x16x32_bf16 v[108:111], v[28:31], v[212:215], v[108:111]
    s_waitcnt lgkmcnt(2)
    v_cvt_pk_bf16_f32 v188, v16, v17
    s_sub_u32 s3, s29, 147456
    v_mfma_f32_16x16x32_bf16 v[64:67], v[32:35], a[208:211], v[64:67]
    s_add_u32 s27, s27, 24576
    ds_read_b128 v[24:27], v2 offset:12288
    v_cvt_pk_bf16_f32 v149, v153, v157
    v_mfma_f32_16x16x32_bf16 v[64:67], v[36:39], a[212:215], v[64:67]
L_pg8:
    s_cbranch_execz L_pg12
    s_min_u32 s29, s29, s3
    v_exp_f32 v16, v124
    v_mfma_f32_16x16x32_bf16 v[68:71], v[32:35], a[232:235], v[68:71]
    v_add_f32 v8, v8, v18
    v_add_f32 v8, v8, v19
    v_mfma_f32_16x16x32_bf16 v[68:71], v[36:39], a[236:239], v[68:71]
    v_exp_f32 v17, v125
    v_mfma_f32_16x16x32_bf16 v[72:75], v[32:35], v[192:195], v[72:75]
    s_add_u32 s56, s56, 12288
    ds_read_b128 v[28:31], v3 offset:12288
    v_cvt_pk_bf16_f32 v152, v146, v150
    v_mfma_f32_16x16x32_bf16 v[72:75], v[36:39], v[196:199], v[72:75]
    v_cvt_pk_bf16_f32 v189, v18, v19
    v_mfma_f32_16x16x32_bf16 v[76:79], v[32:35], v[216:219], v[76:79]
    v_exp_f32 v18, v126
    v_mfma_f32_16x16x32_bf16 v[76:79], v[36:39], v[220:223], v[76:79]
    s_waitcnt lgkmcnt(2)
    v_add_f32 v8, v8, v16
    v_mfma_f32_16x16x32_bf16 v[96:99], v[40:43], a[208:211], v[96:99]
    ds_read_b128 v[32:35], v2 offset:18432
    v_add_f32 v8, v8, v17
    v_mfma_f32_16x16x32_bf16 v[96:99], v[44:47], a[212:215], v[96:99]
    s_sub_u32 s3, s29, s30
    v_exp_f32 v19, v127
    v_mfma_f32_16x16x32_bf16 v[100:103], v[40:43], a[232:235], v[100:103]
    s_mov_b32 m0, s56
    v_cvt_pk_bf16_f32 v153, v154, v158
    v_mfma_f32_16x16x32_bf16 v[100:103], v[44:47], a[236:239], v[100:103]
    v_cvt_pk_bf16_f32 v190, v16, v17
    v_mfma_f32_16x16x32_bf16 v[104:107], v[40:43], v[192:195], v[104:107]
    ds_read_b128 v[36:39], v3 offset:18432
    v_add_f32 v8, v8, v18
    v_mfma_f32_16x16x32_bf16 v[104:107], v[44:47], v[196:199], v[104:107]
    v_add_f32 v8, v8, v19
    v_cvt_pk_bf16_f32 v191, v18, v19
    v_mfma_f32_16x16x32_bf16 v[108:111], v[40:43], v[216:219], v[108:111]
    v_mfma_f32_16x16x32_bf16 v[108:111], v[44:47], v[220:223], v[108:111]
    s_waitcnt lgkmcnt(2)
    v_exp_f32 v16, v64
    v_mfma_f32_16x16x32_bf16 v[80:83], v[24:27], a[192:195], v[128:131]
    ds_read_b128 v[40:43], v2 offset:12416
    v_mfma_f32_16x16x32_bf16 v[80:83], v[28:31], a[196:199], v[80:83]
    s_mov_b32 s30, s29
    v_exp_f32 v17, v65
    v_mfma_f32_16x16x32_bf16 v[84:87], v[24:27], a[216:219], v[132:135]
    v_exp_f32 v18, v66
    v_mfma_f32_16x16x32_bf16 v[84:87], v[28:31], a[220:223], v[84:87]
    s_waitcnt vmcnt(14)
    buffer_load_dwordx4 v4, s[4:7], s27 offen offset:0 sc1 lds
    v_mfma_f32_16x16x32_bf16 v[88:91], v[24:27], a[240:243], v[136:139]
    ds_read_b128 v[44:47], v3 offset:12416
    v_add_f32 v5, v5, v16
    v_mfma_f32_16x16x32_bf16 v[88:91], v[28:31], a[244:247], v[88:91]
    v_add_f32 v5, v5, v17
    v_lshlrev_b32 v48, 16, v60
    v_mfma_f32_16x16x32_bf16 v[92:95], v[24:27], v[200:203], v[140:143]
    v_exp_f32 v19, v67
    v_mfma_f32_16x16x32_bf16 v[92:95], v[28:31], v[204:207], v[92:95]
    s_waitcnt lgkmcnt(2)
    v_cvt_pk_bf16_f32 v64, v16, v17
    v_and_b32 v49, s97, v60
    v_mfma_f32_16x16x32_bf16 v[112:115], v[32:35], a[192:195], v[128:131]
    ds_read_b128 v[24:27], v2 offset:18560
    v_mfma_f32_16x16x32_bf16 v[112:115], v[36:39], a[196:199], v[112:115]
    v_exp_f32 v16, v96
    v_mfma_f32_16x16x32_bf16 v[116:119], v[32:35], a[216:219], v[132:135]
    v_add_f32 v5, v5, v18
    v_lshlrev_b32 v50, 16, v62
    v_mfma_f32_16x16x32_bf16 v[116:119], v[36:39], a[220:223], v[116:119]
    v_add_f32 v5, v5, v19
    v_add_u32 v1, s3, v1
    v_mfma_f32_16x16x32_bf16 v[120:123], v[32:35], a[240:243], v[136:139]
    ds_read_b128 v[28:31], v3 offset:18560
    v_mfma_f32_16x16x32_bf16 v[120:123], v[36:39], a[244:247], v[120:123]
    v_exp_f32 v17, v97
    v_mfma_f32_16x16x32_bf16 v[124:127], v[32:35], v[200:203], v[140:143]
    v_cvt_pk_bf16_f32 v65, v18, v19
    v_and_b32 v51, s97, v62
    v_mfma_f32_16x16x32_bf16 v[124:127], v[36:39], v[204:207], v[124:127]
    s_waitcnt lgkmcnt(2)
    buffer_load_dwordx4 v4, s[4:7], s27 offen offset:1024 sc1 lds
    v_mfma_f32_16x16x32_bf16 v[80:83], v[40:43], a[200:203], v[80:83]
    ds_read_b128 v[32:35], v2 offset:12544
    v_mfma_f32_16x16x32_bf16 v[80:83], v[44:47], a[204:207], v[80:83]
    v_exp_f32 v18, v98
    v_mfma_f32_16x16x32_bf16 v[84:87], v[40:43], a[224:227], v[84:87]
    v_add_f32 v5, v5, v16
    v_add_f32 v5, v5, v17
    v_mfma_f32_16x16x32_bf16 v[84:87], v[44:47], a[228:231], v[84:87]
    v_exp_f32 v19, v99
    v_mfma_f32_16x16x32_bf16 v[88:91], v[40:43], a[248:251], v[88:91]
    ds_read_b128 v[36:39], v3 offset:12544
    v_cvt_pk_bf16_f32 v66, v16, v17
    v_mfma_f32_16x16x32_bf16 v[88:91], v[44:47], a[252:255], v[88:91]
    v_exp_f32 v16, v68
    v_mfma_f32_16x16x32_bf16 v[92:95], v[40:43], v[208:211], v[92:95]
    v_mul_f32_e64 v50, -v50, v48
    v_add_f32 v5, v5, v18
    v_mfma_f32_16x16x32_bf16 v[92:95], v[44:47], v[212:215], v[92:95]
    s_waitcnt lgkmcnt(2)
    v_add_f32 v5, v5, v19
    v_mul_f32_e64 v51, -v51, v49
    v_mfma_f32_16x16x32_bf16 v[112:115], v[24:27], a[200:203], v[112:115]
    ds_read_b128 v[40:43], v2 offset:18688
    v_mfma_f32_16x16x32_bf16 v[112:115], v[28:31], a[204:207], v[112:115]
    buffer_load_dwordx4 v4, s[4:7], s27 offen offset:2048 sc1 lds
    v_mfma_f32_16x16x32_bf16 v[116:119], v[24:27], a[224:227], v[116:119]
    v_exp_f32 v17, v69
    v_mfma_f32_16x16x32_bf16 v[116:119], v[28:31], a[228:231], v[116:119]
    v_cvt_pk_bf16_f32 v67, v18, v19
    v_cvt_f32_i32 v240, v240
    v_mfma_f32_16x16x32_bf16 v[120:123], v[24:27], a[248:251], v[120:123]
    ds_read_b128 v[44:47], v3 offset:18688
    v_mfma_f32_16x16x32_bf16 v[120:123], v[28:31], a[252:255], v[120:123]
    s_waitcnt lgkmcnt(2)
    v_exp_f32 v18, v70
    v_mfma_f32_16x16x32_bf16 v[124:127], v[24:27], v[208:211], v[124:127]
    s_waitcnt vmcnt(7)
    v_add_f32 v6, v6, v16
    v_add_f32 v6, v6, v17
    v_mfma_f32_16x16x32_bf16 v[124:127], v[28:31], v[212:215], v[124:127]
    s_barrier
    v_cvt_f32_i32 v244, v244
    v_mfma_f32_16x16x32_bf16 v[80:83], v[32:35], a[208:211], v[80:83]
    ds_read_b128 v[24:27], v1 offset:0
    v_mfma_f32_16x16x32_bf16 v[80:83], v[36:39], a[212:215], v[80:83]
    v_exp_f32 v19, v71
    v_mfma_f32_16x16x32_bf16 v[84:87], v[32:35], a[232:235], v[84:87]
    v_cvt_pk_bf16_f32 v68, v16, v17
    v_fma_f32 v240, v240, v48, v50
    v_mfma_f32_16x16x32_bf16 v[84:87], v[36:39], a[236:239], v[84:87]
    v_exp_f32 v16, v100
    v_mfma_f32_16x16x32_bf16 v[88:91], v[32:35], v[192:195], v[88:91]
    ds_read_b128 v[28:31], v1 offset:12288
    v_add_f32 v6, v6, v18
    v_mfma_f32_16x16x32_bf16 v[88:91], v[36:39], v[196:199], v[88:91]
    v_add_f32 v6, v6, v19
    v_fma_f32 v244, v244, v49, v51
    v_mfma_f32_16x16x32_bf16 v[92:95], v[32:35], v[216:219], v[92:95]
    v_exp_f32 v17, v101
    v_mfma_f32_16x16x32_bf16 v[92:95], v[36:39], v[220:223], v[92:95]
    s_waitcnt lgkmcnt(2)
    v_cvt_pk_bf16_f32 v69, v18, v19
    v_mfma_f32_16x16x32_bf16 v[112:115], v[40:43], a[208:211], v[112:115]
    ds_read_b128 v[32:35], v1 offset:1024
    v_mfma_f32_16x16x32_bf16 v[112:115], v[44:47], a[212:215], v[112:115]
    v_exp_f32 v18, v102
    v_mfma_f32_16x16x32_bf16 v[116:119], v[40:43], a[232:235], v[116:119]
    v_add_f32 v6, v6, v16
    v_add_f32 v6, v6, v17
    v_mfma_f32_16x16x32_bf16 v[116:119], v[44:47], a[236:239], v[116:119]
    s_add_u32 s27, s27, 24576
    v_exp_f32 v19, v103
    v_mfma_f32_16x16x32_bf16 v[120:123], v[40:43], v[192:195], v[120:123]
    s_add_u32 s56, s56, 36864
    ds_read_b128 v[36:39], v1 offset:13312
    v_cvt_pk_bf16_f32 v70, v16, v17
    v_mfma_f32_16x16x32_bf16 v[120:123], v[44:47], v[196:199], v[120:123]
    s_sub_u32 s58, s56, 147456
    v_add_f32 v6, v6, v18
    v_add_f32 v6, v6, v19
    v_mfma_f32_16x16x32_bf16 v[124:127], v[40:43], v[216:219], v[124:127]
    s_min_u32 s56, s56, s58
    v_cvt_pk_bf16_f32 v71, v18, v19
    v_mfma_f32_16x16x32_bf16 v[124:127], v[44:47], v[220:223], v[124:127]
    s_waitcnt lgkmcnt(2)
    v_mfma_f32_16x16x32_bf16 a[0:3], v[160:163], v[24:27], a[0:3]
    s_mov_b32 m0, s56
    ds_read_b128 v[40:43], v1 offset:2048
    v_cvt_f32_i32 v241, v241
    v_mfma_f32_16x16x32_bf16 a[0:3], v[176:179], v[28:31], a[0:3]
    buffer_load_dwordx4 v4, s[4:7], s27 offen offset:0 sc1 lds
    v_mfma_f32_16x16x32_bf16 a[48:51], v[164:167], v[24:27], a[48:51]
    v_exp_f32 v16, v72
    v_mfma_f32_16x16x32_bf16 a[48:51], v[180:183], v[28:31], a[48:51]
    v_exp_f32 v17, v73
    v_mfma_f32_16x16x32_bf16 a[96:99], v[168:171], v[24:27], a[96:99]
    ds_read_b128 v[44:47], v1 offset:14336
    v_cvt_f32_i32 v245, v245
    v_mfma_f32_16x16x32_bf16 a[96:99], v[184:187], v[28:31], a[96:99]
    v_exp_f32 v18, v74
    v_mfma_f32_16x16x32_bf16 a[144:147], v[172:175], v[24:27], a[144:147]
    v_add_f32 v7, v7, v16
    v_add_f32 v7, v7, v17
    v_mfma_f32_16x16x32_bf16 a[144:147], v[188:191], v[28:31], a[144:147]
    s_waitcnt lgkmcnt(2)
    v_exp_f32 v19, v75
    v_mfma_f32_16x16x32_bf16 a[4:7], v[160:163], v[32:35], a[4:7]
    ds_read_b128 v[24:27], v1 offset:3072
    v_fma_f32 v241, v241, v48, v50
    v_mfma_f32_16x16x32_bf16 a[4:7], v[176:179], v[36:39], a[4:7]
    buffer_load_dwordx4 v4, s[4:7], s27 offen offset:1024 sc1 lds
    v_mfma_f32_16x16x32_bf16 a[52:55], v[164:167], v[32:35], a[52:55]
    v_cvt_pk_bf16_f32 v72, v16, v17
    v_fma_f32 v245, v245, v49, v51
    v_mfma_f32_16x16x32_bf16 a[52:55], v[180:183], v[36:39], a[52:55]
    v_exp_f32 v16, v104
    v_mfma_f32_16x16x32_bf16 a[100:103], v[168:171], v[32:35], a[100:103]
    ds_read_b128 v[28:31], v1 offset:15360
    v_add_f32 v7, v7, v18
    v_mfma_f32_16x16x32_bf16 a[100:103], v[184:187], v[36:39], a[100:103]
    buffer_load_dword v52, v20, s[20:23], s44 offen sc1
    v_mfma_f32_16x16x32_bf16 a[148:151], v[172:175], v[32:35], a[148:151]
    v_add_f32 v7, v7, v19
    v_cvt_f32_i32 v242, v242
    v_mfma_f32_16x16x32_bf16 a[148:151], v[188:191], v[36:39], a[148:151]
    s_waitcnt lgkmcnt(2)
    v_exp_f32 v17, v105
    v_mfma_f32_16x16x32_bf16 a[8:11], v[160:163], v[40:43], a[8:11]
    ds_read_b128 v[32:35], v1 offset:4096
    v_cvt_pk_bf16_f32 v73, v18, v19
    v_mfma_f32_16x16x32_bf16 a[8:11], v[176:179], v[44:47], a[8:11]
    v_exp_f32 v18, v106
    v_mfma_f32_16x16x32_bf16 a[56:59], v[164:167], v[40:43], a[56:59]
    v_add_f32 v7, v7, v16
    v_cvt_f32_i32 v246, v246
    v_mfma_f32_16x16x32_bf16 a[56:59], v[180:183], v[44:47], a[56:59]
    buffer_load_dwordx4 v4, s[4:7], s27 offen offset:2048 sc1 lds
    v_mfma_f32_16x16x32_bf16 a[104:107], v[168:171], v[40:43], a[104:107]
    ds_read_b128 v[36:39], v1 offset:16384
    v_add_f32 v7, v7, v17
    v_mfma_f32_16x16x32_bf16 a[104:107], v[184:187], v[44:47], a[104:107]
    v_exp_f32 v19, v107
    v_mfma_f32_16x16x32_bf16 a[152:155], v[172:175], v[40:43], a[152:155]
    v_cvt_pk_bf16_f32 v74, v16, v17
    v_fma_f32 v242, v242, v48, v50
    v_mfma_f32_16x16x32_bf16 a[152:155], v[188:191], v[44:47], a[152:155]
    s_waitcnt lgkmcnt(2)
    v_exp_f32 v16, v76
    v_mfma_f32_16x16x32_bf16 a[12:15], v[160:163], v[24:27], a[12:15]
    ds_read_b128 v[40:43], v1 offset:5120
    v_add_f32 v7, v7, v18
    v_mfma_f32_16x16x32_bf16 a[12:15], v[176:179], v[28:31], a[12:15]
    s_add_u32 s27, s27, 24576
    v_add_f32 v7, v7, v19
    v_fma_f32 v246, v246, v49, v51
    v_mfma_f32_16x16x32_bf16 a[60:63], v[164:167], v[24:27], a[60:63]
    v_exp_f32 v17, v77
    v_mfma_f32_16x16x32_bf16 a[60:63], v[180:183], v[28:31], a[60:63]
    v_cvt_pk_bf16_f32 v75, v18, v19
    v_lshlrev_b32 v48, 16, v61
    v_mfma_f32_16x16x32_bf16 a[108:111], v[168:171], v[24:27], a[108:111]
    ds_read_b128 v[44:47], v1 offset:17408
    v_and_b32 v49, s97, v61
    v_mfma_f32_16x16x32_bf16 a[108:111], v[184:187], v[28:31], a[108:111]
    v_exp_f32 v18, v78
    v_mfma_f32_16x16x32_bf16 a[156:159], v[172:175], v[24:27], a[156:159]
    s_add_u32 s29, s28, 49152
    v_add_f32 v8, v8, v16
    v_add_f32 v8, v8, v17
    v_mfma_f32_16x16x32_bf16 a[156:159], v[188:191], v[28:31], a[156:159]
    s_waitcnt lgkmcnt(2)
    v_exp_f32 v19, v79
    v_mfma_f32_16x16x32_bf16 a[16:19], v[160:163], v[32:35], a[16:19]
    s_sub_u32 s3, s29, 147456
    ds_read_b128 v[24:27], v1 offset:6144
    v_lshlrev_b32 v50, 16, v63
    v_mfma_f32_16x16x32_bf16 a[16:19], v[176:179], v[36:39], a[16:19]
    s_add_u32 s56, s56, 12288
    v_cvt_pk_bf16_f32 v76, v16, v17
    v_and_b32 v51, s97, v63
    v_mfma_f32_16x16x32_bf16 a[64:67], v[164:167], v[32:35], a[64:67]
    s_min_u32 s29, s29, s3
    v_exp_f32 v16, v108
    v_mfma_f32_16x16x32_bf16 a[64:67], v[180:183], v[36:39], a[64:67]
    s_mov_b32 m0, s56
    v_add_f32 v8, v8, v18
    v_add_f32 v8, v8, v19
    v_mfma_f32_16x16x32_bf16 a[112:115], v[168:171], v[32:35], a[112:115]
    ds_read_b128 v[28:31], v1 offset:18432
    v_mul_f32_e64 v50, -v50, v48
    v_mfma_f32_16x16x32_bf16 a[112:115], v[184:187], v[36:39], a[112:115]
    v_exp_f32 v17, v109
    v_mfma_f32_16x16x32_bf16 a[160:163], v[172:175], v[32:35], a[160:163]
    v_cvt_pk_bf16_f32 v77, v18, v19
    v_mul_f32_e64 v51, -v51, v49
    v_mfma_f32_16x16x32_bf16 a[160:163], v[188:191], v[36:39], a[160:163]
    s_waitcnt lgkmcnt(2)
    v_exp_f32 v18, v110
    v_mfma_f32_16x16x32_bf16 a[20:23], v[160:163], v[40:43], a[20:23]
    s_sub_u32 s3, s29, s28
    ds_read_b128 v[32:35], v1 offset:7168
    v_add_f32 v8, v8, v16
    v_mfma_f32_16x16x32_bf16 a[20:23], v[176:179], v[44:47], a[20:23]
    v_add_f32 v8, v8, v17
    v_cvt_f32_i32 v248, v248
    v_mfma_f32_16x16x32_bf16 a[68:71], v[164:167], v[40:43], a[68:71]
    v_exp_f32 v19, v111
    v_mfma_f32_16x16x32_bf16 a[68:71], v[180:183], v[44:47], a[68:71]
    buffer_load_dwordx4 v4, s[4:7], s27 offen offset:0 sc1 lds
    v_mfma_f32_16x16x32_bf16 a[116:119], v[168:171], v[40:43], a[116:119]
    ds_read_b128 v[36:39], v1 offset:19456
    v_cvt_pk_bf16_f32 v78, v16, v17
    v_mfma_f32_16x16x32_bf16 a[116:119], v[184:187], v[44:47], a[116:119]
    v_add_f32 v8, v8, v18
    v_cvt_f32_i32 v252, v252
    v_mfma_f32_16x16x32_bf16 a[164:167], v[172:175], v[40:43], a[164:167]
    s_mov_b32 s28, s29
    v_add_f32 v8, v8, v19
    v_cvt_pk_bf16_f32 v79, v18, v19
    v_mfma_f32_16x16x32_bf16 a[164:167], v[188:191], v[44:47], a[164:167]
    s_waitcnt lgkmcnt(2)
    v_exp_f32 v16, v80
    v_mfma_f32_16x16x32_bf16 a[24:27], v[160:163], v[24:27], a[24:27]
    ds_read_b128 v[40:43], v1 offset:8192
    v_fma_f32 v248, v248, v48, v50
    v_mfma_f32_16x16x32_bf16 a[24:27], v[176:179], v[28:31], a[24:27]
    v_exp_f32 v17, v81
    v_mfma_f32_16x16x32_bf16 a[72:75], v[164:167], v[24:27], a[72:75]
    v_fma_f32 v252, v252, v49, v51
    v_cvt_f32_i32 v249, v249
    v_mfma_f32_16x16x32_bf16 a[72:75], v[180:183], v[28:31], a[72:75]
    buffer_load_dwordx4 v4, s[4:7], s27 offen offset:1024 sc1 lds
    v_mfma_f32_16x16x32_bf16 a[120:123], v[168:171], v[24:27], a[120:123]
    ds_read_b128 v[44:47], v1 offset:20480
    v_cvt_f32_i32 v253, v253
    v_mfma_f32_16x16x32_bf16 a[120:123], v[184:187], v[28:31], a[120:123]
    v_exp_f32 v18, v82
    v_mfma_f32_16x16x32_bf16 a[168:171], v[172:175], v[24:27], a[168:171]
    v_add_f32 v5, v5, v16
    v_add_f32 v5, v5, v17
    v_mfma_f32_16x16x32_bf16 a[168:171], v[188:191], v[28:31], a[168:171]
    s_waitcnt lgkmcnt(2)
    v_exp_f32 v19, v83
    v_mfma_f32_16x16x32_bf16 a[28:31], v[160:163], v[32:35], a[28:31]
    ds_read_b128 v[24:27], v1 offset:9216
    v_cvt_pk_bf16_f32 v80, v16, v17
    v_mfma_f32_16x16x32_bf16 a[28:31], v[176:179], v[36:39], a[28:31]
    v_exp_f32 v16, v112
    v_mfma_f32_16x16x32_bf16 a[76:79], v[164:167], v[32:35], a[76:79]
    v_add_f32 v5, v5, v18
    v_fma_f32 v249, v249, v48, v50
    v_mfma_f32_16x16x32_bf16 a[76:79], v[180:183], v[36:39], a[76:79]
    v_add_f32 v5, v5, v19
    v_add_u32 v2, s3, v2
    v_mfma_f32_16x16x32_bf16 a[124:127], v[168:171], v[32:35], a[124:127]
    ds_read_b128 v[28:31], v1 offset:21504
    v_fma_f32 v253, v253, v49, v51
    v_mfma_f32_16x16x32_bf16 a[124:127], v[184:187], v[36:39], a[124:127]
    buffer_load_dwordx4 v4, s[4:7], s27 offen offset:2048 sc1 lds
    v_mfma_f32_16x16x32_bf16 a[172:175], v[172:175], v[32:35], a[172:175]
    v_exp_f32 v17, v113
    v_mfma_f32_16x16x32_bf16 a[172:175], v[188:191], v[36:39], a[172:175]
    s_waitcnt lgkmcnt(2)
    v_cvt_pk_bf16_f32 v81, v18, v19
    v_cvt_f32_i32 v250, v250
    v_mfma_f32_16x16x32_bf16 a[32:35], v[160:163], v[40:43], a[32:35]
    ds_read_b128 v[32:35], v1 offset:10240
    v_add_u32 v3, s3, v3
    v_mfma_f32_16x16x32_bf16 a[32:35], v[176:179], v[44:47], a[32:35]
    v_exp_f32 v18, v114
    v_mfma_f32_16x16x32_bf16 a[80:83], v[164:167], v[40:43], a[80:83]
    v_add_f32 v5, v5, v16
    v_add_f32 v5, v5, v17
    v_mfma_f32_16x16x32_bf16 a[80:83], v[180:183], v[44:47], a[80:83]
    v_exp_f32 v19, v115
    v_mfma_f32_16x16x32_bf16 a[128:131], v[168:171], v[40:43], a[128:131]
    ds_read_b128 v[36:39], v1 offset:22528
    v_cvt_pk_bf16_f32 v82, v16, v17
    v_mfma_f32_16x16x32_bf16 a[128:131], v[184:187], v[44:47], a[128:131]
    v_exp_f32 v16, v84
    v_mfma_f32_16x16x32_bf16 a[176:179], v[172:175], v[40:43], a[176:179]
    v_cvt_f32_i32 v254, v254
    v_add_f32 v5, v5, v18
    v_mfma_f32_16x16x32_bf16 a[176:179], v[188:191], v[44:47], a[176:179]
    s_waitcnt lgkmcnt(2)
    v_add_f32 v5, v5, v19
    v_fma_f32 v250, v250, v48, v50
    v_mfma_f32_16x16x32_bf16 a[36:39], v[160:163], v[24:27], a[36:39]
    ds_read_b128 v[40:43], v1 offset:11264
    v_fma_f32 v254, v254, v49, v51
    v_mfma_f32_16x16x32_bf16 a[36:39], v[176:179], v[28:31], a[36:39]
    v_exp_f32 v17, v85
    v_mfma_f32_16x16x32_bf16 a[84:87], v[164:167], v[24:27], a[84:87]
    v_cvt_pk_bf16_f32 v83, v18, v19
    v_cvt_pk_bf16_f32 v146, v240, v244
    v_mfma_f32_16x16x32_bf16 a[84:87], v[180:183], v[28:31], a[84:87]
    s_add_u32 s27, s27, 24576
    v_exp_f32 v18, v86
    v_mfma_f32_16x16x32_bf16 a[132:135], v[168:171], v[24:27], a[132:135]
    s_add_u32 s56, s56, 36864
    ds_read_b128 v[44:47], v1 offset:23552
    v_add_f32 v6, v6, v16
    v_mfma_f32_16x16x32_bf16 a[132:135], v[184:187], v[28:31], a[132:135]
    s_sub_u32 s58, s56, 147456
    v_add_f32 v6, v6, v17
    v_cvt_pk_bf16_f32 v150, v241, v245
    v_mfma_f32_16x16x32_bf16 a[180:183], v[172:175], v[24:27], a[180:183]
    v_exp_f32 v19, v87
    v_mfma_f32_16x16x32_bf16 a[180:183], v[188:191], v[28:31], a[180:183]
    s_waitcnt lgkmcnt(2)
    v_cvt_pk_bf16_f32 v84, v16, v17
    v_cvt_pk_bf16_f32 v147, v248, v252
    v_mfma_f32_16x16x32_bf16 a[40:43], v[160:163], v[32:35], a[40:43]
    s_min_u32 s56, s56, s58
    ds_read_b128 v[24:27], v2 offset:0
    v_mfma_f32_16x16x32_bf16 a[40:43], v[176:179], v[36:39], a[40:43]
    v_exp_f32 v16, v116
    v_mfma_f32_16x16x32_bf16 a[88:91], v[164:167], v[32:35], a[88:91]
    v_add_f32 v6, v6, v18
    v_add_f32 v6, v6, v19
    v_mfma_f32_16x16x32_bf16 a[88:91], v[180:183], v[36:39], a[88:91]
    v_exp_f32 v17, v117
    v_mfma_f32_16x16x32_bf16 a[136:139], v[168:171], v[32:35], a[136:139]
    ds_read_b128 v[28:31], v3 offset:0
    v_cvt_pk_bf16_f32 v151, v249, v253
    v_mfma_f32_16x16x32_bf16 a[136:139], v[184:187], v[36:39], a[136:139]
    v_cvt_pk_bf16_f32 v85, v18, v19
    v_cvt_pk_bf16_f32 v154, v242, v246
    v_mfma_f32_16x16x32_bf16 a[184:187], v[172:175], v[32:35], a[184:187]
    v_exp_f32 v18, v118
    v_mfma_f32_16x16x32_bf16 a[184:187], v[188:191], v[36:39], a[184:187]
    s_waitcnt lgkmcnt(2)
    v_add_f32 v6, v6, v16
    v_mfma_f32_16x16x32_bf16 a[44:47], v[160:163], v[40:43], a[44:47]
    ds_read_b128 v[32:35], v2 offset:6144
    v_add_f32 v6, v6, v17
    v_mfma_f32_16x16x32_bf16 a[44:47], v[176:179], v[44:47], a[44:47]
    v_exp_f32 v19, v119
    v_mfma_f32_16x16x32_bf16 a[92:95], v[164:167], v[40:43], a[92:95]
    v_cvt_pk_bf16_f32 v155, v250, v254
    v_mfma_f32_16x16x32_bf16 a[92:95], v[180:183], v[44:47], a[92:95]
    v_cvt_pk_bf16_f32 v86, v16, v17
    v_mfma_f32_16x16x32_bf16 a[140:143], v[168:171], v[40:43], a[140:143]
    ds_read_b128 v[36:39], v3 offset:6144
    v_add_f32 v6, v6, v18
    v_mfma_f32_16x16x32_bf16 a[140:143], v[184:187], v[44:47], a[140:143]
    v_add_f32 v6, v6, v19
    v_cvt_pk_bf16_f32 v87, v18, v19
    v_mfma_f32_16x16x32_bf16 a[188:191], v[172:175], v[40:43], a[188:191]
    v_mfma_f32_16x16x32_bf16 a[188:191], v[188:191], v[44:47], a[188:191]
    s_waitcnt lgkmcnt(2)
    v_mfma_f32_16x16x32_bf16 v[160:163], v[24:27], a[192:195], v[128:131]
    ds_read_b128 v[40:43], v2 offset:128
    v_mfma_f32_16x16x32_bf16 v[160:163], v[28:31], a[196:199], v[160:163]
    s_waitcnt vmcnt(4)
    v_subrev_u32 v52, s92, v52
    v_cmp_lt_u32 vcc, 15, v52
    v_mfma_f32_16x16x32_bf16 v[164:167], v[24:27], a[216:219], v[132:135]
    v_exp_f32 v16, v88
    v_mfma_f32_16x16x32_bf16 v[164:167], v[28:31], a[220:223], v[164:167]
    v_exp_f32 v17, v89
    v_mfma_f32_16x16x32_bf16 v[168:171], v[24:27], a[240:243], v[136:139]
    s_and_b32 s59, vcc_lo, 0xff
    ds_read_b128 v[44:47], v3 offset:128
    v_mfma_f32_16x16x32_bf16 v[168:171], v[28:31], a[244:247], v[168:171]
    s_cbranch_scc1 L_pollslow3
L_pollok3:
    v_mfma_f32_16x16x32_bf16 v[172:175], v[24:27], v[200:203], v[140:143]
    s_add_u32 s92, s92, 1
    v_exp_f32 v18, v90
    v_mfma_f32_16x16x32_bf16 v[172:175], v[28:31], v[204:207], v[172:175]
    s_waitcnt lgkmcnt(2)
    v_add_f32 v7, v7, v16
    v_add_f32 v7, v7, v17
    v_mfma_f32_16x16x32_bf16 v[96:99], v[32:35], a[192:195], v[128:131]
    ds_read_b128 v[24:27], v2 offset:6272
    v_mfma_f32_16x16x32_bf16 v[96:99], v[36:39], a[196:199], v[96:99]
    buffer_store_dwordx4 v[144:147], v15, s[4:7], s35 offen offset:0 sc1
    v_mfma_f32_16x16x32_bf16 v[100:103], v[32:35], a[216:219], v[132:135]
    v_exp_f32 v19, v91
    v_mfma_f32_16x16x32_bf16 v[100:103], v[36:39], a[220:223], v[100:103]
    v_cvt_pk_bf16_f32 v88, v16, v17
    v_mfma_f32_16x16x32_bf16 v[104:107], v[32:35], a[240:243], v[136:139]
    ds_read_b128 v[28:31], v3 offset:6272
    v_mfma_f32_16x16x32_bf16 v[104:107], v[36:39], a[244:247], v[104:107]
    v_exp_f32 v16, v120
    v_mfma_f32_16x16x32_bf16 v[108:111], v[32:35], v[200:203], v[140:143]
    v_add_f32 v7, v7, v18
    v_add_f32 v7, v7, v19
    v_mfma_f32_16x16x32_bf16 v[108:111], v[36:39], v[204:207], v[108:111]
    s_waitcnt lgkmcnt(2)
    v_exp_f32 v17, v121
    v_mfma_f32_16x16x32_bf16 v[160:163], v[40:43], a[200:203], v[160:163]
    ds_read_b128 v[32:35], v2 offset:256
    v_cvt_pk_bf16_f32 v89, v18, v19
    v_mfma_f32_16x16x32_bf16 v[160:163], v[44:47], a[204:207], v[160:163]
    buffer_store_dwordx4 v[148:151], v15, s[4:7], s35 offen offset:1024 sc1
    v_mfma_f32_16x16x32_bf16 v[164:167], v[40:43], a[224:227], v[164:167]
    v_exp_f32 v18, v122
    v_mfma_f32_16x16x32_bf16 v[164:167], v[44:47], a[228:231], v[164:167]
    v_add_f32 v7, v7, v16
    v_add_f32 v7, v7, v17
    v_mfma_f32_16x16x32_bf16 v[168:171], v[40:43], a[248:251], v[168:171]
    ds_read_b128 v[36:39], v3 offset:256
    v_mfma_f32_16x16x32_bf16 v[168:171], v[44:47], a[252:255], v[168:171]
    v_exp_f32 v19, v123
    v_mfma_f32_16x16x32_bf16 v[172:175], v[40:43], v[208:211], v[172:175]
    v_cvt_pk_bf16_f32 v90, v16, v17
    v_mfma_f32_16x16x32_bf16 v[172:175], v[44:47], v[212:215], v[172:175]
    s_waitcnt lgkmcnt(2)
    v_exp_f32 v16, v92
    v_mfma_f32_16x16x32_bf16 v[96:99], v[24:27], a[200:203], v[96:99]
    ds_read_b128 v[40:43], v2 offset:6400
    v_add_f32 v7, v7, v18
    v_mfma_f32_16x16x32_bf16 v[96:99], v[28:31], a[204:207], v[96:99]
    buffer_store_dwordx4 v[152:155], v15, s[4:7], s35 offen offset:2048 sc1
    v_mfma_f32_16x16x32_bf16 v[100:103], v[24:27], a[224:227], v[100:103]
    v_add_f32 v7, v7, v19
    v_mfma_f32_16x16x32_bf16 v[100:103], v[28:31], a[228:231], v[100:103]
    v_exp_f32 v17, v93
    v_mfma_f32_16x16x32_bf16 v[104:107], v[24:27], a[248:251], v[104:107]
    ds_read_b128 v[44:47], v3 offset:6400
    v_cvt_pk_bf16_f32 v91, v18, v19
    v_mfma_f32_16x16x32_bf16 v[104:107], v[28:31], a[252:255], v[104:107]
    v_exp_f32 v18, v94
    v_mfma_f32_16x16x32_bf16 v[108:111], v[24:27], v[208:211], v[108:111]
    s_add_u32 s29, s30, 49152
    v_add_f32 v8, v8, v16
    v_add_f32 v8, v8, v17
    v_mfma_f32_16x16x32_bf16 v[108:111], v[28:31], v[212:215], v[108:111]
    s_waitcnt lgkmcnt(2)
    v_exp_f32 v19, v95
    v_mfma_f32_16x16x32_bf16 v[160:163], v[32:35], a[208:211], v[160:163]
    s_sub_u32 s3, s29, 147456
    ds_read_b128 v[24:27], v2 offset:12288
    v_cvt_pk_bf16_f32 v92, v16, v17
    v_mfma_f32_16x16x32_bf16 v[160:163], v[36:39], a[212:215], v[160:163]
    s_min_u32 s29, s29, s3
    v_exp_f32 v16, v124
    v_mfma_f32_16x16x32_bf16 v[164:167], v[32:35], a[232:235], v[164:167]
    v_add_f32 v8, v8, v18
    v_add_f32 v8, v8, v19
    v_mfma_f32_16x16x32_bf16 v[164:167], v[36:39], a[236:239], v[164:167]
    v_exp_f32 v17, v125
    v_mfma_f32_16x16x32_bf16 v[168:171], v[32:35], v[192:195], v[168:171]
    ds_read_b128 v[28:31], v3 offset:12288
    v_mfma_f32_16x16x32_bf16 v[168:171], v[36:39], v[196:199], v[168:171]
    v_cvt_pk_bf16_f32 v93, v18, v19
    v_mfma_f32_16x16x32_bf16 v[172:175], v[32:35], v[216:219], v[172:175]
    v_exp_f32 v18, v126
    v_mfma_f32_16x16x32_bf16 v[172:175], v[36:39], v[220:223], v[172:175]
    s_waitcnt lgkmcnt(2)
    v_add_f32 v8, v8, v16
    v_mfma_f32_16x16x32_bf16 v[96:99], v[40:43], a[208:211], v[96:99]
    ds_read_b128 v[32:35], v2 offset:18432
    v_add_f32 v8, v8, v17
    v_mfma_f32_16x16x32_bf16 v[96:99], v[44:47], a[212:215], v[96:99]
    s_mov_b32 m0, s26
    v_exp_f32 v19, v127
    v_mfma_f32_16x16x32_bf16 v[100:103], v[40:43], a[232:235], v[100:103]
    s_sub_u32 s3, s29, s30
    v_mfma_f32_16x16x32_bf16 v[100:103], v[44:47], a[236:239], v[100:103]
    buffer_load_dwordx4 v4, s[4:7], s32 offen offset:0 sc1 lds
    v_mfma_f32_16x16x32_bf16 v[104:107], v[40:43], v[192:195], v[104:107]
    ds_read_b128 v[36:39], v3 offset:18432
    v_cvt_pk_bf16_f32 v94, v16, v17
    v_mfma_f32_16x16x32_bf16 v[104:107], v[44:47], v[196:199], v[104:107]
    v_add_f32 v8, v8, v18
    v_add_f32 v8, v8, v19
    v_mfma_f32_16x16x32_bf16 v[108:111], v[40:43], v[216:219], v[108:111]
    v_cvt_pk_bf16_f32 v95, v18, v19
    v_mfma_f32_16x16x32_bf16 v[108:111], v[44:47], v[220:223], v[108:111]
    s_waitcnt lgkmcnt(2)
    buffer_load_dwordx4 v4, s[4:7], s32 offen offset:1024 sc1 lds
    v_mfma_f32_16x16x32_bf16 v[176:179], v[24:27], a[192:195], v[128:131]
    ds_read_b128 v[40:43], v2 offset:12416
    v_mfma_f32_16x16x32_bf16 v[176:179], v[28:31], a[196:199], v[176:179]
    s_mov_b32 s30, s29
    v_exp_f32 v16, v160
    v_mfma_f32_16x16x32_bf16 v[180:183], v[24:27], a[216:219], v[132:135]
    v_exp_f32 v17, v161
    v_mfma_f32_16x16x32_bf16 v[180:183], v[28:31], a[220:223], v[180:183]
    buffer_load_dwordx4 v4, s[4:7], s32 offen offset:2048 sc1 lds
    v_mfma_f32_16x16x32_bf16 v[184:187], v[24:27], a[240:243], v[136:139]
    s_add_u32 s32, s32, 24576
    ds_read_b128 v[44:47], v3 offset:12416
    v_mfma_f32_16x16x32_bf16 v[184:187], v[28:31], a[244:247], v[184:187]
    v_exp_f32 v18, v162
    v_mfma_f32_16x16x32_bf16 v[188:191], v[24:27], v[200:203], v[140:143]
    s_add_u32 s26, s26, 12288
    v_add_f32 v5, v5, v16
    v_add_f32 v5, v5, v17
    v_mfma_f32_16x16x32_bf16 v[188:191], v[28:31], v[204:207], v[188:191]
    s_waitcnt lgkmcnt(2)
    v_exp_f32 v19, v163
    v_mfma_f32_16x16x32_bf16 v[112:115], v[32:35], a[192:195], v[128:131]
    s_mov_b32 m0, s26
    ds_read_b128 v[24:27], v2 offset:18560
    v_cvt_pk_bf16_f32 v160, v16, v17
    v_mfma_f32_16x16x32_bf16 v[112:115], v[36:39], a[196:199], v[112:115]
    v_exp_f32 v16, v96
    v_mfma_f32_16x16x32_bf16 v[116:119], v[32:35], a[216:219], v[132:135]
    v_add_f32 v5, v5, v18
    v_add_f32 v5, v5, v19
    v_mfma_f32_16x16x32_bf16 v[116:119], v[36:39], a[220:223], v[116:119]
    v_exp_f32 v17, v97
    v_mfma_f32_16x16x32_bf16 v[120:123], v[32:35], a[240:243], v[136:139]
    ds_read_b128 v[28:31], v3 offset:18560
    v_add_u32 v1, s3, v1
    v_mfma_f32_16x16x32_bf16 v[120:123], v[36:39], a[244:247], v[120:123]
    buffer_load_dwordx4 v4, s[4:7], s32 offen offset:0 sc1 lds
    v_mfma_f32_16x16x32_bf16 v[124:127], v[32:35], v[200:203], v[140:143]
    v_cvt_pk_bf16_f32 v161, v18, v19
    v_mfma_f32_16x16x32_bf16 v[124:127], v[36:39], v[204:207], v[124:127]
    s_waitcnt lgkmcnt(2)
    v_exp_f32 v18, v98
    v_mfma_f32_16x16x32_bf16 v[176:179], v[40:43], a[200:203], v[176:179]
    ds_read_b128 v[32:35], v2 offset:12544
    v_add_f32 v5, v5, v16
    v_mfma_f32_16x16x32_bf16 v[176:179], v[44:47], a[204:207], v[176:179]
    buffer_load_dwordx4 v4, s[4:7], s32 offen offset:1024 sc1 lds
    v_mfma_f32_16x16x32_bf16 v[180:183], v[40:43], a[224:227], v[180:183]
    v_add_f32 v5, v5, v17
    v_mfma_f32_16x16x32_bf16 v[180:183], v[44:47], a[228:231], v[180:183]
    v_exp_f32 v19, v99
    v_mfma_f32_16x16x32_bf16 v[184:187], v[40:43], a[248:251], v[184:187]
    ds_read_b128 v[36:39], v3 offset:12544
    v_cvt_pk_bf16_f32 v162, v16, v17
    v_mfma_f32_16x16x32_bf16 v[184:187], v[44:47], a[252:255], v[184:187]
    buffer_load_dwordx4 v4, s[4:7], s32 offen offset:2048 sc1 lds
    v_mfma_f32_16x16x32_bf16 v[188:191], v[40:43], v[208:211], v[188:191]
    v_exp_f32 v16, v164
    v_mfma_f32_16x16x32_bf16 v[188:191], v[44:47], v[212:215], v[188:191]
    s_waitcnt lgkmcnt(2)
    v_add_f32 v5, v5, v18
    v_add_f32 v5, v5, v19
    v_mfma_f32_16x16x32_bf16 v[112:115], v[24:27], a[200:203], v[112:115]
    ds_read_b128 v[40:43], v2 offset:18688
    v_mfma_f32_16x16x32_bf16 v[112:115], v[28:31], a[204:207], v[112:115]
    v_exp_f32 v17, v165
    v_mfma_f32_16x16x32_bf16 v[116:119], v[24:27], a[224:227], v[116:119]
    v_cvt_pk_bf16_f32 v163, v18, v19
    v_mfma_f32_16x16x32_bf16 v[116:119], v[28:31], a[228:231], v[116:119]
    s_add_u32 s32, s32, 24576
    v_exp_f32 v18, v166
    v_mfma_f32_16x16x32_bf16 v[120:123], v[24:27], a[248:251], v[120:123]
    s_add_u32 s26, s26, 36864
    ds_read_b128 v[44:47], v3 offset:18688
    v_add_f32 v6, v6, v16
    v_mfma_f32_16x16x32_bf16 v[120:123], v[28:31], a[252:255], v[120:123]
L_pg9:
    s_cbranch_execz L_pg13
    s_waitcnt lgkmcnt(2)
    v_add_f32 v6, v6, v17
    s_sub_u32 s57, s26, 147456
    v_mfma_f32_16x16x32_bf16 v[124:127], v[24:27], v[208:211], v[124:127]
    s_waitcnt vmcnt(6)
    v_exp_f32 v19, v167
    v_mfma_f32_16x16x32_bf16 v[124:127], v[28:31], v[212:215], v[124:127]
    s_barrier
    v_cvt_pk_bf16_f32 v164, v16, v17
    v_mfma_f32_16x16x32_bf16 v[176:179], v[32:35], a[208:211], v[176:179]
    s_min_u32 s26, s26, s57
    ds_read_b128 v[24:27], v1 offset:0
    v_add_u32 v0, 1, v0
    v_mfma_f32_16x16x32_bf16 v[176:179], v[36:39], a[212:215], v[176:179]
    buffer_store_dword v0, v13, s[20:23], 0 offen offset:32 sc1
    v_mfma_f32_16x16x32_bf16 v[180:183], v[32:35], a[232:235], v[180:183]
    v_exp_f32 v16, v100
    v_mfma_f32_16x16x32_bf16 v[180:183], v[36:39], a[236:239], v[180:183]
    v_add_f32 v6, v6, v18
    v_add_f32 v6, v6, v19
    v_mfma_f32_16x16x32_bf16 v[184:187], v[32:35], v[192:195], v[184:187]
    ds_read_b128 v[28:31], v1 offset:12288
    v_mfma_f32_16x16x32_bf16 v[184:187], v[36:39], v[196:199], v[184:187]
    v_exp_f32 v17, v101
    v_mfma_f32_16x16x32_bf16 v[188:191], v[32:35], v[216:219], v[188:191]
    v_cvt_pk_bf16_f32 v165, v18, v19
    v_mfma_f32_16x16x32_bf16 v[188:191], v[36:39], v[220:223], v[188:191]
    s_waitcnt lgkmcnt(2)
    v_exp_f32 v18, v102
    v_mfma_f32_16x16x32_bf16 v[112:115], v[40:43], a[208:211], v[112:115]
    ds_read_b128 v[32:35], v1 offset:1024
    v_add_f32 v6, v6, v16
    v_mfma_f32_16x16x32_bf16 v[112:115], v[44:47], a[212:215], v[112:115]
    v_add_f32 v6, v6, v17
    v_mfma_f32_16x16x32_bf16 v[116:119], v[40:43], a[232:235], v[116:119]
    v_exp_f32 v19, v103
    v_mfma_f32_16x16x32_bf16 v[116:119], v[44:47], a[236:239], v[116:119]
    v_cvt_pk_bf16_f32 v166, v16, v17
    v_mfma_f32_16x16x32_bf16 v[120:123], v[40:43], v[192:195], v[120:123]
    ds_read_b128 v[36:39], v1 offset:13312
    v_add_f32 v6, v6, v18
    v_mfma_f32_16x16x32_bf16 v[120:123], v[44:47], v[196:199], v[120:123]
    v_add_f32 v6, v6, v19
    v_cvt_pk_bf16_f32 v167, v18, v19
    v_mfma_f32_16x16x32_bf16 v[124:127], v[40:43], v[216:219], v[124:127]
    v_mfma_f32_16x16x32_bf16 v[124:127], v[44:47], v[220:223], v[124:127]
    s_waitcnt lgkmcnt(2)
    v_mfma_f32_16x16x32_bf16 a[0:3], v[64:67], v[24:27], a[0:3]
    s_mov_b32 m0, s26
    ds_read_b128 v[40:43], v1 offset:2048
    v_mfma_f32_16x16x32_bf16 a[0:3], v[80:83], v[28:31], a[0:3]
    buffer_load_dwordx4 v4, s[4:7], s32 offen offset:0 sc1 lds
    v_mfma_f32_16x16x32_bf16 a[48:51], v[68:71], v[24:27], a[48:51]
    v_exp_f32 v16, v168
    v_mfma_f32_16x16x32_bf16 a[48:51], v[84:87], v[28:31], a[48:51]
    v_exp_f32 v17, v169
    v_mfma_f32_16x16x32_bf16 a[96:99], v[72:75], v[24:27], a[96:99]
    ds_read_b128 v[44:47], v1 offset:14336
    v_mfma_f32_16x16x32_bf16 a[96:99], v[88:91], v[28:31], a[96:99]
    v_exp_f32 v18, v170
    v_mfma_f32_16x16x32_bf16 a[144:147], v[76:79], v[24:27], a[144:147]
    v_add_f32 v7, v7, v16
    v_add_f32 v7, v7, v17
    v_mfma_f32_16x16x32_bf16 a[144:147], v[92:95], v[28:31], a[144:147]
    s_waitcnt lgkmcnt(2)
    v_exp_f32 v19, v171
    v_mfma_f32_16x16x32_bf16 a[4:7], v[64:67], v[32:35], a[4:7]
    ds_read_b128 v[24:27], v1 offset:3072
    v_cvt_pk_bf16_f32 v168, v16, v17
    v_mfma_f32_16x16x32_bf16 a[4:7], v[80:83], v[36:39], a[4:7]
    v_exp_f32 v16, v104
    v_mfma_f32_16x16x32_bf16 a[52:55], v[68:71], v[32:35], a[52:55]
    v_add_f32 v7, v7, v18
    v_add_f32 v7, v7, v19
    v_mfma_f32_16x16x32_bf16 a[52:55], v[84:87], v[36:39], a[52:55]
    buffer_load_dwordx4 v4, s[4:7], s32 offen offset:1024 sc1 lds
    v_mfma_f32_16x16x32_bf16 a[100:103], v[72:75], v[32:35], a[100:103]
    ds_read_b128 v[28:31], v1 offset:15360
    v_mfma_f32_16x16x32_bf16 a[100:103], v[88:91], v[36:39], a[100:103]
    v_exp_f32 v17, v105
    v_mfma_f32_16x16x32_bf16 a[148:151], v[76:79], v[32:35], a[148:151]
    v_cvt_pk_bf16_f32 v169, v18, v19
    v_mfma_f32_16x16x32_bf16 a[148:151], v[92:95], v[36:39], a[148:151]
    s_waitcnt lgkmcnt(2)
    v_exp_f32 v18, v106
    v_mfma_f32_16x16x32_bf16 a[8:11], v[64:67], v[40:43], a[8:11]
    ds_read_b128 v[32:35], v1 offset:4096
    v_add_f32 v7, v7, v16
    v_mfma_f32_16x16x32_bf16 a[8:11], v[80:83], v[44:47], a[8:11]
    v_add_f32 v7, v7, v17
    v_mfma_f32_16x16x32_bf16 a[56:59], v[68:71], v[40:43], a[56:59]
    v_exp_f32 v19, v107
    v_mfma_f32_16x16x32_bf16 a[56:59], v[84:87], v[44:47], a[56:59]
    v_cvt_pk_bf16_f32 v170, v16, v17
    v_mfma_f32_16x16x32_bf16 a[104:107], v[72:75], v[40:43], a[104:107]
    ds_read_b128 v[36:39], v1 offset:16384
    v_mfma_f32_16x16x32_bf16 a[104:107], v[88:91], v[44:47], a[104:107]
    v_exp_f32 v16, v172
    v_mfma_f32_16x16x32_bf16 a[152:155], v[76:79], v[40:43], a[152:155]
    v_add_f32 v7, v7, v18
    v_add_f32 v7, v7, v19
    v_mfma_f32_16x16x32_bf16 a[152:155], v[92:95], v[44:47], a[152:155]
    s_waitcnt lgkmcnt(2)
    buffer_load_dwordx4 v4, s[4:7], s32 offen offset:2048 sc1 lds
    v_mfma_f32_16x16x32_bf16 a[12:15], v[64:67], v[24:27], a[12:15]
    ds_read_b128 v[40:43], v1 offset:5120
    v_mfma_f32_16x16x32_bf16 a[12:15], v[80:83], v[28:31], a[12:15]
    v_exp_f32 v17, v173
    v_mfma_f32_16x16x32_bf16 a[60:63], v[68:71], v[24:27], a[60:63]
    v_cvt_pk_bf16_f32 v171, v18, v19
    v_mfma_f32_16x16x32_bf16 a[60:63], v[84:87], v[28:31], a[60:63]
    v_exp_f32 v18, v174
    v_mfma_f32_16x16x32_bf16 a[108:111], v[72:75], v[24:27], a[108:111]
    ds_read_b128 v[44:47], v1 offset:17408
    v_add_f32 v8, v8, v16
    v_mfma_f32_16x16x32_bf16 a[108:111], v[88:91], v[28:31], a[108:111]
    v_add_f32 v8, v8, v17
    v_mfma_f32_16x16x32_bf16 a[156:159], v[76:79], v[24:27], a[156:159]
    s_add_u32 s29, s28, 49152
    v_exp_f32 v19, v175
    v_mfma_f32_16x16x32_bf16 a[156:159], v[92:95], v[28:31], a[156:159]
    s_waitcnt lgkmcnt(2)
    v_cvt_pk_bf16_f32 v172, v16, v17
    s_sub_u32 s3, s29, 147456
    v_mfma_f32_16x16x32_bf16 a[16:19], v[64:67], v[32:35], a[16:19]
    s_add_u32 s32, s32, 24576
    ds_read_b128 v[24:27], v1 offset:6144
    v_mfma_f32_16x16x32_bf16 a[16:19], v[80:83], v[36:39], a[16:19]
    s_min_u32 s29, s29, s3
    v_exp_f32 v16, v108
    v_mfma_f32_16x16x32_bf16 a[64:67], v[68:71], v[32:35], a[64:67]
    v_add_f32 v8, v8, v18
    v_add_f32 v8, v8, v19
    v_mfma_f32_16x16x32_bf16 a[64:67], v[84:87], v[36:39], a[64:67]
    v_exp_f32 v17, v109
    v_mfma_f32_16x16x32_bf16 a[112:115], v[72:75], v[32:35], a[112:115]
    s_add_u32 s26, s26, 12288
    ds_read_b128 v[28:31], v1 offset:18432
    v_mfma_f32_16x16x32_bf16 a[112:115], v[88:91], v[36:39], a[112:115]
    v_cvt_pk_bf16_f32 v173, v18, v19
    v_mfma_f32_16x16x32_bf16 a[160:163], v[76:79], v[32:35], a[160:163]
    v_exp_f32 v18, v110
    v_mfma_f32_16x16x32_bf16 a[160:163], v[92:95], v[36:39], a[160:163]
    s_waitcnt lgkmcnt(2)
    v_add_f32 v8, v8, v16
    v_mfma_f32_16x16x32_bf16 a[20:23], v[64:67], v[40:43], a[20:23]
    s_sub_u32 s3, s29, s28
    ds_read_b128 v[32:35], v1 offset:7168
    v_add_f32 v8, v8, v17
    v_mfma_f32_16x16x32_bf16 a[20:23], v[80:83], v[44:47], a[20:23]
    v_exp_f32 v19, v111
    v_mfma_f32_16x16x32_bf16 a[68:71], v[68:71], v[40:43], a[68:71]
    s_mov_b32 m0, s26
    v_mfma_f32_16x16x32_bf16 a[68:71], v[84:87], v[44:47], a[68:71]
    v_cvt_pk_bf16_f32 v174, v16, v17
    v_mfma_f32_16x16x32_bf16 a[116:119], v[72:75], v[40:43], a[116:119]
    ds_read_b128 v[36:39], v1 offset:19456
    v_add_f32 v8, v8, v18
    v_mfma_f32_16x16x32_bf16 a[116:119], v[88:91], v[44:47], a[116:119]
    v_add_f32 v8, v8, v19
    v_cvt_pk_bf16_f32 v175, v18, v19
    v_mfma_f32_16x16x32_bf16 a[164:167], v[76:79], v[40:43], a[164:167]
    s_mov_b32 s28, s29
    v_mfma_f32_16x16x32_bf16 a[164:167], v[92:95], v[44:47], a[164:167]
    s_waitcnt lgkmcnt(2)
    v_exp_f32 v16, v176
    v_mfma_f32_16x16x32_bf16 a[24:27], v[64:67], v[24:27], a[24:27]
    ds_read_b128 v[40:43], v1 offset:8192
    v_mfma_f32_16x16x32_bf16 a[24:27], v[80:83], v[28:31], a[24:27]
    v_exp_f32 v17, v177
    v_mfma_f32_16x16x32_bf16 a[72:75], v[68:71], v[24:27], a[72:75]
    v_exp_f32 v18, v178
    v_mfma_f32_16x16x32_bf16 a[72:75], v[84:87], v[28:31], a[72:75]
    buffer_load_dwordx4 v4, s[4:7], s32 offen offset:0 sc1 lds
    v_mfma_f32_16x16x32_bf16 a[120:123], v[72:75], v[24:27], a[120:123]
    ds_read_b128 v[44:47], v1 offset:20480
    v_add_f32 v5, v5, v16
    v_mfma_f32_16x16x32_bf16 a[120:123], v[88:91], v[28:31], a[120:123]
    v_add_f32 v5, v5, v17
    v_add_u32 v2, s3, v2
    v_mfma_f32_16x16x32_bf16 a[168:171], v[76:79], v[24:27], a[168:171]
    v_exp_f32 v19, v179
    v_mfma_f32_16x16x32_bf16 a[168:171], v[92:95], v[28:31], a[168:171]
    s_waitcnt lgkmcnt(2)
    v_cvt_pk_bf16_f32 v176, v16, v17
    v_mfma_f32_16x16x32_bf16 a[28:31], v[64:67], v[32:35], a[28:31]
    ds_read_b128 v[24:27], v1 offset:9216
    v_mfma_f32_16x16x32_bf16 a[28:31], v[80:83], v[36:39], a[28:31]
    v_exp_f32 v16, v112
    v_mfma_f32_16x16x32_bf16 a[76:79], v[68:71], v[32:35], a[76:79]
    v_add_f32 v5, v5, v18
    v_add_f32 v5, v5, v19
    v_mfma_f32_16x16x32_bf16 a[76:79], v[84:87], v[36:39], a[76:79]
    v_exp_f32 v17, v113
    v_mfma_f32_16x16x32_bf16 a[124:127], v[72:75], v[32:35], a[124:127]
    ds_read_b128 v[28:31], v1 offset:21504
    v_add_u32 v3, s3, v3
    v_mfma_f32_16x16x32_bf16 a[124:127], v[88:91], v[36:39], a[124:127]
    v_cvt_pk_bf16_f32 v177, v18, v19
    v_mfma_f32_16x16x32_bf16 a[172:175], v[76:79], v[32:35], a[172:175]
    v_exp_f32 v18, v114
    v_mfma_f32_16x16x32_bf16 a[172:175], v[92:95], v[36:39], a[172:175]
    s_waitcnt lgkmcnt(2)
    buffer_load_dwordx4 v4, s[4:7], s32 offen offset:1024 sc1 lds
    v_mfma_f32_16x16x32_bf16 a[32:35], v[64:67], v[40:43], a[32:35]
    ds_read_b128 v[32:35], v1 offset:10240
    v_add_f32 v5, v5, v16
    v_mfma_f32_16x16x32_bf16 a[32:35], v[80:83], v[44:47], a[32:35]
    v_add_f32 v5, v5, v17
    v_mfma_f32_16x16x32_bf16 a[80:83], v[68:71], v[40:43], a[80:83]
    v_exp_f32 v19, v115
    v_mfma_f32_16x16x32_bf16 a[80:83], v[84:87], v[44:47], a[80:83]
    v_cvt_pk_bf16_f32 v178, v16, v17
    v_mfma_f32_16x16x32_bf16 a[128:131], v[72:75], v[40:43], a[128:131]
    ds_read_b128 v[36:39], v1 offset:22528
    v_mfma_f32_16x16x32_bf16 a[128:131], v[88:91], v[44:47], a[128:131]
    v_exp_f32 v16, v180
    v_mfma_f32_16x16x32_bf16 a[176:179], v[76:79], v[40:43], a[176:179]
    v_add_f32 v5, v5, v18
    v_add_f32 v5, v5, v19
    v_mfma_f32_16x16x32_bf16 a[176:179], v[92:95], v[44:47], a[176:179]
    s_waitcnt lgkmcnt(2)
    v_exp_f32 v17, v181
    v_mfma_f32_16x16x32_bf16 a[36:39], v[64:67], v[24:27], a[36:39]
    ds_read_b128 v[40:43], v1 offset:11264
    v_mfma_f32_16x16x32_bf16 a[36:39], v[80:83], v[28:31], a[36:39]
    buffer_load_dwordx4 v4, s[4:7], s32 offen offset:2048 sc1 lds
    v_mfma_f32_16x16x32_bf16 a[84:87], v[68:71], v[24:27], a[84:87]
    v_cvt_pk_bf16_f32 v179, v18, v19
    v_mfma_f32_16x16x32_bf16 a[84:87], v[84:87], v[28:31], a[84:87]
    v_exp_f32 v18, v182
    v_mfma_f32_16x16x32_bf16 a[132:135], v[72:75], v[24:27], a[132:135]
    ds_read_b128 v[44:47], v1 offset:23552
    v_add_f32 v6, v6, v16
    v_mfma_f32_16x16x32_bf16 a[132:135], v[88:91], v[28:31], a[132:135]
    s_waitcnt lgkmcnt(2)
    v_add_f32 v6, v6, v17
    v_mfma_f32_16x16x32_bf16 a[180:183], v[76:79], v[24:27], a[180:183]
    s_waitcnt vmcnt(7)
    v_exp_f32 v19, v183
    v_mfma_f32_16x16x32_bf16 a[180:183], v[92:95], v[28:31], a[180:183]
    s_barrier
    v_cvt_pk_bf16_f32 v180, v16, v17
    v_mfma_f32_16x16x32_bf16 a[40:43], v[64:67], v[32:35], a[40:43]
    ds_read_b128 v[24:27], v2 offset:0
    v_mfma_f32_16x16x32_bf16 a[40:43], v[80:83], v[36:39], a[40:43]
    v_exp_f32 v16, v116
    v_mfma_f32_16x16x32_bf16 a[88:91], v[68:71], v[32:35], a[88:91]
    v_add_f32 v6, v6, v18
    v_add_f32 v6, v6, v19
    v_mfma_f32_16x16x32_bf16 a[88:91], v[84:87], v[36:39], a[88:91]
    v_exp_f32 v17, v117
    v_mfma_f32_16x16x32_bf16 a[136:139], v[72:75], v[32:35], a[136:139]
    ds_read_b128 v[28:31], v3 offset:0
    v_mfma_f32_16x16x32_bf16 a[136:139], v[88:91], v[36:39], a[136:139]
    v_cvt_pk_bf16_f32 v181, v18, v19
    v_mfma_f32_16x16x32_bf16 a[184:187], v[76:79], v[32:35], a[184:187]
    v_exp_f32 v18, v118
    v_mfma_f32_16x16x32_bf16 a[184:187], v[92:95], v[36:39], a[184:187]
    s_waitcnt lgkmcnt(2)
    v_add_f32 v6, v6, v16
    v_mfma_f32_16x16x32_bf16 a[44:47], v[64:67], v[40:43], a[44:47]
    ds_read_b128 v[32:35], v2 offset:6144
    v_add_f32 v6, v6, v17
    v_mfma_f32_16x16x32_bf16 a[44:47], v[80:83], v[44:47], a[44:47]
    v_exp_f32 v19, v119
    v_mfma_f32_16x16x32_bf16 a[92:95], v[68:71], v[40:43], a[92:95]
    v_mfma_f32_16x16x32_bf16 a[92:95], v[84:87], v[44:47], a[92:95]
    s_add_u32 s32, s32, 24576
    s_add_u32 s26, s26, 36864
    v_cvt_pk_bf16_f32 v182, v16, v17
    v_mfma_f32_16x16x32_bf16 a[140:143], v[72:75], v[40:43], a[140:143]
    s_sub_u32 s57, s26, 147456
    ds_read_b128 v[36:39], v3 offset:6144
    v_add_f32 v6, v6, v18
    v_mfma_f32_16x16x32_bf16 a[140:143], v[88:91], v[44:47], a[140:143]
    s_min_u32 s26, s26, s57
    v_add_f32 v6, v6, v19
    v_cvt_pk_bf16_f32 v183, v18, v19
    v_mfma_f32_16x16x32_bf16 a[188:191], v[76:79], v[40:43], a[188:191]
    v_mfma_f32_16x16x32_bf16 a[188:191], v[92:95], v[44:47], a[188:191]
    s_waitcnt lgkmcnt(2)
    v_mfma_f32_16x16x32_bf16 v[64:67], v[24:27], a[192:195], v[128:131]
    ds_read_b128 v[40:43], v2 offset:128
    v_mfma_f32_16x16x32_bf16 v[64:67], v[28:31], a[196:199], v[64:67]
    v_exp_f32 v16, v184
    v_mfma_f32_16x16x32_bf16 v[68:71], v[24:27], a[216:219], v[132:135]
    v_exp_f32 v17, v185
    v_mfma_f32_16x16x32_bf16 v[68:71], v[28:31], a[220:223], v[68:71]
    buffer_load_dword v52, v20, s[20:23], s44 offen sc1
    v_mfma_f32_16x16x32_bf16 v[72:75], v[24:27], a[240:243], v[136:139]
    ds_read_b128 v[44:47], v3 offset:128
    v_mfma_f32_16x16x32_bf16 v[72:75], v[28:31], a[244:247], v[72:75]
    v_exp_f32 v18, v186
    v_mfma_f32_16x16x32_bf16 v[76:79], v[24:27], v[200:203], v[140:143]
    v_add_f32 v7, v7, v16
    v_add_f32 v7, v7, v17
    v_mfma_f32_16x16x32_bf16 v[76:79], v[28:31], v[204:207], v[76:79]
    s_waitcnt lgkmcnt(2)
    v_exp_f32 v19, v187
    v_mfma_f32_16x16x32_bf16 v[96:99], v[32:35], a[192:195], v[128:131]
    ds_read_b128 v[24:27], v2 offset:6272
    v_cvt_pk_bf16_f32 v184, v16, v17
    v_mfma_f32_16x16x32_bf16 v[96:99], v[36:39], a[196:199], v[96:99]
    v_exp_f32 v16, v120
    v_mfma_f32_16x16x32_bf16 v[100:103], v[32:35], a[216:219], v[132:135]
    v_add_f32 v7, v7, v18
    v_add_f32 v7, v7, v19
    v_mfma_f32_16x16x32_bf16 v[100:103], v[36:39], a[220:223], v[100:103]
    s_mov_b32 m0, s26
    v_exp_f32 v17, v121
    v_mfma_f32_16x16x32_bf16 v[104:107], v[32:35], a[240:243], v[136:139]
    ds_read_b128 v[28:31], v3 offset:6272
    v_mfma_f32_16x16x32_bf16 v[104:107], v[36:39], a[244:247], v[104:107]
    buffer_load_dwordx4 v4, s[4:7], s32 offen offset:0 sc1 lds
    v_mfma_f32_16x16x32_bf16 v[108:111], v[32:35], v[200:203], v[140:143]
    v_cvt_pk_bf16_f32 v185, v18, v19
    v_mfma_f32_16x16x32_bf16 v[108:111], v[36:39], v[204:207], v[108:111]
    s_waitcnt lgkmcnt(2)
    v_exp_f32 v18, v122
    v_mfma_f32_16x16x32_bf16 v[64:67], v[40:43], a[200:203], v[64:67]
    ds_read_b128 v[32:35], v2 offset:256
    v_add_f32 v7, v7, v16
    v_mfma_f32_16x16x32_bf16 v[64:67], v[44:47], a[204:207], v[64:67]
    v_add_f32 v7, v7, v17
    v_mfma_f32_16x16x32_bf16 v[68:71], v[40:43], a[224:227], v[68:71]
    v_exp_f32 v19, v123
    v_mfma_f32_16x16x32_bf16 v[68:71], v[44:47], a[228:231], v[68:71]
    v_cvt_pk_bf16_f32 v186, v16, v17
    v_mfma_f32_16x16x32_bf16 v[72:75], v[40:43], a[248:251], v[72:75]
    ds_read_b128 v[36:39], v3 offset:256
    v_mfma_f32_16x16x32_bf16 v[72:75], v[44:47], a[252:255], v[72:75]
    buffer_load_dwordx4 v4, s[4:7], s32 offen offset:1024 sc1 lds
    v_mfma_f32_16x16x32_bf16 v[76:79], v[40:43], v[208:211], v[76:79]
    v_exp_f32 v16, v188
    v_mfma_f32_16x16x32_bf16 v[76:79], v[44:47], v[212:215], v[76:79]
    s_waitcnt lgkmcnt(2)
    v_add_f32 v7, v7, v18
    v_add_f32 v7, v7, v19
    v_mfma_f32_16x16x32_bf16 v[96:99], v[24:27], a[200:203], v[96:99]
    ds_read_b128 v[40:43], v2 offset:6400
    v_mfma_f32_16x16x32_bf16 v[96:99], v[28:31], a[204:207], v[96:99]
    v_exp_f32 v17, v189
    v_mfma_f32_16x16x32_bf16 v[100:103], v[24:27], a[224:227], v[100:103]
    v_cvt_pk_bf16_f32 v187, v18, v19
    v_mfma_f32_16x16x32_bf16 v[100:103], v[28:31], a[228:231], v[100:103]
    v_exp_f32 v18, v190
    v_mfma_f32_16x16x32_bf16 v[104:107], v[24:27], a[248:251], v[104:107]
    ds_read_b128 v[44:47], v3 offset:6400
    v_add_f32 v8, v8, v16
    v_mfma_f32_16x16x32_bf16 v[104:107], v[28:31], a[252:255], v[104:107]
    v_add_f32 v8, v8, v17
    v_mfma_f32_16x16x32_bf16 v[108:111], v[24:27], v[208:211], v[108:111]
    s_add_u32 s29, s30, 49152
    v_exp_f32 v19, v191
    v_mfma_f32_16x16x32_bf16 v[108:111], v[28:31], v[212:215], v[108:111]
    s_waitcnt lgkmcnt(2)
    buffer_load_dwordx4 v4, s[4:7], s32 offen offset:2048 sc1 lds
    v_mfma_f32_16x16x32_bf16 v[64:67], v[32:35], a[208:211], v[64:67]
    s_sub_u32 s3, s29, 147456
    ds_read_b128 v[24:27], v2 offset:12288
    v_cvt_pk_bf16_f32 v188, v16, v17
    v_mfma_f32_16x16x32_bf16 v[64:67], v[36:39], a[212:215], v[64:67]
    s_min_u32 s29, s29, s3
    v_exp_f32 v16, v124
    v_mfma_f32_16x16x32_bf16 v[68:71], v[32:35], a[232:235], v[68:71]
    v_add_f32 v8, v8, v18
    v_add_f32 v8, v8, v19
    v_mfma_f32_16x16x32_bf16 v[68:71], v[36:39], a[236:239], v[68:71]
    v_exp_f32 v17, v125
    v_mfma_f32_16x16x32_bf16 v[72:75], v[32:35], v[192:195], v[72:75]
    ds_read_b128 v[28:31], v3 offset:12288
    v_mfma_f32_16x16x32_bf16 v[72:75], v[36:39], v[196:199], v[72:75]
    v_cvt_pk_bf16_f32 v189, v18, v19
    v_mfma_f32_16x16x32_bf16 v[76:79], v[32:35], v[216:219], v[76:79]
    v_exp_f32 v18, v126
    v_mfma_f32_16x16x32_bf16 v[76:79], v[36:39], v[220:223], v[76:79]
    s_waitcnt lgkmcnt(2)
    v_add_f32 v8, v8, v16
    s_add_u32 s32, s32, 24576
    v_mfma_f32_16x16x32_bf16 v[96:99], v[40:43], a[208:211], v[96:99]
    ds_read_b128 v[32:35], v2 offset:18432
    v_add_f32 v8, v8, v17
    v_mfma_f32_16x16x32_bf16 v[96:99], v[44:47], a[212:215], v[96:99]
    s_sub_u32 s3, s29, s30
    v_exp_f32 v19, v127
    v_mfma_f32_16x16x32_bf16 v[100:103], v[40:43], a[232:235], v[100:103]
    v_mfma_f32_16x16x32_bf16 v[100:103], v[44:47], a[236:239], v[100:103]
    v_cvt_pk_bf16_f32 v190, v16, v17
    v_mfma_f32_16x16x32_bf16 v[104:107], v[40:43], v[192:195], v[104:107]
    s_add_u32 s26, s26, 12288
    ds_read_b128 v[36:39], v3 offset:18432
    v_add_f32 v8, v8, v18
    v_mfma_f32_16x16x32_bf16 v[104:107], v[44:47], v[196:199], v[104:107]
    v_add_f32 v8, v8, v19
    v_cvt_pk_bf16_f32 v191, v18, v19
    v_mfma_f32_16x16x32_bf16 v[108:111], v[40:43], v[216:219], v[108:111]
    v_mfma_f32_16x16x32_bf16 v[108:111], v[44:47], v[220:223], v[108:111]
    s_waitcnt lgkmcnt(2)
    v_exp_f32 v16, v64
    v_mfma_f32_16x16x32_bf16 v[80:83], v[24:27], a[192:195], v[128:131]
    ds_read_b128 v[40:43], v2 offset:12416
    v_mfma_f32_16x16x32_bf16 v[80:83], v[28:31], a[196:199], v[80:83]
    s_mov_b32 m0, s26
    v_exp_f32 v17, v65
    v_mfma_f32_16x16x32_bf16 v[84:87], v[24:27], a[216:219], v[132:135]
    s_mov_b32 s30, s29
    v_exp_f32 v18, v66
    v_mfma_f32_16x16x32_bf16 v[84:87], v[28:31], a[220:223], v[84:87]
    v_add_f32 v5, v5, v16
    v_mfma_f32_16x16x32_bf16 v[88:91], v[24:27], a[240:243], v[136:139]
    ds_read_b128 v[44:47], v3 offset:12416
    v_add_f32 v5, v5, v17
    v_mfma_f32_16x16x32_bf16 v[88:91], v[28:31], a[244:247], v[88:91]
    v_exp_f32 v19, v67
    v_mfma_f32_16x16x32_bf16 v[92:95], v[24:27], v[200:203], v[140:143]
    v_mfma_f32_16x16x32_bf16 v[92:95], v[28:31], v[204:207], v[92:95]
    s_waitcnt lgkmcnt(2)
    v_cvt_pk_bf16_f32 v64, v16, v17
    v_mfma_f32_16x16x32_bf16 v[112:115], v[32:35], a[192:195], v[128:131]
    ds_read_b128 v[24:27], v2 offset:18560
    v_mfma_f32_16x16x32_bf16 v[112:115], v[36:39], a[196:199], v[112:115]
    buffer_load_dwordx4 v4, s[4:7], s32 offen offset:0 sc1 lds
    v_mfma_f32_16x16x32_bf16 v[116:119], v[32:35], a[216:219], v[132:135]
    v_exp_f32 v16, v96
    v_mfma_f32_16x16x32_bf16 v[116:119], v[36:39], a[220:223], v[116:119]
    v_add_f32 v5, v5, v18
    v_add_f32 v5, v5, v19
    v_mfma_f32_16x16x32_bf16 v[120:123], v[32:35], a[240:243], v[136:139]
    ds_read_b128 v[28:31], v3 offset:18560
    v_add_u32 v1, s3, v1
    v_mfma_f32_16x16x32_bf16 v[120:123], v[36:39], a[244:247], v[120:123]
    v_exp_f32 v17, v97
    v_mfma_f32_16x16x32_bf16 v[124:127], v[32:35], v[200:203], v[140:143]
    v_cvt_pk_bf16_f32 v65, v18, v19
    v_mfma_f32_16x16x32_bf16 v[124:127], v[36:39], v[204:207], v[124:127]
    s_waitcnt lgkmcnt(2)
    v_exp_f32 v18, v98
    v_mfma_f32_16x16x32_bf16 v[80:83], v[40:43], a[200:203], v[80:83]
    ds_read_b128 v[32:35], v2 offset:12544
    v_add_f32 v5, v5, v16
    v_mfma_f32_16x16x32_bf16 v[80:83], v[44:47], a[204:207], v[80:83]
    v_add_f32 v5, v5, v17
    v_mfma_f32_16x16x32_bf16 v[84:87], v[40:43], a[224:227], v[84:87]
    v_exp_f32 v19, v99
    v_mfma_f32_16x16x32_bf16 v[84:87], v[44:47], a[228:231], v[84:87]
    buffer_load_dwordx4 v4, s[4:7], s32 offen offset:1024 sc1 lds
    v_mfma_f32_16x16x32_bf16 v[88:91], v[40:43], a[248:251], v[88:91]
    ds_read_b128 v[36:39], v3 offset:12544
    v_cvt_pk_bf16_f32 v66, v16, v17
    v_mfma_f32_16x16x32_bf16 v[88:91], v[44:47], a[252:255], v[88:91]
    v_exp_f32 v16, v68
    v_mfma_f32_16x16x32_bf16 v[92:95], v[40:43], v[208:211], v[92:95]
    v_add_f32 v5, v5, v18
    v_add_f32 v5, v5, v19
    v_mfma_f32_16x16x32_bf16 v[92:95], v[44:47], v[212:215], v[92:95]
    s_waitcnt lgkmcnt(2)
    v_exp_f32 v17, v69
    v_mfma_f32_16x16x32_bf16 v[112:115], v[24:27], a[200:203], v[112:115]
    ds_read_b128 v[40:43], v2 offset:18688
    v_mfma_f32_16x16x32_bf16 v[112:115], v[28:31], a[204:207], v[112:115]
    v_cvt_pk_bf16_f32 v67, v18, v19
    v_mfma_f32_16x16x32_bf16 v[116:119], v[24:27], a[224:227], v[116:119]
    v_exp_f32 v18, v70
    v_mfma_f32_16x16x32_bf16 v[116:119], v[28:31], a[228:231], v[116:119]
    v_add_f32 v6, v6, v16
    v_mfma_f32_16x16x32_bf16 v[120:123], v[24:27], a[248:251], v[120:123]
    ds_read_b128 v[44:47], v3 offset:18688
    v_add_f32 v6, v6, v17
    v_mfma_f32_16x16x32_bf16 v[120:123], v[28:31], a[252:255], v[120:123]
    s_waitcnt lgkmcnt(2)
    buffer_load_dwordx4 v4, s[4:7], s32 offen offset:2048 sc1 lds
    v_mfma_f32_16x16x32_bf16 v[124:127], v[24:27], v[208:211], v[124:127]
    s_waitcnt vmcnt(7)
    v_exp_f32 v19, v71
    v_mfma_f32_16x16x32_bf16 v[124:127], v[28:31], v[212:215], v[124:127]
    s_barrier
    v_cvt_pk_bf16_f32 v68, v16, v17
    v_mfma_f32_16x16x32_bf16 v[80:83], v[32:35], a[208:211], v[80:83]
    ds_read_b128 v[24:27], v1 offset:0
    v_mfma_f32_16x16x32_bf16 v[80:83], v[36:39], a[212:215], v[80:83]
    v_exp_f32 v16, v100
    v_mfma_f32_16x16x32_bf16 v[84:87], v[32:35], a[232:235], v[84:87]
    v_add_f32 v6, v6, v18
    v_add_f32 v6, v6, v19
    v_mfma_f32_16x16x32_bf16 v[84:87], v[36:39], a[236:239], v[84:87]
    v_exp_f32 v17, v101
    v_mfma_f32_16x16x32_bf16 v[88:91], v[32:35], v[192:195], v[88:91]
    ds_read_b128 v[28:31], v1 offset:12288
    v_mfma_f32_16x16x32_bf16 v[88:91], v[36:39], v[196:199], v[88:91]
    v_cvt_pk_bf16_f32 v69, v18, v19
    v_mfma_f32_16x16x32_bf16 v[92:95], v[32:35], v[216:219], v[92:95]
    v_exp_f32 v18, v102
    v_mfma_f32_16x16x32_bf16 v[92:95], v[36:39], v[220:223], v[92:95]
    s_waitcnt lgkmcnt(2)
    v_add_f32 v6, v6, v16
    v_mfma_f32_16x16x32_bf16 v[112:115], v[40:43], a[208:211], v[112:115]
    ds_read_b128 v[32:35], v1 offset:1024
    v_add_f32 v6, v6, v17
    v_mfma_f32_16x16x32_bf16 v[112:115], v[44:47], a[212:215], v[112:115]
    v_exp_f32 v19, v103
    v_mfma_f32_16x16x32_bf16 v[116:119], v[40:43], a[232:235], v[116:119]
    v_mfma_f32_16x16x32_bf16 v[116:119], v[44:47], a[236:239], v[116:119]
    v_cvt_pk_bf16_f32 v70, v16, v17
    v_mfma_f32_16x16x32_bf16 v[120:123], v[40:43], v[192:195], v[120:123]
    ds_read_b128 v[36:39], v1 offset:13312
    v_add_f32 v6, v6, v18
    v_mfma_f32_16x16x32_bf16 v[120:123], v[44:47], v[196:199], v[120:123]
    s_add_u32 s32, s32, 24576
    s_add_u32 s26, s26, 36864
    v_add_f32 v6, v6, v19
    v_mfma_f32_16x16x32_bf16 v[124:127], v[40:43], v[216:219], v[124:127]
    s_sub_u32 s57, s26, 147456
    v_cvt_pk_bf16_f32 v71, v18, v19
    s_min_u32 s26, s26, s57
    v_mfma_f32_16x16x32_bf16 v[124:127], v[44:47], v[220:223], v[124:127]
    s_waitcnt lgkmcnt(2)
    v_mfma_f32_16x16x32_bf16 a[0:3], v[160:163], v[24:27], a[0:3]
    ds_read_b128 v[40:43], v1 offset:2048
    v_mfma_f32_16x16x32_bf16 a[0:3], v[176:179], v[28:31], a[0:3]
    s_waitcnt vmcnt(6)
    v_subrev_u32 v52, s92, v52
    v_cmp_lt_u32 vcc, 15, v52
    v_mfma_f32_16x16x32_bf16 a[48:51], v[164:167], v[24:27], a[48:51]
    v_exp_f32 v16, v72
    v_mfma_f32_16x16x32_bf16 a[48:51], v[180:183], v[28:31], a[48:51]
    v_exp_f32 v17, v73
    v_mfma_f32_16x16x32_bf16 a[96:99], v[168:171], v[24:27], a[96:99]
    s_and_b32 s59, vcc_lo, 0xff
    ds_read_b128 v[44:47], v1 offset:14336
    v_mfma_f32_16x16x32_bf16 a[96:99], v[184:187], v[28:31], a[96:99]
    s_cbranch_scc1 L_pollslow4
L_pollok4:
    v_mfma_f32_16x16x32_bf16 a[144:147], v[172:175], v[24:27], a[144:147]
    s_add_u32 s92, s92, 1
    v_exp_f32 v18, v74
    v_mfma_f32_16x16x32_bf16 a[144:147], v[188:191], v[28:31], a[144:147]
    s_waitcnt lgkmcnt(2)
    v_add_f32 v7, v7, v16
    v_add_f32 v7, v7, v17
    v_mfma_f32_16x16x32_bf16 a[4:7], v[160:163], v[32:35], a[4:7]
    s_mov_b32 m0, s56
    ds_read_b128 v[24:27], v1 offset:3072
    v_mfma_f32_16x16x32_bf16 a[4:7], v[176:179], v[36:39], a[4:7]
    buffer_load_dwordx4 v4, s[4:7], s27 offen offset:0 sc1 lds
    v_mfma_f32_16x16x32_bf16 a[52:55], v[164:167], v[32:35], a[52:55]
    v_exp_f32 v19, v75
    v_mfma_f32_16x16x32_bf16 a[52:55], v[180:183], v[36:39], a[52:55]
    v_cvt_pk_bf16_f32 v72, v16, v17
    v_mfma_f32_16x16x32_bf16 a[100:103], v[168:171], v[32:35], a[100:103]
    ds_read_b128 v[28:31], v1 offset:15360
    v_mfma_f32_16x16x32_bf16 a[100:103], v[184:187], v[36:39], a[100:103]
    v_exp_f32 v16, v104
    v_mfma_f32_16x16x32_bf16 a[148:151], v[172:175], v[32:35], a[148:151]
    v_add_f32 v7, v7, v18
    v_add_f32 v7, v7, v19
    v_mfma_f32_16x16x32_bf16 a[148:151], v[188:191], v[36:39], a[148:151]
    s_waitcnt lgkmcnt(2)
    v_exp_f32 v17, v105
    v_mfma_f32_16x16x32_bf16 a[8:11], v[160:163], v[40:43], a[8:11]
    ds_read_b128 v[32:35], v1 offset:4096
    v_cvt_pk_bf16_f32 v73, v18, v19
    v_mfma_f32_16x16x32_bf16 a[8:11], v[176:179], v[44:47], a[8:11]
    buffer_load_dwordx4 v4, s[4:7], s27 offen offset:1024 sc1 lds
    v_mfma_f32_16x16x32_bf16 a[56:59], v[164:167], v[40:43], a[56:59]
    v_exp_f32 v18, v106
    v_mfma_f32_16x16x32_bf16 a[56:59], v[180:183], v[44:47], a[56:59]
    v_add_f32 v7, v7, v16
    v_add_f32 v7, v7, v17
    v_mfma_f32_16x16x32_bf16 a[104:107], v[168:171], v[40:43], a[104:107]
    ds_read_b128 v[36:39], v1 offset:16384
    v_mfma_f32_16x16x32_bf16 a[104:107], v[184:187], v[44:47], a[104:107]
    v_exp_f32 v19, v107
    v_mfma_f32_16x16x32_bf16 a[152:155], v[172:175], v[40:43], a[152:155]
    v_cvt_pk_bf16_f32 v74, v16, v17
    v_mfma_f32_16x16x32_bf16 a[152:155], v[188:191], v[44:47], a[152:155]
    s_waitcnt lgkmcnt(2)
    v_exp_f32 v16, v76
    v_mfma_f32_16x16x32_bf16 a[12:15], v[160:163], v[24:27], a[12:15]
    ds_read_b128 v[40:43], v1 offset:5120
    v_add_f32 v7, v7, v18
    v_mfma_f32_16x16x32_bf16 a[12:15], v[176:179], v[28:31], a[12:15]
    buffer_load_dwordx4 v4, s[4:7], s27 offen offset:2048 sc1 lds
    v_mfma_f32_16x16x32_bf16 a[60:63], v[164:167], v[24:27], a[60:63]
    v_add_f32 v7, v7, v19
    v_mfma_f32_16x16x32_bf16 a[60:63], v[180:183], v[28:31], a[60:63]
    v_exp_f32 v17, v77
    v_mfma_f32_16x16x32_bf16 a[108:111], v[168:171], v[24:27], a[108:111]
    ds_read_b128 v[44:47], v1 offset:17408
    v_cvt_pk_bf16_f32 v75, v18, v19
    v_mfma_f32_16x16x32_bf16 a[108:111], v[184:187], v[28:31], a[108:111]
    v_exp_f32 v18, v78
    v_mfma_f32_16x16x32_bf16 a[156:159], v[172:175], v[24:27], a[156:159]
    s_add_u32 s29, s28, 49152
    v_add_f32 v8, v8, v16
    v_add_f32 v8, v8, v17
    v_mfma_f32_16x16x32_bf16 a[156:159], v[188:191], v[28:31], a[156:159]
    s_waitcnt lgkmcnt(2)
    v_exp_f32 v19, v79
    v_mfma_f32_16x16x32_bf16 a[16:19], v[160:163], v[32:35], a[16:19]
    s_sub_u32 s3, s29, 147456
    ds_read_b128 v[24:27], v1 offset:6144
    v_cvt_pk_bf16_f32 v76, v16, v17
    v_mfma_f32_16x16x32_bf16 a[16:19], v[176:179], v[36:39], a[16:19]
    s_add_u32 s27, s27, 24576
    v_exp_f32 v16, v108
    v_mfma_f32_16x16x32_bf16 a[64:67], v[164:167], v[32:35], a[64:67]
    s_min_u32 s29, s29, s3
    v_add_f32 v8, v8, v18
    v_add_f32 v8, v8, v19
    v_mfma_f32_16x16x32_bf16 a[64:67], v[180:183], v[36:39], a[64:67]
    s_add_u32 s56, s56, 12288
    v_exp_f32 v17, v109
    v_mfma_f32_16x16x32_bf16 a[112:115], v[168:171], v[32:35], a[112:115]
    ds_read_b128 v[28:31], v1 offset:18432
    v_mfma_f32_16x16x32_bf16 a[112:115], v[184:187], v[36:39], a[112:115]
    v_cvt_pk_bf16_f32 v77, v18, v19
    v_mfma_f32_16x16x32_bf16 a[160:163], v[172:175], v[32:35], a[160:163]
    v_exp_f32 v18, v110
    v_mfma_f32_16x16x32_bf16 a[160:163], v[188:191], v[36:39], a[160:163]
    s_waitcnt lgkmcnt(2)
    v_add_f32 v8, v8, v16
    s_mov_b32 m0, s56
    v_mfma_f32_16x16x32_bf16 a[20:23], v[160:163], v[40:43], a[20:23]
    s_sub_u32 s3, s29, s28
    ds_read_b128 v[32:35], v1 offset:7168
    v_add_f32 v8, v8, v17
    v_mfma_f32_16x16x32_bf16 a[20:23], v[176:179], v[44:47], a[20:23]
L_pg10:
    s_cbranch_execz L_iwret
    v_exp_f32 v19, v111
    v_mfma_f32_16x16x32_bf16 a[68:71], v[164:167], v[40:43], a[68:71]
    v_mfma_f32_16x16x32_bf16 a[68:71], v[180:183], v[44:47], a[68:71]
    v_cvt_pk_bf16_f32 v78, v16, v17
    v_mfma_f32_16x16x32_bf16 a[116:119], v[168:171], v[40:43], a[116:119]
    ds_read_b128 v[36:39], v1 offset:19456
    v_add_f32 v8, v8, v18
    v_mfma_f32_16x16x32_bf16 a[116:119], v[184:187], v[44:47], a[116:119]
    buffer_load_dwordx4 v4, s[4:7], s27 offen offset:0 sc1 lds
    v_mfma_f32_16x16x32_bf16 a[164:167], v[172:175], v[40:43], a[164:167]
    s_mov_b32 s28, s29
    v_add_f32 v8, v8, v19
    v_cvt_pk_bf16_f32 v79, v18, v19
    v_mfma_f32_16x16x32_bf16 a[164:167], v[188:191], v[44:47], a[164:167]
    s_waitcnt lgkmcnt(2)
    v_exp_f32 v16, v80
    v_mfma_f32_16x16x32_bf16 a[24:27], v[160:163], v[24:27], a[24:27]
    ds_read_b128 v[40:43], v1 offset:8192
    v_mfma_f32_16x16x32_bf16 a[24:27], v[176:179], v[28:31], a[24:27]
    v_exp_f32 v17, v81
    v_mfma_f32_16x16x32_bf16 a[72:75], v[164:167], v[24:27], a[72:75]
    v_exp_f32 v18, v82
    v_mfma_f32_16x16x32_bf16 a[72:75], v[180:183], v[28:31], a[72:75]
    v_add_f32 v5, v5, v16
    v_mfma_f32_16x16x32_bf16 a[120:123], v[168:171], v[24:27], a[120:123]
    ds_read_b128 v[44:47], v1 offset:20480
    v_add_f32 v5, v5, v17
    v_mfma_f32_16x16x32_bf16 a[120:123], v[184:187], v[28:31], a[120:123]
    v_exp_f32 v19, v83
    v_mfma_f32_16x16x32_bf16 a[168:171], v[172:175], v[24:27], a[168:171]
    v_add_u32 v2, s3, v2
    v_mfma_f32_16x16x32_bf16 a[168:171], v[188:191], v[28:31], a[168:171]
    s_waitcnt lgkmcnt(2)
    buffer_load_dwordx4 v4, s[4:7], s27 offen offset:1024 sc1 lds
    v_mfma_f32_16x16x32_bf16 a[28:31], v[160:163], v[32:35], a[28:31]
    ds_read_b128 v[24:27], v1 offset:9216
    v_cvt_pk_bf16_f32 v80, v16, v17
    v_mfma_f32_16x16x32_bf16 a[28:31], v[176:179], v[36:39], a[28:31]
    v_exp_f32 v16, v112
    v_mfma_f32_16x16x32_bf16 a[76:79], v[164:167], v[32:35], a[76:79]
    v_add_f32 v5, v5, v18
    v_add_f32 v5, v5, v19
    v_mfma_f32_16x16x32_bf16 a[76:79], v[180:183], v[36:39], a[76:79]
    v_exp_f32 v17, v113
    v_mfma_f32_16x16x32_bf16 a[124:127], v[168:171], v[32:35], a[124:127]
    ds_read_b128 v[28:31], v1 offset:21504
    v_add_u32 v3, s3, v3
    v_mfma_f32_16x16x32_bf16 a[124:127], v[184:187], v[36:39], a[124:127]
    v_cvt_pk_bf16_f32 v81, v18, v19
    v_mfma_f32_16x16x32_bf16 a[172:175], v[172:175], v[32:35], a[172:175]
    v_exp_f32 v18, v114
    v_mfma_f32_16x16x32_bf16 a[172:175], v[188:191], v[36:39], a[172:175]
    s_waitcnt lgkmcnt(2)
    buffer_load_dwordx4 v4, s[4:7], s27 offen offset:2048 sc1 lds
    v_mfma_f32_16x16x32_bf16 a[32:35], v[160:163], v[40:43], a[32:35]
    ds_read_b128 v[32:35], v1 offset:10240
    v_add_f32 v5, v5, v16
    v_mfma_f32_16x16x32_bf16 a[32:35], v[176:179], v[44:47], a[32:35]
    v_add_f32 v5, v5, v17
    v_mfma_f32_16x16x32_bf16 a[80:83], v[164:167], v[40:43], a[80:83]
    v_exp_f32 v19, v115
    v_mfma_f32_16x16x32_bf16 a[80:83], v[180:183], v[44:47], a[80:83]
    v_cvt_pk_bf16_f32 v82, v16, v17
    v_mfma_f32_16x16x32_bf16 a[128:131], v[168:171], v[40:43], a[128:131]
    ds_read_b128 v[36:39], v1 offset:22528
    v_mfma_f32_16x16x32_bf16 a[128:131], v[184:187], v[44:47], a[128:131]
    v_exp_f32 v16, v84
    v_mfma_f32_16x16x32_bf16 a[176:179], v[172:175], v[40:43], a[176:179]
    v_add_f32 v5, v5, v18
    v_add_f32 v5, v5, v19
    v_mfma_f32_16x16x32_bf16 a[176:179], v[188:191], v[44:47], a[176:179]
    s_waitcnt lgkmcnt(2)
    v_exp_f32 v17, v85
    v_mfma_f32_16x16x32_bf16 a[36:39], v[160:163], v[24:27], a[36:39]
    ds_read_b128 v[40:43], v1 offset:11264
    v_mfma_f32_16x16x32_bf16 a[36:39], v[176:179], v[28:31], a[36:39]
    v_cvt_pk_bf16_f32 v83, v18, v19
    v_mfma_f32_16x16x32_bf16 a[84:87], v[164:167], v[24:27], a[84:87]
    v_exp_f32 v18, v86
    v_mfma_f32_16x16x32_bf16 a[84:87], v[180:183], v[28:31], a[84:87]
    s_add_u32 s27, s27, 24576
    s_add_u32 s56, s56, 36864
    v_add_f32 v6, v6, v16
    v_mfma_f32_16x16x32_bf16 a[132:135], v[168:171], v[24:27], a[132:135]
    s_sub_u32 s58, s56, 147456
    ds_read_b128 v[44:47], v1 offset:23552
    v_add_f32 v6, v6, v17
    v_mfma_f32_16x16x32_bf16 a[132:135], v[184:187], v[28:31], a[132:135]
    v_exp_f32 v19, v87
    v_mfma_f32_16x16x32_bf16 a[180:183], v[172:175], v[24:27], a[180:183]
    v_mfma_f32_16x16x32_bf16 a[180:183], v[188:191], v[28:31], a[180:183]
    s_waitcnt lgkmcnt(2)
    v_cvt_pk_bf16_f32 v84, v16, v17
    s_min_u32 s56, s56, s58
    v_mfma_f32_16x16x32_bf16 a[40:43], v[160:163], v[32:35], a[40:43]
    ds_read_b128 v[24:27], v2 offset:0
    v_mfma_f32_16x16x32_bf16 a[40:43], v[176:179], v[36:39], a[40:43]
    v_exp_f32 v16, v116
    v_mfma_f32_16x16x32_bf16 a[88:91], v[164:167], v[32:35], a[88:91]
    v_add_f32 v6, v6, v18
    v_add_f32 v6, v6, v19
    v_mfma_f32_16x16x32_bf16 a[88:91], v[180:183], v[36:39], a[88:91]
    v_exp_f32 v17, v117
    v_mfma_f32_16x16x32_bf16 a[136:139], v[168:171], v[32:35], a[136:139]
    ds_read_b128 v[28:31], v3 offset:0
    v_mfma_f32_16x16x32_bf16 a[136:139], v[184:187], v[36:39], a[136:139]
    v_cvt_pk_bf16_f32 v85, v18, v19
    v_mfma_f32_16x16x32_bf16 a[184:187], v[172:175], v[32:35], a[184:187]
    v_exp_f32 v18, v118
    v_mfma_f32_16x16x32_bf16 a[184:187], v[188:191], v[36:39], a[184:187]
    s_waitcnt lgkmcnt(2)
    v_add_f32 v6, v6, v16
    v_mfma_f32_16x16x32_bf16 a[44:47], v[160:163], v[40:43], a[44:47]
    ds_read_b128 v[32:35], v2 offset:6144
    v_add_f32 v6, v6, v17
    v_mfma_f32_16x16x32_bf16 a[44:47], v[176:179], v[44:47], a[44:47]
    v_exp_f32 v19, v119
    v_mfma_f32_16x16x32_bf16 a[92:95], v[164:167], v[40:43], a[92:95]
    v_mfma_f32_16x16x32_bf16 a[92:95], v[180:183], v[44:47], a[92:95]
    v_cvt_pk_bf16_f32 v86, v16, v17
    v_mfma_f32_16x16x32_bf16 a[140:143], v[168:171], v[40:43], a[140:143]
    ds_read_b128 v[36:39], v3 offset:6144
    v_add_f32 v6, v6, v18
    v_mfma_f32_16x16x32_bf16 a[140:143], v[184:187], v[44:47], a[140:143]
    v_add_f32 v6, v6, v19
    v_cvt_pk_bf16_f32 v87, v18, v19
    v_mfma_f32_16x16x32_bf16 a[188:191], v[172:175], v[40:43], a[188:191]
    v_mfma_f32_16x16x32_bf16 a[188:191], v[188:191], v[44:47], a[188:191]
    s_waitcnt lgkmcnt(2)
    v_mfma_f32_16x16x32_bf16 v[160:163], v[24:27], a[192:195], v[128:131]
    ds_read_b128 v[40:43], v2 offset:128
    v_mfma_f32_16x16x32_bf16 v[160:163], v[28:31], a[196:199], v[160:163]
    v_exp_f32 v16, v88
    v_mfma_f32_16x16x32_bf16 v[164:167], v[24:27], a[216:219], v[132:135]
    ds_read_b128 v[44:47], v3 offset:128
    v_mfma_f32_16x16x32_bf16 v[164:167], v[28:31], a[220:223], v[164:167]
    s_waitcnt lgkmcnt(2)
    v_exp_f32 v17, v89
    v_mfma_f32_16x16x32_bf16 v[96:99], v[32:35], a[192:195], v[128:131]
    ds_read_b128 v[24:27], v2 offset:6272
    v_mfma_f32_16x16x32_bf16 v[96:99], v[36:39], a[196:199], v[96:99]
    s_waitcnt vmcnt(6)
    v_exp_f32 v18, v90
    v_mfma_f32_16x16x32_bf16 v[100:103], v[32:35], a[216:219], v[132:135]
    ds_read_b128 v[28:31], v3 offset:6272
    v_add_f32 v7, v7, v16
    v_mfma_f32_16x16x32_bf16 v[100:103], v[36:39], a[220:223], v[100:103]
    s_waitcnt lgkmcnt(2)
    s_barrier
    v_mfma_f32_16x16x32_bf16 v[160:163], v[40:43], a[200:203], v[160:163]
    s_mov_b32 m0, s26
    ds_read_b128 v[32:35], v2 offset:256
    v_add_f32 v7, v7, v17
    v_mfma_f32_16x16x32_bf16 v[160:163], v[44:47], a[204:207], v[160:163]
    buffer_load_dwordx4 v4, s[4:7], s32 offen offset:0 sc1 lds
    v_mfma_f32_16x16x32_bf16 v[164:167], v[40:43], a[224:227], v[164:167]
    ds_read_b128 v[36:39], v3 offset:256
    v_mfma_f32_16x16x32_bf16 v[164:167], v[44:47], a[228:231], v[164:167]
    s_waitcnt lgkmcnt(2)
    v_exp_f32 v19, v91
    v_mfma_f32_16x16x32_bf16 v[96:99], v[24:27], a[200:203], v[96:99]
    ds_read_b128 v[40:43], v2 offset:6400
    v_cvt_pk_bf16_f32 v88, v16, v17
    v_mfma_f32_16x16x32_bf16 v[96:99], v[28:31], a[204:207], v[96:99]
    v_exp_f32 v16, v120
    v_mfma_f32_16x16x32_bf16 v[100:103], v[24:27], a[224:227], v[100:103]
    ds_read_b128 v[44:47], v3 offset:6400
    v_add_f32 v7, v7, v18
    v_mfma_f32_16x16x32_bf16 v[100:103], v[28:31], a[228:231], v[100:103]
    s_waitcnt lgkmcnt(2)
    buffer_load_dwordx4 v4, s[4:7], s32 offen offset:1024 sc1 lds
    v_mfma_f32_16x16x32_bf16 v[160:163], v[32:35], a[208:211], v[160:163]
    ds_read_b128 v[24:27], v2 offset:12288
    v_add_f32 v7, v7, v19
    v_mfma_f32_16x16x32_bf16 v[160:163], v[36:39], a[212:215], v[160:163]
    v_exp_f32 v17, v121
    v_mfma_f32_16x16x32_bf16 v[164:167], v[32:35], a[232:235], v[164:167]
    ds_read_b128 v[28:31], v3 offset:12288
    v_cvt_pk_bf16_f32 v89, v18, v19
    v_mfma_f32_16x16x32_bf16 v[164:167], v[36:39], a[236:239], v[164:167]
    s_waitcnt lgkmcnt(2)
    v_exp_f32 v18, v122
    v_mfma_f32_16x16x32_bf16 v[96:99], v[40:43], a[208:211], v[96:99]
    ds_read_b128 v[32:35], v2 offset:18432
    v_add_f32 v7, v7, v16
    v_mfma_f32_16x16x32_bf16 v[96:99], v[44:47], a[212:215], v[96:99]
    buffer_load_dwordx4 v4, s[4:7], s32 offen offset:2048 sc1 lds
    v_mfma_f32_16x16x32_bf16 v[100:103], v[40:43], a[232:235], v[100:103]
    ds_read_b128 v[36:39], v3 offset:18432
    v_add_f32 v7, v7, v17
    v_mfma_f32_16x16x32_bf16 v[100:103], v[44:47], a[236:239], v[100:103]
    s_waitcnt lgkmcnt(2)
    v_exp_f32 v19, v123
    v_mfma_f32_16x16x32_bf16 v[168:171], v[24:27], a[192:195], v[128:131]
    ds_read_b128 v[40:43], v2 offset:12416
    v_cvt_pk_bf16_f32 v90, v16, v17
    v_mfma_f32_16x16x32_bf16 v[168:171], v[28:31], a[196:199], v[168:171]
    v_exp_f32 v16, v92
    v_mfma_f32_16x16x32_bf16 v[172:175], v[24:27], a[216:219], v[132:135]
    s_add_u32 s32, s32, 24576
    ds_read_b128 v[44:47], v3 offset:12416
    v_add_f32 v7, v7, v18
    v_mfma_f32_16x16x32_bf16 v[172:175], v[28:31], a[220:223], v[172:175]
    s_waitcnt lgkmcnt(2)
    v_add_f32 v7, v7, v19
    v_mfma_f32_16x16x32_bf16 v[104:107], v[32:35], a[192:195], v[128:131]
    ds_read_b128 v[24:27], v2 offset:18560
    v_mfma_f32_16x16x32_bf16 v[104:107], v[36:39], a[196:199], v[104:107]
    s_add_u32 s26, s26, 12288
    v_exp_f32 v17, v93
    v_mfma_f32_16x16x32_bf16 v[108:111], v[32:35], a[216:219], v[132:135]
    s_add_u32 s29, s30, 49152
    ds_read_b128 v[28:31], v3 offset:18560
    v_cvt_pk_bf16_f32 v91, v18, v19
    v_mfma_f32_16x16x32_bf16 v[108:111], v[36:39], a[220:223], v[108:111]
    s_waitcnt lgkmcnt(2)
    v_exp_f32 v18, v94
    v_mfma_f32_16x16x32_bf16 v[168:171], v[40:43], a[200:203], v[168:171]
    s_sub_u32 s3, s29, 147456
    ds_read_b128 v[32:35], v2 offset:12544
    v_add_f32 v8, v8, v16
    v_mfma_f32_16x16x32_bf16 v[168:171], v[44:47], a[204:207], v[168:171]
    s_mov_b32 m0, s26
    v_add_f32 v8, v8, v17
    s_min_u32 s29, s29, s3
    v_mfma_f32_16x16x32_bf16 v[172:175], v[40:43], a[224:227], v[172:175]
    ds_read_b128 v[36:39], v3 offset:12544
    v_mfma_f32_16x16x32_bf16 v[172:175], v[44:47], a[228:231], v[172:175]
    s_waitcnt lgkmcnt(2)
    v_exp_f32 v19, v95
    v_mfma_f32_16x16x32_bf16 v[104:107], v[24:27], a[200:203], v[104:107]
    ds_read_b128 v[40:43], v2 offset:18688
    v_cvt_pk_bf16_f32 v92, v16, v17
    v_mfma_f32_16x16x32_bf16 v[104:107], v[28:31], a[204:207], v[104:107]
    buffer_load_dwordx4 v4, s[4:7], s32 offen offset:0 sc1 lds
    v_mfma_f32_16x16x32_bf16 v[108:111], v[24:27], a[224:227], v[108:111]
    ds_read_b128 v[44:47], v3 offset:18688
    v_mfma_f32_16x16x32_bf16 v[108:111], v[28:31], a[228:231], v[108:111]
    s_waitcnt lgkmcnt(2)
    v_subrev_u32 v2, 98304, v2
    v_subrev_u32 v3, 98304, v3
    v_mfma_f32_16x16x32_bf16 v[168:171], v[32:35], a[208:211], v[168:171]
    ds_read_b128 v[24:27], v2 offset:0
    v_mfma_f32_16x16x32_bf16 v[168:171], v[36:39], a[212:215], v[168:171]
    v_exp_f32 v16, v124
    v_add_f32 v8, v8, v18
    v_mfma_f32_16x16x32_bf16 v[172:175], v[32:35], a[232:235], v[172:175]
    s_sub_u32 s3, s29, s30
    ds_read_b128 v[28:31], v3 offset:0
    v_add_f32 v8, v8, v19
    v_mfma_f32_16x16x32_bf16 v[172:175], v[36:39], a[236:239], v[172:175]
    s_waitcnt lgkmcnt(2)
    v_exp_f32 v17, v125
    v_cvt_pk_bf16_f32 v93, v18, v19
    v_mfma_f32_16x16x32_bf16 v[104:107], v[40:43], a[208:211], v[104:107]
    ds_read_b128 v[32:35], v2 offset:6144
    v_mfma_f32_16x16x32_bf16 v[104:107], v[44:47], a[212:215], v[104:107]
    buffer_load_dwordx4 v4, s[4:7], s32 offen offset:1024 sc1 lds
    v_mfma_f32_16x16x32_bf16 v[108:111], v[40:43], a[232:235], v[108:111]
    ds_read_b128 v[36:39], v3 offset:6144
    v_mfma_f32_16x16x32_bf16 v[108:111], v[44:47], a[236:239], v[108:111]
    s_waitcnt lgkmcnt(2)
    v_exp_f32 v18, v126
    v_add_f32 v8, v8, v16
    v_mfma_f32_16x16x32_bf16 v[176:179], v[24:27], a[192:195], v[128:131]
    ds_read_b128 v[40:43], v2 offset:128
    v_add_f32 v8, v8, v17
    v_mfma_f32_16x16x32_bf16 v[176:179], v[28:31], a[196:199], v[176:179]
    v_exp_f32 v19, v127
    v_cvt_pk_bf16_f32 v94, v16, v17
    v_mfma_f32_16x16x32_bf16 v[180:183], v[24:27], a[216:219], v[132:135]
    ds_read_b128 v[44:47], v3 offset:128
    v_add_f32 v8, v8, v18
    v_add_f32 v8, v8, v19
    v_cvt_pk_bf16_f32 v95, v18, v19
    v_mfma_f32_16x16x32_bf16 v[180:183], v[28:31], a[220:223], v[180:183]
    s_waitcnt lgkmcnt(2)
    buffer_load_dwordx4 v4, s[4:7], s32 offen offset:2048 sc1 lds
    v_mfma_f32_16x16x32_bf16 v[112:115], v[32:35], a[192:195], v[128:131]
    s_mov_b32 s30, s29
    ds_read_b128 v[24:27], v2 offset:6272
    v_mfma_f32_16x16x32_bf16 v[112:115], v[36:39], a[196:199], v[112:115]
    v_exp_f32 v16, v160
    v_mfma_f32_16x16x32_bf16 v[116:119], v[32:35], a[216:219], v[132:135]
    ds_read_b128 v[28:31], v3 offset:6272
    v_mfma_f32_16x16x32_bf16 v[116:119], v[36:39], a[220:223], v[116:119]
    s_waitcnt lgkmcnt(2)
    v_exp_f32 v17, v161
    v_mfma_f32_16x16x32_bf16 v[176:179], v[40:43], a[200:203], v[176:179]
    ds_read_b128 v[32:35], v2 offset:256
    v_mfma_f32_16x16x32_bf16 v[176:179], v[44:47], a[204:207], v[176:179]
    v_exp_f32 v18, v162
    v_mfma_f32_16x16x32_bf16 v[180:183], v[40:43], a[224:227], v[180:183]
    ds_read_b128 v[36:39], v3 offset:256
    v_add_f32 v5, v5, v16
    v_mfma_f32_16x16x32_bf16 v[180:183], v[44:47], a[228:231], v[180:183]
    s_waitcnt lgkmcnt(2)
    v_add_f32 v5, v5, v17
    v_add_u32 v1, s3, v1
    v_mfma_f32_16x16x32_bf16 v[112:115], v[24:27], a[200:203], v[112:115]
    ds_read_b128 v[40:43], v2 offset:6400
    v_mfma_f32_16x16x32_bf16 v[112:115], v[28:31], a[204:207], v[112:115]
    v_exp_f32 v19, v163
    v_cvt_pk_bf16_f32 v160, v16, v17
    v_mfma_f32_16x16x32_bf16 v[116:119], v[24:27], a[224:227], v[116:119]
    s_add_u32 s32, s32, 24576
    ds_read_b128 v[44:47], v3 offset:6400
    s_add_u32 s26, s26, 36864
    v_mfma_f32_16x16x32_bf16 v[116:119], v[28:31], a[228:231], v[116:119]
    s_waitcnt lgkmcnt(2)
    v_exp_f32 v16, v96
    v_mfma_f32_16x16x32_bf16 v[176:179], v[32:35], a[208:211], v[176:179]
    s_sub_u32 s57, s26, 147456
    ds_read_b128 v[24:27], v2 offset:12288
    v_add_f32 v5, v5, v18
    v_mfma_f32_16x16x32_bf16 v[176:179], v[36:39], a[212:215], v[176:179]
    s_min_u32 s26, s26, s57
    v_add_f32 v5, v5, v19
    v_mfma_f32_16x16x32_bf16 v[180:183], v[32:35], a[232:235], v[180:183]
    ds_read_b128 v[28:31], v3 offset:12288
    v_mfma_f32_16x16x32_bf16 v[180:183], v[36:39], a[236:239], v[180:183]
    s_waitcnt lgkmcnt(2)
    v_exp_f32 v17, v97
    v_cvt_pk_bf16_f32 v161, v18, v19
    v_mfma_f32_16x16x32_bf16 v[112:115], v[40:43], a[208:211], v[112:115]
    ds_read_b128 v[32:35], v2 offset:18432
    v_mfma_f32_16x16x32_bf16 v[112:115], v[44:47], a[212:215], v[112:115]
    v_exp_f32 v18, v98
    v_mfma_f32_16x16x32_bf16 v[116:119], v[40:43], a[232:235], v[116:119]
    ds_read_b128 v[36:39], v3 offset:18432
    v_add_f32 v5, v5, v16
    v_mfma_f32_16x16x32_bf16 v[116:119], v[44:47], a[236:239], v[116:119]
    s_waitcnt lgkmcnt(2)
    v_add_f32 v5, v5, v17
    v_mfma_f32_16x16x32_bf16 v[184:187], v[24:27], a[192:195], v[128:131]
    ds_read_b128 v[40:43], v2 offset:12416
    v_mfma_f32_16x16x32_bf16 v[184:187], v[28:31], a[196:199], v[184:187]
    v_exp_f32 v19, v99
    v_cvt_pk_bf16_f32 v162, v16, v17
    v_mfma_f32_16x16x32_bf16 v[188:191], v[24:27], a[216:219], v[132:135]
    ds_read_b128 v[44:47], v3 offset:12416
    v_mfma_f32_16x16x32_bf16 v[188:191], v[28:31], a[220:223], v[188:191]
    s_waitcnt lgkmcnt(2)
    v_exp_f32 v16, v164
    v_mfma_f32_16x16x32_bf16 v[120:123], v[32:35], a[192:195], v[128:131]
    ds_read_b128 v[24:27], v2 offset:18560
    v_add_f32 v5, v5, v18
    v_mfma_f32_16x16x32_bf16 v[120:123], v[36:39], a[196:199], v[120:123]
    s_waitcnt vmcnt(6)
    v_add_f32 v5, v5, v19
    v_mfma_f32_16x16x32_bf16 v[124:127], v[32:35], a[216:219], v[132:135]
    ds_read_b128 v[28:31], v3 offset:18560
    v_mfma_f32_16x16x32_bf16 v[124:127], v[36:39], a[220:223], v[124:127]
    s_waitcnt lgkmcnt(2)
    s_barrier
    v_mfma_f32_16x16x32_bf16 v[184:187], v[40:43], a[200:203], v[184:187]
    ds_read_b128 v[32:35], v2 offset:12544
    v_mfma_f32_16x16x32_bf16 v[184:187], v[44:47], a[204:207], v[184:187]
    v_exp_f32 v17, v165
    v_cvt_pk_bf16_f32 v163, v18, v19
    v_mfma_f32_16x16x32_bf16 v[188:191], v[40:43], a[224:227], v[188:191]
    ds_read_b128 v[36:39], v3 offset:12544
    v_mfma_f32_16x16x32_bf16 v[188:191], v[44:47], a[228:231], v[188:191]
    s_waitcnt lgkmcnt(2)
    v_exp_f32 v18, v166
    v_add_f32 v6, v6, v16
    v_mfma_f32_16x16x32_bf16 v[120:123], v[24:27], a[200:203], v[120:123]
    ds_read_b128 v[40:43], v2 offset:18688
    v_add_f32 v6, v6, v17
    v_mfma_f32_16x16x32_bf16 v[120:123], v[28:31], a[204:207], v[120:123]
    v_exp_f32 v19, v167
    v_cvt_pk_bf16_f32 v164, v16, v17
    v_mfma_f32_16x16x32_bf16 v[124:127], v[24:27], a[224:227], v[124:127]
    ds_read_b128 v[44:47], v3 offset:18688
    v_mfma_f32_16x16x32_bf16 v[124:127], v[28:31], a[228:231], v[124:127]
    s_waitcnt lgkmcnt(2)
    v_exp_f32 v16, v100
    v_mfma_f32_16x16x32_bf16 v[184:187], v[32:35], a[208:211], v[184:187]
    ds_read_b128 v[24:27], v1 offset:0
    v_add_f32 v6, v6, v18
    v_mfma_f32_16x16x32_bf16 v[184:187], v[36:39], a[212:215], v[184:187]
    v_add_f32 v6, v6, v19
    v_mfma_f32_16x16x32_bf16 v[188:191], v[32:35], a[232:235], v[188:191]
    ds_read_b128 v[28:31], v1 offset:12288
    v_mfma_f32_16x16x32_bf16 v[188:191], v[36:39], a[236:239], v[188:191]
    s_waitcnt lgkmcnt(2)
    v_exp_f32 v17, v101
    v_cvt_pk_bf16_f32 v165, v18, v19
    v_mfma_f32_16x16x32_bf16 v[120:123], v[40:43], a[208:211], v[120:123]
    ds_read_b128 v[32:35], v1 offset:1024
    v_mfma_f32_16x16x32_bf16 v[120:123], v[44:47], a[212:215], v[120:123]
    v_exp_f32 v18, v102
    v_mfma_f32_16x16x32_bf16 v[124:127], v[40:43], a[232:235], v[124:127]
    ds_read_b128 v[36:39], v1 offset:13312
    v_add_f32 v6, v6, v16
    v_mfma_f32_16x16x32_bf16 v[124:127], v[44:47], a[236:239], v[124:127]
    s_waitcnt lgkmcnt(2)
    v_add_f32 v6, v6, v17
    v_exp_f32 v19, v103
    v_cvt_pk_bf16_f32 v166, v16, v17
    v_add_f32 v6, v6, v18
    v_add_f32 v6, v6, v19
    v_cvt_pk_bf16_f32 v167, v18, v19
    v_mfma_f32_16x16x32_bf16 a[0:3], v[64:67], v[24:27], a[0:3]
    s_mov_b32 m0, s56
    ds_read_b128 v[40:43], v1 offset:2048
    v_bfe_u32 v57, v4, 8, 2
    v_mfma_f32_16x16x32_bf16 a[0:3], v[80:83], v[28:31], a[0:3]
    buffer_load_dwordx4 v4, s[4:7], s27 offen offset:0 sc1 lds
    v_mfma_f32_16x16x32_bf16 a[48:51], v[68:71], v[24:27], a[48:51]
    v_exp_f32 v16, v168
    v_mfma_f32_16x16x32_bf16 a[48:51], v[84:87], v[28:31], a[48:51]
    v_exp_f32 v17, v169
    v_mfma_f32_16x16x32_bf16 a[96:99], v[72:75], v[24:27], a[96:99]
    ds_read_b128 v[44:47], v1 offset:14336
    v_mul_u32_u24 v56, 1536, v57
    v_mfma_f32_16x16x32_bf16 a[96:99], v[88:91], v[28:31], a[96:99]
    buffer_load_dwordx4 v4, s[4:7], s27 offen offset:1024 sc1 lds
    v_mfma_f32_16x16x32_bf16 a[144:147], v[76:79], v[24:27], a[144:147]
    v_exp_f32 v18, v170
    v_mfma_f32_16x16x32_bf16 a[144:147], v[92:95], v[28:31], a[144:147]
    s_waitcnt lgkmcnt(2)
    v_add_f32 v5, v5, v16
    v_add_f32 v5, v5, v17
    v_mfma_f32_16x16x32_bf16 a[4:7], v[64:67], v[32:35], a[4:7]
    ds_read_b128 v[24:27], v1 offset:3072
    v_lshlrev_b32 v58, 4, v57
    v_mfma_f32_16x16x32_bf16 a[4:7], v[80:83], v[36:39], a[4:7]
    buffer_load_dwordx4 v4, s[4:7], s27 offen offset:2048 sc1 lds
    v_mfma_f32_16x16x32_bf16 a[52:55], v[68:71], v[32:35], a[52:55]
    v_exp_f32 v19, v171
    v_mfma_f32_16x16x32_bf16 a[52:55], v[84:87], v[36:39], a[52:55]
    s_add_u32 s27, s27, 24576
    v_cvt_pk_bf16_f32 v168, v16, v17
    v_bfe_u32 v57, v4, 4, 4
    v_mfma_f32_16x16x32_bf16 a[100:103], v[72:75], v[32:35], a[100:103]
    ds_read_b128 v[28:31], v1 offset:15360
    v_mfma_f32_16x16x32_bf16 a[100:103], v[88:91], v[36:39], a[100:103]
    s_add_u32 s56, s56, 12288
    v_exp_f32 v16, v104
    v_mfma_f32_16x16x32_bf16 a[148:151], v[76:79], v[32:35], a[148:151]
    v_add_f32 v5, v5, v18
    v_add_f32 v5, v5, v19
    v_mfma_f32_16x16x32_bf16 a[148:151], v[92:95], v[36:39], a[148:151]
    s_waitcnt lgkmcnt(2)
    v_exp_f32 v17, v105
    v_mfma_f32_16x16x32_bf16 a[8:11], v[64:67], v[40:43], a[8:11]
    s_mov_b32 m0, s56
    ds_read_b128 v[32:35], v1 offset:4096
    v_cvt_pk_bf16_f32 v169, v18, v19
    v_mfma_f32_16x16x32_bf16 a[8:11], v[80:83], v[44:47], a[8:11]
    v_exp_f32 v18, v106
    v_mfma_f32_16x16x32_bf16 a[56:59], v[68:71], v[40:43], a[56:59]
    v_add_f32 v5, v5, v16
    v_add_f32 v5, v5, v17
    v_mfma_f32_16x16x32_bf16 a[56:59], v[84:87], v[44:47], a[56:59]
    buffer_load_dwordx4 v4, s[4:7], s27 offen offset:0 sc1 lds
    v_mfma_f32_16x16x32_bf16 a[104:107], v[72:75], v[40:43], a[104:107]
    ds_read_b128 v[36:39], v1 offset:16384
    v_mul_u32_u24 v57, 12, v57
    v_mfma_f32_16x16x32_bf16 a[104:107], v[88:91], v[44:47], a[104:107]
    v_exp_f32 v19, v107
    v_mfma_f32_16x16x32_bf16 a[152:155], v[76:79], v[40:43], a[152:155]
    v_cvt_pk_bf16_f32 v170, v16, v17
    v_add_u32 v56, v56, v57
    v_mfma_f32_16x16x32_bf16 a[152:155], v[92:95], v[44:47], a[152:155]
    s_waitcnt lgkmcnt(2)
    buffer_load_dwordx4 v4, s[4:7], s27 offen offset:1024 sc1 lds
    v_mfma_f32_16x16x32_bf16 a[12:15], v[64:67], v[24:27], a[12:15]
    ds_read_b128 v[40:43], v1 offset:5120
    v_mfma_f32_16x16x32_bf16 a[12:15], v[80:83], v[28:31], a[12:15]
    v_exp_f32 v16, v172
    v_mfma_f32_16x16x32_bf16 a[60:63], v[68:71], v[24:27], a[60:63]
    v_add_f32 v5, v5, v18
    v_add_f32 v5, v5, v19
    v_mfma_f32_16x16x32_bf16 a[60:63], v[84:87], v[28:31], a[60:63]
    buffer_load_dwordx4 v4, s[4:7], s27 offen offset:2048 sc1 lds
    v_mfma_f32_16x16x32_bf16 a[108:111], v[72:75], v[24:27], a[108:111]
    ds_read_b128 v[44:47], v1 offset:17408
    v_mov_b32 v57, 1.0
    v_mfma_f32_16x16x32_bf16 a[108:111], v[88:91], v[28:31], a[108:111]
    v_exp_f32 v17, v173
    v_mfma_f32_16x16x32_bf16 a[156:159], v[76:79], v[24:27], a[156:159]
    s_add_u32 s27, s27, 24576
    v_cvt_pk_bf16_f32 v171, v18, v19
    v_mfma_f32_16x16x32_bf16 a[156:159], v[92:95], v[28:31], a[156:159]
    s_waitcnt lgkmcnt(2)
    v_exp_f32 v18, v174
    v_mfma_f32_16x16x32_bf16 a[16:19], v[64:67], v[32:35], a[16:19]
    s_add_u32 s56, s56, 36864
    ds_read_b128 v[24:27], v1 offset:6144
    v_add_f32 v6, v6, v16
    v_mfma_f32_16x16x32_bf16 a[16:19], v[80:83], v[36:39], a[16:19]
    v_add_f32 v6, v6, v17
    v_mov_b32 v20, 0x3f803f80
    v_mfma_f32_16x16x32_bf16 a[64:67], v[68:71], v[32:35], a[64:67]
    s_sub_u32 s58, s56, 147456
    v_exp_f32 v19, v175
    v_mfma_f32_16x16x32_bf16 a[64:67], v[84:87], v[36:39], a[64:67]
    v_cvt_pk_bf16_f32 v172, v16, v17
    v_mfma_f32_16x16x32_bf16 a[112:115], v[72:75], v[32:35], a[112:115]
    s_min_u32 s56, s56, s58
    ds_read_b128 v[28:31], v1 offset:18432
    v_mov_b32 v21, 0x3f803f80
    v_mfma_f32_16x16x32_bf16 a[112:115], v[88:91], v[36:39], a[112:115]
    v_exp_f32 v16, v108
    v_mfma_f32_16x16x32_bf16 a[160:163], v[76:79], v[32:35], a[160:163]
    s_mov_b32 m0, s56
    v_add_f32 v6, v6, v18
    v_add_f32 v6, v6, v19
    v_mfma_f32_16x16x32_bf16 a[160:163], v[92:95], v[36:39], a[160:163]
    s_waitcnt lgkmcnt(2)
    v_exp_f32 v17, v109
    v_mfma_f32_16x16x32_bf16 a[20:23], v[64:67], v[40:43], a[20:23]
    ds_read_b128 v[32:35], v1 offset:7168
    v_cvt_pk_bf16_f32 v173, v18, v19
    v_mfma_f32_16x16x32_bf16 a[20:23], v[80:83], v[44:47], a[20:23]
    buffer_load_dwordx4 v4, s[4:7], s27 offen offset:0 sc1 lds
    v_mfma_f32_16x16x32_bf16 a[68:71], v[68:71], v[40:43], a[68:71]
    v_exp_f32 v18, v110
    v_mfma_f32_16x16x32_bf16 a[68:71], v[84:87], v[44:47], a[68:71]
    v_add_f32 v6, v6, v16
    v_add_f32 v6, v6, v17
    v_mfma_f32_16x16x32_bf16 a[116:119], v[72:75], v[40:43], a[116:119]
    ds_read_b128 v[36:39], v1 offset:19456
    v_mov_b32 v22, 0x3f803f80
    v_mfma_f32_16x16x32_bf16 a[116:119], v[88:91], v[44:47], a[116:119]
    buffer_load_dwordx4 v4, s[4:7], s27 offen offset:1024 sc1 lds
    v_mfma_f32_16x16x32_bf16 a[164:167], v[76:79], v[40:43], a[164:167]
    v_exp_f32 v19, v111
    v_mfma_f32_16x16x32_bf16 a[164:167], v[92:95], v[44:47], a[164:167]
    s_waitcnt lgkmcnt(2)
    v_cvt_pk_bf16_f32 v174, v16, v17
    v_add_f32 v6, v6, v18
    v_mfma_f32_16x16x32_bf16 a[24:27], v[64:67], v[24:27], a[24:27]
    ds_read_b128 v[40:43], v1 offset:8192
    v_add_f32 v6, v6, v19
    v_mfma_f32_16x16x32_bf16 a[24:27], v[80:83], v[28:31], a[24:27]
    buffer_load_dwordx4 v4, s[4:7], s27 offen offset:2048 sc1 lds
    v_mfma_f32_16x16x32_bf16 a[72:75], v[68:71], v[24:27], a[72:75]
    v_cvt_pk_bf16_f32 v175, v18, v19
    v_mov_b32 v23, 0x3f803f80
    v_mfma_f32_16x16x32_bf16 a[72:75], v[84:87], v[28:31], a[72:75]
    v_exp_f32 v16, v176
    v_mfma_f32_16x16x32_bf16 a[120:123], v[72:75], v[24:27], a[120:123]
    ds_read_b128 v[44:47], v1 offset:20480
    v_mfma_f32_16x16x32_bf16 a[120:123], v[88:91], v[28:31], a[120:123]
    s_lshl_b32 s24, s95, 2
    v_exp_f32 v17, v177
    v_mfma_f32_16x16x32_bf16 a[168:171], v[76:79], v[24:27], a[168:171]
    s_add_u32 s27, s27, 24576
    v_exp_f32 v18, v178
    v_mfma_f32_16x16x32_bf16 a[168:171], v[92:95], v[28:31], a[168:171]
    s_waitcnt lgkmcnt(2)
    v_add_f32 v5, v5, v16
    v_add_f32 v5, v5, v17
    v_mfma_f32_16x16x32_bf16 a[28:31], v[64:67], v[32:35], a[28:31]
    s_add_u32 s56, s56, 12288
    ds_read_b128 v[24:27], v1 offset:9216
    v_mfma_f32_16x16x32_bf16 a[28:31], v[80:83], v[36:39], a[28:31]
    s_mov_b32 m0, s56
    v_exp_f32 v19, v179
    v_mfma_f32_16x16x32_bf16 a[76:79], v[68:71], v[32:35], a[76:79]
    v_cvt_pk_bf16_f32 v176, v16, v17
    v_mfma_f32_16x16x32_bf16 a[76:79], v[84:87], v[36:39], a[76:79]
    s_add_u32 s24, s24, s25
    v_exp_f32 v16, v112
    v_mfma_f32_16x16x32_bf16 a[124:127], v[72:75], v[32:35], a[124:127]
    ds_read_b128 v[28:31], v1 offset:21504
    v_add_f32 v5, v5, v18
    v_mfma_f32_16x16x32_bf16 a[124:127], v[88:91], v[36:39], a[124:127]
    buffer_load_dwordx4 v4, s[4:7], s27 offen offset:0 sc1 lds
    v_mfma_f32_16x16x32_bf16 a[172:175], v[76:79], v[32:35], a[172:175]
    v_add_f32 v5, v5, v19
    v_mfma_f32_16x16x32_bf16 a[172:175], v[92:95], v[36:39], a[172:175]
    s_waitcnt lgkmcnt(2)
    v_exp_f32 v17, v113
    v_mfma_f32_16x16x32_bf16 a[32:35], v[64:67], v[40:43], a[32:35]
    s_mul_i32 s24, s24, 24576
    ds_read_b128 v[32:35], v1 offset:10240
    v_cvt_pk_bf16_f32 v177, v18, v19
    v_mfma_f32_16x16x32_bf16 a[32:35], v[80:83], v[44:47], a[32:35]
    buffer_load_dwordx4 v4, s[4:7], s27 offen offset:1024 sc1 lds
    v_mfma_f32_16x16x32_bf16 a[80:83], v[68:71], v[40:43], a[80:83]
    v_exp_f32 v18, v114
    v_mfma_f32_16x16x32_bf16 a[80:83], v[84:87], v[44:47], a[80:83]
    v_add_f32 v5, v5, v16
    v_add_f32 v5, v5, v17
    v_mfma_f32_16x16x32_bf16 a[128:131], v[72:75], v[40:43], a[128:131]
    ds_read_b128 v[36:39], v1 offset:22528
    v_mfma_f32_16x16x32_bf16 a[128:131], v[88:91], v[44:47], a[128:131]
    buffer_load_dwordx4 v4, s[4:7], s27 offen offset:2048 sc1 lds
    v_mfma_f32_16x16x32_bf16 a[176:179], v[76:79], v[40:43], a[176:179]
    s_add_u32 s40, s24, 6144
    v_exp_f32 v19, v115
    v_mfma_f32_16x16x32_bf16 a[176:179], v[92:95], v[44:47], a[176:179]
    s_waitcnt lgkmcnt(2)
    v_cvt_pk_bf16_f32 v178, v16, v17
    v_mfma_f32_16x16x32_bf16 a[36:39], v[64:67], v[24:27], a[36:39]
    ds_read_b128 v[40:43], v1 offset:11264
    v_mfma_f32_16x16x32_bf16 a[36:39], v[80:83], v[28:31], a[36:39]
    v_exp_f32 v16, v180
    v_mfma_f32_16x16x32_bf16 a[84:87], v[68:71], v[24:27], a[84:87]
    v_add_f32 v5, v5, v18
    v_add_f32 v5, v5, v19
    v_mfma_f32_16x16x32_bf16 a[84:87], v[84:87], v[28:31], a[84:87]
    s_add_u32 s27, s27, 24576
    v_exp_f32 v17, v181
    v_mfma_f32_16x16x32_bf16 a[132:135], v[72:75], v[24:27], a[132:135]
    s_add_u32 s56, s56, 36864
    ds_read_b128 v[44:47], v1 offset:23552
    v_cvt_pk_bf16_f32 v179, v18, v19
    v_mfma_f32_16x16x32_bf16 a[132:135], v[88:91], v[28:31], a[132:135]
    s_waitcnt lgkmcnt(2)
    v_exp_f32 v18, v182
    v_mfma_f32_16x16x32_bf16 a[180:183], v[76:79], v[24:27], a[180:183]
    s_waitcnt vmcnt(12)
    v_add_f32 v6, v6, v16
    v_add_f32 v6, v6, v17
    v_mfma_f32_16x16x32_bf16 a[180:183], v[92:95], v[28:31], a[180:183]
    s_barrier
    v_add_u32 v2, 49152, v2
    v_add_u32 v3, 49152, v3
    v_mfma_f32_16x16x32_bf16 a[40:43], v[64:67], v[32:35], a[40:43]
L_pg11:
    s_cbranch_execz L_iwret
    s_sub_u32 s58, s56, 147456
    ds_read_b128 v[24:27], v2 offset:0
    s_add_u32 s41, s24, 12288
    v_mfma_f32_16x16x32_bf16 a[40:43], v[80:83], v[36:39], a[40:43]
    s_min_u32 s56, s56, s58
    v_exp_f32 v19, v183
    v_mfma_f32_16x16x32_bf16 a[88:91], v[68:71], v[32:35], a[88:91]
    s_add_u32 s42, s24, 18432
    v_cvt_pk_bf16_f32 v180, v16, v17
    v_mfma_f32_16x16x32_bf16 a[88:91], v[84:87], v[36:39], a[88:91]
    v_exp_f32 v16, v116
    v_mfma_f32_16x16x32_bf16 a[136:139], v[72:75], v[32:35], a[136:139]
    ds_read_b128 v[28:31], v3 offset:0
    v_add_f32 v6, v6, v18
    v_mfma_f32_16x16x32_bf16 a[136:139], v[88:91], v[36:39], a[136:139]
    v_add_f32 v6, v6, v19
    v_mfma_f32_16x16x32_bf16 a[184:187], v[76:79], v[32:35], a[184:187]
    v_exp_f32 v17, v117
    v_mfma_f32_16x16x32_bf16 a[184:187], v[92:95], v[36:39], a[184:187]
    s_waitcnt lgkmcnt(2)
    v_cvt_pk_bf16_f32 v181, v18, v19
    v_mfma_f32_16x16x32_bf16 a[44:47], v[64:67], v[40:43], a[44:47]
    ds_read_b128 v[32:35], v2 offset:6144
    v_mfma_f32_16x16x32_bf16 a[44:47], v[80:83], v[44:47], a[44:47]
    v_exp_f32 v18, v118
    v_mfma_f32_16x16x32_bf16 a[92:95], v[68:71], v[40:43], a[92:95]
    v_add_f32 v6, v6, v16
    v_add_f32 v6, v6, v17
    v_mfma_f32_16x16x32_bf16 a[92:95], v[84:87], v[44:47], a[92:95]
    v_exp_f32 v19, v119
    v_mfma_f32_16x16x32_bf16 a[140:143], v[72:75], v[40:43], a[140:143]
    ds_read_b128 v[36:39], v3 offset:6144
    v_cvt_pk_bf16_f32 v182, v16, v17
    v_mfma_f32_16x16x32_bf16 a[140:143], v[88:91], v[44:47], a[140:143]
    v_add_f32 v6, v6, v18
    v_add_f32 v6, v6, v19
    v_mfma_f32_16x16x32_bf16 a[188:191], v[76:79], v[40:43], a[188:191]
    v_cvt_pk_bf16_f32 v183, v18, v19
    v_mfma_f32_16x16x32_bf16 a[188:191], v[92:95], v[44:47], a[188:191]
    s_waitcnt lgkmcnt(2)
    v_mfma_f32_16x16x32_bf16 v[64:67], v[24:27], a[192:195], v[128:131]
    ds_read_b128 v[40:43], v2 offset:128
    v_mfma_f32_16x16x32_bf16 v[64:67], v[28:31], a[196:199], v[64:67]
    v_exp_f32 v16, v184
    v_mfma_f32_16x16x32_bf16 v[68:71], v[24:27], a[216:219], v[132:135]
    ds_read_b128 v[44:47], v3 offset:128
    v_mfma_f32_16x16x32_bf16 v[68:71], v[28:31], a[220:223], v[68:71]
    s_waitcnt lgkmcnt(2)
    v_exp_f32 v17, v185
    v_mfma_f32_16x16x32_bf16 v[96:99], v[32:35], a[192:195], v[128:131]
    ds_read_b128 v[24:27], v2 offset:6272
    v_mfma_f32_16x16x32_bf16 v[96:99], v[36:39], a[196:199], v[96:99]
    v_exp_f32 v18, v186
    v_mfma_f32_16x16x32_bf16 v[100:103], v[32:35], a[216:219], v[132:135]
    ds_read_b128 v[28:31], v3 offset:6272
    v_add_f32 v5, v5, v16
    v_mfma_f32_16x16x32_bf16 v[100:103], v[36:39], a[220:223], v[100:103]
    s_waitcnt lgkmcnt(2)
    v_add_f32 v5, v5, v17
    v_mfma_f32_16x16x32_bf16 v[64:67], v[40:43], a[200:203], v[64:67]
    ds_read_b128 v[32:35], v2 offset:256
    v_mfma_f32_16x16x32_bf16 v[64:67], v[44:47], a[204:207], v[64:67]
    v_exp_f32 v19, v187
    v_mfma_f32_16x16x32_bf16 v[68:71], v[40:43], a[224:227], v[68:71]
    ds_read_b128 v[36:39], v3 offset:256
    v_cvt_pk_bf16_f32 v184, v16, v17
    v_mfma_f32_16x16x32_bf16 v[68:71], v[44:47], a[228:231], v[68:71]
    s_waitcnt lgkmcnt(2)
    v_exp_f32 v16, v120
    v_mfma_f32_16x16x32_bf16 v[96:99], v[24:27], a[200:203], v[96:99]
    ds_read_b128 v[40:43], v2 offset:6400
    v_add_f32 v5, v5, v18
    v_mfma_f32_16x16x32_bf16 v[96:99], v[28:31], a[204:207], v[96:99]
    s_waitcnt vmcnt(0)
    v_add_f32 v5, v5, v19
    v_mfma_f32_16x16x32_bf16 v[100:103], v[24:27], a[224:227], v[100:103]
    ds_read_b128 v[44:47], v3 offset:6400
    v_mfma_f32_16x16x32_bf16 v[100:103], v[28:31], a[228:231], v[100:103]
    s_waitcnt lgkmcnt(2)
    s_barrier
    v_mfma_f32_16x16x32_bf16 v[64:67], v[32:35], a[208:211], v[64:67]
    s_mov_b32 m0, s56
    ds_read_b128 v[24:27], v2 offset:12288
    v_mfma_f32_16x16x32_bf16 v[64:67], v[36:39], a[212:215], v[64:67]
    buffer_load_dwordx4 v4, s[4:7], s27 offen offset:0 sc1 lds
    v_mfma_f32_16x16x32_bf16 v[68:71], v[32:35], a[232:235], v[68:71]
    ds_read_b128 v[28:31], v3 offset:12288
    v_mfma_f32_16x16x32_bf16 v[68:71], v[36:39], a[236:239], v[68:71]
    s_waitcnt lgkmcnt(2)
    v_exp_f32 v17, v121
    v_cvt_pk_bf16_f32 v185, v18, v19
    v_mfma_f32_16x16x32_bf16 v[96:99], v[40:43], a[208:211], v[96:99]
    ds_read_b128 v[32:35], v2 offset:18432
    v_mfma_f32_16x16x32_bf16 v[96:99], v[44:47], a[212:215], v[96:99]
    buffer_load_dwordx4 v4, s[4:7], s27 offen offset:1024 sc1 lds
    v_mfma_f32_16x16x32_bf16 v[100:103], v[40:43], a[232:235], v[100:103]
    ds_read_b128 v[36:39], v3 offset:18432
    v_mfma_f32_16x16x32_bf16 v[100:103], v[44:47], a[236:239], v[100:103]
    s_waitcnt lgkmcnt(2)
    v_exp_f32 v18, v122
    v_add_f32 v5, v5, v16
    v_mfma_f32_16x16x32_bf16 v[72:75], v[24:27], a[192:195], v[128:131]
    ds_read_b128 v[40:43], v2 offset:12416
    v_add_f32 v5, v5, v17
    v_mfma_f32_16x16x32_bf16 v[72:75], v[28:31], a[196:199], v[72:75]
    v_exp_f32 v19, v123
    v_cvt_pk_bf16_f32 v186, v16, v17
    v_mfma_f32_16x16x32_bf16 v[76:79], v[24:27], a[216:219], v[132:135]
    ds_read_b128 v[44:47], v3 offset:12416
    v_mfma_f32_16x16x32_bf16 v[76:79], v[28:31], a[220:223], v[76:79]
    s_waitcnt lgkmcnt(2)
    buffer_load_dwordx4 v4, s[4:7], s27 offen offset:2048 sc1 lds
    v_mfma_f32_16x16x32_bf16 v[104:107], v[32:35], a[192:195], v[128:131]
    ds_read_b128 v[24:27], v2 offset:18560
    v_mfma_f32_16x16x32_bf16 v[104:107], v[36:39], a[196:199], v[104:107]
    v_exp_f32 v16, v188
    v_add_f32 v5, v5, v18
    v_mfma_f32_16x16x32_bf16 v[108:111], v[32:35], a[216:219], v[132:135]
    ds_read_b128 v[28:31], v3 offset:18560
    v_add_f32 v5, v5, v19
    v_mfma_f32_16x16x32_bf16 v[108:111], v[36:39], a[220:223], v[108:111]
    s_waitcnt lgkmcnt(2)
    v_exp_f32 v17, v189
    v_cvt_pk_bf16_f32 v187, v18, v19
    v_mfma_f32_16x16x32_bf16 v[72:75], v[40:43], a[200:203], v[72:75]
    s_add_u32 s27, s27, 24576
    ds_read_b128 v[32:35], v2 offset:12544
    v_mfma_f32_16x16x32_bf16 v[72:75], v[44:47], a[204:207], v[72:75]
    v_exp_f32 v18, v190
    v_mfma_f32_16x16x32_bf16 v[76:79], v[40:43], a[224:227], v[76:79]
    s_add_u32 s56, s56, 12288
    ds_read_b128 v[36:39], v3 offset:12544
    v_add_f32 v6, v6, v16
    v_mfma_f32_16x16x32_bf16 v[76:79], v[44:47], a[228:231], v[76:79]
    s_waitcnt lgkmcnt(2)
    v_add_f32 v6, v6, v17
    v_mfma_f32_16x16x32_bf16 v[104:107], v[24:27], a[200:203], v[104:107]
    ds_read_b128 v[40:43], v2 offset:18688
    v_mfma_f32_16x16x32_bf16 v[104:107], v[28:31], a[204:207], v[104:107]
    v_exp_f32 v19, v191
    v_cvt_pk_bf16_f32 v188, v16, v17
    v_mfma_f32_16x16x32_bf16 v[108:111], v[24:27], a[224:227], v[108:111]
    s_mov_b32 m0, s56
    ds_read_b128 v[44:47], v3 offset:18688
    v_mfma_f32_16x16x32_bf16 v[108:111], v[28:31], a[228:231], v[108:111]
    s_waitcnt lgkmcnt(2)
    v_add_u32 v2, 49152, v2
    v_add_u32 v3, 49152, v3
    v_mfma_f32_16x16x32_bf16 v[72:75], v[32:35], a[208:211], v[72:75]
    ds_read_b128 v[24:27], v2 offset:0
    v_mfma_f32_16x16x32_bf16 v[72:75], v[36:39], a[212:215], v[72:75]
    buffer_load_dwordx4 v4, s[4:7], s27 offen offset:0 sc1 lds
    v_mfma_f32_16x16x32_bf16 v[76:79], v[32:35], a[232:235], v[76:79]
    ds_read_b128 v[28:31], v3 offset:0
    v_mfma_f32_16x16x32_bf16 v[76:79], v[36:39], a[236:239], v[76:79]
    s_waitcnt lgkmcnt(2)
    v_exp_f32 v16, v124
    v_add_f32 v6, v6, v18
    v_mfma_f32_16x16x32_bf16 v[104:107], v[40:43], a[208:211], v[104:107]
    ds_read_b128 v[32:35], v2 offset:6144
    v_add_f32 v6, v6, v19
    v_mfma_f32_16x16x32_bf16 v[104:107], v[44:47], a[212:215], v[104:107]
    v_exp_f32 v17, v125
    v_cvt_pk_bf16_f32 v189, v18, v19
    v_mfma_f32_16x16x32_bf16 v[108:111], v[40:43], a[232:235], v[108:111]
    ds_read_b128 v[36:39], v3 offset:6144
    v_mfma_f32_16x16x32_bf16 v[108:111], v[44:47], a[236:239], v[108:111]
    s_waitcnt lgkmcnt(2)
    buffer_load_dwordx4 v4, s[4:7], s27 offen offset:1024 sc1 lds
    v_mfma_f32_16x16x32_bf16 v[80:83], v[24:27], a[240:243], v[136:139]
    ds_read_b128 v[40:43], v2 offset:128
    v_mfma_f32_16x16x32_bf16 v[80:83], v[28:31], a[244:247], v[80:83]
    v_exp_f32 v18, v126
    v_add_f32 v6, v6, v16
    v_mfma_f32_16x16x32_bf16 v[84:87], v[24:27], v[200:203], v[140:143]
    ds_read_b128 v[44:47], v3 offset:128
    v_add_f32 v6, v6, v17
    v_exp_f32 v19, v127
    v_cvt_pk_bf16_f32 v190, v16, v17
    v_add_f32 v6, v6, v18
    v_add_f32 v6, v6, v19
    v_cvt_pk_bf16_f32 v191, v18, v19
    v_mfma_f32_16x16x32_bf16 v[84:87], v[28:31], v[204:207], v[84:87]
    s_waitcnt lgkmcnt(2)
    v_exp_f32 v16, v64
    v_mfma_f32_16x16x32_bf16 v[112:115], v[32:35], a[240:243], v[136:139]
    ds_read_b128 v[24:27], v2 offset:6272
    v_mfma_f32_16x16x32_bf16 v[112:115], v[36:39], a[244:247], v[112:115]
    buffer_load_dwordx4 v4, s[4:7], s27 offen offset:2048 sc1 lds
    v_mfma_f32_16x16x32_bf16 v[116:119], v[32:35], v[200:203], v[140:143]
    ds_read_b128 v[28:31], v3 offset:6272
    v_mfma_f32_16x16x32_bf16 v[116:119], v[36:39], v[204:207], v[116:119]
    s_waitcnt lgkmcnt(2)
    v_exp_f32 v17, v65
    v_mfma_f32_16x16x32_bf16 v[80:83], v[40:43], a[248:251], v[80:83]
    ds_read_b128 v[32:35], v2 offset:256
    v_mfma_f32_16x16x32_bf16 v[80:83], v[44:47], a[252:255], v[80:83]
    v_exp_f32 v18, v66
    v_mfma_f32_16x16x32_bf16 v[84:87], v[40:43], v[208:211], v[84:87]
    ds_read_b128 v[36:39], v3 offset:256
    v_add_f32 v5, v5, v16
    v_mfma_f32_16x16x32_bf16 v[84:87], v[44:47], v[212:215], v[84:87]
    s_waitcnt lgkmcnt(2)
    v_add_f32 v5, v5, v17
    v_mfma_f32_16x16x32_bf16 v[112:115], v[24:27], a[248:251], v[112:115]
    ds_read_b128 v[40:43], v2 offset:6400
    v_mfma_f32_16x16x32_bf16 v[112:115], v[28:31], a[252:255], v[112:115]
    v_exp_f32 v19, v67
    v_cvt_pk_bf16_f32 v64, v16, v17
    v_mfma_f32_16x16x32_bf16 v[116:119], v[24:27], v[208:211], v[116:119]
    s_add_u32 s27, s27, 24576
    ds_read_b128 v[44:47], v3 offset:6400
    s_add_u32 s56, s56, 36864
    v_mfma_f32_16x16x32_bf16 v[116:119], v[28:31], v[212:215], v[116:119]
    s_waitcnt lgkmcnt(2)
    v_exp_f32 v16, v96
    v_mfma_f32_16x16x32_bf16 v[80:83], v[32:35], v[192:195], v[80:83]
    s_sub_u32 s58, s56, 147456
    ds_read_b128 v[24:27], v2 offset:12288
    v_add_f32 v5, v5, v18
    v_mfma_f32_16x16x32_bf16 v[80:83], v[36:39], v[196:199], v[80:83]
    s_min_u32 s56, s56, s58
    v_add_f32 v5, v5, v19
    v_mfma_f32_16x16x32_bf16 v[84:87], v[32:35], v[216:219], v[84:87]
    ds_read_b128 v[28:31], v3 offset:12288
    v_mfma_f32_16x16x32_bf16 v[84:87], v[36:39], v[220:223], v[84:87]
    s_waitcnt lgkmcnt(2)
    v_exp_f32 v17, v97
    v_cvt_pk_bf16_f32 v65, v18, v19
    v_mfma_f32_16x16x32_bf16 v[112:115], v[40:43], v[192:195], v[112:115]
    ds_read_b128 v[32:35], v2 offset:18432
    v_mfma_f32_16x16x32_bf16 v[112:115], v[44:47], v[196:199], v[112:115]
    v_exp_f32 v18, v98
    v_mfma_f32_16x16x32_bf16 v[116:119], v[40:43], v[216:219], v[116:119]
    ds_read_b128 v[36:39], v3 offset:18432
    v_add_f32 v5, v5, v16
    v_mfma_f32_16x16x32_bf16 v[116:119], v[44:47], v[220:223], v[116:119]
    s_waitcnt lgkmcnt(2)
    v_add_f32 v5, v5, v17
    v_mfma_f32_16x16x32_bf16 v[88:91], v[24:27], a[240:243], v[136:139]
    ds_read_b128 v[40:43], v2 offset:12416
    v_mfma_f32_16x16x32_bf16 v[88:91], v[28:31], a[244:247], v[88:91]
    v_exp_f32 v19, v99
    v_cvt_pk_bf16_f32 v66, v16, v17
    v_mfma_f32_16x16x32_bf16 v[92:95], v[24:27], v[200:203], v[140:143]
    ds_read_b128 v[44:47], v3 offset:12416
    v_mfma_f32_16x16x32_bf16 v[92:95], v[28:31], v[204:207], v[92:95]
    s_waitcnt lgkmcnt(2)
    v_exp_f32 v16, v68
    v_mfma_f32_16x16x32_bf16 v[120:123], v[32:35], a[240:243], v[136:139]
    ds_read_b128 v[24:27], v2 offset:18560
    v_add_f32 v5, v5, v18
    v_mfma_f32_16x16x32_bf16 v[120:123], v[36:39], a[244:247], v[120:123]
    v_add_f32 v5, v5, v19
    v_mfma_f32_16x16x32_bf16 v[124:127], v[32:35], v[200:203], v[140:143]
    ds_read_b128 v[28:31], v3 offset:18560
    v_mfma_f32_16x16x32_bf16 v[124:127], v[36:39], v[204:207], v[124:127]
    s_waitcnt lgkmcnt(2)
    v_exp_f32 v17, v69
    v_cvt_pk_bf16_f32 v67, v18, v19
    v_mfma_f32_16x16x32_bf16 v[88:91], v[40:43], a[248:251], v[88:91]
    ds_read_b128 v[32:35], v2 offset:12544
    v_mfma_f32_16x16x32_bf16 v[88:91], v[44:47], a[252:255], v[88:91]
    v_exp_f32 v18, v70
    v_mfma_f32_16x16x32_bf16 v[92:95], v[40:43], v[208:211], v[92:95]
    ds_read_b128 v[36:39], v3 offset:12544
    v_add_f32 v6, v6, v16
    v_mfma_f32_16x16x32_bf16 v[92:95], v[44:47], v[212:215], v[92:95]
    s_waitcnt lgkmcnt(2)
    v_add_f32 v6, v6, v17
    v_mfma_f32_16x16x32_bf16 v[120:123], v[24:27], a[248:251], v[120:123]
    ds_read_b128 v[40:43], v2 offset:18688
    v_mfma_f32_16x16x32_bf16 v[120:123], v[28:31], a[252:255], v[120:123]
    v_exp_f32 v19, v71
    v_cvt_pk_bf16_f32 v68, v16, v17
    v_mfma_f32_16x16x32_bf16 v[124:127], v[24:27], v[208:211], v[124:127]
    ds_read_b128 v[44:47], v3 offset:18688
    v_mfma_f32_16x16x32_bf16 v[124:127], v[28:31], v[212:215], v[124:127]
    s_waitcnt lgkmcnt(2)
    v_add_u32 v1, 49152, v1
    v_exp_f32 v16, v100
    v_mfma_f32_16x16x32_bf16 v[88:91], v[32:35], v[192:195], v[88:91]
    ds_read_b128 v[24:27], v1 offset:0
    v_add_f32 v6, v6, v18
    v_mfma_f32_16x16x32_bf16 v[88:91], v[36:39], v[196:199], v[88:91]
    v_add_f32 v6, v6, v19
    v_mfma_f32_16x16x32_bf16 v[92:95], v[32:35], v[216:219], v[92:95]
    ds_read_b128 v[28:31], v1 offset:12288
    v_mfma_f32_16x16x32_bf16 v[92:95], v[36:39], v[220:223], v[92:95]
    s_waitcnt lgkmcnt(2)
    v_exp_f32 v17, v101
    v_cvt_pk_bf16_f32 v69, v18, v19
    v_mfma_f32_16x16x32_bf16 v[120:123], v[40:43], v[192:195], v[120:123]
    ds_read_b128 v[32:35], v1 offset:1024
    v_mfma_f32_16x16x32_bf16 v[120:123], v[44:47], v[196:199], v[120:123]
    v_exp_f32 v18, v102
    v_mfma_f32_16x16x32_bf16 v[124:127], v[40:43], v[216:219], v[124:127]
    ds_read_b128 v[36:39], v1 offset:13312
    v_add_f32 v6, v6, v16
    v_mfma_f32_16x16x32_bf16 v[124:127], v[44:47], v[220:223], v[124:127]
    s_waitcnt lgkmcnt(2)
    v_add_f32 v6, v6, v17
    v_exp_f32 v19, v103
    v_cvt_pk_bf16_f32 v70, v16, v17
    v_add_f32 v6, v6, v18
    v_add_f32 v6, v6, v19
    v_cvt_pk_bf16_f32 v71, v18, v19
    v_mfma_f32_16x16x32_bf16 a[0:3], v[160:163], v[24:27], a[0:3]
    ds_read_b128 v[40:43], v1 offset:2048
    v_mfma_f32_16x16x32_bf16 a[0:3], v[168:171], v[28:31], a[0:3]
    v_exp_f32 v16, v72
    v_mfma_f32_16x16x32_bf16 a[48:51], v[164:167], v[24:27], a[48:51]
    ds_read_b128 v[44:47], v1 offset:14336
    v_mfma_f32_16x16x32_bf16 a[48:51], v[172:175], v[28:31], a[48:51]
    s_waitcnt lgkmcnt(2)
    v_exp_f32 v17, v73
    v_mfma_f32_16x16x32_bf16 a[4:7], v[160:163], v[32:35], a[4:7]
    ds_read_b128 v[24:27], v1 offset:3072
    v_mfma_f32_16x16x32_bf16 a[4:7], v[168:171], v[36:39], a[4:7]
    v_exp_f32 v18, v74
    v_mfma_f32_16x16x32_bf16 a[52:55], v[164:167], v[32:35], a[52:55]
    ds_read_b128 v[28:31], v1 offset:15360
    v_add_f32 v5, v5, v16
    v_mfma_f32_16x16x32_bf16 a[52:55], v[172:175], v[36:39], a[52:55]
    s_waitcnt lgkmcnt(2)
    v_add_f32 v5, v5, v17
    v_mfma_f32_16x16x32_bf16 a[8:11], v[160:163], v[40:43], a[8:11]
    ds_read_b128 v[32:35], v1 offset:4096
    v_mfma_f32_16x16x32_bf16 a[8:11], v[168:171], v[44:47], a[8:11]
    v_exp_f32 v19, v75
    v_mfma_f32_16x16x32_bf16 a[56:59], v[164:167], v[40:43], a[56:59]
    ds_read_b128 v[36:39], v1 offset:16384
    v_cvt_pk_bf16_f32 v72, v16, v17
    v_mfma_f32_16x16x32_bf16 a[56:59], v[172:175], v[44:47], a[56:59]
    s_waitcnt lgkmcnt(2)
    v_exp_f32 v16, v104
    v_mfma_f32_16x16x32_bf16 a[12:15], v[160:163], v[24:27], a[12:15]
    ds_read_b128 v[40:43], v1 offset:5120
    v_add_f32 v5, v5, v18
    v_mfma_f32_16x16x32_bf16 a[12:15], v[168:171], v[28:31], a[12:15]
    v_add_f32 v5, v5, v19
    v_mfma_f32_16x16x32_bf16 a[60:63], v[164:167], v[24:27], a[60:63]
    ds_read_b128 v[44:47], v1 offset:17408
    v_mfma_f32_16x16x32_bf16 a[60:63], v[172:175], v[28:31], a[60:63]
    s_waitcnt lgkmcnt(2)
    v_exp_f32 v17, v105
    v_mfma_f32_16x16x32_bf16 a[16:19], v[160:163], v[32:35], a[16:19]
    ds_read_b128 v[24:27], v1 offset:6144
    v_cvt_pk_bf16_f32 v73, v18, v19
    v_mfma_f32_16x16x32_bf16 a[16:19], v[168:171], v[36:39], a[16:19]
    v_exp_f32 v18, v106
    v_mfma_f32_16x16x32_bf16 a[64:67], v[164:167], v[32:35], a[64:67]
    ds_read_b128 v[28:31], v1 offset:18432
    v_add_f32 v5, v5, v16
    v_mfma_f32_16x16x32_bf16 a[64:67], v[172:175], v[36:39], a[64:67]
    s_waitcnt lgkmcnt(2)
    v_add_f32 v5, v5, v17
    v_mfma_f32_16x16x32_bf16 a[20:23], v[160:163], v[40:43], a[20:23]
    ds_read_b128 v[32:35], v1 offset:7168
    v_mfma_f32_16x16x32_bf16 a[20:23], v[168:171], v[44:47], a[20:23]
    v_exp_f32 v19, v107
    v_mfma_f32_16x16x32_bf16 a[68:71], v[164:167], v[40:43], a[68:71]
    ds_read_b128 v[36:39], v1 offset:19456
    v_cvt_pk_bf16_f32 v74, v16, v17
    v_mfma_f32_16x16x32_bf16 a[68:71], v[172:175], v[44:47], a[68:71]
    s_waitcnt lgkmcnt(2)
    v_exp_f32 v16, v76
    v_mfma_f32_16x16x32_bf16 a[24:27], v[160:163], v[24:27], a[24:27]
    ds_read_b128 v[40:43], v1 offset:8192
    v_add_f32 v5, v5, v18
    v_mfma_f32_16x16x32_bf16 a[24:27], v[168:171], v[28:31], a[24:27]
    v_add_f32 v5, v5, v19
    v_mfma_f32_16x16x32_bf16 a[72:75], v[164:167], v[24:27], a[72:75]
    ds_read_b128 v[44:47], v1 offset:20480
    v_mfma_f32_16x16x32_bf16 a[72:75], v[172:175], v[28:31], a[72:75]
    s_waitcnt lgkmcnt(2)
    v_exp_f32 v17, v77
    v_mfma_f32_16x16x32_bf16 a[28:31], v[160:163], v[32:35], a[28:31]
    ds_read_b128 v[24:27], v1 offset:9216
    v_cvt_pk_bf16_f32 v75, v18, v19
    v_mfma_f32_16x16x32_bf16 a[28:31], v[168:171], v[36:39], a[28:31]
    v_exp_f32 v18, v78
    v_mfma_f32_16x16x32_bf16 a[76:79], v[164:167], v[32:35], a[76:79]
    ds_read_b128 v[28:31], v1 offset:21504
    v_add_f32 v6, v6, v16
    v_mfma_f32_16x16x32_bf16 a[76:79], v[172:175], v[36:39], a[76:79]
    s_waitcnt lgkmcnt(2)
    v_add_f32 v6, v6, v17
    v_mfma_f32_16x16x32_bf16 a[32:35], v[160:163], v[40:43], a[32:35]
    ds_read_b128 v[32:35], v1 offset:10240
    v_mfma_f32_16x16x32_bf16 a[32:35], v[168:171], v[44:47], a[32:35]
    v_exp_f32 v19, v79
    v_mfma_f32_16x16x32_bf16 a[80:83], v[164:167], v[40:43], a[80:83]
    ds_read_b128 v[36:39], v1 offset:22528
    v_cvt_pk_bf16_f32 v76, v16, v17
    v_mfma_f32_16x16x32_bf16 a[80:83], v[172:175], v[44:47], a[80:83]
    s_waitcnt lgkmcnt(2)
    v_exp_f32 v16, v108
    v_mfma_f32_16x16x32_bf16 a[36:39], v[160:163], v[24:27], a[36:39]
    ds_read_b128 v[40:43], v1 offset:11264
    v_add_f32 v6, v6, v18
    v_mfma_f32_16x16x32_bf16 a[36:39], v[168:171], v[28:31], a[36:39]
    v_add_f32 v6, v6, v19
    v_mfma_f32_16x16x32_bf16 a[84:87], v[164:167], v[24:27], a[84:87]
    ds_read_b128 v[44:47], v1 offset:23552
    v_mfma_f32_16x16x32_bf16 a[84:87], v[172:175], v[28:31], a[84:87]
    s_waitcnt lgkmcnt(2)
    v_subrev_u32 v1, 98304, v1
    v_mfma_f32_16x16x32_bf16 a[40:43], v[160:163], v[32:35], a[40:43]
    ds_read_b128 v[24:27], v1 offset:0
    v_mfma_f32_16x16x32_bf16 a[40:43], v[168:171], v[36:39], a[40:43]
    v_exp_f32 v17, v109
    v_mfma_f32_16x16x32_bf16 a[88:91], v[164:167], v[32:35], a[88:91]
    ds_read_b128 v[28:31], v1 offset:12288
    v_cvt_pk_bf16_f32 v77, v18, v19
    v_mfma_f32_16x16x32_bf16 a[88:91], v[172:175], v[36:39], a[88:91]
    s_waitcnt lgkmcnt(2)
    v_exp_f32 v18, v110
    v_mfma_f32_16x16x32_bf16 a[44:47], v[160:163], v[40:43], a[44:47]
    ds_read_b128 v[32:35], v1 offset:1024
    v_add_f32 v6, v6, v16
    v_mfma_f32_16x16x32_bf16 a[44:47], v[168:171], v[44:47], a[44:47]
    v_add_f32 v6, v6, v17
    v_mfma_f32_16x16x32_bf16 a[92:95], v[164:167], v[40:43], a[92:95]
    ds_read_b128 v[36:39], v1 offset:13312
    v_mfma_f32_16x16x32_bf16 a[92:95], v[172:175], v[44:47], a[92:95]
    s_waitcnt lgkmcnt(2)
    v_exp_f32 v19, v111
    v_mfma_f32_16x16x32_bf16 a[0:3], v[176:179], v[24:27], a[0:3]
    ds_read_b128 v[40:43], v1 offset:2048
    v_cvt_pk_bf16_f32 v78, v16, v17
    v_mfma_f32_16x16x32_bf16 a[0:3], v[184:187], v[28:31], a[0:3]
    v_add_f32 v6, v6, v18
    v_add_f32 v6, v6, v19
    v_mfma_f32_16x16x32_bf16 a[48:51], v[180:183], v[24:27], a[48:51]
    ds_read_b128 v[44:47], v1 offset:14336
    v_cvt_pk_bf16_f32 v79, v18, v19
    v_mfma_f32_16x16x32_bf16 a[48:51], v[188:191], v[28:31], a[48:51]
    s_waitcnt lgkmcnt(2)
    v_exp_f32 v16, v80
    v_mfma_f32_16x16x32_bf16 a[4:7], v[176:179], v[32:35], a[4:7]
    ds_read_b128 v[24:27], v1 offset:3072
    v_mfma_f32_16x16x32_bf16 a[4:7], v[184:187], v[36:39], a[4:7]
    v_exp_f32 v17, v81
    v_mfma_f32_16x16x32_bf16 a[52:55], v[180:183], v[32:35], a[52:55]
    ds_read_b128 v[28:31], v1 offset:15360
    v_mfma_f32_16x16x32_bf16 a[52:55], v[188:191], v[36:39], a[52:55]
    s_waitcnt lgkmcnt(2)
    v_exp_f32 v18, v82
    v_mfma_f32_16x16x32_bf16 a[8:11], v[176:179], v[40:43], a[8:11]
    ds_read_b128 v[32:35], v1 offset:4096
    v_add_f32 v7, v7, v16
    v_mfma_f32_16x16x32_bf16 a[8:11], v[184:187], v[44:47], a[8:11]
    v_add_f32 v7, v7, v17
    v_mfma_f32_16x16x32_bf16 a[56:59], v[180:183], v[40:43], a[56:59]
    ds_read_b128 v[36:39], v1 offset:16384
    v_mfma_f32_16x16x32_bf16 a[56:59], v[188:191], v[44:47], a[56:59]
    s_waitcnt lgkmcnt(2)
    v_exp_f32 v19, v83
    v_mfma_f32_16x16x32_bf16 a[12:15], v[176:179], v[24:27], a[12:15]
    ds_read_b128 v[40:43], v1 offset:5120
    v_cvt_pk_bf16_f32 v80, v16, v17
    v_mfma_f32_16x16x32_bf16 a[12:15], v[184:187], v[28:31], a[12:15]
    v_exp_f32 v16, v112
    v_mfma_f32_16x16x32_bf16 a[60:63], v[180:183], v[24:27], a[60:63]
    ds_read_b128 v[44:47], v1 offset:17408
    v_add_f32 v7, v7, v18
    v_mfma_f32_16x16x32_bf16 a[60:63], v[188:191], v[28:31], a[60:63]
    s_waitcnt lgkmcnt(2)
    v_add_f32 v7, v7, v19
    v_mfma_f32_16x16x32_bf16 a[16:19], v[176:179], v[32:35], a[16:19]
    ds_read_b128 v[24:27], v1 offset:6144
    v_mfma_f32_16x16x32_bf16 a[16:19], v[184:187], v[36:39], a[16:19]
    v_exp_f32 v17, v113
    v_mfma_f32_16x16x32_bf16 a[64:67], v[180:183], v[32:35], a[64:67]
    ds_read_b128 v[28:31], v1 offset:18432
    v_cvt_pk_bf16_f32 v81, v18, v19
    v_mfma_f32_16x16x32_bf16 a[64:67], v[188:191], v[36:39], a[64:67]
    s_waitcnt lgkmcnt(2)
    v_exp_f32 v18, v114
    v_mfma_f32_16x16x32_bf16 a[20:23], v[176:179], v[40:43], a[20:23]
    ds_read_b128 v[32:35], v1 offset:7168
    v_add_f32 v7, v7, v16
    v_mfma_f32_16x16x32_bf16 a[20:23], v[184:187], v[44:47], a[20:23]
    v_add_f32 v7, v7, v17
    v_mfma_f32_16x16x32_bf16 a[68:71], v[180:183], v[40:43], a[68:71]
    ds_read_b128 v[36:39], v1 offset:19456
    v_mfma_f32_16x16x32_bf16 a[68:71], v[188:191], v[44:47], a[68:71]
    s_waitcnt lgkmcnt(2)
    v_exp_f32 v19, v115
    v_mfma_f32_16x16x32_bf16 a[24:27], v[176:179], v[24:27], a[24:27]
    ds_read_b128 v[40:43], v1 offset:8192
    v_cvt_pk_bf16_f32 v82, v16, v17
    v_mfma_f32_16x16x32_bf16 a[24:27], v[184:187], v[28:31], a[24:27]
    v_exp_f32 v16, v84
    v_mfma_f32_16x16x32_bf16 a[72:75], v[180:183], v[24:27], a[72:75]
    ds_read_b128 v[44:47], v1 offset:20480
    v_add_f32 v7, v7, v18
    v_mfma_f32_16x16x32_bf16 a[72:75], v[188:191], v[28:31], a[72:75]
    s_waitcnt lgkmcnt(2)
    v_add_f32 v7, v7, v19
    v_mfma_f32_16x16x32_bf16 a[28:31], v[176:179], v[32:35], a[28:31]
    ds_read_b128 v[24:27], v1 offset:9216
    v_mfma_f32_16x16x32_bf16 a[28:31], v[184:187], v[36:39], a[28:31]
    s_waitcnt vmcnt(0)
    v_exp_f32 v17, v85
    v_mfma_f32_16x16x32_bf16 a[76:79], v[180:183], v[32:35], a[76:79]
    ds_read_b128 v[28:31], v1 offset:21504
    v_cvt_pk_bf16_f32 v83, v18, v19
    v_mfma_f32_16x16x32_bf16 a[76:79], v[188:191], v[36:39], a[76:79]
    s_waitcnt lgkmcnt(2)
    s_barrier
    v_mfma_f32_16x16x32_bf16 a[32:35], v[176:179], v[40:43], a[32:35]
    ds_read_b128 v[32:35], v1 offset:10240
    v_mfma_f32_16x16x32_bf16 a[32:35], v[184:187], v[44:47], a[32:35]
    v_exp_f32 v18, v86
    v_mfma_f32_16x16x32_bf16 a[80:83], v[180:183], v[40:43], a[80:83]
    ds_read_b128 v[36:39], v1 offset:22528
    v_add_f32 v8, v8, v16
    v_mfma_f32_16x16x32_bf16 a[80:83], v[188:191], v[44:47], a[80:83]
    s_waitcnt lgkmcnt(2)
    v_add_f32 v8, v8, v17
    v_mfma_f32_16x16x32_bf16 a[36:39], v[176:179], v[24:27], a[36:39]
    ds_read_b128 v[40:43], v1 offset:11264
    v_mfma_f32_16x16x32_bf16 a[36:39], v[184:187], v[28:31], a[36:39]
    v_exp_f32 v19, v87
    v_cvt_pk_bf16_f32 v84, v16, v17
    v_mfma_f32_16x16x32_bf16 a[84:87], v[180:183], v[24:27], a[84:87]
    ds_read_b128 v[44:47], v1 offset:23552
    v_mfma_f32_16x16x32_bf16 a[84:87], v[188:191], v[28:31], a[84:87]
    s_waitcnt lgkmcnt(2)
    v_add_u32 v1, 49152, v1
    v_exp_f32 v16, v116
    v_mfma_f32_16x16x32_bf16 a[40:43], v[176:179], v[32:35], a[40:43]
    ds_read_b128 v[24:27], v1 offset:0
    v_add_f32 v8, v8, v18
    v_mfma_f32_16x16x32_bf16 a[40:43], v[184:187], v[36:39], a[40:43]
    v_add_f32 v8, v8, v19
    v_mfma_f32_16x16x32_bf16 a[88:91], v[180:183], v[32:35], a[88:91]
    ds_read_b128 v[28:31], v1 offset:12288
    v_mfma_f32_16x16x32_bf16 a[88:91], v[188:191], v[36:39], a[88:91]
    s_waitcnt lgkmcnt(2)
    v_exp_f32 v17, v117
    v_cvt_pk_bf16_f32 v85, v18, v19
    v_mfma_f32_16x16x32_bf16 a[44:47], v[176:179], v[40:43], a[44:47]
    ds_read_b128 v[32:35], v1 offset:1024
    v_mfma_f32_16x16x32_bf16 a[44:47], v[184:187], v[44:47], a[44:47]
    v_exp_f32 v18, v118
    v_mfma_f32_16x16x32_bf16 a[92:95], v[180:183], v[40:43], a[92:95]
    ds_read_b128 v[36:39], v1 offset:13312
    v_add_f32 v8, v8, v16
    v_mfma_f32_16x16x32_bf16 a[92:95], v[188:191], v[44:47], a[92:95]
    s_waitcnt lgkmcnt(2)
    v_add_f32 v8, v8, v17
    v_exp_f32 v19, v119
    v_cvt_pk_bf16_f32 v86, v16, v17
    v_add_f32 v8, v8, v18
    v_add_f32 v8, v8, v19
    v_cvt_pk_bf16_f32 v87, v18, v19
    v_mfma_f32_16x16x32_bf16 a[0:3], v[64:67], v[24:27], a[0:3]
    ds_read_b128 v[40:43], v1 offset:2048
    v_mfma_f32_16x16x32_bf16 a[0:3], v[72:75], v[28:31], a[0:3]
    v_exp_f32 v16, v88
    v_exp_f32 v17, v89
    v_exp_f32 v18, v90
    v_mfma_f32_16x16x4_f32 v[48:51], v5, v57, 0
    v_mfma_f32_16x16x32_bf16 a[48:51], v[68:71], v[24:27], a[48:51]
    ds_read_b128 v[44:47], v1 offset:14336
    v_mfma_f32_16x16x32_bf16 a[48:51], v[76:79], v[28:31], a[48:51]
    s_waitcnt lgkmcnt(2)
    v_exp_f32 v19, v91
    v_cvt_pk_bf16_f32 v88, v16, v17
    v_exp_f32 v16, v120
    v_mfma_f32_16x16x4_f32 v[52:55], v6, v57, 0
    v_mfma_f32_16x16x32_bf16 a[4:7], v[64:67], v[32:35], a[4:7]
    ds_read_b128 v[24:27], v1 offset:3072
    v_mfma_f32_16x16x32_bf16 a[4:7], v[72:75], v[36:39], a[4:7]
    v_exp_f32 v17, v121
    v_cvt_pk_bf16_f32 v89, v18, v19
    v_mfma_f32_16x16x32_bf16 a[52:55], v[68:71], v[32:35], a[52:55]
    ds_read_b128 v[28:31], v1 offset:15360
    v_mfma_f32_16x16x32_bf16 a[52:55], v[76:79], v[36:39], a[52:55]
    s_waitcnt lgkmcnt(2)
    v_exp_f32 v18, v122
    v_mfma_f32_16x16x32_bf16 a[8:11], v[64:67], v[40:43], a[8:11]
    ds_read_b128 v[32:35], v1 offset:4096
    v_mfma_f32_16x16x32_bf16 a[8:11], v[72:75], v[44:47], a[8:11]
    v_exp_f32 v19, v123
    v_mfma_f32_16x16x32_bf16 a[56:59], v[68:71], v[40:43], a[56:59]
    ds_read_b128 v[36:39], v1 offset:16384
    v_cvt_pk_bf16_f32 v90, v16, v17
    v_mfma_f32_16x16x32_bf16 a[56:59], v[76:79], v[44:47], a[56:59]
    s_waitcnt lgkmcnt(2)
    v_exp_f32 v16, v92
    v_mfma_f32_16x16x32_bf16 a[12:15], v[64:67], v[24:27], a[12:15]
    ds_read_b128 v[40:43], v1 offset:5120
    v_mfma_f32_16x16x32_bf16 a[12:15], v[72:75], v[28:31], a[12:15]
    v_exp_f32 v17, v93
    v_mfma_f32_16x16x32_bf16 a[60:63], v[68:71], v[24:27], a[60:63]
    ds_read_b128 v[44:47], v1 offset:17408
    v_cvt_pk_bf16_f32 v91, v18, v19
    v_mfma_f32_16x16x32_bf16 a[60:63], v[76:79], v[28:31], a[60:63]
    s_waitcnt lgkmcnt(2)
    v_exp_f32 v18, v94
    v_mfma_f32_16x16x32_bf16 a[16:19], v[64:67], v[32:35], a[16:19]
    ds_read_b128 v[24:27], v1 offset:6144
    v_mfma_f32_16x16x32_bf16 a[16:19], v[72:75], v[36:39], a[16:19]
    v_exp_f32 v19, v95
    v_mfma_f32_16x16x32_bf16 a[64:67], v[68:71], v[32:35], a[64:67]
    ds_read_b128 v[28:31], v1 offset:18432
    v_mfma_f32_16x16x32_bf16 a[64:67], v[76:79], v[36:39], a[64:67]
    s_waitcnt lgkmcnt(2)
    v_mfma_f32_16x16x32_bf16 v[128:131], v[88:91], v[20:23], 0
    v_mfma_f32_16x16x32_bf16 a[20:23], v[64:67], v[40:43], a[20:23]
    ds_read_b128 v[32:35], v1 offset:7168
    v_cvt_pk_bf16_f32 v92, v16, v17
    v_mfma_f32_16x16x32_bf16 a[20:23], v[72:75], v[44:47], a[20:23]
L_pg12:
    s_cbranch_execz L_iwret
    v_exp_f32 v16, v124
    v_mfma_f32_16x16x32_bf16 a[68:71], v[68:71], v[40:43], a[68:71]
    ds_read_b128 v[36:39], v1 offset:19456
    v_mfma_f32_16x16x32_bf16 a[68:71], v[76:79], v[44:47], a[68:71]
    s_waitcnt lgkmcnt(2)
    v_exp_f32 v17, v125
    v_mfma_f32_16x16x32_bf16 a[24:27], v[64:67], v[24:27], a[24:27]
    ds_read_b128 v[40:43], v1 offset:8192
    v_cvt_pk_bf16_f32 v93, v18, v19
    v_mfma_f32_16x16x32_bf16 a[24:27], v[72:75], v[28:31], a[24:27]
    v_exp_f32 v18, v126
    v_mfma_f32_16x16x32_bf16 a[72:75], v[68:71], v[24:27], a[72:75]
    ds_read_b128 v[44:47], v1 offset:20480
    v_mfma_f32_16x16x32_bf16 a[72:75], v[76:79], v[28:31], a[72:75]
    s_waitcnt lgkmcnt(2)
    v_exp_f32 v19, v127
    v_mfma_f32_16x16x32_bf16 a[28:31], v[64:67], v[32:35], a[28:31]
    ds_read_b128 v[24:27], v1 offset:9216
    v_cvt_pk_bf16_f32 v94, v16, v17
    v_mfma_f32_16x16x32_bf16 a[28:31], v[72:75], v[36:39], a[28:31]
    v_cvt_pk_bf16_f32 v95, v18, v19
    s_nop 1
    v_mfma_f32_16x16x32_bf16 a[76:79], v[68:71], v[32:35], a[76:79]
    ds_read_b128 v[28:31], v1 offset:21504
    v_mfma_f32_16x16x32_bf16 a[76:79], v[76:79], v[36:39], a[76:79]
    s_waitcnt lgkmcnt(2)
    v_mfma_f32_16x16x32_bf16 v[132:135], v[92:95], v[20:23], 0
    v_mfma_f32_16x16x32_bf16 a[32:35], v[64:67], v[40:43], a[32:35]
    ds_read_b128 v[32:35], v1 offset:10240
    v_mfma_f32_16x16x32_bf16 a[32:35], v[72:75], v[44:47], a[32:35]
    v_rcp_f32 v48, v48
    v_mfma_f32_16x16x32_bf16 a[80:83], v[68:71], v[40:43], a[80:83]
    ds_read_b128 v[36:39], v1 offset:22528
    v_mfma_f32_16x16x32_bf16 a[80:83], v[76:79], v[44:47], a[80:83]
    s_waitcnt lgkmcnt(2)
    v_rcp_f32 v49, v49
    v_mfma_f32_16x16x32_bf16 a[36:39], v[64:67], v[24:27], a[36:39]
    ds_read_b128 v[40:43], v1 offset:11264
    v_mfma_f32_16x16x32_bf16 a[36:39], v[72:75], v[28:31], a[36:39]
    v_rcp_f32 v50, v50
    v_mfma_f32_16x16x32_bf16 a[84:87], v[68:71], v[24:27], a[84:87]
    ds_read_b128 v[44:47], v1 offset:23552
    v_mfma_f32_16x16x32_bf16 a[84:87], v[76:79], v[28:31], a[84:87]
    s_waitcnt lgkmcnt(2)
    v_subrev_u32 v2, 98304, v2
    v_subrev_u32 v3, 98304, v3
    v_mfma_f32_16x16x32_bf16 a[40:43], v[64:67], v[32:35], a[40:43]
    ds_read_b128 v[24:27], v2 offset:0
    v_mfma_f32_16x16x32_bf16 a[40:43], v[72:75], v[36:39], a[40:43]
    v_rcp_f32 v51, v51
    v_mfma_f32_16x16x32_bf16 a[88:91], v[68:71], v[32:35], a[88:91]
    ds_read_b128 v[28:31], v3 offset:0
    v_mfma_f32_16x16x32_bf16 a[88:91], v[76:79], v[36:39], a[88:91]
    s_waitcnt lgkmcnt(2)
    v_rcp_f32 v52, v52
    v_mfma_f32_16x16x32_bf16 a[44:47], v[64:67], v[40:43], a[44:47]
    ds_read_b128 v[32:35], v2 offset:6144
    v_mfma_f32_16x16x32_bf16 a[44:47], v[72:75], v[44:47], a[44:47]
    v_rcp_f32 v53, v53
    v_mfma_f32_16x16x32_bf16 a[92:95], v[68:71], v[40:43], a[92:95]
    ds_read_b128 v[36:39], v3 offset:6144
    v_mfma_f32_16x16x32_bf16 a[92:95], v[76:79], v[44:47], a[92:95]
    s_waitcnt lgkmcnt(2)
    v_rcp_f32 v54, v54
    v_mfma_f32_16x16x32_bf16 v[160:163], v[24:27], a[240:243], v[136:139]
    ds_read_b128 v[40:43], v2 offset:128
    v_mfma_f32_16x16x32_bf16 v[160:163], v[28:31], a[244:247], v[160:163]
    v_rcp_f32 v55, v55
    v_mfma_f32_16x16x32_bf16 v[164:167], v[24:27], v[200:203], v[140:143]
    ds_read_b128 v[44:47], v3 offset:128
    v_mfma_f32_16x16x32_bf16 v[164:167], v[28:31], v[204:207], v[164:167]
    s_waitcnt lgkmcnt(2)
    v_mfma_f32_16x16x32_bf16 v[96:99], v[32:35], a[240:243], v[136:139]
    ds_read_b128 v[24:27], v2 offset:6272
    v_accvgpr_read_b32 v224, a0
    v_mfma_f32_16x16x32_bf16 v[96:99], v[36:39], a[244:247], v[96:99]
    v_accvgpr_read_b32 v225, a4
    v_accvgpr_read_b32 v226, a8
    v_accvgpr_read_b32 v227, a12
    v_accvgpr_read_b32 v228, a16
    v_accvgpr_read_b32 v229, a20
    v_mfma_f32_16x16x32_bf16 v[100:103], v[32:35], v[200:203], v[140:143]
    ds_read_b128 v[28:31], v3 offset:6272
    v_mul_f32 v224, v224, v48
    v_mfma_f32_16x16x32_bf16 v[100:103], v[36:39], v[204:207], v[100:103]
    s_waitcnt lgkmcnt(2)
    v_mul_f32 v225, v225, v48
    v_mul_f32 v226, v226, v48
    v_mul_f32 v227, v227, v48
    v_mul_f32 v228, v228, v48
    v_mul_f32 v229, v229, v48
    v_mfma_f32_16x16x32_bf16 v[160:163], v[40:43], a[248:251], v[160:163]
    ds_read_b128 v[32:35], v2 offset:256
    v_cvt_pk_bf16_f32 v224, v224, v225
    v_mfma_f32_16x16x32_bf16 v[160:163], v[44:47], a[252:255], v[160:163]
    v_cvt_pk_bf16_f32 v225, v226, v227
    v_cvt_pk_bf16_f32 v226, v228, v229
    v_accvgpr_read_b32 v230, a1
    v_accvgpr_read_b32 v231, a5
    v_accvgpr_read_b32 v232, a9
    v_mfma_f32_16x16x32_bf16 v[164:167], v[40:43], v[208:211], v[164:167]
    ds_read_b128 v[36:39], v3 offset:256
    v_accvgpr_read_b32 v233, a13
    v_mfma_f32_16x16x32_bf16 v[164:167], v[44:47], v[212:215], v[164:167]
    s_waitcnt lgkmcnt(2)
    buffer_store_dwordx3 v[224:226], v56, s[12:15], s24 offen offset:0 sc0 sc1
    v_accvgpr_read_b32 v234, a17
    v_accvgpr_read_b32 v235, a21
    v_mfma_f32_16x16x32_bf16 v[96:99], v[24:27], a[248:251], v[96:99]
    ds_read_b128 v[40:43], v2 offset:6400
    v_mul_f32 v230, v230, v49
    v_mfma_f32_16x16x32_bf16 v[96:99], v[28:31], a[252:255], v[96:99]
    v_mul_f32 v231, v231, v49
    v_mul_f32 v232, v232, v49
    v_mul_f32 v233, v233, v49
    v_mul_f32 v234, v234, v49
    v_mul_f32 v235, v235, v49
    v_mfma_f32_16x16x32_bf16 v[100:103], v[24:27], v[208:211], v[100:103]
    ds_read_b128 v[44:47], v3 offset:6400
    v_cvt_pk_bf16_f32 v230, v230, v231
    v_mfma_f32_16x16x32_bf16 v[100:103], v[28:31], v[212:215], v[100:103]
    s_waitcnt lgkmcnt(2)
    v_cvt_pk_bf16_f32 v231, v232, v233
    v_cvt_pk_bf16_f32 v232, v234, v235
    v_accvgpr_read_b32 v236, a2
    v_accvgpr_read_b32 v237, a6
    v_accvgpr_read_b32 v238, a10
    v_mfma_f32_16x16x32_bf16 v[160:163], v[32:35], v[192:195], v[160:163]
    ds_read_b128 v[24:27], v2 offset:12288
    v_accvgpr_read_b32 v239, a14
    v_mfma_f32_16x16x32_bf16 v[160:163], v[36:39], v[196:199], v[160:163]
    buffer_store_dwordx3 v[230:232], v56, s[12:15], s24 offen offset:384 sc0 sc1
    v_accvgpr_read_b32 v240, a18
    v_accvgpr_read_b32 v241, a22
    v_mfma_f32_16x16x32_bf16 v[164:167], v[32:35], v[216:219], v[164:167]
    ds_read_b128 v[28:31], v3 offset:12288
    v_mul_f32 v236, v236, v50
    v_mfma_f32_16x16x32_bf16 v[164:167], v[36:39], v[220:223], v[164:167]
    s_waitcnt lgkmcnt(2)
    v_mul_f32 v237, v237, v50
    v_mul_f32 v238, v238, v50
    v_mul_f32 v239, v239, v50
    v_mul_f32 v240, v240, v50
    v_mul_f32 v241, v241, v50
    v_mfma_f32_16x16x32_bf16 v[96:99], v[40:43], v[192:195], v[96:99]
    ds_read_b128 v[32:35], v2 offset:18432
    v_cvt_pk_bf16_f32 v236, v236, v237
    v_mfma_f32_16x16x32_bf16 v[96:99], v[44:47], v[196:199], v[96:99]
    v_cvt_pk_bf16_f32 v237, v238, v239
    v_cvt_pk_bf16_f32 v238, v240, v241
    v_accvgpr_read_b32 v242, a3
    v_accvgpr_read_b32 v243, a7
    v_accvgpr_read_b32 v244, a11
    v_mfma_f32_16x16x32_bf16 v[100:103], v[40:43], v[216:219], v[100:103]
    ds_read_b128 v[36:39], v3 offset:18432
    v_accvgpr_read_b32 v245, a15
    v_mfma_f32_16x16x32_bf16 v[100:103], v[44:47], v[220:223], v[100:103]
    s_waitcnt lgkmcnt(2)
    buffer_store_dwordx3 v[236:238], v56, s[12:15], s24 offen offset:768 sc0 sc1
    v_accvgpr_read_b32 v246, a19
    v_accvgpr_read_b32 v247, a23
    v_mfma_f32_16x16x32_bf16 v[168:171], v[24:27], a[240:243], v[136:139]
    ds_read_b128 v[40:43], v2 offset:12416
    v_mul_f32 v242, v242, v51
    v_mfma_f32_16x16x32_bf16 v[168:171], v[28:31], a[244:247], v[168:171]
    v_mul_f32 v243, v243, v51
    v_mul_f32 v244, v244, v51
    v_mul_f32 v245, v245, v51
    v_mul_f32 v246, v246, v51
    v_mul_f32 v247, v247, v51
    v_mfma_f32_16x16x32_bf16 v[172:175], v[24:27], v[200:203], v[140:143]
    ds_read_b128 v[44:47], v3 offset:12416
    v_cvt_pk_bf16_f32 v242, v242, v243
    v_mfma_f32_16x16x32_bf16 v[172:175], v[28:31], v[204:207], v[172:175]
    s_waitcnt lgkmcnt(2)
    v_cvt_pk_bf16_f32 v243, v244, v245
    v_cvt_pk_bf16_f32 v244, v246, v247
    v_accvgpr_read_b32 v248, a24
    v_accvgpr_read_b32 v249, a28
    v_accvgpr_read_b32 v250, a32
    v_mfma_f32_16x16x32_bf16 v[104:107], v[32:35], a[240:243], v[136:139]
    ds_read_b128 v[24:27], v2 offset:18560
    v_accvgpr_read_b32 v251, a36
    v_mfma_f32_16x16x32_bf16 v[104:107], v[36:39], a[244:247], v[104:107]
    buffer_store_dwordx3 v[242:244], v56, s[12:15], s24 offen offset:1152 sc0 sc1
    v_accvgpr_read_b32 v252, a40
    v_accvgpr_read_b32 v253, a44
    v_mfma_f32_16x16x32_bf16 v[108:111], v[32:35], v[200:203], v[140:143]
    ds_read_b128 v[28:31], v3 offset:18560
    v_mul_f32 v248, v248, v48
    v_mfma_f32_16x16x32_bf16 v[108:111], v[36:39], v[204:207], v[108:111]
    s_waitcnt lgkmcnt(2)
    v_mul_f32 v249, v249, v48
    v_mul_f32 v250, v250, v48
    v_mul_f32 v251, v251, v48
    v_mul_f32 v252, v252, v48
    v_mul_f32 v253, v253, v48
    v_mfma_f32_16x16x32_bf16 v[168:171], v[40:43], a[248:251], v[168:171]
    ds_read_b128 v[32:35], v2 offset:12544
    v_cvt_pk_bf16_f32 v248, v248, v249
    v_mfma_f32_16x16x32_bf16 v[168:171], v[44:47], a[252:255], v[168:171]
    v_cvt_pk_bf16_f32 v249, v250, v251
    v_cvt_pk_bf16_f32 v250, v252, v253
    v_accvgpr_read_b32 v224, a25
    v_accvgpr_read_b32 v225, a29
    v_accvgpr_read_b32 v226, a33
    v_mfma_f32_16x16x32_bf16 v[172:175], v[40:43], v[208:211], v[172:175]
    ds_read_b128 v[36:39], v3 offset:12544
    v_accvgpr_read_b32 v227, a37
    v_mfma_f32_16x16x32_bf16 v[172:175], v[44:47], v[212:215], v[172:175]
    s_waitcnt lgkmcnt(2)
    buffer_store_dwordx3 v[248:250], v56, s[12:15], s24 offen offset:192 sc0 sc1
    v_accvgpr_read_b32 v228, a41
    v_mfma_f32_16x16x32_bf16 v[104:107], v[24:27], a[248:251], v[104:107]
    ds_read_b128 v[40:43], v2 offset:18688
    v_accvgpr_read_b32 v229, a45
    v_mfma_f32_16x16x32_bf16 v[104:107], v[28:31], a[252:255], v[104:107]
    v_mul_f32 v224, v224, v49
    v_mul_f32 v225, v225, v49
    v_mul_f32 v226, v226, v49
    v_mul_f32 v227, v227, v49
    v_mul_f32 v228, v228, v49
    v_mul_f32 v229, v229, v49
    v_mfma_f32_16x16x32_bf16 v[108:111], v[24:27], v[208:211], v[108:111]
    ds_read_b128 v[44:47], v3 offset:18688
    v_cvt_pk_bf16_f32 v224, v224, v225
    v_mfma_f32_16x16x32_bf16 v[108:111], v[28:31], v[212:215], v[108:111]
    s_waitcnt lgkmcnt(2)
    v_add_u32 v2, 49152, v2
    v_add_u32 v3, 49152, v3
    v_exp_f32 v16, v160
    v_cvt_pk_bf16_f32 v225, v226, v227
    v_mfma_f32_16x16x32_bf16 v[168:171], v[32:35], v[192:195], v[168:171]
    ds_read_b128 v[24:27], v2 offset:0
    v_cvt_pk_bf16_f32 v226, v228, v229
    v_mfma_f32_16x16x32_bf16 v[168:171], v[36:39], v[196:199], v[168:171]
    buffer_store_dwordx3 v[224:226], v56, s[12:15], s24 offen offset:576 sc0 sc1
    v_accvgpr_read_b32 v230, a26
    v_mfma_f32_16x16x32_bf16 v[172:175], v[32:35], v[216:219], v[172:175]
    ds_read_b128 v[28:31], v3 offset:0
    v_accvgpr_read_b32 v231, a30
    v_mfma_f32_16x16x32_bf16 v[172:175], v[36:39], v[220:223], v[172:175]
    s_waitcnt lgkmcnt(2)
    v_exp_f32 v17, v161
    v_exp_f32 v18, v162
    v_exp_f32 v19, v163
    v_mfma_f32_16x16x32_bf16 v[104:107], v[40:43], v[192:195], v[104:107]
    ds_read_b128 v[32:35], v2 offset:6144
    v_accvgpr_read_b32 v232, a34
    v_mfma_f32_16x16x32_bf16 v[104:107], v[44:47], v[196:199], v[104:107]
    v_cvt_pk_bf16_f32 v160, v16, v17
    v_accvgpr_read_b32 v233, a38
    v_accvgpr_read_b32 v234, a42
    v_exp_f32 v16, v96
    v_mfma_f32_16x16x32_bf16 v[108:111], v[40:43], v[216:219], v[108:111]
    ds_read_b128 v[36:39], v3 offset:6144
    v_accvgpr_read_b32 v235, a46
    v_mfma_f32_16x16x32_bf16 v[108:111], v[44:47], v[220:223], v[108:111]
    s_waitcnt lgkmcnt(2)
    v_mul_f32 v230, v230, v50
    v_exp_f32 v17, v97
    v_mul_f32 v231, v231, v50
    v_mul_f32 v232, v232, v50
    v_mfma_f32_16x16x32_bf16 v[176:179], v[24:27], a[240:243], v[136:139]
    ds_read_b128 v[40:43], v2 offset:128
    v_cvt_pk_bf16_f32 v161, v18, v19
    v_mfma_f32_16x16x32_bf16 v[176:179], v[28:31], a[244:247], v[176:179]
    v_mul_f32 v233, v233, v50
    v_exp_f32 v18, v98
    v_mul_f32 v234, v234, v50
    v_mul_f32 v235, v235, v50
    v_cvt_pk_bf16_f32 v230, v230, v231
    v_mfma_f32_16x16x32_bf16 v[180:183], v[24:27], v[200:203], v[140:143]
    ds_read_b128 v[44:47], v3 offset:128
    v_cvt_pk_bf16_f32 v231, v232, v233
    v_mfma_f32_16x16x32_bf16 v[180:183], v[28:31], v[204:207], v[180:183]
    s_waitcnt lgkmcnt(2)
    v_exp_f32 v19, v99
    v_cvt_pk_bf16_f32 v232, v234, v235
    v_accvgpr_read_b32 v236, a27
    v_cvt_pk_bf16_f32 v162, v16, v17
    v_mfma_f32_16x16x32_bf16 v[112:115], v[32:35], a[240:243], v[136:139]
    ds_read_b128 v[24:27], v2 offset:6272
    v_accvgpr_read_b32 v237, a31
    v_mfma_f32_16x16x32_bf16 v[112:115], v[36:39], a[244:247], v[112:115]
    buffer_store_dwordx3 v[230:232], v56, s[12:15], s24 offen offset:960 sc0 sc1
    v_accvgpr_read_b32 v238, a35
    v_mfma_f32_16x16x32_bf16 v[116:119], v[32:35], v[200:203], v[140:143]
    ds_read_b128 v[28:31], v3 offset:6272
    v_accvgpr_read_b32 v239, a39
    v_mfma_f32_16x16x32_bf16 v[116:119], v[36:39], v[204:207], v[116:119]
    s_waitcnt lgkmcnt(2)
    v_exp_f32 v16, v164
    v_exp_f32 v17, v165
    v_accvgpr_read_b32 v240, a43
    v_accvgpr_read_b32 v241, a47
    v_mfma_f32_16x16x32_bf16 v[176:179], v[40:43], a[248:251], v[176:179]
    ds_read_b128 v[32:35], v2 offset:256
    v_cvt_pk_bf16_f32 v163, v18, v19
    v_mfma_f32_16x16x32_bf16 v[176:179], v[44:47], a[252:255], v[176:179]
    v_exp_f32 v18, v166
    v_mul_f32 v236, v236, v51
    v_mul_f32 v237, v237, v51
    v_mul_f32 v238, v238, v51
    v_mfma_f32_16x16x32_bf16 v[180:183], v[40:43], v[208:211], v[180:183]
    ds_read_b128 v[36:39], v3 offset:256
    v_mul_f32 v239, v239, v51
    v_mfma_f32_16x16x32_bf16 v[180:183], v[44:47], v[212:215], v[180:183]
    s_waitcnt lgkmcnt(2)
    v_exp_f32 v19, v167
    v_mul_f32 v240, v240, v51
    v_mul_f32 v241, v241, v51
    v_cvt_pk_bf16_f32 v236, v236, v237
    v_mfma_f32_16x16x32_bf16 v[112:115], v[24:27], a[248:251], v[112:115]
    ds_read_b128 v[40:43], v2 offset:6400
    v_cvt_pk_bf16_f32 v237, v238, v239
    v_mfma_f32_16x16x32_bf16 v[112:115], v[28:31], a[252:255], v[112:115]
    v_mfma_f32_16x16x32_bf16 v[128:131], v[160:163], v[20:23], v[128:131]
    v_cvt_pk_bf16_f32 v164, v16, v17
    v_cvt_pk_bf16_f32 v238, v240, v241
    v_accvgpr_read_b32 v242, a48
    v_mfma_f32_16x16x32_bf16 v[116:119], v[24:27], v[208:211], v[116:119]
    ds_read_b128 v[44:47], v3 offset:6400
    v_accvgpr_read_b32 v243, a52
    v_mfma_f32_16x16x32_bf16 v[116:119], v[28:31], v[212:215], v[116:119]
    s_waitcnt lgkmcnt(2)
    buffer_store_dwordx3 v[236:238], v56, s[12:15], s24 offen offset:1344 sc0 sc1
    v_exp_f32 v16, v100
    v_mfma_f32_16x16x32_bf16 v[176:179], v[32:35], v[192:195], v[176:179]
    ds_read_b128 v[24:27], v2 offset:12288
    v_accvgpr_read_b32 v244, a56
    v_mfma_f32_16x16x32_bf16 v[176:179], v[36:39], v[196:199], v[176:179]
    v_exp_f32 v17, v101
    v_accvgpr_read_b32 v245, a60
    v_cvt_pk_bf16_f32 v165, v18, v19
    v_accvgpr_read_b32 v246, a64
    v_mfma_f32_16x16x32_bf16 v[180:183], v[32:35], v[216:219], v[180:183]
    ds_read_b128 v[28:31], v3 offset:12288
    v_accvgpr_read_b32 v247, a68
    v_mfma_f32_16x16x32_bf16 v[180:183], v[36:39], v[220:223], v[180:183]
    s_waitcnt lgkmcnt(2)
    v_exp_f32 v18, v102
    v_mul_f32 v242, v242, v52
    v_mul_f32 v243, v243, v52
    v_mul_f32 v244, v244, v52
    v_mfma_f32_16x16x32_bf16 v[112:115], v[40:43], v[192:195], v[112:115]
    ds_read_b128 v[32:35], v2 offset:18432
    v_mul_f32 v245, v245, v52
    v_mfma_f32_16x16x32_bf16 v[112:115], v[44:47], v[196:199], v[112:115]
    v_exp_f32 v19, v103
    v_cvt_pk_bf16_f32 v166, v16, v17
    v_mul_f32 v246, v246, v52
    v_mul_f32 v247, v247, v52
    v_cvt_pk_bf16_f32 v167, v18, v19
    v_mfma_f32_16x16x32_bf16 v[116:119], v[40:43], v[216:219], v[116:119]
    ds_read_b128 v[36:39], v3 offset:18432
    v_cvt_pk_bf16_f32 v242, v242, v243
    v_mfma_f32_16x16x32_bf16 v[116:119], v[44:47], v[220:223], v[116:119]
    s_waitcnt lgkmcnt(2)
    s_nop 1
    v_cvt_pk_bf16_f32 v243, v244, v245
    v_cvt_pk_bf16_f32 v244, v246, v247
    v_accvgpr_read_b32 v248, a49
    v_mfma_f32_16x16x32_bf16 v[184:187], v[24:27], a[240:243], v[136:139]
    ds_read_b128 v[40:43], v2 offset:12416
    v_accvgpr_read_b32 v249, a53
    v_mfma_f32_16x16x32_bf16 v[184:187], v[28:31], a[244:247], v[184:187]
    buffer_store_dwordx3 v[242:244], v56, s[12:15], s40 offen offset:0 sc0 sc1
    v_accvgpr_read_b32 v250, a57
    v_mfma_f32_16x16x32_bf16 v[188:191], v[24:27], v[200:203], v[140:143]
    ds_read_b128 v[44:47], v3 offset:12416
    v_accvgpr_read_b32 v251, a61
    v_mfma_f32_16x16x32_bf16 v[188:191], v[28:31], v[204:207], v[188:191]
    s_waitcnt lgkmcnt(2)
    v_mfma_f32_16x16x32_bf16 v[132:135], v[164:167], v[20:23], v[132:135]
    v_exp_f32 v16, v168
    v_accvgpr_read_b32 v252, a65
    v_accvgpr_read_b32 v253, a69
    v_mfma_f32_16x16x32_bf16 v[120:123], v[32:35], a[240:243], v[136:139]
    ds_read_b128 v[24:27], v2 offset:18560
    v_mul_f32 v248, v248, v53
    v_mfma_f32_16x16x32_bf16 v[120:123], v[36:39], a[244:247], v[120:123]
    v_exp_f32 v17, v169
    v_exp_f32 v18, v170
    v_mul_f32 v249, v249, v53
    v_mfma_f32_16x16x32_bf16 v[124:127], v[32:35], v[200:203], v[140:143]
    ds_read_b128 v[28:31], v3 offset:18560
    v_mul_f32 v250, v250, v53
    v_mfma_f32_16x16x32_bf16 v[124:127], v[36:39], v[204:207], v[124:127]
    s_waitcnt lgkmcnt(2)
    v_exp_f32 v19, v171
    v_mul_f32 v251, v251, v53
    v_mul_f32 v252, v252, v53
    v_mul_f32 v253, v253, v53
    v_mfma_f32_16x16x32_bf16 v[184:187], v[40:43], a[248:251], v[184:187]
    ds_read_b128 v[32:35], v2 offset:12544
    v_cvt_pk_bf16_f32 v168, v16, v17
    v_mfma_f32_16x16x32_bf16 v[184:187], v[44:47], a[252:255], v[184:187]
    v_cvt_pk_bf16_f32 v248, v248, v249
    v_exp_f32 v16, v104
    v_cvt_pk_bf16_f32 v249, v250, v251
    v_cvt_pk_bf16_f32 v250, v252, v253
    v_accvgpr_read_b32 v224, a50
    v_mfma_f32_16x16x32_bf16 v[188:191], v[40:43], v[208:211], v[188:191]
    ds_read_b128 v[36:39], v3 offset:12544
    v_accvgpr_read_b32 v225, a54
    v_mfma_f32_16x16x32_bf16 v[188:191], v[44:47], v[212:215], v[188:191]
    s_waitcnt lgkmcnt(2)
    buffer_store_dwordx3 v[248:250], v56, s[12:15], s40 offen offset:384 sc0 sc1
    v_accvgpr_read_b32 v226, a58
    v_mfma_f32_16x16x32_bf16 v[120:123], v[24:27], a[248:251], v[120:123]
    ds_read_b128 v[40:43], v2 offset:18688
    v_accvgpr_read_b32 v227, a62
    v_mfma_f32_16x16x32_bf16 v[120:123], v[28:31], a[252:255], v[120:123]
    v_exp_f32 v17, v105
    v_cvt_pk_bf16_f32 v169, v18, v19
    v_accvgpr_read_b32 v228, a66
    v_accvgpr_read_b32 v229, a70
    v_mfma_f32_16x16x32_bf16 v[124:127], v[24:27], v[208:211], v[124:127]
    ds_read_b128 v[44:47], v3 offset:18688
    v_mul_f32 v224, v224, v54
    v_mfma_f32_16x16x32_bf16 v[124:127], v[28:31], v[212:215], v[124:127]
    s_waitcnt lgkmcnt(2)
    v_add_u32 v60, 49152, v1
    v_mov_b32 v59, v1
    v_subrev_u32 v1, 49152, v1
    v_exp_f32 v18, v106
    v_mfma_f32_16x16x32_bf16 v[184:187], v[32:35], v[192:195], v[184:187]
    ds_read_b128 v[24:27], v60 offset:0
    v_mul_f32 v225, v225, v54
    v_mfma_f32_16x16x32_bf16 v[184:187], v[36:39], v[196:199], v[184:187]
    v_exp_f32 v19, v107
    v_mul_f32 v226, v226, v54
    v_cvt_pk_bf16_f32 v170, v16, v17
    v_mul_f32 v227, v227, v54
    v_mul_f32 v228, v228, v54
    v_mfma_f32_16x16x32_bf16 v[188:191], v[32:35], v[216:219], v[188:191]
    ds_read_b128 v[28:31], v60 offset:12288
    v_mul_f32 v229, v229, v54
    v_mfma_f32_16x16x32_bf16 v[188:191], v[36:39], v[220:223], v[188:191]
    s_waitcnt lgkmcnt(2)
    v_exp_f32 v16, v172
    v_cvt_pk_bf16_f32 v224, v224, v225
    v_cvt_pk_bf16_f32 v225, v226, v227
    v_cvt_pk_bf16_f32 v226, v228, v229
    v_mfma_f32_16x16x32_bf16 v[120:123], v[40:43], v[192:195], v[120:123]
    ds_read_b128 v[32:35], v60 offset:1024
    v_accvgpr_read_b32 v230, a51
    v_mfma_f32_16x16x32_bf16 v[120:123], v[44:47], v[196:199], v[120:123]
    buffer_store_dwordx3 v[224:226], v56, s[12:15], s40 offen offset:768 sc0 sc1
    v_accvgpr_read_b32 v231, a55
    v_mfma_f32_16x16x32_bf16 v[124:127], v[40:43], v[216:219], v[124:127]
    ds_read_b128 v[36:39], v60 offset:13312
    v_accvgpr_read_b32 v232, a59
    v_mfma_f32_16x16x32_bf16 v[124:127], v[44:47], v[220:223], v[124:127]
    s_waitcnt lgkmcnt(2)
    v_exp_f32 v17, v173
    v_cvt_pk_bf16_f32 v171, v18, v19
    v_exp_f32 v18, v174
    v_accvgpr_read_b32 v233, a63
    v_mfma_f32_16x16x32_bf16 a[96:99], v[80:83], v[24:27], a[96:99]
    ds_read_b128 v[40:43], v60 offset:2048
    v_accvgpr_read_b32 v234, a67
    v_mfma_f32_16x16x32_bf16 a[96:99], v[88:91], v[28:31], a[96:99]
    v_exp_f32 v19, v175
    v_accvgpr_read_b32 v235, a71
    v_mul_f32 v230, v230, v55
    v_mul_f32 v231, v231, v55
    v_mfma_f32_16x16x32_bf16 a[144:147], v[84:87], v[24:27], a[144:147]
    ds_read_b128 v[44:47], v60 offset:14336
    v_mul_f32 v232, v232, v55
    v_mfma_f32_16x16x32_bf16 a[144:147], v[92:95], v[28:31], a[144:147]
    s_waitcnt lgkmcnt(2)
    v_mfma_f32_16x16x32_bf16 v[128:131], v[168:171], v[20:23], v[128:131]
    v_mul_f32 v233, v233, v55
    v_mul_f32 v234, v234, v55
    v_mul_f32 v235, v235, v55
    v_mfma_f32_16x16x32_bf16 a[100:103], v[80:83], v[32:35], a[100:103]
    ds_read_b128 v[24:27], v60 offset:3072
    v_cvt_pk_bf16_f32 v172, v16, v17
    v_mfma_f32_16x16x32_bf16 a[100:103], v[88:91], v[36:39], a[100:103]
    v_exp_f32 v16, v108
    v_cvt_pk_bf16_f32 v230, v230, v231
    v_cvt_pk_bf16_f32 v231, v232, v233
    v_cvt_pk_bf16_f32 v232, v234, v235
    v_accvgpr_read_b32 v236, a72
    v_mfma_f32_16x16x32_bf16 a[148:151], v[84:87], v[32:35], a[148:151]
    ds_read_b128 v[28:31], v60 offset:15360
    v_accvgpr_read_b32 v237, a76
    v_mfma_f32_16x16x32_bf16 a[148:151], v[92:95], v[36:39], a[148:151]
    s_waitcnt lgkmcnt(2)
    buffer_store_dwordx3 v[230:232], v56, s[12:15], s40 offen offset:1152 sc0 sc1
    v_accvgpr_read_b32 v238, a80
    v_mfma_f32_16x16x32_bf16 a[104:107], v[80:83], v[40:43], a[104:107]
    ds_read_b128 v[32:35], v60 offset:4096
    v_accvgpr_read_b32 v239, a84
    v_mfma_f32_16x16x32_bf16 a[104:107], v[88:91], v[44:47], a[104:107]
    v_exp_f32 v17, v109
    v_cvt_pk_bf16_f32 v173, v18, v19
    v_accvgpr_read_b32 v240, a88
    v_accvgpr_read_b32 v241, a92
    v_mfma_f32_16x16x32_bf16 a[152:155], v[84:87], v[40:43], a[152:155]
    ds_read_b128 v[36:39], v60 offset:16384
    v_mul_f32 v236, v236, v52
    v_mfma_f32_16x16x32_bf16 a[152:155], v[92:95], v[44:47], a[152:155]
    s_waitcnt lgkmcnt(2)
    v_exp_f32 v18, v110
    v_mul_f32 v237, v237, v52
    v_mul_f32 v238, v238, v52
    v_mul_f32 v239, v239, v52
    v_mul_f32 v240, v240, v52
    v_mfma_f32_16x16x32_bf16 a[108:111], v[80:83], v[24:27], a[108:111]
    ds_read_b128 v[40:43], v60 offset:5120
    v_mul_f32 v241, v241, v52
    v_mfma_f32_16x16x32_bf16 a[108:111], v[88:91], v[28:31], a[108:111]
    v_exp_f32 v19, v111
    v_cvt_pk_bf16_f32 v236, v236, v237
    v_cvt_pk_bf16_f32 v237, v238, v239
    v_cvt_pk_bf16_f32 v238, v240, v241
    v_mfma_f32_16x16x32_bf16 a[156:159], v[84:87], v[24:27], a[156:159]
    ds_read_b128 v[44:47], v60 offset:17408
    v_cvt_pk_bf16_f32 v174, v16, v17
    v_mfma_f32_16x16x32_bf16 a[156:159], v[92:95], v[28:31], a[156:159]
    s_waitcnt lgkmcnt(2)
    buffer_store_dwordx3 v[236:238], v56, s[12:15], s40 offen offset:192 sc0 sc1
    v_accvgpr_read_b32 v242, a73
    v_mfma_f32_16x16x32_bf16 a[112:115], v[80:83], v[32:35], a[112:115]
    ds_read_b128 v[24:27], v1 offset:0
    v_cvt_pk_bf16_f32 v175, v18, v19
    v_mfma_f32_16x16x32_bf16 a[112:115], v[88:91], v[36:39], a[112:115]
    s_nop 1
    v_accvgpr_read_b32 v243, a77
    v_accvgpr_read_b32 v244, a81
    v_accvgpr_read_b32 v245, a85
    v_accvgpr_read_b32 v246, a89
    v_mfma_f32_16x16x32_bf16 a[160:163], v[84:87], v[32:35], a[160:163]
    ds_read_b128 v[28:31], v1 offset:12288
    v_accvgpr_read_b32 v247, a93
    v_mfma_f32_16x16x32_bf16 a[160:163], v[92:95], v[36:39], a[160:163]
    s_waitcnt lgkmcnt(2)
    v_mul_f32 v242, v242, v53
    v_mfma_f32_16x16x32_bf16 v[132:135], v[172:175], v[20:23], v[132:135]
    v_exp_f32 v16, v176
    v_mul_f32 v243, v243, v53
    v_mfma_f32_16x16x32_bf16 a[116:119], v[80:83], v[40:43], a[116:119]
    ds_read_b128 v[32:35], v1 offset:1024
    v_mul_f32 v244, v244, v53
    v_mfma_f32_16x16x32_bf16 a[116:119], v[88:91], v[44:47], a[116:119]
    v_exp_f32 v17, v177
    v_exp_f32 v18, v178
    v_mul_f32 v245, v245, v53
    v_mfma_f32_16x16x32_bf16 a[164:167], v[84:87], v[40:43], a[164:167]
    ds_read_b128 v[36:39], v1 offset:13312
    v_mul_f32 v246, v246, v53
    v_mfma_f32_16x16x32_bf16 a[164:167], v[92:95], v[44:47], a[164:167]
    s_waitcnt lgkmcnt(2)
    v_exp_f32 v19, v179
    v_cvt_pk_bf16_f32 v176, v16, v17
    v_exp_f32 v16, v112
    v_mfma_f32_16x16x32_bf16 a[96:99], v[160:163], v[24:27], a[96:99]
    ds_read_b128 v[40:43], v1 offset:2048
    v_mul_f32 v247, v247, v53
    v_mfma_f32_16x16x32_bf16 a[96:99], v[168:171], v[28:31], a[96:99]
    v_exp_f32 v17, v113
    v_cvt_pk_bf16_f32 v177, v18, v19
    v_exp_f32 v18, v114
    v_cvt_pk_bf16_f32 v242, v242, v243
    v_mfma_f32_16x16x32_bf16 a[144:147], v[164:167], v[24:27], a[144:147]
    ds_read_b128 v[44:47], v1 offset:14336
    v_cvt_pk_bf16_f32 v243, v244, v245
    v_mfma_f32_16x16x32_bf16 a[144:147], v[172:175], v[28:31], a[144:147]
    s_waitcnt lgkmcnt(2)
    v_exp_f32 v19, v115
    v_cvt_pk_bf16_f32 v178, v16, v17
    v_exp_f32 v16, v180
    v_mfma_f32_16x16x32_bf16 a[100:103], v[160:163], v[32:35], a[100:103]
    ds_read_b128 v[24:27], v1 offset:3072
    v_cvt_pk_bf16_f32 v244, v246, v247
    v_mfma_f32_16x16x32_bf16 a[100:103], v[168:171], v[36:39], a[100:103]
    buffer_store_dwordx3 v[242:244], v56, s[12:15], s40 offen offset:576 sc0 sc1
    v_accvgpr_read_b32 v248, a74
    v_mfma_f32_16x16x32_bf16 a[148:151], v[164:167], v[32:35], a[148:151]
    ds_read_b128 v[28:31], v1 offset:15360
    v_accvgpr_read_b32 v249, a78
    v_mfma_f32_16x16x32_bf16 a[148:151], v[172:175], v[36:39], a[148:151]
    s_waitcnt lgkmcnt(2)
    v_exp_f32 v17, v181
    v_cvt_pk_bf16_f32 v179, v18, v19
    v_exp_f32 v18, v182
    v_accvgpr_read_b32 v250, a82
    v_mfma_f32_16x16x32_bf16 a[104:107], v[160:163], v[40:43], a[104:107]
    ds_read_b128 v[32:35], v1 offset:4096
    v_accvgpr_read_b32 v251, a86
    v_mfma_f32_16x16x32_bf16 a[104:107], v[168:171], v[44:47], a[104:107]
    v_exp_f32 v19, v183
    v_mfma_f32_16x16x32_bf16 v[128:131], v[176:179], v[20:23], v[128:131]
    v_cvt_pk_bf16_f32 v180, v16, v17
    v_mfma_f32_16x16x32_bf16 a[152:155], v[164:167], v[40:43], a[152:155]
    ds_read_b128 v[36:39], v1 offset:16384
    v_accvgpr_read_b32 v252, a90
    v_mfma_f32_16x16x32_bf16 a[152:155], v[172:175], v[44:47], a[152:155]
    s_waitcnt lgkmcnt(2)
    v_exp_f32 v16, v116
    v_exp_f32 v17, v117
    v_cvt_pk_bf16_f32 v181, v18, v19
    v_mfma_f32_16x16x32_bf16 a[108:111], v[160:163], v[24:27], a[108:111]
L_pg13:
    s_cbranch_execz L_iwret
    ds_read_b128 v[40:43], v1 offset:5120
    v_accvgpr_read_b32 v253, a94
    v_mfma_f32_16x16x32_bf16 a[108:111], v[168:171], v[28:31], a[108:111]
    v_exp_f32 v18, v118
    v_exp_f32 v19, v119
    v_cvt_pk_bf16_f32 v182, v16, v17
    v_cvt_pk_bf16_f32 v183, v18, v19
    v_mfma_f32_16x16x32_bf16 a[156:159], v[164:167], v[24:27], a[156:159]
    s_nop 1
    ds_read_b128 v[44:47], v1 offset:17408
    v_mfma_f32_16x16x32_bf16 a[156:159], v[172:175], v[28:31], a[156:159]
    s_waitcnt lgkmcnt(2)
    v_mfma_f32_16x16x32_bf16 v[132:135], v[180:183], v[20:23], v[132:135]
    v_exp_f32 v16, v184
    v_mul_f32 v248, v248, v54
    v_mfma_f32_16x16x32_bf16 a[112:115], v[160:163], v[32:35], a[112:115]
    ds_read_b128 v[24:27], v59 offset:0
    v_mul_f32 v249, v249, v54
    v_mfma_f32_16x16x32_bf16 a[112:115], v[168:171], v[36:39], a[112:115]
    v_exp_f32 v17, v185
    v_exp_f32 v18, v186
    v_mul_f32 v250, v250, v54
    v_mfma_f32_16x16x32_bf16 a[160:163], v[164:167], v[32:35], a[160:163]
    ds_read_b128 v[28:31], v59 offset:12288
    v_mul_f32 v251, v251, v54
    v_mfma_f32_16x16x32_bf16 a[160:163], v[172:175], v[36:39], a[160:163]
    s_waitcnt lgkmcnt(2)
    v_exp_f32 v19, v187
    v_cvt_pk_bf16_f32 v184, v16, v17
    v_exp_f32 v16, v120
    v_exp_f32 v17, v121
    v_cvt_pk_bf16_f32 v185, v18, v19
    v_exp_f32 v18, v122
    v_exp_f32 v19, v123
    v_cvt_pk_bf16_f32 v186, v16, v17
    v_exp_f32 v16, v188
    v_exp_f32 v17, v189
    v_cvt_pk_bf16_f32 v187, v18, v19
    v_exp_f32 v18, v190
    v_exp_f32 v19, v191
    v_mfma_f32_16x16x32_bf16 v[128:131], v[184:187], v[20:23], v[128:131]
    v_cvt_pk_bf16_f32 v188, v16, v17
    v_exp_f32 v16, v124
    v_exp_f32 v17, v125
    v_cvt_pk_bf16_f32 v189, v18, v19
    v_exp_f32 v18, v126
    v_exp_f32 v19, v127
    v_cvt_pk_bf16_f32 v190, v16, v17
    v_cvt_pk_bf16_f32 v191, v18, v19
    s_nop 1
    v_mfma_f32_16x16x32_bf16 v[132:135], v[188:191], v[20:23], v[132:135]
    v_mfma_f32_16x16x32_bf16 a[116:119], v[160:163], v[40:43], a[116:119]
    ds_read_b128 v[32:35], v59 offset:1024
    v_mul_f32 v252, v252, v54
    v_mfma_f32_16x16x32_bf16 a[116:119], v[168:171], v[44:47], a[116:119]
    v_mul_f32 v253, v253, v54
    v_cvt_pk_bf16_f32 v248, v248, v249
    v_cvt_pk_bf16_f32 v249, v250, v251
    v_cvt_pk_bf16_f32 v250, v252, v253
    v_accvgpr_read_b32 v224, a75
    v_mfma_f32_16x16x32_bf16 a[164:167], v[164:167], v[40:43], a[164:167]
    ds_read_b128 v[36:39], v59 offset:13312
    v_accvgpr_read_b32 v225, a79
    v_mfma_f32_16x16x32_bf16 a[164:167], v[172:175], v[44:47], a[164:167]
    s_waitcnt lgkmcnt(2)
    buffer_store_dwordx3 v[248:250], v56, s[12:15], s40 offen offset:960 sc0 sc1
    v_accvgpr_read_b32 v226, a83
    v_accvgpr_read_b32 v227, a87
    v_mfma_f32_16x16x4_f32 v[128:131], v7, v57, v[128:131]
    v_mfma_f32_16x16x32_bf16 a[96:99], v[176:179], v[24:27], a[96:99]
    ds_read_b128 v[40:43], v59 offset:2048
    v_accvgpr_read_b32 v228, a91
    v_mfma_f32_16x16x32_bf16 a[96:99], v[184:187], v[28:31], a[96:99]
    v_accvgpr_read_b32 v229, a95
    v_mul_f32 v224, v224, v55
    v_mul_f32 v225, v225, v55
    v_mul_f32 v226, v226, v55
    v_mul_f32 v227, v227, v55
    v_mul_f32 v228, v228, v55
    v_mfma_f32_16x16x4_f32 v[132:135], v8, v57, v[132:135]
    v_mfma_f32_16x16x32_bf16 a[144:147], v[180:183], v[24:27], a[144:147]
    ds_read_b128 v[44:47], v59 offset:14336
    v_mul_f32 v229, v229, v55
    v_mfma_f32_16x16x32_bf16 a[144:147], v[188:191], v[28:31], a[144:147]
    s_waitcnt lgkmcnt(2)
    v_cvt_pk_bf16_f32 v224, v224, v225
    v_cvt_pk_bf16_f32 v225, v226, v227
    v_cvt_pk_bf16_f32 v226, v228, v229
    v_mfma_f32_16x16x32_bf16 a[100:103], v[176:179], v[32:35], a[100:103]
    ds_read_b128 v[24:27], v59 offset:3072
    v_mfma_f32_16x16x32_bf16 a[100:103], v[184:187], v[36:39], a[100:103]
    buffer_store_dwordx3 v[224:226], v56, s[12:15], s40 offen offset:1344 sc0 sc1
    v_mfma_f32_16x16x32_bf16 a[148:151], v[180:183], v[32:35], a[148:151]
    ds_read_b128 v[28:31], v59 offset:15360
    v_max3_f32 v18, v5, v6, v128
    v_mfma_f32_16x16x32_bf16 a[148:151], v[188:191], v[36:39], a[148:151]
    s_waitcnt lgkmcnt(2)
    v_max3_f32 v18, v18, v129, v130
    v_max3_f32 v18, v18, v131, v132
    v_max3_f32 v18, v18, v133, v134
    v_max_f32 v18, v18, v135
    s_mov_b32 s29, 0x5f800000
    v_cmp_lt_f32 s[48:49], s29, v18
    v_rcp_f32 v128, v128
    v_mfma_f32_16x16x32_bf16 a[104:107], v[176:179], v[40:43], a[104:107]
    ds_read_b128 v[32:35], v59 offset:4096
    v_mfma_f32_16x16x32_bf16 a[104:107], v[184:187], v[44:47], a[104:107]
    v_rcp_f32 v129, v129
    v_rcp_f32 v130, v130
    v_rcp_f32 v131, v131
    v_mfma_f32_16x16x32_bf16 a[152:155], v[180:183], v[40:43], a[152:155]
    ds_read_b128 v[36:39], v59 offset:16384
    v_mfma_f32_16x16x32_bf16 a[152:155], v[188:191], v[44:47], a[152:155]
    s_waitcnt lgkmcnt(2)
    v_rcp_f32 v132, v132
    v_rcp_f32 v133, v133
    v_mfma_f32_16x16x32_bf16 a[108:111], v[176:179], v[24:27], a[108:111]
    ds_read_b128 v[40:43], v59 offset:5120
    v_mfma_f32_16x16x32_bf16 a[108:111], v[184:187], v[28:31], a[108:111]
    v_rcp_f32 v134, v134
    v_rcp_f32 v135, v135
    v_mfma_f32_16x16x32_bf16 a[156:159], v[180:183], v[24:27], a[156:159]
    ds_read_b128 v[44:47], v59 offset:17408
    v_mfma_f32_16x16x32_bf16 a[156:159], v[188:191], v[28:31], a[156:159]
    s_waitcnt lgkmcnt(2)
    v_mfma_f32_16x16x32_bf16 a[112:115], v[176:179], v[32:35], a[112:115]
    ds_read_b128 v[24:27], v60 offset:6144
    v_mfma_f32_16x16x32_bf16 a[112:115], v[184:187], v[36:39], a[112:115]
    v_mfma_f32_16x16x32_bf16 a[160:163], v[180:183], v[32:35], a[160:163]
    ds_read_b128 v[28:31], v60 offset:18432
    v_mfma_f32_16x16x32_bf16 a[160:163], v[188:191], v[36:39], a[160:163]
    s_waitcnt lgkmcnt(2)
    s_cmp_lg_u64 s[48:49], 0
    s_cbranch_scc1 L_slow
    v_mfma_f32_16x16x32_bf16 a[116:119], v[176:179], v[40:43], a[116:119]
    ds_read_b128 v[32:35], v60 offset:7168
    v_mfma_f32_16x16x32_bf16 a[116:119], v[184:187], v[44:47], a[116:119]
    v_mfma_f32_16x16x32_bf16 a[164:167], v[180:183], v[40:43], a[164:167]
    ds_read_b128 v[36:39], v60 offset:19456
    v_mfma_f32_16x16x32_bf16 a[164:167], v[188:191], v[44:47], a[164:167]
    s_waitcnt lgkmcnt(2)
    v_mfma_f32_16x16x32_bf16 a[120:123], v[80:83], v[24:27], a[120:123]
    ds_read_b128 v[40:43], v60 offset:8192
    v_mfma_f32_16x16x32_bf16 a[120:123], v[88:91], v[28:31], a[120:123]
    v_mfma_f32_16x16x32_bf16 a[168:171], v[84:87], v[24:27], a[168:171]
    ds_read_b128 v[44:47], v60 offset:20480
    v_mfma_f32_16x16x32_bf16 a[168:171], v[92:95], v[28:31], a[168:171]
    s_waitcnt lgkmcnt(2)
    v_mfma_f32_16x16x32_bf16 a[124:127], v[80:83], v[32:35], a[124:127]
    ds_read_b128 v[24:27], v1 offset:6144
    v_accvgpr_read_b32 v230, a96
    v_mfma_f32_16x16x32_bf16 a[124:127], v[88:91], v[36:39], a[124:127]
    v_accvgpr_read_b32 v231, a100
    v_accvgpr_read_b32 v232, a104
    v_accvgpr_read_b32 v233, a108
    v_accvgpr_read_b32 v234, a112
    v_accvgpr_read_b32 v235, a116
    v_mul_f32 v230, v230, v128
    v_mul_f32 v231, v231, v128
    v_mul_f32 v232, v232, v128
    v_mul_f32 v233, v233, v128
    v_mul_f32 v234, v234, v128
    v_mul_f32 v235, v235, v128
    v_cvt_pk_bf16_f32 v230, v230, v231
    v_cvt_pk_bf16_f32 v231, v232, v233
    v_cvt_pk_bf16_f32 v232, v234, v235
    v_accvgpr_read_b32 v236, a97
    v_accvgpr_read_b32 v237, a101
    v_accvgpr_read_b32 v238, a105
    v_accvgpr_read_b32 v239, a109
    v_accvgpr_read_b32 v240, a113
    v_accvgpr_read_b32 v241, a117
    v_mul_f32 v236, v236, v129
    v_mul_f32 v237, v237, v129
    v_mul_f32 v238, v238, v129
    v_mul_f32 v239, v239, v129
    v_mul_f32 v240, v240, v129
    v_mul_f32 v241, v241, v129
    v_cvt_pk_bf16_f32 v236, v236, v237
    v_cvt_pk_bf16_f32 v237, v238, v239
    v_cvt_pk_bf16_f32 v238, v240, v241
    v_accvgpr_read_b32 v242, a98
    v_mfma_f32_16x16x32_bf16 a[172:175], v[84:87], v[32:35], a[172:175]
    ds_read_b128 v[28:31], v1 offset:18432
    v_accvgpr_read_b32 v243, a102
    v_mfma_f32_16x16x32_bf16 a[172:175], v[92:95], v[36:39], a[172:175]
    s_waitcnt lgkmcnt(2)
    buffer_store_dwordx3 v[230:232], v56, s[12:15], s41 offen offset:0 sc0 sc1
    v_accvgpr_read_b32 v244, a106
    v_mfma_f32_16x16x32_bf16 a[128:131], v[80:83], v[40:43], a[128:131]
    ds_read_b128 v[32:35], v1 offset:7168
    v_accvgpr_read_b32 v245, a110
    v_mfma_f32_16x16x32_bf16 a[128:131], v[88:91], v[44:47], a[128:131]
    buffer_store_dwordx3 v[236:238], v56, s[12:15], s41 offen offset:384 sc0 sc1
    v_accvgpr_read_b32 v246, a114
    v_mfma_f32_16x16x32_bf16 a[176:179], v[84:87], v[40:43], a[176:179]
    ds_read_b128 v[36:39], v1 offset:19456
    v_accvgpr_read_b32 v247, a118
    v_mfma_f32_16x16x32_bf16 a[176:179], v[92:95], v[44:47], a[176:179]
    s_waitcnt lgkmcnt(2)
    v_mul_f32 v242, v242, v130
    v_mul_f32 v243, v243, v130
    v_mul_f32 v244, v244, v130
    v_mul_f32 v245, v245, v130
    v_mul_f32 v246, v246, v130
    v_mul_f32 v247, v247, v130
    v_mfma_f32_16x16x32_bf16 a[120:123], v[160:163], v[24:27], a[120:123]
    ds_read_b128 v[40:43], v1 offset:8192
    v_cvt_pk_bf16_f32 v242, v242, v243
    v_mfma_f32_16x16x32_bf16 a[120:123], v[168:171], v[28:31], a[120:123]
    v_cvt_pk_bf16_f32 v243, v244, v245
    v_cvt_pk_bf16_f32 v244, v246, v247
    v_accvgpr_read_b32 v248, a99
    v_accvgpr_read_b32 v249, a103
    v_accvgpr_read_b32 v250, a107
    v_mfma_f32_16x16x32_bf16 a[168:171], v[164:167], v[24:27], a[168:171]
    ds_read_b128 v[44:47], v1 offset:20480
    v_accvgpr_read_b32 v251, a111
    v_mfma_f32_16x16x32_bf16 a[168:171], v[172:175], v[28:31], a[168:171]
    s_waitcnt lgkmcnt(2)
    buffer_store_dwordx3 v[242:244], v56, s[12:15], s41 offen offset:768 sc0 sc1
    v_accvgpr_read_b32 v252, a115
    v_mfma_f32_16x16x32_bf16 a[124:127], v[160:163], v[32:35], a[124:127]
    ds_read_b128 v[24:27], v59 offset:6144
    v_accvgpr_read_b32 v253, a119
    v_mfma_f32_16x16x32_bf16 a[124:127], v[168:171], v[36:39], a[124:127]
    v_mul_f32 v248, v248, v131
    v_mul_f32 v249, v249, v131
    v_mul_f32 v250, v250, v131
    v_mul_f32 v251, v251, v131
    v_mul_f32 v252, v252, v131
    v_mul_f32 v253, v253, v131
    v_mfma_f32_16x16x32_bf16 a[172:175], v[164:167], v[32:35], a[172:175]
    ds_read_b128 v[28:31], v59 offset:18432
    v_cvt_pk_bf16_f32 v248, v248, v249
    v_mfma_f32_16x16x32_bf16 a[172:175], v[172:175], v[36:39], a[172:175]
    s_waitcnt lgkmcnt(2)
    v_cvt_pk_bf16_f32 v249, v250, v251
    v_cvt_pk_bf16_f32 v250, v252, v253
    v_accvgpr_read_b32 v224, a144
    v_accvgpr_read_b32 v225, a148
    v_accvgpr_read_b32 v226, a152
    v_mfma_f32_16x16x32_bf16 a[128:131], v[160:163], v[40:43], a[128:131]
    ds_read_b128 v[32:35], v59 offset:7168
    v_accvgpr_read_b32 v227, a156
    v_mfma_f32_16x16x32_bf16 a[128:131], v[168:171], v[44:47], a[128:131]
    buffer_store_dwordx3 v[248:250], v56, s[12:15], s41 offen offset:1152 sc0 sc1
    v_accvgpr_read_b32 v228, a160
    v_mfma_f32_16x16x32_bf16 a[176:179], v[164:167], v[40:43], a[176:179]
    ds_read_b128 v[36:39], v59 offset:19456
    v_accvgpr_read_b32 v229, a164
    v_mfma_f32_16x16x32_bf16 a[176:179], v[172:175], v[44:47], a[176:179]
    s_waitcnt lgkmcnt(2)
    v_mul_f32 v224, v224, v132
    v_mul_f32 v225, v225, v132
    v_mul_f32 v226, v226, v132
    v_mul_f32 v227, v227, v132
    v_mul_f32 v228, v228, v132
    v_mul_f32 v229, v229, v132
    v_mfma_f32_16x16x32_bf16 a[120:123], v[176:179], v[24:27], a[120:123]
    ds_read_b128 v[40:43], v59 offset:8192
    v_cvt_pk_bf16_f32 v224, v224, v225
    v_mfma_f32_16x16x32_bf16 a[120:123], v[184:187], v[28:31], a[120:123]
    v_cvt_pk_bf16_f32 v225, v226, v227
    v_cvt_pk_bf16_f32 v226, v228, v229
    v_accvgpr_read_b32 v230, a145
    v_accvgpr_read_b32 v231, a149
    v_accvgpr_read_b32 v232, a153
    v_mfma_f32_16x16x32_bf16 a[168:171], v[180:183], v[24:27], a[168:171]
    ds_read_b128 v[44:47], v59 offset:20480
    v_accvgpr_read_b32 v233, a157
    v_mfma_f32_16x16x32_bf16 a[168:171], v[188:191], v[28:31], a[168:171]
    s_waitcnt lgkmcnt(2)
    buffer_store_dwordx3 v[224:226], v56, s[12:15], s42 offen offset:0 sc0 sc1
    v_accvgpr_read_b32 v234, a161
    v_mfma_f32_16x16x32_bf16 a[124:127], v[176:179], v[32:35], a[124:127]
    ds_read_b128 v[24:27], v60 offset:9216
    v_accvgpr_read_b32 v235, a165
    v_mfma_f32_16x16x32_bf16 a[124:127], v[184:187], v[36:39], a[124:127]
    v_mul_f32 v230, v230, v133
    v_mul_f32 v231, v231, v133
    v_mul_f32 v232, v232, v133
    v_mul_f32 v233, v233, v133
    v_mul_f32 v234, v234, v133
    v_mul_f32 v235, v235, v133
    v_mfma_f32_16x16x32_bf16 a[172:175], v[180:183], v[32:35], a[172:175]
    ds_read_b128 v[28:31], v60 offset:21504
    v_cvt_pk_bf16_f32 v230, v230, v231
    v_mfma_f32_16x16x32_bf16 a[172:175], v[188:191], v[36:39], a[172:175]
    s_waitcnt lgkmcnt(2)
    v_cvt_pk_bf16_f32 v231, v232, v233
    v_cvt_pk_bf16_f32 v232, v234, v235
    v_accvgpr_read_b32 v236, a146
    v_accvgpr_read_b32 v237, a150
    v_accvgpr_read_b32 v238, a154
    v_mfma_f32_16x16x32_bf16 a[128:131], v[176:179], v[40:43], a[128:131]
    ds_read_b128 v[32:35], v60 offset:10240
    v_accvgpr_read_b32 v239, a158
    v_mfma_f32_16x16x32_bf16 a[128:131], v[184:187], v[44:47], a[128:131]
    buffer_store_dwordx3 v[230:232], v56, s[12:15], s42 offen offset:384 sc0 sc1
    v_accvgpr_read_b32 v240, a162
    v_mfma_f32_16x16x32_bf16 a[176:179], v[180:183], v[40:43], a[176:179]
    ds_read_b128 v[36:39], v60 offset:22528
    v_accvgpr_read_b32 v241, a166
    v_mfma_f32_16x16x32_bf16 a[176:179], v[188:191], v[44:47], a[176:179]
    s_waitcnt lgkmcnt(2)
    v_mul_f32 v236, v236, v134
    v_mul_f32 v237, v237, v134
    v_mul_f32 v238, v238, v134
    v_mul_f32 v239, v239, v134
    v_mul_f32 v240, v240, v134
    v_mfma_f32_16x16x32_bf16 a[132:135], v[80:83], v[24:27], a[132:135]
    ds_read_b128 v[40:43], v60 offset:11264
    v_mul_f32 v241, v241, v134
    v_mfma_f32_16x16x32_bf16 a[132:135], v[88:91], v[28:31], a[132:135]
    v_cvt_pk_bf16_f32 v236, v236, v237
    v_cvt_pk_bf16_f32 v237, v238, v239
    v_cvt_pk_bf16_f32 v238, v240, v241
    v_accvgpr_read_b32 v242, a147
    v_accvgpr_read_b32 v243, a151
    v_accvgpr_read_b32 v244, a155
    v_mfma_f32_16x16x32_bf16 a[180:183], v[84:87], v[24:27], a[180:183]
    ds_read_b128 v[44:47], v60 offset:23552
    v_accvgpr_read_b32 v245, a159
    v_mfma_f32_16x16x32_bf16 a[180:183], v[92:95], v[28:31], a[180:183]
    s_waitcnt lgkmcnt(2)
    buffer_store_dwordx3 v[236:238], v56, s[12:15], s42 offen offset:768 sc0 sc1
    v_accvgpr_read_b32 v246, a163
    v_mfma_f32_16x16x32_bf16 a[136:139], v[80:83], v[32:35], a[136:139]
    ds_read_b128 v[24:27], v1 offset:9216
    v_accvgpr_read_b32 v96, a120
    v_mfma_f32_16x16x32_bf16 a[136:139], v[88:91], v[36:39], a[136:139]
    v_accvgpr_read_b32 v97, a124
    v_accvgpr_read_b32 v98, a128
    v_mul_f32 v96, v96, v128
    v_mul_f32 v97, v97, v128
    v_mul_f32 v98, v98, v128
    v_mfma_f32_16x16x32_bf16 a[184:187], v[84:87], v[32:35], a[184:187]
    ds_read_b128 v[28:31], v1 offset:21504
    v_accvgpr_read_b32 v102, a121
    v_mfma_f32_16x16x32_bf16 a[184:187], v[92:95], v[36:39], a[184:187]
    s_waitcnt lgkmcnt(2)
    v_accvgpr_read_b32 v103, a125
    v_accvgpr_read_b32 v104, a129
    v_mul_f32 v102, v102, v129
    v_mul_f32 v103, v103, v129
    v_mul_f32 v104, v104, v129
    v_accvgpr_read_b32 v108, a122
    v_mfma_f32_16x16x32_bf16 a[140:143], v[80:83], v[40:43], a[140:143]
    ds_read_b128 v[32:35], v1 offset:10240
    v_accvgpr_read_b32 v109, a126
    v_mfma_f32_16x16x32_bf16 a[140:143], v[88:91], v[44:47], a[140:143]
    v_accvgpr_read_b32 v110, a130
    v_mul_f32 v108, v108, v130
    v_mul_f32 v109, v109, v130
    v_mul_f32 v110, v110, v130
    v_accvgpr_read_b32 v114, a123
    v_mfma_f32_16x16x32_bf16 a[188:191], v[84:87], v[40:43], a[188:191]
    ds_read_b128 v[36:39], v1 offset:22528
    v_accvgpr_read_b32 v115, a127
    v_mfma_f32_16x16x32_bf16 a[188:191], v[92:95], v[44:47], a[188:191]
    s_waitcnt lgkmcnt(2)
    v_accvgpr_read_b32 v116, a131
    v_mul_f32 v114, v114, v131
    v_mul_f32 v115, v115, v131
    v_mul_f32 v116, v116, v131
    v_accvgpr_read_b32 v120, a168
    v_mfma_f32_16x16x32_bf16 a[132:135], v[160:163], v[24:27], a[132:135]
    ds_read_b128 v[40:43], v1 offset:11264
    v_accvgpr_read_b32 v121, a172
    v_mfma_f32_16x16x32_bf16 a[132:135], v[168:171], v[28:31], a[132:135]
    v_accvgpr_read_b32 v122, a176
    v_mul_f32 v120, v120, v132
    v_mul_f32 v121, v121, v132
    v_mul_f32 v122, v122, v132
    v_accvgpr_read_b32 v64, a169
    v_accvgpr_read_b32 v65, a173
    v_mfma_f32_16x16x32_bf16 a[180:183], v[164:167], v[24:27], a[180:183]
    ds_read_b128 v[44:47], v1 offset:23552
    v_accvgpr_read_b32 v66, a177
    v_mfma_f32_16x16x32_bf16 a[180:183], v[172:175], v[28:31], a[180:183]
    s_waitcnt lgkmcnt(2)
    v_mul_f32 v64, v64, v133
    v_mul_f32 v65, v65, v133
    v_mul_f32 v66, v66, v133
    v_accvgpr_read_b32 v70, a170
    v_accvgpr_read_b32 v71, a174
    v_mfma_f32_16x16x32_bf16 a[136:139], v[160:163], v[32:35], a[136:139]
    ds_read_b128 v[24:27], v59 offset:9216
    v_accvgpr_read_b32 v247, a167
    v_mfma_f32_16x16x32_bf16 a[136:139], v[168:171], v[36:39], a[136:139]
    v_accvgpr_read_b32 v72, a178
    v_mul_f32 v242, v242, v135
    v_mul_f32 v70, v70, v134
    v_mul_f32 v243, v243, v135
    v_mul_f32 v71, v71, v134
    v_mfma_f32_16x16x32_bf16 a[184:187], v[164:167], v[32:35], a[184:187]
    ds_read_b128 v[28:31], v59 offset:21504
    v_mul_f32 v244, v244, v135
    v_mfma_f32_16x16x32_bf16 a[184:187], v[172:175], v[36:39], a[184:187]
    s_waitcnt lgkmcnt(2)
    v_mul_f32 v72, v72, v134
    v_mul_f32 v245, v245, v135
    v_accvgpr_read_b32 v144, a171
    v_mul_f32 v246, v246, v135
    v_accvgpr_read_b32 v145, a175
    v_mul_f32 v247, v247, v135
    v_mfma_f32_16x16x32_bf16 a[140:143], v[160:163], v[40:43], a[140:143]
    ds_read_b128 v[32:35], v59 offset:10240
    v_accvgpr_read_b32 v146, a179
    v_mfma_f32_16x16x32_bf16 a[140:143], v[168:171], v[44:47], a[140:143]
    v_cvt_pk_bf16_f32 v242, v242, v243
    v_mul_f32 v144, v144, v135
    v_cvt_pk_bf16_f32 v243, v244, v245
    v_mul_f32 v145, v145, v135
    v_cvt_pk_bf16_f32 v244, v246, v247
    v_mfma_f32_16x16x32_bf16 a[188:191], v[164:167], v[40:43], a[188:191]
    ds_read_b128 v[36:39], v59 offset:22528
    v_mul_f32 v146, v146, v135
    v_mfma_f32_16x16x32_bf16 a[188:191], v[172:175], v[44:47], a[188:191]
    s_waitcnt lgkmcnt(2)
    buffer_store_dwordx3 v[242:244], v56, s[12:15], s42 offen offset:1152 sc0 sc1
    v_mfma_f32_16x16x32_bf16 a[132:135], v[176:179], v[24:27], a[132:135]
    ds_read_b128 v[40:43], v59 offset:11264
    v_mfma_f32_16x16x32_bf16 a[132:135], v[184:187], v[28:31], a[132:135]
    v_mfma_f32_16x16x32_bf16 a[180:183], v[180:183], v[24:27], a[180:183]
    ds_read_b128 v[44:47], v59 offset:23552
    v_mfma_f32_16x16x32_bf16 a[180:183], v[188:191], v[28:31], a[180:183]
    s_waitcnt lgkmcnt(2)
    v_mfma_f32_16x16x32_bf16 a[136:139], v[176:179], v[32:35], a[136:139]
    v_mfma_f32_16x16x32_bf16 a[136:139], v[184:187], v[36:39], a[136:139]
    v_mfma_f32_16x16x32_bf16 a[184:187], v[180:183], v[32:35], a[184:187]
    v_mfma_f32_16x16x32_bf16 a[184:187], v[188:191], v[36:39], a[184:187]
    s_waitcnt lgkmcnt(0)
    v_mfma_f32_16x16x32_bf16 a[140:143], v[176:179], v[40:43], a[140:143]
    v_mfma_f32_16x16x32_bf16 a[140:143], v[184:187], v[44:47], a[140:143]
    v_mfma_f32_16x16x32_bf16 a[188:191], v[180:183], v[40:43], a[188:191]
    v_mfma_f32_16x16x32_bf16 a[188:191], v[188:191], v[44:47], a[188:191]
    s_nop 7
    v_accvgpr_read_b32 v99, a132
    v_accvgpr_read_b32 v100, a136
    v_accvgpr_read_b32 v101, a140
    v_cvt_pk_bf16_f32 v96, v96, v97
    v_mul_f32 v99, v99, v128
    v_mul_f32 v100, v100, v128
    v_mul_f32 v101, v101, v128
    v_cvt_pk_bf16_f32 v97, v98, v99
    v_cvt_pk_bf16_f32 v98, v100, v101
    buffer_store_dwordx3 v[96:98], v56, s[12:15], s41 offen offset:192 sc0 sc1
    v_accvgpr_read_b32 v105, a133
    v_accvgpr_read_b32 v106, a137
    v_accvgpr_read_b32 v107, a141
    v_cvt_pk_bf16_f32 v102, v102, v103
    v_mul_f32 v105, v105, v129
    v_mul_f32 v106, v106, v129
    v_mul_f32 v107, v107, v129
    v_cvt_pk_bf16_f32 v103, v104, v105
    v_cvt_pk_bf16_f32 v104, v106, v107
    buffer_store_dwordx3 v[102:104], v56, s[12:15], s41 offen offset:576 sc0 sc1
    v_accvgpr_read_b32 v111, a134
    v_accvgpr_read_b32 v112, a138
    v_accvgpr_read_b32 v113, a142
    v_cvt_pk_bf16_f32 v108, v108, v109
    v_mul_f32 v111, v111, v130
    v_mul_f32 v112, v112, v130
    v_mul_f32 v113, v113, v130
    v_cvt_pk_bf16_f32 v109, v110, v111
    v_cvt_pk_bf16_f32 v110, v112, v113
    buffer_store_dwordx3 v[108:110], v56, s[12:15], s41 offen offset:960 sc0 sc1
    v_accvgpr_read_b32 v117, a135
    v_accvgpr_read_b32 v118, a139
    v_accvgpr_read_b32 v119, a143
    v_cvt_pk_bf16_f32 v114, v114, v115
    v_mul_f32 v117, v117, v131
    v_mul_f32 v118, v118, v131
    v_mul_f32 v119, v119, v131
    v_cvt_pk_bf16_f32 v115, v116, v117
    v_cvt_pk_bf16_f32 v116, v118, v119
    buffer_store_dwordx3 v[114:116], v56, s[12:15], s41 offen offset:1344 sc0 sc1
    v_accvgpr_read_b32 v123, a180
    v_accvgpr_read_b32 v124, a184
    v_accvgpr_read_b32 v125, a188
    v_cvt_pk_bf16_f32 v120, v120, v121
    v_mul_f32 v123, v123, v132
    v_mul_f32 v124, v124, v132
    v_mul_f32 v125, v125, v132
    v_cvt_pk_bf16_f32 v121, v122, v123
    v_cvt_pk_bf16_f32 v122, v124, v125
    buffer_store_dwordx3 v[120:122], v56, s[12:15], s42 offen offset:192 sc0 sc1
    v_accvgpr_read_b32 v67, a181
    v_accvgpr_read_b32 v68, a185
    v_accvgpr_read_b32 v69, a189
    v_cvt_pk_bf16_f32 v64, v64, v65
    v_mul_f32 v67, v67, v133
    v_mul_f32 v68, v68, v133
    v_mul_f32 v69, v69, v133
    v_cvt_pk_bf16_f32 v65, v66, v67
    v_cvt_pk_bf16_f32 v66, v68, v69
    buffer_store_dwordx3 v[64:66], v56, s[12:15], s42 offen offset:576 sc0 sc1
    v_accvgpr_read_b32 v73, a182
    v_accvgpr_read_b32 v74, a186
    v_accvgpr_read_b32 v75, a190
    v_cvt_pk_bf16_f32 v70, v70, v71
    v_mul_f32 v73, v73, v134
    v_mul_f32 v74, v74, v134
    v_mul_f32 v75, v75, v134
    v_cvt_pk_bf16_f32 v71, v72, v73
    v_cvt_pk_bf16_f32 v72, v74, v75
    buffer_store_dwordx3 v[70:72], v56, s[12:15], s42 offen offset:960 sc0 sc1
    v_accvgpr_read_b32 v147, a183
    v_accvgpr_read_b32 v148, a187
    v_accvgpr_read_b32 v149, a191
    v_cvt_pk_bf16_f32 v144, v144, v145
    v_mul_f32 v147, v147, v135
    v_mul_f32 v148, v148, v135
    v_mul_f32 v149, v149, v135
    v_cvt_pk_bf16_f32 v145, v146, v147
    v_cvt_pk_bf16_f32 v146, v148, v149
    buffer_store_dwordx3 v[144:146], v56, s[12:15], s42 offen offset:1344 sc0 sc1
L_fin:
L_done:
    s_endpgm
L_pollslow0:
    s_mov_b32 s59, 60
L_pollsm0:
    s_buffer_load_dwordx8 s[48:55], s[20:23], s44 glc
    s_waitcnt lgkmcnt(0)
    s_sub_u32 s48, s48, s92
    s_sub_u32 s49, s49, s92
    s_sub_u32 s50, s50, s92
    s_sub_u32 s51, s51, s92
    s_sub_u32 s52, s52, s92
    s_sub_u32 s53, s53, s92
    s_sub_u32 s54, s54, s92
    s_sub_u32 s55, s55, s92
    s_max_u32 s48, s48, s49
    s_max_u32 s48, s48, s50
    s_max_u32 s48, s48, s51
    s_max_u32 s48, s48, s52
    s_max_u32 s48, s48, s53
    s_max_u32 s48, s48, s54
    s_max_u32 s48, s48, s55
    s_cmp_lt_u32 s48, 16
    s_cbranch_scc1 L_pollok0
    s_sub_u32 s59, s59, 1
    s_cbranch_scc1 L_pollvec0
    s_sleep 1
    s_branch L_pollsm0
L_pollvec0:
    v_bfe_u32 v53, v4, 4, 6
    v_lshlrev_b32 v53, 2, v53
    s_sub_u32 s96, s96, 1
    s_cbranch_scc1 L_pollgiveup0
    s_sleep 2
    buffer_load_dword v52, v53, s[20:23], s44 offen sc1
    s_waitcnt vmcnt(0)
    s_bitcmp1_b32 s92, 9
    s_cbranch_scc1 L_nomix
    v_xor_b32 v53, s92, v52
    v_lshrrev_b32 v53, 5, v53
    v_add_u32 v53, -1, v53
    v_cmp_gt_u32 vcc, 31, v53
    s_nop 1
    s_and_b32 s59, vcc_lo, 0xff
    s_cbranch_scc0 L_nomix
    buffer_store_dwordx4 v[224:227], v11, s[4:7], s33 offen offset:0 sc1
    v_xor_b32 v55, 16, v11
    buffer_store_dwordx4 v[228:231], v55, s[4:7], s33 offen offset:768 sc1
    v_xor_b32 v54, 32, v11
    buffer_store_dwordx4 v[232:235], v54, s[4:7], s33 offen offset:1536 sc1
    v_xor_b32 v55, 48, v11
    buffer_store_dwordx4 v[236:239], v55, s[4:7], s33 offen offset:2304 sc1
    buffer_store_dwordx4 v[112:115], v15, s[4:7], s35 offen offset:0 sc1
    buffer_store_dwordx4 v[116:119], v15, s[4:7], s35 offen offset:1024 sc1
    buffer_store_dwordx4 v[120:123], v15, s[4:7], s35 offen offset:2048 sc1
    s_waitcnt vmcnt(0)
    s_barrier
    s_and_b32 s92, s92, 0xfffffc00
    s_add_u32 s92, s92, 512
    v_mov_b32 v0, s92
    s_add_u32 s92, s92, 1
    s_mov_b32 s44, 32
    v_add_u32 v0, 1, v0
    buffer_store_dword v0, v13, s[20:23], 0 offen offset:32 sc1
    s_branch L_pollvec0
L_nomix:
    v_subrev_u32 v52, s92, v52
    v_cmp_lt_u32 vcc, 15, v52
    s_nop 0
    s_and_b32 s59, vcc_lo, 0xff
    s_cbranch_scc1 L_pollvec0
    s_branch L_pollok0
L_pollgiveup0:
    s_mov_b32 s96, 0
    s_branch L_pollok0
L_pollslow1:
    s_mov_b32 s59, 200
L_pollsm1:
    s_buffer_load_dwordx8 s[48:55], s[20:23], s44 glc
    s_waitcnt lgkmcnt(0)
    s_sub_u32 s48, s48, s92
    s_sub_u32 s49, s49, s92
    s_sub_u32 s50, s50, s92
    s_sub_u32 s51, s51, s92
    s_sub_u32 s52, s52, s92
    s_sub_u32 s53, s53, s92
    s_sub_u32 s54, s54, s92
    s_sub_u32 s55, s55, s92
    s_max_u32 s48, s48, s49
    s_max_u32 s48, s48, s50
    s_max_u32 s48, s48, s51
    s_max_u32 s48, s48, s52
    s_max_u32 s48, s48, s53
    s_max_u32 s48, s48, s54
    s_max_u32 s48, s48, s55
    s_cmp_lt_u32 s48, 16
    s_cbranch_scc1 L_pollok1
    s_sub_u32 s59, s59, 1
    s_cbranch_scc1 L_pollvec1
    s_sleep 1
    s_branch L_pollsm1
L_pollvec1:
    v_bfe_u32 v53, v4, 4, 6
    v_lshlrev_b32 v53, 2, v53
    s_sub_u32 s96, s96, 1
    s_cbranch_scc1 L_pollgiveup1
    s_sleep 2
    buffer_load_dword v52, v53, s[20:23], s44 offen sc1
    s_waitcnt vmcnt(0)
    v_subrev_u32 v52, s92, v52
    v_cmp_lt_u32 vcc, 15, v52
    s_nop 0
    s_and_b32 s59, vcc_lo, 0xff
    s_cbranch_scc1 L_pollvec1
    s_branch L_pollok1
L_pollgiveup1:
    s_mov_b32 s96, 0
    s_branch L_pollok1
L_pollslow2:
    s_mov_b32 s59, 200
L_pollsm2:
    s_buffer_load_dwordx8 s[48:55], s[20:23], s44 glc
    s_waitcnt lgkmcnt(0)
    s_sub_u32 s48, s48, s92
    s_sub_u32 s49, s49, s92
    s_sub_u32 s50, s50, s92
    s_sub_u32 s51, s51, s92
    s_sub_u32 s52, s52, s92
    s_sub_u32 s53, s53, s92
    s_sub_u32 s54, s54, s92
    s_sub_u32 s55, s55, s92
    s_max_u32 s48, s48, s49
    s_max_u32 s48, s48, s50
    s_max_u32 s48, s48, s51
    s_max_u32 s48, s48, s52
    s_max_u32 s48, s48, s53
    s_max_u32 s48, s48, s54
    s_max_u32 s48, s48, s55
    s_cmp_lt_u32 s48, 16
    s_cbranch_scc1 L_pollok2
    s_sub_u32 s59, s59, 1
    s_cbranch_scc1 L_pollvec2
    s_sleep 1
    s_branch L_pollsm2
L_pollvec2:
    v_bfe_u32 v53, v4, 4, 6
    v_lshlrev_b32 v53, 2, v53
    s_sub_u32 s96, s96, 1
    s_cbranch_scc1 L_pollgiveup2
    s_sleep 2
    buffer_load_dword v52, v53, s[20:23], s44 offen sc1
    s_waitcnt vmcnt(0)
    v_subrev_u32 v52, s92, v52
    v_cmp_lt_u32 vcc, 15, v52
    s_nop 0
    s_and_b32 s59, vcc_lo, 0xff
    s_cbranch_scc1 L_pollvec2
    s_branch L_pollok2
L_pollgiveup2:
    s_mov_b32 s96, 0
    s_branch L_pollok2
L_pollslow3:
    s_mov_b32 s59, 200
L_pollsm3:
    s_buffer_load_dwordx8 s[48:55], s[20:23], s44 glc
    s_waitcnt lgkmcnt(0)
    s_sub_u32 s48, s48, s92
    s_sub_u32 s49, s49, s92
    s_sub_u32 s50, s50, s92
    s_sub_u32 s51, s51, s92
    s_sub_u32 s52, s52, s92
    s_sub_u32 s53, s53, s92
    s_sub_u32 s54, s54, s92
    s_sub_u32 s55, s55, s92
    s_max_u32 s48, s48, s49
    s_max_u32 s48, s48, s50
    s_max_u32 s48, s48, s51
    s_max_u32 s48, s48, s52
    s_max_u32 s48, s48, s53
    s_max_u32 s48, s48, s54
    s_max_u32 s48, s48, s55
    s_cmp_lt_u32 s48, 16
    s_cbranch_scc1 L_pollok3
    s_sub_u32 s59, s59, 1
    s_cbranch_scc1 L_pollvec3
    s_sleep 1
    s_branch L_pollsm3
L_pollvec3:
    v_bfe_u32 v53, v4, 4, 6
    v_lshlrev_b32 v53, 2, v53
    s_sub_u32 s96, s96, 1
    s_cbranch_scc1 L_pollgiveup3
    s_sleep 2
    buffer_load_dword v52, v53, s[20:23], s44 offen sc1
    s_waitcnt vmcnt(0)
    v_subrev_u32 v52, s92, v52
    v_cmp_lt_u32 vcc, 15, v52
    s_nop 0
    s_and_b32 s59, vcc_lo, 0xff
    s_cbranch_scc1 L_pollvec3
    s_branch L_pollok3
L_pollgiveup3:
    s_mov_b32 s96, 0
    s_branch L_pollok3
L_pollslow4:
    s_mov_b32 s59, 200
L_pollsm4:
    s_buffer_load_dwordx8 s[48:55], s[20:23], s44 glc
    s_waitcnt lgkmcnt(0)
    s_sub_u32 s48, s48, s92
    s_sub_u32 s49, s49, s92
    s_sub_u32 s50, s50, s92
    s_sub_u32 s51, s51, s92
    s_sub_u32 s52, s52, s92
    s_sub_u32 s53, s53, s92
    s_sub_u32 s54, s54, s92
    s_sub_u32 s55, s55, s92
    s_max_u32 s48, s48, s49
    s_max_u32 s48, s48, s50
    s_max_u32 s48, s48, s51
    s_max_u32 s48, s48, s52
    s_max_u32 s48, s48, s53
    s_max_u32 s48, s48, s54
    s_max_u32 s48, s48, s55
    s_cmp_lt_u32 s48, 16
    s_cbranch_scc1 L_pollok4
    s_sub_u32 s59, s59, 1
    s_cbranch_scc1 L_pollvec4
    s_sleep 1
    s_branch L_pollsm4
L_pollvec4:
    v_bfe_u32 v53, v4, 4, 6
    v_lshlrev_b32 v53, 2, v53
    s_sub_u32 s96, s96, 1
    s_cbranch_scc1 L_pollgiveup4
    s_sleep 2
    buffer_load_dword v52, v53, s[20:23], s44 offen sc1
    s_waitcnt vmcnt(0)
    v_subrev_u32 v52, s92, v52
    v_cmp_lt_u32 vcc, 15, v52
    s_nop 0
    s_and_b32 s59, vcc_lo, 0xff
    s_cbranch_scc1 L_pollvec4
    s_branch L_pollok4
L_pollgiveup4:
    s_mov_b32 s96, 0
    s_branch L_pollok4
L_tagslow:
    s_sub_u32 s96, s96, 1
    s_cbranch_scc1 L_taggiveup
    s_sleep 2
    buffer_load_dword v0, off, s[88:91], s93 sc1
    s_waitcnt vmcnt(0)
    v_readfirstlane_b32 s42, v0
    s_nop 0
    s_cmp_eq_u32 s42, s46
    s_cbranch_scc1 L_tagslow
    s_cmp_eq_u32 s42, 0
    s_cbranch_scc1 L_tagslow
    s_branch L_tagok
L_taggiveup:
    s_mov_b32 s96, 0
    s_branch L_tagok
L_slow:
    s_waitcnt vmcnt(0) lgkmcnt(0)
    s_nop 15
    v_accvgpr_write_b32 a0, 0
    v_accvgpr_write_b32 a1, 0
    v_accvgpr_write_b32 a2, 0
    v_accvgpr_write_b32 a3, 0
    v_accvgpr_write_b32 a4, 0
    v_accvgpr_write_b32 a5, 0
    v_accvgpr_write_b32 a6, 0
    v_accvgpr_write_b32 a7, 0
    v_accvgpr_write_b32 a8, 0
    v_accvgpr_write_b32 a9, 0
    v_accvgpr_write_b32 a10, 0
    v_accvgpr_write_b32 a11, 0
    v_accvgpr_write_b32 a12, 0
    v_accvgpr_write_b32 a13, 0
    v_accvgpr_write_b32 a14, 0
    v_accvgpr_write_b32 a15, 0
    v_accvgpr_write_b32 a16, 0
    v_accvgpr_write_b32 a17, 0
    v_accvgpr_write_b32 a18, 0
    v_accvgpr_write_b32 a19, 0
    v_accvgpr_write_b32 a20, 0
    v_accvgpr_write_b32 a21, 0
    v_accvgpr_write_b32 a22, 0
    v_accvgpr_write_b32 a23, 0
    v_accvgpr_write_b32 a24, 0
    v_accvgpr_write_b32 a25, 0
    v_accvgpr_write_b32 a26, 0
    v_accvgpr_write_b32 a27, 0
    v_accvgpr_write_b32 a28, 0
    v_accvgpr_write_b32 a29, 0
    v_accvgpr_write_b32 a30, 0
    v_accvgpr_write_b32 a31, 0
    v_accvgpr_write_b32 a32, 0
    v_accvgpr_write_b32 a33, 0
    v_accvgpr_write_b32 a34, 0
    v_accvgpr_write_b32 a35, 0
    v_accvgpr_write_b32 a36, 0
    v_accvgpr_write_b32 a37, 0
    v_accvgpr_write_b32 a38, 0
    v_accvgpr_write_b32 a39, 0
    v_accvgpr_write_b32 a40, 0
    v_accvgpr_write_b32 a41, 0
    v_accvgpr_write_b32 a42, 0
    v_accvgpr_write_b32 a43, 0
    v_accvgpr_write_b32 a44, 0
    v_accvgpr_write_b32 a45, 0
    v_accvgpr_write_b32 a46, 0
    v_accvgpr_write_b32 a47, 0
    v_accvgpr_write_b32 a48, 0
    v_accvgpr_write_b32 a49, 0
    v_accvgpr_write_b32 a50, 0
    v_accvgpr_write_b32 a51, 0
    v_accvgpr_write_b32 a52, 0
    v_accvgpr_write_b32 a53, 0
    v_accvgpr_write_b32 a54, 0
    v_accvgpr_write_b32 a55, 0
    v_accvgpr_write_b32 a56, 0
    v_accvgpr_write_b32 a57, 0
    v_accvgpr_write_b32 a58, 0
    v_accvgpr_write_b32 a59, 0
    v_accvgpr_write_b32 a60, 0
    v_accvgpr_write_b32 a61, 0
    v_accvgpr_write_b32 a62, 0
    v_accvgpr_write_b32 a63, 0
    v_accvgpr_write_b32 a64, 0
    v_accvgpr_write_b32 a65, 0
    v_accvgpr_write_b32 a66, 0
    v_accvgpr_write_b32 a67, 0
    v_accvgpr_write_b32 a68, 0
    v_accvgpr_write_b32 a69, 0
    v_accvgpr_write_b32 a70, 0
    v_accvgpr_write_b32 a71, 0
    v_accvgpr_write_b32 a72, 0
    v_accvgpr_write_b32 a73, 0
    v_accvgpr_write_b32 a74, 0
    v_accvgpr_write_b32 a75, 0
    v_accvgpr_write_b32 a76, 0
    v_accvgpr_write_b32 a77, 0
    v_accvgpr_write_b32 a78, 0
    v_accvgpr_write_b32 a79, 0
    v_accvgpr_write_b32 a80, 0
    v_accvgpr_write_b32 a81, 0
    v_accvgpr_write_b32 a82, 0
    v_accvgpr_write_b32 a83, 0
    v_accvgpr_write_b32 a84, 0
    v_accvgpr_write_b32 a85, 0
    v_accvgpr_write_b32 a86, 0
    v_accvgpr_write_b32 a87, 0
    v_accvgpr_write_b32 a88, 0
    v_accvgpr_write_b32 a89, 0
    v_accvgpr_write_b32 a90, 0
    v_accvgpr_write_b32 a91, 0
    v_accvgpr_write_b32 a92, 0
    v_accvgpr_write_b32 a93, 0
    v_accvgpr_write_b32 a94, 0
    v_accvgpr_write_b32 a95, 0
    v_accvgpr_write_b32 a96, 0
    v_accvgpr_write_b32 a97, 0
    v_accvgpr_write_b32 a98, 0
    v_accvgpr_write_b32 a99, 0
    v_accvgpr_write_b32 a100, 0
    v_accvgpr_write_b32 a101, 0
    v_accvgpr_write_b32 a102, 0
    v_accvgpr_write_b32 a103, 0
    v_accvgpr_write_b32 a104, 0
    v_accvgpr_write_b32 a105, 0
    v_accvgpr_write_b32 a106, 0
    v_accvgpr_write_b32 a107, 0
    v_accvgpr_write_b32 a108, 0
    v_accvgpr_write_b32 a109, 0
    v_accvgpr_write_b32 a110, 0
    v_accvgpr_write_b32 a111, 0
    v_accvgpr_write_b32 a112, 0
    v_accvgpr_write_b32 a113, 0
    v_accvgpr_write_b32 a114, 0
    v_accvgpr_write_b32 a115, 0
    v_accvgpr_write_b32 a116, 0
    v_accvgpr_write_b32 a117, 0
    v_accvgpr_write_b32 a118, 0
    v_accvgpr_write_b32 a119, 0
    v_accvgpr_write_b32 a120, 0
    v_accvgpr_write_b32 a121, 0
    v_accvgpr_write_b32 a122, 0
    v_accvgpr_write_b32 a123, 0
    v_accvgpr_write_b32 a124, 0
    v_accvgpr_write_b32 a125, 0
    v_accvgpr_write_b32 a126, 0
    v_accvgpr_write_b32 a127, 0
    v_accvgpr_write_b32 a128, 0
    v_accvgpr_write_b32 a129, 0
    v_accvgpr_write_b32 a130, 0
    v_accvgpr_write_b32 a131, 0
    v_accvgpr_write_b32 a132, 0
    v_accvgpr_write_b32 a133, 0
    v_accvgpr_write_b32 a134, 0
    v_accvgpr_write_b32 a135, 0
    v_accvgpr_write_b32 a136, 0
    v_accvgpr_write_b32 a137, 0
    v_accvgpr_write_b32 a138, 0
    v_accvgpr_write_b32 a139, 0
    v_accvgpr_write_b32 a140, 0
    v_accvgpr_write_b32 a141, 0
    v_accvgpr_write_b32 a142, 0
    v_accvgpr_write_b32 a143, 0
    v_accvgpr_write_b32 a144, 0
    v_accvgpr_write_b32 a145, 0
    v_accvgpr_write_b32 a146, 0
    v_accvgpr_write_b32 a147, 0
    v_accvgpr_write_b32 a148, 0
    v_accvgpr_write_b32 a149, 0
    v_accvgpr_write_b32 a150, 0
    v_accvgpr_write_b32 a151, 0
    v_accvgpr_write_b32 a152, 0
    v_accvgpr_write_b32 a153, 0
    v_accvgpr_write_b32 a154, 0
    v_accvgpr_write_b32 a155, 0
    v_accvgpr_write_b32 a156, 0
    v_accvgpr_write_b32 a157, 0
    v_accvgpr_write_b32 a158, 0
    v_accvgpr_write_b32 a159, 0
    v_accvgpr_write_b32 a160, 0
    v_accvgpr_write_b32 a161, 0
    v_accvgpr_write_b32 a162, 0
    v_accvgpr_write_b32 a163, 0
    v_accvgpr_write_b32 a164, 0
    v_accvgpr_write_b32 a165, 0
    v_accvgpr_write_b32 a166, 0
    v_accvgpr_write_b32 a167, 0
    v_accvgpr_write_b32 a168, 0
    v_accvgpr_write_b32 a169, 0
    v_accvgpr_write_b32 a170, 0
    v_accvgpr_write_b32 a171, 0
    v_accvgpr_write_b32 a172, 0
    v_accvgpr_write_b32 a173, 0
    v_accvgpr_write_b32 a174, 0
    v_accvgpr_write_b32 a175, 0
    v_accvgpr_write_b32 a176, 0
    v_accvgpr_write_b32 a177, 0
    v_accvgpr_write_b32 a178, 0
    v_accvgpr_write_b32 a179, 0
    v_accvgpr_write_b32 a180, 0
    v_accvgpr_write_b32 a181, 0
    v_accvgpr_write_b32 a182, 0
    v_accvgpr_write_b32 a183, 0
    v_accvgpr_write_b32 a184, 0
    v_accvgpr_write_b32 a185, 0
    v_accvgpr_write_b32 a186, 0
    v_accvgpr_write_b32 a187, 0
    v_accvgpr_write_b32 a188, 0
    v_accvgpr_write_b32 a189, 0
    v_accvgpr_write_b32 a190, 0
    v_accvgpr_write_b32 a191, 0
    v_mov_b32 v5, 0
    v_mov_b32 v240, 0xff7fffff
    v_mov_b32 v6, 0
    v_mov_b32 v241, 0xff7fffff
    v_mov_b32 v7, 0
    v_mov_b32 v242, 0xff7fffff
    v_mov_b32 v8, 0
    v_mov_b32 v243, 0xff7fffff
    v_subrev_u32 v244, 49152, v2
    v_subrev_u32 v245, 49152, v3
    v_subrev_u32 v246, 24576, v1
    s_mov_b32 s48, 0
L_slowloop:
    s_add_u32 s49, s48, 6144
    s_add_u32 s50, s48, 12288
    s_add_u32 s51, s48, 16384
    s_add_u32 s52, s48, 20480
    buffer_load_dwordx4 v[64:67], v244, s[4:7], s48 offen offset:0 sc1
    buffer_load_dwordx4 v[68:71], v245, s[4:7], s48 offen offset:0 sc1
    buffer_load_dwordx4 v[72:75], v244, s[4:7], s49 offen offset:0 sc1
    buffer_load_dwordx4 v[76:79], v245, s[4:7], s49 offen offset:0 sc1
    buffer_load_dwordx4 v[80:83], v244, s[4:7], s48 offen offset:128 sc1
    buffer_load_dwordx4 v[84:87], v245, s[4:7], s48 offen offset:128 sc1
    buffer_load_dwordx4 v[88:91], v244, s[4:7], s49 offen offset:128 sc1
    buffer_load_dwordx4 v[92:95], v245, s[4:7], s49 offen offset:128 sc1
    buffer_load_dwordx4 v[96:99], v244, s[4:7], s48 offen offset:256 sc1
    buffer_load_dwordx4 v[100:103], v245, s[4:7], s48 offen offset:256 sc1
    buffer_load_dwordx4 v[104:107], v244, s[4:7], s49 offen offset:256 sc1
    buffer_load_dwordx4 v[108:111], v245, s[4:7], s49 offen offset:256 sc1
    buffer_load_dwordx4 v[112:115], v246, s[4:7], s50 offen offset:0 sc1
    buffer_load_dwordx4 v[116:119], v246, s[4:7], s50 offen offset:1024 sc1
    buffer_load_dwordx4 v[120:123], v246, s[4:7], s50 offen offset:2048 sc1
    buffer_load_dwordx4 v[124:127], v246, s[4:7], s50 offen offset:3072 sc1
    buffer_load_dwordx4 v[128:131], v246, s[4:7], s51 offen offset:0 sc1
    buffer_load_dwordx4 v[132:135], v246, s[4:7], s51 offen offset:1024 sc1
    buffer_load_dwordx4 v[136:139], v246, s[4:7], s51 offen offset:2048 sc1
    buffer_load_dwordx4 v[140:143], v246, s[4:7], s51 offen offset:3072 sc1
    buffer_load_dwordx4 v[144:147], v246, s[4:7], s52 offen offset:0 sc1
    buffer_load_dwordx4 v[148:151], v246, s[4:7], s52 offen offset:1024 sc1
    buffer_load_dwordx4 v[152:155], v246, s[4:7], s52 offen offset:2048 sc1
    buffer_load_dwordx4 v[156:159], v246, s[4:7], s52 offen offset:3072 sc1
    s_waitcnt vmcnt(12)
    v_mfma_f32_16x16x32_bf16 v[160:163], v[64:67], a[192:195], 0
    v_mfma_f32_16x16x32_bf16 v[168:171], v[64:67], a[216:219], 0
    v_mfma_f32_16x16x32_bf16 v[176:179], v[64:67], a[240:243], 0
    v_mfma_f32_16x16x32_bf16 v[184:187], v[64:67], v[200:203], 0
    v_mfma_f32_16x16x32_bf16 v[160:163], v[68:71], a[196:199], v[160:163]
    v_mfma_f32_16x16x32_bf16 v[168:171], v[68:71], a[220:223], v[168:171]
    v_mfma_f32_16x16x32_bf16 v[176:179], v[68:71], a[244:247], v[176:179]
    v_mfma_f32_16x16x32_bf16 v[184:187], v[68:71], v[204:207], v[184:187]
    v_mfma_f32_16x16x32_bf16 v[164:167], v[72:75], a[192:195], 0
    v_mfma_f32_16x16x32_bf16 v[172:175], v[72:75], a[216:219], 0
    v_mfma_f32_16x16x32_bf16 v[180:183], v[72:75], a[240:243], 0
    v_mfma_f32_16x16x32_bf16 v[188:191], v[72:75], v[200:203], 0
    v_mfma_f32_16x16x32_bf16 v[164:167], v[76:79], a[196:199], v[164:167]
    v_mfma_f32_16x16x32_bf16 v[172:175], v[76:79], a[220:223], v[172:175]
    v_mfma_f32_16x16x32_bf16 v[180:183], v[76:79], a[244:247], v[180:183]
    v_mfma_f32_16x16x32_bf16 v[188:191], v[76:79], v[204:207], v[188:191]
    v_mfma_f32_16x16x32_bf16 v[160:163], v[80:83], a[200:203], v[160:163]
    v_mfma_f32_16x16x32_bf16 v[168:171], v[80:83], a[224:227], v[168:171]
    v_mfma_f32_16x16x32_bf16 v[176:179], v[80:83], a[248:251], v[176:179]
    v_mfma_f32_16x16x32_bf16 v[184:187], v[80:83], v[208:211], v[184:187]
    v_mfma_f32_16x16x32_bf16 v[160:163], v[84:87], a[204:207], v[160:163]
    v_mfma_f32_16x16x32_bf16 v[168:171], v[84:87], a[228:231], v[168:171]
    v_mfma_f32_16x16x32_bf16 v[176:179], v[84:87], a[252:255], v[176:179]
    v_mfma_f32_16x16x32_bf16 v[184:187], v[84:87], v[212:215], v[184:187]
    v_mfma_f32_16x16x32_bf16 v[164:167], v[88:91], a[200:203], v[164:167]
    v_mfma_f32_16x16x32_bf16 v[172:175], v[88:91], a[224:227], v[172:175]
    v_mfma_f32_16x16x32_bf16 v[180:183], v[88:91], a[248:251], v[180:183]
    v_mfma_f32_16x16x32_bf16 v[188:191], v[88:91], v[208:211], v[188:191]
    v_mfma_f32_16x16x32_bf16 v[164:167], v[92:95], a[204:207], v[164:167]
    v_mfma_f32_16x16x32_bf16 v[172:175], v[92:95], a[228:231], v[172:175]
    v_mfma_f32_16x16x32_bf16 v[180:183], v[92:95], a[252:255], v[180:183]
    v_mfma_f32_16x16x32_bf16 v[188:191], v[92:95], v[212:215], v[188:191]
    v_mfma_f32_16x16x32_bf16 v[160:163], v[96:99], a[208:211], v[160:163]
    v_mfma_f32_16x16x32_bf16 v[168:171], v[96:99], a[232:235], v[168:171]
    v_mfma_f32_16x16x32_bf16 v[176:179], v[96:99], v[192:195], v[176:179]
    v_mfma_f32_16x16x32_bf16 v[184:187], v[96:99], v[216:219], v[184:187]
    v_mfma_f32_16x16x32_bf16 v[160:163], v[100:103], a[212:215], v[160:163]
    v_mfma_f32_16x16x32_bf16 v[168:171], v[100:103], a[236:239], v[168:171]
    v_mfma_f32_16x16x32_bf16 v[176:179], v[100:103], v[196:199], v[176:179]
    v_mfma_f32_16x16x32_bf16 v[184:187], v[100:103], v[220:223], v[184:187]
    v_mfma_f32_16x16x32_bf16 v[164:167], v[104:107], a[208:211], v[164:167]
    v_mfma_f32_16x16x32_bf16 v[172:175], v[104:107], a[232:235], v[172:175]
    v_mfma_f32_16x16x32_bf16 v[180:183], v[104:107], v[192:195], v[180:183]
    v_mfma_f32_16x16x32_bf16 v[188:191], v[104:107], v[216:219], v[188:191]
    v_mfma_f32_16x16x32_bf16 v[164:167], v[108:111], a[212:215], v[164:167]
    v_mfma_f32_16x16x32_bf16 v[172:175], v[108:111], a[236:239], v[172:175]
    v_mfma_f32_16x16x32_bf16 v[180:183], v[108:111], v[196:199], v[180:183]
    v_mfma_f32_16x16x32_bf16 v[188:191], v[108:111], v[220:223], v[188:191]
    s_nop 9
    v_max3_f32 v16, v160, v161, v162
    v_max3_f32 v16, v16, v163, v164
    v_max3_f32 v16, v16, v165, v166
    v_max3_f32 v16, v16, v167, v240
    v_mov_b32 v17, v16
    s_nop 1
    v_permlane16_swap_b32 v16, v17
    s_nop 1
    v_max_f32 v16, v16, v17
    v_mov_b32 v17, v16
    s_nop 1
    v_permlane32_swap_b32 v16, v17
    s_nop 1
    v_max_f32 v16, v16, v17
    v_sub_f32 v17, v240, v16
    v_exp_f32 v17, v17
    v_mov_b32 v240, v16
    v_sub_f32 v160, v160, v16
    v_sub_f32 v161, v161, v16
    v_sub_f32 v162, v162, v16
    v_sub_f32 v163, v163, v16
    v_sub_f32 v164, v164, v16
    v_sub_f32 v165, v165, v16
    v_sub_f32 v166, v166, v16
    v_sub_f32 v167, v167, v16
    v_exp_f32 v160, v160
    v_exp_f32 v161, v161
    v_exp_f32 v162, v162
    v_exp_f32 v163, v163
    v_exp_f32 v164, v164
    v_exp_f32 v165, v165
    v_exp_f32 v166, v166
    v_exp_f32 v167, v167
    v_mul_f32 v5, v5, v17
    v_add_f32 v5, v5, v160
    v_add_f32 v5, v5, v161
    v_add_f32 v5, v5, v162
    v_add_f32 v5, v5, v163
    v_add_f32 v5, v5, v164
    v_add_f32 v5, v5, v165
    v_add_f32 v5, v5, v166
    v_add_f32 v5, v5, v167
    v_cvt_pk_bf16_f32 v224, v160, v161
    v_cvt_pk_bf16_f32 v225, v162, v163
    v_cvt_pk_bf16_f32 v226, v164, v165
    v_cvt_pk_bf16_f32 v227, v166, v167
    ds_bpermute_b32 v248, v58, v17 offset:0
    ds_bpermute_b32 v249, v58, v17 offset:4
    ds_bpermute_b32 v250, v58, v17 offset:8
    ds_bpermute_b32 v251, v58, v17 offset:12
    s_waitcnt lgkmcnt(0)
    v_accvgpr_read_b32 v18, a0
    v_mul_f32 v18, v18, v248
    v_accvgpr_write_b32 a0, v18
    v_accvgpr_read_b32 v19, a1
    v_mul_f32 v19, v19, v249
    v_accvgpr_write_b32 a1, v19
    v_accvgpr_read_b32 v18, a2
    v_mul_f32 v18, v18, v250
    v_accvgpr_write_b32 a2, v18
    v_accvgpr_read_b32 v19, a3
    v_mul_f32 v19, v19, v251
    v_accvgpr_write_b32 a3, v19
    v_accvgpr_read_b32 v18, a4
    v_mul_f32 v18, v18, v248
    v_accvgpr_write_b32 a4, v18
    v_accvgpr_read_b32 v19, a5
    v_mul_f32 v19, v19, v249
    v_accvgpr_write_b32 a5, v19
    v_accvgpr_read_b32 v18, a6
    v_mul_f32 v18, v18, v250
    v_accvgpr_write_b32 a6, v18
    v_accvgpr_read_b32 v19, a7
    v_mul_f32 v19, v19, v251
    v_accvgpr_write_b32 a7, v19
    v_accvgpr_read_b32 v18, a8
    v_mul_f32 v18, v18, v248
    v_accvgpr_write_b32 a8, v18
    v_accvgpr_read_b32 v19, a9
    v_mul_f32 v19, v19, v249
    v_accvgpr_write_b32 a9, v19
    v_accvgpr_read_b32 v18, a10
    v_mul_f32 v18, v18, v250
    v_accvgpr_write_b32 a10, v18
    v_accvgpr_read_b32 v19, a11
    v_mul_f32 v19, v19, v251
    v_accvgpr_write_b32 a11, v19
    v_accvgpr_read_b32 v18, a12
    v_mul_f32 v18, v18, v248
    v_accvgpr_write_b32 a12, v18
    v_accvgpr_read_b32 v19, a13
    v_mul_f32 v19, v19, v249
    v_accvgpr_write_b32 a13, v19
    v_accvgpr_read_b32 v18, a14
    v_mul_f32 v18, v18, v250
    v_accvgpr_write_b32 a14, v18
    v_accvgpr_read_b32 v19, a15
    v_mul_f32 v19, v19, v251
    v_accvgpr_write_b32 a15, v19
    v_accvgpr_read_b32 v18, a16
    v_mul_f32 v18, v18, v248
    v_accvgpr_write_b32 a16, v18
    v_accvgpr_read_b32 v19, a17
    v_mul_f32 v19, v19, v249
    v_accvgpr_write_b32 a17, v19
    v_accvgpr_read_b32 v18, a18
    v_mul_f32 v18, v18, v250
    v_accvgpr_write_b32 a18, v18
    v_accvgpr_read_b32 v19, a19
    v_mul_f32 v19, v19, v251
    v_accvgpr_write_b32 a19, v19
    v_accvgpr_read_b32 v18, a20
    v_mul_f32 v18, v18, v248
    v_accvgpr_write_b32 a20, v18
    v_accvgpr_read_b32 v19, a21
    v_mul_f32 v19, v19, v249
    v_accvgpr_write_b32 a21, v19
    v_accvgpr_read_b32 v18, a22
    v_mul_f32 v18, v18, v250
    v_accvgpr_write_b32 a22, v18
    v_accvgpr_read_b32 v19, a23
    v_mul_f32 v19, v19, v251
    v_accvgpr_write_b32 a23, v19
    v_accvgpr_read_b32 v18, a24
    v_mul_f32 v18, v18, v248
    v_accvgpr_write_b32 a24, v18
    v_accvgpr_read_b32 v19, a25
    v_mul_f32 v19, v19, v249
    v_accvgpr_write_b32 a25, v19
    v_accvgpr_read_b32 v18, a26
    v_mul_f32 v18, v18, v250
    v_accvgpr_write_b32 a26, v18
    v_accvgpr_read_b32 v19, a27
    v_mul_f32 v19, v19, v251
    v_accvgpr_write_b32 a27, v19
    v_accvgpr_read_b32 v18, a28
    v_mul_f32 v18, v18, v248
    v_accvgpr_write_b32 a28, v18
    v_accvgpr_read_b32 v19, a29
    v_mul_f32 v19, v19, v249
    v_accvgpr_write_b32 a29, v19
    v_accvgpr_read_b32 v18, a30
    v_mul_f32 v18, v18, v250
    v_accvgpr_write_b32 a30, v18
    v_accvgpr_read_b32 v19, a31
    v_mul_f32 v19, v19, v251
    v_accvgpr_write_b32 a31, v19
    v_accvgpr_read_b32 v18, a32
    v_mul_f32 v18, v18, v248
    v_accvgpr_write_b32 a32, v18
    v_accvgpr_read_b32 v19, a33
    v_mul_f32 v19, v19, v249
    v_accvgpr_write_b32 a33, v19
    v_accvgpr_read_b32 v18, a34
    v_mul_f32 v18, v18, v250
    v_accvgpr_write_b32 a34, v18
    v_accvgpr_read_b32 v19, a35
    v_mul_f32 v19, v19, v251
    v_accvgpr_write_b32 a35, v19
    v_accvgpr_read_b32 v18, a36
    v_mul_f32 v18, v18, v248
    v_accvgpr_write_b32 a36, v18
    v_accvgpr_read_b32 v19, a37
    v_mul_f32 v19, v19, v249
    v_accvgpr_write_b32 a37, v19
    v_accvgpr_read_b32 v18, a38
    v_mul_f32 v18, v18, v250
    v_accvgpr_write_b32 a38, v18
    v_accvgpr_read_b32 v19, a39
    v_mul_f32 v19, v19, v251
    v_accvgpr_write_b32 a39, v19
    v_accvgpr_read_b32 v18, a40
    v_mul_f32 v18, v18, v248
    v_accvgpr_write_b32 a40, v18
    v_accvgpr_read_b32 v19, a41
    v_mul_f32 v19, v19, v249
    v_accvgpr_write_b32 a41, v19
    v_accvgpr_read_b32 v18, a42
    v_mul_f32 v18, v18, v250
    v_accvgpr_write_b32 a42, v18
    v_accvgpr_read_b32 v19, a43
    v_mul_f32 v19, v19, v251
    v_accvgpr_write_b32 a43, v19
    v_accvgpr_read_b32 v18, a44
    v_mul_f32 v18, v18, v248
    v_accvgpr_write_b32 a44, v18
    v_accvgpr_read_b32 v19, a45
    v_mul_f32 v19, v19, v249
    v_accvgpr_write_b32 a45, v19
    v_accvgpr_read_b32 v18, a46
    v_mul_f32 v18, v18, v250
    v_accvgpr_write_b32 a46, v18
    v_accvgpr_read_b32 v19, a47
    v_mul_f32 v19, v19, v251
    v_accvgpr_write_b32 a47, v19
    v_max3_f32 v16, v168, v169, v170
    v_max3_f32 v16, v16, v171, v172
    v_max3_f32 v16, v16, v173, v174
    v_max3_f32 v16, v16, v175, v241
    v_mov_b32 v17, v16
    s_nop 1
    v_permlane16_swap_b32 v16, v17
    s_nop 1
    v_max_f32 v16, v16, v17
    v_mov_b32 v17, v16
    s_nop 1
    v_permlane32_swap_b32 v16, v17
    s_nop 1
    v_max_f32 v16, v16, v17
    v_sub_f32 v17, v241, v16
    v_exp_f32 v17, v17
    v_mov_b32 v241, v16
    v_sub_f32 v168, v168, v16
    v_sub_f32 v169, v169, v16
    v_sub_f32 v170, v170, v16
    v_sub_f32 v171, v171, v16
    v_sub_f32 v172, v172, v16
    v_sub_f32 v173, v173, v16
    v_sub_f32 v174, v174, v16
    v_sub_f32 v175, v175, v16
    v_exp_f32 v168, v168
    v_exp_f32 v169, v169
    v_exp_f32 v170, v170
    v_exp_f32 v171, v171
    v_exp_f32 v172, v172
    v_exp_f32 v173, v173
    v_exp_f32 v174, v174
    v_exp_f32 v175, v175
    v_mul_f32 v6, v6, v17
    v_add_f32 v6, v6, v168
    v_add_f32 v6, v6, v169
    v_add_f32 v6, v6, v170
    v_add_f32 v6, v6, v171
    v_add_f32 v6, v6, v172
    v_add_f32 v6, v6, v173
    v_add_f32 v6, v6, v174
    v_add_f32 v6, v6, v175
    v_cvt_pk_bf16_f32 v228, v168, v169
    v_cvt_pk_bf16_f32 v229, v170, v171
    v_cvt_pk_bf16_f32 v230, v172, v173
    v_cvt_pk_bf16_f32 v231, v174, v175
    ds_bpermute_b32 v248, v58, v17 offset:0
    ds_bpermute_b32 v249, v58, v17 offset:4
    ds_bpermute_b32 v250, v58, v17 offset:8
    ds_bpermute_b32 v251, v58, v17 offset:12
    s_waitcnt lgkmcnt(0)
    v_accvgpr_read_b32 v18, a48
    v_mul_f32 v18, v18, v248
    v_accvgpr_write_b32 a48, v18
    v_accvgpr_read_b32 v19, a49
    v_mul_f32 v19, v19, v249
    v_accvgpr_write_b32 a49, v19
    v_accvgpr_read_b32 v18, a50
    v_mul_f32 v18, v18, v250
    v_accvgpr_write_b32 a50, v18
    v_accvgpr_read_b32 v19, a51
    v_mul_f32 v19, v19, v251
    v_accvgpr_write_b32 a51, v19
    v_accvgpr_read_b32 v18, a52
    v_mul_f32 v18, v18, v248
    v_accvgpr_write_b32 a52, v18
    v_accvgpr_read_b32 v19, a53
    v_mul_f32 v19, v19, v249
    v_accvgpr_write_b32 a53, v19
    v_accvgpr_read_b32 v18, a54
    v_mul_f32 v18, v18, v250
    v_accvgpr_write_b32 a54, v18
    v_accvgpr_read_b32 v19, a55
    v_mul_f32 v19, v19, v251
    v_accvgpr_write_b32 a55, v19
    v_accvgpr_read_b32 v18, a56
    v_mul_f32 v18, v18, v248
    v_accvgpr_write_b32 a56, v18
    v_accvgpr_read_b32 v19, a57
    v_mul_f32 v19, v19, v249
    v_accvgpr_write_b32 a57, v19
    v_accvgpr_read_b32 v18, a58
    v_mul_f32 v18, v18, v250
    v_accvgpr_write_b32 a58, v18
    v_accvgpr_read_b32 v19, a59
    v_mul_f32 v19, v19, v251
    v_accvgpr_write_b32 a59, v19
    v_accvgpr_read_b32 v18, a60
    v_mul_f32 v18, v18, v248
    v_accvgpr_write_b32 a60, v18
    v_accvgpr_read_b32 v19, a61
    v_mul_f32 v19, v19, v249
    v_accvgpr_write_b32 a61, v19
    v_accvgpr_read_b32 v18, a62
    v_mul_f32 v18, v18, v250
    v_accvgpr_write_b32 a62, v18
    v_accvgpr_read_b32 v19, a63
    v_mul_f32 v19, v19, v251
    v_accvgpr_write_b32 a63, v19
    v_accvgpr_read_b32 v18, a64
    v_mul_f32 v18, v18, v248
    v_accvgpr_write_b32 a64, v18
    v_accvgpr_read_b32 v19, a65
    v_mul_f32 v19, v19, v249
    v_accvgpr_write_b32 a65, v19
    v_accvgpr_read_b32 v18, a66
    v_mul_f32 v18, v18, v250
    v_accvgpr_write_b32 a66, v18
    v_accvgpr_read_b32 v19, a67
    v_mul_f32 v19, v19, v251
    v_accvgpr_write_b32 a67, v19
    v_accvgpr_read_b32 v18, a68
    v_mul_f32 v18, v18, v248
    v_accvgpr_write_b32 a68, v18
    v_accvgpr_read_b32 v19, a69
    v_mul_f32 v19, v19, v249
    v_accvgpr_write_b32 a69, v19
    v_accvgpr_read_b32 v18, a70
    v_mul_f32 v18, v18, v250
    v_accvgpr_write_b32 a70, v18
    v_accvgpr_read_b32 v19, a71
    v_mul_f32 v19, v19, v251
    v_accvgpr_write_b32 a71, v19
    v_accvgpr_read_b32 v18, a72
    v_mul_f32 v18, v18, v248
    v_accvgpr_write_b32 a72, v18
    v_accvgpr_read_b32 v19, a73
    v_mul_f32 v19, v19, v249
    v_accvgpr_write_b32 a73, v19
    v_accvgpr_read_b32 v18, a74
    v_mul_f32 v18, v18, v250
    v_accvgpr_write_b32 a74, v18
    v_accvgpr_read_b32 v19, a75
    v_mul_f32 v19, v19, v251
    v_accvgpr_write_b32 a75, v19
    v_accvgpr_read_b32 v18, a76
    v_mul_f32 v18, v18, v248
    v_accvgpr_write_b32 a76, v18
    v_accvgpr_read_b32 v19, a77
    v_mul_f32 v19, v19, v249
    v_accvgpr_write_b32 a77, v19
    v_accvgpr_read_b32 v18, a78
    v_mul_f32 v18, v18, v250
    v_accvgpr_write_b32 a78, v18
    v_accvgpr_read_b32 v19, a79
    v_mul_f32 v19, v19, v251
    v_accvgpr_write_b32 a79, v19
    v_accvgpr_read_b32 v18, a80
    v_mul_f32 v18, v18, v248
    v_accvgpr_write_b32 a80, v18
    v_accvgpr_read_b32 v19, a81
    v_mul_f32 v19, v19, v249
    v_accvgpr_write_b32 a81, v19
    v_accvgpr_read_b32 v18, a82
    v_mul_f32 v18, v18, v250
    v_accvgpr_write_b32 a82, v18
    v_accvgpr_read_b32 v19, a83
    v_mul_f32 v19, v19, v251
    v_accvgpr_write_b32 a83, v19
    v_accvgpr_read_b32 v18, a84
    v_mul_f32 v18, v18, v248
    v_accvgpr_write_b32 a84, v18
    v_accvgpr_read_b32 v19, a85
    v_mul_f32 v19, v19, v249
    v_accvgpr_write_b32 a85, v19
    v_accvgpr_read_b32 v18, a86
    v_mul_f32 v18, v18, v250
    v_accvgpr_write_b32 a86, v18
    v_accvgpr_read_b32 v19, a87
    v_mul_f32 v19, v19, v251
    v_accvgpr_write_b32 a87, v19
    v_accvgpr_read_b32 v18, a88
    v_mul_f32 v18, v18, v248
    v_accvgpr_write_b32 a88, v18
    v_accvgpr_read_b32 v19, a89
    v_mul_f32 v19, v19, v249
    v_accvgpr_write_b32 a89, v19
    v_accvgpr_read_b32 v18, a90
    v_mul_f32 v18, v18, v250
    v_accvgpr_write_b32 a90, v18
    v_accvgpr_read_b32 v19, a91
    v_mul_f32 v19, v19, v251
    v_accvgpr_write_b32 a91, v19
    v_accvgpr_read_b32 v18, a92
    v_mul_f32 v18, v18, v248
    v_accvgpr_write_b32 a92, v18
    v_accvgpr_read_b32 v19, a93
    v_mul_f32 v19, v19, v249
    v_accvgpr_write_b32 a93, v19
    v_accvgpr_read_b32 v18, a94
    v_mul_f32 v18, v18, v250
    v_accvgpr_write_b32 a94, v18
    v_accvgpr_read_b32 v19, a95
    v_mul_f32 v19, v19, v251
    v_accvgpr_write_b32 a95, v19
    v_max3_f32 v16, v176, v177, v178
    v_max3_f32 v16, v16, v179, v180
    v_max3_f32 v16, v16, v181, v182
    v_max3_f32 v16, v16, v183, v242
    v_mov_b32 v17, v16
    s_nop 1
    v_permlane16_swap_b32 v16, v17
    s_nop 1
    v_max_f32 v16, v16, v17
    v_mov_b32 v17, v16
    s_nop 1
    v_permlane32_swap_b32 v16, v17
    s_nop 1
    v_max_f32 v16, v16, v17
    v_sub_f32 v17, v242, v16
    v_exp_f32 v17, v17
    v_mov_b32 v242, v16
    v_sub_f32 v176, v176, v16
    v_sub_f32 v177, v177, v16
    v_sub_f32 v178, v178, v16
    v_sub_f32 v179, v179, v16
    v_sub_f32 v180, v180, v16
    v_sub_f32 v181, v181, v16
    v_sub_f32 v182, v182, v16
    v_sub_f32 v183, v183, v16
    v_exp_f32 v176, v176
    v_exp_f32 v177, v177
    v_exp_f32 v178, v178
    v_exp_f32 v179, v179
    v_exp_f32 v180, v180
    v_exp_f32 v181, v181
    v_exp_f32 v182, v182
    v_exp_f32 v183, v183
    v_mul_f32 v7, v7, v17
    v_add_f32 v7, v7, v176
    v_add_f32 v7, v7, v177
    v_add_f32 v7, v7, v178
    v_add_f32 v7, v7, v179
    v_add_f32 v7, v7, v180
    v_add_f32 v7, v7, v181
    v_add_f32 v7, v7, v182
    v_add_f32 v7, v7, v183
    v_cvt_pk_bf16_f32 v232, v176, v177
    v_cvt_pk_bf16_f32 v233, v178, v179
    v_cvt_pk_bf16_f32 v234, v180, v181
    v_cvt_pk_bf16_f32 v235, v182, v183
    ds_bpermute_b32 v248, v58, v17 offset:0
    ds_bpermute_b32 v249, v58, v17 offset:4
    ds_bpermute_b32 v250, v58, v17 offset:8
    ds_bpermute_b32 v251, v58, v17 offset:12
    s_waitcnt lgkmcnt(0)
    v_accvgpr_read_b32 v18, a96
    v_mul_f32 v18, v18, v248
    v_accvgpr_write_b32 a96, v18
    v_accvgpr_read_b32 v19, a97
    v_mul_f32 v19, v19, v249
    v_accvgpr_write_b32 a97, v19
    v_accvgpr_read_b32 v18, a98
    v_mul_f32 v18, v18, v250
    v_accvgpr_write_b32 a98, v18
    v_accvgpr_read_b32 v19, a99
    v_mul_f32 v19, v19, v251
    v_accvgpr_write_b32 a99, v19
    v_accvgpr_read_b32 v18, a100
    v_mul_f32 v18, v18, v248
    v_accvgpr_write_b32 a100, v18
    v_accvgpr_read_b32 v19, a101
    v_mul_f32 v19, v19, v249
    v_accvgpr_write_b32 a101, v19
    v_accvgpr_read_b32 v18, a102
    v_mul_f32 v18, v18, v250
    v_accvgpr_write_b32 a102, v18
    v_accvgpr_read_b32 v19, a103
    v_mul_f32 v19, v19, v251
    v_accvgpr_write_b32 a103, v19
    v_accvgpr_read_b32 v18, a104
    v_mul_f32 v18, v18, v248
    v_accvgpr_write_b32 a104, v18
    v_accvgpr_read_b32 v19, a105
    v_mul_f32 v19, v19, v249
    v_accvgpr_write_b32 a105, v19
    v_accvgpr_read_b32 v18, a106
    v_mul_f32 v18, v18, v250
    v_accvgpr_write_b32 a106, v18
    v_accvgpr_read_b32 v19, a107
    v_mul_f32 v19, v19, v251
    v_accvgpr_write_b32 a107, v19
    v_accvgpr_read_b32 v18, a108
    v_mul_f32 v18, v18, v248
    v_accvgpr_write_b32 a108, v18
    v_accvgpr_read_b32 v19, a109
    v_mul_f32 v19, v19, v249
    v_accvgpr_write_b32 a109, v19
    v_accvgpr_read_b32 v18, a110
    v_mul_f32 v18, v18, v250
    v_accvgpr_write_b32 a110, v18
    v_accvgpr_read_b32 v19, a111
    v_mul_f32 v19, v19, v251
    v_accvgpr_write_b32 a111, v19
    v_accvgpr_read_b32 v18, a112
    v_mul_f32 v18, v18, v248
    v_accvgpr_write_b32 a112, v18
    v_accvgpr_read_b32 v19, a113
    v_mul_f32 v19, v19, v249
    v_accvgpr_write_b32 a113, v19
    v_accvgpr_read_b32 v18, a114
    v_mul_f32 v18, v18, v250
    v_accvgpr_write_b32 a114, v18
    v_accvgpr_read_b32 v19, a115
    v_mul_f32 v19, v19, v251
    v_accvgpr_write_b32 a115, v19
    v_accvgpr_read_b32 v18, a116
    v_mul_f32 v18, v18, v248
    v_accvgpr_write_b32 a116, v18
    v_accvgpr_read_b32 v19, a117
    v_mul_f32 v19, v19, v249
    v_accvgpr_write_b32 a117, v19
    v_accvgpr_read_b32 v18, a118
    v_mul_f32 v18, v18, v250
    v_accvgpr_write_b32 a118, v18
    v_accvgpr_read_b32 v19, a119
    v_mul_f32 v19, v19, v251
    v_accvgpr_write_b32 a119, v19
    v_accvgpr_read_b32 v18, a120
    v_mul_f32 v18, v18, v248
    v_accvgpr_write_b32 a120, v18
    v_accvgpr_read_b32 v19, a121
    v_mul_f32 v19, v19, v249
    v_accvgpr_write_b32 a121, v19
    v_accvgpr_read_b32 v18, a122
    v_mul_f32 v18, v18, v250
    v_accvgpr_write_b32 a122, v18
    v_accvgpr_read_b32 v19, a123
    v_mul_f32 v19, v19, v251
    v_accvgpr_write_b32 a123, v19
    v_accvgpr_read_b32 v18, a124
    v_mul_f32 v18, v18, v248
    v_accvgpr_write_b32 a124, v18
    v_accvgpr_read_b32 v19, a125
    v_mul_f32 v19, v19, v249
    v_accvgpr_write_b32 a125, v19
    v_accvgpr_read_b32 v18, a126
    v_mul_f32 v18, v18, v250
    v_accvgpr_write_b32 a126, v18
    v_accvgpr_read_b32 v19, a127
    v_mul_f32 v19, v19, v251
    v_accvgpr_write_b32 a127, v19
    v_accvgpr_read_b32 v18, a128
    v_mul_f32 v18, v18, v248
    v_accvgpr_write_b32 a128, v18
    v_accvgpr_read_b32 v19, a129
    v_mul_f32 v19, v19, v249
    v_accvgpr_write_b32 a129, v19
    v_accvgpr_read_b32 v18, a130
    v_mul_f32 v18, v18, v250
    v_accvgpr_write_b32 a130, v18
    v_accvgpr_read_b32 v19, a131
    v_mul_f32 v19, v19, v251
    v_accvgpr_write_b32 a131, v19
    v_accvgpr_read_b32 v18, a132
    v_mul_f32 v18, v18, v248
    v_accvgpr_write_b32 a132, v18
    v_accvgpr_read_b32 v19, a133
    v_mul_f32 v19, v19, v249
    v_accvgpr_write_b32 a133, v19
    v_accvgpr_read_b32 v18, a134
    v_mul_f32 v18, v18, v250
    v_accvgpr_write_b32 a134, v18
    v_accvgpr_read_b32 v19, a135
    v_mul_f32 v19, v19, v251
    v_accvgpr_write_b32 a135, v19
    v_accvgpr_read_b32 v18, a136
    v_mul_f32 v18, v18, v248
    v_accvgpr_write_b32 a136, v18
    v_accvgpr_read_b32 v19, a137
    v_mul_f32 v19, v19, v249
    v_accvgpr_write_b32 a137, v19
    v_accvgpr_read_b32 v18, a138
    v_mul_f32 v18, v18, v250
    v_accvgpr_write_b32 a138, v18
    v_accvgpr_read_b32 v19, a139
    v_mul_f32 v19, v19, v251
    v_accvgpr_write_b32 a139, v19
    v_accvgpr_read_b32 v18, a140
    v_mul_f32 v18, v18, v248
    v_accvgpr_write_b32 a140, v18
    v_accvgpr_read_b32 v19, a141
    v_mul_f32 v19, v19, v249
    v_accvgpr_write_b32 a141, v19
    v_accvgpr_read_b32 v18, a142
    v_mul_f32 v18, v18, v250
    v_accvgpr_write_b32 a142, v18
    v_accvgpr_read_b32 v19, a143
    v_mul_f32 v19, v19, v251
    v_accvgpr_write_b32 a143, v19
    v_max3_f32 v16, v184, v185, v186
    v_max3_f32 v16, v16, v187, v188
    v_max3_f32 v16, v16, v189, v190
    v_max3_f32 v16, v16, v191, v243
    v_mov_b32 v17, v16
    s_nop 1
    v_permlane16_swap_b32 v16, v17
    s_nop 1
    v_max_f32 v16, v16, v17
    v_mov_b32 v17, v16
    s_nop 1
    v_permlane32_swap_b32 v16, v17
    s_nop 1
    v_max_f32 v16, v16, v17
    v_sub_f32 v17, v243, v16
    v_exp_f32 v17, v17
    v_mov_b32 v243, v16
    v_sub_f32 v184, v184, v16
    v_sub_f32 v185, v185, v16
    v_sub_f32 v186, v186, v16
    v_sub_f32 v187, v187, v16
    v_sub_f32 v188, v188, v16
    v_sub_f32 v189, v189, v16
    v_sub_f32 v190, v190, v16
    v_sub_f32 v191, v191, v16
    v_exp_f32 v184, v184
    v_exp_f32 v185, v185
    v_exp_f32 v186, v186
    v_exp_f32 v187, v187
    v_exp_f32 v188, v188
    v_exp_f32 v189, v189
    v_exp_f32 v190, v190
    v_exp_f32 v191, v191
    v_mul_f32 v8, v8, v17
    v_add_f32 v8, v8, v184
    v_add_f32 v8, v8, v185
    v_add_f32 v8, v8, v186
    v_add_f32 v8, v8, v187
    v_add_f32 v8, v8, v188
    v_add_f32 v8, v8, v189
    v_add_f32 v8, v8, v190
    v_add_f32 v8, v8, v191
    v_cvt_pk_bf16_f32 v236, v184, v185
    v_cvt_pk_bf16_f32 v237, v186, v187
    v_cvt_pk_bf16_f32 v238, v188, v189
    v_cvt_pk_bf16_f32 v239, v190, v191
    ds_bpermute_b32 v248, v58, v17 offset:0
    ds_bpermute_b32 v249, v58, v17 offset:4
    ds_bpermute_b32 v250, v58, v17 offset:8
    ds_bpermute_b32 v251, v58, v17 offset:12
    s_waitcnt lgkmcnt(0)
    v_accvgpr_read_b32 v18, a144
    v_mul_f32 v18, v18, v248
    v_accvgpr_write_b32 a144, v18
    v_accvgpr_read_b32 v19, a145
    v_mul_f32 v19, v19, v249
    v_accvgpr_write_b32 a145, v19
    v_accvgpr_read_b32 v18, a146
    v_mul_f32 v18, v18, v250
    v_accvgpr_write_b32 a146, v18
    v_accvgpr_read_b32 v19, a147
    v_mul_f32 v19, v19, v251
    v_accvgpr_write_b32 a147, v19
    v_accvgpr_read_b32 v18, a148
    v_mul_f32 v18, v18, v248
    v_accvgpr_write_b32 a148, v18
    v_accvgpr_read_b32 v19, a149
    v_mul_f32 v19, v19, v249
    v_accvgpr_write_b32 a149, v19
    v_accvgpr_read_b32 v18, a150
    v_mul_f32 v18, v18, v250
    v_accvgpr_write_b32 a150, v18
    v_accvgpr_read_b32 v19, a151
    v_mul_f32 v19, v19, v251
    v_accvgpr_write_b32 a151, v19
    v_accvgpr_read_b32 v18, a152
    v_mul_f32 v18, v18, v248
    v_accvgpr_write_b32 a152, v18
    v_accvgpr_read_b32 v19, a153
    v_mul_f32 v19, v19, v249
    v_accvgpr_write_b32 a153, v19
    v_accvgpr_read_b32 v18, a154
    v_mul_f32 v18, v18, v250
    v_accvgpr_write_b32 a154, v18
    v_accvgpr_read_b32 v19, a155
    v_mul_f32 v19, v19, v251
    v_accvgpr_write_b32 a155, v19
    v_accvgpr_read_b32 v18, a156
    v_mul_f32 v18, v18, v248
    v_accvgpr_write_b32 a156, v18
    v_accvgpr_read_b32 v19, a157
    v_mul_f32 v19, v19, v249
    v_accvgpr_write_b32 a157, v19
    v_accvgpr_read_b32 v18, a158
    v_mul_f32 v18, v18, v250
    v_accvgpr_write_b32 a158, v18
    v_accvgpr_read_b32 v19, a159
    v_mul_f32 v19, v19, v251
    v_accvgpr_write_b32 a159, v19
    v_accvgpr_read_b32 v18, a160
    v_mul_f32 v18, v18, v248
    v_accvgpr_write_b32 a160, v18
    v_accvgpr_read_b32 v19, a161
    v_mul_f32 v19, v19, v249
    v_accvgpr_write_b32 a161, v19
    v_accvgpr_read_b32 v18, a162
    v_mul_f32 v18, v18, v250
    v_accvgpr_write_b32 a162, v18
    v_accvgpr_read_b32 v19, a163
    v_mul_f32 v19, v19, v251
    v_accvgpr_write_b32 a163, v19
    v_accvgpr_read_b32 v18, a164
    v_mul_f32 v18, v18, v248
    v_accvgpr_write_b32 a164, v18
    v_accvgpr_read_b32 v19, a165
    v_mul_f32 v19, v19, v249
    v_accvgpr_write_b32 a165, v19
    v_accvgpr_read_b32 v18, a166
    v_mul_f32 v18, v18, v250
    v_accvgpr_write_b32 a166, v18
    v_accvgpr_read_b32 v19, a167
    v_mul_f32 v19, v19, v251
    v_accvgpr_write_b32 a167, v19
    v_accvgpr_read_b32 v18, a168
    v_mul_f32 v18, v18, v248
    v_accvgpr_write_b32 a168, v18
    v_accvgpr_read_b32 v19, a169
    v_mul_f32 v19, v19, v249
    v_accvgpr_write_b32 a169, v19
    v_accvgpr_read_b32 v18, a170
    v_mul_f32 v18, v18, v250
    v_accvgpr_write_b32 a170, v18
    v_accvgpr_read_b32 v19, a171
    v_mul_f32 v19, v19, v251
    v_accvgpr_write_b32 a171, v19
    v_accvgpr_read_b32 v18, a172
    v_mul_f32 v18, v18, v248
    v_accvgpr_write_b32 a172, v18
    v_accvgpr_read_b32 v19, a173
    v_mul_f32 v19, v19, v249
    v_accvgpr_write_b32 a173, v19
    v_accvgpr_read_b32 v18, a174
    v_mul_f32 v18, v18, v250
    v_accvgpr_write_b32 a174, v18
    v_accvgpr_read_b32 v19, a175
    v_mul_f32 v19, v19, v251
    v_accvgpr_write_b32 a175, v19
    v_accvgpr_read_b32 v18, a176
    v_mul_f32 v18, v18, v248
    v_accvgpr_write_b32 a176, v18
    v_accvgpr_read_b32 v19, a177
    v_mul_f32 v19, v19, v249
    v_accvgpr_write_b32 a177, v19
    v_accvgpr_read_b32 v18, a178
    v_mul_f32 v18, v18, v250
    v_accvgpr_write_b32 a178, v18
    v_accvgpr_read_b32 v19, a179
    v_mul_f32 v19, v19, v251
    v_accvgpr_write_b32 a179, v19
    v_accvgpr_read_b32 v18, a180
    v_mul_f32 v18, v18, v248
    v_accvgpr_write_b32 a180, v18
    v_accvgpr_read_b32 v19, a181
    v_mul_f32 v19, v19, v249
    v_accvgpr_write_b32 a181, v19
    v_accvgpr_read_b32 v18, a182
    v_mul_f32 v18, v18, v250
    v_accvgpr_write_b32 a182, v18
    v_accvgpr_read_b32 v19, a183
    v_mul_f32 v19, v19, v251
    v_accvgpr_write_b32 a183, v19
    v_accvgpr_read_b32 v18, a184
    v_mul_f32 v18, v18, v248
    v_accvgpr_write_b32 a184, v18
    v_accvgpr_read_b32 v19, a185
    v_mul_f32 v19, v19, v249
    v_accvgpr_write_b32 a185, v19
    v_accvgpr_read_b32 v18, a186
    v_mul_f32 v18, v18, v250
    v_accvgpr_write_b32 a186, v18
    v_accvgpr_read_b32 v19, a187
    v_mul_f32 v19, v19, v251
    v_accvgpr_write_b32 a187, v19
    v_accvgpr_read_b32 v18, a188
    v_mul_f32 v18, v18, v248
    v_accvgpr_write_b32 a188, v18
    v_accvgpr_read_b32 v19, a189
    v_mul_f32 v19, v19, v249
    v_accvgpr_write_b32 a189, v19
    v_accvgpr_read_b32 v18, a190
    v_mul_f32 v18, v18, v250
    v_accvgpr_write_b32 a190, v18
    v_accvgpr_read_b32 v19, a191
    v_mul_f32 v19, v19, v251
    v_accvgpr_write_b32 a191, v19
    s_waitcnt vmcnt(0)
    s_nop 1
    v_mfma_f32_16x16x32_bf16 a[0:3], v[224:227], v[112:115], a[0:3]
    v_mfma_f32_16x16x32_bf16 a[48:51], v[228:231], v[112:115], a[48:51]
    v_mfma_f32_16x16x32_bf16 a[96:99], v[232:235], v[112:115], a[96:99]
    v_mfma_f32_16x16x32_bf16 a[144:147], v[236:239], v[112:115], a[144:147]
    v_mfma_f32_16x16x32_bf16 a[4:7], v[224:227], v[116:119], a[4:7]
    v_mfma_f32_16x16x32_bf16 a[52:55], v[228:231], v[116:119], a[52:55]
    v_mfma_f32_16x16x32_bf16 a[100:103], v[232:235], v[116:119], a[100:103]
    v_mfma_f32_16x16x32_bf16 a[148:151], v[236:239], v[116:119], a[148:151]
    v_mfma_f32_16x16x32_bf16 a[8:11], v[224:227], v[120:123], a[8:11]
    v_mfma_f32_16x16x32_bf16 a[56:59], v[228:231], v[120:123], a[56:59]
    v_mfma_f32_16x16x32_bf16 a[104:107], v[232:235], v[120:123], a[104:107]
    v_mfma_f32_16x16x32_bf16 a[152:155], v[236:239], v[120:123], a[152:155]
    v_mfma_f32_16x16x32_bf16 a[12:15], v[224:227], v[124:127], a[12:15]
    v_mfma_f32_16x16x32_bf16 a[60:63], v[228:231], v[124:127], a[60:63]
    v_mfma_f32_16x16x32_bf16 a[108:111], v[232:235], v[124:127], a[108:111]
    v_mfma_f32_16x16x32_bf16 a[156:159], v[236:239], v[124:127], a[156:159]
    v_mfma_f32_16x16x32_bf16 a[16:19], v[224:227], v[128:131], a[16:19]
    v_mfma_f32_16x16x32_bf16 a[64:67], v[228:231], v[128:131], a[64:67]
    v_mfma_f32_16x16x32_bf16 a[112:115], v[232:235], v[128:131], a[112:115]
    v_mfma_f32_16x16x32_bf16 a[160:163], v[236:239], v[128:131], a[160:163]
    v_mfma_f32_16x16x32_bf16 a[20:23], v[224:227], v[132:135], a[20:23]
    v_mfma_f32_16x16x32_bf16 a[68:71], v[228:231], v[132:135], a[68:71]
    v_mfma_f32_16x16x32_bf16 a[116:119], v[232:235], v[132:135], a[116:119]
    v_mfma_f32_16x16x32_bf16 a[164:167], v[236:239], v[132:135], a[164:167]
    v_mfma_f32_16x16x32_bf16 a[24:27], v[224:227], v[136:139], a[24:27]
    v_mfma_f32_16x16x32_bf16 a[72:75], v[228:231], v[136:139], a[72:75]
    v_mfma_f32_16x16x32_bf16 a[120:123], v[232:235], v[136:139], a[120:123]
    v_mfma_f32_16x16x32_bf16 a[168:171], v[236:239], v[136:139], a[168:171]
    v_mfma_f32_16x16x32_bf16 a[28:31], v[224:227], v[140:143], a[28:31]
    v_mfma_f32_16x16x32_bf16 a[76:79], v[228:231], v[140:143], a[76:79]
    v_mfma_f32_16x16x32_bf16 a[124:127], v[232:235], v[140:143], a[124:127]
    v_mfma_f32_16x16x32_bf16 a[172:175], v[236:239], v[140:143], a[172:175]
    v_mfma_f32_16x16x32_bf16 a[32:35], v[224:227], v[144:147], a[32:35]
    v_mfma_f32_16x16x32_bf16 a[80:83], v[228:231], v[144:147], a[80:83]
    v_mfma_f32_16x16x32_bf16 a[128:131], v[232:235], v[144:147], a[128:131]
    v_mfma_f32_16x16x32_bf16 a[176:179], v[236:239], v[144:147], a[176:179]
    v_mfma_f32_16x16x32_bf16 a[36:39], v[224:227], v[148:151], a[36:39]
    v_mfma_f32_16x16x32_bf16 a[84:87], v[228:231], v[148:151], a[84:87]
    v_mfma_f32_16x16x32_bf16 a[132:135], v[232:235], v[148:151], a[132:135]
    v_mfma_f32_16x16x32_bf16 a[180:183], v[236:239], v[148:151], a[180:183]
    v_mfma_f32_16x16x32_bf16 a[40:43], v[224:227], v[152:155], a[40:43]
    v_mfma_f32_16x16x32_bf16 a[88:91], v[228:231], v[152:155], a[88:91]
    v_mfma_f32_16x16x32_bf16 a[136:139], v[232:235], v[152:155], a[136:139]
    v_mfma_f32_16x16x32_bf16 a[184:187], v[236:239], v[152:155], a[184:187]
    v_mfma_f32_16x16x32_bf16 a[44:47], v[224:227], v[156:159], a[44:47]
    v_mfma_f32_16x16x32_bf16 a[92:95], v[228:231], v[156:159], a[92:95]
    v_mfma_f32_16x16x32_bf16 a[140:143], v[232:235], v[156:159], a[140:143]
    v_mfma_f32_16x16x32_bf16 a[188:191], v[236:239], v[156:159], a[188:191]
    s_add_u32 s48, s48, 24576
    s_cmp_lt_u32 s48, 1572864
    s_nop 7
    s_cbranch_scc1 L_slowloop
    s_nop 1
    v_mfma_f32_16x16x4_f32 v[48:51], v5, v57, 0
    v_mfma_f32_16x16x4_f32 v[52:55], v6, v57, 0
    s_nop 7
    s_nop 1
    v_rcp_f32 v48, v48
    v_rcp_f32 v49, v49
    v_rcp_f32 v50, v50
    v_rcp_f32 v51, v51
    v_rcp_f32 v52, v52
    v_rcp_f32 v53, v53
    v_rcp_f32 v54, v54
    v_rcp_f32 v55, v55
    v_mfma_f32_16x16x4_f32 v[128:131], v7, v57, 0
    v_mfma_f32_16x16x4_f32 v[132:135], v8, v57, 0
    s_nop 7
    s_nop 1
    v_rcp_f32 v128, v128
    v_rcp_f32 v129, v129
    v_rcp_f32 v130, v130
    v_rcp_f32 v131, v131
    v_rcp_f32 v132, v132
    v_rcp_f32 v133, v133
    v_rcp_f32 v134, v134
    v_rcp_f32 v135, v135
    s_nop 0
    v_accvgpr_read_b32 v64, a0
    v_accvgpr_read_b32 v65, a4
    v_accvgpr_read_b32 v66, a8
    v_accvgpr_read_b32 v67, a12
    v_accvgpr_read_b32 v68, a16
    v_accvgpr_read_b32 v69, a20
    v_pk_mul_f32 v[64:65], v[64:65], v[48:49] op_sel_hi:[1,0]
    v_pk_mul_f32 v[66:67], v[66:67], v[48:49] op_sel_hi:[1,0]
    v_pk_mul_f32 v[68:69], v[68:69], v[48:49] op_sel_hi:[1,0]
    v_cvt_pk_bf16_f32 v64, v64, v65
    v_cvt_pk_bf16_f32 v65, v66, v67
    v_cvt_pk_bf16_f32 v66, v68, v69
    v_accvgpr_read_b32 v70, a1
    v_accvgpr_read_b32 v71, a5
    v_accvgpr_read_b32 v72, a9
    v_accvgpr_read_b32 v73, a13
    v_accvgpr_read_b32 v74, a17
    v_accvgpr_read_b32 v75, a21
    v_pk_mul_f32 v[70:71], v[70:71], v[48:49] op_sel:[0,1] op_sel_hi:[1,1]
    v_pk_mul_f32 v[72:73], v[72:73], v[48:49] op_sel:[0,1] op_sel_hi:[1,1]
    v_pk_mul_f32 v[74:75], v[74:75], v[48:49] op_sel:[0,1] op_sel_hi:[1,1]
    v_cvt_pk_bf16_f32 v70, v70, v71
    v_cvt_pk_bf16_f32 v71, v72, v73
    v_cvt_pk_bf16_f32 v72, v74, v75
    buffer_store_dwordx3 v[64:66], v56, s[12:15], s24 offen offset:0 sc0 sc1
    v_accvgpr_read_b32 v76, a2
    v_accvgpr_read_b32 v77, a6
    v_accvgpr_read_b32 v78, a10
    v_accvgpr_read_b32 v79, a14
    v_accvgpr_read_b32 v80, a18
    v_accvgpr_read_b32 v81, a22
    v_pk_mul_f32 v[76:77], v[76:77], v[50:51] op_sel_hi:[1,0]
    v_pk_mul_f32 v[78:79], v[78:79], v[50:51] op_sel_hi:[1,0]
    v_pk_mul_f32 v[80:81], v[80:81], v[50:51] op_sel_hi:[1,0]
    v_cvt_pk_bf16_f32 v76, v76, v77
    v_cvt_pk_bf16_f32 v77, v78, v79
    v_cvt_pk_bf16_f32 v78, v80, v81
    buffer_store_dwordx3 v[70:72], v56, s[12:15], s24 offen offset:384 sc0 sc1
    v_accvgpr_read_b32 v82, a3
    v_accvgpr_read_b32 v83, a7
    v_accvgpr_read_b32 v84, a11
    v_accvgpr_read_b32 v85, a15
    v_accvgpr_read_b32 v86, a19
    v_accvgpr_read_b32 v87, a23
    v_pk_mul_f32 v[82:83], v[82:83], v[50:51] op_sel:[0,1] op_sel_hi:[1,1]
    v_pk_mul_f32 v[84:85], v[84:85], v[50:51] op_sel:[0,1] op_sel_hi:[1,1]
    v_pk_mul_f32 v[86:87], v[86:87], v[50:51] op_sel:[0,1] op_sel_hi:[1,1]
    v_cvt_pk_bf16_f32 v82, v82, v83
    v_cvt_pk_bf16_f32 v83, v84, v85
    v_cvt_pk_bf16_f32 v84, v86, v87
    buffer_store_dwordx3 v[76:78], v56, s[12:15], s24 offen offset:768 sc0 sc1
    v_accvgpr_read_b32 v88, a24
    v_accvgpr_read_b32 v89, a28
    v_accvgpr_read_b32 v90, a32
    v_accvgpr_read_b32 v91, a36
    v_accvgpr_read_b32 v92, a40
    v_accvgpr_read_b32 v93, a44
    v_pk_mul_f32 v[88:89], v[88:89], v[48:49] op_sel_hi:[1,0]
    v_pk_mul_f32 v[90:91], v[90:91], v[48:49] op_sel_hi:[1,0]
    v_pk_mul_f32 v[92:93], v[92:93], v[48:49] op_sel_hi:[1,0]
    v_cvt_pk_bf16_f32 v88, v88, v89
    v_cvt_pk_bf16_f32 v89, v90, v91
    v_cvt_pk_bf16_f32 v90, v92, v93
    buffer_store_dwordx3 v[82:84], v56, s[12:15], s24 offen offset:1152 sc0 sc1
    v_accvgpr_read_b32 v94, a25
    v_accvgpr_read_b32 v95, a29
    v_accvgpr_read_b32 v96, a33
    v_accvgpr_read_b32 v97, a37
    v_accvgpr_read_b32 v98, a41
    v_accvgpr_read_b32 v99, a45
    v_pk_mul_f32 v[94:95], v[94:95], v[48:49] op_sel:[0,1] op_sel_hi:[1,1]
    v_pk_mul_f32 v[96:97], v[96:97], v[48:49] op_sel:[0,1] op_sel_hi:[1,1]
    v_pk_mul_f32 v[98:99], v[98:99], v[48:49] op_sel:[0,1] op_sel_hi:[1,1]
    v_cvt_pk_bf16_f32 v94, v94, v95
    v_cvt_pk_bf16_f32 v95, v96, v97
    v_cvt_pk_bf16_f32 v96, v98, v99
    buffer_store_dwordx3 v[88:90], v56, s[12:15], s24 offen offset:192 sc0 sc1
    v_accvgpr_read_b32 v100, a26
    v_accvgpr_read_b32 v101, a30
    v_accvgpr_read_b32 v102, a34
    v_accvgpr_read_b32 v103, a38
    v_accvgpr_read_b32 v104, a42
    v_accvgpr_read_b32 v105, a46
    v_pk_mul_f32 v[100:101], v[100:101], v[50:51] op_sel_hi:[1,0]
    v_pk_mul_f32 v[102:103], v[102:103], v[50:51] op_sel_hi:[1,0]
    v_pk_mul_f32 v[104:105], v[104:105], v[50:51] op_sel_hi:[1,0]
    v_cvt_pk_bf16_f32 v100, v100, v101
    v_cvt_pk_bf16_f32 v101, v102, v103
    v_cvt_pk_bf16_f32 v102, v104, v105
    buffer_store_dwordx3 v[94:96], v56, s[12:15], s24 offen offset:576 sc0 sc1
    v_accvgpr_read_b32 v106, a27
    v_accvgpr_read_b32 v107, a31
    v_accvgpr_read_b32 v108, a35
    v_accvgpr_read_b32 v109, a39
    v_accvgpr_read_b32 v110, a43
    v_accvgpr_read_b32 v111, a47
    v_pk_mul_f32 v[106:107], v[106:107], v[50:51] op_sel:[0,1] op_sel_hi:[1,1]
    v_pk_mul_f32 v[108:109], v[108:109], v[50:51] op_sel:[0,1] op_sel_hi:[1,1]
    v_pk_mul_f32 v[110:111], v[110:111], v[50:51] op_sel:[0,1] op_sel_hi:[1,1]
    v_cvt_pk_bf16_f32 v106, v106, v107
    v_cvt_pk_bf16_f32 v107, v108, v109
    v_cvt_pk_bf16_f32 v108, v110, v111
    buffer_store_dwordx3 v[100:102], v56, s[12:15], s24 offen offset:960 sc0 sc1
    v_accvgpr_read_b32 v64, a48
    v_accvgpr_read_b32 v65, a52
    v_accvgpr_read_b32 v66, a56
    v_accvgpr_read_b32 v67, a60
    v_accvgpr_read_b32 v68, a64
    v_accvgpr_read_b32 v69, a68
    v_pk_mul_f32 v[64:65], v[64:65], v[52:53] op_sel_hi:[1,0]
    v_pk_mul_f32 v[66:67], v[66:67], v[52:53] op_sel_hi:[1,0]
    v_pk_mul_f32 v[68:69], v[68:69], v[52:53] op_sel_hi:[1,0]
    v_cvt_pk_bf16_f32 v64, v64, v65
    v_cvt_pk_bf16_f32 v65, v66, v67
    v_cvt_pk_bf16_f32 v66, v68, v69
    buffer_store_dwordx3 v[106:108], v56, s[12:15], s24 offen offset:1344 sc0 sc1
    v_accvgpr_read_b32 v70, a49
    v_accvgpr_read_b32 v71, a53
    v_accvgpr_read_b32 v72, a57
    v_accvgpr_read_b32 v73, a61
    v_accvgpr_read_b32 v74, a65
    v_accvgpr_read_b32 v75, a69
    v_pk_mul_f32 v[70:71], v[70:71], v[52:53] op_sel:[0,1] op_sel_hi:[1,1]
    v_pk_mul_f32 v[72:73], v[72:73], v[52:53] op_sel:[0,1] op_sel_hi:[1,1]
    v_pk_mul_f32 v[74:75], v[74:75], v[52:53] op_sel:[0,1] op_sel_hi:[1,1]
    v_cvt_pk_bf16_f32 v70, v70, v71
    v_cvt_pk_bf16_f32 v71, v72, v73
    v_cvt_pk_bf16_f32 v72, v74, v75
    buffer_store_dwordx3 v[64:66], v56, s[12:15], s40 offen offset:0 sc0 sc1
    v_accvgpr_read_b32 v76, a50
    v_accvgpr_read_b32 v77, a54
    v_accvgpr_read_b32 v78, a58
    v_accvgpr_read_b32 v79, a62
    v_accvgpr_read_b32 v80, a66
    v_accvgpr_read_b32 v81, a70
    v_pk_mul_f32 v[76:77], v[76:77], v[54:55] op_sel_hi:[1,0]
    v_pk_mul_f32 v[78:79], v[78:79], v[54:55] op_sel_hi:[1,0]
    v_pk_mul_f32 v[80:81], v[80:81], v[54:55] op_sel_hi:[1,0]
    v_cvt_pk_bf16_f32 v76, v76, v77
    v_cvt_pk_bf16_f32 v77, v78, v79
    v_cvt_pk_bf16_f32 v78, v80, v81
    buffer_store_dwordx3 v[70:72], v56, s[12:15], s40 offen offset:384 sc0 sc1
    v_accvgpr_read_b32 v82, a51
    v_accvgpr_read_b32 v83, a55
    v_accvgpr_read_b32 v84, a59
    v_accvgpr_read_b32 v85, a63
    v_accvgpr_read_b32 v86, a67
    v_accvgpr_read_b32 v87, a71
    v_pk_mul_f32 v[82:83], v[82:83], v[54:55] op_sel:[0,1] op_sel_hi:[1,1]
    v_pk_mul_f32 v[84:85], v[84:85], v[54:55] op_sel:[0,1] op_sel_hi:[1,1]
    v_pk_mul_f32 v[86:87], v[86:87], v[54:55] op_sel:[0,1] op_sel_hi:[1,1]
    v_cvt_pk_bf16_f32 v82, v82, v83
    v_cvt_pk_bf16_f32 v83, v84, v85
    v_cvt_pk_bf16_f32 v84, v86, v87
    buffer_store_dwordx3 v[76:78], v56, s[12:15], s40 offen offset:768 sc0 sc1
    v_accvgpr_read_b32 v88, a72
    v_accvgpr_read_b32 v89, a76
    v_accvgpr_read_b32 v90, a80
    v_accvgpr_read_b32 v91, a84
    v_accvgpr_read_b32 v92, a88
    v_accvgpr_read_b32 v93, a92
    v_pk_mul_f32 v[88:89], v[88:89], v[52:53] op_sel_hi:[1,0]
    v_pk_mul_f32 v[90:91], v[90:91], v[52:53] op_sel_hi:[1,0]
    v_pk_mul_f32 v[92:93], v[92:93], v[52:53] op_sel_hi:[1,0]
    v_cvt_pk_bf16_f32 v88, v88, v89
    v_cvt_pk_bf16_f32 v89, v90, v91
    v_cvt_pk_bf16_f32 v90, v92, v93
    buffer_store_dwordx3 v[82:84], v56, s[12:15], s40 offen offset:1152 sc0 sc1
    v_accvgpr_read_b32 v94, a73
    v_accvgpr_read_b32 v95, a77
    v_accvgpr_read_b32 v96, a81
    v_accvgpr_read_b32 v97, a85
    v_accvgpr_read_b32 v98, a89
    v_accvgpr_read_b32 v99, a93
    v_pk_mul_f32 v[94:95], v[94:95], v[52:53] op_sel:[0,1] op_sel_hi:[1,1]
    v_pk_mul_f32 v[96:97], v[96:97], v[52:53] op_sel:[0,1] op_sel_hi:[1,1]
    v_pk_mul_f32 v[98:99], v[98:99], v[52:53] op_sel:[0,1] op_sel_hi:[1,1]
    v_cvt_pk_bf16_f32 v94, v94, v95
    v_cvt_pk_bf16_f32 v95, v96, v97
    v_cvt_pk_bf16_f32 v96, v98, v99
    buffer_store_dwordx3 v[88:90], v56, s[12:15], s40 offen offset:192 sc0 sc1
    v_accvgpr_read_b32 v100, a74
    v_accvgpr_read_b32 v101, a78
    v_accvgpr_read_b32 v102, a82
    v_accvgpr_read_b32 v103, a86
    v_accvgpr_read_b32 v104, a90
    v_accvgpr_read_b32 v105, a94
    v_pk_mul_f32 v[100:101], v[100:101], v[54:55] op_sel_hi:[1,0]
    v_pk_mul_f32 v[102:103], v[102:103], v[54:55] op_sel_hi:[1,0]
    v_pk_mul_f32 v[104:105], v[104:105], v[54:55] op_sel_hi:[1,0]
    v_cvt_pk_bf16_f32 v100, v100, v101
    v_cvt_pk_bf16_f32 v101, v102, v103
    v_cvt_pk_bf16_f32 v102, v104, v105
    buffer_store_dwordx3 v[94:96], v56, s[12:15], s40 offen offset:576 sc0 sc1
    v_accvgpr_read_b32 v106, a75
    v_accvgpr_read_b32 v107, a79
    v_accvgpr_read_b32 v108, a83
    v_accvgpr_read_b32 v109, a87
    v_accvgpr_read_b32 v110, a91
    v_accvgpr_read_b32 v111, a95
    v_pk_mul_f32 v[106:107], v[106:107], v[54:55] op_sel:[0,1] op_sel_hi:[1,1]
    v_pk_mul_f32 v[108:109], v[108:109], v[54:55] op_sel:[0,1] op_sel_hi:[1,1]
    v_pk_mul_f32 v[110:111], v[110:111], v[54:55] op_sel:[0,1] op_sel_hi:[1,1]
    v_cvt_pk_bf16_f32 v106, v106, v107
    v_cvt_pk_bf16_f32 v107, v108, v109
    v_cvt_pk_bf16_f32 v108, v110, v111
    buffer_store_dwordx3 v[100:102], v56, s[12:15], s40 offen offset:960 sc0 sc1
    v_accvgpr_read_b32 v64, a96
    v_accvgpr_read_b32 v65, a100
    v_accvgpr_read_b32 v66, a104
    v_accvgpr_read_b32 v67, a108
    v_accvgpr_read_b32 v68, a112
    v_accvgpr_read_b32 v69, a116
    v_pk_mul_f32 v[64:65], v[64:65], v[128:129] op_sel_hi:[1,0]
    v_pk_mul_f32 v[66:67], v[66:67], v[128:129] op_sel_hi:[1,0]
    v_pk_mul_f32 v[68:69], v[68:69], v[128:129] op_sel_hi:[1,0]
    v_cvt_pk_bf16_f32 v64, v64, v65
    v_cvt_pk_bf16_f32 v65, v66, v67
    v_cvt_pk_bf16_f32 v66, v68, v69
    buffer_store_dwordx3 v[106:108], v56, s[12:15], s40 offen offset:1344 sc0 sc1
    v_accvgpr_read_b32 v70, a97
    v_accvgpr_read_b32 v71, a101
    v_accvgpr_read_b32 v72, a105
    v_accvgpr_read_b32 v73, a109
    v_accvgpr_read_b32 v74, a113
    v_accvgpr_read_b32 v75, a117
    v_pk_mul_f32 v[70:71], v[70:71], v[128:129] op_sel:[0,1] op_sel_hi:[1,1]
    v_pk_mul_f32 v[72:73], v[72:73], v[128:129] op_sel:[0,1] op_sel_hi:[1,1]
    v_pk_mul_f32 v[74:75], v[74:75], v[128:129] op_sel:[0,1] op_sel_hi:[1,1]
    v_cvt_pk_bf16_f32 v70, v70, v71
    v_cvt_pk_bf16_f32 v71, v72, v73
    v_cvt_pk_bf16_f32 v72, v74, v75
    buffer_store_dwordx3 v[64:66], v56, s[12:15], s41 offen offset:0 sc0 sc1
    v_accvgpr_read_b32 v76, a98
    v_accvgpr_read_b32 v77, a102
    v_accvgpr_read_b32 v78, a106
    v_accvgpr_read_b32 v79, a110
    v_accvgpr_read_b32 v80, a114
    v_accvgpr_read_b32 v81, a118
    v_pk_mul_f32 v[76:77], v[76:77], v[130:131] op_sel_hi:[1,0]
    v_pk_mul_f32 v[78:79], v[78:79], v[130:131] op_sel_hi:[1,0]
    v_pk_mul_f32 v[80:81], v[80:81], v[130:131] op_sel_hi:[1,0]
    v_cvt_pk_bf16_f32 v76, v76, v77
    v_cvt_pk_bf16_f32 v77, v78, v79
    v_cvt_pk_bf16_f32 v78, v80, v81
    buffer_store_dwordx3 v[70:72], v56, s[12:15], s41 offen offset:384 sc0 sc1
    v_accvgpr_read_b32 v82, a99
    v_accvgpr_read_b32 v83, a103
    v_accvgpr_read_b32 v84, a107
    v_accvgpr_read_b32 v85, a111
    v_accvgpr_read_b32 v86, a115
    v_accvgpr_read_b32 v87, a119
    v_pk_mul_f32 v[82:83], v[82:83], v[130:131] op_sel:[0,1] op_sel_hi:[1,1]
    v_pk_mul_f32 v[84:85], v[84:85], v[130:131] op_sel:[0,1] op_sel_hi:[1,1]
    v_pk_mul_f32 v[86:87], v[86:87], v[130:131] op_sel:[0,1] op_sel_hi:[1,1]
    v_cvt_pk_bf16_f32 v82, v82, v83
    v_cvt_pk_bf16_f32 v83, v84, v85
    v_cvt_pk_bf16_f32 v84, v86, v87
    buffer_store_dwordx3 v[76:78], v56, s[12:15], s41 offen offset:768 sc0 sc1
    v_accvgpr_read_b32 v88, a120
    v_accvgpr_read_b32 v89, a124
    v_accvgpr_read_b32 v90, a128
    v_accvgpr_read_b32 v91, a132
    v_accvgpr_read_b32 v92, a136
    v_accvgpr_read_b32 v93, a140
    v_pk_mul_f32 v[88:89], v[88:89], v[128:129] op_sel_hi:[1,0]
    v_pk_mul_f32 v[90:91], v[90:91], v[128:129] op_sel_hi:[1,0]
    v_pk_mul_f32 v[92:93], v[92:93], v[128:129] op_sel_hi:[1,0]
    v_cvt_pk_bf16_f32 v88, v88, v89
    v_cvt_pk_bf16_f32 v89, v90, v91
    v_cvt_pk_bf16_f32 v90, v92, v93
    buffer_store_dwordx3 v[82:84], v56, s[12:15], s41 offen offset:1152 sc0 sc1
    v_accvgpr_read_b32 v94, a121
    v_accvgpr_read_b32 v95, a125
    v_accvgpr_read_b32 v96, a129
    v_accvgpr_read_b32 v97, a133
    v_accvgpr_read_b32 v98, a137
    v_accvgpr_read_b32 v99, a141
    v_pk_mul_f32 v[94:95], v[94:95], v[128:129] op_sel:[0,1] op_sel_hi:[1,1]
    v_pk_mul_f32 v[96:97], v[96:97], v[128:129] op_sel:[0,1] op_sel_hi:[1,1]
    v_pk_mul_f32 v[98:99], v[98:99], v[128:129] op_sel:[0,1] op_sel_hi:[1,1]
    v_cvt_pk_bf16_f32 v94, v94, v95
    v_cvt_pk_bf16_f32 v95, v96, v97
    v_cvt_pk_bf16_f32 v96, v98, v99
    buffer_store_dwordx3 v[88:90], v56, s[12:15], s41 offen offset:192 sc0 sc1
    v_accvgpr_read_b32 v100, a122
    v_accvgpr_read_b32 v101, a126
    v_accvgpr_read_b32 v102, a130
    v_accvgpr_read_b32 v103, a134
    v_accvgpr_read_b32 v104, a138
    v_accvgpr_read_b32 v105, a142
    v_pk_mul_f32 v[100:101], v[100:101], v[130:131] op_sel_hi:[1,0]
    v_pk_mul_f32 v[102:103], v[102:103], v[130:131] op_sel_hi:[1,0]
    v_pk_mul_f32 v[104:105], v[104:105], v[130:131] op_sel_hi:[1,0]
    v_cvt_pk_bf16_f32 v100, v100, v101
    v_cvt_pk_bf16_f32 v101, v102, v103
    v_cvt_pk_bf16_f32 v102, v104, v105
    buffer_store_dwordx3 v[94:96], v56, s[12:15], s41 offen offset:576 sc0 sc1
    v_accvgpr_read_b32 v106, a123
    v_accvgpr_read_b32 v107, a127
    v_accvgpr_read_b32 v108, a131
    v_accvgpr_read_b32 v109, a135
    v_accvgpr_read_b32 v110, a139
    v_accvgpr_read_b32 v111, a143
    v_pk_mul_f32 v[106:107], v[106:107], v[130:131] op_sel:[0,1] op_sel_hi:[1,1]
    v_pk_mul_f32 v[108:109], v[108:109], v[130:131] op_sel:[0,1] op_sel_hi:[1,1]
    v_pk_mul_f32 v[110:111], v[110:111], v[130:131] op_sel:[0,1] op_sel_hi:[1,1]
    v_cvt_pk_bf16_f32 v106, v106, v107
    v_cvt_pk_bf16_f32 v107, v108, v109
    v_cvt_pk_bf16_f32 v108, v110, v111
    buffer_store_dwordx3 v[100:102], v56, s[12:15], s41 offen offset:960 sc0 sc1
    v_accvgpr_read_b32 v64, a144
    v_accvgpr_read_b32 v65, a148
    v_accvgpr_read_b32 v66, a152
    v_accvgpr_read_b32 v67, a156
    v_accvgpr_read_b32 v68, a160
    v_accvgpr_read_b32 v69, a164
    v_pk_mul_f32 v[64:65], v[64:65], v[132:133] op_sel_hi:[1,0]
    v_pk_mul_f32 v[66:67], v[66:67], v[132:133] op_sel_hi:[1,0]
    v_pk_mul_f32 v[68:69], v[68:69], v[132:133] op_sel_hi:[1,0]
    v_cvt_pk_bf16_f32 v64, v64, v65
    v_cvt_pk_bf16_f32 v65, v66, v67
    v_cvt_pk_bf16_f32 v66, v68, v69
    buffer_store_dwordx3 v[106:108], v56, s[12:15], s41 offen offset:1344 sc0 sc1
    v_accvgpr_read_b32 v70, a145
    v_accvgpr_read_b32 v71, a149
    v_accvgpr_read_b32 v72, a153
    v_accvgpr_read_b32 v73, a157
    v_accvgpr_read_b32 v74, a161
    v_accvgpr_read_b32 v75, a165
    v_pk_mul_f32 v[70:71], v[70:71], v[132:133] op_sel:[0,1] op_sel_hi:[1,1]
    v_pk_mul_f32 v[72:73], v[72:73], v[132:133] op_sel:[0,1] op_sel_hi:[1,1]
    v_pk_mul_f32 v[74:75], v[74:75], v[132:133] op_sel:[0,1] op_sel_hi:[1,1]
    v_cvt_pk_bf16_f32 v70, v70, v71
    v_cvt_pk_bf16_f32 v71, v72, v73
    v_cvt_pk_bf16_f32 v72, v74, v75
    buffer_store_dwordx3 v[64:66], v56, s[12:15], s42 offen offset:0 sc0 sc1
    v_accvgpr_read_b32 v76, a146
    v_accvgpr_read_b32 v77, a150
    v_accvgpr_read_b32 v78, a154
    v_accvgpr_read_b32 v79, a158
    v_accvgpr_read_b32 v80, a162
    v_accvgpr_read_b32 v81, a166
    v_pk_mul_f32 v[76:77], v[76:77], v[134:135] op_sel_hi:[1,0]
    v_pk_mul_f32 v[78:79], v[78:79], v[134:135] op_sel_hi:[1,0]
    v_pk_mul_f32 v[80:81], v[80:81], v[134:135] op_sel_hi:[1,0]
    v_cvt_pk_bf16_f32 v76, v76, v77
    v_cvt_pk_bf16_f32 v77, v78, v79
    v_cvt_pk_bf16_f32 v78, v80, v81
    buffer_store_dwordx3 v[70:72], v56, s[12:15], s42 offen offset:384 sc0 sc1
    v_accvgpr_read_b32 v82, a147
    v_accvgpr_read_b32 v83, a151
    v_accvgpr_read_b32 v84, a155
    v_accvgpr_read_b32 v85, a159
    v_accvgpr_read_b32 v86, a163
    v_accvgpr_read_b32 v87, a167
    v_pk_mul_f32 v[82:83], v[82:83], v[134:135] op_sel:[0,1] op_sel_hi:[1,1]
    v_pk_mul_f32 v[84:85], v[84:85], v[134:135] op_sel:[0,1] op_sel_hi:[1,1]
    v_pk_mul_f32 v[86:87], v[86:87], v[134:135] op_sel:[0,1] op_sel_hi:[1,1]
    v_cvt_pk_bf16_f32 v82, v82, v83
    v_cvt_pk_bf16_f32 v83, v84, v85
    v_cvt_pk_bf16_f32 v84, v86, v87
    buffer_store_dwordx3 v[76:78], v56, s[12:15], s42 offen offset:768 sc0 sc1
    v_accvgpr_read_b32 v88, a168
    v_accvgpr_read_b32 v89, a172
    v_accvgpr_read_b32 v90, a176
    v_accvgpr_read_b32 v91, a180
    v_accvgpr_read_b32 v92, a184
    v_accvgpr_read_b32 v93, a188
    v_pk_mul_f32 v[88:89], v[88:89], v[132:133] op_sel_hi:[1,0]
    v_pk_mul_f32 v[90:91], v[90:91], v[132:133] op_sel_hi:[1,0]
    v_pk_mul_f32 v[92:93], v[92:93], v[132:133] op_sel_hi:[1,0]
    v_cvt_pk_bf16_f32 v88, v88, v89
    v_cvt_pk_bf16_f32 v89, v90, v91
    v_cvt_pk_bf16_f32 v90, v92, v93
    buffer_store_dwordx3 v[82:84], v56, s[12:15], s42 offen offset:1152 sc0 sc1
    v_accvgpr_read_b32 v94, a169
    v_accvgpr_read_b32 v95, a173
    v_accvgpr_read_b32 v96, a177
    v_accvgpr_read_b32 v97, a181
    v_accvgpr_read_b32 v98, a185
    v_accvgpr_read_b32 v99, a189
    v_pk_mul_f32 v[94:95], v[94:95], v[132:133] op_sel:[0,1] op_sel_hi:[1,1]
    v_pk_mul_f32 v[96:97], v[96:97], v[132:133] op_sel:[0,1] op_sel_hi:[1,1]
    v_pk_mul_f32 v[98:99], v[98:99], v[132:133] op_sel:[0,1] op_sel_hi:[1,1]
    v_cvt_pk_bf16_f32 v94, v94, v95
    v_cvt_pk_bf16_f32 v95, v96, v97
    v_cvt_pk_bf16_f32 v96, v98, v99
    buffer_store_dwordx3 v[88:90], v56, s[12:15], s42 offen offset:192 sc0 sc1
    v_accvgpr_read_b32 v100, a170
    v_accvgpr_read_b32 v101, a174
    v_accvgpr_read_b32 v102, a178
    v_accvgpr_read_b32 v103, a182
    v_accvgpr_read_b32 v104, a186
    v_accvgpr_read_b32 v105, a190
    v_pk_mul_f32 v[100:101], v[100:101], v[134:135] op_sel_hi:[1,0]
    v_pk_mul_f32 v[102:103], v[102:103], v[134:135] op_sel_hi:[1,0]
    v_pk_mul_f32 v[104:105], v[104:105], v[134:135] op_sel_hi:[1,0]
    v_cvt_pk_bf16_f32 v100, v100, v101
    v_cvt_pk_bf16_f32 v101, v102, v103
    v_cvt_pk_bf16_f32 v102, v104, v105
    buffer_store_dwordx3 v[94:96], v56, s[12:15], s42 offen offset:576 sc0 sc1
    v_accvgpr_read_b32 v106, a171
    v_accvgpr_read_b32 v107, a175
    v_accvgpr_read_b32 v108, a179
    v_accvgpr_read_b32 v109, a183
    v_accvgpr_read_b32 v110, a187
    v_accvgpr_read_b32 v111, a191
    v_pk_mul_f32 v[106:107], v[106:107], v[134:135] op_sel:[0,1] op_sel_hi:[1,1]
    v_pk_mul_f32 v[108:109], v[108:109], v[134:135] op_sel:[0,1] op_sel_hi:[1,1]
    v_pk_mul_f32 v[110:111], v[110:111], v[134:135] op_sel:[0,1] op_sel_hi:[1,1]
    v_cvt_pk_bf16_f32 v106, v106, v107
    v_cvt_pk_bf16_f32 v107, v108, v109
    v_cvt_pk_bf16_f32 v108, v110, v111
    buffer_store_dwordx3 v[100:102], v56, s[12:15], s42 offen offset:960 sc0 sc1
    buffer_store_dwordx3 v[106:108], v56, s[12:15], s42 offen offset:1344 sc0 sc1
    s_branch L_fin
.section .rodata,"a"
.p2align 6
.amdhsa_kernel standalone__kv_cache_quant_int4_int2_kv_with_per_channel_or_per_token_scales__prompt_kernel
  .amdhsa_next_free_vgpr 512
  .amdhsa_next_free_sgpr 102
  .amdhsa_accum_offset 256
  .amdhsa_group_segment_fixed_size 0
  .amdhsa_kernarg_size 80
  .amdhsa_user_sgpr_count 2
  .amdhsa_user_sgpr_kernarg_segment_ptr 1
  .amdhsa_system_sgpr_workgroup_id_x 1
.end_amdhsa_kernel
```

```asm
; @launch grid=(256,1,1) block=(256,1,1) lds=147584
.amdgcn_target "amdgcn-amd-amdhsa--gfx950"
.text
.globl standalone__kv_cache_quant_int4_int2_kv_with_per_channel_or_per_token_scales__prompt_kernel
.p2align 8
.type standalone__kv_cache_quant_int4_int2_kv_with_per_channel_or_per_token_scales__prompt_kernel,@function
standalone__kv_cache_quant_int4_int2_kv_with_per_channel_or_per_token_scales__prompt_kernel:
    s_cmp_ge_u32 s2, 256
    s_cbranch_scc1 L_done
    s_load_dwordx16 s[40:55], s[0:1], 0
    s_load_dwordx4 s[16:19], s[0:1], 64
    s_and_b32 s94, s2, 7
    s_lshr_b32 s95, s2, 3
    s_lshr_b32 s24, s95, 3
    s_lshl_b32 s94, s94, 2
    s_add_u32 s94, s94, s24
    s_and_b32 s95, s95, 7
    s_getpc_b64 s[60:61]
L_pc:
    s_sub_u32 s60, s60, L_pc-standalone__kv_cache_quant_int4_int2_kv_with_per_channel_or_per_token_scales__prompt_kernel
    s_subb_u32 s61, s61, 0
    s_mov_b32 s62, L_slow-standalone__kv_cache_quant_int4_int2_kv_with_per_channel_or_per_token_scales__prompt_kernel
    s_mov_b32 s63, 0x20000
    s_lshr_b32 s22, s2, 3
    s_lshl_b32 s22, s22, 12
    v_lshlrev_b32 v30, 4, v0
    buffer_load_dwordx4 v[128:131], v30, s[60:63], s22 offen
    v_lshrrev_b32 v24, 6, v0
    v_and_b32 v25, 63, v0
    v_readfirstlane_b32 s25, v24
    v_lshlrev_b32 v1, 4, v25
    v_mul_u32_u24 v26, 43, v25
    v_lshrrev_b32 v26, 10, v26
    v_mul_u32_u24 v27, 24, v26
    v_sub_u32 v27, v25, v27
    v_lshrrev_b32 v28, 1, v24
    v_and_b32 v29, 1, v24
    v_lshlrev_b32 v30, 4, v29
    v_lshl_add_u32 v30, v28, 2, v30
    v_add_u32 v30, v30, v26
    v_mul_u32_u24 v30, 768, v30
    v_lshrrev_b32 v48, 1, v26
    v_lshlrev_b32 v48, 30, v48
    v_lshl_add_u32 v30, v27, 4, v30
    v_or_b32 v9, v30, v48
    v_lshl_or_b32 v10, v27, 3, v48
    v_mul_u32_u24 v30, 6144, v24
    v_mul_u32_u24 v31, 12, v25
    v_add_u32 v12, v30, v31
    s_mov_b32 s66, 1572864
    s_mov_b32 s67, 0x20000
    s_mov_b32 s70, 1572864
    s_mov_b32 s71, 0x20000
    s_mov_b32 s74, 12288
    s_mov_b32 s75, 0x20000
    s_mov_b32 s78, 12288
    s_mov_b32 s79, 0x20000
    s_mov_b32 s82, 4096
    s_mov_b32 s83, 0x20000
    s_mov_b32 s86, 4096
    s_mov_b32 s87, 0x20000
    s_mov_b32 s22, 64
    s_mov_b32 s23, 0x20000
    s_mul_i32 s33, s95, 24576
    s_add_u32 s34, s33, 6144
    s_mov_b32 s35, s33
    s_lshr_b32 s36, s95, 1
    s_mul_i32 s36, s36, 384
    s_lshl_b32 s37, s95, 6
    s_lshl_b32 s24, s25, 4
    s_add_u32 s37, s37, s24
    s_mul_i32 s24, s94, 1572864
    s_mul_i32 s56, s94, 12288
    s_lshl_b32 s57, s94, 12
    s_lshl_b32 s58, s94, 10
    s_add_u32 s58, s58, 51380320
    s_or_b32 s39, s95, s25
    s_waitcnt lgkmcnt(0)
    s_add_u32 s64, s42, s24
    s_addc_u32 s65, s43, 0
    s_add_u32 s72, s46, s56
    s_addc_u32 s73, s47, 0
    s_add_u32 s76, s48, s56
    s_addc_u32 s77, s49, 0
    buffer_load_dwordx4 v[224:227], v9, s[64:67], s33 offen offset:0 nt
    buffer_load_dwordx4 v[228:231], v9, s[64:67], s33 offen offset:1536 nt
    buffer_load_dwordx4 v[232:235], v9, s[64:67], s34 offen offset:0 nt
    buffer_load_dwordx4 v[236:239], v9, s[64:67], s34 offen offset:1536 nt
    buffer_load_dwordx2 v[32:33], v10, s[72:75], s36 offen offset:0
    buffer_load_dwordx2 v[34:35], v10, s[76:79], s36 offen offset:0
    buffer_load_dwordx2 v[36:37], v10, s[72:75], s36 offen offset:192
    buffer_load_dwordx2 v[38:39], v10, s[76:79], s36 offen offset:192
    s_add_u32 s20, s18, s58
    s_addc_u32 s21, s19, 0
    s_add_u32 s80, s50, s57
    s_addc_u32 s81, s51, 0
    s_add_u32 s84, s52, s57
    s_addc_u32 s85, s53, 0
    s_add_u32 s68, s44, s24
    s_addc_u32 s69, s45, 0
    s_mul_i32 s59, s94, 786432
    s_add_u32 s12, s54, s59
    s_addc_u32 s13, s55, 0
    s_add_u32 s8, s40, s59
    s_addc_u32 s9, s41, 0
    s_cmp_lg_u32 s39, 0
    s_cbranch_scc1 L_notleader0
    s_buffer_load_dwordx16 s[40:55], s[20:23], 0 glc
L_notleader0:
    buffer_load_dwordx4 v[240:243], v9, s[64:67], s33 offen offset:384 nt
    buffer_load_dwordx4 v[244:247], v9, s[64:67], s33 offen offset:1920 nt
    buffer_load_dwordx4 v[248:251], v9, s[64:67], s34 offen offset:384 nt
    buffer_load_dwordx4 v[252:255], v9, s[64:67], s34 offen offset:1920 nt
    s_add_u32 s4, s18, s24
    s_addc_u32 s5, s19, 0
    s_mov_b32 s6, 1572864
    s_mov_b32 s7, 0x20000
    s_mov_b32 s10, 786432
    s_mov_b32 s11, 0x20000
    s_mov_b32 s88, s16
    s_mov_b32 s89, s17
    s_add_u32 s16, s33, 3072
    s_add_u32 s17, s33, 6144
    s_mov_b32 s90, 256
    s_mov_b32 s91, 0x20000
    s_lshl_b32 s93, s94, 3
    s_cmp_lg_u32 s39, 0
    s_cbranch_scc1 L_notleader
    s_waitcnt lgkmcnt(0)
    s_mov_b32 s59, 1
    s_lshr_b32 s40, s40, 10
    s_min_u32 s40, s40, 31
    s_bitset1_b32 s59, s40
    s_lshr_b32 s41, s41, 10
    s_min_u32 s41, s41, 31
    s_bitset1_b32 s59, s41
    s_lshr_b32 s42, s42, 10
    s_min_u32 s42, s42, 31
    s_bitset1_b32 s59, s42
    s_lshr_b32 s43, s43, 10
    s_min_u32 s43, s43, 31
    s_bitset1_b32 s59, s43
    s_lshr_b32 s44, s44, 10
    s_min_u32 s44, s44, 31
    s_bitset1_b32 s59, s44
    s_lshr_b32 s45, s45, 10
    s_min_u32 s45, s45, 31
    s_bitset1_b32 s59, s45
    s_lshr_b32 s46, s46, 10
    s_min_u32 s46, s46, 31
    s_bitset1_b32 s59, s46
    s_lshr_b32 s47, s47, 10
    s_min_u32 s47, s47, 31
    s_bitset1_b32 s59, s47
    s_lshr_b32 s48, s48, 10
    s_min_u32 s48, s48, 31
    s_bitset1_b32 s59, s48
    s_lshr_b32 s49, s49, 10
    s_min_u32 s49, s49, 31
    s_bitset1_b32 s59, s49
    s_lshr_b32 s50, s50, 10
    s_min_u32 s50, s50, 31
    s_bitset1_b32 s59, s50
    s_lshr_b32 s51, s51, 10
    s_min_u32 s51, s51, 31
    s_bitset1_b32 s59, s51
    s_lshr_b32 s52, s52, 10
    s_min_u32 s52, s52, 31
    s_bitset1_b32 s59, s52
    s_lshr_b32 s53, s53, 10
    s_min_u32 s53, s53, 31
    s_bitset1_b32 s59, s53
    s_lshr_b32 s54, s54, 10
    s_min_u32 s54, s54, 31
    s_bitset1_b32 s59, s54
    s_lshr_b32 s55, s55, 10
    s_min_u32 s55, s55, 31
    s_bitset1_b32 s59, s55
    s_ff0_i32_b32 s59, s59
    s_lshl_b32 s59, s59, 10
    v_mov_b32 v52, s59
    s_mov_b64 exec, 1
    buffer_store_dword v52, off, s[88:91], s93 sc1
    s_mov_b64 exec, -1
L_notleader:
    s_lshl_b32 s24, s95, 2
    s_add_u32 s24, s24, 32
    s_buffer_load_dword s46, s[20:23], s24 glc
    s_getreg_b32 s45, hwreg(HW_REG_XCC_ID, 0, 4)
    s_lshl_b32 s45, s45, 5
    s_mov_b32 s44, 32
    buffer_load_dwordx3 v[112:114], v12, s[68:71], s35 offen offset:0 nt
    buffer_load_dwordx3 v[116:118], v12, s[68:71], s35 offen offset:768 nt
    buffer_load_dwordx3 v[120:122], v12, s[68:71], s35 offen offset:1536 nt
    buffer_load_dwordx3 v[124:126], v12, s[68:71], s35 offen offset:2304 nt
    buffer_load_dwordx2 v[40:41], off, s[80:83], s37 offset:0
    buffer_load_dwordx2 v[42:43], off, s[84:87], s37 offset:0
    buffer_load_dwordx2 v[44:45], off, s[80:83], s37 offset:8
    buffer_load_dwordx2 v[46:47], off, s[84:87], s37 offset:8
    s_mov_b32 s14, 786432
    s_mov_b32 s15, 0x20000
    s_lshl_b32 s24, s25, 8
    s_add_u32 s93, s93, s24
    v_mul_u32_u24 v30, 3072, v24
    v_add_u32 v4, v30, v1
    v_lshl_add_u32 v30, v24, 3, v26
    v_mul_u32_u24 v30, 384, v30
    v_lshlrev_b32 v31, 2, v29
    v_xor_b32 v31, v27, v31
    v_lshl_add_u32 v30, v31, 4, v30
    v_or_b32 v11, v30, v48
    v_lshlrev_b32 v30, 8, v24
    v_add_u32 v30, 12288, v30
    v_lshrrev_b32 v31, 5, v25
    v_mul_u32_u24 v31, 6144, v31
    v_add_u32 v30, v30, v31
    v_and_b32 v31, 1, v25
    v_mul_u32_u24 v31, 3072, v31
    v_add_u32 v30, v30, v31
    v_bfe_u32 v31, v25, 1, 4
    v_lshl_add_u32 v15, v31, 4, v30
    s_lshl_b32 s24, s95, 2
    v_lshl_add_u32 v13, v0, 2, s24
    v_cmp_lt_u32 vcc, 0, v0
    v_mov_b32 v30, 0x40000000
    s_nop 0
    v_cndmask_b32 v13, v13, v30, vcc
    s_mul_i32 s26, s25, 3072
    s_add_u32 s26, s26, 12288
    s_add_u32 s56, s26, 24576
    s_add_u32 s24, s95, 1
    s_and_b32 s24, s24, 7
    s_mul_i32 s32, s24, 24576
    s_add_u32 s27, s32, 12288
    s_mov_b32 s28, 98304
    s_mov_b32 s30, 73728
    v_add_u32 v1, 24576, v1
    s_mov_b32 s38, 0x3dd53b95
    s_mov_b32 s97, 0xffff0000
    s_mov_b32 s96, 100000
    v_and_b32 v26, 15, v25
    v_lshrrev_b32 v27, 4, v25
    v_bfe_u32 v28, v25, 1, 3
    v_xor_b32 v29, v27, v28
    v_mul_u32_u24 v30, 384, v26
    v_lshl_add_u32 v2, v29, 4, v30
    v_xor_b32 v3, 64, v2
    s_mul_i32 s40, s25, 6144
    s_add_u32 s40, s40, 73728
    v_lshrrev_b32 v29, 1, v27
    v_xor_b32 v29, v29, v28
    v_lshl_add_u32 v31, v29, 4, v30
    v_and_b32 v29, 1, v27
    v_lshl_add_u32 v31, v29, 3, v31
    v_xor_b32 v22, 0, v31
    v_add_u32 v22, s40, v22
    v_xor_b32 v23, 32, v31
    v_add_u32 v23, s40, v23
    v_xor_b32 v142, 64, v31
    v_add_u32 v142, s40, v142
    v_xor_b32 v143, 96, v31
    v_add_u32 v143, s40, v143
    s_lshl_b32 s24, s95, 2
    s_add_u32 s24, s24, s25
    s_mul_i32 s24, s24, 24576
    v_add_u32 v26, 0, v25
    v_mul_u32_u24 v27, 2731, v26
    v_lshrrev_b32 v27, 17, v27
    v_and_b32 v27, 7, v27
    v_xor_b32 v26, v26, v27
    v_lshlrev_b32 v136, 4, v26
    v_add_u32 v136, s24, v136
    v_add_u32 v26, 64, v25
    v_mul_u32_u24 v27, 2731, v26
    v_lshrrev_b32 v27, 17, v27
    v_and_b32 v27, 7, v27
    v_xor_b32 v26, v26, v27
    v_lshlrev_b32 v137, 4, v26
    v_add_u32 v137, s24, v137
    v_add_u32 v26, 128, v25
    v_mul_u32_u24 v27, 2731, v26
    v_lshrrev_b32 v27, 17, v27
    v_and_b32 v27, 7, v27
    v_xor_b32 v26, v26, v27
    v_lshlrev_b32 v138, 4, v26
    v_add_u32 v138, s24, v138
    v_add_u32 v26, 192, v25
    v_mul_u32_u24 v27, 2731, v26
    v_lshrrev_b32 v27, 17, v27
    v_and_b32 v27, 7, v27
    v_xor_b32 v26, v26, v27
    v_lshlrev_b32 v139, 4, v26
    v_add_u32 v139, s24, v139
    v_add_u32 v26, 256, v25
    v_mul_u32_u24 v27, 2731, v26
    v_lshrrev_b32 v27, 17, v27
    v_and_b32 v27, 7, v27
    v_xor_b32 v26, v26, v27
    v_lshlrev_b32 v140, 4, v26
    v_add_u32 v140, s24, v140
    v_add_u32 v26, 320, v25
    v_mul_u32_u24 v27, 2731, v26
    v_lshrrev_b32 v27, 17, v27
    v_and_b32 v27, 7, v27
    v_xor_b32 v26, v26, v27
    v_lshlrev_b32 v141, 4, v26
    v_add_u32 v141, s24, v141
    v_mov_b32 v5, 0
    v_mov_b32 v6, 0
    v_mov_b32 v7, 0
    v_mov_b32 v8, 0
    s_mov_b32 s62, -1
    s_mov_b32 s63, 0xffff
    s_waitcnt vmcnt(12)
    buffer_load_dwordx3 v[80:82], v12, s[68:71], s16 offen offset:0 nt
    buffer_load_dwordx3 v[84:86], v12, s[68:71], s16 offen offset:768 nt
    buffer_load_dwordx3 v[88:90], v12, s[68:71], s16 offen offset:1536 nt
    buffer_load_dwordx3 v[92:94], v12, s[68:71], s16 offen offset:2304 nt
    v_lshlrev_b32 v48, 16, v32
    v_and_b32 v49, s97, v32
    v_lshlrev_b32 v50, 16, v34
    v_and_b32 v51, s97, v34
    v_mul_f32 v48, s38, v48
    v_mul_f32 v49, s38, v49
    v_mul_f32_e64 v50, -v50, v48
    v_mul_f32_e64 v51, -v51, v49
    v_cvt_f32_i32 v224, v224
    v_cvt_f32_i32 v225, v225
    v_fma_f32 v224, v224, v48, v50
    v_fma_f32 v225, v225, v49, v51
    v_cvt_pk_bf16_f32 v224, v224, v225
    v_cvt_f32_i32 v228, v228
    v_cvt_f32_i32 v229, v229
    v_fma_f32 v228, v228, v48, v50
    v_fma_f32 v229, v229, v49, v51
    v_cvt_pk_bf16_f32 v228, v228, v229
    v_cvt_f32_i32 v232, v232
    v_cvt_f32_i32 v233, v233
    v_fma_f32 v232, v232, v48, v50
    v_fma_f32 v233, v233, v49, v51
    v_cvt_pk_bf16_f32 v232, v232, v233
    v_cvt_f32_i32 v236, v236
    v_cvt_f32_i32 v237, v237
    v_fma_f32 v236, v236, v48, v50
    v_fma_f32 v237, v237, v49, v51
    v_cvt_pk_bf16_f32 v236, v236, v237
    v_lshlrev_b32 v48, 16, v33
    v_and_b32 v49, s97, v33
    v_lshlrev_b32 v50, 16, v35
    v_and_b32 v51, s97, v35
    v_mul_f32 v48, s38, v48
    v_mul_f32 v49, s38, v49
    v_mul_f32_e64 v50, -v50, v48
    v_mul_f32_e64 v51, -v51, v49
    v_cvt_f32_i32 v226, v226
    v_cvt_f32_i32 v227, v227
    v_fma_f32 v226, v226, v48, v50
    v_fma_f32 v227, v227, v49, v51
    v_cvt_pk_bf16_f32 v225, v226, v227
    v_cvt_f32_i32 v230, v230
    v_cvt_f32_i32 v231, v231
    v_fma_f32 v230, v230, v48, v50
    v_fma_f32 v231, v231, v49, v51
    v_cvt_pk_bf16_f32 v229, v230, v231
    v_cvt_f32_i32 v234, v234
    v_cvt_f32_i32 v235, v235
    v_fma_f32 v234, v234, v48, v50
    v_fma_f32 v235, v235, v49, v51
    v_cvt_pk_bf16_f32 v233, v234, v235
    v_cvt_f32_i32 v238, v238
    v_cvt_f32_i32 v239, v239
    v_fma_f32 v238, v238, v48, v50
    v_fma_f32 v239, v239, v49, v51
    v_cvt_pk_bf16_f32 v237, v238, v239
    s_waitcnt vmcnt(12)
    v_lshlrev_b32 v48, 16, v36
    v_and_b32 v49, s97, v36
    v_lshlrev_b32 v50, 16, v38
    v_and_b32 v51, s97, v38
    v_mul_f32 v48, s38, v48
    v_mul_f32 v49, s38, v49
    v_mul_f32_e64 v50, -v50, v48
    v_mul_f32_e64 v51, -v51, v49
    v_cvt_f32_i32 v240, v240
    v_cvt_f32_i32 v241, v241
    v_fma_f32 v240, v240, v48, v50
    v_fma_f32 v241, v241, v49, v51
    v_cvt_pk_bf16_f32 v226, v240, v241
    v_cvt_f32_i32 v244, v244
    v_cvt_f32_i32 v245, v245
    v_fma_f32 v244, v244, v48, v50
    v_fma_f32 v245, v245, v49, v51
    v_cvt_pk_bf16_f32 v230, v244, v245
    v_cvt_f32_i32 v248, v248
    v_cvt_f32_i32 v249, v249
    v_fma_f32 v248, v248, v48, v50
    v_fma_f32 v249, v249, v49, v51
    v_cvt_pk_bf16_f32 v234, v248, v249
    v_cvt_f32_i32 v252, v252
    v_cvt_f32_i32 v253, v253
    v_fma_f32 v252, v252, v48, v50
    v_fma_f32 v253, v253, v49, v51
    v_cvt_pk_bf16_f32 v238, v252, v253
    v_lshlrev_b32 v48, 16, v37
    v_and_b32 v49, s97, v37
    v_lshlrev_b32 v50, 16, v39
    v_and_b32 v51, s97, v39
    v_mul_f32 v48, s38, v48
    v_mul_f32 v49, s38, v49
    v_mul_f32_e64 v50, -v50, v48
    v_mul_f32_e64 v51, -v51, v49
    v_cvt_f32_i32 v242, v242
    v_cvt_f32_i32 v243, v243
    v_fma_f32 v242, v242, v48, v50
    v_fma_f32 v243, v243, v49, v51
    v_cvt_pk_bf16_f32 v227, v242, v243
    v_cvt_f32_i32 v246, v246
    v_cvt_f32_i32 v247, v247
    v_fma_f32 v246, v246, v48, v50
    v_fma_f32 v247, v247, v49, v51
    v_cvt_pk_bf16_f32 v231, v246, v247
    v_cvt_f32_i32 v250, v250
    v_cvt_f32_i32 v251, v251
    v_fma_f32 v250, v250, v48, v50
    v_fma_f32 v251, v251, v49, v51
    v_cvt_pk_bf16_f32 v235, v250, v251
    v_cvt_f32_i32 v254, v254
    v_cvt_f32_i32 v255, v255
    v_fma_f32 v254, v254, v48, v50
    v_fma_f32 v255, v255, v49, v51
    v_cvt_pk_bf16_f32 v239, v254, v255
    buffer_store_dwordx4 v[224:227], v11, s[4:7], s33 offen offset:0
    s_mov_b64 exec, s[62:63]
    ds_write_b128 v11, v[224:227] offset:0
    s_mov_b64 exec, -1
    v_xor_b32 v55, 16, v11
    buffer_store_dwordx4 v[228:231], v55, s[4:7], s33 offen offset:768
    s_mov_b64 exec, s[62:63]
    ds_write_b128 v55, v[228:231] offset:768
    s_mov_b64 exec, -1
    v_xor_b32 v54, 32, v11
    buffer_store_dwordx4 v[232:235], v54, s[4:7], s33 offen offset:1536
    s_mov_b64 exec, s[62:63]
    ds_write_b128 v54, v[232:235] offset:1536
    s_mov_b64 exec, -1
    v_xor_b32 v55, 48, v11
    buffer_store_dwordx4 v[236:239], v55, s[4:7], s33 offen offset:2304
    s_mov_b64 exec, s[62:63]
    ds_write_b128 v55, v[236:239] offset:2304
    s_mov_b64 exec, -1
    s_mov_b32 s41, 0
    s_add_u32 m0, s40, 24576
    s_nop 0
    buffer_load_dwordx4 v136, s[8:11], s41 offen nt lds
    s_add_u32 m0, s40, 25600
    s_nop 0
    buffer_load_dwordx4 v137, s[8:11], s41 offen nt lds
    s_add_u32 m0, s40, 26624
    s_nop 0
    buffer_load_dwordx4 v138, s[8:11], s41 offen nt lds
    s_add_u32 m0, s40, 27648
    s_nop 0
    buffer_load_dwordx4 v139, s[8:11], s41 offen nt lds
    s_add_u32 m0, s40, 28672
    s_nop 0
    buffer_load_dwordx4 v140, s[8:11], s41 offen nt lds
    s_add_u32 m0, s40, 29696
    s_waitcnt vmcnt(20)
    buffer_load_dwordx4 v141, s[8:11], s41 offen nt lds
    s_waitcnt vmcnt(14)
    v_lshlrev_b32 v48, 16, v40
    v_and_b32 v49, s97, v40
    v_lshlrev_b32 v50, 16, v42
    v_and_b32 v51, s97, v42
    v_mul_f32_e64 v50, -v50, v48
    v_mul_f32_e64 v51, -v51, v49
    v_cvt_f32_i32 v112, v112
    v_cvt_f32_i32 v116, v116
    v_fma_f32 v112, v112, v48, v50
    v_fma_f32 v116, v116, v49, v51
    v_cvt_f32_i32 v113, v113
    v_cvt_f32_i32 v117, v117
    v_fma_f32 v113, v113, v48, v50
    v_fma_f32 v117, v117, v49, v51
    v_cvt_f32_i32 v114, v114
    v_cvt_f32_i32 v118, v118
    v_fma_f32 v114, v114, v48, v50
    v_fma_f32 v118, v118, v49, v51
    v_lshlrev_b32 v48, 16, v41
    v_and_b32 v49, s97, v41
    v_lshlrev_b32 v50, 16, v43
    v_and_b32 v51, s97, v43
    v_mul_f32_e64 v50, -v50, v48
    v_mul_f32_e64 v51, -v51, v49
    v_cvt_f32_i32 v120, v120
    v_cvt_f32_i32 v124, v124
    v_fma_f32 v120, v120, v48, v50
    v_fma_f32 v124, v124, v49, v51
    v_cvt_f32_i32 v121, v121
    v_cvt_f32_i32 v125, v125
    v_fma_f32 v121, v121, v48, v50
    v_fma_f32 v125, v125, v49, v51
    v_cvt_f32_i32 v122, v122
    v_cvt_f32_i32 v126, v126
    v_fma_f32 v122, v122, v48, v50
    v_fma_f32 v126, v126, v49, v51
    v_cvt_pk_bf16_f32 v112, v112, v116
    v_cvt_pk_bf16_f32 v116, v113, v117
    v_cvt_pk_bf16_f32 v113, v120, v124
    v_cvt_pk_bf16_f32 v117, v121, v125
    v_cvt_pk_bf16_f32 v120, v114, v118
    v_cvt_pk_bf16_f32 v121, v122, v126
    s_waitcnt vmcnt(10)
    v_lshlrev_b32 v48, 16, v44
    v_and_b32 v49, s97, v44
    v_lshlrev_b32 v50, 16, v46
    v_and_b32 v51, s97, v46
    v_mul_f32_e64 v50, -v50, v48
    v_mul_f32_e64 v51, -v51, v49
    v_cvt_f32_i32 v80, v80
    v_cvt_f32_i32 v84, v84
    v_fma_f32 v80, v80, v48, v50
    v_fma_f32 v84, v84, v49, v51
    v_cvt_f32_i32 v81, v81
    v_cvt_f32_i32 v85, v85
    v_fma_f32 v81, v81, v48, v50
    v_fma_f32 v85, v85, v49, v51
    v_cvt_f32_i32 v82, v82
    v_cvt_f32_i32 v86, v86
    v_fma_f32 v82, v82, v48, v50
    v_fma_f32 v86, v86, v49, v51
    v_lshlrev_b32 v48, 16, v45
    v_and_b32 v49, s97, v45
    v_lshlrev_b32 v50, 16, v47
    v_and_b32 v51, s97, v47
    v_mul_f32_e64 v50, -v50, v48
    v_mul_f32_e64 v51, -v51, v49
    v_cvt_f32_i32 v88, v88
    v_cvt_f32_i32 v92, v92
    v_fma_f32 v88, v88, v48, v50
    v_fma_f32 v92, v92, v49, v51
    v_cvt_f32_i32 v89, v89
    v_cvt_f32_i32 v93, v93
    v_fma_f32 v89, v89, v48, v50
    v_fma_f32 v93, v93, v49, v51
    v_cvt_f32_i32 v90, v90
    v_cvt_f32_i32 v94, v94
    v_fma_f32 v90, v90, v48, v50
    v_fma_f32 v94, v94, v49, v51
    v_cvt_pk_bf16_f32 v114, v80, v84
    v_cvt_pk_bf16_f32 v118, v81, v85
    v_cvt_pk_bf16_f32 v115, v88, v92
    v_cvt_pk_bf16_f32 v119, v89, v93
    v_cvt_pk_bf16_f32 v122, v82, v86
    v_cvt_pk_bf16_f32 v123, v90, v94
    buffer_store_dwordx4 v[112:115], v15, s[4:7], s35 offen offset:0
    buffer_store_dwordx4 v[116:119], v15, s[4:7], s35 offen offset:1024
    buffer_store_dwordx4 v[120:123], v15, s[4:7], s35 offen offset:2048
    ds_write_b128 v15, v[112:115] offset:12288
    ds_write_b128 v15, v[116:119] offset:13312
    ds_write_b128 v15, v[120:123] offset:14336
    buffer_load_dword v0, off, s[88:91], s93 sc1
    s_mov_b32 s41, 6144
    s_add_u32 m0, s40, 0
    s_nop 0
    buffer_load_dwordx4 v136, s[8:11], s41 offen nt lds
    s_add_u32 m0, s40, 1024
    s_nop 0
    buffer_load_dwordx4 v137, s[8:11], s41 offen nt lds
    s_add_u32 m0, s40, 2048
    s_nop 0
    buffer_load_dwordx4 v138, s[8:11], s41 offen nt lds
    s_add_u32 m0, s40, 3072
    s_nop 0
    buffer_load_dwordx4 v139, s[8:11], s41 offen nt lds
    s_add_u32 m0, s40, 4096
    s_nop 0
    buffer_load_dwordx4 v140, s[8:11], s41 offen nt lds
    s_add_u32 m0, s40, 5120
    s_waitcnt vmcnt(14)
    buffer_load_dwordx4 v141, s[8:11], s41 offen nt lds
    s_mov_b32 s41, 12288
    s_add_u32 m0, s40, 49152
    s_waitcnt vmcnt(14)
    buffer_load_dwordx4 v136, s[8:11], s41 offen nt lds
    s_add_u32 m0, s40, 50176
    s_waitcnt vmcnt(14)
    buffer_load_dwordx4 v137, s[8:11], s41 offen nt lds
    s_add_u32 m0, s40, 51200
    s_waitcnt vmcnt(14)
    buffer_load_dwordx4 v138, s[8:11], s41 offen nt lds
    s_add_u32 m0, s40, 52224
    s_waitcnt vmcnt(14)
    buffer_load_dwordx4 v139, s[8:11], s41 offen nt lds
    s_add_u32 m0, s40, 53248
    s_waitcnt vmcnt(14)
    buffer_load_dwordx4 v140, s[8:11], s41 offen nt lds
    s_add_u32 m0, s40, 54272
    s_waitcnt vmcnt(11)
    buffer_load_dwordx4 v141, s[8:11], s41 offen nt lds
    s_mov_b64 exec, 0
    s_cmp_eq_u32 s25, 0
    s_cbranch_scc1 L_iw0
    s_cmp_eq_u32 s25, 1
    s_cbranch_scc1 L_iw1
    s_cmp_eq_u32 s25, 2
    s_cbranch_scc1 L_iw2
    s_branch L_iw3
L_iwret:
    s_mov_b64 exec, -1
    s_waitcnt vmcnt(12)
    s_cmp_lg_u32 s25, 0
    s_cbranch_scc1 L_tagdone
    v_readfirstlane_b32 s42, v0
    s_mov_b32 s39, 100
    s_waitcnt lgkmcnt(0)
    s_and_b32 s46, s46, 0xfffffc00
L_tagretry:
    s_cmp_eq_u32 s42, s46
    s_cselect_b32 s42, 0, s42
    s_cmp_lg_u32 s42, 0
    s_cbranch_scc1 L_tagok
    s_sub_u32 s39, s39, 1
    s_cbranch_scc1 L_tagslow
    s_sleep 4
    s_buffer_load_dword s42, s[88:91], s93 glc
    s_waitcnt lgkmcnt(0)
    s_branch L_tagretry
L_tagok:
    s_add_u32 s42, s42, s45
    v_mov_b32 v0, s42
    v_mov_b32 v16, 147456
    ds_write_b32 v16, v0
L_tagdone:
    s_waitcnt lgkmcnt(0)
    s_barrier
    v_add_u32 v0, 1, v0
    buffer_store_dword v0, v13, s[20:23], 0 offen offset:32 sc1
    v_mov_b32 v16, 147456
    ds_read_b32 v17, v16
    ds_read_b128 v[144:147], v2 offset:0
    ds_read_b128 v[148:151], v3 offset:0
    ds_read_b128 v[152:155], v2 offset:6144
    ds_read_b128 v[156:159], v3 offset:6144
    ds_read_b128 v[160:163], v2 offset:128
    ds_read_b128 v[164:167], v3 offset:128
    ds_read_b128 v[168:171], v2 offset:6272
    ds_read_b128 v[172:175], v3 offset:6272
    ds_read_b128 v[176:179], v2 offset:256
    ds_read_b128 v[180:183], v3 offset:256
    ds_read_b128 v[184:187], v2 offset:6400
    ds_read_b128 v[188:191], v3 offset:6400
    s_waitcnt vmcnt(17)
    ds_read_b64 a[192:193], v22 offset:24576
    ds_read_b64 a[194:195], v142 offset:24704
    ds_read_b64 a[196:197], v23 offset:24576
    ds_read_b64 a[198:199], v143 offset:24704
    ds_read_b64 a[200:201], v142 offset:24576
    ds_read_b64 a[202:203], v22 offset:24832
    ds_read_b64 a[204:205], v143 offset:24576
    ds_read_b64 a[206:207], v23 offset:24832
    ds_read_b64 a[208:209], v22 offset:24704
    ds_read_b64 a[210:211], v142 offset:24832
    ds_read_b64 a[212:213], v23 offset:24704
    ds_read_b64 a[214:215], v143 offset:24832
    s_waitcnt lgkmcnt(15)
    v_readfirstlane_b32 s92, v17
    s_add_u32 s92, s92, 1
    s_waitcnt lgkmcnt(0)
    s_mov_b32 s41, 18432
    s_add_u32 m0, s40, 24576
    s_waitcnt vmcnt(12)
    buffer_load_dwordx4 v136, s[8:11], s41 offen nt lds
    s_add_u32 m0, s40, 25600
    s_waitcnt vmcnt(12)
    buffer_load_dwordx4 v137, s[8:11], s41 offen nt lds
    s_add_u32 m0, s40, 26624
    s_waitcnt vmcnt(12)
    buffer_load_dwordx4 v138, s[8:11], s41 offen nt lds
    v_mfma_f32_16x16x32_bf16 v[64:67], v[144:147], a[192:195], 0
    v_mfma_f32_16x16x32_bf16 v[64:67], v[148:151], a[196:199], v[64:67]
    v_mfma_f32_16x16x32_bf16 v[64:67], v[160:163], a[200:203], v[64:67]
    v_mfma_f32_16x16x32_bf16 v[64:67], v[164:167], a[204:207], v[64:67]
    v_mfma_f32_16x16x32_bf16 v[64:67], v[176:179], a[208:211], v[64:67]
    v_mfma_f32_16x16x32_bf16 v[64:67], v[180:183], a[212:215], v[64:67]
    v_mfma_f32_16x16x32_bf16 v[96:99], v[152:155], a[192:195], 0
    v_mfma_f32_16x16x32_bf16 v[96:99], v[156:159], a[196:199], v[96:99]
    v_mfma_f32_16x16x32_bf16 v[96:99], v[168:171], a[200:203], v[96:99]
    v_mfma_f32_16x16x32_bf16 v[96:99], v[172:175], a[204:207], v[96:99]
    v_mfma_f32_16x16x32_bf16 v[96:99], v[184:187], a[208:211], v[96:99]
    v_mfma_f32_16x16x32_bf16 v[96:99], v[188:191], a[212:215], v[96:99]
    s_nop 7
    v_max3_f32 v48, v64, v65, v66
    v_max3_f32 v50, v67, v96, v97
    v_max3_f32 v48, v48, v98, v99
    v_max_f32 v48, v48, v50
    v_mov_b32 v49, v48
    s_nop 1
    v_permlane16_swap_b32 v48, v49
    s_nop 1
    v_max_f32 v48, v48, v49
    v_mov_b32 v49, v48
    s_nop 1
    v_permlane32_swap_b32 v48, v49
    s_nop 1
    v_max_f32 v48, v48, v49
    v_sub_f32 v64, v64, v48
    v_sub_f32 v65, v65, v48
    v_sub_f32 v66, v66, v48
    v_sub_f32 v67, v67, v48
    v_sub_f32 v96, v96, v48
    v_sub_f32 v97, v97, v48
    v_sub_f32 v98, v98, v48
    v_sub_f32 v99, v99, v48
    v_exp_f32 v64, v64
    v_exp_f32 v65, v65
    v_exp_f32 v66, v66
    v_exp_f32 v67, v67
    v_exp_f32 v96, v96
    v_exp_f32 v97, v97
    v_exp_f32 v98, v98
L_iw0:
L_pg0:
    s_cbranch_execz L_pg4
    v_exp_f32 v99, v99
    v_sub_f32 v128, 0, v48
    v_sub_f32 v129, 0, v48
    v_sub_f32 v130, 0, v48
    v_sub_f32 v131, 0, v48
    v_add_f32 v5, v5, v64
    v_add_f32 v5, v5, v65
    v_add_f32 v5, v5, v66
    v_add_f32 v5, v5, v67
    v_add_f32 v5, v5, v96
    v_add_f32 v5, v5, v97
    v_add_f32 v5, v5, v98
    v_add_f32 v5, v5, v99
    v_cvt_pk_bf16_f32 v64, v64, v65
    v_cvt_pk_bf16_f32 v65, v66, v67
    v_cvt_pk_bf16_f32 v66, v96, v97
    v_cvt_pk_bf16_f32 v67, v98, v99
    s_waitcnt vmcnt(10)
    ds_read_b64 a[216:217], v22 offset:0
    ds_read_b64 a[218:219], v142 offset:128
    ds_read_b64 a[220:221], v23 offset:0
    ds_read_b64 a[222:223], v143 offset:128
    ds_read_b64 a[224:225], v142 offset:0
    ds_read_b64 a[226:227], v22 offset:256
    ds_read_b64 a[228:229], v143 offset:0
    ds_read_b64 a[230:231], v23 offset:256
    ds_read_b64 a[232:233], v22 offset:128
    ds_read_b64 a[234:235], v142 offset:256
    ds_read_b64 a[236:237], v23 offset:128
    ds_read_b64 a[238:239], v143 offset:256
    s_waitcnt lgkmcnt(0)
    s_mov_b32 s41, 18432
    s_add_u32 m0, s40, 27648
    s_nop 0
    buffer_load_dwordx4 v139, s[8:11], s41 offen nt lds
    s_add_u32 m0, s40, 28672
    s_nop 0
    buffer_load_dwordx4 v140, s[8:11], s41 offen nt lds
    s_add_u32 m0, s40, 29696
    s_nop 0
    buffer_load_dwordx4 v141, s[8:11], s41 offen nt lds
    v_mfma_f32_16x16x32_bf16 v[68:71], v[144:147], a[216:219], 0
    v_mfma_f32_16x16x32_bf16 v[68:71], v[148:151], a[220:223], v[68:71]
    v_mfma_f32_16x16x32_bf16 v[68:71], v[160:163], a[224:227], v[68:71]
    v_mfma_f32_16x16x32_bf16 v[68:71], v[164:167], a[228:231], v[68:71]
    v_mfma_f32_16x16x32_bf16 v[68:71], v[176:179], a[232:235], v[68:71]
    v_mfma_f32_16x16x32_bf16 v[68:71], v[180:183], a[236:239], v[68:71]
    v_mfma_f32_16x16x32_bf16 v[100:103], v[152:155], a[216:219], 0
    v_mfma_f32_16x16x32_bf16 v[100:103], v[156:159], a[220:223], v[100:103]
    v_mfma_f32_16x16x32_bf16 v[100:103], v[168:171], a[224:227], v[100:103]
    v_mfma_f32_16x16x32_bf16 v[100:103], v[172:175], a[228:231], v[100:103]
    v_mfma_f32_16x16x32_bf16 v[100:103], v[184:187], a[232:235], v[100:103]
    v_mfma_f32_16x16x32_bf16 v[100:103], v[188:191], a[236:239], v[100:103]
    s_nop 7
    v_max3_f32 v48, v68, v69, v70
    v_max3_f32 v50, v71, v100, v101
    v_max3_f32 v48, v48, v102, v103
    v_max_f32 v48, v48, v50
    v_mov_b32 v49, v48
    s_nop 1
    v_permlane16_swap_b32 v48, v49
    s_nop 1
    v_max_f32 v48, v48, v49
    v_mov_b32 v49, v48
    s_nop 1
    v_permlane32_swap_b32 v48, v49
    s_nop 1
    v_max_f32 v48, v48, v49
    v_sub_f32 v68, v68, v48
    v_sub_f32 v69, v69, v48
    v_sub_f32 v70, v70, v48
    v_sub_f32 v71, v71, v48
    v_sub_f32 v100, v100, v48
    v_sub_f32 v101, v101, v48
    v_sub_f32 v102, v102, v48
    v_sub_f32 v103, v103, v48
    v_exp_f32 v68, v68
    v_exp_f32 v69, v69
    v_exp_f32 v70, v70
    v_exp_f32 v71, v71
    v_exp_f32 v100, v100
    v_exp_f32 v101, v101
    v_exp_f32 v102, v102
    v_exp_f32 v103, v103
    v_sub_f32 v132, 0, v48
    v_sub_f32 v133, 0, v48
    v_sub_f32 v134, 0, v48
    v_sub_f32 v135, 0, v48
    v_add_f32 v6, v6, v68
    v_add_f32 v6, v6, v69
    v_add_f32 v6, v6, v70
    v_add_f32 v6, v6, v71
    v_add_f32 v6, v6, v100
    v_add_f32 v6, v6, v101
    v_add_f32 v6, v6, v102
    v_add_f32 v6, v6, v103
    v_cvt_pk_bf16_f32 v68, v68, v69
    v_cvt_pk_bf16_f32 v69, v70, v71
    v_cvt_pk_bf16_f32 v70, v100, v101
    v_cvt_pk_bf16_f32 v71, v102, v103
    s_waitcnt vmcnt(7)
    ds_read_b64 a[240:241], v22 offset:49152
    ds_read_b64 a[242:243], v142 offset:49280
    ds_read_b64 a[244:245], v23 offset:49152
    ds_read_b64 a[246:247], v143 offset:49280
    ds_read_b64 a[248:249], v142 offset:49152
    ds_read_b64 a[250:251], v22 offset:49408
    ds_read_b64 a[252:253], v143 offset:49152
    ds_read_b64 a[254:255], v23 offset:49408
    ds_read_b64 v[192:193], v22 offset:49280
    ds_read_b64 v[194:195], v142 offset:49408
    ds_read_b64 v[196:197], v23 offset:49280
    ds_read_b64 v[198:199], v143 offset:49408
    s_buffer_load_dwordx8 s[48:55], s[20:23], s44 glc
    s_waitcnt lgkmcnt(0)
    v_mfma_f32_16x16x32_bf16 v[72:75], v[144:147], a[240:243], 0
    v_mfma_f32_16x16x32_bf16 v[72:75], v[148:151], a[244:247], v[72:75]
    v_mfma_f32_16x16x32_bf16 v[72:75], v[160:163], a[248:251], v[72:75]
    v_mfma_f32_16x16x32_bf16 v[72:75], v[164:167], a[252:255], v[72:75]
    v_mfma_f32_16x16x32_bf16 v[72:75], v[176:179], v[192:195], v[72:75]
    v_mfma_f32_16x16x32_bf16 v[72:75], v[180:183], v[196:199], v[72:75]
    v_mfma_f32_16x16x32_bf16 v[104:107], v[152:155], a[240:243], 0
    v_mfma_f32_16x16x32_bf16 v[104:107], v[156:159], a[244:247], v[104:107]
    v_mfma_f32_16x16x32_bf16 v[104:107], v[168:171], a[248:251], v[104:107]
    v_mfma_f32_16x16x32_bf16 v[104:107], v[172:175], a[252:255], v[104:107]
    v_mfma_f32_16x16x32_bf16 v[104:107], v[184:187], v[192:195], v[104:107]
    v_mfma_f32_16x16x32_bf16 v[104:107], v[188:191], v[196:199], v[104:107]
    s_waitcnt lgkmcnt(0)
    s_sub_u32 s48, s48, s92
    s_sub_u32 s49, s49, s92
    s_sub_u32 s50, s50, s92
    s_sub_u32 s51, s51, s92
    s_sub_u32 s52, s52, s92
    s_sub_u32 s53, s53, s92
    s_sub_u32 s54, s54, s92
    s_sub_u32 s55, s55, s92
    s_max_u32 s48, s48, s49
    s_max_u32 s48, s48, s50
    s_max_u32 s48, s48, s51
    s_max_u32 s48, s48, s52
    s_max_u32 s48, s48, s53
    s_max_u32 s48, s48, s54
    s_max_u32 s48, s48, s55
    s_cmp_ge_u32 s48, 16
    s_cbranch_scc1 L_pollslow0
L_pollok0:
    s_add_u32 s92, s92, 1
    s_mov_b32 m0, s26
    s_nop 0
    buffer_load_dwordx4 v4, s[4:7], s32 offen offset:0 sc1 lds
    buffer_load_dwordx4 v4, s[4:7], s32 offen offset:1024 sc1 lds
    buffer_load_dwordx4 v4, s[4:7], s32 offen offset:2048 sc1 lds
    s_add_u32 s32, s32, 24576
    s_sub_u32 s57, s32, 196608
    s_min_u32 s32, s32, s57
    s_add_u32 s26, s26, 36864
    s_sub_u32 s57, s26, 147456
    s_min_u32 s26, s26, s57
    s_mov_b32 m0, s26
    s_nop 0
    buffer_load_dwordx4 v4, s[4:7], s32 offen offset:0 sc1 lds
    buffer_load_dwordx4 v4, s[4:7], s32 offen offset:1024 sc1 lds
    buffer_load_dwordx4 v4, s[4:7], s32 offen offset:2048 sc1 lds
    s_add_u32 s32, s32, 24576
    s_sub_u32 s57, s32, 196608
    s_min_u32 s32, s32, s57
    s_add_u32 s26, s26, 12288
    s_mov_b32 m0, s26
    s_waitcnt vmcnt(11)
    buffer_load_dwordx4 v4, s[4:7], s32 offen offset:0 sc1 lds
    s_waitcnt vmcnt(11)
    buffer_load_dwordx4 v4, s[4:7], s32 offen offset:1024 sc1 lds
    s_waitcnt vmcnt(11)
    buffer_load_dwordx4 v4, s[4:7], s32 offen offset:2048 sc1 lds
    s_add_u32 s32, s32, 24576
    s_sub_u32 s57, s32, 196608
    s_min_u32 s32, s32, s57
    s_add_u32 s26, s26, 36864
    s_sub_u32 s57, s26, 147456
    s_min_u32 s26, s26, s57
    s_mov_b32 m0, s56
    s_waitcnt vmcnt(11)
    buffer_load_dwordx4 v4, s[4:7], s27 offen offset:0 sc1 lds
    s_waitcnt vmcnt(11)
    buffer_load_dwordx4 v4, s[4:7], s27 offen offset:1024 sc1 lds
    s_waitcnt vmcnt(11)
    buffer_load_dwordx4 v4, s[4:7], s27 offen offset:2048 sc1 lds
    s_add_u32 s27, s27, 24576
    s_sub_u32 s58, s27, 196608
    s_min_u32 s27, s27, s58
    s_add_u32 s56, s56, 36864
    s_sub_u32 s58, s56, 147456
    s_min_u32 s56, s56, s58
    s_add_u32 s33, s33, 196608
    s_add_u32 s34, s34, 196608
    s_add_u32 s36, s36, 1536
    s_add_u32 s35, s35, 196608
    s_add_u32 s16, s16, 196608
    s_add_u32 s17, s17, 196608
    s_add_u32 s37, s37, 512
    v_max3_f32 v48, v72, v73, v74
    v_max3_f32 v50, v75, v104, v105
    v_max3_f32 v48, v48, v106, v107
    v_max_f32 v48, v48, v50
    v_mov_b32 v49, v48
    s_nop 1
    v_permlane16_swap_b32 v48, v49
    s_nop 1
    v_max_f32 v48, v48, v49
    v_mov_b32 v49, v48
    s_nop 1
    v_permlane32_swap_b32 v48, v49
    s_nop 1
    v_max_f32 v48, v48, v49
    v_sub_f32 v72, v72, v48
    v_sub_f32 v73, v73, v48
    v_sub_f32 v74, v74, v48
    v_sub_f32 v75, v75, v48
    v_sub_f32 v104, v104, v48
    v_sub_f32 v105, v105, v48
    v_sub_f32 v106, v106, v48
    v_sub_f32 v107, v107, v48
    v_exp_f32 v72, v72
    v_exp_f32 v73, v73
    v_exp_f32 v74, v74
    v_exp_f32 v75, v75
    v_exp_f32 v104, v104
    v_exp_f32 v105, v105
    v_exp_f32 v106, v106
    v_exp_f32 v107, v107
    v_sub_f32 v136, 0, v48
    v_sub_f32 v137, 0, v48
    v_sub_f32 v138, 0, v48
    v_sub_f32 v139, 0, v48
    v_add_f32 v7, v7, v72
    v_add_f32 v7, v7, v73
    v_add_f32 v7, v7, v74
    v_add_f32 v7, v7, v75
    v_add_f32 v7, v7, v104
    v_add_f32 v7, v7, v105
    v_add_f32 v7, v7, v106
    v_add_f32 v7, v7, v107
    v_cvt_pk_bf16_f32 v72, v72, v73
    v_cvt_pk_bf16_f32 v73, v74, v75
    v_cvt_pk_bf16_f32 v74, v104, v105
    v_cvt_pk_bf16_f32 v75, v106, v107
    ds_read_b128 v[24:27], v1 offset:0
    ds_read_b128 v[28:31], v1 offset:1024
    ds_read_b128 v[32:35], v1 offset:2048
    ds_read_b128 v[36:39], v1 offset:3072
    s_waitcnt lgkmcnt(2)
    v_mfma_f32_16x16x32_bf16 a[0:3], v[64:67], v[24:27], 0
    ds_read_b128 v[40:43], v1 offset:4096
    v_mfma_f32_16x16x32_bf16 a[4:7], v[64:67], v[28:31], 0
    s_waitcnt vmcnt(11)
    buffer_load_dwordx2 v[56:57], v10, s[72:75], s36 offen offset:0
    v_mfma_f32_16x16x32_bf16 a[48:51], v[68:71], v[24:27], 0
    v_mfma_f32_16x16x32_bf16 a[52:55], v[68:71], v[28:31], 0
    ds_read_b128 v[44:47], v1 offset:5120
    v_mfma_f32_16x16x32_bf16 a[96:99], v[72:75], v[24:27], 0
    v_mfma_f32_16x16x32_bf16 a[100:103], v[72:75], v[28:31], 0
    s_waitcnt lgkmcnt(2)
    buffer_load_dwordx2 v[58:59], v10, s[76:79], s36 offen offset:0
    v_mfma_f32_16x16x32_bf16 a[8:11], v[64:67], v[32:35], 0
    ds_read_b128 v[24:27], v1 offset:6144
    v_mfma_f32_16x16x32_bf16 a[12:15], v[64:67], v[36:39], 0
    s_waitcnt vmcnt(12)
    buffer_load_dwordx4 v[224:227], v9, s[64:67], s33 offen offset:0 nt
    v_mfma_f32_16x16x32_bf16 a[56:59], v[68:71], v[32:35], 0
    v_mfma_f32_16x16x32_bf16 a[60:63], v[68:71], v[36:39], 0
    ds_read_b128 v[28:31], v1 offset:7168
    v_mfma_f32_16x16x32_bf16 a[104:107], v[72:75], v[32:35], 0
    v_mfma_f32_16x16x32_bf16 a[108:111], v[72:75], v[36:39], 0
    s_waitcnt lgkmcnt(2)
    s_waitcnt vmcnt(12)
    buffer_load_dwordx4 v[228:231], v9, s[64:67], s33 offen offset:1536 nt
    v_mfma_f32_16x16x32_bf16 a[16:19], v[64:67], v[40:43], 0
    ds_read_b128 v[32:35], v1 offset:8192
    v_mfma_f32_16x16x32_bf16 a[20:23], v[64:67], v[44:47], 0
    buffer_load_dwordx4 v[232:235], v9, s[64:67], s34 offen offset:0 nt
    v_mfma_f32_16x16x32_bf16 a[64:67], v[68:71], v[40:43], 0
    v_mfma_f32_16x16x32_bf16 a[68:71], v[68:71], v[44:47], 0
    ds_read_b128 v[36:39], v1 offset:9216
    v_mfma_f32_16x16x32_bf16 a[112:115], v[72:75], v[40:43], 0
    s_waitcnt vmcnt(13)
    buffer_load_dwordx4 v[236:239], v9, s[64:67], s34 offen offset:1536 nt
    v_mfma_f32_16x16x32_bf16 a[116:119], v[72:75], v[44:47], 0
    s_waitcnt lgkmcnt(2)
    v_mfma_f32_16x16x32_bf16 a[24:27], v[64:67], v[24:27], 0
    ds_read_b128 v[40:43], v1 offset:10240
    v_mfma_f32_16x16x32_bf16 a[28:31], v[64:67], v[28:31], 0
    s_waitcnt vmcnt(13)
    buffer_load_dwordx2 v[60:61], v10, s[72:75], s36 offen offset:192
    v_mfma_f32_16x16x32_bf16 a[72:75], v[68:71], v[24:27], 0
    v_mfma_f32_16x16x32_bf16 a[76:79], v[68:71], v[28:31], 0
    ds_read_b128 v[44:47], v1 offset:11264
    v_mfma_f32_16x16x32_bf16 a[120:123], v[72:75], v[24:27], 0
    v_mfma_f32_16x16x32_bf16 a[124:127], v[72:75], v[28:31], 0
    s_waitcnt lgkmcnt(2)
    buffer_load_dwordx2 v[62:63], v10, s[76:79], s36 offen offset:192
    v_mfma_f32_16x16x32_bf16 a[32:35], v[64:67], v[32:35], 0
    v_mfma_f32_16x16x32_bf16 a[36:39], v[64:67], v[36:39], 0
    s_waitcnt vmcnt(14)
    buffer_load_dwordx4 v[240:243], v9, s[64:67], s33 offen offset:384 nt
    v_mfma_f32_16x16x32_bf16 a[80:83], v[68:71], v[32:35], 0
    v_mfma_f32_16x16x32_bf16 a[84:87], v[68:71], v[36:39], 0
    buffer_load_dwordx4 v[244:247], v9, s[64:67], s33 offen offset:1920 nt
    v_mfma_f32_16x16x32_bf16 a[128:131], v[72:75], v[32:35], 0
    v_mfma_f32_16x16x32_bf16 a[132:135], v[72:75], v[36:39], 0
    s_waitcnt lgkmcnt(0)
    s_waitcnt vmcnt(15)
    buffer_load_dwordx4 v[248:251], v9, s[64:67], s34 offen offset:384 nt
    v_mfma_f32_16x16x32_bf16 a[40:43], v[64:67], v[40:43], 0
    v_mfma_f32_16x16x32_bf16 a[44:47], v[64:67], v[44:47], 0
    s_waitcnt vmcnt(15)
    buffer_load_dwordx4 v[252:255], v9, s[64:67], s34 offen offset:1920 nt
    v_mfma_f32_16x16x32_bf16 a[88:91], v[68:71], v[40:43], 0
    v_mfma_f32_16x16x32_bf16 a[92:95], v[68:71], v[44:47], 0
    v_mfma_f32_16x16x32_bf16 a[136:139], v[72:75], v[40:43], 0
    v_mfma_f32_16x16x32_bf16 a[140:143], v[72:75], v[44:47], 0
    s_waitcnt vmcnt(24)
    ds_read_b64 v[200:201], v22 offset:24576
    ds_read_b64 v[202:203], v142 offset:24704
    ds_read_b64 v[204:205], v23 offset:24576
    ds_read_b64 v[206:207], v143 offset:24704
    ds_read_b64 v[208:209], v142 offset:24576
    ds_read_b64 v[210:211], v22 offset:24832
    ds_read_b64 v[212:213], v143 offset:24576
    ds_read_b64 v[214:215], v23 offset:24832
    ds_read_b64 v[216:217], v22 offset:24704
    ds_read_b64 v[218:219], v142 offset:24832
    ds_read_b64 v[220:221], v23 offset:24704
    ds_read_b64 v[222:223], v143 offset:24832
    s_waitcnt lgkmcnt(0)
    v_mfma_f32_16x16x32_bf16 v[76:79], v[144:147], v[200:203], 0
    v_mfma_f32_16x16x32_bf16 v[76:79], v[148:151], v[204:207], v[76:79]
    v_mfma_f32_16x16x32_bf16 v[76:79], v[160:163], v[208:211], v[76:79]
    v_mfma_f32_16x16x32_bf16 v[76:79], v[164:167], v[212:215], v[76:79]
    v_mfma_f32_16x16x32_bf16 v[76:79], v[176:179], v[216:219], v[76:79]
    v_mfma_f32_16x16x32_bf16 v[76:79], v[180:183], v[220:223], v[76:79]
    v_mfma_f32_16x16x32_bf16 v[108:111], v[152:155], v[200:203], 0
    v_mfma_f32_16x16x32_bf16 v[108:111], v[156:159], v[204:207], v[108:111]
    v_mfma_f32_16x16x32_bf16 v[108:111], v[168:171], v[208:211], v[108:111]
    v_mfma_f32_16x16x32_bf16 v[108:111], v[172:175], v[212:215], v[108:111]
    v_mfma_f32_16x16x32_bf16 v[108:111], v[184:187], v[216:219], v[108:111]
    v_mfma_f32_16x16x32_bf16 v[108:111], v[188:191], v[220:223], v[108:111]
    s_nop 7
    v_max3_f32 v48, v76, v77, v78
    v_max3_f32 v50, v79, v108, v109
    v_max3_f32 v48, v48, v110, v111
    v_max_f32 v48, v48, v50
    v_mov_b32 v49, v48
    s_nop 1
    v_permlane16_swap_b32 v48, v49
    s_nop 1
    v_max_f32 v48, v48, v49
    v_mov_b32 v49, v48
    s_nop 1
    v_permlane32_swap_b32 v48, v49
    s_nop 1
    v_max_f32 v48, v48, v49
    v_sub_f32 v76, v76, v48
    v_sub_f32 v77, v77, v48
    v_sub_f32 v78, v78, v48
    v_sub_f32 v79, v79, v48
    v_sub_f32 v108, v108, v48
    v_sub_f32 v109, v109, v48
    v_sub_f32 v110, v110, v48
    v_sub_f32 v111, v111, v48
    v_exp_f32 v76, v76
    v_exp_f32 v77, v77
    v_exp_f32 v78, v78
    v_exp_f32 v79, v79
    v_exp_f32 v108, v108
    v_exp_f32 v109, v109
    v_exp_f32 v110, v110
    v_exp_f32 v111, v111
    v_sub_f32 v140, 0, v48
    v_sub_f32 v141, 0, v48
    v_sub_f32 v142, 0, v48
    v_sub_f32 v143, 0, v48
    v_add_f32 v8, v8, v76
    v_add_f32 v8, v8, v77
    v_add_f32 v8, v8, v78
    v_add_f32 v8, v8, v79
    v_add_f32 v8, v8, v108
    v_add_f32 v8, v8, v109
    v_add_f32 v8, v8, v110
    v_add_f32 v8, v8, v111
    v_cvt_pk_bf16_f32 v76, v76, v77
    v_cvt_pk_bf16_f32 v77, v78, v79
    v_cvt_pk_bf16_f32 v78, v108, v109
    v_cvt_pk_bf16_f32 v79, v110, v111
    s_waitcnt vmcnt(21)
    s_barrier
    ds_read_b128 v[24:27], v2 offset:12288
    ds_read_b128 v[28:31], v3 offset:12288
    ds_read_b128 v[32:35], v2 offset:18432
    ds_read_b128 v[36:39], v3 offset:18432
    s_waitcnt lgkmcnt(2)
    v_mfma_f32_16x16x32_bf16 v[80:83], v[24:27], a[192:195], v[128:131]
    ds_read_b128 v[40:43], v2 offset:12416
    v_bfe_u32 v20, v4, 4, 6
    v_mfma_f32_16x16x32_bf16 v[80:83], v[28:31], a[196:199], v[80:83]
    v_lshlrev_b32 v20, 2, v20
    v_mfma_f32_16x16x32_bf16 v[84:87], v[24:27], a[216:219], v[132:135]
    v_mfma_f32_16x16x32_bf16 v[84:87], v[28:31], a[220:223], v[84:87]
    v_xor_b32 v21, 16, v11
    v_mfma_f32_16x16x32_bf16 v[88:91], v[24:27], a[240:243], v[136:139]
    ds_read_b128 v[44:47], v3 offset:12416
    v_mfma_f32_16x16x32_bf16 v[88:91], v[28:31], a[244:247], v[88:91]
    v_mfma_f32_16x16x32_bf16 v[92:95], v[24:27], v[200:203], v[140:143]
    v_mfma_f32_16x16x32_bf16 v[92:95], v[28:31], v[204:207], v[92:95]
    s_waitcnt lgkmcnt(2)
    v_mfma_f32_16x16x32_bf16 v[112:115], v[32:35], a[192:195], v[128:131]
    ds_read_b128 v[24:27], v2 offset:18560
    v_mfma_f32_16x16x32_bf16 v[112:115], v[36:39], a[196:199], v[112:115]
    v_xor_b32 v22, 32, v11
    v_mfma_f32_16x16x32_bf16 v[116:119], v[32:35], a[216:219], v[132:135]
    v_mfma_f32_16x16x32_bf16 v[116:119], v[36:39], a[220:223], v[116:119]
    v_mfma_f32_16x16x32_bf16 v[120:123], v[32:35], a[240:243], v[136:139]
    ds_read_b128 v[28:31], v3 offset:18560
    v_mfma_f32_16x16x32_bf16 v[120:123], v[36:39], a[244:247], v[120:123]
    v_mfma_f32_16x16x32_bf16 v[124:127], v[32:35], v[200:203], v[140:143]
    v_mfma_f32_16x16x32_bf16 v[124:127], v[36:39], v[204:207], v[124:127]
    s_waitcnt lgkmcnt(2)
    v_xor_b32 v23, 48, v11
    v_mfma_f32_16x16x32_bf16 v[80:83], v[40:43], a[200:203], v[80:83]
    ds_read_b128 v[32:35], v2 offset:12544
    v_mfma_f32_16x16x32_bf16 v[80:83], v[44:47], a[204:207], v[80:83]
    v_mfma_f32_16x16x32_bf16 v[84:87], v[40:43], a[224:227], v[84:87]
    v_mfma_f32_16x16x32_bf16 v[84:87], v[44:47], a[228:231], v[84:87]
    v_mfma_f32_16x16x32_bf16 v[88:91], v[40:43], a[248:251], v[88:91]
    ds_read_b128 v[36:39], v3 offset:12544
    v_mfma_f32_16x16x32_bf16 v[88:91], v[44:47], a[252:255], v[88:91]
    v_mfma_f32_16x16x32_bf16 v[92:95], v[40:43], v[208:211], v[92:95]
    v_mfma_f32_16x16x32_bf16 v[92:95], v[44:47], v[212:215], v[92:95]
    s_waitcnt lgkmcnt(2)
    v_mfma_f32_16x16x32_bf16 v[112:115], v[24:27], a[200:203], v[112:115]
    ds_read_b128 v[40:43], v2 offset:18688
    v_mfma_f32_16x16x32_bf16 v[112:115], v[28:31], a[204:207], v[112:115]
    v_mfma_f32_16x16x32_bf16 v[116:119], v[24:27], a[224:227], v[116:119]
    v_mfma_f32_16x16x32_bf16 v[116:119], v[28:31], a[228:231], v[116:119]
    v_mfma_f32_16x16x32_bf16 v[120:123], v[24:27], a[248:251], v[120:123]
    ds_read_b128 v[44:47], v3 offset:18688
    v_mfma_f32_16x16x32_bf16 v[120:123], v[28:31], a[252:255], v[120:123]
    s_waitcnt lgkmcnt(2)
    v_mfma_f32_16x16x32_bf16 v[124:127], v[24:27], v[208:211], v[124:127]
    s_waitcnt vmcnt(15)
    v_mfma_f32_16x16x32_bf16 v[124:127], v[28:31], v[212:215], v[124:127]
    s_barrier
    v_add_u32 v2, 49152, v2
    v_add_u32 v3, 49152, v3
    v_mfma_f32_16x16x32_bf16 v[80:83], v[32:35], a[208:211], v[80:83]
    s_mov_b32 m0, s26
    ds_read_b128 v[24:27], v2 offset:0
    v_mfma_f32_16x16x32_bf16 v[80:83], v[36:39], a[212:215], v[80:83]
    buffer_load_dwordx4 v4, s[4:7], s32 offen offset:0 sc1 lds
    v_mfma_f32_16x16x32_bf16 v[84:87], v[32:35], a[232:235], v[84:87]
    v_mfma_f32_16x16x32_bf16 v[84:87], v[36:39], a[236:239], v[84:87]
    s_waitcnt vmcnt(15)
    buffer_load_dwordx4 v4, s[4:7], s32 offen offset:1024 sc1 lds
    v_mfma_f32_16x16x32_bf16 v[88:91], v[32:35], v[192:195], v[88:91]
    ds_read_b128 v[28:31], v3 offset:0
    v_mfma_f32_16x16x32_bf16 v[88:91], v[36:39], v[196:199], v[88:91]
    s_waitcnt vmcnt(15)
    buffer_load_dwordx4 v4, s[4:7], s32 offen offset:2048 sc1 lds
    v_mfma_f32_16x16x32_bf16 v[92:95], v[32:35], v[216:219], v[92:95]
    s_add_u32 s32, s32, 24576
    s_sub_u32 s57, s32, 196608
    v_mfma_f32_16x16x32_bf16 v[92:95], v[36:39], v[220:223], v[92:95]
    s_waitcnt lgkmcnt(2)
    s_min_u32 s32, s32, s57
    s_add_u32 s26, s26, 12288
    v_mfma_f32_16x16x32_bf16 v[112:115], v[40:43], a[208:211], v[112:115]
    s_mov_b32 m0, s26
    ds_read_b128 v[32:35], v2 offset:6144
    v_mfma_f32_16x16x32_bf16 v[112:115], v[44:47], a[212:215], v[112:115]
    s_waitcnt vmcnt(15)
    buffer_load_dwordx4 v4, s[4:7], s32 offen offset:0 sc1 lds
    v_mfma_f32_16x16x32_bf16 v[116:119], v[40:43], a[232:235], v[116:119]
    v_mfma_f32_16x16x32_bf16 v[116:119], v[44:47], a[236:239], v[116:119]
    s_waitcnt vmcnt(14)
    buffer_load_dwordx4 v4, s[4:7], s32 offen offset:1024 sc1 lds
    v_mfma_f32_16x16x32_bf16 v[120:123], v[40:43], v[192:195], v[120:123]
    ds_read_b128 v[36:39], v3 offset:6144
    v_mfma_f32_16x16x32_bf16 v[120:123], v[44:47], v[196:199], v[120:123]
    s_waitcnt vmcnt(14)
    buffer_load_dwordx4 v4, s[4:7], s32 offen offset:2048 sc1 lds
    v_mfma_f32_16x16x32_bf16 v[124:127], v[40:43], v[216:219], v[124:127]
    v_mfma_f32_16x16x32_bf16 v[124:127], v[44:47], v[220:223], v[124:127]
    s_waitcnt lgkmcnt(2)
    s_add_u32 s32, s32, 24576
    s_sub_u32 s57, s32, 196608
    s_min_u32 s32, s32, s57
    s_add_u32 s26, s26, 36864
    s_sub_u32 s57, s26, 147456
    s_min_u32 s26, s26, s57
    v_mfma_f32_16x16x32_bf16 v[160:163], v[24:27], a[192:195], v[128:131]
    s_mov_b32 m0, s56
    ds_read_b128 v[40:43], v2 offset:128
    v_mfma_f32_16x16x32_bf16 v[160:163], v[28:31], a[196:199], v[160:163]
    s_waitcnt vmcnt(13)
    buffer_load_dwordx4 v4, s[4:7], s27 offen offset:0 sc1 lds
    v_mfma_f32_16x16x32_bf16 v[164:167], v[24:27], a[216:219], v[132:135]
    v_exp_f32 v16, v80
    v_mfma_f32_16x16x32_bf16 v[164:167], v[28:31], a[220:223], v[164:167]
    s_waitcnt vmcnt(13)
    buffer_load_dwordx4 v4, s[4:7], s27 offen offset:1024 sc1 lds
    v_exp_f32 v17, v81
    v_exp_f32 v18, v82
    v_add_f32 v5, v5, v16
    v_add_f32 v5, v5, v17
    v_mfma_f32_16x16x32_bf16 v[168:171], v[24:27], a[240:243], v[136:139]
    ds_read_b128 v[44:47], v3 offset:128
    v_mfma_f32_16x16x32_bf16 v[168:171], v[28:31], a[244:247], v[168:171]
    s_waitcnt vmcnt(12)
    buffer_load_dwordx4 v4, s[4:7], s27 offen offset:2048 sc1 lds
    v_exp_f32 v19, v83
    v_cvt_pk_bf16_f32 v80, v16, v17
    v_mfma_f32_16x16x32_bf16 v[172:175], v[24:27], v[200:203], v[140:143]
    s_add_u32 s27, s27, 24576
    v_exp_f32 v16, v112
    v_mfma_f32_16x16x32_bf16 v[172:175], v[28:31], v[204:207], v[172:175]
    s_waitcnt lgkmcnt(2)
    v_add_f32 v5, v5, v18
    v_add_f32 v5, v5, v19
    v_exp_f32 v17, v113
    v_cvt_pk_bf16_f32 v81, v18, v19
    s_sub_u32 s58, s27, 196608
    v_mfma_f32_16x16x32_bf16 v[96:99], v[32:35], a[192:195], v[128:131]
    s_min_u32 s27, s27, s58
    ds_read_b128 v[24:27], v2 offset:6272
    s_add_u32 s56, s56, 12288
    v_mfma_f32_16x16x32_bf16 v[96:99], v[36:39], a[196:199], v[96:99]
    s_mov_b32 m0, s56
    v_exp_f32 v18, v114
    v_add_f32 v5, v5, v16
    v_add_f32 v5, v5, v17
    v_mfma_f32_16x16x32_bf16 v[100:103], v[32:35], a[216:219], v[132:135]
    v_exp_f32 v19, v115
    v_mfma_f32_16x16x32_bf16 v[100:103], v[36:39], a[220:223], v[100:103]
    s_waitcnt vmcnt(11)
    buffer_load_dwordx4 v4, s[4:7], s27 offen offset:0 sc1 lds
    v_cvt_pk_bf16_f32 v82, v16, v17
    v_exp_f32 v16, v84
    v_add_f32 v5, v5, v18
    v_mfma_f32_16x16x32_bf16 v[104:107], v[32:35], a[240:243], v[136:139]
    ds_read_b128 v[28:31], v3 offset:6272
    v_add_f32 v5, v5, v19
    v_mfma_f32_16x16x32_bf16 v[104:107], v[36:39], a[244:247], v[104:107]
    s_waitcnt vmcnt(11)
    buffer_load_dwordx4 v4, s[4:7], s27 offen offset:1024 sc1 lds
    v_exp_f32 v17, v85
    v_cvt_pk_bf16_f32 v83, v18, v19
    v_mfma_f32_16x16x32_bf16 v[108:111], v[32:35], v[200:203], v[140:143]
    v_exp_f32 v18, v86
    v_mfma_f32_16x16x32_bf16 v[108:111], v[36:39], v[204:207], v[108:111]
    s_waitcnt lgkmcnt(2)
    s_waitcnt vmcnt(11)
    buffer_load_dwordx4 v4, s[4:7], s27 offen offset:2048 sc1 lds
    v_add_f32 v6, v6, v16
    v_add_f32 v6, v6, v17
    v_exp_f32 v19, v87
    v_mfma_f32_16x16x32_bf16 v[160:163], v[40:43], a[200:203], v[160:163]
    ds_read_b128 v[32:35], v2 offset:256
    v_cvt_pk_bf16_f32 v84, v16, v17
    v_mfma_f32_16x16x32_bf16 v[160:163], v[44:47], a[204:207], v[160:163]
    v_exp_f32 v16, v116
    v_add_f32 v6, v6, v18
    v_add_f32 v6, v6, v19
    v_mfma_f32_16x16x32_bf16 v[164:167], v[40:43], a[224:227], v[164:167]
    v_exp_f32 v17, v117
    v_mfma_f32_16x16x32_bf16 v[164:167], v[44:47], a[228:231], v[164:167]
    s_add_u32 s27, s27, 24576
    v_cvt_pk_bf16_f32 v85, v18, v19
    v_exp_f32 v18, v118
    v_add_f32 v6, v6, v16
    v_add_f32 v6, v6, v17
    s_sub_u32 s58, s27, 196608
    v_mfma_f32_16x16x32_bf16 v[168:171], v[40:43], a[248:251], v[168:171]
    s_waitcnt vmcnt(18)
    ds_read_b128 v[36:39], v3 offset:256
    v_lshlrev_b32 v48, 16, v56
    v_mfma_f32_16x16x32_bf16 v[168:171], v[44:47], a[252:255], v[168:171]
    s_waitcnt vmcnt(11)
    buffer_load_dwordx3 v[144:146], v12, s[68:71], s35 offen offset:0 nt
    v_exp_f32 v19, v119
    v_cvt_pk_bf16_f32 v86, v16, v17
    v_mfma_f32_16x16x32_bf16 v[172:175], v[40:43], v[208:211], v[172:175]
    s_min_u32 s27, s27, s58
    v_add_f32 v6, v6, v18
    v_add_f32 v6, v6, v19
    v_mfma_f32_16x16x32_bf16 v[172:175], v[44:47], v[212:215], v[172:175]
    s_waitcnt lgkmcnt(2)
    s_waitcnt vmcnt(11)
    buffer_load_dwordx3 v[148:150], v12, s[68:71], s35 offen offset:768 nt
    v_cvt_pk_bf16_f32 v87, v18, v19
    v_exp_f32 v16, v88
    v_and_b32 v49, s97, v56
    v_mfma_f32_16x16x32_bf16 v[96:99], v[24:27], a[200:203], v[96:99]
    s_add_u32 s56, s56, 36864
    ds_read_b128 v[40:43], v2 offset:6400
    v_lshlrev_b32 v50, 16, v58
    v_mfma_f32_16x16x32_bf16 v[96:99], v[28:31], a[204:207], v[96:99]
    s_waitcnt vmcnt(11)
    buffer_load_dwordx3 v[152:154], v12, s[68:71], s35 offen offset:1536 nt
    v_exp_f32 v17, v89
    v_and_b32 v51, s97, v58
    v_mfma_f32_16x16x32_bf16 v[100:103], v[24:27], a[224:227], v[100:103]
    s_sub_u32 s58, s56, 147456
    v_exp_f32 v18, v90
    v_mfma_f32_16x16x32_bf16 v[100:103], v[28:31], a[228:231], v[100:103]
    buffer_load_dwordx3 v[156:158], v12, s[68:71], s35 offen offset:2304 nt
    v_add_f32 v7, v7, v16
    v_add_f32 v7, v7, v17
    v_mul_f32 v48, s38, v48
    v_mfma_f32_16x16x32_bf16 v[104:107], v[24:27], a[248:251], v[104:107]
    s_min_u32 s56, s56, s58
    ds_read_b128 v[44:47], v3 offset:6400
    v_mul_f32 v49, s38, v49
    v_mfma_f32_16x16x32_bf16 v[104:107], v[28:31], a[252:255], v[104:107]
    v_exp_f32 v19, v91
    v_cvt_pk_bf16_f32 v88, v16, v17
    v_exp_f32 v16, v120
    v_mfma_f32_16x16x32_bf16 v[108:111], v[24:27], v[208:211], v[108:111]
    v_add_f32 v7, v7, v18
    v_add_f32 v7, v7, v19
    v_mfma_f32_16x16x32_bf16 v[108:111], v[28:31], v[212:215], v[108:111]
    s_waitcnt lgkmcnt(2)
    v_exp_f32 v17, v121
    v_mul_f32_e64 v50, -v50, v48
    v_mul_f32_e64 v51, -v51, v49
    v_cvt_pk_bf16_f32 v89, v18, v19
    v_cvt_f32_i32 v224, v224
    v_mfma_f32_16x16x32_bf16 v[160:163], v[32:35], a[208:211], v[160:163]
    ds_read_b128 v[24:27], v2 offset:12288
    v_cvt_f32_i32 v225, v225
    v_mfma_f32_16x16x32_bf16 v[160:163], v[36:39], a[212:215], v[160:163]
    v_exp_f32 v18, v122
    v_fma_f32 v224, v224, v48, v50
    v_add_f32 v7, v7, v16
    v_fma_f32 v225, v225, v49, v51
    v_mfma_f32_16x16x32_bf16 v[164:167], v[32:35], a[232:235], v[164:167]
    v_add_f32 v7, v7, v17
    v_cvt_pk_bf16_f32 v224, v224, v225
    v_mfma_f32_16x16x32_bf16 v[164:167], v[36:39], a[236:239], v[164:167]
    v_exp_f32 v19, v123
    v_cvt_f32_i32 v228, v228
    v_cvt_f32_i32 v229, v229
    v_cvt_pk_bf16_f32 v90, v16, v17
    v_mfma_f32_16x16x32_bf16 v[168:171], v[32:35], v[192:195], v[168:171]
    ds_read_b128 v[28:31], v3 offset:12288
    v_fma_f32 v228, v228, v48, v50
    v_mfma_f32_16x16x32_bf16 v[168:171], v[36:39], v[196:199], v[168:171]
    v_exp_f32 v16, v92
    v_fma_f32 v229, v229, v49, v51
    v_cvt_pk_bf16_f32 v228, v228, v229
    v_add_f32 v7, v7, v18
    v_mfma_f32_16x16x32_bf16 v[172:175], v[32:35], v[216:219], v[172:175]
    v_cvt_f32_i32 v232, v232
    v_add_f32 v7, v7, v19
    v_mfma_f32_16x16x32_bf16 v[172:175], v[36:39], v[220:223], v[172:175]
L_iw1:
L_pg1:
    s_cbranch_execz L_pg5
    s_waitcnt lgkmcnt(2)
    v_exp_f32 v17, v93
    v_cvt_f32_i32 v233, v233
    v_fma_f32 v232, v232, v48, v50
    v_fma_f32 v233, v233, v49, v51
    v_cvt_pk_bf16_f32 v91, v18, v19
    v_mfma_f32_16x16x32_bf16 v[96:99], v[40:43], a[208:211], v[96:99]
    ds_read_b128 v[32:35], v2 offset:18432
    v_cvt_pk_bf16_f32 v232, v232, v233
    v_mfma_f32_16x16x32_bf16 v[96:99], v[44:47], a[212:215], v[96:99]
    v_exp_f32 v18, v94
    v_cvt_f32_i32 v236, v236
    v_cvt_f32_i32 v237, v237
    v_add_f32 v8, v8, v16
    v_mfma_f32_16x16x32_bf16 v[100:103], v[40:43], a[232:235], v[100:103]
    v_fma_f32 v236, v236, v48, v50
    v_add_f32 v8, v8, v17
    v_mfma_f32_16x16x32_bf16 v[100:103], v[44:47], a[236:239], v[100:103]
    v_exp_f32 v19, v95
    v_fma_f32 v237, v237, v49, v51
    v_cvt_pk_bf16_f32 v236, v236, v237
    v_lshlrev_b32 v48, 16, v57
    v_mfma_f32_16x16x32_bf16 v[104:107], v[40:43], v[192:195], v[104:107]
    ds_read_b128 v[36:39], v3 offset:18432
    v_cvt_pk_bf16_f32 v92, v16, v17
    v_mfma_f32_16x16x32_bf16 v[104:107], v[44:47], v[196:199], v[104:107]
    v_exp_f32 v16, v124
    v_and_b32 v49, s97, v57
    v_lshlrev_b32 v50, 16, v59
    v_and_b32 v51, s97, v59
    v_mfma_f32_16x16x32_bf16 v[108:111], v[40:43], v[216:219], v[108:111]
    v_add_f32 v8, v8, v18
    v_mul_f32 v48, s38, v48
    v_mfma_f32_16x16x32_bf16 v[108:111], v[44:47], v[220:223], v[108:111]
    s_waitcnt lgkmcnt(2)
    v_add_f32 v8, v8, v19
    v_mul_f32 v49, s38, v49
    v_exp_f32 v17, v125
    v_mul_f32_e64 v50, -v50, v48
    v_mul_f32_e64 v51, -v51, v49
    v_mfma_f32_16x16x32_bf16 v[176:179], v[24:27], a[192:195], v[128:131]
    ds_read_b128 v[40:43], v2 offset:12416
    v_cvt_pk_bf16_f32 v93, v18, v19
    v_mfma_f32_16x16x32_bf16 v[176:179], v[28:31], a[196:199], v[176:179]
    v_exp_f32 v18, v126
    v_cvt_f32_i32 v226, v226
    v_cvt_f32_i32 v227, v227
    v_fma_f32 v226, v226, v48, v50
    v_mfma_f32_16x16x32_bf16 v[180:183], v[24:27], a[216:219], v[132:135]
    v_add_f32 v8, v8, v16
    v_fma_f32 v227, v227, v49, v51
    v_mfma_f32_16x16x32_bf16 v[180:183], v[28:31], a[220:223], v[180:183]
    v_add_f32 v8, v8, v17
    v_cvt_pk_bf16_f32 v225, v226, v227
    v_exp_f32 v19, v127
    v_cvt_f32_i32 v230, v230
    v_mfma_f32_16x16x32_bf16 v[184:187], v[24:27], a[240:243], v[136:139]
    ds_read_b128 v[44:47], v3 offset:12416
    v_cvt_f32_i32 v231, v231
    v_mfma_f32_16x16x32_bf16 v[184:187], v[28:31], a[244:247], v[184:187]
    v_cvt_pk_bf16_f32 v94, v16, v17
    v_fma_f32 v230, v230, v48, v50
    v_add_f32 v8, v8, v18
    v_fma_f32 v231, v231, v49, v51
    v_cvt_pk_bf16_f32 v229, v230, v231
    v_mfma_f32_16x16x32_bf16 v[188:191], v[24:27], v[200:203], v[140:143]
    v_add_f32 v8, v8, v19
    v_cvt_pk_bf16_f32 v95, v18, v19
    v_mfma_f32_16x16x32_bf16 v[188:191], v[28:31], v[204:207], v[188:191]
    s_waitcnt lgkmcnt(2)
    v_cvt_f32_i32 v234, v234
    v_cvt_f32_i32 v235, v235
    v_exp_f32 v16, v160
    v_fma_f32 v234, v234, v48, v50
    v_fma_f32 v235, v235, v49, v51
    v_mfma_f32_16x16x32_bf16 v[112:115], v[32:35], a[192:195], v[128:131]
    ds_read_b128 v[24:27], v2 offset:18560
    v_cvt_pk_bf16_f32 v233, v234, v235
    v_mfma_f32_16x16x32_bf16 v[112:115], v[36:39], a[196:199], v[112:115]
    v_exp_f32 v17, v161
    v_exp_f32 v18, v162
    v_add_f32 v5, v5, v16
    v_mfma_f32_16x16x32_bf16 v[116:119], v[32:35], a[216:219], v[132:135]
    v_cvt_f32_i32 v238, v238
    v_cvt_f32_i32 v239, v239
    v_mfma_f32_16x16x32_bf16 v[116:119], v[36:39], a[220:223], v[116:119]
    v_fma_f32 v238, v238, v48, v50
    v_add_f32 v5, v5, v17
    v_exp_f32 v19, v163
    v_cvt_pk_bf16_f32 v160, v16, v17
    v_mfma_f32_16x16x32_bf16 v[120:123], v[32:35], a[240:243], v[136:139]
    ds_read_b128 v[28:31], v3 offset:18560
    v_fma_f32 v239, v239, v49, v51
    v_cvt_pk_bf16_f32 v237, v238, v239
    v_mfma_f32_16x16x32_bf16 v[120:123], v[36:39], a[244:247], v[120:123]
    s_waitcnt vmcnt(16)
    v_lshlrev_b32 v48, 16, v60
    v_and_b32 v49, s97, v60
    v_lshlrev_b32 v50, 16, v62
    v_and_b32 v51, s97, v62
    v_mul_f32 v48, s38, v48
    v_mfma_f32_16x16x32_bf16 v[124:127], v[32:35], v[200:203], v[140:143]
    v_mul_f32 v49, s38, v49
    v_mul_f32_e64 v50, -v50, v48
    v_mfma_f32_16x16x32_bf16 v[124:127], v[36:39], v[204:207], v[124:127]
    s_waitcnt lgkmcnt(2)
    s_waitcnt vmcnt(12)
    buffer_load_dwordx2 v[56:57], off, s[80:83], s37 offset:0
    v_mul_f32_e64 v51, -v51, v49
    v_cvt_f32_i32 v240, v240
    v_cvt_f32_i32 v241, v241
    v_mfma_f32_16x16x32_bf16 v[176:179], v[40:43], a[200:203], v[176:179]
    ds_read_b128 v[32:35], v2 offset:12544
    v_fma_f32 v240, v240, v48, v50
    v_mfma_f32_16x16x32_bf16 v[176:179], v[44:47], a[204:207], v[176:179]
    buffer_load_dwordx2 v[58:59], off, s[84:87], s37 offset:0
    v_exp_f32 v16, v96
    v_fma_f32 v241, v241, v49, v51
    v_mfma_f32_16x16x32_bf16 v[180:183], v[40:43], a[224:227], v[180:183]
    v_cvt_pk_bf16_f32 v226, v240, v241
    v_add_f32 v5, v5, v18
    v_mfma_f32_16x16x32_bf16 v[180:183], v[44:47], a[228:231], v[180:183]
    v_cvt_f32_i32 v244, v244
    v_add_f32 v5, v5, v19
    v_cvt_f32_i32 v245, v245
    v_exp_f32 v17, v97
    v_fma_f32 v244, v244, v48, v50
    v_mfma_f32_16x16x32_bf16 v[184:187], v[40:43], a[248:251], v[184:187]
    ds_read_b128 v[36:39], v3 offset:12544
    v_fma_f32 v245, v245, v49, v51
    v_mfma_f32_16x16x32_bf16 v[184:187], v[44:47], a[252:255], v[184:187]
    v_cvt_pk_bf16_f32 v161, v18, v19
    v_cvt_pk_bf16_f32 v230, v244, v245
    v_exp_f32 v18, v98
    v_cvt_f32_i32 v248, v248
    v_mfma_f32_16x16x32_bf16 v[188:191], v[40:43], v[208:211], v[188:191]
    v_cvt_f32_i32 v249, v249
    v_add_f32 v5, v5, v16
    v_mfma_f32_16x16x32_bf16 v[188:191], v[44:47], v[212:215], v[188:191]
    s_waitcnt lgkmcnt(2)
    v_fma_f32 v248, v248, v48, v50
    v_add_f32 v5, v5, v17
    v_fma_f32 v249, v249, v49, v51
    v_exp_f32 v19, v99
    v_mfma_f32_16x16x32_bf16 v[112:115], v[24:27], a[200:203], v[112:115]
    ds_read_b128 v[40:43], v2 offset:18688
    v_cvt_pk_bf16_f32 v234, v248, v249
    v_mfma_f32_16x16x32_bf16 v[112:115], v[28:31], a[204:207], v[112:115]
    v_cvt_f32_i32 v252, v252
    v_cvt_pk_bf16_f32 v162, v16, v17
    v_cvt_f32_i32 v253, v253
    v_exp_f32 v16, v164
    v_mfma_f32_16x16x32_bf16 v[116:119], v[24:27], a[224:227], v[116:119]
    v_fma_f32 v252, v252, v48, v50
    v_fma_f32 v253, v253, v49, v51
    v_mfma_f32_16x16x32_bf16 v[116:119], v[28:31], a[228:231], v[116:119]
    v_add_f32 v5, v5, v18
    v_cvt_pk_bf16_f32 v238, v252, v253
    v_add_f32 v5, v5, v19
    v_lshlrev_b32 v48, 16, v61
    v_exp_f32 v17, v165
    v_mfma_f32_16x16x32_bf16 v[120:123], v[24:27], a[248:251], v[120:123]
    ds_read_b128 v[44:47], v3 offset:18688
    v_and_b32 v49, s97, v61
    v_mfma_f32_16x16x32_bf16 v[120:123], v[28:31], a[252:255], v[120:123]
    s_waitcnt lgkmcnt(2)
    v_lshlrev_b32 v50, 16, v63
    v_cvt_pk_bf16_f32 v163, v18, v19
    v_and_b32 v51, s97, v63
    v_exp_f32 v18, v166
    v_mfma_f32_16x16x32_bf16 v[124:127], v[24:27], v[208:211], v[124:127]
    s_waitcnt vmcnt(30)
    v_mul_f32 v48, s38, v48
    v_mul_f32 v49, s38, v49
    v_mfma_f32_16x16x32_bf16 v[124:127], v[28:31], v[212:215], v[124:127]
    s_barrier
    v_add_f32 v6, v6, v16
    v_mul_f32_e64 v50, -v50, v48
    v_add_f32 v6, v6, v17
    v_mul_f32_e64 v51, -v51, v49
    v_mfma_f32_16x16x32_bf16 v[176:179], v[32:35], a[208:211], v[176:179]
    ds_read_b128 v[24:27], v1 offset:0
    v_cvt_f32_i32 v242, v242
    v_mfma_f32_16x16x32_bf16 v[176:179], v[36:39], a[212:215], v[176:179]
    v_exp_f32 v19, v167
    v_cvt_f32_i32 v243, v243
    v_cvt_pk_bf16_f32 v164, v16, v17
    v_fma_f32 v242, v242, v48, v50
    v_mfma_f32_16x16x32_bf16 v[180:183], v[32:35], a[232:235], v[180:183]
    v_exp_f32 v16, v100
    v_mfma_f32_16x16x32_bf16 v[180:183], v[36:39], a[236:239], v[180:183]
    v_fma_f32 v243, v243, v49, v51
    v_cvt_pk_bf16_f32 v227, v242, v243
    v_add_f32 v6, v6, v18
    v_cvt_f32_i32 v246, v246
    v_add_f32 v6, v6, v19
    v_cvt_f32_i32 v247, v247
    v_mfma_f32_16x16x32_bf16 v[184:187], v[32:35], v[192:195], v[184:187]
    ds_read_b128 v[28:31], v1 offset:12288
    v_fma_f32 v246, v246, v48, v50
    v_mfma_f32_16x16x32_bf16 v[184:187], v[36:39], v[196:199], v[184:187]
    v_exp_f32 v17, v101
    v_fma_f32 v247, v247, v49, v51
    v_cvt_pk_bf16_f32 v165, v18, v19
    v_cvt_pk_bf16_f32 v231, v246, v247
    v_mfma_f32_16x16x32_bf16 v[188:191], v[32:35], v[216:219], v[188:191]
    v_exp_f32 v18, v102
    v_mfma_f32_16x16x32_bf16 v[188:191], v[36:39], v[220:223], v[188:191]
    s_waitcnt lgkmcnt(2)
    v_cvt_f32_i32 v250, v250
    v_cvt_f32_i32 v251, v251
    v_add_f32 v6, v6, v16
    v_fma_f32 v250, v250, v48, v50
    v_add_f32 v6, v6, v17
    v_mfma_f32_16x16x32_bf16 v[112:115], v[40:43], a[208:211], v[112:115]
    ds_read_b128 v[32:35], v1 offset:1024
    v_fma_f32 v251, v251, v49, v51
    v_mfma_f32_16x16x32_bf16 v[112:115], v[44:47], a[212:215], v[112:115]
    v_exp_f32 v19, v103
    v_cvt_pk_bf16_f32 v235, v250, v251
    v_cvt_f32_i32 v254, v254
    v_cvt_pk_bf16_f32 v166, v16, v17
    v_mfma_f32_16x16x32_bf16 v[116:119], v[40:43], a[232:235], v[116:119]
    v_cvt_f32_i32 v255, v255
    v_add_f32 v6, v6, v18
    v_mfma_f32_16x16x32_bf16 v[116:119], v[44:47], a[236:239], v[116:119]
    v_fma_f32 v254, v254, v48, v50
    v_add_f32 v6, v6, v19
    v_fma_f32 v255, v255, v49, v51
    v_cvt_pk_bf16_f32 v167, v18, v19
    v_cvt_pk_bf16_f32 v239, v254, v255
    v_mfma_f32_16x16x32_bf16 v[120:123], v[40:43], v[192:195], v[120:123]
    ds_read_b128 v[36:39], v1 offset:13312
    v_mfma_f32_16x16x32_bf16 v[120:123], v[44:47], v[196:199], v[120:123]
    v_mfma_f32_16x16x32_bf16 v[124:127], v[40:43], v[216:219], v[124:127]
    v_mfma_f32_16x16x32_bf16 v[124:127], v[44:47], v[220:223], v[124:127]
    s_waitcnt lgkmcnt(2)
    v_mfma_f32_16x16x32_bf16 a[144:147], v[76:79], v[24:27], 0
    ds_read_b128 v[40:43], v1 offset:2048
    v_mfma_f32_16x16x32_bf16 a[144:147], v[92:95], v[28:31], a[144:147]
    buffer_store_dwordx4 v[224:227], v11, s[4:7], s33 offen offset:0 sc1
    v_mfma_f32_16x16x32_bf16 a[0:3], v[80:83], v[28:31], a[0:3]
    ds_read_b128 v[44:47], v1 offset:14336
    v_mfma_f32_16x16x32_bf16 a[48:51], v[84:87], v[28:31], a[48:51]
    v_exp_f32 v16, v168
    v_mfma_f32_16x16x32_bf16 a[96:99], v[88:91], v[28:31], a[96:99]
    s_waitcnt lgkmcnt(2)
    v_exp_f32 v17, v169
    v_mfma_f32_16x16x32_bf16 a[148:151], v[76:79], v[32:35], 0
    ds_read_b128 v[24:27], v1 offset:3072
    v_exp_f32 v18, v170
    v_mfma_f32_16x16x32_bf16 a[148:151], v[92:95], v[36:39], a[148:151]
    v_add_f32 v7, v7, v16
    v_add_f32 v7, v7, v17
    v_mfma_f32_16x16x32_bf16 a[4:7], v[80:83], v[36:39], a[4:7]
    ds_read_b128 v[28:31], v1 offset:15360
    v_exp_f32 v19, v171
    v_mfma_f32_16x16x32_bf16 a[52:55], v[84:87], v[36:39], a[52:55]
    v_cvt_pk_bf16_f32 v168, v16, v17
    v_mfma_f32_16x16x32_bf16 a[100:103], v[88:91], v[36:39], a[100:103]
    s_waitcnt lgkmcnt(2)
    v_exp_f32 v16, v104
    v_mfma_f32_16x16x32_bf16 a[152:155], v[76:79], v[40:43], 0
    ds_read_b128 v[32:35], v1 offset:4096
    v_add_f32 v7, v7, v18
    v_mfma_f32_16x16x32_bf16 a[152:155], v[92:95], v[44:47], a[152:155]
    buffer_store_dwordx4 v[228:231], v21, s[4:7], s33 offen offset:768 sc1
    v_mfma_f32_16x16x32_bf16 a[8:11], v[80:83], v[44:47], a[8:11]
    ds_read_b128 v[36:39], v1 offset:16384
    v_add_f32 v7, v7, v19
    v_mfma_f32_16x16x32_bf16 a[56:59], v[84:87], v[44:47], a[56:59]
    v_exp_f32 v17, v105
    v_cvt_pk_bf16_f32 v169, v18, v19
    v_mfma_f32_16x16x32_bf16 a[104:107], v[88:91], v[44:47], a[104:107]
    s_waitcnt lgkmcnt(2)
    v_exp_f32 v18, v106
    v_mfma_f32_16x16x32_bf16 a[156:159], v[76:79], v[24:27], 0
    ds_read_b128 v[40:43], v1 offset:5120
    v_add_f32 v7, v7, v16
    v_add_f32 v7, v7, v17
    v_mfma_f32_16x16x32_bf16 a[156:159], v[92:95], v[28:31], a[156:159]
    v_exp_f32 v19, v107
    v_mfma_f32_16x16x32_bf16 a[12:15], v[80:83], v[28:31], a[12:15]
    ds_read_b128 v[44:47], v1 offset:17408
    v_cvt_pk_bf16_f32 v170, v16, v17
    v_mfma_f32_16x16x32_bf16 a[60:63], v[84:87], v[28:31], a[60:63]
    v_exp_f32 v16, v172
    v_mfma_f32_16x16x32_bf16 a[108:111], v[88:91], v[28:31], a[108:111]
    s_waitcnt lgkmcnt(2)
    v_add_f32 v7, v7, v18
    v_add_f32 v7, v7, v19
    v_mfma_f32_16x16x32_bf16 a[160:163], v[76:79], v[32:35], 0
    ds_read_b128 v[24:27], v1 offset:6144
    v_mfma_f32_16x16x32_bf16 a[160:163], v[92:95], v[36:39], a[160:163]
    buffer_store_dwordx4 v[232:235], v22, s[4:7], s33 offen offset:1536 sc1
    v_mfma_f32_16x16x32_bf16 a[16:19], v[80:83], v[36:39], a[16:19]
    ds_read_b128 v[28:31], v1 offset:18432
    v_mfma_f32_16x16x32_bf16 a[64:67], v[84:87], v[36:39], a[64:67]
    v_exp_f32 v17, v173
    v_cvt_pk_bf16_f32 v171, v18, v19
    v_mfma_f32_16x16x32_bf16 a[112:115], v[88:91], v[36:39], a[112:115]
    s_waitcnt lgkmcnt(2)
    v_exp_f32 v18, v174
    v_mfma_f32_16x16x32_bf16 a[164:167], v[76:79], v[40:43], 0
    ds_read_b128 v[32:35], v1 offset:7168
    v_add_f32 v8, v8, v16
    v_add_f32 v8, v8, v17
    v_mfma_f32_16x16x32_bf16 a[164:167], v[92:95], v[44:47], a[164:167]
    v_exp_f32 v19, v175
    v_mfma_f32_16x16x32_bf16 a[20:23], v[80:83], v[44:47], a[20:23]
    ds_read_b128 v[36:39], v1 offset:19456
    v_cvt_pk_bf16_f32 v172, v16, v17
    v_mfma_f32_16x16x32_bf16 a[68:71], v[84:87], v[44:47], a[68:71]
    v_exp_f32 v16, v108
    v_mfma_f32_16x16x32_bf16 a[116:119], v[88:91], v[44:47], a[116:119]
    s_waitcnt lgkmcnt(2)
    v_add_f32 v8, v8, v18
    v_add_f32 v8, v8, v19
    v_mfma_f32_16x16x32_bf16 a[168:171], v[76:79], v[24:27], 0
    ds_read_b128 v[40:43], v1 offset:8192
    v_mfma_f32_16x16x32_bf16 a[168:171], v[92:95], v[28:31], a[168:171]
    buffer_store_dwordx4 v[236:239], v23, s[4:7], s33 offen offset:2304 sc1
    v_mfma_f32_16x16x32_bf16 a[24:27], v[80:83], v[28:31], a[24:27]
    ds_read_b128 v[44:47], v1 offset:20480
    v_mfma_f32_16x16x32_bf16 a[72:75], v[84:87], v[28:31], a[72:75]
    v_exp_f32 v17, v109
    v_cvt_pk_bf16_f32 v173, v18, v19
    v_mfma_f32_16x16x32_bf16 a[120:123], v[88:91], v[28:31], a[120:123]
    s_waitcnt lgkmcnt(2)
    v_exp_f32 v18, v110
    v_mfma_f32_16x16x32_bf16 a[172:175], v[76:79], v[32:35], 0
    ds_read_b128 v[24:27], v1 offset:9216
    v_add_f32 v8, v8, v16
    v_add_f32 v8, v8, v17
    v_mfma_f32_16x16x32_bf16 a[172:175], v[92:95], v[36:39], a[172:175]
    v_exp_f32 v19, v111
    v_mfma_f32_16x16x32_bf16 a[28:31], v[80:83], v[36:39], a[28:31]
    ds_read_b128 v[28:31], v1 offset:21504
    v_cvt_pk_bf16_f32 v174, v16, v17
    v_add_f32 v8, v8, v18
    v_mfma_f32_16x16x32_bf16 a[76:79], v[84:87], v[36:39], a[76:79]
    v_add_f32 v8, v8, v19
    v_cvt_pk_bf16_f32 v175, v18, v19
    v_mfma_f32_16x16x32_bf16 a[124:127], v[88:91], v[36:39], a[124:127]
    s_waitcnt lgkmcnt(2)
    buffer_load_dwordx2 v[60:61], off, s[80:83], s37 offset:8
    v_mfma_f32_16x16x32_bf16 a[176:179], v[76:79], v[40:43], 0
    ds_read_b128 v[32:35], v1 offset:10240
    v_mfma_f32_16x16x32_bf16 a[176:179], v[92:95], v[44:47], a[176:179]
    buffer_load_dwordx2 v[62:63], off, s[84:87], s37 offset:8
    v_mfma_f32_16x16x32_bf16 a[32:35], v[80:83], v[44:47], a[32:35]
    ds_read_b128 v[36:39], v1 offset:22528
    v_mfma_f32_16x16x32_bf16 a[80:83], v[84:87], v[44:47], a[80:83]
    s_waitcnt vmcnt(19)
    buffer_load_dwordx3 v[240:242], v12, s[68:71], s16 offen offset:0 nt
    v_mfma_f32_16x16x32_bf16 a[128:131], v[88:91], v[44:47], a[128:131]
    s_waitcnt lgkmcnt(2)
    v_exp_f32 v16, v176
    v_mfma_f32_16x16x32_bf16 a[180:183], v[76:79], v[24:27], 0
    ds_read_b128 v[40:43], v1 offset:11264
    v_exp_f32 v17, v177
    v_mfma_f32_16x16x32_bf16 a[180:183], v[92:95], v[28:31], a[180:183]
    v_exp_f32 v18, v178
    v_mfma_f32_16x16x32_bf16 a[36:39], v[80:83], v[28:31], a[36:39]
    s_waitcnt vmcnt(19)
    ds_read_b128 v[44:47], v1 offset:23552
    v_add_f32 v5, v5, v16
    v_add_f32 v5, v5, v17
    v_mfma_f32_16x16x32_bf16 a[84:87], v[84:87], v[28:31], a[84:87]
    v_exp_f32 v19, v179
    v_mfma_f32_16x16x32_bf16 a[132:135], v[88:91], v[28:31], a[132:135]
    s_waitcnt lgkmcnt(2)
    s_barrier
    v_add_u32 v2, 49152, v2
    v_add_u32 v3, 49152, v3
    v_mfma_f32_16x16x32_bf16 a[184:187], v[76:79], v[32:35], 0
    ds_read_b128 v[24:27], v2 offset:0
    v_cvt_pk_bf16_f32 v176, v16, v17
    v_mfma_f32_16x16x32_bf16 a[184:187], v[92:95], v[36:39], a[184:187]
    buffer_load_dwordx3 v[244:246], v12, s[68:71], s16 offen offset:768 nt
    v_mfma_f32_16x16x32_bf16 a[40:43], v[80:83], v[36:39], a[40:43]
    ds_read_b128 v[28:31], v3 offset:0
    v_mfma_f32_16x16x32_bf16 a[88:91], v[84:87], v[36:39], a[88:91]
    buffer_load_dwordx3 v[248:250], v12, s[68:71], s16 offen offset:1536 nt
    v_mfma_f32_16x16x32_bf16 a[136:139], v[88:91], v[36:39], a[136:139]
    s_waitcnt lgkmcnt(2)
    v_exp_f32 v16, v112
    v_mfma_f32_16x16x32_bf16 a[188:191], v[76:79], v[40:43], 0
    ds_read_b128 v[32:35], v2 offset:6144
    v_add_f32 v5, v5, v18
    v_add_f32 v5, v5, v19
    v_mfma_f32_16x16x32_bf16 a[188:191], v[92:95], v[44:47], a[188:191]
    v_exp_f32 v17, v113
    v_mfma_f32_16x16x32_bf16 a[44:47], v[80:83], v[44:47], a[44:47]
    ds_read_b128 v[36:39], v3 offset:6144
    v_cvt_pk_bf16_f32 v177, v18, v19
    v_mfma_f32_16x16x32_bf16 a[92:95], v[84:87], v[44:47], a[92:95]
    v_exp_f32 v18, v114
    v_mfma_f32_16x16x32_bf16 a[140:143], v[88:91], v[44:47], a[140:143]
    s_waitcnt lgkmcnt(2)
    s_waitcnt vmcnt(20)
    buffer_load_dwordx3 v[252:254], v12, s[68:71], s16 offen offset:2304 nt
    v_add_f32 v5, v5, v16
    v_add_f32 v5, v5, v17
    v_exp_f32 v19, v115
    v_cvt_pk_bf16_f32 v178, v16, v17
    v_exp_f32 v16, v180
    v_add_f32 v5, v5, v18
    v_add_f32 v5, v5, v19
    v_exp_f32 v17, v181
    v_cvt_pk_bf16_f32 v179, v18, v19
    v_exp_f32 v18, v182
    v_add_f32 v6, v6, v16
    v_add_f32 v6, v6, v17
    v_exp_f32 v19, v183
    v_cvt_pk_bf16_f32 v180, v16, v17
    v_exp_f32 v16, v116
    v_add_f32 v6, v6, v18
    v_add_f32 v6, v6, v19
    v_exp_f32 v17, v117
    v_cvt_pk_bf16_f32 v181, v18, v19
    v_exp_f32 v18, v118
    v_add_f32 v6, v6, v16
    v_add_f32 v6, v6, v17
    v_exp_f32 v19, v119
    v_cvt_pk_bf16_f32 v182, v16, v17
    v_add_f32 v6, v6, v18
    v_add_f32 v6, v6, v19
    v_cvt_pk_bf16_f32 v183, v18, v19
    v_mfma_f32_16x16x32_bf16 v[64:67], v[24:27], a[192:195], v[128:131]
    s_waitcnt vmcnt(10)
    ds_read_b128 v[40:43], v2 offset:128
    v_lshlrev_b32 v48, 16, v56
    v_mfma_f32_16x16x32_bf16 v[64:67], v[28:31], a[196:199], v[64:67]
    v_exp_f32 v16, v184
    v_mfma_f32_16x16x32_bf16 v[68:71], v[24:27], a[216:219], v[132:135]
    v_exp_f32 v17, v185
    v_mfma_f32_16x16x32_bf16 v[68:71], v[28:31], a[220:223], v[68:71]
    v_exp_f32 v18, v186
    v_mfma_f32_16x16x32_bf16 v[72:75], v[24:27], a[240:243], v[136:139]
    ds_read_b128 v[44:47], v3 offset:128
    v_and_b32 v49, s97, v56
    v_mfma_f32_16x16x32_bf16 v[72:75], v[28:31], a[244:247], v[72:75]
    v_add_f32 v7, v7, v16
    v_add_f32 v7, v7, v17
    v_mfma_f32_16x16x32_bf16 v[76:79], v[24:27], v[200:203], v[140:143]
    v_exp_f32 v19, v187
    v_mfma_f32_16x16x32_bf16 v[76:79], v[28:31], v[204:207], v[76:79]
    s_waitcnt lgkmcnt(2)
    v_lshlrev_b32 v50, 16, v58
    v_and_b32 v51, s97, v58
    v_mfma_f32_16x16x32_bf16 v[96:99], v[32:35], a[192:195], v[128:131]
    ds_read_b128 v[24:27], v2 offset:6272
    v_cvt_pk_bf16_f32 v184, v16, v17
    v_mfma_f32_16x16x32_bf16 v[96:99], v[36:39], a[196:199], v[96:99]
    v_exp_f32 v16, v120
    v_mfma_f32_16x16x32_bf16 v[100:103], v[32:35], a[216:219], v[132:135]
    v_mul_f32_e64 v50, -v50, v48
    v_add_f32 v7, v7, v18
    v_mfma_f32_16x16x32_bf16 v[100:103], v[36:39], a[220:223], v[100:103]
    v_add_f32 v7, v7, v19
    v_mul_f32_e64 v51, -v51, v49
    v_mfma_f32_16x16x32_bf16 v[104:107], v[32:35], a[240:243], v[136:139]
    ds_read_b128 v[28:31], v3 offset:6272
    v_cvt_f32_i32 v144, v144
    v_mfma_f32_16x16x32_bf16 v[104:107], v[36:39], a[244:247], v[104:107]
    s_waitcnt lgkmcnt(2)
    v_exp_f32 v17, v121
    v_mfma_f32_16x16x32_bf16 v[108:111], v[32:35], v[200:203], v[140:143]
    s_waitcnt vmcnt(6)
    v_cvt_pk_bf16_f32 v185, v18, v19
    v_cvt_f32_i32 v148, v148
    v_mfma_f32_16x16x32_bf16 v[108:111], v[36:39], v[204:207], v[108:111]
    s_barrier
    v_mfma_f32_16x16x32_bf16 v[64:67], v[40:43], a[200:203], v[64:67]
    ds_read_b128 v[32:35], v2 offset:256
    v_add_u32 v0, 1, v0
    v_mfma_f32_16x16x32_bf16 v[64:67], v[44:47], a[204:207], v[64:67]
    buffer_store_dword v0, v13, s[20:23], 0 offen offset:32 sc1
    v_mfma_f32_16x16x32_bf16 v[68:71], v[40:43], a[224:227], v[68:71]
    s_mov_b32 m0, s26
    v_exp_f32 v18, v122
    v_mfma_f32_16x16x32_bf16 v[68:71], v[44:47], a[228:231], v[68:71]
    v_add_f32 v7, v7, v16
    v_add_f32 v7, v7, v17
    v_mfma_f32_16x16x32_bf16 v[72:75], v[40:43], a[248:251], v[72:75]
    ds_read_b128 v[36:39], v3 offset:256
    v_fma_f32 v144, v144, v48, v50
    v_mfma_f32_16x16x32_bf16 v[72:75], v[44:47], a[252:255], v[72:75]
    buffer_load_dwordx4 v4, s[4:7], s32 offen offset:0 sc1 lds
    v_mfma_f32_16x16x32_bf16 v[76:79], v[40:43], v[208:211], v[76:79]
    v_exp_f32 v19, v123
    v_mfma_f32_16x16x32_bf16 v[76:79], v[44:47], v[212:215], v[76:79]
    s_waitcnt lgkmcnt(2)
    v_cvt_pk_bf16_f32 v186, v16, v17
    v_fma_f32 v148, v148, v49, v51
    v_mfma_f32_16x16x32_bf16 v[96:99], v[24:27], a[200:203], v[96:99]
    ds_read_b128 v[40:43], v2 offset:6400
    v_cvt_f32_i32 v145, v145
    v_mfma_f32_16x16x32_bf16 v[96:99], v[28:31], a[204:207], v[96:99]
    buffer_load_dwordx4 v4, s[4:7], s32 offen offset:1024 sc1 lds
    v_mfma_f32_16x16x32_bf16 v[100:103], v[24:27], a[224:227], v[100:103]
    v_exp_f32 v16, v188
    v_mfma_f32_16x16x32_bf16 v[100:103], v[28:31], a[228:231], v[100:103]
    v_add_f32 v7, v7, v18
    v_add_f32 v7, v7, v19
    v_mfma_f32_16x16x32_bf16 v[104:107], v[24:27], a[248:251], v[104:107]
    ds_read_b128 v[44:47], v3 offset:6400
    v_cvt_f32_i32 v149, v149
    v_mfma_f32_16x16x32_bf16 v[104:107], v[28:31], a[252:255], v[104:107]
    buffer_load_dwordx4 v4, s[4:7], s32 offen offset:2048 sc1 lds
    v_mfma_f32_16x16x32_bf16 v[108:111], v[24:27], v[208:211], v[108:111]
    s_add_u32 s32, s32, 24576
    v_exp_f32 v17, v189
    v_mfma_f32_16x16x32_bf16 v[108:111], v[28:31], v[212:215], v[108:111]
    s_waitcnt lgkmcnt(2)
    v_cvt_pk_bf16_f32 v187, v18, v19
    v_fma_f32 v145, v145, v48, v50
    v_mfma_f32_16x16x32_bf16 v[64:67], v[32:35], a[208:211], v[64:67]
    s_sub_u32 s57, s32, 196608
    ds_read_b128 v[24:27], v2 offset:12288
    v_fma_f32 v149, v149, v49, v51
    v_mfma_f32_16x16x32_bf16 v[64:67], v[36:39], a[212:215], v[64:67]
    s_min_u32 s32, s32, s57
    v_exp_f32 v18, v190
    v_mfma_f32_16x16x32_bf16 v[68:71], v[32:35], a[232:235], v[68:71]
    s_add_u32 s26, s26, 12288
    v_add_f32 v8, v8, v16
    v_add_f32 v8, v8, v17
    v_mfma_f32_16x16x32_bf16 v[68:71], v[36:39], a[236:239], v[68:71]
    s_mov_b32 m0, s26
    v_exp_f32 v19, v191
    v_mfma_f32_16x16x32_bf16 v[72:75], v[32:35], v[192:195], v[72:75]
    ds_read_b128 v[28:31], v3 offset:12288
    v_cvt_pk_bf16_f32 v188, v16, v17
    v_mfma_f32_16x16x32_bf16 v[72:75], v[36:39], v[196:199], v[72:75]
    v_exp_f32 v16, v124
    v_mfma_f32_16x16x32_bf16 v[76:79], v[32:35], v[216:219], v[76:79]
    v_add_f32 v8, v8, v18
    v_add_f32 v8, v8, v19
    v_mfma_f32_16x16x32_bf16 v[76:79], v[36:39], v[220:223], v[76:79]
    s_waitcnt lgkmcnt(2)
    buffer_load_dwordx4 v4, s[4:7], s32 offen offset:0 sc1 lds
    v_mfma_f32_16x16x32_bf16 v[96:99], v[40:43], a[208:211], v[96:99]
    ds_read_b128 v[32:35], v2 offset:18432
    v_cvt_f32_i32 v146, v146
    v_mfma_f32_16x16x32_bf16 v[96:99], v[44:47], a[212:215], v[96:99]
    v_exp_f32 v17, v125
    v_mfma_f32_16x16x32_bf16 v[100:103], v[40:43], a[232:235], v[100:103]
    v_cvt_pk_bf16_f32 v189, v18, v19
    v_cvt_f32_i32 v150, v150
    v_mfma_f32_16x16x32_bf16 v[100:103], v[44:47], a[236:239], v[100:103]
    buffer_load_dwordx4 v4, s[4:7], s32 offen offset:1024 sc1 lds
    v_mfma_f32_16x16x32_bf16 v[104:107], v[40:43], v[192:195], v[104:107]
    ds_read_b128 v[36:39], v3 offset:18432
    v_fma_f32 v146, v146, v48, v50
    v_mfma_f32_16x16x32_bf16 v[104:107], v[44:47], v[196:199], v[104:107]
    v_exp_f32 v18, v126
    v_mfma_f32_16x16x32_bf16 v[108:111], v[40:43], v[216:219], v[108:111]
    v_add_f32 v8, v8, v16
    v_add_f32 v8, v8, v17
    v_mfma_f32_16x16x32_bf16 v[108:111], v[44:47], v[220:223], v[108:111]
    s_waitcnt lgkmcnt(2)
    buffer_load_dwordx4 v4, s[4:7], s32 offen offset:2048 sc1 lds
    v_mfma_f32_16x16x32_bf16 v[80:83], v[24:27], a[192:195], v[128:131]
    s_mov_b32 s32, 196608
    ds_read_b128 v[40:43], v2 offset:12416
    v_fma_f32 v150, v150, v49, v51
    v_mfma_f32_16x16x32_bf16 v[80:83], v[28:31], a[196:199], v[80:83]
    v_exp_f32 v19, v127
    v_cvt_pk_bf16_f32 v190, v16, v17
    v_mfma_f32_16x16x32_bf16 v[84:87], v[24:27], a[216:219], v[132:135]
    s_add_u32 s26, s26, 36864
    v_add_f32 v8, v8, v18
    v_add_f32 v8, v8, v19
    v_mfma_f32_16x16x32_bf16 v[84:87], v[28:31], a[220:223], v[84:87]
    s_sub_u32 s57, s26, 147456
    v_cvt_pk_bf16_f32 v191, v18, v19
    v_lshlrev_b32 v48, 16, v57
    v_mfma_f32_16x16x32_bf16 v[88:91], v[24:27], a[240:243], v[136:139]
    ds_read_b128 v[44:47], v3 offset:12416
    v_and_b32 v49, s97, v57
    v_mfma_f32_16x16x32_bf16 v[88:91], v[28:31], a[244:247], v[88:91]
    s_min_u32 s26, s26, s57
    v_exp_f32 v16, v64
    v_mfma_f32_16x16x32_bf16 v[92:95], v[24:27], v[200:203], v[140:143]
    v_exp_f32 v17, v65
    v_mfma_f32_16x16x32_bf16 v[92:95], v[28:31], v[204:207], v[92:95]
    s_waitcnt lgkmcnt(2)
    v_exp_f32 v18, v66
    v_mfma_f32_16x16x32_bf16 v[112:115], v[32:35], a[192:195], v[128:131]
    s_mov_b32 m0, s56
    ds_read_b128 v[24:27], v2 offset:18560
    v_lshlrev_b32 v50, 16, v59
    v_mfma_f32_16x16x32_bf16 v[112:115], v[36:39], a[196:199], v[112:115]
    v_add_f32 v5, v5, v16
    v_add_f32 v5, v5, v17
    v_mfma_f32_16x16x32_bf16 v[116:119], v[32:35], a[216:219], v[132:135]
    v_exp_f32 v19, v67
    v_mfma_f32_16x16x32_bf16 v[116:119], v[36:39], a[220:223], v[116:119]
    buffer_load_dwordx4 v4, s[4:7], s27 offen offset:0 sc1 lds
    v_mfma_f32_16x16x32_bf16 v[120:123], v[32:35], a[240:243], v[136:139]
    ds_read_b128 v[28:31], v3 offset:18560
    v_and_b32 v51, s97, v59
    v_mfma_f32_16x16x32_bf16 v[120:123], v[36:39], a[244:247], v[120:123]
    v_cvt_pk_bf16_f32 v64, v16, v17
    v_mul_f32_e64 v50, -v50, v48
    v_mfma_f32_16x16x32_bf16 v[124:127], v[32:35], v[200:203], v[140:143]
    v_exp_f32 v16, v96
    v_mfma_f32_16x16x32_bf16 v[124:127], v[36:39], v[204:207], v[124:127]
    s_waitcnt lgkmcnt(2)
    buffer_load_dwordx4 v4, s[4:7], s27 offen offset:1024 sc1 lds
    v_mfma_f32_16x16x32_bf16 v[80:83], v[40:43], a[200:203], v[80:83]
    ds_read_b128 v[32:35], v2 offset:12544
    v_add_f32 v5, v5, v18
    v_mfma_f32_16x16x32_bf16 v[80:83], v[44:47], a[204:207], v[80:83]
    v_add_f32 v5, v5, v19
    v_mul_f32_e64 v51, -v51, v49
    v_mfma_f32_16x16x32_bf16 v[84:87], v[40:43], a[224:227], v[84:87]
    v_exp_f32 v17, v97
    v_mfma_f32_16x16x32_bf16 v[84:87], v[44:47], a[228:231], v[84:87]
    s_waitcnt vmcnt(13)
    buffer_load_dwordx4 v4, s[4:7], s27 offen offset:2048 sc1 lds
    v_cvt_pk_bf16_f32 v65, v18, v19
    v_mfma_f32_16x16x32_bf16 v[88:91], v[40:43], a[248:251], v[88:91]
    s_add_u32 s27, s27, 24576
    ds_read_b128 v[36:39], v3 offset:12544
    v_cvt_f32_i32 v152, v152
    v_mfma_f32_16x16x32_bf16 v[88:91], v[44:47], a[252:255], v[88:91]
    v_exp_f32 v18, v98
    v_mfma_f32_16x16x32_bf16 v[92:95], v[40:43], v[208:211], v[92:95]
    s_sub_u32 s58, s27, 196608
    v_add_f32 v5, v5, v16
    v_add_f32 v5, v5, v17
    v_mfma_f32_16x16x32_bf16 v[92:95], v[44:47], v[212:215], v[92:95]
    s_waitcnt lgkmcnt(2)
    v_cvt_f32_i32 v156, v156
    v_fma_f32 v152, v152, v48, v50
    v_mfma_f32_16x16x32_bf16 v[112:115], v[24:27], a[200:203], v[112:115]
    s_min_u32 s27, s27, s58
    ds_read_b128 v[40:43], v2 offset:18688
    v_fma_f32 v156, v156, v49, v51
    v_mfma_f32_16x16x32_bf16 v[112:115], v[28:31], a[204:207], v[112:115]
L_iw2:
L_pg2:
    s_cbranch_execz L_pg6
    v_exp_f32 v19, v99
    v_cvt_pk_bf16_f32 v66, v16, v17
    v_mfma_f32_16x16x32_bf16 v[116:119], v[24:27], a[224:227], v[116:119]
    s_add_u32 s56, s56, 12288
    v_exp_f32 v16, v68
    v_mfma_f32_16x16x32_bf16 v[116:119], v[28:31], a[228:231], v[116:119]
    s_mov_b32 m0, s56
    v_add_f32 v5, v5, v18
    v_cvt_f32_i32 v153, v153
    v_mfma_f32_16x16x32_bf16 v[120:123], v[24:27], a[248:251], v[120:123]
    ds_read_b128 v[44:47], v3 offset:18688
    v_add_f32 v5, v5, v19
    v_mfma_f32_16x16x32_bf16 v[120:123], v[28:31], a[252:255], v[120:123]
    s_waitcnt lgkmcnt(2)
    v_exp_f32 v17, v69
    v_mfma_f32_16x16x32_bf16 v[124:127], v[24:27], v[208:211], v[124:127]
    s_waitcnt vmcnt(26)
    v_cvt_f32_i32 v157, v157
    v_cvt_pk_bf16_f32 v67, v18, v19
    v_mfma_f32_16x16x32_bf16 v[124:127], v[28:31], v[212:215], v[124:127]
    s_barrier
    v_add_u32 v1, 49152, v1
    v_mfma_f32_16x16x32_bf16 v[80:83], v[32:35], a[208:211], v[80:83]
    ds_read_b128 v[24:27], v1 offset:0
    v_fma_f32 v153, v153, v48, v50
    v_mfma_f32_16x16x32_bf16 v[80:83], v[36:39], a[212:215], v[80:83]
    s_waitcnt vmcnt(12)
    buffer_load_dwordx4 v4, s[4:7], s27 offen offset:0 sc1 lds
    v_mfma_f32_16x16x32_bf16 v[84:87], v[32:35], a[232:235], v[84:87]
    v_exp_f32 v18, v70
    v_mfma_f32_16x16x32_bf16 v[84:87], v[36:39], a[236:239], v[84:87]
    v_add_f32 v6, v6, v16
    v_add_f32 v6, v6, v17
    v_mfma_f32_16x16x32_bf16 v[88:91], v[32:35], v[192:195], v[88:91]
    ds_read_b128 v[28:31], v1 offset:12288
    v_fma_f32 v157, v157, v49, v51
    v_mfma_f32_16x16x32_bf16 v[88:91], v[36:39], v[196:199], v[88:91]
    s_waitcnt vmcnt(12)
    buffer_load_dwordx4 v4, s[4:7], s27 offen offset:1024 sc1 lds
    v_mfma_f32_16x16x32_bf16 v[92:95], v[32:35], v[216:219], v[92:95]
    v_exp_f32 v19, v71
    v_mfma_f32_16x16x32_bf16 v[92:95], v[36:39], v[220:223], v[92:95]
    s_waitcnt lgkmcnt(2)
    v_cvt_pk_bf16_f32 v68, v16, v17
    v_exp_f32 v16, v100
    v_mfma_f32_16x16x32_bf16 v[112:115], v[40:43], a[208:211], v[112:115]
    ds_read_b128 v[32:35], v1 offset:1024
    v_cvt_f32_i32 v154, v154
    v_mfma_f32_16x16x32_bf16 v[112:115], v[44:47], a[212:215], v[112:115]
    s_waitcnt vmcnt(12)
    buffer_load_dwordx4 v4, s[4:7], s27 offen offset:2048 sc1 lds
    v_add_f32 v6, v6, v18
    v_mfma_f32_16x16x32_bf16 v[116:119], v[40:43], a[232:235], v[116:119]
    v_add_f32 v6, v6, v19
    v_cvt_f32_i32 v158, v158
    v_mfma_f32_16x16x32_bf16 v[116:119], v[44:47], a[236:239], v[116:119]
    v_exp_f32 v17, v101
    v_cvt_pk_bf16_f32 v69, v18, v19
    v_mfma_f32_16x16x32_bf16 v[120:123], v[40:43], v[192:195], v[120:123]
    s_add_u32 s27, s27, 24576
    ds_read_b128 v[36:39], v1 offset:13312
    v_fma_f32 v154, v154, v48, v50
    v_mfma_f32_16x16x32_bf16 v[120:123], v[44:47], v[196:199], v[120:123]
    v_exp_f32 v18, v102
    v_fma_f32 v158, v158, v49, v51
    v_mfma_f32_16x16x32_bf16 v[124:127], v[40:43], v[216:219], v[124:127]
    s_sub_u32 s58, s27, 196608
    v_add_f32 v6, v6, v16
    v_add_f32 v6, v6, v17
    v_mfma_f32_16x16x32_bf16 v[124:127], v[44:47], v[220:223], v[124:127]
    s_waitcnt lgkmcnt(2)
    v_exp_f32 v19, v103
    v_cvt_pk_bf16_f32 v144, v144, v148
    v_cvt_pk_bf16_f32 v148, v145, v149
    v_cvt_pk_bf16_f32 v70, v16, v17
    s_min_u32 s27, s27, s58
    v_cvt_pk_bf16_f32 v145, v152, v156
    v_add_f32 v6, v6, v18
    s_add_u32 s56, s56, 36864
    v_cvt_pk_bf16_f32 v149, v153, v157
    v_add_f32 v6, v6, v19
    s_sub_u32 s58, s56, 147456
    v_cvt_pk_bf16_f32 v152, v146, v150
    v_cvt_pk_bf16_f32 v71, v18, v19
    s_min_u32 s56, s56, s58
    v_cvt_pk_bf16_f32 v153, v154, v158
    s_mov_b32 s31, 6
    v_mfma_f32_16x16x32_bf16 a[0:3], v[160:163], v[24:27], a[0:3]
    s_add_u32 s33, s33, 196608
    ds_read_b128 v[40:43], v1 offset:2048
    v_mfma_f32_16x16x32_bf16 a[0:3], v[176:179], v[28:31], a[0:3]
    s_add_u32 s34, s34, 196608
    v_exp_f32 v16, v72
    v_mfma_f32_16x16x32_bf16 a[48:51], v[164:167], v[24:27], a[48:51]
    s_add_u32 s36, s36, 1536
    v_exp_f32 v17, v73
    v_mfma_f32_16x16x32_bf16 a[48:51], v[180:183], v[28:31], a[48:51]
    v_exp_f32 v18, v74
    v_mfma_f32_16x16x32_bf16 a[96:99], v[168:171], v[24:27], a[96:99]
    ds_read_b128 v[44:47], v1 offset:14336
    v_add_f32 v7, v7, v16
    v_mfma_f32_16x16x32_bf16 a[96:99], v[184:187], v[28:31], a[96:99]
    s_waitcnt vmcnt(11)
    buffer_load_dwordx2 v[56:57], v10, s[72:75], s36 offen offset:0
    v_mfma_f32_16x16x32_bf16 a[144:147], v[172:175], v[24:27], a[144:147]
    v_add_f32 v7, v7, v17
    v_mfma_f32_16x16x32_bf16 a[144:147], v[188:191], v[28:31], a[144:147]
    s_waitcnt lgkmcnt(2)
    v_exp_f32 v19, v75
    v_mfma_f32_16x16x32_bf16 a[4:7], v[160:163], v[32:35], a[4:7]
    ds_read_b128 v[24:27], v1 offset:3072
    v_cvt_pk_bf16_f32 v72, v16, v17
    v_mfma_f32_16x16x32_bf16 a[4:7], v[176:179], v[36:39], a[4:7]
    buffer_load_dwordx2 v[58:59], v10, s[76:79], s36 offen offset:0
    v_mfma_f32_16x16x32_bf16 a[52:55], v[164:167], v[32:35], a[52:55]
    v_exp_f32 v16, v104
    v_mfma_f32_16x16x32_bf16 a[52:55], v[180:183], v[36:39], a[52:55]
    v_add_f32 v7, v7, v18
    v_add_f32 v7, v7, v19
    v_mfma_f32_16x16x32_bf16 a[100:103], v[168:171], v[32:35], a[100:103]
    ds_read_b128 v[28:31], v1 offset:15360
    v_mfma_f32_16x16x32_bf16 a[100:103], v[184:187], v[36:39], a[100:103]
    s_waitcnt vmcnt(12)
    buffer_load_dwordx4 v[224:227], v9, s[64:67], s33 offen offset:0 nt
    v_mfma_f32_16x16x32_bf16 a[148:151], v[172:175], v[32:35], a[148:151]
    v_exp_f32 v17, v105
    v_mfma_f32_16x16x32_bf16 a[148:151], v[188:191], v[36:39], a[148:151]
    s_waitcnt lgkmcnt(2)
    v_cvt_pk_bf16_f32 v73, v18, v19
    v_mfma_f32_16x16x32_bf16 a[8:11], v[160:163], v[40:43], a[8:11]
    ds_read_b128 v[32:35], v1 offset:4096
    v_mfma_f32_16x16x32_bf16 a[8:11], v[176:179], v[44:47], a[8:11]
    s_waitcnt vmcnt(12)
    buffer_load_dwordx4 v[228:231], v9, s[64:67], s33 offen offset:1536 nt
    v_mfma_f32_16x16x32_bf16 a[56:59], v[164:167], v[40:43], a[56:59]
    v_exp_f32 v18, v106
    v_mfma_f32_16x16x32_bf16 a[56:59], v[180:183], v[44:47], a[56:59]
    v_add_f32 v7, v7, v16
    v_add_f32 v7, v7, v17
    v_mfma_f32_16x16x32_bf16 a[104:107], v[168:171], v[40:43], a[104:107]
    s_waitcnt vmcnt(17)
    ds_read_b128 v[36:39], v1 offset:16384
    v_lshlrev_b32 v48, 16, v60
    v_mfma_f32_16x16x32_bf16 a[104:107], v[184:187], v[44:47], a[104:107]
    buffer_load_dwordx4 v[232:235], v9, s[64:67], s34 offen offset:0 nt
    v_mfma_f32_16x16x32_bf16 a[152:155], v[172:175], v[40:43], a[152:155]
    v_exp_f32 v19, v107
    v_mfma_f32_16x16x32_bf16 a[152:155], v[188:191], v[44:47], a[152:155]
    s_waitcnt lgkmcnt(2)
    v_cvt_pk_bf16_f32 v74, v16, v17
    v_and_b32 v49, s97, v60
    v_mfma_f32_16x16x32_bf16 a[12:15], v[160:163], v[24:27], a[12:15]
    ds_read_b128 v[40:43], v1 offset:5120
    v_lshlrev_b32 v50, 16, v62
    v_mfma_f32_16x16x32_bf16 a[12:15], v[176:179], v[28:31], a[12:15]
    s_waitcnt vmcnt(13)
    buffer_load_dwordx4 v[236:239], v9, s[64:67], s34 offen offset:1536 nt
    v_mfma_f32_16x16x32_bf16 a[60:63], v[164:167], v[24:27], a[60:63]
    v_exp_f32 v16, v76
    v_mfma_f32_16x16x32_bf16 a[60:63], v[180:183], v[28:31], a[60:63]
    v_add_f32 v7, v7, v18
    v_add_f32 v7, v7, v19
    v_mfma_f32_16x16x32_bf16 a[108:111], v[168:171], v[24:27], a[108:111]
    ds_read_b128 v[44:47], v1 offset:17408
    v_and_b32 v51, s97, v62
    v_mfma_f32_16x16x32_bf16 a[108:111], v[184:187], v[28:31], a[108:111]
    v_exp_f32 v17, v77
    v_mfma_f32_16x16x32_bf16 a[156:159], v[172:175], v[24:27], a[156:159]
    s_add_u32 s29, s28, 49152
    v_cvt_pk_bf16_f32 v75, v18, v19
    v_mul_f32_e64 v50, -v50, v48
    v_mfma_f32_16x16x32_bf16 a[156:159], v[188:191], v[28:31], a[156:159]
    s_waitcnt lgkmcnt(2)
    v_exp_f32 v18, v78
    v_mfma_f32_16x16x32_bf16 a[16:19], v[160:163], v[32:35], a[16:19]
    s_mov_b32 m0, s56
    ds_read_b128 v[24:27], v1 offset:6144
    v_add_f32 v8, v8, v16
    v_mfma_f32_16x16x32_bf16 a[16:19], v[176:179], v[36:39], a[16:19]
    s_sub_u32 s3, s29, 147456
    s_waitcnt vmcnt(13)
    buffer_load_dwordx4 v4, s[4:7], s27 offen offset:0 sc1 lds
    v_mfma_f32_16x16x32_bf16 a[64:67], v[164:167], v[32:35], a[64:67]
    s_min_u32 s29, s29, s3
    v_add_f32 v8, v8, v17
    v_mul_f32_e64 v51, -v51, v49
    v_mfma_f32_16x16x32_bf16 a[64:67], v[180:183], v[36:39], a[64:67]
    v_exp_f32 v19, v79
    v_mfma_f32_16x16x32_bf16 a[112:115], v[168:171], v[32:35], a[112:115]
    ds_read_b128 v[28:31], v1 offset:18432
    v_cvt_pk_bf16_f32 v76, v16, v17
    v_mfma_f32_16x16x32_bf16 a[112:115], v[184:187], v[36:39], a[112:115]
    s_waitcnt vmcnt(13)
    buffer_load_dwordx4 v4, s[4:7], s27 offen offset:1024 sc1 lds
    v_mfma_f32_16x16x32_bf16 a[160:163], v[172:175], v[32:35], a[160:163]
    s_sub_u32 s3, s29, s28
    v_exp_f32 v16, v108
    v_mfma_f32_16x16x32_bf16 a[160:163], v[188:191], v[36:39], a[160:163]
    s_waitcnt lgkmcnt(2)
    v_add_f32 v8, v8, v18
    v_add_f32 v8, v8, v19
    v_mfma_f32_16x16x32_bf16 a[20:23], v[160:163], v[40:43], a[20:23]
    ds_read_b128 v[32:35], v1 offset:7168
    v_cvt_f32_i32 v240, v240
    v_mfma_f32_16x16x32_bf16 a[20:23], v[176:179], v[44:47], a[20:23]
    buffer_load_dword v52, v20, s[20:23], s44 offen sc1
    v_mfma_f32_16x16x32_bf16 a[68:71], v[164:167], v[40:43], a[68:71]
    v_exp_f32 v17, v109
    v_mfma_f32_16x16x32_bf16 a[68:71], v[180:183], v[44:47], a[68:71]
    v_cvt_pk_bf16_f32 v77, v18, v19
    v_cvt_f32_i32 v244, v244
    v_mfma_f32_16x16x32_bf16 a[116:119], v[168:171], v[40:43], a[116:119]
    s_mov_b32 s28, s29
    ds_read_b128 v[36:39], v1 offset:19456
    v_fma_f32 v240, v240, v48, v50
    v_mfma_f32_16x16x32_bf16 a[116:119], v[184:187], v[44:47], a[116:119]
    s_waitcnt vmcnt(14)
    buffer_load_dwordx4 v4, s[4:7], s27 offen offset:2048 sc1 lds
    v_mfma_f32_16x16x32_bf16 a[164:167], v[172:175], v[40:43], a[164:167]
    s_add_u32 s27, s27, 24576
    v_exp_f32 v18, v110
    v_mfma_f32_16x16x32_bf16 a[164:167], v[188:191], v[44:47], a[164:167]
    s_waitcnt lgkmcnt(2)
    v_add_f32 v8, v8, v16
    v_add_f32 v8, v8, v17
    v_fma_f32 v244, v244, v49, v51
    v_mfma_f32_16x16x32_bf16 a[24:27], v[160:163], v[24:27], a[24:27]
    s_sub_u32 s58, s27, 196608
    ds_read_b128 v[40:43], v1 offset:8192
    v_cvt_f32_i32 v241, v241
    v_mfma_f32_16x16x32_bf16 a[24:27], v[176:179], v[28:31], a[24:27]
    v_exp_f32 v19, v111
    v_cvt_pk_bf16_f32 v78, v16, v17
    v_mfma_f32_16x16x32_bf16 a[72:75], v[164:167], v[24:27], a[72:75]
    s_min_u32 s27, s27, s58
    v_add_f32 v8, v8, v18
    v_add_f32 v8, v8, v19
    v_mfma_f32_16x16x32_bf16 a[72:75], v[180:183], v[28:31], a[72:75]
    v_cvt_f32_i32 v245, v245
    v_cvt_pk_bf16_f32 v79, v18, v19
    v_mfma_f32_16x16x32_bf16 a[120:123], v[168:171], v[24:27], a[120:123]
    s_add_u32 s56, s56, 12288
    ds_read_b128 v[44:47], v1 offset:20480
    v_fma_f32 v241, v241, v48, v50
    v_mfma_f32_16x16x32_bf16 a[120:123], v[184:187], v[28:31], a[120:123]
    v_exp_f32 v16, v80
    v_mfma_f32_16x16x32_bf16 a[168:171], v[172:175], v[24:27], a[168:171]
    s_mov_b32 m0, s56
    v_exp_f32 v17, v81
    v_mfma_f32_16x16x32_bf16 a[168:171], v[188:191], v[28:31], a[168:171]
    s_waitcnt lgkmcnt(2)
    v_fma_f32 v245, v245, v49, v51
    v_exp_f32 v18, v82
    v_mfma_f32_16x16x32_bf16 a[28:31], v[160:163], v[32:35], a[28:31]
    ds_read_b128 v[24:27], v1 offset:9216
    v_cvt_f32_i32 v242, v242
    v_mfma_f32_16x16x32_bf16 a[28:31], v[176:179], v[36:39], a[28:31]
    v_add_f32 v5, v5, v16
    v_cvt_f32_i32 v246, v246
    v_mfma_f32_16x16x32_bf16 a[76:79], v[164:167], v[32:35], a[76:79]
    v_add_f32 v5, v5, v17
    v_fma_f32 v242, v242, v48, v50
    v_mfma_f32_16x16x32_bf16 a[76:79], v[180:183], v[36:39], a[76:79]
    s_waitcnt vmcnt(14)
    buffer_load_dwordx4 v4, s[4:7], s27 offen offset:0 sc1 lds
    v_mfma_f32_16x16x32_bf16 a[124:127], v[168:171], v[32:35], a[124:127]
    ds_read_b128 v[28:31], v1 offset:21504
    v_fma_f32 v246, v246, v49, v51
    v_mfma_f32_16x16x32_bf16 a[124:127], v[184:187], v[36:39], a[124:127]
    v_exp_f32 v19, v83
    v_cvt_pk_bf16_f32 v80, v16, v17
    v_mfma_f32_16x16x32_bf16 a[172:175], v[172:175], v[32:35], a[172:175]
    v_exp_f32 v16, v112
    v_mfma_f32_16x16x32_bf16 a[172:175], v[188:191], v[36:39], a[172:175]
    s_waitcnt lgkmcnt(2)
    s_waitcnt vmcnt(14)
    buffer_load_dwordx4 v4, s[4:7], s27 offen offset:1024 sc1 lds
    v_add_f32 v5, v5, v18
    v_mfma_f32_16x16x32_bf16 a[32:35], v[160:163], v[40:43], a[32:35]
    ds_read_b128 v[32:35], v1 offset:10240
    v_lshlrev_b32 v48, 16, v61
    v_mfma_f32_16x16x32_bf16 a[32:35], v[176:179], v[44:47], a[32:35]
    v_add_f32 v5, v5, v19
    v_exp_f32 v17, v113
    v_mfma_f32_16x16x32_bf16 a[80:83], v[164:167], v[40:43], a[80:83]
    v_and_b32 v49, s97, v61
    v_cvt_pk_bf16_f32 v81, v18, v19
    v_mfma_f32_16x16x32_bf16 a[80:83], v[180:183], v[44:47], a[80:83]
    s_waitcnt vmcnt(14)
    buffer_load_dwordx4 v4, s[4:7], s27 offen offset:2048 sc1 lds
    v_lshlrev_b32 v50, 16, v63
    v_mfma_f32_16x16x32_bf16 a[128:131], v[168:171], v[40:43], a[128:131]
    ds_read_b128 v[36:39], v1 offset:22528
    v_and_b32 v51, s97, v63
    v_mfma_f32_16x16x32_bf16 a[128:131], v[184:187], v[44:47], a[128:131]
    v_exp_f32 v18, v114
    v_add_f32 v5, v5, v16
    v_mfma_f32_16x16x32_bf16 a[176:179], v[172:175], v[40:43], a[176:179]
    v_add_u32 v2, s3, v2
    v_add_u32 v3, s3, v3
    v_mfma_f32_16x16x32_bf16 a[176:179], v[188:191], v[44:47], a[176:179]
    s_waitcnt lgkmcnt(2)
    v_add_f32 v5, v5, v17
    v_exp_f32 v19, v115
    v_mfma_f32_16x16x32_bf16 a[36:39], v[160:163], v[24:27], a[36:39]
    ds_read_b128 v[40:43], v1 offset:11264
    v_mul_f32_e64 v50, -v50, v48
    v_mfma_f32_16x16x32_bf16 a[36:39], v[176:179], v[28:31], a[36:39]
    v_cvt_pk_bf16_f32 v82, v16, v17
    v_mul_f32_e64 v51, -v51, v49
    v_mfma_f32_16x16x32_bf16 a[84:87], v[164:167], v[24:27], a[84:87]
    v_exp_f32 v16, v84
    v_mfma_f32_16x16x32_bf16 a[84:87], v[180:183], v[28:31], a[84:87]
    v_cvt_f32_i32 v248, v248
    v_add_f32 v5, v5, v18
    v_cvt_f32_i32 v252, v252
    v_mfma_f32_16x16x32_bf16 a[132:135], v[168:171], v[24:27], a[132:135]
    s_mov_b32 s27, 208896
    ds_read_b128 v[44:47], v1 offset:23552
    v_add_f32 v5, v5, v19
    v_mfma_f32_16x16x32_bf16 a[132:135], v[184:187], v[28:31], a[132:135]
    s_waitcnt lgkmcnt(2)
    v_exp_f32 v17, v85
    v_fma_f32 v248, v248, v48, v50
    v_mfma_f32_16x16x32_bf16 a[180:183], v[172:175], v[24:27], a[180:183]
    s_waitcnt vmcnt(19)
    v_cvt_pk_bf16_f32 v83, v18, v19
    v_fma_f32 v252, v252, v49, v51
    v_mfma_f32_16x16x32_bf16 a[180:183], v[188:191], v[28:31], a[180:183]
    s_barrier
    v_exp_f32 v18, v86
    v_mfma_f32_16x16x32_bf16 a[40:43], v[160:163], v[32:35], a[40:43]
    s_add_u32 s56, s56, 36864
    ds_read_b128 v[24:27], v2 offset:0
    v_cvt_f32_i32 v249, v249
    v_mfma_f32_16x16x32_bf16 a[40:43], v[176:179], v[36:39], a[40:43]
    s_sub_u32 s58, s56, 147456
    v_add_f32 v6, v6, v16
    v_add_f32 v6, v6, v17
    v_mfma_f32_16x16x32_bf16 a[88:91], v[164:167], v[32:35], a[88:91]
    s_min_u32 s56, s56, s58
    v_cvt_f32_i32 v253, v253
    v_fma_f32 v249, v249, v48, v50
    v_mfma_f32_16x16x32_bf16 a[88:91], v[180:183], v[36:39], a[88:91]
    v_exp_f32 v19, v87
    v_mfma_f32_16x16x32_bf16 a[136:139], v[168:171], v[32:35], a[136:139]
    ds_read_b128 v[28:31], v3 offset:0
    v_cvt_pk_bf16_f32 v84, v16, v17
    v_mfma_f32_16x16x32_bf16 a[136:139], v[184:187], v[36:39], a[136:139]
    v_exp_f32 v16, v116
    v_mfma_f32_16x16x32_bf16 a[184:187], v[172:175], v[32:35], a[184:187]
    v_fma_f32 v253, v253, v49, v51
    v_add_f32 v6, v6, v18
    v_mfma_f32_16x16x32_bf16 a[184:187], v[188:191], v[36:39], a[184:187]
    s_waitcnt lgkmcnt(2)
    v_cvt_f32_i32 v250, v250
    v_add_f32 v6, v6, v19
    v_mfma_f32_16x16x32_bf16 a[44:47], v[160:163], v[40:43], a[44:47]
    ds_read_b128 v[32:35], v2 offset:6144
    v_cvt_f32_i32 v254, v254
    v_mfma_f32_16x16x32_bf16 a[44:47], v[176:179], v[44:47], a[44:47]
    v_exp_f32 v17, v117
    v_mfma_f32_16x16x32_bf16 a[92:95], v[164:167], v[40:43], a[92:95]
    v_cvt_pk_bf16_f32 v85, v18, v19
    v_fma_f32 v250, v250, v48, v50
    v_mfma_f32_16x16x32_bf16 a[92:95], v[180:183], v[44:47], a[92:95]
    v_exp_f32 v18, v118
    v_mfma_f32_16x16x32_bf16 a[140:143], v[168:171], v[40:43], a[140:143]
    s_nop 0
    ds_read_b128 v[36:39], v3 offset:6144
    v_fma_f32 v254, v254, v49, v51
    v_mfma_f32_16x16x32_bf16 a[140:143], v[184:187], v[44:47], a[140:143]
    v_add_f32 v6, v6, v16
    v_add_f32 v6, v6, v17
    v_mfma_f32_16x16x32_bf16 a[188:191], v[172:175], v[40:43], a[188:191]
    s_waitcnt lgkmcnt(2)
    v_exp_f32 v19, v119
    v_cvt_pk_bf16_f32 v146, v240, v244
    v_cvt_pk_bf16_f32 v150, v241, v245
    v_cvt_pk_bf16_f32 v86, v16, v17
    v_cvt_pk_bf16_f32 v147, v248, v252
    v_add_f32 v6, v6, v18
    v_cvt_pk_bf16_f32 v151, v249, v253
    v_add_f32 v6, v6, v19
    v_cvt_pk_bf16_f32 v154, v242, v246
    v_cvt_pk_bf16_f32 v87, v18, v19
    v_cvt_pk_bf16_f32 v155, v250, v254
    v_mfma_f32_16x16x32_bf16 a[188:191], v[188:191], v[44:47], a[188:191]
    s_branch L_join
.p2align 6
L_loop:
    v_mfma_f32_16x16x32_bf16 v[160:163], v[24:27], a[192:195], v[128:131]
    s_mov_b32 m0, s56
    ds_read_b128 v[40:43], v2 offset:128
    v_cvt_f32_i32 v247, v247
    v_mfma_f32_16x16x32_bf16 v[160:163], v[28:31], a[196:199], v[160:163]
    buffer_load_dwordx4 v4, s[4:7], s27 offen offset:0 sc1 lds
    v_mfma_f32_16x16x32_bf16 v[164:167], v[24:27], a[216:219], v[132:135]
    v_exp_f32 v16, v88
    v_mfma_f32_16x16x32_bf16 v[164:167], v[28:31], a[220:223], v[164:167]
    v_exp_f32 v17, v89
    v_mfma_f32_16x16x32_bf16 v[168:171], v[24:27], a[240:243], v[136:139]
    ds_read_b128 v[44:47], v3 offset:128
    v_fma_f32 v246, v246, v48, v50
    v_mfma_f32_16x16x32_bf16 v[168:171], v[28:31], a[244:247], v[168:171]
    v_exp_f32 v18, v90
    v_mfma_f32_16x16x32_bf16 v[172:175], v[24:27], v[200:203], v[140:143]
    v_fma_f32 v247, v247, v49, v51
    v_add_f32 v7, v7, v16
    v_mfma_f32_16x16x32_bf16 v[172:175], v[28:31], v[204:207], v[172:175]
    s_waitcnt lgkmcnt(2)
    v_add_f32 v7, v7, v17
    v_cvt_pk_bf16_f32 v231, v246, v247
    v_mfma_f32_16x16x32_bf16 v[96:99], v[32:35], a[192:195], v[128:131]
    ds_read_b128 v[24:27], v2 offset:6272
    v_cvt_f32_i32 v250, v250
    v_mfma_f32_16x16x32_bf16 v[96:99], v[36:39], a[196:199], v[96:99]
    buffer_load_dwordx4 v4, s[4:7], s27 offen offset:1024 sc1 lds
    v_mfma_f32_16x16x32_bf16 v[100:103], v[32:35], a[216:219], v[132:135]
    v_exp_f32 v19, v91
    v_mfma_f32_16x16x32_bf16 v[100:103], v[36:39], a[220:223], v[100:103]
    v_cvt_pk_bf16_f32 v88, v16, v17
    v_cvt_f32_i32 v251, v251
    v_mfma_f32_16x16x32_bf16 v[104:107], v[32:35], a[240:243], v[136:139]
    ds_read_b128 v[28:31], v3 offset:6272
    v_fma_f32 v250, v250, v48, v50
    v_mfma_f32_16x16x32_bf16 v[104:107], v[36:39], a[244:247], v[104:107]
    v_exp_f32 v16, v120
    v_mfma_f32_16x16x32_bf16 v[108:111], v[32:35], v[200:203], v[140:143]
    v_add_f32 v7, v7, v18
    v_add_f32 v7, v7, v19
    v_mfma_f32_16x16x32_bf16 v[108:111], v[36:39], v[204:207], v[108:111]
    s_waitcnt lgkmcnt(2)
    v_exp_f32 v17, v121
    v_mfma_f32_16x16x32_bf16 v[160:163], v[40:43], a[200:203], v[160:163]
    ds_read_b128 v[32:35], v2 offset:256
    v_cvt_pk_bf16_f32 v89, v18, v19
    v_mfma_f32_16x16x32_bf16 v[160:163], v[44:47], a[204:207], v[160:163]
    v_exp_f32 v18, v122
    v_mfma_f32_16x16x32_bf16 v[164:167], v[40:43], a[224:227], v[164:167]
    v_fma_f32 v251, v251, v49, v51
    v_add_f32 v7, v7, v16
    v_mfma_f32_16x16x32_bf16 v[164:167], v[44:47], a[228:231], v[164:167]
    buffer_load_dwordx4 v4, s[4:7], s27 offen offset:2048 sc1 lds
    v_mfma_f32_16x16x32_bf16 v[168:171], v[40:43], a[248:251], v[168:171]
    ds_read_b128 v[36:39], v3 offset:256
    v_cvt_pk_bf16_f32 v235, v250, v251
    v_mfma_f32_16x16x32_bf16 v[168:171], v[44:47], a[252:255], v[168:171]
    v_add_f32 v7, v7, v17
    v_cvt_f32_i32 v254, v254
    v_mfma_f32_16x16x32_bf16 v[172:175], v[40:43], v[208:211], v[172:175]
    v_exp_f32 v19, v123
    v_mfma_f32_16x16x32_bf16 v[172:175], v[44:47], v[212:215], v[172:175]
    s_waitcnt lgkmcnt(2)
    v_cvt_pk_bf16_f32 v90, v16, v17
    v_cvt_f32_i32 v255, v255
    v_mfma_f32_16x16x32_bf16 v[96:99], v[24:27], a[200:203], v[96:99]
    ds_read_b128 v[40:43], v2 offset:6400
    v_fma_f32 v254, v254, v48, v50
    v_mfma_f32_16x16x32_bf16 v[96:99], v[28:31], a[204:207], v[96:99]
    s_add_u32 s27, s27, 24576
    v_exp_f32 v16, v92
    v_mfma_f32_16x16x32_bf16 v[100:103], v[24:27], a[224:227], v[100:103]
    v_add_f32 v7, v7, v18
    v_add_f32 v7, v7, v19
    v_mfma_f32_16x16x32_bf16 v[100:103], v[28:31], a[228:231], v[100:103]
    v_exp_f32 v17, v93
    v_mfma_f32_16x16x32_bf16 v[104:107], v[24:27], a[248:251], v[104:107]
    ds_read_b128 v[44:47], v3 offset:6400
    v_fma_f32 v255, v255, v49, v51
    v_mfma_f32_16x16x32_bf16 v[104:107], v[28:31], a[252:255], v[104:107]
    v_cvt_pk_bf16_f32 v91, v18, v19
    v_cvt_pk_bf16_f32 v239, v254, v255
    v_mfma_f32_16x16x32_bf16 v[108:111], v[24:27], v[208:211], v[108:111]
    s_add_u32 s29, s30, 49152
    v_exp_f32 v18, v94
    v_mfma_f32_16x16x32_bf16 v[108:111], v[28:31], v[212:215], v[108:111]
    s_waitcnt lgkmcnt(2)
    v_add_f32 v8, v8, v16
    v_add_f32 v8, v8, v17
    v_mfma_f32_16x16x32_bf16 v[160:163], v[32:35], a[208:211], v[160:163]
    s_waitcnt vmcnt(11)
    ds_read_b128 v[24:27], v2 offset:12288
    v_lshlrev_b32 v48, 16, v56
    v_mfma_f32_16x16x32_bf16 v[160:163], v[36:39], a[212:215], v[160:163]
    s_sub_u32 s3, s29, 147456
    buffer_load_dwordx2 v[60:61], off, s[80:83], s37 offset:8
    v_mfma_f32_16x16x32_bf16 v[164:167], v[32:35], a[232:235], v[164:167]
    s_add_u32 s56, s56, 12288
    v_exp_f32 v19, v95
    v_mfma_f32_16x16x32_bf16 v[164:167], v[36:39], a[236:239], v[164:167]
    s_min_u32 s29, s29, s3
    v_cvt_pk_bf16_f32 v92, v16, v17
    v_and_b32 v49, s97, v56
    v_mfma_f32_16x16x32_bf16 v[168:171], v[32:35], v[192:195], v[168:171]
    s_mov_b32 m0, s56
    ds_read_b128 v[28:31], v3 offset:12288
    v_mfma_f32_16x16x32_bf16 v[168:171], v[36:39], v[196:199], v[168:171]
    buffer_load_dwordx2 v[62:63], off, s[84:87], s37 offset:8
    v_mfma_f32_16x16x32_bf16 v[172:175], v[32:35], v[216:219], v[172:175]
    v_exp_f32 v16, v124
    v_mfma_f32_16x16x32_bf16 v[172:175], v[36:39], v[220:223], v[172:175]
    s_waitcnt lgkmcnt(2)
    v_add_f32 v8, v8, v18
    v_add_f32 v8, v8, v19
    v_mfma_f32_16x16x32_bf16 v[96:99], v[40:43], a[208:211], v[96:99]
    ds_read_b128 v[32:35], v2 offset:18432
    v_lshlrev_b32 v50, 16, v58
    v_mfma_f32_16x16x32_bf16 v[96:99], v[44:47], a[212:215], v[96:99]
    s_sub_u32 s3, s29, s30
    v_exp_f32 v17, v125
    v_mfma_f32_16x16x32_bf16 v[100:103], v[40:43], a[232:235], v[100:103]
    v_cvt_pk_bf16_f32 v93, v18, v19
    v_mfma_f32_16x16x32_bf16 v[100:103], v[44:47], a[236:239], v[100:103]
    buffer_load_dwordx4 v4, s[4:7], s27 offen offset:0 sc1 lds
    v_mfma_f32_16x16x32_bf16 v[104:107], v[40:43], v[192:195], v[104:107]
    ds_read_b128 v[36:39], v3 offset:18432
    v_mfma_f32_16x16x32_bf16 v[104:107], v[44:47], v[196:199], v[104:107]
    v_exp_f32 v18, v126
    v_mfma_f32_16x16x32_bf16 v[108:111], v[40:43], v[216:219], v[108:111]
    v_add_f32 v8, v8, v16
    v_add_f32 v8, v8, v17
    v_mfma_f32_16x16x32_bf16 v[108:111], v[44:47], v[220:223], v[108:111]
    s_waitcnt lgkmcnt(2)
    buffer_load_dwordx3 v[240:242], v12, s[68:71], s16 offen offset:0 nt
    v_mfma_f32_16x16x32_bf16 v[176:179], v[24:27], a[192:195], v[128:131]
    ds_read_b128 v[40:43], v2 offset:12416
    v_and_b32 v51, s97, v58
    v_mfma_f32_16x16x32_bf16 v[176:179], v[28:31], a[196:199], v[176:179]
    v_exp_f32 v19, v127
    v_cvt_pk_bf16_f32 v94, v16, v17
    v_mfma_f32_16x16x32_bf16 v[180:183], v[24:27], a[216:219], v[132:135]
    s_mov_b32 s30, s29
    v_add_f32 v8, v8, v18
    v_add_f32 v8, v8, v19
    v_mfma_f32_16x16x32_bf16 v[180:183], v[28:31], a[220:223], v[180:183]
    buffer_load_dwordx4 v4, s[4:7], s27 offen offset:1024 sc1 lds
    v_mfma_f32_16x16x32_bf16 v[184:187], v[24:27], a[240:243], v[136:139]
    ds_read_b128 v[44:47], v3 offset:12416
    v_cvt_pk_bf16_f32 v95, v18, v19
    v_mfma_f32_16x16x32_bf16 v[184:187], v[28:31], a[244:247], v[184:187]
    v_exp_f32 v16, v160
    v_mfma_f32_16x16x32_bf16 v[188:191], v[24:27], v[200:203], v[140:143]
    v_exp_f32 v17, v161
    v_mfma_f32_16x16x32_bf16 v[188:191], v[28:31], v[204:207], v[188:191]
    s_waitcnt lgkmcnt(2)
    buffer_load_dwordx3 v[244:246], v12, s[68:71], s16 offen offset:768 nt
    v_mfma_f32_16x16x32_bf16 v[112:115], v[32:35], a[192:195], v[128:131]
    ds_read_b128 v[24:27], v2 offset:18560
    v_mul_f32_e64 v50, -v50, v48
    v_mfma_f32_16x16x32_bf16 v[112:115], v[36:39], a[196:199], v[112:115]
    v_exp_f32 v18, v162
    v_mfma_f32_16x16x32_bf16 v[116:119], v[32:35], a[216:219], v[132:135]
    v_add_f32 v5, v5, v16
    v_add_f32 v5, v5, v17
    v_mfma_f32_16x16x32_bf16 v[116:119], v[36:39], a[220:223], v[116:119]
    v_exp_f32 v19, v163
    v_mfma_f32_16x16x32_bf16 v[120:123], v[32:35], a[240:243], v[136:139]
    ds_read_b128 v[28:31], v3 offset:18560
    v_cvt_pk_bf16_f32 v160, v16, v17
    v_mfma_f32_16x16x32_bf16 v[120:123], v[36:39], a[244:247], v[120:123]
    buffer_load_dwordx3 v[248:250], v12, s[68:71], s16 offen offset:1536 nt
    v_mfma_f32_16x16x32_bf16 v[124:127], v[32:35], v[200:203], v[140:143]
    v_exp_f32 v16, v96
    v_mfma_f32_16x16x32_bf16 v[124:127], v[36:39], v[204:207], v[124:127]
    s_waitcnt lgkmcnt(2)
    v_add_f32 v5, v5, v18
    v_add_f32 v5, v5, v19
    v_mfma_f32_16x16x32_bf16 v[176:179], v[40:43], a[200:203], v[176:179]
    ds_read_b128 v[32:35], v2 offset:12544
    v_mul_f32_e64 v51, -v51, v49
    v_mfma_f32_16x16x32_bf16 v[176:179], v[44:47], a[204:207], v[176:179]
    buffer_load_dwordx4 v4, s[4:7], s27 offen offset:2048 sc1 lds
    v_mfma_f32_16x16x32_bf16 v[180:183], v[40:43], a[224:227], v[180:183]
    v_exp_f32 v17, v97
    v_mfma_f32_16x16x32_bf16 v[180:183], v[44:47], a[228:231], v[180:183]
    v_cvt_pk_bf16_f32 v161, v18, v19
    v_add_u32 v1, s3, v1
    v_mfma_f32_16x16x32_bf16 v[184:187], v[40:43], a[248:251], v[184:187]
    ds_read_b128 v[36:39], v3 offset:12544
    v_cvt_f32_i32 v144, v144
    v_mfma_f32_16x16x32_bf16 v[184:187], v[44:47], a[252:255], v[184:187]
    buffer_load_dwordx3 v[252:254], v12, s[68:71], s16 offen offset:2304 nt
    v_mfma_f32_16x16x32_bf16 v[188:191], v[40:43], v[208:211], v[188:191]
    v_exp_f32 v18, v98
    v_mfma_f32_16x16x32_bf16 v[188:191], v[44:47], v[212:215], v[188:191]
    s_waitcnt lgkmcnt(2)
    v_add_f32 v5, v5, v16
    v_add_f32 v5, v5, v17
    v_mfma_f32_16x16x32_bf16 v[112:115], v[24:27], a[200:203], v[112:115]
    ds_read_b128 v[40:43], v2 offset:18688
    v_cvt_f32_i32 v148, v148
    v_mfma_f32_16x16x32_bf16 v[112:115], v[28:31], a[204:207], v[112:115]
    v_exp_f32 v19, v99
    v_cvt_pk_bf16_f32 v162, v16, v17
    v_mfma_f32_16x16x32_bf16 v[116:119], v[24:27], a[224:227], v[116:119]
    v_exp_f32 v16, v164
    v_mfma_f32_16x16x32_bf16 v[116:119], v[28:31], a[228:231], v[116:119]
    s_add_u32 s27, s27, 24576
    v_add_f32 v5, v5, v18
    v_add_f32 v5, v5, v19
    v_mfma_f32_16x16x32_bf16 v[120:123], v[24:27], a[248:251], v[120:123]
    s_add_u32 s56, s56, 36864
    ds_read_b128 v[44:47], v3 offset:18688
    v_fma_f32 v144, v144, v48, v50
    v_mfma_f32_16x16x32_bf16 v[120:123], v[28:31], a[252:255], v[120:123]
    s_waitcnt lgkmcnt(2)
    v_exp_f32 v17, v165
    v_mfma_f32_16x16x32_bf16 v[124:127], v[24:27], v[208:211], v[124:127]
    s_waitcnt vmcnt(12)
    v_cvt_pk_bf16_f32 v163, v18, v19
    s_sub_u32 s58, s56, 147456
    v_mfma_f32_16x16x32_bf16 v[124:127], v[28:31], v[212:215], v[124:127]
    s_barrier
    s_min_u32 s56, s56, s58
    v_mfma_f32_16x16x32_bf16 v[176:179], v[32:35], a[208:211], v[176:179]
    ds_read_b128 v[24:27], v1 offset:0
    v_mfma_f32_16x16x32_bf16 v[176:179], v[36:39], a[212:215], v[176:179]
    v_exp_f32 v18, v166
    v_mfma_f32_16x16x32_bf16 v[180:183], v[32:35], a[232:235], v[180:183]
    v_add_f32 v6, v6, v16
    v_add_f32 v6, v6, v17
    v_mfma_f32_16x16x32_bf16 v[180:183], v[36:39], a[236:239], v[180:183]
    v_exp_f32 v19, v167
    v_mfma_f32_16x16x32_bf16 v[184:187], v[32:35], v[192:195], v[184:187]
    ds_read_b128 v[28:31], v1 offset:12288
    v_cvt_pk_bf16_f32 v164, v16, v17
    v_mfma_f32_16x16x32_bf16 v[184:187], v[36:39], v[196:199], v[184:187]
L_iw3:
L_pg3:
    s_cbranch_execz L_pg7
    v_exp_f32 v16, v100
    v_mfma_f32_16x16x32_bf16 v[188:191], v[32:35], v[216:219], v[188:191]
    v_add_f32 v6, v6, v18
    v_add_f32 v6, v6, v19
    v_mfma_f32_16x16x32_bf16 v[188:191], v[36:39], v[220:223], v[188:191]
    s_waitcnt lgkmcnt(2)
    v_exp_f32 v17, v101
    v_mfma_f32_16x16x32_bf16 v[112:115], v[40:43], a[208:211], v[112:115]
    ds_read_b128 v[32:35], v1 offset:1024
    v_cvt_pk_bf16_f32 v165, v18, v19
    v_mfma_f32_16x16x32_bf16 v[112:115], v[44:47], a[212:215], v[112:115]
    v_exp_f32 v18, v102
    v_mfma_f32_16x16x32_bf16 v[116:119], v[40:43], a[232:235], v[116:119]
    v_add_f32 v6, v6, v16
    v_add_f32 v6, v6, v17
    v_mfma_f32_16x16x32_bf16 v[116:119], v[44:47], a[236:239], v[116:119]
    v_exp_f32 v19, v103
    v_mfma_f32_16x16x32_bf16 v[120:123], v[40:43], v[192:195], v[120:123]
    ds_read_b128 v[36:39], v1 offset:13312
    v_cvt_pk_bf16_f32 v166, v16, v17
    v_mfma_f32_16x16x32_bf16 v[120:123], v[44:47], v[196:199], v[120:123]
    v_add_f32 v6, v6, v18
    v_fma_f32 v148, v148, v49, v51
    v_mfma_f32_16x16x32_bf16 v[124:127], v[40:43], v[216:219], v[124:127]
    v_add_f32 v6, v6, v19
    v_cvt_pk_bf16_f32 v167, v18, v19
    v_mfma_f32_16x16x32_bf16 v[124:127], v[44:47], v[220:223], v[124:127]
    s_waitcnt lgkmcnt(2)
    v_mfma_f32_16x16x32_bf16 a[0:3], v[64:67], v[24:27], a[0:3]
    ds_read_b128 v[40:43], v1 offset:2048
    v_cvt_f32_i32 v145, v145
    v_mfma_f32_16x16x32_bf16 a[0:3], v[80:83], v[28:31], a[0:3]
    buffer_store_dwordx4 v[224:227], v11, s[4:7], s33 offen offset:0 sc1
    v_mfma_f32_16x16x32_bf16 a[48:51], v[68:71], v[24:27], a[48:51]
    v_exp_f32 v16, v168
    v_mfma_f32_16x16x32_bf16 a[48:51], v[84:87], v[28:31], a[48:51]
    v_exp_f32 v17, v169
    v_mfma_f32_16x16x32_bf16 a[96:99], v[72:75], v[24:27], a[96:99]
    ds_read_b128 v[44:47], v1 offset:14336
    v_cvt_f32_i32 v149, v149
    v_mfma_f32_16x16x32_bf16 a[96:99], v[88:91], v[28:31], a[96:99]
    v_exp_f32 v18, v170
    v_mfma_f32_16x16x32_bf16 a[144:147], v[76:79], v[24:27], a[144:147]
    v_add_f32 v7, v7, v16
    v_add_f32 v7, v7, v17
    v_mfma_f32_16x16x32_bf16 a[144:147], v[92:95], v[28:31], a[144:147]
    s_waitcnt lgkmcnt(2)
    v_exp_f32 v19, v171
    v_mfma_f32_16x16x32_bf16 a[4:7], v[64:67], v[32:35], a[4:7]
    ds_read_b128 v[24:27], v1 offset:3072
    v_cvt_pk_bf16_f32 v168, v16, v17
    v_mfma_f32_16x16x32_bf16 a[4:7], v[80:83], v[36:39], a[4:7]
    buffer_store_dwordx4 v[228:231], v21, s[4:7], s33 offen offset:768 sc1
    v_mfma_f32_16x16x32_bf16 a[52:55], v[68:71], v[32:35], a[52:55]
    v_exp_f32 v16, v104
    v_mfma_f32_16x16x32_bf16 a[52:55], v[84:87], v[36:39], a[52:55]
    v_add_f32 v7, v7, v18
    v_fma_f32 v145, v145, v48, v50
    v_mfma_f32_16x16x32_bf16 a[100:103], v[72:75], v[32:35], a[100:103]
    ds_read_b128 v[28:31], v1 offset:15360
    v_add_f32 v7, v7, v19
    v_mfma_f32_16x16x32_bf16 a[100:103], v[88:91], v[36:39], a[100:103]
    v_exp_f32 v17, v105
    v_mfma_f32_16x16x32_bf16 a[148:151], v[76:79], v[32:35], a[148:151]
    v_cvt_pk_bf16_f32 v169, v18, v19
    v_fma_f32 v149, v149, v49, v51
    v_mfma_f32_16x16x32_bf16 a[148:151], v[92:95], v[36:39], a[148:151]
    s_waitcnt lgkmcnt(2)
    v_exp_f32 v18, v106
    v_mfma_f32_16x16x32_bf16 a[8:11], v[64:67], v[40:43], a[8:11]
    ds_read_b128 v[32:35], v1 offset:4096
    v_add_f32 v7, v7, v16
    v_mfma_f32_16x16x32_bf16 a[8:11], v[80:83], v[44:47], a[8:11]
    buffer_store_dwordx4 v[232:235], v22, s[4:7], s33 offen offset:1536 sc1
    v_mfma_f32_16x16x32_bf16 a[56:59], v[68:71], v[40:43], a[56:59]
    v_add_f32 v7, v7, v17
    v_cvt_f32_i32 v146, v146
    v_mfma_f32_16x16x32_bf16 a[56:59], v[84:87], v[44:47], a[56:59]
    v_exp_f32 v19, v107
    v_mfma_f32_16x16x32_bf16 a[104:107], v[72:75], v[40:43], a[104:107]
    ds_read_b128 v[36:39], v1 offset:16384
    v_cvt_pk_bf16_f32 v170, v16, v17
    v_mfma_f32_16x16x32_bf16 a[104:107], v[88:91], v[44:47], a[104:107]
    v_exp_f32 v16, v172
    v_mfma_f32_16x16x32_bf16 a[152:155], v[76:79], v[40:43], a[152:155]
    v_add_f32 v7, v7, v18
    v_cvt_f32_i32 v150, v150
    v_mfma_f32_16x16x32_bf16 a[152:155], v[92:95], v[44:47], a[152:155]
    s_waitcnt lgkmcnt(2)
    v_add_f32 v7, v7, v19
    v_fma_f32 v146, v146, v48, v50
    v_mfma_f32_16x16x32_bf16 a[12:15], v[64:67], v[24:27], a[12:15]
    ds_read_b128 v[40:43], v1 offset:5120
    v_mfma_f32_16x16x32_bf16 a[12:15], v[80:83], v[28:31], a[12:15]
    buffer_store_dwordx4 v[236:239], v23, s[4:7], s33 offen offset:2304 sc1
    v_mfma_f32_16x16x32_bf16 a[60:63], v[68:71], v[24:27], a[60:63]
    v_exp_f32 v17, v173
    v_mfma_f32_16x16x32_bf16 a[60:63], v[84:87], v[28:31], a[60:63]
    v_cvt_pk_bf16_f32 v171, v18, v19
    v_fma_f32 v150, v150, v49, v51
    v_mfma_f32_16x16x32_bf16 a[108:111], v[72:75], v[24:27], a[108:111]
    ds_read_b128 v[44:47], v1 offset:17408
    v_mfma_f32_16x16x32_bf16 a[108:111], v[88:91], v[28:31], a[108:111]
    v_exp_f32 v18, v174
    v_mfma_f32_16x16x32_bf16 a[156:159], v[76:79], v[24:27], a[156:159]
    s_add_u32 s29, s28, 49152
    v_add_f32 v8, v8, v16
    v_add_f32 v8, v8, v17
    v_mfma_f32_16x16x32_bf16 a[156:159], v[92:95], v[28:31], a[156:159]
    s_waitcnt lgkmcnt(2)
    v_exp_f32 v19, v175
    v_mfma_f32_16x16x32_bf16 a[16:19], v[64:67], v[32:35], a[16:19]
    s_sub_u32 s3, s29, 147456
    ds_read_b128 v[24:27], v1 offset:6144
    v_cvt_pk_bf16_f32 v172, v16, v17
    v_mfma_f32_16x16x32_bf16 a[16:19], v[80:83], v[36:39], a[16:19]
    s_mov_b32 m0, s26
    v_exp_f32 v16, v108
    v_mfma_f32_16x16x32_bf16 a[64:67], v[68:71], v[32:35], a[64:67]
    s_min_u32 s29, s29, s3
    v_add_f32 v8, v8, v18
    v_lshlrev_b32 v48, 16, v57
    v_mfma_f32_16x16x32_bf16 a[64:67], v[84:87], v[36:39], a[64:67]
    buffer_load_dwordx4 v4, s[4:7], s32 offen offset:0 sc1 lds
    v_mfma_f32_16x16x32_bf16 a[112:115], v[72:75], v[32:35], a[112:115]
    ds_read_b128 v[28:31], v1 offset:18432
    v_add_f32 v8, v8, v19
    v_mfma_f32_16x16x32_bf16 a[112:115], v[88:91], v[36:39], a[112:115]
    v_exp_f32 v17, v109
    v_mfma_f32_16x16x32_bf16 a[160:163], v[76:79], v[32:35], a[160:163]
    v_cvt_pk_bf16_f32 v173, v18, v19
    v_and_b32 v49, s97, v57
    v_mfma_f32_16x16x32_bf16 a[160:163], v[92:95], v[36:39], a[160:163]
    s_waitcnt lgkmcnt(2)
    buffer_load_dwordx4 v4, s[4:7], s32 offen offset:1024 sc1 lds
    v_mfma_f32_16x16x32_bf16 a[20:23], v[64:67], v[40:43], a[20:23]
    s_sub_u32 s3, s29, s28
    ds_read_b128 v[32:35], v1 offset:7168
    v_lshlrev_b32 v50, 16, v59
    v_mfma_f32_16x16x32_bf16 a[20:23], v[80:83], v[44:47], a[20:23]
    v_exp_f32 v18, v110
    v_mfma_f32_16x16x32_bf16 a[68:71], v[68:71], v[40:43], a[68:71]
    v_add_f32 v8, v8, v16
    v_add_f32 v8, v8, v17
    v_mfma_f32_16x16x32_bf16 a[68:71], v[84:87], v[44:47], a[68:71]
    buffer_load_dwordx4 v4, s[4:7], s32 offen offset:2048 sc1 lds
    v_mfma_f32_16x16x32_bf16 a[116:119], v[72:75], v[40:43], a[116:119]
    ds_read_b128 v[36:39], v1 offset:19456
    v_mfma_f32_16x16x32_bf16 a[116:119], v[88:91], v[44:47], a[116:119]
    v_exp_f32 v19, v111
    v_mfma_f32_16x16x32_bf16 a[164:167], v[76:79], v[40:43], a[164:167]
    s_mov_b32 s28, s29
    v_cvt_pk_bf16_f32 v174, v16, v17
    v_add_f32 v8, v8, v18
    v_mfma_f32_16x16x32_bf16 a[164:167], v[92:95], v[44:47], a[164:167]
    s_waitcnt lgkmcnt(2)
    v_add_f32 v8, v8, v19
    v_cvt_pk_bf16_f32 v175, v18, v19
    v_mfma_f32_16x16x32_bf16 a[24:27], v[64:67], v[24:27], a[24:27]
    s_add_u32 s32, s32, 24576
    ds_read_b128 v[40:43], v1 offset:8192
    v_and_b32 v51, s97, v59
    v_mfma_f32_16x16x32_bf16 a[24:27], v[80:83], v[28:31], a[24:27]
    v_exp_f32 v16, v176
    v_mfma_f32_16x16x32_bf16 a[72:75], v[68:71], v[24:27], a[72:75]
    s_add_u32 s26, s26, 12288
    v_exp_f32 v17, v177
    v_mfma_f32_16x16x32_bf16 a[72:75], v[84:87], v[28:31], a[72:75]
    v_exp_f32 v18, v178
    v_mfma_f32_16x16x32_bf16 a[120:123], v[72:75], v[24:27], a[120:123]
    s_mov_b32 m0, s26
    ds_read_b128 v[44:47], v1 offset:20480
    v_add_f32 v5, v5, v16
    v_mfma_f32_16x16x32_bf16 a[120:123], v[88:91], v[28:31], a[120:123]
    v_add_f32 v5, v5, v17
    v_mul_f32_e64 v50, -v50, v48
    v_mfma_f32_16x16x32_bf16 a[168:171], v[76:79], v[24:27], a[168:171]
    v_exp_f32 v19, v179
    v_mfma_f32_16x16x32_bf16 a[168:171], v[92:95], v[28:31], a[168:171]
    s_waitcnt lgkmcnt(2)
    v_cvt_pk_bf16_f32 v176, v16, v17
    v_mul_f32_e64 v51, -v51, v49
    v_mfma_f32_16x16x32_bf16 a[28:31], v[64:67], v[32:35], a[28:31]
    ds_read_b128 v[24:27], v1 offset:9216
    v_add_u32 v2, s3, v2
    v_mfma_f32_16x16x32_bf16 a[28:31], v[80:83], v[36:39], a[28:31]
    buffer_load_dwordx4 v4, s[4:7], s32 offen offset:0 sc1 lds
    v_mfma_f32_16x16x32_bf16 a[76:79], v[68:71], v[32:35], a[76:79]
    v_exp_f32 v16, v112
    v_mfma_f32_16x16x32_bf16 a[76:79], v[84:87], v[36:39], a[76:79]
    v_add_f32 v5, v5, v18
    v_add_f32 v5, v5, v19
    v_mfma_f32_16x16x32_bf16 a[124:127], v[72:75], v[32:35], a[124:127]
    ds_read_b128 v[28:31], v1 offset:21504
    v_cvt_f32_i32 v152, v152
    v_mfma_f32_16x16x32_bf16 a[124:127], v[88:91], v[36:39], a[124:127]
    buffer_load_dwordx4 v4, s[4:7], s32 offen offset:1024 sc1 lds
    v_mfma_f32_16x16x32_bf16 a[172:175], v[76:79], v[32:35], a[172:175]
    v_exp_f32 v17, v113
    v_mfma_f32_16x16x32_bf16 a[172:175], v[92:95], v[36:39], a[172:175]
    s_waitcnt lgkmcnt(2)
    v_cvt_pk_bf16_f32 v177, v18, v19
    v_add_u32 v3, s3, v3
    v_mfma_f32_16x16x32_bf16 a[32:35], v[64:67], v[40:43], a[32:35]
    ds_read_b128 v[32:35], v1 offset:10240
    v_cvt_f32_i32 v156, v156
    v_mfma_f32_16x16x32_bf16 a[32:35], v[80:83], v[44:47], a[32:35]
    v_exp_f32 v18, v114
    v_mfma_f32_16x16x32_bf16 a[80:83], v[68:71], v[40:43], a[80:83]
    v_add_f32 v5, v5, v16
    v_add_f32 v5, v5, v17
    v_mfma_f32_16x16x32_bf16 a[80:83], v[84:87], v[44:47], a[80:83]
    buffer_load_dwordx4 v4, s[4:7], s32 offen offset:2048 sc1 lds
    v_mfma_f32_16x16x32_bf16 a[128:131], v[72:75], v[40:43], a[128:131]
    ds_read_b128 v[36:39], v1 offset:22528
    v_mfma_f32_16x16x32_bf16 a[128:131], v[88:91], v[44:47], a[128:131]
    v_exp_f32 v19, v115
    v_mfma_f32_16x16x32_bf16 a[176:179], v[76:79], v[40:43], a[176:179]
    v_cvt_pk_bf16_f32 v178, v16, v17
    v_fma_f32 v152, v152, v48, v50
    v_mfma_f32_16x16x32_bf16 a[176:179], v[92:95], v[44:47], a[176:179]
    s_waitcnt lgkmcnt(2)
    v_exp_f32 v16, v180
    v_mfma_f32_16x16x32_bf16 a[36:39], v[64:67], v[24:27], a[36:39]
    ds_read_b128 v[40:43], v1 offset:11264
    v_add_f32 v5, v5, v18
    v_mfma_f32_16x16x32_bf16 a[36:39], v[80:83], v[28:31], a[36:39]
    v_add_f32 v5, v5, v19
    v_mfma_f32_16x16x32_bf16 a[84:87], v[68:71], v[24:27], a[84:87]
    v_exp_f32 v17, v181
    v_mfma_f32_16x16x32_bf16 a[84:87], v[84:87], v[28:31], a[84:87]
    s_add_u32 s32, s32, 24576
    v_cvt_pk_bf16_f32 v179, v18, v19
    s_add_u32 s26, s26, 36864
    v_mfma_f32_16x16x32_bf16 a[132:135], v[72:75], v[24:27], a[132:135]
    s_sub_u32 s57, s26, 147456
    ds_read_b128 v[44:47], v1 offset:23552
    v_fma_f32 v156, v156, v49, v51
    v_mfma_f32_16x16x32_bf16 a[132:135], v[88:91], v[28:31], a[132:135]
    s_waitcnt lgkmcnt(2)
    v_exp_f32 v18, v182
    v_mfma_f32_16x16x32_bf16 a[180:183], v[76:79], v[24:27], a[180:183]
    s_waitcnt vmcnt(6)
    v_add_f32 v6, v6, v16
    v_add_f32 v6, v6, v17
    v_mfma_f32_16x16x32_bf16 a[180:183], v[92:95], v[28:31], a[180:183]
    s_barrier
    v_cvt_f32_i32 v153, v153
    v_mfma_f32_16x16x32_bf16 a[40:43], v[64:67], v[32:35], a[40:43]
    s_min_u32 s26, s26, s57
    ds_read_b128 v[24:27], v2 offset:0
    v_add_u32 v0, 1, v0
    v_mfma_f32_16x16x32_bf16 a[40:43], v[80:83], v[36:39], a[40:43]
    buffer_store_dword v0, v13, s[20:23], 0 offen offset:32 sc1
    v_mfma_f32_16x16x32_bf16 a[88:91], v[68:71], v[32:35], a[88:91]
    v_exp_f32 v19, v183
    v_mfma_f32_16x16x32_bf16 a[88:91], v[84:87], v[36:39], a[88:91]
    v_cvt_pk_bf16_f32 v180, v16, v17
    v_cvt_f32_i32 v157, v157
    v_mfma_f32_16x16x32_bf16 a[136:139], v[72:75], v[32:35], a[136:139]
    ds_read_b128 v[28:31], v3 offset:0
    v_mfma_f32_16x16x32_bf16 a[136:139], v[88:91], v[36:39], a[136:139]
    v_exp_f32 v16, v116
    v_mfma_f32_16x16x32_bf16 a[184:187], v[76:79], v[32:35], a[184:187]
    v_add_f32 v6, v6, v18
    v_add_f32 v6, v6, v19
    v_mfma_f32_16x16x32_bf16 a[184:187], v[92:95], v[36:39], a[184:187]
    s_waitcnt lgkmcnt(2)
    v_exp_f32 v17, v117
    v_mfma_f32_16x16x32_bf16 a[44:47], v[64:67], v[40:43], a[44:47]
    ds_read_b128 v[32:35], v2 offset:6144
    v_cvt_pk_bf16_f32 v181, v18, v19
    v_mfma_f32_16x16x32_bf16 a[44:47], v[80:83], v[44:47], a[44:47]
    v_exp_f32 v18, v118
    v_mfma_f32_16x16x32_bf16 a[92:95], v[68:71], v[40:43], a[92:95]
    v_add_f32 v6, v6, v16
    v_add_f32 v6, v6, v17
    v_mfma_f32_16x16x32_bf16 a[92:95], v[84:87], v[44:47], a[92:95]
    v_exp_f32 v19, v119
    v_mfma_f32_16x16x32_bf16 a[140:143], v[72:75], v[40:43], a[140:143]
    ds_read_b128 v[36:39], v3 offset:6144
    v_cvt_pk_bf16_f32 v182, v16, v17
    v_mfma_f32_16x16x32_bf16 a[140:143], v[88:91], v[44:47], a[140:143]
    v_add_f32 v6, v6, v18
    v_add_f32 v6, v6, v19
    v_mfma_f32_16x16x32_bf16 a[188:191], v[76:79], v[40:43], a[188:191]
    v_cvt_pk_bf16_f32 v183, v18, v19
    v_mfma_f32_16x16x32_bf16 a[188:191], v[92:95], v[44:47], a[188:191]
    s_waitcnt lgkmcnt(2)
    v_mfma_f32_16x16x32_bf16 v[64:67], v[24:27], a[192:195], v[128:131]
    s_add_u32 s33, s33, 196608
    ds_read_b128 v[40:43], v2 offset:128
    v_fma_f32 v153, v153, v48, v50
    v_mfma_f32_16x16x32_bf16 v[64:67], v[28:31], a[196:199], v[64:67]
    s_mov_b32 m0, s56
    v_exp_f32 v16, v184
    v_mfma_f32_16x16x32_bf16 v[68:71], v[24:27], a[216:219], v[132:135]
    s_add_u32 s34, s34, 196608
    v_exp_f32 v17, v185
    v_mfma_f32_16x16x32_bf16 v[68:71], v[28:31], a[220:223], v[68:71]
    s_add_u32 s36, s36, 1536
    buffer_load_dwordx4 v4, s[4:7], s27 offen offset:0 sc1 lds
    v_mfma_f32_16x16x32_bf16 v[72:75], v[24:27], a[240:243], v[136:139]
    ds_read_b128 v[44:47], v3 offset:128
    v_fma_f32 v157, v157, v49, v51
    v_mfma_f32_16x16x32_bf16 v[72:75], v[28:31], a[244:247], v[72:75]
    v_exp_f32 v18, v186
    v_mfma_f32_16x16x32_bf16 v[76:79], v[24:27], v[200:203], v[140:143]
    v_add_f32 v7, v7, v16
    v_add_f32 v7, v7, v17
    v_mfma_f32_16x16x32_bf16 v[76:79], v[28:31], v[204:207], v[76:79]
    s_waitcnt lgkmcnt(2)
    buffer_load_dwordx2 v[56:57], v10, s[72:75], s36 offen offset:0
    v_mfma_f32_16x16x32_bf16 v[96:99], v[32:35], a[192:195], v[128:131]
    ds_read_b128 v[24:27], v2 offset:6272
    v_cvt_f32_i32 v154, v154
    v_mfma_f32_16x16x32_bf16 v[96:99], v[36:39], a[196:199], v[96:99]
    v_exp_f32 v19, v187
    v_mfma_f32_16x16x32_bf16 v[100:103], v[32:35], a[216:219], v[132:135]
    v_cvt_pk_bf16_f32 v184, v16, v17
    v_cvt_f32_i32 v158, v158
    v_mfma_f32_16x16x32_bf16 v[100:103], v[36:39], a[220:223], v[100:103]
    buffer_load_dwordx4 v4, s[4:7], s27 offen offset:1024 sc1 lds
    v_mfma_f32_16x16x32_bf16 v[104:107], v[32:35], a[240:243], v[136:139]
    ds_read_b128 v[28:31], v3 offset:6272
    v_fma_f32 v154, v154, v48, v50
    v_mfma_f32_16x16x32_bf16 v[104:107], v[36:39], a[244:247], v[104:107]
    v_exp_f32 v16, v120
    v_mfma_f32_16x16x32_bf16 v[108:111], v[32:35], v[200:203], v[140:143]
    v_add_f32 v7, v7, v18
    v_add_f32 v7, v7, v19
    v_mfma_f32_16x16x32_bf16 v[108:111], v[36:39], v[204:207], v[108:111]
    s_waitcnt lgkmcnt(2)
    buffer_load_dwordx2 v[58:59], v10, s[76:79], s36 offen offset:0
    v_mfma_f32_16x16x32_bf16 v[64:67], v[40:43], a[200:203], v[64:67]
    ds_read_b128 v[32:35], v2 offset:256
    v_fma_f32 v158, v158, v49, v51
    v_mfma_f32_16x16x32_bf16 v[64:67], v[44:47], a[204:207], v[64:67]
    v_exp_f32 v17, v121
    v_mfma_f32_16x16x32_bf16 v[68:71], v[40:43], a[224:227], v[68:71]
    v_cvt_pk_bf16_f32 v185, v18, v19
    v_mfma_f32_16x16x32_bf16 v[68:71], v[44:47], a[228:231], v[68:71]
    buffer_load_dwordx4 v[224:227], v9, s[64:67], s33 offen offset:0 nt
    v_mfma_f32_16x16x32_bf16 v[72:75], v[40:43], a[248:251], v[72:75]
    ds_read_b128 v[36:39], v3 offset:256
    v_cvt_pk_bf16_f32 v144, v144, v148
    v_mfma_f32_16x16x32_bf16 v[72:75], v[44:47], a[252:255], v[72:75]
    v_exp_f32 v18, v122
    v_mfma_f32_16x16x32_bf16 v[76:79], v[40:43], v[208:211], v[76:79]
    v_add_f32 v7, v7, v16
    v_add_f32 v7, v7, v17
    v_mfma_f32_16x16x32_bf16 v[76:79], v[44:47], v[212:215], v[76:79]
    s_waitcnt lgkmcnt(2)
    buffer_load_dwordx4 v4, s[4:7], s27 offen offset:2048 sc1 lds
    v_mfma_f32_16x16x32_bf16 v[96:99], v[24:27], a[200:203], v[96:99]
    ds_read_b128 v[40:43], v2 offset:6400
    v_cvt_pk_bf16_f32 v148, v145, v149
    v_mfma_f32_16x16x32_bf16 v[96:99], v[28:31], a[204:207], v[96:99]
    v_exp_f32 v19, v123
    v_cvt_pk_bf16_f32 v186, v16, v17
    v_mfma_f32_16x16x32_bf16 v[100:103], v[24:27], a[224:227], v[100:103]
    v_exp_f32 v16, v188
    v_mfma_f32_16x16x32_bf16 v[100:103], v[28:31], a[228:231], v[100:103]
    buffer_load_dwordx4 v[228:231], v9, s[64:67], s33 offen offset:1536 nt
    v_mfma_f32_16x16x32_bf16 v[104:107], v[24:27], a[248:251], v[104:107]
    ds_read_b128 v[44:47], v3 offset:6400
    v_add_f32 v7, v7, v18
    v_mfma_f32_16x16x32_bf16 v[104:107], v[28:31], a[252:255], v[104:107]
    v_add_f32 v7, v7, v19
    v_cvt_pk_bf16_f32 v145, v152, v156
    v_mfma_f32_16x16x32_bf16 v[108:111], v[24:27], v[208:211], v[108:111]
    s_add_u32 s29, s30, 49152
    v_exp_f32 v17, v189
    v_mfma_f32_16x16x32_bf16 v[108:111], v[28:31], v[212:215], v[108:111]
    s_waitcnt lgkmcnt(2)
    buffer_load_dwordx4 v[232:235], v9, s[64:67], s34 offen offset:0 nt
    v_cvt_pk_bf16_f32 v187, v18, v19
    v_mfma_f32_16x16x32_bf16 v[64:67], v[32:35], a[208:211], v[64:67]
    s_sub_u32 s3, s29, 147456
    ds_read_b128 v[24:27], v2 offset:12288
    s_add_u32 s27, s27, 24576
    v_mfma_f32_16x16x32_bf16 v[64:67], v[36:39], a[212:215], v[64:67]
    s_min_u32 s29, s29, s3
    v_exp_f32 v18, v190
    v_mfma_f32_16x16x32_bf16 v[68:71], v[32:35], a[232:235], v[68:71]
    v_add_f32 v8, v8, v16
    v_add_f32 v8, v8, v17
    v_mfma_f32_16x16x32_bf16 v[68:71], v[36:39], a[236:239], v[68:71]
    buffer_load_dwordx4 v[236:239], v9, s[64:67], s34 offen offset:1536 nt
    v_mfma_f32_16x16x32_bf16 v[72:75], v[32:35], v[192:195], v[72:75]
    s_add_u32 s56, s56, 12288
    ds_read_b128 v[28:31], v3 offset:12288
    v_cvt_pk_bf16_f32 v149, v153, v157
    v_mfma_f32_16x16x32_bf16 v[72:75], v[36:39], v[196:199], v[72:75]
    v_exp_f32 v19, v191
    v_cvt_pk_bf16_f32 v188, v16, v17
    v_mfma_f32_16x16x32_bf16 v[76:79], v[32:35], v[216:219], v[76:79]
    v_exp_f32 v16, v124
    v_mfma_f32_16x16x32_bf16 v[76:79], v[36:39], v[220:223], v[76:79]
    s_waitcnt lgkmcnt(2)
    v_add_f32 v8, v8, v18
    v_add_f32 v8, v8, v19
    v_mfma_f32_16x16x32_bf16 v[96:99], v[40:43], a[208:211], v[96:99]
    ds_read_b128 v[32:35], v2 offset:18432
    v_cvt_pk_bf16_f32 v152, v146, v150
    v_mfma_f32_16x16x32_bf16 v[96:99], v[44:47], a[212:215], v[96:99]
    s_sub_u32 s3, s29, s30
    v_exp_f32 v17, v125
    v_mfma_f32_16x16x32_bf16 v[100:103], v[40:43], a[232:235], v[100:103]
    s_mov_b32 m0, s56
    v_cvt_pk_bf16_f32 v189, v18, v19
    v_cvt_pk_bf16_f32 v153, v154, v158
    v_mfma_f32_16x16x32_bf16 v[100:103], v[44:47], a[236:239], v[100:103]
    v_exp_f32 v18, v126
    v_mfma_f32_16x16x32_bf16 v[104:107], v[40:43], v[192:195], v[104:107]
    ds_read_b128 v[36:39], v3 offset:18432
    v_add_f32 v8, v8, v16
    v_mfma_f32_16x16x32_bf16 v[104:107], v[44:47], v[196:199], v[104:107]
    v_add_f32 v8, v8, v17
    v_mfma_f32_16x16x32_bf16 v[108:111], v[40:43], v[216:219], v[108:111]
    v_exp_f32 v19, v127
    v_mfma_f32_16x16x32_bf16 v[108:111], v[44:47], v[220:223], v[108:111]
    s_waitcnt lgkmcnt(2)
    v_cvt_pk_bf16_f32 v190, v16, v17
    v_add_f32 v8, v8, v18
    v_mfma_f32_16x16x32_bf16 v[80:83], v[24:27], a[192:195], v[128:131]
    ds_read_b128 v[40:43], v2 offset:12416
    v_add_f32 v8, v8, v19
    v_mfma_f32_16x16x32_bf16 v[80:83], v[28:31], a[196:199], v[80:83]
    s_mov_b32 s30, s29
    v_cvt_pk_bf16_f32 v191, v18, v19
    v_mfma_f32_16x16x32_bf16 v[84:87], v[24:27], a[216:219], v[132:135]
    v_exp_f32 v16, v64
    v_mfma_f32_16x16x32_bf16 v[84:87], v[28:31], a[220:223], v[84:87]
    s_waitcnt vmcnt(20)
    buffer_load_dwordx4 v4, s[4:7], s27 offen offset:0 sc1 lds
    v_mfma_f32_16x16x32_bf16 v[88:91], v[24:27], a[240:243], v[136:139]
    ds_read_b128 v[44:47], v3 offset:12416
    v_lshlrev_b32 v48, 16, v60
    v_mfma_f32_16x16x32_bf16 v[88:91], v[28:31], a[244:247], v[88:91]
    v_exp_f32 v17, v65
    v_mfma_f32_16x16x32_bf16 v[92:95], v[24:27], v[200:203], v[140:143]
    v_exp_f32 v18, v66
    v_mfma_f32_16x16x32_bf16 v[92:95], v[28:31], v[204:207], v[92:95]
    s_waitcnt lgkmcnt(2)
    v_add_f32 v5, v5, v16
    v_add_f32 v5, v5, v17
    v_mfma_f32_16x16x32_bf16 v[112:115], v[32:35], a[192:195], v[128:131]
    ds_read_b128 v[24:27], v2 offset:18560
    v_and_b32 v49, s97, v60
    v_mfma_f32_16x16x32_bf16 v[112:115], v[36:39], a[196:199], v[112:115]
    v_exp_f32 v19, v67
    v_mfma_f32_16x16x32_bf16 v[116:119], v[32:35], a[216:219], v[132:135]
    v_cvt_pk_bf16_f32 v64, v16, v17
    v_lshlrev_b32 v50, 16, v62
    v_mfma_f32_16x16x32_bf16 v[116:119], v[36:39], a[220:223], v[116:119]
    v_exp_f32 v16, v96
    v_mfma_f32_16x16x32_bf16 v[120:123], v[32:35], a[240:243], v[136:139]
    ds_read_b128 v[28:31], v3 offset:18560
    v_add_f32 v5, v5, v18
    v_mfma_f32_16x16x32_bf16 v[120:123], v[36:39], a[244:247], v[120:123]
    v_add_f32 v5, v5, v19
    v_and_b32 v51, s97, v62
    v_mfma_f32_16x16x32_bf16 v[124:127], v[32:35], v[200:203], v[140:143]
    v_exp_f32 v17, v97
    v_mfma_f32_16x16x32_bf16 v[124:127], v[36:39], v[204:207], v[124:127]
    s_waitcnt lgkmcnt(2)
    buffer_load_dwordx4 v4, s[4:7], s27 offen offset:1024 sc1 lds
    v_mfma_f32_16x16x32_bf16 v[80:83], v[40:43], a[200:203], v[80:83]
    ds_read_b128 v[32:35], v2 offset:12544
    v_cvt_pk_bf16_f32 v65, v18, v19
    v_mfma_f32_16x16x32_bf16 v[80:83], v[44:47], a[204:207], v[80:83]
    v_exp_f32 v18, v98
    v_mfma_f32_16x16x32_bf16 v[84:87], v[40:43], a[224:227], v[84:87]
    v_add_f32 v5, v5, v16
    v_add_f32 v5, v5, v17
    v_mfma_f32_16x16x32_bf16 v[84:87], v[44:47], a[228:231], v[84:87]
    v_exp_f32 v19, v99
    v_mfma_f32_16x16x32_bf16 v[88:91], v[40:43], a[248:251], v[88:91]
    ds_read_b128 v[36:39], v3 offset:12544
    v_cvt_pk_bf16_f32 v66, v16, v17
    v_mfma_f32_16x16x32_bf16 v[88:91], v[44:47], a[252:255], v[88:91]
    v_exp_f32 v16, v68
    v_mfma_f32_16x16x32_bf16 v[92:95], v[40:43], v[208:211], v[92:95]
    v_add_u32 v1, s3, v1
    v_mul_f32_e64 v50, -v50, v48
    v_mfma_f32_16x16x32_bf16 v[92:95], v[44:47], v[212:215], v[92:95]
    s_waitcnt lgkmcnt(2)
    v_add_f32 v5, v5, v18
    v_add_f32 v5, v5, v19
    v_mfma_f32_16x16x32_bf16 v[112:115], v[24:27], a[200:203], v[112:115]
    ds_read_b128 v[40:43], v2 offset:18688
    v_mul_f32_e64 v51, -v51, v49
    v_mfma_f32_16x16x32_bf16 v[112:115], v[28:31], a[204:207], v[112:115]
    buffer_load_dwordx4 v4, s[4:7], s27 offen offset:2048 sc1 lds
    v_mfma_f32_16x16x32_bf16 v[116:119], v[24:27], a[224:227], v[116:119]
    v_exp_f32 v17, v69
    v_mfma_f32_16x16x32_bf16 v[116:119], v[28:31], a[228:231], v[116:119]
    v_cvt_pk_bf16_f32 v67, v18, v19
    v_cvt_f32_i32 v240, v240
    v_mfma_f32_16x16x32_bf16 v[120:123], v[24:27], a[248:251], v[120:123]
    ds_read_b128 v[44:47], v3 offset:18688
    v_mfma_f32_16x16x32_bf16 v[120:123], v[28:31], a[252:255], v[120:123]
    s_waitcnt lgkmcnt(2)
    v_exp_f32 v18, v70
    v_mfma_f32_16x16x32_bf16 v[124:127], v[24:27], v[208:211], v[124:127]
    s_waitcnt vmcnt(13)
    v_add_f32 v6, v6, v16
    v_add_f32 v6, v6, v17
    v_mfma_f32_16x16x32_bf16 v[124:127], v[28:31], v[212:215], v[124:127]
    s_barrier
    v_cvt_f32_i32 v244, v244
    v_mfma_f32_16x16x32_bf16 v[80:83], v[32:35], a[208:211], v[80:83]
    ds_read_b128 v[24:27], v1 offset:0
    v_mfma_f32_16x16x32_bf16 v[80:83], v[36:39], a[212:215], v[80:83]
    v_exp_f32 v19, v71
    v_mfma_f32_16x16x32_bf16 v[84:87], v[32:35], a[232:235], v[84:87]
    v_cvt_pk_bf16_f32 v68, v16, v17
    v_fma_f32 v240, v240, v48, v50
    v_mfma_f32_16x16x32_bf16 v[84:87], v[36:39], a[236:239], v[84:87]
    v_exp_f32 v16, v100
    v_mfma_f32_16x16x32_bf16 v[88:91], v[32:35], v[192:195], v[88:91]
    ds_read_b128 v[28:31], v1 offset:12288
    v_add_f32 v6, v6, v18
    v_mfma_f32_16x16x32_bf16 v[88:91], v[36:39], v[196:199], v[88:91]
    v_add_f32 v6, v6, v19
    v_fma_f32 v244, v244, v49, v51
    v_mfma_f32_16x16x32_bf16 v[92:95], v[32:35], v[216:219], v[92:95]
    v_exp_f32 v17, v101
    v_mfma_f32_16x16x32_bf16 v[92:95], v[36:39], v[220:223], v[92:95]
    s_waitcnt lgkmcnt(2)
    v_cvt_pk_bf16_f32 v69, v18, v19
    v_mfma_f32_16x16x32_bf16 v[112:115], v[40:43], a[208:211], v[112:115]
    ds_read_b128 v[32:35], v1 offset:1024
    v_mfma_f32_16x16x32_bf16 v[112:115], v[44:47], a[212:215], v[112:115]
    v_exp_f32 v18, v102
    v_mfma_f32_16x16x32_bf16 v[116:119], v[40:43], a[232:235], v[116:119]
    v_add_f32 v6, v6, v16
    v_add_f32 v6, v6, v17
    v_mfma_f32_16x16x32_bf16 v[116:119], v[44:47], a[236:239], v[116:119]
    s_add_u32 s27, s27, 24576
    v_exp_f32 v19, v103
    v_mfma_f32_16x16x32_bf16 v[120:123], v[40:43], v[192:195], v[120:123]
    s_add_u32 s56, s56, 36864
    ds_read_b128 v[36:39], v1 offset:13312
    v_cvt_pk_bf16_f32 v70, v16, v17
    v_mfma_f32_16x16x32_bf16 v[120:123], v[44:47], v[196:199], v[120:123]
    s_sub_u32 s58, s56, 147456
    v_add_f32 v6, v6, v18
    v_add_f32 v6, v6, v19
    v_mfma_f32_16x16x32_bf16 v[124:127], v[40:43], v[216:219], v[124:127]
    s_min_u32 s56, s56, s58
    v_cvt_pk_bf16_f32 v71, v18, v19
    v_mfma_f32_16x16x32_bf16 v[124:127], v[44:47], v[220:223], v[124:127]
    s_waitcnt lgkmcnt(2)
    v_mfma_f32_16x16x32_bf16 a[0:3], v[160:163], v[24:27], a[0:3]
    s_mov_b32 m0, s56
    ds_read_b128 v[40:43], v1 offset:2048
    v_cvt_f32_i32 v241, v241
    v_mfma_f32_16x16x32_bf16 a[0:3], v[176:179], v[28:31], a[0:3]
    buffer_load_dwordx4 v4, s[4:7], s27 offen offset:0 sc1 lds
    v_mfma_f32_16x16x32_bf16 a[48:51], v[164:167], v[24:27], a[48:51]
    v_exp_f32 v16, v72
    v_mfma_f32_16x16x32_bf16 a[48:51], v[180:183], v[28:31], a[48:51]
    v_exp_f32 v17, v73
    v_mfma_f32_16x16x32_bf16 a[96:99], v[168:171], v[24:27], a[96:99]
    ds_read_b128 v[44:47], v1 offset:14336
    v_cvt_f32_i32 v245, v245
    v_mfma_f32_16x16x32_bf16 a[96:99], v[184:187], v[28:31], a[96:99]
    v_exp_f32 v18, v74
    v_mfma_f32_16x16x32_bf16 a[144:147], v[172:175], v[24:27], a[144:147]
    v_add_f32 v7, v7, v16
    v_add_f32 v7, v7, v17
    v_mfma_f32_16x16x32_bf16 a[144:147], v[188:191], v[28:31], a[144:147]
    s_waitcnt lgkmcnt(2)
    v_exp_f32 v19, v75
    v_mfma_f32_16x16x32_bf16 a[4:7], v[160:163], v[32:35], a[4:7]
    ds_read_b128 v[24:27], v1 offset:3072
    v_fma_f32 v241, v241, v48, v50
    v_mfma_f32_16x16x32_bf16 a[4:7], v[176:179], v[36:39], a[4:7]
    buffer_load_dwordx4 v4, s[4:7], s27 offen offset:1024 sc1 lds
    v_mfma_f32_16x16x32_bf16 a[52:55], v[164:167], v[32:35], a[52:55]
    v_cvt_pk_bf16_f32 v72, v16, v17
    v_fma_f32 v245, v245, v49, v51
    v_mfma_f32_16x16x32_bf16 a[52:55], v[180:183], v[36:39], a[52:55]
    v_exp_f32 v16, v104
    v_mfma_f32_16x16x32_bf16 a[100:103], v[168:171], v[32:35], a[100:103]
    ds_read_b128 v[28:31], v1 offset:15360
    v_add_f32 v7, v7, v18
    v_mfma_f32_16x16x32_bf16 a[100:103], v[184:187], v[36:39], a[100:103]
    buffer_load_dword v52, v20, s[20:23], s44 offen sc1
    v_mfma_f32_16x16x32_bf16 a[148:151], v[172:175], v[32:35], a[148:151]
    v_add_f32 v7, v7, v19
    v_cvt_f32_i32 v242, v242
    v_mfma_f32_16x16x32_bf16 a[148:151], v[188:191], v[36:39], a[148:151]
    s_waitcnt lgkmcnt(2)
    v_exp_f32 v17, v105
    v_mfma_f32_16x16x32_bf16 a[8:11], v[160:163], v[40:43], a[8:11]
    ds_read_b128 v[32:35], v1 offset:4096
    v_cvt_pk_bf16_f32 v73, v18, v19
    v_mfma_f32_16x16x32_bf16 a[8:11], v[176:179], v[44:47], a[8:11]
    v_exp_f32 v18, v106
    v_mfma_f32_16x16x32_bf16 a[56:59], v[164:167], v[40:43], a[56:59]
    v_add_f32 v7, v7, v16
    v_cvt_f32_i32 v246, v246
    v_mfma_f32_16x16x32_bf16 a[56:59], v[180:183], v[44:47], a[56:59]
    buffer_load_dwordx4 v4, s[4:7], s27 offen offset:2048 sc1 lds
    v_mfma_f32_16x16x32_bf16 a[104:107], v[168:171], v[40:43], a[104:107]
    ds_read_b128 v[36:39], v1 offset:16384
    v_add_f32 v7, v7, v17
    v_mfma_f32_16x16x32_bf16 a[104:107], v[184:187], v[44:47], a[104:107]
    v_exp_f32 v19, v107
    v_mfma_f32_16x16x32_bf16 a[152:155], v[172:175], v[40:43], a[152:155]
    v_cvt_pk_bf16_f32 v74, v16, v17
    v_fma_f32 v242, v242, v48, v50
    v_mfma_f32_16x16x32_bf16 a[152:155], v[188:191], v[44:47], a[152:155]
    s_waitcnt lgkmcnt(2)
    v_exp_f32 v16, v76
    v_mfma_f32_16x16x32_bf16 a[12:15], v[160:163], v[24:27], a[12:15]
    ds_read_b128 v[40:43], v1 offset:5120
    v_add_f32 v7, v7, v18
    v_mfma_f32_16x16x32_bf16 a[12:15], v[176:179], v[28:31], a[12:15]
    s_add_u32 s27, s27, 24576
    v_add_f32 v7, v7, v19
    v_fma_f32 v246, v246, v49, v51
    v_mfma_f32_16x16x32_bf16 a[60:63], v[164:167], v[24:27], a[60:63]
L_pg4:
    s_cbranch_execz L_pg8
    v_exp_f32 v17, v77
    v_mfma_f32_16x16x32_bf16 a[60:63], v[180:183], v[28:31], a[60:63]
    v_cvt_pk_bf16_f32 v75, v18, v19
    v_lshlrev_b32 v48, 16, v61
    v_mfma_f32_16x16x32_bf16 a[108:111], v[168:171], v[24:27], a[108:111]
    ds_read_b128 v[44:47], v1 offset:17408
    v_and_b32 v49, s97, v61
    v_mfma_f32_16x16x32_bf16 a[108:111], v[184:187], v[28:31], a[108:111]
    v_exp_f32 v18, v78
    v_mfma_f32_16x16x32_bf16 a[156:159], v[172:175], v[24:27], a[156:159]
    s_add_u32 s29, s28, 49152
    v_add_f32 v8, v8, v16
    v_add_f32 v8, v8, v17
    v_mfma_f32_16x16x32_bf16 a[156:159], v[188:191], v[28:31], a[156:159]
    s_waitcnt lgkmcnt(2)
    v_exp_f32 v19, v79
    v_mfma_f32_16x16x32_bf16 a[16:19], v[160:163], v[32:35], a[16:19]
    s_sub_u32 s3, s29, 147456
    ds_read_b128 v[24:27], v1 offset:6144
    v_lshlrev_b32 v50, 16, v63
    v_mfma_f32_16x16x32_bf16 a[16:19], v[176:179], v[36:39], a[16:19]
    s_add_u32 s56, s56, 12288
    v_cvt_pk_bf16_f32 v76, v16, v17
    v_and_b32 v51, s97, v63
    v_mfma_f32_16x16x32_bf16 a[64:67], v[164:167], v[32:35], a[64:67]
    s_min_u32 s29, s29, s3
    v_exp_f32 v16, v108
    v_mfma_f32_16x16x32_bf16 a[64:67], v[180:183], v[36:39], a[64:67]
    s_mov_b32 m0, s56
    v_add_f32 v8, v8, v18
    v_add_f32 v8, v8, v19
    v_mfma_f32_16x16x32_bf16 a[112:115], v[168:171], v[32:35], a[112:115]
    ds_read_b128 v[28:31], v1 offset:18432
    v_mul_f32_e64 v50, -v50, v48
    v_mfma_f32_16x16x32_bf16 a[112:115], v[184:187], v[36:39], a[112:115]
    v_exp_f32 v17, v109
    v_mfma_f32_16x16x32_bf16 a[160:163], v[172:175], v[32:35], a[160:163]
    v_cvt_pk_bf16_f32 v77, v18, v19
    v_mul_f32_e64 v51, -v51, v49
    v_mfma_f32_16x16x32_bf16 a[160:163], v[188:191], v[36:39], a[160:163]
    s_waitcnt lgkmcnt(2)
    v_exp_f32 v18, v110
    v_mfma_f32_16x16x32_bf16 a[20:23], v[160:163], v[40:43], a[20:23]
    s_sub_u32 s3, s29, s28
    ds_read_b128 v[32:35], v1 offset:7168
    v_add_f32 v8, v8, v16
    v_mfma_f32_16x16x32_bf16 a[20:23], v[176:179], v[44:47], a[20:23]
    v_add_f32 v8, v8, v17
    v_cvt_f32_i32 v248, v248
    v_mfma_f32_16x16x32_bf16 a[68:71], v[164:167], v[40:43], a[68:71]
    v_exp_f32 v19, v111
    v_mfma_f32_16x16x32_bf16 a[68:71], v[180:183], v[44:47], a[68:71]
    buffer_load_dwordx4 v4, s[4:7], s27 offen offset:0 sc1 lds
    v_mfma_f32_16x16x32_bf16 a[116:119], v[168:171], v[40:43], a[116:119]
    ds_read_b128 v[36:39], v1 offset:19456
    v_cvt_pk_bf16_f32 v78, v16, v17
    v_mfma_f32_16x16x32_bf16 a[116:119], v[184:187], v[44:47], a[116:119]
    v_add_f32 v8, v8, v18
    v_cvt_f32_i32 v252, v252
    v_mfma_f32_16x16x32_bf16 a[164:167], v[172:175], v[40:43], a[164:167]
    s_mov_b32 s28, s29
    v_add_f32 v8, v8, v19
    v_cvt_pk_bf16_f32 v79, v18, v19
    v_mfma_f32_16x16x32_bf16 a[164:167], v[188:191], v[44:47], a[164:167]
    s_waitcnt lgkmcnt(2)
    v_exp_f32 v16, v80
    v_mfma_f32_16x16x32_bf16 a[24:27], v[160:163], v[24:27], a[24:27]
    ds_read_b128 v[40:43], v1 offset:8192
    v_fma_f32 v248, v248, v48, v50
    v_mfma_f32_16x16x32_bf16 a[24:27], v[176:179], v[28:31], a[24:27]
    v_exp_f32 v17, v81
    v_mfma_f32_16x16x32_bf16 a[72:75], v[164:167], v[24:27], a[72:75]
    v_fma_f32 v252, v252, v49, v51
    v_cvt_f32_i32 v249, v249
    v_mfma_f32_16x16x32_bf16 a[72:75], v[180:183], v[28:31], a[72:75]
    buffer_load_dwordx4 v4, s[4:7], s27 offen offset:1024 sc1 lds
    v_mfma_f32_16x16x32_bf16 a[120:123], v[168:171], v[24:27], a[120:123]
    ds_read_b128 v[44:47], v1 offset:20480
    v_cvt_f32_i32 v253, v253
    v_mfma_f32_16x16x32_bf16 a[120:123], v[184:187], v[28:31], a[120:123]
    v_exp_f32 v18, v82
    v_mfma_f32_16x16x32_bf16 a[168:171], v[172:175], v[24:27], a[168:171]
    v_add_f32 v5, v5, v16
    v_add_f32 v5, v5, v17
    v_mfma_f32_16x16x32_bf16 a[168:171], v[188:191], v[28:31], a[168:171]
    s_waitcnt lgkmcnt(2)
    v_exp_f32 v19, v83
    v_mfma_f32_16x16x32_bf16 a[28:31], v[160:163], v[32:35], a[28:31]
    ds_read_b128 v[24:27], v1 offset:9216
    v_cvt_pk_bf16_f32 v80, v16, v17
    v_mfma_f32_16x16x32_bf16 a[28:31], v[176:179], v[36:39], a[28:31]
    v_exp_f32 v16, v112
    v_mfma_f32_16x16x32_bf16 a[76:79], v[164:167], v[32:35], a[76:79]
    v_add_f32 v5, v5, v18
    v_fma_f32 v249, v249, v48, v50
    v_mfma_f32_16x16x32_bf16 a[76:79], v[180:183], v[36:39], a[76:79]
    v_add_f32 v5, v5, v19
    v_add_u32 v2, s3, v2
    v_mfma_f32_16x16x32_bf16 a[124:127], v[168:171], v[32:35], a[124:127]
    ds_read_b128 v[28:31], v1 offset:21504
    v_fma_f32 v253, v253, v49, v51
    v_mfma_f32_16x16x32_bf16 a[124:127], v[184:187], v[36:39], a[124:127]
    buffer_load_dwordx4 v4, s[4:7], s27 offen offset:2048 sc1 lds
    v_mfma_f32_16x16x32_bf16 a[172:175], v[172:175], v[32:35], a[172:175]
    v_exp_f32 v17, v113
    v_mfma_f32_16x16x32_bf16 a[172:175], v[188:191], v[36:39], a[172:175]
    s_waitcnt lgkmcnt(2)
    v_cvt_pk_bf16_f32 v81, v18, v19
    v_cvt_f32_i32 v250, v250
    v_mfma_f32_16x16x32_bf16 a[32:35], v[160:163], v[40:43], a[32:35]
    ds_read_b128 v[32:35], v1 offset:10240
    v_add_u32 v3, s3, v3
    v_mfma_f32_16x16x32_bf16 a[32:35], v[176:179], v[44:47], a[32:35]
    v_exp_f32 v18, v114
    v_mfma_f32_16x16x32_bf16 a[80:83], v[164:167], v[40:43], a[80:83]
    v_add_f32 v5, v5, v16
    v_add_f32 v5, v5, v17
    v_mfma_f32_16x16x32_bf16 a[80:83], v[180:183], v[44:47], a[80:83]
    v_exp_f32 v19, v115
    v_mfma_f32_16x16x32_bf16 a[128:131], v[168:171], v[40:43], a[128:131]
    ds_read_b128 v[36:39], v1 offset:22528
    v_cvt_pk_bf16_f32 v82, v16, v17
    v_mfma_f32_16x16x32_bf16 a[128:131], v[184:187], v[44:47], a[128:131]
    v_exp_f32 v16, v84
    v_mfma_f32_16x16x32_bf16 a[176:179], v[172:175], v[40:43], a[176:179]
    v_cvt_f32_i32 v254, v254
    v_add_f32 v5, v5, v18
    v_mfma_f32_16x16x32_bf16 a[176:179], v[188:191], v[44:47], a[176:179]
    s_waitcnt lgkmcnt(2)
    v_add_f32 v5, v5, v19
    v_fma_f32 v250, v250, v48, v50
    v_mfma_f32_16x16x32_bf16 a[36:39], v[160:163], v[24:27], a[36:39]
    ds_read_b128 v[40:43], v1 offset:11264
    v_fma_f32 v254, v254, v49, v51
    v_mfma_f32_16x16x32_bf16 a[36:39], v[176:179], v[28:31], a[36:39]
    v_exp_f32 v17, v85
    v_mfma_f32_16x16x32_bf16 a[84:87], v[164:167], v[24:27], a[84:87]
    v_cvt_pk_bf16_f32 v83, v18, v19
    v_cvt_pk_bf16_f32 v146, v240, v244
    v_mfma_f32_16x16x32_bf16 a[84:87], v[180:183], v[28:31], a[84:87]
    s_add_u32 s27, s27, 24576
    v_exp_f32 v18, v86
    v_mfma_f32_16x16x32_bf16 a[132:135], v[168:171], v[24:27], a[132:135]
    s_add_u32 s56, s56, 36864
    ds_read_b128 v[44:47], v1 offset:23552
    v_add_f32 v6, v6, v16
    v_mfma_f32_16x16x32_bf16 a[132:135], v[184:187], v[28:31], a[132:135]
    s_sub_u32 s58, s56, 147456
    v_add_f32 v6, v6, v17
    v_cvt_pk_bf16_f32 v150, v241, v245
    v_mfma_f32_16x16x32_bf16 a[180:183], v[172:175], v[24:27], a[180:183]
    v_exp_f32 v19, v87
    v_mfma_f32_16x16x32_bf16 a[180:183], v[188:191], v[28:31], a[180:183]
    s_waitcnt lgkmcnt(2)
    v_cvt_pk_bf16_f32 v84, v16, v17
    v_cvt_pk_bf16_f32 v147, v248, v252
    v_mfma_f32_16x16x32_bf16 a[40:43], v[160:163], v[32:35], a[40:43]
    s_min_u32 s56, s56, s58
    ds_read_b128 v[24:27], v2 offset:0
    v_mfma_f32_16x16x32_bf16 a[40:43], v[176:179], v[36:39], a[40:43]
    v_exp_f32 v16, v116
    v_mfma_f32_16x16x32_bf16 a[88:91], v[164:167], v[32:35], a[88:91]
    v_add_f32 v6, v6, v18
    v_add_f32 v6, v6, v19
    v_mfma_f32_16x16x32_bf16 a[88:91], v[180:183], v[36:39], a[88:91]
    v_exp_f32 v17, v117
    v_mfma_f32_16x16x32_bf16 a[136:139], v[168:171], v[32:35], a[136:139]
    ds_read_b128 v[28:31], v3 offset:0
    v_cvt_pk_bf16_f32 v151, v249, v253
    v_mfma_f32_16x16x32_bf16 a[136:139], v[184:187], v[36:39], a[136:139]
    v_cvt_pk_bf16_f32 v85, v18, v19
    v_cvt_pk_bf16_f32 v154, v242, v246
    v_mfma_f32_16x16x32_bf16 a[184:187], v[172:175], v[32:35], a[184:187]
    v_exp_f32 v18, v118
    v_mfma_f32_16x16x32_bf16 a[184:187], v[188:191], v[36:39], a[184:187]
    s_waitcnt lgkmcnt(2)
    v_add_f32 v6, v6, v16
    v_mfma_f32_16x16x32_bf16 a[44:47], v[160:163], v[40:43], a[44:47]
    ds_read_b128 v[32:35], v2 offset:6144
    v_add_f32 v6, v6, v17
    v_mfma_f32_16x16x32_bf16 a[44:47], v[176:179], v[44:47], a[44:47]
    v_exp_f32 v19, v119
    v_mfma_f32_16x16x32_bf16 a[92:95], v[164:167], v[40:43], a[92:95]
    v_cvt_pk_bf16_f32 v155, v250, v254
    v_mfma_f32_16x16x32_bf16 a[92:95], v[180:183], v[44:47], a[92:95]
    v_cvt_pk_bf16_f32 v86, v16, v17
    v_mfma_f32_16x16x32_bf16 a[140:143], v[168:171], v[40:43], a[140:143]
    ds_read_b128 v[36:39], v3 offset:6144
    v_add_f32 v6, v6, v18
    v_mfma_f32_16x16x32_bf16 a[140:143], v[184:187], v[44:47], a[140:143]
    v_add_f32 v6, v6, v19
    v_cvt_pk_bf16_f32 v87, v18, v19
    v_mfma_f32_16x16x32_bf16 a[188:191], v[172:175], v[40:43], a[188:191]
    v_mfma_f32_16x16x32_bf16 a[188:191], v[188:191], v[44:47], a[188:191]
    s_waitcnt lgkmcnt(2)
L_join:
    v_mfma_f32_16x16x32_bf16 v[160:163], v[24:27], a[192:195], v[128:131]
L_pg5:
    s_cbranch_execz L_pg9
    ds_read_b128 v[40:43], v2 offset:128
    v_mfma_f32_16x16x32_bf16 v[160:163], v[28:31], a[196:199], v[160:163]
    s_waitcnt vmcnt(4)
    v_subrev_u32 v52, s92, v52
    v_cmp_lt_u32 vcc, 15, v52
    v_mfma_f32_16x16x32_bf16 v[164:167], v[24:27], a[216:219], v[132:135]
    v_exp_f32 v16, v88
    v_mfma_f32_16x16x32_bf16 v[164:167], v[28:31], a[220:223], v[164:167]
    v_exp_f32 v17, v89
    v_mfma_f32_16x16x32_bf16 v[168:171], v[24:27], a[240:243], v[136:139]
    s_and_b32 s59, vcc_lo, 0xff
    ds_read_b128 v[44:47], v3 offset:128
    v_mfma_f32_16x16x32_bf16 v[168:171], v[28:31], a[244:247], v[168:171]
    s_cbranch_scc1 L_pollslow1
L_pollok1:
    v_mfma_f32_16x16x32_bf16 v[172:175], v[24:27], v[200:203], v[140:143]
    s_add_u32 s92, s92, 1
    v_exp_f32 v18, v90
    v_mfma_f32_16x16x32_bf16 v[172:175], v[28:31], v[204:207], v[172:175]
    s_waitcnt lgkmcnt(2)
    v_add_f32 v7, v7, v16
    v_add_f32 v7, v7, v17
    v_mfma_f32_16x16x32_bf16 v[96:99], v[32:35], a[192:195], v[128:131]
    ds_read_b128 v[24:27], v2 offset:6272
    v_mfma_f32_16x16x32_bf16 v[96:99], v[36:39], a[196:199], v[96:99]
    buffer_store_dwordx4 v[144:147], v15, s[4:7], s35 offen offset:0 sc1
    v_mfma_f32_16x16x32_bf16 v[100:103], v[32:35], a[216:219], v[132:135]
    v_exp_f32 v19, v91
    v_mfma_f32_16x16x32_bf16 v[100:103], v[36:39], a[220:223], v[100:103]
    v_cvt_pk_bf16_f32 v88, v16, v17
    v_mfma_f32_16x16x32_bf16 v[104:107], v[32:35], a[240:243], v[136:139]
    ds_read_b128 v[28:31], v3 offset:6272
    v_mfma_f32_16x16x32_bf16 v[104:107], v[36:39], a[244:247], v[104:107]
    v_exp_f32 v16, v120
    v_mfma_f32_16x16x32_bf16 v[108:111], v[32:35], v[200:203], v[140:143]
    v_add_f32 v7, v7, v18
    v_add_f32 v7, v7, v19
    v_mfma_f32_16x16x32_bf16 v[108:111], v[36:39], v[204:207], v[108:111]
    s_waitcnt lgkmcnt(2)
    v_exp_f32 v17, v121
    v_mfma_f32_16x16x32_bf16 v[160:163], v[40:43], a[200:203], v[160:163]
    ds_read_b128 v[32:35], v2 offset:256
    v_cvt_pk_bf16_f32 v89, v18, v19
    v_mfma_f32_16x16x32_bf16 v[160:163], v[44:47], a[204:207], v[160:163]
    buffer_store_dwordx4 v[148:151], v15, s[4:7], s35 offen offset:1024 sc1
    v_mfma_f32_16x16x32_bf16 v[164:167], v[40:43], a[224:227], v[164:167]
    v_exp_f32 v18, v122
    v_mfma_f32_16x16x32_bf16 v[164:167], v[44:47], a[228:231], v[164:167]
    v_add_f32 v7, v7, v16
    v_add_f32 v7, v7, v17
    v_mfma_f32_16x16x32_bf16 v[168:171], v[40:43], a[248:251], v[168:171]
    ds_read_b128 v[36:39], v3 offset:256
    v_mfma_f32_16x16x32_bf16 v[168:171], v[44:47], a[252:255], v[168:171]
    v_exp_f32 v19, v123
    v_mfma_f32_16x16x32_bf16 v[172:175], v[40:43], v[208:211], v[172:175]
    v_cvt_pk_bf16_f32 v90, v16, v17
    v_mfma_f32_16x16x32_bf16 v[172:175], v[44:47], v[212:215], v[172:175]
    s_waitcnt lgkmcnt(2)
    v_exp_f32 v16, v92
    v_mfma_f32_16x16x32_bf16 v[96:99], v[24:27], a[200:203], v[96:99]
    ds_read_b128 v[40:43], v2 offset:6400
    v_add_f32 v7, v7, v18
    v_mfma_f32_16x16x32_bf16 v[96:99], v[28:31], a[204:207], v[96:99]
    buffer_store_dwordx4 v[152:155], v15, s[4:7], s35 offen offset:2048 sc1
    v_mfma_f32_16x16x32_bf16 v[100:103], v[24:27], a[224:227], v[100:103]
    v_add_f32 v7, v7, v19
    v_mfma_f32_16x16x32_bf16 v[100:103], v[28:31], a[228:231], v[100:103]
    v_exp_f32 v17, v93
    v_mfma_f32_16x16x32_bf16 v[104:107], v[24:27], a[248:251], v[104:107]
    ds_read_b128 v[44:47], v3 offset:6400
    v_cvt_pk_bf16_f32 v91, v18, v19
    v_mfma_f32_16x16x32_bf16 v[104:107], v[28:31], a[252:255], v[104:107]
    v_exp_f32 v18, v94
    v_mfma_f32_16x16x32_bf16 v[108:111], v[24:27], v[208:211], v[108:111]
    s_add_u32 s29, s30, 49152
    v_add_f32 v8, v8, v16
    v_add_f32 v8, v8, v17
    v_mfma_f32_16x16x32_bf16 v[108:111], v[28:31], v[212:215], v[108:111]
    s_waitcnt lgkmcnt(2)
    v_exp_f32 v19, v95
    v_mfma_f32_16x16x32_bf16 v[160:163], v[32:35], a[208:211], v[160:163]
    s_sub_u32 s3, s29, 147456
    ds_read_b128 v[24:27], v2 offset:12288
    v_cvt_pk_bf16_f32 v92, v16, v17
    v_mfma_f32_16x16x32_bf16 v[160:163], v[36:39], a[212:215], v[160:163]
    s_min_u32 s29, s29, s3
    v_exp_f32 v16, v124
    v_mfma_f32_16x16x32_bf16 v[164:167], v[32:35], a[232:235], v[164:167]
    v_add_f32 v8, v8, v18
    v_add_f32 v8, v8, v19
    v_mfma_f32_16x16x32_bf16 v[164:167], v[36:39], a[236:239], v[164:167]
    v_exp_f32 v17, v125
    v_mfma_f32_16x16x32_bf16 v[168:171], v[32:35], v[192:195], v[168:171]
    ds_read_b128 v[28:31], v3 offset:12288
    v_mfma_f32_16x16x32_bf16 v[168:171], v[36:39], v[196:199], v[168:171]
    v_cvt_pk_bf16_f32 v93, v18, v19
    v_mfma_f32_16x16x32_bf16 v[172:175], v[32:35], v[216:219], v[172:175]
    v_exp_f32 v18, v126
    v_mfma_f32_16x16x32_bf16 v[172:175], v[36:39], v[220:223], v[172:175]
    s_waitcnt lgkmcnt(2)
    v_add_f32 v8, v8, v16
    v_mfma_f32_16x16x32_bf16 v[96:99], v[40:43], a[208:211], v[96:99]
    s_waitcnt vmcnt(10)
    ds_read_b128 v[32:35], v2 offset:18432
    v_lshlrev_b32 v48, 16, v56
    v_mfma_f32_16x16x32_bf16 v[96:99], v[44:47], a[212:215], v[96:99]
    s_mov_b32 m0, s26
    v_add_f32 v8, v8, v17
    v_and_b32 v49, s97, v56
    v_mfma_f32_16x16x32_bf16 v[100:103], v[40:43], a[232:235], v[100:103]
    s_sub_u32 s3, s29, s30
    v_exp_f32 v19, v127
    v_mfma_f32_16x16x32_bf16 v[100:103], v[44:47], a[236:239], v[100:103]
    buffer_load_dwordx4 v4, s[4:7], s32 offen offset:0 sc1 lds
    v_mfma_f32_16x16x32_bf16 v[104:107], v[40:43], v[192:195], v[104:107]
    ds_read_b128 v[36:39], v3 offset:18432
    v_cvt_pk_bf16_f32 v94, v16, v17
    v_mfma_f32_16x16x32_bf16 v[104:107], v[44:47], v[196:199], v[104:107]
    v_add_f32 v8, v8, v18
    v_add_f32 v8, v8, v19
    v_mfma_f32_16x16x32_bf16 v[108:111], v[40:43], v[216:219], v[108:111]
    v_lshlrev_b32 v50, 16, v58
    v_cvt_pk_bf16_f32 v95, v18, v19
    v_mfma_f32_16x16x32_bf16 v[108:111], v[44:47], v[220:223], v[108:111]
    s_waitcnt lgkmcnt(2)
    buffer_load_dwordx4 v4, s[4:7], s32 offen offset:1024 sc1 lds
    v_mfma_f32_16x16x32_bf16 v[176:179], v[24:27], a[192:195], v[128:131]
    ds_read_b128 v[40:43], v2 offset:12416
    v_and_b32 v51, s97, v58
    v_mfma_f32_16x16x32_bf16 v[176:179], v[28:31], a[196:199], v[176:179]
    s_mov_b32 s30, s29
    v_exp_f32 v16, v160
    v_mfma_f32_16x16x32_bf16 v[180:183], v[24:27], a[216:219], v[132:135]
    v_exp_f32 v17, v161
    v_mfma_f32_16x16x32_bf16 v[180:183], v[28:31], a[220:223], v[180:183]
    buffer_load_dwordx4 v4, s[4:7], s32 offen offset:2048 sc1 lds
    v_mfma_f32_16x16x32_bf16 v[184:187], v[24:27], a[240:243], v[136:139]
    s_add_u32 s32, s32, 24576
    ds_read_b128 v[44:47], v3 offset:12416
    v_mul_f32 v48, s38, v48
    v_mfma_f32_16x16x32_bf16 v[184:187], v[28:31], a[244:247], v[184:187]
    v_exp_f32 v18, v162
    v_mfma_f32_16x16x32_bf16 v[188:191], v[24:27], v[200:203], v[140:143]
    s_add_u32 s26, s26, 12288
    v_add_f32 v5, v5, v16
    v_add_f32 v5, v5, v17
    v_mfma_f32_16x16x32_bf16 v[188:191], v[28:31], v[204:207], v[188:191]
    s_waitcnt lgkmcnt(2)
    v_exp_f32 v19, v163
    v_mfma_f32_16x16x32_bf16 v[112:115], v[32:35], a[192:195], v[128:131]
    s_mov_b32 m0, s26
    ds_read_b128 v[24:27], v2 offset:18560
    v_mul_f32 v49, s38, v49
    v_mfma_f32_16x16x32_bf16 v[112:115], v[36:39], a[196:199], v[112:115]
    v_cvt_pk_bf16_f32 v160, v16, v17
    v_mul_f32_e64 v50, -v50, v48
    v_mfma_f32_16x16x32_bf16 v[116:119], v[32:35], a[216:219], v[132:135]
    v_exp_f32 v16, v96
    v_mfma_f32_16x16x32_bf16 v[116:119], v[36:39], a[220:223], v[116:119]
    v_add_f32 v5, v5, v18
    v_mul_f32_e64 v51, -v51, v49
    v_mfma_f32_16x16x32_bf16 v[120:123], v[32:35], a[240:243], v[136:139]
    ds_read_b128 v[28:31], v3 offset:18560
    v_add_f32 v5, v5, v19
    v_mfma_f32_16x16x32_bf16 v[120:123], v[36:39], a[244:247], v[120:123]
    buffer_load_dwordx4 v4, s[4:7], s32 offen offset:0 sc1 lds
    v_mfma_f32_16x16x32_bf16 v[124:127], v[32:35], v[200:203], v[140:143]
    v_exp_f32 v17, v97
    v_mfma_f32_16x16x32_bf16 v[124:127], v[36:39], v[204:207], v[124:127]
    s_waitcnt lgkmcnt(2)
    v_cvt_pk_bf16_f32 v161, v18, v19
    v_cvt_f32_i32 v224, v224
    v_mfma_f32_16x16x32_bf16 v[176:179], v[40:43], a[200:203], v[176:179]
    ds_read_b128 v[32:35], v2 offset:12544
    v_cvt_f32_i32 v225, v225
    v_mfma_f32_16x16x32_bf16 v[176:179], v[44:47], a[204:207], v[176:179]
    buffer_load_dwordx4 v4, s[4:7], s32 offen offset:1024 sc1 lds
    v_mfma_f32_16x16x32_bf16 v[180:183], v[40:43], a[224:227], v[180:183]
    v_exp_f32 v18, v98
    v_mfma_f32_16x16x32_bf16 v[180:183], v[44:47], a[228:231], v[180:183]
    v_add_f32 v5, v5, v16
    v_add_f32 v5, v5, v17
    v_mfma_f32_16x16x32_bf16 v[184:187], v[40:43], a[248:251], v[184:187]
    ds_read_b128 v[36:39], v3 offset:12544
    v_fma_f32 v224, v224, v48, v50
    v_mfma_f32_16x16x32_bf16 v[184:187], v[44:47], a[252:255], v[184:187]
    buffer_load_dwordx4 v4, s[4:7], s32 offen offset:2048 sc1 lds
    v_mfma_f32_16x16x32_bf16 v[188:191], v[40:43], v[208:211], v[188:191]
    v_exp_f32 v19, v99
    v_mfma_f32_16x16x32_bf16 v[188:191], v[44:47], v[212:215], v[188:191]
    s_waitcnt lgkmcnt(2)
    v_cvt_pk_bf16_f32 v162, v16, v17
    v_fma_f32 v225, v225, v49, v51
    v_mfma_f32_16x16x32_bf16 v[112:115], v[24:27], a[200:203], v[112:115]
    ds_read_b128 v[40:43], v2 offset:18688
    v_add_u32 v1, s3, v1
    v_mfma_f32_16x16x32_bf16 v[112:115], v[28:31], a[204:207], v[112:115]
    v_exp_f32 v16, v164
    v_mfma_f32_16x16x32_bf16 v[116:119], v[24:27], a[224:227], v[116:119]
    v_add_f32 v5, v5, v18
    v_add_f32 v5, v5, v19
    v_mfma_f32_16x16x32_bf16 v[116:119], v[28:31], a[228:231], v[116:119]
    s_add_u32 s32, s32, 24576
    v_exp_f32 v17, v165
    v_mfma_f32_16x16x32_bf16 v[120:123], v[24:27], a[248:251], v[120:123]
    s_add_u32 s26, s26, 36864
    ds_read_b128 v[44:47], v3 offset:18688
    v_cvt_pk_bf16_f32 v163, v18, v19
    v_mfma_f32_16x16x32_bf16 v[120:123], v[28:31], a[252:255], v[120:123]
    s_waitcnt lgkmcnt(2)
    v_exp_f32 v18, v166
    v_mfma_f32_16x16x32_bf16 v[124:127], v[24:27], v[208:211], v[124:127]
    s_waitcnt vmcnt(6)
    v_cvt_pk_bf16_f32 v224, v224, v225
    v_add_f32 v6, v6, v16
    v_mfma_f32_16x16x32_bf16 v[124:127], v[28:31], v[212:215], v[124:127]
    s_barrier
    v_cvt_f32_i32 v228, v228
    v_mfma_f32_16x16x32_bf16 v[176:179], v[32:35], a[208:211], v[176:179]
    s_sub_u32 s57, s26, 147456
    ds_read_b128 v[24:27], v1 offset:0
    v_add_f32 v6, v6, v17
    v_mfma_f32_16x16x32_bf16 v[176:179], v[36:39], a[212:215], v[176:179]
    s_min_u32 s26, s26, s57
    v_exp_f32 v19, v167
    v_mfma_f32_16x16x32_bf16 v[180:183], v[32:35], a[232:235], v[180:183]
    v_cvt_pk_bf16_f32 v164, v16, v17
    v_cvt_f32_i32 v229, v229
    v_mfma_f32_16x16x32_bf16 v[180:183], v[36:39], a[236:239], v[180:183]
    v_exp_f32 v16, v100
    v_mfma_f32_16x16x32_bf16 v[184:187], v[32:35], v[192:195], v[184:187]
    ds_read_b128 v[28:31], v1 offset:12288
    v_fma_f32 v228, v228, v48, v50
    v_mfma_f32_16x16x32_bf16 v[184:187], v[36:39], v[196:199], v[184:187]
    v_add_f32 v6, v6, v18
    v_add_f32 v6, v6, v19
    v_mfma_f32_16x16x32_bf16 v[188:191], v[32:35], v[216:219], v[188:191]
    v_exp_f32 v17, v101
    v_mfma_f32_16x16x32_bf16 v[188:191], v[36:39], v[220:223], v[188:191]
    s_waitcnt lgkmcnt(2)
    v_fma_f32 v229, v229, v49, v51
    v_add_u32 v0, 1, v0
    v_mfma_f32_16x16x32_bf16 v[112:115], v[40:43], a[208:211], v[112:115]
    ds_read_b128 v[32:35], v1 offset:1024
    v_cvt_pk_bf16_f32 v165, v18, v19
    v_mfma_f32_16x16x32_bf16 v[112:115], v[44:47], a[212:215], v[112:115]
    buffer_store_dword v0, v13, s[20:23], 0 offen offset:32 sc1
    v_mfma_f32_16x16x32_bf16 v[116:119], v[40:43], a[232:235], v[116:119]
    v_exp_f32 v18, v102
    v_mfma_f32_16x16x32_bf16 v[116:119], v[44:47], a[236:239], v[116:119]
    v_cvt_pk_bf16_f32 v228, v228, v229
    v_add_f32 v6, v6, v16
    v_mfma_f32_16x16x32_bf16 v[120:123], v[40:43], v[192:195], v[120:123]
    ds_read_b128 v[36:39], v1 offset:13312
    v_add_f32 v6, v6, v17
    v_mfma_f32_16x16x32_bf16 v[120:123], v[44:47], v[196:199], v[120:123]
    v_exp_f32 v19, v103
    v_mfma_f32_16x16x32_bf16 v[124:127], v[40:43], v[216:219], v[124:127]
    v_cvt_f32_i32 v232, v232
    v_cvt_pk_bf16_f32 v166, v16, v17
    v_mfma_f32_16x16x32_bf16 v[124:127], v[44:47], v[220:223], v[124:127]
    s_waitcnt lgkmcnt(2)
    v_add_f32 v6, v6, v18
    v_cvt_f32_i32 v233, v233
    v_add_f32 v6, v6, v19
    v_fma_f32 v232, v232, v48, v50
    v_cvt_pk_bf16_f32 v167, v18, v19
    v_fma_f32 v233, v233, v49, v51
    v_mfma_f32_16x16x32_bf16 a[0:3], v[64:67], v[24:27], a[0:3]
    s_mov_b32 m0, s26
    ds_read_b128 v[40:43], v1 offset:2048
    v_cvt_pk_bf16_f32 v232, v232, v233
    v_mfma_f32_16x16x32_bf16 a[0:3], v[80:83], v[28:31], a[0:3]
    buffer_load_dwordx2 v[60:61], v10, s[72:75], s36 offen offset:192
    v_mfma_f32_16x16x32_bf16 a[48:51], v[68:71], v[24:27], a[48:51]
    v_exp_f32 v16, v168
    v_mfma_f32_16x16x32_bf16 a[48:51], v[84:87], v[28:31], a[48:51]
    v_exp_f32 v17, v169
    v_mfma_f32_16x16x32_bf16 a[96:99], v[72:75], v[24:27], a[96:99]
    ds_read_b128 v[44:47], v1 offset:14336
    v_cvt_f32_i32 v236, v236
    v_mfma_f32_16x16x32_bf16 a[96:99], v[88:91], v[28:31], a[96:99]
    buffer_load_dwordx4 v4, s[4:7], s32 offen offset:0 sc1 lds
    v_mfma_f32_16x16x32_bf16 a[144:147], v[76:79], v[24:27], a[144:147]
    v_exp_f32 v18, v170
    v_mfma_f32_16x16x32_bf16 a[144:147], v[92:95], v[28:31], a[144:147]
    s_waitcnt lgkmcnt(2)
    v_add_f32 v7, v7, v16
    v_add_f32 v7, v7, v17
    v_mfma_f32_16x16x32_bf16 a[4:7], v[64:67], v[32:35], a[4:7]
    ds_read_b128 v[24:27], v1 offset:3072
    v_cvt_f32_i32 v237, v237
    v_mfma_f32_16x16x32_bf16 a[4:7], v[80:83], v[36:39], a[4:7]
    buffer_load_dwordx2 v[62:63], v10, s[76:79], s36 offen offset:192
    v_mfma_f32_16x16x32_bf16 a[52:55], v[68:71], v[32:35], a[52:55]
    v_exp_f32 v19, v171
    v_mfma_f32_16x16x32_bf16 a[52:55], v[84:87], v[36:39], a[52:55]
    v_cvt_pk_bf16_f32 v168, v16, v17
    v_fma_f32 v236, v236, v48, v50
    v_mfma_f32_16x16x32_bf16 a[100:103], v[72:75], v[32:35], a[100:103]
    ds_read_b128 v[28:31], v1 offset:15360
    v_fma_f32 v237, v237, v49, v51
    v_mfma_f32_16x16x32_bf16 a[100:103], v[88:91], v[36:39], a[100:103]
    buffer_load_dwordx4 v[240:243], v9, s[64:67], s33 offen offset:384 nt
    v_mfma_f32_16x16x32_bf16 a[148:151], v[76:79], v[32:35], a[148:151]
    v_exp_f32 v16, v104
    v_mfma_f32_16x16x32_bf16 a[148:151], v[92:95], v[36:39], a[148:151]
    s_waitcnt lgkmcnt(2)
    v_add_f32 v7, v7, v18
    v_add_f32 v7, v7, v19
    v_mfma_f32_16x16x32_bf16 a[8:11], v[64:67], v[40:43], a[8:11]
    ds_read_b128 v[32:35], v1 offset:4096
    v_cvt_pk_bf16_f32 v236, v236, v237
    v_mfma_f32_16x16x32_bf16 a[8:11], v[80:83], v[44:47], a[8:11]
    buffer_load_dwordx4 v4, s[4:7], s32 offen offset:1024 sc1 lds
    v_mfma_f32_16x16x32_bf16 a[56:59], v[68:71], v[40:43], a[56:59]
    v_exp_f32 v17, v105
    v_mfma_f32_16x16x32_bf16 a[56:59], v[84:87], v[44:47], a[56:59]
    v_cvt_pk_bf16_f32 v169, v18, v19
    v_lshlrev_b32 v48, 16, v57
    v_mfma_f32_16x16x32_bf16 a[104:107], v[72:75], v[40:43], a[104:107]
    ds_read_b128 v[36:39], v1 offset:16384
    v_mfma_f32_16x16x32_bf16 a[104:107], v[88:91], v[44:47], a[104:107]
    buffer_load_dwordx4 v[244:247], v9, s[64:67], s33 offen offset:1920 nt
    v_mfma_f32_16x16x32_bf16 a[152:155], v[76:79], v[40:43], a[152:155]
    v_exp_f32 v18, v106
    v_mfma_f32_16x16x32_bf16 a[152:155], v[92:95], v[44:47], a[152:155]
    s_waitcnt lgkmcnt(2)
    v_add_f32 v7, v7, v16
    v_add_f32 v7, v7, v17
    v_mfma_f32_16x16x32_bf16 a[12:15], v[64:67], v[24:27], a[12:15]
    ds_read_b128 v[40:43], v1 offset:5120
    v_and_b32 v49, s97, v57
    v_mfma_f32_16x16x32_bf16 a[12:15], v[80:83], v[28:31], a[12:15]
    buffer_load_dwordx4 v4, s[4:7], s32 offen offset:2048 sc1 lds
    v_mfma_f32_16x16x32_bf16 a[60:63], v[68:71], v[24:27], a[60:63]
    v_exp_f32 v19, v107
    v_mfma_f32_16x16x32_bf16 a[60:63], v[84:87], v[28:31], a[60:63]
    v_cvt_pk_bf16_f32 v170, v16, v17
    v_exp_f32 v16, v172
    v_mfma_f32_16x16x32_bf16 a[108:111], v[72:75], v[24:27], a[108:111]
    ds_read_b128 v[44:47], v1 offset:17408
    v_add_f32 v7, v7, v18
    v_mfma_f32_16x16x32_bf16 a[108:111], v[88:91], v[28:31], a[108:111]
    buffer_load_dwordx4 v[248:251], v9, s[64:67], s34 offen offset:384 nt
    v_add_f32 v7, v7, v19
    v_mfma_f32_16x16x32_bf16 a[156:159], v[76:79], v[24:27], a[156:159]
    s_add_u32 s29, s28, 49152
    v_exp_f32 v17, v173
    v_mfma_f32_16x16x32_bf16 a[156:159], v[92:95], v[28:31], a[156:159]
    s_waitcnt lgkmcnt(2)
    v_cvt_pk_bf16_f32 v171, v18, v19
    v_lshlrev_b32 v50, 16, v59
    v_mfma_f32_16x16x32_bf16 a[16:19], v[64:67], v[32:35], a[16:19]
    s_sub_u32 s3, s29, 147456
    ds_read_b128 v[24:27], v1 offset:6144
    v_and_b32 v51, s97, v59
    v_mfma_f32_16x16x32_bf16 a[16:19], v[80:83], v[36:39], a[16:19]
    s_add_u32 s32, s32, 24576
    buffer_load_dwordx4 v[252:255], v9, s[64:67], s34 offen offset:1920 nt
    v_mfma_f32_16x16x32_bf16 a[64:67], v[68:71], v[32:35], a[64:67]
    s_min_u32 s29, s29, s3
    v_exp_f32 v18, v174
    v_mfma_f32_16x16x32_bf16 a[64:67], v[84:87], v[36:39], a[64:67]
    v_add_f32 v8, v8, v16
    v_add_f32 v8, v8, v17
    v_mfma_f32_16x16x32_bf16 a[112:115], v[72:75], v[32:35], a[112:115]
    s_add_u32 s26, s26, 12288
    ds_read_b128 v[28:31], v1 offset:18432
    v_mul_f32 v48, s38, v48
    v_mfma_f32_16x16x32_bf16 a[112:115], v[88:91], v[36:39], a[112:115]
    v_exp_f32 v19, v175
    v_cvt_pk_bf16_f32 v172, v16, v17
    v_mfma_f32_16x16x32_bf16 a[160:163], v[76:79], v[32:35], a[160:163]
    v_exp_f32 v16, v108
    v_mfma_f32_16x16x32_bf16 a[160:163], v[92:95], v[36:39], a[160:163]
    s_waitcnt lgkmcnt(2)
    v_add_f32 v8, v8, v18
    v_add_f32 v8, v8, v19
    v_mfma_f32_16x16x32_bf16 a[20:23], v[64:67], v[40:43], a[20:23]
    s_sub_u32 s3, s29, s28
    ds_read_b128 v[32:35], v1 offset:7168
    v_mul_f32 v49, s38, v49
    v_mfma_f32_16x16x32_bf16 a[20:23], v[80:83], v[44:47], a[20:23]
    v_exp_f32 v17, v109
    v_mfma_f32_16x16x32_bf16 a[68:71], v[68:71], v[40:43], a[68:71]
    s_mov_b32 m0, s26
    v_cvt_pk_bf16_f32 v173, v18, v19
    v_mul_f32_e64 v50, -v50, v48
    v_mfma_f32_16x16x32_bf16 a[68:71], v[84:87], v[44:47], a[68:71]
    v_exp_f32 v18, v110
    v_mfma_f32_16x16x32_bf16 a[116:119], v[72:75], v[40:43], a[116:119]
    ds_read_b128 v[36:39], v1 offset:19456
    v_add_f32 v8, v8, v16
    v_mfma_f32_16x16x32_bf16 a[116:119], v[88:91], v[44:47], a[116:119]
    v_add_f32 v8, v8, v17
    v_mul_f32_e64 v51, -v51, v49
    v_mfma_f32_16x16x32_bf16 a[164:167], v[76:79], v[40:43], a[164:167]
    s_mov_b32 s28, s29
    v_exp_f32 v19, v111
    v_mfma_f32_16x16x32_bf16 a[164:167], v[92:95], v[44:47], a[164:167]
    s_waitcnt lgkmcnt(2)
    v_cvt_pk_bf16_f32 v174, v16, v17
    v_add_f32 v8, v8, v18
    v_mfma_f32_16x16x32_bf16 a[24:27], v[64:67], v[24:27], a[24:27]
    ds_read_b128 v[40:43], v1 offset:8192
    v_add_f32 v8, v8, v19
    v_mfma_f32_16x16x32_bf16 a[24:27], v[80:83], v[28:31], a[24:27]
    v_cvt_pk_bf16_f32 v175, v18, v19
    v_cvt_f32_i32 v226, v226
    v_mfma_f32_16x16x32_bf16 a[72:75], v[68:71], v[24:27], a[72:75]
    v_exp_f32 v16, v176
    v_mfma_f32_16x16x32_bf16 a[72:75], v[84:87], v[28:31], a[72:75]
    buffer_load_dwordx4 v4, s[4:7], s32 offen offset:0 sc1 lds
    v_mfma_f32_16x16x32_bf16 a[120:123], v[72:75], v[24:27], a[120:123]
    ds_read_b128 v[44:47], v1 offset:20480
    v_mfma_f32_16x16x32_bf16 a[120:123], v[88:91], v[28:31], a[120:123]
    v_exp_f32 v17, v177
    v_mfma_f32_16x16x32_bf16 a[168:171], v[76:79], v[24:27], a[168:171]
    v_exp_f32 v18, v178
    v_mfma_f32_16x16x32_bf16 a[168:171], v[92:95], v[28:31], a[168:171]
    s_waitcnt lgkmcnt(2)
    v_add_f32 v5, v5, v16
    v_add_f32 v5, v5, v17
    v_mfma_f32_16x16x32_bf16 a[28:31], v[64:67], v[32:35], a[28:31]
    ds_read_b128 v[24:27], v1 offset:9216
    v_cvt_f32_i32 v227, v227
    v_mfma_f32_16x16x32_bf16 a[28:31], v[80:83], v[36:39], a[28:31]
    v_exp_f32 v19, v179
    v_mfma_f32_16x16x32_bf16 a[76:79], v[68:71], v[32:35], a[76:79]
    v_cvt_pk_bf16_f32 v176, v16, v17
    v_add_u32 v2, s3, v2
    v_mfma_f32_16x16x32_bf16 a[76:79], v[84:87], v[36:39], a[76:79]
L_pg6:
    s_cbranch_execz L_pg10
    v_exp_f32 v16, v112
    v_mfma_f32_16x16x32_bf16 a[124:127], v[72:75], v[32:35], a[124:127]
    ds_read_b128 v[28:31], v1 offset:21504
    v_add_f32 v5, v5, v18
    v_mfma_f32_16x16x32_bf16 a[124:127], v[88:91], v[36:39], a[124:127]
    v_add_f32 v5, v5, v19
    v_fma_f32 v226, v226, v48, v50
    v_mfma_f32_16x16x32_bf16 a[172:175], v[76:79], v[32:35], a[172:175]
    v_exp_f32 v17, v113
    v_mfma_f32_16x16x32_bf16 a[172:175], v[92:95], v[36:39], a[172:175]
    s_waitcnt lgkmcnt(2)
    buffer_load_dwordx4 v4, s[4:7], s32 offen offset:1024 sc1 lds
    v_mfma_f32_16x16x32_bf16 a[32:35], v[64:67], v[40:43], a[32:35]
    ds_read_b128 v[32:35], v1 offset:10240
    v_cvt_pk_bf16_f32 v177, v18, v19
    v_mfma_f32_16x16x32_bf16 a[32:35], v[80:83], v[44:47], a[32:35]
    v_exp_f32 v18, v114
    v_mfma_f32_16x16x32_bf16 a[80:83], v[68:71], v[40:43], a[80:83]
    v_add_f32 v5, v5, v16
    v_add_f32 v5, v5, v17
    v_mfma_f32_16x16x32_bf16 a[80:83], v[84:87], v[44:47], a[80:83]
    v_exp_f32 v19, v115
    v_mfma_f32_16x16x32_bf16 a[128:131], v[72:75], v[40:43], a[128:131]
    ds_read_b128 v[36:39], v1 offset:22528
    v_cvt_pk_bf16_f32 v178, v16, v17
    v_mfma_f32_16x16x32_bf16 a[128:131], v[88:91], v[44:47], a[128:131]
    v_exp_f32 v16, v180
    v_mfma_f32_16x16x32_bf16 a[176:179], v[76:79], v[40:43], a[176:179]
    v_fma_f32 v227, v227, v49, v51
    v_add_u32 v3, s3, v3
    v_mfma_f32_16x16x32_bf16 a[176:179], v[92:95], v[44:47], a[176:179]
    s_waitcnt lgkmcnt(2)
    v_add_f32 v5, v5, v18
    v_add_f32 v5, v5, v19
    v_mfma_f32_16x16x32_bf16 a[36:39], v[64:67], v[24:27], a[36:39]
    ds_read_b128 v[40:43], v1 offset:11264
    v_cvt_pk_bf16_f32 v225, v226, v227
    v_mfma_f32_16x16x32_bf16 a[36:39], v[80:83], v[28:31], a[36:39]
    buffer_load_dwordx4 v4, s[4:7], s32 offen offset:2048 sc1 lds
    v_mfma_f32_16x16x32_bf16 a[84:87], v[68:71], v[24:27], a[84:87]
    v_exp_f32 v17, v181
    v_mfma_f32_16x16x32_bf16 a[84:87], v[84:87], v[28:31], a[84:87]
    v_cvt_pk_bf16_f32 v179, v18, v19
    v_cvt_f32_i32 v230, v230
    v_mfma_f32_16x16x32_bf16 a[132:135], v[72:75], v[24:27], a[132:135]
    ds_read_b128 v[44:47], v1 offset:23552
    v_cvt_f32_i32 v231, v231
    v_mfma_f32_16x16x32_bf16 a[132:135], v[88:91], v[28:31], a[132:135]
    s_waitcnt lgkmcnt(2)
    v_exp_f32 v18, v182
    v_mfma_f32_16x16x32_bf16 a[180:183], v[76:79], v[24:27], a[180:183]
    s_waitcnt vmcnt(13)
    v_add_f32 v6, v6, v16
    v_add_f32 v6, v6, v17
    v_mfma_f32_16x16x32_bf16 a[180:183], v[92:95], v[28:31], a[180:183]
    s_barrier
    v_fma_f32 v230, v230, v48, v50
    v_mfma_f32_16x16x32_bf16 a[40:43], v[64:67], v[32:35], a[40:43]
    ds_read_b128 v[24:27], v2 offset:0
    v_mfma_f32_16x16x32_bf16 a[40:43], v[80:83], v[36:39], a[40:43]
    v_exp_f32 v19, v183
    v_mfma_f32_16x16x32_bf16 a[88:91], v[68:71], v[32:35], a[88:91]
    v_cvt_pk_bf16_f32 v180, v16, v17
    v_fma_f32 v231, v231, v49, v51
    v_mfma_f32_16x16x32_bf16 a[88:91], v[84:87], v[36:39], a[88:91]
    v_exp_f32 v16, v116
    v_mfma_f32_16x16x32_bf16 a[136:139], v[72:75], v[32:35], a[136:139]
    ds_read_b128 v[28:31], v3 offset:0
    v_add_f32 v6, v6, v18
    v_mfma_f32_16x16x32_bf16 a[136:139], v[88:91], v[36:39], a[136:139]
    v_add_f32 v6, v6, v19
    v_cvt_pk_bf16_f32 v229, v230, v231
    v_mfma_f32_16x16x32_bf16 a[184:187], v[76:79], v[32:35], a[184:187]
    v_exp_f32 v17, v117
    v_mfma_f32_16x16x32_bf16 a[184:187], v[92:95], v[36:39], a[184:187]
    s_waitcnt lgkmcnt(2)
    v_cvt_pk_bf16_f32 v181, v18, v19
    v_mfma_f32_16x16x32_bf16 a[44:47], v[64:67], v[40:43], a[44:47]
    ds_read_b128 v[32:35], v2 offset:6144
    v_mfma_f32_16x16x32_bf16 a[44:47], v[80:83], v[44:47], a[44:47]
    v_exp_f32 v18, v118
    v_mfma_f32_16x16x32_bf16 a[92:95], v[68:71], v[40:43], a[92:95]
    v_add_f32 v6, v6, v16
    v_add_f32 v6, v6, v17
    v_mfma_f32_16x16x32_bf16 a[92:95], v[84:87], v[44:47], a[92:95]
    s_add_u32 s32, s32, 24576
    v_exp_f32 v19, v119
    v_mfma_f32_16x16x32_bf16 a[140:143], v[72:75], v[40:43], a[140:143]
    s_add_u32 s26, s26, 36864
    ds_read_b128 v[36:39], v3 offset:6144
    v_cvt_pk_bf16_f32 v182, v16, v17
    v_mfma_f32_16x16x32_bf16 a[140:143], v[88:91], v[44:47], a[140:143]
    s_sub_u32 s57, s26, 147456
    v_add_f32 v6, v6, v18
    v_add_f32 v6, v6, v19
    v_mfma_f32_16x16x32_bf16 a[188:191], v[76:79], v[40:43], a[188:191]
    s_min_u32 s26, s26, s57
    v_cvt_pk_bf16_f32 v183, v18, v19
    v_mfma_f32_16x16x32_bf16 a[188:191], v[92:95], v[44:47], a[188:191]
    s_waitcnt lgkmcnt(2)
    v_mfma_f32_16x16x32_bf16 v[64:67], v[24:27], a[192:195], v[128:131]
    ds_read_b128 v[40:43], v2 offset:128
    v_cvt_f32_i32 v234, v234
    v_mfma_f32_16x16x32_bf16 v[64:67], v[28:31], a[196:199], v[64:67]
    v_exp_f32 v16, v184
    v_mfma_f32_16x16x32_bf16 v[68:71], v[24:27], a[216:219], v[132:135]
    v_exp_f32 v17, v185
    v_mfma_f32_16x16x32_bf16 v[68:71], v[28:31], a[220:223], v[68:71]
    buffer_load_dword v52, v20, s[20:23], s44 offen sc1
    v_mfma_f32_16x16x32_bf16 v[72:75], v[24:27], a[240:243], v[136:139]
    ds_read_b128 v[44:47], v3 offset:128
    v_cvt_f32_i32 v235, v235
    v_mfma_f32_16x16x32_bf16 v[72:75], v[28:31], a[244:247], v[72:75]
    v_exp_f32 v18, v186
    v_mfma_f32_16x16x32_bf16 v[76:79], v[24:27], v[200:203], v[140:143]
    v_add_f32 v7, v7, v16
    v_add_f32 v7, v7, v17
    v_mfma_f32_16x16x32_bf16 v[76:79], v[28:31], v[204:207], v[76:79]
    s_waitcnt lgkmcnt(2)
    v_exp_f32 v19, v187
    v_mfma_f32_16x16x32_bf16 v[96:99], v[32:35], a[192:195], v[128:131]
    ds_read_b128 v[24:27], v2 offset:6272
    v_cvt_pk_bf16_f32 v184, v16, v17
    v_mfma_f32_16x16x32_bf16 v[96:99], v[36:39], a[196:199], v[96:99]
    v_exp_f32 v16, v120
    v_mfma_f32_16x16x32_bf16 v[100:103], v[32:35], a[216:219], v[132:135]
    v_add_f32 v7, v7, v18
    v_fma_f32 v234, v234, v48, v50
    v_mfma_f32_16x16x32_bf16 v[100:103], v[36:39], a[220:223], v[100:103]
    s_add_u32 s35, s35, 196608
    s_mov_b32 m0, s26
    v_add_f32 v7, v7, v19
    v_mfma_f32_16x16x32_bf16 v[104:107], v[32:35], a[240:243], v[136:139]
    s_add_u32 s16, s16, 196608
    ds_read_b128 v[28:31], v3 offset:6272
    v_fma_f32 v235, v235, v49, v51
    v_mfma_f32_16x16x32_bf16 v[104:107], v[36:39], a[244:247], v[104:107]
    s_add_u32 s17, s17, 196608
    buffer_load_dwordx4 v4, s[4:7], s32 offen offset:0 sc1 lds
    v_mfma_f32_16x16x32_bf16 v[108:111], v[32:35], v[200:203], v[140:143]
    v_exp_f32 v17, v121
    v_mfma_f32_16x16x32_bf16 v[108:111], v[36:39], v[204:207], v[108:111]
    s_waitcnt lgkmcnt(2)
    v_cvt_pk_bf16_f32 v185, v18, v19
    v_cvt_pk_bf16_f32 v233, v234, v235
    v_mfma_f32_16x16x32_bf16 v[64:67], v[40:43], a[200:203], v[64:67]
    s_add_u32 s37, s37, 512
    ds_read_b128 v[32:35], v2 offset:256
    v_mfma_f32_16x16x32_bf16 v[64:67], v[44:47], a[204:207], v[64:67]
    v_exp_f32 v18, v122
    v_mfma_f32_16x16x32_bf16 v[68:71], v[40:43], a[224:227], v[68:71]
    v_add_f32 v7, v7, v16
    v_add_f32 v7, v7, v17
    v_mfma_f32_16x16x32_bf16 v[68:71], v[44:47], a[228:231], v[68:71]
    v_exp_f32 v19, v123
    v_mfma_f32_16x16x32_bf16 v[72:75], v[40:43], a[248:251], v[72:75]
    ds_read_b128 v[36:39], v3 offset:256
    v_cvt_pk_bf16_f32 v186, v16, v17
    v_mfma_f32_16x16x32_bf16 v[72:75], v[44:47], a[252:255], v[72:75]
    buffer_load_dwordx4 v4, s[4:7], s32 offen offset:1024 sc1 lds
    v_mfma_f32_16x16x32_bf16 v[76:79], v[40:43], v[208:211], v[76:79]
    v_exp_f32 v16, v188
    v_mfma_f32_16x16x32_bf16 v[76:79], v[44:47], v[212:215], v[76:79]
    s_waitcnt lgkmcnt(2)
    v_add_f32 v7, v7, v18
    v_add_f32 v7, v7, v19
    v_mfma_f32_16x16x32_bf16 v[96:99], v[24:27], a[200:203], v[96:99]
    ds_read_b128 v[40:43], v2 offset:6400
    v_cvt_f32_i32 v238, v238
    v_mfma_f32_16x16x32_bf16 v[96:99], v[28:31], a[204:207], v[96:99]
    buffer_load_dwordx2 v[56:57], off, s[80:83], s37 offset:0
    v_mfma_f32_16x16x32_bf16 v[100:103], v[24:27], a[224:227], v[100:103]
    v_exp_f32 v17, v189
    v_mfma_f32_16x16x32_bf16 v[100:103], v[28:31], a[228:231], v[100:103]
    v_cvt_pk_bf16_f32 v187, v18, v19
    v_cvt_f32_i32 v239, v239
    v_mfma_f32_16x16x32_bf16 v[104:107], v[24:27], a[248:251], v[104:107]
    ds_read_b128 v[44:47], v3 offset:6400
    v_mfma_f32_16x16x32_bf16 v[104:107], v[28:31], a[252:255], v[104:107]
    buffer_load_dwordx2 v[58:59], off, s[84:87], s37 offset:0
    v_mfma_f32_16x16x32_bf16 v[108:111], v[24:27], v[208:211], v[108:111]
    s_add_u32 s29, s30, 49152
    v_exp_f32 v18, v190
    v_mfma_f32_16x16x32_bf16 v[108:111], v[28:31], v[212:215], v[108:111]
    s_waitcnt lgkmcnt(2)
    v_add_f32 v8, v8, v16
    v_add_f32 v8, v8, v17
    v_mfma_f32_16x16x32_bf16 v[64:67], v[32:35], a[208:211], v[64:67]
    s_sub_u32 s3, s29, 147456
    ds_read_b128 v[24:27], v2 offset:12288
    v_mfma_f32_16x16x32_bf16 v[64:67], v[36:39], a[212:215], v[64:67]
    s_min_u32 s29, s29, s3
    buffer_load_dwordx4 v4, s[4:7], s32 offen offset:2048 sc1 lds
    v_mfma_f32_16x16x32_bf16 v[68:71], v[32:35], a[232:235], v[68:71]
    v_exp_f32 v19, v191
    v_mfma_f32_16x16x32_bf16 v[68:71], v[36:39], a[236:239], v[68:71]
    v_cvt_pk_bf16_f32 v188, v16, v17
    v_fma_f32 v238, v238, v48, v50
    v_mfma_f32_16x16x32_bf16 v[72:75], v[32:35], v[192:195], v[72:75]
    ds_read_b128 v[28:31], v3 offset:12288
    v_mfma_f32_16x16x32_bf16 v[72:75], v[36:39], v[196:199], v[72:75]
    buffer_load_dwordx3 v[144:146], v12, s[68:71], s35 offen offset:0 nt
    v_mfma_f32_16x16x32_bf16 v[76:79], v[32:35], v[216:219], v[76:79]
    v_exp_f32 v16, v124
    v_mfma_f32_16x16x32_bf16 v[76:79], v[36:39], v[220:223], v[76:79]
    s_waitcnt lgkmcnt(2)
    v_add_f32 v8, v8, v18
    v_add_f32 v8, v8, v19
    v_mfma_f32_16x16x32_bf16 v[96:99], v[40:43], a[208:211], v[96:99]
    s_add_u32 s32, s32, 24576
    ds_read_b128 v[32:35], v2 offset:18432
    v_fma_f32 v239, v239, v49, v51
    v_mfma_f32_16x16x32_bf16 v[96:99], v[44:47], a[212:215], v[96:99]
    s_sub_u32 s3, s29, s30
    v_exp_f32 v17, v125
    v_mfma_f32_16x16x32_bf16 v[100:103], v[40:43], a[232:235], v[100:103]
    v_cvt_pk_bf16_f32 v189, v18, v19
    v_mfma_f32_16x16x32_bf16 v[100:103], v[44:47], a[236:239], v[100:103]
    v_exp_f32 v18, v126
    v_mfma_f32_16x16x32_bf16 v[104:107], v[40:43], v[192:195], v[104:107]
    s_add_u32 s26, s26, 12288
    ds_read_b128 v[36:39], v3 offset:18432
    v_add_f32 v8, v8, v16
    v_mfma_f32_16x16x32_bf16 v[104:107], v[44:47], v[196:199], v[104:107]
    buffer_load_dwordx3 v[148:150], v12, s[68:71], s35 offen offset:768 nt
    v_mfma_f32_16x16x32_bf16 v[108:111], v[40:43], v[216:219], v[108:111]
    v_add_f32 v8, v8, v17
    v_cvt_pk_bf16_f32 v237, v238, v239
    v_mfma_f32_16x16x32_bf16 v[108:111], v[44:47], v[220:223], v[108:111]
    s_waitcnt lgkmcnt(2)
    v_exp_f32 v19, v127
    v_mfma_f32_16x16x32_bf16 v[80:83], v[24:27], a[192:195], v[128:131]
    ds_read_b128 v[40:43], v2 offset:12416
    v_cvt_pk_bf16_f32 v190, v16, v17
    v_mfma_f32_16x16x32_bf16 v[80:83], v[28:31], a[196:199], v[80:83]
    s_mov_b32 m0, s26
    v_add_f32 v8, v8, v18
    v_add_f32 v8, v8, v19
    v_mfma_f32_16x16x32_bf16 v[84:87], v[24:27], a[216:219], v[132:135]
    s_mov_b32 s30, s29
    v_cvt_pk_bf16_f32 v191, v18, v19
    v_mfma_f32_16x16x32_bf16 v[84:87], v[28:31], a[220:223], v[84:87]
    v_exp_f32 v16, v64
    v_mfma_f32_16x16x32_bf16 v[88:91], v[24:27], a[240:243], v[136:139]
    ds_read_b128 v[44:47], v3 offset:12416
    v_mfma_f32_16x16x32_bf16 v[88:91], v[28:31], a[244:247], v[88:91]
    buffer_load_dwordx3 v[152:154], v12, s[68:71], s35 offen offset:1536 nt
    v_mfma_f32_16x16x32_bf16 v[92:95], v[24:27], v[200:203], v[140:143]
    v_exp_f32 v17, v65
    v_mfma_f32_16x16x32_bf16 v[92:95], v[28:31], v[204:207], v[92:95]
    s_waitcnt lgkmcnt(2)
    v_exp_f32 v18, v66
    v_mfma_f32_16x16x32_bf16 v[112:115], v[32:35], a[192:195], v[128:131]
    ds_read_b128 v[24:27], v2 offset:18560
    v_add_f32 v5, v5, v16
    v_mfma_f32_16x16x32_bf16 v[112:115], v[36:39], a[196:199], v[112:115]
    buffer_load_dwordx4 v4, s[4:7], s32 offen offset:0 sc1 lds
    v_mfma_f32_16x16x32_bf16 v[116:119], v[32:35], a[216:219], v[132:135]
    v_add_f32 v5, v5, v17
    v_add_u32 v1, s3, v1
    v_mfma_f32_16x16x32_bf16 v[116:119], v[36:39], a[220:223], v[116:119]
    v_exp_f32 v19, v67
    v_mfma_f32_16x16x32_bf16 v[120:123], v[32:35], a[240:243], v[136:139]
    ds_read_b128 v[28:31], v3 offset:18560
    v_cvt_pk_bf16_f32 v64, v16, v17
    v_mfma_f32_16x16x32_bf16 v[120:123], v[36:39], a[244:247], v[120:123]
    s_waitcnt vmcnt(13)
    buffer_load_dwordx3 v[156:158], v12, s[68:71], s35 offen offset:2304 nt
    v_mfma_f32_16x16x32_bf16 v[124:127], v[32:35], v[200:203], v[140:143]
    v_exp_f32 v16, v96
    v_mfma_f32_16x16x32_bf16 v[124:127], v[36:39], v[204:207], v[124:127]
    s_waitcnt lgkmcnt(2)
    v_add_f32 v5, v5, v18
    v_add_f32 v5, v5, v19
    v_mfma_f32_16x16x32_bf16 v[80:83], v[40:43], a[200:203], v[80:83]
    ds_read_b128 v[32:35], v2 offset:12544
    v_lshlrev_b32 v48, 16, v60
    v_mfma_f32_16x16x32_bf16 v[80:83], v[44:47], a[204:207], v[80:83]
    v_exp_f32 v17, v97
    v_mfma_f32_16x16x32_bf16 v[84:87], v[40:43], a[224:227], v[84:87]
    v_cvt_pk_bf16_f32 v65, v18, v19
    v_and_b32 v49, s97, v60
    v_mfma_f32_16x16x32_bf16 v[84:87], v[44:47], a[228:231], v[84:87]
    buffer_load_dwordx4 v4, s[4:7], s32 offen offset:1024 sc1 lds
    v_mfma_f32_16x16x32_bf16 v[88:91], v[40:43], a[248:251], v[88:91]
    ds_read_b128 v[36:39], v3 offset:12544
    v_lshlrev_b32 v50, 16, v62
    v_mfma_f32_16x16x32_bf16 v[88:91], v[44:47], a[252:255], v[88:91]
    v_exp_f32 v18, v98
    v_mfma_f32_16x16x32_bf16 v[92:95], v[40:43], v[208:211], v[92:95]
    v_add_f32 v5, v5, v16
    v_add_f32 v5, v5, v17
    v_mfma_f32_16x16x32_bf16 v[92:95], v[44:47], v[212:215], v[92:95]
    s_waitcnt lgkmcnt(2)
    v_exp_f32 v19, v99
    v_mfma_f32_16x16x32_bf16 v[112:115], v[24:27], a[200:203], v[112:115]
    ds_read_b128 v[40:43], v2 offset:18688
    v_cvt_pk_bf16_f32 v66, v16, v17
    v_mfma_f32_16x16x32_bf16 v[112:115], v[28:31], a[204:207], v[112:115]
    v_exp_f32 v16, v68
    v_mfma_f32_16x16x32_bf16 v[116:119], v[24:27], a[224:227], v[116:119]
    v_add_f32 v5, v5, v18
    v_add_f32 v5, v5, v19
    v_mfma_f32_16x16x32_bf16 v[116:119], v[28:31], a[228:231], v[116:119]
    v_exp_f32 v17, v69
    v_mfma_f32_16x16x32_bf16 v[120:123], v[24:27], a[248:251], v[120:123]
    ds_read_b128 v[44:47], v3 offset:18688
    v_cvt_pk_bf16_f32 v67, v18, v19
    v_mfma_f32_16x16x32_bf16 v[120:123], v[28:31], a[252:255], v[120:123]
    s_waitcnt lgkmcnt(2)
    buffer_load_dwordx4 v4, s[4:7], s32 offen offset:2048 sc1 lds
    v_mfma_f32_16x16x32_bf16 v[124:127], v[24:27], v[208:211], v[124:127]
    s_waitcnt vmcnt(13)
    v_exp_f32 v18, v70
    v_mfma_f32_16x16x32_bf16 v[124:127], v[28:31], v[212:215], v[124:127]
    s_barrier
    v_add_f32 v6, v6, v16
    v_mfma_f32_16x16x32_bf16 v[80:83], v[32:35], a[208:211], v[80:83]
    ds_read_b128 v[24:27], v1 offset:0
    v_add_f32 v6, v6, v17
    v_mfma_f32_16x16x32_bf16 v[80:83], v[36:39], a[212:215], v[80:83]
    v_exp_f32 v19, v71
    v_mfma_f32_16x16x32_bf16 v[84:87], v[32:35], a[232:235], v[84:87]
    v_cvt_pk_bf16_f32 v68, v16, v17
    v_and_b32 v51, s97, v62
    v_mfma_f32_16x16x32_bf16 v[84:87], v[36:39], a[236:239], v[84:87]
    v_exp_f32 v16, v100
    v_mfma_f32_16x16x32_bf16 v[88:91], v[32:35], v[192:195], v[88:91]
    ds_read_b128 v[28:31], v1 offset:12288
    v_add_f32 v6, v6, v18
    v_mfma_f32_16x16x32_bf16 v[88:91], v[36:39], v[196:199], v[88:91]
    v_add_f32 v6, v6, v19
    v_mul_f32 v48, s38, v48
    v_mfma_f32_16x16x32_bf16 v[92:95], v[32:35], v[216:219], v[92:95]
    v_exp_f32 v17, v101
    v_mfma_f32_16x16x32_bf16 v[92:95], v[36:39], v[220:223], v[92:95]
    s_waitcnt lgkmcnt(2)
    v_cvt_pk_bf16_f32 v69, v18, v19
    v_mul_f32 v49, s38, v49
    v_mfma_f32_16x16x32_bf16 v[112:115], v[40:43], a[208:211], v[112:115]
    ds_read_b128 v[32:35], v1 offset:1024
    v_mfma_f32_16x16x32_bf16 v[112:115], v[44:47], a[212:215], v[112:115]
    v_exp_f32 v18, v102
    v_mfma_f32_16x16x32_bf16 v[116:119], v[40:43], a[232:235], v[116:119]
    v_add_f32 v6, v6, v16
    v_add_f32 v6, v6, v17
    v_mfma_f32_16x16x32_bf16 v[116:119], v[44:47], a[236:239], v[116:119]
    v_exp_f32 v19, v103
    v_mfma_f32_16x16x32_bf16 v[120:123], v[40:43], v[192:195], v[120:123]
    ds_read_b128 v[36:39], v1 offset:13312
    v_cvt_pk_bf16_f32 v70, v16, v17
    v_mfma_f32_16x16x32_bf16 v[120:123], v[44:47], v[196:199], v[120:123]
    s_add_u32 s32, s32, 24576
    v_add_f32 v6, v6, v18
    s_add_u32 s26, s26, 36864
    v_mfma_f32_16x16x32_bf16 v[124:127], v[40:43], v[216:219], v[124:127]
    s_sub_u32 s57, s26, 147456
    v_add_f32 v6, v6, v19
    v_cvt_pk_bf16_f32 v71, v18, v19
    v_mfma_f32_16x16x32_bf16 v[124:127], v[44:47], v[220:223], v[124:127]
    s_waitcnt lgkmcnt(2)
    s_min_u32 s26, s26, s57
    v_mfma_f32_16x16x32_bf16 a[0:3], v[160:163], v[24:27], a[0:3]
    ds_read_b128 v[40:43], v1 offset:2048
    v_mul_f32_e64 v50, -v50, v48
    v_mfma_f32_16x16x32_bf16 a[0:3], v[176:179], v[28:31], a[0:3]
    s_waitcnt vmcnt(12)
    v_subrev_u32 v52, s92, v52
    v_cmp_lt_u32 vcc, 15, v52
    v_mfma_f32_16x16x32_bf16 a[48:51], v[164:167], v[24:27], a[48:51]
    v_exp_f32 v16, v72
    v_mfma_f32_16x16x32_bf16 a[48:51], v[180:183], v[28:31], a[48:51]
    v_exp_f32 v17, v73
    v_mfma_f32_16x16x32_bf16 a[96:99], v[168:171], v[24:27], a[96:99]
    s_and_b32 s59, vcc_lo, 0xff
    ds_read_b128 v[44:47], v1 offset:14336
    v_mul_f32_e64 v51, -v51, v49
    v_mfma_f32_16x16x32_bf16 a[96:99], v[184:187], v[28:31], a[96:99]
    s_cbranch_scc1 L_pollslow2
L_pollok2:
    v_mfma_f32_16x16x32_bf16 a[144:147], v[172:175], v[24:27], a[144:147]
    s_add_u32 s92, s92, 1
    v_exp_f32 v18, v74
    v_mfma_f32_16x16x32_bf16 a[144:147], v[188:191], v[28:31], a[144:147]
    s_waitcnt lgkmcnt(2)
    v_add_f32 v7, v7, v16
    v_add_f32 v7, v7, v17
    v_mfma_f32_16x16x32_bf16 a[4:7], v[160:163], v[32:35], a[4:7]
    s_mov_b32 m0, s56
    ds_read_b128 v[24:27], v1 offset:3072
    v_cvt_f32_i32 v240, v240
    v_mfma_f32_16x16x32_bf16 a[4:7], v[176:179], v[36:39], a[4:7]
    buffer_load_dwordx4 v4, s[4:7], s27 offen offset:0 sc1 lds
    v_mfma_f32_16x16x32_bf16 a[52:55], v[164:167], v[32:35], a[52:55]
    v_exp_f32 v19, v75
    v_mfma_f32_16x16x32_bf16 a[52:55], v[180:183], v[36:39], a[52:55]
    v_cvt_pk_bf16_f32 v72, v16, v17
    v_cvt_f32_i32 v241, v241
    v_mfma_f32_16x16x32_bf16 a[100:103], v[168:171], v[32:35], a[100:103]
    ds_read_b128 v[28:31], v1 offset:15360
    v_fma_f32 v240, v240, v48, v50
    v_mfma_f32_16x16x32_bf16 a[100:103], v[184:187], v[36:39], a[100:103]
    v_exp_f32 v16, v104
    v_mfma_f32_16x16x32_bf16 a[148:151], v[172:175], v[32:35], a[148:151]
    v_add_f32 v7, v7, v18
    v_add_f32 v7, v7, v19
    v_mfma_f32_16x16x32_bf16 a[148:151], v[188:191], v[36:39], a[148:151]
    s_waitcnt lgkmcnt(2)
    v_exp_f32 v17, v105
    v_mfma_f32_16x16x32_bf16 a[8:11], v[160:163], v[40:43], a[8:11]
    ds_read_b128 v[32:35], v1 offset:4096
    v_cvt_pk_bf16_f32 v73, v18, v19
    v_mfma_f32_16x16x32_bf16 a[8:11], v[176:179], v[44:47], a[8:11]
    buffer_load_dwordx4 v4, s[4:7], s27 offen offset:1024 sc1 lds
    v_mfma_f32_16x16x32_bf16 a[56:59], v[164:167], v[40:43], a[56:59]
    v_exp_f32 v18, v106
    v_mfma_f32_16x16x32_bf16 a[56:59], v[180:183], v[44:47], a[56:59]
    v_add_f32 v7, v7, v16
    v_fma_f32 v241, v241, v49, v51
    v_mfma_f32_16x16x32_bf16 a[104:107], v[168:171], v[40:43], a[104:107]
    ds_read_b128 v[36:39], v1 offset:16384
    v_add_f32 v7, v7, v17
    v_mfma_f32_16x16x32_bf16 a[104:107], v[184:187], v[44:47], a[104:107]
    v_exp_f32 v19, v107
    v_mfma_f32_16x16x32_bf16 a[152:155], v[172:175], v[40:43], a[152:155]
    v_cvt_pk_bf16_f32 v74, v16, v17
    v_cvt_pk_bf16_f32 v226, v240, v241
    v_mfma_f32_16x16x32_bf16 a[152:155], v[188:191], v[44:47], a[152:155]
    s_waitcnt lgkmcnt(2)
    v_exp_f32 v16, v76
    v_mfma_f32_16x16x32_bf16 a[12:15], v[160:163], v[24:27], a[12:15]
    ds_read_b128 v[40:43], v1 offset:5120
    v_add_f32 v7, v7, v18
    v_mfma_f32_16x16x32_bf16 a[12:15], v[176:179], v[28:31], a[12:15]
    buffer_load_dwordx4 v4, s[4:7], s27 offen offset:2048 sc1 lds
    v_mfma_f32_16x16x32_bf16 a[60:63], v[164:167], v[24:27], a[60:63]
    v_add_f32 v7, v7, v19
    v_cvt_f32_i32 v244, v244
    v_mfma_f32_16x16x32_bf16 a[60:63], v[180:183], v[28:31], a[60:63]
    v_exp_f32 v17, v77
    v_mfma_f32_16x16x32_bf16 a[108:111], v[168:171], v[24:27], a[108:111]
    ds_read_b128 v[44:47], v1 offset:17408
    v_cvt_pk_bf16_f32 v75, v18, v19
    v_mfma_f32_16x16x32_bf16 a[108:111], v[184:187], v[28:31], a[108:111]
    v_exp_f32 v18, v78
    v_mfma_f32_16x16x32_bf16 a[156:159], v[172:175], v[24:27], a[156:159]
    s_add_u32 s29, s28, 49152
    v_cvt_f32_i32 v245, v245
    v_fma_f32 v244, v244, v48, v50
    v_mfma_f32_16x16x32_bf16 a[156:159], v[188:191], v[28:31], a[156:159]
    s_waitcnt lgkmcnt(2)
    v_add_f32 v8, v8, v16
    v_add_f32 v8, v8, v17
    v_mfma_f32_16x16x32_bf16 a[16:19], v[160:163], v[32:35], a[16:19]
    s_sub_u32 s3, s29, 147456
    ds_read_b128 v[24:27], v1 offset:6144
    v_fma_f32 v245, v245, v49, v51
    v_mfma_f32_16x16x32_bf16 a[16:19], v[176:179], v[36:39], a[16:19]
    s_add_u32 s27, s27, 24576
    v_exp_f32 v19, v79
    v_mfma_f32_16x16x32_bf16 a[64:67], v[164:167], v[32:35], a[64:67]
    s_min_u32 s29, s29, s3
    v_cvt_pk_bf16_f32 v76, v16, v17
    v_cvt_pk_bf16_f32 v230, v244, v245
    v_mfma_f32_16x16x32_bf16 a[64:67], v[180:183], v[36:39], a[64:67]
    s_add_u32 s56, s56, 12288
    v_exp_f32 v16, v108
    v_mfma_f32_16x16x32_bf16 a[112:115], v[168:171], v[32:35], a[112:115]
    ds_read_b128 v[28:31], v1 offset:18432
    v_add_f32 v8, v8, v18
    v_mfma_f32_16x16x32_bf16 a[112:115], v[184:187], v[36:39], a[112:115]
    v_add_f32 v8, v8, v19
    v_cvt_f32_i32 v248, v248
    v_mfma_f32_16x16x32_bf16 a[160:163], v[172:175], v[32:35], a[160:163]
    v_exp_f32 v17, v109
    v_mfma_f32_16x16x32_bf16 a[160:163], v[188:191], v[36:39], a[160:163]
    s_waitcnt lgkmcnt(2)
    v_cvt_f32_i32 v249, v249
    v_cvt_pk_bf16_f32 v77, v18, v19
    v_mfma_f32_16x16x32_bf16 a[20:23], v[160:163], v[40:43], a[20:23]
    s_mov_b32 m0, s56
    ds_read_b128 v[32:35], v1 offset:7168
    v_fma_f32 v248, v248, v48, v50
    v_mfma_f32_16x16x32_bf16 a[20:23], v[176:179], v[44:47], a[20:23]
    s_sub_u32 s3, s29, s28
    v_exp_f32 v18, v110
    v_mfma_f32_16x16x32_bf16 a[68:71], v[164:167], v[40:43], a[68:71]
    v_add_f32 v8, v8, v16
    v_add_f32 v8, v8, v17
    v_mfma_f32_16x16x32_bf16 a[68:71], v[180:183], v[44:47], a[68:71]
    v_exp_f32 v19, v111
    v_mfma_f32_16x16x32_bf16 a[116:119], v[168:171], v[40:43], a[116:119]
    ds_read_b128 v[36:39], v1 offset:19456
    v_fma_f32 v249, v249, v49, v51
    v_mfma_f32_16x16x32_bf16 a[116:119], v[184:187], v[44:47], a[116:119]
    buffer_load_dwordx4 v4, s[4:7], s27 offen offset:0 sc1 lds
    v_mfma_f32_16x16x32_bf16 a[164:167], v[172:175], v[40:43], a[164:167]
    s_mov_b32 s28, s29
    v_cvt_pk_bf16_f32 v78, v16, v17
    v_add_f32 v8, v8, v18
    v_mfma_f32_16x16x32_bf16 a[164:167], v[188:191], v[44:47], a[164:167]
    s_waitcnt lgkmcnt(2)
    v_add_f32 v8, v8, v19
    v_cvt_pk_bf16_f32 v234, v248, v249
    v_mfma_f32_16x16x32_bf16 a[24:27], v[160:163], v[24:27], a[24:27]
    ds_read_b128 v[40:43], v1 offset:8192
    v_cvt_pk_bf16_f32 v79, v18, v19
    v_mfma_f32_16x16x32_bf16 a[24:27], v[176:179], v[28:31], a[24:27]
    v_exp_f32 v16, v80
    v_mfma_f32_16x16x32_bf16 a[72:75], v[164:167], v[24:27], a[72:75]
    v_cvt_f32_i32 v252, v252
    v_cvt_f32_i32 v253, v253
    v_mfma_f32_16x16x32_bf16 a[72:75], v[180:183], v[28:31], a[72:75]
    v_exp_f32 v17, v81
    v_mfma_f32_16x16x32_bf16 a[120:123], v[168:171], v[24:27], a[120:123]
    ds_read_b128 v[44:47], v1 offset:20480
    v_fma_f32 v252, v252, v48, v50
    v_mfma_f32_16x16x32_bf16 a[120:123], v[184:187], v[28:31], a[120:123]
    v_exp_f32 v18, v82
    v_mfma_f32_16x16x32_bf16 a[168:171], v[172:175], v[24:27], a[168:171]
    v_add_f32 v5, v5, v16
    v_add_f32 v5, v5, v17
    v_mfma_f32_16x16x32_bf16 a[168:171], v[188:191], v[28:31], a[168:171]
    s_waitcnt lgkmcnt(2)
    buffer_load_dwordx4 v4, s[4:7], s27 offen offset:1024 sc1 lds
    v_mfma_f32_16x16x32_bf16 a[28:31], v[160:163], v[32:35], a[28:31]
    ds_read_b128 v[24:27], v1 offset:9216
    v_fma_f32 v253, v253, v49, v51
    v_mfma_f32_16x16x32_bf16 a[28:31], v[176:179], v[36:39], a[28:31]
    v_exp_f32 v19, v83
    v_mfma_f32_16x16x32_bf16 a[76:79], v[164:167], v[32:35], a[76:79]
    v_cvt_pk_bf16_f32 v80, v16, v17
    v_cvt_pk_bf16_f32 v238, v252, v253
    v_mfma_f32_16x16x32_bf16 a[76:79], v[180:183], v[36:39], a[76:79]
    v_exp_f32 v16, v112
    v_mfma_f32_16x16x32_bf16 a[124:127], v[168:171], v[32:35], a[124:127]
    ds_read_b128 v[28:31], v1 offset:21504
    v_add_f32 v5, v5, v18
    v_mfma_f32_16x16x32_bf16 a[124:127], v[184:187], v[36:39], a[124:127]
    v_add_f32 v5, v5, v19
    v_lshlrev_b32 v48, 16, v61
    v_mfma_f32_16x16x32_bf16 a[172:175], v[172:175], v[32:35], a[172:175]
    v_exp_f32 v17, v113
    v_mfma_f32_16x16x32_bf16 a[172:175], v[188:191], v[36:39], a[172:175]
    s_waitcnt lgkmcnt(2)
    buffer_load_dwordx4 v4, s[4:7], s27 offen offset:2048 sc1 lds
    v_mfma_f32_16x16x32_bf16 a[32:35], v[160:163], v[40:43], a[32:35]
    ds_read_b128 v[32:35], v1 offset:10240
    v_cvt_pk_bf16_f32 v81, v18, v19
    v_mfma_f32_16x16x32_bf16 a[32:35], v[176:179], v[44:47], a[32:35]
    v_exp_f32 v18, v114
    v_mfma_f32_16x16x32_bf16 a[80:83], v[164:167], v[40:43], a[80:83]
    v_add_f32 v5, v5, v16
    v_and_b32 v49, s97, v61
    v_mfma_f32_16x16x32_bf16 a[80:83], v[180:183], v[44:47], a[80:83]
    v_add_f32 v5, v5, v17
    v_lshlrev_b32 v50, 16, v63
    v_mfma_f32_16x16x32_bf16 a[128:131], v[168:171], v[40:43], a[128:131]
    ds_read_b128 v[36:39], v1 offset:22528
    v_add_u32 v2, s3, v2
    v_mfma_f32_16x16x32_bf16 a[128:131], v[184:187], v[44:47], a[128:131]
    v_exp_f32 v19, v115
    v_mfma_f32_16x16x32_bf16 a[176:179], v[172:175], v[40:43], a[176:179]
    v_cvt_pk_bf16_f32 v82, v16, v17
    v_and_b32 v51, s97, v63
    v_mfma_f32_16x16x32_bf16 a[176:179], v[188:191], v[44:47], a[176:179]
    s_waitcnt lgkmcnt(2)
    v_exp_f32 v16, v84
    v_mfma_f32_16x16x32_bf16 a[36:39], v[160:163], v[24:27], a[36:39]
    ds_read_b128 v[40:43], v1 offset:11264
    v_add_f32 v5, v5, v18
    v_mfma_f32_16x16x32_bf16 a[36:39], v[176:179], v[28:31], a[36:39]
    v_add_f32 v5, v5, v19
    v_mul_f32 v48, s38, v48
    v_mfma_f32_16x16x32_bf16 a[84:87], v[164:167], v[24:27], a[84:87]
    v_exp_f32 v17, v85
    v_mfma_f32_16x16x32_bf16 a[84:87], v[180:183], v[28:31], a[84:87]
    s_add_u32 s27, s27, 24576
    v_add_u32 v3, s3, v3
    v_cvt_pk_bf16_f32 v83, v18, v19
    v_mfma_f32_16x16x32_bf16 a[132:135], v[168:171], v[24:27], a[132:135]
    s_add_u32 s56, s56, 36864
    ds_read_b128 v[44:47], v1 offset:23552
    v_mul_f32 v49, s38, v49
    v_mfma_f32_16x16x32_bf16 a[132:135], v[184:187], v[28:31], a[132:135]
    s_sub_u32 s58, s56, 147456
    v_exp_f32 v18, v86
    v_mfma_f32_16x16x32_bf16 a[180:183], v[172:175], v[24:27], a[180:183]
    v_add_f32 v6, v6, v16
    v_add_f32 v6, v6, v17
    v_mfma_f32_16x16x32_bf16 a[180:183], v[188:191], v[28:31], a[180:183]
    s_waitcnt lgkmcnt(2)
    v_mul_f32_e64 v50, -v50, v48
    v_mul_f32_e64 v51, -v51, v49
    v_mfma_f32_16x16x32_bf16 a[40:43], v[160:163], v[32:35], a[40:43]
    s_min_u32 s56, s56, s58
    ds_read_b128 v[24:27], v2 offset:0
    v_cvt_f32_i32 v242, v242
    v_mfma_f32_16x16x32_bf16 a[40:43], v[176:179], v[36:39], a[40:43]
    v_exp_f32 v19, v87
    v_mfma_f32_16x16x32_bf16 a[88:91], v[164:167], v[32:35], a[88:91]
    v_cvt_pk_bf16_f32 v84, v16, v17
    v_cvt_f32_i32 v243, v243
    v_mfma_f32_16x16x32_bf16 a[88:91], v[180:183], v[36:39], a[88:91]
    v_exp_f32 v16, v116
    v_mfma_f32_16x16x32_bf16 a[136:139], v[168:171], v[32:35], a[136:139]
    ds_read_b128 v[28:31], v3 offset:0
    v_add_f32 v6, v6, v18
    v_mfma_f32_16x16x32_bf16 a[136:139], v[184:187], v[36:39], a[136:139]
    v_add_f32 v6, v6, v19
    v_fma_f32 v242, v242, v48, v50
    v_mfma_f32_16x16x32_bf16 a[184:187], v[172:175], v[32:35], a[184:187]
    v_exp_f32 v17, v117
    v_mfma_f32_16x16x32_bf16 a[184:187], v[188:191], v[36:39], a[184:187]
    s_waitcnt lgkmcnt(2)
    v_cvt_pk_bf16_f32 v85, v18, v19
    v_fma_f32 v243, v243, v49, v51
    v_mfma_f32_16x16x32_bf16 a[44:47], v[160:163], v[40:43], a[44:47]
    ds_read_b128 v[32:35], v2 offset:6144
    v_cvt_pk_bf16_f32 v227, v242, v243
    v_mfma_f32_16x16x32_bf16 a[44:47], v[176:179], v[44:47], a[44:47]
    v_exp_f32 v18, v118
    v_mfma_f32_16x16x32_bf16 a[92:95], v[164:167], v[40:43], a[92:95]
    v_add_f32 v6, v6, v16
    v_add_f32 v6, v6, v17
    v_mfma_f32_16x16x32_bf16 a[92:95], v[180:183], v[44:47], a[92:95]
    v_exp_f32 v19, v119
    v_mfma_f32_16x16x32_bf16 a[140:143], v[168:171], v[40:43], a[140:143]
    s_sub_u32 s31, s31, 1
    ds_read_b128 v[36:39], v3 offset:6144
    v_cvt_pk_bf16_f32 v86, v16, v17
    v_mfma_f32_16x16x32_bf16 a[140:143], v[184:187], v[44:47], a[140:143]
L_pg7:
    s_cbranch_execz L_pg11
    v_add_f32 v6, v6, v18
    v_add_f32 v6, v6, v19
    v_mfma_f32_16x16x32_bf16 a[188:191], v[172:175], v[40:43], a[188:191]
    s_waitcnt lgkmcnt(2)
    s_cmp_lg_u32 s31, 0
    v_cvt_pk_bf16_f32 v87, v18, v19
    v_cvt_f32_i32 v246, v246
    v_mfma_f32_16x16x32_bf16 a[188:191], v[188:191], v[44:47], a[188:191]
    s_cbranch_scc1 L_loop
    v_mfma_f32_16x16x32_bf16 v[160:163], v[24:27], a[192:195], v[128:131]
    s_mov_b32 m0, s56
    ds_read_b128 v[40:43], v2 offset:128
    v_cvt_f32_i32 v247, v247
    v_mfma_f32_16x16x32_bf16 v[160:163], v[28:31], a[196:199], v[160:163]
    buffer_load_dwordx4 v4, s[4:7], s27 offen offset:0 sc1 lds
    v_mfma_f32_16x16x32_bf16 v[164:167], v[24:27], a[216:219], v[132:135]
    v_exp_f32 v16, v88
    v_mfma_f32_16x16x32_bf16 v[164:167], v[28:31], a[220:223], v[164:167]
    v_exp_f32 v17, v89
    v_mfma_f32_16x16x32_bf16 v[168:171], v[24:27], a[240:243], v[136:139]
    ds_read_b128 v[44:47], v3 offset:128
    v_fma_f32 v246, v246, v48, v50
    v_mfma_f32_16x16x32_bf16 v[168:171], v[28:31], a[244:247], v[168:171]
    v_exp_f32 v18, v90
    v_mfma_f32_16x16x32_bf16 v[172:175], v[24:27], v[200:203], v[140:143]
    v_fma_f32 v247, v247, v49, v51
    v_add_f32 v7, v7, v16
    v_mfma_f32_16x16x32_bf16 v[172:175], v[28:31], v[204:207], v[172:175]
    s_waitcnt lgkmcnt(2)
    v_add_f32 v7, v7, v17
    v_cvt_pk_bf16_f32 v231, v246, v247
    v_mfma_f32_16x16x32_bf16 v[96:99], v[32:35], a[192:195], v[128:131]
    ds_read_b128 v[24:27], v2 offset:6272
    v_cvt_f32_i32 v250, v250
    v_mfma_f32_16x16x32_bf16 v[96:99], v[36:39], a[196:199], v[96:99]
    buffer_load_dwordx4 v4, s[4:7], s27 offen offset:1024 sc1 lds
    v_mfma_f32_16x16x32_bf16 v[100:103], v[32:35], a[216:219], v[132:135]
    v_exp_f32 v19, v91
    v_mfma_f32_16x16x32_bf16 v[100:103], v[36:39], a[220:223], v[100:103]
    v_cvt_pk_bf16_f32 v88, v16, v17
    v_cvt_f32_i32 v251, v251
    v_mfma_f32_16x16x32_bf16 v[104:107], v[32:35], a[240:243], v[136:139]
    ds_read_b128 v[28:31], v3 offset:6272
    v_fma_f32 v250, v250, v48, v50
    v_mfma_f32_16x16x32_bf16 v[104:107], v[36:39], a[244:247], v[104:107]
    v_exp_f32 v16, v120
    v_mfma_f32_16x16x32_bf16 v[108:111], v[32:35], v[200:203], v[140:143]
    v_add_f32 v7, v7, v18
    v_add_f32 v7, v7, v19
    v_mfma_f32_16x16x32_bf16 v[108:111], v[36:39], v[204:207], v[108:111]
    s_waitcnt lgkmcnt(2)
    v_exp_f32 v17, v121
    v_mfma_f32_16x16x32_bf16 v[160:163], v[40:43], a[200:203], v[160:163]
    ds_read_b128 v[32:35], v2 offset:256
    v_cvt_pk_bf16_f32 v89, v18, v19
    v_mfma_f32_16x16x32_bf16 v[160:163], v[44:47], a[204:207], v[160:163]
    v_exp_f32 v18, v122
    v_mfma_f32_16x16x32_bf16 v[164:167], v[40:43], a[224:227], v[164:167]
    v_fma_f32 v251, v251, v49, v51
    v_add_f32 v7, v7, v16
    v_mfma_f32_16x16x32_bf16 v[164:167], v[44:47], a[228:231], v[164:167]
    buffer_load_dwordx4 v4, s[4:7], s27 offen offset:2048 sc1 lds
    v_mfma_f32_16x16x32_bf16 v[168:171], v[40:43], a[248:251], v[168:171]
    ds_read_b128 v[36:39], v3 offset:256
    v_cvt_pk_bf16_f32 v235, v250, v251
    v_mfma_f32_16x16x32_bf16 v[168:171], v[44:47], a[252:255], v[168:171]
    v_add_f32 v7, v7, v17
    v_cvt_f32_i32 v254, v254
    v_mfma_f32_16x16x32_bf16 v[172:175], v[40:43], v[208:211], v[172:175]
    v_exp_f32 v19, v123
    v_mfma_f32_16x16x32_bf16 v[172:175], v[44:47], v[212:215], v[172:175]
    s_waitcnt lgkmcnt(2)
    v_cvt_pk_bf16_f32 v90, v16, v17
    v_cvt_f32_i32 v255, v255
    v_mfma_f32_16x16x32_bf16 v[96:99], v[24:27], a[200:203], v[96:99]
    ds_read_b128 v[40:43], v2 offset:6400
    v_fma_f32 v254, v254, v48, v50
    v_mfma_f32_16x16x32_bf16 v[96:99], v[28:31], a[204:207], v[96:99]
    s_add_u32 s27, s27, 24576
    v_exp_f32 v16, v92
    v_mfma_f32_16x16x32_bf16 v[100:103], v[24:27], a[224:227], v[100:103]
    v_add_f32 v7, v7, v18
    v_add_f32 v7, v7, v19
    v_mfma_f32_16x16x32_bf16 v[100:103], v[28:31], a[228:231], v[100:103]
    v_exp_f32 v17, v93
    v_mfma_f32_16x16x32_bf16 v[104:107], v[24:27], a[248:251], v[104:107]
    ds_read_b128 v[44:47], v3 offset:6400
    v_fma_f32 v255, v255, v49, v51
    v_mfma_f32_16x16x32_bf16 v[104:107], v[28:31], a[252:255], v[104:107]
    v_cvt_pk_bf16_f32 v91, v18, v19
    v_cvt_pk_bf16_f32 v239, v254, v255
    v_mfma_f32_16x16x32_bf16 v[108:111], v[24:27], v[208:211], v[108:111]
    s_add_u32 s29, s30, 49152
    v_exp_f32 v18, v94
    v_mfma_f32_16x16x32_bf16 v[108:111], v[28:31], v[212:215], v[108:111]
    s_waitcnt lgkmcnt(2)
    v_add_f32 v8, v8, v16
    v_add_f32 v8, v8, v17
    v_mfma_f32_16x16x32_bf16 v[160:163], v[32:35], a[208:211], v[160:163]
    s_waitcnt vmcnt(11)
    ds_read_b128 v[24:27], v2 offset:12288
    v_lshlrev_b32 v48, 16, v56
    v_mfma_f32_16x16x32_bf16 v[160:163], v[36:39], a[212:215], v[160:163]
    s_sub_u32 s3, s29, 147456
    buffer_load_dwordx2 v[60:61], off, s[80:83], s37 offset:8
    v_mfma_f32_16x16x32_bf16 v[164:167], v[32:35], a[232:235], v[164:167]
    s_add_u32 s56, s56, 12288
    v_exp_f32 v19, v95
    v_mfma_f32_16x16x32_bf16 v[164:167], v[36:39], a[236:239], v[164:167]
    s_min_u32 s29, s29, s3
    v_cvt_pk_bf16_f32 v92, v16, v17
    v_and_b32 v49, s97, v56
    v_mfma_f32_16x16x32_bf16 v[168:171], v[32:35], v[192:195], v[168:171]
    s_mov_b32 m0, s56
    ds_read_b128 v[28:31], v3 offset:12288
    v_mfma_f32_16x16x32_bf16 v[168:171], v[36:39], v[196:199], v[168:171]
    buffer_load_dwordx2 v[62:63], off, s[84:87], s37 offset:8
    v_mfma_f32_16x16x32_bf16 v[172:175], v[32:35], v[216:219], v[172:175]
    v_exp_f32 v16, v124
    v_mfma_f32_16x16x32_bf16 v[172:175], v[36:39], v[220:223], v[172:175]
    s_waitcnt lgkmcnt(2)
    v_add_f32 v8, v8, v18
    v_add_f32 v8, v8, v19
    v_mfma_f32_16x16x32_bf16 v[96:99], v[40:43], a[208:211], v[96:99]
    ds_read_b128 v[32:35], v2 offset:18432
    v_lshlrev_b32 v50, 16, v58
    v_mfma_f32_16x16x32_bf16 v[96:99], v[44:47], a[212:215], v[96:99]
    s_sub_u32 s3, s29, s30
    v_exp_f32 v17, v125
    v_mfma_f32_16x16x32_bf16 v[100:103], v[40:43], a[232:235], v[100:103]
    v_cvt_pk_bf16_f32 v93, v18, v19
    v_mfma_f32_16x16x32_bf16 v[100:103], v[44:47], a[236:239], v[100:103]
    buffer_load_dwordx4 v4, s[4:7], s27 offen offset:0 sc1 lds
    v_mfma_f32_16x16x32_bf16 v[104:107], v[40:43], v[192:195], v[104:107]
    ds_read_b128 v[36:39], v3 offset:18432
    v_mfma_f32_16x16x32_bf16 v[104:107], v[44:47], v[196:199], v[104:107]
    v_exp_f32 v18, v126
    v_mfma_f32_16x16x32_bf16 v[108:111], v[40:43], v[216:219], v[108:111]
    v_add_f32 v8, v8, v16
    v_add_f32 v8, v8, v17
    v_mfma_f32_16x16x32_bf16 v[108:111], v[44:47], v[220:223], v[108:111]
    s_waitcnt lgkmcnt(2)
    buffer_load_dwordx3 v[240:242], v12, s[68:71], s16 offen offset:0 nt
    v_mfma_f32_16x16x32_bf16 v[176:179], v[24:27], a[192:195], v[128:131]
    ds_read_b128 v[40:43], v2 offset:12416
    v_and_b32 v51, s97, v58
    v_mfma_f32_16x16x32_bf16 v[176:179], v[28:31], a[196:199], v[176:179]
    v_exp_f32 v19, v127
    v_cvt_pk_bf16_f32 v94, v16, v17
    v_mfma_f32_16x16x32_bf16 v[180:183], v[24:27], a[216:219], v[132:135]
    s_mov_b32 s30, s29
    v_add_f32 v8, v8, v18
    v_add_f32 v8, v8, v19
    v_mfma_f32_16x16x32_bf16 v[180:183], v[28:31], a[220:223], v[180:183]
    buffer_load_dwordx4 v4, s[4:7], s27 offen offset:1024 sc1 lds
    v_mfma_f32_16x16x32_bf16 v[184:187], v[24:27], a[240:243], v[136:139]
    ds_read_b128 v[44:47], v3 offset:12416
    v_cvt_pk_bf16_f32 v95, v18, v19
    v_mfma_f32_16x16x32_bf16 v[184:187], v[28:31], a[244:247], v[184:187]
    v_exp_f32 v16, v160
    v_mfma_f32_16x16x32_bf16 v[188:191], v[24:27], v[200:203], v[140:143]
    v_exp_f32 v17, v161
    v_mfma_f32_16x16x32_bf16 v[188:191], v[28:31], v[204:207], v[188:191]
    s_waitcnt lgkmcnt(2)
    buffer_load_dwordx3 v[244:246], v12, s[68:71], s16 offen offset:768 nt
    v_mfma_f32_16x16x32_bf16 v[112:115], v[32:35], a[192:195], v[128:131]
    ds_read_b128 v[24:27], v2 offset:18560
    v_mul_f32_e64 v50, -v50, v48
    v_mfma_f32_16x16x32_bf16 v[112:115], v[36:39], a[196:199], v[112:115]
    v_exp_f32 v18, v162
    v_mfma_f32_16x16x32_bf16 v[116:119], v[32:35], a[216:219], v[132:135]
    v_add_f32 v5, v5, v16
    v_add_f32 v5, v5, v17
    v_mfma_f32_16x16x32_bf16 v[116:119], v[36:39], a[220:223], v[116:119]
    v_exp_f32 v19, v163
    v_mfma_f32_16x16x32_bf16 v[120:123], v[32:35], a[240:243], v[136:139]
    ds_read_b128 v[28:31], v3 offset:18560
    v_cvt_pk_bf16_f32 v160, v16, v17
    v_mfma_f32_16x16x32_bf16 v[120:123], v[36:39], a[244:247], v[120:123]
    buffer_load_dwordx3 v[248:250], v12, s[68:71], s16 offen offset:1536 nt
    v_mfma_f32_16x16x32_bf16 v[124:127], v[32:35], v[200:203], v[140:143]
    v_exp_f32 v16, v96
    v_mfma_f32_16x16x32_bf16 v[124:127], v[36:39], v[204:207], v[124:127]
    s_waitcnt lgkmcnt(2)
    v_add_f32 v5, v5, v18
    v_add_f32 v5, v5, v19
    v_mfma_f32_16x16x32_bf16 v[176:179], v[40:43], a[200:203], v[176:179]
    ds_read_b128 v[32:35], v2 offset:12544
    v_mul_f32_e64 v51, -v51, v49
    v_mfma_f32_16x16x32_bf16 v[176:179], v[44:47], a[204:207], v[176:179]
    buffer_load_dwordx4 v4, s[4:7], s27 offen offset:2048 sc1 lds
    v_mfma_f32_16x16x32_bf16 v[180:183], v[40:43], a[224:227], v[180:183]
    v_exp_f32 v17, v97
    v_mfma_f32_16x16x32_bf16 v[180:183], v[44:47], a[228:231], v[180:183]
    v_cvt_pk_bf16_f32 v161, v18, v19
    v_add_u32 v1, s3, v1
    v_mfma_f32_16x16x32_bf16 v[184:187], v[40:43], a[248:251], v[184:187]
    ds_read_b128 v[36:39], v3 offset:12544
    v_cvt_f32_i32 v144, v144
    v_mfma_f32_16x16x32_bf16 v[184:187], v[44:47], a[252:255], v[184:187]
    buffer_load_dwordx3 v[252:254], v12, s[68:71], s16 offen offset:2304 nt
    v_mfma_f32_16x16x32_bf16 v[188:191], v[40:43], v[208:211], v[188:191]
    v_exp_f32 v18, v98
    v_mfma_f32_16x16x32_bf16 v[188:191], v[44:47], v[212:215], v[188:191]
    s_waitcnt lgkmcnt(2)
    v_add_f32 v5, v5, v16
    v_add_f32 v5, v5, v17
    v_mfma_f32_16x16x32_bf16 v[112:115], v[24:27], a[200:203], v[112:115]
    ds_read_b128 v[40:43], v2 offset:18688
    v_cvt_f32_i32 v148, v148
    v_mfma_f32_16x16x32_bf16 v[112:115], v[28:31], a[204:207], v[112:115]
    v_exp_f32 v19, v99
    v_cvt_pk_bf16_f32 v162, v16, v17
    v_mfma_f32_16x16x32_bf16 v[116:119], v[24:27], a[224:227], v[116:119]
    v_exp_f32 v16, v164
    v_mfma_f32_16x16x32_bf16 v[116:119], v[28:31], a[228:231], v[116:119]
    s_add_u32 s27, s27, 24576
    v_add_f32 v5, v5, v18
    v_add_f32 v5, v5, v19
    v_mfma_f32_16x16x32_bf16 v[120:123], v[24:27], a[248:251], v[120:123]
    s_add_u32 s56, s56, 36864
    ds_read_b128 v[44:47], v3 offset:18688
    v_fma_f32 v144, v144, v48, v50
    v_mfma_f32_16x16x32_bf16 v[120:123], v[28:31], a[252:255], v[120:123]
    s_waitcnt lgkmcnt(2)
    v_exp_f32 v17, v165
    v_mfma_f32_16x16x32_bf16 v[124:127], v[24:27], v[208:211], v[124:127]
    s_waitcnt vmcnt(12)
    v_cvt_pk_bf16_f32 v163, v18, v19
    s_sub_u32 s58, s56, 147456
    v_mfma_f32_16x16x32_bf16 v[124:127], v[28:31], v[212:215], v[124:127]
    s_barrier
    s_min_u32 s56, s56, s58
    v_mfma_f32_16x16x32_bf16 v[176:179], v[32:35], a[208:211], v[176:179]
    ds_read_b128 v[24:27], v1 offset:0
    v_mfma_f32_16x16x32_bf16 v[176:179], v[36:39], a[212:215], v[176:179]
    v_exp_f32 v18, v166
    v_mfma_f32_16x16x32_bf16 v[180:183], v[32:35], a[232:235], v[180:183]
    v_add_f32 v6, v6, v16
    v_add_f32 v6, v6, v17
    v_mfma_f32_16x16x32_bf16 v[180:183], v[36:39], a[236:239], v[180:183]
    v_exp_f32 v19, v167
    v_mfma_f32_16x16x32_bf16 v[184:187], v[32:35], v[192:195], v[184:187]
    ds_read_b128 v[28:31], v1 offset:12288
    v_cvt_pk_bf16_f32 v164, v16, v17
    v_mfma_f32_16x16x32_bf16 v[184:187], v[36:39], v[196:199], v[184:187]
    v_exp_f32 v16, v100
    v_mfma_f32_16x16x32_bf16 v[188:191], v[32:35], v[216:219], v[188:191]
    v_add_f32 v6, v6, v18
    v_add_f32 v6, v6, v19
    v_mfma_f32_16x16x32_bf16 v[188:191], v[36:39], v[220:223], v[188:191]
    s_waitcnt lgkmcnt(2)
    v_exp_f32 v17, v101
    v_mfma_f32_16x16x32_bf16 v[112:115], v[40:43], a[208:211], v[112:115]
    ds_read_b128 v[32:35], v1 offset:1024
    v_cvt_pk_bf16_f32 v165, v18, v19
    v_mfma_f32_16x16x32_bf16 v[112:115], v[44:47], a[212:215], v[112:115]
    v_exp_f32 v18, v102
    v_mfma_f32_16x16x32_bf16 v[116:119], v[40:43], a[232:235], v[116:119]
    v_add_f32 v6, v6, v16
    v_add_f32 v6, v6, v17
    v_mfma_f32_16x16x32_bf16 v[116:119], v[44:47], a[236:239], v[116:119]
    v_exp_f32 v19, v103
    v_mfma_f32_16x16x32_bf16 v[120:123], v[40:43], v[192:195], v[120:123]
    ds_read_b128 v[36:39], v1 offset:13312
    v_cvt_pk_bf16_f32 v166, v16, v17
    v_mfma_f32_16x16x32_bf16 v[120:123], v[44:47], v[196:199], v[120:123]
    v_add_f32 v6, v6, v18
    v_fma_f32 v148, v148, v49, v51
    v_mfma_f32_16x16x32_bf16 v[124:127], v[40:43], v[216:219], v[124:127]
    v_add_f32 v6, v6, v19
    v_cvt_pk_bf16_f32 v167, v18, v19
    v_mfma_f32_16x16x32_bf16 v[124:127], v[44:47], v[220:223], v[124:127]
    s_waitcnt lgkmcnt(2)
    v_mfma_f32_16x16x32_bf16 a[0:3], v[64:67], v[24:27], a[0:3]
    ds_read_b128 v[40:43], v1 offset:2048
    v_cvt_f32_i32 v145, v145
    v_mfma_f32_16x16x32_bf16 a[0:3], v[80:83], v[28:31], a[0:3]
    buffer_store_dwordx4 v[224:227], v11, s[4:7], s33 offen offset:0 sc1
    v_mfma_f32_16x16x32_bf16 a[48:51], v[68:71], v[24:27], a[48:51]
    v_exp_f32 v16, v168
    v_mfma_f32_16x16x32_bf16 a[48:51], v[84:87], v[28:31], a[48:51]
    v_exp_f32 v17, v169
    v_mfma_f32_16x16x32_bf16 a[96:99], v[72:75], v[24:27], a[96:99]
    ds_read_b128 v[44:47], v1 offset:14336
    v_cvt_f32_i32 v149, v149
    v_mfma_f32_16x16x32_bf16 a[96:99], v[88:91], v[28:31], a[96:99]
    v_exp_f32 v18, v170
    v_mfma_f32_16x16x32_bf16 a[144:147], v[76:79], v[24:27], a[144:147]
    v_add_f32 v7, v7, v16
    v_add_f32 v7, v7, v17
    v_mfma_f32_16x16x32_bf16 a[144:147], v[92:95], v[28:31], a[144:147]
    s_waitcnt lgkmcnt(2)
    v_exp_f32 v19, v171
    v_mfma_f32_16x16x32_bf16 a[4:7], v[64:67], v[32:35], a[4:7]
    ds_read_b128 v[24:27], v1 offset:3072
    v_cvt_pk_bf16_f32 v168, v16, v17
    v_mfma_f32_16x16x32_bf16 a[4:7], v[80:83], v[36:39], a[4:7]
    buffer_store_dwordx4 v[228:231], v21, s[4:7], s33 offen offset:768 sc1
    v_mfma_f32_16x16x32_bf16 a[52:55], v[68:71], v[32:35], a[52:55]
    v_exp_f32 v16, v104
    v_mfma_f32_16x16x32_bf16 a[52:55], v[84:87], v[36:39], a[52:55]
    v_add_f32 v7, v7, v18
    v_fma_f32 v145, v145, v48, v50
    v_mfma_f32_16x16x32_bf16 a[100:103], v[72:75], v[32:35], a[100:103]
    ds_read_b128 v[28:31], v1 offset:15360
    v_add_f32 v7, v7, v19
    v_mfma_f32_16x16x32_bf16 a[100:103], v[88:91], v[36:39], a[100:103]
    v_exp_f32 v17, v105
    v_mfma_f32_16x16x32_bf16 a[148:151], v[76:79], v[32:35], a[148:151]
    v_cvt_pk_bf16_f32 v169, v18, v19
    v_fma_f32 v149, v149, v49, v51
    v_mfma_f32_16x16x32_bf16 a[148:151], v[92:95], v[36:39], a[148:151]
    s_waitcnt lgkmcnt(2)
    v_exp_f32 v18, v106
    v_mfma_f32_16x16x32_bf16 a[8:11], v[64:67], v[40:43], a[8:11]
    ds_read_b128 v[32:35], v1 offset:4096
    v_add_f32 v7, v7, v16
    v_mfma_f32_16x16x32_bf16 a[8:11], v[80:83], v[44:47], a[8:11]
    buffer_store_dwordx4 v[232:235], v22, s[4:7], s33 offen offset:1536 sc1
    v_mfma_f32_16x16x32_bf16 a[56:59], v[68:71], v[40:43], a[56:59]
    v_add_f32 v7, v7, v17
    v_cvt_f32_i32 v146, v146
    v_mfma_f32_16x16x32_bf16 a[56:59], v[84:87], v[44:47], a[56:59]
    v_exp_f32 v19, v107
    v_mfma_f32_16x16x32_bf16 a[104:107], v[72:75], v[40:43], a[104:107]
    ds_read_b128 v[36:39], v1 offset:16384
    v_cvt_pk_bf16_f32 v170, v16, v17
    v_mfma_f32_16x16x32_bf16 a[104:107], v[88:91], v[44:47], a[104:107]
    v_exp_f32 v16, v172
    v_mfma_f32_16x16x32_bf16 a[152:155], v[76:79], v[40:43], a[152:155]
    v_add_f32 v7, v7, v18
    v_cvt_f32_i32 v150, v150
    v_mfma_f32_16x16x32_bf16 a[152:155], v[92:95], v[44:47], a[152:155]
    s_waitcnt lgkmcnt(2)
    v_add_f32 v7, v7, v19
    v_fma_f32 v146, v146, v48, v50
    v_mfma_f32_16x16x32_bf16 a[12:15], v[64:67], v[24:27], a[12:15]
    ds_read_b128 v[40:43], v1 offset:5120
    v_mfma_f32_16x16x32_bf16 a[12:15], v[80:83], v[28:31], a[12:15]
    buffer_store_dwordx4 v[236:239], v23, s[4:7], s33 offen offset:2304 sc1
    v_mfma_f32_16x16x32_bf16 a[60:63], v[68:71], v[24:27], a[60:63]
    v_exp_f32 v17, v173
    v_mfma_f32_16x16x32_bf16 a[60:63], v[84:87], v[28:31], a[60:63]
    v_cvt_pk_bf16_f32 v171, v18, v19
    v_fma_f32 v150, v150, v49, v51
    v_mfma_f32_16x16x32_bf16 a[108:111], v[72:75], v[24:27], a[108:111]
    ds_read_b128 v[44:47], v1 offset:17408
    v_mfma_f32_16x16x32_bf16 a[108:111], v[88:91], v[28:31], a[108:111]
    v_exp_f32 v18, v174
    v_mfma_f32_16x16x32_bf16 a[156:159], v[76:79], v[24:27], a[156:159]
    s_add_u32 s29, s28, 49152
    v_add_f32 v8, v8, v16
    v_add_f32 v8, v8, v17
    v_mfma_f32_16x16x32_bf16 a[156:159], v[92:95], v[28:31], a[156:159]
    s_waitcnt lgkmcnt(2)
    v_exp_f32 v19, v175
    v_mfma_f32_16x16x32_bf16 a[16:19], v[64:67], v[32:35], a[16:19]
    s_sub_u32 s3, s29, 147456
    ds_read_b128 v[24:27], v1 offset:6144
    v_cvt_pk_bf16_f32 v172, v16, v17
    v_mfma_f32_16x16x32_bf16 a[16:19], v[80:83], v[36:39], a[16:19]
    s_mov_b32 m0, s26
    v_exp_f32 v16, v108
    v_mfma_f32_16x16x32_bf16 a[64:67], v[68:71], v[32:35], a[64:67]
    s_min_u32 s29, s29, s3
    v_add_f32 v8, v8, v18
    v_lshlrev_b32 v48, 16, v57
    v_mfma_f32_16x16x32_bf16 a[64:67], v[84:87], v[36:39], a[64:67]
    buffer_load_dwordx4 v4, s[4:7], s32 offen offset:0 sc1 lds
    v_mfma_f32_16x16x32_bf16 a[112:115], v[72:75], v[32:35], a[112:115]
    ds_read_b128 v[28:31], v1 offset:18432
    v_add_f32 v8, v8, v19
    v_mfma_f32_16x16x32_bf16 a[112:115], v[88:91], v[36:39], a[112:115]
    v_exp_f32 v17, v109
    v_mfma_f32_16x16x32_bf16 a[160:163], v[76:79], v[32:35], a[160:163]
    v_cvt_pk_bf16_f32 v173, v18, v19
    v_and_b32 v49, s97, v57
    v_mfma_f32_16x16x32_bf16 a[160:163], v[92:95], v[36:39], a[160:163]
    s_waitcnt lgkmcnt(2)
    buffer_load_dwordx4 v4, s[4:7], s32 offen offset:1024 sc1 lds
    v_mfma_f32_16x16x32_bf16 a[20:23], v[64:67], v[40:43], a[20:23]
    s_sub_u32 s3, s29, s28
    ds_read_b128 v[32:35], v1 offset:7168
    v_lshlrev_b32 v50, 16, v59
    v_mfma_f32_16x16x32_bf16 a[20:23], v[80:83], v[44:47], a[20:23]
    v_exp_f32 v18, v110
    v_mfma_f32_16x16x32_bf16 a[68:71], v[68:71], v[40:43], a[68:71]
    v_add_f32 v8, v8, v16
    v_add_f32 v8, v8, v17
    v_mfma_f32_16x16x32_bf16 a[68:71], v[84:87], v[44:47], a[68:71]
    buffer_load_dwordx4 v4, s[4:7], s32 offen offset:2048 sc1 lds
    v_mfma_f32_16x16x32_bf16 a[116:119], v[72:75], v[40:43], a[116:119]
    ds_read_b128 v[36:39], v1 offset:19456
    v_mfma_f32_16x16x32_bf16 a[116:119], v[88:91], v[44:47], a[116:119]
    v_exp_f32 v19, v111
    v_mfma_f32_16x16x32_bf16 a[164:167], v[76:79], v[40:43], a[164:167]
    s_mov_b32 s28, s29
    v_cvt_pk_bf16_f32 v174, v16, v17
    v_add_f32 v8, v8, v18
    v_mfma_f32_16x16x32_bf16 a[164:167], v[92:95], v[44:47], a[164:167]
    s_waitcnt lgkmcnt(2)
    v_add_f32 v8, v8, v19
    v_cvt_pk_bf16_f32 v175, v18, v19
    v_mfma_f32_16x16x32_bf16 a[24:27], v[64:67], v[24:27], a[24:27]
    s_add_u32 s32, s32, 24576
    ds_read_b128 v[40:43], v1 offset:8192
    v_and_b32 v51, s97, v59
    v_mfma_f32_16x16x32_bf16 a[24:27], v[80:83], v[28:31], a[24:27]
    v_exp_f32 v16, v176
    v_mfma_f32_16x16x32_bf16 a[72:75], v[68:71], v[24:27], a[72:75]
    s_add_u32 s26, s26, 12288
    v_exp_f32 v17, v177
    v_mfma_f32_16x16x32_bf16 a[72:75], v[84:87], v[28:31], a[72:75]
    v_exp_f32 v18, v178
    v_mfma_f32_16x16x32_bf16 a[120:123], v[72:75], v[24:27], a[120:123]
    s_mov_b32 m0, s26
    ds_read_b128 v[44:47], v1 offset:20480
    v_add_f32 v5, v5, v16
    v_mfma_f32_16x16x32_bf16 a[120:123], v[88:91], v[28:31], a[120:123]
    v_add_f32 v5, v5, v17
    v_mul_f32_e64 v50, -v50, v48
    v_mfma_f32_16x16x32_bf16 a[168:171], v[76:79], v[24:27], a[168:171]
    v_exp_f32 v19, v179
    v_mfma_f32_16x16x32_bf16 a[168:171], v[92:95], v[28:31], a[168:171]
    s_waitcnt lgkmcnt(2)
    v_cvt_pk_bf16_f32 v176, v16, v17
    v_mul_f32_e64 v51, -v51, v49
    v_mfma_f32_16x16x32_bf16 a[28:31], v[64:67], v[32:35], a[28:31]
    ds_read_b128 v[24:27], v1 offset:9216
    v_add_u32 v2, s3, v2
    v_mfma_f32_16x16x32_bf16 a[28:31], v[80:83], v[36:39], a[28:31]
    buffer_load_dwordx4 v4, s[4:7], s32 offen offset:0 sc1 lds
    v_mfma_f32_16x16x32_bf16 a[76:79], v[68:71], v[32:35], a[76:79]
    v_exp_f32 v16, v112
    v_mfma_f32_16x16x32_bf16 a[76:79], v[84:87], v[36:39], a[76:79]
    v_add_f32 v5, v5, v18
    v_add_f32 v5, v5, v19
    v_mfma_f32_16x16x32_bf16 a[124:127], v[72:75], v[32:35], a[124:127]
    ds_read_b128 v[28:31], v1 offset:21504
    v_cvt_f32_i32 v152, v152
    v_mfma_f32_16x16x32_bf16 a[124:127], v[88:91], v[36:39], a[124:127]
    buffer_load_dwordx4 v4, s[4:7], s32 offen offset:1024 sc1 lds
    v_mfma_f32_16x16x32_bf16 a[172:175], v[76:79], v[32:35], a[172:175]
    v_exp_f32 v17, v113
    v_mfma_f32_16x16x32_bf16 a[172:175], v[92:95], v[36:39], a[172:175]
    s_waitcnt lgkmcnt(2)
    v_cvt_pk_bf16_f32 v177, v18, v19
    v_add_u32 v3, s3, v3
    v_mfma_f32_16x16x32_bf16 a[32:35], v[64:67], v[40:43], a[32:35]
    ds_read_b128 v[32:35], v1 offset:10240
    v_cvt_f32_i32 v156, v156
    v_mfma_f32_16x16x32_bf16 a[32:35], v[80:83], v[44:47], a[32:35]
    v_exp_f32 v18, v114
    v_mfma_f32_16x16x32_bf16 a[80:83], v[68:71], v[40:43], a[80:83]
    v_add_f32 v5, v5, v16
    v_add_f32 v5, v5, v17
    v_mfma_f32_16x16x32_bf16 a[80:83], v[84:87], v[44:47], a[80:83]
    buffer_load_dwordx4 v4, s[4:7], s32 offen offset:2048 sc1 lds
    v_mfma_f32_16x16x32_bf16 a[128:131], v[72:75], v[40:43], a[128:131]
    ds_read_b128 v[36:39], v1 offset:22528
    v_mfma_f32_16x16x32_bf16 a[128:131], v[88:91], v[44:47], a[128:131]
    v_exp_f32 v19, v115
    v_mfma_f32_16x16x32_bf16 a[176:179], v[76:79], v[40:43], a[176:179]
    v_cvt_pk_bf16_f32 v178, v16, v17
    v_fma_f32 v152, v152, v48, v50
    v_mfma_f32_16x16x32_bf16 a[176:179], v[92:95], v[44:47], a[176:179]
    s_waitcnt lgkmcnt(2)
    v_exp_f32 v16, v180
    v_mfma_f32_16x16x32_bf16 a[36:39], v[64:67], v[24:27], a[36:39]
    ds_read_b128 v[40:43], v1 offset:11264
    v_add_f32 v5, v5, v18
    v_mfma_f32_16x16x32_bf16 a[36:39], v[80:83], v[28:31], a[36:39]
    v_add_f32 v5, v5, v19
    v_mfma_f32_16x16x32_bf16 a[84:87], v[68:71], v[24:27], a[84:87]
    v_exp_f32 v17, v181
    v_mfma_f32_16x16x32_bf16 a[84:87], v[84:87], v[28:31], a[84:87]
    s_add_u32 s32, s32, 24576
    v_cvt_pk_bf16_f32 v179, v18, v19
    s_add_u32 s26, s26, 36864
    v_mfma_f32_16x16x32_bf16 a[132:135], v[72:75], v[24:27], a[132:135]
    s_sub_u32 s57, s26, 147456
    ds_read_b128 v[44:47], v1 offset:23552
    v_fma_f32 v156, v156, v49, v51
    v_mfma_f32_16x16x32_bf16 a[132:135], v[88:91], v[28:31], a[132:135]
    s_waitcnt lgkmcnt(2)
    v_exp_f32 v18, v182
    v_mfma_f32_16x16x32_bf16 a[180:183], v[76:79], v[24:27], a[180:183]
    s_waitcnt vmcnt(6)
    v_add_f32 v6, v6, v16
    v_add_f32 v6, v6, v17
    v_mfma_f32_16x16x32_bf16 a[180:183], v[92:95], v[28:31], a[180:183]
    s_barrier
    v_cvt_f32_i32 v153, v153
    v_mfma_f32_16x16x32_bf16 a[40:43], v[64:67], v[32:35], a[40:43]
    s_min_u32 s26, s26, s57
    ds_read_b128 v[24:27], v2 offset:0
    v_add_u32 v0, 1, v0
    v_mfma_f32_16x16x32_bf16 a[40:43], v[80:83], v[36:39], a[40:43]
    buffer_store_dword v0, v13, s[20:23], 0 offen offset:32 sc1
    v_mfma_f32_16x16x32_bf16 a[88:91], v[68:71], v[32:35], a[88:91]
    v_exp_f32 v19, v183
    v_mfma_f32_16x16x32_bf16 a[88:91], v[84:87], v[36:39], a[88:91]
    v_cvt_pk_bf16_f32 v180, v16, v17
    v_cvt_f32_i32 v157, v157
    v_mfma_f32_16x16x32_bf16 a[136:139], v[72:75], v[32:35], a[136:139]
    ds_read_b128 v[28:31], v3 offset:0
    v_mfma_f32_16x16x32_bf16 a[136:139], v[88:91], v[36:39], a[136:139]
    v_exp_f32 v16, v116
    v_mfma_f32_16x16x32_bf16 a[184:187], v[76:79], v[32:35], a[184:187]
    v_add_f32 v6, v6, v18
    v_add_f32 v6, v6, v19
    v_mfma_f32_16x16x32_bf16 a[184:187], v[92:95], v[36:39], a[184:187]
    s_waitcnt lgkmcnt(2)
    v_exp_f32 v17, v117
    v_mfma_f32_16x16x32_bf16 a[44:47], v[64:67], v[40:43], a[44:47]
    ds_read_b128 v[32:35], v2 offset:6144
    v_cvt_pk_bf16_f32 v181, v18, v19
    v_mfma_f32_16x16x32_bf16 a[44:47], v[80:83], v[44:47], a[44:47]
    v_exp_f32 v18, v118
    v_mfma_f32_16x16x32_bf16 a[92:95], v[68:71], v[40:43], a[92:95]
    v_add_f32 v6, v6, v16
    v_add_f32 v6, v6, v17
    v_mfma_f32_16x16x32_bf16 a[92:95], v[84:87], v[44:47], a[92:95]
    v_exp_f32 v19, v119
    v_mfma_f32_16x16x32_bf16 a[140:143], v[72:75], v[40:43], a[140:143]
    ds_read_b128 v[36:39], v3 offset:6144
    v_cvt_pk_bf16_f32 v182, v16, v17
    v_mfma_f32_16x16x32_bf16 a[140:143], v[88:91], v[44:47], a[140:143]
    v_add_f32 v6, v6, v18
    v_add_f32 v6, v6, v19
    v_mfma_f32_16x16x32_bf16 a[188:191], v[76:79], v[40:43], a[188:191]
    v_cvt_pk_bf16_f32 v183, v18, v19
    v_mfma_f32_16x16x32_bf16 a[188:191], v[92:95], v[44:47], a[188:191]
    s_waitcnt lgkmcnt(2)
    v_mfma_f32_16x16x32_bf16 v[64:67], v[24:27], a[192:195], v[128:131]
    s_mov_b32 m0, s56
    ds_read_b128 v[40:43], v2 offset:128
    v_fma_f32 v153, v153, v48, v50
    v_mfma_f32_16x16x32_bf16 v[64:67], v[28:31], a[196:199], v[64:67]
    buffer_load_dwordx4 v4, s[4:7], s27 offen offset:0 sc1 lds
    v_mfma_f32_16x16x32_bf16 v[68:71], v[24:27], a[216:219], v[132:135]
    v_exp_f32 v16, v184
    v_mfma_f32_16x16x32_bf16 v[68:71], v[28:31], a[220:223], v[68:71]
    v_exp_f32 v17, v185
    v_mfma_f32_16x16x32_bf16 v[72:75], v[24:27], a[240:243], v[136:139]
    ds_read_b128 v[44:47], v3 offset:128
    v_fma_f32 v157, v157, v49, v51
    v_mfma_f32_16x16x32_bf16 v[72:75], v[28:31], a[244:247], v[72:75]
    v_exp_f32 v18, v186
    v_mfma_f32_16x16x32_bf16 v[76:79], v[24:27], v[200:203], v[140:143]
    v_add_f32 v7, v7, v16
    v_add_f32 v7, v7, v17
    v_mfma_f32_16x16x32_bf16 v[76:79], v[28:31], v[204:207], v[76:79]
    s_waitcnt lgkmcnt(2)
    v_exp_f32 v19, v187
    v_mfma_f32_16x16x32_bf16 v[96:99], v[32:35], a[192:195], v[128:131]
    ds_read_b128 v[24:27], v2 offset:6272
    v_cvt_pk_bf16_f32 v184, v16, v17
    v_mfma_f32_16x16x32_bf16 v[96:99], v[36:39], a[196:199], v[96:99]
    v_exp_f32 v16, v120
    v_mfma_f32_16x16x32_bf16 v[100:103], v[32:35], a[216:219], v[132:135]
    v_cvt_f32_i32 v154, v154
    v_add_f32 v7, v7, v18
    v_mfma_f32_16x16x32_bf16 v[100:103], v[36:39], a[220:223], v[100:103]
    buffer_load_dwordx4 v4, s[4:7], s27 offen offset:1024 sc1 lds
    v_mfma_f32_16x16x32_bf16 v[104:107], v[32:35], a[240:243], v[136:139]
    ds_read_b128 v[28:31], v3 offset:6272
    v_add_f32 v7, v7, v19
    v_mfma_f32_16x16x32_bf16 v[104:107], v[36:39], a[244:247], v[104:107]
    v_exp_f32 v17, v121
    v_mfma_f32_16x16x32_bf16 v[108:111], v[32:35], v[200:203], v[140:143]
    v_cvt_f32_i32 v158, v158
    v_cvt_pk_bf16_f32 v185, v18, v19
    v_mfma_f32_16x16x32_bf16 v[108:111], v[36:39], v[204:207], v[108:111]
    s_waitcnt lgkmcnt(2)
    v_exp_f32 v18, v122
    v_mfma_f32_16x16x32_bf16 v[64:67], v[40:43], a[200:203], v[64:67]
    ds_read_b128 v[32:35], v2 offset:256
    v_fma_f32 v154, v154, v48, v50
    v_mfma_f32_16x16x32_bf16 v[64:67], v[44:47], a[204:207], v[64:67]
    v_add_f32 v7, v7, v16
    v_add_f32 v7, v7, v17
    v_mfma_f32_16x16x32_bf16 v[68:71], v[40:43], a[224:227], v[68:71]
    v_exp_f32 v19, v123
    v_mfma_f32_16x16x32_bf16 v[68:71], v[44:47], a[228:231], v[68:71]
    v_fma_f32 v158, v158, v49, v51
    v_cvt_pk_bf16_f32 v186, v16, v17
    v_mfma_f32_16x16x32_bf16 v[72:75], v[40:43], a[248:251], v[72:75]
    ds_read_b128 v[36:39], v3 offset:256
    v_cvt_pk_bf16_f32 v144, v144, v148
    v_mfma_f32_16x16x32_bf16 v[72:75], v[44:47], a[252:255], v[72:75]
    v_exp_f32 v16, v188
    v_mfma_f32_16x16x32_bf16 v[76:79], v[40:43], v[208:211], v[76:79]
    v_add_f32 v7, v7, v18
    v_add_f32 v7, v7, v19
    v_mfma_f32_16x16x32_bf16 v[76:79], v[44:47], v[212:215], v[76:79]
    s_waitcnt lgkmcnt(2)
    buffer_load_dwordx4 v4, s[4:7], s27 offen offset:2048 sc1 lds
    v_mfma_f32_16x16x32_bf16 v[96:99], v[24:27], a[200:203], v[96:99]
    ds_read_b128 v[40:43], v2 offset:6400
    v_cvt_pk_bf16_f32 v148, v145, v149
    v_mfma_f32_16x16x32_bf16 v[96:99], v[28:31], a[204:207], v[96:99]
    v_exp_f32 v17, v189
    v_mfma_f32_16x16x32_bf16 v[100:103], v[24:27], a[224:227], v[100:103]
    v_cvt_pk_bf16_f32 v187, v18, v19
    v_mfma_f32_16x16x32_bf16 v[100:103], v[28:31], a[228:231], v[100:103]
    v_exp_f32 v18, v190
    v_mfma_f32_16x16x32_bf16 v[104:107], v[24:27], a[248:251], v[104:107]
    ds_read_b128 v[44:47], v3 offset:6400
    v_add_f32 v8, v8, v16
    v_mfma_f32_16x16x32_bf16 v[104:107], v[28:31], a[252:255], v[104:107]
    v_add_f32 v8, v8, v17
    v_cvt_pk_bf16_f32 v145, v152, v156
    v_mfma_f32_16x16x32_bf16 v[108:111], v[24:27], v[208:211], v[108:111]
    s_add_u32 s29, s30, 49152
    v_exp_f32 v19, v191
    v_mfma_f32_16x16x32_bf16 v[108:111], v[28:31], v[212:215], v[108:111]
    s_waitcnt lgkmcnt(2)
    v_cvt_pk_bf16_f32 v188, v16, v17
    s_sub_u32 s3, s29, 147456
    v_mfma_f32_16x16x32_bf16 v[64:67], v[32:35], a[208:211], v[64:67]
    s_add_u32 s27, s27, 24576
    ds_read_b128 v[24:27], v2 offset:12288
    v_cvt_pk_bf16_f32 v149, v153, v157
    v_mfma_f32_16x16x32_bf16 v[64:67], v[36:39], a[212:215], v[64:67]
L_pg8:
    s_cbranch_execz L_pg12
    s_min_u32 s29, s29, s3
    v_exp_f32 v16, v124
    v_mfma_f32_16x16x32_bf16 v[68:71], v[32:35], a[232:235], v[68:71]
    v_add_f32 v8, v8, v18
    v_add_f32 v8, v8, v19
    v_mfma_f32_16x16x32_bf16 v[68:71], v[36:39], a[236:239], v[68:71]
    v_exp_f32 v17, v125
    v_mfma_f32_16x16x32_bf16 v[72:75], v[32:35], v[192:195], v[72:75]
    s_add_u32 s56, s56, 12288
    ds_read_b128 v[28:31], v3 offset:12288
    v_cvt_pk_bf16_f32 v152, v146, v150
    v_mfma_f32_16x16x32_bf16 v[72:75], v[36:39], v[196:199], v[72:75]
    v_cvt_pk_bf16_f32 v189, v18, v19
    v_mfma_f32_16x16x32_bf16 v[76:79], v[32:35], v[216:219], v[76:79]
    v_exp_f32 v18, v126
    v_mfma_f32_16x16x32_bf16 v[76:79], v[36:39], v[220:223], v[76:79]
    s_waitcnt lgkmcnt(2)
    v_add_f32 v8, v8, v16
    v_mfma_f32_16x16x32_bf16 v[96:99], v[40:43], a[208:211], v[96:99]
    ds_read_b128 v[32:35], v2 offset:18432
    v_add_f32 v8, v8, v17
    v_mfma_f32_16x16x32_bf16 v[96:99], v[44:47], a[212:215], v[96:99]
    s_sub_u32 s3, s29, s30
    v_exp_f32 v19, v127
    v_mfma_f32_16x16x32_bf16 v[100:103], v[40:43], a[232:235], v[100:103]
    s_mov_b32 m0, s56
    v_cvt_pk_bf16_f32 v153, v154, v158
    v_mfma_f32_16x16x32_bf16 v[100:103], v[44:47], a[236:239], v[100:103]
    v_cvt_pk_bf16_f32 v190, v16, v17
    v_mfma_f32_16x16x32_bf16 v[104:107], v[40:43], v[192:195], v[104:107]
    ds_read_b128 v[36:39], v3 offset:18432
    v_add_f32 v8, v8, v18
    v_mfma_f32_16x16x32_bf16 v[104:107], v[44:47], v[196:199], v[104:107]
    v_add_f32 v8, v8, v19
    v_cvt_pk_bf16_f32 v191, v18, v19
    v_mfma_f32_16x16x32_bf16 v[108:111], v[40:43], v[216:219], v[108:111]
    v_mfma_f32_16x16x32_bf16 v[108:111], v[44:47], v[220:223], v[108:111]
    s_waitcnt lgkmcnt(2)
    v_exp_f32 v16, v64
    v_mfma_f32_16x16x32_bf16 v[80:83], v[24:27], a[192:195], v[128:131]
    ds_read_b128 v[40:43], v2 offset:12416
    v_mfma_f32_16x16x32_bf16 v[80:83], v[28:31], a[196:199], v[80:83]
    s_mov_b32 s30, s29
    v_exp_f32 v17, v65
    v_mfma_f32_16x16x32_bf16 v[84:87], v[24:27], a[216:219], v[132:135]
    v_exp_f32 v18, v66
    v_mfma_f32_16x16x32_bf16 v[84:87], v[28:31], a[220:223], v[84:87]
    s_waitcnt vmcnt(14)
    buffer_load_dwordx4 v4, s[4:7], s27 offen offset:0 sc1 lds
    v_mfma_f32_16x16x32_bf16 v[88:91], v[24:27], a[240:243], v[136:139]
    ds_read_b128 v[44:47], v3 offset:12416
    v_add_f32 v5, v5, v16
    v_mfma_f32_16x16x32_bf16 v[88:91], v[28:31], a[244:247], v[88:91]
    v_add_f32 v5, v5, v17
    v_lshlrev_b32 v48, 16, v60
    v_mfma_f32_16x16x32_bf16 v[92:95], v[24:27], v[200:203], v[140:143]
    v_exp_f32 v19, v67
    v_mfma_f32_16x16x32_bf16 v[92:95], v[28:31], v[204:207], v[92:95]
    s_waitcnt lgkmcnt(2)
    v_cvt_pk_bf16_f32 v64, v16, v17
    v_and_b32 v49, s97, v60
    v_mfma_f32_16x16x32_bf16 v[112:115], v[32:35], a[192:195], v[128:131]
    ds_read_b128 v[24:27], v2 offset:18560
    v_mfma_f32_16x16x32_bf16 v[112:115], v[36:39], a[196:199], v[112:115]
    v_exp_f32 v16, v96
    v_mfma_f32_16x16x32_bf16 v[116:119], v[32:35], a[216:219], v[132:135]
    v_add_f32 v5, v5, v18
    v_lshlrev_b32 v50, 16, v62
    v_mfma_f32_16x16x32_bf16 v[116:119], v[36:39], a[220:223], v[116:119]
    v_add_f32 v5, v5, v19
    v_add_u32 v1, s3, v1
    v_mfma_f32_16x16x32_bf16 v[120:123], v[32:35], a[240:243], v[136:139]
    ds_read_b128 v[28:31], v3 offset:18560
    v_mfma_f32_16x16x32_bf16 v[120:123], v[36:39], a[244:247], v[120:123]
    v_exp_f32 v17, v97
    v_mfma_f32_16x16x32_bf16 v[124:127], v[32:35], v[200:203], v[140:143]
    v_cvt_pk_bf16_f32 v65, v18, v19
    v_and_b32 v51, s97, v62
    v_mfma_f32_16x16x32_bf16 v[124:127], v[36:39], v[204:207], v[124:127]
    s_waitcnt lgkmcnt(2)
    buffer_load_dwordx4 v4, s[4:7], s27 offen offset:1024 sc1 lds
    v_mfma_f32_16x16x32_bf16 v[80:83], v[40:43], a[200:203], v[80:83]
    ds_read_b128 v[32:35], v2 offset:12544
    v_mfma_f32_16x16x32_bf16 v[80:83], v[44:47], a[204:207], v[80:83]
    v_exp_f32 v18, v98
    v_mfma_f32_16x16x32_bf16 v[84:87], v[40:43], a[224:227], v[84:87]
    v_add_f32 v5, v5, v16
    v_add_f32 v5, v5, v17
    v_mfma_f32_16x16x32_bf16 v[84:87], v[44:47], a[228:231], v[84:87]
    v_exp_f32 v19, v99
    v_mfma_f32_16x16x32_bf16 v[88:91], v[40:43], a[248:251], v[88:91]
    ds_read_b128 v[36:39], v3 offset:12544
    v_cvt_pk_bf16_f32 v66, v16, v17
    v_mfma_f32_16x16x32_bf16 v[88:91], v[44:47], a[252:255], v[88:91]
    v_exp_f32 v16, v68
    v_mfma_f32_16x16x32_bf16 v[92:95], v[40:43], v[208:211], v[92:95]
    v_mul_f32_e64 v50, -v50, v48
    v_add_f32 v5, v5, v18
    v_mfma_f32_16x16x32_bf16 v[92:95], v[44:47], v[212:215], v[92:95]
    s_waitcnt lgkmcnt(2)
    v_add_f32 v5, v5, v19
    v_mul_f32_e64 v51, -v51, v49
    v_mfma_f32_16x16x32_bf16 v[112:115], v[24:27], a[200:203], v[112:115]
    ds_read_b128 v[40:43], v2 offset:18688
    v_mfma_f32_16x16x32_bf16 v[112:115], v[28:31], a[204:207], v[112:115]
    buffer_load_dwordx4 v4, s[4:7], s27 offen offset:2048 sc1 lds
    v_mfma_f32_16x16x32_bf16 v[116:119], v[24:27], a[224:227], v[116:119]
    v_exp_f32 v17, v69
    v_mfma_f32_16x16x32_bf16 v[116:119], v[28:31], a[228:231], v[116:119]
    v_cvt_pk_bf16_f32 v67, v18, v19
    v_cvt_f32_i32 v240, v240
    v_mfma_f32_16x16x32_bf16 v[120:123], v[24:27], a[248:251], v[120:123]
    ds_read_b128 v[44:47], v3 offset:18688
    v_mfma_f32_16x16x32_bf16 v[120:123], v[28:31], a[252:255], v[120:123]
    s_waitcnt lgkmcnt(2)
    v_exp_f32 v18, v70
    v_mfma_f32_16x16x32_bf16 v[124:127], v[24:27], v[208:211], v[124:127]
    s_waitcnt vmcnt(7)
    v_add_f32 v6, v6, v16
    v_add_f32 v6, v6, v17
    v_mfma_f32_16x16x32_bf16 v[124:127], v[28:31], v[212:215], v[124:127]
    s_barrier
    v_cvt_f32_i32 v244, v244
    v_mfma_f32_16x16x32_bf16 v[80:83], v[32:35], a[208:211], v[80:83]
    ds_read_b128 v[24:27], v1 offset:0
    v_mfma_f32_16x16x32_bf16 v[80:83], v[36:39], a[212:215], v[80:83]
    v_exp_f32 v19, v71
    v_mfma_f32_16x16x32_bf16 v[84:87], v[32:35], a[232:235], v[84:87]
    v_cvt_pk_bf16_f32 v68, v16, v17
    v_fma_f32 v240, v240, v48, v50
    v_mfma_f32_16x16x32_bf16 v[84:87], v[36:39], a[236:239], v[84:87]
    v_exp_f32 v16, v100
    v_mfma_f32_16x16x32_bf16 v[88:91], v[32:35], v[192:195], v[88:91]
    ds_read_b128 v[28:31], v1 offset:12288
    v_add_f32 v6, v6, v18
    v_mfma_f32_16x16x32_bf16 v[88:91], v[36:39], v[196:199], v[88:91]
    v_add_f32 v6, v6, v19
    v_fma_f32 v244, v244, v49, v51
    v_mfma_f32_16x16x32_bf16 v[92:95], v[32:35], v[216:219], v[92:95]
    v_exp_f32 v17, v101
    v_mfma_f32_16x16x32_bf16 v[92:95], v[36:39], v[220:223], v[92:95]
    s_waitcnt lgkmcnt(2)
    v_cvt_pk_bf16_f32 v69, v18, v19
    v_mfma_f32_16x16x32_bf16 v[112:115], v[40:43], a[208:211], v[112:115]
    ds_read_b128 v[32:35], v1 offset:1024
    v_mfma_f32_16x16x32_bf16 v[112:115], v[44:47], a[212:215], v[112:115]
    v_exp_f32 v18, v102
    v_mfma_f32_16x16x32_bf16 v[116:119], v[40:43], a[232:235], v[116:119]
    v_add_f32 v6, v6, v16
    v_add_f32 v6, v6, v17
    v_mfma_f32_16x16x32_bf16 v[116:119], v[44:47], a[236:239], v[116:119]
    s_add_u32 s27, s27, 24576
    v_exp_f32 v19, v103
    v_mfma_f32_16x16x32_bf16 v[120:123], v[40:43], v[192:195], v[120:123]
    s_add_u32 s56, s56, 36864
    ds_read_b128 v[36:39], v1 offset:13312
    v_cvt_pk_bf16_f32 v70, v16, v17
    v_mfma_f32_16x16x32_bf16 v[120:123], v[44:47], v[196:199], v[120:123]
    s_sub_u32 s58, s56, 147456
    v_add_f32 v6, v6, v18
    v_add_f32 v6, v6, v19
    v_mfma_f32_16x16x32_bf16 v[124:127], v[40:43], v[216:219], v[124:127]
    s_min_u32 s56, s56, s58
    v_cvt_pk_bf16_f32 v71, v18, v19
    v_mfma_f32_16x16x32_bf16 v[124:127], v[44:47], v[220:223], v[124:127]
    s_waitcnt lgkmcnt(2)
    v_mfma_f32_16x16x32_bf16 a[0:3], v[160:163], v[24:27], a[0:3]
    s_mov_b32 m0, s56
    ds_read_b128 v[40:43], v1 offset:2048
    v_cvt_f32_i32 v241, v241
    v_mfma_f32_16x16x32_bf16 a[0:3], v[176:179], v[28:31], a[0:3]
    buffer_load_dwordx4 v4, s[4:7], s27 offen offset:0 sc1 lds
    v_mfma_f32_16x16x32_bf16 a[48:51], v[164:167], v[24:27], a[48:51]
    v_exp_f32 v16, v72
    v_mfma_f32_16x16x32_bf16 a[48:51], v[180:183], v[28:31], a[48:51]
    v_exp_f32 v17, v73
    v_mfma_f32_16x16x32_bf16 a[96:99], v[168:171], v[24:27], a[96:99]
    ds_read_b128 v[44:47], v1 offset:14336
    v_cvt_f32_i32 v245, v245
    v_mfma_f32_16x16x32_bf16 a[96:99], v[184:187], v[28:31], a[96:99]
    v_exp_f32 v18, v74
    v_mfma_f32_16x16x32_bf16 a[144:147], v[172:175], v[24:27], a[144:147]
    v_add_f32 v7, v7, v16
    v_add_f32 v7, v7, v17
    v_mfma_f32_16x16x32_bf16 a[144:147], v[188:191], v[28:31], a[144:147]
    s_waitcnt lgkmcnt(2)
    v_exp_f32 v19, v75
    v_mfma_f32_16x16x32_bf16 a[4:7], v[160:163], v[32:35], a[4:7]
    ds_read_b128 v[24:27], v1 offset:3072
    v_fma_f32 v241, v241, v48, v50
    v_mfma_f32_16x16x32_bf16 a[4:7], v[176:179], v[36:39], a[4:7]
    buffer_load_dwordx4 v4, s[4:7], s27 offen offset:1024 sc1 lds
    v_mfma_f32_16x16x32_bf16 a[52:55], v[164:167], v[32:35], a[52:55]
    v_cvt_pk_bf16_f32 v72, v16, v17
    v_fma_f32 v245, v245, v49, v51
    v_mfma_f32_16x16x32_bf16 a[52:55], v[180:183], v[36:39], a[52:55]
    v_exp_f32 v16, v104
    v_mfma_f32_16x16x32_bf16 a[100:103], v[168:171], v[32:35], a[100:103]
    ds_read_b128 v[28:31], v1 offset:15360
    v_add_f32 v7, v7, v18
    v_mfma_f32_16x16x32_bf16 a[100:103], v[184:187], v[36:39], a[100:103]
    buffer_load_dword v52, v20, s[20:23], s44 offen sc1
    v_mfma_f32_16x16x32_bf16 a[148:151], v[172:175], v[32:35], a[148:151]
    v_add_f32 v7, v7, v19
    v_cvt_f32_i32 v242, v242
    v_mfma_f32_16x16x32_bf16 a[148:151], v[188:191], v[36:39], a[148:151]
    s_waitcnt lgkmcnt(2)
    v_exp_f32 v17, v105
    v_mfma_f32_16x16x32_bf16 a[8:11], v[160:163], v[40:43], a[8:11]
    ds_read_b128 v[32:35], v1 offset:4096
    v_cvt_pk_bf16_f32 v73, v18, v19
    v_mfma_f32_16x16x32_bf16 a[8:11], v[176:179], v[44:47], a[8:11]
    v_exp_f32 v18, v106
    v_mfma_f32_16x16x32_bf16 a[56:59], v[164:167], v[40:43], a[56:59]
    v_add_f32 v7, v7, v16
    v_cvt_f32_i32 v246, v246
    v_mfma_f32_16x16x32_bf16 a[56:59], v[180:183], v[44:47], a[56:59]
    buffer_load_dwordx4 v4, s[4:7], s27 offen offset:2048 sc1 lds
    v_mfma_f32_16x16x32_bf16 a[104:107], v[168:171], v[40:43], a[104:107]
    ds_read_b128 v[36:39], v1 offset:16384
    v_add_f32 v7, v7, v17
    v_mfma_f32_16x16x32_bf16 a[104:107], v[184:187], v[44:47], a[104:107]
    v_exp_f32 v19, v107
    v_mfma_f32_16x16x32_bf16 a[152:155], v[172:175], v[40:43], a[152:155]
    v_cvt_pk_bf16_f32 v74, v16, v17
    v_fma_f32 v242, v242, v48, v50
    v_mfma_f32_16x16x32_bf16 a[152:155], v[188:191], v[44:47], a[152:155]
    s_waitcnt lgkmcnt(2)
    v_exp_f32 v16, v76
    v_mfma_f32_16x16x32_bf16 a[12:15], v[160:163], v[24:27], a[12:15]
    ds_read_b128 v[40:43], v1 offset:5120
    v_add_f32 v7, v7, v18
    v_mfma_f32_16x16x32_bf16 a[12:15], v[176:179], v[28:31], a[12:15]
    s_add_u32 s27, s27, 24576
    v_add_f32 v7, v7, v19
    v_fma_f32 v246, v246, v49, v51
    v_mfma_f32_16x16x32_bf16 a[60:63], v[164:167], v[24:27], a[60:63]
    v_exp_f32 v17, v77
    v_mfma_f32_16x16x32_bf16 a[60:63], v[180:183], v[28:31], a[60:63]
    v_cvt_pk_bf16_f32 v75, v18, v19
    v_lshlrev_b32 v48, 16, v61
    v_mfma_f32_16x16x32_bf16 a[108:111], v[168:171], v[24:27], a[108:111]
    ds_read_b128 v[44:47], v1 offset:17408
    v_and_b32 v49, s97, v61
    v_mfma_f32_16x16x32_bf16 a[108:111], v[184:187], v[28:31], a[108:111]
    v_exp_f32 v18, v78
    v_mfma_f32_16x16x32_bf16 a[156:159], v[172:175], v[24:27], a[156:159]
    s_add_u32 s29, s28, 49152
    v_add_f32 v8, v8, v16
    v_add_f32 v8, v8, v17
    v_mfma_f32_16x16x32_bf16 a[156:159], v[188:191], v[28:31], a[156:159]
    s_waitcnt lgkmcnt(2)
    v_exp_f32 v19, v79
    v_mfma_f32_16x16x32_bf16 a[16:19], v[160:163], v[32:35], a[16:19]
    s_sub_u32 s3, s29, 147456
    ds_read_b128 v[24:27], v1 offset:6144
    v_lshlrev_b32 v50, 16, v63
    v_mfma_f32_16x16x32_bf16 a[16:19], v[176:179], v[36:39], a[16:19]
    s_add_u32 s56, s56, 12288
    v_cvt_pk_bf16_f32 v76, v16, v17
    v_and_b32 v51, s97, v63
    v_mfma_f32_16x16x32_bf16 a[64:67], v[164:167], v[32:35], a[64:67]
    s_min_u32 s29, s29, s3
    v_exp_f32 v16, v108
    v_mfma_f32_16x16x32_bf16 a[64:67], v[180:183], v[36:39], a[64:67]
    s_mov_b32 m0, s56
    v_add_f32 v8, v8, v18
    v_add_f32 v8, v8, v19
    v_mfma_f32_16x16x32_bf16 a[112:115], v[168:171], v[32:35], a[112:115]
    ds_read_b128 v[28:31], v1 offset:18432
    v_mul_f32_e64 v50, -v50, v48
    v_mfma_f32_16x16x32_bf16 a[112:115], v[184:187], v[36:39], a[112:115]
    v_exp_f32 v17, v109
    v_mfma_f32_16x16x32_bf16 a[160:163], v[172:175], v[32:35], a[160:163]
    v_cvt_pk_bf16_f32 v77, v18, v19
    v_mul_f32_e64 v51, -v51, v49
    v_mfma_f32_16x16x32_bf16 a[160:163], v[188:191], v[36:39], a[160:163]
    s_waitcnt lgkmcnt(2)
    v_exp_f32 v18, v110
    v_mfma_f32_16x16x32_bf16 a[20:23], v[160:163], v[40:43], a[20:23]
    s_sub_u32 s3, s29, s28
    ds_read_b128 v[32:35], v1 offset:7168
    v_add_f32 v8, v8, v16
    v_mfma_f32_16x16x32_bf16 a[20:23], v[176:179], v[44:47], a[20:23]
    v_add_f32 v8, v8, v17
    v_cvt_f32_i32 v248, v248
    v_mfma_f32_16x16x32_bf16 a[68:71], v[164:167], v[40:43], a[68:71]
    v_exp_f32 v19, v111
    v_mfma_f32_16x16x32_bf16 a[68:71], v[180:183], v[44:47], a[68:71]
    buffer_load_dwordx4 v4, s[4:7], s27 offen offset:0 sc1 lds
    v_mfma_f32_16x16x32_bf16 a[116:119], v[168:171], v[40:43], a[116:119]
    ds_read_b128 v[36:39], v1 offset:19456
    v_cvt_pk_bf16_f32 v78, v16, v17
    v_mfma_f32_16x16x32_bf16 a[116:119], v[184:187], v[44:47], a[116:119]
    v_add_f32 v8, v8, v18
    v_cvt_f32_i32 v252, v252
    v_mfma_f32_16x16x32_bf16 a[164:167], v[172:175], v[40:43], a[164:167]
    s_mov_b32 s28, s29
    v_add_f32 v8, v8, v19
    v_cvt_pk_bf16_f32 v79, v18, v19
    v_mfma_f32_16x16x32_bf16 a[164:167], v[188:191], v[44:47], a[164:167]
    s_waitcnt lgkmcnt(2)
    v_exp_f32 v16, v80
    v_mfma_f32_16x16x32_bf16 a[24:27], v[160:163], v[24:27], a[24:27]
    ds_read_b128 v[40:43], v1 offset:8192
    v_fma_f32 v248, v248, v48, v50
    v_mfma_f32_16x16x32_bf16 a[24:27], v[176:179], v[28:31], a[24:27]
    v_exp_f32 v17, v81
    v_mfma_f32_16x16x32_bf16 a[72:75], v[164:167], v[24:27], a[72:75]
    v_fma_f32 v252, v252, v49, v51
    v_cvt_f32_i32 v249, v249
    v_mfma_f32_16x16x32_bf16 a[72:75], v[180:183], v[28:31], a[72:75]
    buffer_load_dwordx4 v4, s[4:7], s27 offen offset:1024 sc1 lds
    v_mfma_f32_16x16x32_bf16 a[120:123], v[168:171], v[24:27], a[120:123]
    ds_read_b128 v[44:47], v1 offset:20480
    v_cvt_f32_i32 v253, v253
    v_mfma_f32_16x16x32_bf16 a[120:123], v[184:187], v[28:31], a[120:123]
    v_exp_f32 v18, v82
    v_mfma_f32_16x16x32_bf16 a[168:171], v[172:175], v[24:27], a[168:171]
    v_add_f32 v5, v5, v16
    v_add_f32 v5, v5, v17
    v_mfma_f32_16x16x32_bf16 a[168:171], v[188:191], v[28:31], a[168:171]
    s_waitcnt lgkmcnt(2)
    v_exp_f32 v19, v83
    v_mfma_f32_16x16x32_bf16 a[28:31], v[160:163], v[32:35], a[28:31]
    ds_read_b128 v[24:27], v1 offset:9216
    v_cvt_pk_bf16_f32 v80, v16, v17
    v_mfma_f32_16x16x32_bf16 a[28:31], v[176:179], v[36:39], a[28:31]
    v_exp_f32 v16, v112
    v_mfma_f32_16x16x32_bf16 a[76:79], v[164:167], v[32:35], a[76:79]
    v_add_f32 v5, v5, v18
    v_fma_f32 v249, v249, v48, v50
    v_mfma_f32_16x16x32_bf16 a[76:79], v[180:183], v[36:39], a[76:79]
    v_add_f32 v5, v5, v19
    v_add_u32 v2, s3, v2
    v_mfma_f32_16x16x32_bf16 a[124:127], v[168:171], v[32:35], a[124:127]
    ds_read_b128 v[28:31], v1 offset:21504
    v_fma_f32 v253, v253, v49, v51
    v_mfma_f32_16x16x32_bf16 a[124:127], v[184:187], v[36:39], a[124:127]
    buffer_load_dwordx4 v4, s[4:7], s27 offen offset:2048 sc1 lds
    v_mfma_f32_16x16x32_bf16 a[172:175], v[172:175], v[32:35], a[172:175]
    v_exp_f32 v17, v113
    v_mfma_f32_16x16x32_bf16 a[172:175], v[188:191], v[36:39], a[172:175]
    s_waitcnt lgkmcnt(2)
    v_cvt_pk_bf16_f32 v81, v18, v19
    v_cvt_f32_i32 v250, v250
    v_mfma_f32_16x16x32_bf16 a[32:35], v[160:163], v[40:43], a[32:35]
    ds_read_b128 v[32:35], v1 offset:10240
    v_add_u32 v3, s3, v3
    v_mfma_f32_16x16x32_bf16 a[32:35], v[176:179], v[44:47], a[32:35]
    v_exp_f32 v18, v114
    v_mfma_f32_16x16x32_bf16 a[80:83], v[164:167], v[40:43], a[80:83]
    v_add_f32 v5, v5, v16
    v_add_f32 v5, v5, v17
    v_mfma_f32_16x16x32_bf16 a[80:83], v[180:183], v[44:47], a[80:83]
    v_exp_f32 v19, v115
    v_mfma_f32_16x16x32_bf16 a[128:131], v[168:171], v[40:43], a[128:131]
    ds_read_b128 v[36:39], v1 offset:22528
    v_cvt_pk_bf16_f32 v82, v16, v17
    v_mfma_f32_16x16x32_bf16 a[128:131], v[184:187], v[44:47], a[128:131]
    v_exp_f32 v16, v84
    v_mfma_f32_16x16x32_bf16 a[176:179], v[172:175], v[40:43], a[176:179]
    v_cvt_f32_i32 v254, v254
    v_add_f32 v5, v5, v18
    v_mfma_f32_16x16x32_bf16 a[176:179], v[188:191], v[44:47], a[176:179]
    s_waitcnt lgkmcnt(2)
    v_add_f32 v5, v5, v19
    v_fma_f32 v250, v250, v48, v50
    v_mfma_f32_16x16x32_bf16 a[36:39], v[160:163], v[24:27], a[36:39]
    ds_read_b128 v[40:43], v1 offset:11264
    v_fma_f32 v254, v254, v49, v51
    v_mfma_f32_16x16x32_bf16 a[36:39], v[176:179], v[28:31], a[36:39]
    v_exp_f32 v17, v85
    v_mfma_f32_16x16x32_bf16 a[84:87], v[164:167], v[24:27], a[84:87]
    v_cvt_pk_bf16_f32 v83, v18, v19
    v_cvt_pk_bf16_f32 v146, v240, v244
    v_mfma_f32_16x16x32_bf16 a[84:87], v[180:183], v[28:31], a[84:87]
    s_add_u32 s27, s27, 24576
    v_exp_f32 v18, v86
    v_mfma_f32_16x16x32_bf16 a[132:135], v[168:171], v[24:27], a[132:135]
    s_add_u32 s56, s56, 36864
    ds_read_b128 v[44:47], v1 offset:23552
    v_add_f32 v6, v6, v16
    v_mfma_f32_16x16x32_bf16 a[132:135], v[184:187], v[28:31], a[132:135]
    s_sub_u32 s58, s56, 147456
    v_add_f32 v6, v6, v17
    v_cvt_pk_bf16_f32 v150, v241, v245
    v_mfma_f32_16x16x32_bf16 a[180:183], v[172:175], v[24:27], a[180:183]
    v_exp_f32 v19, v87
    v_mfma_f32_16x16x32_bf16 a[180:183], v[188:191], v[28:31], a[180:183]
    s_waitcnt lgkmcnt(2)
    v_cvt_pk_bf16_f32 v84, v16, v17
    v_cvt_pk_bf16_f32 v147, v248, v252
    v_mfma_f32_16x16x32_bf16 a[40:43], v[160:163], v[32:35], a[40:43]
    s_min_u32 s56, s56, s58
    ds_read_b128 v[24:27], v2 offset:0
    v_mfma_f32_16x16x32_bf16 a[40:43], v[176:179], v[36:39], a[40:43]
    v_exp_f32 v16, v116
    v_mfma_f32_16x16x32_bf16 a[88:91], v[164:167], v[32:35], a[88:91]
    v_add_f32 v6, v6, v18
    v_add_f32 v6, v6, v19
    v_mfma_f32_16x16x32_bf16 a[88:91], v[180:183], v[36:39], a[88:91]
    v_exp_f32 v17, v117
    v_mfma_f32_16x16x32_bf16 a[136:139], v[168:171], v[32:35], a[136:139]
    ds_read_b128 v[28:31], v3 offset:0
    v_cvt_pk_bf16_f32 v151, v249, v253
    v_mfma_f32_16x16x32_bf16 a[136:139], v[184:187], v[36:39], a[136:139]
    v_cvt_pk_bf16_f32 v85, v18, v19
    v_cvt_pk_bf16_f32 v154, v242, v246
    v_mfma_f32_16x16x32_bf16 a[184:187], v[172:175], v[32:35], a[184:187]
    v_exp_f32 v18, v118
    v_mfma_f32_16x16x32_bf16 a[184:187], v[188:191], v[36:39], a[184:187]
    s_waitcnt lgkmcnt(2)
    v_add_f32 v6, v6, v16
    v_mfma_f32_16x16x32_bf16 a[44:47], v[160:163], v[40:43], a[44:47]
    ds_read_b128 v[32:35], v2 offset:6144
    v_add_f32 v6, v6, v17
    v_mfma_f32_16x16x32_bf16 a[44:47], v[176:179], v[44:47], a[44:47]
    v_exp_f32 v19, v119
    v_mfma_f32_16x16x32_bf16 a[92:95], v[164:167], v[40:43], a[92:95]
    v_cvt_pk_bf16_f32 v155, v250, v254
    v_mfma_f32_16x16x32_bf16 a[92:95], v[180:183], v[44:47], a[92:95]
    v_cvt_pk_bf16_f32 v86, v16, v17
    v_mfma_f32_16x16x32_bf16 a[140:143], v[168:171], v[40:43], a[140:143]
    ds_read_b128 v[36:39], v3 offset:6144
    v_add_f32 v6, v6, v18
    v_mfma_f32_16x16x32_bf16 a[140:143], v[184:187], v[44:47], a[140:143]
    v_add_f32 v6, v6, v19
    v_cvt_pk_bf16_f32 v87, v18, v19
    v_mfma_f32_16x16x32_bf16 a[188:191], v[172:175], v[40:43], a[188:191]
    v_mfma_f32_16x16x32_bf16 a[188:191], v[188:191], v[44:47], a[188:191]
    s_waitcnt lgkmcnt(2)
    v_mfma_f32_16x16x32_bf16 v[160:163], v[24:27], a[192:195], v[128:131]
    ds_read_b128 v[40:43], v2 offset:128
    v_mfma_f32_16x16x32_bf16 v[160:163], v[28:31], a[196:199], v[160:163]
    s_waitcnt vmcnt(4)
    v_subrev_u32 v52, s92, v52
    v_cmp_lt_u32 vcc, 15, v52
    v_mfma_f32_16x16x32_bf16 v[164:167], v[24:27], a[216:219], v[132:135]
    v_exp_f32 v16, v88
    v_mfma_f32_16x16x32_bf16 v[164:167], v[28:31], a[220:223], v[164:167]
    v_exp_f32 v17, v89
    v_mfma_f32_16x16x32_bf16 v[168:171], v[24:27], a[240:243], v[136:139]
    s_and_b32 s59, vcc_lo, 0xff
    ds_read_b128 v[44:47], v3 offset:128
    v_mfma_f32_16x16x32_bf16 v[168:171], v[28:31], a[244:247], v[168:171]
    s_cbranch_scc1 L_pollslow3
L_pollok3:
    v_mfma_f32_16x16x32_bf16 v[172:175], v[24:27], v[200:203], v[140:143]
    s_add_u32 s92, s92, 1
    v_exp_f32 v18, v90
    v_mfma_f32_16x16x32_bf16 v[172:175], v[28:31], v[204:207], v[172:175]
    s_waitcnt lgkmcnt(2)
    v_add_f32 v7, v7, v16
    v_add_f32 v7, v7, v17
    v_mfma_f32_16x16x32_bf16 v[96:99], v[32:35], a[192:195], v[128:131]
    ds_read_b128 v[24:27], v2 offset:6272
    v_mfma_f32_16x16x32_bf16 v[96:99], v[36:39], a[196:199], v[96:99]
    buffer_store_dwordx4 v[144:147], v15, s[4:7], s35 offen offset:0 sc1
    v_mfma_f32_16x16x32_bf16 v[100:103], v[32:35], a[216:219], v[132:135]
    v_exp_f32 v19, v91
    v_mfma_f32_16x16x32_bf16 v[100:103], v[36:39], a[220:223], v[100:103]
    v_cvt_pk_bf16_f32 v88, v16, v17
    v_mfma_f32_16x16x32_bf16 v[104:107], v[32:35], a[240:243], v[136:139]
    ds_read_b128 v[28:31], v3 offset:6272
    v_mfma_f32_16x16x32_bf16 v[104:107], v[36:39], a[244:247], v[104:107]
    v_exp_f32 v16, v120
    v_mfma_f32_16x16x32_bf16 v[108:111], v[32:35], v[200:203], v[140:143]
    v_add_f32 v7, v7, v18
    v_add_f32 v7, v7, v19
    v_mfma_f32_16x16x32_bf16 v[108:111], v[36:39], v[204:207], v[108:111]
    s_waitcnt lgkmcnt(2)
    v_exp_f32 v17, v121
    v_mfma_f32_16x16x32_bf16 v[160:163], v[40:43], a[200:203], v[160:163]
    ds_read_b128 v[32:35], v2 offset:256
    v_cvt_pk_bf16_f32 v89, v18, v19
    v_mfma_f32_16x16x32_bf16 v[160:163], v[44:47], a[204:207], v[160:163]
    buffer_store_dwordx4 v[148:151], v15, s[4:7], s35 offen offset:1024 sc1
    v_mfma_f32_16x16x32_bf16 v[164:167], v[40:43], a[224:227], v[164:167]
    v_exp_f32 v18, v122
    v_mfma_f32_16x16x32_bf16 v[164:167], v[44:47], a[228:231], v[164:167]
    v_add_f32 v7, v7, v16
    v_add_f32 v7, v7, v17
    v_mfma_f32_16x16x32_bf16 v[168:171], v[40:43], a[248:251], v[168:171]
    ds_read_b128 v[36:39], v3 offset:256
    v_mfma_f32_16x16x32_bf16 v[168:171], v[44:47], a[252:255], v[168:171]
    v_exp_f32 v19, v123
    v_mfma_f32_16x16x32_bf16 v[172:175], v[40:43], v[208:211], v[172:175]
    v_cvt_pk_bf16_f32 v90, v16, v17
    v_mfma_f32_16x16x32_bf16 v[172:175], v[44:47], v[212:215], v[172:175]
    s_waitcnt lgkmcnt(2)
    v_exp_f32 v16, v92
    v_mfma_f32_16x16x32_bf16 v[96:99], v[24:27], a[200:203], v[96:99]
    ds_read_b128 v[40:43], v2 offset:6400
    v_add_f32 v7, v7, v18
    v_mfma_f32_16x16x32_bf16 v[96:99], v[28:31], a[204:207], v[96:99]
    buffer_store_dwordx4 v[152:155], v15, s[4:7], s35 offen offset:2048 sc1
    v_mfma_f32_16x16x32_bf16 v[100:103], v[24:27], a[224:227], v[100:103]
    v_add_f32 v7, v7, v19
    v_mfma_f32_16x16x32_bf16 v[100:103], v[28:31], a[228:231], v[100:103]
    v_exp_f32 v17, v93
    v_mfma_f32_16x16x32_bf16 v[104:107], v[24:27], a[248:251], v[104:107]
    ds_read_b128 v[44:47], v3 offset:6400
    v_cvt_pk_bf16_f32 v91, v18, v19
    v_mfma_f32_16x16x32_bf16 v[104:107], v[28:31], a[252:255], v[104:107]
    v_exp_f32 v18, v94
    v_mfma_f32_16x16x32_bf16 v[108:111], v[24:27], v[208:211], v[108:111]
    s_add_u32 s29, s30, 49152
    v_add_f32 v8, v8, v16
    v_add_f32 v8, v8, v17
    v_mfma_f32_16x16x32_bf16 v[108:111], v[28:31], v[212:215], v[108:111]
    s_waitcnt lgkmcnt(2)
    v_exp_f32 v19, v95
    v_mfma_f32_16x16x32_bf16 v[160:163], v[32:35], a[208:211], v[160:163]
    s_sub_u32 s3, s29, 147456
    ds_read_b128 v[24:27], v2 offset:12288
    v_cvt_pk_bf16_f32 v92, v16, v17
    v_mfma_f32_16x16x32_bf16 v[160:163], v[36:39], a[212:215], v[160:163]
    s_min_u32 s29, s29, s3
    v_exp_f32 v16, v124
    v_mfma_f32_16x16x32_bf16 v[164:167], v[32:35], a[232:235], v[164:167]
    v_add_f32 v8, v8, v18
    v_add_f32 v8, v8, v19
    v_mfma_f32_16x16x32_bf16 v[164:167], v[36:39], a[236:239], v[164:167]
    v_exp_f32 v17, v125
    v_mfma_f32_16x16x32_bf16 v[168:171], v[32:35], v[192:195], v[168:171]
    ds_read_b128 v[28:31], v3 offset:12288
    v_mfma_f32_16x16x32_bf16 v[168:171], v[36:39], v[196:199], v[168:171]
    v_cvt_pk_bf16_f32 v93, v18, v19
    v_mfma_f32_16x16x32_bf16 v[172:175], v[32:35], v[216:219], v[172:175]
    v_exp_f32 v18, v126
    v_mfma_f32_16x16x32_bf16 v[172:175], v[36:39], v[220:223], v[172:175]
    s_waitcnt lgkmcnt(2)
    v_add_f32 v8, v8, v16
    v_mfma_f32_16x16x32_bf16 v[96:99], v[40:43], a[208:211], v[96:99]
    ds_read_b128 v[32:35], v2 offset:18432
    v_add_f32 v8, v8, v17
    v_mfma_f32_16x16x32_bf16 v[96:99], v[44:47], a[212:215], v[96:99]
    s_mov_b32 m0, s26
    v_exp_f32 v19, v127
    v_mfma_f32_16x16x32_bf16 v[100:103], v[40:43], a[232:235], v[100:103]
    s_sub_u32 s3, s29, s30
    v_mfma_f32_16x16x32_bf16 v[100:103], v[44:47], a[236:239], v[100:103]
    buffer_load_dwordx4 v4, s[4:7], s32 offen offset:0 sc1 lds
    v_mfma_f32_16x16x32_bf16 v[104:107], v[40:43], v[192:195], v[104:107]
    ds_read_b128 v[36:39], v3 offset:18432
    v_cvt_pk_bf16_f32 v94, v16, v17
    v_mfma_f32_16x16x32_bf16 v[104:107], v[44:47], v[196:199], v[104:107]
    v_add_f32 v8, v8, v18
    v_add_f32 v8, v8, v19
    v_mfma_f32_16x16x32_bf16 v[108:111], v[40:43], v[216:219], v[108:111]
    v_cvt_pk_bf16_f32 v95, v18, v19
    v_mfma_f32_16x16x32_bf16 v[108:111], v[44:47], v[220:223], v[108:111]
    s_waitcnt lgkmcnt(2)
    buffer_load_dwordx4 v4, s[4:7], s32 offen offset:1024 sc1 lds
    v_mfma_f32_16x16x32_bf16 v[176:179], v[24:27], a[192:195], v[128:131]
    ds_read_b128 v[40:43], v2 offset:12416
    v_mfma_f32_16x16x32_bf16 v[176:179], v[28:31], a[196:199], v[176:179]
    s_mov_b32 s30, s29
    v_exp_f32 v16, v160
    v_mfma_f32_16x16x32_bf16 v[180:183], v[24:27], a[216:219], v[132:135]
    v_exp_f32 v17, v161
    v_mfma_f32_16x16x32_bf16 v[180:183], v[28:31], a[220:223], v[180:183]
    buffer_load_dwordx4 v4, s[4:7], s32 offen offset:2048 sc1 lds
    v_mfma_f32_16x16x32_bf16 v[184:187], v[24:27], a[240:243], v[136:139]
    s_add_u32 s32, s32, 24576
    ds_read_b128 v[44:47], v3 offset:12416
    v_mfma_f32_16x16x32_bf16 v[184:187], v[28:31], a[244:247], v[184:187]
    v_exp_f32 v18, v162
    v_mfma_f32_16x16x32_bf16 v[188:191], v[24:27], v[200:203], v[140:143]
    s_add_u32 s26, s26, 12288
    v_add_f32 v5, v5, v16
    v_add_f32 v5, v5, v17
    v_mfma_f32_16x16x32_bf16 v[188:191], v[28:31], v[204:207], v[188:191]
    s_waitcnt lgkmcnt(2)
    v_exp_f32 v19, v163
    v_mfma_f32_16x16x32_bf16 v[112:115], v[32:35], a[192:195], v[128:131]
    s_mov_b32 m0, s26
    ds_read_b128 v[24:27], v2 offset:18560
    v_cvt_pk_bf16_f32 v160, v16, v17
    v_mfma_f32_16x16x32_bf16 v[112:115], v[36:39], a[196:199], v[112:115]
    v_exp_f32 v16, v96
    v_mfma_f32_16x16x32_bf16 v[116:119], v[32:35], a[216:219], v[132:135]
    v_add_f32 v5, v5, v18
    v_add_f32 v5, v5, v19
    v_mfma_f32_16x16x32_bf16 v[116:119], v[36:39], a[220:223], v[116:119]
    v_exp_f32 v17, v97
    v_mfma_f32_16x16x32_bf16 v[120:123], v[32:35], a[240:243], v[136:139]
    ds_read_b128 v[28:31], v3 offset:18560
    v_add_u32 v1, s3, v1
    v_mfma_f32_16x16x32_bf16 v[120:123], v[36:39], a[244:247], v[120:123]
    buffer_load_dwordx4 v4, s[4:7], s32 offen offset:0 sc1 lds
    v_mfma_f32_16x16x32_bf16 v[124:127], v[32:35], v[200:203], v[140:143]
    v_cvt_pk_bf16_f32 v161, v18, v19
    v_mfma_f32_16x16x32_bf16 v[124:127], v[36:39], v[204:207], v[124:127]
    s_waitcnt lgkmcnt(2)
    v_exp_f32 v18, v98
    v_mfma_f32_16x16x32_bf16 v[176:179], v[40:43], a[200:203], v[176:179]
    ds_read_b128 v[32:35], v2 offset:12544
    v_add_f32 v5, v5, v16
    v_mfma_f32_16x16x32_bf16 v[176:179], v[44:47], a[204:207], v[176:179]
    buffer_load_dwordx4 v4, s[4:7], s32 offen offset:1024 sc1 lds
    v_mfma_f32_16x16x32_bf16 v[180:183], v[40:43], a[224:227], v[180:183]
    v_add_f32 v5, v5, v17
    v_mfma_f32_16x16x32_bf16 v[180:183], v[44:47], a[228:231], v[180:183]
    v_exp_f32 v19, v99
    v_mfma_f32_16x16x32_bf16 v[184:187], v[40:43], a[248:251], v[184:187]
    ds_read_b128 v[36:39], v3 offset:12544
    v_cvt_pk_bf16_f32 v162, v16, v17
    v_mfma_f32_16x16x32_bf16 v[184:187], v[44:47], a[252:255], v[184:187]
    buffer_load_dwordx4 v4, s[4:7], s32 offen offset:2048 sc1 lds
    v_mfma_f32_16x16x32_bf16 v[188:191], v[40:43], v[208:211], v[188:191]
    v_exp_f32 v16, v164
    v_mfma_f32_16x16x32_bf16 v[188:191], v[44:47], v[212:215], v[188:191]
    s_waitcnt lgkmcnt(2)
    v_add_f32 v5, v5, v18
    v_add_f32 v5, v5, v19
    v_mfma_f32_16x16x32_bf16 v[112:115], v[24:27], a[200:203], v[112:115]
    ds_read_b128 v[40:43], v2 offset:18688
    v_mfma_f32_16x16x32_bf16 v[112:115], v[28:31], a[204:207], v[112:115]
    v_exp_f32 v17, v165
    v_mfma_f32_16x16x32_bf16 v[116:119], v[24:27], a[224:227], v[116:119]
    v_cvt_pk_bf16_f32 v163, v18, v19
    v_mfma_f32_16x16x32_bf16 v[116:119], v[28:31], a[228:231], v[116:119]
    s_add_u32 s32, s32, 24576
    v_exp_f32 v18, v166
    v_mfma_f32_16x16x32_bf16 v[120:123], v[24:27], a[248:251], v[120:123]
    s_add_u32 s26, s26, 36864
    ds_read_b128 v[44:47], v3 offset:18688
    v_add_f32 v6, v6, v16
    v_mfma_f32_16x16x32_bf16 v[120:123], v[28:31], a[252:255], v[120:123]
L_pg9:
    s_cbranch_execz L_pg13
    s_waitcnt lgkmcnt(2)
    v_add_f32 v6, v6, v17
    s_sub_u32 s57, s26, 147456
    v_mfma_f32_16x16x32_bf16 v[124:127], v[24:27], v[208:211], v[124:127]
    s_waitcnt vmcnt(6)
    v_exp_f32 v19, v167
    v_mfma_f32_16x16x32_bf16 v[124:127], v[28:31], v[212:215], v[124:127]
    s_barrier
    v_cvt_pk_bf16_f32 v164, v16, v17
    v_mfma_f32_16x16x32_bf16 v[176:179], v[32:35], a[208:211], v[176:179]
    s_min_u32 s26, s26, s57
    ds_read_b128 v[24:27], v1 offset:0
    v_add_u32 v0, 1, v0
    v_mfma_f32_16x16x32_bf16 v[176:179], v[36:39], a[212:215], v[176:179]
    buffer_store_dword v0, v13, s[20:23], 0 offen offset:32 sc1
    v_mfma_f32_16x16x32_bf16 v[180:183], v[32:35], a[232:235], v[180:183]
    v_exp_f32 v16, v100
    v_mfma_f32_16x16x32_bf16 v[180:183], v[36:39], a[236:239], v[180:183]
    v_add_f32 v6, v6, v18
    v_add_f32 v6, v6, v19
    v_mfma_f32_16x16x32_bf16 v[184:187], v[32:35], v[192:195], v[184:187]
    ds_read_b128 v[28:31], v1 offset:12288
    v_mfma_f32_16x16x32_bf16 v[184:187], v[36:39], v[196:199], v[184:187]
    v_exp_f32 v17, v101
    v_mfma_f32_16x16x32_bf16 v[188:191], v[32:35], v[216:219], v[188:191]
    v_cvt_pk_bf16_f32 v165, v18, v19
    v_mfma_f32_16x16x32_bf16 v[188:191], v[36:39], v[220:223], v[188:191]
    s_waitcnt lgkmcnt(2)
    v_exp_f32 v18, v102
    v_mfma_f32_16x16x32_bf16 v[112:115], v[40:43], a[208:211], v[112:115]
    ds_read_b128 v[32:35], v1 offset:1024
    v_add_f32 v6, v6, v16
    v_mfma_f32_16x16x32_bf16 v[112:115], v[44:47], a[212:215], v[112:115]
    v_add_f32 v6, v6, v17
    v_mfma_f32_16x16x32_bf16 v[116:119], v[40:43], a[232:235], v[116:119]
    v_exp_f32 v19, v103
    v_mfma_f32_16x16x32_bf16 v[116:119], v[44:47], a[236:239], v[116:119]
    v_cvt_pk_bf16_f32 v166, v16, v17
    v_mfma_f32_16x16x32_bf16 v[120:123], v[40:43], v[192:195], v[120:123]
    ds_read_b128 v[36:39], v1 offset:13312
    v_add_f32 v6, v6, v18
    v_mfma_f32_16x16x32_bf16 v[120:123], v[44:47], v[196:199], v[120:123]
    v_add_f32 v6, v6, v19
    v_cvt_pk_bf16_f32 v167, v18, v19
    v_mfma_f32_16x16x32_bf16 v[124:127], v[40:43], v[216:219], v[124:127]
    v_mfma_f32_16x16x32_bf16 v[124:127], v[44:47], v[220:223], v[124:127]
    s_waitcnt lgkmcnt(2)
    v_mfma_f32_16x16x32_bf16 a[0:3], v[64:67], v[24:27], a[0:3]
    s_mov_b32 m0, s26
    ds_read_b128 v[40:43], v1 offset:2048
    v_mfma_f32_16x16x32_bf16 a[0:3], v[80:83], v[28:31], a[0:3]
    buffer_load_dwordx4 v4, s[4:7], s32 offen offset:0 sc1 lds
    v_mfma_f32_16x16x32_bf16 a[48:51], v[68:71], v[24:27], a[48:51]
    v_exp_f32 v16, v168
    v_mfma_f32_16x16x32_bf16 a[48:51], v[84:87], v[28:31], a[48:51]
    v_exp_f32 v17, v169
    v_mfma_f32_16x16x32_bf16 a[96:99], v[72:75], v[24:27], a[96:99]
    ds_read_b128 v[44:47], v1 offset:14336
    v_mfma_f32_16x16x32_bf16 a[96:99], v[88:91], v[28:31], a[96:99]
    v_exp_f32 v18, v170
    v_mfma_f32_16x16x32_bf16 a[144:147], v[76:79], v[24:27], a[144:147]
    v_add_f32 v7, v7, v16
    v_add_f32 v7, v7, v17
    v_mfma_f32_16x16x32_bf16 a[144:147], v[92:95], v[28:31], a[144:147]
    s_waitcnt lgkmcnt(2)
    v_exp_f32 v19, v171
    v_mfma_f32_16x16x32_bf16 a[4:7], v[64:67], v[32:35], a[4:7]
    ds_read_b128 v[24:27], v1 offset:3072
    v_cvt_pk_bf16_f32 v168, v16, v17
    v_mfma_f32_16x16x32_bf16 a[4:7], v[80:83], v[36:39], a[4:7]
    v_exp_f32 v16, v104
    v_mfma_f32_16x16x32_bf16 a[52:55], v[68:71], v[32:35], a[52:55]
    v_add_f32 v7, v7, v18
    v_add_f32 v7, v7, v19
    v_mfma_f32_16x16x32_bf16 a[52:55], v[84:87], v[36:39], a[52:55]
    buffer_load_dwordx4 v4, s[4:7], s32 offen offset:1024 sc1 lds
    v_mfma_f32_16x16x32_bf16 a[100:103], v[72:75], v[32:35], a[100:103]
    ds_read_b128 v[28:31], v1 offset:15360
    v_mfma_f32_16x16x32_bf16 a[100:103], v[88:91], v[36:39], a[100:103]
    v_exp_f32 v17, v105
    v_mfma_f32_16x16x32_bf16 a[148:151], v[76:79], v[32:35], a[148:151]
    v_cvt_pk_bf16_f32 v169, v18, v19
    v_mfma_f32_16x16x32_bf16 a[148:151], v[92:95], v[36:39], a[148:151]
    s_waitcnt lgkmcnt(2)
    v_exp_f32 v18, v106
    v_mfma_f32_16x16x32_bf16 a[8:11], v[64:67], v[40:43], a[8:11]
    ds_read_b128 v[32:35], v1 offset:4096
    v_add_f32 v7, v7, v16
    v_mfma_f32_16x16x32_bf16 a[8:11], v[80:83], v[44:47], a[8:11]
    v_add_f32 v7, v7, v17
    v_mfma_f32_16x16x32_bf16 a[56:59], v[68:71], v[40:43], a[56:59]
    v_exp_f32 v19, v107
    v_mfma_f32_16x16x32_bf16 a[56:59], v[84:87], v[44:47], a[56:59]
    v_cvt_pk_bf16_f32 v170, v16, v17
    v_mfma_f32_16x16x32_bf16 a[104:107], v[72:75], v[40:43], a[104:107]
    ds_read_b128 v[36:39], v1 offset:16384
    v_mfma_f32_16x16x32_bf16 a[104:107], v[88:91], v[44:47], a[104:107]
    v_exp_f32 v16, v172
    v_mfma_f32_16x16x32_bf16 a[152:155], v[76:79], v[40:43], a[152:155]
    v_add_f32 v7, v7, v18
    v_add_f32 v7, v7, v19
    v_mfma_f32_16x16x32_bf16 a[152:155], v[92:95], v[44:47], a[152:155]
    s_waitcnt lgkmcnt(2)
    buffer_load_dwordx4 v4, s[4:7], s32 offen offset:2048 sc1 lds
    v_mfma_f32_16x16x32_bf16 a[12:15], v[64:67], v[24:27], a[12:15]
    ds_read_b128 v[40:43], v1 offset:5120
    v_mfma_f32_16x16x32_bf16 a[12:15], v[80:83], v[28:31], a[12:15]
    v_exp_f32 v17, v173
    v_mfma_f32_16x16x32_bf16 a[60:63], v[68:71], v[24:27], a[60:63]
    v_cvt_pk_bf16_f32 v171, v18, v19
    v_mfma_f32_16x16x32_bf16 a[60:63], v[84:87], v[28:31], a[60:63]
    v_exp_f32 v18, v174
    v_mfma_f32_16x16x32_bf16 a[108:111], v[72:75], v[24:27], a[108:111]
    ds_read_b128 v[44:47], v1 offset:17408
    v_add_f32 v8, v8, v16
    v_mfma_f32_16x16x32_bf16 a[108:111], v[88:91], v[28:31], a[108:111]
    v_add_f32 v8, v8, v17
    v_mfma_f32_16x16x32_bf16 a[156:159], v[76:79], v[24:27], a[156:159]
    s_add_u32 s29, s28, 49152
    v_exp_f32 v19, v175
    v_mfma_f32_16x16x32_bf16 a[156:159], v[92:95], v[28:31], a[156:159]
    s_waitcnt lgkmcnt(2)
    v_cvt_pk_bf16_f32 v172, v16, v17
    s_sub_u32 s3, s29, 147456
    v_mfma_f32_16x16x32_bf16 a[16:19], v[64:67], v[32:35], a[16:19]
    s_add_u32 s32, s32, 24576
    ds_read_b128 v[24:27], v1 offset:6144
    v_mfma_f32_16x16x32_bf16 a[16:19], v[80:83], v[36:39], a[16:19]
    s_min_u32 s29, s29, s3
    v_exp_f32 v16, v108
    v_mfma_f32_16x16x32_bf16 a[64:67], v[68:71], v[32:35], a[64:67]
    v_add_f32 v8, v8, v18
    v_add_f32 v8, v8, v19
    v_mfma_f32_16x16x32_bf16 a[64:67], v[84:87], v[36:39], a[64:67]
    v_exp_f32 v17, v109
    v_mfma_f32_16x16x32_bf16 a[112:115], v[72:75], v[32:35], a[112:115]
    s_add_u32 s26, s26, 12288
    ds_read_b128 v[28:31], v1 offset:18432
    v_mfma_f32_16x16x32_bf16 a[112:115], v[88:91], v[36:39], a[112:115]
    v_cvt_pk_bf16_f32 v173, v18, v19
    v_mfma_f32_16x16x32_bf16 a[160:163], v[76:79], v[32:35], a[160:163]
    v_exp_f32 v18, v110
    v_mfma_f32_16x16x32_bf16 a[160:163], v[92:95], v[36:39], a[160:163]
    s_waitcnt lgkmcnt(2)
    v_add_f32 v8, v8, v16
    v_mfma_f32_16x16x32_bf16 a[20:23], v[64:67], v[40:43], a[20:23]
    s_sub_u32 s3, s29, s28
    ds_read_b128 v[32:35], v1 offset:7168
    v_add_f32 v8, v8, v17
    v_mfma_f32_16x16x32_bf16 a[20:23], v[80:83], v[44:47], a[20:23]
    v_exp_f32 v19, v111
    v_mfma_f32_16x16x32_bf16 a[68:71], v[68:71], v[40:43], a[68:71]
    s_mov_b32 m0, s26
    v_mfma_f32_16x16x32_bf16 a[68:71], v[84:87], v[44:47], a[68:71]
    v_cvt_pk_bf16_f32 v174, v16, v17
    v_mfma_f32_16x16x32_bf16 a[116:119], v[72:75], v[40:43], a[116:119]
    ds_read_b128 v[36:39], v1 offset:19456
    v_add_f32 v8, v8, v18
    v_mfma_f32_16x16x32_bf16 a[116:119], v[88:91], v[44:47], a[116:119]
    v_add_f32 v8, v8, v19
    v_cvt_pk_bf16_f32 v175, v18, v19
    v_mfma_f32_16x16x32_bf16 a[164:167], v[76:79], v[40:43], a[164:167]
    s_mov_b32 s28, s29
    v_mfma_f32_16x16x32_bf16 a[164:167], v[92:95], v[44:47], a[164:167]
    s_waitcnt lgkmcnt(2)
    v_exp_f32 v16, v176
    v_mfma_f32_16x16x32_bf16 a[24:27], v[64:67], v[24:27], a[24:27]
    ds_read_b128 v[40:43], v1 offset:8192
    v_mfma_f32_16x16x32_bf16 a[24:27], v[80:83], v[28:31], a[24:27]
    v_exp_f32 v17, v177
    v_mfma_f32_16x16x32_bf16 a[72:75], v[68:71], v[24:27], a[72:75]
    v_exp_f32 v18, v178
    v_mfma_f32_16x16x32_bf16 a[72:75], v[84:87], v[28:31], a[72:75]
    buffer_load_dwordx4 v4, s[4:7], s32 offen offset:0 sc1 lds
    v_mfma_f32_16x16x32_bf16 a[120:123], v[72:75], v[24:27], a[120:123]
    ds_read_b128 v[44:47], v1 offset:20480
    v_add_f32 v5, v5, v16
    v_mfma_f32_16x16x32_bf16 a[120:123], v[88:91], v[28:31], a[120:123]
    v_add_f32 v5, v5, v17
    v_add_u32 v2, s3, v2
    v_mfma_f32_16x16x32_bf16 a[168:171], v[76:79], v[24:27], a[168:171]
    v_exp_f32 v19, v179
    v_mfma_f32_16x16x32_bf16 a[168:171], v[92:95], v[28:31], a[168:171]
    s_waitcnt lgkmcnt(2)
    v_cvt_pk_bf16_f32 v176, v16, v17
    v_mfma_f32_16x16x32_bf16 a[28:31], v[64:67], v[32:35], a[28:31]
    ds_read_b128 v[24:27], v1 offset:9216
    v_mfma_f32_16x16x32_bf16 a[28:31], v[80:83], v[36:39], a[28:31]
    v_exp_f32 v16, v112
    v_mfma_f32_16x16x32_bf16 a[76:79], v[68:71], v[32:35], a[76:79]
    v_add_f32 v5, v5, v18
    v_add_f32 v5, v5, v19
    v_mfma_f32_16x16x32_bf16 a[76:79], v[84:87], v[36:39], a[76:79]
    v_exp_f32 v17, v113
    v_mfma_f32_16x16x32_bf16 a[124:127], v[72:75], v[32:35], a[124:127]
    ds_read_b128 v[28:31], v1 offset:21504
    v_add_u32 v3, s3, v3
    v_mfma_f32_16x16x32_bf16 a[124:127], v[88:91], v[36:39], a[124:127]
    v_cvt_pk_bf16_f32 v177, v18, v19
    v_mfma_f32_16x16x32_bf16 a[172:175], v[76:79], v[32:35], a[172:175]
    v_exp_f32 v18, v114
    v_mfma_f32_16x16x32_bf16 a[172:175], v[92:95], v[36:39], a[172:175]
    s_waitcnt lgkmcnt(2)
    buffer_load_dwordx4 v4, s[4:7], s32 offen offset:1024 sc1 lds
    v_mfma_f32_16x16x32_bf16 a[32:35], v[64:67], v[40:43], a[32:35]
    ds_read_b128 v[32:35], v1 offset:10240
    v_add_f32 v5, v5, v16
    v_mfma_f32_16x16x32_bf16 a[32:35], v[80:83], v[44:47], a[32:35]
    v_add_f32 v5, v5, v17
    v_mfma_f32_16x16x32_bf16 a[80:83], v[68:71], v[40:43], a[80:83]
    v_exp_f32 v19, v115
    v_mfma_f32_16x16x32_bf16 a[80:83], v[84:87], v[44:47], a[80:83]
    v_cvt_pk_bf16_f32 v178, v16, v17
    v_mfma_f32_16x16x32_bf16 a[128:131], v[72:75], v[40:43], a[128:131]
    ds_read_b128 v[36:39], v1 offset:22528
    v_mfma_f32_16x16x32_bf16 a[128:131], v[88:91], v[44:47], a[128:131]
    v_exp_f32 v16, v180
    v_mfma_f32_16x16x32_bf16 a[176:179], v[76:79], v[40:43], a[176:179]
    v_add_f32 v5, v5, v18
    v_add_f32 v5, v5, v19
    v_mfma_f32_16x16x32_bf16 a[176:179], v[92:95], v[44:47], a[176:179]
    s_waitcnt lgkmcnt(2)
    v_exp_f32 v17, v181
    v_mfma_f32_16x16x32_bf16 a[36:39], v[64:67], v[24:27], a[36:39]
    ds_read_b128 v[40:43], v1 offset:11264
    v_mfma_f32_16x16x32_bf16 a[36:39], v[80:83], v[28:31], a[36:39]
    buffer_load_dwordx4 v4, s[4:7], s32 offen offset:2048 sc1 lds
    v_mfma_f32_16x16x32_bf16 a[84:87], v[68:71], v[24:27], a[84:87]
    v_cvt_pk_bf16_f32 v179, v18, v19
    v_mfma_f32_16x16x32_bf16 a[84:87], v[84:87], v[28:31], a[84:87]
    v_exp_f32 v18, v182
    v_mfma_f32_16x16x32_bf16 a[132:135], v[72:75], v[24:27], a[132:135]
    ds_read_b128 v[44:47], v1 offset:23552
    v_add_f32 v6, v6, v16
    v_mfma_f32_16x16x32_bf16 a[132:135], v[88:91], v[28:31], a[132:135]
    s_waitcnt lgkmcnt(2)
    v_add_f32 v6, v6, v17
    v_mfma_f32_16x16x32_bf16 a[180:183], v[76:79], v[24:27], a[180:183]
    s_waitcnt vmcnt(7)
    v_exp_f32 v19, v183
    v_mfma_f32_16x16x32_bf16 a[180:183], v[92:95], v[28:31], a[180:183]
    s_barrier
    v_cvt_pk_bf16_f32 v180, v16, v17
    v_mfma_f32_16x16x32_bf16 a[40:43], v[64:67], v[32:35], a[40:43]
    ds_read_b128 v[24:27], v2 offset:0
    v_mfma_f32_16x16x32_bf16 a[40:43], v[80:83], v[36:39], a[40:43]
    v_exp_f32 v16, v116
    v_mfma_f32_16x16x32_bf16 a[88:91], v[68:71], v[32:35], a[88:91]
    v_add_f32 v6, v6, v18
    v_add_f32 v6, v6, v19
    v_mfma_f32_16x16x32_bf16 a[88:91], v[84:87], v[36:39], a[88:91]
    v_exp_f32 v17, v117
    v_mfma_f32_16x16x32_bf16 a[136:139], v[72:75], v[32:35], a[136:139]
    ds_read_b128 v[28:31], v3 offset:0
    v_mfma_f32_16x16x32_bf16 a[136:139], v[88:91], v[36:39], a[136:139]
    v_cvt_pk_bf16_f32 v181, v18, v19
    v_mfma_f32_16x16x32_bf16 a[184:187], v[76:79], v[32:35], a[184:187]
    v_exp_f32 v18, v118
    v_mfma_f32_16x16x32_bf16 a[184:187], v[92:95], v[36:39], a[184:187]
    s_waitcnt lgkmcnt(2)
    v_add_f32 v6, v6, v16
    v_mfma_f32_16x16x32_bf16 a[44:47], v[64:67], v[40:43], a[44:47]
    ds_read_b128 v[32:35], v2 offset:6144
    v_add_f32 v6, v6, v17
    v_mfma_f32_16x16x32_bf16 a[44:47], v[80:83], v[44:47], a[44:47]
    v_exp_f32 v19, v119
    v_mfma_f32_16x16x32_bf16 a[92:95], v[68:71], v[40:43], a[92:95]
    v_mfma_f32_16x16x32_bf16 a[92:95], v[84:87], v[44:47], a[92:95]
    s_add_u32 s32, s32, 24576
    s_add_u32 s26, s26, 36864
    v_cvt_pk_bf16_f32 v182, v16, v17
    v_mfma_f32_16x16x32_bf16 a[140:143], v[72:75], v[40:43], a[140:143]
    s_sub_u32 s57, s26, 147456
    ds_read_b128 v[36:39], v3 offset:6144
    v_add_f32 v6, v6, v18
    v_mfma_f32_16x16x32_bf16 a[140:143], v[88:91], v[44:47], a[140:143]
    s_min_u32 s26, s26, s57
    v_add_f32 v6, v6, v19
    v_cvt_pk_bf16_f32 v183, v18, v19
    v_mfma_f32_16x16x32_bf16 a[188:191], v[76:79], v[40:43], a[188:191]
    v_mfma_f32_16x16x32_bf16 a[188:191], v[92:95], v[44:47], a[188:191]
    s_waitcnt lgkmcnt(2)
    v_mfma_f32_16x16x32_bf16 v[64:67], v[24:27], a[192:195], v[128:131]
    ds_read_b128 v[40:43], v2 offset:128
    v_mfma_f32_16x16x32_bf16 v[64:67], v[28:31], a[196:199], v[64:67]
    v_exp_f32 v16, v184
    v_mfma_f32_16x16x32_bf16 v[68:71], v[24:27], a[216:219], v[132:135]
    v_exp_f32 v17, v185
    v_mfma_f32_16x16x32_bf16 v[68:71], v[28:31], a[220:223], v[68:71]
    buffer_load_dword v52, v20, s[20:23], s44 offen sc1
    v_mfma_f32_16x16x32_bf16 v[72:75], v[24:27], a[240:243], v[136:139]
    ds_read_b128 v[44:47], v3 offset:128
    v_mfma_f32_16x16x32_bf16 v[72:75], v[28:31], a[244:247], v[72:75]
    v_exp_f32 v18, v186
    v_mfma_f32_16x16x32_bf16 v[76:79], v[24:27], v[200:203], v[140:143]
    v_add_f32 v7, v7, v16
    v_add_f32 v7, v7, v17
    v_mfma_f32_16x16x32_bf16 v[76:79], v[28:31], v[204:207], v[76:79]
    s_waitcnt lgkmcnt(2)
    v_exp_f32 v19, v187
    v_mfma_f32_16x16x32_bf16 v[96:99], v[32:35], a[192:195], v[128:131]
    ds_read_b128 v[24:27], v2 offset:6272
    v_cvt_pk_bf16_f32 v184, v16, v17
    v_mfma_f32_16x16x32_bf16 v[96:99], v[36:39], a[196:199], v[96:99]
    v_exp_f32 v16, v120
    v_mfma_f32_16x16x32_bf16 v[100:103], v[32:35], a[216:219], v[132:135]
    v_add_f32 v7, v7, v18
    v_add_f32 v7, v7, v19
    v_mfma_f32_16x16x32_bf16 v[100:103], v[36:39], a[220:223], v[100:103]
    s_mov_b32 m0, s26
    v_exp_f32 v17, v121
    v_mfma_f32_16x16x32_bf16 v[104:107], v[32:35], a[240:243], v[136:139]
    ds_read_b128 v[28:31], v3 offset:6272
    v_mfma_f32_16x16x32_bf16 v[104:107], v[36:39], a[244:247], v[104:107]
    buffer_load_dwordx4 v4, s[4:7], s32 offen offset:0 sc1 lds
    v_mfma_f32_16x16x32_bf16 v[108:111], v[32:35], v[200:203], v[140:143]
    v_cvt_pk_bf16_f32 v185, v18, v19
    v_mfma_f32_16x16x32_bf16 v[108:111], v[36:39], v[204:207], v[108:111]
    s_waitcnt lgkmcnt(2)
    v_exp_f32 v18, v122
    v_mfma_f32_16x16x32_bf16 v[64:67], v[40:43], a[200:203], v[64:67]
    ds_read_b128 v[32:35], v2 offset:256
    v_add_f32 v7, v7, v16
    v_mfma_f32_16x16x32_bf16 v[64:67], v[44:47], a[204:207], v[64:67]
    v_add_f32 v7, v7, v17
    v_mfma_f32_16x16x32_bf16 v[68:71], v[40:43], a[224:227], v[68:71]
    v_exp_f32 v19, v123
    v_mfma_f32_16x16x32_bf16 v[68:71], v[44:47], a[228:231], v[68:71]
    v_cvt_pk_bf16_f32 v186, v16, v17
    v_mfma_f32_16x16x32_bf16 v[72:75], v[40:43], a[248:251], v[72:75]
    ds_read_b128 v[36:39], v3 offset:256
    v_mfma_f32_16x16x32_bf16 v[72:75], v[44:47], a[252:255], v[72:75]
    buffer_load_dwordx4 v4, s[4:7], s32 offen offset:1024 sc1 lds
    v_mfma_f32_16x16x32_bf16 v[76:79], v[40:43], v[208:211], v[76:79]
    v_exp_f32 v16, v188
    v_mfma_f32_16x16x32_bf16 v[76:79], v[44:47], v[212:215], v[76:79]
    s_waitcnt lgkmcnt(2)
    v_add_f32 v7, v7, v18
    v_add_f32 v7, v7, v19
    v_mfma_f32_16x16x32_bf16 v[96:99], v[24:27], a[200:203], v[96:99]
    ds_read_b128 v[40:43], v2 offset:6400
    v_mfma_f32_16x16x32_bf16 v[96:99], v[28:31], a[204:207], v[96:99]
    v_exp_f32 v17, v189
    v_mfma_f32_16x16x32_bf16 v[100:103], v[24:27], a[224:227], v[100:103]
    v_cvt_pk_bf16_f32 v187, v18, v19
    v_mfma_f32_16x16x32_bf16 v[100:103], v[28:31], a[228:231], v[100:103]
    v_exp_f32 v18, v190
    v_mfma_f32_16x16x32_bf16 v[104:107], v[24:27], a[248:251], v[104:107]
    ds_read_b128 v[44:47], v3 offset:6400
    v_add_f32 v8, v8, v16
    v_mfma_f32_16x16x32_bf16 v[104:107], v[28:31], a[252:255], v[104:107]
    v_add_f32 v8, v8, v17
    v_mfma_f32_16x16x32_bf16 v[108:111], v[24:27], v[208:211], v[108:111]
    s_add_u32 s29, s30, 49152
    v_exp_f32 v19, v191
    v_mfma_f32_16x16x32_bf16 v[108:111], v[28:31], v[212:215], v[108:111]
    s_waitcnt lgkmcnt(2)
    buffer_load_dwordx4 v4, s[4:7], s32 offen offset:2048 sc1 lds
    v_mfma_f32_16x16x32_bf16 v[64:67], v[32:35], a[208:211], v[64:67]
    s_sub_u32 s3, s29, 147456
    ds_read_b128 v[24:27], v2 offset:12288
    v_cvt_pk_bf16_f32 v188, v16, v17
    v_mfma_f32_16x16x32_bf16 v[64:67], v[36:39], a[212:215], v[64:67]
    s_min_u32 s29, s29, s3
    v_exp_f32 v16, v124
    v_mfma_f32_16x16x32_bf16 v[68:71], v[32:35], a[232:235], v[68:71]
    v_add_f32 v8, v8, v18
    v_add_f32 v8, v8, v19
    v_mfma_f32_16x16x32_bf16 v[68:71], v[36:39], a[236:239], v[68:71]
    v_exp_f32 v17, v125
    v_mfma_f32_16x16x32_bf16 v[72:75], v[32:35], v[192:195], v[72:75]
    ds_read_b128 v[28:31], v3 offset:12288
    v_mfma_f32_16x16x32_bf16 v[72:75], v[36:39], v[196:199], v[72:75]
    v_cvt_pk_bf16_f32 v189, v18, v19
    v_mfma_f32_16x16x32_bf16 v[76:79], v[32:35], v[216:219], v[76:79]
    v_exp_f32 v18, v126
    v_mfma_f32_16x16x32_bf16 v[76:79], v[36:39], v[220:223], v[76:79]
    s_waitcnt lgkmcnt(2)
    v_add_f32 v8, v8, v16
    s_add_u32 s32, s32, 24576
    v_mfma_f32_16x16x32_bf16 v[96:99], v[40:43], a[208:211], v[96:99]
    ds_read_b128 v[32:35], v2 offset:18432
    v_add_f32 v8, v8, v17
    v_mfma_f32_16x16x32_bf16 v[96:99], v[44:47], a[212:215], v[96:99]
    s_sub_u32 s3, s29, s30
    v_exp_f32 v19, v127
    v_mfma_f32_16x16x32_bf16 v[100:103], v[40:43], a[232:235], v[100:103]
    v_mfma_f32_16x16x32_bf16 v[100:103], v[44:47], a[236:239], v[100:103]
    v_cvt_pk_bf16_f32 v190, v16, v17
    v_mfma_f32_16x16x32_bf16 v[104:107], v[40:43], v[192:195], v[104:107]
    s_add_u32 s26, s26, 12288
    ds_read_b128 v[36:39], v3 offset:18432
    v_add_f32 v8, v8, v18
    v_mfma_f32_16x16x32_bf16 v[104:107], v[44:47], v[196:199], v[104:107]
    v_add_f32 v8, v8, v19
    v_cvt_pk_bf16_f32 v191, v18, v19
    v_mfma_f32_16x16x32_bf16 v[108:111], v[40:43], v[216:219], v[108:111]
    v_mfma_f32_16x16x32_bf16 v[108:111], v[44:47], v[220:223], v[108:111]
    s_waitcnt lgkmcnt(2)
    v_exp_f32 v16, v64
    v_mfma_f32_16x16x32_bf16 v[80:83], v[24:27], a[192:195], v[128:131]
    ds_read_b128 v[40:43], v2 offset:12416
    v_mfma_f32_16x16x32_bf16 v[80:83], v[28:31], a[196:199], v[80:83]
    s_mov_b32 m0, s26
    v_exp_f32 v17, v65
    v_mfma_f32_16x16x32_bf16 v[84:87], v[24:27], a[216:219], v[132:135]
    s_mov_b32 s30, s29
    v_exp_f32 v18, v66
    v_mfma_f32_16x16x32_bf16 v[84:87], v[28:31], a[220:223], v[84:87]
    v_add_f32 v5, v5, v16
    v_mfma_f32_16x16x32_bf16 v[88:91], v[24:27], a[240:243], v[136:139]
    ds_read_b128 v[44:47], v3 offset:12416
    v_add_f32 v5, v5, v17
    v_mfma_f32_16x16x32_bf16 v[88:91], v[28:31], a[244:247], v[88:91]
    v_exp_f32 v19, v67
    v_mfma_f32_16x16x32_bf16 v[92:95], v[24:27], v[200:203], v[140:143]
    v_mfma_f32_16x16x32_bf16 v[92:95], v[28:31], v[204:207], v[92:95]
    s_waitcnt lgkmcnt(2)
    v_cvt_pk_bf16_f32 v64, v16, v17
    v_mfma_f32_16x16x32_bf16 v[112:115], v[32:35], a[192:195], v[128:131]
    ds_read_b128 v[24:27], v2 offset:18560
    v_mfma_f32_16x16x32_bf16 v[112:115], v[36:39], a[196:199], v[112:115]
    buffer_load_dwordx4 v4, s[4:7], s32 offen offset:0 sc1 lds
    v_mfma_f32_16x16x32_bf16 v[116:119], v[32:35], a[216:219], v[132:135]
    v_exp_f32 v16, v96
    v_mfma_f32_16x16x32_bf16 v[116:119], v[36:39], a[220:223], v[116:119]
    v_add_f32 v5, v5, v18
    v_add_f32 v5, v5, v19
    v_mfma_f32_16x16x32_bf16 v[120:123], v[32:35], a[240:243], v[136:139]
    ds_read_b128 v[28:31], v3 offset:18560
    v_add_u32 v1, s3, v1
    v_mfma_f32_16x16x32_bf16 v[120:123], v[36:39], a[244:247], v[120:123]
    v_exp_f32 v17, v97
    v_mfma_f32_16x16x32_bf16 v[124:127], v[32:35], v[200:203], v[140:143]
    v_cvt_pk_bf16_f32 v65, v18, v19
    v_mfma_f32_16x16x32_bf16 v[124:127], v[36:39], v[204:207], v[124:127]
    s_waitcnt lgkmcnt(2)
    v_exp_f32 v18, v98
    v_mfma_f32_16x16x32_bf16 v[80:83], v[40:43], a[200:203], v[80:83]
    ds_read_b128 v[32:35], v2 offset:12544
    v_add_f32 v5, v5, v16
    v_mfma_f32_16x16x32_bf16 v[80:83], v[44:47], a[204:207], v[80:83]
    v_add_f32 v5, v5, v17
    v_mfma_f32_16x16x32_bf16 v[84:87], v[40:43], a[224:227], v[84:87]
    v_exp_f32 v19, v99
    v_mfma_f32_16x16x32_bf16 v[84:87], v[44:47], a[228:231], v[84:87]
    buffer_load_dwordx4 v4, s[4:7], s32 offen offset:1024 sc1 lds
    v_mfma_f32_16x16x32_bf16 v[88:91], v[40:43], a[248:251], v[88:91]
    ds_read_b128 v[36:39], v3 offset:12544
    v_cvt_pk_bf16_f32 v66, v16, v17
    v_mfma_f32_16x16x32_bf16 v[88:91], v[44:47], a[252:255], v[88:91]
    v_exp_f32 v16, v68
    v_mfma_f32_16x16x32_bf16 v[92:95], v[40:43], v[208:211], v[92:95]
    v_add_f32 v5, v5, v18
    v_add_f32 v5, v5, v19
    v_mfma_f32_16x16x32_bf16 v[92:95], v[44:47], v[212:215], v[92:95]
    s_waitcnt lgkmcnt(2)
    v_exp_f32 v17, v69
    v_mfma_f32_16x16x32_bf16 v[112:115], v[24:27], a[200:203], v[112:115]
    ds_read_b128 v[40:43], v2 offset:18688
    v_mfma_f32_16x16x32_bf16 v[112:115], v[28:31], a[204:207], v[112:115]
    v_cvt_pk_bf16_f32 v67, v18, v19
    v_mfma_f32_16x16x32_bf16 v[116:119], v[24:27], a[224:227], v[116:119]
    v_exp_f32 v18, v70
    v_mfma_f32_16x16x32_bf16 v[116:119], v[28:31], a[228:231], v[116:119]
    v_add_f32 v6, v6, v16
    v_mfma_f32_16x16x32_bf16 v[120:123], v[24:27], a[248:251], v[120:123]
    ds_read_b128 v[44:47], v3 offset:18688
    v_add_f32 v6, v6, v17
    v_mfma_f32_16x16x32_bf16 v[120:123], v[28:31], a[252:255], v[120:123]
    s_waitcnt lgkmcnt(2)
    buffer_load_dwordx4 v4, s[4:7], s32 offen offset:2048 sc1 lds
    v_mfma_f32_16x16x32_bf16 v[124:127], v[24:27], v[208:211], v[124:127]
    s_waitcnt vmcnt(7)
    v_exp_f32 v19, v71
    v_mfma_f32_16x16x32_bf16 v[124:127], v[28:31], v[212:215], v[124:127]
    s_barrier
    v_cvt_pk_bf16_f32 v68, v16, v17
    v_mfma_f32_16x16x32_bf16 v[80:83], v[32:35], a[208:211], v[80:83]
    ds_read_b128 v[24:27], v1 offset:0
    v_mfma_f32_16x16x32_bf16 v[80:83], v[36:39], a[212:215], v[80:83]
    v_exp_f32 v16, v100
    v_mfma_f32_16x16x32_bf16 v[84:87], v[32:35], a[232:235], v[84:87]
    v_add_f32 v6, v6, v18
    v_add_f32 v6, v6, v19
    v_mfma_f32_16x16x32_bf16 v[84:87], v[36:39], a[236:239], v[84:87]
    v_exp_f32 v17, v101
    v_mfma_f32_16x16x32_bf16 v[88:91], v[32:35], v[192:195], v[88:91]
    ds_read_b128 v[28:31], v1 offset:12288
    v_mfma_f32_16x16x32_bf16 v[88:91], v[36:39], v[196:199], v[88:91]
    v_cvt_pk_bf16_f32 v69, v18, v19
    v_mfma_f32_16x16x32_bf16 v[92:95], v[32:35], v[216:219], v[92:95]
    v_exp_f32 v18, v102
    v_mfma_f32_16x16x32_bf16 v[92:95], v[36:39], v[220:223], v[92:95]
    s_waitcnt lgkmcnt(2)
    v_add_f32 v6, v6, v16
    v_mfma_f32_16x16x32_bf16 v[112:115], v[40:43], a[208:211], v[112:115]
    ds_read_b128 v[32:35], v1 offset:1024
    v_add_f32 v6, v6, v17
    v_mfma_f32_16x16x32_bf16 v[112:115], v[44:47], a[212:215], v[112:115]
    v_exp_f32 v19, v103
    v_mfma_f32_16x16x32_bf16 v[116:119], v[40:43], a[232:235], v[116:119]
    v_mfma_f32_16x16x32_bf16 v[116:119], v[44:47], a[236:239], v[116:119]
    v_cvt_pk_bf16_f32 v70, v16, v17
    v_mfma_f32_16x16x32_bf16 v[120:123], v[40:43], v[192:195], v[120:123]
    ds_read_b128 v[36:39], v1 offset:13312
    v_add_f32 v6, v6, v18
    v_mfma_f32_16x16x32_bf16 v[120:123], v[44:47], v[196:199], v[120:123]
    s_add_u32 s32, s32, 24576
    s_add_u32 s26, s26, 36864
    v_add_f32 v6, v6, v19
    v_mfma_f32_16x16x32_bf16 v[124:127], v[40:43], v[216:219], v[124:127]
    s_sub_u32 s57, s26, 147456
    v_cvt_pk_bf16_f32 v71, v18, v19
    s_min_u32 s26, s26, s57
    v_mfma_f32_16x16x32_bf16 v[124:127], v[44:47], v[220:223], v[124:127]
    s_waitcnt lgkmcnt(2)
    v_mfma_f32_16x16x32_bf16 a[0:3], v[160:163], v[24:27], a[0:3]
    ds_read_b128 v[40:43], v1 offset:2048
    v_mfma_f32_16x16x32_bf16 a[0:3], v[176:179], v[28:31], a[0:3]
    s_waitcnt vmcnt(6)
    v_subrev_u32 v52, s92, v52
    v_cmp_lt_u32 vcc, 15, v52
    v_mfma_f32_16x16x32_bf16 a[48:51], v[164:167], v[24:27], a[48:51]
    v_exp_f32 v16, v72
    v_mfma_f32_16x16x32_bf16 a[48:51], v[180:183], v[28:31], a[48:51]
    v_exp_f32 v17, v73
    v_mfma_f32_16x16x32_bf16 a[96:99], v[168:171], v[24:27], a[96:99]
    s_and_b32 s59, vcc_lo, 0xff
    ds_read_b128 v[44:47], v1 offset:14336
    v_mfma_f32_16x16x32_bf16 a[96:99], v[184:187], v[28:31], a[96:99]
    s_cbranch_scc1 L_pollslow4
L_pollok4:
    v_mfma_f32_16x16x32_bf16 a[144:147], v[172:175], v[24:27], a[144:147]
    s_add_u32 s92, s92, 1
    v_exp_f32 v18, v74
    v_mfma_f32_16x16x32_bf16 a[144:147], v[188:191], v[28:31], a[144:147]
    s_waitcnt lgkmcnt(2)
    v_add_f32 v7, v7, v16
    v_add_f32 v7, v7, v17
    v_mfma_f32_16x16x32_bf16 a[4:7], v[160:163], v[32:35], a[4:7]
    ds_read_b128 v[24:27], v1 offset:3072
    v_mfma_f32_16x16x32_bf16 a[4:7], v[176:179], v[36:39], a[4:7]
    v_exp_f32 v19, v75
    v_mfma_f32_16x16x32_bf16 a[52:55], v[164:167], v[32:35], a[52:55]
    v_cvt_pk_bf16_f32 v72, v16, v17
    v_mfma_f32_16x16x32_bf16 a[52:55], v[180:183], v[36:39], a[52:55]
    v_exp_f32 v16, v104
    v_mfma_f32_16x16x32_bf16 a[100:103], v[168:171], v[32:35], a[100:103]
    ds_read_b128 v[28:31], v1 offset:15360
    v_add_f32 v7, v7, v18
    v_mfma_f32_16x16x32_bf16 a[100:103], v[184:187], v[36:39], a[100:103]
    s_waitcnt lgkmcnt(2)
    v_add_f32 v7, v7, v19
    v_mfma_f32_16x16x32_bf16 a[148:151], v[172:175], v[32:35], a[148:151]
    s_waitcnt vmcnt(0)
    v_exp_f32 v17, v105
    v_mfma_f32_16x16x32_bf16 a[148:151], v[188:191], v[36:39], a[148:151]
    s_barrier
    v_cvt_pk_bf16_f32 v73, v18, v19
    v_mfma_f32_16x16x32_bf16 a[8:11], v[160:163], v[40:43], a[8:11]
    s_mov_b32 m0, s56
    ds_read_b128 v[32:35], v1 offset:4096
    v_mfma_f32_16x16x32_bf16 a[8:11], v[176:179], v[44:47], a[8:11]
    buffer_load_dwordx4 v4, s[4:7], s27 offen offset:0 sc1 lds
    v_mfma_f32_16x16x32_bf16 a[56:59], v[164:167], v[40:43], a[56:59]
    v_exp_f32 v18, v106
    v_mfma_f32_16x16x32_bf16 a[56:59], v[180:183], v[44:47], a[56:59]
    v_add_f32 v7, v7, v16
    v_add_f32 v7, v7, v17
    v_mfma_f32_16x16x32_bf16 a[104:107], v[168:171], v[40:43], a[104:107]
    ds_read_b128 v[36:39], v1 offset:16384
    v_mfma_f32_16x16x32_bf16 a[104:107], v[184:187], v[44:47], a[104:107]
    buffer_load_dwordx4 v4, s[4:7], s27 offen offset:1024 sc1 lds
    v_mfma_f32_16x16x32_bf16 a[152:155], v[172:175], v[40:43], a[152:155]
    v_exp_f32 v19, v107
    v_mfma_f32_16x16x32_bf16 a[152:155], v[188:191], v[44:47], a[152:155]
    s_waitcnt lgkmcnt(2)
    v_cvt_pk_bf16_f32 v74, v16, v17
    v_mfma_f32_16x16x32_bf16 a[12:15], v[160:163], v[24:27], a[12:15]
    ds_read_b128 v[40:43], v1 offset:5120
    v_mfma_f32_16x16x32_bf16 a[12:15], v[176:179], v[28:31], a[12:15]
    buffer_load_dwordx4 v4, s[4:7], s27 offen offset:2048 sc1 lds
    v_mfma_f32_16x16x32_bf16 a[60:63], v[164:167], v[24:27], a[60:63]
    v_exp_f32 v16, v76
    v_mfma_f32_16x16x32_bf16 a[60:63], v[180:183], v[28:31], a[60:63]
    s_add_u32 s27, s27, 24576
    v_add_f32 v7, v7, v18
    v_add_f32 v7, v7, v19
    v_mfma_f32_16x16x32_bf16 a[108:111], v[168:171], v[24:27], a[108:111]
    ds_read_b128 v[44:47], v1 offset:17408
    v_mfma_f32_16x16x32_bf16 a[108:111], v[184:187], v[28:31], a[108:111]
    s_add_u32 s56, s56, 12288
    v_exp_f32 v17, v77
    v_mfma_f32_16x16x32_bf16 a[156:159], v[172:175], v[24:27], a[156:159]
    s_add_u32 s29, s28, 49152
    v_cvt_pk_bf16_f32 v75, v18, v19
    v_mfma_f32_16x16x32_bf16 a[156:159], v[188:191], v[28:31], a[156:159]
    s_waitcnt lgkmcnt(2)
    v_exp_f32 v18, v78
    v_mfma_f32_16x16x32_bf16 a[16:19], v[160:163], v[32:35], a[16:19]
    s_sub_u32 s3, s29, 147456
    ds_read_b128 v[24:27], v1 offset:6144
    v_add_f32 v8, v8, v16
    v_mfma_f32_16x16x32_bf16 a[16:19], v[176:179], v[36:39], a[16:19]
    s_mov_b32 m0, s56
    v_add_f32 v8, v8, v17
    s_min_u32 s29, s29, s3
    v_mfma_f32_16x16x32_bf16 a[64:67], v[164:167], v[32:35], a[64:67]
    v_exp_f32 v19, v79
    v_mfma_f32_16x16x32_bf16 a[64:67], v[180:183], v[36:39], a[64:67]
    buffer_load_dwordx4 v4, s[4:7], s27 offen offset:0 sc1 lds
    v_mfma_f32_16x16x32_bf16 a[112:115], v[168:171], v[32:35], a[112:115]
    ds_read_b128 v[28:31], v1 offset:18432
    v_cvt_pk_bf16_f32 v76, v16, v17
    v_mfma_f32_16x16x32_bf16 a[112:115], v[184:187], v[36:39], a[112:115]
    v_exp_f32 v16, v108
    v_mfma_f32_16x16x32_bf16 a[160:163], v[172:175], v[32:35], a[160:163]
    v_add_f32 v8, v8, v18
    v_add_f32 v8, v8, v19
    v_mfma_f32_16x16x32_bf16 a[160:163], v[188:191], v[36:39], a[160:163]
    s_waitcnt lgkmcnt(2)
    buffer_load_dwordx4 v4, s[4:7], s27 offen offset:1024 sc1 lds
    v_mfma_f32_16x16x32_bf16 a[20:23], v[160:163], v[40:43], a[20:23]
    s_sub_u32 s3, s29, s28
    ds_read_b128 v[32:35], v1 offset:7168
    v_mfma_f32_16x16x32_bf16 a[20:23], v[176:179], v[44:47], a[20:23]
L_pg10:
    s_cbranch_execz L_iwret
    v_exp_f32 v17, v109
    v_mfma_f32_16x16x32_bf16 a[68:71], v[164:167], v[40:43], a[68:71]
    v_cvt_pk_bf16_f32 v77, v18, v19
    v_mfma_f32_16x16x32_bf16 a[68:71], v[180:183], v[44:47], a[68:71]
    buffer_load_dwordx4 v4, s[4:7], s27 offen offset:2048 sc1 lds
    v_mfma_f32_16x16x32_bf16 a[116:119], v[168:171], v[40:43], a[116:119]
    ds_read_b128 v[36:39], v1 offset:19456
    v_mfma_f32_16x16x32_bf16 a[116:119], v[184:187], v[44:47], a[116:119]
    v_exp_f32 v18, v110
    v_mfma_f32_16x16x32_bf16 a[164:167], v[172:175], v[40:43], a[164:167]
    s_add_u32 s27, s27, 24576
    v_add_f32 v8, v8, v16
    v_add_f32 v8, v8, v17
    v_mfma_f32_16x16x32_bf16 a[164:167], v[188:191], v[44:47], a[164:167]
    s_waitcnt lgkmcnt(2)
    v_exp_f32 v19, v111
    v_mfma_f32_16x16x32_bf16 a[24:27], v[160:163], v[24:27], a[24:27]
    s_add_u32 s56, s56, 36864
    ds_read_b128 v[40:43], v1 offset:8192
    v_cvt_pk_bf16_f32 v78, v16, v17
    v_mfma_f32_16x16x32_bf16 a[24:27], v[176:179], v[28:31], a[24:27]
    s_mov_b32 s28, s29
    v_add_f32 v8, v8, v18
    v_add_f32 v8, v8, v19
    v_mfma_f32_16x16x32_bf16 a[72:75], v[164:167], v[24:27], a[72:75]
    s_sub_u32 s58, s56, 147456
    v_cvt_pk_bf16_f32 v79, v18, v19
    v_mfma_f32_16x16x32_bf16 a[72:75], v[180:183], v[28:31], a[72:75]
    v_exp_f32 v16, v80
    v_mfma_f32_16x16x32_bf16 a[120:123], v[168:171], v[24:27], a[120:123]
    s_min_u32 s56, s56, s58
    ds_read_b128 v[44:47], v1 offset:20480
    v_mfma_f32_16x16x32_bf16 a[120:123], v[184:187], v[28:31], a[120:123]
    v_exp_f32 v17, v81
    v_mfma_f32_16x16x32_bf16 a[168:171], v[172:175], v[24:27], a[168:171]
    s_mov_b32 m0, s26
    v_exp_f32 v18, v82
    v_mfma_f32_16x16x32_bf16 a[168:171], v[188:191], v[28:31], a[168:171]
    s_waitcnt lgkmcnt(2)
    v_add_f32 v5, v5, v16
    v_add_f32 v5, v5, v17
    v_mfma_f32_16x16x32_bf16 a[28:31], v[160:163], v[32:35], a[28:31]
    ds_read_b128 v[24:27], v1 offset:9216
    v_add_u32 v2, s3, v2
    v_mfma_f32_16x16x32_bf16 a[28:31], v[176:179], v[36:39], a[28:31]
    buffer_load_dwordx4 v4, s[4:7], s32 offen offset:0 sc1 lds
    v_mfma_f32_16x16x32_bf16 a[76:79], v[164:167], v[32:35], a[76:79]
    v_exp_f32 v19, v83
    v_mfma_f32_16x16x32_bf16 a[76:79], v[180:183], v[36:39], a[76:79]
    v_cvt_pk_bf16_f32 v80, v16, v17
    v_mfma_f32_16x16x32_bf16 a[124:127], v[168:171], v[32:35], a[124:127]
    ds_read_b128 v[28:31], v1 offset:21504
    v_add_u32 v3, s3, v3
    v_mfma_f32_16x16x32_bf16 a[124:127], v[184:187], v[36:39], a[124:127]
    buffer_load_dwordx4 v4, s[4:7], s32 offen offset:1024 sc1 lds
    v_mfma_f32_16x16x32_bf16 a[172:175], v[172:175], v[32:35], a[172:175]
    v_exp_f32 v16, v112
    v_mfma_f32_16x16x32_bf16 a[172:175], v[188:191], v[36:39], a[172:175]
    s_waitcnt lgkmcnt(2)
    v_add_f32 v5, v5, v18
    v_add_f32 v5, v5, v19
    v_mfma_f32_16x16x32_bf16 a[32:35], v[160:163], v[40:43], a[32:35]
    ds_read_b128 v[32:35], v1 offset:10240
    v_mfma_f32_16x16x32_bf16 a[32:35], v[176:179], v[44:47], a[32:35]
    buffer_load_dwordx4 v4, s[4:7], s32 offen offset:2048 sc1 lds
    v_mfma_f32_16x16x32_bf16 a[80:83], v[164:167], v[40:43], a[80:83]
    v_exp_f32 v17, v113
    v_mfma_f32_16x16x32_bf16 a[80:83], v[180:183], v[44:47], a[80:83]
    v_cvt_pk_bf16_f32 v81, v18, v19
    v_mfma_f32_16x16x32_bf16 a[128:131], v[168:171], v[40:43], a[128:131]
    ds_read_b128 v[36:39], v1 offset:22528
    v_mfma_f32_16x16x32_bf16 a[128:131], v[184:187], v[44:47], a[128:131]
    s_add_u32 s32, s32, 24576
    v_exp_f32 v18, v114
    v_mfma_f32_16x16x32_bf16 a[176:179], v[172:175], v[40:43], a[176:179]
    v_add_f32 v5, v5, v16
    v_add_f32 v5, v5, v17
    v_mfma_f32_16x16x32_bf16 a[176:179], v[188:191], v[44:47], a[176:179]
    s_waitcnt lgkmcnt(2)
    v_exp_f32 v19, v115
    v_mfma_f32_16x16x32_bf16 a[36:39], v[160:163], v[24:27], a[36:39]
    s_add_u32 s26, s26, 12288
    ds_read_b128 v[40:43], v1 offset:11264
    v_cvt_pk_bf16_f32 v82, v16, v17
    v_mfma_f32_16x16x32_bf16 a[36:39], v[176:179], v[28:31], a[36:39]
    s_mov_b32 m0, s26
    v_exp_f32 v16, v84
    v_mfma_f32_16x16x32_bf16 a[84:87], v[164:167], v[24:27], a[84:87]
    v_add_f32 v5, v5, v18
    v_add_f32 v5, v5, v19
    v_mfma_f32_16x16x32_bf16 a[84:87], v[180:183], v[28:31], a[84:87]
    v_exp_f32 v17, v85
    v_mfma_f32_16x16x32_bf16 a[132:135], v[168:171], v[24:27], a[132:135]
    ds_read_b128 v[44:47], v1 offset:23552
    v_cvt_pk_bf16_f32 v83, v18, v19
    v_mfma_f32_16x16x32_bf16 a[132:135], v[184:187], v[28:31], a[132:135]
    buffer_load_dwordx4 v4, s[4:7], s32 offen offset:0 sc1 lds
    v_mfma_f32_16x16x32_bf16 a[180:183], v[172:175], v[24:27], a[180:183]
    v_exp_f32 v18, v86
    v_mfma_f32_16x16x32_bf16 a[180:183], v[188:191], v[28:31], a[180:183]
    s_waitcnt lgkmcnt(2)
    v_add_f32 v6, v6, v16
    v_add_f32 v6, v6, v17
    v_mfma_f32_16x16x32_bf16 a[40:43], v[160:163], v[32:35], a[40:43]
    ds_read_b128 v[24:27], v2 offset:0
    v_mfma_f32_16x16x32_bf16 a[40:43], v[176:179], v[36:39], a[40:43]
    buffer_load_dwordx4 v4, s[4:7], s32 offen offset:1024 sc1 lds
    v_mfma_f32_16x16x32_bf16 a[88:91], v[164:167], v[32:35], a[88:91]
    v_exp_f32 v19, v87
    v_mfma_f32_16x16x32_bf16 a[88:91], v[180:183], v[36:39], a[88:91]
    v_cvt_pk_bf16_f32 v84, v16, v17
    v_mfma_f32_16x16x32_bf16 a[136:139], v[168:171], v[32:35], a[136:139]
    ds_read_b128 v[28:31], v3 offset:0
    v_mfma_f32_16x16x32_bf16 a[136:139], v[184:187], v[36:39], a[136:139]
    buffer_load_dwordx4 v4, s[4:7], s32 offen offset:2048 sc1 lds
    v_mfma_f32_16x16x32_bf16 a[184:187], v[172:175], v[32:35], a[184:187]
    v_exp_f32 v16, v116
    v_mfma_f32_16x16x32_bf16 a[184:187], v[188:191], v[36:39], a[184:187]
    s_waitcnt lgkmcnt(2)
    v_add_f32 v6, v6, v18
    v_add_f32 v6, v6, v19
    v_mfma_f32_16x16x32_bf16 a[44:47], v[160:163], v[40:43], a[44:47]
    ds_read_b128 v[32:35], v2 offset:6144
    v_mfma_f32_16x16x32_bf16 a[44:47], v[176:179], v[44:47], a[44:47]
    v_exp_f32 v17, v117
    v_mfma_f32_16x16x32_bf16 a[92:95], v[164:167], v[40:43], a[92:95]
    v_cvt_pk_bf16_f32 v85, v18, v19
    v_mfma_f32_16x16x32_bf16 a[92:95], v[180:183], v[44:47], a[92:95]
    s_add_u32 s32, s32, 24576
    v_exp_f32 v18, v118
    v_mfma_f32_16x16x32_bf16 a[140:143], v[168:171], v[40:43], a[140:143]
    s_add_u32 s26, s26, 36864
    ds_read_b128 v[36:39], v3 offset:6144
    v_add_f32 v6, v6, v16
    v_mfma_f32_16x16x32_bf16 a[140:143], v[184:187], v[44:47], a[140:143]
    s_sub_u32 s57, s26, 147456
    v_add_f32 v6, v6, v17
    s_min_u32 s26, s26, s57
    v_mfma_f32_16x16x32_bf16 a[188:191], v[172:175], v[40:43], a[188:191]
    v_exp_f32 v19, v119
    v_mfma_f32_16x16x32_bf16 a[188:191], v[188:191], v[44:47], a[188:191]
    s_waitcnt lgkmcnt(2)
    v_cvt_pk_bf16_f32 v86, v16, v17
    v_add_f32 v6, v6, v18
    v_add_f32 v6, v6, v19
    v_cvt_pk_bf16_f32 v87, v18, v19
    v_mfma_f32_16x16x32_bf16 v[160:163], v[24:27], a[192:195], v[128:131]
    ds_read_b128 v[40:43], v2 offset:128
    v_mfma_f32_16x16x32_bf16 v[160:163], v[28:31], a[196:199], v[160:163]
    v_exp_f32 v16, v88
    v_mfma_f32_16x16x32_bf16 v[164:167], v[24:27], a[216:219], v[132:135]
    ds_read_b128 v[44:47], v3 offset:128
    v_mfma_f32_16x16x32_bf16 v[164:167], v[28:31], a[220:223], v[164:167]
    s_waitcnt lgkmcnt(2)
    v_exp_f32 v17, v89
    v_mfma_f32_16x16x32_bf16 v[96:99], v[32:35], a[192:195], v[128:131]
    ds_read_b128 v[24:27], v2 offset:6272
    v_mfma_f32_16x16x32_bf16 v[96:99], v[36:39], a[196:199], v[96:99]
    v_exp_f32 v18, v90
    v_mfma_f32_16x16x32_bf16 v[100:103], v[32:35], a[216:219], v[132:135]
    ds_read_b128 v[28:31], v3 offset:6272
    v_add_f32 v7, v7, v16
    v_mfma_f32_16x16x32_bf16 v[100:103], v[36:39], a[220:223], v[100:103]
    s_waitcnt lgkmcnt(2)
    v_add_f32 v7, v7, v17
    v_mfma_f32_16x16x32_bf16 v[160:163], v[40:43], a[200:203], v[160:163]
    ds_read_b128 v[32:35], v2 offset:256
    v_mfma_f32_16x16x32_bf16 v[160:163], v[44:47], a[204:207], v[160:163]
    v_exp_f32 v19, v91
    v_mfma_f32_16x16x32_bf16 v[164:167], v[40:43], a[224:227], v[164:167]
    ds_read_b128 v[36:39], v3 offset:256
    v_cvt_pk_bf16_f32 v88, v16, v17
    v_mfma_f32_16x16x32_bf16 v[164:167], v[44:47], a[228:231], v[164:167]
    s_waitcnt lgkmcnt(2)
    v_exp_f32 v16, v120
    v_mfma_f32_16x16x32_bf16 v[96:99], v[24:27], a[200:203], v[96:99]
    ds_read_b128 v[40:43], v2 offset:6400
    v_add_f32 v7, v7, v18
    v_mfma_f32_16x16x32_bf16 v[96:99], v[28:31], a[204:207], v[96:99]
    v_add_f32 v7, v7, v19
    v_mfma_f32_16x16x32_bf16 v[100:103], v[24:27], a[224:227], v[100:103]
    ds_read_b128 v[44:47], v3 offset:6400
    v_mfma_f32_16x16x32_bf16 v[100:103], v[28:31], a[228:231], v[100:103]
    s_waitcnt lgkmcnt(2)
    v_exp_f32 v17, v121
    v_mfma_f32_16x16x32_bf16 v[160:163], v[32:35], a[208:211], v[160:163]
    ds_read_b128 v[24:27], v2 offset:12288
    v_cvt_pk_bf16_f32 v89, v18, v19
    v_mfma_f32_16x16x32_bf16 v[160:163], v[36:39], a[212:215], v[160:163]
    v_exp_f32 v18, v122
    v_mfma_f32_16x16x32_bf16 v[164:167], v[32:35], a[232:235], v[164:167]
    ds_read_b128 v[28:31], v3 offset:12288
    v_add_f32 v7, v7, v16
    v_mfma_f32_16x16x32_bf16 v[164:167], v[36:39], a[236:239], v[164:167]
    s_waitcnt lgkmcnt(2)
    v_add_f32 v7, v7, v17
    v_mfma_f32_16x16x32_bf16 v[96:99], v[40:43], a[208:211], v[96:99]
    ds_read_b128 v[32:35], v2 offset:18432
    v_mfma_f32_16x16x32_bf16 v[96:99], v[44:47], a[212:215], v[96:99]
    v_exp_f32 v19, v123
    v_mfma_f32_16x16x32_bf16 v[100:103], v[40:43], a[232:235], v[100:103]
    ds_read_b128 v[36:39], v3 offset:18432
    v_cvt_pk_bf16_f32 v90, v16, v17
    v_mfma_f32_16x16x32_bf16 v[100:103], v[44:47], a[236:239], v[100:103]
    s_waitcnt lgkmcnt(2)
    v_exp_f32 v16, v92
    v_mfma_f32_16x16x32_bf16 v[168:171], v[24:27], a[192:195], v[128:131]
    ds_read_b128 v[40:43], v2 offset:12416
    v_add_f32 v7, v7, v18
    v_mfma_f32_16x16x32_bf16 v[168:171], v[28:31], a[196:199], v[168:171]
    v_add_f32 v7, v7, v19
    v_mfma_f32_16x16x32_bf16 v[172:175], v[24:27], a[216:219], v[132:135]
    ds_read_b128 v[44:47], v3 offset:12416
    v_mfma_f32_16x16x32_bf16 v[172:175], v[28:31], a[220:223], v[172:175]
    s_waitcnt lgkmcnt(2)
    v_exp_f32 v17, v93
    v_mfma_f32_16x16x32_bf16 v[104:107], v[32:35], a[192:195], v[128:131]
    ds_read_b128 v[24:27], v2 offset:18560
    v_cvt_pk_bf16_f32 v91, v18, v19
    v_mfma_f32_16x16x32_bf16 v[104:107], v[36:39], a[196:199], v[104:107]
    v_exp_f32 v18, v94
    v_mfma_f32_16x16x32_bf16 v[108:111], v[32:35], a[216:219], v[132:135]
    s_add_u32 s29, s30, 49152
    ds_read_b128 v[28:31], v3 offset:18560
    v_add_f32 v8, v8, v16
    v_mfma_f32_16x16x32_bf16 v[108:111], v[36:39], a[220:223], v[108:111]
    s_waitcnt lgkmcnt(2)
    v_add_f32 v8, v8, v17
    s_sub_u32 s3, s29, 147456
    v_mfma_f32_16x16x32_bf16 v[168:171], v[40:43], a[200:203], v[168:171]
    ds_read_b128 v[32:35], v2 offset:12544
    v_mfma_f32_16x16x32_bf16 v[168:171], v[44:47], a[204:207], v[168:171]
    s_min_u32 s29, s29, s3
    v_exp_f32 v19, v95
    v_mfma_f32_16x16x32_bf16 v[172:175], v[40:43], a[224:227], v[172:175]
    ds_read_b128 v[36:39], v3 offset:12544
    v_cvt_pk_bf16_f32 v92, v16, v17
    v_mfma_f32_16x16x32_bf16 v[172:175], v[44:47], a[228:231], v[172:175]
    s_waitcnt lgkmcnt(2)
    v_exp_f32 v16, v124
    v_mfma_f32_16x16x32_bf16 v[104:107], v[24:27], a[200:203], v[104:107]
    ds_read_b128 v[40:43], v2 offset:18688
    v_add_f32 v8, v8, v18
    v_mfma_f32_16x16x32_bf16 v[104:107], v[28:31], a[204:207], v[104:107]
    v_add_f32 v8, v8, v19
    v_mfma_f32_16x16x32_bf16 v[108:111], v[24:27], a[224:227], v[108:111]
    ds_read_b128 v[44:47], v3 offset:18688
    v_mfma_f32_16x16x32_bf16 v[108:111], v[28:31], a[228:231], v[108:111]
    s_waitcnt lgkmcnt(2)
    v_subrev_u32 v2, 98304, v2
    v_subrev_u32 v3, 98304, v3
    v_mfma_f32_16x16x32_bf16 v[168:171], v[32:35], a[208:211], v[168:171]
    ds_read_b128 v[24:27], v2 offset:0
    v_mfma_f32_16x16x32_bf16 v[168:171], v[36:39], a[212:215], v[168:171]
    s_sub_u32 s3, s29, s30
    v_exp_f32 v17, v125
    v_mfma_f32_16x16x32_bf16 v[172:175], v[32:35], a[232:235], v[172:175]
    ds_read_b128 v[28:31], v3 offset:0
    v_cvt_pk_bf16_f32 v93, v18, v19
    v_mfma_f32_16x16x32_bf16 v[172:175], v[36:39], a[236:239], v[172:175]
    s_waitcnt lgkmcnt(2)
    v_exp_f32 v18, v126
    v_mfma_f32_16x16x32_bf16 v[104:107], v[40:43], a[208:211], v[104:107]
    ds_read_b128 v[32:35], v2 offset:6144
    v_add_f32 v8, v8, v16
    v_mfma_f32_16x16x32_bf16 v[104:107], v[44:47], a[212:215], v[104:107]
    v_add_f32 v8, v8, v17
    v_mfma_f32_16x16x32_bf16 v[108:111], v[40:43], a[232:235], v[108:111]
    ds_read_b128 v[36:39], v3 offset:6144
    v_mfma_f32_16x16x32_bf16 v[108:111], v[44:47], a[236:239], v[108:111]
    s_waitcnt lgkmcnt(2)
    v_exp_f32 v19, v127
    v_mfma_f32_16x16x32_bf16 v[176:179], v[24:27], a[192:195], v[128:131]
    ds_read_b128 v[40:43], v2 offset:128
    v_cvt_pk_bf16_f32 v94, v16, v17
    v_mfma_f32_16x16x32_bf16 v[176:179], v[28:31], a[196:199], v[176:179]
    s_mov_b32 s30, s29
    v_add_f32 v8, v8, v18
    v_add_f32 v8, v8, v19
    v_mfma_f32_16x16x32_bf16 v[180:183], v[24:27], a[216:219], v[132:135]
    ds_read_b128 v[44:47], v3 offset:128
    v_cvt_pk_bf16_f32 v95, v18, v19
    v_mfma_f32_16x16x32_bf16 v[180:183], v[28:31], a[220:223], v[180:183]
    s_waitcnt lgkmcnt(2)
    v_exp_f32 v16, v160
    v_mfma_f32_16x16x32_bf16 v[112:115], v[32:35], a[192:195], v[128:131]
    ds_read_b128 v[24:27], v2 offset:6272
    v_mfma_f32_16x16x32_bf16 v[112:115], v[36:39], a[196:199], v[112:115]
    v_exp_f32 v17, v161
    v_mfma_f32_16x16x32_bf16 v[116:119], v[32:35], a[216:219], v[132:135]
    ds_read_b128 v[28:31], v3 offset:6272
    v_mfma_f32_16x16x32_bf16 v[116:119], v[36:39], a[220:223], v[116:119]
    s_waitcnt lgkmcnt(2)
    v_exp_f32 v18, v162
    v_mfma_f32_16x16x32_bf16 v[176:179], v[40:43], a[200:203], v[176:179]
    ds_read_b128 v[32:35], v2 offset:256
    v_add_f32 v5, v5, v16
    v_mfma_f32_16x16x32_bf16 v[176:179], v[44:47], a[204:207], v[176:179]
    v_add_f32 v5, v5, v17
    v_add_u32 v1, s3, v1
    v_mfma_f32_16x16x32_bf16 v[180:183], v[40:43], a[224:227], v[180:183]
    ds_read_b128 v[36:39], v3 offset:256
    v_mfma_f32_16x16x32_bf16 v[180:183], v[44:47], a[228:231], v[180:183]
    s_waitcnt lgkmcnt(2)
    v_exp_f32 v19, v163
    v_mfma_f32_16x16x32_bf16 v[112:115], v[24:27], a[200:203], v[112:115]
    ds_read_b128 v[40:43], v2 offset:6400
    v_cvt_pk_bf16_f32 v160, v16, v17
    v_mfma_f32_16x16x32_bf16 v[112:115], v[28:31], a[204:207], v[112:115]
    v_exp_f32 v16, v96
    v_mfma_f32_16x16x32_bf16 v[116:119], v[24:27], a[224:227], v[116:119]
    ds_read_b128 v[44:47], v3 offset:6400
    v_add_f32 v5, v5, v18
    v_mfma_f32_16x16x32_bf16 v[116:119], v[28:31], a[228:231], v[116:119]
    s_waitcnt lgkmcnt(2)
    v_add_f32 v5, v5, v19
    v_mfma_f32_16x16x32_bf16 v[176:179], v[32:35], a[208:211], v[176:179]
    ds_read_b128 v[24:27], v2 offset:12288
    v_mfma_f32_16x16x32_bf16 v[176:179], v[36:39], a[212:215], v[176:179]
    v_exp_f32 v17, v97
    v_mfma_f32_16x16x32_bf16 v[180:183], v[32:35], a[232:235], v[180:183]
    ds_read_b128 v[28:31], v3 offset:12288
    v_cvt_pk_bf16_f32 v161, v18, v19
    v_mfma_f32_16x16x32_bf16 v[180:183], v[36:39], a[236:239], v[180:183]
    s_waitcnt lgkmcnt(2)
    v_exp_f32 v18, v98
    v_mfma_f32_16x16x32_bf16 v[112:115], v[40:43], a[208:211], v[112:115]
    ds_read_b128 v[32:35], v2 offset:18432
    v_add_f32 v5, v5, v16
    v_mfma_f32_16x16x32_bf16 v[112:115], v[44:47], a[212:215], v[112:115]
    v_add_f32 v5, v5, v17
    v_mfma_f32_16x16x32_bf16 v[116:119], v[40:43], a[232:235], v[116:119]
    ds_read_b128 v[36:39], v3 offset:18432
    v_mfma_f32_16x16x32_bf16 v[116:119], v[44:47], a[236:239], v[116:119]
    s_waitcnt lgkmcnt(2)
    v_exp_f32 v19, v99
    v_mfma_f32_16x16x32_bf16 v[184:187], v[24:27], a[192:195], v[128:131]
    ds_read_b128 v[40:43], v2 offset:12416
    v_cvt_pk_bf16_f32 v162, v16, v17
    v_mfma_f32_16x16x32_bf16 v[184:187], v[28:31], a[196:199], v[184:187]
    v_exp_f32 v16, v164
    v_mfma_f32_16x16x32_bf16 v[188:191], v[24:27], a[216:219], v[132:135]
    ds_read_b128 v[44:47], v3 offset:12416
    v_add_f32 v5, v5, v18
    v_mfma_f32_16x16x32_bf16 v[188:191], v[28:31], a[220:223], v[188:191]
    s_waitcnt lgkmcnt(2)
    v_add_f32 v5, v5, v19
    v_mfma_f32_16x16x32_bf16 v[120:123], v[32:35], a[192:195], v[128:131]
    ds_read_b128 v[24:27], v2 offset:18560
    v_mfma_f32_16x16x32_bf16 v[120:123], v[36:39], a[196:199], v[120:123]
    s_waitcnt vmcnt(6)
    v_exp_f32 v17, v165
    v_mfma_f32_16x16x32_bf16 v[124:127], v[32:35], a[216:219], v[132:135]
    ds_read_b128 v[28:31], v3 offset:18560
    v_cvt_pk_bf16_f32 v163, v18, v19
    v_mfma_f32_16x16x32_bf16 v[124:127], v[36:39], a[220:223], v[124:127]
    s_waitcnt lgkmcnt(2)
    s_barrier
    v_mfma_f32_16x16x32_bf16 v[184:187], v[40:43], a[200:203], v[184:187]
    ds_read_b128 v[32:35], v2 offset:12544
    v_mfma_f32_16x16x32_bf16 v[184:187], v[44:47], a[204:207], v[184:187]
    v_exp_f32 v18, v166
    v_mfma_f32_16x16x32_bf16 v[188:191], v[40:43], a[224:227], v[188:191]
    ds_read_b128 v[36:39], v3 offset:12544
    v_add_f32 v6, v6, v16
    v_mfma_f32_16x16x32_bf16 v[188:191], v[44:47], a[228:231], v[188:191]
    s_waitcnt lgkmcnt(2)
    v_add_f32 v6, v6, v17
    v_mfma_f32_16x16x32_bf16 v[120:123], v[24:27], a[200:203], v[120:123]
    ds_read_b128 v[40:43], v2 offset:18688
    v_mfma_f32_16x16x32_bf16 v[120:123], v[28:31], a[204:207], v[120:123]
    v_exp_f32 v19, v167
    v_cvt_pk_bf16_f32 v164, v16, v17
    v_mfma_f32_16x16x32_bf16 v[124:127], v[24:27], a[224:227], v[124:127]
    ds_read_b128 v[44:47], v3 offset:18688
    v_mfma_f32_16x16x32_bf16 v[124:127], v[28:31], a[228:231], v[124:127]
    s_waitcnt lgkmcnt(2)
    v_exp_f32 v16, v100
    v_mfma_f32_16x16x32_bf16 v[184:187], v[32:35], a[208:211], v[184:187]
    ds_read_b128 v[24:27], v1 offset:0
    v_add_f32 v6, v6, v18
    v_mfma_f32_16x16x32_bf16 v[184:187], v[36:39], a[212:215], v[184:187]
    v_add_f32 v6, v6, v19
    v_mfma_f32_16x16x32_bf16 v[188:191], v[32:35], a[232:235], v[188:191]
    ds_read_b128 v[28:31], v1 offset:12288
    v_mfma_f32_16x16x32_bf16 v[188:191], v[36:39], a[236:239], v[188:191]
    s_waitcnt lgkmcnt(2)
    v_exp_f32 v17, v101
    v_cvt_pk_bf16_f32 v165, v18, v19
    v_mfma_f32_16x16x32_bf16 v[120:123], v[40:43], a[208:211], v[120:123]
    ds_read_b128 v[32:35], v1 offset:1024
    v_mfma_f32_16x16x32_bf16 v[120:123], v[44:47], a[212:215], v[120:123]
    v_exp_f32 v18, v102
    v_mfma_f32_16x16x32_bf16 v[124:127], v[40:43], a[232:235], v[124:127]
    ds_read_b128 v[36:39], v1 offset:13312
    v_add_f32 v6, v6, v16
    v_mfma_f32_16x16x32_bf16 v[124:127], v[44:47], a[236:239], v[124:127]
    s_waitcnt lgkmcnt(2)
    v_add_f32 v6, v6, v17
    v_exp_f32 v19, v103
    v_cvt_pk_bf16_f32 v166, v16, v17
    v_add_f32 v6, v6, v18
    v_add_f32 v6, v6, v19
    v_cvt_pk_bf16_f32 v167, v18, v19
    v_mfma_f32_16x16x32_bf16 a[0:3], v[64:67], v[24:27], a[0:3]
    s_mov_b32 m0, s56
    ds_read_b128 v[40:43], v1 offset:2048
    v_bfe_u32 v57, v4, 8, 2
    v_mfma_f32_16x16x32_bf16 a[0:3], v[80:83], v[28:31], a[0:3]
    buffer_load_dwordx4 v4, s[4:7], s27 offen offset:0 sc1 lds
    v_mfma_f32_16x16x32_bf16 a[48:51], v[68:71], v[24:27], a[48:51]
    v_exp_f32 v16, v168
    v_mfma_f32_16x16x32_bf16 a[48:51], v[84:87], v[28:31], a[48:51]
    v_exp_f32 v17, v169
    v_mfma_f32_16x16x32_bf16 a[96:99], v[72:75], v[24:27], a[96:99]
    ds_read_b128 v[44:47], v1 offset:14336
    v_mul_u32_u24 v56, 1536, v57
    v_mfma_f32_16x16x32_bf16 a[96:99], v[88:91], v[28:31], a[96:99]
    buffer_load_dwordx4 v4, s[4:7], s27 offen offset:1024 sc1 lds
    v_mfma_f32_16x16x32_bf16 a[144:147], v[76:79], v[24:27], a[144:147]
    v_exp_f32 v18, v170
    v_mfma_f32_16x16x32_bf16 a[144:147], v[92:95], v[28:31], a[144:147]
    s_waitcnt lgkmcnt(2)
    v_add_f32 v5, v5, v16
    v_add_f32 v5, v5, v17
    v_mfma_f32_16x16x32_bf16 a[4:7], v[64:67], v[32:35], a[4:7]
    ds_read_b128 v[24:27], v1 offset:3072
    v_lshlrev_b32 v58, 4, v57
    v_mfma_f32_16x16x32_bf16 a[4:7], v[80:83], v[36:39], a[4:7]
    buffer_load_dwordx4 v4, s[4:7], s27 offen offset:2048 sc1 lds
    v_mfma_f32_16x16x32_bf16 a[52:55], v[68:71], v[32:35], a[52:55]
    v_exp_f32 v19, v171
    v_mfma_f32_16x16x32_bf16 a[52:55], v[84:87], v[36:39], a[52:55]
    s_add_u32 s27, s27, 24576
    v_cvt_pk_bf16_f32 v168, v16, v17
    v_bfe_u32 v57, v4, 4, 4
    v_mfma_f32_16x16x32_bf16 a[100:103], v[72:75], v[32:35], a[100:103]
    ds_read_b128 v[28:31], v1 offset:15360
    v_mfma_f32_16x16x32_bf16 a[100:103], v[88:91], v[36:39], a[100:103]
    s_add_u32 s56, s56, 12288
    v_exp_f32 v16, v104
    v_mfma_f32_16x16x32_bf16 a[148:151], v[76:79], v[32:35], a[148:151]
    v_add_f32 v5, v5, v18
    v_add_f32 v5, v5, v19
    v_mfma_f32_16x16x32_bf16 a[148:151], v[92:95], v[36:39], a[148:151]
    s_waitcnt lgkmcnt(2)
    v_exp_f32 v17, v105
    v_mfma_f32_16x16x32_bf16 a[8:11], v[64:67], v[40:43], a[8:11]
    s_mov_b32 m0, s56
    ds_read_b128 v[32:35], v1 offset:4096
    v_cvt_pk_bf16_f32 v169, v18, v19
    v_mfma_f32_16x16x32_bf16 a[8:11], v[80:83], v[44:47], a[8:11]
    v_exp_f32 v18, v106
    v_mfma_f32_16x16x32_bf16 a[56:59], v[68:71], v[40:43], a[56:59]
    v_add_f32 v5, v5, v16
    v_add_f32 v5, v5, v17
    v_mfma_f32_16x16x32_bf16 a[56:59], v[84:87], v[44:47], a[56:59]
    buffer_load_dwordx4 v4, s[4:7], s27 offen offset:0 sc1 lds
    v_mfma_f32_16x16x32_bf16 a[104:107], v[72:75], v[40:43], a[104:107]
    ds_read_b128 v[36:39], v1 offset:16384
    v_mul_u32_u24 v57, 12, v57
    v_mfma_f32_16x16x32_bf16 a[104:107], v[88:91], v[44:47], a[104:107]
    v_exp_f32 v19, v107
    v_mfma_f32_16x16x32_bf16 a[152:155], v[76:79], v[40:43], a[152:155]
    v_cvt_pk_bf16_f32 v170, v16, v17
    v_add_u32 v56, v56, v57
    v_mfma_f32_16x16x32_bf16 a[152:155], v[92:95], v[44:47], a[152:155]
    s_waitcnt lgkmcnt(2)
    buffer_load_dwordx4 v4, s[4:7], s27 offen offset:1024 sc1 lds
    v_mfma_f32_16x16x32_bf16 a[12:15], v[64:67], v[24:27], a[12:15]
    ds_read_b128 v[40:43], v1 offset:5120
    v_mfma_f32_16x16x32_bf16 a[12:15], v[80:83], v[28:31], a[12:15]
    v_exp_f32 v16, v172
    v_mfma_f32_16x16x32_bf16 a[60:63], v[68:71], v[24:27], a[60:63]
    v_add_f32 v5, v5, v18
    v_add_f32 v5, v5, v19
    v_mfma_f32_16x16x32_bf16 a[60:63], v[84:87], v[28:31], a[60:63]
    buffer_load_dwordx4 v4, s[4:7], s27 offen offset:2048 sc1 lds
    v_mfma_f32_16x16x32_bf16 a[108:111], v[72:75], v[24:27], a[108:111]
    ds_read_b128 v[44:47], v1 offset:17408
    v_mov_b32 v57, 1.0
    v_mfma_f32_16x16x32_bf16 a[108:111], v[88:91], v[28:31], a[108:111]
    v_exp_f32 v17, v173
    v_mfma_f32_16x16x32_bf16 a[156:159], v[76:79], v[24:27], a[156:159]
    s_add_u32 s27, s27, 24576
    v_cvt_pk_bf16_f32 v171, v18, v19
    v_mfma_f32_16x16x32_bf16 a[156:159], v[92:95], v[28:31], a[156:159]
    s_waitcnt lgkmcnt(2)
    v_exp_f32 v18, v174
    v_mfma_f32_16x16x32_bf16 a[16:19], v[64:67], v[32:35], a[16:19]
    s_add_u32 s56, s56, 36864
    ds_read_b128 v[24:27], v1 offset:6144
    v_add_f32 v6, v6, v16
    v_mfma_f32_16x16x32_bf16 a[16:19], v[80:83], v[36:39], a[16:19]
    v_add_f32 v6, v6, v17
    v_mov_b32 v20, 0x3f803f80
    v_mfma_f32_16x16x32_bf16 a[64:67], v[68:71], v[32:35], a[64:67]
    s_sub_u32 s58, s56, 147456
    v_exp_f32 v19, v175
    v_mfma_f32_16x16x32_bf16 a[64:67], v[84:87], v[36:39], a[64:67]
    v_cvt_pk_bf16_f32 v172, v16, v17
    v_mfma_f32_16x16x32_bf16 a[112:115], v[72:75], v[32:35], a[112:115]
    s_min_u32 s56, s56, s58
    ds_read_b128 v[28:31], v1 offset:18432
    v_mov_b32 v21, 0x3f803f80
    v_mfma_f32_16x16x32_bf16 a[112:115], v[88:91], v[36:39], a[112:115]
    v_exp_f32 v16, v108
    v_mfma_f32_16x16x32_bf16 a[160:163], v[76:79], v[32:35], a[160:163]
    s_mov_b32 m0, s56
    v_add_f32 v6, v6, v18
    v_add_f32 v6, v6, v19
    v_mfma_f32_16x16x32_bf16 a[160:163], v[92:95], v[36:39], a[160:163]
    s_waitcnt lgkmcnt(2)
    v_exp_f32 v17, v109
    v_mfma_f32_16x16x32_bf16 a[20:23], v[64:67], v[40:43], a[20:23]
    ds_read_b128 v[32:35], v1 offset:7168
    v_cvt_pk_bf16_f32 v173, v18, v19
    v_mfma_f32_16x16x32_bf16 a[20:23], v[80:83], v[44:47], a[20:23]
    buffer_load_dwordx4 v4, s[4:7], s27 offen offset:0 sc1 lds
    v_mfma_f32_16x16x32_bf16 a[68:71], v[68:71], v[40:43], a[68:71]
    v_exp_f32 v18, v110
    v_mfma_f32_16x16x32_bf16 a[68:71], v[84:87], v[44:47], a[68:71]
    v_add_f32 v6, v6, v16
    v_add_f32 v6, v6, v17
    v_mfma_f32_16x16x32_bf16 a[116:119], v[72:75], v[40:43], a[116:119]
    ds_read_b128 v[36:39], v1 offset:19456
    v_mov_b32 v22, 0x3f803f80
    v_mfma_f32_16x16x32_bf16 a[116:119], v[88:91], v[44:47], a[116:119]
    buffer_load_dwordx4 v4, s[4:7], s27 offen offset:1024 sc1 lds
    v_mfma_f32_16x16x32_bf16 a[164:167], v[76:79], v[40:43], a[164:167]
    v_exp_f32 v19, v111
    v_mfma_f32_16x16x32_bf16 a[164:167], v[92:95], v[44:47], a[164:167]
    s_waitcnt lgkmcnt(2)
    v_cvt_pk_bf16_f32 v174, v16, v17
    v_add_f32 v6, v6, v18
    v_mfma_f32_16x16x32_bf16 a[24:27], v[64:67], v[24:27], a[24:27]
    ds_read_b128 v[40:43], v1 offset:8192
    v_add_f32 v6, v6, v19
    v_mfma_f32_16x16x32_bf16 a[24:27], v[80:83], v[28:31], a[24:27]
    buffer_load_dwordx4 v4, s[4:7], s27 offen offset:2048 sc1 lds
    v_mfma_f32_16x16x32_bf16 a[72:75], v[68:71], v[24:27], a[72:75]
    v_cvt_pk_bf16_f32 v175, v18, v19
    v_mov_b32 v23, 0x3f803f80
    v_mfma_f32_16x16x32_bf16 a[72:75], v[84:87], v[28:31], a[72:75]
    v_exp_f32 v16, v176
    v_mfma_f32_16x16x32_bf16 a[120:123], v[72:75], v[24:27], a[120:123]
    ds_read_b128 v[44:47], v1 offset:20480
    v_mfma_f32_16x16x32_bf16 a[120:123], v[88:91], v[28:31], a[120:123]
    s_lshl_b32 s24, s95, 2
    v_exp_f32 v17, v177
    v_mfma_f32_16x16x32_bf16 a[168:171], v[76:79], v[24:27], a[168:171]
    s_add_u32 s27, s27, 24576
    v_exp_f32 v18, v178
    v_mfma_f32_16x16x32_bf16 a[168:171], v[92:95], v[28:31], a[168:171]
    s_waitcnt lgkmcnt(2)
    v_add_f32 v5, v5, v16
    v_add_f32 v5, v5, v17
    v_mfma_f32_16x16x32_bf16 a[28:31], v[64:67], v[32:35], a[28:31]
    s_add_u32 s56, s56, 12288
    ds_read_b128 v[24:27], v1 offset:9216
    v_mfma_f32_16x16x32_bf16 a[28:31], v[80:83], v[36:39], a[28:31]
    s_mov_b32 m0, s56
    v_exp_f32 v19, v179
    v_mfma_f32_16x16x32_bf16 a[76:79], v[68:71], v[32:35], a[76:79]
    v_cvt_pk_bf16_f32 v176, v16, v17
    v_mfma_f32_16x16x32_bf16 a[76:79], v[84:87], v[36:39], a[76:79]
    s_add_u32 s24, s24, s25
    v_exp_f32 v16, v112
    v_mfma_f32_16x16x32_bf16 a[124:127], v[72:75], v[32:35], a[124:127]
    ds_read_b128 v[28:31], v1 offset:21504
    v_add_f32 v5, v5, v18
    v_mfma_f32_16x16x32_bf16 a[124:127], v[88:91], v[36:39], a[124:127]
    buffer_load_dwordx4 v4, s[4:7], s27 offen offset:0 sc1 lds
    v_mfma_f32_16x16x32_bf16 a[172:175], v[76:79], v[32:35], a[172:175]
    v_add_f32 v5, v5, v19
    v_mfma_f32_16x16x32_bf16 a[172:175], v[92:95], v[36:39], a[172:175]
    s_waitcnt lgkmcnt(2)
    v_exp_f32 v17, v113
    v_mfma_f32_16x16x32_bf16 a[32:35], v[64:67], v[40:43], a[32:35]
    s_mul_i32 s24, s24, 24576
    ds_read_b128 v[32:35], v1 offset:10240
    v_cvt_pk_bf16_f32 v177, v18, v19
    v_mfma_f32_16x16x32_bf16 a[32:35], v[80:83], v[44:47], a[32:35]
    buffer_load_dwordx4 v4, s[4:7], s27 offen offset:1024 sc1 lds
    v_mfma_f32_16x16x32_bf16 a[80:83], v[68:71], v[40:43], a[80:83]
    v_exp_f32 v18, v114
    v_mfma_f32_16x16x32_bf16 a[80:83], v[84:87], v[44:47], a[80:83]
    v_add_f32 v5, v5, v16
    v_add_f32 v5, v5, v17
    v_mfma_f32_16x16x32_bf16 a[128:131], v[72:75], v[40:43], a[128:131]
    ds_read_b128 v[36:39], v1 offset:22528
    v_mfma_f32_16x16x32_bf16 a[128:131], v[88:91], v[44:47], a[128:131]
    buffer_load_dwordx4 v4, s[4:7], s27 offen offset:2048 sc1 lds
    v_mfma_f32_16x16x32_bf16 a[176:179], v[76:79], v[40:43], a[176:179]
    s_add_u32 s40, s24, 6144
    v_exp_f32 v19, v115
    v_mfma_f32_16x16x32_bf16 a[176:179], v[92:95], v[44:47], a[176:179]
    s_waitcnt lgkmcnt(2)
    v_cvt_pk_bf16_f32 v178, v16, v17
    v_mfma_f32_16x16x32_bf16 a[36:39], v[64:67], v[24:27], a[36:39]
    ds_read_b128 v[40:43], v1 offset:11264
    v_mfma_f32_16x16x32_bf16 a[36:39], v[80:83], v[28:31], a[36:39]
    v_exp_f32 v16, v180
    v_mfma_f32_16x16x32_bf16 a[84:87], v[68:71], v[24:27], a[84:87]
    v_add_f32 v5, v5, v18
    v_add_f32 v5, v5, v19
    v_mfma_f32_16x16x32_bf16 a[84:87], v[84:87], v[28:31], a[84:87]
    s_add_u32 s27, s27, 24576
    v_exp_f32 v17, v181
    v_mfma_f32_16x16x32_bf16 a[132:135], v[72:75], v[24:27], a[132:135]
    s_add_u32 s56, s56, 36864
    ds_read_b128 v[44:47], v1 offset:23552
    v_cvt_pk_bf16_f32 v179, v18, v19
    v_mfma_f32_16x16x32_bf16 a[132:135], v[88:91], v[28:31], a[132:135]
    s_waitcnt lgkmcnt(2)
    v_exp_f32 v18, v182
    v_mfma_f32_16x16x32_bf16 a[180:183], v[76:79], v[24:27], a[180:183]
    s_waitcnt vmcnt(12)
    v_add_f32 v6, v6, v16
    v_add_f32 v6, v6, v17
    v_mfma_f32_16x16x32_bf16 a[180:183], v[92:95], v[28:31], a[180:183]
    s_barrier
    v_add_u32 v2, 49152, v2
    v_add_u32 v3, 49152, v3
    v_mfma_f32_16x16x32_bf16 a[40:43], v[64:67], v[32:35], a[40:43]
L_pg11:
    s_cbranch_execz L_iwret
    s_sub_u32 s58, s56, 147456
    ds_read_b128 v[24:27], v2 offset:0
    s_add_u32 s41, s24, 12288
    v_mfma_f32_16x16x32_bf16 a[40:43], v[80:83], v[36:39], a[40:43]
    s_min_u32 s56, s56, s58
    v_exp_f32 v19, v183
    v_mfma_f32_16x16x32_bf16 a[88:91], v[68:71], v[32:35], a[88:91]
    s_add_u32 s42, s24, 18432
    v_cvt_pk_bf16_f32 v180, v16, v17
    v_mfma_f32_16x16x32_bf16 a[88:91], v[84:87], v[36:39], a[88:91]
    v_exp_f32 v16, v116
    v_mfma_f32_16x16x32_bf16 a[136:139], v[72:75], v[32:35], a[136:139]
    ds_read_b128 v[28:31], v3 offset:0
    v_add_f32 v6, v6, v18
    v_mfma_f32_16x16x32_bf16 a[136:139], v[88:91], v[36:39], a[136:139]
    v_add_f32 v6, v6, v19
    v_mfma_f32_16x16x32_bf16 a[184:187], v[76:79], v[32:35], a[184:187]
    v_exp_f32 v17, v117
    v_mfma_f32_16x16x32_bf16 a[184:187], v[92:95], v[36:39], a[184:187]
    s_waitcnt lgkmcnt(2)
    v_cvt_pk_bf16_f32 v181, v18, v19
    v_mfma_f32_16x16x32_bf16 a[44:47], v[64:67], v[40:43], a[44:47]
    ds_read_b128 v[32:35], v2 offset:6144
    v_mfma_f32_16x16x32_bf16 a[44:47], v[80:83], v[44:47], a[44:47]
    v_exp_f32 v18, v118
    v_mfma_f32_16x16x32_bf16 a[92:95], v[68:71], v[40:43], a[92:95]
    v_add_f32 v6, v6, v16
    v_add_f32 v6, v6, v17
    v_mfma_f32_16x16x32_bf16 a[92:95], v[84:87], v[44:47], a[92:95]
    v_exp_f32 v19, v119
    v_mfma_f32_16x16x32_bf16 a[140:143], v[72:75], v[40:43], a[140:143]
    ds_read_b128 v[36:39], v3 offset:6144
    v_cvt_pk_bf16_f32 v182, v16, v17
    v_mfma_f32_16x16x32_bf16 a[140:143], v[88:91], v[44:47], a[140:143]
    v_add_f32 v6, v6, v18
    v_add_f32 v6, v6, v19
    v_mfma_f32_16x16x32_bf16 a[188:191], v[76:79], v[40:43], a[188:191]
    v_cvt_pk_bf16_f32 v183, v18, v19
    v_mfma_f32_16x16x32_bf16 a[188:191], v[92:95], v[44:47], a[188:191]
    s_waitcnt lgkmcnt(2)
    v_mfma_f32_16x16x32_bf16 v[64:67], v[24:27], a[192:195], v[128:131]
    ds_read_b128 v[40:43], v2 offset:128
    v_mfma_f32_16x16x32_bf16 v[64:67], v[28:31], a[196:199], v[64:67]
    v_exp_f32 v16, v184
    v_mfma_f32_16x16x32_bf16 v[68:71], v[24:27], a[216:219], v[132:135]
    ds_read_b128 v[44:47], v3 offset:128
    v_mfma_f32_16x16x32_bf16 v[68:71], v[28:31], a[220:223], v[68:71]
    s_waitcnt lgkmcnt(2)
    v_exp_f32 v17, v185
    v_mfma_f32_16x16x32_bf16 v[96:99], v[32:35], a[192:195], v[128:131]
    ds_read_b128 v[24:27], v2 offset:6272
    v_mfma_f32_16x16x32_bf16 v[96:99], v[36:39], a[196:199], v[96:99]
    v_exp_f32 v18, v186
    v_mfma_f32_16x16x32_bf16 v[100:103], v[32:35], a[216:219], v[132:135]
    ds_read_b128 v[28:31], v3 offset:6272
    v_add_f32 v5, v5, v16
    v_mfma_f32_16x16x32_bf16 v[100:103], v[36:39], a[220:223], v[100:103]
    s_waitcnt lgkmcnt(2)
    v_add_f32 v5, v5, v17
    v_mfma_f32_16x16x32_bf16 v[64:67], v[40:43], a[200:203], v[64:67]
    ds_read_b128 v[32:35], v2 offset:256
    v_mfma_f32_16x16x32_bf16 v[64:67], v[44:47], a[204:207], v[64:67]
    v_exp_f32 v19, v187
    v_mfma_f32_16x16x32_bf16 v[68:71], v[40:43], a[224:227], v[68:71]
    ds_read_b128 v[36:39], v3 offset:256
    v_cvt_pk_bf16_f32 v184, v16, v17
    v_mfma_f32_16x16x32_bf16 v[68:71], v[44:47], a[228:231], v[68:71]
    s_waitcnt lgkmcnt(2)
    v_exp_f32 v16, v120
    v_mfma_f32_16x16x32_bf16 v[96:99], v[24:27], a[200:203], v[96:99]
    ds_read_b128 v[40:43], v2 offset:6400
    v_add_f32 v5, v5, v18
    v_mfma_f32_16x16x32_bf16 v[96:99], v[28:31], a[204:207], v[96:99]
    s_waitcnt vmcnt(0)
    v_add_f32 v5, v5, v19
    v_mfma_f32_16x16x32_bf16 v[100:103], v[24:27], a[224:227], v[100:103]
    ds_read_b128 v[44:47], v3 offset:6400
    v_mfma_f32_16x16x32_bf16 v[100:103], v[28:31], a[228:231], v[100:103]
    s_waitcnt lgkmcnt(2)
    s_barrier
    v_mfma_f32_16x16x32_bf16 v[64:67], v[32:35], a[208:211], v[64:67]
    s_mov_b32 m0, s56
    ds_read_b128 v[24:27], v2 offset:12288
    v_mfma_f32_16x16x32_bf16 v[64:67], v[36:39], a[212:215], v[64:67]
    buffer_load_dwordx4 v4, s[4:7], s27 offen offset:0 sc1 lds
    v_mfma_f32_16x16x32_bf16 v[68:71], v[32:35], a[232:235], v[68:71]
    ds_read_b128 v[28:31], v3 offset:12288
    v_mfma_f32_16x16x32_bf16 v[68:71], v[36:39], a[236:239], v[68:71]
    s_waitcnt lgkmcnt(2)
    v_exp_f32 v17, v121
    v_cvt_pk_bf16_f32 v185, v18, v19
    v_mfma_f32_16x16x32_bf16 v[96:99], v[40:43], a[208:211], v[96:99]
    ds_read_b128 v[32:35], v2 offset:18432
    v_mfma_f32_16x16x32_bf16 v[96:99], v[44:47], a[212:215], v[96:99]
    buffer_load_dwordx4 v4, s[4:7], s27 offen offset:1024 sc1 lds
    v_mfma_f32_16x16x32_bf16 v[100:103], v[40:43], a[232:235], v[100:103]
    ds_read_b128 v[36:39], v3 offset:18432
    v_mfma_f32_16x16x32_bf16 v[100:103], v[44:47], a[236:239], v[100:103]
    s_waitcnt lgkmcnt(2)
    v_exp_f32 v18, v122
    v_add_f32 v5, v5, v16
    v_mfma_f32_16x16x32_bf16 v[72:75], v[24:27], a[192:195], v[128:131]
    ds_read_b128 v[40:43], v2 offset:12416
    v_add_f32 v5, v5, v17
    v_mfma_f32_16x16x32_bf16 v[72:75], v[28:31], a[196:199], v[72:75]
    v_exp_f32 v19, v123
    v_cvt_pk_bf16_f32 v186, v16, v17
    v_mfma_f32_16x16x32_bf16 v[76:79], v[24:27], a[216:219], v[132:135]
    ds_read_b128 v[44:47], v3 offset:12416
    v_mfma_f32_16x16x32_bf16 v[76:79], v[28:31], a[220:223], v[76:79]
    s_waitcnt lgkmcnt(2)
    buffer_load_dwordx4 v4, s[4:7], s27 offen offset:2048 sc1 lds
    v_mfma_f32_16x16x32_bf16 v[104:107], v[32:35], a[192:195], v[128:131]
    ds_read_b128 v[24:27], v2 offset:18560
    v_mfma_f32_16x16x32_bf16 v[104:107], v[36:39], a[196:199], v[104:107]
    v_exp_f32 v16, v188
    v_add_f32 v5, v5, v18
    v_mfma_f32_16x16x32_bf16 v[108:111], v[32:35], a[216:219], v[132:135]
    ds_read_b128 v[28:31], v3 offset:18560
    v_add_f32 v5, v5, v19
    v_mfma_f32_16x16x32_bf16 v[108:111], v[36:39], a[220:223], v[108:111]
    s_waitcnt lgkmcnt(2)
    v_exp_f32 v17, v189
    v_cvt_pk_bf16_f32 v187, v18, v19
    v_mfma_f32_16x16x32_bf16 v[72:75], v[40:43], a[200:203], v[72:75]
    s_add_u32 s27, s27, 24576
    ds_read_b128 v[32:35], v2 offset:12544
    v_mfma_f32_16x16x32_bf16 v[72:75], v[44:47], a[204:207], v[72:75]
    v_exp_f32 v18, v190
    v_mfma_f32_16x16x32_bf16 v[76:79], v[40:43], a[224:227], v[76:79]
    s_add_u32 s56, s56, 12288
    ds_read_b128 v[36:39], v3 offset:12544
    v_add_f32 v6, v6, v16
    v_mfma_f32_16x16x32_bf16 v[76:79], v[44:47], a[228:231], v[76:79]
    s_waitcnt lgkmcnt(2)
    v_add_f32 v6, v6, v17
    v_mfma_f32_16x16x32_bf16 v[104:107], v[24:27], a[200:203], v[104:107]
    ds_read_b128 v[40:43], v2 offset:18688
    v_mfma_f32_16x16x32_bf16 v[104:107], v[28:31], a[204:207], v[104:107]
    v_exp_f32 v19, v191
    v_cvt_pk_bf16_f32 v188, v16, v17
    v_mfma_f32_16x16x32_bf16 v[108:111], v[24:27], a[224:227], v[108:111]
    s_mov_b32 m0, s56
    ds_read_b128 v[44:47], v3 offset:18688
    v_mfma_f32_16x16x32_bf16 v[108:111], v[28:31], a[228:231], v[108:111]
    s_waitcnt lgkmcnt(2)
    v_add_u32 v2, 49152, v2
    v_add_u32 v3, 49152, v3
    v_mfma_f32_16x16x32_bf16 v[72:75], v[32:35], a[208:211], v[72:75]
    ds_read_b128 v[24:27], v2 offset:0
    v_mfma_f32_16x16x32_bf16 v[72:75], v[36:39], a[212:215], v[72:75]
    buffer_load_dwordx4 v4, s[4:7], s27 offen offset:0 sc1 lds
    v_mfma_f32_16x16x32_bf16 v[76:79], v[32:35], a[232:235], v[76:79]
    ds_read_b128 v[28:31], v3 offset:0
    v_mfma_f32_16x16x32_bf16 v[76:79], v[36:39], a[236:239], v[76:79]
    s_waitcnt lgkmcnt(2)
    v_exp_f32 v16, v124
    v_add_f32 v6, v6, v18
    v_mfma_f32_16x16x32_bf16 v[104:107], v[40:43], a[208:211], v[104:107]
    ds_read_b128 v[32:35], v2 offset:6144
    v_add_f32 v6, v6, v19
    v_mfma_f32_16x16x32_bf16 v[104:107], v[44:47], a[212:215], v[104:107]
    v_exp_f32 v17, v125
    v_cvt_pk_bf16_f32 v189, v18, v19
    v_mfma_f32_16x16x32_bf16 v[108:111], v[40:43], a[232:235], v[108:111]
    ds_read_b128 v[36:39], v3 offset:6144
    v_mfma_f32_16x16x32_bf16 v[108:111], v[44:47], a[236:239], v[108:111]
    s_waitcnt lgkmcnt(2)
    buffer_load_dwordx4 v4, s[4:7], s27 offen offset:1024 sc1 lds
    v_mfma_f32_16x16x32_bf16 v[80:83], v[24:27], a[240:243], v[136:139]
    ds_read_b128 v[40:43], v2 offset:128
    v_mfma_f32_16x16x32_bf16 v[80:83], v[28:31], a[244:247], v[80:83]
    v_exp_f32 v18, v126
    v_add_f32 v6, v6, v16
    v_mfma_f32_16x16x32_bf16 v[84:87], v[24:27], v[200:203], v[140:143]
    ds_read_b128 v[44:47], v3 offset:128
    v_add_f32 v6, v6, v17
    v_exp_f32 v19, v127
    v_cvt_pk_bf16_f32 v190, v16, v17
    v_add_f32 v6, v6, v18
    v_add_f32 v6, v6, v19
    v_cvt_pk_bf16_f32 v191, v18, v19
    v_mfma_f32_16x16x32_bf16 v[84:87], v[28:31], v[204:207], v[84:87]
    s_waitcnt lgkmcnt(2)
    v_exp_f32 v16, v64
    v_mfma_f32_16x16x32_bf16 v[112:115], v[32:35], a[240:243], v[136:139]
    ds_read_b128 v[24:27], v2 offset:6272
    v_mfma_f32_16x16x32_bf16 v[112:115], v[36:39], a[244:247], v[112:115]
    buffer_load_dwordx4 v4, s[4:7], s27 offen offset:2048 sc1 lds
    v_mfma_f32_16x16x32_bf16 v[116:119], v[32:35], v[200:203], v[140:143]
    ds_read_b128 v[28:31], v3 offset:6272
    v_mfma_f32_16x16x32_bf16 v[116:119], v[36:39], v[204:207], v[116:119]
    s_waitcnt lgkmcnt(2)
    v_exp_f32 v17, v65
    v_mfma_f32_16x16x32_bf16 v[80:83], v[40:43], a[248:251], v[80:83]
    ds_read_b128 v[32:35], v2 offset:256
    v_mfma_f32_16x16x32_bf16 v[80:83], v[44:47], a[252:255], v[80:83]
    v_exp_f32 v18, v66
    v_mfma_f32_16x16x32_bf16 v[84:87], v[40:43], v[208:211], v[84:87]
    ds_read_b128 v[36:39], v3 offset:256
    v_add_f32 v5, v5, v16
    v_mfma_f32_16x16x32_bf16 v[84:87], v[44:47], v[212:215], v[84:87]
    s_waitcnt lgkmcnt(2)
    v_add_f32 v5, v5, v17
    v_mfma_f32_16x16x32_bf16 v[112:115], v[24:27], a[248:251], v[112:115]
    ds_read_b128 v[40:43], v2 offset:6400
    v_mfma_f32_16x16x32_bf16 v[112:115], v[28:31], a[252:255], v[112:115]
    v_exp_f32 v19, v67
    v_cvt_pk_bf16_f32 v64, v16, v17
    v_mfma_f32_16x16x32_bf16 v[116:119], v[24:27], v[208:211], v[116:119]
    s_add_u32 s27, s27, 24576
    ds_read_b128 v[44:47], v3 offset:6400
    s_add_u32 s56, s56, 36864
    v_mfma_f32_16x16x32_bf16 v[116:119], v[28:31], v[212:215], v[116:119]
    s_waitcnt lgkmcnt(2)
    v_exp_f32 v16, v96
    v_mfma_f32_16x16x32_bf16 v[80:83], v[32:35], v[192:195], v[80:83]
    s_sub_u32 s58, s56, 147456
    ds_read_b128 v[24:27], v2 offset:12288
    v_add_f32 v5, v5, v18
    v_mfma_f32_16x16x32_bf16 v[80:83], v[36:39], v[196:199], v[80:83]
    s_min_u32 s56, s56, s58
    v_add_f32 v5, v5, v19
    v_mfma_f32_16x16x32_bf16 v[84:87], v[32:35], v[216:219], v[84:87]
    ds_read_b128 v[28:31], v3 offset:12288
    v_mfma_f32_16x16x32_bf16 v[84:87], v[36:39], v[220:223], v[84:87]
    s_waitcnt lgkmcnt(2)
    v_exp_f32 v17, v97
    v_cvt_pk_bf16_f32 v65, v18, v19
    v_mfma_f32_16x16x32_bf16 v[112:115], v[40:43], v[192:195], v[112:115]
    ds_read_b128 v[32:35], v2 offset:18432
    v_mfma_f32_16x16x32_bf16 v[112:115], v[44:47], v[196:199], v[112:115]
    v_exp_f32 v18, v98
    v_mfma_f32_16x16x32_bf16 v[116:119], v[40:43], v[216:219], v[116:119]
    ds_read_b128 v[36:39], v3 offset:18432
    v_add_f32 v5, v5, v16
    v_mfma_f32_16x16x32_bf16 v[116:119], v[44:47], v[220:223], v[116:119]
    s_waitcnt lgkmcnt(2)
    v_add_f32 v5, v5, v17
    v_mfma_f32_16x16x32_bf16 v[88:91], v[24:27], a[240:243], v[136:139]
    ds_read_b128 v[40:43], v2 offset:12416
    v_mfma_f32_16x16x32_bf16 v[88:91], v[28:31], a[244:247], v[88:91]
    v_exp_f32 v19, v99
    v_cvt_pk_bf16_f32 v66, v16, v17
    v_mfma_f32_16x16x32_bf16 v[92:95], v[24:27], v[200:203], v[140:143]
    ds_read_b128 v[44:47], v3 offset:12416
    v_mfma_f32_16x16x32_bf16 v[92:95], v[28:31], v[204:207], v[92:95]
    s_waitcnt lgkmcnt(2)
    v_exp_f32 v16, v68
    v_mfma_f32_16x16x32_bf16 v[120:123], v[32:35], a[240:243], v[136:139]
    ds_read_b128 v[24:27], v2 offset:18560
    v_add_f32 v5, v5, v18
    v_mfma_f32_16x16x32_bf16 v[120:123], v[36:39], a[244:247], v[120:123]
    v_add_f32 v5, v5, v19
    v_mfma_f32_16x16x32_bf16 v[124:127], v[32:35], v[200:203], v[140:143]
    ds_read_b128 v[28:31], v3 offset:18560
    v_mfma_f32_16x16x32_bf16 v[124:127], v[36:39], v[204:207], v[124:127]
    s_waitcnt lgkmcnt(2)
    v_exp_f32 v17, v69
    v_cvt_pk_bf16_f32 v67, v18, v19
    v_mfma_f32_16x16x32_bf16 v[88:91], v[40:43], a[248:251], v[88:91]
    ds_read_b128 v[32:35], v2 offset:12544
    v_mfma_f32_16x16x32_bf16 v[88:91], v[44:47], a[252:255], v[88:91]
    v_exp_f32 v18, v70
    v_mfma_f32_16x16x32_bf16 v[92:95], v[40:43], v[208:211], v[92:95]
    ds_read_b128 v[36:39], v3 offset:12544
    v_add_f32 v6, v6, v16
    v_mfma_f32_16x16x32_bf16 v[92:95], v[44:47], v[212:215], v[92:95]
    s_waitcnt lgkmcnt(2)
    v_add_f32 v6, v6, v17
    v_mfma_f32_16x16x32_bf16 v[120:123], v[24:27], a[248:251], v[120:123]
    ds_read_b128 v[40:43], v2 offset:18688
    v_mfma_f32_16x16x32_bf16 v[120:123], v[28:31], a[252:255], v[120:123]
    v_exp_f32 v19, v71
    v_cvt_pk_bf16_f32 v68, v16, v17
    v_mfma_f32_16x16x32_bf16 v[124:127], v[24:27], v[208:211], v[124:127]
    ds_read_b128 v[44:47], v3 offset:18688
    v_mfma_f32_16x16x32_bf16 v[124:127], v[28:31], v[212:215], v[124:127]
    s_waitcnt lgkmcnt(2)
    v_add_u32 v1, 49152, v1
    v_exp_f32 v16, v100
    v_mfma_f32_16x16x32_bf16 v[88:91], v[32:35], v[192:195], v[88:91]
    ds_read_b128 v[24:27], v1 offset:0
    v_add_f32 v6, v6, v18
    v_mfma_f32_16x16x32_bf16 v[88:91], v[36:39], v[196:199], v[88:91]
    v_add_f32 v6, v6, v19
    v_mfma_f32_16x16x32_bf16 v[92:95], v[32:35], v[216:219], v[92:95]
    ds_read_b128 v[28:31], v1 offset:12288
    v_mfma_f32_16x16x32_bf16 v[92:95], v[36:39], v[220:223], v[92:95]
    s_waitcnt lgkmcnt(2)
    v_exp_f32 v17, v101
    v_cvt_pk_bf16_f32 v69, v18, v19
    v_mfma_f32_16x16x32_bf16 v[120:123], v[40:43], v[192:195], v[120:123]
    ds_read_b128 v[32:35], v1 offset:1024
    v_mfma_f32_16x16x32_bf16 v[120:123], v[44:47], v[196:199], v[120:123]
    v_exp_f32 v18, v102
    v_mfma_f32_16x16x32_bf16 v[124:127], v[40:43], v[216:219], v[124:127]
    ds_read_b128 v[36:39], v1 offset:13312
    v_add_f32 v6, v6, v16
    v_mfma_f32_16x16x32_bf16 v[124:127], v[44:47], v[220:223], v[124:127]
    s_waitcnt lgkmcnt(2)
    v_add_f32 v6, v6, v17
    v_exp_f32 v19, v103
    v_cvt_pk_bf16_f32 v70, v16, v17
    v_add_f32 v6, v6, v18
    v_add_f32 v6, v6, v19
    v_cvt_pk_bf16_f32 v71, v18, v19
    v_mfma_f32_16x16x32_bf16 a[0:3], v[160:163], v[24:27], a[0:3]
    ds_read_b128 v[40:43], v1 offset:2048
    v_mfma_f32_16x16x32_bf16 a[0:3], v[168:171], v[28:31], a[0:3]
    v_exp_f32 v16, v72
    v_mfma_f32_16x16x32_bf16 a[48:51], v[164:167], v[24:27], a[48:51]
    ds_read_b128 v[44:47], v1 offset:14336
    v_mfma_f32_16x16x32_bf16 a[48:51], v[172:175], v[28:31], a[48:51]
    s_waitcnt lgkmcnt(2)
    v_exp_f32 v17, v73
    v_mfma_f32_16x16x32_bf16 a[4:7], v[160:163], v[32:35], a[4:7]
    ds_read_b128 v[24:27], v1 offset:3072
    v_mfma_f32_16x16x32_bf16 a[4:7], v[168:171], v[36:39], a[4:7]
    v_exp_f32 v18, v74
    v_mfma_f32_16x16x32_bf16 a[52:55], v[164:167], v[32:35], a[52:55]
    ds_read_b128 v[28:31], v1 offset:15360
    v_add_f32 v5, v5, v16
    v_mfma_f32_16x16x32_bf16 a[52:55], v[172:175], v[36:39], a[52:55]
    s_waitcnt lgkmcnt(2)
    v_add_f32 v5, v5, v17
    v_mfma_f32_16x16x32_bf16 a[8:11], v[160:163], v[40:43], a[8:11]
    ds_read_b128 v[32:35], v1 offset:4096
    v_mfma_f32_16x16x32_bf16 a[8:11], v[168:171], v[44:47], a[8:11]
    v_exp_f32 v19, v75
    v_mfma_f32_16x16x32_bf16 a[56:59], v[164:167], v[40:43], a[56:59]
    ds_read_b128 v[36:39], v1 offset:16384
    v_cvt_pk_bf16_f32 v72, v16, v17
    v_mfma_f32_16x16x32_bf16 a[56:59], v[172:175], v[44:47], a[56:59]
    s_waitcnt lgkmcnt(2)
    v_exp_f32 v16, v104
    v_mfma_f32_16x16x32_bf16 a[12:15], v[160:163], v[24:27], a[12:15]
    ds_read_b128 v[40:43], v1 offset:5120
    v_add_f32 v5, v5, v18
    v_mfma_f32_16x16x32_bf16 a[12:15], v[168:171], v[28:31], a[12:15]
    v_add_f32 v5, v5, v19
    v_mfma_f32_16x16x32_bf16 a[60:63], v[164:167], v[24:27], a[60:63]
    ds_read_b128 v[44:47], v1 offset:17408
    v_mfma_f32_16x16x32_bf16 a[60:63], v[172:175], v[28:31], a[60:63]
    s_waitcnt lgkmcnt(2)
    v_exp_f32 v17, v105
    v_mfma_f32_16x16x32_bf16 a[16:19], v[160:163], v[32:35], a[16:19]
    ds_read_b128 v[24:27], v1 offset:6144
    v_cvt_pk_bf16_f32 v73, v18, v19
    v_mfma_f32_16x16x32_bf16 a[16:19], v[168:171], v[36:39], a[16:19]
    v_exp_f32 v18, v106
    v_mfma_f32_16x16x32_bf16 a[64:67], v[164:167], v[32:35], a[64:67]
    ds_read_b128 v[28:31], v1 offset:18432
    v_add_f32 v5, v5, v16
    v_mfma_f32_16x16x32_bf16 a[64:67], v[172:175], v[36:39], a[64:67]
    s_waitcnt lgkmcnt(2)
    v_add_f32 v5, v5, v17
    v_mfma_f32_16x16x32_bf16 a[20:23], v[160:163], v[40:43], a[20:23]
    ds_read_b128 v[32:35], v1 offset:7168
    v_mfma_f32_16x16x32_bf16 a[20:23], v[168:171], v[44:47], a[20:23]
    v_exp_f32 v19, v107
    v_mfma_f32_16x16x32_bf16 a[68:71], v[164:167], v[40:43], a[68:71]
    ds_read_b128 v[36:39], v1 offset:19456
    v_cvt_pk_bf16_f32 v74, v16, v17
    v_mfma_f32_16x16x32_bf16 a[68:71], v[172:175], v[44:47], a[68:71]
    s_waitcnt lgkmcnt(2)
    v_exp_f32 v16, v76
    v_mfma_f32_16x16x32_bf16 a[24:27], v[160:163], v[24:27], a[24:27]
    ds_read_b128 v[40:43], v1 offset:8192
    v_add_f32 v5, v5, v18
    v_mfma_f32_16x16x32_bf16 a[24:27], v[168:171], v[28:31], a[24:27]
    v_add_f32 v5, v5, v19
    v_mfma_f32_16x16x32_bf16 a[72:75], v[164:167], v[24:27], a[72:75]
    ds_read_b128 v[44:47], v1 offset:20480
    v_mfma_f32_16x16x32_bf16 a[72:75], v[172:175], v[28:31], a[72:75]
    s_waitcnt lgkmcnt(2)
    v_exp_f32 v17, v77
    v_mfma_f32_16x16x32_bf16 a[28:31], v[160:163], v[32:35], a[28:31]
    ds_read_b128 v[24:27], v1 offset:9216
    v_cvt_pk_bf16_f32 v75, v18, v19
    v_mfma_f32_16x16x32_bf16 a[28:31], v[168:171], v[36:39], a[28:31]
    v_exp_f32 v18, v78
    v_mfma_f32_16x16x32_bf16 a[76:79], v[164:167], v[32:35], a[76:79]
    ds_read_b128 v[28:31], v1 offset:21504
    v_add_f32 v6, v6, v16
    v_mfma_f32_16x16x32_bf16 a[76:79], v[172:175], v[36:39], a[76:79]
    s_waitcnt lgkmcnt(2)
    v_add_f32 v6, v6, v17
    v_mfma_f32_16x16x32_bf16 a[32:35], v[160:163], v[40:43], a[32:35]
    ds_read_b128 v[32:35], v1 offset:10240
    v_mfma_f32_16x16x32_bf16 a[32:35], v[168:171], v[44:47], a[32:35]
    v_exp_f32 v19, v79
    v_mfma_f32_16x16x32_bf16 a[80:83], v[164:167], v[40:43], a[80:83]
    ds_read_b128 v[36:39], v1 offset:22528
    v_cvt_pk_bf16_f32 v76, v16, v17
    v_mfma_f32_16x16x32_bf16 a[80:83], v[172:175], v[44:47], a[80:83]
    s_waitcnt lgkmcnt(2)
    v_exp_f32 v16, v108
    v_mfma_f32_16x16x32_bf16 a[36:39], v[160:163], v[24:27], a[36:39]
    ds_read_b128 v[40:43], v1 offset:11264
    v_add_f32 v6, v6, v18
    v_mfma_f32_16x16x32_bf16 a[36:39], v[168:171], v[28:31], a[36:39]
    v_add_f32 v6, v6, v19
    v_mfma_f32_16x16x32_bf16 a[84:87], v[164:167], v[24:27], a[84:87]
    ds_read_b128 v[44:47], v1 offset:23552
    v_mfma_f32_16x16x32_bf16 a[84:87], v[172:175], v[28:31], a[84:87]
    s_waitcnt lgkmcnt(2)
    v_subrev_u32 v1, 98304, v1
    v_mfma_f32_16x16x32_bf16 a[40:43], v[160:163], v[32:35], a[40:43]
    ds_read_b128 v[24:27], v1 offset:0
    v_mfma_f32_16x16x32_bf16 a[40:43], v[168:171], v[36:39], a[40:43]
    v_exp_f32 v17, v109
    v_mfma_f32_16x16x32_bf16 a[88:91], v[164:167], v[32:35], a[88:91]
    ds_read_b128 v[28:31], v1 offset:12288
    v_cvt_pk_bf16_f32 v77, v18, v19
    v_mfma_f32_16x16x32_bf16 a[88:91], v[172:175], v[36:39], a[88:91]
    s_waitcnt lgkmcnt(2)
    v_exp_f32 v18, v110
    v_mfma_f32_16x16x32_bf16 a[44:47], v[160:163], v[40:43], a[44:47]
    ds_read_b128 v[32:35], v1 offset:1024
    v_add_f32 v6, v6, v16
    v_mfma_f32_16x16x32_bf16 a[44:47], v[168:171], v[44:47], a[44:47]
    v_add_f32 v6, v6, v17
    v_mfma_f32_16x16x32_bf16 a[92:95], v[164:167], v[40:43], a[92:95]
    ds_read_b128 v[36:39], v1 offset:13312
    v_mfma_f32_16x16x32_bf16 a[92:95], v[172:175], v[44:47], a[92:95]
    s_waitcnt lgkmcnt(2)
    v_exp_f32 v19, v111
    v_mfma_f32_16x16x32_bf16 a[0:3], v[176:179], v[24:27], a[0:3]
    ds_read_b128 v[40:43], v1 offset:2048
    v_cvt_pk_bf16_f32 v78, v16, v17
    v_mfma_f32_16x16x32_bf16 a[0:3], v[184:187], v[28:31], a[0:3]
    v_add_f32 v6, v6, v18
    v_add_f32 v6, v6, v19
    v_mfma_f32_16x16x32_bf16 a[48:51], v[180:183], v[24:27], a[48:51]
    ds_read_b128 v[44:47], v1 offset:14336
    v_cvt_pk_bf16_f32 v79, v18, v19
    v_mfma_f32_16x16x32_bf16 a[48:51], v[188:191], v[28:31], a[48:51]
    s_waitcnt lgkmcnt(2)
    v_exp_f32 v16, v80
    v_mfma_f32_16x16x32_bf16 a[4:7], v[176:179], v[32:35], a[4:7]
    ds_read_b128 v[24:27], v1 offset:3072
    v_mfma_f32_16x16x32_bf16 a[4:7], v[184:187], v[36:39], a[4:7]
    v_exp_f32 v17, v81
    v_mfma_f32_16x16x32_bf16 a[52:55], v[180:183], v[32:35], a[52:55]
    ds_read_b128 v[28:31], v1 offset:15360
    v_mfma_f32_16x16x32_bf16 a[52:55], v[188:191], v[36:39], a[52:55]
    s_waitcnt lgkmcnt(2)
    v_exp_f32 v18, v82
    v_mfma_f32_16x16x32_bf16 a[8:11], v[176:179], v[40:43], a[8:11]
    ds_read_b128 v[32:35], v1 offset:4096
    v_add_f32 v7, v7, v16
    v_mfma_f32_16x16x32_bf16 a[8:11], v[184:187], v[44:47], a[8:11]
    v_add_f32 v7, v7, v17
    v_mfma_f32_16x16x32_bf16 a[56:59], v[180:183], v[40:43], a[56:59]
    ds_read_b128 v[36:39], v1 offset:16384
    v_mfma_f32_16x16x32_bf16 a[56:59], v[188:191], v[44:47], a[56:59]
    s_waitcnt lgkmcnt(2)
    v_exp_f32 v19, v83
    v_mfma_f32_16x16x32_bf16 a[12:15], v[176:179], v[24:27], a[12:15]
    ds_read_b128 v[40:43], v1 offset:5120
    v_cvt_pk_bf16_f32 v80, v16, v17
    v_mfma_f32_16x16x32_bf16 a[12:15], v[184:187], v[28:31], a[12:15]
    v_exp_f32 v16, v112
    v_mfma_f32_16x16x32_bf16 a[60:63], v[180:183], v[24:27], a[60:63]
    ds_read_b128 v[44:47], v1 offset:17408
    v_add_f32 v7, v7, v18
    v_mfma_f32_16x16x32_bf16 a[60:63], v[188:191], v[28:31], a[60:63]
    s_waitcnt lgkmcnt(2)
    v_add_f32 v7, v7, v19
    v_mfma_f32_16x16x32_bf16 a[16:19], v[176:179], v[32:35], a[16:19]
    ds_read_b128 v[24:27], v1 offset:6144
    v_mfma_f32_16x16x32_bf16 a[16:19], v[184:187], v[36:39], a[16:19]
    v_exp_f32 v17, v113
    v_mfma_f32_16x16x32_bf16 a[64:67], v[180:183], v[32:35], a[64:67]
    ds_read_b128 v[28:31], v1 offset:18432
    v_cvt_pk_bf16_f32 v81, v18, v19
    v_mfma_f32_16x16x32_bf16 a[64:67], v[188:191], v[36:39], a[64:67]
    s_waitcnt lgkmcnt(2)
    v_exp_f32 v18, v114
    v_mfma_f32_16x16x32_bf16 a[20:23], v[176:179], v[40:43], a[20:23]
    ds_read_b128 v[32:35], v1 offset:7168
    v_add_f32 v7, v7, v16
    v_mfma_f32_16x16x32_bf16 a[20:23], v[184:187], v[44:47], a[20:23]
    v_add_f32 v7, v7, v17
    v_mfma_f32_16x16x32_bf16 a[68:71], v[180:183], v[40:43], a[68:71]
    ds_read_b128 v[36:39], v1 offset:19456
    v_mfma_f32_16x16x32_bf16 a[68:71], v[188:191], v[44:47], a[68:71]
    s_waitcnt lgkmcnt(2)
    v_exp_f32 v19, v115
    v_mfma_f32_16x16x32_bf16 a[24:27], v[176:179], v[24:27], a[24:27]
    ds_read_b128 v[40:43], v1 offset:8192
    v_cvt_pk_bf16_f32 v82, v16, v17
    v_mfma_f32_16x16x32_bf16 a[24:27], v[184:187], v[28:31], a[24:27]
    v_exp_f32 v16, v84
    v_mfma_f32_16x16x32_bf16 a[72:75], v[180:183], v[24:27], a[72:75]
    ds_read_b128 v[44:47], v1 offset:20480
    v_add_f32 v7, v7, v18
    v_mfma_f32_16x16x32_bf16 a[72:75], v[188:191], v[28:31], a[72:75]
    s_waitcnt lgkmcnt(2)
    v_add_f32 v7, v7, v19
    v_mfma_f32_16x16x32_bf16 a[28:31], v[176:179], v[32:35], a[28:31]
    ds_read_b128 v[24:27], v1 offset:9216
    v_mfma_f32_16x16x32_bf16 a[28:31], v[184:187], v[36:39], a[28:31]
    s_waitcnt vmcnt(0)
    v_exp_f32 v17, v85
    v_mfma_f32_16x16x32_bf16 a[76:79], v[180:183], v[32:35], a[76:79]
    ds_read_b128 v[28:31], v1 offset:21504
    v_cvt_pk_bf16_f32 v83, v18, v19
    v_mfma_f32_16x16x32_bf16 a[76:79], v[188:191], v[36:39], a[76:79]
    s_waitcnt lgkmcnt(2)
    s_barrier
    v_mfma_f32_16x16x32_bf16 a[32:35], v[176:179], v[40:43], a[32:35]
    ds_read_b128 v[32:35], v1 offset:10240
    v_mfma_f32_16x16x32_bf16 a[32:35], v[184:187], v[44:47], a[32:35]
    v_exp_f32 v18, v86
    v_mfma_f32_16x16x32_bf16 a[80:83], v[180:183], v[40:43], a[80:83]
    ds_read_b128 v[36:39], v1 offset:22528
    v_add_f32 v8, v8, v16
    v_mfma_f32_16x16x32_bf16 a[80:83], v[188:191], v[44:47], a[80:83]
    s_waitcnt lgkmcnt(2)
    v_add_f32 v8, v8, v17
    v_mfma_f32_16x16x32_bf16 a[36:39], v[176:179], v[24:27], a[36:39]
    ds_read_b128 v[40:43], v1 offset:11264
    v_mfma_f32_16x16x32_bf16 a[36:39], v[184:187], v[28:31], a[36:39]
    v_exp_f32 v19, v87
    v_cvt_pk_bf16_f32 v84, v16, v17
    v_mfma_f32_16x16x32_bf16 a[84:87], v[180:183], v[24:27], a[84:87]
    ds_read_b128 v[44:47], v1 offset:23552
    v_mfma_f32_16x16x32_bf16 a[84:87], v[188:191], v[28:31], a[84:87]
    s_waitcnt lgkmcnt(2)
    v_add_u32 v1, 49152, v1
    v_exp_f32 v16, v116
    v_mfma_f32_16x16x32_bf16 a[40:43], v[176:179], v[32:35], a[40:43]
    ds_read_b128 v[24:27], v1 offset:0
    v_add_f32 v8, v8, v18
    v_mfma_f32_16x16x32_bf16 a[40:43], v[184:187], v[36:39], a[40:43]
    v_add_f32 v8, v8, v19
    v_mfma_f32_16x16x32_bf16 a[88:91], v[180:183], v[32:35], a[88:91]
    ds_read_b128 v[28:31], v1 offset:12288
    v_mfma_f32_16x16x32_bf16 a[88:91], v[188:191], v[36:39], a[88:91]
    s_waitcnt lgkmcnt(2)
    v_exp_f32 v17, v117
    v_cvt_pk_bf16_f32 v85, v18, v19
    v_mfma_f32_16x16x32_bf16 a[44:47], v[176:179], v[40:43], a[44:47]
    ds_read_b128 v[32:35], v1 offset:1024
    v_mfma_f32_16x16x32_bf16 a[44:47], v[184:187], v[44:47], a[44:47]
    v_exp_f32 v18, v118
    v_mfma_f32_16x16x32_bf16 a[92:95], v[180:183], v[40:43], a[92:95]
    ds_read_b128 v[36:39], v1 offset:13312
    v_add_f32 v8, v8, v16
    v_mfma_f32_16x16x32_bf16 a[92:95], v[188:191], v[44:47], a[92:95]
    s_waitcnt lgkmcnt(2)
    v_add_f32 v8, v8, v17
    v_exp_f32 v19, v119
    v_cvt_pk_bf16_f32 v86, v16, v17
    v_add_f32 v8, v8, v18
    v_add_f32 v8, v8, v19
    v_cvt_pk_bf16_f32 v87, v18, v19
    v_mfma_f32_16x16x32_bf16 a[0:3], v[64:67], v[24:27], a[0:3]
    ds_read_b128 v[40:43], v1 offset:2048
    v_mfma_f32_16x16x32_bf16 a[0:3], v[72:75], v[28:31], a[0:3]
    v_exp_f32 v16, v88
    v_exp_f32 v17, v89
    v_exp_f32 v18, v90
    v_mfma_f32_16x16x4_f32 v[48:51], v5, v57, 0
    v_mfma_f32_16x16x32_bf16 a[48:51], v[68:71], v[24:27], a[48:51]
    ds_read_b128 v[44:47], v1 offset:14336
    v_mfma_f32_16x16x32_bf16 a[48:51], v[76:79], v[28:31], a[48:51]
    s_waitcnt lgkmcnt(2)
    v_exp_f32 v19, v91
    v_cvt_pk_bf16_f32 v88, v16, v17
    v_exp_f32 v16, v120
    v_mfma_f32_16x16x4_f32 v[52:55], v6, v57, 0
    v_mfma_f32_16x16x32_bf16 a[4:7], v[64:67], v[32:35], a[4:7]
    ds_read_b128 v[24:27], v1 offset:3072
    v_mfma_f32_16x16x32_bf16 a[4:7], v[72:75], v[36:39], a[4:7]
    v_exp_f32 v17, v121
    v_cvt_pk_bf16_f32 v89, v18, v19
    v_mfma_f32_16x16x32_bf16 a[52:55], v[68:71], v[32:35], a[52:55]
    ds_read_b128 v[28:31], v1 offset:15360
    v_mfma_f32_16x16x32_bf16 a[52:55], v[76:79], v[36:39], a[52:55]
    s_waitcnt lgkmcnt(2)
    v_exp_f32 v18, v122
    v_mfma_f32_16x16x32_bf16 a[8:11], v[64:67], v[40:43], a[8:11]
    ds_read_b128 v[32:35], v1 offset:4096
    v_mfma_f32_16x16x32_bf16 a[8:11], v[72:75], v[44:47], a[8:11]
    v_exp_f32 v19, v123
    v_mfma_f32_16x16x32_bf16 a[56:59], v[68:71], v[40:43], a[56:59]
    ds_read_b128 v[36:39], v1 offset:16384
    v_cvt_pk_bf16_f32 v90, v16, v17
    v_mfma_f32_16x16x32_bf16 a[56:59], v[76:79], v[44:47], a[56:59]
    s_waitcnt lgkmcnt(2)
    v_exp_f32 v16, v92
    v_mfma_f32_16x16x32_bf16 a[12:15], v[64:67], v[24:27], a[12:15]
    ds_read_b128 v[40:43], v1 offset:5120
    v_mfma_f32_16x16x32_bf16 a[12:15], v[72:75], v[28:31], a[12:15]
    v_exp_f32 v17, v93
    v_mfma_f32_16x16x32_bf16 a[60:63], v[68:71], v[24:27], a[60:63]
    ds_read_b128 v[44:47], v1 offset:17408
    v_cvt_pk_bf16_f32 v91, v18, v19
    v_mfma_f32_16x16x32_bf16 a[60:63], v[76:79], v[28:31], a[60:63]
    s_waitcnt lgkmcnt(2)
    v_exp_f32 v18, v94
    v_mfma_f32_16x16x32_bf16 a[16:19], v[64:67], v[32:35], a[16:19]
    ds_read_b128 v[24:27], v1 offset:6144
    v_mfma_f32_16x16x32_bf16 a[16:19], v[72:75], v[36:39], a[16:19]
    v_exp_f32 v19, v95
    v_mfma_f32_16x16x32_bf16 a[64:67], v[68:71], v[32:35], a[64:67]
    ds_read_b128 v[28:31], v1 offset:18432
    v_mfma_f32_16x16x32_bf16 a[64:67], v[76:79], v[36:39], a[64:67]
    s_waitcnt lgkmcnt(2)
    v_mfma_f32_16x16x32_bf16 v[128:131], v[88:91], v[20:23], 0
    v_mfma_f32_16x16x32_bf16 a[20:23], v[64:67], v[40:43], a[20:23]
    ds_read_b128 v[32:35], v1 offset:7168
    v_cvt_pk_bf16_f32 v92, v16, v17
    v_mfma_f32_16x16x32_bf16 a[20:23], v[72:75], v[44:47], a[20:23]
L_pg12:
    s_cbranch_execz L_iwret
    v_exp_f32 v16, v124
    v_mfma_f32_16x16x32_bf16 a[68:71], v[68:71], v[40:43], a[68:71]
    ds_read_b128 v[36:39], v1 offset:19456
    v_mfma_f32_16x16x32_bf16 a[68:71], v[76:79], v[44:47], a[68:71]
    s_waitcnt lgkmcnt(2)
    v_exp_f32 v17, v125
    v_mfma_f32_16x16x32_bf16 a[24:27], v[64:67], v[24:27], a[24:27]
    ds_read_b128 v[40:43], v1 offset:8192
    v_cvt_pk_bf16_f32 v93, v18, v19
    v_mfma_f32_16x16x32_bf16 a[24:27], v[72:75], v[28:31], a[24:27]
    v_exp_f32 v18, v126
    v_mfma_f32_16x16x32_bf16 a[72:75], v[68:71], v[24:27], a[72:75]
    ds_read_b128 v[44:47], v1 offset:20480
    v_mfma_f32_16x16x32_bf16 a[72:75], v[76:79], v[28:31], a[72:75]
    s_waitcnt lgkmcnt(2)
    v_exp_f32 v19, v127
    v_mfma_f32_16x16x32_bf16 a[28:31], v[64:67], v[32:35], a[28:31]
    ds_read_b128 v[24:27], v1 offset:9216
    v_cvt_pk_bf16_f32 v94, v16, v17
    v_mfma_f32_16x16x32_bf16 a[28:31], v[72:75], v[36:39], a[28:31]
    v_cvt_pk_bf16_f32 v95, v18, v19
    s_nop 1
    v_mfma_f32_16x16x32_bf16 a[76:79], v[68:71], v[32:35], a[76:79]
    ds_read_b128 v[28:31], v1 offset:21504
    v_mfma_f32_16x16x32_bf16 a[76:79], v[76:79], v[36:39], a[76:79]
    s_waitcnt lgkmcnt(2)
    v_mfma_f32_16x16x32_bf16 v[132:135], v[92:95], v[20:23], 0
    v_mfma_f32_16x16x32_bf16 a[32:35], v[64:67], v[40:43], a[32:35]
    ds_read_b128 v[32:35], v1 offset:10240
    v_mfma_f32_16x16x32_bf16 a[32:35], v[72:75], v[44:47], a[32:35]
    v_rcp_f32 v48, v48
    v_mfma_f32_16x16x32_bf16 a[80:83], v[68:71], v[40:43], a[80:83]
    ds_read_b128 v[36:39], v1 offset:22528
    v_mfma_f32_16x16x32_bf16 a[80:83], v[76:79], v[44:47], a[80:83]
    s_waitcnt lgkmcnt(2)
    v_rcp_f32 v49, v49
    v_mfma_f32_16x16x32_bf16 a[36:39], v[64:67], v[24:27], a[36:39]
    ds_read_b128 v[40:43], v1 offset:11264
    v_mfma_f32_16x16x32_bf16 a[36:39], v[72:75], v[28:31], a[36:39]
    v_rcp_f32 v50, v50
    v_mfma_f32_16x16x32_bf16 a[84:87], v[68:71], v[24:27], a[84:87]
    ds_read_b128 v[44:47], v1 offset:23552
    v_mfma_f32_16x16x32_bf16 a[84:87], v[76:79], v[28:31], a[84:87]
    s_waitcnt lgkmcnt(2)
    v_subrev_u32 v2, 98304, v2
    v_subrev_u32 v3, 98304, v3
    v_mfma_f32_16x16x32_bf16 a[40:43], v[64:67], v[32:35], a[40:43]
    ds_read_b128 v[24:27], v2 offset:0
    v_mfma_f32_16x16x32_bf16 a[40:43], v[72:75], v[36:39], a[40:43]
    v_rcp_f32 v51, v51
    v_mfma_f32_16x16x32_bf16 a[88:91], v[68:71], v[32:35], a[88:91]
    ds_read_b128 v[28:31], v3 offset:0
    v_mfma_f32_16x16x32_bf16 a[88:91], v[76:79], v[36:39], a[88:91]
    s_waitcnt lgkmcnt(2)
    v_rcp_f32 v52, v52
    v_mfma_f32_16x16x32_bf16 a[44:47], v[64:67], v[40:43], a[44:47]
    ds_read_b128 v[32:35], v2 offset:6144
    v_mfma_f32_16x16x32_bf16 a[44:47], v[72:75], v[44:47], a[44:47]
    v_rcp_f32 v53, v53
    v_mfma_f32_16x16x32_bf16 a[92:95], v[68:71], v[40:43], a[92:95]
    ds_read_b128 v[36:39], v3 offset:6144
    v_mfma_f32_16x16x32_bf16 a[92:95], v[76:79], v[44:47], a[92:95]
    s_waitcnt lgkmcnt(2)
    v_rcp_f32 v54, v54
    v_mfma_f32_16x16x32_bf16 v[160:163], v[24:27], a[240:243], v[136:139]
    ds_read_b128 v[40:43], v2 offset:128
    v_mfma_f32_16x16x32_bf16 v[160:163], v[28:31], a[244:247], v[160:163]
    v_rcp_f32 v55, v55
    v_mfma_f32_16x16x32_bf16 v[164:167], v[24:27], v[200:203], v[140:143]
    ds_read_b128 v[44:47], v3 offset:128
    v_mfma_f32_16x16x32_bf16 v[164:167], v[28:31], v[204:207], v[164:167]
    s_waitcnt lgkmcnt(2)
    v_mfma_f32_16x16x32_bf16 v[96:99], v[32:35], a[240:243], v[136:139]
    ds_read_b128 v[24:27], v2 offset:6272
    v_accvgpr_read_b32 v224, a0
    v_mfma_f32_16x16x32_bf16 v[96:99], v[36:39], a[244:247], v[96:99]
    v_accvgpr_read_b32 v225, a4
    v_accvgpr_read_b32 v226, a8
    v_accvgpr_read_b32 v227, a12
    v_accvgpr_read_b32 v228, a16
    v_accvgpr_read_b32 v229, a20
    v_mfma_f32_16x16x32_bf16 v[100:103], v[32:35], v[200:203], v[140:143]
    ds_read_b128 v[28:31], v3 offset:6272
    v_mul_f32 v224, v224, v48
    v_mfma_f32_16x16x32_bf16 v[100:103], v[36:39], v[204:207], v[100:103]
    s_waitcnt lgkmcnt(2)
    v_mul_f32 v225, v225, v48
    v_mul_f32 v226, v226, v48
    v_mul_f32 v227, v227, v48
    v_mul_f32 v228, v228, v48
    v_mul_f32 v229, v229, v48
    v_mfma_f32_16x16x32_bf16 v[160:163], v[40:43], a[248:251], v[160:163]
    ds_read_b128 v[32:35], v2 offset:256
    v_cvt_pk_bf16_f32 v224, v224, v225
    v_mfma_f32_16x16x32_bf16 v[160:163], v[44:47], a[252:255], v[160:163]
    v_cvt_pk_bf16_f32 v225, v226, v227
    v_cvt_pk_bf16_f32 v226, v228, v229
    v_accvgpr_read_b32 v230, a1
    v_accvgpr_read_b32 v231, a5
    v_accvgpr_read_b32 v232, a9
    v_mfma_f32_16x16x32_bf16 v[164:167], v[40:43], v[208:211], v[164:167]
    ds_read_b128 v[36:39], v3 offset:256
    v_accvgpr_read_b32 v233, a13
    v_mfma_f32_16x16x32_bf16 v[164:167], v[44:47], v[212:215], v[164:167]
    s_waitcnt lgkmcnt(2)
    buffer_store_dwordx3 v[224:226], v56, s[12:15], s24 offen offset:0 sc0 sc1
    v_accvgpr_read_b32 v234, a17
    v_accvgpr_read_b32 v235, a21
    v_mfma_f32_16x16x32_bf16 v[96:99], v[24:27], a[248:251], v[96:99]
    ds_read_b128 v[40:43], v2 offset:6400
    v_mul_f32 v230, v230, v49
    v_mfma_f32_16x16x32_bf16 v[96:99], v[28:31], a[252:255], v[96:99]
    v_mul_f32 v231, v231, v49
    v_mul_f32 v232, v232, v49
    v_mul_f32 v233, v233, v49
    v_mul_f32 v234, v234, v49
    v_mul_f32 v235, v235, v49
    v_mfma_f32_16x16x32_bf16 v[100:103], v[24:27], v[208:211], v[100:103]
    ds_read_b128 v[44:47], v3 offset:6400
    v_cvt_pk_bf16_f32 v230, v230, v231
    v_mfma_f32_16x16x32_bf16 v[100:103], v[28:31], v[212:215], v[100:103]
    s_waitcnt lgkmcnt(2)
    v_cvt_pk_bf16_f32 v231, v232, v233
    v_cvt_pk_bf16_f32 v232, v234, v235
    v_accvgpr_read_b32 v236, a2
    v_accvgpr_read_b32 v237, a6
    v_accvgpr_read_b32 v238, a10
    v_mfma_f32_16x16x32_bf16 v[160:163], v[32:35], v[192:195], v[160:163]
    ds_read_b128 v[24:27], v2 offset:12288
    v_accvgpr_read_b32 v239, a14
    v_mfma_f32_16x16x32_bf16 v[160:163], v[36:39], v[196:199], v[160:163]
    buffer_store_dwordx3 v[230:232], v56, s[12:15], s24 offen offset:384 sc0 sc1
    v_accvgpr_read_b32 v240, a18
    v_accvgpr_read_b32 v241, a22
    v_mfma_f32_16x16x32_bf16 v[164:167], v[32:35], v[216:219], v[164:167]
    ds_read_b128 v[28:31], v3 offset:12288
    v_mul_f32 v236, v236, v50
    v_mfma_f32_16x16x32_bf16 v[164:167], v[36:39], v[220:223], v[164:167]
    s_waitcnt lgkmcnt(2)
    v_mul_f32 v237, v237, v50
    v_mul_f32 v238, v238, v50
    v_mul_f32 v239, v239, v50
    v_mul_f32 v240, v240, v50
    v_mul_f32 v241, v241, v50
    v_mfma_f32_16x16x32_bf16 v[96:99], v[40:43], v[192:195], v[96:99]
    ds_read_b128 v[32:35], v2 offset:18432
    v_cvt_pk_bf16_f32 v236, v236, v237
    v_mfma_f32_16x16x32_bf16 v[96:99], v[44:47], v[196:199], v[96:99]
    v_cvt_pk_bf16_f32 v237, v238, v239
    v_cvt_pk_bf16_f32 v238, v240, v241
    v_accvgpr_read_b32 v242, a3
    v_accvgpr_read_b32 v243, a7
    v_accvgpr_read_b32 v244, a11
    v_mfma_f32_16x16x32_bf16 v[100:103], v[40:43], v[216:219], v[100:103]
    ds_read_b128 v[36:39], v3 offset:18432
    v_accvgpr_read_b32 v245, a15
    v_mfma_f32_16x16x32_bf16 v[100:103], v[44:47], v[220:223], v[100:103]
    s_waitcnt lgkmcnt(2)
    buffer_store_dwordx3 v[236:238], v56, s[12:15], s24 offen offset:768 sc0 sc1
    v_accvgpr_read_b32 v246, a19
    v_accvgpr_read_b32 v247, a23
    v_mfma_f32_16x16x32_bf16 v[168:171], v[24:27], a[240:243], v[136:139]
    ds_read_b128 v[40:43], v2 offset:12416
    v_mul_f32 v242, v242, v51
    v_mfma_f32_16x16x32_bf16 v[168:171], v[28:31], a[244:247], v[168:171]
    v_mul_f32 v243, v243, v51
    v_mul_f32 v244, v244, v51
    v_mul_f32 v245, v245, v51
    v_mul_f32 v246, v246, v51
    v_mul_f32 v247, v247, v51
    v_mfma_f32_16x16x32_bf16 v[172:175], v[24:27], v[200:203], v[140:143]
    ds_read_b128 v[44:47], v3 offset:12416
    v_cvt_pk_bf16_f32 v242, v242, v243
    v_mfma_f32_16x16x32_bf16 v[172:175], v[28:31], v[204:207], v[172:175]
    s_waitcnt lgkmcnt(2)
    v_cvt_pk_bf16_f32 v243, v244, v245
    v_cvt_pk_bf16_f32 v244, v246, v247
    v_accvgpr_read_b32 v248, a24
    v_accvgpr_read_b32 v249, a28
    v_accvgpr_read_b32 v250, a32
    v_mfma_f32_16x16x32_bf16 v[104:107], v[32:35], a[240:243], v[136:139]
    ds_read_b128 v[24:27], v2 offset:18560
    v_accvgpr_read_b32 v251, a36
    v_mfma_f32_16x16x32_bf16 v[104:107], v[36:39], a[244:247], v[104:107]
    buffer_store_dwordx3 v[242:244], v56, s[12:15], s24 offen offset:1152 sc0 sc1
    v_accvgpr_read_b32 v252, a40
    v_accvgpr_read_b32 v253, a44
    v_mfma_f32_16x16x32_bf16 v[108:111], v[32:35], v[200:203], v[140:143]
    ds_read_b128 v[28:31], v3 offset:18560
    v_mul_f32 v248, v248, v48
    v_mfma_f32_16x16x32_bf16 v[108:111], v[36:39], v[204:207], v[108:111]
    s_waitcnt lgkmcnt(2)
    v_mul_f32 v249, v249, v48
    v_mul_f32 v250, v250, v48
    v_mul_f32 v251, v251, v48
    v_mul_f32 v252, v252, v48
    v_mul_f32 v253, v253, v48
    v_mfma_f32_16x16x32_bf16 v[168:171], v[40:43], a[248:251], v[168:171]
    ds_read_b128 v[32:35], v2 offset:12544
    v_cvt_pk_bf16_f32 v248, v248, v249
    v_mfma_f32_16x16x32_bf16 v[168:171], v[44:47], a[252:255], v[168:171]
    v_cvt_pk_bf16_f32 v249, v250, v251
    v_cvt_pk_bf16_f32 v250, v252, v253
    v_accvgpr_read_b32 v224, a25
    v_accvgpr_read_b32 v225, a29
    v_accvgpr_read_b32 v226, a33
    v_mfma_f32_16x16x32_bf16 v[172:175], v[40:43], v[208:211], v[172:175]
    ds_read_b128 v[36:39], v3 offset:12544
    v_accvgpr_read_b32 v227, a37
    v_mfma_f32_16x16x32_bf16 v[172:175], v[44:47], v[212:215], v[172:175]
    s_waitcnt lgkmcnt(2)
    buffer_store_dwordx3 v[248:250], v56, s[12:15], s24 offen offset:192 sc0 sc1
    v_accvgpr_read_b32 v228, a41
    v_mfma_f32_16x16x32_bf16 v[104:107], v[24:27], a[248:251], v[104:107]
    ds_read_b128 v[40:43], v2 offset:18688
    v_accvgpr_read_b32 v229, a45
    v_mfma_f32_16x16x32_bf16 v[104:107], v[28:31], a[252:255], v[104:107]
    v_mul_f32 v224, v224, v49
    v_mul_f32 v225, v225, v49
    v_mul_f32 v226, v226, v49
    v_mul_f32 v227, v227, v49
    v_mul_f32 v228, v228, v49
    v_mul_f32 v229, v229, v49
    v_mfma_f32_16x16x32_bf16 v[108:111], v[24:27], v[208:211], v[108:111]
    ds_read_b128 v[44:47], v3 offset:18688
    v_cvt_pk_bf16_f32 v224, v224, v225
    v_mfma_f32_16x16x32_bf16 v[108:111], v[28:31], v[212:215], v[108:111]
    s_waitcnt lgkmcnt(2)
    v_add_u32 v2, 49152, v2
    v_add_u32 v3, 49152, v3
    v_exp_f32 v16, v160
    v_cvt_pk_bf16_f32 v225, v226, v227
    v_mfma_f32_16x16x32_bf16 v[168:171], v[32:35], v[192:195], v[168:171]
    ds_read_b128 v[24:27], v2 offset:0
    v_cvt_pk_bf16_f32 v226, v228, v229
    v_mfma_f32_16x16x32_bf16 v[168:171], v[36:39], v[196:199], v[168:171]
    buffer_store_dwordx3 v[224:226], v56, s[12:15], s24 offen offset:576 sc0 sc1
    v_accvgpr_read_b32 v230, a26
    v_mfma_f32_16x16x32_bf16 v[172:175], v[32:35], v[216:219], v[172:175]
    ds_read_b128 v[28:31], v3 offset:0
    v_accvgpr_read_b32 v231, a30
    v_mfma_f32_16x16x32_bf16 v[172:175], v[36:39], v[220:223], v[172:175]
    s_waitcnt lgkmcnt(2)
    v_exp_f32 v17, v161
    v_exp_f32 v18, v162
    v_exp_f32 v19, v163
    v_mfma_f32_16x16x32_bf16 v[104:107], v[40:43], v[192:195], v[104:107]
    ds_read_b128 v[32:35], v2 offset:6144
    v_accvgpr_read_b32 v232, a34
    v_mfma_f32_16x16x32_bf16 v[104:107], v[44:47], v[196:199], v[104:107]
    v_cvt_pk_bf16_f32 v160, v16, v17
    v_accvgpr_read_b32 v233, a38
    v_accvgpr_read_b32 v234, a42
    v_exp_f32 v16, v96
    v_mfma_f32_16x16x32_bf16 v[108:111], v[40:43], v[216:219], v[108:111]
    ds_read_b128 v[36:39], v3 offset:6144
    v_accvgpr_read_b32 v235, a46
    v_mfma_f32_16x16x32_bf16 v[108:111], v[44:47], v[220:223], v[108:111]
    s_waitcnt lgkmcnt(2)
    v_mul_f32 v230, v230, v50
    v_exp_f32 v17, v97
    v_mul_f32 v231, v231, v50
    v_mul_f32 v232, v232, v50
    v_mfma_f32_16x16x32_bf16 v[176:179], v[24:27], a[240:243], v[136:139]
    ds_read_b128 v[40:43], v2 offset:128
    v_cvt_pk_bf16_f32 v161, v18, v19
    v_mfma_f32_16x16x32_bf16 v[176:179], v[28:31], a[244:247], v[176:179]
    v_mul_f32 v233, v233, v50
    v_exp_f32 v18, v98
    v_mul_f32 v234, v234, v50
    v_mul_f32 v235, v235, v50
    v_cvt_pk_bf16_f32 v230, v230, v231
    v_mfma_f32_16x16x32_bf16 v[180:183], v[24:27], v[200:203], v[140:143]
    ds_read_b128 v[44:47], v3 offset:128
    v_cvt_pk_bf16_f32 v231, v232, v233
    v_mfma_f32_16x16x32_bf16 v[180:183], v[28:31], v[204:207], v[180:183]
    s_waitcnt lgkmcnt(2)
    v_exp_f32 v19, v99
    v_cvt_pk_bf16_f32 v232, v234, v235
    v_accvgpr_read_b32 v236, a27
    v_cvt_pk_bf16_f32 v162, v16, v17
    v_mfma_f32_16x16x32_bf16 v[112:115], v[32:35], a[240:243], v[136:139]
    ds_read_b128 v[24:27], v2 offset:6272
    v_accvgpr_read_b32 v237, a31
    v_mfma_f32_16x16x32_bf16 v[112:115], v[36:39], a[244:247], v[112:115]
    buffer_store_dwordx3 v[230:232], v56, s[12:15], s24 offen offset:960 sc0 sc1
    v_accvgpr_read_b32 v238, a35
    v_mfma_f32_16x16x32_bf16 v[116:119], v[32:35], v[200:203], v[140:143]
    ds_read_b128 v[28:31], v3 offset:6272
    v_accvgpr_read_b32 v239, a39
    v_mfma_f32_16x16x32_bf16 v[116:119], v[36:39], v[204:207], v[116:119]
    s_waitcnt lgkmcnt(2)
    v_exp_f32 v16, v164
    v_exp_f32 v17, v165
    v_accvgpr_read_b32 v240, a43
    v_accvgpr_read_b32 v241, a47
    v_mfma_f32_16x16x32_bf16 v[176:179], v[40:43], a[248:251], v[176:179]
    ds_read_b128 v[32:35], v2 offset:256
    v_cvt_pk_bf16_f32 v163, v18, v19
    v_mfma_f32_16x16x32_bf16 v[176:179], v[44:47], a[252:255], v[176:179]
    v_exp_f32 v18, v166
    v_mul_f32 v236, v236, v51
    v_mul_f32 v237, v237, v51
    v_mul_f32 v238, v238, v51
    v_mfma_f32_16x16x32_bf16 v[180:183], v[40:43], v[208:211], v[180:183]
    ds_read_b128 v[36:39], v3 offset:256
    v_mul_f32 v239, v239, v51
    v_mfma_f32_16x16x32_bf16 v[180:183], v[44:47], v[212:215], v[180:183]
    s_waitcnt lgkmcnt(2)
    v_exp_f32 v19, v167
    v_mul_f32 v240, v240, v51
    v_mul_f32 v241, v241, v51
    v_cvt_pk_bf16_f32 v236, v236, v237
    v_mfma_f32_16x16x32_bf16 v[112:115], v[24:27], a[248:251], v[112:115]
    ds_read_b128 v[40:43], v2 offset:6400
    v_cvt_pk_bf16_f32 v237, v238, v239
    v_mfma_f32_16x16x32_bf16 v[112:115], v[28:31], a[252:255], v[112:115]
    v_mfma_f32_16x16x32_bf16 v[128:131], v[160:163], v[20:23], v[128:131]
    v_cvt_pk_bf16_f32 v164, v16, v17
    v_cvt_pk_bf16_f32 v238, v240, v241
    v_accvgpr_read_b32 v242, a48
    v_mfma_f32_16x16x32_bf16 v[116:119], v[24:27], v[208:211], v[116:119]
    ds_read_b128 v[44:47], v3 offset:6400
    v_accvgpr_read_b32 v243, a52
    v_mfma_f32_16x16x32_bf16 v[116:119], v[28:31], v[212:215], v[116:119]
    s_waitcnt lgkmcnt(2)
    buffer_store_dwordx3 v[236:238], v56, s[12:15], s24 offen offset:1344 sc0 sc1
    v_exp_f32 v16, v100
    v_mfma_f32_16x16x32_bf16 v[176:179], v[32:35], v[192:195], v[176:179]
    ds_read_b128 v[24:27], v2 offset:12288
    v_accvgpr_read_b32 v244, a56
    v_mfma_f32_16x16x32_bf16 v[176:179], v[36:39], v[196:199], v[176:179]
    v_exp_f32 v17, v101
    v_accvgpr_read_b32 v245, a60
    v_cvt_pk_bf16_f32 v165, v18, v19
    v_accvgpr_read_b32 v246, a64
    v_mfma_f32_16x16x32_bf16 v[180:183], v[32:35], v[216:219], v[180:183]
    ds_read_b128 v[28:31], v3 offset:12288
    v_accvgpr_read_b32 v247, a68
    v_mfma_f32_16x16x32_bf16 v[180:183], v[36:39], v[220:223], v[180:183]
    s_waitcnt lgkmcnt(2)
    v_exp_f32 v18, v102
    v_mul_f32 v242, v242, v52
    v_mul_f32 v243, v243, v52
    v_mul_f32 v244, v244, v52
    v_mfma_f32_16x16x32_bf16 v[112:115], v[40:43], v[192:195], v[112:115]
    ds_read_b128 v[32:35], v2 offset:18432
    v_mul_f32 v245, v245, v52
    v_mfma_f32_16x16x32_bf16 v[112:115], v[44:47], v[196:199], v[112:115]
    v_exp_f32 v19, v103
    v_cvt_pk_bf16_f32 v166, v16, v17
    v_mul_f32 v246, v246, v52
    v_mul_f32 v247, v247, v52
    v_cvt_pk_bf16_f32 v167, v18, v19
    v_mfma_f32_16x16x32_bf16 v[116:119], v[40:43], v[216:219], v[116:119]
    ds_read_b128 v[36:39], v3 offset:18432
    v_cvt_pk_bf16_f32 v242, v242, v243
    v_mfma_f32_16x16x32_bf16 v[116:119], v[44:47], v[220:223], v[116:119]
    s_waitcnt lgkmcnt(2)
    s_nop 1
    v_cvt_pk_bf16_f32 v243, v244, v245
    v_cvt_pk_bf16_f32 v244, v246, v247
    v_accvgpr_read_b32 v248, a49
    v_mfma_f32_16x16x32_bf16 v[184:187], v[24:27], a[240:243], v[136:139]
    ds_read_b128 v[40:43], v2 offset:12416
    v_accvgpr_read_b32 v249, a53
    v_mfma_f32_16x16x32_bf16 v[184:187], v[28:31], a[244:247], v[184:187]
    buffer_store_dwordx3 v[242:244], v56, s[12:15], s40 offen offset:0 sc0 sc1
    v_accvgpr_read_b32 v250, a57
    v_mfma_f32_16x16x32_bf16 v[188:191], v[24:27], v[200:203], v[140:143]
    ds_read_b128 v[44:47], v3 offset:12416
    v_accvgpr_read_b32 v251, a61
    v_mfma_f32_16x16x32_bf16 v[188:191], v[28:31], v[204:207], v[188:191]
    s_waitcnt lgkmcnt(2)
    v_mfma_f32_16x16x32_bf16 v[132:135], v[164:167], v[20:23], v[132:135]
    v_exp_f32 v16, v168
    v_accvgpr_read_b32 v252, a65
    v_accvgpr_read_b32 v253, a69
    v_mfma_f32_16x16x32_bf16 v[120:123], v[32:35], a[240:243], v[136:139]
    ds_read_b128 v[24:27], v2 offset:18560
    v_mul_f32 v248, v248, v53
    v_mfma_f32_16x16x32_bf16 v[120:123], v[36:39], a[244:247], v[120:123]
    v_exp_f32 v17, v169
    v_exp_f32 v18, v170
    v_mul_f32 v249, v249, v53
    v_mfma_f32_16x16x32_bf16 v[124:127], v[32:35], v[200:203], v[140:143]
    ds_read_b128 v[28:31], v3 offset:18560
    v_mul_f32 v250, v250, v53
    v_mfma_f32_16x16x32_bf16 v[124:127], v[36:39], v[204:207], v[124:127]
    s_waitcnt lgkmcnt(2)
    v_exp_f32 v19, v171
    v_mul_f32 v251, v251, v53
    v_mul_f32 v252, v252, v53
    v_mul_f32 v253, v253, v53
    v_mfma_f32_16x16x32_bf16 v[184:187], v[40:43], a[248:251], v[184:187]
    ds_read_b128 v[32:35], v2 offset:12544
    v_cvt_pk_bf16_f32 v168, v16, v17
    v_mfma_f32_16x16x32_bf16 v[184:187], v[44:47], a[252:255], v[184:187]
    v_cvt_pk_bf16_f32 v248, v248, v249
    v_exp_f32 v16, v104
    v_cvt_pk_bf16_f32 v249, v250, v251
    v_cvt_pk_bf16_f32 v250, v252, v253
    v_accvgpr_read_b32 v224, a50
    v_mfma_f32_16x16x32_bf16 v[188:191], v[40:43], v[208:211], v[188:191]
    ds_read_b128 v[36:39], v3 offset:12544
    v_accvgpr_read_b32 v225, a54
    v_mfma_f32_16x16x32_bf16 v[188:191], v[44:47], v[212:215], v[188:191]
    s_waitcnt lgkmcnt(2)
    buffer_store_dwordx3 v[248:250], v56, s[12:15], s40 offen offset:384 sc0 sc1
    v_accvgpr_read_b32 v226, a58
    v_mfma_f32_16x16x32_bf16 v[120:123], v[24:27], a[248:251], v[120:123]
    ds_read_b128 v[40:43], v2 offset:18688
    v_accvgpr_read_b32 v227, a62
    v_mfma_f32_16x16x32_bf16 v[120:123], v[28:31], a[252:255], v[120:123]
    v_exp_f32 v17, v105
    v_cvt_pk_bf16_f32 v169, v18, v19
    v_accvgpr_read_b32 v228, a66
    v_accvgpr_read_b32 v229, a70
    v_mfma_f32_16x16x32_bf16 v[124:127], v[24:27], v[208:211], v[124:127]
    ds_read_b128 v[44:47], v3 offset:18688
    v_mul_f32 v224, v224, v54
    v_mfma_f32_16x16x32_bf16 v[124:127], v[28:31], v[212:215], v[124:127]
    s_waitcnt lgkmcnt(2)
    v_add_u32 v60, 49152, v1
    v_mov_b32 v59, v1
    v_subrev_u32 v1, 49152, v1
    v_exp_f32 v18, v106
    v_mfma_f32_16x16x32_bf16 v[184:187], v[32:35], v[192:195], v[184:187]
    ds_read_b128 v[24:27], v60 offset:0
    v_mul_f32 v225, v225, v54
    v_mfma_f32_16x16x32_bf16 v[184:187], v[36:39], v[196:199], v[184:187]
    v_exp_f32 v19, v107
    v_mul_f32 v226, v226, v54
    v_cvt_pk_bf16_f32 v170, v16, v17
    v_mul_f32 v227, v227, v54
    v_mul_f32 v228, v228, v54
    v_mfma_f32_16x16x32_bf16 v[188:191], v[32:35], v[216:219], v[188:191]
    ds_read_b128 v[28:31], v60 offset:12288
    v_mul_f32 v229, v229, v54
    v_mfma_f32_16x16x32_bf16 v[188:191], v[36:39], v[220:223], v[188:191]
    s_waitcnt lgkmcnt(2)
    v_exp_f32 v16, v172
    v_cvt_pk_bf16_f32 v224, v224, v225
    v_cvt_pk_bf16_f32 v225, v226, v227
    v_cvt_pk_bf16_f32 v226, v228, v229
    v_mfma_f32_16x16x32_bf16 v[120:123], v[40:43], v[192:195], v[120:123]
    ds_read_b128 v[32:35], v60 offset:1024
    v_accvgpr_read_b32 v230, a51
    v_mfma_f32_16x16x32_bf16 v[120:123], v[44:47], v[196:199], v[120:123]
    buffer_store_dwordx3 v[224:226], v56, s[12:15], s40 offen offset:768 sc0 sc1
    v_accvgpr_read_b32 v231, a55
    v_mfma_f32_16x16x32_bf16 v[124:127], v[40:43], v[216:219], v[124:127]
    ds_read_b128 v[36:39], v60 offset:13312
    v_accvgpr_read_b32 v232, a59
    v_mfma_f32_16x16x32_bf16 v[124:127], v[44:47], v[220:223], v[124:127]
    s_waitcnt lgkmcnt(2)
    v_exp_f32 v17, v173
    v_cvt_pk_bf16_f32 v171, v18, v19
    v_exp_f32 v18, v174
    v_accvgpr_read_b32 v233, a63
    v_mfma_f32_16x16x32_bf16 a[96:99], v[80:83], v[24:27], a[96:99]
    ds_read_b128 v[40:43], v60 offset:2048
    v_accvgpr_read_b32 v234, a67
    v_mfma_f32_16x16x32_bf16 a[96:99], v[88:91], v[28:31], a[96:99]
    v_exp_f32 v19, v175
    v_accvgpr_read_b32 v235, a71
    v_mul_f32 v230, v230, v55
    v_mul_f32 v231, v231, v55
    v_mfma_f32_16x16x32_bf16 a[144:147], v[84:87], v[24:27], a[144:147]
    ds_read_b128 v[44:47], v60 offset:14336
    v_mul_f32 v232, v232, v55
    v_mfma_f32_16x16x32_bf16 a[144:147], v[92:95], v[28:31], a[144:147]
    s_waitcnt lgkmcnt(2)
    v_mfma_f32_16x16x32_bf16 v[128:131], v[168:171], v[20:23], v[128:131]
    v_mul_f32 v233, v233, v55
    v_mul_f32 v234, v234, v55
    v_mul_f32 v235, v235, v55
    v_mfma_f32_16x16x32_bf16 a[100:103], v[80:83], v[32:35], a[100:103]
    ds_read_b128 v[24:27], v60 offset:3072
    v_cvt_pk_bf16_f32 v172, v16, v17
    v_mfma_f32_16x16x32_bf16 a[100:103], v[88:91], v[36:39], a[100:103]
    v_exp_f32 v16, v108
    v_cvt_pk_bf16_f32 v230, v230, v231
    v_cvt_pk_bf16_f32 v231, v232, v233
    v_cvt_pk_bf16_f32 v232, v234, v235
    v_accvgpr_read_b32 v236, a72
    v_mfma_f32_16x16x32_bf16 a[148:151], v[84:87], v[32:35], a[148:151]
    ds_read_b128 v[28:31], v60 offset:15360
    v_accvgpr_read_b32 v237, a76
    v_mfma_f32_16x16x32_bf16 a[148:151], v[92:95], v[36:39], a[148:151]
    s_waitcnt lgkmcnt(2)
    buffer_store_dwordx3 v[230:232], v56, s[12:15], s40 offen offset:1152 sc0 sc1
    v_accvgpr_read_b32 v238, a80
    v_mfma_f32_16x16x32_bf16 a[104:107], v[80:83], v[40:43], a[104:107]
    ds_read_b128 v[32:35], v60 offset:4096
    v_accvgpr_read_b32 v239, a84
    v_mfma_f32_16x16x32_bf16 a[104:107], v[88:91], v[44:47], a[104:107]
    v_exp_f32 v17, v109
    v_cvt_pk_bf16_f32 v173, v18, v19
    v_accvgpr_read_b32 v240, a88
    v_accvgpr_read_b32 v241, a92
    v_mfma_f32_16x16x32_bf16 a[152:155], v[84:87], v[40:43], a[152:155]
    ds_read_b128 v[36:39], v60 offset:16384
    v_mul_f32 v236, v236, v52
    v_mfma_f32_16x16x32_bf16 a[152:155], v[92:95], v[44:47], a[152:155]
    s_waitcnt lgkmcnt(2)
    v_exp_f32 v18, v110
    v_mul_f32 v237, v237, v52
    v_mul_f32 v238, v238, v52
    v_mul_f32 v239, v239, v52
    v_mul_f32 v240, v240, v52
    v_mfma_f32_16x16x32_bf16 a[108:111], v[80:83], v[24:27], a[108:111]
    ds_read_b128 v[40:43], v60 offset:5120
    v_mul_f32 v241, v241, v52
    v_mfma_f32_16x16x32_bf16 a[108:111], v[88:91], v[28:31], a[108:111]
    v_exp_f32 v19, v111
    v_cvt_pk_bf16_f32 v236, v236, v237
    v_cvt_pk_bf16_f32 v237, v238, v239
    v_cvt_pk_bf16_f32 v238, v240, v241
    v_mfma_f32_16x16x32_bf16 a[156:159], v[84:87], v[24:27], a[156:159]
    ds_read_b128 v[44:47], v60 offset:17408
    v_cvt_pk_bf16_f32 v174, v16, v17
    v_mfma_f32_16x16x32_bf16 a[156:159], v[92:95], v[28:31], a[156:159]
    s_waitcnt lgkmcnt(2)
    buffer_store_dwordx3 v[236:238], v56, s[12:15], s40 offen offset:192 sc0 sc1
    v_accvgpr_read_b32 v242, a73
    v_mfma_f32_16x16x32_bf16 a[112:115], v[80:83], v[32:35], a[112:115]
    ds_read_b128 v[24:27], v1 offset:0
    v_cvt_pk_bf16_f32 v175, v18, v19
    v_mfma_f32_16x16x32_bf16 a[112:115], v[88:91], v[36:39], a[112:115]
    s_nop 1
    v_accvgpr_read_b32 v243, a77
    v_accvgpr_read_b32 v244, a81
    v_accvgpr_read_b32 v245, a85
    v_accvgpr_read_b32 v246, a89
    v_mfma_f32_16x16x32_bf16 a[160:163], v[84:87], v[32:35], a[160:163]
    ds_read_b128 v[28:31], v1 offset:12288
    v_accvgpr_read_b32 v247, a93
    v_mfma_f32_16x16x32_bf16 a[160:163], v[92:95], v[36:39], a[160:163]
    s_waitcnt lgkmcnt(2)
    v_mul_f32 v242, v242, v53
    v_mfma_f32_16x16x32_bf16 v[132:135], v[172:175], v[20:23], v[132:135]
    v_exp_f32 v16, v176
    v_mul_f32 v243, v243, v53
    v_mfma_f32_16x16x32_bf16 a[116:119], v[80:83], v[40:43], a[116:119]
    ds_read_b128 v[32:35], v1 offset:1024
    v_mul_f32 v244, v244, v53
    v_mfma_f32_16x16x32_bf16 a[116:119], v[88:91], v[44:47], a[116:119]
    v_exp_f32 v17, v177
    v_exp_f32 v18, v178
    v_mul_f32 v245, v245, v53
    v_mfma_f32_16x16x32_bf16 a[164:167], v[84:87], v[40:43], a[164:167]
    ds_read_b128 v[36:39], v1 offset:13312
    v_mul_f32 v246, v246, v53
    v_mfma_f32_16x16x32_bf16 a[164:167], v[92:95], v[44:47], a[164:167]
    s_waitcnt lgkmcnt(2)
    v_exp_f32 v19, v179
    v_cvt_pk_bf16_f32 v176, v16, v17
    v_exp_f32 v16, v112
    v_mfma_f32_16x16x32_bf16 a[96:99], v[160:163], v[24:27], a[96:99]
    ds_read_b128 v[40:43], v1 offset:2048
    v_mul_f32 v247, v247, v53
    v_mfma_f32_16x16x32_bf16 a[96:99], v[168:171], v[28:31], a[96:99]
    v_exp_f32 v17, v113
    v_cvt_pk_bf16_f32 v177, v18, v19
    v_exp_f32 v18, v114
    v_cvt_pk_bf16_f32 v242, v242, v243
    v_mfma_f32_16x16x32_bf16 a[144:147], v[164:167], v[24:27], a[144:147]
    ds_read_b128 v[44:47], v1 offset:14336
    v_cvt_pk_bf16_f32 v243, v244, v245
    v_mfma_f32_16x16x32_bf16 a[144:147], v[172:175], v[28:31], a[144:147]
    s_waitcnt lgkmcnt(2)
    v_exp_f32 v19, v115
    v_cvt_pk_bf16_f32 v178, v16, v17
    v_exp_f32 v16, v180
    v_mfma_f32_16x16x32_bf16 a[100:103], v[160:163], v[32:35], a[100:103]
    ds_read_b128 v[24:27], v1 offset:3072
    v_cvt_pk_bf16_f32 v244, v246, v247
    v_mfma_f32_16x16x32_bf16 a[100:103], v[168:171], v[36:39], a[100:103]
    buffer_store_dwordx3 v[242:244], v56, s[12:15], s40 offen offset:576 sc0 sc1
    v_accvgpr_read_b32 v248, a74
    v_mfma_f32_16x16x32_bf16 a[148:151], v[164:167], v[32:35], a[148:151]
    ds_read_b128 v[28:31], v1 offset:15360
    v_accvgpr_read_b32 v249, a78
    v_mfma_f32_16x16x32_bf16 a[148:151], v[172:175], v[36:39], a[148:151]
    s_waitcnt lgkmcnt(2)
    v_exp_f32 v17, v181
    v_cvt_pk_bf16_f32 v179, v18, v19
    v_exp_f32 v18, v182
    v_accvgpr_read_b32 v250, a82
    v_mfma_f32_16x16x32_bf16 a[104:107], v[160:163], v[40:43], a[104:107]
    ds_read_b128 v[32:35], v1 offset:4096
    v_accvgpr_read_b32 v251, a86
    v_mfma_f32_16x16x32_bf16 a[104:107], v[168:171], v[44:47], a[104:107]
    v_exp_f32 v19, v183
    v_mfma_f32_16x16x32_bf16 v[128:131], v[176:179], v[20:23], v[128:131]
    v_cvt_pk_bf16_f32 v180, v16, v17
    v_mfma_f32_16x16x32_bf16 a[152:155], v[164:167], v[40:43], a[152:155]
    ds_read_b128 v[36:39], v1 offset:16384
    v_accvgpr_read_b32 v252, a90
    v_mfma_f32_16x16x32_bf16 a[152:155], v[172:175], v[44:47], a[152:155]
    s_waitcnt lgkmcnt(2)
    v_exp_f32 v16, v116
    v_exp_f32 v17, v117
    v_cvt_pk_bf16_f32 v181, v18, v19
    v_mfma_f32_16x16x32_bf16 a[108:111], v[160:163], v[24:27], a[108:111]
L_pg13:
    s_cbranch_execz L_iwret
    ds_read_b128 v[40:43], v1 offset:5120
    v_accvgpr_read_b32 v253, a94
    v_mfma_f32_16x16x32_bf16 a[108:111], v[168:171], v[28:31], a[108:111]
    v_exp_f32 v18, v118
    v_exp_f32 v19, v119
    v_cvt_pk_bf16_f32 v182, v16, v17
    v_cvt_pk_bf16_f32 v183, v18, v19
    v_mfma_f32_16x16x32_bf16 a[156:159], v[164:167], v[24:27], a[156:159]
    s_nop 1
    ds_read_b128 v[44:47], v1 offset:17408
    v_mfma_f32_16x16x32_bf16 a[156:159], v[172:175], v[28:31], a[156:159]
    s_waitcnt lgkmcnt(2)
    v_mfma_f32_16x16x32_bf16 v[132:135], v[180:183], v[20:23], v[132:135]
    v_exp_f32 v16, v184
    v_mul_f32 v248, v248, v54
    v_mfma_f32_16x16x32_bf16 a[112:115], v[160:163], v[32:35], a[112:115]
    ds_read_b128 v[24:27], v59 offset:0
    v_mul_f32 v249, v249, v54
    v_mfma_f32_16x16x32_bf16 a[112:115], v[168:171], v[36:39], a[112:115]
    v_exp_f32 v17, v185
    v_exp_f32 v18, v186
    v_mul_f32 v250, v250, v54
    v_mfma_f32_16x16x32_bf16 a[160:163], v[164:167], v[32:35], a[160:163]
    ds_read_b128 v[28:31], v59 offset:12288
    v_mul_f32 v251, v251, v54
    v_mfma_f32_16x16x32_bf16 a[160:163], v[172:175], v[36:39], a[160:163]
    s_waitcnt lgkmcnt(2)
    v_exp_f32 v19, v187
    v_cvt_pk_bf16_f32 v184, v16, v17
    v_exp_f32 v16, v120
    v_exp_f32 v17, v121
    v_cvt_pk_bf16_f32 v185, v18, v19
    v_exp_f32 v18, v122
    v_exp_f32 v19, v123
    v_cvt_pk_bf16_f32 v186, v16, v17
    v_exp_f32 v16, v188
    v_exp_f32 v17, v189
    v_cvt_pk_bf16_f32 v187, v18, v19
    v_exp_f32 v18, v190
    v_exp_f32 v19, v191
    v_mfma_f32_16x16x32_bf16 v[128:131], v[184:187], v[20:23], v[128:131]
    v_cvt_pk_bf16_f32 v188, v16, v17
    v_exp_f32 v16, v124
    v_exp_f32 v17, v125
    v_cvt_pk_bf16_f32 v189, v18, v19
    v_exp_f32 v18, v126
    v_exp_f32 v19, v127
    v_cvt_pk_bf16_f32 v190, v16, v17
    v_cvt_pk_bf16_f32 v191, v18, v19
    s_nop 1
    v_mfma_f32_16x16x32_bf16 v[132:135], v[188:191], v[20:23], v[132:135]
    v_mfma_f32_16x16x32_bf16 a[116:119], v[160:163], v[40:43], a[116:119]
    ds_read_b128 v[32:35], v59 offset:1024
    v_mul_f32 v252, v252, v54
    v_mfma_f32_16x16x32_bf16 a[116:119], v[168:171], v[44:47], a[116:119]
    v_mul_f32 v253, v253, v54
    v_cvt_pk_bf16_f32 v248, v248, v249
    v_cvt_pk_bf16_f32 v249, v250, v251
    v_cvt_pk_bf16_f32 v250, v252, v253
    v_accvgpr_read_b32 v224, a75
    v_mfma_f32_16x16x32_bf16 a[164:167], v[164:167], v[40:43], a[164:167]
    ds_read_b128 v[36:39], v59 offset:13312
    v_accvgpr_read_b32 v225, a79
    v_mfma_f32_16x16x32_bf16 a[164:167], v[172:175], v[44:47], a[164:167]
    s_waitcnt lgkmcnt(2)
    buffer_store_dwordx3 v[248:250], v56, s[12:15], s40 offen offset:960 sc0 sc1
    v_accvgpr_read_b32 v226, a83
    v_accvgpr_read_b32 v227, a87
    v_mfma_f32_16x16x4_f32 v[128:131], v7, v57, v[128:131]
    v_mfma_f32_16x16x32_bf16 a[96:99], v[176:179], v[24:27], a[96:99]
    ds_read_b128 v[40:43], v59 offset:2048
    v_accvgpr_read_b32 v228, a91
    v_mfma_f32_16x16x32_bf16 a[96:99], v[184:187], v[28:31], a[96:99]
    v_accvgpr_read_b32 v229, a95
    v_mul_f32 v224, v224, v55
    v_mul_f32 v225, v225, v55
    v_mul_f32 v226, v226, v55
    v_mul_f32 v227, v227, v55
    v_mul_f32 v228, v228, v55
    v_mfma_f32_16x16x4_f32 v[132:135], v8, v57, v[132:135]
    v_mfma_f32_16x16x32_bf16 a[144:147], v[180:183], v[24:27], a[144:147]
    ds_read_b128 v[44:47], v59 offset:14336
    v_mul_f32 v229, v229, v55
    v_mfma_f32_16x16x32_bf16 a[144:147], v[188:191], v[28:31], a[144:147]
    s_waitcnt lgkmcnt(2)
    v_cvt_pk_bf16_f32 v224, v224, v225
    v_cvt_pk_bf16_f32 v225, v226, v227
    v_cvt_pk_bf16_f32 v226, v228, v229
    v_mfma_f32_16x16x32_bf16 a[100:103], v[176:179], v[32:35], a[100:103]
    ds_read_b128 v[24:27], v59 offset:3072
    v_mfma_f32_16x16x32_bf16 a[100:103], v[184:187], v[36:39], a[100:103]
    buffer_store_dwordx3 v[224:226], v56, s[12:15], s40 offen offset:1344 sc0 sc1
    v_mfma_f32_16x16x32_bf16 a[148:151], v[180:183], v[32:35], a[148:151]
    ds_read_b128 v[28:31], v59 offset:15360
    v_max3_f32 v18, v5, v6, v128
    v_mfma_f32_16x16x32_bf16 a[148:151], v[188:191], v[36:39], a[148:151]
    s_waitcnt lgkmcnt(2)
    v_max3_f32 v18, v18, v129, v130
    v_max3_f32 v18, v18, v131, v132
    v_max3_f32 v18, v18, v133, v134
    v_max_f32 v18, v18, v135
    s_mov_b32 s29, 0x5f800000
    v_cmp_lt_f32 s[48:49], s29, v18
    v_rcp_f32 v128, v128
    v_mfma_f32_16x16x32_bf16 a[104:107], v[176:179], v[40:43], a[104:107]
    ds_read_b128 v[32:35], v59 offset:4096
    v_mfma_f32_16x16x32_bf16 a[104:107], v[184:187], v[44:47], a[104:107]
    v_rcp_f32 v129, v129
    v_rcp_f32 v130, v130
    v_rcp_f32 v131, v131
    v_mfma_f32_16x16x32_bf16 a[152:155], v[180:183], v[40:43], a[152:155]
    ds_read_b128 v[36:39], v59 offset:16384
    v_mfma_f32_16x16x32_bf16 a[152:155], v[188:191], v[44:47], a[152:155]
    s_waitcnt lgkmcnt(2)
    v_rcp_f32 v132, v132
    v_rcp_f32 v133, v133
    v_mfma_f32_16x16x32_bf16 a[108:111], v[176:179], v[24:27], a[108:111]
    ds_read_b128 v[40:43], v59 offset:5120
    v_mfma_f32_16x16x32_bf16 a[108:111], v[184:187], v[28:31], a[108:111]
    v_rcp_f32 v134, v134
    v_rcp_f32 v135, v135
    v_mfma_f32_16x16x32_bf16 a[156:159], v[180:183], v[24:27], a[156:159]
    ds_read_b128 v[44:47], v59 offset:17408
    v_mfma_f32_16x16x32_bf16 a[156:159], v[188:191], v[28:31], a[156:159]
    s_waitcnt lgkmcnt(2)
    v_mfma_f32_16x16x32_bf16 a[112:115], v[176:179], v[32:35], a[112:115]
    ds_read_b128 v[24:27], v60 offset:6144
    v_mfma_f32_16x16x32_bf16 a[112:115], v[184:187], v[36:39], a[112:115]
    v_mfma_f32_16x16x32_bf16 a[160:163], v[180:183], v[32:35], a[160:163]
    ds_read_b128 v[28:31], v60 offset:18432
    v_mfma_f32_16x16x32_bf16 a[160:163], v[188:191], v[36:39], a[160:163]
    s_waitcnt lgkmcnt(2)
    s_cmp_lg_u64 s[48:49], 0
    s_cbranch_scc1 L_slow
    v_mfma_f32_16x16x32_bf16 a[116:119], v[176:179], v[40:43], a[116:119]
    ds_read_b128 v[32:35], v60 offset:7168
    v_mfma_f32_16x16x32_bf16 a[116:119], v[184:187], v[44:47], a[116:119]
    v_mfma_f32_16x16x32_bf16 a[164:167], v[180:183], v[40:43], a[164:167]
    ds_read_b128 v[36:39], v60 offset:19456
    v_mfma_f32_16x16x32_bf16 a[164:167], v[188:191], v[44:47], a[164:167]
    s_waitcnt lgkmcnt(2)
    v_mfma_f32_16x16x32_bf16 a[120:123], v[80:83], v[24:27], a[120:123]
    ds_read_b128 v[40:43], v60 offset:8192
    v_mfma_f32_16x16x32_bf16 a[120:123], v[88:91], v[28:31], a[120:123]
    v_mfma_f32_16x16x32_bf16 a[168:171], v[84:87], v[24:27], a[168:171]
    ds_read_b128 v[44:47], v60 offset:20480
    v_mfma_f32_16x16x32_bf16 a[168:171], v[92:95], v[28:31], a[168:171]
    s_waitcnt lgkmcnt(2)
    v_mfma_f32_16x16x32_bf16 a[124:127], v[80:83], v[32:35], a[124:127]
    ds_read_b128 v[24:27], v1 offset:6144
    v_accvgpr_read_b32 v230, a96
    v_mfma_f32_16x16x32_bf16 a[124:127], v[88:91], v[36:39], a[124:127]
    v_accvgpr_read_b32 v231, a100
    v_accvgpr_read_b32 v232, a104
    v_accvgpr_read_b32 v233, a108
    v_accvgpr_read_b32 v234, a112
    v_accvgpr_read_b32 v235, a116
    v_mul_f32 v230, v230, v128
    v_mul_f32 v231, v231, v128
    v_mul_f32 v232, v232, v128
    v_mul_f32 v233, v233, v128
    v_mul_f32 v234, v234, v128
    v_mul_f32 v235, v235, v128
    v_cvt_pk_bf16_f32 v230, v230, v231
    v_cvt_pk_bf16_f32 v231, v232, v233
    v_cvt_pk_bf16_f32 v232, v234, v235
    v_accvgpr_read_b32 v236, a97
    v_accvgpr_read_b32 v237, a101
    v_accvgpr_read_b32 v238, a105
    v_accvgpr_read_b32 v239, a109
    v_accvgpr_read_b32 v240, a113
    v_accvgpr_read_b32 v241, a117
    v_mul_f32 v236, v236, v129
    v_mul_f32 v237, v237, v129
    v_mul_f32 v238, v238, v129
    v_mul_f32 v239, v239, v129
    v_mul_f32 v240, v240, v129
    v_mul_f32 v241, v241, v129
    v_cvt_pk_bf16_f32 v236, v236, v237
    v_cvt_pk_bf16_f32 v237, v238, v239
    v_cvt_pk_bf16_f32 v238, v240, v241
    v_accvgpr_read_b32 v242, a98
    v_mfma_f32_16x16x32_bf16 a[172:175], v[84:87], v[32:35], a[172:175]
    ds_read_b128 v[28:31], v1 offset:18432
    v_accvgpr_read_b32 v243, a102
    v_mfma_f32_16x16x32_bf16 a[172:175], v[92:95], v[36:39], a[172:175]
    s_waitcnt lgkmcnt(2)
    buffer_store_dwordx3 v[230:232], v56, s[12:15], s41 offen offset:0 sc0 sc1
    v_accvgpr_read_b32 v244, a106
    v_mfma_f32_16x16x32_bf16 a[128:131], v[80:83], v[40:43], a[128:131]
    ds_read_b128 v[32:35], v1 offset:7168
    v_accvgpr_read_b32 v245, a110
    v_mfma_f32_16x16x32_bf16 a[128:131], v[88:91], v[44:47], a[128:131]
    buffer_store_dwordx3 v[236:238], v56, s[12:15], s41 offen offset:384 sc0 sc1
    v_accvgpr_read_b32 v246, a114
    v_mfma_f32_16x16x32_bf16 a[176:179], v[84:87], v[40:43], a[176:179]
    ds_read_b128 v[36:39], v1 offset:19456
    v_accvgpr_read_b32 v247, a118
    v_mfma_f32_16x16x32_bf16 a[176:179], v[92:95], v[44:47], a[176:179]
    s_waitcnt lgkmcnt(2)
    v_mul_f32 v242, v242, v130
    v_mul_f32 v243, v243, v130
    v_mul_f32 v244, v244, v130
    v_mul_f32 v245, v245, v130
    v_mul_f32 v246, v246, v130
    v_mul_f32 v247, v247, v130
    v_mfma_f32_16x16x32_bf16 a[120:123], v[160:163], v[24:27], a[120:123]
    ds_read_b128 v[40:43], v1 offset:8192
    v_cvt_pk_bf16_f32 v242, v242, v243
    v_mfma_f32_16x16x32_bf16 a[120:123], v[168:171], v[28:31], a[120:123]
    v_cvt_pk_bf16_f32 v243, v244, v245
    v_cvt_pk_bf16_f32 v244, v246, v247
    v_accvgpr_read_b32 v248, a99
    v_accvgpr_read_b32 v249, a103
    v_accvgpr_read_b32 v250, a107
    v_mfma_f32_16x16x32_bf16 a[168:171], v[164:167], v[24:27], a[168:171]
    ds_read_b128 v[44:47], v1 offset:20480
    v_accvgpr_read_b32 v251, a111
    v_mfma_f32_16x16x32_bf16 a[168:171], v[172:175], v[28:31], a[168:171]
    s_waitcnt lgkmcnt(2)
    buffer_store_dwordx3 v[242:244], v56, s[12:15], s41 offen offset:768 sc0 sc1
    v_accvgpr_read_b32 v252, a115
    v_mfma_f32_16x16x32_bf16 a[124:127], v[160:163], v[32:35], a[124:127]
    ds_read_b128 v[24:27], v59 offset:6144
    v_accvgpr_read_b32 v253, a119
    v_mfma_f32_16x16x32_bf16 a[124:127], v[168:171], v[36:39], a[124:127]
    v_mul_f32 v248, v248, v131
    v_mul_f32 v249, v249, v131
    v_mul_f32 v250, v250, v131
    v_mul_f32 v251, v251, v131
    v_mul_f32 v252, v252, v131
    v_mul_f32 v253, v253, v131
    v_mfma_f32_16x16x32_bf16 a[172:175], v[164:167], v[32:35], a[172:175]
    ds_read_b128 v[28:31], v59 offset:18432
    v_cvt_pk_bf16_f32 v248, v248, v249
    v_mfma_f32_16x16x32_bf16 a[172:175], v[172:175], v[36:39], a[172:175]
    s_waitcnt lgkmcnt(2)
    v_cvt_pk_bf16_f32 v249, v250, v251
    v_cvt_pk_bf16_f32 v250, v252, v253
    v_accvgpr_read_b32 v224, a144
    v_accvgpr_read_b32 v225, a148
    v_accvgpr_read_b32 v226, a152
    v_mfma_f32_16x16x32_bf16 a[128:131], v[160:163], v[40:43], a[128:131]
    ds_read_b128 v[32:35], v59 offset:7168
    v_accvgpr_read_b32 v227, a156
    v_mfma_f32_16x16x32_bf16 a[128:131], v[168:171], v[44:47], a[128:131]
    buffer_store_dwordx3 v[248:250], v56, s[12:15], s41 offen offset:1152 sc0 sc1
    v_accvgpr_read_b32 v228, a160
    v_mfma_f32_16x16x32_bf16 a[176:179], v[164:167], v[40:43], a[176:179]
    ds_read_b128 v[36:39], v59 offset:19456
    v_accvgpr_read_b32 v229, a164
    v_mfma_f32_16x16x32_bf16 a[176:179], v[172:175], v[44:47], a[176:179]
    s_waitcnt lgkmcnt(2)
    v_mul_f32 v224, v224, v132
    v_mul_f32 v225, v225, v132
    v_mul_f32 v226, v226, v132
    v_mul_f32 v227, v227, v132
    v_mul_f32 v228, v228, v132
    v_mul_f32 v229, v229, v132
    v_mfma_f32_16x16x32_bf16 a[120:123], v[176:179], v[24:27], a[120:123]
    ds_read_b128 v[40:43], v59 offset:8192
    v_cvt_pk_bf16_f32 v224, v224, v225
    v_mfma_f32_16x16x32_bf16 a[120:123], v[184:187], v[28:31], a[120:123]
    v_cvt_pk_bf16_f32 v225, v226, v227
    v_cvt_pk_bf16_f32 v226, v228, v229
    v_accvgpr_read_b32 v230, a145
    v_accvgpr_read_b32 v231, a149
    v_accvgpr_read_b32 v232, a153
    v_mfma_f32_16x16x32_bf16 a[168:171], v[180:183], v[24:27], a[168:171]
    ds_read_b128 v[44:47], v59 offset:20480
    v_accvgpr_read_b32 v233, a157
    v_mfma_f32_16x16x32_bf16 a[168:171], v[188:191], v[28:31], a[168:171]
    s_waitcnt lgkmcnt(2)
    buffer_store_dwordx3 v[224:226], v56, s[12:15], s42 offen offset:0 sc0 sc1
    v_accvgpr_read_b32 v234, a161
    v_mfma_f32_16x16x32_bf16 a[124:127], v[176:179], v[32:35], a[124:127]
    ds_read_b128 v[24:27], v60 offset:9216
    v_accvgpr_read_b32 v235, a165
    v_mfma_f32_16x16x32_bf16 a[124:127], v[184:187], v[36:39], a[124:127]
    v_mul_f32 v230, v230, v133
    v_mul_f32 v231, v231, v133
    v_mul_f32 v232, v232, v133
    v_mul_f32 v233, v233, v133
    v_mul_f32 v234, v234, v133
    v_mul_f32 v235, v235, v133
    v_mfma_f32_16x16x32_bf16 a[172:175], v[180:183], v[32:35], a[172:175]
    ds_read_b128 v[28:31], v60 offset:21504
    v_cvt_pk_bf16_f32 v230, v230, v231
    v_mfma_f32_16x16x32_bf16 a[172:175], v[188:191], v[36:39], a[172:175]
    s_waitcnt lgkmcnt(2)
    v_cvt_pk_bf16_f32 v231, v232, v233
    v_cvt_pk_bf16_f32 v232, v234, v235
    v_accvgpr_read_b32 v236, a146
    v_accvgpr_read_b32 v237, a150
    v_accvgpr_read_b32 v238, a154
    v_mfma_f32_16x16x32_bf16 a[128:131], v[176:179], v[40:43], a[128:131]
    ds_read_b128 v[32:35], v60 offset:10240
    v_accvgpr_read_b32 v239, a158
    v_mfma_f32_16x16x32_bf16 a[128:131], v[184:187], v[44:47], a[128:131]
    buffer_store_dwordx3 v[230:232], v56, s[12:15], s42 offen offset:384 sc0 sc1
    v_accvgpr_read_b32 v240, a162
    v_mfma_f32_16x16x32_bf16 a[176:179], v[180:183], v[40:43], a[176:179]
    ds_read_b128 v[36:39], v60 offset:22528
    v_accvgpr_read_b32 v241, a166
    v_mfma_f32_16x16x32_bf16 a[176:179], v[188:191], v[44:47], a[176:179]
    s_waitcnt lgkmcnt(2)
    v_mul_f32 v236, v236, v134
    v_mul_f32 v237, v237, v134
    v_mul_f32 v238, v238, v134
    v_mul_f32 v239, v239, v134
    v_mul_f32 v240, v240, v134
    v_mfma_f32_16x16x32_bf16 a[132:135], v[80:83], v[24:27], a[132:135]
    ds_read_b128 v[40:43], v60 offset:11264
    v_mul_f32 v241, v241, v134
    v_mfma_f32_16x16x32_bf16 a[132:135], v[88:91], v[28:31], a[132:135]
    v_cvt_pk_bf16_f32 v236, v236, v237
    v_cvt_pk_bf16_f32 v237, v238, v239
    v_cvt_pk_bf16_f32 v238, v240, v241
    v_accvgpr_read_b32 v242, a147
    v_accvgpr_read_b32 v243, a151
    v_accvgpr_read_b32 v244, a155
    v_mfma_f32_16x16x32_bf16 a[180:183], v[84:87], v[24:27], a[180:183]
    ds_read_b128 v[44:47], v60 offset:23552
    v_accvgpr_read_b32 v245, a159
    v_mfma_f32_16x16x32_bf16 a[180:183], v[92:95], v[28:31], a[180:183]
    s_waitcnt lgkmcnt(2)
    buffer_store_dwordx3 v[236:238], v56, s[12:15], s42 offen offset:768 sc0 sc1
    v_accvgpr_read_b32 v246, a163
    v_mfma_f32_16x16x32_bf16 a[136:139], v[80:83], v[32:35], a[136:139]
    ds_read_b128 v[24:27], v1 offset:9216
    v_accvgpr_read_b32 v96, a120
    v_mfma_f32_16x16x32_bf16 a[136:139], v[88:91], v[36:39], a[136:139]
    v_accvgpr_read_b32 v97, a124
    v_accvgpr_read_b32 v98, a128
    v_mul_f32 v96, v96, v128
    v_mul_f32 v97, v97, v128
    v_mul_f32 v98, v98, v128
    v_mfma_f32_16x16x32_bf16 a[184:187], v[84:87], v[32:35], a[184:187]
    ds_read_b128 v[28:31], v1 offset:21504
    v_accvgpr_read_b32 v102, a121
    v_mfma_f32_16x16x32_bf16 a[184:187], v[92:95], v[36:39], a[184:187]
    s_waitcnt lgkmcnt(2)
    v_accvgpr_read_b32 v103, a125
    v_accvgpr_read_b32 v104, a129
    v_mul_f32 v102, v102, v129
    v_mul_f32 v103, v103, v129
    v_mul_f32 v104, v104, v129
    v_accvgpr_read_b32 v108, a122
    v_mfma_f32_16x16x32_bf16 a[140:143], v[80:83], v[40:43], a[140:143]
    ds_read_b128 v[32:35], v1 offset:10240
    v_accvgpr_read_b32 v109, a126
    v_mfma_f32_16x16x32_bf16 a[140:143], v[88:91], v[44:47], a[140:143]
    v_accvgpr_read_b32 v110, a130
    v_mul_f32 v108, v108, v130
    v_mul_f32 v109, v109, v130
    v_mul_f32 v110, v110, v130
    v_accvgpr_read_b32 v114, a123
    v_mfma_f32_16x16x32_bf16 a[188:191], v[84:87], v[40:43], a[188:191]
    ds_read_b128 v[36:39], v1 offset:22528
    v_accvgpr_read_b32 v115, a127
    v_mfma_f32_16x16x32_bf16 a[188:191], v[92:95], v[44:47], a[188:191]
    s_waitcnt lgkmcnt(2)
    v_accvgpr_read_b32 v116, a131
    v_mul_f32 v114, v114, v131
    v_mul_f32 v115, v115, v131
    v_mul_f32 v116, v116, v131
    v_accvgpr_read_b32 v120, a168
    v_mfma_f32_16x16x32_bf16 a[132:135], v[160:163], v[24:27], a[132:135]
    ds_read_b128 v[40:43], v1 offset:11264
    v_accvgpr_read_b32 v121, a172
    v_mfma_f32_16x16x32_bf16 a[132:135], v[168:171], v[28:31], a[132:135]
    v_accvgpr_read_b32 v122, a176
    v_mul_f32 v120, v120, v132
    v_mul_f32 v121, v121, v132
    v_mul_f32 v122, v122, v132
    v_accvgpr_read_b32 v64, a169
    v_accvgpr_read_b32 v65, a173
    v_mfma_f32_16x16x32_bf16 a[180:183], v[164:167], v[24:27], a[180:183]
    ds_read_b128 v[44:47], v1 offset:23552
    v_accvgpr_read_b32 v66, a177
    v_mfma_f32_16x16x32_bf16 a[180:183], v[172:175], v[28:31], a[180:183]
    s_waitcnt lgkmcnt(2)
    v_mul_f32 v64, v64, v133
    v_mul_f32 v65, v65, v133
    v_mul_f32 v66, v66, v133
    v_accvgpr_read_b32 v70, a170
    v_accvgpr_read_b32 v71, a174
    v_mfma_f32_16x16x32_bf16 a[136:139], v[160:163], v[32:35], a[136:139]
    ds_read_b128 v[24:27], v59 offset:9216
    v_accvgpr_read_b32 v247, a167
    v_mfma_f32_16x16x32_bf16 a[136:139], v[168:171], v[36:39], a[136:139]
    v_accvgpr_read_b32 v72, a178
    v_mul_f32 v242, v242, v135
    v_mul_f32 v70, v70, v134
    v_mul_f32 v243, v243, v135
    v_mul_f32 v71, v71, v134
    v_mfma_f32_16x16x32_bf16 a[184:187], v[164:167], v[32:35], a[184:187]
    ds_read_b128 v[28:31], v59 offset:21504
    v_mul_f32 v244, v244, v135
    v_mfma_f32_16x16x32_bf16 a[184:187], v[172:175], v[36:39], a[184:187]
    s_waitcnt lgkmcnt(2)
    v_mul_f32 v72, v72, v134
    v_mul_f32 v245, v245, v135
    v_accvgpr_read_b32 v144, a171
    v_mul_f32 v246, v246, v135
    v_accvgpr_read_b32 v145, a175
    v_mul_f32 v247, v247, v135
    v_mfma_f32_16x16x32_bf16 a[140:143], v[160:163], v[40:43], a[140:143]
    ds_read_b128 v[32:35], v59 offset:10240
    v_accvgpr_read_b32 v146, a179
    v_mfma_f32_16x16x32_bf16 a[140:143], v[168:171], v[44:47], a[140:143]
    v_cvt_pk_bf16_f32 v242, v242, v243
    v_mul_f32 v144, v144, v135
    v_cvt_pk_bf16_f32 v243, v244, v245
    v_mul_f32 v145, v145, v135
    v_cvt_pk_bf16_f32 v244, v246, v247
    v_mfma_f32_16x16x32_bf16 a[188:191], v[164:167], v[40:43], a[188:191]
    ds_read_b128 v[36:39], v59 offset:22528
    v_mul_f32 v146, v146, v135
    v_mfma_f32_16x16x32_bf16 a[188:191], v[172:175], v[44:47], a[188:191]
    s_waitcnt lgkmcnt(2)
    buffer_store_dwordx3 v[242:244], v56, s[12:15], s42 offen offset:1152 sc0 sc1
    v_mfma_f32_16x16x32_bf16 a[132:135], v[176:179], v[24:27], a[132:135]
    ds_read_b128 v[40:43], v59 offset:11264
    v_mfma_f32_16x16x32_bf16 a[132:135], v[184:187], v[28:31], a[132:135]
    v_mfma_f32_16x16x32_bf16 a[180:183], v[180:183], v[24:27], a[180:183]
    ds_read_b128 v[44:47], v59 offset:23552
    v_mfma_f32_16x16x32_bf16 a[180:183], v[188:191], v[28:31], a[180:183]
    s_waitcnt lgkmcnt(2)
    v_mfma_f32_16x16x32_bf16 a[136:139], v[176:179], v[32:35], a[136:139]
    v_mfma_f32_16x16x32_bf16 a[136:139], v[184:187], v[36:39], a[136:139]
    v_mfma_f32_16x16x32_bf16 a[184:187], v[180:183], v[32:35], a[184:187]
    v_mfma_f32_16x16x32_bf16 a[184:187], v[188:191], v[36:39], a[184:187]
    s_waitcnt lgkmcnt(0)
    v_mfma_f32_16x16x32_bf16 a[140:143], v[176:179], v[40:43], a[140:143]
    v_mfma_f32_16x16x32_bf16 a[140:143], v[184:187], v[44:47], a[140:143]
    v_mfma_f32_16x16x32_bf16 a[188:191], v[180:183], v[40:43], a[188:191]
    v_mfma_f32_16x16x32_bf16 a[188:191], v[188:191], v[44:47], a[188:191]
    s_nop 7
    v_accvgpr_read_b32 v99, a132
    v_accvgpr_read_b32 v100, a136
    v_accvgpr_read_b32 v101, a140
    v_cvt_pk_bf16_f32 v96, v96, v97
    v_mul_f32 v99, v99, v128
    v_mul_f32 v100, v100, v128
    v_mul_f32 v101, v101, v128
    v_cvt_pk_bf16_f32 v97, v98, v99
    v_cvt_pk_bf16_f32 v98, v100, v101
    buffer_store_dwordx3 v[96:98], v56, s[12:15], s41 offen offset:192 sc0 sc1
    v_accvgpr_read_b32 v105, a133
    v_accvgpr_read_b32 v106, a137
    v_accvgpr_read_b32 v107, a141
    v_cvt_pk_bf16_f32 v102, v102, v103
    v_mul_f32 v105, v105, v129
    v_mul_f32 v106, v106, v129
    v_mul_f32 v107, v107, v129
    v_cvt_pk_bf16_f32 v103, v104, v105
    v_cvt_pk_bf16_f32 v104, v106, v107
    buffer_store_dwordx3 v[102:104], v56, s[12:15], s41 offen offset:576 sc0 sc1
    v_accvgpr_read_b32 v111, a134
    v_accvgpr_read_b32 v112, a138
    v_accvgpr_read_b32 v113, a142
    v_cvt_pk_bf16_f32 v108, v108, v109
    v_mul_f32 v111, v111, v130
    v_mul_f32 v112, v112, v130
    v_mul_f32 v113, v113, v130
    v_cvt_pk_bf16_f32 v109, v110, v111
    v_cvt_pk_bf16_f32 v110, v112, v113
    buffer_store_dwordx3 v[108:110], v56, s[12:15], s41 offen offset:960 sc0 sc1
    v_accvgpr_read_b32 v117, a135
    v_accvgpr_read_b32 v118, a139
    v_accvgpr_read_b32 v119, a143
    v_cvt_pk_bf16_f32 v114, v114, v115
    v_mul_f32 v117, v117, v131
    v_mul_f32 v118, v118, v131
    v_mul_f32 v119, v119, v131
    v_cvt_pk_bf16_f32 v115, v116, v117
    v_cvt_pk_bf16_f32 v116, v118, v119
    buffer_store_dwordx3 v[114:116], v56, s[12:15], s41 offen offset:1344 sc0 sc1
    v_accvgpr_read_b32 v123, a180
    v_accvgpr_read_b32 v124, a184
    v_accvgpr_read_b32 v125, a188
    v_cvt_pk_bf16_f32 v120, v120, v121
    v_mul_f32 v123, v123, v132
    v_mul_f32 v124, v124, v132
    v_mul_f32 v125, v125, v132
    v_cvt_pk_bf16_f32 v121, v122, v123
    v_cvt_pk_bf16_f32 v122, v124, v125
    buffer_store_dwordx3 v[120:122], v56, s[12:15], s42 offen offset:192 sc0 sc1
    v_accvgpr_read_b32 v67, a181
    v_accvgpr_read_b32 v68, a185
    v_accvgpr_read_b32 v69, a189
    v_cvt_pk_bf16_f32 v64, v64, v65
    v_mul_f32 v67, v67, v133
    v_mul_f32 v68, v68, v133
    v_mul_f32 v69, v69, v133
    v_cvt_pk_bf16_f32 v65, v66, v67
    v_cvt_pk_bf16_f32 v66, v68, v69
    buffer_store_dwordx3 v[64:66], v56, s[12:15], s42 offen offset:576 sc0 sc1
    v_accvgpr_read_b32 v73, a182
    v_accvgpr_read_b32 v74, a186
    v_accvgpr_read_b32 v75, a190
    v_cvt_pk_bf16_f32 v70, v70, v71
    v_mul_f32 v73, v73, v134
    v_mul_f32 v74, v74, v134
    v_mul_f32 v75, v75, v134
    v_cvt_pk_bf16_f32 v71, v72, v73
    v_cvt_pk_bf16_f32 v72, v74, v75
    buffer_store_dwordx3 v[70:72], v56, s[12:15], s42 offen offset:960 sc0 sc1
    v_accvgpr_read_b32 v147, a183
    v_accvgpr_read_b32 v148, a187
    v_accvgpr_read_b32 v149, a191
    v_cvt_pk_bf16_f32 v144, v144, v145
    v_mul_f32 v147, v147, v135
    v_mul_f32 v148, v148, v135
    v_mul_f32 v149, v149, v135
    v_cvt_pk_bf16_f32 v145, v146, v147
    v_cvt_pk_bf16_f32 v146, v148, v149
    buffer_store_dwordx3 v[144:146], v56, s[12:15], s42 offen offset:1344 sc0 sc1
L_fin:
L_done:
    s_endpgm
L_pollslow0:
    s_mov_b32 s59, 60
L_pollsm0:
    s_buffer_load_dwordx8 s[48:55], s[20:23], s44 glc
    s_waitcnt lgkmcnt(0)
    s_sub_u32 s48, s48, s92
    s_sub_u32 s49, s49, s92
    s_sub_u32 s50, s50, s92
    s_sub_u32 s51, s51, s92
    s_sub_u32 s52, s52, s92
    s_sub_u32 s53, s53, s92
    s_sub_u32 s54, s54, s92
    s_sub_u32 s55, s55, s92
    s_max_u32 s48, s48, s49
    s_max_u32 s48, s48, s50
    s_max_u32 s48, s48, s51
    s_max_u32 s48, s48, s52
    s_max_u32 s48, s48, s53
    s_max_u32 s48, s48, s54
    s_max_u32 s48, s48, s55
    s_cmp_lt_u32 s48, 16
    s_cbranch_scc1 L_pollok0
    s_sub_u32 s59, s59, 1
    s_cbranch_scc1 L_pollvec0
    s_sleep 1
    s_branch L_pollsm0
L_pollvec0:
    v_bfe_u32 v53, v4, 4, 6
    v_lshlrev_b32 v53, 2, v53
    s_sub_u32 s96, s96, 1
    s_cbranch_scc1 L_pollgiveup0
    s_sleep 2
    buffer_load_dword v52, v53, s[20:23], s44 offen sc1
    s_waitcnt vmcnt(0)
    s_bitcmp1_b32 s92, 9
    s_cbranch_scc1 L_nomix
    v_xor_b32 v53, s92, v52
    v_lshrrev_b32 v53, 5, v53
    v_add_u32 v53, -1, v53
    v_cmp_gt_u32 vcc, 31, v53
    s_nop 1
    s_and_b32 s59, vcc_lo, 0xff
    s_cbranch_scc0 L_nomix
    buffer_store_dwordx4 v[224:227], v11, s[4:7], s33 offen offset:0 sc1
    v_xor_b32 v55, 16, v11
    buffer_store_dwordx4 v[228:231], v55, s[4:7], s33 offen offset:768 sc1
    v_xor_b32 v54, 32, v11
    buffer_store_dwordx4 v[232:235], v54, s[4:7], s33 offen offset:1536 sc1
    v_xor_b32 v55, 48, v11
    buffer_store_dwordx4 v[236:239], v55, s[4:7], s33 offen offset:2304 sc1
    buffer_store_dwordx4 v[112:115], v15, s[4:7], s35 offen offset:0 sc1
    buffer_store_dwordx4 v[116:119], v15, s[4:7], s35 offen offset:1024 sc1
    buffer_store_dwordx4 v[120:123], v15, s[4:7], s35 offen offset:2048 sc1
    s_waitcnt vmcnt(0)
    s_barrier
    s_and_b32 s92, s92, 0xfffffc00
    s_add_u32 s92, s92, 512
    v_mov_b32 v0, s92
    s_add_u32 s92, s92, 1
    s_mov_b32 s44, 32
    v_add_u32 v0, 1, v0
    buffer_store_dword v0, v13, s[20:23], 0 offen offset:32 sc1
    s_branch L_pollvec0
L_nomix:
    v_subrev_u32 v52, s92, v52
    v_cmp_lt_u32 vcc, 15, v52
    s_nop 0
    s_and_b32 s59, vcc_lo, 0xff
    s_cbranch_scc1 L_pollvec0
    s_branch L_pollok0
L_pollgiveup0:
    s_mov_b32 s96, 0
    s_branch L_pollok0
L_pollslow1:
    s_mov_b32 s59, 200
L_pollsm1:
    s_buffer_load_dwordx8 s[48:55], s[20:23], s44 glc
    s_waitcnt lgkmcnt(0)
    s_sub_u32 s48, s48, s92
    s_sub_u32 s49, s49, s92
    s_sub_u32 s50, s50, s92
    s_sub_u32 s51, s51, s92
    s_sub_u32 s52, s52, s92
    s_sub_u32 s53, s53, s92
    s_sub_u32 s54, s54, s92
    s_sub_u32 s55, s55, s92
    s_max_u32 s48, s48, s49
    s_max_u32 s48, s48, s50
    s_max_u32 s48, s48, s51
    s_max_u32 s48, s48, s52
    s_max_u32 s48, s48, s53
    s_max_u32 s48, s48, s54
    s_max_u32 s48, s48, s55
    s_cmp_lt_u32 s48, 16
    s_cbranch_scc1 L_pollok1
    s_sub_u32 s59, s59, 1
    s_cbranch_scc1 L_pollvec1
    s_sleep 1
    s_branch L_pollsm1
L_pollvec1:
    v_bfe_u32 v53, v4, 4, 6
    v_lshlrev_b32 v53, 2, v53
    s_sub_u32 s96, s96, 1
    s_cbranch_scc1 L_pollgiveup1
    s_sleep 2
    buffer_load_dword v52, v53, s[20:23], s44 offen sc1
    s_waitcnt vmcnt(0)
    v_subrev_u32 v52, s92, v52
    v_cmp_lt_u32 vcc, 15, v52
    s_nop 0
    s_and_b32 s59, vcc_lo, 0xff
    s_cbranch_scc1 L_pollvec1
    s_branch L_pollok1
L_pollgiveup1:
    s_mov_b32 s96, 0
    s_branch L_pollok1
L_pollslow2:
    s_mov_b32 s59, 200
L_pollsm2:
    s_buffer_load_dwordx8 s[48:55], s[20:23], s44 glc
    s_waitcnt lgkmcnt(0)
    s_sub_u32 s48, s48, s92
    s_sub_u32 s49, s49, s92
    s_sub_u32 s50, s50, s92
    s_sub_u32 s51, s51, s92
    s_sub_u32 s52, s52, s92
    s_sub_u32 s53, s53, s92
    s_sub_u32 s54, s54, s92
    s_sub_u32 s55, s55, s92
    s_max_u32 s48, s48, s49
    s_max_u32 s48, s48, s50
    s_max_u32 s48, s48, s51
    s_max_u32 s48, s48, s52
    s_max_u32 s48, s48, s53
    s_max_u32 s48, s48, s54
    s_max_u32 s48, s48, s55
    s_cmp_lt_u32 s48, 16
    s_cbranch_scc1 L_pollok2
    s_sub_u32 s59, s59, 1
    s_cbranch_scc1 L_pollvec2
    s_sleep 1
    s_branch L_pollsm2
L_pollvec2:
    v_bfe_u32 v53, v4, 4, 6
    v_lshlrev_b32 v53, 2, v53
    s_sub_u32 s96, s96, 1
    s_cbranch_scc1 L_pollgiveup2
    s_sleep 2
    buffer_load_dword v52, v53, s[20:23], s44 offen sc1
    s_waitcnt vmcnt(0)
    v_subrev_u32 v52, s92, v52
    v_cmp_lt_u32 vcc, 15, v52
    s_nop 0
    s_and_b32 s59, vcc_lo, 0xff
    s_cbranch_scc1 L_pollvec2
    s_branch L_pollok2
L_pollgiveup2:
    s_mov_b32 s96, 0
    s_branch L_pollok2
L_pollslow3:
    s_mov_b32 s59, 200
L_pollsm3:
    s_buffer_load_dwordx8 s[48:55], s[20:23], s44 glc
    s_waitcnt lgkmcnt(0)
    s_sub_u32 s48, s48, s92
    s_sub_u32 s49, s49, s92
    s_sub_u32 s50, s50, s92
    s_sub_u32 s51, s51, s92
    s_sub_u32 s52, s52, s92
    s_sub_u32 s53, s53, s92
    s_sub_u32 s54, s54, s92
    s_sub_u32 s55, s55, s92
    s_max_u32 s48, s48, s49
    s_max_u32 s48, s48, s50
    s_max_u32 s48, s48, s51
    s_max_u32 s48, s48, s52
    s_max_u32 s48, s48, s53
    s_max_u32 s48, s48, s54
    s_max_u32 s48, s48, s55
    s_cmp_lt_u32 s48, 16
    s_cbranch_scc1 L_pollok3
    s_sub_u32 s59, s59, 1
    s_cbranch_scc1 L_pollvec3
    s_sleep 1
    s_branch L_pollsm3
L_pollvec3:
    v_bfe_u32 v53, v4, 4, 6
    v_lshlrev_b32 v53, 2, v53
    s_sub_u32 s96, s96, 1
    s_cbranch_scc1 L_pollgiveup3
    s_sleep 2
    buffer_load_dword v52, v53, s[20:23], s44 offen sc1
    s_waitcnt vmcnt(0)
    v_subrev_u32 v52, s92, v52
    v_cmp_lt_u32 vcc, 15, v52
    s_nop 0
    s_and_b32 s59, vcc_lo, 0xff
    s_cbranch_scc1 L_pollvec3
    s_branch L_pollok3
L_pollgiveup3:
    s_mov_b32 s96, 0
    s_branch L_pollok3
L_pollslow4:
    s_mov_b32 s59, 200
L_pollsm4:
    s_buffer_load_dwordx8 s[48:55], s[20:23], s44 glc
    s_waitcnt lgkmcnt(0)
    s_sub_u32 s48, s48, s92
    s_sub_u32 s49, s49, s92
    s_sub_u32 s50, s50, s92
    s_sub_u32 s51, s51, s92
    s_sub_u32 s52, s52, s92
    s_sub_u32 s53, s53, s92
    s_sub_u32 s54, s54, s92
    s_sub_u32 s55, s55, s92
    s_max_u32 s48, s48, s49
    s_max_u32 s48, s48, s50
    s_max_u32 s48, s48, s51
    s_max_u32 s48, s48, s52
    s_max_u32 s48, s48, s53
    s_max_u32 s48, s48, s54
    s_max_u32 s48, s48, s55
    s_cmp_lt_u32 s48, 16
    s_cbranch_scc1 L_pollok4
    s_sub_u32 s59, s59, 1
    s_cbranch_scc1 L_pollvec4
    s_sleep 1
    s_branch L_pollsm4
L_pollvec4:
    v_bfe_u32 v53, v4, 4, 6
    v_lshlrev_b32 v53, 2, v53
    s_sub_u32 s96, s96, 1
    s_cbranch_scc1 L_pollgiveup4
    s_sleep 2
    buffer_load_dword v52, v53, s[20:23], s44 offen sc1
    s_waitcnt vmcnt(0)
    v_subrev_u32 v52, s92, v52
    v_cmp_lt_u32 vcc, 15, v52
    s_nop 0
    s_and_b32 s59, vcc_lo, 0xff
    s_cbranch_scc1 L_pollvec4
    s_branch L_pollok4
L_pollgiveup4:
    s_mov_b32 s96, 0
    s_branch L_pollok4
L_tagslow:
    s_sub_u32 s96, s96, 1
    s_cbranch_scc1 L_taggiveup
    s_sleep 2
    buffer_load_dword v0, off, s[88:91], s93 sc1
    s_waitcnt vmcnt(0)
    v_readfirstlane_b32 s42, v0
    s_nop 0
    s_cmp_eq_u32 s42, s46
    s_cbranch_scc1 L_tagslow
    s_cmp_eq_u32 s42, 0
    s_cbranch_scc1 L_tagslow
    s_branch L_tagok
L_taggiveup:
    s_mov_b32 s96, 0
    s_branch L_tagok
L_slow:
    s_waitcnt vmcnt(0) lgkmcnt(0)
    s_nop 15
    v_accvgpr_write_b32 a0, 0
    v_accvgpr_write_b32 a1, 0
    v_accvgpr_write_b32 a2, 0
    v_accvgpr_write_b32 a3, 0
    v_accvgpr_write_b32 a4, 0
    v_accvgpr_write_b32 a5, 0
    v_accvgpr_write_b32 a6, 0
    v_accvgpr_write_b32 a7, 0
    v_accvgpr_write_b32 a8, 0
    v_accvgpr_write_b32 a9, 0
    v_accvgpr_write_b32 a10, 0
    v_accvgpr_write_b32 a11, 0
    v_accvgpr_write_b32 a12, 0
    v_accvgpr_write_b32 a13, 0
    v_accvgpr_write_b32 a14, 0
    v_accvgpr_write_b32 a15, 0
    v_accvgpr_write_b32 a16, 0
    v_accvgpr_write_b32 a17, 0
    v_accvgpr_write_b32 a18, 0
    v_accvgpr_write_b32 a19, 0
    v_accvgpr_write_b32 a20, 0
    v_accvgpr_write_b32 a21, 0
    v_accvgpr_write_b32 a22, 0
    v_accvgpr_write_b32 a23, 0
    v_accvgpr_write_b32 a24, 0
    v_accvgpr_write_b32 a25, 0
    v_accvgpr_write_b32 a26, 0
    v_accvgpr_write_b32 a27, 0
    v_accvgpr_write_b32 a28, 0
    v_accvgpr_write_b32 a29, 0
    v_accvgpr_write_b32 a30, 0
    v_accvgpr_write_b32 a31, 0
    v_accvgpr_write_b32 a32, 0
    v_accvgpr_write_b32 a33, 0
    v_accvgpr_write_b32 a34, 0
    v_accvgpr_write_b32 a35, 0
    v_accvgpr_write_b32 a36, 0
    v_accvgpr_write_b32 a37, 0
    v_accvgpr_write_b32 a38, 0
    v_accvgpr_write_b32 a39, 0
    v_accvgpr_write_b32 a40, 0
    v_accvgpr_write_b32 a41, 0
    v_accvgpr_write_b32 a42, 0
    v_accvgpr_write_b32 a43, 0
    v_accvgpr_write_b32 a44, 0
    v_accvgpr_write_b32 a45, 0
    v_accvgpr_write_b32 a46, 0
    v_accvgpr_write_b32 a47, 0
    v_accvgpr_write_b32 a48, 0
    v_accvgpr_write_b32 a49, 0
    v_accvgpr_write_b32 a50, 0
    v_accvgpr_write_b32 a51, 0
    v_accvgpr_write_b32 a52, 0
    v_accvgpr_write_b32 a53, 0
    v_accvgpr_write_b32 a54, 0
    v_accvgpr_write_b32 a55, 0
    v_accvgpr_write_b32 a56, 0
    v_accvgpr_write_b32 a57, 0
    v_accvgpr_write_b32 a58, 0
    v_accvgpr_write_b32 a59, 0
    v_accvgpr_write_b32 a60, 0
    v_accvgpr_write_b32 a61, 0
    v_accvgpr_write_b32 a62, 0
    v_accvgpr_write_b32 a63, 0
    v_accvgpr_write_b32 a64, 0
    v_accvgpr_write_b32 a65, 0
    v_accvgpr_write_b32 a66, 0
    v_accvgpr_write_b32 a67, 0
    v_accvgpr_write_b32 a68, 0
    v_accvgpr_write_b32 a69, 0
    v_accvgpr_write_b32 a70, 0
    v_accvgpr_write_b32 a71, 0
    v_accvgpr_write_b32 a72, 0
    v_accvgpr_write_b32 a73, 0
    v_accvgpr_write_b32 a74, 0
    v_accvgpr_write_b32 a75, 0
    v_accvgpr_write_b32 a76, 0
    v_accvgpr_write_b32 a77, 0
    v_accvgpr_write_b32 a78, 0
    v_accvgpr_write_b32 a79, 0
    v_accvgpr_write_b32 a80, 0
    v_accvgpr_write_b32 a81, 0
    v_accvgpr_write_b32 a82, 0
    v_accvgpr_write_b32 a83, 0
    v_accvgpr_write_b32 a84, 0
    v_accvgpr_write_b32 a85, 0
    v_accvgpr_write_b32 a86, 0
    v_accvgpr_write_b32 a87, 0
    v_accvgpr_write_b32 a88, 0
    v_accvgpr_write_b32 a89, 0
    v_accvgpr_write_b32 a90, 0
    v_accvgpr_write_b32 a91, 0
    v_accvgpr_write_b32 a92, 0
    v_accvgpr_write_b32 a93, 0
    v_accvgpr_write_b32 a94, 0
    v_accvgpr_write_b32 a95, 0
    v_accvgpr_write_b32 a96, 0
    v_accvgpr_write_b32 a97, 0
    v_accvgpr_write_b32 a98, 0
    v_accvgpr_write_b32 a99, 0
    v_accvgpr_write_b32 a100, 0
    v_accvgpr_write_b32 a101, 0
    v_accvgpr_write_b32 a102, 0
    v_accvgpr_write_b32 a103, 0
    v_accvgpr_write_b32 a104, 0
    v_accvgpr_write_b32 a105, 0
    v_accvgpr_write_b32 a106, 0
    v_accvgpr_write_b32 a107, 0
    v_accvgpr_write_b32 a108, 0
    v_accvgpr_write_b32 a109, 0
    v_accvgpr_write_b32 a110, 0
    v_accvgpr_write_b32 a111, 0
    v_accvgpr_write_b32 a112, 0
    v_accvgpr_write_b32 a113, 0
    v_accvgpr_write_b32 a114, 0
    v_accvgpr_write_b32 a115, 0
    v_accvgpr_write_b32 a116, 0
    v_accvgpr_write_b32 a117, 0
    v_accvgpr_write_b32 a118, 0
    v_accvgpr_write_b32 a119, 0
    v_accvgpr_write_b32 a120, 0
    v_accvgpr_write_b32 a121, 0
    v_accvgpr_write_b32 a122, 0
    v_accvgpr_write_b32 a123, 0
    v_accvgpr_write_b32 a124, 0
    v_accvgpr_write_b32 a125, 0
    v_accvgpr_write_b32 a126, 0
    v_accvgpr_write_b32 a127, 0
    v_accvgpr_write_b32 a128, 0
    v_accvgpr_write_b32 a129, 0
    v_accvgpr_write_b32 a130, 0
    v_accvgpr_write_b32 a131, 0
    v_accvgpr_write_b32 a132, 0
    v_accvgpr_write_b32 a133, 0
    v_accvgpr_write_b32 a134, 0
    v_accvgpr_write_b32 a135, 0
    v_accvgpr_write_b32 a136, 0
    v_accvgpr_write_b32 a137, 0
    v_accvgpr_write_b32 a138, 0
    v_accvgpr_write_b32 a139, 0
    v_accvgpr_write_b32 a140, 0
    v_accvgpr_write_b32 a141, 0
    v_accvgpr_write_b32 a142, 0
    v_accvgpr_write_b32 a143, 0
    v_accvgpr_write_b32 a144, 0
    v_accvgpr_write_b32 a145, 0
    v_accvgpr_write_b32 a146, 0
    v_accvgpr_write_b32 a147, 0
    v_accvgpr_write_b32 a148, 0
    v_accvgpr_write_b32 a149, 0
    v_accvgpr_write_b32 a150, 0
    v_accvgpr_write_b32 a151, 0
    v_accvgpr_write_b32 a152, 0
    v_accvgpr_write_b32 a153, 0
    v_accvgpr_write_b32 a154, 0
    v_accvgpr_write_b32 a155, 0
    v_accvgpr_write_b32 a156, 0
    v_accvgpr_write_b32 a157, 0
    v_accvgpr_write_b32 a158, 0
    v_accvgpr_write_b32 a159, 0
    v_accvgpr_write_b32 a160, 0
    v_accvgpr_write_b32 a161, 0
    v_accvgpr_write_b32 a162, 0
    v_accvgpr_write_b32 a163, 0
    v_accvgpr_write_b32 a164, 0
    v_accvgpr_write_b32 a165, 0
    v_accvgpr_write_b32 a166, 0
    v_accvgpr_write_b32 a167, 0
    v_accvgpr_write_b32 a168, 0
    v_accvgpr_write_b32 a169, 0
    v_accvgpr_write_b32 a170, 0
    v_accvgpr_write_b32 a171, 0
    v_accvgpr_write_b32 a172, 0
    v_accvgpr_write_b32 a173, 0
    v_accvgpr_write_b32 a174, 0
    v_accvgpr_write_b32 a175, 0
    v_accvgpr_write_b32 a176, 0
    v_accvgpr_write_b32 a177, 0
    v_accvgpr_write_b32 a178, 0
    v_accvgpr_write_b32 a179, 0
    v_accvgpr_write_b32 a180, 0
    v_accvgpr_write_b32 a181, 0
    v_accvgpr_write_b32 a182, 0
    v_accvgpr_write_b32 a183, 0
    v_accvgpr_write_b32 a184, 0
    v_accvgpr_write_b32 a185, 0
    v_accvgpr_write_b32 a186, 0
    v_accvgpr_write_b32 a187, 0
    v_accvgpr_write_b32 a188, 0
    v_accvgpr_write_b32 a189, 0
    v_accvgpr_write_b32 a190, 0
    v_accvgpr_write_b32 a191, 0
    v_mov_b32 v5, 0
    v_mov_b32 v240, 0xff7fffff
    v_mov_b32 v6, 0
    v_mov_b32 v241, 0xff7fffff
    v_mov_b32 v7, 0
    v_mov_b32 v242, 0xff7fffff
    v_mov_b32 v8, 0
    v_mov_b32 v243, 0xff7fffff
    v_subrev_u32 v244, 49152, v2
    v_subrev_u32 v245, 49152, v3
    v_subrev_u32 v246, 24576, v1
    s_mov_b32 s48, 0
L_slowloop:
    s_add_u32 s49, s48, 6144
    s_add_u32 s50, s48, 12288
    s_add_u32 s51, s48, 16384
    s_add_u32 s52, s48, 20480
    buffer_load_dwordx4 v[64:67], v244, s[4:7], s48 offen offset:0 sc1
    buffer_load_dwordx4 v[68:71], v245, s[4:7], s48 offen offset:0 sc1
    buffer_load_dwordx4 v[72:75], v244, s[4:7], s49 offen offset:0 sc1
    buffer_load_dwordx4 v[76:79], v245, s[4:7], s49 offen offset:0 sc1
    buffer_load_dwordx4 v[80:83], v244, s[4:7], s48 offen offset:128 sc1
    buffer_load_dwordx4 v[84:87], v245, s[4:7], s48 offen offset:128 sc1
    buffer_load_dwordx4 v[88:91], v244, s[4:7], s49 offen offset:128 sc1
    buffer_load_dwordx4 v[92:95], v245, s[4:7], s49 offen offset:128 sc1
    buffer_load_dwordx4 v[96:99], v244, s[4:7], s48 offen offset:256 sc1
    buffer_load_dwordx4 v[100:103], v245, s[4:7], s48 offen offset:256 sc1
    buffer_load_dwordx4 v[104:107], v244, s[4:7], s49 offen offset:256 sc1
    buffer_load_dwordx4 v[108:111], v245, s[4:7], s49 offen offset:256 sc1
    buffer_load_dwordx4 v[112:115], v246, s[4:7], s50 offen offset:0 sc1
    buffer_load_dwordx4 v[116:119], v246, s[4:7], s50 offen offset:1024 sc1
    buffer_load_dwordx4 v[120:123], v246, s[4:7], s50 offen offset:2048 sc1
    buffer_load_dwordx4 v[124:127], v246, s[4:7], s50 offen offset:3072 sc1
    buffer_load_dwordx4 v[128:131], v246, s[4:7], s51 offen offset:0 sc1
    buffer_load_dwordx4 v[132:135], v246, s[4:7], s51 offen offset:1024 sc1
    buffer_load_dwordx4 v[136:139], v246, s[4:7], s51 offen offset:2048 sc1
    buffer_load_dwordx4 v[140:143], v246, s[4:7], s51 offen offset:3072 sc1
    buffer_load_dwordx4 v[144:147], v246, s[4:7], s52 offen offset:0 sc1
    buffer_load_dwordx4 v[148:151], v246, s[4:7], s52 offen offset:1024 sc1
    buffer_load_dwordx4 v[152:155], v246, s[4:7], s52 offen offset:2048 sc1
    buffer_load_dwordx4 v[156:159], v246, s[4:7], s52 offen offset:3072 sc1
    s_waitcnt vmcnt(12)
    v_mfma_f32_16x16x32_bf16 v[160:163], v[64:67], a[192:195], 0
    v_mfma_f32_16x16x32_bf16 v[168:171], v[64:67], a[216:219], 0
    v_mfma_f32_16x16x32_bf16 v[176:179], v[64:67], a[240:243], 0
    v_mfma_f32_16x16x32_bf16 v[184:187], v[64:67], v[200:203], 0
    v_mfma_f32_16x16x32_bf16 v[160:163], v[68:71], a[196:199], v[160:163]
    v_mfma_f32_16x16x32_bf16 v[168:171], v[68:71], a[220:223], v[168:171]
    v_mfma_f32_16x16x32_bf16 v[176:179], v[68:71], a[244:247], v[176:179]
    v_mfma_f32_16x16x32_bf16 v[184:187], v[68:71], v[204:207], v[184:187]
    v_mfma_f32_16x16x32_bf16 v[164:167], v[72:75], a[192:195], 0
    v_mfma_f32_16x16x32_bf16 v[172:175], v[72:75], a[216:219], 0
    v_mfma_f32_16x16x32_bf16 v[180:183], v[72:75], a[240:243], 0
    v_mfma_f32_16x16x32_bf16 v[188:191], v[72:75], v[200:203], 0
    v_mfma_f32_16x16x32_bf16 v[164:167], v[76:79], a[196:199], v[164:167]
    v_mfma_f32_16x16x32_bf16 v[172:175], v[76:79], a[220:223], v[172:175]
    v_mfma_f32_16x16x32_bf16 v[180:183], v[76:79], a[244:247], v[180:183]
    v_mfma_f32_16x16x32_bf16 v[188:191], v[76:79], v[204:207], v[188:191]
    v_mfma_f32_16x16x32_bf16 v[160:163], v[80:83], a[200:203], v[160:163]
    v_mfma_f32_16x16x32_bf16 v[168:171], v[80:83], a[224:227], v[168:171]
    v_mfma_f32_16x16x32_bf16 v[176:179], v[80:83], a[248:251], v[176:179]
    v_mfma_f32_16x16x32_bf16 v[184:187], v[80:83], v[208:211], v[184:187]
    v_mfma_f32_16x16x32_bf16 v[160:163], v[84:87], a[204:207], v[160:163]
    v_mfma_f32_16x16x32_bf16 v[168:171], v[84:87], a[228:231], v[168:171]
    v_mfma_f32_16x16x32_bf16 v[176:179], v[84:87], a[252:255], v[176:179]
    v_mfma_f32_16x16x32_bf16 v[184:187], v[84:87], v[212:215], v[184:187]
    v_mfma_f32_16x16x32_bf16 v[164:167], v[88:91], a[200:203], v[164:167]
    v_mfma_f32_16x16x32_bf16 v[172:175], v[88:91], a[224:227], v[172:175]
    v_mfma_f32_16x16x32_bf16 v[180:183], v[88:91], a[248:251], v[180:183]
    v_mfma_f32_16x16x32_bf16 v[188:191], v[88:91], v[208:211], v[188:191]
    v_mfma_f32_16x16x32_bf16 v[164:167], v[92:95], a[204:207], v[164:167]
    v_mfma_f32_16x16x32_bf16 v[172:175], v[92:95], a[228:231], v[172:175]
    v_mfma_f32_16x16x32_bf16 v[180:183], v[92:95], a[252:255], v[180:183]
    v_mfma_f32_16x16x32_bf16 v[188:191], v[92:95], v[212:215], v[188:191]
    v_mfma_f32_16x16x32_bf16 v[160:163], v[96:99], a[208:211], v[160:163]
    v_mfma_f32_16x16x32_bf16 v[168:171], v[96:99], a[232:235], v[168:171]
    v_mfma_f32_16x16x32_bf16 v[176:179], v[96:99], v[192:195], v[176:179]
    v_mfma_f32_16x16x32_bf16 v[184:187], v[96:99], v[216:219], v[184:187]
    v_mfma_f32_16x16x32_bf16 v[160:163], v[100:103], a[212:215], v[160:163]
    v_mfma_f32_16x16x32_bf16 v[168:171], v[100:103], a[236:239], v[168:171]
    v_mfma_f32_16x16x32_bf16 v[176:179], v[100:103], v[196:199], v[176:179]
    v_mfma_f32_16x16x32_bf16 v[184:187], v[100:103], v[220:223], v[184:187]
    v_mfma_f32_16x16x32_bf16 v[164:167], v[104:107], a[208:211], v[164:167]
    v_mfma_f32_16x16x32_bf16 v[172:175], v[104:107], a[232:235], v[172:175]
    v_mfma_f32_16x16x32_bf16 v[180:183], v[104:107], v[192:195], v[180:183]
    v_mfma_f32_16x16x32_bf16 v[188:191], v[104:107], v[216:219], v[188:191]
    v_mfma_f32_16x16x32_bf16 v[164:167], v[108:111], a[212:215], v[164:167]
    v_mfma_f32_16x16x32_bf16 v[172:175], v[108:111], a[236:239], v[172:175]
    v_mfma_f32_16x16x32_bf16 v[180:183], v[108:111], v[196:199], v[180:183]
    v_mfma_f32_16x16x32_bf16 v[188:191], v[108:111], v[220:223], v[188:191]
    s_nop 9
    v_max3_f32 v16, v160, v161, v162
    v_max3_f32 v16, v16, v163, v164
    v_max3_f32 v16, v16, v165, v166
    v_max3_f32 v16, v16, v167, v240
    v_mov_b32 v17, v16
    s_nop 1
    v_permlane16_swap_b32 v16, v17
    s_nop 1
    v_max_f32 v16, v16, v17
    v_mov_b32 v17, v16
    s_nop 1
    v_permlane32_swap_b32 v16, v17
    s_nop 1
    v_max_f32 v16, v16, v17
    v_sub_f32 v17, v240, v16
    v_exp_f32 v17, v17
    v_mov_b32 v240, v16
    v_sub_f32 v160, v160, v16
    v_sub_f32 v161, v161, v16
    v_sub_f32 v162, v162, v16
    v_sub_f32 v163, v163, v16
    v_sub_f32 v164, v164, v16
    v_sub_f32 v165, v165, v16
    v_sub_f32 v166, v166, v16
    v_sub_f32 v167, v167, v16
    v_exp_f32 v160, v160
    v_exp_f32 v161, v161
    v_exp_f32 v162, v162
    v_exp_f32 v163, v163
    v_exp_f32 v164, v164
    v_exp_f32 v165, v165
    v_exp_f32 v166, v166
    v_exp_f32 v167, v167
    v_mul_f32 v5, v5, v17
    v_add_f32 v5, v5, v160
    v_add_f32 v5, v5, v161
    v_add_f32 v5, v5, v162
    v_add_f32 v5, v5, v163
    v_add_f32 v5, v5, v164
    v_add_f32 v5, v5, v165
    v_add_f32 v5, v5, v166
    v_add_f32 v5, v5, v167
    v_cvt_pk_bf16_f32 v224, v160, v161
    v_cvt_pk_bf16_f32 v225, v162, v163
    v_cvt_pk_bf16_f32 v226, v164, v165
    v_cvt_pk_bf16_f32 v227, v166, v167
    ds_bpermute_b32 v248, v58, v17 offset:0
    ds_bpermute_b32 v249, v58, v17 offset:4
    ds_bpermute_b32 v250, v58, v17 offset:8
    ds_bpermute_b32 v251, v58, v17 offset:12
    s_waitcnt lgkmcnt(0)
    v_accvgpr_read_b32 v18, a0
    v_mul_f32 v18, v18, v248
    v_accvgpr_write_b32 a0, v18
    v_accvgpr_read_b32 v19, a1
    v_mul_f32 v19, v19, v249
    v_accvgpr_write_b32 a1, v19
    v_accvgpr_read_b32 v18, a2
    v_mul_f32 v18, v18, v250
    v_accvgpr_write_b32 a2, v18
    v_accvgpr_read_b32 v19, a3
    v_mul_f32 v19, v19, v251
    v_accvgpr_write_b32 a3, v19
    v_accvgpr_read_b32 v18, a4
    v_mul_f32 v18, v18, v248
    v_accvgpr_write_b32 a4, v18
    v_accvgpr_read_b32 v19, a5
    v_mul_f32 v19, v19, v249
    v_accvgpr_write_b32 a5, v19
    v_accvgpr_read_b32 v18, a6
    v_mul_f32 v18, v18, v250
    v_accvgpr_write_b32 a6, v18
    v_accvgpr_read_b32 v19, a7
    v_mul_f32 v19, v19, v251
    v_accvgpr_write_b32 a7, v19
    v_accvgpr_read_b32 v18, a8
    v_mul_f32 v18, v18, v248
    v_accvgpr_write_b32 a8, v18
    v_accvgpr_read_b32 v19, a9
    v_mul_f32 v19, v19, v249
    v_accvgpr_write_b32 a9, v19
    v_accvgpr_read_b32 v18, a10
    v_mul_f32 v18, v18, v250
    v_accvgpr_write_b32 a10, v18
    v_accvgpr_read_b32 v19, a11
    v_mul_f32 v19, v19, v251
    v_accvgpr_write_b32 a11, v19
    v_accvgpr_read_b32 v18, a12
    v_mul_f32 v18, v18, v248
    v_accvgpr_write_b32 a12, v18
    v_accvgpr_read_b32 v19, a13
    v_mul_f32 v19, v19, v249
    v_accvgpr_write_b32 a13, v19
    v_accvgpr_read_b32 v18, a14
    v_mul_f32 v18, v18, v250
    v_accvgpr_write_b32 a14, v18
    v_accvgpr_read_b32 v19, a15
    v_mul_f32 v19, v19, v251
    v_accvgpr_write_b32 a15, v19
    v_accvgpr_read_b32 v18, a16
    v_mul_f32 v18, v18, v248
    v_accvgpr_write_b32 a16, v18
    v_accvgpr_read_b32 v19, a17
    v_mul_f32 v19, v19, v249
    v_accvgpr_write_b32 a17, v19
    v_accvgpr_read_b32 v18, a18
    v_mul_f32 v18, v18, v250
    v_accvgpr_write_b32 a18, v18
    v_accvgpr_read_b32 v19, a19
    v_mul_f32 v19, v19, v251
    v_accvgpr_write_b32 a19, v19
    v_accvgpr_read_b32 v18, a20
    v_mul_f32 v18, v18, v248
    v_accvgpr_write_b32 a20, v18
    v_accvgpr_read_b32 v19, a21
    v_mul_f32 v19, v19, v249
    v_accvgpr_write_b32 a21, v19
    v_accvgpr_read_b32 v18, a22
    v_mul_f32 v18, v18, v250
    v_accvgpr_write_b32 a22, v18
    v_accvgpr_read_b32 v19, a23
    v_mul_f32 v19, v19, v251
    v_accvgpr_write_b32 a23, v19
    v_accvgpr_read_b32 v18, a24
    v_mul_f32 v18, v18, v248
    v_accvgpr_write_b32 a24, v18
    v_accvgpr_read_b32 v19, a25
    v_mul_f32 v19, v19, v249
    v_accvgpr_write_b32 a25, v19
    v_accvgpr_read_b32 v18, a26
    v_mul_f32 v18, v18, v250
    v_accvgpr_write_b32 a26, v18
    v_accvgpr_read_b32 v19, a27
    v_mul_f32 v19, v19, v251
    v_accvgpr_write_b32 a27, v19
    v_accvgpr_read_b32 v18, a28
    v_mul_f32 v18, v18, v248
    v_accvgpr_write_b32 a28, v18
    v_accvgpr_read_b32 v19, a29
    v_mul_f32 v19, v19, v249
    v_accvgpr_write_b32 a29, v19
    v_accvgpr_read_b32 v18, a30
    v_mul_f32 v18, v18, v250
    v_accvgpr_write_b32 a30, v18
    v_accvgpr_read_b32 v19, a31
    v_mul_f32 v19, v19, v251
    v_accvgpr_write_b32 a31, v19
    v_accvgpr_read_b32 v18, a32
    v_mul_f32 v18, v18, v248
    v_accvgpr_write_b32 a32, v18
    v_accvgpr_read_b32 v19, a33
    v_mul_f32 v19, v19, v249
    v_accvgpr_write_b32 a33, v19
    v_accvgpr_read_b32 v18, a34
    v_mul_f32 v18, v18, v250
    v_accvgpr_write_b32 a34, v18
    v_accvgpr_read_b32 v19, a35
    v_mul_f32 v19, v19, v251
    v_accvgpr_write_b32 a35, v19
    v_accvgpr_read_b32 v18, a36
    v_mul_f32 v18, v18, v248
    v_accvgpr_write_b32 a36, v18
    v_accvgpr_read_b32 v19, a37
    v_mul_f32 v19, v19, v249
    v_accvgpr_write_b32 a37, v19
    v_accvgpr_read_b32 v18, a38
    v_mul_f32 v18, v18, v250
    v_accvgpr_write_b32 a38, v18
    v_accvgpr_read_b32 v19, a39
    v_mul_f32 v19, v19, v251
    v_accvgpr_write_b32 a39, v19
    v_accvgpr_read_b32 v18, a40
    v_mul_f32 v18, v18, v248
    v_accvgpr_write_b32 a40, v18
    v_accvgpr_read_b32 v19, a41
    v_mul_f32 v19, v19, v249
    v_accvgpr_write_b32 a41, v19
    v_accvgpr_read_b32 v18, a42
    v_mul_f32 v18, v18, v250
    v_accvgpr_write_b32 a42, v18
    v_accvgpr_read_b32 v19, a43
    v_mul_f32 v19, v19, v251
    v_accvgpr_write_b32 a43, v19
    v_accvgpr_read_b32 v18, a44
    v_mul_f32 v18, v18, v248
    v_accvgpr_write_b32 a44, v18
    v_accvgpr_read_b32 v19, a45
    v_mul_f32 v19, v19, v249
    v_accvgpr_write_b32 a45, v19
    v_accvgpr_read_b32 v18, a46
    v_mul_f32 v18, v18, v250
    v_accvgpr_write_b32 a46, v18
    v_accvgpr_read_b32 v19, a47
    v_mul_f32 v19, v19, v251
    v_accvgpr_write_b32 a47, v19
    v_max3_f32 v16, v168, v169, v170
    v_max3_f32 v16, v16, v171, v172
    v_max3_f32 v16, v16, v173, v174
    v_max3_f32 v16, v16, v175, v241
    v_mov_b32 v17, v16
    s_nop 1
    v_permlane16_swap_b32 v16, v17
    s_nop 1
    v_max_f32 v16, v16, v17
    v_mov_b32 v17, v16
    s_nop 1
    v_permlane32_swap_b32 v16, v17
    s_nop 1
    v_max_f32 v16, v16, v17
    v_sub_f32 v17, v241, v16
    v_exp_f32 v17, v17
    v_mov_b32 v241, v16
    v_sub_f32 v168, v168, v16
    v_sub_f32 v169, v169, v16
    v_sub_f32 v170, v170, v16
    v_sub_f32 v171, v171, v16
    v_sub_f32 v172, v172, v16
    v_sub_f32 v173, v173, v16
    v_sub_f32 v174, v174, v16
    v_sub_f32 v175, v175, v16
    v_exp_f32 v168, v168
    v_exp_f32 v169, v169
    v_exp_f32 v170, v170
    v_exp_f32 v171, v171
    v_exp_f32 v172, v172
    v_exp_f32 v173, v173
    v_exp_f32 v174, v174
    v_exp_f32 v175, v175
    v_mul_f32 v6, v6, v17
    v_add_f32 v6, v6, v168
    v_add_f32 v6, v6, v169
    v_add_f32 v6, v6, v170
    v_add_f32 v6, v6, v171
    v_add_f32 v6, v6, v172
    v_add_f32 v6, v6, v173
    v_add_f32 v6, v6, v174
    v_add_f32 v6, v6, v175
    v_cvt_pk_bf16_f32 v228, v168, v169
    v_cvt_pk_bf16_f32 v229, v170, v171
    v_cvt_pk_bf16_f32 v230, v172, v173
    v_cvt_pk_bf16_f32 v231, v174, v175
    ds_bpermute_b32 v248, v58, v17 offset:0
    ds_bpermute_b32 v249, v58, v17 offset:4
    ds_bpermute_b32 v250, v58, v17 offset:8
    ds_bpermute_b32 v251, v58, v17 offset:12
    s_waitcnt lgkmcnt(0)
    v_accvgpr_read_b32 v18, a48
    v_mul_f32 v18, v18, v248
    v_accvgpr_write_b32 a48, v18
    v_accvgpr_read_b32 v19, a49
    v_mul_f32 v19, v19, v249
    v_accvgpr_write_b32 a49, v19
    v_accvgpr_read_b32 v18, a50
    v_mul_f32 v18, v18, v250
    v_accvgpr_write_b32 a50, v18
    v_accvgpr_read_b32 v19, a51
    v_mul_f32 v19, v19, v251
    v_accvgpr_write_b32 a51, v19
    v_accvgpr_read_b32 v18, a52
    v_mul_f32 v18, v18, v248
    v_accvgpr_write_b32 a52, v18
    v_accvgpr_read_b32 v19, a53
    v_mul_f32 v19, v19, v249
    v_accvgpr_write_b32 a53, v19
    v_accvgpr_read_b32 v18, a54
    v_mul_f32 v18, v18, v250
    v_accvgpr_write_b32 a54, v18
    v_accvgpr_read_b32 v19, a55
    v_mul_f32 v19, v19, v251
    v_accvgpr_write_b32 a55, v19
    v_accvgpr_read_b32 v18, a56
    v_mul_f32 v18, v18, v248
    v_accvgpr_write_b32 a56, v18
    v_accvgpr_read_b32 v19, a57
    v_mul_f32 v19, v19, v249
    v_accvgpr_write_b32 a57, v19
    v_accvgpr_read_b32 v18, a58
    v_mul_f32 v18, v18, v250
    v_accvgpr_write_b32 a58, v18
    v_accvgpr_read_b32 v19, a59
    v_mul_f32 v19, v19, v251
    v_accvgpr_write_b32 a59, v19
    v_accvgpr_read_b32 v18, a60
    v_mul_f32 v18, v18, v248
    v_accvgpr_write_b32 a60, v18
    v_accvgpr_read_b32 v19, a61
    v_mul_f32 v19, v19, v249
    v_accvgpr_write_b32 a61, v19
    v_accvgpr_read_b32 v18, a62
    v_mul_f32 v18, v18, v250
    v_accvgpr_write_b32 a62, v18
    v_accvgpr_read_b32 v19, a63
    v_mul_f32 v19, v19, v251
    v_accvgpr_write_b32 a63, v19
    v_accvgpr_read_b32 v18, a64
    v_mul_f32 v18, v18, v248
    v_accvgpr_write_b32 a64, v18
    v_accvgpr_read_b32 v19, a65
    v_mul_f32 v19, v19, v249
    v_accvgpr_write_b32 a65, v19
    v_accvgpr_read_b32 v18, a66
    v_mul_f32 v18, v18, v250
    v_accvgpr_write_b32 a66, v18
    v_accvgpr_read_b32 v19, a67
    v_mul_f32 v19, v19, v251
    v_accvgpr_write_b32 a67, v19
    v_accvgpr_read_b32 v18, a68
    v_mul_f32 v18, v18, v248
    v_accvgpr_write_b32 a68, v18
    v_accvgpr_read_b32 v19, a69
    v_mul_f32 v19, v19, v249
    v_accvgpr_write_b32 a69, v19
    v_accvgpr_read_b32 v18, a70
    v_mul_f32 v18, v18, v250
    v_accvgpr_write_b32 a70, v18
    v_accvgpr_read_b32 v19, a71
    v_mul_f32 v19, v19, v251
    v_accvgpr_write_b32 a71, v19
    v_accvgpr_read_b32 v18, a72
    v_mul_f32 v18, v18, v248
    v_accvgpr_write_b32 a72, v18
    v_accvgpr_read_b32 v19, a73
    v_mul_f32 v19, v19, v249
    v_accvgpr_write_b32 a73, v19
    v_accvgpr_read_b32 v18, a74
    v_mul_f32 v18, v18, v250
    v_accvgpr_write_b32 a74, v18
    v_accvgpr_read_b32 v19, a75
    v_mul_f32 v19, v19, v251
    v_accvgpr_write_b32 a75, v19
    v_accvgpr_read_b32 v18, a76
    v_mul_f32 v18, v18, v248
    v_accvgpr_write_b32 a76, v18
    v_accvgpr_read_b32 v19, a77
    v_mul_f32 v19, v19, v249
    v_accvgpr_write_b32 a77, v19
    v_accvgpr_read_b32 v18, a78
    v_mul_f32 v18, v18, v250
    v_accvgpr_write_b32 a78, v18
    v_accvgpr_read_b32 v19, a79
    v_mul_f32 v19, v19, v251
    v_accvgpr_write_b32 a79, v19
    v_accvgpr_read_b32 v18, a80
    v_mul_f32 v18, v18, v248
    v_accvgpr_write_b32 a80, v18
    v_accvgpr_read_b32 v19, a81
    v_mul_f32 v19, v19, v249
    v_accvgpr_write_b32 a81, v19
    v_accvgpr_read_b32 v18, a82
    v_mul_f32 v18, v18, v250
    v_accvgpr_write_b32 a82, v18
    v_accvgpr_read_b32 v19, a83
    v_mul_f32 v19, v19, v251
    v_accvgpr_write_b32 a83, v19
    v_accvgpr_read_b32 v18, a84
    v_mul_f32 v18, v18, v248
    v_accvgpr_write_b32 a84, v18
    v_accvgpr_read_b32 v19, a85
    v_mul_f32 v19, v19, v249
    v_accvgpr_write_b32 a85, v19
    v_accvgpr_read_b32 v18, a86
    v_mul_f32 v18, v18, v250
    v_accvgpr_write_b32 a86, v18
    v_accvgpr_read_b32 v19, a87
    v_mul_f32 v19, v19, v251
    v_accvgpr_write_b32 a87, v19
    v_accvgpr_read_b32 v18, a88
    v_mul_f32 v18, v18, v248
    v_accvgpr_write_b32 a88, v18
    v_accvgpr_read_b32 v19, a89
    v_mul_f32 v19, v19, v249
    v_accvgpr_write_b32 a89, v19
    v_accvgpr_read_b32 v18, a90
    v_mul_f32 v18, v18, v250
    v_accvgpr_write_b32 a90, v18
    v_accvgpr_read_b32 v19, a91
    v_mul_f32 v19, v19, v251
    v_accvgpr_write_b32 a91, v19
    v_accvgpr_read_b32 v18, a92
    v_mul_f32 v18, v18, v248
    v_accvgpr_write_b32 a92, v18
    v_accvgpr_read_b32 v19, a93
    v_mul_f32 v19, v19, v249
    v_accvgpr_write_b32 a93, v19
    v_accvgpr_read_b32 v18, a94
    v_mul_f32 v18, v18, v250
    v_accvgpr_write_b32 a94, v18
    v_accvgpr_read_b32 v19, a95
    v_mul_f32 v19, v19, v251
    v_accvgpr_write_b32 a95, v19
    v_max3_f32 v16, v176, v177, v178
    v_max3_f32 v16, v16, v179, v180
    v_max3_f32 v16, v16, v181, v182
    v_max3_f32 v16, v16, v183, v242
    v_mov_b32 v17, v16
    s_nop 1
    v_permlane16_swap_b32 v16, v17
    s_nop 1
    v_max_f32 v16, v16, v17
    v_mov_b32 v17, v16
    s_nop 1
    v_permlane32_swap_b32 v16, v17
    s_nop 1
    v_max_f32 v16, v16, v17
    v_sub_f32 v17, v242, v16
    v_exp_f32 v17, v17
    v_mov_b32 v242, v16
    v_sub_f32 v176, v176, v16
    v_sub_f32 v177, v177, v16
    v_sub_f32 v178, v178, v16
    v_sub_f32 v179, v179, v16
    v_sub_f32 v180, v180, v16
    v_sub_f32 v181, v181, v16
    v_sub_f32 v182, v182, v16
    v_sub_f32 v183, v183, v16
    v_exp_f32 v176, v176
    v_exp_f32 v177, v177
    v_exp_f32 v178, v178
    v_exp_f32 v179, v179
    v_exp_f32 v180, v180
    v_exp_f32 v181, v181
    v_exp_f32 v182, v182
    v_exp_f32 v183, v183
    v_mul_f32 v7, v7, v17
    v_add_f32 v7, v7, v176
    v_add_f32 v7, v7, v177
    v_add_f32 v7, v7, v178
    v_add_f32 v7, v7, v179
    v_add_f32 v7, v7, v180
    v_add_f32 v7, v7, v181
    v_add_f32 v7, v7, v182
    v_add_f32 v7, v7, v183
    v_cvt_pk_bf16_f32 v232, v176, v177
    v_cvt_pk_bf16_f32 v233, v178, v179
    v_cvt_pk_bf16_f32 v234, v180, v181
    v_cvt_pk_bf16_f32 v235, v182, v183
    ds_bpermute_b32 v248, v58, v17 offset:0
    ds_bpermute_b32 v249, v58, v17 offset:4
    ds_bpermute_b32 v250, v58, v17 offset:8
    ds_bpermute_b32 v251, v58, v17 offset:12
    s_waitcnt lgkmcnt(0)
    v_accvgpr_read_b32 v18, a96
    v_mul_f32 v18, v18, v248
    v_accvgpr_write_b32 a96, v18
    v_accvgpr_read_b32 v19, a97
    v_mul_f32 v19, v19, v249
    v_accvgpr_write_b32 a97, v19
    v_accvgpr_read_b32 v18, a98
    v_mul_f32 v18, v18, v250
    v_accvgpr_write_b32 a98, v18
    v_accvgpr_read_b32 v19, a99
    v_mul_f32 v19, v19, v251
    v_accvgpr_write_b32 a99, v19
    v_accvgpr_read_b32 v18, a100
    v_mul_f32 v18, v18, v248
    v_accvgpr_write_b32 a100, v18
    v_accvgpr_read_b32 v19, a101
    v_mul_f32 v19, v19, v249
    v_accvgpr_write_b32 a101, v19
    v_accvgpr_read_b32 v18, a102
    v_mul_f32 v18, v18, v250
    v_accvgpr_write_b32 a102, v18
    v_accvgpr_read_b32 v19, a103
    v_mul_f32 v19, v19, v251
    v_accvgpr_write_b32 a103, v19
    v_accvgpr_read_b32 v18, a104
    v_mul_f32 v18, v18, v248
    v_accvgpr_write_b32 a104, v18
    v_accvgpr_read_b32 v19, a105
    v_mul_f32 v19, v19, v249
    v_accvgpr_write_b32 a105, v19
    v_accvgpr_read_b32 v18, a106
    v_mul_f32 v18, v18, v250
    v_accvgpr_write_b32 a106, v18
    v_accvgpr_read_b32 v19, a107
    v_mul_f32 v19, v19, v251
    v_accvgpr_write_b32 a107, v19
    v_accvgpr_read_b32 v18, a108
    v_mul_f32 v18, v18, v248
    v_accvgpr_write_b32 a108, v18
    v_accvgpr_read_b32 v19, a109
    v_mul_f32 v19, v19, v249
    v_accvgpr_write_b32 a109, v19
    v_accvgpr_read_b32 v18, a110
    v_mul_f32 v18, v18, v250
    v_accvgpr_write_b32 a110, v18
    v_accvgpr_read_b32 v19, a111
    v_mul_f32 v19, v19, v251
    v_accvgpr_write_b32 a111, v19
    v_accvgpr_read_b32 v18, a112
    v_mul_f32 v18, v18, v248
    v_accvgpr_write_b32 a112, v18
    v_accvgpr_read_b32 v19, a113
    v_mul_f32 v19, v19, v249
    v_accvgpr_write_b32 a113, v19
    v_accvgpr_read_b32 v18, a114
    v_mul_f32 v18, v18, v250
    v_accvgpr_write_b32 a114, v18
    v_accvgpr_read_b32 v19, a115
    v_mul_f32 v19, v19, v251
    v_accvgpr_write_b32 a115, v19
    v_accvgpr_read_b32 v18, a116
    v_mul_f32 v18, v18, v248
    v_accvgpr_write_b32 a116, v18
    v_accvgpr_read_b32 v19, a117
    v_mul_f32 v19, v19, v249
    v_accvgpr_write_b32 a117, v19
    v_accvgpr_read_b32 v18, a118
    v_mul_f32 v18, v18, v250
    v_accvgpr_write_b32 a118, v18
    v_accvgpr_read_b32 v19, a119
    v_mul_f32 v19, v19, v251
    v_accvgpr_write_b32 a119, v19
    v_accvgpr_read_b32 v18, a120
    v_mul_f32 v18, v18, v248
    v_accvgpr_write_b32 a120, v18
    v_accvgpr_read_b32 v19, a121
    v_mul_f32 v19, v19, v249
    v_accvgpr_write_b32 a121, v19
    v_accvgpr_read_b32 v18, a122
    v_mul_f32 v18, v18, v250
    v_accvgpr_write_b32 a122, v18
    v_accvgpr_read_b32 v19, a123
    v_mul_f32 v19, v19, v251
    v_accvgpr_write_b32 a123, v19
    v_accvgpr_read_b32 v18, a124
    v_mul_f32 v18, v18, v248
    v_accvgpr_write_b32 a124, v18
    v_accvgpr_read_b32 v19, a125
    v_mul_f32 v19, v19, v249
    v_accvgpr_write_b32 a125, v19
    v_accvgpr_read_b32 v18, a126
    v_mul_f32 v18, v18, v250
    v_accvgpr_write_b32 a126, v18
    v_accvgpr_read_b32 v19, a127
    v_mul_f32 v19, v19, v251
    v_accvgpr_write_b32 a127, v19
    v_accvgpr_read_b32 v18, a128
    v_mul_f32 v18, v18, v248
    v_accvgpr_write_b32 a128, v18
    v_accvgpr_read_b32 v19, a129
    v_mul_f32 v19, v19, v249
    v_accvgpr_write_b32 a129, v19
    v_accvgpr_read_b32 v18, a130
    v_mul_f32 v18, v18, v250
    v_accvgpr_write_b32 a130, v18
    v_accvgpr_read_b32 v19, a131
    v_mul_f32 v19, v19, v251
    v_accvgpr_write_b32 a131, v19
    v_accvgpr_read_b32 v18, a132
    v_mul_f32 v18, v18, v248
    v_accvgpr_write_b32 a132, v18
    v_accvgpr_read_b32 v19, a133
    v_mul_f32 v19, v19, v249
    v_accvgpr_write_b32 a133, v19
    v_accvgpr_read_b32 v18, a134
    v_mul_f32 v18, v18, v250
    v_accvgpr_write_b32 a134, v18
    v_accvgpr_read_b32 v19, a135
    v_mul_f32 v19, v19, v251
    v_accvgpr_write_b32 a135, v19
    v_accvgpr_read_b32 v18, a136
    v_mul_f32 v18, v18, v248
    v_accvgpr_write_b32 a136, v18
    v_accvgpr_read_b32 v19, a137
    v_mul_f32 v19, v19, v249
    v_accvgpr_write_b32 a137, v19
    v_accvgpr_read_b32 v18, a138
    v_mul_f32 v18, v18, v250
    v_accvgpr_write_b32 a138, v18
    v_accvgpr_read_b32 v19, a139
    v_mul_f32 v19, v19, v251
    v_accvgpr_write_b32 a139, v19
    v_accvgpr_read_b32 v18, a140
    v_mul_f32 v18, v18, v248
    v_accvgpr_write_b32 a140, v18
    v_accvgpr_read_b32 v19, a141
    v_mul_f32 v19, v19, v249
    v_accvgpr_write_b32 a141, v19
    v_accvgpr_read_b32 v18, a142
    v_mul_f32 v18, v18, v250
    v_accvgpr_write_b32 a142, v18
    v_accvgpr_read_b32 v19, a143
    v_mul_f32 v19, v19, v251
    v_accvgpr_write_b32 a143, v19
    v_max3_f32 v16, v184, v185, v186
    v_max3_f32 v16, v16, v187, v188
    v_max3_f32 v16, v16, v189, v190
    v_max3_f32 v16, v16, v191, v243
    v_mov_b32 v17, v16
    s_nop 1
    v_permlane16_swap_b32 v16, v17
    s_nop 1
    v_max_f32 v16, v16, v17
    v_mov_b32 v17, v16
    s_nop 1
    v_permlane32_swap_b32 v16, v17
    s_nop 1
    v_max_f32 v16, v16, v17
    v_sub_f32 v17, v243, v16
    v_exp_f32 v17, v17
    v_mov_b32 v243, v16
    v_sub_f32 v184, v184, v16
    v_sub_f32 v185, v185, v16
    v_sub_f32 v186, v186, v16
    v_sub_f32 v187, v187, v16
    v_sub_f32 v188, v188, v16
    v_sub_f32 v189, v189, v16
    v_sub_f32 v190, v190, v16
    v_sub_f32 v191, v191, v16
    v_exp_f32 v184, v184
    v_exp_f32 v185, v185
    v_exp_f32 v186, v186
    v_exp_f32 v187, v187
    v_exp_f32 v188, v188
    v_exp_f32 v189, v189
    v_exp_f32 v190, v190
    v_exp_f32 v191, v191
    v_mul_f32 v8, v8, v17
    v_add_f32 v8, v8, v184
    v_add_f32 v8, v8, v185
    v_add_f32 v8, v8, v186
    v_add_f32 v8, v8, v187
    v_add_f32 v8, v8, v188
    v_add_f32 v8, v8, v189
    v_add_f32 v8, v8, v190
    v_add_f32 v8, v8, v191
    v_cvt_pk_bf16_f32 v236, v184, v185
    v_cvt_pk_bf16_f32 v237, v186, v187
    v_cvt_pk_bf16_f32 v238, v188, v189
    v_cvt_pk_bf16_f32 v239, v190, v191
    ds_bpermute_b32 v248, v58, v17 offset:0
    ds_bpermute_b32 v249, v58, v17 offset:4
    ds_bpermute_b32 v250, v58, v17 offset:8
    ds_bpermute_b32 v251, v58, v17 offset:12
    s_waitcnt lgkmcnt(0)
    v_accvgpr_read_b32 v18, a144
    v_mul_f32 v18, v18, v248
    v_accvgpr_write_b32 a144, v18
    v_accvgpr_read_b32 v19, a145
    v_mul_f32 v19, v19, v249
    v_accvgpr_write_b32 a145, v19
    v_accvgpr_read_b32 v18, a146
    v_mul_f32 v18, v18, v250
    v_accvgpr_write_b32 a146, v18
    v_accvgpr_read_b32 v19, a147
    v_mul_f32 v19, v19, v251
    v_accvgpr_write_b32 a147, v19
    v_accvgpr_read_b32 v18, a148
    v_mul_f32 v18, v18, v248
    v_accvgpr_write_b32 a148, v18
    v_accvgpr_read_b32 v19, a149
    v_mul_f32 v19, v19, v249
    v_accvgpr_write_b32 a149, v19
    v_accvgpr_read_b32 v18, a150
    v_mul_f32 v18, v18, v250
    v_accvgpr_write_b32 a150, v18
    v_accvgpr_read_b32 v19, a151
    v_mul_f32 v19, v19, v251
    v_accvgpr_write_b32 a151, v19
    v_accvgpr_read_b32 v18, a152
    v_mul_f32 v18, v18, v248
    v_accvgpr_write_b32 a152, v18
    v_accvgpr_read_b32 v19, a153
    v_mul_f32 v19, v19, v249
    v_accvgpr_write_b32 a153, v19
    v_accvgpr_read_b32 v18, a154
    v_mul_f32 v18, v18, v250
    v_accvgpr_write_b32 a154, v18
    v_accvgpr_read_b32 v19, a155
    v_mul_f32 v19, v19, v251
    v_accvgpr_write_b32 a155, v19
    v_accvgpr_read_b32 v18, a156
    v_mul_f32 v18, v18, v248
    v_accvgpr_write_b32 a156, v18
    v_accvgpr_read_b32 v19, a157
    v_mul_f32 v19, v19, v249
    v_accvgpr_write_b32 a157, v19
    v_accvgpr_read_b32 v18, a158
    v_mul_f32 v18, v18, v250
    v_accvgpr_write_b32 a158, v18
    v_accvgpr_read_b32 v19, a159
    v_mul_f32 v19, v19, v251
    v_accvgpr_write_b32 a159, v19
    v_accvgpr_read_b32 v18, a160
    v_mul_f32 v18, v18, v248
    v_accvgpr_write_b32 a160, v18
    v_accvgpr_read_b32 v19, a161
    v_mul_f32 v19, v19, v249
    v_accvgpr_write_b32 a161, v19
    v_accvgpr_read_b32 v18, a162
    v_mul_f32 v18, v18, v250
    v_accvgpr_write_b32 a162, v18
    v_accvgpr_read_b32 v19, a163
    v_mul_f32 v19, v19, v251
    v_accvgpr_write_b32 a163, v19
    v_accvgpr_read_b32 v18, a164
    v_mul_f32 v18, v18, v248
    v_accvgpr_write_b32 a164, v18
    v_accvgpr_read_b32 v19, a165
    v_mul_f32 v19, v19, v249
    v_accvgpr_write_b32 a165, v19
    v_accvgpr_read_b32 v18, a166
    v_mul_f32 v18, v18, v250
    v_accvgpr_write_b32 a166, v18
    v_accvgpr_read_b32 v19, a167
    v_mul_f32 v19, v19, v251
    v_accvgpr_write_b32 a167, v19
    v_accvgpr_read_b32 v18, a168
    v_mul_f32 v18, v18, v248
    v_accvgpr_write_b32 a168, v18
    v_accvgpr_read_b32 v19, a169
    v_mul_f32 v19, v19, v249
    v_accvgpr_write_b32 a169, v19
    v_accvgpr_read_b32 v18, a170
    v_mul_f32 v18, v18, v250
    v_accvgpr_write_b32 a170, v18
    v_accvgpr_read_b32 v19, a171
    v_mul_f32 v19, v19, v251
    v_accvgpr_write_b32 a171, v19
    v_accvgpr_read_b32 v18, a172
    v_mul_f32 v18, v18, v248
    v_accvgpr_write_b32 a172, v18
    v_accvgpr_read_b32 v19, a173
    v_mul_f32 v19, v19, v249
    v_accvgpr_write_b32 a173, v19
    v_accvgpr_read_b32 v18, a174
    v_mul_f32 v18, v18, v250
    v_accvgpr_write_b32 a174, v18
    v_accvgpr_read_b32 v19, a175
    v_mul_f32 v19, v19, v251
    v_accvgpr_write_b32 a175, v19
    v_accvgpr_read_b32 v18, a176
    v_mul_f32 v18, v18, v248
    v_accvgpr_write_b32 a176, v18
    v_accvgpr_read_b32 v19, a177
    v_mul_f32 v19, v19, v249
    v_accvgpr_write_b32 a177, v19
    v_accvgpr_read_b32 v18, a178
    v_mul_f32 v18, v18, v250
    v_accvgpr_write_b32 a178, v18
    v_accvgpr_read_b32 v19, a179
    v_mul_f32 v19, v19, v251
    v_accvgpr_write_b32 a179, v19
    v_accvgpr_read_b32 v18, a180
    v_mul_f32 v18, v18, v248
    v_accvgpr_write_b32 a180, v18
    v_accvgpr_read_b32 v19, a181
    v_mul_f32 v19, v19, v249
    v_accvgpr_write_b32 a181, v19
    v_accvgpr_read_b32 v18, a182
    v_mul_f32 v18, v18, v250
    v_accvgpr_write_b32 a182, v18
    v_accvgpr_read_b32 v19, a183
    v_mul_f32 v19, v19, v251
    v_accvgpr_write_b32 a183, v19
    v_accvgpr_read_b32 v18, a184
    v_mul_f32 v18, v18, v248
    v_accvgpr_write_b32 a184, v18
    v_accvgpr_read_b32 v19, a185
    v_mul_f32 v19, v19, v249
    v_accvgpr_write_b32 a185, v19
    v_accvgpr_read_b32 v18, a186
    v_mul_f32 v18, v18, v250
    v_accvgpr_write_b32 a186, v18
    v_accvgpr_read_b32 v19, a187
    v_mul_f32 v19, v19, v251
    v_accvgpr_write_b32 a187, v19
    v_accvgpr_read_b32 v18, a188
    v_mul_f32 v18, v18, v248
    v_accvgpr_write_b32 a188, v18
    v_accvgpr_read_b32 v19, a189
    v_mul_f32 v19, v19, v249
    v_accvgpr_write_b32 a189, v19
    v_accvgpr_read_b32 v18, a190
    v_mul_f32 v18, v18, v250
    v_accvgpr_write_b32 a190, v18
    v_accvgpr_read_b32 v19, a191
    v_mul_f32 v19, v19, v251
    v_accvgpr_write_b32 a191, v19
    s_waitcnt vmcnt(0)
    s_nop 1
    v_mfma_f32_16x16x32_bf16 a[0:3], v[224:227], v[112:115], a[0:3]
    v_mfma_f32_16x16x32_bf16 a[48:51], v[228:231], v[112:115], a[48:51]
    v_mfma_f32_16x16x32_bf16 a[96:99], v[232:235], v[112:115], a[96:99]
    v_mfma_f32_16x16x32_bf16 a[144:147], v[236:239], v[112:115], a[144:147]
    v_mfma_f32_16x16x32_bf16 a[4:7], v[224:227], v[116:119], a[4:7]
    v_mfma_f32_16x16x32_bf16 a[52:55], v[228:231], v[116:119], a[52:55]
    v_mfma_f32_16x16x32_bf16 a[100:103], v[232:235], v[116:119], a[100:103]
    v_mfma_f32_16x16x32_bf16 a[148:151], v[236:239], v[116:119], a[148:151]
    v_mfma_f32_16x16x32_bf16 a[8:11], v[224:227], v[120:123], a[8:11]
    v_mfma_f32_16x16x32_bf16 a[56:59], v[228:231], v[120:123], a[56:59]
    v_mfma_f32_16x16x32_bf16 a[104:107], v[232:235], v[120:123], a[104:107]
    v_mfma_f32_16x16x32_bf16 a[152:155], v[236:239], v[120:123], a[152:155]
    v_mfma_f32_16x16x32_bf16 a[12:15], v[224:227], v[124:127], a[12:15]
    v_mfma_f32_16x16x32_bf16 a[60:63], v[228:231], v[124:127], a[60:63]
    v_mfma_f32_16x16x32_bf16 a[108:111], v[232:235], v[124:127], a[108:111]
    v_mfma_f32_16x16x32_bf16 a[156:159], v[236:239], v[124:127], a[156:159]
    v_mfma_f32_16x16x32_bf16 a[16:19], v[224:227], v[128:131], a[16:19]
    v_mfma_f32_16x16x32_bf16 a[64:67], v[228:231], v[128:131], a[64:67]
    v_mfma_f32_16x16x32_bf16 a[112:115], v[232:235], v[128:131], a[112:115]
    v_mfma_f32_16x16x32_bf16 a[160:163], v[236:239], v[128:131], a[160:163]
    v_mfma_f32_16x16x32_bf16 a[20:23], v[224:227], v[132:135], a[20:23]
    v_mfma_f32_16x16x32_bf16 a[68:71], v[228:231], v[132:135], a[68:71]
    v_mfma_f32_16x16x32_bf16 a[116:119], v[232:235], v[132:135], a[116:119]
    v_mfma_f32_16x16x32_bf16 a[164:167], v[236:239], v[132:135], a[164:167]
    v_mfma_f32_16x16x32_bf16 a[24:27], v[224:227], v[136:139], a[24:27]
    v_mfma_f32_16x16x32_bf16 a[72:75], v[228:231], v[136:139], a[72:75]
    v_mfma_f32_16x16x32_bf16 a[120:123], v[232:235], v[136:139], a[120:123]
    v_mfma_f32_16x16x32_bf16 a[168:171], v[236:239], v[136:139], a[168:171]
    v_mfma_f32_16x16x32_bf16 a[28:31], v[224:227], v[140:143], a[28:31]
    v_mfma_f32_16x16x32_bf16 a[76:79], v[228:231], v[140:143], a[76:79]
    v_mfma_f32_16x16x32_bf16 a[124:127], v[232:235], v[140:143], a[124:127]
    v_mfma_f32_16x16x32_bf16 a[172:175], v[236:239], v[140:143], a[172:175]
    v_mfma_f32_16x16x32_bf16 a[32:35], v[224:227], v[144:147], a[32:35]
    v_mfma_f32_16x16x32_bf16 a[80:83], v[228:231], v[144:147], a[80:83]
    v_mfma_f32_16x16x32_bf16 a[128:131], v[232:235], v[144:147], a[128:131]
    v_mfma_f32_16x16x32_bf16 a[176:179], v[236:239], v[144:147], a[176:179]
    v_mfma_f32_16x16x32_bf16 a[36:39], v[224:227], v[148:151], a[36:39]
    v_mfma_f32_16x16x32_bf16 a[84:87], v[228:231], v[148:151], a[84:87]
    v_mfma_f32_16x16x32_bf16 a[132:135], v[232:235], v[148:151], a[132:135]
    v_mfma_f32_16x16x32_bf16 a[180:183], v[236:239], v[148:151], a[180:183]
    v_mfma_f32_16x16x32_bf16 a[40:43], v[224:227], v[152:155], a[40:43]
    v_mfma_f32_16x16x32_bf16 a[88:91], v[228:231], v[152:155], a[88:91]
    v_mfma_f32_16x16x32_bf16 a[136:139], v[232:235], v[152:155], a[136:139]
    v_mfma_f32_16x16x32_bf16 a[184:187], v[236:239], v[152:155], a[184:187]
    v_mfma_f32_16x16x32_bf16 a[44:47], v[224:227], v[156:159], a[44:47]
    v_mfma_f32_16x16x32_bf16 a[92:95], v[228:231], v[156:159], a[92:95]
    v_mfma_f32_16x16x32_bf16 a[140:143], v[232:235], v[156:159], a[140:143]
    v_mfma_f32_16x16x32_bf16 a[188:191], v[236:239], v[156:159], a[188:191]
    s_add_u32 s48, s48, 24576
    s_cmp_lt_u32 s48, 1572864
    s_nop 7
    s_cbranch_scc1 L_slowloop
    s_nop 1
    v_mfma_f32_16x16x4_f32 v[48:51], v5, v57, 0
    v_mfma_f32_16x16x4_f32 v[52:55], v6, v57, 0
    s_nop 7
    s_nop 1
    v_rcp_f32 v48, v48
    v_rcp_f32 v49, v49
    v_rcp_f32 v50, v50
    v_rcp_f32 v51, v51
    v_rcp_f32 v52, v52
    v_rcp_f32 v53, v53
    v_rcp_f32 v54, v54
    v_rcp_f32 v55, v55
    v_mfma_f32_16x16x4_f32 v[128:131], v7, v57, 0
    v_mfma_f32_16x16x4_f32 v[132:135], v8, v57, 0
    s_nop 7
    s_nop 1
    v_rcp_f32 v128, v128
    v_rcp_f32 v129, v129
    v_rcp_f32 v130, v130
    v_rcp_f32 v131, v131
    v_rcp_f32 v132, v132
    v_rcp_f32 v133, v133
    v_rcp_f32 v134, v134
    v_rcp_f32 v135, v135
    s_nop 0
    v_accvgpr_read_b32 v64, a0
    v_accvgpr_read_b32 v65, a4
    v_accvgpr_read_b32 v66, a8
    v_accvgpr_read_b32 v67, a12
    v_accvgpr_read_b32 v68, a16
    v_accvgpr_read_b32 v69, a20
    v_pk_mul_f32 v[64:65], v[64:65], v[48:49] op_sel_hi:[1,0]
    v_pk_mul_f32 v[66:67], v[66:67], v[48:49] op_sel_hi:[1,0]
    v_pk_mul_f32 v[68:69], v[68:69], v[48:49] op_sel_hi:[1,0]
    v_cvt_pk_bf16_f32 v64, v64, v65
    v_cvt_pk_bf16_f32 v65, v66, v67
    v_cvt_pk_bf16_f32 v66, v68, v69
    v_accvgpr_read_b32 v70, a1
    v_accvgpr_read_b32 v71, a5
    v_accvgpr_read_b32 v72, a9
    v_accvgpr_read_b32 v73, a13
    v_accvgpr_read_b32 v74, a17
    v_accvgpr_read_b32 v75, a21
    v_pk_mul_f32 v[70:71], v[70:71], v[48:49] op_sel:[0,1] op_sel_hi:[1,1]
    v_pk_mul_f32 v[72:73], v[72:73], v[48:49] op_sel:[0,1] op_sel_hi:[1,1]
    v_pk_mul_f32 v[74:75], v[74:75], v[48:49] op_sel:[0,1] op_sel_hi:[1,1]
    v_cvt_pk_bf16_f32 v70, v70, v71
    v_cvt_pk_bf16_f32 v71, v72, v73
    v_cvt_pk_bf16_f32 v72, v74, v75
    buffer_store_dwordx3 v[64:66], v56, s[12:15], s24 offen offset:0 sc0 sc1
    v_accvgpr_read_b32 v76, a2
    v_accvgpr_read_b32 v77, a6
    v_accvgpr_read_b32 v78, a10
    v_accvgpr_read_b32 v79, a14
    v_accvgpr_read_b32 v80, a18
    v_accvgpr_read_b32 v81, a22
    v_pk_mul_f32 v[76:77], v[76:77], v[50:51] op_sel_hi:[1,0]
    v_pk_mul_f32 v[78:79], v[78:79], v[50:51] op_sel_hi:[1,0]
    v_pk_mul_f32 v[80:81], v[80:81], v[50:51] op_sel_hi:[1,0]
    v_cvt_pk_bf16_f32 v76, v76, v77
    v_cvt_pk_bf16_f32 v77, v78, v79
    v_cvt_pk_bf16_f32 v78, v80, v81
    buffer_store_dwordx3 v[70:72], v56, s[12:15], s24 offen offset:384 sc0 sc1
    v_accvgpr_read_b32 v82, a3
    v_accvgpr_read_b32 v83, a7
    v_accvgpr_read_b32 v84, a11
    v_accvgpr_read_b32 v85, a15
    v_accvgpr_read_b32 v86, a19
    v_accvgpr_read_b32 v87, a23
    v_pk_mul_f32 v[82:83], v[82:83], v[50:51] op_sel:[0,1] op_sel_hi:[1,1]
    v_pk_mul_f32 v[84:85], v[84:85], v[50:51] op_sel:[0,1] op_sel_hi:[1,1]
    v_pk_mul_f32 v[86:87], v[86:87], v[50:51] op_sel:[0,1] op_sel_hi:[1,1]
    v_cvt_pk_bf16_f32 v82, v82, v83
    v_cvt_pk_bf16_f32 v83, v84, v85
    v_cvt_pk_bf16_f32 v84, v86, v87
    buffer_store_dwordx3 v[76:78], v56, s[12:15], s24 offen offset:768 sc0 sc1
    v_accvgpr_read_b32 v88, a24
    v_accvgpr_read_b32 v89, a28
    v_accvgpr_read_b32 v90, a32
    v_accvgpr_read_b32 v91, a36
    v_accvgpr_read_b32 v92, a40
    v_accvgpr_read_b32 v93, a44
    v_pk_mul_f32 v[88:89], v[88:89], v[48:49] op_sel_hi:[1,0]
    v_pk_mul_f32 v[90:91], v[90:91], v[48:49] op_sel_hi:[1,0]
    v_pk_mul_f32 v[92:93], v[92:93], v[48:49] op_sel_hi:[1,0]
    v_cvt_pk_bf16_f32 v88, v88, v89
    v_cvt_pk_bf16_f32 v89, v90, v91
    v_cvt_pk_bf16_f32 v90, v92, v93
    buffer_store_dwordx3 v[82:84], v56, s[12:15], s24 offen offset:1152 sc0 sc1
    v_accvgpr_read_b32 v94, a25
    v_accvgpr_read_b32 v95, a29
    v_accvgpr_read_b32 v96, a33
    v_accvgpr_read_b32 v97, a37
    v_accvgpr_read_b32 v98, a41
    v_accvgpr_read_b32 v99, a45
    v_pk_mul_f32 v[94:95], v[94:95], v[48:49] op_sel:[0,1] op_sel_hi:[1,1]
    v_pk_mul_f32 v[96:97], v[96:97], v[48:49] op_sel:[0,1] op_sel_hi:[1,1]
    v_pk_mul_f32 v[98:99], v[98:99], v[48:49] op_sel:[0,1] op_sel_hi:[1,1]
    v_cvt_pk_bf16_f32 v94, v94, v95
    v_cvt_pk_bf16_f32 v95, v96, v97
    v_cvt_pk_bf16_f32 v96, v98, v99
    buffer_store_dwordx3 v[88:90], v56, s[12:15], s24 offen offset:192 sc0 sc1
    v_accvgpr_read_b32 v100, a26
    v_accvgpr_read_b32 v101, a30
    v_accvgpr_read_b32 v102, a34
    v_accvgpr_read_b32 v103, a38
    v_accvgpr_read_b32 v104, a42
    v_accvgpr_read_b32 v105, a46
    v_pk_mul_f32 v[100:101], v[100:101], v[50:51] op_sel_hi:[1,0]
    v_pk_mul_f32 v[102:103], v[102:103], v[50:51] op_sel_hi:[1,0]
    v_pk_mul_f32 v[104:105], v[104:105], v[50:51] op_sel_hi:[1,0]
    v_cvt_pk_bf16_f32 v100, v100, v101
    v_cvt_pk_bf16_f32 v101, v102, v103
    v_cvt_pk_bf16_f32 v102, v104, v105
    buffer_store_dwordx3 v[94:96], v56, s[12:15], s24 offen offset:576 sc0 sc1
    v_accvgpr_read_b32 v106, a27
    v_accvgpr_read_b32 v107, a31
    v_accvgpr_read_b32 v108, a35
    v_accvgpr_read_b32 v109, a39
    v_accvgpr_read_b32 v110, a43
    v_accvgpr_read_b32 v111, a47
    v_pk_mul_f32 v[106:107], v[106:107], v[50:51] op_sel:[0,1] op_sel_hi:[1,1]
    v_pk_mul_f32 v[108:109], v[108:109], v[50:51] op_sel:[0,1] op_sel_hi:[1,1]
    v_pk_mul_f32 v[110:111], v[110:111], v[50:51] op_sel:[0,1] op_sel_hi:[1,1]
    v_cvt_pk_bf16_f32 v106, v106, v107
    v_cvt_pk_bf16_f32 v107, v108, v109
    v_cvt_pk_bf16_f32 v108, v110, v111
    buffer_store_dwordx3 v[100:102], v56, s[12:15], s24 offen offset:960 sc0 sc1
    v_accvgpr_read_b32 v64, a48
    v_accvgpr_read_b32 v65, a52
    v_accvgpr_read_b32 v66, a56
    v_accvgpr_read_b32 v67, a60
    v_accvgpr_read_b32 v68, a64
    v_accvgpr_read_b32 v69, a68
    v_pk_mul_f32 v[64:65], v[64:65], v[52:53] op_sel_hi:[1,0]
    v_pk_mul_f32 v[66:67], v[66:67], v[52:53] op_sel_hi:[1,0]
    v_pk_mul_f32 v[68:69], v[68:69], v[52:53] op_sel_hi:[1,0]
    v_cvt_pk_bf16_f32 v64, v64, v65
    v_cvt_pk_bf16_f32 v65, v66, v67
    v_cvt_pk_bf16_f32 v66, v68, v69
    buffer_store_dwordx3 v[106:108], v56, s[12:15], s24 offen offset:1344 sc0 sc1
    v_accvgpr_read_b32 v70, a49
    v_accvgpr_read_b32 v71, a53
    v_accvgpr_read_b32 v72, a57
    v_accvgpr_read_b32 v73, a61
    v_accvgpr_read_b32 v74, a65
    v_accvgpr_read_b32 v75, a69
    v_pk_mul_f32 v[70:71], v[70:71], v[52:53] op_sel:[0,1] op_sel_hi:[1,1]
    v_pk_mul_f32 v[72:73], v[72:73], v[52:53] op_sel:[0,1] op_sel_hi:[1,1]
    v_pk_mul_f32 v[74:75], v[74:75], v[52:53] op_sel:[0,1] op_sel_hi:[1,1]
    v_cvt_pk_bf16_f32 v70, v70, v71
    v_cvt_pk_bf16_f32 v71, v72, v73
    v_cvt_pk_bf16_f32 v72, v74, v75
    buffer_store_dwordx3 v[64:66], v56, s[12:15], s40 offen offset:0 sc0 sc1
    v_accvgpr_read_b32 v76, a50
    v_accvgpr_read_b32 v77, a54
    v_accvgpr_read_b32 v78, a58
    v_accvgpr_read_b32 v79, a62
    v_accvgpr_read_b32 v80, a66
    v_accvgpr_read_b32 v81, a70
    v_pk_mul_f32 v[76:77], v[76:77], v[54:55] op_sel_hi:[1,0]
    v_pk_mul_f32 v[78:79], v[78:79], v[54:55] op_sel_hi:[1,0]
    v_pk_mul_f32 v[80:81], v[80:81], v[54:55] op_sel_hi:[1,0]
    v_cvt_pk_bf16_f32 v76, v76, v77
    v_cvt_pk_bf16_f32 v77, v78, v79
    v_cvt_pk_bf16_f32 v78, v80, v81
    buffer_store_dwordx3 v[70:72], v56, s[12:15], s40 offen offset:384 sc0 sc1
    v_accvgpr_read_b32 v82, a51
    v_accvgpr_read_b32 v83, a55
    v_accvgpr_read_b32 v84, a59
    v_accvgpr_read_b32 v85, a63
    v_accvgpr_read_b32 v86, a67
    v_accvgpr_read_b32 v87, a71
    v_pk_mul_f32 v[82:83], v[82:83], v[54:55] op_sel:[0,1] op_sel_hi:[1,1]
    v_pk_mul_f32 v[84:85], v[84:85], v[54:55] op_sel:[0,1] op_sel_hi:[1,1]
    v_pk_mul_f32 v[86:87], v[86:87], v[54:55] op_sel:[0,1] op_sel_hi:[1,1]
    v_cvt_pk_bf16_f32 v82, v82, v83
    v_cvt_pk_bf16_f32 v83, v84, v85
    v_cvt_pk_bf16_f32 v84, v86, v87
    buffer_store_dwordx3 v[76:78], v56, s[12:15], s40 offen offset:768 sc0 sc1
    v_accvgpr_read_b32 v88, a72
    v_accvgpr_read_b32 v89, a76
    v_accvgpr_read_b32 v90, a80
    v_accvgpr_read_b32 v91, a84
    v_accvgpr_read_b32 v92, a88
    v_accvgpr_read_b32 v93, a92
    v_pk_mul_f32 v[88:89], v[88:89], v[52:53] op_sel_hi:[1,0]
    v_pk_mul_f32 v[90:91], v[90:91], v[52:53] op_sel_hi:[1,0]
    v_pk_mul_f32 v[92:93], v[92:93], v[52:53] op_sel_hi:[1,0]
    v_cvt_pk_bf16_f32 v88, v88, v89
    v_cvt_pk_bf16_f32 v89, v90, v91
    v_cvt_pk_bf16_f32 v90, v92, v93
    buffer_store_dwordx3 v[82:84], v56, s[12:15], s40 offen offset:1152 sc0 sc1
    v_accvgpr_read_b32 v94, a73
    v_accvgpr_read_b32 v95, a77
    v_accvgpr_read_b32 v96, a81
    v_accvgpr_read_b32 v97, a85
    v_accvgpr_read_b32 v98, a89
    v_accvgpr_read_b32 v99, a93
    v_pk_mul_f32 v[94:95], v[94:95], v[52:53] op_sel:[0,1] op_sel_hi:[1,1]
    v_pk_mul_f32 v[96:97], v[96:97], v[52:53] op_sel:[0,1] op_sel_hi:[1,1]
    v_pk_mul_f32 v[98:99], v[98:99], v[52:53] op_sel:[0,1] op_sel_hi:[1,1]
    v_cvt_pk_bf16_f32 v94, v94, v95
    v_cvt_pk_bf16_f32 v95, v96, v97
    v_cvt_pk_bf16_f32 v96, v98, v99
    buffer_store_dwordx3 v[88:90], v56, s[12:15], s40 offen offset:192 sc0 sc1
    v_accvgpr_read_b32 v100, a74
    v_accvgpr_read_b32 v101, a78
    v_accvgpr_read_b32 v102, a82
    v_accvgpr_read_b32 v103, a86
    v_accvgpr_read_b32 v104, a90
    v_accvgpr_read_b32 v105, a94
    v_pk_mul_f32 v[100:101], v[100:101], v[54:55] op_sel_hi:[1,0]
    v_pk_mul_f32 v[102:103], v[102:103], v[54:55] op_sel_hi:[1,0]
    v_pk_mul_f32 v[104:105], v[104:105], v[54:55] op_sel_hi:[1,0]
    v_cvt_pk_bf16_f32 v100, v100, v101
    v_cvt_pk_bf16_f32 v101, v102, v103
    v_cvt_pk_bf16_f32 v102, v104, v105
    buffer_store_dwordx3 v[94:96], v56, s[12:15], s40 offen offset:576 sc0 sc1
    v_accvgpr_read_b32 v106, a75
    v_accvgpr_read_b32 v107, a79
    v_accvgpr_read_b32 v108, a83
    v_accvgpr_read_b32 v109, a87
    v_accvgpr_read_b32 v110, a91
    v_accvgpr_read_b32 v111, a95
    v_pk_mul_f32 v[106:107], v[106:107], v[54:55] op_sel:[0,1] op_sel_hi:[1,1]
    v_pk_mul_f32 v[108:109], v[108:109], v[54:55] op_sel:[0,1] op_sel_hi:[1,1]
    v_pk_mul_f32 v[110:111], v[110:111], v[54:55] op_sel:[0,1] op_sel_hi:[1,1]
    v_cvt_pk_bf16_f32 v106, v106, v107
    v_cvt_pk_bf16_f32 v107, v108, v109
    v_cvt_pk_bf16_f32 v108, v110, v111
    buffer_store_dwordx3 v[100:102], v56, s[12:15], s40 offen offset:960 sc0 sc1
    v_accvgpr_read_b32 v64, a96
    v_accvgpr_read_b32 v65, a100
    v_accvgpr_read_b32 v66, a104
    v_accvgpr_read_b32 v67, a108
    v_accvgpr_read_b32 v68, a112
    v_accvgpr_read_b32 v69, a116
    v_pk_mul_f32 v[64:65], v[64:65], v[128:129] op_sel_hi:[1,0]
    v_pk_mul_f32 v[66:67], v[66:67], v[128:129] op_sel_hi:[1,0]
    v_pk_mul_f32 v[68:69], v[68:69], v[128:129] op_sel_hi:[1,0]
    v_cvt_pk_bf16_f32 v64, v64, v65
    v_cvt_pk_bf16_f32 v65, v66, v67
    v_cvt_pk_bf16_f32 v66, v68, v69
    buffer_store_dwordx3 v[106:108], v56, s[12:15], s40 offen offset:1344 sc0 sc1
    v_accvgpr_read_b32 v70, a97
    v_accvgpr_read_b32 v71, a101
    v_accvgpr_read_b32 v72, a105
    v_accvgpr_read_b32 v73, a109
    v_accvgpr_read_b32 v74, a113
    v_accvgpr_read_b32 v75, a117
    v_pk_mul_f32 v[70:71], v[70:71], v[128:129] op_sel:[0,1] op_sel_hi:[1,1]
    v_pk_mul_f32 v[72:73], v[72:73], v[128:129] op_sel:[0,1] op_sel_hi:[1,1]
    v_pk_mul_f32 v[74:75], v[74:75], v[128:129] op_sel:[0,1] op_sel_hi:[1,1]
    v_cvt_pk_bf16_f32 v70, v70, v71
    v_cvt_pk_bf16_f32 v71, v72, v73
    v_cvt_pk_bf16_f32 v72, v74, v75
    buffer_store_dwordx3 v[64:66], v56, s[12:15], s41 offen offset:0 sc0 sc1
    v_accvgpr_read_b32 v76, a98
    v_accvgpr_read_b32 v77, a102
    v_accvgpr_read_b32 v78, a106
    v_accvgpr_read_b32 v79, a110
    v_accvgpr_read_b32 v80, a114
    v_accvgpr_read_b32 v81, a118
    v_pk_mul_f32 v[76:77], v[76:77], v[130:131] op_sel_hi:[1,0]
    v_pk_mul_f32 v[78:79], v[78:79], v[130:131] op_sel_hi:[1,0]
    v_pk_mul_f32 v[80:81], v[80:81], v[130:131] op_sel_hi:[1,0]
    v_cvt_pk_bf16_f32 v76, v76, v77
    v_cvt_pk_bf16_f32 v77, v78, v79
    v_cvt_pk_bf16_f32 v78, v80, v81
    buffer_store_dwordx3 v[70:72], v56, s[12:15], s41 offen offset:384 sc0 sc1
    v_accvgpr_read_b32 v82, a99
    v_accvgpr_read_b32 v83, a103
    v_accvgpr_read_b32 v84, a107
    v_accvgpr_read_b32 v85, a111
    v_accvgpr_read_b32 v86, a115
    v_accvgpr_read_b32 v87, a119
    v_pk_mul_f32 v[82:83], v[82:83], v[130:131] op_sel:[0,1] op_sel_hi:[1,1]
    v_pk_mul_f32 v[84:85], v[84:85], v[130:131] op_sel:[0,1] op_sel_hi:[1,1]
    v_pk_mul_f32 v[86:87], v[86:87], v[130:131] op_sel:[0,1] op_sel_hi:[1,1]
    v_cvt_pk_bf16_f32 v82, v82, v83
    v_cvt_pk_bf16_f32 v83, v84, v85
    v_cvt_pk_bf16_f32 v84, v86, v87
    buffer_store_dwordx3 v[76:78], v56, s[12:15], s41 offen offset:768 sc0 sc1
    v_accvgpr_read_b32 v88, a120
    v_accvgpr_read_b32 v89, a124
    v_accvgpr_read_b32 v90, a128
    v_accvgpr_read_b32 v91, a132
    v_accvgpr_read_b32 v92, a136
    v_accvgpr_read_b32 v93, a140
    v_pk_mul_f32 v[88:89], v[88:89], v[128:129] op_sel_hi:[1,0]
    v_pk_mul_f32 v[90:91], v[90:91], v[128:129] op_sel_hi:[1,0]
    v_pk_mul_f32 v[92:93], v[92:93], v[128:129] op_sel_hi:[1,0]
    v_cvt_pk_bf16_f32 v88, v88, v89
    v_cvt_pk_bf16_f32 v89, v90, v91
    v_cvt_pk_bf16_f32 v90, v92, v93
    buffer_store_dwordx3 v[82:84], v56, s[12:15], s41 offen offset:1152 sc0 sc1
    v_accvgpr_read_b32 v94, a121
    v_accvgpr_read_b32 v95, a125
    v_accvgpr_read_b32 v96, a129
    v_accvgpr_read_b32 v97, a133
    v_accvgpr_read_b32 v98, a137
    v_accvgpr_read_b32 v99, a141
    v_pk_mul_f32 v[94:95], v[94:95], v[128:129] op_sel:[0,1] op_sel_hi:[1,1]
    v_pk_mul_f32 v[96:97], v[96:97], v[128:129] op_sel:[0,1] op_sel_hi:[1,1]
    v_pk_mul_f32 v[98:99], v[98:99], v[128:129] op_sel:[0,1] op_sel_hi:[1,1]
    v_cvt_pk_bf16_f32 v94, v94, v95
    v_cvt_pk_bf16_f32 v95, v96, v97
    v_cvt_pk_bf16_f32 v96, v98, v99
    buffer_store_dwordx3 v[88:90], v56, s[12:15], s41 offen offset:192 sc0 sc1
    v_accvgpr_read_b32 v100, a122
    v_accvgpr_read_b32 v101, a126
    v_accvgpr_read_b32 v102, a130
    v_accvgpr_read_b32 v103, a134
    v_accvgpr_read_b32 v104, a138
    v_accvgpr_read_b32 v105, a142
    v_pk_mul_f32 v[100:101], v[100:101], v[130:131] op_sel_hi:[1,0]
    v_pk_mul_f32 v[102:103], v[102:103], v[130:131] op_sel_hi:[1,0]
    v_pk_mul_f32 v[104:105], v[104:105], v[130:131] op_sel_hi:[1,0]
    v_cvt_pk_bf16_f32 v100, v100, v101
    v_cvt_pk_bf16_f32 v101, v102, v103
    v_cvt_pk_bf16_f32 v102, v104, v105
    buffer_store_dwordx3 v[94:96], v56, s[12:15], s41 offen offset:576 sc0 sc1
    v_accvgpr_read_b32 v106, a123
    v_accvgpr_read_b32 v107, a127
    v_accvgpr_read_b32 v108, a131
    v_accvgpr_read_b32 v109, a135
    v_accvgpr_read_b32 v110, a139
    v_accvgpr_read_b32 v111, a143
    v_pk_mul_f32 v[106:107], v[106:107], v[130:131] op_sel:[0,1] op_sel_hi:[1,1]
    v_pk_mul_f32 v[108:109], v[108:109], v[130:131] op_sel:[0,1] op_sel_hi:[1,1]
    v_pk_mul_f32 v[110:111], v[110:111], v[130:131] op_sel:[0,1] op_sel_hi:[1,1]
    v_cvt_pk_bf16_f32 v106, v106, v107
    v_cvt_pk_bf16_f32 v107, v108, v109
    v_cvt_pk_bf16_f32 v108, v110, v111
    buffer_store_dwordx3 v[100:102], v56, s[12:15], s41 offen offset:960 sc0 sc1
    v_accvgpr_read_b32 v64, a144
    v_accvgpr_read_b32 v65, a148
    v_accvgpr_read_b32 v66, a152
    v_accvgpr_read_b32 v67, a156
    v_accvgpr_read_b32 v68, a160
    v_accvgpr_read_b32 v69, a164
    v_pk_mul_f32 v[64:65], v[64:65], v[132:133] op_sel_hi:[1,0]
    v_pk_mul_f32 v[66:67], v[66:67], v[132:133] op_sel_hi:[1,0]
    v_pk_mul_f32 v[68:69], v[68:69], v[132:133] op_sel_hi:[1,0]
    v_cvt_pk_bf16_f32 v64, v64, v65
    v_cvt_pk_bf16_f32 v65, v66, v67
    v_cvt_pk_bf16_f32 v66, v68, v69
    buffer_store_dwordx3 v[106:108], v56, s[12:15], s41 offen offset:1344 sc0 sc1
    v_accvgpr_read_b32 v70, a145
    v_accvgpr_read_b32 v71, a149
    v_accvgpr_read_b32 v72, a153
    v_accvgpr_read_b32 v73, a157
    v_accvgpr_read_b32 v74, a161
    v_accvgpr_read_b32 v75, a165
    v_pk_mul_f32 v[70:71], v[70:71], v[132:133] op_sel:[0,1] op_sel_hi:[1,1]
    v_pk_mul_f32 v[72:73], v[72:73], v[132:133] op_sel:[0,1] op_sel_hi:[1,1]
    v_pk_mul_f32 v[74:75], v[74:75], v[132:133] op_sel:[0,1] op_sel_hi:[1,1]
    v_cvt_pk_bf16_f32 v70, v70, v71
    v_cvt_pk_bf16_f32 v71, v72, v73
    v_cvt_pk_bf16_f32 v72, v74, v75
    buffer_store_dwordx3 v[64:66], v56, s[12:15], s42 offen offset:0 sc0 sc1
    v_accvgpr_read_b32 v76, a146
    v_accvgpr_read_b32 v77, a150
    v_accvgpr_read_b32 v78, a154
    v_accvgpr_read_b32 v79, a158
    v_accvgpr_read_b32 v80, a162
    v_accvgpr_read_b32 v81, a166
    v_pk_mul_f32 v[76:77], v[76:77], v[134:135] op_sel_hi:[1,0]
    v_pk_mul_f32 v[78:79], v[78:79], v[134:135] op_sel_hi:[1,0]
    v_pk_mul_f32 v[80:81], v[80:81], v[134:135] op_sel_hi:[1,0]
    v_cvt_pk_bf16_f32 v76, v76, v77
    v_cvt_pk_bf16_f32 v77, v78, v79
    v_cvt_pk_bf16_f32 v78, v80, v81
    buffer_store_dwordx3 v[70:72], v56, s[12:15], s42 offen offset:384 sc0 sc1
    v_accvgpr_read_b32 v82, a147
    v_accvgpr_read_b32 v83, a151
    v_accvgpr_read_b32 v84, a155
    v_accvgpr_read_b32 v85, a159
    v_accvgpr_read_b32 v86, a163
    v_accvgpr_read_b32 v87, a167
    v_pk_mul_f32 v[82:83], v[82:83], v[134:135] op_sel:[0,1] op_sel_hi:[1,1]
    v_pk_mul_f32 v[84:85], v[84:85], v[134:135] op_sel:[0,1] op_sel_hi:[1,1]
    v_pk_mul_f32 v[86:87], v[86:87], v[134:135] op_sel:[0,1] op_sel_hi:[1,1]
    v_cvt_pk_bf16_f32 v82, v82, v83
    v_cvt_pk_bf16_f32 v83, v84, v85
    v_cvt_pk_bf16_f32 v84, v86, v87
    buffer_store_dwordx3 v[76:78], v56, s[12:15], s42 offen offset:768 sc0 sc1
    v_accvgpr_read_b32 v88, a168
    v_accvgpr_read_b32 v89, a172
    v_accvgpr_read_b32 v90, a176
    v_accvgpr_read_b32 v91, a180
    v_accvgpr_read_b32 v92, a184
    v_accvgpr_read_b32 v93, a188
    v_pk_mul_f32 v[88:89], v[88:89], v[132:133] op_sel_hi:[1,0]
    v_pk_mul_f32 v[90:91], v[90:91], v[132:133] op_sel_hi:[1,0]
    v_pk_mul_f32 v[92:93], v[92:93], v[132:133] op_sel_hi:[1,0]
    v_cvt_pk_bf16_f32 v88, v88, v89
    v_cvt_pk_bf16_f32 v89, v90, v91
    v_cvt_pk_bf16_f32 v90, v92, v93
    buffer_store_dwordx3 v[82:84], v56, s[12:15], s42 offen offset:1152 sc0 sc1
    v_accvgpr_read_b32 v94, a169
    v_accvgpr_read_b32 v95, a173
    v_accvgpr_read_b32 v96, a177
    v_accvgpr_read_b32 v97, a181
    v_accvgpr_read_b32 v98, a185
    v_accvgpr_read_b32 v99, a189
    v_pk_mul_f32 v[94:95], v[94:95], v[132:133] op_sel:[0,1] op_sel_hi:[1,1]
    v_pk_mul_f32 v[96:97], v[96:97], v[132:133] op_sel:[0,1] op_sel_hi:[1,1]
    v_pk_mul_f32 v[98:99], v[98:99], v[132:133] op_sel:[0,1] op_sel_hi:[1,1]
    v_cvt_pk_bf16_f32 v94, v94, v95
    v_cvt_pk_bf16_f32 v95, v96, v97
    v_cvt_pk_bf16_f32 v96, v98, v99
    buffer_store_dwordx3 v[88:90], v56, s[12:15], s42 offen offset:192 sc0 sc1
    v_accvgpr_read_b32 v100, a170
    v_accvgpr_read_b32 v101, a174
    v_accvgpr_read_b32 v102, a178
    v_accvgpr_read_b32 v103, a182
    v_accvgpr_read_b32 v104, a186
    v_accvgpr_read_b32 v105, a190
    v_pk_mul_f32 v[100:101], v[100:101], v[134:135] op_sel_hi:[1,0]
    v_pk_mul_f32 v[102:103], v[102:103], v[134:135] op_sel_hi:[1,0]
    v_pk_mul_f32 v[104:105], v[104:105], v[134:135] op_sel_hi:[1,0]
    v_cvt_pk_bf16_f32 v100, v100, v101
    v_cvt_pk_bf16_f32 v101, v102, v103
    v_cvt_pk_bf16_f32 v102, v104, v105
    buffer_store_dwordx3 v[94:96], v56, s[12:15], s42 offen offset:576 sc0 sc1
    v_accvgpr_read_b32 v106, a171
    v_accvgpr_read_b32 v107, a175
    v_accvgpr_read_b32 v108, a179
    v_accvgpr_read_b32 v109, a183
    v_accvgpr_read_b32 v110, a187
    v_accvgpr_read_b32 v111, a191
    v_pk_mul_f32 v[106:107], v[106:107], v[134:135] op_sel:[0,1] op_sel_hi:[1,1]
    v_pk_mul_f32 v[108:109], v[108:109], v[134:135] op_sel:[0,1] op_sel_hi:[1,1]
    v_pk_mul_f32 v[110:111], v[110:111], v[134:135] op_sel:[0,1] op_sel_hi:[1,1]
    v_cvt_pk_bf16_f32 v106, v106, v107
    v_cvt_pk_bf16_f32 v107, v108, v109
    v_cvt_pk_bf16_f32 v108, v110, v111
    buffer_store_dwordx3 v[100:102], v56, s[12:15], s42 offen offset:960 sc0 sc1
    buffer_store_dwordx3 v[106:108], v56, s[12:15], s42 offen offset:1344 sc0 sc1
    s_branch L_fin
.section .rodata,"a"
.p2align 6
.amdhsa_kernel standalone__kv_cache_quant_int4_int2_kv_with_per_channel_or_per_token_scales__prompt_kernel
  .amdhsa_next_free_vgpr 512
  .amdhsa_next_free_sgpr 102
  .amdhsa_accum_offset 256
  .amdhsa_group_segment_fixed_size 0
  .amdhsa_kernarg_size 80
  .amdhsa_user_sgpr_count 2
  .amdhsa_user_sgpr_kernarg_segment_ptr 1
  .amdhsa_system_sgpr_workgroup_id_x 1
.end_amdhsa_kernel
```

```asm
; @launch grid=(256,1,1) block=(256,1,1) lds=147584
.amdgcn_target "amdgcn-amd-amdhsa--gfx950"
.text
.globl standalone__kv_cache_quant_int4_int2_kv_with_per_channel_or_per_token_scales__prompt_kernel
.p2align 8
.type standalone__kv_cache_quant_int4_int2_kv_with_per_channel_or_per_token_scales__prompt_kernel,@function
standalone__kv_cache_quant_int4_int2_kv_with_per_channel_or_per_token_scales__prompt_kernel:
    s_cmp_ge_u32 s2, 256
    s_cbranch_scc1 L_done
    s_load_dwordx16 s[40:55], s[0:1], 0
    s_load_dwordx4 s[16:19], s[0:1], 64
    s_and_b32 s94, s2, 7
    s_lshr_b32 s95, s2, 3
    s_lshr_b32 s24, s95, 3
    s_lshl_b32 s94, s94, 2
    s_add_u32 s94, s94, s24
    s_and_b32 s95, s95, 7
    s_getpc_b64 s[60:61]
L_pc:
    s_sub_u32 s60, s60, L_pc-standalone__kv_cache_quant_int4_int2_kv_with_per_channel_or_per_token_scales__prompt_kernel
    s_subb_u32 s61, s61, 0
    s_mov_b32 s62, L_slow-standalone__kv_cache_quant_int4_int2_kv_with_per_channel_or_per_token_scales__prompt_kernel
    s_mov_b32 s63, 0x20000
    s_lshr_b32 s22, s2, 3
    s_lshl_b32 s22, s22, 12
    v_lshlrev_b32 v30, 4, v0
    buffer_load_dwordx4 v[128:131], v30, s[60:63], s22 offen
    v_lshrrev_b32 v24, 6, v0
    v_and_b32 v25, 63, v0
    v_readfirstlane_b32 s25, v24
    v_lshlrev_b32 v1, 4, v25
    v_mul_u32_u24 v26, 43, v25
    v_lshrrev_b32 v26, 10, v26
    v_mul_u32_u24 v27, 24, v26
    v_sub_u32 v27, v25, v27
    v_lshrrev_b32 v28, 1, v24
    v_and_b32 v29, 1, v24
    v_lshlrev_b32 v30, 4, v29
    v_lshl_add_u32 v30, v28, 2, v30
    v_add_u32 v30, v30, v26
    v_mul_u32_u24 v30, 768, v30
    v_lshrrev_b32 v48, 1, v26
    v_lshlrev_b32 v48, 30, v48
    v_lshl_add_u32 v30, v27, 4, v30
    v_or_b32 v9, v30, v48
    v_lshl_or_b32 v10, v27, 3, v48
    v_mul_u32_u24 v30, 6144, v24
    v_mul_u32_u24 v31, 12, v25
    v_add_u32 v12, v30, v31
    s_mov_b32 s66, 1572864
    s_mov_b32 s67, 0x20000
    s_mov_b32 s70, 1572864
    s_mov_b32 s71, 0x20000
    s_mov_b32 s74, 12288
    s_mov_b32 s75, 0x20000
    s_mov_b32 s78, 12288
    s_mov_b32 s79, 0x20000
    s_mov_b32 s82, 4096
    s_mov_b32 s83, 0x20000
    s_mov_b32 s86, 4096
    s_mov_b32 s87, 0x20000
    s_mov_b32 s22, 64
    s_mov_b32 s23, 0x20000
    s_mul_i32 s33, s95, 24576
    s_add_u32 s34, s33, 6144
    s_mov_b32 s35, s33
    s_lshr_b32 s36, s95, 1
    s_mul_i32 s36, s36, 384
    s_lshl_b32 s37, s95, 6
    s_lshl_b32 s24, s25, 4
    s_add_u32 s37, s37, s24
    s_mul_i32 s24, s94, 1572864
    s_mul_i32 s56, s94, 12288
    s_lshl_b32 s57, s94, 12
    s_lshl_b32 s58, s94, 10
    s_add_u32 s58, s58, 51380320
    s_or_b32 s39, s95, s25
    s_waitcnt lgkmcnt(0)
    s_add_u32 s64, s42, s24
    s_addc_u32 s65, s43, 0
    s_add_u32 s72, s46, s56
    s_addc_u32 s73, s47, 0
    s_add_u32 s76, s48, s56
    s_addc_u32 s77, s49, 0
    buffer_load_dwordx4 v[224:227], v9, s[64:67], s33 offen offset:0 nt
    buffer_load_dwordx4 v[228:231], v9, s[64:67], s33 offen offset:1536 nt
    buffer_load_dwordx4 v[232:235], v9, s[64:67], s34 offen offset:0 nt
    buffer_load_dwordx4 v[236:239], v9, s[64:67], s34 offen offset:1536 nt
    buffer_load_dwordx2 v[32:33], v10, s[72:75], s36 offen offset:0
    buffer_load_dwordx2 v[34:35], v10, s[76:79], s36 offen offset:0
    buffer_load_dwordx2 v[36:37], v10, s[72:75], s36 offen offset:192
    buffer_load_dwordx2 v[38:39], v10, s[76:79], s36 offen offset:192
    s_add_u32 s20, s18, s58
    s_addc_u32 s21, s19, 0
    s_add_u32 s80, s50, s57
    s_addc_u32 s81, s51, 0
    s_add_u32 s84, s52, s57
    s_addc_u32 s85, s53, 0
    s_add_u32 s68, s44, s24
    s_addc_u32 s69, s45, 0
    s_mul_i32 s59, s94, 786432
    s_add_u32 s12, s54, s59
    s_addc_u32 s13, s55, 0
    s_add_u32 s8, s40, s59
    s_addc_u32 s9, s41, 0
    s_cmp_lg_u32 s39, 0
    s_cbranch_scc1 L_notleader0
    s_buffer_load_dwordx16 s[40:55], s[20:23], 0 glc
L_notleader0:
    buffer_load_dwordx4 v[240:243], v9, s[64:67], s33 offen offset:384 nt
    buffer_load_dwordx4 v[244:247], v9, s[64:67], s33 offen offset:1920 nt
    buffer_load_dwordx4 v[248:251], v9, s[64:67], s34 offen offset:384 nt
    buffer_load_dwordx4 v[252:255], v9, s[64:67], s34 offen offset:1920 nt
    s_add_u32 s4, s18, s24
    s_addc_u32 s5, s19, 0
    s_mov_b32 s6, 1572864
    s_mov_b32 s7, 0x20000
    s_mov_b32 s10, 786432
    s_mov_b32 s11, 0x20000
    s_mov_b32 s88, s16
    s_mov_b32 s89, s17
    s_add_u32 s16, s33, 3072
    s_add_u32 s17, s33, 6144
    s_mov_b32 s90, 256
    s_mov_b32 s91, 0x20000
    s_lshl_b32 s93, s94, 3
    s_cmp_lg_u32 s39, 0
    s_cbranch_scc1 L_notleader
    s_waitcnt lgkmcnt(0)
    s_mov_b32 s59, 1
    s_lshr_b32 s40, s40, 10
    s_min_u32 s40, s40, 31
    s_bitset1_b32 s59, s40
    s_lshr_b32 s41, s41, 10
    s_min_u32 s41, s41, 31
    s_bitset1_b32 s59, s41
    s_lshr_b32 s42, s42, 10
    s_min_u32 s42, s42, 31
    s_bitset1_b32 s59, s42
    s_lshr_b32 s43, s43, 10
    s_min_u32 s43, s43, 31
    s_bitset1_b32 s59, s43
    s_lshr_b32 s44, s44, 10
    s_min_u32 s44, s44, 31
    s_bitset1_b32 s59, s44
    s_lshr_b32 s45, s45, 10
    s_min_u32 s45, s45, 31
    s_bitset1_b32 s59, s45
    s_lshr_b32 s46, s46, 10
    s_min_u32 s46, s46, 31
    s_bitset1_b32 s59, s46
    s_lshr_b32 s47, s47, 10
    s_min_u32 s47, s47, 31
    s_bitset1_b32 s59, s47
    s_lshr_b32 s48, s48, 10
    s_min_u32 s48, s48, 31
    s_bitset1_b32 s59, s48
    s_lshr_b32 s49, s49, 10
    s_min_u32 s49, s49, 31
    s_bitset1_b32 s59, s49
    s_lshr_b32 s50, s50, 10
    s_min_u32 s50, s50, 31
    s_bitset1_b32 s59, s50
    s_lshr_b32 s51, s51, 10
    s_min_u32 s51, s51, 31
    s_bitset1_b32 s59, s51
    s_lshr_b32 s52, s52, 10
    s_min_u32 s52, s52, 31
    s_bitset1_b32 s59, s52
    s_lshr_b32 s53, s53, 10
    s_min_u32 s53, s53, 31
    s_bitset1_b32 s59, s53
    s_lshr_b32 s54, s54, 10
    s_min_u32 s54, s54, 31
    s_bitset1_b32 s59, s54
    s_lshr_b32 s55, s55, 10
    s_min_u32 s55, s55, 31
    s_bitset1_b32 s59, s55
    s_ff0_i32_b32 s59, s59
    s_lshl_b32 s59, s59, 10
    v_mov_b32 v52, s59
    s_mov_b64 exec, 1
    buffer_store_dword v52, off, s[88:91], s93 sc1
    s_mov_b64 exec, -1
L_notleader:
    s_lshl_b32 s24, s95, 2
    s_add_u32 s24, s24, 32
    s_buffer_load_dword s46, s[20:23], s24 glc
    s_getreg_b32 s45, hwreg(HW_REG_XCC_ID, 0, 4)
    s_lshl_b32 s45, s45, 5
    s_mov_b32 s44, 32
    buffer_load_dwordx3 v[112:114], v12, s[68:71], s35 offen offset:0 nt
    buffer_load_dwordx3 v[116:118], v12, s[68:71], s35 offen offset:768 nt
    buffer_load_dwordx3 v[120:122], v12, s[68:71], s35 offen offset:1536 nt
    buffer_load_dwordx3 v[124:126], v12, s[68:71], s35 offen offset:2304 nt
    buffer_load_dwordx2 v[40:41], off, s[80:83], s37 offset:0
    buffer_load_dwordx2 v[42:43], off, s[84:87], s37 offset:0
    buffer_load_dwordx2 v[44:45], off, s[80:83], s37 offset:8
    buffer_load_dwordx2 v[46:47], off, s[84:87], s37 offset:8
    s_mov_b32 s14, 786432
    s_mov_b32 s15, 0x20000
    s_lshl_b32 s24, s25, 8
    s_add_u32 s93, s93, s24
    v_mul_u32_u24 v30, 3072, v24
    v_add_u32 v4, v30, v1
    v_lshl_add_u32 v30, v24, 3, v26
    v_mul_u32_u24 v30, 384, v30
    v_lshlrev_b32 v31, 2, v29
    v_xor_b32 v31, v27, v31
    v_lshl_add_u32 v30, v31, 4, v30
    v_or_b32 v11, v30, v48
    v_lshlrev_b32 v30, 8, v24
    v_add_u32 v30, 12288, v30
    v_lshrrev_b32 v31, 5, v25
    v_mul_u32_u24 v31, 6144, v31
    v_add_u32 v30, v30, v31
    v_and_b32 v31, 1, v25
    v_mul_u32_u24 v31, 3072, v31
    v_add_u32 v30, v30, v31
    v_bfe_u32 v31, v25, 1, 4
    v_lshl_add_u32 v15, v31, 4, v30
    s_lshl_b32 s24, s95, 2
    v_lshl_add_u32 v13, v0, 2, s24
    v_cmp_lt_u32 vcc, 0, v0
    v_mov_b32 v30, 0x40000000
    s_nop 0
    v_cndmask_b32 v13, v13, v30, vcc
    s_mul_i32 s26, s25, 3072
    s_add_u32 s26, s26, 12288
    s_add_u32 s56, s26, 24576
    s_add_u32 s24, s95, 1
    s_and_b32 s24, s24, 7
    s_mul_i32 s32, s24, 24576
    s_add_u32 s27, s32, 12288
    s_mov_b32 s28, 98304
    s_mov_b32 s30, 73728
    v_add_u32 v1, 24576, v1
    s_mov_b32 s38, 0x3dd53b95
    s_mov_b32 s97, 0xffff0000
    s_mov_b32 s96, 100000
    v_and_b32 v26, 15, v25
    v_lshrrev_b32 v27, 4, v25
    v_bfe_u32 v28, v25, 1, 3
    v_xor_b32 v29, v27, v28
    v_mul_u32_u24 v30, 384, v26
    v_lshl_add_u32 v2, v29, 4, v30
    v_xor_b32 v3, 64, v2
    s_mul_i32 s40, s25, 6144
    s_add_u32 s40, s40, 73728
    v_lshrrev_b32 v29, 1, v27
    v_xor_b32 v29, v29, v28
    v_lshl_add_u32 v31, v29, 4, v30
    v_and_b32 v29, 1, v27
    v_lshl_add_u32 v31, v29, 3, v31
    v_xor_b32 v22, 0, v31
    v_add_u32 v22, s40, v22
    v_xor_b32 v23, 32, v31
    v_add_u32 v23, s40, v23
    v_xor_b32 v142, 64, v31
    v_add_u32 v142, s40, v142
    v_xor_b32 v143, 96, v31
    v_add_u32 v143, s40, v143
    s_lshl_b32 s24, s95, 2
    s_add_u32 s24, s24, s25
    s_mul_i32 s24, s24, 24576
    v_add_u32 v26, 0, v25
    v_mul_u32_u24 v27, 2731, v26
    v_lshrrev_b32 v27, 17, v27
    v_and_b32 v27, 7, v27
    v_xor_b32 v26, v26, v27
    v_lshlrev_b32 v136, 4, v26
    v_add_u32 v136, s24, v136
    v_add_u32 v26, 64, v25
    v_mul_u32_u24 v27, 2731, v26
    v_lshrrev_b32 v27, 17, v27
    v_and_b32 v27, 7, v27
    v_xor_b32 v26, v26, v27
    v_lshlrev_b32 v137, 4, v26
    v_add_u32 v137, s24, v137
    v_add_u32 v26, 128, v25
    v_mul_u32_u24 v27, 2731, v26
    v_lshrrev_b32 v27, 17, v27
    v_and_b32 v27, 7, v27
    v_xor_b32 v26, v26, v27
    v_lshlrev_b32 v138, 4, v26
    v_add_u32 v138, s24, v138
    v_add_u32 v26, 192, v25
    v_mul_u32_u24 v27, 2731, v26
    v_lshrrev_b32 v27, 17, v27
    v_and_b32 v27, 7, v27
    v_xor_b32 v26, v26, v27
    v_lshlrev_b32 v139, 4, v26
    v_add_u32 v139, s24, v139
    v_add_u32 v26, 256, v25
    v_mul_u32_u24 v27, 2731, v26
    v_lshrrev_b32 v27, 17, v27
    v_and_b32 v27, 7, v27
    v_xor_b32 v26, v26, v27
    v_lshlrev_b32 v140, 4, v26
    v_add_u32 v140, s24, v140
    v_add_u32 v26, 320, v25
    v_mul_u32_u24 v27, 2731, v26
    v_lshrrev_b32 v27, 17, v27
    v_and_b32 v27, 7, v27
    v_xor_b32 v26, v26, v27
    v_lshlrev_b32 v141, 4, v26
    v_add_u32 v141, s24, v141
    v_mov_b32 v5, 0
    v_mov_b32 v6, 0
    v_mov_b32 v7, 0
    v_mov_b32 v8, 0
    s_mov_b32 s62, -1
    s_mov_b32 s63, 0xffff
    s_waitcnt vmcnt(12)
    buffer_load_dwordx3 v[80:82], v12, s[68:71], s16 offen offset:0 nt
    buffer_load_dwordx3 v[84:86], v12, s[68:71], s16 offen offset:768 nt
    buffer_load_dwordx3 v[88:90], v12, s[68:71], s16 offen offset:1536 nt
    buffer_load_dwordx3 v[92:94], v12, s[68:71], s16 offen offset:2304 nt
    v_lshlrev_b32 v48, 16, v32
    v_and_b32 v49, s97, v32
    v_lshlrev_b32 v50, 16, v34
    v_and_b32 v51, s97, v34
    v_mul_f32 v48, s38, v48
    v_mul_f32 v49, s38, v49
    v_mul_f32_e64 v50, -v50, v48
    v_mul_f32_e64 v51, -v51, v49
    v_cvt_f32_i32 v224, v224
    v_cvt_f32_i32 v225, v225
    v_fma_f32 v224, v224, v48, v50
    v_fma_f32 v225, v225, v49, v51
    v_cvt_pk_bf16_f32 v224, v224, v225
    v_cvt_f32_i32 v228, v228
    v_cvt_f32_i32 v229, v229
    v_fma_f32 v228, v228, v48, v50
    v_fma_f32 v229, v229, v49, v51
    v_cvt_pk_bf16_f32 v228, v228, v229
    v_cvt_f32_i32 v232, v232
    v_cvt_f32_i32 v233, v233
    v_fma_f32 v232, v232, v48, v50
    v_fma_f32 v233, v233, v49, v51
    v_cvt_pk_bf16_f32 v232, v232, v233
    v_cvt_f32_i32 v236, v236
    v_cvt_f32_i32 v237, v237
    v_fma_f32 v236, v236, v48, v50
    v_fma_f32 v237, v237, v49, v51
    v_cvt_pk_bf16_f32 v236, v236, v237
    v_lshlrev_b32 v48, 16, v33
    v_and_b32 v49, s97, v33
    v_lshlrev_b32 v50, 16, v35
    v_and_b32 v51, s97, v35
    v_mul_f32 v48, s38, v48
    v_mul_f32 v49, s38, v49
    v_mul_f32_e64 v50, -v50, v48
    v_mul_f32_e64 v51, -v51, v49
    v_cvt_f32_i32 v226, v226
    v_cvt_f32_i32 v227, v227
    v_fma_f32 v226, v226, v48, v50
    v_fma_f32 v227, v227, v49, v51
    v_cvt_pk_bf16_f32 v225, v226, v227
    v_cvt_f32_i32 v230, v230
    v_cvt_f32_i32 v231, v231
    v_fma_f32 v230, v230, v48, v50
    v_fma_f32 v231, v231, v49, v51
    v_cvt_pk_bf16_f32 v229, v230, v231
    v_cvt_f32_i32 v234, v234
    v_cvt_f32_i32 v235, v235
    v_fma_f32 v234, v234, v48, v50
    v_fma_f32 v235, v235, v49, v51
    v_cvt_pk_bf16_f32 v233, v234, v235
    v_cvt_f32_i32 v238, v238
    v_cvt_f32_i32 v239, v239
    v_fma_f32 v238, v238, v48, v50
    v_fma_f32 v239, v239, v49, v51
    v_cvt_pk_bf16_f32 v237, v238, v239
    s_waitcnt vmcnt(12)
    v_lshlrev_b32 v48, 16, v36
    v_and_b32 v49, s97, v36
    v_lshlrev_b32 v50, 16, v38
    v_and_b32 v51, s97, v38
    v_mul_f32 v48, s38, v48
    v_mul_f32 v49, s38, v49
    v_mul_f32_e64 v50, -v50, v48
    v_mul_f32_e64 v51, -v51, v49
    v_cvt_f32_i32 v240, v240
    v_cvt_f32_i32 v241, v241
    v_fma_f32 v240, v240, v48, v50
    v_fma_f32 v241, v241, v49, v51
    v_cvt_pk_bf16_f32 v226, v240, v241
    v_cvt_f32_i32 v244, v244
    v_cvt_f32_i32 v245, v245
    v_fma_f32 v244, v244, v48, v50
    v_fma_f32 v245, v245, v49, v51
    v_cvt_pk_bf16_f32 v230, v244, v245
    v_cvt_f32_i32 v248, v248
    v_cvt_f32_i32 v249, v249
    v_fma_f32 v248, v248, v48, v50
    v_fma_f32 v249, v249, v49, v51
    v_cvt_pk_bf16_f32 v234, v248, v249
    v_cvt_f32_i32 v252, v252
    v_cvt_f32_i32 v253, v253
    v_fma_f32 v252, v252, v48, v50
    v_fma_f32 v253, v253, v49, v51
    v_cvt_pk_bf16_f32 v238, v252, v253
    v_lshlrev_b32 v48, 16, v37
    v_and_b32 v49, s97, v37
    v_lshlrev_b32 v50, 16, v39
    v_and_b32 v51, s97, v39
    v_mul_f32 v48, s38, v48
    v_mul_f32 v49, s38, v49
    v_mul_f32_e64 v50, -v50, v48
    v_mul_f32_e64 v51, -v51, v49
    v_cvt_f32_i32 v242, v242
    v_cvt_f32_i32 v243, v243
    v_fma_f32 v242, v242, v48, v50
    v_fma_f32 v243, v243, v49, v51
    v_cvt_pk_bf16_f32 v227, v242, v243
    v_cvt_f32_i32 v246, v246
    v_cvt_f32_i32 v247, v247
    v_fma_f32 v246, v246, v48, v50
    v_fma_f32 v247, v247, v49, v51
    v_cvt_pk_bf16_f32 v231, v246, v247
    v_cvt_f32_i32 v250, v250
    v_cvt_f32_i32 v251, v251
    v_fma_f32 v250, v250, v48, v50
    v_fma_f32 v251, v251, v49, v51
    v_cvt_pk_bf16_f32 v235, v250, v251
    v_cvt_f32_i32 v254, v254
    v_cvt_f32_i32 v255, v255
    v_fma_f32 v254, v254, v48, v50
    v_fma_f32 v255, v255, v49, v51
    v_cvt_pk_bf16_f32 v239, v254, v255
    buffer_store_dwordx4 v[224:227], v11, s[4:7], s33 offen offset:0
    s_mov_b64 exec, s[62:63]
    ds_write_b128 v11, v[224:227] offset:0
    s_mov_b64 exec, -1
    v_xor_b32 v55, 16, v11
    buffer_store_dwordx4 v[228:231], v55, s[4:7], s33 offen offset:768
    s_mov_b64 exec, s[62:63]
    ds_write_b128 v55, v[228:231] offset:768
    s_mov_b64 exec, -1
    v_xor_b32 v54, 32, v11
    buffer_store_dwordx4 v[232:235], v54, s[4:7], s33 offen offset:1536
    s_mov_b64 exec, s[62:63]
    ds_write_b128 v54, v[232:235] offset:1536
    s_mov_b64 exec, -1
    v_xor_b32 v55, 48, v11
    buffer_store_dwordx4 v[236:239], v55, s[4:7], s33 offen offset:2304
    s_mov_b64 exec, s[62:63]
    ds_write_b128 v55, v[236:239] offset:2304
    s_mov_b64 exec, -1
    s_mov_b32 s41, 0
    s_add_u32 m0, s40, 24576
    s_nop 0
    buffer_load_dwordx4 v136, s[8:11], s41 offen nt lds
    s_add_u32 m0, s40, 25600
    s_nop 0
    buffer_load_dwordx4 v137, s[8:11], s41 offen nt lds
    s_add_u32 m0, s40, 26624
    s_nop 0
    buffer_load_dwordx4 v138, s[8:11], s41 offen nt lds
    s_add_u32 m0, s40, 27648
    s_nop 0
    buffer_load_dwordx4 v139, s[8:11], s41 offen nt lds
    s_add_u32 m0, s40, 28672
    s_nop 0
    buffer_load_dwordx4 v140, s[8:11], s41 offen nt lds
    s_add_u32 m0, s40, 29696
    s_waitcnt vmcnt(20)
    buffer_load_dwordx4 v141, s[8:11], s41 offen nt lds
    s_waitcnt vmcnt(14)
    v_lshlrev_b32 v48, 16, v40
    v_and_b32 v49, s97, v40
    v_lshlrev_b32 v50, 16, v42
    v_and_b32 v51, s97, v42
    v_mul_f32_e64 v50, -v50, v48
    v_mul_f32_e64 v51, -v51, v49
    v_cvt_f32_i32 v112, v112
    v_cvt_f32_i32 v116, v116
    v_fma_f32 v112, v112, v48, v50
    v_fma_f32 v116, v116, v49, v51
    v_cvt_f32_i32 v113, v113
    v_cvt_f32_i32 v117, v117
    v_fma_f32 v113, v113, v48, v50
    v_fma_f32 v117, v117, v49, v51
    v_cvt_f32_i32 v114, v114
    v_cvt_f32_i32 v118, v118
    v_fma_f32 v114, v114, v48, v50
    v_fma_f32 v118, v118, v49, v51
    v_lshlrev_b32 v48, 16, v41
    v_and_b32 v49, s97, v41
    v_lshlrev_b32 v50, 16, v43
    v_and_b32 v51, s97, v43
    v_mul_f32_e64 v50, -v50, v48
    v_mul_f32_e64 v51, -v51, v49
    v_cvt_f32_i32 v120, v120
    v_cvt_f32_i32 v124, v124
    v_fma_f32 v120, v120, v48, v50
    v_fma_f32 v124, v124, v49, v51
    v_cvt_f32_i32 v121, v121
    v_cvt_f32_i32 v125, v125
    v_fma_f32 v121, v121, v48, v50
    v_fma_f32 v125, v125, v49, v51
    v_cvt_f32_i32 v122, v122
    v_cvt_f32_i32 v126, v126
    v_fma_f32 v122, v122, v48, v50
    v_fma_f32 v126, v126, v49, v51
    v_cvt_pk_bf16_f32 v112, v112, v116
    v_cvt_pk_bf16_f32 v116, v113, v117
    v_cvt_pk_bf16_f32 v113, v120, v124
    v_cvt_pk_bf16_f32 v117, v121, v125
    v_cvt_pk_bf16_f32 v120, v114, v118
    v_cvt_pk_bf16_f32 v121, v122, v126
    s_waitcnt vmcnt(10)
    v_lshlrev_b32 v48, 16, v44
    v_and_b32 v49, s97, v44
    v_lshlrev_b32 v50, 16, v46
    v_and_b32 v51, s97, v46
    v_mul_f32_e64 v50, -v50, v48
    v_mul_f32_e64 v51, -v51, v49
    v_cvt_f32_i32 v80, v80
    v_cvt_f32_i32 v84, v84
    v_fma_f32 v80, v80, v48, v50
    v_fma_f32 v84, v84, v49, v51
    v_cvt_f32_i32 v81, v81
    v_cvt_f32_i32 v85, v85
    v_fma_f32 v81, v81, v48, v50
    v_fma_f32 v85, v85, v49, v51
    v_cvt_f32_i32 v82, v82
    v_cvt_f32_i32 v86, v86
    v_fma_f32 v82, v82, v48, v50
    v_fma_f32 v86, v86, v49, v51
    v_lshlrev_b32 v48, 16, v45
    v_and_b32 v49, s97, v45
    v_lshlrev_b32 v50, 16, v47
    v_and_b32 v51, s97, v47
    v_mul_f32_e64 v50, -v50, v48
    v_mul_f32_e64 v51, -v51, v49
    v_cvt_f32_i32 v88, v88
    v_cvt_f32_i32 v92, v92
    v_fma_f32 v88, v88, v48, v50
    v_fma_f32 v92, v92, v49, v51
    v_cvt_f32_i32 v89, v89
    v_cvt_f32_i32 v93, v93
    v_fma_f32 v89, v89, v48, v50
    v_fma_f32 v93, v93, v49, v51
    v_cvt_f32_i32 v90, v90
    v_cvt_f32_i32 v94, v94
    v_fma_f32 v90, v90, v48, v50
    v_fma_f32 v94, v94, v49, v51
    v_cvt_pk_bf16_f32 v114, v80, v84
    v_cvt_pk_bf16_f32 v118, v81, v85
    v_cvt_pk_bf16_f32 v115, v88, v92
    v_cvt_pk_bf16_f32 v119, v89, v93
    v_cvt_pk_bf16_f32 v122, v82, v86
    v_cvt_pk_bf16_f32 v123, v90, v94
    buffer_store_dwordx4 v[112:115], v15, s[4:7], s35 offen offset:0
    buffer_store_dwordx4 v[116:119], v15, s[4:7], s35 offen offset:1024
    buffer_store_dwordx4 v[120:123], v15, s[4:7], s35 offen offset:2048
    ds_write_b128 v15, v[112:115] offset:12288
    ds_write_b128 v15, v[116:119] offset:13312
    ds_write_b128 v15, v[120:123] offset:14336
    buffer_load_dword v0, off, s[88:91], s93 sc1
    s_mov_b32 s41, 6144
    s_add_u32 m0, s40, 0
    s_nop 0
    buffer_load_dwordx4 v136, s[8:11], s41 offen nt lds
    s_add_u32 m0, s40, 1024
    s_nop 0
    buffer_load_dwordx4 v137, s[8:11], s41 offen nt lds
    s_add_u32 m0, s40, 2048
    s_nop 0
    buffer_load_dwordx4 v138, s[8:11], s41 offen nt lds
    s_add_u32 m0, s40, 3072
    s_nop 0
    buffer_load_dwordx4 v139, s[8:11], s41 offen nt lds
    s_add_u32 m0, s40, 4096
    s_nop 0
    buffer_load_dwordx4 v140, s[8:11], s41 offen nt lds
    s_add_u32 m0, s40, 5120
    s_waitcnt vmcnt(14)
    buffer_load_dwordx4 v141, s[8:11], s41 offen nt lds
    s_mov_b64 exec, 0
    s_cmp_eq_u32 s25, 0
    s_cbranch_scc1 L_iw0
    s_cmp_eq_u32 s25, 1
    s_cbranch_scc1 L_iw1
    s_cmp_eq_u32 s25, 2
    s_cbranch_scc1 L_iw2
    s_branch L_iw3
L_iwret:
    s_mov_b64 exec, -1
    s_waitcnt vmcnt(6)
    s_cmp_lg_u32 s25, 0
    s_cbranch_scc1 L_tagdone
    v_readfirstlane_b32 s42, v0
    s_mov_b32 s39, 100
    s_waitcnt lgkmcnt(0)
    s_and_b32 s46, s46, 0xfffffc00
L_tagretry:
    s_cmp_eq_u32 s42, s46
    s_cselect_b32 s42, 0, s42
    s_cmp_lg_u32 s42, 0
    s_cbranch_scc1 L_tagok
    s_sub_u32 s39, s39, 1
    s_cbranch_scc1 L_tagslow
    s_sleep 4
    s_buffer_load_dword s42, s[88:91], s93 glc
    s_waitcnt lgkmcnt(0)
    s_branch L_tagretry
L_tagok:
    s_add_u32 s42, s42, s45
    v_mov_b32 v0, s42
    v_mov_b32 v16, 147456
    ds_write_b32 v16, v0
L_tagdone:
    s_waitcnt lgkmcnt(0)
    s_barrier
    v_add_u32 v0, 1, v0
    buffer_store_dword v0, v13, s[20:23], 0 offen offset:32 sc1
    v_mov_b32 v16, 147456
    ds_read_b32 v17, v16
    ds_read_b128 v[144:147], v2 offset:0
    ds_read_b128 v[148:151], v3 offset:0
    ds_read_b128 v[152:155], v2 offset:6144
    ds_read_b128 v[156:159], v3 offset:6144
    ds_read_b128 v[160:163], v2 offset:128
    ds_read_b128 v[164:167], v3 offset:128
    ds_read_b128 v[168:171], v2 offset:6272
    ds_read_b128 v[172:175], v3 offset:6272
    ds_read_b128 v[176:179], v2 offset:256
    ds_read_b128 v[180:183], v3 offset:256
    ds_read_b128 v[184:187], v2 offset:6400
    ds_read_b128 v[188:191], v3 offset:6400
    s_mov_b32 s41, 12288
    s_add_u32 m0, s40, 49152
    s_nop 0
    buffer_load_dwordx4 v136, s[8:11], s41 offen nt lds
    s_add_u32 m0, s40, 50176
    s_nop 0
    buffer_load_dwordx4 v137, s[8:11], s41 offen nt lds
    s_add_u32 m0, s40, 51200
    s_nop 0
    buffer_load_dwordx4 v138, s[8:11], s41 offen nt lds
    s_add_u32 m0, s40, 52224
    s_nop 0
    buffer_load_dwordx4 v139, s[8:11], s41 offen nt lds
    s_add_u32 m0, s40, 53248
    s_nop 0
    buffer_load_dwordx4 v140, s[8:11], s41 offen nt lds
    s_add_u32 m0, s40, 54272
    s_nop 0
    buffer_load_dwordx4 v141, s[8:11], s41 offen nt lds
    s_waitcnt vmcnt(17)
    ds_read_b64 a[192:193], v22 offset:24576
    ds_read_b64 a[194:195], v142 offset:24704
    ds_read_b64 a[196:197], v23 offset:24576
    ds_read_b64 a[198:199], v143 offset:24704
    ds_read_b64 a[200:201], v142 offset:24576
    ds_read_b64 a[202:203], v22 offset:24832
    ds_read_b64 a[204:205], v143 offset:24576
    ds_read_b64 a[206:207], v23 offset:24832
    ds_read_b64 a[208:209], v22 offset:24704
    ds_read_b64 a[210:211], v142 offset:24832
    ds_read_b64 a[212:213], v23 offset:24704
    ds_read_b64 a[214:215], v143 offset:24832
    s_waitcnt lgkmcnt(15)
    v_readfirstlane_b32 s92, v17
    s_add_u32 s92, s92, 1
    s_waitcnt lgkmcnt(0)
    s_mov_b32 s41, 18432
    s_add_u32 m0, s40, 24576
    s_waitcnt vmcnt(12)
    buffer_load_dwordx4 v136, s[8:11], s41 offen nt lds
    s_add_u32 m0, s40, 25600
    s_waitcnt vmcnt(12)
    buffer_load_dwordx4 v137, s[8:11], s41 offen nt lds
    s_add_u32 m0, s40, 26624
    s_waitcnt vmcnt(12)
    buffer_load_dwordx4 v138, s[8:11], s41 offen nt lds
    v_mfma_f32_16x16x32_bf16 v[64:67], v[144:147], a[192:195], 0
    v_mfma_f32_16x16x32_bf16 v[64:67], v[148:151], a[196:199], v[64:67]
    v_mfma_f32_16x16x32_bf16 v[64:67], v[160:163], a[200:203], v[64:67]
    v_mfma_f32_16x16x32_bf16 v[64:67], v[164:167], a[204:207], v[64:67]
    v_mfma_f32_16x16x32_bf16 v[64:67], v[176:179], a[208:211], v[64:67]
    v_mfma_f32_16x16x32_bf16 v[64:67], v[180:183], a[212:215], v[64:67]
    v_mfma_f32_16x16x32_bf16 v[96:99], v[152:155], a[192:195], 0
    v_mfma_f32_16x16x32_bf16 v[96:99], v[156:159], a[196:199], v[96:99]
    v_mfma_f32_16x16x32_bf16 v[96:99], v[168:171], a[200:203], v[96:99]
    v_mfma_f32_16x16x32_bf16 v[96:99], v[172:175], a[204:207], v[96:99]
    v_mfma_f32_16x16x32_bf16 v[96:99], v[184:187], a[208:211], v[96:99]
    v_mfma_f32_16x16x32_bf16 v[96:99], v[188:191], a[212:215], v[96:99]
    s_waitcnt vmcnt(10)
    ds_read_b64 a[216:217], v22 offset:0
    ds_read_b64 a[218:219], v142 offset:128
    ds_read_b64 a[220:221], v23 offset:0
    ds_read_b64 a[222:223], v143 offset:128
    ds_read_b64 a[224:225], v142 offset:0
    ds_read_b64 a[226:227], v22 offset:256
    ds_read_b64 a[228:229], v143 offset:0
    ds_read_b64 a[230:231], v23 offset:256
    ds_read_b64 a[232:233], v22 offset:128
    ds_read_b64 a[234:235], v142 offset:256
    ds_read_b64 a[236:237], v23 offset:128
    ds_read_b64 a[238:239], v143 offset:256
    s_mov_b32 s41, 18432
    s_add_u32 m0, s40, 27648
    s_nop 0
    buffer_load_dwordx4 v139, s[8:11], s41 offen nt lds
    s_add_u32 m0, s40, 28672
    s_nop 0
    buffer_load_dwordx4 v140, s[8:11], s41 offen nt lds
    s_add_u32 m0, s40, 29696
    s_nop 0
    buffer_load_dwordx4 v141, s[8:11], s41 offen nt lds
    v_max3_f32 v48, v64, v65, v66
L_iw0:
L_pg0:
    s_cbranch_execz L_pg4
    v_max3_f32 v50, v67, v96, v97
    v_max3_f32 v48, v48, v98, v99
    v_max_f32 v48, v48, v50
    v_mov_b32 v49, v48
    s_nop 1
    v_permlane16_swap_b32 v48, v49
    s_nop 1
    v_max_f32 v48, v48, v49
    v_mov_b32 v49, v48
    s_nop 1
    v_permlane32_swap_b32 v48, v49
    s_nop 1
    v_max_f32 v48, v48, v49
    s_waitcnt lgkmcnt(0)
    v_mfma_f32_16x16x32_bf16 v[68:71], v[144:147], a[216:219], 0
    v_sub_f32 v64, v64, v48
    v_sub_f32 v65, v65, v48
    v_sub_f32 v66, v66, v48
    v_mfma_f32_16x16x32_bf16 v[68:71], v[148:151], a[220:223], v[68:71]
    v_sub_f32 v67, v67, v48
    v_sub_f32 v96, v96, v48
    v_sub_f32 v97, v97, v48
    v_mfma_f32_16x16x32_bf16 v[68:71], v[160:163], a[224:227], v[68:71]
    v_sub_f32 v98, v98, v48
    v_sub_f32 v99, v99, v48
    v_mfma_f32_16x16x32_bf16 v[68:71], v[164:167], a[228:231], v[68:71]
    v_exp_f32 v64, v64
    v_mfma_f32_16x16x32_bf16 v[68:71], v[176:179], a[232:235], v[68:71]
    v_exp_f32 v65, v65
    v_mfma_f32_16x16x32_bf16 v[68:71], v[180:183], a[236:239], v[68:71]
    v_exp_f32 v66, v66
    v_mfma_f32_16x16x32_bf16 v[100:103], v[152:155], a[216:219], 0
    v_exp_f32 v67, v67
    v_mfma_f32_16x16x32_bf16 v[100:103], v[156:159], a[220:223], v[100:103]
    v_exp_f32 v96, v96
    v_mfma_f32_16x16x32_bf16 v[100:103], v[168:171], a[224:227], v[100:103]
    v_exp_f32 v97, v97
    v_mfma_f32_16x16x32_bf16 v[100:103], v[172:175], a[228:231], v[100:103]
    v_exp_f32 v98, v98
    v_mfma_f32_16x16x32_bf16 v[100:103], v[184:187], a[232:235], v[100:103]
    v_exp_f32 v99, v99
    v_sub_f32 v128, 0, v48
    v_mfma_f32_16x16x32_bf16 v[100:103], v[188:191], a[236:239], v[100:103]
    v_sub_f32 v129, 0, v48
    v_sub_f32 v130, 0, v48
    v_sub_f32 v131, 0, v48
    v_add_f32 v5, v5, v64
    v_add_f32 v5, v5, v65
    v_add_f32 v5, v5, v66
    v_add_f32 v5, v5, v67
    v_add_f32 v5, v5, v96
    v_add_f32 v5, v5, v97
    v_add_f32 v5, v5, v98
    v_add_f32 v5, v5, v99
    v_cvt_pk_bf16_f32 v64, v64, v65
    v_cvt_pk_bf16_f32 v65, v66, v67
    v_cvt_pk_bf16_f32 v66, v96, v97
    v_cvt_pk_bf16_f32 v67, v98, v99
    s_waitcnt vmcnt(6)
    ds_read_b64 a[240:241], v22 offset:49152
    ds_read_b64 a[242:243], v142 offset:49280
    ds_read_b64 a[244:245], v23 offset:49152
    ds_read_b64 a[246:247], v143 offset:49280
    ds_read_b64 a[248:249], v142 offset:49152
    ds_read_b64 a[250:251], v22 offset:49408
    ds_read_b64 a[252:253], v143 offset:49152
    ds_read_b64 a[254:255], v23 offset:49408
    ds_read_b64 v[192:193], v22 offset:49280
    ds_read_b64 v[194:195], v142 offset:49408
    ds_read_b64 v[196:197], v23 offset:49280
    ds_read_b64 v[198:199], v143 offset:49408
    s_buffer_load_dwordx8 s[48:55], s[20:23], s44 glc
    v_max3_f32 v48, v68, v69, v70
    v_max3_f32 v50, v71, v100, v101
    v_max3_f32 v48, v48, v102, v103
    v_max_f32 v48, v48, v50
    v_mov_b32 v49, v48
    s_nop 1
    v_permlane16_swap_b32 v48, v49
    s_nop 1
    v_max_f32 v48, v48, v49
    v_mov_b32 v49, v48
    s_nop 1
    v_permlane32_swap_b32 v48, v49
    s_nop 1
    v_max_f32 v48, v48, v49
    s_waitcnt lgkmcnt(0)
    v_mfma_f32_16x16x32_bf16 v[72:75], v[144:147], a[240:243], 0
    v_sub_f32 v68, v68, v48
    v_sub_f32 v69, v69, v48
    v_sub_f32 v70, v70, v48
    v_mfma_f32_16x16x32_bf16 v[72:75], v[148:151], a[244:247], v[72:75]
    v_sub_f32 v71, v71, v48
    v_sub_f32 v100, v100, v48
    v_sub_f32 v101, v101, v48
    v_mfma_f32_16x16x32_bf16 v[72:75], v[160:163], a[248:251], v[72:75]
    v_sub_f32 v102, v102, v48
    v_sub_f32 v103, v103, v48
    v_mfma_f32_16x16x32_bf16 v[72:75], v[164:167], a[252:255], v[72:75]
    v_exp_f32 v68, v68
    v_mfma_f32_16x16x32_bf16 v[72:75], v[176:179], v[192:195], v[72:75]
    v_exp_f32 v69, v69
    v_mfma_f32_16x16x32_bf16 v[72:75], v[180:183], v[196:199], v[72:75]
    v_exp_f32 v70, v70
    v_mfma_f32_16x16x32_bf16 v[104:107], v[152:155], a[240:243], 0
    v_exp_f32 v71, v71
    v_mfma_f32_16x16x32_bf16 v[104:107], v[156:159], a[244:247], v[104:107]
    v_exp_f32 v100, v100
    v_mfma_f32_16x16x32_bf16 v[104:107], v[168:171], a[248:251], v[104:107]
    v_exp_f32 v101, v101
    v_mfma_f32_16x16x32_bf16 v[104:107], v[172:175], a[252:255], v[104:107]
    v_exp_f32 v102, v102
    v_mfma_f32_16x16x32_bf16 v[104:107], v[184:187], v[192:195], v[104:107]
    v_exp_f32 v103, v103
    v_sub_f32 v132, 0, v48
    v_mfma_f32_16x16x32_bf16 v[104:107], v[188:191], v[196:199], v[104:107]
    v_sub_f32 v133, 0, v48
    v_sub_f32 v134, 0, v48
    v_sub_f32 v135, 0, v48
    v_add_f32 v6, v6, v68
    v_add_f32 v6, v6, v69
    v_add_f32 v6, v6, v70
    v_add_f32 v6, v6, v71
    v_add_f32 v6, v6, v100
    v_add_f32 v6, v6, v101
    v_add_f32 v6, v6, v102
    v_add_f32 v6, v6, v103
    v_cvt_pk_bf16_f32 v68, v68, v69
    v_cvt_pk_bf16_f32 v69, v70, v71
    v_cvt_pk_bf16_f32 v70, v100, v101
    v_cvt_pk_bf16_f32 v71, v102, v103
    ds_read_b128 v[24:27], v1 offset:0
    ds_read_b128 v[28:31], v1 offset:1024
    ds_read_b128 v[32:35], v1 offset:2048
    ds_read_b128 v[36:39], v1 offset:3072
    s_waitcnt lgkmcnt(0)
    s_sub_u32 s48, s48, s92
    s_sub_u32 s49, s49, s92
    s_sub_u32 s50, s50, s92
    s_sub_u32 s51, s51, s92
    s_sub_u32 s52, s52, s92
    s_sub_u32 s53, s53, s92
    s_sub_u32 s54, s54, s92
    s_sub_u32 s55, s55, s92
    s_max_u32 s48, s48, s49
    s_max_u32 s48, s48, s50
    s_max_u32 s48, s48, s51
    s_max_u32 s48, s48, s52
    s_max_u32 s48, s48, s53
    s_max_u32 s48, s48, s54
    s_max_u32 s48, s48, s55
    s_cmp_ge_u32 s48, 16
    s_cbranch_scc1 L_pollslow0
L_pollok0:
    s_add_u32 s92, s92, 1
    s_mov_b32 m0, s26
    s_nop 0
    buffer_load_dwordx4 v4, s[4:7], s32 offen offset:0 sc1 lds
    buffer_load_dwordx4 v4, s[4:7], s32 offen offset:1024 sc1 lds
    buffer_load_dwordx4 v4, s[4:7], s32 offen offset:2048 sc1 lds
    s_add_u32 s32, s32, 24576
    s_sub_u32 s57, s32, 196608
    s_min_u32 s32, s32, s57
    s_add_u32 s26, s26, 36864
    s_sub_u32 s57, s26, 147456
    s_min_u32 s26, s26, s57
    s_mov_b32 m0, s26
    s_nop 0
    buffer_load_dwordx4 v4, s[4:7], s32 offen offset:0 sc1 lds
    buffer_load_dwordx4 v4, s[4:7], s32 offen offset:1024 sc1 lds
    buffer_load_dwordx4 v4, s[4:7], s32 offen offset:2048 sc1 lds
    s_add_u32 s32, s32, 24576
    s_sub_u32 s57, s32, 196608
    s_min_u32 s32, s32, s57
    s_add_u32 s26, s26, 12288
    s_mov_b32 m0, s26
    s_waitcnt vmcnt(11)
    buffer_load_dwordx4 v4, s[4:7], s32 offen offset:0 sc1 lds
    s_waitcnt vmcnt(11)
    buffer_load_dwordx4 v4, s[4:7], s32 offen offset:1024 sc1 lds
    s_waitcnt vmcnt(11)
    buffer_load_dwordx4 v4, s[4:7], s32 offen offset:2048 sc1 lds
    s_add_u32 s32, s32, 24576
    s_sub_u32 s57, s32, 196608
    s_min_u32 s32, s32, s57
    s_add_u32 s26, s26, 36864
    s_sub_u32 s57, s26, 147456
    s_min_u32 s26, s26, s57
    s_mov_b32 m0, s56
    s_waitcnt vmcnt(11)
    buffer_load_dwordx4 v4, s[4:7], s27 offen offset:0 sc1 lds
    s_waitcnt vmcnt(11)
    buffer_load_dwordx4 v4, s[4:7], s27 offen offset:1024 sc1 lds
    s_waitcnt vmcnt(11)
    buffer_load_dwordx4 v4, s[4:7], s27 offen offset:2048 sc1 lds
    s_add_u32 s27, s27, 24576
    s_sub_u32 s58, s27, 196608
    s_min_u32 s27, s27, s58
    s_add_u32 s56, s56, 36864
    s_sub_u32 s58, s56, 147456
    s_min_u32 s56, s56, s58
    s_add_u32 s33, s33, 196608
    s_add_u32 s34, s34, 196608
    s_add_u32 s36, s36, 1536
    s_add_u32 s35, s35, 196608
    s_add_u32 s16, s16, 196608
    s_add_u32 s17, s17, 196608
    s_add_u32 s37, s37, 512
    v_mfma_f32_16x16x32_bf16 a[0:3], v[64:67], v[24:27], 0
    ds_read_b128 v[40:43], v1 offset:4096
    v_max3_f32 v48, v72, v73, v74
    v_mfma_f32_16x16x32_bf16 a[4:7], v[64:67], v[28:31], 0
    v_max3_f32 v50, v75, v104, v105
    v_max3_f32 v48, v48, v106, v107
    v_mfma_f32_16x16x32_bf16 a[48:51], v[68:71], v[24:27], 0
    ds_read_b128 v[44:47], v1 offset:5120
    v_max_f32 v48, v48, v50
    v_mfma_f32_16x16x32_bf16 a[52:55], v[68:71], v[28:31], 0
    s_waitcnt lgkmcnt(2)
    v_mov_b32 v49, v48
    v_mfma_f32_16x16x32_bf16 a[8:11], v[64:67], v[32:35], 0
    s_nop 1
    ds_read_b128 v[24:27], v1 offset:6144
    v_mfma_f32_16x16x32_bf16 a[12:15], v[64:67], v[36:39], 0
    v_permlane16_swap_b32 v48, v49
    s_nop 1
    v_mfma_f32_16x16x32_bf16 a[56:59], v[68:71], v[32:35], 0
    ds_read_b128 v[28:31], v1 offset:7168
    v_max_f32 v48, v48, v49
    v_mfma_f32_16x16x32_bf16 a[60:63], v[68:71], v[36:39], 0
    s_waitcnt lgkmcnt(2)
    v_mov_b32 v49, v48
    s_nop 1
    v_mfma_f32_16x16x32_bf16 a[16:19], v[64:67], v[40:43], 0
    ds_read_b128 v[32:35], v1 offset:8192
    v_permlane32_swap_b32 v48, v49
    v_mfma_f32_16x16x32_bf16 a[20:23], v[64:67], v[44:47], 0
    s_nop 1
    v_max_f32 v48, v48, v49
    v_sub_f32 v72, v72, v48
    v_mfma_f32_16x16x32_bf16 a[64:67], v[68:71], v[40:43], 0
    ds_read_b128 v[36:39], v1 offset:9216
    v_sub_f32 v73, v73, v48
    v_mfma_f32_16x16x32_bf16 a[68:71], v[68:71], v[44:47], 0
    s_waitcnt lgkmcnt(2)
    v_sub_f32 v74, v74, v48
    v_sub_f32 v75, v75, v48
    v_sub_f32 v104, v104, v48
    v_mfma_f32_16x16x32_bf16 a[24:27], v[64:67], v[24:27], 0
    ds_read_b128 v[40:43], v1 offset:10240
    v_sub_f32 v105, v105, v48
    v_mfma_f32_16x16x32_bf16 a[28:31], v[64:67], v[28:31], 0
    v_sub_f32 v106, v106, v48
    v_sub_f32 v107, v107, v48
    v_mfma_f32_16x16x32_bf16 a[72:75], v[68:71], v[24:27], 0
    ds_read_b128 v[44:47], v1 offset:11264
    v_mfma_f32_16x16x32_bf16 a[76:79], v[68:71], v[28:31], 0
    s_waitcnt lgkmcnt(2)
    v_exp_f32 v72, v72
    v_mfma_f32_16x16x32_bf16 a[32:35], v[64:67], v[32:35], 0
    v_exp_f32 v73, v73
    v_mfma_f32_16x16x32_bf16 a[36:39], v[64:67], v[36:39], 0
    v_exp_f32 v74, v74
    v_mfma_f32_16x16x32_bf16 a[80:83], v[68:71], v[32:35], 0
    v_exp_f32 v75, v75
    v_mfma_f32_16x16x32_bf16 a[84:87], v[68:71], v[36:39], 0
    s_waitcnt lgkmcnt(0)
    v_exp_f32 v104, v104
    v_mfma_f32_16x16x32_bf16 a[40:43], v[64:67], v[40:43], 0
    v_exp_f32 v105, v105
    v_mfma_f32_16x16x32_bf16 a[44:47], v[64:67], v[44:47], 0
    v_exp_f32 v106, v106
    v_mfma_f32_16x16x32_bf16 a[88:91], v[68:71], v[40:43], 0
    v_exp_f32 v107, v107
    v_mfma_f32_16x16x32_bf16 a[92:95], v[68:71], v[44:47], 0
    v_sub_f32 v136, 0, v48
    v_sub_f32 v137, 0, v48
    v_sub_f32 v138, 0, v48
    v_sub_f32 v139, 0, v48
    v_add_f32 v7, v7, v72
    v_add_f32 v7, v7, v73
    v_add_f32 v7, v7, v74
    v_add_f32 v7, v7, v75
    v_add_f32 v7, v7, v104
    v_add_f32 v7, v7, v105
    v_add_f32 v7, v7, v106
    v_add_f32 v7, v7, v107
    v_cvt_pk_bf16_f32 v72, v72, v73
    v_cvt_pk_bf16_f32 v73, v74, v75
    v_cvt_pk_bf16_f32 v74, v104, v105
    v_cvt_pk_bf16_f32 v75, v106, v107
    s_waitcnt vmcnt(12)
    ds_read_b64 v[200:201], v22 offset:24576
    ds_read_b64 v[202:203], v142 offset:24704
    ds_read_b64 v[204:205], v23 offset:24576
    ds_read_b64 v[206:207], v143 offset:24704
    ds_read_b64 v[208:209], v142 offset:24576
    ds_read_b64 v[210:211], v22 offset:24832
    ds_read_b64 v[212:213], v143 offset:24576
    ds_read_b64 v[214:215], v23 offset:24832
    ds_read_b64 v[216:217], v22 offset:24704
    ds_read_b64 v[218:219], v142 offset:24832
    ds_read_b64 v[220:221], v23 offset:24704
    ds_read_b64 v[222:223], v143 offset:24832
    s_waitcnt lgkmcnt(0)
    v_mfma_f32_16x16x32_bf16 v[76:79], v[144:147], v[200:203], 0
    v_mfma_f32_16x16x32_bf16 v[76:79], v[148:151], v[204:207], v[76:79]
    v_mfma_f32_16x16x32_bf16 v[76:79], v[160:163], v[208:211], v[76:79]
    v_mfma_f32_16x16x32_bf16 v[76:79], v[164:167], v[212:215], v[76:79]
    v_mfma_f32_16x16x32_bf16 v[76:79], v[176:179], v[216:219], v[76:79]
    v_mfma_f32_16x16x32_bf16 v[76:79], v[180:183], v[220:223], v[76:79]
    v_mfma_f32_16x16x32_bf16 v[108:111], v[152:155], v[200:203], 0
    v_mfma_f32_16x16x32_bf16 v[108:111], v[156:159], v[204:207], v[108:111]
    v_mfma_f32_16x16x32_bf16 v[108:111], v[168:171], v[208:211], v[108:111]
    v_mfma_f32_16x16x32_bf16 v[108:111], v[172:175], v[212:215], v[108:111]
    v_mfma_f32_16x16x32_bf16 v[108:111], v[184:187], v[216:219], v[108:111]
    v_mfma_f32_16x16x32_bf16 v[108:111], v[188:191], v[220:223], v[108:111]
    s_nop 7
    v_max3_f32 v48, v76, v77, v78
    v_max3_f32 v50, v79, v108, v109
    v_max3_f32 v48, v48, v110, v111
    v_max_f32 v48, v48, v50
    v_mov_b32 v49, v48
    s_nop 1
    v_permlane16_swap_b32 v48, v49
    s_nop 1
    v_max_f32 v48, v48, v49
    v_mov_b32 v49, v48
    s_nop 1
    v_permlane32_swap_b32 v48, v49
    s_nop 1
    v_max_f32 v48, v48, v49
    v_sub_f32 v140, 0, v48
    v_sub_f32 v141, 0, v48
    v_sub_f32 v142, 0, v48
    v_sub_f32 v143, 0, v48
    s_waitcnt vmcnt(9)
    s_barrier
    ds_read_b128 v[24:27], v2 offset:12288
    ds_read_b128 v[28:31], v3 offset:12288
    ds_read_b128 v[32:35], v2 offset:18432
    ds_read_b128 v[36:39], v3 offset:18432
    s_waitcnt lgkmcnt(2)
    v_mfma_f32_16x16x32_bf16 v[80:83], v[24:27], a[192:195], v[128:131]
    ds_read_b128 v[40:43], v2 offset:12416
    v_sub_f32 v76, v76, v48
    v_mfma_f32_16x16x32_bf16 v[80:83], v[28:31], a[196:199], v[80:83]
    buffer_load_dwordx2 v[56:57], v10, s[72:75], s36 offen offset:0
    v_mfma_f32_16x16x32_bf16 v[84:87], v[24:27], a[216:219], v[132:135]
    v_sub_f32 v77, v77, v48
    v_sub_f32 v78, v78, v48
    v_mfma_f32_16x16x32_bf16 v[84:87], v[28:31], a[220:223], v[84:87]
    buffer_load_dwordx2 v[58:59], v10, s[76:79], s36 offen offset:0
    v_mfma_f32_16x16x32_bf16 v[88:91], v[24:27], a[240:243], v[136:139]
    ds_read_b128 v[44:47], v3 offset:12416
    v_sub_f32 v79, v79, v48
    v_mfma_f32_16x16x32_bf16 v[88:91], v[28:31], a[244:247], v[88:91]
    buffer_load_dwordx4 v[224:227], v9, s[64:67], s33 offen offset:0 nt
    v_mfma_f32_16x16x32_bf16 v[92:95], v[24:27], v[200:203], v[140:143]
    v_sub_f32 v108, v108, v48
    v_sub_f32 v109, v109, v48
    v_mfma_f32_16x16x32_bf16 v[92:95], v[28:31], v[204:207], v[92:95]
    s_waitcnt lgkmcnt(2)
    buffer_load_dwordx4 v[228:231], v9, s[64:67], s33 offen offset:1536 nt
    v_mfma_f32_16x16x32_bf16 v[112:115], v[32:35], a[192:195], v[128:131]
    ds_read_b128 v[24:27], v2 offset:18560
    v_sub_f32 v110, v110, v48
    v_mfma_f32_16x16x32_bf16 v[112:115], v[36:39], a[196:199], v[112:115]
    buffer_load_dwordx4 v[232:235], v9, s[64:67], s34 offen offset:0 nt
    v_mfma_f32_16x16x32_bf16 v[116:119], v[32:35], a[216:219], v[132:135]
    v_sub_f32 v111, v111, v48
    v_mfma_f32_16x16x32_bf16 v[116:119], v[36:39], a[220:223], v[116:119]
    s_waitcnt vmcnt(13)
    buffer_load_dwordx4 v[236:239], v9, s[64:67], s34 offen offset:1536 nt
    v_mfma_f32_16x16x32_bf16 v[120:123], v[32:35], a[240:243], v[136:139]
    ds_read_b128 v[28:31], v3 offset:18560
    v_mfma_f32_16x16x32_bf16 v[120:123], v[36:39], a[244:247], v[120:123]
    v_exp_f32 v76, v76
    v_mfma_f32_16x16x32_bf16 v[124:127], v[32:35], v[200:203], v[140:143]
    v_exp_f32 v77, v77
    v_mfma_f32_16x16x32_bf16 v[124:127], v[36:39], v[204:207], v[124:127]
    s_waitcnt lgkmcnt(2)
    s_waitcnt vmcnt(13)
    buffer_load_dwordx2 v[60:61], v10, s[72:75], s36 offen offset:192
    v_mfma_f32_16x16x32_bf16 v[80:83], v[40:43], a[200:203], v[80:83]
    ds_read_b128 v[32:35], v2 offset:12544
    v_mfma_f32_16x16x32_bf16 v[80:83], v[44:47], a[204:207], v[80:83]
    buffer_load_dwordx2 v[62:63], v10, s[76:79], s36 offen offset:192
    v_mfma_f32_16x16x32_bf16 v[84:87], v[40:43], a[224:227], v[84:87]
    v_exp_f32 v78, v78
    v_mfma_f32_16x16x32_bf16 v[84:87], v[44:47], a[228:231], v[84:87]
    s_waitcnt vmcnt(14)
    buffer_load_dwordx4 v[240:243], v9, s[64:67], s33 offen offset:384 nt
    v_mfma_f32_16x16x32_bf16 v[88:91], v[40:43], a[248:251], v[88:91]
    ds_read_b128 v[36:39], v3 offset:12544
    v_mfma_f32_16x16x32_bf16 v[88:91], v[44:47], a[252:255], v[88:91]
    buffer_load_dwordx4 v[244:247], v9, s[64:67], s33 offen offset:1920 nt
    v_mfma_f32_16x16x32_bf16 v[92:95], v[40:43], v[208:211], v[92:95]
    v_exp_f32 v79, v79
    v_mfma_f32_16x16x32_bf16 v[92:95], v[44:47], v[212:215], v[92:95]
    s_waitcnt lgkmcnt(2)
    v_exp_f32 v108, v108
    v_mfma_f32_16x16x32_bf16 v[112:115], v[24:27], a[200:203], v[112:115]
    ds_read_b128 v[40:43], v2 offset:18688
    v_mfma_f32_16x16x32_bf16 v[112:115], v[28:31], a[204:207], v[112:115]
    s_waitcnt vmcnt(15)
    buffer_load_dwordx4 v[248:251], v9, s[64:67], s34 offen offset:384 nt
    v_mfma_f32_16x16x32_bf16 v[116:119], v[24:27], a[224:227], v[116:119]
    v_exp_f32 v109, v109
    v_mfma_f32_16x16x32_bf16 v[116:119], v[28:31], a[228:231], v[116:119]
    s_waitcnt vmcnt(15)
    buffer_load_dwordx4 v[252:255], v9, s[64:67], s34 offen offset:1920 nt
    v_mfma_f32_16x16x32_bf16 v[120:123], v[24:27], a[248:251], v[120:123]
    ds_read_b128 v[44:47], v3 offset:18688
    v_mfma_f32_16x16x32_bf16 v[120:123], v[28:31], a[252:255], v[120:123]
    s_waitcnt lgkmcnt(2)
    v_exp_f32 v110, v110
    v_mfma_f32_16x16x32_bf16 v[124:127], v[24:27], v[208:211], v[124:127]
    s_waitcnt vmcnt(15)
    v_exp_f32 v111, v111
    v_mfma_f32_16x16x32_bf16 v[124:127], v[28:31], v[212:215], v[124:127]
    s_barrier
    v_add_u32 v2, 49152, v2
    v_add_u32 v3, 49152, v3
    v_mfma_f32_16x16x32_bf16 v[80:83], v[32:35], a[208:211], v[80:83]
    s_mov_b32 m0, s26
    ds_read_b128 v[24:27], v2 offset:0
    v_add_f32 v8, v8, v76
    v_mfma_f32_16x16x32_bf16 v[80:83], v[36:39], a[212:215], v[80:83]
    buffer_load_dwordx4 v4, s[4:7], s32 offen offset:0 sc1 lds
    v_add_f32 v8, v8, v77
    v_mfma_f32_16x16x32_bf16 v[84:87], v[32:35], a[232:235], v[84:87]
    v_add_f32 v8, v8, v78
    v_add_f32 v8, v8, v79
    v_mfma_f32_16x16x32_bf16 v[84:87], v[36:39], a[236:239], v[84:87]
    s_waitcnt vmcnt(15)
    buffer_load_dwordx4 v4, s[4:7], s32 offen offset:1024 sc1 lds
    v_add_f32 v8, v8, v108
    v_mfma_f32_16x16x32_bf16 v[88:91], v[32:35], v[192:195], v[88:91]
    ds_read_b128 v[28:31], v3 offset:0
    v_add_f32 v8, v8, v109
    v_mfma_f32_16x16x32_bf16 v[88:91], v[36:39], v[196:199], v[88:91]
    s_waitcnt vmcnt(15)
    buffer_load_dwordx4 v4, s[4:7], s32 offen offset:2048 sc1 lds
    v_add_f32 v8, v8, v110
    v_mfma_f32_16x16x32_bf16 v[92:95], v[32:35], v[216:219], v[92:95]
    s_add_u32 s32, s32, 24576
    v_add_f32 v8, v8, v111
    v_cvt_pk_bf16_f32 v76, v76, v77
    v_mfma_f32_16x16x32_bf16 v[92:95], v[36:39], v[220:223], v[92:95]
    s_waitcnt lgkmcnt(2)
    v_cvt_pk_bf16_f32 v77, v78, v79
    v_cvt_pk_bf16_f32 v78, v108, v109
    v_mfma_f32_16x16x32_bf16 v[112:115], v[40:43], a[208:211], v[112:115]
    ds_read_b128 v[32:35], v2 offset:6144
    v_cvt_pk_bf16_f32 v79, v110, v111
    v_bfe_u32 v20, v4, 4, 6
    v_lshlrev_b32 v20, 2, v20
    v_xor_b32 v21, 16, v11
    v_xor_b32 v22, 32, v11
    v_xor_b32 v23, 48, v11
    v_mfma_f32_16x16x32_bf16 v[112:115], v[44:47], a[212:215], v[112:115]
    s_sub_u32 s57, s32, 196608
    s_min_u32 s32, s32, s57
    v_mfma_f32_16x16x32_bf16 v[116:119], v[40:43], a[232:235], v[116:119]
    s_add_u32 s26, s26, 12288
    s_mov_b32 m0, s26
    v_mfma_f32_16x16x32_bf16 v[116:119], v[44:47], a[236:239], v[116:119]
    s_waitcnt vmcnt(15)
    buffer_load_dwordx4 v4, s[4:7], s32 offen offset:0 sc1 lds
    v_mfma_f32_16x16x32_bf16 v[120:123], v[40:43], v[192:195], v[120:123]
    ds_read_b128 v[36:39], v3 offset:6144
    v_mfma_f32_16x16x32_bf16 v[120:123], v[44:47], v[196:199], v[120:123]
    s_waitcnt vmcnt(14)
    buffer_load_dwordx4 v4, s[4:7], s32 offen offset:1024 sc1 lds
    v_mfma_f32_16x16x32_bf16 v[124:127], v[40:43], v[216:219], v[124:127]
    s_waitcnt vmcnt(14)
    buffer_load_dwordx4 v4, s[4:7], s32 offen offset:2048 sc1 lds
    v_mfma_f32_16x16x32_bf16 v[124:127], v[44:47], v[220:223], v[124:127]
    s_waitcnt lgkmcnt(2)
    s_add_u32 s32, s32, 24576
    s_sub_u32 s57, s32, 196608
    s_min_u32 s32, s32, s57
    s_add_u32 s26, s26, 36864
    s_sub_u32 s57, s26, 147456
    s_min_u32 s26, s26, s57
    v_mfma_f32_16x16x32_bf16 v[160:163], v[24:27], a[192:195], v[128:131]
    s_mov_b32 m0, s56
    ds_read_b128 v[40:43], v2 offset:128
    v_mfma_f32_16x16x32_bf16 v[160:163], v[28:31], a[196:199], v[160:163]
    s_waitcnt vmcnt(13)
    buffer_load_dwordx4 v4, s[4:7], s27 offen offset:0 sc1 lds
    v_mfma_f32_16x16x32_bf16 v[164:167], v[24:27], a[216:219], v[132:135]
    v_exp_f32 v16, v80
    v_mfma_f32_16x16x32_bf16 v[164:167], v[28:31], a[220:223], v[164:167]
    s_waitcnt vmcnt(13)
    buffer_load_dwordx4 v4, s[4:7], s27 offen offset:1024 sc1 lds
    v_exp_f32 v17, v81
    v_exp_f32 v18, v82
    v_add_f32 v5, v5, v16
    v_add_f32 v5, v5, v17
    v_mfma_f32_16x16x32_bf16 v[168:171], v[24:27], a[240:243], v[136:139]
    ds_read_b128 v[44:47], v3 offset:128
    v_mfma_f32_16x16x32_bf16 v[168:171], v[28:31], a[244:247], v[168:171]
    s_waitcnt vmcnt(12)
    buffer_load_dwordx4 v4, s[4:7], s27 offen offset:2048 sc1 lds
    v_exp_f32 v19, v83
    v_cvt_pk_bf16_f32 v80, v16, v17
    v_mfma_f32_16x16x32_bf16 v[172:175], v[24:27], v[200:203], v[140:143]
    s_add_u32 s27, s27, 24576
    v_exp_f32 v16, v112
    v_mfma_f32_16x16x32_bf16 v[172:175], v[28:31], v[204:207], v[172:175]
    s_waitcnt lgkmcnt(2)
    v_add_f32 v5, v5, v18
    v_add_f32 v5, v5, v19
    v_exp_f32 v17, v113
    v_cvt_pk_bf16_f32 v81, v18, v19
    s_sub_u32 s58, s27, 196608
    v_mfma_f32_16x16x32_bf16 v[96:99], v[32:35], a[192:195], v[128:131]
    s_min_u32 s27, s27, s58
    ds_read_b128 v[24:27], v2 offset:6272
    s_add_u32 s56, s56, 12288
    v_mfma_f32_16x16x32_bf16 v[96:99], v[36:39], a[196:199], v[96:99]
    s_mov_b32 m0, s56
    v_exp_f32 v18, v114
    v_add_f32 v5, v5, v16
    v_add_f32 v5, v5, v17
    v_mfma_f32_16x16x32_bf16 v[100:103], v[32:35], a[216:219], v[132:135]
    v_exp_f32 v19, v115
    v_mfma_f32_16x16x32_bf16 v[100:103], v[36:39], a[220:223], v[100:103]
    s_waitcnt vmcnt(11)
    buffer_load_dwordx4 v4, s[4:7], s27 offen offset:0 sc1 lds
    v_cvt_pk_bf16_f32 v82, v16, v17
    v_exp_f32 v16, v84
    v_add_f32 v5, v5, v18
    v_mfma_f32_16x16x32_bf16 v[104:107], v[32:35], a[240:243], v[136:139]
    ds_read_b128 v[28:31], v3 offset:6272
    v_add_f32 v5, v5, v19
    v_mfma_f32_16x16x32_bf16 v[104:107], v[36:39], a[244:247], v[104:107]
    s_waitcnt vmcnt(11)
    buffer_load_dwordx4 v4, s[4:7], s27 offen offset:1024 sc1 lds
    v_exp_f32 v17, v85
    v_cvt_pk_bf16_f32 v83, v18, v19
    v_mfma_f32_16x16x32_bf16 v[108:111], v[32:35], v[200:203], v[140:143]
    v_exp_f32 v18, v86
    v_mfma_f32_16x16x32_bf16 v[108:111], v[36:39], v[204:207], v[108:111]
    s_waitcnt lgkmcnt(2)
    s_waitcnt vmcnt(11)
    buffer_load_dwordx4 v4, s[4:7], s27 offen offset:2048 sc1 lds
    v_add_f32 v6, v6, v16
    v_add_f32 v6, v6, v17
    v_exp_f32 v19, v87
    v_mfma_f32_16x16x32_bf16 v[160:163], v[40:43], a[200:203], v[160:163]
    ds_read_b128 v[32:35], v2 offset:256
    v_cvt_pk_bf16_f32 v84, v16, v17
    v_mfma_f32_16x16x32_bf16 v[160:163], v[44:47], a[204:207], v[160:163]
    v_exp_f32 v16, v116
    v_add_f32 v6, v6, v18
    v_add_f32 v6, v6, v19
    v_mfma_f32_16x16x32_bf16 v[164:167], v[40:43], a[224:227], v[164:167]
    v_exp_f32 v17, v117
    v_mfma_f32_16x16x32_bf16 v[164:167], v[44:47], a[228:231], v[164:167]
    s_add_u32 s27, s27, 24576
    v_cvt_pk_bf16_f32 v85, v18, v19
    v_exp_f32 v18, v118
    v_add_f32 v6, v6, v16
    v_add_f32 v6, v6, v17
    s_sub_u32 s58, s27, 196608
    v_mfma_f32_16x16x32_bf16 v[168:171], v[40:43], a[248:251], v[168:171]
    s_waitcnt vmcnt(18)
    ds_read_b128 v[36:39], v3 offset:256
    v_lshlrev_b32 v48, 16, v56
    v_mfma_f32_16x16x32_bf16 v[168:171], v[44:47], a[252:255], v[168:171]
    s_waitcnt vmcnt(11)
    buffer_load_dwordx3 v[144:146], v12, s[68:71], s35 offen offset:0 nt
    v_exp_f32 v19, v119
    v_cvt_pk_bf16_f32 v86, v16, v17
    v_mfma_f32_16x16x32_bf16 v[172:175], v[40:43], v[208:211], v[172:175]
    s_min_u32 s27, s27, s58
    v_add_f32 v6, v6, v18
    v_add_f32 v6, v6, v19
    v_mfma_f32_16x16x32_bf16 v[172:175], v[44:47], v[212:215], v[172:175]
    s_waitcnt lgkmcnt(2)
    s_waitcnt vmcnt(11)
    buffer_load_dwordx3 v[148:150], v12, s[68:71], s35 offen offset:768 nt
    v_cvt_pk_bf16_f32 v87, v18, v19
    v_exp_f32 v16, v88
    v_and_b32 v49, s97, v56
    v_mfma_f32_16x16x32_bf16 v[96:99], v[24:27], a[200:203], v[96:99]
    s_add_u32 s56, s56, 36864
    ds_read_b128 v[40:43], v2 offset:6400
    v_lshlrev_b32 v50, 16, v58
    v_mfma_f32_16x16x32_bf16 v[96:99], v[28:31], a[204:207], v[96:99]
    s_waitcnt vmcnt(11)
    buffer_load_dwordx3 v[152:154], v12, s[68:71], s35 offen offset:1536 nt
    v_exp_f32 v17, v89
    v_and_b32 v51, s97, v58
    v_mfma_f32_16x16x32_bf16 v[100:103], v[24:27], a[224:227], v[100:103]
    s_sub_u32 s58, s56, 147456
    v_exp_f32 v18, v90
    v_mfma_f32_16x16x32_bf16 v[100:103], v[28:31], a[228:231], v[100:103]
    buffer_load_dwordx3 v[156:158], v12, s[68:71], s35 offen offset:2304 nt
    v_add_f32 v7, v7, v16
    v_add_f32 v7, v7, v17
    v_mul_f32 v48, s38, v48
    v_mfma_f32_16x16x32_bf16 v[104:107], v[24:27], a[248:251], v[104:107]
    s_min_u32 s56, s56, s58
    ds_read_b128 v[44:47], v3 offset:6400
    v_mul_f32 v49, s38, v49
    v_mfma_f32_16x16x32_bf16 v[104:107], v[28:31], a[252:255], v[104:107]
    v_exp_f32 v19, v91
    v_cvt_pk_bf16_f32 v88, v16, v17
    v_exp_f32 v16, v120
    v_mfma_f32_16x16x32_bf16 v[108:111], v[24:27], v[208:211], v[108:111]
    v_add_f32 v7, v7, v18
    v_add_f32 v7, v7, v19
    v_mfma_f32_16x16x32_bf16 v[108:111], v[28:31], v[212:215], v[108:111]
    s_waitcnt lgkmcnt(2)
    v_exp_f32 v17, v121
    v_mul_f32_e64 v50, -v50, v48
    v_mul_f32_e64 v51, -v51, v49
    v_cvt_pk_bf16_f32 v89, v18, v19
    v_cvt_f32_i32 v224, v224
    v_mfma_f32_16x16x32_bf16 v[160:163], v[32:35], a[208:211], v[160:163]
    ds_read_b128 v[24:27], v2 offset:12288
    v_cvt_f32_i32 v225, v225
    v_mfma_f32_16x16x32_bf16 v[160:163], v[36:39], a[212:215], v[160:163]
    v_exp_f32 v18, v122
    v_fma_f32 v224, v224, v48, v50
    v_add_f32 v7, v7, v16
    v_fma_f32 v225, v225, v49, v51
    v_mfma_f32_16x16x32_bf16 v[164:167], v[32:35], a[232:235], v[164:167]
    v_add_f32 v7, v7, v17
    v_cvt_pk_bf16_f32 v224, v224, v225
    v_mfma_f32_16x16x32_bf16 v[164:167], v[36:39], a[236:239], v[164:167]
    v_exp_f32 v19, v123
    v_cvt_f32_i32 v228, v228
    v_cvt_f32_i32 v229, v229
    v_cvt_pk_bf16_f32 v90, v16, v17
    v_mfma_f32_16x16x32_bf16 v[168:171], v[32:35], v[192:195], v[168:171]
    ds_read_b128 v[28:31], v3 offset:12288
    v_fma_f32 v228, v228, v48, v50
    v_mfma_f32_16x16x32_bf16 v[168:171], v[36:39], v[196:199], v[168:171]
    v_exp_f32 v16, v92
    v_fma_f32 v229, v229, v49, v51
    v_cvt_pk_bf16_f32 v228, v228, v229
    v_add_f32 v7, v7, v18
    v_mfma_f32_16x16x32_bf16 v[172:175], v[32:35], v[216:219], v[172:175]
    v_cvt_f32_i32 v232, v232
    v_add_f32 v7, v7, v19
    v_mfma_f32_16x16x32_bf16 v[172:175], v[36:39], v[220:223], v[172:175]
    s_waitcnt lgkmcnt(2)
    v_exp_f32 v17, v93
    v_cvt_f32_i32 v233, v233
    v_fma_f32 v232, v232, v48, v50
    v_fma_f32 v233, v233, v49, v51
    v_cvt_pk_bf16_f32 v91, v18, v19
    v_mfma_f32_16x16x32_bf16 v[96:99], v[40:43], a[208:211], v[96:99]
    ds_read_b128 v[32:35], v2 offset:18432
    v_cvt_pk_bf16_f32 v232, v232, v233
    v_mfma_f32_16x16x32_bf16 v[96:99], v[44:47], a[212:215], v[96:99]
    v_exp_f32 v18, v94
    v_cvt_f32_i32 v236, v236
    v_cvt_f32_i32 v237, v237
    v_add_f32 v8, v8, v16
    v_mfma_f32_16x16x32_bf16 v[100:103], v[40:43], a[232:235], v[100:103]
    v_fma_f32 v236, v236, v48, v50
    v_add_f32 v8, v8, v17
    v_mfma_f32_16x16x32_bf16 v[100:103], v[44:47], a[236:239], v[100:103]
L_iw1:
L_pg1:
    s_cbranch_execz L_pg5
    v_exp_f32 v19, v95
    v_fma_f32 v237, v237, v49, v51
    v_cvt_pk_bf16_f32 v236, v236, v237
    v_lshlrev_b32 v48, 16, v57
    v_mfma_f32_16x16x32_bf16 v[104:107], v[40:43], v[192:195], v[104:107]
    ds_read_b128 v[36:39], v3 offset:18432
    v_cvt_pk_bf16_f32 v92, v16, v17
    v_mfma_f32_16x16x32_bf16 v[104:107], v[44:47], v[196:199], v[104:107]
    v_exp_f32 v16, v124
    v_and_b32 v49, s97, v57
    v_lshlrev_b32 v50, 16, v59
    v_and_b32 v51, s97, v59
    v_mfma_f32_16x16x32_bf16 v[108:111], v[40:43], v[216:219], v[108:111]
    v_add_f32 v8, v8, v18
    v_mul_f32 v48, s38, v48
    v_mfma_f32_16x16x32_bf16 v[108:111], v[44:47], v[220:223], v[108:111]
    s_waitcnt lgkmcnt(2)
    v_add_f32 v8, v8, v19
    v_mul_f32 v49, s38, v49
    v_exp_f32 v17, v125
    v_mul_f32_e64 v50, -v50, v48
    v_mul_f32_e64 v51, -v51, v49
    v_mfma_f32_16x16x32_bf16 v[176:179], v[24:27], a[192:195], v[128:131]
    ds_read_b128 v[40:43], v2 offset:12416
    v_cvt_pk_bf16_f32 v93, v18, v19
    v_mfma_f32_16x16x32_bf16 v[176:179], v[28:31], a[196:199], v[176:179]
    v_exp_f32 v18, v126
    v_cvt_f32_i32 v226, v226
    v_cvt_f32_i32 v227, v227
    v_fma_f32 v226, v226, v48, v50
    v_mfma_f32_16x16x32_bf16 v[180:183], v[24:27], a[216:219], v[132:135]
    v_add_f32 v8, v8, v16
    v_fma_f32 v227, v227, v49, v51
    v_mfma_f32_16x16x32_bf16 v[180:183], v[28:31], a[220:223], v[180:183]
    v_add_f32 v8, v8, v17
    v_cvt_pk_bf16_f32 v225, v226, v227
    v_exp_f32 v19, v127
    v_cvt_f32_i32 v230, v230
    v_mfma_f32_16x16x32_bf16 v[184:187], v[24:27], a[240:243], v[136:139]
    ds_read_b128 v[44:47], v3 offset:12416
    v_cvt_f32_i32 v231, v231
    v_mfma_f32_16x16x32_bf16 v[184:187], v[28:31], a[244:247], v[184:187]
    v_cvt_pk_bf16_f32 v94, v16, v17
    v_fma_f32 v230, v230, v48, v50
    v_add_f32 v8, v8, v18
    v_fma_f32 v231, v231, v49, v51
    v_cvt_pk_bf16_f32 v229, v230, v231
    v_mfma_f32_16x16x32_bf16 v[188:191], v[24:27], v[200:203], v[140:143]
    v_add_f32 v8, v8, v19
    v_cvt_pk_bf16_f32 v95, v18, v19
    v_mfma_f32_16x16x32_bf16 v[188:191], v[28:31], v[204:207], v[188:191]
    s_waitcnt lgkmcnt(2)
    v_cvt_f32_i32 v234, v234
    v_cvt_f32_i32 v235, v235
    v_exp_f32 v16, v160
    v_fma_f32 v234, v234, v48, v50
    v_fma_f32 v235, v235, v49, v51
    v_mfma_f32_16x16x32_bf16 v[112:115], v[32:35], a[192:195], v[128:131]
    ds_read_b128 v[24:27], v2 offset:18560
    v_cvt_pk_bf16_f32 v233, v234, v235
    v_mfma_f32_16x16x32_bf16 v[112:115], v[36:39], a[196:199], v[112:115]
    v_exp_f32 v17, v161
    v_exp_f32 v18, v162
    v_add_f32 v5, v5, v16
    v_mfma_f32_16x16x32_bf16 v[116:119], v[32:35], a[216:219], v[132:135]
    v_cvt_f32_i32 v238, v238
    v_cvt_f32_i32 v239, v239
    v_mfma_f32_16x16x32_bf16 v[116:119], v[36:39], a[220:223], v[116:119]
    v_fma_f32 v238, v238, v48, v50
    v_add_f32 v5, v5, v17
    v_exp_f32 v19, v163
    v_cvt_pk_bf16_f32 v160, v16, v17
    v_mfma_f32_16x16x32_bf16 v[120:123], v[32:35], a[240:243], v[136:139]
    ds_read_b128 v[28:31], v3 offset:18560
    v_fma_f32 v239, v239, v49, v51
    v_cvt_pk_bf16_f32 v237, v238, v239
    v_mfma_f32_16x16x32_bf16 v[120:123], v[36:39], a[244:247], v[120:123]
    s_waitcnt vmcnt(16)
    v_lshlrev_b32 v48, 16, v60
    v_and_b32 v49, s97, v60
    v_lshlrev_b32 v50, 16, v62
    v_and_b32 v51, s97, v62
    v_mul_f32 v48, s38, v48
    v_mfma_f32_16x16x32_bf16 v[124:127], v[32:35], v[200:203], v[140:143]
    v_mul_f32 v49, s38, v49
    v_mul_f32_e64 v50, -v50, v48
    v_mfma_f32_16x16x32_bf16 v[124:127], v[36:39], v[204:207], v[124:127]
    s_waitcnt lgkmcnt(2)
    s_waitcnt vmcnt(12)
    buffer_load_dwordx2 v[56:57], off, s[80:83], s37 offset:0
    v_mul_f32_e64 v51, -v51, v49
    v_cvt_f32_i32 v240, v240
    v_cvt_f32_i32 v241, v241
    v_mfma_f32_16x16x32_bf16 v[176:179], v[40:43], a[200:203], v[176:179]
    ds_read_b128 v[32:35], v2 offset:12544
    v_fma_f32 v240, v240, v48, v50
    v_mfma_f32_16x16x32_bf16 v[176:179], v[44:47], a[204:207], v[176:179]
    buffer_load_dwordx2 v[58:59], off, s[84:87], s37 offset:0
    v_exp_f32 v16, v96
    v_fma_f32 v241, v241, v49, v51
    v_mfma_f32_16x16x32_bf16 v[180:183], v[40:43], a[224:227], v[180:183]
    v_cvt_pk_bf16_f32 v226, v240, v241
    v_add_f32 v5, v5, v18
    v_mfma_f32_16x16x32_bf16 v[180:183], v[44:47], a[228:231], v[180:183]
    v_cvt_f32_i32 v244, v244
    v_add_f32 v5, v5, v19
    v_cvt_f32_i32 v245, v245
    v_exp_f32 v17, v97
    v_fma_f32 v244, v244, v48, v50
    v_mfma_f32_16x16x32_bf16 v[184:187], v[40:43], a[248:251], v[184:187]
    ds_read_b128 v[36:39], v3 offset:12544
    v_fma_f32 v245, v245, v49, v51
    v_mfma_f32_16x16x32_bf16 v[184:187], v[44:47], a[252:255], v[184:187]
    v_cvt_pk_bf16_f32 v161, v18, v19
    v_cvt_pk_bf16_f32 v230, v244, v245
    v_exp_f32 v18, v98
    v_cvt_f32_i32 v248, v248
    v_mfma_f32_16x16x32_bf16 v[188:191], v[40:43], v[208:211], v[188:191]
    v_cvt_f32_i32 v249, v249
    v_add_f32 v5, v5, v16
    v_mfma_f32_16x16x32_bf16 v[188:191], v[44:47], v[212:215], v[188:191]
    s_waitcnt lgkmcnt(2)
    v_fma_f32 v248, v248, v48, v50
    v_add_f32 v5, v5, v17
    v_fma_f32 v249, v249, v49, v51
    v_exp_f32 v19, v99
    v_mfma_f32_16x16x32_bf16 v[112:115], v[24:27], a[200:203], v[112:115]
    ds_read_b128 v[40:43], v2 offset:18688
    v_cvt_pk_bf16_f32 v234, v248, v249
    v_mfma_f32_16x16x32_bf16 v[112:115], v[28:31], a[204:207], v[112:115]
    v_cvt_f32_i32 v252, v252
    v_cvt_pk_bf16_f32 v162, v16, v17
    v_cvt_f32_i32 v253, v253
    v_exp_f32 v16, v164
    v_mfma_f32_16x16x32_bf16 v[116:119], v[24:27], a[224:227], v[116:119]
    v_fma_f32 v252, v252, v48, v50
    v_fma_f32 v253, v253, v49, v51
    v_mfma_f32_16x16x32_bf16 v[116:119], v[28:31], a[228:231], v[116:119]
    v_add_f32 v5, v5, v18
    v_cvt_pk_bf16_f32 v238, v252, v253
    v_add_f32 v5, v5, v19
    v_lshlrev_b32 v48, 16, v61
    v_exp_f32 v17, v165
    v_mfma_f32_16x16x32_bf16 v[120:123], v[24:27], a[248:251], v[120:123]
    ds_read_b128 v[44:47], v3 offset:18688
    v_and_b32 v49, s97, v61
    v_mfma_f32_16x16x32_bf16 v[120:123], v[28:31], a[252:255], v[120:123]
    s_waitcnt lgkmcnt(2)
    v_lshlrev_b32 v50, 16, v63
    v_cvt_pk_bf16_f32 v163, v18, v19
    v_and_b32 v51, s97, v63
    v_exp_f32 v18, v166
    v_mfma_f32_16x16x32_bf16 v[124:127], v[24:27], v[208:211], v[124:127]
    s_waitcnt vmcnt(30)
    v_mul_f32 v48, s38, v48
    v_mul_f32 v49, s38, v49
    v_mfma_f32_16x16x32_bf16 v[124:127], v[28:31], v[212:215], v[124:127]
    s_barrier
    v_add_f32 v6, v6, v16
    v_mul_f32_e64 v50, -v50, v48
    v_add_f32 v6, v6, v17
    v_mul_f32_e64 v51, -v51, v49
    v_mfma_f32_16x16x32_bf16 v[176:179], v[32:35], a[208:211], v[176:179]
    ds_read_b128 v[24:27], v1 offset:0
    v_cvt_f32_i32 v242, v242
    v_mfma_f32_16x16x32_bf16 v[176:179], v[36:39], a[212:215], v[176:179]
    v_exp_f32 v19, v167
    v_cvt_f32_i32 v243, v243
    v_cvt_pk_bf16_f32 v164, v16, v17
    v_fma_f32 v242, v242, v48, v50
    v_mfma_f32_16x16x32_bf16 v[180:183], v[32:35], a[232:235], v[180:183]
    v_exp_f32 v16, v100
    v_mfma_f32_16x16x32_bf16 v[180:183], v[36:39], a[236:239], v[180:183]
    v_fma_f32 v243, v243, v49, v51
    v_cvt_pk_bf16_f32 v227, v242, v243
    v_add_f32 v6, v6, v18
    v_cvt_f32_i32 v246, v246
    v_add_f32 v6, v6, v19
    v_cvt_f32_i32 v247, v247
    v_mfma_f32_16x16x32_bf16 v[184:187], v[32:35], v[192:195], v[184:187]
    ds_read_b128 v[28:31], v1 offset:12288
    v_fma_f32 v246, v246, v48, v50
    v_mfma_f32_16x16x32_bf16 v[184:187], v[36:39], v[196:199], v[184:187]
    v_exp_f32 v17, v101
    v_fma_f32 v247, v247, v49, v51
    v_cvt_pk_bf16_f32 v165, v18, v19
    v_cvt_pk_bf16_f32 v231, v246, v247
    v_mfma_f32_16x16x32_bf16 v[188:191], v[32:35], v[216:219], v[188:191]
    v_exp_f32 v18, v102
    v_mfma_f32_16x16x32_bf16 v[188:191], v[36:39], v[220:223], v[188:191]
    s_waitcnt lgkmcnt(2)
    v_cvt_f32_i32 v250, v250
    v_cvt_f32_i32 v251, v251
    v_add_f32 v6, v6, v16
    v_fma_f32 v250, v250, v48, v50
    v_add_f32 v6, v6, v17
    v_mfma_f32_16x16x32_bf16 v[112:115], v[40:43], a[208:211], v[112:115]
    ds_read_b128 v[32:35], v1 offset:1024
    v_fma_f32 v251, v251, v49, v51
    v_mfma_f32_16x16x32_bf16 v[112:115], v[44:47], a[212:215], v[112:115]
    v_exp_f32 v19, v103
    v_cvt_pk_bf16_f32 v235, v250, v251
    v_cvt_f32_i32 v254, v254
    v_cvt_pk_bf16_f32 v166, v16, v17
    v_mfma_f32_16x16x32_bf16 v[116:119], v[40:43], a[232:235], v[116:119]
    v_cvt_f32_i32 v255, v255
    v_add_f32 v6, v6, v18
    v_mfma_f32_16x16x32_bf16 v[116:119], v[44:47], a[236:239], v[116:119]
    v_fma_f32 v254, v254, v48, v50
    v_add_f32 v6, v6, v19
    v_fma_f32 v255, v255, v49, v51
    v_cvt_pk_bf16_f32 v167, v18, v19
    v_cvt_pk_bf16_f32 v239, v254, v255
    v_mfma_f32_16x16x32_bf16 v[120:123], v[40:43], v[192:195], v[120:123]
    ds_read_b128 v[36:39], v1 offset:13312
    v_mfma_f32_16x16x32_bf16 v[120:123], v[44:47], v[196:199], v[120:123]
    v_mfma_f32_16x16x32_bf16 v[124:127], v[40:43], v[216:219], v[124:127]
    v_mfma_f32_16x16x32_bf16 v[124:127], v[44:47], v[220:223], v[124:127]
    s_waitcnt lgkmcnt(2)
    v_mfma_f32_16x16x32_bf16 a[144:147], v[76:79], v[24:27], 0
    ds_read_b128 v[40:43], v1 offset:2048
    v_mfma_f32_16x16x32_bf16 a[144:147], v[92:95], v[28:31], a[144:147]
    buffer_store_dwordx4 v[224:227], v11, s[4:7], s33 offen offset:0 sc1
    v_mfma_f32_16x16x32_bf16 a[96:99], v[72:75], v[24:27], 0
    v_exp_f32 v16, v168
    v_mfma_f32_16x16x32_bf16 a[96:99], v[88:91], v[28:31], a[96:99]
    ds_read_b128 v[44:47], v1 offset:14336
    v_mfma_f32_16x16x32_bf16 a[0:3], v[80:83], v[28:31], a[0:3]
    v_exp_f32 v17, v169
    v_mfma_f32_16x16x32_bf16 a[48:51], v[84:87], v[28:31], a[48:51]
    s_waitcnt lgkmcnt(2)
    v_exp_f32 v18, v170
    v_mfma_f32_16x16x32_bf16 a[148:151], v[76:79], v[32:35], 0
    ds_read_b128 v[24:27], v1 offset:3072
    v_add_f32 v7, v7, v16
    v_mfma_f32_16x16x32_bf16 a[148:151], v[92:95], v[36:39], a[148:151]
    v_add_f32 v7, v7, v17
    v_mfma_f32_16x16x32_bf16 a[100:103], v[72:75], v[32:35], 0
    v_exp_f32 v19, v171
    v_mfma_f32_16x16x32_bf16 a[100:103], v[88:91], v[36:39], a[100:103]
    ds_read_b128 v[28:31], v1 offset:15360
    v_cvt_pk_bf16_f32 v168, v16, v17
    v_mfma_f32_16x16x32_bf16 a[4:7], v[80:83], v[36:39], a[4:7]
    v_exp_f32 v16, v104
    v_mfma_f32_16x16x32_bf16 a[52:55], v[84:87], v[36:39], a[52:55]
    s_waitcnt lgkmcnt(2)
    v_add_f32 v7, v7, v18
    v_add_f32 v7, v7, v19
    v_mfma_f32_16x16x32_bf16 a[152:155], v[76:79], v[40:43], 0
    ds_read_b128 v[32:35], v1 offset:4096
    v_mfma_f32_16x16x32_bf16 a[152:155], v[92:95], v[44:47], a[152:155]
    buffer_store_dwordx4 v[228:231], v21, s[4:7], s33 offen offset:768 sc1
    v_mfma_f32_16x16x32_bf16 a[104:107], v[72:75], v[40:43], 0
    v_exp_f32 v17, v105
    v_mfma_f32_16x16x32_bf16 a[104:107], v[88:91], v[44:47], a[104:107]
    ds_read_b128 v[36:39], v1 offset:16384
    v_cvt_pk_bf16_f32 v169, v18, v19
    v_mfma_f32_16x16x32_bf16 a[8:11], v[80:83], v[44:47], a[8:11]
    v_exp_f32 v18, v106
    v_mfma_f32_16x16x32_bf16 a[56:59], v[84:87], v[44:47], a[56:59]
    s_waitcnt lgkmcnt(2)
    v_add_f32 v7, v7, v16
    v_add_f32 v7, v7, v17
    v_mfma_f32_16x16x32_bf16 a[156:159], v[76:79], v[24:27], 0
    ds_read_b128 v[40:43], v1 offset:5120
    v_mfma_f32_16x16x32_bf16 a[156:159], v[92:95], v[28:31], a[156:159]
    v_exp_f32 v19, v107
    v_cvt_pk_bf16_f32 v170, v16, v17
    v_mfma_f32_16x16x32_bf16 a[108:111], v[72:75], v[24:27], 0
    v_exp_f32 v16, v172
    v_mfma_f32_16x16x32_bf16 a[108:111], v[88:91], v[28:31], a[108:111]
    ds_read_b128 v[44:47], v1 offset:17408
    v_add_f32 v7, v7, v18
    v_add_f32 v7, v7, v19
    v_mfma_f32_16x16x32_bf16 a[12:15], v[80:83], v[28:31], a[12:15]
    v_exp_f32 v17, v173
    v_mfma_f32_16x16x32_bf16 a[60:63], v[84:87], v[28:31], a[60:63]
    s_waitcnt lgkmcnt(2)
    v_cvt_pk_bf16_f32 v171, v18, v19
    v_mfma_f32_16x16x32_bf16 a[160:163], v[76:79], v[32:35], 0
    ds_read_b128 v[24:27], v1 offset:6144
    v_mfma_f32_16x16x32_bf16 a[160:163], v[92:95], v[36:39], a[160:163]
    buffer_store_dwordx4 v[232:235], v22, s[4:7], s33 offen offset:1536 sc1
    v_mfma_f32_16x16x32_bf16 a[112:115], v[72:75], v[32:35], 0
    v_exp_f32 v18, v174
    v_mfma_f32_16x16x32_bf16 a[112:115], v[88:91], v[36:39], a[112:115]
    ds_read_b128 v[28:31], v1 offset:18432
    v_add_f32 v8, v8, v16
    v_add_f32 v8, v8, v17
    v_mfma_f32_16x16x32_bf16 a[16:19], v[80:83], v[36:39], a[16:19]
    v_exp_f32 v19, v175
    v_mfma_f32_16x16x32_bf16 a[64:67], v[84:87], v[36:39], a[64:67]
    s_waitcnt lgkmcnt(2)
    v_cvt_pk_bf16_f32 v172, v16, v17
    v_exp_f32 v16, v108
    v_mfma_f32_16x16x32_bf16 a[164:167], v[76:79], v[40:43], 0
    ds_read_b128 v[32:35], v1 offset:7168
    v_add_f32 v8, v8, v18
    v_mfma_f32_16x16x32_bf16 a[164:167], v[92:95], v[44:47], a[164:167]
    v_add_f32 v8, v8, v19
    v_exp_f32 v17, v109
    v_mfma_f32_16x16x32_bf16 a[116:119], v[72:75], v[40:43], 0
    v_cvt_pk_bf16_f32 v173, v18, v19
    v_mfma_f32_16x16x32_bf16 a[116:119], v[88:91], v[44:47], a[116:119]
    ds_read_b128 v[36:39], v1 offset:19456
    v_exp_f32 v18, v110
    v_mfma_f32_16x16x32_bf16 a[20:23], v[80:83], v[44:47], a[20:23]
    v_add_f32 v8, v8, v16
    v_add_f32 v8, v8, v17
    v_mfma_f32_16x16x32_bf16 a[68:71], v[84:87], v[44:47], a[68:71]
    s_waitcnt lgkmcnt(2)
    v_exp_f32 v19, v111
    v_mfma_f32_16x16x32_bf16 a[168:171], v[76:79], v[24:27], 0
    ds_read_b128 v[40:43], v1 offset:8192
    v_cvt_pk_bf16_f32 v174, v16, v17
    v_mfma_f32_16x16x32_bf16 a[168:171], v[92:95], v[28:31], a[168:171]
    buffer_store_dwordx4 v[236:239], v23, s[4:7], s33 offen offset:2304 sc1
    v_mfma_f32_16x16x32_bf16 a[120:123], v[72:75], v[24:27], 0
    v_add_f32 v8, v8, v18
    v_add_f32 v8, v8, v19
    v_mfma_f32_16x16x32_bf16 a[120:123], v[88:91], v[28:31], a[120:123]
    ds_read_b128 v[44:47], v1 offset:20480
    v_cvt_pk_bf16_f32 v175, v18, v19
    v_mfma_f32_16x16x32_bf16 a[24:27], v[80:83], v[28:31], a[24:27]
    v_exp_f32 v16, v176
    v_mfma_f32_16x16x32_bf16 a[72:75], v[84:87], v[28:31], a[72:75]
    s_waitcnt lgkmcnt(2)
    v_exp_f32 v17, v177
    v_mfma_f32_16x16x32_bf16 a[172:175], v[76:79], v[32:35], 0
    ds_read_b128 v[24:27], v1 offset:9216
    v_mfma_f32_16x16x32_bf16 a[172:175], v[92:95], v[36:39], a[172:175]
    v_exp_f32 v18, v178
    v_add_f32 v5, v5, v16
    v_mfma_f32_16x16x32_bf16 a[124:127], v[72:75], v[32:35], 0
    v_add_f32 v5, v5, v17
    v_mfma_f32_16x16x32_bf16 a[124:127], v[88:91], v[36:39], a[124:127]
    ds_read_b128 v[28:31], v1 offset:21504
    v_exp_f32 v19, v179
    v_mfma_f32_16x16x32_bf16 a[28:31], v[80:83], v[36:39], a[28:31]
    v_cvt_pk_bf16_f32 v176, v16, v17
    v_mfma_f32_16x16x32_bf16 a[76:79], v[84:87], v[36:39], a[76:79]
    s_waitcnt lgkmcnt(2)
    buffer_load_dwordx2 v[60:61], off, s[80:83], s37 offset:8
    v_mfma_f32_16x16x32_bf16 a[176:179], v[76:79], v[40:43], 0
    ds_read_b128 v[32:35], v1 offset:10240
    v_mfma_f32_16x16x32_bf16 a[176:179], v[92:95], v[44:47], a[176:179]
    buffer_load_dwordx2 v[62:63], off, s[84:87], s37 offset:8
    v_mfma_f32_16x16x32_bf16 a[128:131], v[72:75], v[40:43], 0
    v_exp_f32 v16, v112
    v_mfma_f32_16x16x32_bf16 a[128:131], v[88:91], v[44:47], a[128:131]
    ds_read_b128 v[36:39], v1 offset:22528
    v_add_f32 v5, v5, v18
    v_add_f32 v5, v5, v19
    v_mfma_f32_16x16x32_bf16 a[32:35], v[80:83], v[44:47], a[32:35]
    v_exp_f32 v17, v113
    v_mfma_f32_16x16x32_bf16 a[80:83], v[84:87], v[44:47], a[80:83]
    s_waitcnt lgkmcnt(2)
    s_waitcnt vmcnt(19)
    buffer_load_dwordx3 v[240:242], v12, s[68:71], s16 offen offset:0 nt
    v_cvt_pk_bf16_f32 v177, v18, v19
    v_mfma_f32_16x16x32_bf16 a[180:183], v[76:79], v[24:27], 0
    ds_read_b128 v[40:43], v1 offset:11264
    v_mfma_f32_16x16x32_bf16 a[180:183], v[92:95], v[28:31], a[180:183]
    buffer_load_dwordx3 v[244:246], v12, s[68:71], s16 offen offset:768 nt
    v_mfma_f32_16x16x32_bf16 a[132:135], v[72:75], v[24:27], 0
    v_exp_f32 v18, v114
    v_mfma_f32_16x16x32_bf16 a[132:135], v[88:91], v[28:31], a[132:135]
    s_waitcnt vmcnt(20)
    ds_read_b128 v[44:47], v1 offset:23552
    v_add_f32 v5, v5, v16
    v_add_f32 v5, v5, v17
    v_mfma_f32_16x16x32_bf16 a[36:39], v[80:83], v[28:31], a[36:39]
    v_exp_f32 v19, v115
    v_mfma_f32_16x16x32_bf16 a[84:87], v[84:87], v[28:31], a[84:87]
    s_waitcnt lgkmcnt(2)
    s_barrier
    v_add_u32 v2, 49152, v2
    v_add_u32 v3, 49152, v3
    v_mfma_f32_16x16x32_bf16 a[184:187], v[76:79], v[32:35], 0
    ds_read_b128 v[24:27], v2 offset:0
    v_cvt_pk_bf16_f32 v178, v16, v17
    v_mfma_f32_16x16x32_bf16 a[184:187], v[92:95], v[36:39], a[184:187]
    buffer_load_dwordx3 v[248:250], v12, s[68:71], s16 offen offset:1536 nt
    v_mfma_f32_16x16x32_bf16 a[136:139], v[72:75], v[32:35], 0
    v_exp_f32 v16, v180
    v_mfma_f32_16x16x32_bf16 a[136:139], v[88:91], v[36:39], a[136:139]
    ds_read_b128 v[28:31], v3 offset:0
    v_add_f32 v5, v5, v18
    v_add_f32 v5, v5, v19
    v_mfma_f32_16x16x32_bf16 a[40:43], v[80:83], v[36:39], a[40:43]
    v_exp_f32 v17, v181
    v_mfma_f32_16x16x32_bf16 a[88:91], v[84:87], v[36:39], a[88:91]
    s_waitcnt lgkmcnt(2)
    s_waitcnt vmcnt(20)
    buffer_load_dwordx3 v[252:254], v12, s[68:71], s16 offen offset:2304 nt
    v_cvt_pk_bf16_f32 v179, v18, v19
    v_mfma_f32_16x16x32_bf16 a[188:191], v[76:79], v[40:43], 0
    ds_read_b128 v[32:35], v2 offset:6144
    v_mfma_f32_16x16x32_bf16 a[188:191], v[92:95], v[44:47], a[188:191]
    v_exp_f32 v18, v182
    v_add_f32 v6, v6, v16
    v_mfma_f32_16x16x32_bf16 a[140:143], v[72:75], v[40:43], 0
    v_add_f32 v6, v6, v17
    v_mfma_f32_16x16x32_bf16 a[140:143], v[88:91], v[44:47], a[140:143]
    ds_read_b128 v[36:39], v3 offset:6144
    v_exp_f32 v19, v183
    v_mfma_f32_16x16x32_bf16 a[44:47], v[80:83], v[44:47], a[44:47]
    v_cvt_pk_bf16_f32 v180, v16, v17
    v_mfma_f32_16x16x32_bf16 a[92:95], v[84:87], v[44:47], a[92:95]
    s_waitcnt lgkmcnt(2)
    v_exp_f32 v16, v116
    v_add_f32 v6, v6, v18
    v_add_f32 v6, v6, v19
    v_exp_f32 v17, v117
    v_cvt_pk_bf16_f32 v181, v18, v19
    v_exp_f32 v18, v118
    v_add_f32 v6, v6, v16
    v_add_f32 v6, v6, v17
    v_exp_f32 v19, v119
    v_cvt_pk_bf16_f32 v182, v16, v17
    v_add_f32 v6, v6, v18
    v_add_f32 v6, v6, v19
    v_cvt_pk_bf16_f32 v183, v18, v19
    v_mfma_f32_16x16x32_bf16 v[64:67], v[24:27], a[192:195], v[128:131]
    s_waitcnt vmcnt(10)
    ds_read_b128 v[40:43], v2 offset:128
    v_lshlrev_b32 v48, 16, v56
    v_mfma_f32_16x16x32_bf16 v[64:67], v[28:31], a[196:199], v[64:67]
    v_exp_f32 v16, v184
    v_mfma_f32_16x16x32_bf16 v[68:71], v[24:27], a[216:219], v[132:135]
    v_exp_f32 v17, v185
    v_mfma_f32_16x16x32_bf16 v[68:71], v[28:31], a[220:223], v[68:71]
    v_exp_f32 v18, v186
    v_mfma_f32_16x16x32_bf16 v[72:75], v[24:27], a[240:243], v[136:139]
    ds_read_b128 v[44:47], v3 offset:128
    v_and_b32 v49, s97, v56
    v_mfma_f32_16x16x32_bf16 v[72:75], v[28:31], a[244:247], v[72:75]
    v_add_f32 v7, v7, v16
    v_add_f32 v7, v7, v17
    v_mfma_f32_16x16x32_bf16 v[76:79], v[24:27], v[200:203], v[140:143]
    v_exp_f32 v19, v187
    v_mfma_f32_16x16x32_bf16 v[76:79], v[28:31], v[204:207], v[76:79]
    s_waitcnt lgkmcnt(2)
    v_lshlrev_b32 v50, 16, v58
    v_and_b32 v51, s97, v58
    v_mfma_f32_16x16x32_bf16 v[96:99], v[32:35], a[192:195], v[128:131]
    ds_read_b128 v[24:27], v2 offset:6272
    v_cvt_pk_bf16_f32 v184, v16, v17
    v_mfma_f32_16x16x32_bf16 v[96:99], v[36:39], a[196:199], v[96:99]
    v_exp_f32 v16, v120
    v_mfma_f32_16x16x32_bf16 v[100:103], v[32:35], a[216:219], v[132:135]
    v_mul_f32_e64 v50, -v50, v48
    v_add_f32 v7, v7, v18
    v_mfma_f32_16x16x32_bf16 v[100:103], v[36:39], a[220:223], v[100:103]
    v_add_f32 v7, v7, v19
    v_mul_f32_e64 v51, -v51, v49
    v_mfma_f32_16x16x32_bf16 v[104:107], v[32:35], a[240:243], v[136:139]
    ds_read_b128 v[28:31], v3 offset:6272
    v_cvt_f32_i32 v144, v144
    v_mfma_f32_16x16x32_bf16 v[104:107], v[36:39], a[244:247], v[104:107]
    s_waitcnt lgkmcnt(2)
    v_exp_f32 v17, v121
    v_mfma_f32_16x16x32_bf16 v[108:111], v[32:35], v[200:203], v[140:143]
    s_waitcnt vmcnt(6)
    v_cvt_pk_bf16_f32 v185, v18, v19
    v_cvt_f32_i32 v148, v148
    v_mfma_f32_16x16x32_bf16 v[108:111], v[36:39], v[204:207], v[108:111]
    s_barrier
    v_mfma_f32_16x16x32_bf16 v[64:67], v[40:43], a[200:203], v[64:67]
    ds_read_b128 v[32:35], v2 offset:256
    v_add_u32 v0, 1, v0
    v_mfma_f32_16x16x32_bf16 v[64:67], v[44:47], a[204:207], v[64:67]
    buffer_store_dword v0, v13, s[20:23], 0 offen offset:32 sc1
    v_mfma_f32_16x16x32_bf16 v[68:71], v[40:43], a[224:227], v[68:71]
    s_mov_b32 m0, s26
    v_exp_f32 v18, v122
    v_mfma_f32_16x16x32_bf16 v[68:71], v[44:47], a[228:231], v[68:71]
    v_add_f32 v7, v7, v16
    v_add_f32 v7, v7, v17
    v_mfma_f32_16x16x32_bf16 v[72:75], v[40:43], a[248:251], v[72:75]
    ds_read_b128 v[36:39], v3 offset:256
    v_fma_f32 v144, v144, v48, v50
    v_mfma_f32_16x16x32_bf16 v[72:75], v[44:47], a[252:255], v[72:75]
    buffer_load_dwordx4 v4, s[4:7], s32 offen offset:0 sc1 lds
    v_mfma_f32_16x16x32_bf16 v[76:79], v[40:43], v[208:211], v[76:79]
    v_exp_f32 v19, v123
    v_mfma_f32_16x16x32_bf16 v[76:79], v[44:47], v[212:215], v[76:79]
    s_waitcnt lgkmcnt(2)
    v_cvt_pk_bf16_f32 v186, v16, v17
    v_fma_f32 v148, v148, v49, v51
    v_mfma_f32_16x16x32_bf16 v[96:99], v[24:27], a[200:203], v[96:99]
    ds_read_b128 v[40:43], v2 offset:6400
    v_cvt_f32_i32 v145, v145
    v_mfma_f32_16x16x32_bf16 v[96:99], v[28:31], a[204:207], v[96:99]
    buffer_load_dwordx4 v4, s[4:7], s32 offen offset:1024 sc1 lds
    v_mfma_f32_16x16x32_bf16 v[100:103], v[24:27], a[224:227], v[100:103]
    v_exp_f32 v16, v188
    v_mfma_f32_16x16x32_bf16 v[100:103], v[28:31], a[228:231], v[100:103]
    v_add_f32 v7, v7, v18
    v_add_f32 v7, v7, v19
    v_mfma_f32_16x16x32_bf16 v[104:107], v[24:27], a[248:251], v[104:107]
    ds_read_b128 v[44:47], v3 offset:6400
    v_cvt_f32_i32 v149, v149
    v_mfma_f32_16x16x32_bf16 v[104:107], v[28:31], a[252:255], v[104:107]
    buffer_load_dwordx4 v4, s[4:7], s32 offen offset:2048 sc1 lds
    v_mfma_f32_16x16x32_bf16 v[108:111], v[24:27], v[208:211], v[108:111]
    s_add_u32 s32, s32, 24576
    v_exp_f32 v17, v189
    v_mfma_f32_16x16x32_bf16 v[108:111], v[28:31], v[212:215], v[108:111]
    s_waitcnt lgkmcnt(2)
    v_cvt_pk_bf16_f32 v187, v18, v19
    v_fma_f32 v145, v145, v48, v50
    v_mfma_f32_16x16x32_bf16 v[64:67], v[32:35], a[208:211], v[64:67]
    s_sub_u32 s57, s32, 196608
    ds_read_b128 v[24:27], v2 offset:12288
    v_fma_f32 v149, v149, v49, v51
    v_mfma_f32_16x16x32_bf16 v[64:67], v[36:39], a[212:215], v[64:67]
    s_min_u32 s32, s32, s57
    v_exp_f32 v18, v190
    v_mfma_f32_16x16x32_bf16 v[68:71], v[32:35], a[232:235], v[68:71]
    s_add_u32 s26, s26, 12288
    v_add_f32 v8, v8, v16
    v_add_f32 v8, v8, v17
    v_mfma_f32_16x16x32_bf16 v[68:71], v[36:39], a[236:239], v[68:71]
    s_mov_b32 m0, s26
    v_exp_f32 v19, v191
    v_mfma_f32_16x16x32_bf16 v[72:75], v[32:35], v[192:195], v[72:75]
    ds_read_b128 v[28:31], v3 offset:12288
    v_cvt_pk_bf16_f32 v188, v16, v17
    v_mfma_f32_16x16x32_bf16 v[72:75], v[36:39], v[196:199], v[72:75]
    v_exp_f32 v16, v124
    v_mfma_f32_16x16x32_bf16 v[76:79], v[32:35], v[216:219], v[76:79]
    v_add_f32 v8, v8, v18
    v_add_f32 v8, v8, v19
    v_mfma_f32_16x16x32_bf16 v[76:79], v[36:39], v[220:223], v[76:79]
    s_waitcnt lgkmcnt(2)
    buffer_load_dwordx4 v4, s[4:7], s32 offen offset:0 sc1 lds
    v_mfma_f32_16x16x32_bf16 v[96:99], v[40:43], a[208:211], v[96:99]
    ds_read_b128 v[32:35], v2 offset:18432
    v_cvt_f32_i32 v146, v146
    v_mfma_f32_16x16x32_bf16 v[96:99], v[44:47], a[212:215], v[96:99]
    v_exp_f32 v17, v125
    v_mfma_f32_16x16x32_bf16 v[100:103], v[40:43], a[232:235], v[100:103]
    v_cvt_pk_bf16_f32 v189, v18, v19
    v_cvt_f32_i32 v150, v150
    v_mfma_f32_16x16x32_bf16 v[100:103], v[44:47], a[236:239], v[100:103]
    buffer_load_dwordx4 v4, s[4:7], s32 offen offset:1024 sc1 lds
    v_mfma_f32_16x16x32_bf16 v[104:107], v[40:43], v[192:195], v[104:107]
    ds_read_b128 v[36:39], v3 offset:18432
    v_fma_f32 v146, v146, v48, v50
    v_mfma_f32_16x16x32_bf16 v[104:107], v[44:47], v[196:199], v[104:107]
    v_exp_f32 v18, v126
    v_mfma_f32_16x16x32_bf16 v[108:111], v[40:43], v[216:219], v[108:111]
    v_add_f32 v8, v8, v16
    v_add_f32 v8, v8, v17
    v_mfma_f32_16x16x32_bf16 v[108:111], v[44:47], v[220:223], v[108:111]
    s_waitcnt lgkmcnt(2)
    buffer_load_dwordx4 v4, s[4:7], s32 offen offset:2048 sc1 lds
    v_mfma_f32_16x16x32_bf16 v[80:83], v[24:27], a[192:195], v[128:131]
    s_mov_b32 s32, 196608
    ds_read_b128 v[40:43], v2 offset:12416
    v_fma_f32 v150, v150, v49, v51
    v_mfma_f32_16x16x32_bf16 v[80:83], v[28:31], a[196:199], v[80:83]
    v_exp_f32 v19, v127
    v_cvt_pk_bf16_f32 v190, v16, v17
    v_mfma_f32_16x16x32_bf16 v[84:87], v[24:27], a[216:219], v[132:135]
    s_add_u32 s26, s26, 36864
    v_add_f32 v8, v8, v18
    v_add_f32 v8, v8, v19
    v_mfma_f32_16x16x32_bf16 v[84:87], v[28:31], a[220:223], v[84:87]
    s_sub_u32 s57, s26, 147456
    v_cvt_pk_bf16_f32 v191, v18, v19
    v_lshlrev_b32 v48, 16, v57
    v_mfma_f32_16x16x32_bf16 v[88:91], v[24:27], a[240:243], v[136:139]
    ds_read_b128 v[44:47], v3 offset:12416
    v_and_b32 v49, s97, v57
    v_mfma_f32_16x16x32_bf16 v[88:91], v[28:31], a[244:247], v[88:91]
    s_min_u32 s26, s26, s57
    v_exp_f32 v16, v64
    v_mfma_f32_16x16x32_bf16 v[92:95], v[24:27], v[200:203], v[140:143]
    v_exp_f32 v17, v65
    v_mfma_f32_16x16x32_bf16 v[92:95], v[28:31], v[204:207], v[92:95]
    s_waitcnt lgkmcnt(2)
    v_exp_f32 v18, v66
    v_mfma_f32_16x16x32_bf16 v[112:115], v[32:35], a[192:195], v[128:131]
    s_mov_b32 m0, s56
    ds_read_b128 v[24:27], v2 offset:18560
    v_lshlrev_b32 v50, 16, v59
    v_mfma_f32_16x16x32_bf16 v[112:115], v[36:39], a[196:199], v[112:115]
    v_add_f32 v5, v5, v16
    v_add_f32 v5, v5, v17
    v_mfma_f32_16x16x32_bf16 v[116:119], v[32:35], a[216:219], v[132:135]
    v_exp_f32 v19, v67
    v_mfma_f32_16x16x32_bf16 v[116:119], v[36:39], a[220:223], v[116:119]
    buffer_load_dwordx4 v4, s[4:7], s27 offen offset:0 sc1 lds
    v_mfma_f32_16x16x32_bf16 v[120:123], v[32:35], a[240:243], v[136:139]
    ds_read_b128 v[28:31], v3 offset:18560
    v_and_b32 v51, s97, v59
    v_mfma_f32_16x16x32_bf16 v[120:123], v[36:39], a[244:247], v[120:123]
    v_cvt_pk_bf16_f32 v64, v16, v17
    v_mul_f32_e64 v50, -v50, v48
    v_mfma_f32_16x16x32_bf16 v[124:127], v[32:35], v[200:203], v[140:143]
    v_exp_f32 v16, v96
    v_mfma_f32_16x16x32_bf16 v[124:127], v[36:39], v[204:207], v[124:127]
    s_waitcnt lgkmcnt(2)
    buffer_load_dwordx4 v4, s[4:7], s27 offen offset:1024 sc1 lds
    v_mfma_f32_16x16x32_bf16 v[80:83], v[40:43], a[200:203], v[80:83]
    ds_read_b128 v[32:35], v2 offset:12544
    v_add_f32 v5, v5, v18
    v_mfma_f32_16x16x32_bf16 v[80:83], v[44:47], a[204:207], v[80:83]
    v_add_f32 v5, v5, v19
    v_mul_f32_e64 v51, -v51, v49
    v_mfma_f32_16x16x32_bf16 v[84:87], v[40:43], a[224:227], v[84:87]
    v_exp_f32 v17, v97
    v_mfma_f32_16x16x32_bf16 v[84:87], v[44:47], a[228:231], v[84:87]
    s_waitcnt vmcnt(13)
    buffer_load_dwordx4 v4, s[4:7], s27 offen offset:2048 sc1 lds
    v_cvt_pk_bf16_f32 v65, v18, v19
    v_mfma_f32_16x16x32_bf16 v[88:91], v[40:43], a[248:251], v[88:91]
    s_add_u32 s27, s27, 24576
    ds_read_b128 v[36:39], v3 offset:12544
    v_cvt_f32_i32 v152, v152
    v_mfma_f32_16x16x32_bf16 v[88:91], v[44:47], a[252:255], v[88:91]
    v_exp_f32 v18, v98
    v_mfma_f32_16x16x32_bf16 v[92:95], v[40:43], v[208:211], v[92:95]
    s_sub_u32 s58, s27, 196608
    v_add_f32 v5, v5, v16
    v_add_f32 v5, v5, v17
    v_mfma_f32_16x16x32_bf16 v[92:95], v[44:47], v[212:215], v[92:95]
    s_waitcnt lgkmcnt(2)
    v_cvt_f32_i32 v156, v156
    v_fma_f32 v152, v152, v48, v50
    v_mfma_f32_16x16x32_bf16 v[112:115], v[24:27], a[200:203], v[112:115]
    s_min_u32 s27, s27, s58
    ds_read_b128 v[40:43], v2 offset:18688
    v_fma_f32 v156, v156, v49, v51
    v_mfma_f32_16x16x32_bf16 v[112:115], v[28:31], a[204:207], v[112:115]
    v_exp_f32 v19, v99
    v_cvt_pk_bf16_f32 v66, v16, v17
    v_mfma_f32_16x16x32_bf16 v[116:119], v[24:27], a[224:227], v[116:119]
L_iw2:
L_pg2:
    s_cbranch_execz L_pg6
    s_add_u32 s56, s56, 12288
    v_exp_f32 v16, v68
    v_mfma_f32_16x16x32_bf16 v[116:119], v[28:31], a[228:231], v[116:119]
    s_mov_b32 m0, s56
    v_add_f32 v5, v5, v18
    v_cvt_f32_i32 v153, v153
    v_mfma_f32_16x16x32_bf16 v[120:123], v[24:27], a[248:251], v[120:123]
    ds_read_b128 v[44:47], v3 offset:18688
    v_add_f32 v5, v5, v19
    v_mfma_f32_16x16x32_bf16 v[120:123], v[28:31], a[252:255], v[120:123]
    s_waitcnt lgkmcnt(2)
    v_exp_f32 v17, v69
    v_mfma_f32_16x16x32_bf16 v[124:127], v[24:27], v[208:211], v[124:127]
    s_waitcnt vmcnt(26)
    v_cvt_f32_i32 v157, v157
    v_cvt_pk_bf16_f32 v67, v18, v19
    v_mfma_f32_16x16x32_bf16 v[124:127], v[28:31], v[212:215], v[124:127]
    s_barrier
    v_add_u32 v1, 49152, v1
    v_mfma_f32_16x16x32_bf16 v[80:83], v[32:35], a[208:211], v[80:83]
    ds_read_b128 v[24:27], v1 offset:0
    v_fma_f32 v153, v153, v48, v50
    v_mfma_f32_16x16x32_bf16 v[80:83], v[36:39], a[212:215], v[80:83]
    s_waitcnt vmcnt(12)
    buffer_load_dwordx4 v4, s[4:7], s27 offen offset:0 sc1 lds
    v_mfma_f32_16x16x32_bf16 v[84:87], v[32:35], a[232:235], v[84:87]
    v_exp_f32 v18, v70
    v_mfma_f32_16x16x32_bf16 v[84:87], v[36:39], a[236:239], v[84:87]
    v_add_f32 v6, v6, v16
    v_add_f32 v6, v6, v17
    v_mfma_f32_16x16x32_bf16 v[88:91], v[32:35], v[192:195], v[88:91]
    ds_read_b128 v[28:31], v1 offset:12288
    v_fma_f32 v157, v157, v49, v51
    v_mfma_f32_16x16x32_bf16 v[88:91], v[36:39], v[196:199], v[88:91]
    s_waitcnt vmcnt(12)
    buffer_load_dwordx4 v4, s[4:7], s27 offen offset:1024 sc1 lds
    v_mfma_f32_16x16x32_bf16 v[92:95], v[32:35], v[216:219], v[92:95]
    v_exp_f32 v19, v71
    v_mfma_f32_16x16x32_bf16 v[92:95], v[36:39], v[220:223], v[92:95]
    s_waitcnt lgkmcnt(2)
    v_cvt_pk_bf16_f32 v68, v16, v17
    v_exp_f32 v16, v100
    v_mfma_f32_16x16x32_bf16 v[112:115], v[40:43], a[208:211], v[112:115]
    ds_read_b128 v[32:35], v1 offset:1024
    v_cvt_f32_i32 v154, v154
    v_mfma_f32_16x16x32_bf16 v[112:115], v[44:47], a[212:215], v[112:115]
    s_waitcnt vmcnt(12)
    buffer_load_dwordx4 v4, s[4:7], s27 offen offset:2048 sc1 lds
    v_add_f32 v6, v6, v18
    v_mfma_f32_16x16x32_bf16 v[116:119], v[40:43], a[232:235], v[116:119]
    v_add_f32 v6, v6, v19
    v_cvt_f32_i32 v158, v158
    v_mfma_f32_16x16x32_bf16 v[116:119], v[44:47], a[236:239], v[116:119]
    v_exp_f32 v17, v101
    v_cvt_pk_bf16_f32 v69, v18, v19
    v_mfma_f32_16x16x32_bf16 v[120:123], v[40:43], v[192:195], v[120:123]
    s_add_u32 s27, s27, 24576
    ds_read_b128 v[36:39], v1 offset:13312
    v_fma_f32 v154, v154, v48, v50
    v_mfma_f32_16x16x32_bf16 v[120:123], v[44:47], v[196:199], v[120:123]
    v_exp_f32 v18, v102
    v_fma_f32 v158, v158, v49, v51
    v_mfma_f32_16x16x32_bf16 v[124:127], v[40:43], v[216:219], v[124:127]
    s_sub_u32 s58, s27, 196608
    v_add_f32 v6, v6, v16
    v_add_f32 v6, v6, v17
    v_mfma_f32_16x16x32_bf16 v[124:127], v[44:47], v[220:223], v[124:127]
    s_waitcnt lgkmcnt(2)
    v_exp_f32 v19, v103
    v_cvt_pk_bf16_f32 v144, v144, v148
    v_cvt_pk_bf16_f32 v148, v145, v149
    v_cvt_pk_bf16_f32 v70, v16, v17
    s_min_u32 s27, s27, s58
    v_cvt_pk_bf16_f32 v145, v152, v156
    v_add_f32 v6, v6, v18
    s_add_u32 s56, s56, 36864
    v_cvt_pk_bf16_f32 v149, v153, v157
    v_add_f32 v6, v6, v19
    s_sub_u32 s58, s56, 147456
    v_cvt_pk_bf16_f32 v152, v146, v150
    v_cvt_pk_bf16_f32 v71, v18, v19
    s_min_u32 s56, s56, s58
    v_cvt_pk_bf16_f32 v153, v154, v158
    s_mov_b32 s31, 6
    v_mfma_f32_16x16x32_bf16 a[0:3], v[160:163], v[24:27], a[0:3]
    s_add_u32 s33, s33, 196608
    ds_read_b128 v[40:43], v1 offset:2048
    v_mfma_f32_16x16x32_bf16 a[0:3], v[176:179], v[28:31], a[0:3]
    s_add_u32 s34, s34, 196608
    v_exp_f32 v16, v72
    v_mfma_f32_16x16x32_bf16 a[48:51], v[164:167], v[24:27], a[48:51]
    s_add_u32 s36, s36, 1536
    v_exp_f32 v17, v73
    v_mfma_f32_16x16x32_bf16 a[48:51], v[180:183], v[28:31], a[48:51]
    v_exp_f32 v18, v74
    v_mfma_f32_16x16x32_bf16 a[96:99], v[168:171], v[24:27], a[96:99]
    ds_read_b128 v[44:47], v1 offset:14336
    v_add_f32 v7, v7, v16
    v_mfma_f32_16x16x32_bf16 a[96:99], v[184:187], v[28:31], a[96:99]
    s_waitcnt vmcnt(11)
    buffer_load_dwordx2 v[56:57], v10, s[72:75], s36 offen offset:0
    v_mfma_f32_16x16x32_bf16 a[144:147], v[172:175], v[24:27], a[144:147]
    v_add_f32 v7, v7, v17
    v_mfma_f32_16x16x32_bf16 a[144:147], v[188:191], v[28:31], a[144:147]
    s_waitcnt lgkmcnt(2)
    v_exp_f32 v19, v75
    v_mfma_f32_16x16x32_bf16 a[4:7], v[160:163], v[32:35], a[4:7]
    ds_read_b128 v[24:27], v1 offset:3072
    v_cvt_pk_bf16_f32 v72, v16, v17
    v_mfma_f32_16x16x32_bf16 a[4:7], v[176:179], v[36:39], a[4:7]
    buffer_load_dwordx2 v[58:59], v10, s[76:79], s36 offen offset:0
    v_mfma_f32_16x16x32_bf16 a[52:55], v[164:167], v[32:35], a[52:55]
    v_exp_f32 v16, v104
    v_mfma_f32_16x16x32_bf16 a[52:55], v[180:183], v[36:39], a[52:55]
    v_add_f32 v7, v7, v18
    v_add_f32 v7, v7, v19
    v_mfma_f32_16x16x32_bf16 a[100:103], v[168:171], v[32:35], a[100:103]
    ds_read_b128 v[28:31], v1 offset:15360
    v_mfma_f32_16x16x32_bf16 a[100:103], v[184:187], v[36:39], a[100:103]
    s_waitcnt vmcnt(12)
    buffer_load_dwordx4 v[224:227], v9, s[64:67], s33 offen offset:0 nt
    v_mfma_f32_16x16x32_bf16 a[148:151], v[172:175], v[32:35], a[148:151]
    v_exp_f32 v17, v105
    v_mfma_f32_16x16x32_bf16 a[148:151], v[188:191], v[36:39], a[148:151]
    s_waitcnt lgkmcnt(2)
    v_cvt_pk_bf16_f32 v73, v18, v19
    v_mfma_f32_16x16x32_bf16 a[8:11], v[160:163], v[40:43], a[8:11]
    ds_read_b128 v[32:35], v1 offset:4096
    v_mfma_f32_16x16x32_bf16 a[8:11], v[176:179], v[44:47], a[8:11]
    s_waitcnt vmcnt(12)
    buffer_load_dwordx4 v[228:231], v9, s[64:67], s33 offen offset:1536 nt
    v_mfma_f32_16x16x32_bf16 a[56:59], v[164:167], v[40:43], a[56:59]
    v_exp_f32 v18, v106
    v_mfma_f32_16x16x32_bf16 a[56:59], v[180:183], v[44:47], a[56:59]
    v_add_f32 v7, v7, v16
    v_add_f32 v7, v7, v17
    v_mfma_f32_16x16x32_bf16 a[104:107], v[168:171], v[40:43], a[104:107]
    s_waitcnt vmcnt(17)
    ds_read_b128 v[36:39], v1 offset:16384
    v_lshlrev_b32 v48, 16, v60
    v_mfma_f32_16x16x32_bf16 a[104:107], v[184:187], v[44:47], a[104:107]
    buffer_load_dwordx4 v[232:235], v9, s[64:67], s34 offen offset:0 nt
    v_mfma_f32_16x16x32_bf16 a[152:155], v[172:175], v[40:43], a[152:155]
    v_exp_f32 v19, v107
    v_mfma_f32_16x16x32_bf16 a[152:155], v[188:191], v[44:47], a[152:155]
    s_waitcnt lgkmcnt(2)
    v_cvt_pk_bf16_f32 v74, v16, v17
    v_and_b32 v49, s97, v60
    v_mfma_f32_16x16x32_bf16 a[12:15], v[160:163], v[24:27], a[12:15]
    ds_read_b128 v[40:43], v1 offset:5120
    v_lshlrev_b32 v50, 16, v62
    v_mfma_f32_16x16x32_bf16 a[12:15], v[176:179], v[28:31], a[12:15]
    s_waitcnt vmcnt(13)
    buffer_load_dwordx4 v[236:239], v9, s[64:67], s34 offen offset:1536 nt
    v_mfma_f32_16x16x32_bf16 a[60:63], v[164:167], v[24:27], a[60:63]
    v_exp_f32 v16, v76
    v_mfma_f32_16x16x32_bf16 a[60:63], v[180:183], v[28:31], a[60:63]
    v_add_f32 v7, v7, v18
    v_add_f32 v7, v7, v19
    v_mfma_f32_16x16x32_bf16 a[108:111], v[168:171], v[24:27], a[108:111]
    ds_read_b128 v[44:47], v1 offset:17408
    v_and_b32 v51, s97, v62
    v_mfma_f32_16x16x32_bf16 a[108:111], v[184:187], v[28:31], a[108:111]
    v_exp_f32 v17, v77
    v_mfma_f32_16x16x32_bf16 a[156:159], v[172:175], v[24:27], a[156:159]
    s_add_u32 s29, s28, 49152
    v_cvt_pk_bf16_f32 v75, v18, v19
    v_mul_f32_e64 v50, -v50, v48
    v_mfma_f32_16x16x32_bf16 a[156:159], v[188:191], v[28:31], a[156:159]
    s_waitcnt lgkmcnt(2)
    v_exp_f32 v18, v78
    v_mfma_f32_16x16x32_bf16 a[16:19], v[160:163], v[32:35], a[16:19]
    s_mov_b32 m0, s56
    ds_read_b128 v[24:27], v1 offset:6144
    v_add_f32 v8, v8, v16
    v_mfma_f32_16x16x32_bf16 a[16:19], v[176:179], v[36:39], a[16:19]
    s_sub_u32 s3, s29, 147456
    s_waitcnt vmcnt(13)
    buffer_load_dwordx4 v4, s[4:7], s27 offen offset:0 sc1 lds
    v_mfma_f32_16x16x32_bf16 a[64:67], v[164:167], v[32:35], a[64:67]
    s_min_u32 s29, s29, s3
    v_add_f32 v8, v8, v17
    v_mul_f32_e64 v51, -v51, v49
    v_mfma_f32_16x16x32_bf16 a[64:67], v[180:183], v[36:39], a[64:67]
    v_exp_f32 v19, v79
    v_mfma_f32_16x16x32_bf16 a[112:115], v[168:171], v[32:35], a[112:115]
    ds_read_b128 v[28:31], v1 offset:18432
    v_cvt_pk_bf16_f32 v76, v16, v17
    v_mfma_f32_16x16x32_bf16 a[112:115], v[184:187], v[36:39], a[112:115]
    s_waitcnt vmcnt(13)
    buffer_load_dwordx4 v4, s[4:7], s27 offen offset:1024 sc1 lds
    v_mfma_f32_16x16x32_bf16 a[160:163], v[172:175], v[32:35], a[160:163]
    s_sub_u32 s3, s29, s28
    v_exp_f32 v16, v108
    v_mfma_f32_16x16x32_bf16 a[160:163], v[188:191], v[36:39], a[160:163]
    s_waitcnt lgkmcnt(2)
    v_add_f32 v8, v8, v18
    v_add_f32 v8, v8, v19
    v_mfma_f32_16x16x32_bf16 a[20:23], v[160:163], v[40:43], a[20:23]
    ds_read_b128 v[32:35], v1 offset:7168
    v_cvt_f32_i32 v240, v240
    v_mfma_f32_16x16x32_bf16 a[20:23], v[176:179], v[44:47], a[20:23]
    buffer_load_dword v52, v20, s[20:23], s44 offen sc1
    v_mfma_f32_16x16x32_bf16 a[68:71], v[164:167], v[40:43], a[68:71]
    v_exp_f32 v17, v109
    v_mfma_f32_16x16x32_bf16 a[68:71], v[180:183], v[44:47], a[68:71]
    v_cvt_pk_bf16_f32 v77, v18, v19
    v_cvt_f32_i32 v244, v244
    v_mfma_f32_16x16x32_bf16 a[116:119], v[168:171], v[40:43], a[116:119]
    s_mov_b32 s28, s29
    ds_read_b128 v[36:39], v1 offset:19456
    v_fma_f32 v240, v240, v48, v50
    v_mfma_f32_16x16x32_bf16 a[116:119], v[184:187], v[44:47], a[116:119]
    s_waitcnt vmcnt(14)
    buffer_load_dwordx4 v4, s[4:7], s27 offen offset:2048 sc1 lds
    v_mfma_f32_16x16x32_bf16 a[164:167], v[172:175], v[40:43], a[164:167]
    s_add_u32 s27, s27, 24576
    v_exp_f32 v18, v110
    v_mfma_f32_16x16x32_bf16 a[164:167], v[188:191], v[44:47], a[164:167]
    s_waitcnt lgkmcnt(2)
    v_add_f32 v8, v8, v16
    v_add_f32 v8, v8, v17
    v_fma_f32 v244, v244, v49, v51
    v_mfma_f32_16x16x32_bf16 a[24:27], v[160:163], v[24:27], a[24:27]
    s_sub_u32 s58, s27, 196608
    ds_read_b128 v[40:43], v1 offset:8192
    v_cvt_f32_i32 v241, v241
    v_mfma_f32_16x16x32_bf16 a[24:27], v[176:179], v[28:31], a[24:27]
    v_exp_f32 v19, v111
    v_cvt_pk_bf16_f32 v78, v16, v17
    v_mfma_f32_16x16x32_bf16 a[72:75], v[164:167], v[24:27], a[72:75]
    s_min_u32 s27, s27, s58
    v_add_f32 v8, v8, v18
    v_add_f32 v8, v8, v19
    v_mfma_f32_16x16x32_bf16 a[72:75], v[180:183], v[28:31], a[72:75]
    v_cvt_f32_i32 v245, v245
    v_cvt_pk_bf16_f32 v79, v18, v19
    v_mfma_f32_16x16x32_bf16 a[120:123], v[168:171], v[24:27], a[120:123]
    s_add_u32 s56, s56, 12288
    ds_read_b128 v[44:47], v1 offset:20480
    v_fma_f32 v241, v241, v48, v50
    v_mfma_f32_16x16x32_bf16 a[120:123], v[184:187], v[28:31], a[120:123]
    v_exp_f32 v16, v80
    v_mfma_f32_16x16x32_bf16 a[168:171], v[172:175], v[24:27], a[168:171]
    s_mov_b32 m0, s56
    v_exp_f32 v17, v81
    v_mfma_f32_16x16x32_bf16 a[168:171], v[188:191], v[28:31], a[168:171]
    s_waitcnt lgkmcnt(2)
    v_fma_f32 v245, v245, v49, v51
    v_exp_f32 v18, v82
    v_mfma_f32_16x16x32_bf16 a[28:31], v[160:163], v[32:35], a[28:31]
    ds_read_b128 v[24:27], v1 offset:9216
    v_cvt_f32_i32 v242, v242
    v_mfma_f32_16x16x32_bf16 a[28:31], v[176:179], v[36:39], a[28:31]
    v_add_f32 v5, v5, v16
    v_cvt_f32_i32 v246, v246
    v_mfma_f32_16x16x32_bf16 a[76:79], v[164:167], v[32:35], a[76:79]
    v_add_f32 v5, v5, v17
    v_fma_f32 v242, v242, v48, v50
    v_mfma_f32_16x16x32_bf16 a[76:79], v[180:183], v[36:39], a[76:79]
    s_waitcnt vmcnt(14)
    buffer_load_dwordx4 v4, s[4:7], s27 offen offset:0 sc1 lds
    v_mfma_f32_16x16x32_bf16 a[124:127], v[168:171], v[32:35], a[124:127]
    ds_read_b128 v[28:31], v1 offset:21504
    v_fma_f32 v246, v246, v49, v51
    v_mfma_f32_16x16x32_bf16 a[124:127], v[184:187], v[36:39], a[124:127]
    v_exp_f32 v19, v83
    v_cvt_pk_bf16_f32 v80, v16, v17
    v_mfma_f32_16x16x32_bf16 a[172:175], v[172:175], v[32:35], a[172:175]
    v_exp_f32 v16, v112
    v_mfma_f32_16x16x32_bf16 a[172:175], v[188:191], v[36:39], a[172:175]
    s_waitcnt lgkmcnt(2)
    s_waitcnt vmcnt(14)
    buffer_load_dwordx4 v4, s[4:7], s27 offen offset:1024 sc1 lds
    v_add_f32 v5, v5, v18
    v_mfma_f32_16x16x32_bf16 a[32:35], v[160:163], v[40:43], a[32:35]
    ds_read_b128 v[32:35], v1 offset:10240
    v_lshlrev_b32 v48, 16, v61
    v_mfma_f32_16x16x32_bf16 a[32:35], v[176:179], v[44:47], a[32:35]
    v_add_f32 v5, v5, v19
    v_exp_f32 v17, v113
    v_mfma_f32_16x16x32_bf16 a[80:83], v[164:167], v[40:43], a[80:83]
    v_and_b32 v49, s97, v61
    v_cvt_pk_bf16_f32 v81, v18, v19
    v_mfma_f32_16x16x32_bf16 a[80:83], v[180:183], v[44:47], a[80:83]
    s_waitcnt vmcnt(14)
    buffer_load_dwordx4 v4, s[4:7], s27 offen offset:2048 sc1 lds
    v_lshlrev_b32 v50, 16, v63
    v_mfma_f32_16x16x32_bf16 a[128:131], v[168:171], v[40:43], a[128:131]
    ds_read_b128 v[36:39], v1 offset:22528
    v_and_b32 v51, s97, v63
    v_mfma_f32_16x16x32_bf16 a[128:131], v[184:187], v[44:47], a[128:131]
    v_exp_f32 v18, v114
    v_add_f32 v5, v5, v16
    v_mfma_f32_16x16x32_bf16 a[176:179], v[172:175], v[40:43], a[176:179]
    v_add_u32 v2, s3, v2
    v_add_u32 v3, s3, v3
    v_mfma_f32_16x16x32_bf16 a[176:179], v[188:191], v[44:47], a[176:179]
    s_waitcnt lgkmcnt(2)
    v_add_f32 v5, v5, v17
    v_exp_f32 v19, v115
    v_mfma_f32_16x16x32_bf16 a[36:39], v[160:163], v[24:27], a[36:39]
    ds_read_b128 v[40:43], v1 offset:11264
    v_mul_f32_e64 v50, -v50, v48
    v_mfma_f32_16x16x32_bf16 a[36:39], v[176:179], v[28:31], a[36:39]
    v_cvt_pk_bf16_f32 v82, v16, v17
    v_mul_f32_e64 v51, -v51, v49
    v_mfma_f32_16x16x32_bf16 a[84:87], v[164:167], v[24:27], a[84:87]
    v_exp_f32 v16, v84
    v_mfma_f32_16x16x32_bf16 a[84:87], v[180:183], v[28:31], a[84:87]
    v_cvt_f32_i32 v248, v248
    v_add_f32 v5, v5, v18
    v_cvt_f32_i32 v252, v252
    v_mfma_f32_16x16x32_bf16 a[132:135], v[168:171], v[24:27], a[132:135]
    s_mov_b32 s27, 208896
    ds_read_b128 v[44:47], v1 offset:23552
    v_add_f32 v5, v5, v19
    v_mfma_f32_16x16x32_bf16 a[132:135], v[184:187], v[28:31], a[132:135]
    s_waitcnt lgkmcnt(2)
    v_exp_f32 v17, v85
    v_fma_f32 v248, v248, v48, v50
    v_mfma_f32_16x16x32_bf16 a[180:183], v[172:175], v[24:27], a[180:183]
    s_waitcnt vmcnt(19)
    v_cvt_pk_bf16_f32 v83, v18, v19
    v_fma_f32 v252, v252, v49, v51
    v_mfma_f32_16x16x32_bf16 a[180:183], v[188:191], v[28:31], a[180:183]
    s_barrier
    v_exp_f32 v18, v86
    v_mfma_f32_16x16x32_bf16 a[40:43], v[160:163], v[32:35], a[40:43]
    s_add_u32 s56, s56, 36864
    ds_read_b128 v[24:27], v2 offset:0
    v_cvt_f32_i32 v249, v249
    v_mfma_f32_16x16x32_bf16 a[40:43], v[176:179], v[36:39], a[40:43]
    s_sub_u32 s58, s56, 147456
    v_add_f32 v6, v6, v16
    v_add_f32 v6, v6, v17
    v_mfma_f32_16x16x32_bf16 a[88:91], v[164:167], v[32:35], a[88:91]
    s_min_u32 s56, s56, s58
    v_cvt_f32_i32 v253, v253
    v_fma_f32 v249, v249, v48, v50
    v_mfma_f32_16x16x32_bf16 a[88:91], v[180:183], v[36:39], a[88:91]
    v_exp_f32 v19, v87
    v_mfma_f32_16x16x32_bf16 a[136:139], v[168:171], v[32:35], a[136:139]
    ds_read_b128 v[28:31], v3 offset:0
    v_cvt_pk_bf16_f32 v84, v16, v17
    v_mfma_f32_16x16x32_bf16 a[136:139], v[184:187], v[36:39], a[136:139]
    v_exp_f32 v16, v116
    v_mfma_f32_16x16x32_bf16 a[184:187], v[172:175], v[32:35], a[184:187]
    v_fma_f32 v253, v253, v49, v51
    v_add_f32 v6, v6, v18
    v_mfma_f32_16x16x32_bf16 a[184:187], v[188:191], v[36:39], a[184:187]
    s_waitcnt lgkmcnt(2)
    v_cvt_f32_i32 v250, v250
    v_add_f32 v6, v6, v19
    v_mfma_f32_16x16x32_bf16 a[44:47], v[160:163], v[40:43], a[44:47]
    ds_read_b128 v[32:35], v2 offset:6144
    v_cvt_f32_i32 v254, v254
    v_mfma_f32_16x16x32_bf16 a[44:47], v[176:179], v[44:47], a[44:47]
    v_exp_f32 v17, v117
    v_mfma_f32_16x16x32_bf16 a[92:95], v[164:167], v[40:43], a[92:95]
    v_cvt_pk_bf16_f32 v85, v18, v19
    v_fma_f32 v250, v250, v48, v50
    v_mfma_f32_16x16x32_bf16 a[92:95], v[180:183], v[44:47], a[92:95]
    v_exp_f32 v18, v118
    v_mfma_f32_16x16x32_bf16 a[140:143], v[168:171], v[40:43], a[140:143]
    s_nop 0
    ds_read_b128 v[36:39], v3 offset:6144
    v_fma_f32 v254, v254, v49, v51
    v_mfma_f32_16x16x32_bf16 a[140:143], v[184:187], v[44:47], a[140:143]
    v_add_f32 v6, v6, v16
    v_add_f32 v6, v6, v17
    v_mfma_f32_16x16x32_bf16 a[188:191], v[172:175], v[40:43], a[188:191]
    s_waitcnt lgkmcnt(2)
    v_exp_f32 v19, v119
    v_cvt_pk_bf16_f32 v146, v240, v244
    v_cvt_pk_bf16_f32 v150, v241, v245
    v_cvt_pk_bf16_f32 v86, v16, v17
    v_cvt_pk_bf16_f32 v147, v248, v252
    v_add_f32 v6, v6, v18
    v_cvt_pk_bf16_f32 v151, v249, v253
    v_add_f32 v6, v6, v19
    v_cvt_pk_bf16_f32 v154, v242, v246
    v_cvt_pk_bf16_f32 v87, v18, v19
    v_cvt_pk_bf16_f32 v155, v250, v254
    v_mfma_f32_16x16x32_bf16 a[188:191], v[188:191], v[44:47], a[188:191]
    s_branch L_join
.p2align 6
L_loop:
    v_mfma_f32_16x16x32_bf16 v[160:163], v[24:27], a[192:195], v[128:131]
    s_mov_b32 m0, s56
    ds_read_b128 v[40:43], v2 offset:128
    v_cvt_f32_i32 v247, v247
    v_mfma_f32_16x16x32_bf16 v[160:163], v[28:31], a[196:199], v[160:163]
    buffer_load_dwordx4 v4, s[4:7], s27 offen offset:0 sc1 lds
    v_mfma_f32_16x16x32_bf16 v[164:167], v[24:27], a[216:219], v[132:135]
    v_exp_f32 v16, v88
    v_mfma_f32_16x16x32_bf16 v[164:167], v[28:31], a[220:223], v[164:167]
    v_exp_f32 v17, v89
    v_mfma_f32_16x16x32_bf16 v[168:171], v[24:27], a[240:243], v[136:139]
    ds_read_b128 v[44:47], v3 offset:128
    v_fma_f32 v246, v246, v48, v50
    v_mfma_f32_16x16x32_bf16 v[168:171], v[28:31], a[244:247], v[168:171]
    v_exp_f32 v18, v90
    v_mfma_f32_16x16x32_bf16 v[172:175], v[24:27], v[200:203], v[140:143]
    v_fma_f32 v247, v247, v49, v51
    v_add_f32 v7, v7, v16
    v_mfma_f32_16x16x32_bf16 v[172:175], v[28:31], v[204:207], v[172:175]
    s_waitcnt lgkmcnt(2)
    v_add_f32 v7, v7, v17
    v_cvt_pk_bf16_f32 v231, v246, v247
    v_mfma_f32_16x16x32_bf16 v[96:99], v[32:35], a[192:195], v[128:131]
    ds_read_b128 v[24:27], v2 offset:6272
    v_cvt_f32_i32 v250, v250
    v_mfma_f32_16x16x32_bf16 v[96:99], v[36:39], a[196:199], v[96:99]
    buffer_load_dwordx4 v4, s[4:7], s27 offen offset:1024 sc1 lds
    v_mfma_f32_16x16x32_bf16 v[100:103], v[32:35], a[216:219], v[132:135]
    v_exp_f32 v19, v91
    v_mfma_f32_16x16x32_bf16 v[100:103], v[36:39], a[220:223], v[100:103]
    v_cvt_pk_bf16_f32 v88, v16, v17
    v_cvt_f32_i32 v251, v251
    v_mfma_f32_16x16x32_bf16 v[104:107], v[32:35], a[240:243], v[136:139]
    ds_read_b128 v[28:31], v3 offset:6272
    v_fma_f32 v250, v250, v48, v50
    v_mfma_f32_16x16x32_bf16 v[104:107], v[36:39], a[244:247], v[104:107]
    v_exp_f32 v16, v120
    v_mfma_f32_16x16x32_bf16 v[108:111], v[32:35], v[200:203], v[140:143]
    v_add_f32 v7, v7, v18
    v_add_f32 v7, v7, v19
    v_mfma_f32_16x16x32_bf16 v[108:111], v[36:39], v[204:207], v[108:111]
    s_waitcnt lgkmcnt(2)
    v_exp_f32 v17, v121
    v_mfma_f32_16x16x32_bf16 v[160:163], v[40:43], a[200:203], v[160:163]
    ds_read_b128 v[32:35], v2 offset:256
    v_cvt_pk_bf16_f32 v89, v18, v19
    v_mfma_f32_16x16x32_bf16 v[160:163], v[44:47], a[204:207], v[160:163]
    v_exp_f32 v18, v122
    v_mfma_f32_16x16x32_bf16 v[164:167], v[40:43], a[224:227], v[164:167]
    v_fma_f32 v251, v251, v49, v51
    v_add_f32 v7, v7, v16
    v_mfma_f32_16x16x32_bf16 v[164:167], v[44:47], a[228:231], v[164:167]
    buffer_load_dwordx4 v4, s[4:7], s27 offen offset:2048 sc1 lds
    v_mfma_f32_16x16x32_bf16 v[168:171], v[40:43], a[248:251], v[168:171]
    ds_read_b128 v[36:39], v3 offset:256
    v_cvt_pk_bf16_f32 v235, v250, v251
    v_mfma_f32_16x16x32_bf16 v[168:171], v[44:47], a[252:255], v[168:171]
    v_add_f32 v7, v7, v17
    v_cvt_f32_i32 v254, v254
    v_mfma_f32_16x16x32_bf16 v[172:175], v[40:43], v[208:211], v[172:175]
    v_exp_f32 v19, v123
    v_mfma_f32_16x16x32_bf16 v[172:175], v[44:47], v[212:215], v[172:175]
    s_waitcnt lgkmcnt(2)
    v_cvt_pk_bf16_f32 v90, v16, v17
    v_cvt_f32_i32 v255, v255
    v_mfma_f32_16x16x32_bf16 v[96:99], v[24:27], a[200:203], v[96:99]
    ds_read_b128 v[40:43], v2 offset:6400
    v_fma_f32 v254, v254, v48, v50
    v_mfma_f32_16x16x32_bf16 v[96:99], v[28:31], a[204:207], v[96:99]
    s_add_u32 s27, s27, 24576
    v_exp_f32 v16, v92
    v_mfma_f32_16x16x32_bf16 v[100:103], v[24:27], a[224:227], v[100:103]
    v_add_f32 v7, v7, v18
    v_add_f32 v7, v7, v19
    v_mfma_f32_16x16x32_bf16 v[100:103], v[28:31], a[228:231], v[100:103]
    v_exp_f32 v17, v93
    v_mfma_f32_16x16x32_bf16 v[104:107], v[24:27], a[248:251], v[104:107]
    ds_read_b128 v[44:47], v3 offset:6400
    v_fma_f32 v255, v255, v49, v51
    v_mfma_f32_16x16x32_bf16 v[104:107], v[28:31], a[252:255], v[104:107]
    v_cvt_pk_bf16_f32 v91, v18, v19
    v_cvt_pk_bf16_f32 v239, v254, v255
    v_mfma_f32_16x16x32_bf16 v[108:111], v[24:27], v[208:211], v[108:111]
    s_add_u32 s29, s30, 49152
    v_exp_f32 v18, v94
    v_mfma_f32_16x16x32_bf16 v[108:111], v[28:31], v[212:215], v[108:111]
    s_waitcnt lgkmcnt(2)
    v_add_f32 v8, v8, v16
    v_add_f32 v8, v8, v17
    v_mfma_f32_16x16x32_bf16 v[160:163], v[32:35], a[208:211], v[160:163]
    s_waitcnt vmcnt(11)
    ds_read_b128 v[24:27], v2 offset:12288
    v_lshlrev_b32 v48, 16, v56
    v_mfma_f32_16x16x32_bf16 v[160:163], v[36:39], a[212:215], v[160:163]
    s_sub_u32 s3, s29, 147456
    buffer_load_dwordx2 v[60:61], off, s[80:83], s37 offset:8
    v_mfma_f32_16x16x32_bf16 v[164:167], v[32:35], a[232:235], v[164:167]
    s_add_u32 s56, s56, 12288
    v_exp_f32 v19, v95
    v_mfma_f32_16x16x32_bf16 v[164:167], v[36:39], a[236:239], v[164:167]
    s_min_u32 s29, s29, s3
    v_cvt_pk_bf16_f32 v92, v16, v17
    v_and_b32 v49, s97, v56
    v_mfma_f32_16x16x32_bf16 v[168:171], v[32:35], v[192:195], v[168:171]
    s_mov_b32 m0, s56
    ds_read_b128 v[28:31], v3 offset:12288
    v_mfma_f32_16x16x32_bf16 v[168:171], v[36:39], v[196:199], v[168:171]
    buffer_load_dwordx2 v[62:63], off, s[84:87], s37 offset:8
    v_mfma_f32_16x16x32_bf16 v[172:175], v[32:35], v[216:219], v[172:175]
    v_exp_f32 v16, v124
    v_mfma_f32_16x16x32_bf16 v[172:175], v[36:39], v[220:223], v[172:175]
    s_waitcnt lgkmcnt(2)
    v_add_f32 v8, v8, v18
    v_add_f32 v8, v8, v19
    v_mfma_f32_16x16x32_bf16 v[96:99], v[40:43], a[208:211], v[96:99]
    ds_read_b128 v[32:35], v2 offset:18432
    v_lshlrev_b32 v50, 16, v58
    v_mfma_f32_16x16x32_bf16 v[96:99], v[44:47], a[212:215], v[96:99]
    s_sub_u32 s3, s29, s30
    v_exp_f32 v17, v125
    v_mfma_f32_16x16x32_bf16 v[100:103], v[40:43], a[232:235], v[100:103]
    v_cvt_pk_bf16_f32 v93, v18, v19
    v_mfma_f32_16x16x32_bf16 v[100:103], v[44:47], a[236:239], v[100:103]
    buffer_load_dwordx4 v4, s[4:7], s27 offen offset:0 sc1 lds
    v_mfma_f32_16x16x32_bf16 v[104:107], v[40:43], v[192:195], v[104:107]
    ds_read_b128 v[36:39], v3 offset:18432
    v_mfma_f32_16x16x32_bf16 v[104:107], v[44:47], v[196:199], v[104:107]
    v_exp_f32 v18, v126
    v_mfma_f32_16x16x32_bf16 v[108:111], v[40:43], v[216:219], v[108:111]
    v_add_f32 v8, v8, v16
    v_add_f32 v8, v8, v17
    v_mfma_f32_16x16x32_bf16 v[108:111], v[44:47], v[220:223], v[108:111]
    s_waitcnt lgkmcnt(2)
    buffer_load_dwordx3 v[240:242], v12, s[68:71], s16 offen offset:0 nt
    v_mfma_f32_16x16x32_bf16 v[176:179], v[24:27], a[192:195], v[128:131]
    ds_read_b128 v[40:43], v2 offset:12416
    v_and_b32 v51, s97, v58
    v_mfma_f32_16x16x32_bf16 v[176:179], v[28:31], a[196:199], v[176:179]
    v_exp_f32 v19, v127
    v_cvt_pk_bf16_f32 v94, v16, v17
    v_mfma_f32_16x16x32_bf16 v[180:183], v[24:27], a[216:219], v[132:135]
    s_mov_b32 s30, s29
    v_add_f32 v8, v8, v18
    v_add_f32 v8, v8, v19
    v_mfma_f32_16x16x32_bf16 v[180:183], v[28:31], a[220:223], v[180:183]
    buffer_load_dwordx4 v4, s[4:7], s27 offen offset:1024 sc1 lds
    v_mfma_f32_16x16x32_bf16 v[184:187], v[24:27], a[240:243], v[136:139]
    ds_read_b128 v[44:47], v3 offset:12416
    v_cvt_pk_bf16_f32 v95, v18, v19
    v_mfma_f32_16x16x32_bf16 v[184:187], v[28:31], a[244:247], v[184:187]
    v_exp_f32 v16, v160
    v_mfma_f32_16x16x32_bf16 v[188:191], v[24:27], v[200:203], v[140:143]
    v_exp_f32 v17, v161
    v_mfma_f32_16x16x32_bf16 v[188:191], v[28:31], v[204:207], v[188:191]
    s_waitcnt lgkmcnt(2)
    buffer_load_dwordx3 v[244:246], v12, s[68:71], s16 offen offset:768 nt
    v_mfma_f32_16x16x32_bf16 v[112:115], v[32:35], a[192:195], v[128:131]
    ds_read_b128 v[24:27], v2 offset:18560
    v_mul_f32_e64 v50, -v50, v48
    v_mfma_f32_16x16x32_bf16 v[112:115], v[36:39], a[196:199], v[112:115]
    v_exp_f32 v18, v162
    v_mfma_f32_16x16x32_bf16 v[116:119], v[32:35], a[216:219], v[132:135]
    v_add_f32 v5, v5, v16
    v_add_f32 v5, v5, v17
    v_mfma_f32_16x16x32_bf16 v[116:119], v[36:39], a[220:223], v[116:119]
    v_exp_f32 v19, v163
    v_mfma_f32_16x16x32_bf16 v[120:123], v[32:35], a[240:243], v[136:139]
    ds_read_b128 v[28:31], v3 offset:18560
    v_cvt_pk_bf16_f32 v160, v16, v17
    v_mfma_f32_16x16x32_bf16 v[120:123], v[36:39], a[244:247], v[120:123]
    buffer_load_dwordx3 v[248:250], v12, s[68:71], s16 offen offset:1536 nt
    v_mfma_f32_16x16x32_bf16 v[124:127], v[32:35], v[200:203], v[140:143]
    v_exp_f32 v16, v96
    v_mfma_f32_16x16x32_bf16 v[124:127], v[36:39], v[204:207], v[124:127]
    s_waitcnt lgkmcnt(2)
    v_add_f32 v5, v5, v18
    v_add_f32 v5, v5, v19
    v_mfma_f32_16x16x32_bf16 v[176:179], v[40:43], a[200:203], v[176:179]
    ds_read_b128 v[32:35], v2 offset:12544
    v_mul_f32_e64 v51, -v51, v49
    v_mfma_f32_16x16x32_bf16 v[176:179], v[44:47], a[204:207], v[176:179]
    buffer_load_dwordx4 v4, s[4:7], s27 offen offset:2048 sc1 lds
    v_mfma_f32_16x16x32_bf16 v[180:183], v[40:43], a[224:227], v[180:183]
    v_exp_f32 v17, v97
    v_mfma_f32_16x16x32_bf16 v[180:183], v[44:47], a[228:231], v[180:183]
    v_cvt_pk_bf16_f32 v161, v18, v19
    v_add_u32 v1, s3, v1
    v_mfma_f32_16x16x32_bf16 v[184:187], v[40:43], a[248:251], v[184:187]
    ds_read_b128 v[36:39], v3 offset:12544
    v_cvt_f32_i32 v144, v144
    v_mfma_f32_16x16x32_bf16 v[184:187], v[44:47], a[252:255], v[184:187]
    buffer_load_dwordx3 v[252:254], v12, s[68:71], s16 offen offset:2304 nt
    v_mfma_f32_16x16x32_bf16 v[188:191], v[40:43], v[208:211], v[188:191]
    v_exp_f32 v18, v98
    v_mfma_f32_16x16x32_bf16 v[188:191], v[44:47], v[212:215], v[188:191]
    s_waitcnt lgkmcnt(2)
    v_add_f32 v5, v5, v16
    v_add_f32 v5, v5, v17
    v_mfma_f32_16x16x32_bf16 v[112:115], v[24:27], a[200:203], v[112:115]
    ds_read_b128 v[40:43], v2 offset:18688
    v_cvt_f32_i32 v148, v148
    v_mfma_f32_16x16x32_bf16 v[112:115], v[28:31], a[204:207], v[112:115]
    v_exp_f32 v19, v99
    v_cvt_pk_bf16_f32 v162, v16, v17
    v_mfma_f32_16x16x32_bf16 v[116:119], v[24:27], a[224:227], v[116:119]
    v_exp_f32 v16, v164
    v_mfma_f32_16x16x32_bf16 v[116:119], v[28:31], a[228:231], v[116:119]
    s_add_u32 s27, s27, 24576
    v_add_f32 v5, v5, v18
    v_add_f32 v5, v5, v19
    v_mfma_f32_16x16x32_bf16 v[120:123], v[24:27], a[248:251], v[120:123]
    s_add_u32 s56, s56, 36864
    ds_read_b128 v[44:47], v3 offset:18688
    v_fma_f32 v144, v144, v48, v50
    v_mfma_f32_16x16x32_bf16 v[120:123], v[28:31], a[252:255], v[120:123]
    s_waitcnt lgkmcnt(2)
    v_exp_f32 v17, v165
    v_mfma_f32_16x16x32_bf16 v[124:127], v[24:27], v[208:211], v[124:127]
    s_waitcnt vmcnt(12)
    v_cvt_pk_bf16_f32 v163, v18, v19
    s_sub_u32 s58, s56, 147456
    v_mfma_f32_16x16x32_bf16 v[124:127], v[28:31], v[212:215], v[124:127]
    s_barrier
    s_min_u32 s56, s56, s58
    v_mfma_f32_16x16x32_bf16 v[176:179], v[32:35], a[208:211], v[176:179]
    ds_read_b128 v[24:27], v1 offset:0
    v_mfma_f32_16x16x32_bf16 v[176:179], v[36:39], a[212:215], v[176:179]
    v_exp_f32 v18, v166
    v_mfma_f32_16x16x32_bf16 v[180:183], v[32:35], a[232:235], v[180:183]
    v_add_f32 v6, v6, v16
    v_add_f32 v6, v6, v17
    v_mfma_f32_16x16x32_bf16 v[180:183], v[36:39], a[236:239], v[180:183]
    v_exp_f32 v19, v167
    v_mfma_f32_16x16x32_bf16 v[184:187], v[32:35], v[192:195], v[184:187]
    ds_read_b128 v[28:31], v1 offset:12288
    v_cvt_pk_bf16_f32 v164, v16, v17
    v_mfma_f32_16x16x32_bf16 v[184:187], v[36:39], v[196:199], v[184:187]
    v_exp_f32 v16, v100
    v_mfma_f32_16x16x32_bf16 v[188:191], v[32:35], v[216:219], v[188:191]
    v_add_f32 v6, v6, v18
    v_add_f32 v6, v6, v19
    v_mfma_f32_16x16x32_bf16 v[188:191], v[36:39], v[220:223], v[188:191]
    s_waitcnt lgkmcnt(2)
    v_exp_f32 v17, v101
    v_mfma_f32_16x16x32_bf16 v[112:115], v[40:43], a[208:211], v[112:115]
L_iw3:
L_pg3:
    s_cbranch_execz L_pg7
    ds_read_b128 v[32:35], v1 offset:1024
    v_cvt_pk_bf16_f32 v165, v18, v19
    v_mfma_f32_16x16x32_bf16 v[112:115], v[44:47], a[212:215], v[112:115]
    v_exp_f32 v18, v102
    v_mfma_f32_16x16x32_bf16 v[116:119], v[40:43], a[232:235], v[116:119]
    v_add_f32 v6, v6, v16
    v_add_f32 v6, v6, v17
    v_mfma_f32_16x16x32_bf16 v[116:119], v[44:47], a[236:239], v[116:119]
    v_exp_f32 v19, v103
    v_mfma_f32_16x16x32_bf16 v[120:123], v[40:43], v[192:195], v[120:123]
    ds_read_b128 v[36:39], v1 offset:13312
    v_cvt_pk_bf16_f32 v166, v16, v17
    v_mfma_f32_16x16x32_bf16 v[120:123], v[44:47], v[196:199], v[120:123]
    v_add_f32 v6, v6, v18
    v_fma_f32 v148, v148, v49, v51
    v_mfma_f32_16x16x32_bf16 v[124:127], v[40:43], v[216:219], v[124:127]
    v_add_f32 v6, v6, v19
    v_cvt_pk_bf16_f32 v167, v18, v19
    v_mfma_f32_16x16x32_bf16 v[124:127], v[44:47], v[220:223], v[124:127]
    s_waitcnt lgkmcnt(2)
    v_mfma_f32_16x16x32_bf16 a[0:3], v[64:67], v[24:27], a[0:3]
    ds_read_b128 v[40:43], v1 offset:2048
    v_cvt_f32_i32 v145, v145
    v_mfma_f32_16x16x32_bf16 a[0:3], v[80:83], v[28:31], a[0:3]
    buffer_store_dwordx4 v[224:227], v11, s[4:7], s33 offen offset:0 sc1
    v_mfma_f32_16x16x32_bf16 a[48:51], v[68:71], v[24:27], a[48:51]
    v_exp_f32 v16, v168
    v_mfma_f32_16x16x32_bf16 a[48:51], v[84:87], v[28:31], a[48:51]
    v_exp_f32 v17, v169
    v_mfma_f32_16x16x32_bf16 a[96:99], v[72:75], v[24:27], a[96:99]
    ds_read_b128 v[44:47], v1 offset:14336
    v_cvt_f32_i32 v149, v149
    v_mfma_f32_16x16x32_bf16 a[96:99], v[88:91], v[28:31], a[96:99]
    v_exp_f32 v18, v170
    v_mfma_f32_16x16x32_bf16 a[144:147], v[76:79], v[24:27], a[144:147]
    v_add_f32 v7, v7, v16
    v_add_f32 v7, v7, v17
    v_mfma_f32_16x16x32_bf16 a[144:147], v[92:95], v[28:31], a[144:147]
    s_waitcnt lgkmcnt(2)
    v_exp_f32 v19, v171
    v_mfma_f32_16x16x32_bf16 a[4:7], v[64:67], v[32:35], a[4:7]
    ds_read_b128 v[24:27], v1 offset:3072
    v_cvt_pk_bf16_f32 v168, v16, v17
    v_mfma_f32_16x16x32_bf16 a[4:7], v[80:83], v[36:39], a[4:7]
    buffer_store_dwordx4 v[228:231], v21, s[4:7], s33 offen offset:768 sc1
    v_mfma_f32_16x16x32_bf16 a[52:55], v[68:71], v[32:35], a[52:55]
    v_exp_f32 v16, v104
    v_mfma_f32_16x16x32_bf16 a[52:55], v[84:87], v[36:39], a[52:55]
    v_add_f32 v7, v7, v18
    v_fma_f32 v145, v145, v48, v50
    v_mfma_f32_16x16x32_bf16 a[100:103], v[72:75], v[32:35], a[100:103]
    ds_read_b128 v[28:31], v1 offset:15360
    v_add_f32 v7, v7, v19
    v_mfma_f32_16x16x32_bf16 a[100:103], v[88:91], v[36:39], a[100:103]
    v_exp_f32 v17, v105
    v_mfma_f32_16x16x32_bf16 a[148:151], v[76:79], v[32:35], a[148:151]
    v_cvt_pk_bf16_f32 v169, v18, v19
    v_fma_f32 v149, v149, v49, v51
    v_mfma_f32_16x16x32_bf16 a[148:151], v[92:95], v[36:39], a[148:151]
    s_waitcnt lgkmcnt(2)
    v_exp_f32 v18, v106
    v_mfma_f32_16x16x32_bf16 a[8:11], v[64:67], v[40:43], a[8:11]
    ds_read_b128 v[32:35], v1 offset:4096
    v_add_f32 v7, v7, v16
    v_mfma_f32_16x16x32_bf16 a[8:11], v[80:83], v[44:47], a[8:11]
    buffer_store_dwordx4 v[232:235], v22, s[4:7], s33 offen offset:1536 sc1
    v_mfma_f32_16x16x32_bf16 a[56:59], v[68:71], v[40:43], a[56:59]
    v_add_f32 v7, v7, v17
    v_cvt_f32_i32 v146, v146
    v_mfma_f32_16x16x32_bf16 a[56:59], v[84:87], v[44:47], a[56:59]
    v_exp_f32 v19, v107
    v_mfma_f32_16x16x32_bf16 a[104:107], v[72:75], v[40:43], a[104:107]
    ds_read_b128 v[36:39], v1 offset:16384
    v_cvt_pk_bf16_f32 v170, v16, v17
    v_mfma_f32_16x16x32_bf16 a[104:107], v[88:91], v[44:47], a[104:107]
    v_exp_f32 v16, v172
    v_mfma_f32_16x16x32_bf16 a[152:155], v[76:79], v[40:43], a[152:155]
    v_add_f32 v7, v7, v18
    v_cvt_f32_i32 v150, v150
    v_mfma_f32_16x16x32_bf16 a[152:155], v[92:95], v[44:47], a[152:155]
    s_waitcnt lgkmcnt(2)
    v_add_f32 v7, v7, v19
    v_fma_f32 v146, v146, v48, v50
    v_mfma_f32_16x16x32_bf16 a[12:15], v[64:67], v[24:27], a[12:15]
    ds_read_b128 v[40:43], v1 offset:5120
    v_mfma_f32_16x16x32_bf16 a[12:15], v[80:83], v[28:31], a[12:15]
    buffer_store_dwordx4 v[236:239], v23, s[4:7], s33 offen offset:2304 sc1
    v_mfma_f32_16x16x32_bf16 a[60:63], v[68:71], v[24:27], a[60:63]
    v_exp_f32 v17, v173
    v_mfma_f32_16x16x32_bf16 a[60:63], v[84:87], v[28:31], a[60:63]
    v_cvt_pk_bf16_f32 v171, v18, v19
    v_fma_f32 v150, v150, v49, v51
    v_mfma_f32_16x16x32_bf16 a[108:111], v[72:75], v[24:27], a[108:111]
    ds_read_b128 v[44:47], v1 offset:17408
    v_mfma_f32_16x16x32_bf16 a[108:111], v[88:91], v[28:31], a[108:111]
    v_exp_f32 v18, v174
    v_mfma_f32_16x16x32_bf16 a[156:159], v[76:79], v[24:27], a[156:159]
    s_add_u32 s29, s28, 49152
    v_add_f32 v8, v8, v16
    v_add_f32 v8, v8, v17
    v_mfma_f32_16x16x32_bf16 a[156:159], v[92:95], v[28:31], a[156:159]
    s_waitcnt lgkmcnt(2)
    v_exp_f32 v19, v175
    v_mfma_f32_16x16x32_bf16 a[16:19], v[64:67], v[32:35], a[16:19]
    s_sub_u32 s3, s29, 147456
    ds_read_b128 v[24:27], v1 offset:6144
    v_cvt_pk_bf16_f32 v172, v16, v17
    v_mfma_f32_16x16x32_bf16 a[16:19], v[80:83], v[36:39], a[16:19]
    s_mov_b32 m0, s26
    v_exp_f32 v16, v108
    v_mfma_f32_16x16x32_bf16 a[64:67], v[68:71], v[32:35], a[64:67]
    s_min_u32 s29, s29, s3
    v_add_f32 v8, v8, v18
    v_lshlrev_b32 v48, 16, v57
    v_mfma_f32_16x16x32_bf16 a[64:67], v[84:87], v[36:39], a[64:67]
    buffer_load_dwordx4 v4, s[4:7], s32 offen offset:0 sc1 lds
    v_mfma_f32_16x16x32_bf16 a[112:115], v[72:75], v[32:35], a[112:115]
    ds_read_b128 v[28:31], v1 offset:18432
    v_add_f32 v8, v8, v19
    v_mfma_f32_16x16x32_bf16 a[112:115], v[88:91], v[36:39], a[112:115]
    v_exp_f32 v17, v109
    v_mfma_f32_16x16x32_bf16 a[160:163], v[76:79], v[32:35], a[160:163]
    v_cvt_pk_bf16_f32 v173, v18, v19
    v_and_b32 v49, s97, v57
    v_mfma_f32_16x16x32_bf16 a[160:163], v[92:95], v[36:39], a[160:163]
    s_waitcnt lgkmcnt(2)
    buffer_load_dwordx4 v4, s[4:7], s32 offen offset:1024 sc1 lds
    v_mfma_f32_16x16x32_bf16 a[20:23], v[64:67], v[40:43], a[20:23]
    s_sub_u32 s3, s29, s28
    ds_read_b128 v[32:35], v1 offset:7168
    v_lshlrev_b32 v50, 16, v59
    v_mfma_f32_16x16x32_bf16 a[20:23], v[80:83], v[44:47], a[20:23]
    v_exp_f32 v18, v110
    v_mfma_f32_16x16x32_bf16 a[68:71], v[68:71], v[40:43], a[68:71]
    v_add_f32 v8, v8, v16
    v_add_f32 v8, v8, v17
    v_mfma_f32_16x16x32_bf16 a[68:71], v[84:87], v[44:47], a[68:71]
    buffer_load_dwordx4 v4, s[4:7], s32 offen offset:2048 sc1 lds
    v_mfma_f32_16x16x32_bf16 a[116:119], v[72:75], v[40:43], a[116:119]
    ds_read_b128 v[36:39], v1 offset:19456
    v_mfma_f32_16x16x32_bf16 a[116:119], v[88:91], v[44:47], a[116:119]
    v_exp_f32 v19, v111
    v_mfma_f32_16x16x32_bf16 a[164:167], v[76:79], v[40:43], a[164:167]
    s_mov_b32 s28, s29
    v_cvt_pk_bf16_f32 v174, v16, v17
    v_add_f32 v8, v8, v18
    v_mfma_f32_16x16x32_bf16 a[164:167], v[92:95], v[44:47], a[164:167]
    s_waitcnt lgkmcnt(2)
    v_add_f32 v8, v8, v19
    v_cvt_pk_bf16_f32 v175, v18, v19
    v_mfma_f32_16x16x32_bf16 a[24:27], v[64:67], v[24:27], a[24:27]
    s_add_u32 s32, s32, 24576
    ds_read_b128 v[40:43], v1 offset:8192
    v_and_b32 v51, s97, v59
    v_mfma_f32_16x16x32_bf16 a[24:27], v[80:83], v[28:31], a[24:27]
    v_exp_f32 v16, v176
    v_mfma_f32_16x16x32_bf16 a[72:75], v[68:71], v[24:27], a[72:75]
    s_add_u32 s26, s26, 12288
    v_exp_f32 v17, v177
    v_mfma_f32_16x16x32_bf16 a[72:75], v[84:87], v[28:31], a[72:75]
    v_exp_f32 v18, v178
    v_mfma_f32_16x16x32_bf16 a[120:123], v[72:75], v[24:27], a[120:123]
    s_mov_b32 m0, s26
    ds_read_b128 v[44:47], v1 offset:20480
    v_add_f32 v5, v5, v16
    v_mfma_f32_16x16x32_bf16 a[120:123], v[88:91], v[28:31], a[120:123]
    v_add_f32 v5, v5, v17
    v_mul_f32_e64 v50, -v50, v48
    v_mfma_f32_16x16x32_bf16 a[168:171], v[76:79], v[24:27], a[168:171]
    v_exp_f32 v19, v179
    v_mfma_f32_16x16x32_bf16 a[168:171], v[92:95], v[28:31], a[168:171]
    s_waitcnt lgkmcnt(2)
    v_cvt_pk_bf16_f32 v176, v16, v17
    v_mul_f32_e64 v51, -v51, v49
    v_mfma_f32_16x16x32_bf16 a[28:31], v[64:67], v[32:35], a[28:31]
    ds_read_b128 v[24:27], v1 offset:9216
    v_add_u32 v2, s3, v2
    v_mfma_f32_16x16x32_bf16 a[28:31], v[80:83], v[36:39], a[28:31]
    buffer_load_dwordx4 v4, s[4:7], s32 offen offset:0 sc1 lds
    v_mfma_f32_16x16x32_bf16 a[76:79], v[68:71], v[32:35], a[76:79]
    v_exp_f32 v16, v112
    v_mfma_f32_16x16x32_bf16 a[76:79], v[84:87], v[36:39], a[76:79]
    v_add_f32 v5, v5, v18
    v_add_f32 v5, v5, v19
    v_mfma_f32_16x16x32_bf16 a[124:127], v[72:75], v[32:35], a[124:127]
    ds_read_b128 v[28:31], v1 offset:21504
    v_cvt_f32_i32 v152, v152
    v_mfma_f32_16x16x32_bf16 a[124:127], v[88:91], v[36:39], a[124:127]
    buffer_load_dwordx4 v4, s[4:7], s32 offen offset:1024 sc1 lds
    v_mfma_f32_16x16x32_bf16 a[172:175], v[76:79], v[32:35], a[172:175]
    v_exp_f32 v17, v113
    v_mfma_f32_16x16x32_bf16 a[172:175], v[92:95], v[36:39], a[172:175]
    s_waitcnt lgkmcnt(2)
    v_cvt_pk_bf16_f32 v177, v18, v19
    v_add_u32 v3, s3, v3
    v_mfma_f32_16x16x32_bf16 a[32:35], v[64:67], v[40:43], a[32:35]
    ds_read_b128 v[32:35], v1 offset:10240
    v_cvt_f32_i32 v156, v156
    v_mfma_f32_16x16x32_bf16 a[32:35], v[80:83], v[44:47], a[32:35]
    v_exp_f32 v18, v114
    v_mfma_f32_16x16x32_bf16 a[80:83], v[68:71], v[40:43], a[80:83]
    v_add_f32 v5, v5, v16
    v_add_f32 v5, v5, v17
    v_mfma_f32_16x16x32_bf16 a[80:83], v[84:87], v[44:47], a[80:83]
    buffer_load_dwordx4 v4, s[4:7], s32 offen offset:2048 sc1 lds
    v_mfma_f32_16x16x32_bf16 a[128:131], v[72:75], v[40:43], a[128:131]
    ds_read_b128 v[36:39], v1 offset:22528
    v_mfma_f32_16x16x32_bf16 a[128:131], v[88:91], v[44:47], a[128:131]
    v_exp_f32 v19, v115
    v_mfma_f32_16x16x32_bf16 a[176:179], v[76:79], v[40:43], a[176:179]
    v_cvt_pk_bf16_f32 v178, v16, v17
    v_fma_f32 v152, v152, v48, v50
    v_mfma_f32_16x16x32_bf16 a[176:179], v[92:95], v[44:47], a[176:179]
    s_waitcnt lgkmcnt(2)
    v_exp_f32 v16, v180
    v_mfma_f32_16x16x32_bf16 a[36:39], v[64:67], v[24:27], a[36:39]
    ds_read_b128 v[40:43], v1 offset:11264
    v_add_f32 v5, v5, v18
    v_mfma_f32_16x16x32_bf16 a[36:39], v[80:83], v[28:31], a[36:39]
    v_add_f32 v5, v5, v19
    v_mfma_f32_16x16x32_bf16 a[84:87], v[68:71], v[24:27], a[84:87]
    v_exp_f32 v17, v181
    v_mfma_f32_16x16x32_bf16 a[84:87], v[84:87], v[28:31], a[84:87]
    s_add_u32 s32, s32, 24576
    v_cvt_pk_bf16_f32 v179, v18, v19
    s_add_u32 s26, s26, 36864
    v_mfma_f32_16x16x32_bf16 a[132:135], v[72:75], v[24:27], a[132:135]
    s_sub_u32 s57, s26, 147456
    ds_read_b128 v[44:47], v1 offset:23552
    v_fma_f32 v156, v156, v49, v51
    v_mfma_f32_16x16x32_bf16 a[132:135], v[88:91], v[28:31], a[132:135]
    s_waitcnt lgkmcnt(2)
    v_exp_f32 v18, v182
    v_mfma_f32_16x16x32_bf16 a[180:183], v[76:79], v[24:27], a[180:183]
    s_waitcnt vmcnt(6)
    v_add_f32 v6, v6, v16
    v_add_f32 v6, v6, v17
    v_mfma_f32_16x16x32_bf16 a[180:183], v[92:95], v[28:31], a[180:183]
    s_barrier
    v_cvt_f32_i32 v153, v153
    v_mfma_f32_16x16x32_bf16 a[40:43], v[64:67], v[32:35], a[40:43]
    s_min_u32 s26, s26, s57
    ds_read_b128 v[24:27], v2 offset:0
    v_add_u32 v0, 1, v0
    v_mfma_f32_16x16x32_bf16 a[40:43], v[80:83], v[36:39], a[40:43]
    buffer_store_dword v0, v13, s[20:23], 0 offen offset:32 sc1
    v_mfma_f32_16x16x32_bf16 a[88:91], v[68:71], v[32:35], a[88:91]
    v_exp_f32 v19, v183
    v_mfma_f32_16x16x32_bf16 a[88:91], v[84:87], v[36:39], a[88:91]
    v_cvt_pk_bf16_f32 v180, v16, v17
    v_cvt_f32_i32 v157, v157
    v_mfma_f32_16x16x32_bf16 a[136:139], v[72:75], v[32:35], a[136:139]
    ds_read_b128 v[28:31], v3 offset:0
    v_mfma_f32_16x16x32_bf16 a[136:139], v[88:91], v[36:39], a[136:139]
    v_exp_f32 v16, v116
    v_mfma_f32_16x16x32_bf16 a[184:187], v[76:79], v[32:35], a[184:187]
    v_add_f32 v6, v6, v18
    v_add_f32 v6, v6, v19
    v_mfma_f32_16x16x32_bf16 a[184:187], v[92:95], v[36:39], a[184:187]
    s_waitcnt lgkmcnt(2)
    v_exp_f32 v17, v117
    v_mfma_f32_16x16x32_bf16 a[44:47], v[64:67], v[40:43], a[44:47]
    ds_read_b128 v[32:35], v2 offset:6144
    v_cvt_pk_bf16_f32 v181, v18, v19
    v_mfma_f32_16x16x32_bf16 a[44:47], v[80:83], v[44:47], a[44:47]
    v_exp_f32 v18, v118
    v_mfma_f32_16x16x32_bf16 a[92:95], v[68:71], v[40:43], a[92:95]
    v_add_f32 v6, v6, v16
    v_add_f32 v6, v6, v17
    v_mfma_f32_16x16x32_bf16 a[92:95], v[84:87], v[44:47], a[92:95]
    v_exp_f32 v19, v119
    v_mfma_f32_16x16x32_bf16 a[140:143], v[72:75], v[40:43], a[140:143]
    ds_read_b128 v[36:39], v3 offset:6144
    v_cvt_pk_bf16_f32 v182, v16, v17
    v_mfma_f32_16x16x32_bf16 a[140:143], v[88:91], v[44:47], a[140:143]
    v_add_f32 v6, v6, v18
    v_add_f32 v6, v6, v19
    v_mfma_f32_16x16x32_bf16 a[188:191], v[76:79], v[40:43], a[188:191]
    v_cvt_pk_bf16_f32 v183, v18, v19
    v_mfma_f32_16x16x32_bf16 a[188:191], v[92:95], v[44:47], a[188:191]
    s_waitcnt lgkmcnt(2)
    v_mfma_f32_16x16x32_bf16 v[64:67], v[24:27], a[192:195], v[128:131]
    s_add_u32 s33, s33, 196608
    ds_read_b128 v[40:43], v2 offset:128
    v_fma_f32 v153, v153, v48, v50
    v_mfma_f32_16x16x32_bf16 v[64:67], v[28:31], a[196:199], v[64:67]
    s_mov_b32 m0, s56
    v_exp_f32 v16, v184
    v_mfma_f32_16x16x32_bf16 v[68:71], v[24:27], a[216:219], v[132:135]
    s_add_u32 s34, s34, 196608
    v_exp_f32 v17, v185
    v_mfma_f32_16x16x32_bf16 v[68:71], v[28:31], a[220:223], v[68:71]
    s_add_u32 s36, s36, 1536
    buffer_load_dwordx4 v4, s[4:7], s27 offen offset:0 sc1 lds
    v_mfma_f32_16x16x32_bf16 v[72:75], v[24:27], a[240:243], v[136:139]
    ds_read_b128 v[44:47], v3 offset:128
    v_fma_f32 v157, v157, v49, v51
    v_mfma_f32_16x16x32_bf16 v[72:75], v[28:31], a[244:247], v[72:75]
    v_exp_f32 v18, v186
    v_mfma_f32_16x16x32_bf16 v[76:79], v[24:27], v[200:203], v[140:143]
    v_add_f32 v7, v7, v16
    v_add_f32 v7, v7, v17
    v_mfma_f32_16x16x32_bf16 v[76:79], v[28:31], v[204:207], v[76:79]
    s_waitcnt lgkmcnt(2)
    buffer_load_dwordx2 v[56:57], v10, s[72:75], s36 offen offset:0
    v_mfma_f32_16x16x32_bf16 v[96:99], v[32:35], a[192:195], v[128:131]
    ds_read_b128 v[24:27], v2 offset:6272
    v_cvt_f32_i32 v154, v154
    v_mfma_f32_16x16x32_bf16 v[96:99], v[36:39], a[196:199], v[96:99]
    v_exp_f32 v19, v187
    v_mfma_f32_16x16x32_bf16 v[100:103], v[32:35], a[216:219], v[132:135]
    v_cvt_pk_bf16_f32 v184, v16, v17
    v_cvt_f32_i32 v158, v158
    v_mfma_f32_16x16x32_bf16 v[100:103], v[36:39], a[220:223], v[100:103]
    buffer_load_dwordx4 v4, s[4:7], s27 offen offset:1024 sc1 lds
    v_mfma_f32_16x16x32_bf16 v[104:107], v[32:35], a[240:243], v[136:139]
    ds_read_b128 v[28:31], v3 offset:6272
    v_fma_f32 v154, v154, v48, v50
    v_mfma_f32_16x16x32_bf16 v[104:107], v[36:39], a[244:247], v[104:107]
    v_exp_f32 v16, v120
    v_mfma_f32_16x16x32_bf16 v[108:111], v[32:35], v[200:203], v[140:143]
    v_add_f32 v7, v7, v18
    v_add_f32 v7, v7, v19
    v_mfma_f32_16x16x32_bf16 v[108:111], v[36:39], v[204:207], v[108:111]
    s_waitcnt lgkmcnt(2)
    buffer_load_dwordx2 v[58:59], v10, s[76:79], s36 offen offset:0
    v_mfma_f32_16x16x32_bf16 v[64:67], v[40:43], a[200:203], v[64:67]
    ds_read_b128 v[32:35], v2 offset:256
    v_fma_f32 v158, v158, v49, v51
    v_mfma_f32_16x16x32_bf16 v[64:67], v[44:47], a[204:207], v[64:67]
    v_exp_f32 v17, v121
    v_mfma_f32_16x16x32_bf16 v[68:71], v[40:43], a[224:227], v[68:71]
    v_cvt_pk_bf16_f32 v185, v18, v19
    v_mfma_f32_16x16x32_bf16 v[68:71], v[44:47], a[228:231], v[68:71]
    buffer_load_dwordx4 v[224:227], v9, s[64:67], s33 offen offset:0 nt
    v_mfma_f32_16x16x32_bf16 v[72:75], v[40:43], a[248:251], v[72:75]
    ds_read_b128 v[36:39], v3 offset:256
    v_cvt_pk_bf16_f32 v144, v144, v148
    v_mfma_f32_16x16x32_bf16 v[72:75], v[44:47], a[252:255], v[72:75]
    v_exp_f32 v18, v122
    v_mfma_f32_16x16x32_bf16 v[76:79], v[40:43], v[208:211], v[76:79]
    v_add_f32 v7, v7, v16
    v_add_f32 v7, v7, v17
    v_mfma_f32_16x16x32_bf16 v[76:79], v[44:47], v[212:215], v[76:79]
    s_waitcnt lgkmcnt(2)
    buffer_load_dwordx4 v4, s[4:7], s27 offen offset:2048 sc1 lds
    v_mfma_f32_16x16x32_bf16 v[96:99], v[24:27], a[200:203], v[96:99]
    ds_read_b128 v[40:43], v2 offset:6400
    v_cvt_pk_bf16_f32 v148, v145, v149
    v_mfma_f32_16x16x32_bf16 v[96:99], v[28:31], a[204:207], v[96:99]
    v_exp_f32 v19, v123
    v_cvt_pk_bf16_f32 v186, v16, v17
    v_mfma_f32_16x16x32_bf16 v[100:103], v[24:27], a[224:227], v[100:103]
    v_exp_f32 v16, v188
    v_mfma_f32_16x16x32_bf16 v[100:103], v[28:31], a[228:231], v[100:103]
    buffer_load_dwordx4 v[228:231], v9, s[64:67], s33 offen offset:1536 nt
    v_mfma_f32_16x16x32_bf16 v[104:107], v[24:27], a[248:251], v[104:107]
    ds_read_b128 v[44:47], v3 offset:6400
    v_add_f32 v7, v7, v18
    v_mfma_f32_16x16x32_bf16 v[104:107], v[28:31], a[252:255], v[104:107]
    v_add_f32 v7, v7, v19
    v_cvt_pk_bf16_f32 v145, v152, v156
    v_mfma_f32_16x16x32_bf16 v[108:111], v[24:27], v[208:211], v[108:111]
    s_add_u32 s29, s30, 49152
    v_exp_f32 v17, v189
    v_mfma_f32_16x16x32_bf16 v[108:111], v[28:31], v[212:215], v[108:111]
    s_waitcnt lgkmcnt(2)
    buffer_load_dwordx4 v[232:235], v9, s[64:67], s34 offen offset:0 nt
    v_cvt_pk_bf16_f32 v187, v18, v19
    v_mfma_f32_16x16x32_bf16 v[64:67], v[32:35], a[208:211], v[64:67]
    s_sub_u32 s3, s29, 147456
    ds_read_b128 v[24:27], v2 offset:12288
    s_add_u32 s27, s27, 24576
    v_mfma_f32_16x16x32_bf16 v[64:67], v[36:39], a[212:215], v[64:67]
    s_min_u32 s29, s29, s3
    v_exp_f32 v18, v190
    v_mfma_f32_16x16x32_bf16 v[68:71], v[32:35], a[232:235], v[68:71]
    v_add_f32 v8, v8, v16
    v_add_f32 v8, v8, v17
    v_mfma_f32_16x16x32_bf16 v[68:71], v[36:39], a[236:239], v[68:71]
    buffer_load_dwordx4 v[236:239], v9, s[64:67], s34 offen offset:1536 nt
    v_mfma_f32_16x16x32_bf16 v[72:75], v[32:35], v[192:195], v[72:75]
    s_add_u32 s56, s56, 12288
    ds_read_b128 v[28:31], v3 offset:12288
    v_cvt_pk_bf16_f32 v149, v153, v157
    v_mfma_f32_16x16x32_bf16 v[72:75], v[36:39], v[196:199], v[72:75]
    v_exp_f32 v19, v191
    v_cvt_pk_bf16_f32 v188, v16, v17
    v_mfma_f32_16x16x32_bf16 v[76:79], v[32:35], v[216:219], v[76:79]
    v_exp_f32 v16, v124
    v_mfma_f32_16x16x32_bf16 v[76:79], v[36:39], v[220:223], v[76:79]
    s_waitcnt lgkmcnt(2)
    v_add_f32 v8, v8, v18
    v_add_f32 v8, v8, v19
    v_mfma_f32_16x16x32_bf16 v[96:99], v[40:43], a[208:211], v[96:99]
    ds_read_b128 v[32:35], v2 offset:18432
    v_cvt_pk_bf16_f32 v152, v146, v150
    v_mfma_f32_16x16x32_bf16 v[96:99], v[44:47], a[212:215], v[96:99]
    s_sub_u32 s3, s29, s30
    v_exp_f32 v17, v125
    v_mfma_f32_16x16x32_bf16 v[100:103], v[40:43], a[232:235], v[100:103]
    s_mov_b32 m0, s56
    v_cvt_pk_bf16_f32 v189, v18, v19
    v_cvt_pk_bf16_f32 v153, v154, v158
    v_mfma_f32_16x16x32_bf16 v[100:103], v[44:47], a[236:239], v[100:103]
    v_exp_f32 v18, v126
    v_mfma_f32_16x16x32_bf16 v[104:107], v[40:43], v[192:195], v[104:107]
    ds_read_b128 v[36:39], v3 offset:18432
    v_add_f32 v8, v8, v16
    v_mfma_f32_16x16x32_bf16 v[104:107], v[44:47], v[196:199], v[104:107]
    v_add_f32 v8, v8, v17
    v_mfma_f32_16x16x32_bf16 v[108:111], v[40:43], v[216:219], v[108:111]
    v_exp_f32 v19, v127
    v_mfma_f32_16x16x32_bf16 v[108:111], v[44:47], v[220:223], v[108:111]
    s_waitcnt lgkmcnt(2)
    v_cvt_pk_bf16_f32 v190, v16, v17
    v_add_f32 v8, v8, v18
    v_mfma_f32_16x16x32_bf16 v[80:83], v[24:27], a[192:195], v[128:131]
    ds_read_b128 v[40:43], v2 offset:12416
    v_add_f32 v8, v8, v19
    v_mfma_f32_16x16x32_bf16 v[80:83], v[28:31], a[196:199], v[80:83]
    s_mov_b32 s30, s29
    v_cvt_pk_bf16_f32 v191, v18, v19
    v_mfma_f32_16x16x32_bf16 v[84:87], v[24:27], a[216:219], v[132:135]
    v_exp_f32 v16, v64
    v_mfma_f32_16x16x32_bf16 v[84:87], v[28:31], a[220:223], v[84:87]
    s_waitcnt vmcnt(20)
    buffer_load_dwordx4 v4, s[4:7], s27 offen offset:0 sc1 lds
    v_mfma_f32_16x16x32_bf16 v[88:91], v[24:27], a[240:243], v[136:139]
    ds_read_b128 v[44:47], v3 offset:12416
    v_lshlrev_b32 v48, 16, v60
    v_mfma_f32_16x16x32_bf16 v[88:91], v[28:31], a[244:247], v[88:91]
    v_exp_f32 v17, v65
    v_mfma_f32_16x16x32_bf16 v[92:95], v[24:27], v[200:203], v[140:143]
    v_exp_f32 v18, v66
    v_mfma_f32_16x16x32_bf16 v[92:95], v[28:31], v[204:207], v[92:95]
    s_waitcnt lgkmcnt(2)
    v_add_f32 v5, v5, v16
    v_add_f32 v5, v5, v17
    v_mfma_f32_16x16x32_bf16 v[112:115], v[32:35], a[192:195], v[128:131]
    ds_read_b128 v[24:27], v2 offset:18560
    v_and_b32 v49, s97, v60
    v_mfma_f32_16x16x32_bf16 v[112:115], v[36:39], a[196:199], v[112:115]
    v_exp_f32 v19, v67
    v_mfma_f32_16x16x32_bf16 v[116:119], v[32:35], a[216:219], v[132:135]
    v_cvt_pk_bf16_f32 v64, v16, v17
    v_lshlrev_b32 v50, 16, v62
    v_mfma_f32_16x16x32_bf16 v[116:119], v[36:39], a[220:223], v[116:119]
    v_exp_f32 v16, v96
    v_mfma_f32_16x16x32_bf16 v[120:123], v[32:35], a[240:243], v[136:139]
    ds_read_b128 v[28:31], v3 offset:18560
    v_add_f32 v5, v5, v18
    v_mfma_f32_16x16x32_bf16 v[120:123], v[36:39], a[244:247], v[120:123]
    v_add_f32 v5, v5, v19
    v_and_b32 v51, s97, v62
    v_mfma_f32_16x16x32_bf16 v[124:127], v[32:35], v[200:203], v[140:143]
    v_exp_f32 v17, v97
    v_mfma_f32_16x16x32_bf16 v[124:127], v[36:39], v[204:207], v[124:127]
    s_waitcnt lgkmcnt(2)
    buffer_load_dwordx4 v4, s[4:7], s27 offen offset:1024 sc1 lds
    v_mfma_f32_16x16x32_bf16 v[80:83], v[40:43], a[200:203], v[80:83]
    ds_read_b128 v[32:35], v2 offset:12544
    v_cvt_pk_bf16_f32 v65, v18, v19
    v_mfma_f32_16x16x32_bf16 v[80:83], v[44:47], a[204:207], v[80:83]
    v_exp_f32 v18, v98
    v_mfma_f32_16x16x32_bf16 v[84:87], v[40:43], a[224:227], v[84:87]
    v_add_f32 v5, v5, v16
    v_add_f32 v5, v5, v17
    v_mfma_f32_16x16x32_bf16 v[84:87], v[44:47], a[228:231], v[84:87]
    v_exp_f32 v19, v99
    v_mfma_f32_16x16x32_bf16 v[88:91], v[40:43], a[248:251], v[88:91]
    ds_read_b128 v[36:39], v3 offset:12544
    v_cvt_pk_bf16_f32 v66, v16, v17
    v_mfma_f32_16x16x32_bf16 v[88:91], v[44:47], a[252:255], v[88:91]
    v_exp_f32 v16, v68
    v_mfma_f32_16x16x32_bf16 v[92:95], v[40:43], v[208:211], v[92:95]
    v_add_u32 v1, s3, v1
    v_mul_f32_e64 v50, -v50, v48
    v_mfma_f32_16x16x32_bf16 v[92:95], v[44:47], v[212:215], v[92:95]
    s_waitcnt lgkmcnt(2)
    v_add_f32 v5, v5, v18
    v_add_f32 v5, v5, v19
    v_mfma_f32_16x16x32_bf16 v[112:115], v[24:27], a[200:203], v[112:115]
    ds_read_b128 v[40:43], v2 offset:18688
    v_mul_f32_e64 v51, -v51, v49
    v_mfma_f32_16x16x32_bf16 v[112:115], v[28:31], a[204:207], v[112:115]
    buffer_load_dwordx4 v4, s[4:7], s27 offen offset:2048 sc1 lds
    v_mfma_f32_16x16x32_bf16 v[116:119], v[24:27], a[224:227], v[116:119]
    v_exp_f32 v17, v69
    v_mfma_f32_16x16x32_bf16 v[116:119], v[28:31], a[228:231], v[116:119]
    v_cvt_pk_bf16_f32 v67, v18, v19
    v_cvt_f32_i32 v240, v240
    v_mfma_f32_16x16x32_bf16 v[120:123], v[24:27], a[248:251], v[120:123]
    ds_read_b128 v[44:47], v3 offset:18688
    v_mfma_f32_16x16x32_bf16 v[120:123], v[28:31], a[252:255], v[120:123]
    s_waitcnt lgkmcnt(2)
    v_exp_f32 v18, v70
    v_mfma_f32_16x16x32_bf16 v[124:127], v[24:27], v[208:211], v[124:127]
    s_waitcnt vmcnt(13)
    v_add_f32 v6, v6, v16
    v_add_f32 v6, v6, v17
    v_mfma_f32_16x16x32_bf16 v[124:127], v[28:31], v[212:215], v[124:127]
    s_barrier
    v_cvt_f32_i32 v244, v244
    v_mfma_f32_16x16x32_bf16 v[80:83], v[32:35], a[208:211], v[80:83]
    ds_read_b128 v[24:27], v1 offset:0
    v_mfma_f32_16x16x32_bf16 v[80:83], v[36:39], a[212:215], v[80:83]
    v_exp_f32 v19, v71
    v_mfma_f32_16x16x32_bf16 v[84:87], v[32:35], a[232:235], v[84:87]
    v_cvt_pk_bf16_f32 v68, v16, v17
    v_fma_f32 v240, v240, v48, v50
    v_mfma_f32_16x16x32_bf16 v[84:87], v[36:39], a[236:239], v[84:87]
    v_exp_f32 v16, v100
    v_mfma_f32_16x16x32_bf16 v[88:91], v[32:35], v[192:195], v[88:91]
    ds_read_b128 v[28:31], v1 offset:12288
    v_add_f32 v6, v6, v18
    v_mfma_f32_16x16x32_bf16 v[88:91], v[36:39], v[196:199], v[88:91]
    v_add_f32 v6, v6, v19
    v_fma_f32 v244, v244, v49, v51
    v_mfma_f32_16x16x32_bf16 v[92:95], v[32:35], v[216:219], v[92:95]
    v_exp_f32 v17, v101
    v_mfma_f32_16x16x32_bf16 v[92:95], v[36:39], v[220:223], v[92:95]
    s_waitcnt lgkmcnt(2)
    v_cvt_pk_bf16_f32 v69, v18, v19
    v_mfma_f32_16x16x32_bf16 v[112:115], v[40:43], a[208:211], v[112:115]
    ds_read_b128 v[32:35], v1 offset:1024
    v_mfma_f32_16x16x32_bf16 v[112:115], v[44:47], a[212:215], v[112:115]
    v_exp_f32 v18, v102
    v_mfma_f32_16x16x32_bf16 v[116:119], v[40:43], a[232:235], v[116:119]
    v_add_f32 v6, v6, v16
    v_add_f32 v6, v6, v17
    v_mfma_f32_16x16x32_bf16 v[116:119], v[44:47], a[236:239], v[116:119]
    s_add_u32 s27, s27, 24576
    v_exp_f32 v19, v103
    v_mfma_f32_16x16x32_bf16 v[120:123], v[40:43], v[192:195], v[120:123]
    s_add_u32 s56, s56, 36864
    ds_read_b128 v[36:39], v1 offset:13312
    v_cvt_pk_bf16_f32 v70, v16, v17
    v_mfma_f32_16x16x32_bf16 v[120:123], v[44:47], v[196:199], v[120:123]
    s_sub_u32 s58, s56, 147456
    v_add_f32 v6, v6, v18
    v_add_f32 v6, v6, v19
    v_mfma_f32_16x16x32_bf16 v[124:127], v[40:43], v[216:219], v[124:127]
    s_min_u32 s56, s56, s58
    v_cvt_pk_bf16_f32 v71, v18, v19
    v_mfma_f32_16x16x32_bf16 v[124:127], v[44:47], v[220:223], v[124:127]
    s_waitcnt lgkmcnt(2)
    v_mfma_f32_16x16x32_bf16 a[0:3], v[160:163], v[24:27], a[0:3]
    s_mov_b32 m0, s56
    ds_read_b128 v[40:43], v1 offset:2048
    v_cvt_f32_i32 v241, v241
    v_mfma_f32_16x16x32_bf16 a[0:3], v[176:179], v[28:31], a[0:3]
    buffer_load_dwordx4 v4, s[4:7], s27 offen offset:0 sc1 lds
    v_mfma_f32_16x16x32_bf16 a[48:51], v[164:167], v[24:27], a[48:51]
    v_exp_f32 v16, v72
    v_mfma_f32_16x16x32_bf16 a[48:51], v[180:183], v[28:31], a[48:51]
    v_exp_f32 v17, v73
    v_mfma_f32_16x16x32_bf16 a[96:99], v[168:171], v[24:27], a[96:99]
    ds_read_b128 v[44:47], v1 offset:14336
    v_cvt_f32_i32 v245, v245
    v_mfma_f32_16x16x32_bf16 a[96:99], v[184:187], v[28:31], a[96:99]
    v_exp_f32 v18, v74
    v_mfma_f32_16x16x32_bf16 a[144:147], v[172:175], v[24:27], a[144:147]
    v_add_f32 v7, v7, v16
    v_add_f32 v7, v7, v17
    v_mfma_f32_16x16x32_bf16 a[144:147], v[188:191], v[28:31], a[144:147]
    s_waitcnt lgkmcnt(2)
    v_exp_f32 v19, v75
    v_mfma_f32_16x16x32_bf16 a[4:7], v[160:163], v[32:35], a[4:7]
    ds_read_b128 v[24:27], v1 offset:3072
    v_fma_f32 v241, v241, v48, v50
    v_mfma_f32_16x16x32_bf16 a[4:7], v[176:179], v[36:39], a[4:7]
    buffer_load_dwordx4 v4, s[4:7], s27 offen offset:1024 sc1 lds
    v_mfma_f32_16x16x32_bf16 a[52:55], v[164:167], v[32:35], a[52:55]
    v_cvt_pk_bf16_f32 v72, v16, v17
    v_fma_f32 v245, v245, v49, v51
    v_mfma_f32_16x16x32_bf16 a[52:55], v[180:183], v[36:39], a[52:55]
    v_exp_f32 v16, v104
    v_mfma_f32_16x16x32_bf16 a[100:103], v[168:171], v[32:35], a[100:103]
    ds_read_b128 v[28:31], v1 offset:15360
    v_add_f32 v7, v7, v18
    v_mfma_f32_16x16x32_bf16 a[100:103], v[184:187], v[36:39], a[100:103]
    buffer_load_dword v52, v20, s[20:23], s44 offen sc1
    v_mfma_f32_16x16x32_bf16 a[148:151], v[172:175], v[32:35], a[148:151]
    v_add_f32 v7, v7, v19
    v_cvt_f32_i32 v242, v242
    v_mfma_f32_16x16x32_bf16 a[148:151], v[188:191], v[36:39], a[148:151]
    s_waitcnt lgkmcnt(2)
    v_exp_f32 v17, v105
    v_mfma_f32_16x16x32_bf16 a[8:11], v[160:163], v[40:43], a[8:11]
    ds_read_b128 v[32:35], v1 offset:4096
    v_cvt_pk_bf16_f32 v73, v18, v19
    v_mfma_f32_16x16x32_bf16 a[8:11], v[176:179], v[44:47], a[8:11]
    v_exp_f32 v18, v106
    v_mfma_f32_16x16x32_bf16 a[56:59], v[164:167], v[40:43], a[56:59]
    v_add_f32 v7, v7, v16
    v_cvt_f32_i32 v246, v246
    v_mfma_f32_16x16x32_bf16 a[56:59], v[180:183], v[44:47], a[56:59]
    buffer_load_dwordx4 v4, s[4:7], s27 offen offset:2048 sc1 lds
    v_mfma_f32_16x16x32_bf16 a[104:107], v[168:171], v[40:43], a[104:107]
    ds_read_b128 v[36:39], v1 offset:16384
    v_add_f32 v7, v7, v17
    v_mfma_f32_16x16x32_bf16 a[104:107], v[184:187], v[44:47], a[104:107]
    v_exp_f32 v19, v107
    v_mfma_f32_16x16x32_bf16 a[152:155], v[172:175], v[40:43], a[152:155]
    v_cvt_pk_bf16_f32 v74, v16, v17
    v_fma_f32 v242, v242, v48, v50
    v_mfma_f32_16x16x32_bf16 a[152:155], v[188:191], v[44:47], a[152:155]
    s_waitcnt lgkmcnt(2)
    v_exp_f32 v16, v76
    v_mfma_f32_16x16x32_bf16 a[12:15], v[160:163], v[24:27], a[12:15]
    ds_read_b128 v[40:43], v1 offset:5120
    v_add_f32 v7, v7, v18
    v_mfma_f32_16x16x32_bf16 a[12:15], v[176:179], v[28:31], a[12:15]
    s_add_u32 s27, s27, 24576
    v_add_f32 v7, v7, v19
    v_fma_f32 v246, v246, v49, v51
    v_mfma_f32_16x16x32_bf16 a[60:63], v[164:167], v[24:27], a[60:63]
    v_exp_f32 v17, v77
    v_mfma_f32_16x16x32_bf16 a[60:63], v[180:183], v[28:31], a[60:63]
    v_cvt_pk_bf16_f32 v75, v18, v19
    v_lshlrev_b32 v48, 16, v61
    v_mfma_f32_16x16x32_bf16 a[108:111], v[168:171], v[24:27], a[108:111]
    ds_read_b128 v[44:47], v1 offset:17408
    v_and_b32 v49, s97, v61
    v_mfma_f32_16x16x32_bf16 a[108:111], v[184:187], v[28:31], a[108:111]
L_pg4:
    s_cbranch_execz L_pg8
    v_exp_f32 v18, v78
    v_mfma_f32_16x16x32_bf16 a[156:159], v[172:175], v[24:27], a[156:159]
    s_add_u32 s29, s28, 49152
    v_add_f32 v8, v8, v16
    v_add_f32 v8, v8, v17
    v_mfma_f32_16x16x32_bf16 a[156:159], v[188:191], v[28:31], a[156:159]
    s_waitcnt lgkmcnt(2)
    v_exp_f32 v19, v79
    v_mfma_f32_16x16x32_bf16 a[16:19], v[160:163], v[32:35], a[16:19]
    s_sub_u32 s3, s29, 147456
    ds_read_b128 v[24:27], v1 offset:6144
    v_lshlrev_b32 v50, 16, v63
    v_mfma_f32_16x16x32_bf16 a[16:19], v[176:179], v[36:39], a[16:19]
    s_add_u32 s56, s56, 12288
    v_cvt_pk_bf16_f32 v76, v16, v17
    v_and_b32 v51, s97, v63
    v_mfma_f32_16x16x32_bf16 a[64:67], v[164:167], v[32:35], a[64:67]
    s_min_u32 s29, s29, s3
    v_exp_f32 v16, v108
    v_mfma_f32_16x16x32_bf16 a[64:67], v[180:183], v[36:39], a[64:67]
    s_mov_b32 m0, s56
    v_add_f32 v8, v8, v18
    v_add_f32 v8, v8, v19
    v_mfma_f32_16x16x32_bf16 a[112:115], v[168:171], v[32:35], a[112:115]
    ds_read_b128 v[28:31], v1 offset:18432
    v_mul_f32_e64 v50, -v50, v48
    v_mfma_f32_16x16x32_bf16 a[112:115], v[184:187], v[36:39], a[112:115]
    v_exp_f32 v17, v109
    v_mfma_f32_16x16x32_bf16 a[160:163], v[172:175], v[32:35], a[160:163]
    v_cvt_pk_bf16_f32 v77, v18, v19
    v_mul_f32_e64 v51, -v51, v49
    v_mfma_f32_16x16x32_bf16 a[160:163], v[188:191], v[36:39], a[160:163]
    s_waitcnt lgkmcnt(2)
    v_exp_f32 v18, v110
    v_mfma_f32_16x16x32_bf16 a[20:23], v[160:163], v[40:43], a[20:23]
    s_sub_u32 s3, s29, s28
    ds_read_b128 v[32:35], v1 offset:7168
    v_add_f32 v8, v8, v16
    v_mfma_f32_16x16x32_bf16 a[20:23], v[176:179], v[44:47], a[20:23]
    v_add_f32 v8, v8, v17
    v_cvt_f32_i32 v248, v248
    v_mfma_f32_16x16x32_bf16 a[68:71], v[164:167], v[40:43], a[68:71]
    v_exp_f32 v19, v111
    v_mfma_f32_16x16x32_bf16 a[68:71], v[180:183], v[44:47], a[68:71]
    buffer_load_dwordx4 v4, s[4:7], s27 offen offset:0 sc1 lds
    v_mfma_f32_16x16x32_bf16 a[116:119], v[168:171], v[40:43], a[116:119]
    ds_read_b128 v[36:39], v1 offset:19456
    v_cvt_pk_bf16_f32 v78, v16, v17
    v_mfma_f32_16x16x32_bf16 a[116:119], v[184:187], v[44:47], a[116:119]
    v_add_f32 v8, v8, v18
    v_cvt_f32_i32 v252, v252
    v_mfma_f32_16x16x32_bf16 a[164:167], v[172:175], v[40:43], a[164:167]
    s_mov_b32 s28, s29
    v_add_f32 v8, v8, v19
    v_cvt_pk_bf16_f32 v79, v18, v19
    v_mfma_f32_16x16x32_bf16 a[164:167], v[188:191], v[44:47], a[164:167]
    s_waitcnt lgkmcnt(2)
    v_exp_f32 v16, v80
    v_mfma_f32_16x16x32_bf16 a[24:27], v[160:163], v[24:27], a[24:27]
    ds_read_b128 v[40:43], v1 offset:8192
    v_fma_f32 v248, v248, v48, v50
    v_mfma_f32_16x16x32_bf16 a[24:27], v[176:179], v[28:31], a[24:27]
    v_exp_f32 v17, v81
    v_mfma_f32_16x16x32_bf16 a[72:75], v[164:167], v[24:27], a[72:75]
    v_fma_f32 v252, v252, v49, v51
    v_cvt_f32_i32 v249, v249
    v_mfma_f32_16x16x32_bf16 a[72:75], v[180:183], v[28:31], a[72:75]
    buffer_load_dwordx4 v4, s[4:7], s27 offen offset:1024 sc1 lds
    v_mfma_f32_16x16x32_bf16 a[120:123], v[168:171], v[24:27], a[120:123]
    ds_read_b128 v[44:47], v1 offset:20480
    v_cvt_f32_i32 v253, v253
    v_mfma_f32_16x16x32_bf16 a[120:123], v[184:187], v[28:31], a[120:123]
    v_exp_f32 v18, v82
    v_mfma_f32_16x16x32_bf16 a[168:171], v[172:175], v[24:27], a[168:171]
    v_add_f32 v5, v5, v16
    v_add_f32 v5, v5, v17
    v_mfma_f32_16x16x32_bf16 a[168:171], v[188:191], v[28:31], a[168:171]
    s_waitcnt lgkmcnt(2)
    v_exp_f32 v19, v83
    v_mfma_f32_16x16x32_bf16 a[28:31], v[160:163], v[32:35], a[28:31]
    ds_read_b128 v[24:27], v1 offset:9216
    v_cvt_pk_bf16_f32 v80, v16, v17
    v_mfma_f32_16x16x32_bf16 a[28:31], v[176:179], v[36:39], a[28:31]
    v_exp_f32 v16, v112
    v_mfma_f32_16x16x32_bf16 a[76:79], v[164:167], v[32:35], a[76:79]
    v_add_f32 v5, v5, v18
    v_fma_f32 v249, v249, v48, v50
    v_mfma_f32_16x16x32_bf16 a[76:79], v[180:183], v[36:39], a[76:79]
    v_add_f32 v5, v5, v19
    v_add_u32 v2, s3, v2
    v_mfma_f32_16x16x32_bf16 a[124:127], v[168:171], v[32:35], a[124:127]
    ds_read_b128 v[28:31], v1 offset:21504
    v_fma_f32 v253, v253, v49, v51
    v_mfma_f32_16x16x32_bf16 a[124:127], v[184:187], v[36:39], a[124:127]
    buffer_load_dwordx4 v4, s[4:7], s27 offen offset:2048 sc1 lds
    v_mfma_f32_16x16x32_bf16 a[172:175], v[172:175], v[32:35], a[172:175]
    v_exp_f32 v17, v113
    v_mfma_f32_16x16x32_bf16 a[172:175], v[188:191], v[36:39], a[172:175]
    s_waitcnt lgkmcnt(2)
    v_cvt_pk_bf16_f32 v81, v18, v19
    v_cvt_f32_i32 v250, v250
    v_mfma_f32_16x16x32_bf16 a[32:35], v[160:163], v[40:43], a[32:35]
    ds_read_b128 v[32:35], v1 offset:10240
    v_add_u32 v3, s3, v3
    v_mfma_f32_16x16x32_bf16 a[32:35], v[176:179], v[44:47], a[32:35]
    v_exp_f32 v18, v114
    v_mfma_f32_16x16x32_bf16 a[80:83], v[164:167], v[40:43], a[80:83]
    v_add_f32 v5, v5, v16
    v_add_f32 v5, v5, v17
    v_mfma_f32_16x16x32_bf16 a[80:83], v[180:183], v[44:47], a[80:83]
    v_exp_f32 v19, v115
    v_mfma_f32_16x16x32_bf16 a[128:131], v[168:171], v[40:43], a[128:131]
    ds_read_b128 v[36:39], v1 offset:22528
    v_cvt_pk_bf16_f32 v82, v16, v17
    v_mfma_f32_16x16x32_bf16 a[128:131], v[184:187], v[44:47], a[128:131]
    v_exp_f32 v16, v84
    v_mfma_f32_16x16x32_bf16 a[176:179], v[172:175], v[40:43], a[176:179]
    v_cvt_f32_i32 v254, v254
    v_add_f32 v5, v5, v18
    v_mfma_f32_16x16x32_bf16 a[176:179], v[188:191], v[44:47], a[176:179]
    s_waitcnt lgkmcnt(2)
    v_add_f32 v5, v5, v19
    v_fma_f32 v250, v250, v48, v50
    v_mfma_f32_16x16x32_bf16 a[36:39], v[160:163], v[24:27], a[36:39]
    ds_read_b128 v[40:43], v1 offset:11264
    v_fma_f32 v254, v254, v49, v51
    v_mfma_f32_16x16x32_bf16 a[36:39], v[176:179], v[28:31], a[36:39]
    v_exp_f32 v17, v85
    v_mfma_f32_16x16x32_bf16 a[84:87], v[164:167], v[24:27], a[84:87]
    v_cvt_pk_bf16_f32 v83, v18, v19
    v_cvt_pk_bf16_f32 v146, v240, v244
    v_mfma_f32_16x16x32_bf16 a[84:87], v[180:183], v[28:31], a[84:87]
    s_add_u32 s27, s27, 24576
    v_exp_f32 v18, v86
    v_mfma_f32_16x16x32_bf16 a[132:135], v[168:171], v[24:27], a[132:135]
    s_add_u32 s56, s56, 36864
    ds_read_b128 v[44:47], v1 offset:23552
    v_add_f32 v6, v6, v16
    v_mfma_f32_16x16x32_bf16 a[132:135], v[184:187], v[28:31], a[132:135]
    s_sub_u32 s58, s56, 147456
    v_add_f32 v6, v6, v17
    v_cvt_pk_bf16_f32 v150, v241, v245
    v_mfma_f32_16x16x32_bf16 a[180:183], v[172:175], v[24:27], a[180:183]
    v_exp_f32 v19, v87
    v_mfma_f32_16x16x32_bf16 a[180:183], v[188:191], v[28:31], a[180:183]
    s_waitcnt lgkmcnt(2)
    v_cvt_pk_bf16_f32 v84, v16, v17
    v_cvt_pk_bf16_f32 v147, v248, v252
    v_mfma_f32_16x16x32_bf16 a[40:43], v[160:163], v[32:35], a[40:43]
    s_min_u32 s56, s56, s58
    ds_read_b128 v[24:27], v2 offset:0
    v_mfma_f32_16x16x32_bf16 a[40:43], v[176:179], v[36:39], a[40:43]
    v_exp_f32 v16, v116
    v_mfma_f32_16x16x32_bf16 a[88:91], v[164:167], v[32:35], a[88:91]
    v_add_f32 v6, v6, v18
    v_add_f32 v6, v6, v19
    v_mfma_f32_16x16x32_bf16 a[88:91], v[180:183], v[36:39], a[88:91]
    v_exp_f32 v17, v117
    v_mfma_f32_16x16x32_bf16 a[136:139], v[168:171], v[32:35], a[136:139]
    ds_read_b128 v[28:31], v3 offset:0
    v_cvt_pk_bf16_f32 v151, v249, v253
    v_mfma_f32_16x16x32_bf16 a[136:139], v[184:187], v[36:39], a[136:139]
    v_cvt_pk_bf16_f32 v85, v18, v19
    v_cvt_pk_bf16_f32 v154, v242, v246
    v_mfma_f32_16x16x32_bf16 a[184:187], v[172:175], v[32:35], a[184:187]
    v_exp_f32 v18, v118
    v_mfma_f32_16x16x32_bf16 a[184:187], v[188:191], v[36:39], a[184:187]
    s_waitcnt lgkmcnt(2)
    v_add_f32 v6, v6, v16
    v_mfma_f32_16x16x32_bf16 a[44:47], v[160:163], v[40:43], a[44:47]
    ds_read_b128 v[32:35], v2 offset:6144
    v_add_f32 v6, v6, v17
    v_mfma_f32_16x16x32_bf16 a[44:47], v[176:179], v[44:47], a[44:47]
    v_exp_f32 v19, v119
    v_mfma_f32_16x16x32_bf16 a[92:95], v[164:167], v[40:43], a[92:95]
    v_cvt_pk_bf16_f32 v155, v250, v254
    v_mfma_f32_16x16x32_bf16 a[92:95], v[180:183], v[44:47], a[92:95]
    v_cvt_pk_bf16_f32 v86, v16, v17
    v_mfma_f32_16x16x32_bf16 a[140:143], v[168:171], v[40:43], a[140:143]
    ds_read_b128 v[36:39], v3 offset:6144
    v_add_f32 v6, v6, v18
    v_mfma_f32_16x16x32_bf16 a[140:143], v[184:187], v[44:47], a[140:143]
    v_add_f32 v6, v6, v19
    v_cvt_pk_bf16_f32 v87, v18, v19
    v_mfma_f32_16x16x32_bf16 a[188:191], v[172:175], v[40:43], a[188:191]
    v_mfma_f32_16x16x32_bf16 a[188:191], v[188:191], v[44:47], a[188:191]
    s_waitcnt lgkmcnt(2)
L_join:
    v_mfma_f32_16x16x32_bf16 v[160:163], v[24:27], a[192:195], v[128:131]
L_pg5:
    s_cbranch_execz L_pg9
    ds_read_b128 v[40:43], v2 offset:128
    v_mfma_f32_16x16x32_bf16 v[160:163], v[28:31], a[196:199], v[160:163]
    s_waitcnt vmcnt(4)
    v_subrev_u32 v52, s92, v52
    v_cmp_lt_u32 vcc, 15, v52
    v_mfma_f32_16x16x32_bf16 v[164:167], v[24:27], a[216:219], v[132:135]
    v_exp_f32 v16, v88
    v_mfma_f32_16x16x32_bf16 v[164:167], v[28:31], a[220:223], v[164:167]
    v_exp_f32 v17, v89
    v_mfma_f32_16x16x32_bf16 v[168:171], v[24:27], a[240:243], v[136:139]
    s_and_b32 s59, vcc_lo, 0xff
    ds_read_b128 v[44:47], v3 offset:128
    v_mfma_f32_16x16x32_bf16 v[168:171], v[28:31], a[244:247], v[168:171]
    s_cbranch_scc1 L_pollslow1
L_pollok1:
    v_mfma_f32_16x16x32_bf16 v[172:175], v[24:27], v[200:203], v[140:143]
    s_add_u32 s92, s92, 1
    v_exp_f32 v18, v90
    v_mfma_f32_16x16x32_bf16 v[172:175], v[28:31], v[204:207], v[172:175]
    s_waitcnt lgkmcnt(2)
    v_add_f32 v7, v7, v16
    v_add_f32 v7, v7, v17
    v_mfma_f32_16x16x32_bf16 v[96:99], v[32:35], a[192:195], v[128:131]
    ds_read_b128 v[24:27], v2 offset:6272
    v_mfma_f32_16x16x32_bf16 v[96:99], v[36:39], a[196:199], v[96:99]
    buffer_store_dwordx4 v[144:147], v15, s[4:7], s35 offen offset:0 sc1
    v_mfma_f32_16x16x32_bf16 v[100:103], v[32:35], a[216:219], v[132:135]
    v_exp_f32 v19, v91
    v_mfma_f32_16x16x32_bf16 v[100:103], v[36:39], a[220:223], v[100:103]
    v_cvt_pk_bf16_f32 v88, v16, v17
    v_mfma_f32_16x16x32_bf16 v[104:107], v[32:35], a[240:243], v[136:139]
    ds_read_b128 v[28:31], v3 offset:6272
    v_mfma_f32_16x16x32_bf16 v[104:107], v[36:39], a[244:247], v[104:107]
    v_exp_f32 v16, v120
    v_mfma_f32_16x16x32_bf16 v[108:111], v[32:35], v[200:203], v[140:143]
    v_add_f32 v7, v7, v18
    v_add_f32 v7, v7, v19
    v_mfma_f32_16x16x32_bf16 v[108:111], v[36:39], v[204:207], v[108:111]
    s_waitcnt lgkmcnt(2)
    v_exp_f32 v17, v121
    v_mfma_f32_16x16x32_bf16 v[160:163], v[40:43], a[200:203], v[160:163]
    ds_read_b128 v[32:35], v2 offset:256
    v_cvt_pk_bf16_f32 v89, v18, v19
    v_mfma_f32_16x16x32_bf16 v[160:163], v[44:47], a[204:207], v[160:163]
    buffer_store_dwordx4 v[148:151], v15, s[4:7], s35 offen offset:1024 sc1
    v_mfma_f32_16x16x32_bf16 v[164:167], v[40:43], a[224:227], v[164:167]
    v_exp_f32 v18, v122
    v_mfma_f32_16x16x32_bf16 v[164:167], v[44:47], a[228:231], v[164:167]
    v_add_f32 v7, v7, v16
    v_add_f32 v7, v7, v17
    v_mfma_f32_16x16x32_bf16 v[168:171], v[40:43], a[248:251], v[168:171]
    ds_read_b128 v[36:39], v3 offset:256
    v_mfma_f32_16x16x32_bf16 v[168:171], v[44:47], a[252:255], v[168:171]
    v_exp_f32 v19, v123
    v_mfma_f32_16x16x32_bf16 v[172:175], v[40:43], v[208:211], v[172:175]
    v_cvt_pk_bf16_f32 v90, v16, v17
    v_mfma_f32_16x16x32_bf16 v[172:175], v[44:47], v[212:215], v[172:175]
    s_waitcnt lgkmcnt(2)
    v_exp_f32 v16, v92
    v_mfma_f32_16x16x32_bf16 v[96:99], v[24:27], a[200:203], v[96:99]
    ds_read_b128 v[40:43], v2 offset:6400
    v_add_f32 v7, v7, v18
    v_mfma_f32_16x16x32_bf16 v[96:99], v[28:31], a[204:207], v[96:99]
    buffer_store_dwordx4 v[152:155], v15, s[4:7], s35 offen offset:2048 sc1
    v_mfma_f32_16x16x32_bf16 v[100:103], v[24:27], a[224:227], v[100:103]
    v_add_f32 v7, v7, v19
    v_mfma_f32_16x16x32_bf16 v[100:103], v[28:31], a[228:231], v[100:103]
    v_exp_f32 v17, v93
    v_mfma_f32_16x16x32_bf16 v[104:107], v[24:27], a[248:251], v[104:107]
    ds_read_b128 v[44:47], v3 offset:6400
    v_cvt_pk_bf16_f32 v91, v18, v19
    v_mfma_f32_16x16x32_bf16 v[104:107], v[28:31], a[252:255], v[104:107]
    v_exp_f32 v18, v94
    v_mfma_f32_16x16x32_bf16 v[108:111], v[24:27], v[208:211], v[108:111]
    s_add_u32 s29, s30, 49152
    v_add_f32 v8, v8, v16
    v_add_f32 v8, v8, v17
    v_mfma_f32_16x16x32_bf16 v[108:111], v[28:31], v[212:215], v[108:111]
    s_waitcnt lgkmcnt(2)
    v_exp_f32 v19, v95
    v_mfma_f32_16x16x32_bf16 v[160:163], v[32:35], a[208:211], v[160:163]
    s_sub_u32 s3, s29, 147456
    ds_read_b128 v[24:27], v2 offset:12288
    v_cvt_pk_bf16_f32 v92, v16, v17
    v_mfma_f32_16x16x32_bf16 v[160:163], v[36:39], a[212:215], v[160:163]
    s_min_u32 s29, s29, s3
    v_exp_f32 v16, v124
    v_mfma_f32_16x16x32_bf16 v[164:167], v[32:35], a[232:235], v[164:167]
    v_add_f32 v8, v8, v18
    v_add_f32 v8, v8, v19
    v_mfma_f32_16x16x32_bf16 v[164:167], v[36:39], a[236:239], v[164:167]
    v_exp_f32 v17, v125
    v_mfma_f32_16x16x32_bf16 v[168:171], v[32:35], v[192:195], v[168:171]
    ds_read_b128 v[28:31], v3 offset:12288
    v_mfma_f32_16x16x32_bf16 v[168:171], v[36:39], v[196:199], v[168:171]
    v_cvt_pk_bf16_f32 v93, v18, v19
    v_mfma_f32_16x16x32_bf16 v[172:175], v[32:35], v[216:219], v[172:175]
    v_exp_f32 v18, v126
    v_mfma_f32_16x16x32_bf16 v[172:175], v[36:39], v[220:223], v[172:175]
    s_waitcnt lgkmcnt(2)
    v_add_f32 v8, v8, v16
    v_mfma_f32_16x16x32_bf16 v[96:99], v[40:43], a[208:211], v[96:99]
    s_waitcnt vmcnt(10)
    ds_read_b128 v[32:35], v2 offset:18432
    v_lshlrev_b32 v48, 16, v56
    v_mfma_f32_16x16x32_bf16 v[96:99], v[44:47], a[212:215], v[96:99]
    s_mov_b32 m0, s26
    v_add_f32 v8, v8, v17
    v_and_b32 v49, s97, v56
    v_mfma_f32_16x16x32_bf16 v[100:103], v[40:43], a[232:235], v[100:103]
    s_sub_u32 s3, s29, s30
    v_exp_f32 v19, v127
    v_mfma_f32_16x16x32_bf16 v[100:103], v[44:47], a[236:239], v[100:103]
    buffer_load_dwordx4 v4, s[4:7], s32 offen offset:0 sc1 lds
    v_mfma_f32_16x16x32_bf16 v[104:107], v[40:43], v[192:195], v[104:107]
    ds_read_b128 v[36:39], v3 offset:18432
    v_cvt_pk_bf16_f32 v94, v16, v17
    v_mfma_f32_16x16x32_bf16 v[104:107], v[44:47], v[196:199], v[104:107]
    v_add_f32 v8, v8, v18
    v_add_f32 v8, v8, v19
    v_mfma_f32_16x16x32_bf16 v[108:111], v[40:43], v[216:219], v[108:111]
    v_lshlrev_b32 v50, 16, v58
    v_cvt_pk_bf16_f32 v95, v18, v19
    v_mfma_f32_16x16x32_bf16 v[108:111], v[44:47], v[220:223], v[108:111]
    s_waitcnt lgkmcnt(2)
    buffer_load_dwordx4 v4, s[4:7], s32 offen offset:1024 sc1 lds
    v_mfma_f32_16x16x32_bf16 v[176:179], v[24:27], a[192:195], v[128:131]
    ds_read_b128 v[40:43], v2 offset:12416
    v_and_b32 v51, s97, v58
    v_mfma_f32_16x16x32_bf16 v[176:179], v[28:31], a[196:199], v[176:179]
    s_mov_b32 s30, s29
    v_exp_f32 v16, v160
    v_mfma_f32_16x16x32_bf16 v[180:183], v[24:27], a[216:219], v[132:135]
    v_exp_f32 v17, v161
    v_mfma_f32_16x16x32_bf16 v[180:183], v[28:31], a[220:223], v[180:183]
    buffer_load_dwordx4 v4, s[4:7], s32 offen offset:2048 sc1 lds
    v_mfma_f32_16x16x32_bf16 v[184:187], v[24:27], a[240:243], v[136:139]
    s_add_u32 s32, s32, 24576
    ds_read_b128 v[44:47], v3 offset:12416
    v_mul_f32 v48, s38, v48
    v_mfma_f32_16x16x32_bf16 v[184:187], v[28:31], a[244:247], v[184:187]
    v_exp_f32 v18, v162
    v_mfma_f32_16x16x32_bf16 v[188:191], v[24:27], v[200:203], v[140:143]
    s_add_u32 s26, s26, 12288
    v_add_f32 v5, v5, v16
    v_add_f32 v5, v5, v17
    v_mfma_f32_16x16x32_bf16 v[188:191], v[28:31], v[204:207], v[188:191]
    s_waitcnt lgkmcnt(2)
    v_exp_f32 v19, v163
    v_mfma_f32_16x16x32_bf16 v[112:115], v[32:35], a[192:195], v[128:131]
    s_mov_b32 m0, s26
    ds_read_b128 v[24:27], v2 offset:18560
    v_mul_f32 v49, s38, v49
    v_mfma_f32_16x16x32_bf16 v[112:115], v[36:39], a[196:199], v[112:115]
    v_cvt_pk_bf16_f32 v160, v16, v17
    v_mul_f32_e64 v50, -v50, v48
    v_mfma_f32_16x16x32_bf16 v[116:119], v[32:35], a[216:219], v[132:135]
    v_exp_f32 v16, v96
    v_mfma_f32_16x16x32_bf16 v[116:119], v[36:39], a[220:223], v[116:119]
    v_add_f32 v5, v5, v18
    v_mul_f32_e64 v51, -v51, v49
    v_mfma_f32_16x16x32_bf16 v[120:123], v[32:35], a[240:243], v[136:139]
    ds_read_b128 v[28:31], v3 offset:18560
    v_add_f32 v5, v5, v19
    v_mfma_f32_16x16x32_bf16 v[120:123], v[36:39], a[244:247], v[120:123]
    buffer_load_dwordx4 v4, s[4:7], s32 offen offset:0 sc1 lds
    v_mfma_f32_16x16x32_bf16 v[124:127], v[32:35], v[200:203], v[140:143]
    v_exp_f32 v17, v97
    v_mfma_f32_16x16x32_bf16 v[124:127], v[36:39], v[204:207], v[124:127]
    s_waitcnt lgkmcnt(2)
    v_cvt_pk_bf16_f32 v161, v18, v19
    v_cvt_f32_i32 v224, v224
    v_mfma_f32_16x16x32_bf16 v[176:179], v[40:43], a[200:203], v[176:179]
    ds_read_b128 v[32:35], v2 offset:12544
    v_cvt_f32_i32 v225, v225
    v_mfma_f32_16x16x32_bf16 v[176:179], v[44:47], a[204:207], v[176:179]
    buffer_load_dwordx4 v4, s[4:7], s32 offen offset:1024 sc1 lds
    v_mfma_f32_16x16x32_bf16 v[180:183], v[40:43], a[224:227], v[180:183]
    v_exp_f32 v18, v98
    v_mfma_f32_16x16x32_bf16 v[180:183], v[44:47], a[228:231], v[180:183]
    v_add_f32 v5, v5, v16
    v_add_f32 v5, v5, v17
    v_mfma_f32_16x16x32_bf16 v[184:187], v[40:43], a[248:251], v[184:187]
    ds_read_b128 v[36:39], v3 offset:12544
    v_fma_f32 v224, v224, v48, v50
    v_mfma_f32_16x16x32_bf16 v[184:187], v[44:47], a[252:255], v[184:187]
    buffer_load_dwordx4 v4, s[4:7], s32 offen offset:2048 sc1 lds
    v_mfma_f32_16x16x32_bf16 v[188:191], v[40:43], v[208:211], v[188:191]
    v_exp_f32 v19, v99
    v_mfma_f32_16x16x32_bf16 v[188:191], v[44:47], v[212:215], v[188:191]
    s_waitcnt lgkmcnt(2)
    v_cvt_pk_bf16_f32 v162, v16, v17
    v_fma_f32 v225, v225, v49, v51
    v_mfma_f32_16x16x32_bf16 v[112:115], v[24:27], a[200:203], v[112:115]
    ds_read_b128 v[40:43], v2 offset:18688
    v_add_u32 v1, s3, v1
    v_mfma_f32_16x16x32_bf16 v[112:115], v[28:31], a[204:207], v[112:115]
    v_exp_f32 v16, v164
    v_mfma_f32_16x16x32_bf16 v[116:119], v[24:27], a[224:227], v[116:119]
    v_add_f32 v5, v5, v18
    v_add_f32 v5, v5, v19
    v_mfma_f32_16x16x32_bf16 v[116:119], v[28:31], a[228:231], v[116:119]
    s_add_u32 s32, s32, 24576
    v_exp_f32 v17, v165
    v_mfma_f32_16x16x32_bf16 v[120:123], v[24:27], a[248:251], v[120:123]
    s_add_u32 s26, s26, 36864
    ds_read_b128 v[44:47], v3 offset:18688
    v_cvt_pk_bf16_f32 v163, v18, v19
    v_mfma_f32_16x16x32_bf16 v[120:123], v[28:31], a[252:255], v[120:123]
    s_waitcnt lgkmcnt(2)
    v_exp_f32 v18, v166
    v_mfma_f32_16x16x32_bf16 v[124:127], v[24:27], v[208:211], v[124:127]
    s_waitcnt vmcnt(6)
    v_cvt_pk_bf16_f32 v224, v224, v225
    v_add_f32 v6, v6, v16
    v_mfma_f32_16x16x32_bf16 v[124:127], v[28:31], v[212:215], v[124:127]
    s_barrier
    v_cvt_f32_i32 v228, v228
    v_mfma_f32_16x16x32_bf16 v[176:179], v[32:35], a[208:211], v[176:179]
    s_sub_u32 s57, s26, 147456
    ds_read_b128 v[24:27], v1 offset:0
    v_add_f32 v6, v6, v17
    v_mfma_f32_16x16x32_bf16 v[176:179], v[36:39], a[212:215], v[176:179]
    s_min_u32 s26, s26, s57
    v_exp_f32 v19, v167
    v_mfma_f32_16x16x32_bf16 v[180:183], v[32:35], a[232:235], v[180:183]
    v_cvt_pk_bf16_f32 v164, v16, v17
    v_cvt_f32_i32 v229, v229
    v_mfma_f32_16x16x32_bf16 v[180:183], v[36:39], a[236:239], v[180:183]
    v_exp_f32 v16, v100
    v_mfma_f32_16x16x32_bf16 v[184:187], v[32:35], v[192:195], v[184:187]
    ds_read_b128 v[28:31], v1 offset:12288
    v_fma_f32 v228, v228, v48, v50
    v_mfma_f32_16x16x32_bf16 v[184:187], v[36:39], v[196:199], v[184:187]
    v_add_f32 v6, v6, v18
    v_add_f32 v6, v6, v19
    v_mfma_f32_16x16x32_bf16 v[188:191], v[32:35], v[216:219], v[188:191]
    v_exp_f32 v17, v101
    v_mfma_f32_16x16x32_bf16 v[188:191], v[36:39], v[220:223], v[188:191]
    s_waitcnt lgkmcnt(2)
    v_fma_f32 v229, v229, v49, v51
    v_add_u32 v0, 1, v0
    v_mfma_f32_16x16x32_bf16 v[112:115], v[40:43], a[208:211], v[112:115]
    ds_read_b128 v[32:35], v1 offset:1024
    v_cvt_pk_bf16_f32 v165, v18, v19
    v_mfma_f32_16x16x32_bf16 v[112:115], v[44:47], a[212:215], v[112:115]
    buffer_store_dword v0, v13, s[20:23], 0 offen offset:32 sc1
    v_mfma_f32_16x16x32_bf16 v[116:119], v[40:43], a[232:235], v[116:119]
    v_exp_f32 v18, v102
    v_mfma_f32_16x16x32_bf16 v[116:119], v[44:47], a[236:239], v[116:119]
    v_cvt_pk_bf16_f32 v228, v228, v229
    v_add_f32 v6, v6, v16
    v_mfma_f32_16x16x32_bf16 v[120:123], v[40:43], v[192:195], v[120:123]
    ds_read_b128 v[36:39], v1 offset:13312
    v_add_f32 v6, v6, v17
    v_mfma_f32_16x16x32_bf16 v[120:123], v[44:47], v[196:199], v[120:123]
    v_exp_f32 v19, v103
    v_mfma_f32_16x16x32_bf16 v[124:127], v[40:43], v[216:219], v[124:127]
    v_cvt_f32_i32 v232, v232
    v_cvt_pk_bf16_f32 v166, v16, v17
    v_mfma_f32_16x16x32_bf16 v[124:127], v[44:47], v[220:223], v[124:127]
    s_waitcnt lgkmcnt(2)
    v_add_f32 v6, v6, v18
    v_cvt_f32_i32 v233, v233
    v_add_f32 v6, v6, v19
    v_fma_f32 v232, v232, v48, v50
    v_cvt_pk_bf16_f32 v167, v18, v19
    v_fma_f32 v233, v233, v49, v51
    v_mfma_f32_16x16x32_bf16 a[0:3], v[64:67], v[24:27], a[0:3]
    s_mov_b32 m0, s26
    ds_read_b128 v[40:43], v1 offset:2048
    v_cvt_pk_bf16_f32 v232, v232, v233
    v_mfma_f32_16x16x32_bf16 a[0:3], v[80:83], v[28:31], a[0:3]
    buffer_load_dwordx2 v[60:61], v10, s[72:75], s36 offen offset:192
    v_mfma_f32_16x16x32_bf16 a[48:51], v[68:71], v[24:27], a[48:51]
    v_exp_f32 v16, v168
    v_mfma_f32_16x16x32_bf16 a[48:51], v[84:87], v[28:31], a[48:51]
    v_exp_f32 v17, v169
    v_mfma_f32_16x16x32_bf16 a[96:99], v[72:75], v[24:27], a[96:99]
    ds_read_b128 v[44:47], v1 offset:14336
    v_cvt_f32_i32 v236, v236
    v_mfma_f32_16x16x32_bf16 a[96:99], v[88:91], v[28:31], a[96:99]
    buffer_load_dwordx4 v4, s[4:7], s32 offen offset:0 sc1 lds
    v_mfma_f32_16x16x32_bf16 a[144:147], v[76:79], v[24:27], a[144:147]
    v_exp_f32 v18, v170
    v_mfma_f32_16x16x32_bf16 a[144:147], v[92:95], v[28:31], a[144:147]
    s_waitcnt lgkmcnt(2)
    v_add_f32 v7, v7, v16
    v_add_f32 v7, v7, v17
    v_mfma_f32_16x16x32_bf16 a[4:7], v[64:67], v[32:35], a[4:7]
    ds_read_b128 v[24:27], v1 offset:3072
    v_cvt_f32_i32 v237, v237
    v_mfma_f32_16x16x32_bf16 a[4:7], v[80:83], v[36:39], a[4:7]
    buffer_load_dwordx2 v[62:63], v10, s[76:79], s36 offen offset:192
    v_mfma_f32_16x16x32_bf16 a[52:55], v[68:71], v[32:35], a[52:55]
    v_exp_f32 v19, v171
    v_mfma_f32_16x16x32_bf16 a[52:55], v[84:87], v[36:39], a[52:55]
    v_cvt_pk_bf16_f32 v168, v16, v17
    v_fma_f32 v236, v236, v48, v50
    v_mfma_f32_16x16x32_bf16 a[100:103], v[72:75], v[32:35], a[100:103]
    ds_read_b128 v[28:31], v1 offset:15360
    v_fma_f32 v237, v237, v49, v51
    v_mfma_f32_16x16x32_bf16 a[100:103], v[88:91], v[36:39], a[100:103]
    buffer_load_dwordx4 v[240:243], v9, s[64:67], s33 offen offset:384 nt
    v_mfma_f32_16x16x32_bf16 a[148:151], v[76:79], v[32:35], a[148:151]
    v_exp_f32 v16, v104
    v_mfma_f32_16x16x32_bf16 a[148:151], v[92:95], v[36:39], a[148:151]
    s_waitcnt lgkmcnt(2)
    v_add_f32 v7, v7, v18
    v_add_f32 v7, v7, v19
    v_mfma_f32_16x16x32_bf16 a[8:11], v[64:67], v[40:43], a[8:11]
    ds_read_b128 v[32:35], v1 offset:4096
    v_cvt_pk_bf16_f32 v236, v236, v237
    v_mfma_f32_16x16x32_bf16 a[8:11], v[80:83], v[44:47], a[8:11]
    buffer_load_dwordx4 v4, s[4:7], s32 offen offset:1024 sc1 lds
    v_mfma_f32_16x16x32_bf16 a[56:59], v[68:71], v[40:43], a[56:59]
    v_exp_f32 v17, v105
    v_mfma_f32_16x16x32_bf16 a[56:59], v[84:87], v[44:47], a[56:59]
    v_cvt_pk_bf16_f32 v169, v18, v19
    v_lshlrev_b32 v48, 16, v57
    v_mfma_f32_16x16x32_bf16 a[104:107], v[72:75], v[40:43], a[104:107]
    ds_read_b128 v[36:39], v1 offset:16384
    v_mfma_f32_16x16x32_bf16 a[104:107], v[88:91], v[44:47], a[104:107]
    buffer_load_dwordx4 v[244:247], v9, s[64:67], s33 offen offset:1920 nt
    v_mfma_f32_16x16x32_bf16 a[152:155], v[76:79], v[40:43], a[152:155]
    v_exp_f32 v18, v106
    v_mfma_f32_16x16x32_bf16 a[152:155], v[92:95], v[44:47], a[152:155]
    s_waitcnt lgkmcnt(2)
    v_add_f32 v7, v7, v16
    v_add_f32 v7, v7, v17
    v_mfma_f32_16x16x32_bf16 a[12:15], v[64:67], v[24:27], a[12:15]
    ds_read_b128 v[40:43], v1 offset:5120
    v_and_b32 v49, s97, v57
    v_mfma_f32_16x16x32_bf16 a[12:15], v[80:83], v[28:31], a[12:15]
    buffer_load_dwordx4 v4, s[4:7], s32 offen offset:2048 sc1 lds
    v_mfma_f32_16x16x32_bf16 a[60:63], v[68:71], v[24:27], a[60:63]
    v_exp_f32 v19, v107
    v_mfma_f32_16x16x32_bf16 a[60:63], v[84:87], v[28:31], a[60:63]
    v_cvt_pk_bf16_f32 v170, v16, v17
    v_exp_f32 v16, v172
    v_mfma_f32_16x16x32_bf16 a[108:111], v[72:75], v[24:27], a[108:111]
    ds_read_b128 v[44:47], v1 offset:17408
    v_add_f32 v7, v7, v18
    v_mfma_f32_16x16x32_bf16 a[108:111], v[88:91], v[28:31], a[108:111]
    buffer_load_dwordx4 v[248:251], v9, s[64:67], s34 offen offset:384 nt
    v_add_f32 v7, v7, v19
    v_mfma_f32_16x16x32_bf16 a[156:159], v[76:79], v[24:27], a[156:159]
    s_add_u32 s29, s28, 49152
    v_exp_f32 v17, v173
    v_mfma_f32_16x16x32_bf16 a[156:159], v[92:95], v[28:31], a[156:159]
    s_waitcnt lgkmcnt(2)
    v_cvt_pk_bf16_f32 v171, v18, v19
    v_lshlrev_b32 v50, 16, v59
    v_mfma_f32_16x16x32_bf16 a[16:19], v[64:67], v[32:35], a[16:19]
    s_sub_u32 s3, s29, 147456
    ds_read_b128 v[24:27], v1 offset:6144
    v_and_b32 v51, s97, v59
    v_mfma_f32_16x16x32_bf16 a[16:19], v[80:83], v[36:39], a[16:19]
    s_add_u32 s32, s32, 24576
    buffer_load_dwordx4 v[252:255], v9, s[64:67], s34 offen offset:1920 nt
    v_mfma_f32_16x16x32_bf16 a[64:67], v[68:71], v[32:35], a[64:67]
    s_min_u32 s29, s29, s3
    v_exp_f32 v18, v174
    v_mfma_f32_16x16x32_bf16 a[64:67], v[84:87], v[36:39], a[64:67]
    v_add_f32 v8, v8, v16
    v_add_f32 v8, v8, v17
    v_mfma_f32_16x16x32_bf16 a[112:115], v[72:75], v[32:35], a[112:115]
    s_add_u32 s26, s26, 12288
    ds_read_b128 v[28:31], v1 offset:18432
    v_mul_f32 v48, s38, v48
    v_mfma_f32_16x16x32_bf16 a[112:115], v[88:91], v[36:39], a[112:115]
    v_exp_f32 v19, v175
    v_cvt_pk_bf16_f32 v172, v16, v17
    v_mfma_f32_16x16x32_bf16 a[160:163], v[76:79], v[32:35], a[160:163]
    v_exp_f32 v16, v108
    v_mfma_f32_16x16x32_bf16 a[160:163], v[92:95], v[36:39], a[160:163]
    s_waitcnt lgkmcnt(2)
    v_add_f32 v8, v8, v18
    v_add_f32 v8, v8, v19
    v_mfma_f32_16x16x32_bf16 a[20:23], v[64:67], v[40:43], a[20:23]
    s_sub_u32 s3, s29, s28
    ds_read_b128 v[32:35], v1 offset:7168
    v_mul_f32 v49, s38, v49
    v_mfma_f32_16x16x32_bf16 a[20:23], v[80:83], v[44:47], a[20:23]
    v_exp_f32 v17, v109
    v_mfma_f32_16x16x32_bf16 a[68:71], v[68:71], v[40:43], a[68:71]
    s_mov_b32 m0, s26
    v_cvt_pk_bf16_f32 v173, v18, v19
    v_mul_f32_e64 v50, -v50, v48
    v_mfma_f32_16x16x32_bf16 a[68:71], v[84:87], v[44:47], a[68:71]
    v_exp_f32 v18, v110
    v_mfma_f32_16x16x32_bf16 a[116:119], v[72:75], v[40:43], a[116:119]
    ds_read_b128 v[36:39], v1 offset:19456
    v_add_f32 v8, v8, v16
    v_mfma_f32_16x16x32_bf16 a[116:119], v[88:91], v[44:47], a[116:119]
    v_add_f32 v8, v8, v17
    v_mul_f32_e64 v51, -v51, v49
    v_mfma_f32_16x16x32_bf16 a[164:167], v[76:79], v[40:43], a[164:167]
    s_mov_b32 s28, s29
    v_exp_f32 v19, v111
    v_mfma_f32_16x16x32_bf16 a[164:167], v[92:95], v[44:47], a[164:167]
    s_waitcnt lgkmcnt(2)
    v_cvt_pk_bf16_f32 v174, v16, v17
    v_add_f32 v8, v8, v18
    v_mfma_f32_16x16x32_bf16 a[24:27], v[64:67], v[24:27], a[24:27]
    ds_read_b128 v[40:43], v1 offset:8192
    v_add_f32 v8, v8, v19
    v_mfma_f32_16x16x32_bf16 a[24:27], v[80:83], v[28:31], a[24:27]
    v_cvt_pk_bf16_f32 v175, v18, v19
    v_cvt_f32_i32 v226, v226
    v_mfma_f32_16x16x32_bf16 a[72:75], v[68:71], v[24:27], a[72:75]
    v_exp_f32 v16, v176
    v_mfma_f32_16x16x32_bf16 a[72:75], v[84:87], v[28:31], a[72:75]
    buffer_load_dwordx4 v4, s[4:7], s32 offen offset:0 sc1 lds
    v_mfma_f32_16x16x32_bf16 a[120:123], v[72:75], v[24:27], a[120:123]
    ds_read_b128 v[44:47], v1 offset:20480
    v_mfma_f32_16x16x32_bf16 a[120:123], v[88:91], v[28:31], a[120:123]
    v_exp_f32 v17, v177
    v_mfma_f32_16x16x32_bf16 a[168:171], v[76:79], v[24:27], a[168:171]
    v_exp_f32 v18, v178
    v_mfma_f32_16x16x32_bf16 a[168:171], v[92:95], v[28:31], a[168:171]
    s_waitcnt lgkmcnt(2)
    v_add_f32 v5, v5, v16
    v_add_f32 v5, v5, v17
    v_mfma_f32_16x16x32_bf16 a[28:31], v[64:67], v[32:35], a[28:31]
    ds_read_b128 v[24:27], v1 offset:9216
    v_cvt_f32_i32 v227, v227
    v_mfma_f32_16x16x32_bf16 a[28:31], v[80:83], v[36:39], a[28:31]
    v_exp_f32 v19, v179
    v_mfma_f32_16x16x32_bf16 a[76:79], v[68:71], v[32:35], a[76:79]
    v_cvt_pk_bf16_f32 v176, v16, v17
    v_add_u32 v2, s3, v2
    v_mfma_f32_16x16x32_bf16 a[76:79], v[84:87], v[36:39], a[76:79]
    v_exp_f32 v16, v112
    v_mfma_f32_16x16x32_bf16 a[124:127], v[72:75], v[32:35], a[124:127]
    ds_read_b128 v[28:31], v1 offset:21504
    v_add_f32 v5, v5, v18
    v_mfma_f32_16x16x32_bf16 a[124:127], v[88:91], v[36:39], a[124:127]
    v_add_f32 v5, v5, v19
    v_fma_f32 v226, v226, v48, v50
    v_mfma_f32_16x16x32_bf16 a[172:175], v[76:79], v[32:35], a[172:175]
    v_exp_f32 v17, v113
    v_mfma_f32_16x16x32_bf16 a[172:175], v[92:95], v[36:39], a[172:175]
L_pg6:
    s_cbranch_execz L_pg10
    s_waitcnt lgkmcnt(2)
    buffer_load_dwordx4 v4, s[4:7], s32 offen offset:1024 sc1 lds
    v_mfma_f32_16x16x32_bf16 a[32:35], v[64:67], v[40:43], a[32:35]
    ds_read_b128 v[32:35], v1 offset:10240
    v_cvt_pk_bf16_f32 v177, v18, v19
    v_mfma_f32_16x16x32_bf16 a[32:35], v[80:83], v[44:47], a[32:35]
    v_exp_f32 v18, v114
    v_mfma_f32_16x16x32_bf16 a[80:83], v[68:71], v[40:43], a[80:83]
    v_add_f32 v5, v5, v16
    v_add_f32 v5, v5, v17
    v_mfma_f32_16x16x32_bf16 a[80:83], v[84:87], v[44:47], a[80:83]
    v_exp_f32 v19, v115
    v_mfma_f32_16x16x32_bf16 a[128:131], v[72:75], v[40:43], a[128:131]
    ds_read_b128 v[36:39], v1 offset:22528
    v_cvt_pk_bf16_f32 v178, v16, v17
    v_mfma_f32_16x16x32_bf16 a[128:131], v[88:91], v[44:47], a[128:131]
    v_exp_f32 v16, v180
    v_mfma_f32_16x16x32_bf16 a[176:179], v[76:79], v[40:43], a[176:179]
    v_fma_f32 v227, v227, v49, v51
    v_add_u32 v3, s3, v3
    v_mfma_f32_16x16x32_bf16 a[176:179], v[92:95], v[44:47], a[176:179]
    s_waitcnt lgkmcnt(2)
    v_add_f32 v5, v5, v18
    v_add_f32 v5, v5, v19
    v_mfma_f32_16x16x32_bf16 a[36:39], v[64:67], v[24:27], a[36:39]
    ds_read_b128 v[40:43], v1 offset:11264
    v_cvt_pk_bf16_f32 v225, v226, v227
    v_mfma_f32_16x16x32_bf16 a[36:39], v[80:83], v[28:31], a[36:39]
    buffer_load_dwordx4 v4, s[4:7], s32 offen offset:2048 sc1 lds
    v_mfma_f32_16x16x32_bf16 a[84:87], v[68:71], v[24:27], a[84:87]
    v_exp_f32 v17, v181
    v_mfma_f32_16x16x32_bf16 a[84:87], v[84:87], v[28:31], a[84:87]
    v_cvt_pk_bf16_f32 v179, v18, v19
    v_cvt_f32_i32 v230, v230
    v_mfma_f32_16x16x32_bf16 a[132:135], v[72:75], v[24:27], a[132:135]
    ds_read_b128 v[44:47], v1 offset:23552
    v_cvt_f32_i32 v231, v231
    v_mfma_f32_16x16x32_bf16 a[132:135], v[88:91], v[28:31], a[132:135]
    s_waitcnt lgkmcnt(2)
    v_exp_f32 v18, v182
    v_mfma_f32_16x16x32_bf16 a[180:183], v[76:79], v[24:27], a[180:183]
    s_waitcnt vmcnt(13)
    v_add_f32 v6, v6, v16
    v_add_f32 v6, v6, v17
    v_mfma_f32_16x16x32_bf16 a[180:183], v[92:95], v[28:31], a[180:183]
    s_barrier
    v_fma_f32 v230, v230, v48, v50
    v_mfma_f32_16x16x32_bf16 a[40:43], v[64:67], v[32:35], a[40:43]
    ds_read_b128 v[24:27], v2 offset:0
    v_mfma_f32_16x16x32_bf16 a[40:43], v[80:83], v[36:39], a[40:43]
    v_exp_f32 v19, v183
    v_mfma_f32_16x16x32_bf16 a[88:91], v[68:71], v[32:35], a[88:91]
    v_cvt_pk_bf16_f32 v180, v16, v17
    v_fma_f32 v231, v231, v49, v51
    v_mfma_f32_16x16x32_bf16 a[88:91], v[84:87], v[36:39], a[88:91]
    v_exp_f32 v16, v116
    v_mfma_f32_16x16x32_bf16 a[136:139], v[72:75], v[32:35], a[136:139]
    ds_read_b128 v[28:31], v3 offset:0
    v_add_f32 v6, v6, v18
    v_mfma_f32_16x16x32_bf16 a[136:139], v[88:91], v[36:39], a[136:139]
    v_add_f32 v6, v6, v19
    v_cvt_pk_bf16_f32 v229, v230, v231
    v_mfma_f32_16x16x32_bf16 a[184:187], v[76:79], v[32:35], a[184:187]
    v_exp_f32 v17, v117
    v_mfma_f32_16x16x32_bf16 a[184:187], v[92:95], v[36:39], a[184:187]
    s_waitcnt lgkmcnt(2)
    v_cvt_pk_bf16_f32 v181, v18, v19
    v_mfma_f32_16x16x32_bf16 a[44:47], v[64:67], v[40:43], a[44:47]
    ds_read_b128 v[32:35], v2 offset:6144
    v_mfma_f32_16x16x32_bf16 a[44:47], v[80:83], v[44:47], a[44:47]
    v_exp_f32 v18, v118
    v_mfma_f32_16x16x32_bf16 a[92:95], v[68:71], v[40:43], a[92:95]
    v_add_f32 v6, v6, v16
    v_add_f32 v6, v6, v17
    v_mfma_f32_16x16x32_bf16 a[92:95], v[84:87], v[44:47], a[92:95]
    s_add_u32 s32, s32, 24576
    v_exp_f32 v19, v119
    v_mfma_f32_16x16x32_bf16 a[140:143], v[72:75], v[40:43], a[140:143]
    s_add_u32 s26, s26, 36864
    ds_read_b128 v[36:39], v3 offset:6144
    v_cvt_pk_bf16_f32 v182, v16, v17
    v_mfma_f32_16x16x32_bf16 a[140:143], v[88:91], v[44:47], a[140:143]
    s_sub_u32 s57, s26, 147456
    v_add_f32 v6, v6, v18
    v_add_f32 v6, v6, v19
    v_mfma_f32_16x16x32_bf16 a[188:191], v[76:79], v[40:43], a[188:191]
    s_min_u32 s26, s26, s57
    v_cvt_pk_bf16_f32 v183, v18, v19
    v_mfma_f32_16x16x32_bf16 a[188:191], v[92:95], v[44:47], a[188:191]
    s_waitcnt lgkmcnt(2)
    v_mfma_f32_16x16x32_bf16 v[64:67], v[24:27], a[192:195], v[128:131]
    ds_read_b128 v[40:43], v2 offset:128
    v_cvt_f32_i32 v234, v234
    v_mfma_f32_16x16x32_bf16 v[64:67], v[28:31], a[196:199], v[64:67]
    v_exp_f32 v16, v184
    v_mfma_f32_16x16x32_bf16 v[68:71], v[24:27], a[216:219], v[132:135]
    v_exp_f32 v17, v185
    v_mfma_f32_16x16x32_bf16 v[68:71], v[28:31], a[220:223], v[68:71]
    buffer_load_dword v52, v20, s[20:23], s44 offen sc1
    v_mfma_f32_16x16x32_bf16 v[72:75], v[24:27], a[240:243], v[136:139]
    ds_read_b128 v[44:47], v3 offset:128
    v_cvt_f32_i32 v235, v235
    v_mfma_f32_16x16x32_bf16 v[72:75], v[28:31], a[244:247], v[72:75]
    v_exp_f32 v18, v186
    v_mfma_f32_16x16x32_bf16 v[76:79], v[24:27], v[200:203], v[140:143]
    v_add_f32 v7, v7, v16
    v_add_f32 v7, v7, v17
    v_mfma_f32_16x16x32_bf16 v[76:79], v[28:31], v[204:207], v[76:79]
    s_waitcnt lgkmcnt(2)
    v_exp_f32 v19, v187
    v_mfma_f32_16x16x32_bf16 v[96:99], v[32:35], a[192:195], v[128:131]
    ds_read_b128 v[24:27], v2 offset:6272
    v_cvt_pk_bf16_f32 v184, v16, v17
    v_mfma_f32_16x16x32_bf16 v[96:99], v[36:39], a[196:199], v[96:99]
    v_exp_f32 v16, v120
    v_mfma_f32_16x16x32_bf16 v[100:103], v[32:35], a[216:219], v[132:135]
    v_add_f32 v7, v7, v18
    v_fma_f32 v234, v234, v48, v50
    v_mfma_f32_16x16x32_bf16 v[100:103], v[36:39], a[220:223], v[100:103]
    s_add_u32 s35, s35, 196608
    s_mov_b32 m0, s26
    v_add_f32 v7, v7, v19
    v_mfma_f32_16x16x32_bf16 v[104:107], v[32:35], a[240:243], v[136:139]
    s_add_u32 s16, s16, 196608
    ds_read_b128 v[28:31], v3 offset:6272
    v_fma_f32 v235, v235, v49, v51
    v_mfma_f32_16x16x32_bf16 v[104:107], v[36:39], a[244:247], v[104:107]
    s_add_u32 s17, s17, 196608
    buffer_load_dwordx4 v4, s[4:7], s32 offen offset:0 sc1 lds
    v_mfma_f32_16x16x32_bf16 v[108:111], v[32:35], v[200:203], v[140:143]
    v_exp_f32 v17, v121
    v_mfma_f32_16x16x32_bf16 v[108:111], v[36:39], v[204:207], v[108:111]
    s_waitcnt lgkmcnt(2)
    v_cvt_pk_bf16_f32 v185, v18, v19
    v_cvt_pk_bf16_f32 v233, v234, v235
    v_mfma_f32_16x16x32_bf16 v[64:67], v[40:43], a[200:203], v[64:67]
    s_add_u32 s37, s37, 512
    ds_read_b128 v[32:35], v2 offset:256
    v_mfma_f32_16x16x32_bf16 v[64:67], v[44:47], a[204:207], v[64:67]
    v_exp_f32 v18, v122
    v_mfma_f32_16x16x32_bf16 v[68:71], v[40:43], a[224:227], v[68:71]
    v_add_f32 v7, v7, v16
    v_add_f32 v7, v7, v17
    v_mfma_f32_16x16x32_bf16 v[68:71], v[44:47], a[228:231], v[68:71]
    v_exp_f32 v19, v123
    v_mfma_f32_16x16x32_bf16 v[72:75], v[40:43], a[248:251], v[72:75]
    ds_read_b128 v[36:39], v3 offset:256
    v_cvt_pk_bf16_f32 v186, v16, v17
    v_mfma_f32_16x16x32_bf16 v[72:75], v[44:47], a[252:255], v[72:75]
    buffer_load_dwordx4 v4, s[4:7], s32 offen offset:1024 sc1 lds
    v_mfma_f32_16x16x32_bf16 v[76:79], v[40:43], v[208:211], v[76:79]
    v_exp_f32 v16, v188
    v_mfma_f32_16x16x32_bf16 v[76:79], v[44:47], v[212:215], v[76:79]
    s_waitcnt lgkmcnt(2)
    v_add_f32 v7, v7, v18
    v_add_f32 v7, v7, v19
    v_mfma_f32_16x16x32_bf16 v[96:99], v[24:27], a[200:203], v[96:99]
    ds_read_b128 v[40:43], v2 offset:6400
    v_cvt_f32_i32 v238, v238
    v_mfma_f32_16x16x32_bf16 v[96:99], v[28:31], a[204:207], v[96:99]
    buffer_load_dwordx2 v[56:57], off, s[80:83], s37 offset:0
    v_mfma_f32_16x16x32_bf16 v[100:103], v[24:27], a[224:227], v[100:103]
    v_exp_f32 v17, v189
    v_mfma_f32_16x16x32_bf16 v[100:103], v[28:31], a[228:231], v[100:103]
    v_cvt_pk_bf16_f32 v187, v18, v19
    v_cvt_f32_i32 v239, v239
    v_mfma_f32_16x16x32_bf16 v[104:107], v[24:27], a[248:251], v[104:107]
    ds_read_b128 v[44:47], v3 offset:6400
    v_mfma_f32_16x16x32_bf16 v[104:107], v[28:31], a[252:255], v[104:107]
    buffer_load_dwordx2 v[58:59], off, s[84:87], s37 offset:0
    v_mfma_f32_16x16x32_bf16 v[108:111], v[24:27], v[208:211], v[108:111]
    s_add_u32 s29, s30, 49152
    v_exp_f32 v18, v190
    v_mfma_f32_16x16x32_bf16 v[108:111], v[28:31], v[212:215], v[108:111]
    s_waitcnt lgkmcnt(2)
    v_add_f32 v8, v8, v16
    v_add_f32 v8, v8, v17
    v_mfma_f32_16x16x32_bf16 v[64:67], v[32:35], a[208:211], v[64:67]
    s_sub_u32 s3, s29, 147456
    ds_read_b128 v[24:27], v2 offset:12288
    v_mfma_f32_16x16x32_bf16 v[64:67], v[36:39], a[212:215], v[64:67]
    s_min_u32 s29, s29, s3
    buffer_load_dwordx4 v4, s[4:7], s32 offen offset:2048 sc1 lds
    v_mfma_f32_16x16x32_bf16 v[68:71], v[32:35], a[232:235], v[68:71]
    v_exp_f32 v19, v191
    v_mfma_f32_16x16x32_bf16 v[68:71], v[36:39], a[236:239], v[68:71]
    v_cvt_pk_bf16_f32 v188, v16, v17
    v_fma_f32 v238, v238, v48, v50
    v_mfma_f32_16x16x32_bf16 v[72:75], v[32:35], v[192:195], v[72:75]
    ds_read_b128 v[28:31], v3 offset:12288
    v_mfma_f32_16x16x32_bf16 v[72:75], v[36:39], v[196:199], v[72:75]
    buffer_load_dwordx3 v[144:146], v12, s[68:71], s35 offen offset:0 nt
    v_mfma_f32_16x16x32_bf16 v[76:79], v[32:35], v[216:219], v[76:79]
    v_exp_f32 v16, v124
    v_mfma_f32_16x16x32_bf16 v[76:79], v[36:39], v[220:223], v[76:79]
    s_waitcnt lgkmcnt(2)
    v_add_f32 v8, v8, v18
    v_add_f32 v8, v8, v19
    v_mfma_f32_16x16x32_bf16 v[96:99], v[40:43], a[208:211], v[96:99]
    s_add_u32 s32, s32, 24576
    ds_read_b128 v[32:35], v2 offset:18432
    v_fma_f32 v239, v239, v49, v51
    v_mfma_f32_16x16x32_bf16 v[96:99], v[44:47], a[212:215], v[96:99]
    s_sub_u32 s3, s29, s30
    v_exp_f32 v17, v125
    v_mfma_f32_16x16x32_bf16 v[100:103], v[40:43], a[232:235], v[100:103]
    v_cvt_pk_bf16_f32 v189, v18, v19
    v_mfma_f32_16x16x32_bf16 v[100:103], v[44:47], a[236:239], v[100:103]
    v_exp_f32 v18, v126
    v_mfma_f32_16x16x32_bf16 v[104:107], v[40:43], v[192:195], v[104:107]
    s_add_u32 s26, s26, 12288
    ds_read_b128 v[36:39], v3 offset:18432
    v_add_f32 v8, v8, v16
    v_mfma_f32_16x16x32_bf16 v[104:107], v[44:47], v[196:199], v[104:107]
    buffer_load_dwordx3 v[148:150], v12, s[68:71], s35 offen offset:768 nt
    v_mfma_f32_16x16x32_bf16 v[108:111], v[40:43], v[216:219], v[108:111]
    v_add_f32 v8, v8, v17
    v_cvt_pk_bf16_f32 v237, v238, v239
    v_mfma_f32_16x16x32_bf16 v[108:111], v[44:47], v[220:223], v[108:111]
    s_waitcnt lgkmcnt(2)
    v_exp_f32 v19, v127
    v_mfma_f32_16x16x32_bf16 v[80:83], v[24:27], a[192:195], v[128:131]
    ds_read_b128 v[40:43], v2 offset:12416
    v_cvt_pk_bf16_f32 v190, v16, v17
    v_mfma_f32_16x16x32_bf16 v[80:83], v[28:31], a[196:199], v[80:83]
    s_mov_b32 m0, s26
    v_add_f32 v8, v8, v18
    v_add_f32 v8, v8, v19
    v_mfma_f32_16x16x32_bf16 v[84:87], v[24:27], a[216:219], v[132:135]
    s_mov_b32 s30, s29
    v_cvt_pk_bf16_f32 v191, v18, v19
    v_mfma_f32_16x16x32_bf16 v[84:87], v[28:31], a[220:223], v[84:87]
    v_exp_f32 v16, v64
    v_mfma_f32_16x16x32_bf16 v[88:91], v[24:27], a[240:243], v[136:139]
    ds_read_b128 v[44:47], v3 offset:12416
    v_mfma_f32_16x16x32_bf16 v[88:91], v[28:31], a[244:247], v[88:91]
    buffer_load_dwordx3 v[152:154], v12, s[68:71], s35 offen offset:1536 nt
    v_mfma_f32_16x16x32_bf16 v[92:95], v[24:27], v[200:203], v[140:143]
    v_exp_f32 v17, v65
    v_mfma_f32_16x16x32_bf16 v[92:95], v[28:31], v[204:207], v[92:95]
    s_waitcnt lgkmcnt(2)
    v_exp_f32 v18, v66
    v_mfma_f32_16x16x32_bf16 v[112:115], v[32:35], a[192:195], v[128:131]
    ds_read_b128 v[24:27], v2 offset:18560
    v_add_f32 v5, v5, v16
    v_mfma_f32_16x16x32_bf16 v[112:115], v[36:39], a[196:199], v[112:115]
    buffer_load_dwordx4 v4, s[4:7], s32 offen offset:0 sc1 lds
    v_mfma_f32_16x16x32_bf16 v[116:119], v[32:35], a[216:219], v[132:135]
    v_add_f32 v5, v5, v17
    v_add_u32 v1, s3, v1
    v_mfma_f32_16x16x32_bf16 v[116:119], v[36:39], a[220:223], v[116:119]
    v_exp_f32 v19, v67
    v_mfma_f32_16x16x32_bf16 v[120:123], v[32:35], a[240:243], v[136:139]
    ds_read_b128 v[28:31], v3 offset:18560
    v_cvt_pk_bf16_f32 v64, v16, v17
    v_mfma_f32_16x16x32_bf16 v[120:123], v[36:39], a[244:247], v[120:123]
    s_waitcnt vmcnt(13)
    buffer_load_dwordx3 v[156:158], v12, s[68:71], s35 offen offset:2304 nt
    v_mfma_f32_16x16x32_bf16 v[124:127], v[32:35], v[200:203], v[140:143]
    v_exp_f32 v16, v96
    v_mfma_f32_16x16x32_bf16 v[124:127], v[36:39], v[204:207], v[124:127]
    s_waitcnt lgkmcnt(2)
    v_add_f32 v5, v5, v18
    v_add_f32 v5, v5, v19
    v_mfma_f32_16x16x32_bf16 v[80:83], v[40:43], a[200:203], v[80:83]
    ds_read_b128 v[32:35], v2 offset:12544
    v_lshlrev_b32 v48, 16, v60
    v_mfma_f32_16x16x32_bf16 v[80:83], v[44:47], a[204:207], v[80:83]
    v_exp_f32 v17, v97
    v_mfma_f32_16x16x32_bf16 v[84:87], v[40:43], a[224:227], v[84:87]
    v_cvt_pk_bf16_f32 v65, v18, v19
    v_and_b32 v49, s97, v60
    v_mfma_f32_16x16x32_bf16 v[84:87], v[44:47], a[228:231], v[84:87]
    buffer_load_dwordx4 v4, s[4:7], s32 offen offset:1024 sc1 lds
    v_mfma_f32_16x16x32_bf16 v[88:91], v[40:43], a[248:251], v[88:91]
    ds_read_b128 v[36:39], v3 offset:12544
    v_lshlrev_b32 v50, 16, v62
    v_mfma_f32_16x16x32_bf16 v[88:91], v[44:47], a[252:255], v[88:91]
    v_exp_f32 v18, v98
    v_mfma_f32_16x16x32_bf16 v[92:95], v[40:43], v[208:211], v[92:95]
    v_add_f32 v5, v5, v16
    v_add_f32 v5, v5, v17
    v_mfma_f32_16x16x32_bf16 v[92:95], v[44:47], v[212:215], v[92:95]
    s_waitcnt lgkmcnt(2)
    v_exp_f32 v19, v99
    v_mfma_f32_16x16x32_bf16 v[112:115], v[24:27], a[200:203], v[112:115]
    ds_read_b128 v[40:43], v2 offset:18688
    v_cvt_pk_bf16_f32 v66, v16, v17
    v_mfma_f32_16x16x32_bf16 v[112:115], v[28:31], a[204:207], v[112:115]
    v_exp_f32 v16, v68
    v_mfma_f32_16x16x32_bf16 v[116:119], v[24:27], a[224:227], v[116:119]
    v_add_f32 v5, v5, v18
    v_add_f32 v5, v5, v19
    v_mfma_f32_16x16x32_bf16 v[116:119], v[28:31], a[228:231], v[116:119]
    v_exp_f32 v17, v69
    v_mfma_f32_16x16x32_bf16 v[120:123], v[24:27], a[248:251], v[120:123]
    ds_read_b128 v[44:47], v3 offset:18688
    v_cvt_pk_bf16_f32 v67, v18, v19
    v_mfma_f32_16x16x32_bf16 v[120:123], v[28:31], a[252:255], v[120:123]
    s_waitcnt lgkmcnt(2)
    buffer_load_dwordx4 v4, s[4:7], s32 offen offset:2048 sc1 lds
    v_mfma_f32_16x16x32_bf16 v[124:127], v[24:27], v[208:211], v[124:127]
    s_waitcnt vmcnt(13)
    v_exp_f32 v18, v70
    v_mfma_f32_16x16x32_bf16 v[124:127], v[28:31], v[212:215], v[124:127]
    s_barrier
    v_add_f32 v6, v6, v16
    v_mfma_f32_16x16x32_bf16 v[80:83], v[32:35], a[208:211], v[80:83]
    ds_read_b128 v[24:27], v1 offset:0
    v_add_f32 v6, v6, v17
    v_mfma_f32_16x16x32_bf16 v[80:83], v[36:39], a[212:215], v[80:83]
    v_exp_f32 v19, v71
    v_mfma_f32_16x16x32_bf16 v[84:87], v[32:35], a[232:235], v[84:87]
    v_cvt_pk_bf16_f32 v68, v16, v17
    v_and_b32 v51, s97, v62
    v_mfma_f32_16x16x32_bf16 v[84:87], v[36:39], a[236:239], v[84:87]
    v_exp_f32 v16, v100
    v_mfma_f32_16x16x32_bf16 v[88:91], v[32:35], v[192:195], v[88:91]
    ds_read_b128 v[28:31], v1 offset:12288
    v_add_f32 v6, v6, v18
    v_mfma_f32_16x16x32_bf16 v[88:91], v[36:39], v[196:199], v[88:91]
    v_add_f32 v6, v6, v19
    v_mul_f32 v48, s38, v48
    v_mfma_f32_16x16x32_bf16 v[92:95], v[32:35], v[216:219], v[92:95]
    v_exp_f32 v17, v101
    v_mfma_f32_16x16x32_bf16 v[92:95], v[36:39], v[220:223], v[92:95]
    s_waitcnt lgkmcnt(2)
    v_cvt_pk_bf16_f32 v69, v18, v19
    v_mul_f32 v49, s38, v49
    v_mfma_f32_16x16x32_bf16 v[112:115], v[40:43], a[208:211], v[112:115]
    ds_read_b128 v[32:35], v1 offset:1024
    v_mfma_f32_16x16x32_bf16 v[112:115], v[44:47], a[212:215], v[112:115]
    v_exp_f32 v18, v102
    v_mfma_f32_16x16x32_bf16 v[116:119], v[40:43], a[232:235], v[116:119]
    v_add_f32 v6, v6, v16
    v_add_f32 v6, v6, v17
    v_mfma_f32_16x16x32_bf16 v[116:119], v[44:47], a[236:239], v[116:119]
    v_exp_f32 v19, v103
    v_mfma_f32_16x16x32_bf16 v[120:123], v[40:43], v[192:195], v[120:123]
    ds_read_b128 v[36:39], v1 offset:13312
    v_cvt_pk_bf16_f32 v70, v16, v17
    v_mfma_f32_16x16x32_bf16 v[120:123], v[44:47], v[196:199], v[120:123]
    s_add_u32 s32, s32, 24576
    v_add_f32 v6, v6, v18
    s_add_u32 s26, s26, 36864
    v_mfma_f32_16x16x32_bf16 v[124:127], v[40:43], v[216:219], v[124:127]
    s_sub_u32 s57, s26, 147456
    v_add_f32 v6, v6, v19
    v_cvt_pk_bf16_f32 v71, v18, v19
    v_mfma_f32_16x16x32_bf16 v[124:127], v[44:47], v[220:223], v[124:127]
    s_waitcnt lgkmcnt(2)
    s_min_u32 s26, s26, s57
    v_mfma_f32_16x16x32_bf16 a[0:3], v[160:163], v[24:27], a[0:3]
    ds_read_b128 v[40:43], v1 offset:2048
    v_mul_f32_e64 v50, -v50, v48
    v_mfma_f32_16x16x32_bf16 a[0:3], v[176:179], v[28:31], a[0:3]
    s_waitcnt vmcnt(12)
    v_subrev_u32 v52, s92, v52
    v_cmp_lt_u32 vcc, 15, v52
    v_mfma_f32_16x16x32_bf16 a[48:51], v[164:167], v[24:27], a[48:51]
    v_exp_f32 v16, v72
    v_mfma_f32_16x16x32_bf16 a[48:51], v[180:183], v[28:31], a[48:51]
    v_exp_f32 v17, v73
    v_mfma_f32_16x16x32_bf16 a[96:99], v[168:171], v[24:27], a[96:99]
    s_and_b32 s59, vcc_lo, 0xff
    ds_read_b128 v[44:47], v1 offset:14336
    v_mul_f32_e64 v51, -v51, v49
    v_mfma_f32_16x16x32_bf16 a[96:99], v[184:187], v[28:31], a[96:99]
    s_cbranch_scc1 L_pollslow2
L_pollok2:
    v_mfma_f32_16x16x32_bf16 a[144:147], v[172:175], v[24:27], a[144:147]
    s_add_u32 s92, s92, 1
    v_exp_f32 v18, v74
    v_mfma_f32_16x16x32_bf16 a[144:147], v[188:191], v[28:31], a[144:147]
    s_waitcnt lgkmcnt(2)
    v_add_f32 v7, v7, v16
    v_add_f32 v7, v7, v17
    v_mfma_f32_16x16x32_bf16 a[4:7], v[160:163], v[32:35], a[4:7]
    s_mov_b32 m0, s56
    ds_read_b128 v[24:27], v1 offset:3072
    v_cvt_f32_i32 v240, v240
    v_mfma_f32_16x16x32_bf16 a[4:7], v[176:179], v[36:39], a[4:7]
    buffer_load_dwordx4 v4, s[4:7], s27 offen offset:0 sc1 lds
    v_mfma_f32_16x16x32_bf16 a[52:55], v[164:167], v[32:35], a[52:55]
    v_exp_f32 v19, v75
    v_mfma_f32_16x16x32_bf16 a[52:55], v[180:183], v[36:39], a[52:55]
    v_cvt_pk_bf16_f32 v72, v16, v17
    v_cvt_f32_i32 v241, v241
    v_mfma_f32_16x16x32_bf16 a[100:103], v[168:171], v[32:35], a[100:103]
    ds_read_b128 v[28:31], v1 offset:15360
    v_fma_f32 v240, v240, v48, v50
    v_mfma_f32_16x16x32_bf16 a[100:103], v[184:187], v[36:39], a[100:103]
    v_exp_f32 v16, v104
    v_mfma_f32_16x16x32_bf16 a[148:151], v[172:175], v[32:35], a[148:151]
    v_add_f32 v7, v7, v18
    v_add_f32 v7, v7, v19
    v_mfma_f32_16x16x32_bf16 a[148:151], v[188:191], v[36:39], a[148:151]
    s_waitcnt lgkmcnt(2)
    v_exp_f32 v17, v105
    v_mfma_f32_16x16x32_bf16 a[8:11], v[160:163], v[40:43], a[8:11]
    ds_read_b128 v[32:35], v1 offset:4096
    v_cvt_pk_bf16_f32 v73, v18, v19
    v_mfma_f32_16x16x32_bf16 a[8:11], v[176:179], v[44:47], a[8:11]
    buffer_load_dwordx4 v4, s[4:7], s27 offen offset:1024 sc1 lds
    v_mfma_f32_16x16x32_bf16 a[56:59], v[164:167], v[40:43], a[56:59]
    v_exp_f32 v18, v106
    v_mfma_f32_16x16x32_bf16 a[56:59], v[180:183], v[44:47], a[56:59]
    v_add_f32 v7, v7, v16
    v_fma_f32 v241, v241, v49, v51
    v_mfma_f32_16x16x32_bf16 a[104:107], v[168:171], v[40:43], a[104:107]
    ds_read_b128 v[36:39], v1 offset:16384
    v_add_f32 v7, v7, v17
    v_mfma_f32_16x16x32_bf16 a[104:107], v[184:187], v[44:47], a[104:107]
    v_exp_f32 v19, v107
    v_mfma_f32_16x16x32_bf16 a[152:155], v[172:175], v[40:43], a[152:155]
    v_cvt_pk_bf16_f32 v74, v16, v17
    v_cvt_pk_bf16_f32 v226, v240, v241
    v_mfma_f32_16x16x32_bf16 a[152:155], v[188:191], v[44:47], a[152:155]
    s_waitcnt lgkmcnt(2)
    v_exp_f32 v16, v76
    v_mfma_f32_16x16x32_bf16 a[12:15], v[160:163], v[24:27], a[12:15]
    ds_read_b128 v[40:43], v1 offset:5120
    v_add_f32 v7, v7, v18
    v_mfma_f32_16x16x32_bf16 a[12:15], v[176:179], v[28:31], a[12:15]
    buffer_load_dwordx4 v4, s[4:7], s27 offen offset:2048 sc1 lds
    v_mfma_f32_16x16x32_bf16 a[60:63], v[164:167], v[24:27], a[60:63]
    v_add_f32 v7, v7, v19
    v_cvt_f32_i32 v244, v244
    v_mfma_f32_16x16x32_bf16 a[60:63], v[180:183], v[28:31], a[60:63]
    v_exp_f32 v17, v77
    v_mfma_f32_16x16x32_bf16 a[108:111], v[168:171], v[24:27], a[108:111]
    ds_read_b128 v[44:47], v1 offset:17408
    v_cvt_pk_bf16_f32 v75, v18, v19
    v_mfma_f32_16x16x32_bf16 a[108:111], v[184:187], v[28:31], a[108:111]
    v_exp_f32 v18, v78
    v_mfma_f32_16x16x32_bf16 a[156:159], v[172:175], v[24:27], a[156:159]
    s_add_u32 s29, s28, 49152
    v_cvt_f32_i32 v245, v245
    v_fma_f32 v244, v244, v48, v50
    v_mfma_f32_16x16x32_bf16 a[156:159], v[188:191], v[28:31], a[156:159]
    s_waitcnt lgkmcnt(2)
    v_add_f32 v8, v8, v16
    v_add_f32 v8, v8, v17
    v_mfma_f32_16x16x32_bf16 a[16:19], v[160:163], v[32:35], a[16:19]
    s_sub_u32 s3, s29, 147456
    ds_read_b128 v[24:27], v1 offset:6144
    v_fma_f32 v245, v245, v49, v51
    v_mfma_f32_16x16x32_bf16 a[16:19], v[176:179], v[36:39], a[16:19]
    s_add_u32 s27, s27, 24576
    v_exp_f32 v19, v79
    v_mfma_f32_16x16x32_bf16 a[64:67], v[164:167], v[32:35], a[64:67]
    s_min_u32 s29, s29, s3
    v_cvt_pk_bf16_f32 v76, v16, v17
    v_cvt_pk_bf16_f32 v230, v244, v245
    v_mfma_f32_16x16x32_bf16 a[64:67], v[180:183], v[36:39], a[64:67]
    s_add_u32 s56, s56, 12288
    v_exp_f32 v16, v108
    v_mfma_f32_16x16x32_bf16 a[112:115], v[168:171], v[32:35], a[112:115]
    ds_read_b128 v[28:31], v1 offset:18432
    v_add_f32 v8, v8, v18
    v_mfma_f32_16x16x32_bf16 a[112:115], v[184:187], v[36:39], a[112:115]
    v_add_f32 v8, v8, v19
    v_cvt_f32_i32 v248, v248
    v_mfma_f32_16x16x32_bf16 a[160:163], v[172:175], v[32:35], a[160:163]
    v_exp_f32 v17, v109
    v_mfma_f32_16x16x32_bf16 a[160:163], v[188:191], v[36:39], a[160:163]
    s_waitcnt lgkmcnt(2)
    v_cvt_f32_i32 v249, v249
    v_cvt_pk_bf16_f32 v77, v18, v19
    v_mfma_f32_16x16x32_bf16 a[20:23], v[160:163], v[40:43], a[20:23]
    s_mov_b32 m0, s56
    ds_read_b128 v[32:35], v1 offset:7168
    v_fma_f32 v248, v248, v48, v50
    v_mfma_f32_16x16x32_bf16 a[20:23], v[176:179], v[44:47], a[20:23]
    s_sub_u32 s3, s29, s28
    v_exp_f32 v18, v110
    v_mfma_f32_16x16x32_bf16 a[68:71], v[164:167], v[40:43], a[68:71]
    v_add_f32 v8, v8, v16
    v_add_f32 v8, v8, v17
    v_mfma_f32_16x16x32_bf16 a[68:71], v[180:183], v[44:47], a[68:71]
    v_exp_f32 v19, v111
    v_mfma_f32_16x16x32_bf16 a[116:119], v[168:171], v[40:43], a[116:119]
    ds_read_b128 v[36:39], v1 offset:19456
    v_fma_f32 v249, v249, v49, v51
    v_mfma_f32_16x16x32_bf16 a[116:119], v[184:187], v[44:47], a[116:119]
    buffer_load_dwordx4 v4, s[4:7], s27 offen offset:0 sc1 lds
    v_mfma_f32_16x16x32_bf16 a[164:167], v[172:175], v[40:43], a[164:167]
    s_mov_b32 s28, s29
    v_cvt_pk_bf16_f32 v78, v16, v17
    v_add_f32 v8, v8, v18
    v_mfma_f32_16x16x32_bf16 a[164:167], v[188:191], v[44:47], a[164:167]
    s_waitcnt lgkmcnt(2)
    v_add_f32 v8, v8, v19
    v_cvt_pk_bf16_f32 v234, v248, v249
    v_mfma_f32_16x16x32_bf16 a[24:27], v[160:163], v[24:27], a[24:27]
    ds_read_b128 v[40:43], v1 offset:8192
    v_cvt_pk_bf16_f32 v79, v18, v19
    v_mfma_f32_16x16x32_bf16 a[24:27], v[176:179], v[28:31], a[24:27]
    v_exp_f32 v16, v80
    v_mfma_f32_16x16x32_bf16 a[72:75], v[164:167], v[24:27], a[72:75]
    v_cvt_f32_i32 v252, v252
    v_cvt_f32_i32 v253, v253
    v_mfma_f32_16x16x32_bf16 a[72:75], v[180:183], v[28:31], a[72:75]
    v_exp_f32 v17, v81
    v_mfma_f32_16x16x32_bf16 a[120:123], v[168:171], v[24:27], a[120:123]
    ds_read_b128 v[44:47], v1 offset:20480
    v_fma_f32 v252, v252, v48, v50
    v_mfma_f32_16x16x32_bf16 a[120:123], v[184:187], v[28:31], a[120:123]
    v_exp_f32 v18, v82
    v_mfma_f32_16x16x32_bf16 a[168:171], v[172:175], v[24:27], a[168:171]
    v_add_f32 v5, v5, v16
    v_add_f32 v5, v5, v17
    v_mfma_f32_16x16x32_bf16 a[168:171], v[188:191], v[28:31], a[168:171]
    s_waitcnt lgkmcnt(2)
    buffer_load_dwordx4 v4, s[4:7], s27 offen offset:1024 sc1 lds
    v_mfma_f32_16x16x32_bf16 a[28:31], v[160:163], v[32:35], a[28:31]
    ds_read_b128 v[24:27], v1 offset:9216
    v_fma_f32 v253, v253, v49, v51
    v_mfma_f32_16x16x32_bf16 a[28:31], v[176:179], v[36:39], a[28:31]
    v_exp_f32 v19, v83
    v_mfma_f32_16x16x32_bf16 a[76:79], v[164:167], v[32:35], a[76:79]
    v_cvt_pk_bf16_f32 v80, v16, v17
    v_cvt_pk_bf16_f32 v238, v252, v253
    v_mfma_f32_16x16x32_bf16 a[76:79], v[180:183], v[36:39], a[76:79]
    v_exp_f32 v16, v112
    v_mfma_f32_16x16x32_bf16 a[124:127], v[168:171], v[32:35], a[124:127]
    ds_read_b128 v[28:31], v1 offset:21504
    v_add_f32 v5, v5, v18
    v_mfma_f32_16x16x32_bf16 a[124:127], v[184:187], v[36:39], a[124:127]
    v_add_f32 v5, v5, v19
    v_lshlrev_b32 v48, 16, v61
    v_mfma_f32_16x16x32_bf16 a[172:175], v[172:175], v[32:35], a[172:175]
    v_exp_f32 v17, v113
    v_mfma_f32_16x16x32_bf16 a[172:175], v[188:191], v[36:39], a[172:175]
    s_waitcnt lgkmcnt(2)
    buffer_load_dwordx4 v4, s[4:7], s27 offen offset:2048 sc1 lds
    v_mfma_f32_16x16x32_bf16 a[32:35], v[160:163], v[40:43], a[32:35]
    ds_read_b128 v[32:35], v1 offset:10240
    v_cvt_pk_bf16_f32 v81, v18, v19
    v_mfma_f32_16x16x32_bf16 a[32:35], v[176:179], v[44:47], a[32:35]
    v_exp_f32 v18, v114
    v_mfma_f32_16x16x32_bf16 a[80:83], v[164:167], v[40:43], a[80:83]
    v_add_f32 v5, v5, v16
    v_and_b32 v49, s97, v61
    v_mfma_f32_16x16x32_bf16 a[80:83], v[180:183], v[44:47], a[80:83]
    v_add_f32 v5, v5, v17
    v_lshlrev_b32 v50, 16, v63
    v_mfma_f32_16x16x32_bf16 a[128:131], v[168:171], v[40:43], a[128:131]
    ds_read_b128 v[36:39], v1 offset:22528
    v_add_u32 v2, s3, v2
    v_mfma_f32_16x16x32_bf16 a[128:131], v[184:187], v[44:47], a[128:131]
    v_exp_f32 v19, v115
    v_mfma_f32_16x16x32_bf16 a[176:179], v[172:175], v[40:43], a[176:179]
    v_cvt_pk_bf16_f32 v82, v16, v17
    v_and_b32 v51, s97, v63
    v_mfma_f32_16x16x32_bf16 a[176:179], v[188:191], v[44:47], a[176:179]
    s_waitcnt lgkmcnt(2)
    v_exp_f32 v16, v84
    v_mfma_f32_16x16x32_bf16 a[36:39], v[160:163], v[24:27], a[36:39]
    ds_read_b128 v[40:43], v1 offset:11264
    v_add_f32 v5, v5, v18
    v_mfma_f32_16x16x32_bf16 a[36:39], v[176:179], v[28:31], a[36:39]
    v_add_f32 v5, v5, v19
    v_mul_f32 v48, s38, v48
    v_mfma_f32_16x16x32_bf16 a[84:87], v[164:167], v[24:27], a[84:87]
    v_exp_f32 v17, v85
    v_mfma_f32_16x16x32_bf16 a[84:87], v[180:183], v[28:31], a[84:87]
    s_add_u32 s27, s27, 24576
    v_add_u32 v3, s3, v3
    v_cvt_pk_bf16_f32 v83, v18, v19
    v_mfma_f32_16x16x32_bf16 a[132:135], v[168:171], v[24:27], a[132:135]
    s_add_u32 s56, s56, 36864
    ds_read_b128 v[44:47], v1 offset:23552
    v_mul_f32 v49, s38, v49
    v_mfma_f32_16x16x32_bf16 a[132:135], v[184:187], v[28:31], a[132:135]
    s_sub_u32 s58, s56, 147456
    v_exp_f32 v18, v86
    v_mfma_f32_16x16x32_bf16 a[180:183], v[172:175], v[24:27], a[180:183]
    v_add_f32 v6, v6, v16
    v_add_f32 v6, v6, v17
    v_mfma_f32_16x16x32_bf16 a[180:183], v[188:191], v[28:31], a[180:183]
    s_waitcnt lgkmcnt(2)
    v_mul_f32_e64 v50, -v50, v48
    v_mul_f32_e64 v51, -v51, v49
    v_mfma_f32_16x16x32_bf16 a[40:43], v[160:163], v[32:35], a[40:43]
    s_min_u32 s56, s56, s58
    ds_read_b128 v[24:27], v2 offset:0
    v_cvt_f32_i32 v242, v242
    v_mfma_f32_16x16x32_bf16 a[40:43], v[176:179], v[36:39], a[40:43]
    v_exp_f32 v19, v87
    v_mfma_f32_16x16x32_bf16 a[88:91], v[164:167], v[32:35], a[88:91]
    v_cvt_pk_bf16_f32 v84, v16, v17
    v_cvt_f32_i32 v243, v243
    v_mfma_f32_16x16x32_bf16 a[88:91], v[180:183], v[36:39], a[88:91]
    v_exp_f32 v16, v116
    v_mfma_f32_16x16x32_bf16 a[136:139], v[168:171], v[32:35], a[136:139]
    ds_read_b128 v[28:31], v3 offset:0
    v_add_f32 v6, v6, v18
    v_mfma_f32_16x16x32_bf16 a[136:139], v[184:187], v[36:39], a[136:139]
    v_add_f32 v6, v6, v19
    v_fma_f32 v242, v242, v48, v50
    v_mfma_f32_16x16x32_bf16 a[184:187], v[172:175], v[32:35], a[184:187]
    v_exp_f32 v17, v117
    v_mfma_f32_16x16x32_bf16 a[184:187], v[188:191], v[36:39], a[184:187]
    s_waitcnt lgkmcnt(2)
    v_cvt_pk_bf16_f32 v85, v18, v19
    v_fma_f32 v243, v243, v49, v51
    v_mfma_f32_16x16x32_bf16 a[44:47], v[160:163], v[40:43], a[44:47]
    ds_read_b128 v[32:35], v2 offset:6144
    v_cvt_pk_bf16_f32 v227, v242, v243
    v_mfma_f32_16x16x32_bf16 a[44:47], v[176:179], v[44:47], a[44:47]
    v_exp_f32 v18, v118
    v_mfma_f32_16x16x32_bf16 a[92:95], v[164:167], v[40:43], a[92:95]
    v_add_f32 v6, v6, v16
    v_add_f32 v6, v6, v17
    v_mfma_f32_16x16x32_bf16 a[92:95], v[180:183], v[44:47], a[92:95]
    v_exp_f32 v19, v119
    v_mfma_f32_16x16x32_bf16 a[140:143], v[168:171], v[40:43], a[140:143]
    s_sub_u32 s31, s31, 1
    ds_read_b128 v[36:39], v3 offset:6144
    v_cvt_pk_bf16_f32 v86, v16, v17
    v_mfma_f32_16x16x32_bf16 a[140:143], v[184:187], v[44:47], a[140:143]
    v_add_f32 v6, v6, v18
    v_add_f32 v6, v6, v19
    v_mfma_f32_16x16x32_bf16 a[188:191], v[172:175], v[40:43], a[188:191]
    s_waitcnt lgkmcnt(2)
    s_cmp_lg_u32 s31, 0
    v_cvt_pk_bf16_f32 v87, v18, v19
    v_cvt_f32_i32 v246, v246
    v_mfma_f32_16x16x32_bf16 a[188:191], v[188:191], v[44:47], a[188:191]
    s_cbranch_scc1 L_loop
    v_mfma_f32_16x16x32_bf16 v[160:163], v[24:27], a[192:195], v[128:131]
L_pg7:
    s_cbranch_execz L_pg11
    s_mov_b32 m0, s56
    ds_read_b128 v[40:43], v2 offset:128
    v_cvt_f32_i32 v247, v247
    v_mfma_f32_16x16x32_bf16 v[160:163], v[28:31], a[196:199], v[160:163]
    buffer_load_dwordx4 v4, s[4:7], s27 offen offset:0 sc1 lds
    v_mfma_f32_16x16x32_bf16 v[164:167], v[24:27], a[216:219], v[132:135]
    v_exp_f32 v16, v88
    v_mfma_f32_16x16x32_bf16 v[164:167], v[28:31], a[220:223], v[164:167]
    v_exp_f32 v17, v89
    v_mfma_f32_16x16x32_bf16 v[168:171], v[24:27], a[240:243], v[136:139]
    ds_read_b128 v[44:47], v3 offset:128
    v_fma_f32 v246, v246, v48, v50
    v_mfma_f32_16x16x32_bf16 v[168:171], v[28:31], a[244:247], v[168:171]
    v_exp_f32 v18, v90
    v_mfma_f32_16x16x32_bf16 v[172:175], v[24:27], v[200:203], v[140:143]
    v_fma_f32 v247, v247, v49, v51
    v_add_f32 v7, v7, v16
    v_mfma_f32_16x16x32_bf16 v[172:175], v[28:31], v[204:207], v[172:175]
    s_waitcnt lgkmcnt(2)
    v_add_f32 v7, v7, v17
    v_cvt_pk_bf16_f32 v231, v246, v247
    v_mfma_f32_16x16x32_bf16 v[96:99], v[32:35], a[192:195], v[128:131]
    ds_read_b128 v[24:27], v2 offset:6272
    v_cvt_f32_i32 v250, v250
    v_mfma_f32_16x16x32_bf16 v[96:99], v[36:39], a[196:199], v[96:99]
    buffer_load_dwordx4 v4, s[4:7], s27 offen offset:1024 sc1 lds
    v_mfma_f32_16x16x32_bf16 v[100:103], v[32:35], a[216:219], v[132:135]
    v_exp_f32 v19, v91
    v_mfma_f32_16x16x32_bf16 v[100:103], v[36:39], a[220:223], v[100:103]
    v_cvt_pk_bf16_f32 v88, v16, v17
    v_cvt_f32_i32 v251, v251
    v_mfma_f32_16x16x32_bf16 v[104:107], v[32:35], a[240:243], v[136:139]
    ds_read_b128 v[28:31], v3 offset:6272
    v_fma_f32 v250, v250, v48, v50
    v_mfma_f32_16x16x32_bf16 v[104:107], v[36:39], a[244:247], v[104:107]
    v_exp_f32 v16, v120
    v_mfma_f32_16x16x32_bf16 v[108:111], v[32:35], v[200:203], v[140:143]
    v_add_f32 v7, v7, v18
    v_add_f32 v7, v7, v19
    v_mfma_f32_16x16x32_bf16 v[108:111], v[36:39], v[204:207], v[108:111]
    s_waitcnt lgkmcnt(2)
    v_exp_f32 v17, v121
    v_mfma_f32_16x16x32_bf16 v[160:163], v[40:43], a[200:203], v[160:163]
    ds_read_b128 v[32:35], v2 offset:256
    v_cvt_pk_bf16_f32 v89, v18, v19
    v_mfma_f32_16x16x32_bf16 v[160:163], v[44:47], a[204:207], v[160:163]
    v_exp_f32 v18, v122
    v_mfma_f32_16x16x32_bf16 v[164:167], v[40:43], a[224:227], v[164:167]
    v_fma_f32 v251, v251, v49, v51
    v_add_f32 v7, v7, v16
    v_mfma_f32_16x16x32_bf16 v[164:167], v[44:47], a[228:231], v[164:167]
    buffer_load_dwordx4 v4, s[4:7], s27 offen offset:2048 sc1 lds
    v_mfma_f32_16x16x32_bf16 v[168:171], v[40:43], a[248:251], v[168:171]
    ds_read_b128 v[36:39], v3 offset:256
    v_cvt_pk_bf16_f32 v235, v250, v251
    v_mfma_f32_16x16x32_bf16 v[168:171], v[44:47], a[252:255], v[168:171]
    v_add_f32 v7, v7, v17
    v_cvt_f32_i32 v254, v254
    v_mfma_f32_16x16x32_bf16 v[172:175], v[40:43], v[208:211], v[172:175]
    v_exp_f32 v19, v123
    v_mfma_f32_16x16x32_bf16 v[172:175], v[44:47], v[212:215], v[172:175]
    s_waitcnt lgkmcnt(2)
    v_cvt_pk_bf16_f32 v90, v16, v17
    v_cvt_f32_i32 v255, v255
    v_mfma_f32_16x16x32_bf16 v[96:99], v[24:27], a[200:203], v[96:99]
    ds_read_b128 v[40:43], v2 offset:6400
    v_fma_f32 v254, v254, v48, v50
    v_mfma_f32_16x16x32_bf16 v[96:99], v[28:31], a[204:207], v[96:99]
    s_add_u32 s27, s27, 24576
    v_exp_f32 v16, v92
    v_mfma_f32_16x16x32_bf16 v[100:103], v[24:27], a[224:227], v[100:103]
    v_add_f32 v7, v7, v18
    v_add_f32 v7, v7, v19
    v_mfma_f32_16x16x32_bf16 v[100:103], v[28:31], a[228:231], v[100:103]
    v_exp_f32 v17, v93
    v_mfma_f32_16x16x32_bf16 v[104:107], v[24:27], a[248:251], v[104:107]
    ds_read_b128 v[44:47], v3 offset:6400
    v_fma_f32 v255, v255, v49, v51
    v_mfma_f32_16x16x32_bf16 v[104:107], v[28:31], a[252:255], v[104:107]
    v_cvt_pk_bf16_f32 v91, v18, v19
    v_cvt_pk_bf16_f32 v239, v254, v255
    v_mfma_f32_16x16x32_bf16 v[108:111], v[24:27], v[208:211], v[108:111]
    s_add_u32 s29, s30, 49152
    v_exp_f32 v18, v94
    v_mfma_f32_16x16x32_bf16 v[108:111], v[28:31], v[212:215], v[108:111]
    s_waitcnt lgkmcnt(2)
    v_add_f32 v8, v8, v16
    v_add_f32 v8, v8, v17
    v_mfma_f32_16x16x32_bf16 v[160:163], v[32:35], a[208:211], v[160:163]
    s_waitcnt vmcnt(11)
    ds_read_b128 v[24:27], v2 offset:12288
    v_lshlrev_b32 v48, 16, v56
    v_mfma_f32_16x16x32_bf16 v[160:163], v[36:39], a[212:215], v[160:163]
    s_sub_u32 s3, s29, 147456
    buffer_load_dwordx2 v[60:61], off, s[80:83], s37 offset:8
    v_mfma_f32_16x16x32_bf16 v[164:167], v[32:35], a[232:235], v[164:167]
    s_add_u32 s56, s56, 12288
    v_exp_f32 v19, v95
    v_mfma_f32_16x16x32_bf16 v[164:167], v[36:39], a[236:239], v[164:167]
    s_min_u32 s29, s29, s3
    v_cvt_pk_bf16_f32 v92, v16, v17
    v_and_b32 v49, s97, v56
    v_mfma_f32_16x16x32_bf16 v[168:171], v[32:35], v[192:195], v[168:171]
    s_mov_b32 m0, s56
    ds_read_b128 v[28:31], v3 offset:12288
    v_mfma_f32_16x16x32_bf16 v[168:171], v[36:39], v[196:199], v[168:171]
    buffer_load_dwordx2 v[62:63], off, s[84:87], s37 offset:8
    v_mfma_f32_16x16x32_bf16 v[172:175], v[32:35], v[216:219], v[172:175]
    v_exp_f32 v16, v124
    v_mfma_f32_16x16x32_bf16 v[172:175], v[36:39], v[220:223], v[172:175]
    s_waitcnt lgkmcnt(2)
    v_add_f32 v8, v8, v18
    v_add_f32 v8, v8, v19
    v_mfma_f32_16x16x32_bf16 v[96:99], v[40:43], a[208:211], v[96:99]
    ds_read_b128 v[32:35], v2 offset:18432
    v_lshlrev_b32 v50, 16, v58
    v_mfma_f32_16x16x32_bf16 v[96:99], v[44:47], a[212:215], v[96:99]
    s_sub_u32 s3, s29, s30
    v_exp_f32 v17, v125
    v_mfma_f32_16x16x32_bf16 v[100:103], v[40:43], a[232:235], v[100:103]
    v_cvt_pk_bf16_f32 v93, v18, v19
    v_mfma_f32_16x16x32_bf16 v[100:103], v[44:47], a[236:239], v[100:103]
    buffer_load_dwordx4 v4, s[4:7], s27 offen offset:0 sc1 lds
    v_mfma_f32_16x16x32_bf16 v[104:107], v[40:43], v[192:195], v[104:107]
    ds_read_b128 v[36:39], v3 offset:18432
    v_mfma_f32_16x16x32_bf16 v[104:107], v[44:47], v[196:199], v[104:107]
    v_exp_f32 v18, v126
    v_mfma_f32_16x16x32_bf16 v[108:111], v[40:43], v[216:219], v[108:111]
    v_add_f32 v8, v8, v16
    v_add_f32 v8, v8, v17
    v_mfma_f32_16x16x32_bf16 v[108:111], v[44:47], v[220:223], v[108:111]
    s_waitcnt lgkmcnt(2)
    buffer_load_dwordx3 v[240:242], v12, s[68:71], s16 offen offset:0 nt
    v_mfma_f32_16x16x32_bf16 v[176:179], v[24:27], a[192:195], v[128:131]
    ds_read_b128 v[40:43], v2 offset:12416
    v_and_b32 v51, s97, v58
    v_mfma_f32_16x16x32_bf16 v[176:179], v[28:31], a[196:199], v[176:179]
    v_exp_f32 v19, v127
    v_cvt_pk_bf16_f32 v94, v16, v17
    v_mfma_f32_16x16x32_bf16 v[180:183], v[24:27], a[216:219], v[132:135]
    s_mov_b32 s30, s29
    v_add_f32 v8, v8, v18
    v_add_f32 v8, v8, v19
    v_mfma_f32_16x16x32_bf16 v[180:183], v[28:31], a[220:223], v[180:183]
    buffer_load_dwordx4 v4, s[4:7], s27 offen offset:1024 sc1 lds
    v_mfma_f32_16x16x32_bf16 v[184:187], v[24:27], a[240:243], v[136:139]
    ds_read_b128 v[44:47], v3 offset:12416
    v_cvt_pk_bf16_f32 v95, v18, v19
    v_mfma_f32_16x16x32_bf16 v[184:187], v[28:31], a[244:247], v[184:187]
    v_exp_f32 v16, v160
    v_mfma_f32_16x16x32_bf16 v[188:191], v[24:27], v[200:203], v[140:143]
    v_exp_f32 v17, v161
    v_mfma_f32_16x16x32_bf16 v[188:191], v[28:31], v[204:207], v[188:191]
    s_waitcnt lgkmcnt(2)
    buffer_load_dwordx3 v[244:246], v12, s[68:71], s16 offen offset:768 nt
    v_mfma_f32_16x16x32_bf16 v[112:115], v[32:35], a[192:195], v[128:131]
    ds_read_b128 v[24:27], v2 offset:18560
    v_mul_f32_e64 v50, -v50, v48
    v_mfma_f32_16x16x32_bf16 v[112:115], v[36:39], a[196:199], v[112:115]
    v_exp_f32 v18, v162
    v_mfma_f32_16x16x32_bf16 v[116:119], v[32:35], a[216:219], v[132:135]
    v_add_f32 v5, v5, v16
    v_add_f32 v5, v5, v17
    v_mfma_f32_16x16x32_bf16 v[116:119], v[36:39], a[220:223], v[116:119]
    v_exp_f32 v19, v163
    v_mfma_f32_16x16x32_bf16 v[120:123], v[32:35], a[240:243], v[136:139]
    ds_read_b128 v[28:31], v3 offset:18560
    v_cvt_pk_bf16_f32 v160, v16, v17
    v_mfma_f32_16x16x32_bf16 v[120:123], v[36:39], a[244:247], v[120:123]
    buffer_load_dwordx3 v[248:250], v12, s[68:71], s16 offen offset:1536 nt
    v_mfma_f32_16x16x32_bf16 v[124:127], v[32:35], v[200:203], v[140:143]
    v_exp_f32 v16, v96
    v_mfma_f32_16x16x32_bf16 v[124:127], v[36:39], v[204:207], v[124:127]
    s_waitcnt lgkmcnt(2)
    v_add_f32 v5, v5, v18
    v_add_f32 v5, v5, v19
    v_mfma_f32_16x16x32_bf16 v[176:179], v[40:43], a[200:203], v[176:179]
    ds_read_b128 v[32:35], v2 offset:12544
    v_mul_f32_e64 v51, -v51, v49
    v_mfma_f32_16x16x32_bf16 v[176:179], v[44:47], a[204:207], v[176:179]
    buffer_load_dwordx4 v4, s[4:7], s27 offen offset:2048 sc1 lds
    v_mfma_f32_16x16x32_bf16 v[180:183], v[40:43], a[224:227], v[180:183]
    v_exp_f32 v17, v97
    v_mfma_f32_16x16x32_bf16 v[180:183], v[44:47], a[228:231], v[180:183]
    v_cvt_pk_bf16_f32 v161, v18, v19
    v_add_u32 v1, s3, v1
    v_mfma_f32_16x16x32_bf16 v[184:187], v[40:43], a[248:251], v[184:187]
    ds_read_b128 v[36:39], v3 offset:12544
    v_cvt_f32_i32 v144, v144
    v_mfma_f32_16x16x32_bf16 v[184:187], v[44:47], a[252:255], v[184:187]
    buffer_load_dwordx3 v[252:254], v12, s[68:71], s16 offen offset:2304 nt
    v_mfma_f32_16x16x32_bf16 v[188:191], v[40:43], v[208:211], v[188:191]
    v_exp_f32 v18, v98
    v_mfma_f32_16x16x32_bf16 v[188:191], v[44:47], v[212:215], v[188:191]
    s_waitcnt lgkmcnt(2)
    v_add_f32 v5, v5, v16
    v_add_f32 v5, v5, v17
    v_mfma_f32_16x16x32_bf16 v[112:115], v[24:27], a[200:203], v[112:115]
    ds_read_b128 v[40:43], v2 offset:18688
    v_cvt_f32_i32 v148, v148
    v_mfma_f32_16x16x32_bf16 v[112:115], v[28:31], a[204:207], v[112:115]
    v_exp_f32 v19, v99
    v_cvt_pk_bf16_f32 v162, v16, v17
    v_mfma_f32_16x16x32_bf16 v[116:119], v[24:27], a[224:227], v[116:119]
    v_exp_f32 v16, v164
    v_mfma_f32_16x16x32_bf16 v[116:119], v[28:31], a[228:231], v[116:119]
    s_add_u32 s27, s27, 24576
    v_add_f32 v5, v5, v18
    v_add_f32 v5, v5, v19
    v_mfma_f32_16x16x32_bf16 v[120:123], v[24:27], a[248:251], v[120:123]
    s_add_u32 s56, s56, 36864
    ds_read_b128 v[44:47], v3 offset:18688
    v_fma_f32 v144, v144, v48, v50
    v_mfma_f32_16x16x32_bf16 v[120:123], v[28:31], a[252:255], v[120:123]
    s_waitcnt lgkmcnt(2)
    v_exp_f32 v17, v165
    v_mfma_f32_16x16x32_bf16 v[124:127], v[24:27], v[208:211], v[124:127]
    s_waitcnt vmcnt(12)
    v_cvt_pk_bf16_f32 v163, v18, v19
    s_sub_u32 s58, s56, 147456
    v_mfma_f32_16x16x32_bf16 v[124:127], v[28:31], v[212:215], v[124:127]
    s_barrier
    s_min_u32 s56, s56, s58
    v_mfma_f32_16x16x32_bf16 v[176:179], v[32:35], a[208:211], v[176:179]
    ds_read_b128 v[24:27], v1 offset:0
    v_mfma_f32_16x16x32_bf16 v[176:179], v[36:39], a[212:215], v[176:179]
    v_exp_f32 v18, v166
    v_mfma_f32_16x16x32_bf16 v[180:183], v[32:35], a[232:235], v[180:183]
    v_add_f32 v6, v6, v16
    v_add_f32 v6, v6, v17
    v_mfma_f32_16x16x32_bf16 v[180:183], v[36:39], a[236:239], v[180:183]
    v_exp_f32 v19, v167
    v_mfma_f32_16x16x32_bf16 v[184:187], v[32:35], v[192:195], v[184:187]
    ds_read_b128 v[28:31], v1 offset:12288
    v_cvt_pk_bf16_f32 v164, v16, v17
    v_mfma_f32_16x16x32_bf16 v[184:187], v[36:39], v[196:199], v[184:187]
    v_exp_f32 v16, v100
    v_mfma_f32_16x16x32_bf16 v[188:191], v[32:35], v[216:219], v[188:191]
    v_add_f32 v6, v6, v18
    v_add_f32 v6, v6, v19
    v_mfma_f32_16x16x32_bf16 v[188:191], v[36:39], v[220:223], v[188:191]
    s_waitcnt lgkmcnt(2)
    v_exp_f32 v17, v101
    v_mfma_f32_16x16x32_bf16 v[112:115], v[40:43], a[208:211], v[112:115]
    ds_read_b128 v[32:35], v1 offset:1024
    v_cvt_pk_bf16_f32 v165, v18, v19
    v_mfma_f32_16x16x32_bf16 v[112:115], v[44:47], a[212:215], v[112:115]
    v_exp_f32 v18, v102
    v_mfma_f32_16x16x32_bf16 v[116:119], v[40:43], a[232:235], v[116:119]
    v_add_f32 v6, v6, v16
    v_add_f32 v6, v6, v17
    v_mfma_f32_16x16x32_bf16 v[116:119], v[44:47], a[236:239], v[116:119]
    v_exp_f32 v19, v103
    v_mfma_f32_16x16x32_bf16 v[120:123], v[40:43], v[192:195], v[120:123]
    ds_read_b128 v[36:39], v1 offset:13312
    v_cvt_pk_bf16_f32 v166, v16, v17
    v_mfma_f32_16x16x32_bf16 v[120:123], v[44:47], v[196:199], v[120:123]
    v_add_f32 v6, v6, v18
    v_fma_f32 v148, v148, v49, v51
    v_mfma_f32_16x16x32_bf16 v[124:127], v[40:43], v[216:219], v[124:127]
    v_add_f32 v6, v6, v19
    v_cvt_pk_bf16_f32 v167, v18, v19
    v_mfma_f32_16x16x32_bf16 v[124:127], v[44:47], v[220:223], v[124:127]
    s_waitcnt lgkmcnt(2)
    v_mfma_f32_16x16x32_bf16 a[0:3], v[64:67], v[24:27], a[0:3]
    ds_read_b128 v[40:43], v1 offset:2048
    v_cvt_f32_i32 v145, v145
    v_mfma_f32_16x16x32_bf16 a[0:3], v[80:83], v[28:31], a[0:3]
    buffer_store_dwordx4 v[224:227], v11, s[4:7], s33 offen offset:0 sc1
    v_mfma_f32_16x16x32_bf16 a[48:51], v[68:71], v[24:27], a[48:51]
    v_exp_f32 v16, v168
    v_mfma_f32_16x16x32_bf16 a[48:51], v[84:87], v[28:31], a[48:51]
    v_exp_f32 v17, v169
    v_mfma_f32_16x16x32_bf16 a[96:99], v[72:75], v[24:27], a[96:99]
    ds_read_b128 v[44:47], v1 offset:14336
    v_cvt_f32_i32 v149, v149
    v_mfma_f32_16x16x32_bf16 a[96:99], v[88:91], v[28:31], a[96:99]
    v_exp_f32 v18, v170
    v_mfma_f32_16x16x32_bf16 a[144:147], v[76:79], v[24:27], a[144:147]
    v_add_f32 v7, v7, v16
    v_add_f32 v7, v7, v17
    v_mfma_f32_16x16x32_bf16 a[144:147], v[92:95], v[28:31], a[144:147]
    s_waitcnt lgkmcnt(2)
    v_exp_f32 v19, v171
    v_mfma_f32_16x16x32_bf16 a[4:7], v[64:67], v[32:35], a[4:7]
    ds_read_b128 v[24:27], v1 offset:3072
    v_cvt_pk_bf16_f32 v168, v16, v17
    v_mfma_f32_16x16x32_bf16 a[4:7], v[80:83], v[36:39], a[4:7]
    buffer_store_dwordx4 v[228:231], v21, s[4:7], s33 offen offset:768 sc1
    v_mfma_f32_16x16x32_bf16 a[52:55], v[68:71], v[32:35], a[52:55]
    v_exp_f32 v16, v104
    v_mfma_f32_16x16x32_bf16 a[52:55], v[84:87], v[36:39], a[52:55]
    v_add_f32 v7, v7, v18
    v_fma_f32 v145, v145, v48, v50
    v_mfma_f32_16x16x32_bf16 a[100:103], v[72:75], v[32:35], a[100:103]
    ds_read_b128 v[28:31], v1 offset:15360
    v_add_f32 v7, v7, v19
    v_mfma_f32_16x16x32_bf16 a[100:103], v[88:91], v[36:39], a[100:103]
    v_exp_f32 v17, v105
    v_mfma_f32_16x16x32_bf16 a[148:151], v[76:79], v[32:35], a[148:151]
    v_cvt_pk_bf16_f32 v169, v18, v19
    v_fma_f32 v149, v149, v49, v51
    v_mfma_f32_16x16x32_bf16 a[148:151], v[92:95], v[36:39], a[148:151]
    s_waitcnt lgkmcnt(2)
    v_exp_f32 v18, v106
    v_mfma_f32_16x16x32_bf16 a[8:11], v[64:67], v[40:43], a[8:11]
    ds_read_b128 v[32:35], v1 offset:4096
    v_add_f32 v7, v7, v16
    v_mfma_f32_16x16x32_bf16 a[8:11], v[80:83], v[44:47], a[8:11]
    buffer_store_dwordx4 v[232:235], v22, s[4:7], s33 offen offset:1536 sc1
    v_mfma_f32_16x16x32_bf16 a[56:59], v[68:71], v[40:43], a[56:59]
    v_add_f32 v7, v7, v17
    v_cvt_f32_i32 v146, v146
    v_mfma_f32_16x16x32_bf16 a[56:59], v[84:87], v[44:47], a[56:59]
    v_exp_f32 v19, v107
    v_mfma_f32_16x16x32_bf16 a[104:107], v[72:75], v[40:43], a[104:107]
    ds_read_b128 v[36:39], v1 offset:16384
    v_cvt_pk_bf16_f32 v170, v16, v17
    v_mfma_f32_16x16x32_bf16 a[104:107], v[88:91], v[44:47], a[104:107]
    v_exp_f32 v16, v172
    v_mfma_f32_16x16x32_bf16 a[152:155], v[76:79], v[40:43], a[152:155]
    v_add_f32 v7, v7, v18
    v_cvt_f32_i32 v150, v150
    v_mfma_f32_16x16x32_bf16 a[152:155], v[92:95], v[44:47], a[152:155]
    s_waitcnt lgkmcnt(2)
    v_add_f32 v7, v7, v19
    v_fma_f32 v146, v146, v48, v50
    v_mfma_f32_16x16x32_bf16 a[12:15], v[64:67], v[24:27], a[12:15]
    ds_read_b128 v[40:43], v1 offset:5120
    v_mfma_f32_16x16x32_bf16 a[12:15], v[80:83], v[28:31], a[12:15]
    buffer_store_dwordx4 v[236:239], v23, s[4:7], s33 offen offset:2304 sc1
    v_mfma_f32_16x16x32_bf16 a[60:63], v[68:71], v[24:27], a[60:63]
    v_exp_f32 v17, v173
    v_mfma_f32_16x16x32_bf16 a[60:63], v[84:87], v[28:31], a[60:63]
    v_cvt_pk_bf16_f32 v171, v18, v19
    v_fma_f32 v150, v150, v49, v51
    v_mfma_f32_16x16x32_bf16 a[108:111], v[72:75], v[24:27], a[108:111]
    ds_read_b128 v[44:47], v1 offset:17408
    v_mfma_f32_16x16x32_bf16 a[108:111], v[88:91], v[28:31], a[108:111]
    v_exp_f32 v18, v174
    v_mfma_f32_16x16x32_bf16 a[156:159], v[76:79], v[24:27], a[156:159]
    s_add_u32 s29, s28, 49152
    v_add_f32 v8, v8, v16
    v_add_f32 v8, v8, v17
    v_mfma_f32_16x16x32_bf16 a[156:159], v[92:95], v[28:31], a[156:159]
    s_waitcnt lgkmcnt(2)
    v_exp_f32 v19, v175
    v_mfma_f32_16x16x32_bf16 a[16:19], v[64:67], v[32:35], a[16:19]
    s_sub_u32 s3, s29, 147456
    ds_read_b128 v[24:27], v1 offset:6144
    v_cvt_pk_bf16_f32 v172, v16, v17
    v_mfma_f32_16x16x32_bf16 a[16:19], v[80:83], v[36:39], a[16:19]
    s_mov_b32 m0, s26
    v_exp_f32 v16, v108
    v_mfma_f32_16x16x32_bf16 a[64:67], v[68:71], v[32:35], a[64:67]
    s_min_u32 s29, s29, s3
    v_add_f32 v8, v8, v18
    v_lshlrev_b32 v48, 16, v57
    v_mfma_f32_16x16x32_bf16 a[64:67], v[84:87], v[36:39], a[64:67]
    buffer_load_dwordx4 v4, s[4:7], s32 offen offset:0 sc1 lds
    v_mfma_f32_16x16x32_bf16 a[112:115], v[72:75], v[32:35], a[112:115]
    ds_read_b128 v[28:31], v1 offset:18432
    v_add_f32 v8, v8, v19
    v_mfma_f32_16x16x32_bf16 a[112:115], v[88:91], v[36:39], a[112:115]
    v_exp_f32 v17, v109
    v_mfma_f32_16x16x32_bf16 a[160:163], v[76:79], v[32:35], a[160:163]
    v_cvt_pk_bf16_f32 v173, v18, v19
    v_and_b32 v49, s97, v57
    v_mfma_f32_16x16x32_bf16 a[160:163], v[92:95], v[36:39], a[160:163]
    s_waitcnt lgkmcnt(2)
    buffer_load_dwordx4 v4, s[4:7], s32 offen offset:1024 sc1 lds
    v_mfma_f32_16x16x32_bf16 a[20:23], v[64:67], v[40:43], a[20:23]
    s_sub_u32 s3, s29, s28
    ds_read_b128 v[32:35], v1 offset:7168
    v_lshlrev_b32 v50, 16, v59
    v_mfma_f32_16x16x32_bf16 a[20:23], v[80:83], v[44:47], a[20:23]
    v_exp_f32 v18, v110
    v_mfma_f32_16x16x32_bf16 a[68:71], v[68:71], v[40:43], a[68:71]
    v_add_f32 v8, v8, v16
    v_add_f32 v8, v8, v17
    v_mfma_f32_16x16x32_bf16 a[68:71], v[84:87], v[44:47], a[68:71]
    buffer_load_dwordx4 v4, s[4:7], s32 offen offset:2048 sc1 lds
    v_mfma_f32_16x16x32_bf16 a[116:119], v[72:75], v[40:43], a[116:119]
    ds_read_b128 v[36:39], v1 offset:19456
    v_mfma_f32_16x16x32_bf16 a[116:119], v[88:91], v[44:47], a[116:119]
    v_exp_f32 v19, v111
    v_mfma_f32_16x16x32_bf16 a[164:167], v[76:79], v[40:43], a[164:167]
    s_mov_b32 s28, s29
    v_cvt_pk_bf16_f32 v174, v16, v17
    v_add_f32 v8, v8, v18
    v_mfma_f32_16x16x32_bf16 a[164:167], v[92:95], v[44:47], a[164:167]
    s_waitcnt lgkmcnt(2)
    v_add_f32 v8, v8, v19
    v_cvt_pk_bf16_f32 v175, v18, v19
    v_mfma_f32_16x16x32_bf16 a[24:27], v[64:67], v[24:27], a[24:27]
    s_add_u32 s32, s32, 24576
    ds_read_b128 v[40:43], v1 offset:8192
    v_and_b32 v51, s97, v59
    v_mfma_f32_16x16x32_bf16 a[24:27], v[80:83], v[28:31], a[24:27]
    v_exp_f32 v16, v176
    v_mfma_f32_16x16x32_bf16 a[72:75], v[68:71], v[24:27], a[72:75]
    s_add_u32 s26, s26, 12288
    v_exp_f32 v17, v177
    v_mfma_f32_16x16x32_bf16 a[72:75], v[84:87], v[28:31], a[72:75]
    v_exp_f32 v18, v178
    v_mfma_f32_16x16x32_bf16 a[120:123], v[72:75], v[24:27], a[120:123]
    s_mov_b32 m0, s26
    ds_read_b128 v[44:47], v1 offset:20480
    v_add_f32 v5, v5, v16
    v_mfma_f32_16x16x32_bf16 a[120:123], v[88:91], v[28:31], a[120:123]
    v_add_f32 v5, v5, v17
    v_mul_f32_e64 v50, -v50, v48
    v_mfma_f32_16x16x32_bf16 a[168:171], v[76:79], v[24:27], a[168:171]
    v_exp_f32 v19, v179
    v_mfma_f32_16x16x32_bf16 a[168:171], v[92:95], v[28:31], a[168:171]
    s_waitcnt lgkmcnt(2)
    v_cvt_pk_bf16_f32 v176, v16, v17
    v_mul_f32_e64 v51, -v51, v49
    v_mfma_f32_16x16x32_bf16 a[28:31], v[64:67], v[32:35], a[28:31]
    ds_read_b128 v[24:27], v1 offset:9216
    v_add_u32 v2, s3, v2
    v_mfma_f32_16x16x32_bf16 a[28:31], v[80:83], v[36:39], a[28:31]
    buffer_load_dwordx4 v4, s[4:7], s32 offen offset:0 sc1 lds
    v_mfma_f32_16x16x32_bf16 a[76:79], v[68:71], v[32:35], a[76:79]
    v_exp_f32 v16, v112
    v_mfma_f32_16x16x32_bf16 a[76:79], v[84:87], v[36:39], a[76:79]
    v_add_f32 v5, v5, v18
    v_add_f32 v5, v5, v19
    v_mfma_f32_16x16x32_bf16 a[124:127], v[72:75], v[32:35], a[124:127]
    ds_read_b128 v[28:31], v1 offset:21504
    v_cvt_f32_i32 v152, v152
    v_mfma_f32_16x16x32_bf16 a[124:127], v[88:91], v[36:39], a[124:127]
    buffer_load_dwordx4 v4, s[4:7], s32 offen offset:1024 sc1 lds
    v_mfma_f32_16x16x32_bf16 a[172:175], v[76:79], v[32:35], a[172:175]
    v_exp_f32 v17, v113
    v_mfma_f32_16x16x32_bf16 a[172:175], v[92:95], v[36:39], a[172:175]
    s_waitcnt lgkmcnt(2)
    v_cvt_pk_bf16_f32 v177, v18, v19
    v_add_u32 v3, s3, v3
    v_mfma_f32_16x16x32_bf16 a[32:35], v[64:67], v[40:43], a[32:35]
    ds_read_b128 v[32:35], v1 offset:10240
    v_cvt_f32_i32 v156, v156
    v_mfma_f32_16x16x32_bf16 a[32:35], v[80:83], v[44:47], a[32:35]
    v_exp_f32 v18, v114
    v_mfma_f32_16x16x32_bf16 a[80:83], v[68:71], v[40:43], a[80:83]
    v_add_f32 v5, v5, v16
    v_add_f32 v5, v5, v17
    v_mfma_f32_16x16x32_bf16 a[80:83], v[84:87], v[44:47], a[80:83]
    buffer_load_dwordx4 v4, s[4:7], s32 offen offset:2048 sc1 lds
    v_mfma_f32_16x16x32_bf16 a[128:131], v[72:75], v[40:43], a[128:131]
    ds_read_b128 v[36:39], v1 offset:22528
    v_mfma_f32_16x16x32_bf16 a[128:131], v[88:91], v[44:47], a[128:131]
    v_exp_f32 v19, v115
    v_mfma_f32_16x16x32_bf16 a[176:179], v[76:79], v[40:43], a[176:179]
    v_cvt_pk_bf16_f32 v178, v16, v17
    v_fma_f32 v152, v152, v48, v50
    v_mfma_f32_16x16x32_bf16 a[176:179], v[92:95], v[44:47], a[176:179]
    s_waitcnt lgkmcnt(2)
    v_exp_f32 v16, v180
    v_mfma_f32_16x16x32_bf16 a[36:39], v[64:67], v[24:27], a[36:39]
    ds_read_b128 v[40:43], v1 offset:11264
    v_add_f32 v5, v5, v18
    v_mfma_f32_16x16x32_bf16 a[36:39], v[80:83], v[28:31], a[36:39]
    v_add_f32 v5, v5, v19
    v_mfma_f32_16x16x32_bf16 a[84:87], v[68:71], v[24:27], a[84:87]
    v_exp_f32 v17, v181
    v_mfma_f32_16x16x32_bf16 a[84:87], v[84:87], v[28:31], a[84:87]
    s_add_u32 s32, s32, 24576
    v_cvt_pk_bf16_f32 v179, v18, v19
    s_add_u32 s26, s26, 36864
    v_mfma_f32_16x16x32_bf16 a[132:135], v[72:75], v[24:27], a[132:135]
    s_sub_u32 s57, s26, 147456
    ds_read_b128 v[44:47], v1 offset:23552
    v_fma_f32 v156, v156, v49, v51
    v_mfma_f32_16x16x32_bf16 a[132:135], v[88:91], v[28:31], a[132:135]
    s_waitcnt lgkmcnt(2)
    v_exp_f32 v18, v182
    v_mfma_f32_16x16x32_bf16 a[180:183], v[76:79], v[24:27], a[180:183]
    s_waitcnt vmcnt(6)
    v_add_f32 v6, v6, v16
    v_add_f32 v6, v6, v17
    v_mfma_f32_16x16x32_bf16 a[180:183], v[92:95], v[28:31], a[180:183]
    s_barrier
    v_cvt_f32_i32 v153, v153
    v_mfma_f32_16x16x32_bf16 a[40:43], v[64:67], v[32:35], a[40:43]
    s_min_u32 s26, s26, s57
    ds_read_b128 v[24:27], v2 offset:0
    v_add_u32 v0, 1, v0
    v_mfma_f32_16x16x32_bf16 a[40:43], v[80:83], v[36:39], a[40:43]
    buffer_store_dword v0, v13, s[20:23], 0 offen offset:32 sc1
    v_mfma_f32_16x16x32_bf16 a[88:91], v[68:71], v[32:35], a[88:91]
    v_exp_f32 v19, v183
    v_mfma_f32_16x16x32_bf16 a[88:91], v[84:87], v[36:39], a[88:91]
    v_cvt_pk_bf16_f32 v180, v16, v17
    v_cvt_f32_i32 v157, v157
    v_mfma_f32_16x16x32_bf16 a[136:139], v[72:75], v[32:35], a[136:139]
    ds_read_b128 v[28:31], v3 offset:0
    v_mfma_f32_16x16x32_bf16 a[136:139], v[88:91], v[36:39], a[136:139]
    v_exp_f32 v16, v116
    v_mfma_f32_16x16x32_bf16 a[184:187], v[76:79], v[32:35], a[184:187]
    v_add_f32 v6, v6, v18
    v_add_f32 v6, v6, v19
    v_mfma_f32_16x16x32_bf16 a[184:187], v[92:95], v[36:39], a[184:187]
    s_waitcnt lgkmcnt(2)
    v_exp_f32 v17, v117
    v_mfma_f32_16x16x32_bf16 a[44:47], v[64:67], v[40:43], a[44:47]
    ds_read_b128 v[32:35], v2 offset:6144
    v_cvt_pk_bf16_f32 v181, v18, v19
    v_mfma_f32_16x16x32_bf16 a[44:47], v[80:83], v[44:47], a[44:47]
    v_exp_f32 v18, v118
    v_mfma_f32_16x16x32_bf16 a[92:95], v[68:71], v[40:43], a[92:95]
    v_add_f32 v6, v6, v16
    v_add_f32 v6, v6, v17
    v_mfma_f32_16x16x32_bf16 a[92:95], v[84:87], v[44:47], a[92:95]
    v_exp_f32 v19, v119
    v_mfma_f32_16x16x32_bf16 a[140:143], v[72:75], v[40:43], a[140:143]
    ds_read_b128 v[36:39], v3 offset:6144
    v_cvt_pk_bf16_f32 v182, v16, v17
    v_mfma_f32_16x16x32_bf16 a[140:143], v[88:91], v[44:47], a[140:143]
    v_add_f32 v6, v6, v18
    v_add_f32 v6, v6, v19
    v_mfma_f32_16x16x32_bf16 a[188:191], v[76:79], v[40:43], a[188:191]
    v_cvt_pk_bf16_f32 v183, v18, v19
    v_mfma_f32_16x16x32_bf16 a[188:191], v[92:95], v[44:47], a[188:191]
    s_waitcnt lgkmcnt(2)
    v_mfma_f32_16x16x32_bf16 v[64:67], v[24:27], a[192:195], v[128:131]
    s_mov_b32 m0, s56
    ds_read_b128 v[40:43], v2 offset:128
    v_fma_f32 v153, v153, v48, v50
    v_mfma_f32_16x16x32_bf16 v[64:67], v[28:31], a[196:199], v[64:67]
    buffer_load_dwordx4 v4, s[4:7], s27 offen offset:0 sc1 lds
    v_mfma_f32_16x16x32_bf16 v[68:71], v[24:27], a[216:219], v[132:135]
    v_exp_f32 v16, v184
    v_mfma_f32_16x16x32_bf16 v[68:71], v[28:31], a[220:223], v[68:71]
    v_exp_f32 v17, v185
    v_mfma_f32_16x16x32_bf16 v[72:75], v[24:27], a[240:243], v[136:139]
    ds_read_b128 v[44:47], v3 offset:128
    v_fma_f32 v157, v157, v49, v51
    v_mfma_f32_16x16x32_bf16 v[72:75], v[28:31], a[244:247], v[72:75]
    v_exp_f32 v18, v186
    v_mfma_f32_16x16x32_bf16 v[76:79], v[24:27], v[200:203], v[140:143]
    v_add_f32 v7, v7, v16
    v_add_f32 v7, v7, v17
    v_mfma_f32_16x16x32_bf16 v[76:79], v[28:31], v[204:207], v[76:79]
    s_waitcnt lgkmcnt(2)
    v_exp_f32 v19, v187
    v_mfma_f32_16x16x32_bf16 v[96:99], v[32:35], a[192:195], v[128:131]
    ds_read_b128 v[24:27], v2 offset:6272
    v_cvt_pk_bf16_f32 v184, v16, v17
    v_mfma_f32_16x16x32_bf16 v[96:99], v[36:39], a[196:199], v[96:99]
    v_exp_f32 v16, v120
    v_mfma_f32_16x16x32_bf16 v[100:103], v[32:35], a[216:219], v[132:135]
    v_cvt_f32_i32 v154, v154
    v_add_f32 v7, v7, v18
    v_mfma_f32_16x16x32_bf16 v[100:103], v[36:39], a[220:223], v[100:103]
    buffer_load_dwordx4 v4, s[4:7], s27 offen offset:1024 sc1 lds
    v_mfma_f32_16x16x32_bf16 v[104:107], v[32:35], a[240:243], v[136:139]
    ds_read_b128 v[28:31], v3 offset:6272
    v_add_f32 v7, v7, v19
    v_mfma_f32_16x16x32_bf16 v[104:107], v[36:39], a[244:247], v[104:107]
    v_exp_f32 v17, v121
    v_mfma_f32_16x16x32_bf16 v[108:111], v[32:35], v[200:203], v[140:143]
    v_cvt_f32_i32 v158, v158
    v_cvt_pk_bf16_f32 v185, v18, v19
    v_mfma_f32_16x16x32_bf16 v[108:111], v[36:39], v[204:207], v[108:111]
    s_waitcnt lgkmcnt(2)
    v_exp_f32 v18, v122
    v_mfma_f32_16x16x32_bf16 v[64:67], v[40:43], a[200:203], v[64:67]
    ds_read_b128 v[32:35], v2 offset:256
    v_fma_f32 v154, v154, v48, v50
    v_mfma_f32_16x16x32_bf16 v[64:67], v[44:47], a[204:207], v[64:67]
    v_add_f32 v7, v7, v16
    v_add_f32 v7, v7, v17
    v_mfma_f32_16x16x32_bf16 v[68:71], v[40:43], a[224:227], v[68:71]
    v_exp_f32 v19, v123
    v_mfma_f32_16x16x32_bf16 v[68:71], v[44:47], a[228:231], v[68:71]
    v_fma_f32 v158, v158, v49, v51
    v_cvt_pk_bf16_f32 v186, v16, v17
    v_mfma_f32_16x16x32_bf16 v[72:75], v[40:43], a[248:251], v[72:75]
    ds_read_b128 v[36:39], v3 offset:256
    v_cvt_pk_bf16_f32 v144, v144, v148
    v_mfma_f32_16x16x32_bf16 v[72:75], v[44:47], a[252:255], v[72:75]
    v_exp_f32 v16, v188
    v_mfma_f32_16x16x32_bf16 v[76:79], v[40:43], v[208:211], v[76:79]
    v_add_f32 v7, v7, v18
    v_add_f32 v7, v7, v19
    v_mfma_f32_16x16x32_bf16 v[76:79], v[44:47], v[212:215], v[76:79]
    s_waitcnt lgkmcnt(2)
    buffer_load_dwordx4 v4, s[4:7], s27 offen offset:2048 sc1 lds
    v_mfma_f32_16x16x32_bf16 v[96:99], v[24:27], a[200:203], v[96:99]
    ds_read_b128 v[40:43], v2 offset:6400
    v_cvt_pk_bf16_f32 v148, v145, v149
    v_mfma_f32_16x16x32_bf16 v[96:99], v[28:31], a[204:207], v[96:99]
    v_exp_f32 v17, v189
    v_mfma_f32_16x16x32_bf16 v[100:103], v[24:27], a[224:227], v[100:103]
    v_cvt_pk_bf16_f32 v187, v18, v19
    v_mfma_f32_16x16x32_bf16 v[100:103], v[28:31], a[228:231], v[100:103]
    v_exp_f32 v18, v190
    v_mfma_f32_16x16x32_bf16 v[104:107], v[24:27], a[248:251], v[104:107]
    ds_read_b128 v[44:47], v3 offset:6400
    v_add_f32 v8, v8, v16
    v_mfma_f32_16x16x32_bf16 v[104:107], v[28:31], a[252:255], v[104:107]
    v_add_f32 v8, v8, v17
    v_cvt_pk_bf16_f32 v145, v152, v156
    v_mfma_f32_16x16x32_bf16 v[108:111], v[24:27], v[208:211], v[108:111]
    s_add_u32 s29, s30, 49152
    v_exp_f32 v19, v191
    v_mfma_f32_16x16x32_bf16 v[108:111], v[28:31], v[212:215], v[108:111]
    s_waitcnt lgkmcnt(2)
    v_cvt_pk_bf16_f32 v188, v16, v17
    s_sub_u32 s3, s29, 147456
    v_mfma_f32_16x16x32_bf16 v[64:67], v[32:35], a[208:211], v[64:67]
    s_add_u32 s27, s27, 24576
    ds_read_b128 v[24:27], v2 offset:12288
    v_cvt_pk_bf16_f32 v149, v153, v157
    v_mfma_f32_16x16x32_bf16 v[64:67], v[36:39], a[212:215], v[64:67]
    s_min_u32 s29, s29, s3
    v_exp_f32 v16, v124
    v_mfma_f32_16x16x32_bf16 v[68:71], v[32:35], a[232:235], v[68:71]
    v_add_f32 v8, v8, v18
    v_add_f32 v8, v8, v19
    v_mfma_f32_16x16x32_bf16 v[68:71], v[36:39], a[236:239], v[68:71]
    v_exp_f32 v17, v125
    v_mfma_f32_16x16x32_bf16 v[72:75], v[32:35], v[192:195], v[72:75]
    s_add_u32 s56, s56, 12288
    ds_read_b128 v[28:31], v3 offset:12288
    v_cvt_pk_bf16_f32 v152, v146, v150
    v_mfma_f32_16x16x32_bf16 v[72:75], v[36:39], v[196:199], v[72:75]
L_pg8:
    s_cbranch_execz L_pg12
    v_cvt_pk_bf16_f32 v189, v18, v19
    v_mfma_f32_16x16x32_bf16 v[76:79], v[32:35], v[216:219], v[76:79]
    v_exp_f32 v18, v126
    v_mfma_f32_16x16x32_bf16 v[76:79], v[36:39], v[220:223], v[76:79]
    s_waitcnt lgkmcnt(2)
    v_add_f32 v8, v8, v16
    v_mfma_f32_16x16x32_bf16 v[96:99], v[40:43], a[208:211], v[96:99]
    ds_read_b128 v[32:35], v2 offset:18432
    v_add_f32 v8, v8, v17
    v_mfma_f32_16x16x32_bf16 v[96:99], v[44:47], a[212:215], v[96:99]
    s_sub_u32 s3, s29, s30
    v_exp_f32 v19, v127
    v_mfma_f32_16x16x32_bf16 v[100:103], v[40:43], a[232:235], v[100:103]
    s_mov_b32 m0, s56
    v_cvt_pk_bf16_f32 v153, v154, v158
    v_mfma_f32_16x16x32_bf16 v[100:103], v[44:47], a[236:239], v[100:103]
    v_cvt_pk_bf16_f32 v190, v16, v17
    v_mfma_f32_16x16x32_bf16 v[104:107], v[40:43], v[192:195], v[104:107]
    ds_read_b128 v[36:39], v3 offset:18432
    v_add_f32 v8, v8, v18
    v_mfma_f32_16x16x32_bf16 v[104:107], v[44:47], v[196:199], v[104:107]
    v_add_f32 v8, v8, v19
    v_cvt_pk_bf16_f32 v191, v18, v19
    v_mfma_f32_16x16x32_bf16 v[108:111], v[40:43], v[216:219], v[108:111]
    v_mfma_f32_16x16x32_bf16 v[108:111], v[44:47], v[220:223], v[108:111]
    s_waitcnt lgkmcnt(2)
    v_exp_f32 v16, v64
    v_mfma_f32_16x16x32_bf16 v[80:83], v[24:27], a[192:195], v[128:131]
    ds_read_b128 v[40:43], v2 offset:12416
    v_mfma_f32_16x16x32_bf16 v[80:83], v[28:31], a[196:199], v[80:83]
    s_mov_b32 s30, s29
    v_exp_f32 v17, v65
    v_mfma_f32_16x16x32_bf16 v[84:87], v[24:27], a[216:219], v[132:135]
    v_exp_f32 v18, v66
    v_mfma_f32_16x16x32_bf16 v[84:87], v[28:31], a[220:223], v[84:87]
    s_waitcnt vmcnt(14)
    buffer_load_dwordx4 v4, s[4:7], s27 offen offset:0 sc1 lds
    v_mfma_f32_16x16x32_bf16 v[88:91], v[24:27], a[240:243], v[136:139]
    ds_read_b128 v[44:47], v3 offset:12416
    v_add_f32 v5, v5, v16
    v_mfma_f32_16x16x32_bf16 v[88:91], v[28:31], a[244:247], v[88:91]
    v_add_f32 v5, v5, v17
    v_lshlrev_b32 v48, 16, v60
    v_mfma_f32_16x16x32_bf16 v[92:95], v[24:27], v[200:203], v[140:143]
    v_exp_f32 v19, v67
    v_mfma_f32_16x16x32_bf16 v[92:95], v[28:31], v[204:207], v[92:95]
    s_waitcnt lgkmcnt(2)
    v_cvt_pk_bf16_f32 v64, v16, v17
    v_and_b32 v49, s97, v60
    v_mfma_f32_16x16x32_bf16 v[112:115], v[32:35], a[192:195], v[128:131]
    ds_read_b128 v[24:27], v2 offset:18560
    v_mfma_f32_16x16x32_bf16 v[112:115], v[36:39], a[196:199], v[112:115]
    v_exp_f32 v16, v96
    v_mfma_f32_16x16x32_bf16 v[116:119], v[32:35], a[216:219], v[132:135]
    v_add_f32 v5, v5, v18
    v_lshlrev_b32 v50, 16, v62
    v_mfma_f32_16x16x32_bf16 v[116:119], v[36:39], a[220:223], v[116:119]
    v_add_f32 v5, v5, v19
    v_add_u32 v1, s3, v1
    v_mfma_f32_16x16x32_bf16 v[120:123], v[32:35], a[240:243], v[136:139]
    ds_read_b128 v[28:31], v3 offset:18560
    v_mfma_f32_16x16x32_bf16 v[120:123], v[36:39], a[244:247], v[120:123]
    v_exp_f32 v17, v97
    v_mfma_f32_16x16x32_bf16 v[124:127], v[32:35], v[200:203], v[140:143]
    v_cvt_pk_bf16_f32 v65, v18, v19
    v_and_b32 v51, s97, v62
    v_mfma_f32_16x16x32_bf16 v[124:127], v[36:39], v[204:207], v[124:127]
    s_waitcnt lgkmcnt(2)
    buffer_load_dwordx4 v4, s[4:7], s27 offen offset:1024 sc1 lds
    v_mfma_f32_16x16x32_bf16 v[80:83], v[40:43], a[200:203], v[80:83]
    ds_read_b128 v[32:35], v2 offset:12544
    v_mfma_f32_16x16x32_bf16 v[80:83], v[44:47], a[204:207], v[80:83]
    v_exp_f32 v18, v98
    v_mfma_f32_16x16x32_bf16 v[84:87], v[40:43], a[224:227], v[84:87]
    v_add_f32 v5, v5, v16
    v_add_f32 v5, v5, v17
    v_mfma_f32_16x16x32_bf16 v[84:87], v[44:47], a[228:231], v[84:87]
    v_exp_f32 v19, v99
    v_mfma_f32_16x16x32_bf16 v[88:91], v[40:43], a[248:251], v[88:91]
    ds_read_b128 v[36:39], v3 offset:12544
    v_cvt_pk_bf16_f32 v66, v16, v17
    v_mfma_f32_16x16x32_bf16 v[88:91], v[44:47], a[252:255], v[88:91]
    v_exp_f32 v16, v68
    v_mfma_f32_16x16x32_bf16 v[92:95], v[40:43], v[208:211], v[92:95]
    v_mul_f32_e64 v50, -v50, v48
    v_add_f32 v5, v5, v18
    v_mfma_f32_16x16x32_bf16 v[92:95], v[44:47], v[212:215], v[92:95]
    s_waitcnt lgkmcnt(2)
    v_add_f32 v5, v5, v19
    v_mul_f32_e64 v51, -v51, v49
    v_mfma_f32_16x16x32_bf16 v[112:115], v[24:27], a[200:203], v[112:115]
    ds_read_b128 v[40:43], v2 offset:18688
    v_mfma_f32_16x16x32_bf16 v[112:115], v[28:31], a[204:207], v[112:115]
    buffer_load_dwordx4 v4, s[4:7], s27 offen offset:2048 sc1 lds
    v_mfma_f32_16x16x32_bf16 v[116:119], v[24:27], a[224:227], v[116:119]
    v_exp_f32 v17, v69
    v_mfma_f32_16x16x32_bf16 v[116:119], v[28:31], a[228:231], v[116:119]
    v_cvt_pk_bf16_f32 v67, v18, v19
    v_cvt_f32_i32 v240, v240
    v_mfma_f32_16x16x32_bf16 v[120:123], v[24:27], a[248:251], v[120:123]
    ds_read_b128 v[44:47], v3 offset:18688
    v_mfma_f32_16x16x32_bf16 v[120:123], v[28:31], a[252:255], v[120:123]
    s_waitcnt lgkmcnt(2)
    v_exp_f32 v18, v70
    v_mfma_f32_16x16x32_bf16 v[124:127], v[24:27], v[208:211], v[124:127]
    s_waitcnt vmcnt(7)
    v_add_f32 v6, v6, v16
    v_add_f32 v6, v6, v17
    v_mfma_f32_16x16x32_bf16 v[124:127], v[28:31], v[212:215], v[124:127]
    s_barrier
    v_cvt_f32_i32 v244, v244
    v_mfma_f32_16x16x32_bf16 v[80:83], v[32:35], a[208:211], v[80:83]
    ds_read_b128 v[24:27], v1 offset:0
    v_mfma_f32_16x16x32_bf16 v[80:83], v[36:39], a[212:215], v[80:83]
    v_exp_f32 v19, v71
    v_mfma_f32_16x16x32_bf16 v[84:87], v[32:35], a[232:235], v[84:87]
    v_cvt_pk_bf16_f32 v68, v16, v17
    v_fma_f32 v240, v240, v48, v50
    v_mfma_f32_16x16x32_bf16 v[84:87], v[36:39], a[236:239], v[84:87]
    v_exp_f32 v16, v100
    v_mfma_f32_16x16x32_bf16 v[88:91], v[32:35], v[192:195], v[88:91]
    ds_read_b128 v[28:31], v1 offset:12288
    v_add_f32 v6, v6, v18
    v_mfma_f32_16x16x32_bf16 v[88:91], v[36:39], v[196:199], v[88:91]
    v_add_f32 v6, v6, v19
    v_fma_f32 v244, v244, v49, v51
    v_mfma_f32_16x16x32_bf16 v[92:95], v[32:35], v[216:219], v[92:95]
    v_exp_f32 v17, v101
    v_mfma_f32_16x16x32_bf16 v[92:95], v[36:39], v[220:223], v[92:95]
    s_waitcnt lgkmcnt(2)
    v_cvt_pk_bf16_f32 v69, v18, v19
    v_mfma_f32_16x16x32_bf16 v[112:115], v[40:43], a[208:211], v[112:115]
    ds_read_b128 v[32:35], v1 offset:1024
    v_mfma_f32_16x16x32_bf16 v[112:115], v[44:47], a[212:215], v[112:115]
    v_exp_f32 v18, v102
    v_mfma_f32_16x16x32_bf16 v[116:119], v[40:43], a[232:235], v[116:119]
    v_add_f32 v6, v6, v16
    v_add_f32 v6, v6, v17
    v_mfma_f32_16x16x32_bf16 v[116:119], v[44:47], a[236:239], v[116:119]
    s_add_u32 s27, s27, 24576
    v_exp_f32 v19, v103
    v_mfma_f32_16x16x32_bf16 v[120:123], v[40:43], v[192:195], v[120:123]
    s_add_u32 s56, s56, 36864
    ds_read_b128 v[36:39], v1 offset:13312
    v_cvt_pk_bf16_f32 v70, v16, v17
    v_mfma_f32_16x16x32_bf16 v[120:123], v[44:47], v[196:199], v[120:123]
    s_sub_u32 s58, s56, 147456
    v_add_f32 v6, v6, v18
    v_add_f32 v6, v6, v19
    v_mfma_f32_16x16x32_bf16 v[124:127], v[40:43], v[216:219], v[124:127]
    s_min_u32 s56, s56, s58
    v_cvt_pk_bf16_f32 v71, v18, v19
    v_mfma_f32_16x16x32_bf16 v[124:127], v[44:47], v[220:223], v[124:127]
    s_waitcnt lgkmcnt(2)
    v_mfma_f32_16x16x32_bf16 a[0:3], v[160:163], v[24:27], a[0:3]
    s_mov_b32 m0, s56
    ds_read_b128 v[40:43], v1 offset:2048
    v_cvt_f32_i32 v241, v241
    v_mfma_f32_16x16x32_bf16 a[0:3], v[176:179], v[28:31], a[0:3]
    buffer_load_dwordx4 v4, s[4:7], s27 offen offset:0 sc1 lds
    v_mfma_f32_16x16x32_bf16 a[48:51], v[164:167], v[24:27], a[48:51]
    v_exp_f32 v16, v72
    v_mfma_f32_16x16x32_bf16 a[48:51], v[180:183], v[28:31], a[48:51]
    v_exp_f32 v17, v73
    v_mfma_f32_16x16x32_bf16 a[96:99], v[168:171], v[24:27], a[96:99]
    ds_read_b128 v[44:47], v1 offset:14336
    v_cvt_f32_i32 v245, v245
    v_mfma_f32_16x16x32_bf16 a[96:99], v[184:187], v[28:31], a[96:99]
    v_exp_f32 v18, v74
    v_mfma_f32_16x16x32_bf16 a[144:147], v[172:175], v[24:27], a[144:147]
    v_add_f32 v7, v7, v16
    v_add_f32 v7, v7, v17
    v_mfma_f32_16x16x32_bf16 a[144:147], v[188:191], v[28:31], a[144:147]
    s_waitcnt lgkmcnt(2)
    v_exp_f32 v19, v75
    v_mfma_f32_16x16x32_bf16 a[4:7], v[160:163], v[32:35], a[4:7]
    ds_read_b128 v[24:27], v1 offset:3072
    v_fma_f32 v241, v241, v48, v50
    v_mfma_f32_16x16x32_bf16 a[4:7], v[176:179], v[36:39], a[4:7]
    buffer_load_dwordx4 v4, s[4:7], s27 offen offset:1024 sc1 lds
    v_mfma_f32_16x16x32_bf16 a[52:55], v[164:167], v[32:35], a[52:55]
    v_cvt_pk_bf16_f32 v72, v16, v17
    v_fma_f32 v245, v245, v49, v51
    v_mfma_f32_16x16x32_bf16 a[52:55], v[180:183], v[36:39], a[52:55]
    v_exp_f32 v16, v104
    v_mfma_f32_16x16x32_bf16 a[100:103], v[168:171], v[32:35], a[100:103]
    ds_read_b128 v[28:31], v1 offset:15360
    v_add_f32 v7, v7, v18
    v_mfma_f32_16x16x32_bf16 a[100:103], v[184:187], v[36:39], a[100:103]
    buffer_load_dword v52, v20, s[20:23], s44 offen sc1
    v_mfma_f32_16x16x32_bf16 a[148:151], v[172:175], v[32:35], a[148:151]
    v_add_f32 v7, v7, v19
    v_cvt_f32_i32 v242, v242
    v_mfma_f32_16x16x32_bf16 a[148:151], v[188:191], v[36:39], a[148:151]
    s_waitcnt lgkmcnt(2)
    v_exp_f32 v17, v105
    v_mfma_f32_16x16x32_bf16 a[8:11], v[160:163], v[40:43], a[8:11]
    ds_read_b128 v[32:35], v1 offset:4096
    v_cvt_pk_bf16_f32 v73, v18, v19
    v_mfma_f32_16x16x32_bf16 a[8:11], v[176:179], v[44:47], a[8:11]
    v_exp_f32 v18, v106
    v_mfma_f32_16x16x32_bf16 a[56:59], v[164:167], v[40:43], a[56:59]
    v_add_f32 v7, v7, v16
    v_cvt_f32_i32 v246, v246
    v_mfma_f32_16x16x32_bf16 a[56:59], v[180:183], v[44:47], a[56:59]
    buffer_load_dwordx4 v4, s[4:7], s27 offen offset:2048 sc1 lds
    v_mfma_f32_16x16x32_bf16 a[104:107], v[168:171], v[40:43], a[104:107]
    ds_read_b128 v[36:39], v1 offset:16384
    v_add_f32 v7, v7, v17
    v_mfma_f32_16x16x32_bf16 a[104:107], v[184:187], v[44:47], a[104:107]
    v_exp_f32 v19, v107
    v_mfma_f32_16x16x32_bf16 a[152:155], v[172:175], v[40:43], a[152:155]
    v_cvt_pk_bf16_f32 v74, v16, v17
    v_fma_f32 v242, v242, v48, v50
    v_mfma_f32_16x16x32_bf16 a[152:155], v[188:191], v[44:47], a[152:155]
    s_waitcnt lgkmcnt(2)
    v_exp_f32 v16, v76
    v_mfma_f32_16x16x32_bf16 a[12:15], v[160:163], v[24:27], a[12:15]
    ds_read_b128 v[40:43], v1 offset:5120
    v_add_f32 v7, v7, v18
    v_mfma_f32_16x16x32_bf16 a[12:15], v[176:179], v[28:31], a[12:15]
    s_add_u32 s27, s27, 24576
    v_add_f32 v7, v7, v19
    v_fma_f32 v246, v246, v49, v51
    v_mfma_f32_16x16x32_bf16 a[60:63], v[164:167], v[24:27], a[60:63]
    v_exp_f32 v17, v77
    v_mfma_f32_16x16x32_bf16 a[60:63], v[180:183], v[28:31], a[60:63]
    v_cvt_pk_bf16_f32 v75, v18, v19
    v_lshlrev_b32 v48, 16, v61
    v_mfma_f32_16x16x32_bf16 a[108:111], v[168:171], v[24:27], a[108:111]
    ds_read_b128 v[44:47], v1 offset:17408
    v_and_b32 v49, s97, v61
    v_mfma_f32_16x16x32_bf16 a[108:111], v[184:187], v[28:31], a[108:111]
    v_exp_f32 v18, v78
    v_mfma_f32_16x16x32_bf16 a[156:159], v[172:175], v[24:27], a[156:159]
    s_add_u32 s29, s28, 49152
    v_add_f32 v8, v8, v16
    v_add_f32 v8, v8, v17
    v_mfma_f32_16x16x32_bf16 a[156:159], v[188:191], v[28:31], a[156:159]
    s_waitcnt lgkmcnt(2)
    v_exp_f32 v19, v79
    v_mfma_f32_16x16x32_bf16 a[16:19], v[160:163], v[32:35], a[16:19]
    s_sub_u32 s3, s29, 147456
    ds_read_b128 v[24:27], v1 offset:6144
    v_lshlrev_b32 v50, 16, v63
    v_mfma_f32_16x16x32_bf16 a[16:19], v[176:179], v[36:39], a[16:19]
    s_add_u32 s56, s56, 12288
    v_cvt_pk_bf16_f32 v76, v16, v17
    v_and_b32 v51, s97, v63
    v_mfma_f32_16x16x32_bf16 a[64:67], v[164:167], v[32:35], a[64:67]
    s_min_u32 s29, s29, s3
    v_exp_f32 v16, v108
    v_mfma_f32_16x16x32_bf16 a[64:67], v[180:183], v[36:39], a[64:67]
    s_mov_b32 m0, s56
    v_add_f32 v8, v8, v18
    v_add_f32 v8, v8, v19
    v_mfma_f32_16x16x32_bf16 a[112:115], v[168:171], v[32:35], a[112:115]
    ds_read_b128 v[28:31], v1 offset:18432
    v_mul_f32_e64 v50, -v50, v48
    v_mfma_f32_16x16x32_bf16 a[112:115], v[184:187], v[36:39], a[112:115]
    v_exp_f32 v17, v109
    v_mfma_f32_16x16x32_bf16 a[160:163], v[172:175], v[32:35], a[160:163]
    v_cvt_pk_bf16_f32 v77, v18, v19
    v_mul_f32_e64 v51, -v51, v49
    v_mfma_f32_16x16x32_bf16 a[160:163], v[188:191], v[36:39], a[160:163]
    s_waitcnt lgkmcnt(2)
    v_exp_f32 v18, v110
    v_mfma_f32_16x16x32_bf16 a[20:23], v[160:163], v[40:43], a[20:23]
    s_sub_u32 s3, s29, s28
    ds_read_b128 v[32:35], v1 offset:7168
    v_add_f32 v8, v8, v16
    v_mfma_f32_16x16x32_bf16 a[20:23], v[176:179], v[44:47], a[20:23]
    v_add_f32 v8, v8, v17
    v_cvt_f32_i32 v248, v248
    v_mfma_f32_16x16x32_bf16 a[68:71], v[164:167], v[40:43], a[68:71]
    v_exp_f32 v19, v111
    v_mfma_f32_16x16x32_bf16 a[68:71], v[180:183], v[44:47], a[68:71]
    buffer_load_dwordx4 v4, s[4:7], s27 offen offset:0 sc1 lds
    v_mfma_f32_16x16x32_bf16 a[116:119], v[168:171], v[40:43], a[116:119]
    ds_read_b128 v[36:39], v1 offset:19456
    v_cvt_pk_bf16_f32 v78, v16, v17
    v_mfma_f32_16x16x32_bf16 a[116:119], v[184:187], v[44:47], a[116:119]
    v_add_f32 v8, v8, v18
    v_cvt_f32_i32 v252, v252
    v_mfma_f32_16x16x32_bf16 a[164:167], v[172:175], v[40:43], a[164:167]
    s_mov_b32 s28, s29
    v_add_f32 v8, v8, v19
    v_cvt_pk_bf16_f32 v79, v18, v19
    v_mfma_f32_16x16x32_bf16 a[164:167], v[188:191], v[44:47], a[164:167]
    s_waitcnt lgkmcnt(2)
    v_exp_f32 v16, v80
    v_mfma_f32_16x16x32_bf16 a[24:27], v[160:163], v[24:27], a[24:27]
    ds_read_b128 v[40:43], v1 offset:8192
    v_fma_f32 v248, v248, v48, v50
    v_mfma_f32_16x16x32_bf16 a[24:27], v[176:179], v[28:31], a[24:27]
    v_exp_f32 v17, v81
    v_mfma_f32_16x16x32_bf16 a[72:75], v[164:167], v[24:27], a[72:75]
    v_fma_f32 v252, v252, v49, v51
    v_cvt_f32_i32 v249, v249
    v_mfma_f32_16x16x32_bf16 a[72:75], v[180:183], v[28:31], a[72:75]
    buffer_load_dwordx4 v4, s[4:7], s27 offen offset:1024 sc1 lds
    v_mfma_f32_16x16x32_bf16 a[120:123], v[168:171], v[24:27], a[120:123]
    ds_read_b128 v[44:47], v1 offset:20480
    v_cvt_f32_i32 v253, v253
    v_mfma_f32_16x16x32_bf16 a[120:123], v[184:187], v[28:31], a[120:123]
    v_exp_f32 v18, v82
    v_mfma_f32_16x16x32_bf16 a[168:171], v[172:175], v[24:27], a[168:171]
    v_add_f32 v5, v5, v16
    v_add_f32 v5, v5, v17
    v_mfma_f32_16x16x32_bf16 a[168:171], v[188:191], v[28:31], a[168:171]
    s_waitcnt lgkmcnt(2)
    v_exp_f32 v19, v83
    v_mfma_f32_16x16x32_bf16 a[28:31], v[160:163], v[32:35], a[28:31]
    ds_read_b128 v[24:27], v1 offset:9216
    v_cvt_pk_bf16_f32 v80, v16, v17
    v_mfma_f32_16x16x32_bf16 a[28:31], v[176:179], v[36:39], a[28:31]
    v_exp_f32 v16, v112
    v_mfma_f32_16x16x32_bf16 a[76:79], v[164:167], v[32:35], a[76:79]
    v_add_f32 v5, v5, v18
    v_fma_f32 v249, v249, v48, v50
    v_mfma_f32_16x16x32_bf16 a[76:79], v[180:183], v[36:39], a[76:79]
    v_add_f32 v5, v5, v19
    v_add_u32 v2, s3, v2
    v_mfma_f32_16x16x32_bf16 a[124:127], v[168:171], v[32:35], a[124:127]
    ds_read_b128 v[28:31], v1 offset:21504
    v_fma_f32 v253, v253, v49, v51
    v_mfma_f32_16x16x32_bf16 a[124:127], v[184:187], v[36:39], a[124:127]
    buffer_load_dwordx4 v4, s[4:7], s27 offen offset:2048 sc1 lds
    v_mfma_f32_16x16x32_bf16 a[172:175], v[172:175], v[32:35], a[172:175]
    v_exp_f32 v17, v113
    v_mfma_f32_16x16x32_bf16 a[172:175], v[188:191], v[36:39], a[172:175]
    s_waitcnt lgkmcnt(2)
    v_cvt_pk_bf16_f32 v81, v18, v19
    v_cvt_f32_i32 v250, v250
    v_mfma_f32_16x16x32_bf16 a[32:35], v[160:163], v[40:43], a[32:35]
    ds_read_b128 v[32:35], v1 offset:10240
    v_add_u32 v3, s3, v3
    v_mfma_f32_16x16x32_bf16 a[32:35], v[176:179], v[44:47], a[32:35]
    v_exp_f32 v18, v114
    v_mfma_f32_16x16x32_bf16 a[80:83], v[164:167], v[40:43], a[80:83]
    v_add_f32 v5, v5, v16
    v_add_f32 v5, v5, v17
    v_mfma_f32_16x16x32_bf16 a[80:83], v[180:183], v[44:47], a[80:83]
    v_exp_f32 v19, v115
    v_mfma_f32_16x16x32_bf16 a[128:131], v[168:171], v[40:43], a[128:131]
    ds_read_b128 v[36:39], v1 offset:22528
    v_cvt_pk_bf16_f32 v82, v16, v17
    v_mfma_f32_16x16x32_bf16 a[128:131], v[184:187], v[44:47], a[128:131]
    v_exp_f32 v16, v84
    v_mfma_f32_16x16x32_bf16 a[176:179], v[172:175], v[40:43], a[176:179]
    v_cvt_f32_i32 v254, v254
    v_add_f32 v5, v5, v18
    v_mfma_f32_16x16x32_bf16 a[176:179], v[188:191], v[44:47], a[176:179]
    s_waitcnt lgkmcnt(2)
    v_add_f32 v5, v5, v19
    v_fma_f32 v250, v250, v48, v50
    v_mfma_f32_16x16x32_bf16 a[36:39], v[160:163], v[24:27], a[36:39]
    ds_read_b128 v[40:43], v1 offset:11264
    v_fma_f32 v254, v254, v49, v51
    v_mfma_f32_16x16x32_bf16 a[36:39], v[176:179], v[28:31], a[36:39]
    v_exp_f32 v17, v85
    v_mfma_f32_16x16x32_bf16 a[84:87], v[164:167], v[24:27], a[84:87]
    v_cvt_pk_bf16_f32 v83, v18, v19
    v_cvt_pk_bf16_f32 v146, v240, v244
    v_mfma_f32_16x16x32_bf16 a[84:87], v[180:183], v[28:31], a[84:87]
    s_add_u32 s27, s27, 24576
    v_exp_f32 v18, v86
    v_mfma_f32_16x16x32_bf16 a[132:135], v[168:171], v[24:27], a[132:135]
    s_add_u32 s56, s56, 36864
    ds_read_b128 v[44:47], v1 offset:23552
    v_add_f32 v6, v6, v16
    v_mfma_f32_16x16x32_bf16 a[132:135], v[184:187], v[28:31], a[132:135]
    s_sub_u32 s58, s56, 147456
    v_add_f32 v6, v6, v17
    v_cvt_pk_bf16_f32 v150, v241, v245
    v_mfma_f32_16x16x32_bf16 a[180:183], v[172:175], v[24:27], a[180:183]
    v_exp_f32 v19, v87
    v_mfma_f32_16x16x32_bf16 a[180:183], v[188:191], v[28:31], a[180:183]
    s_waitcnt lgkmcnt(2)
    v_cvt_pk_bf16_f32 v84, v16, v17
    v_cvt_pk_bf16_f32 v147, v248, v252
    v_mfma_f32_16x16x32_bf16 a[40:43], v[160:163], v[32:35], a[40:43]
    s_min_u32 s56, s56, s58
    ds_read_b128 v[24:27], v2 offset:0
    v_mfma_f32_16x16x32_bf16 a[40:43], v[176:179], v[36:39], a[40:43]
    v_exp_f32 v16, v116
    v_mfma_f32_16x16x32_bf16 a[88:91], v[164:167], v[32:35], a[88:91]
    v_add_f32 v6, v6, v18
    v_add_f32 v6, v6, v19
    v_mfma_f32_16x16x32_bf16 a[88:91], v[180:183], v[36:39], a[88:91]
    v_exp_f32 v17, v117
    v_mfma_f32_16x16x32_bf16 a[136:139], v[168:171], v[32:35], a[136:139]
    ds_read_b128 v[28:31], v3 offset:0
    v_cvt_pk_bf16_f32 v151, v249, v253
    v_mfma_f32_16x16x32_bf16 a[136:139], v[184:187], v[36:39], a[136:139]
    v_cvt_pk_bf16_f32 v85, v18, v19
    v_cvt_pk_bf16_f32 v154, v242, v246
    v_mfma_f32_16x16x32_bf16 a[184:187], v[172:175], v[32:35], a[184:187]
    v_exp_f32 v18, v118
    v_mfma_f32_16x16x32_bf16 a[184:187], v[188:191], v[36:39], a[184:187]
    s_waitcnt lgkmcnt(2)
    v_add_f32 v6, v6, v16
    v_mfma_f32_16x16x32_bf16 a[44:47], v[160:163], v[40:43], a[44:47]
    ds_read_b128 v[32:35], v2 offset:6144
    v_add_f32 v6, v6, v17
    v_mfma_f32_16x16x32_bf16 a[44:47], v[176:179], v[44:47], a[44:47]
    v_exp_f32 v19, v119
    v_mfma_f32_16x16x32_bf16 a[92:95], v[164:167], v[40:43], a[92:95]
    v_cvt_pk_bf16_f32 v155, v250, v254
    v_mfma_f32_16x16x32_bf16 a[92:95], v[180:183], v[44:47], a[92:95]
    v_cvt_pk_bf16_f32 v86, v16, v17
    v_mfma_f32_16x16x32_bf16 a[140:143], v[168:171], v[40:43], a[140:143]
    ds_read_b128 v[36:39], v3 offset:6144
    v_add_f32 v6, v6, v18
    v_mfma_f32_16x16x32_bf16 a[140:143], v[184:187], v[44:47], a[140:143]
    v_add_f32 v6, v6, v19
    v_cvt_pk_bf16_f32 v87, v18, v19
    v_mfma_f32_16x16x32_bf16 a[188:191], v[172:175], v[40:43], a[188:191]
    v_mfma_f32_16x16x32_bf16 a[188:191], v[188:191], v[44:47], a[188:191]
    s_waitcnt lgkmcnt(2)
    v_mfma_f32_16x16x32_bf16 v[160:163], v[24:27], a[192:195], v[128:131]
    ds_read_b128 v[40:43], v2 offset:128
    v_mfma_f32_16x16x32_bf16 v[160:163], v[28:31], a[196:199], v[160:163]
    s_waitcnt vmcnt(4)
    v_subrev_u32 v52, s92, v52
    v_cmp_lt_u32 vcc, 15, v52
    v_mfma_f32_16x16x32_bf16 v[164:167], v[24:27], a[216:219], v[132:135]
    v_exp_f32 v16, v88
    v_mfma_f32_16x16x32_bf16 v[164:167], v[28:31], a[220:223], v[164:167]
    v_exp_f32 v17, v89
    v_mfma_f32_16x16x32_bf16 v[168:171], v[24:27], a[240:243], v[136:139]
    s_and_b32 s59, vcc_lo, 0xff
    ds_read_b128 v[44:47], v3 offset:128
    v_mfma_f32_16x16x32_bf16 v[168:171], v[28:31], a[244:247], v[168:171]
    s_cbranch_scc1 L_pollslow3
L_pollok3:
    v_mfma_f32_16x16x32_bf16 v[172:175], v[24:27], v[200:203], v[140:143]
    s_add_u32 s92, s92, 1
    v_exp_f32 v18, v90
    v_mfma_f32_16x16x32_bf16 v[172:175], v[28:31], v[204:207], v[172:175]
    s_waitcnt lgkmcnt(2)
    v_add_f32 v7, v7, v16
    v_add_f32 v7, v7, v17
    v_mfma_f32_16x16x32_bf16 v[96:99], v[32:35], a[192:195], v[128:131]
    ds_read_b128 v[24:27], v2 offset:6272
    v_mfma_f32_16x16x32_bf16 v[96:99], v[36:39], a[196:199], v[96:99]
    buffer_store_dwordx4 v[144:147], v15, s[4:7], s35 offen offset:0 sc1
    v_mfma_f32_16x16x32_bf16 v[100:103], v[32:35], a[216:219], v[132:135]
    v_exp_f32 v19, v91
    v_mfma_f32_16x16x32_bf16 v[100:103], v[36:39], a[220:223], v[100:103]
    v_cvt_pk_bf16_f32 v88, v16, v17
    v_mfma_f32_16x16x32_bf16 v[104:107], v[32:35], a[240:243], v[136:139]
    ds_read_b128 v[28:31], v3 offset:6272
    v_mfma_f32_16x16x32_bf16 v[104:107], v[36:39], a[244:247], v[104:107]
    v_exp_f32 v16, v120
    v_mfma_f32_16x16x32_bf16 v[108:111], v[32:35], v[200:203], v[140:143]
    v_add_f32 v7, v7, v18
    v_add_f32 v7, v7, v19
    v_mfma_f32_16x16x32_bf16 v[108:111], v[36:39], v[204:207], v[108:111]
    s_waitcnt lgkmcnt(2)
    v_exp_f32 v17, v121
    v_mfma_f32_16x16x32_bf16 v[160:163], v[40:43], a[200:203], v[160:163]
    ds_read_b128 v[32:35], v2 offset:256
    v_cvt_pk_bf16_f32 v89, v18, v19
    v_mfma_f32_16x16x32_bf16 v[160:163], v[44:47], a[204:207], v[160:163]
    buffer_store_dwordx4 v[148:151], v15, s[4:7], s35 offen offset:1024 sc1
    v_mfma_f32_16x16x32_bf16 v[164:167], v[40:43], a[224:227], v[164:167]
    v_exp_f32 v18, v122
    v_mfma_f32_16x16x32_bf16 v[164:167], v[44:47], a[228:231], v[164:167]
    v_add_f32 v7, v7, v16
    v_add_f32 v7, v7, v17
    v_mfma_f32_16x16x32_bf16 v[168:171], v[40:43], a[248:251], v[168:171]
    ds_read_b128 v[36:39], v3 offset:256
    v_mfma_f32_16x16x32_bf16 v[168:171], v[44:47], a[252:255], v[168:171]
    v_exp_f32 v19, v123
    v_mfma_f32_16x16x32_bf16 v[172:175], v[40:43], v[208:211], v[172:175]
    v_cvt_pk_bf16_f32 v90, v16, v17
    v_mfma_f32_16x16x32_bf16 v[172:175], v[44:47], v[212:215], v[172:175]
    s_waitcnt lgkmcnt(2)
    v_exp_f32 v16, v92
    v_mfma_f32_16x16x32_bf16 v[96:99], v[24:27], a[200:203], v[96:99]
    ds_read_b128 v[40:43], v2 offset:6400
    v_add_f32 v7, v7, v18
    v_mfma_f32_16x16x32_bf16 v[96:99], v[28:31], a[204:207], v[96:99]
    buffer_store_dwordx4 v[152:155], v15, s[4:7], s35 offen offset:2048 sc1
    v_mfma_f32_16x16x32_bf16 v[100:103], v[24:27], a[224:227], v[100:103]
    v_add_f32 v7, v7, v19
    v_mfma_f32_16x16x32_bf16 v[100:103], v[28:31], a[228:231], v[100:103]
    v_exp_f32 v17, v93
    v_mfma_f32_16x16x32_bf16 v[104:107], v[24:27], a[248:251], v[104:107]
    ds_read_b128 v[44:47], v3 offset:6400
    v_cvt_pk_bf16_f32 v91, v18, v19
    v_mfma_f32_16x16x32_bf16 v[104:107], v[28:31], a[252:255], v[104:107]
    v_exp_f32 v18, v94
    v_mfma_f32_16x16x32_bf16 v[108:111], v[24:27], v[208:211], v[108:111]
    s_add_u32 s29, s30, 49152
    v_add_f32 v8, v8, v16
    v_add_f32 v8, v8, v17
    v_mfma_f32_16x16x32_bf16 v[108:111], v[28:31], v[212:215], v[108:111]
    s_waitcnt lgkmcnt(2)
    v_exp_f32 v19, v95
    v_mfma_f32_16x16x32_bf16 v[160:163], v[32:35], a[208:211], v[160:163]
    s_sub_u32 s3, s29, 147456
    ds_read_b128 v[24:27], v2 offset:12288
    v_cvt_pk_bf16_f32 v92, v16, v17
    v_mfma_f32_16x16x32_bf16 v[160:163], v[36:39], a[212:215], v[160:163]
    s_min_u32 s29, s29, s3
    v_exp_f32 v16, v124
    v_mfma_f32_16x16x32_bf16 v[164:167], v[32:35], a[232:235], v[164:167]
    v_add_f32 v8, v8, v18
    v_add_f32 v8, v8, v19
    v_mfma_f32_16x16x32_bf16 v[164:167], v[36:39], a[236:239], v[164:167]
    v_exp_f32 v17, v125
    v_mfma_f32_16x16x32_bf16 v[168:171], v[32:35], v[192:195], v[168:171]
    ds_read_b128 v[28:31], v3 offset:12288
    v_mfma_f32_16x16x32_bf16 v[168:171], v[36:39], v[196:199], v[168:171]
    v_cvt_pk_bf16_f32 v93, v18, v19
    v_mfma_f32_16x16x32_bf16 v[172:175], v[32:35], v[216:219], v[172:175]
    v_exp_f32 v18, v126
    v_mfma_f32_16x16x32_bf16 v[172:175], v[36:39], v[220:223], v[172:175]
    s_waitcnt lgkmcnt(2)
    v_add_f32 v8, v8, v16
    v_mfma_f32_16x16x32_bf16 v[96:99], v[40:43], a[208:211], v[96:99]
    ds_read_b128 v[32:35], v2 offset:18432
    v_add_f32 v8, v8, v17
    v_mfma_f32_16x16x32_bf16 v[96:99], v[44:47], a[212:215], v[96:99]
    s_mov_b32 m0, s26
    v_exp_f32 v19, v127
    v_mfma_f32_16x16x32_bf16 v[100:103], v[40:43], a[232:235], v[100:103]
    s_sub_u32 s3, s29, s30
    v_mfma_f32_16x16x32_bf16 v[100:103], v[44:47], a[236:239], v[100:103]
    buffer_load_dwordx4 v4, s[4:7], s32 offen offset:0 sc1 lds
    v_mfma_f32_16x16x32_bf16 v[104:107], v[40:43], v[192:195], v[104:107]
    ds_read_b128 v[36:39], v3 offset:18432
    v_cvt_pk_bf16_f32 v94, v16, v17
    v_mfma_f32_16x16x32_bf16 v[104:107], v[44:47], v[196:199], v[104:107]
    v_add_f32 v8, v8, v18
    v_add_f32 v8, v8, v19
    v_mfma_f32_16x16x32_bf16 v[108:111], v[40:43], v[216:219], v[108:111]
    v_cvt_pk_bf16_f32 v95, v18, v19
    v_mfma_f32_16x16x32_bf16 v[108:111], v[44:47], v[220:223], v[108:111]
    s_waitcnt lgkmcnt(2)
    buffer_load_dwordx4 v4, s[4:7], s32 offen offset:1024 sc1 lds
    v_mfma_f32_16x16x32_bf16 v[176:179], v[24:27], a[192:195], v[128:131]
    ds_read_b128 v[40:43], v2 offset:12416
    v_mfma_f32_16x16x32_bf16 v[176:179], v[28:31], a[196:199], v[176:179]
    s_mov_b32 s30, s29
    v_exp_f32 v16, v160
    v_mfma_f32_16x16x32_bf16 v[180:183], v[24:27], a[216:219], v[132:135]
    v_exp_f32 v17, v161
    v_mfma_f32_16x16x32_bf16 v[180:183], v[28:31], a[220:223], v[180:183]
    buffer_load_dwordx4 v4, s[4:7], s32 offen offset:2048 sc1 lds
    v_mfma_f32_16x16x32_bf16 v[184:187], v[24:27], a[240:243], v[136:139]
    s_add_u32 s32, s32, 24576
    ds_read_b128 v[44:47], v3 offset:12416
    v_mfma_f32_16x16x32_bf16 v[184:187], v[28:31], a[244:247], v[184:187]
    v_exp_f32 v18, v162
    v_mfma_f32_16x16x32_bf16 v[188:191], v[24:27], v[200:203], v[140:143]
    s_add_u32 s26, s26, 12288
    v_add_f32 v5, v5, v16
    v_add_f32 v5, v5, v17
    v_mfma_f32_16x16x32_bf16 v[188:191], v[28:31], v[204:207], v[188:191]
    s_waitcnt lgkmcnt(2)
    v_exp_f32 v19, v163
    v_mfma_f32_16x16x32_bf16 v[112:115], v[32:35], a[192:195], v[128:131]
    s_mov_b32 m0, s26
    ds_read_b128 v[24:27], v2 offset:18560
    v_cvt_pk_bf16_f32 v160, v16, v17
    v_mfma_f32_16x16x32_bf16 v[112:115], v[36:39], a[196:199], v[112:115]
    v_exp_f32 v16, v96
    v_mfma_f32_16x16x32_bf16 v[116:119], v[32:35], a[216:219], v[132:135]
    v_add_f32 v5, v5, v18
    v_add_f32 v5, v5, v19
    v_mfma_f32_16x16x32_bf16 v[116:119], v[36:39], a[220:223], v[116:119]
    v_exp_f32 v17, v97
    v_mfma_f32_16x16x32_bf16 v[120:123], v[32:35], a[240:243], v[136:139]
    ds_read_b128 v[28:31], v3 offset:18560
    v_add_u32 v1, s3, v1
    v_mfma_f32_16x16x32_bf16 v[120:123], v[36:39], a[244:247], v[120:123]
    buffer_load_dwordx4 v4, s[4:7], s32 offen offset:0 sc1 lds
    v_mfma_f32_16x16x32_bf16 v[124:127], v[32:35], v[200:203], v[140:143]
    v_cvt_pk_bf16_f32 v161, v18, v19
    v_mfma_f32_16x16x32_bf16 v[124:127], v[36:39], v[204:207], v[124:127]
    s_waitcnt lgkmcnt(2)
    v_exp_f32 v18, v98
    v_mfma_f32_16x16x32_bf16 v[176:179], v[40:43], a[200:203], v[176:179]
    ds_read_b128 v[32:35], v2 offset:12544
    v_add_f32 v5, v5, v16
    v_mfma_f32_16x16x32_bf16 v[176:179], v[44:47], a[204:207], v[176:179]
    buffer_load_dwordx4 v4, s[4:7], s32 offen offset:1024 sc1 lds
    v_mfma_f32_16x16x32_bf16 v[180:183], v[40:43], a[224:227], v[180:183]
    v_add_f32 v5, v5, v17
    v_mfma_f32_16x16x32_bf16 v[180:183], v[44:47], a[228:231], v[180:183]
    v_exp_f32 v19, v99
    v_mfma_f32_16x16x32_bf16 v[184:187], v[40:43], a[248:251], v[184:187]
    ds_read_b128 v[36:39], v3 offset:12544
    v_cvt_pk_bf16_f32 v162, v16, v17
    v_mfma_f32_16x16x32_bf16 v[184:187], v[44:47], a[252:255], v[184:187]
    buffer_load_dwordx4 v4, s[4:7], s32 offen offset:2048 sc1 lds
    v_mfma_f32_16x16x32_bf16 v[188:191], v[40:43], v[208:211], v[188:191]
    v_exp_f32 v16, v164
    v_mfma_f32_16x16x32_bf16 v[188:191], v[44:47], v[212:215], v[188:191]
    s_waitcnt lgkmcnt(2)
    v_add_f32 v5, v5, v18
    v_add_f32 v5, v5, v19
    v_mfma_f32_16x16x32_bf16 v[112:115], v[24:27], a[200:203], v[112:115]
    ds_read_b128 v[40:43], v2 offset:18688
    v_mfma_f32_16x16x32_bf16 v[112:115], v[28:31], a[204:207], v[112:115]
    v_exp_f32 v17, v165
    v_mfma_f32_16x16x32_bf16 v[116:119], v[24:27], a[224:227], v[116:119]
    v_cvt_pk_bf16_f32 v163, v18, v19
    v_mfma_f32_16x16x32_bf16 v[116:119], v[28:31], a[228:231], v[116:119]
    s_add_u32 s32, s32, 24576
    v_exp_f32 v18, v166
    v_mfma_f32_16x16x32_bf16 v[120:123], v[24:27], a[248:251], v[120:123]
    s_add_u32 s26, s26, 36864
    ds_read_b128 v[44:47], v3 offset:18688
    v_add_f32 v6, v6, v16
    v_mfma_f32_16x16x32_bf16 v[120:123], v[28:31], a[252:255], v[120:123]
    s_waitcnt lgkmcnt(2)
    v_add_f32 v6, v6, v17
    s_sub_u32 s57, s26, 147456
    v_mfma_f32_16x16x32_bf16 v[124:127], v[24:27], v[208:211], v[124:127]
    s_waitcnt vmcnt(6)
    v_exp_f32 v19, v167
    v_mfma_f32_16x16x32_bf16 v[124:127], v[28:31], v[212:215], v[124:127]
    s_barrier
    v_cvt_pk_bf16_f32 v164, v16, v17
    v_mfma_f32_16x16x32_bf16 v[176:179], v[32:35], a[208:211], v[176:179]
L_pg9:
    s_cbranch_execz L_pg13
    s_min_u32 s26, s26, s57
    ds_read_b128 v[24:27], v1 offset:0
    v_add_u32 v0, 1, v0
    v_mfma_f32_16x16x32_bf16 v[176:179], v[36:39], a[212:215], v[176:179]
    buffer_store_dword v0, v13, s[20:23], 0 offen offset:32 sc1
    v_mfma_f32_16x16x32_bf16 v[180:183], v[32:35], a[232:235], v[180:183]
    v_exp_f32 v16, v100
    v_mfma_f32_16x16x32_bf16 v[180:183], v[36:39], a[236:239], v[180:183]
    v_add_f32 v6, v6, v18
    v_add_f32 v6, v6, v19
    v_mfma_f32_16x16x32_bf16 v[184:187], v[32:35], v[192:195], v[184:187]
    ds_read_b128 v[28:31], v1 offset:12288
    v_mfma_f32_16x16x32_bf16 v[184:187], v[36:39], v[196:199], v[184:187]
    v_exp_f32 v17, v101
    v_mfma_f32_16x16x32_bf16 v[188:191], v[32:35], v[216:219], v[188:191]
    v_cvt_pk_bf16_f32 v165, v18, v19
    v_mfma_f32_16x16x32_bf16 v[188:191], v[36:39], v[220:223], v[188:191]
    s_waitcnt lgkmcnt(2)
    v_exp_f32 v18, v102
    v_mfma_f32_16x16x32_bf16 v[112:115], v[40:43], a[208:211], v[112:115]
    ds_read_b128 v[32:35], v1 offset:1024
    v_add_f32 v6, v6, v16
    v_mfma_f32_16x16x32_bf16 v[112:115], v[44:47], a[212:215], v[112:115]
    v_add_f32 v6, v6, v17
    v_mfma_f32_16x16x32_bf16 v[116:119], v[40:43], a[232:235], v[116:119]
    v_exp_f32 v19, v103
    v_mfma_f32_16x16x32_bf16 v[116:119], v[44:47], a[236:239], v[116:119]
    v_cvt_pk_bf16_f32 v166, v16, v17
    v_mfma_f32_16x16x32_bf16 v[120:123], v[40:43], v[192:195], v[120:123]
    ds_read_b128 v[36:39], v1 offset:13312
    v_add_f32 v6, v6, v18
    v_mfma_f32_16x16x32_bf16 v[120:123], v[44:47], v[196:199], v[120:123]
    v_add_f32 v6, v6, v19
    v_cvt_pk_bf16_f32 v167, v18, v19
    v_mfma_f32_16x16x32_bf16 v[124:127], v[40:43], v[216:219], v[124:127]
    v_mfma_f32_16x16x32_bf16 v[124:127], v[44:47], v[220:223], v[124:127]
    s_waitcnt lgkmcnt(2)
    v_mfma_f32_16x16x32_bf16 a[0:3], v[64:67], v[24:27], a[0:3]
    s_mov_b32 m0, s26
    ds_read_b128 v[40:43], v1 offset:2048
    v_mfma_f32_16x16x32_bf16 a[0:3], v[80:83], v[28:31], a[0:3]
    buffer_load_dwordx4 v4, s[4:7], s32 offen offset:0 sc1 lds
    v_mfma_f32_16x16x32_bf16 a[48:51], v[68:71], v[24:27], a[48:51]
    v_exp_f32 v16, v168
    v_mfma_f32_16x16x32_bf16 a[48:51], v[84:87], v[28:31], a[48:51]
    v_exp_f32 v17, v169
    v_mfma_f32_16x16x32_bf16 a[96:99], v[72:75], v[24:27], a[96:99]
    ds_read_b128 v[44:47], v1 offset:14336
    v_mfma_f32_16x16x32_bf16 a[96:99], v[88:91], v[28:31], a[96:99]
    v_exp_f32 v18, v170
    v_mfma_f32_16x16x32_bf16 a[144:147], v[76:79], v[24:27], a[144:147]
    v_add_f32 v7, v7, v16
    v_add_f32 v7, v7, v17
    v_mfma_f32_16x16x32_bf16 a[144:147], v[92:95], v[28:31], a[144:147]
    s_waitcnt lgkmcnt(2)
    v_exp_f32 v19, v171
    v_mfma_f32_16x16x32_bf16 a[4:7], v[64:67], v[32:35], a[4:7]
    ds_read_b128 v[24:27], v1 offset:3072
    v_cvt_pk_bf16_f32 v168, v16, v17
    v_mfma_f32_16x16x32_bf16 a[4:7], v[80:83], v[36:39], a[4:7]
    v_exp_f32 v16, v104
    v_mfma_f32_16x16x32_bf16 a[52:55], v[68:71], v[32:35], a[52:55]
    v_add_f32 v7, v7, v18
    v_add_f32 v7, v7, v19
    v_mfma_f32_16x16x32_bf16 a[52:55], v[84:87], v[36:39], a[52:55]
    buffer_load_dwordx4 v4, s[4:7], s32 offen offset:1024 sc1 lds
    v_mfma_f32_16x16x32_bf16 a[100:103], v[72:75], v[32:35], a[100:103]
    ds_read_b128 v[28:31], v1 offset:15360
    v_mfma_f32_16x16x32_bf16 a[100:103], v[88:91], v[36:39], a[100:103]
    v_exp_f32 v17, v105
    v_mfma_f32_16x16x32_bf16 a[148:151], v[76:79], v[32:35], a[148:151]
    v_cvt_pk_bf16_f32 v169, v18, v19
    v_mfma_f32_16x16x32_bf16 a[148:151], v[92:95], v[36:39], a[148:151]
    s_waitcnt lgkmcnt(2)
    v_exp_f32 v18, v106
    v_mfma_f32_16x16x32_bf16 a[8:11], v[64:67], v[40:43], a[8:11]
    ds_read_b128 v[32:35], v1 offset:4096
    v_add_f32 v7, v7, v16
    v_mfma_f32_16x16x32_bf16 a[8:11], v[80:83], v[44:47], a[8:11]
    v_add_f32 v7, v7, v17
    v_mfma_f32_16x16x32_bf16 a[56:59], v[68:71], v[40:43], a[56:59]
    v_exp_f32 v19, v107
    v_mfma_f32_16x16x32_bf16 a[56:59], v[84:87], v[44:47], a[56:59]
    v_cvt_pk_bf16_f32 v170, v16, v17
    v_mfma_f32_16x16x32_bf16 a[104:107], v[72:75], v[40:43], a[104:107]
    ds_read_b128 v[36:39], v1 offset:16384
    v_mfma_f32_16x16x32_bf16 a[104:107], v[88:91], v[44:47], a[104:107]
    v_exp_f32 v16, v172
    v_mfma_f32_16x16x32_bf16 a[152:155], v[76:79], v[40:43], a[152:155]
    v_add_f32 v7, v7, v18
    v_add_f32 v7, v7, v19
    v_mfma_f32_16x16x32_bf16 a[152:155], v[92:95], v[44:47], a[152:155]
    s_waitcnt lgkmcnt(2)
    buffer_load_dwordx4 v4, s[4:7], s32 offen offset:2048 sc1 lds
    v_mfma_f32_16x16x32_bf16 a[12:15], v[64:67], v[24:27], a[12:15]
    ds_read_b128 v[40:43], v1 offset:5120
    v_mfma_f32_16x16x32_bf16 a[12:15], v[80:83], v[28:31], a[12:15]
    v_exp_f32 v17, v173
    v_mfma_f32_16x16x32_bf16 a[60:63], v[68:71], v[24:27], a[60:63]
    v_cvt_pk_bf16_f32 v171, v18, v19
    v_mfma_f32_16x16x32_bf16 a[60:63], v[84:87], v[28:31], a[60:63]
    v_exp_f32 v18, v174
    v_mfma_f32_16x16x32_bf16 a[108:111], v[72:75], v[24:27], a[108:111]
    ds_read_b128 v[44:47], v1 offset:17408
    v_add_f32 v8, v8, v16
    v_mfma_f32_16x16x32_bf16 a[108:111], v[88:91], v[28:31], a[108:111]
    v_add_f32 v8, v8, v17
    v_mfma_f32_16x16x32_bf16 a[156:159], v[76:79], v[24:27], a[156:159]
    s_add_u32 s29, s28, 49152
    v_exp_f32 v19, v175
    v_mfma_f32_16x16x32_bf16 a[156:159], v[92:95], v[28:31], a[156:159]
    s_waitcnt lgkmcnt(2)
    v_cvt_pk_bf16_f32 v172, v16, v17
    s_sub_u32 s3, s29, 147456
    v_mfma_f32_16x16x32_bf16 a[16:19], v[64:67], v[32:35], a[16:19]
    s_add_u32 s32, s32, 24576
    ds_read_b128 v[24:27], v1 offset:6144
    v_mfma_f32_16x16x32_bf16 a[16:19], v[80:83], v[36:39], a[16:19]
    s_min_u32 s29, s29, s3
    v_exp_f32 v16, v108
    v_mfma_f32_16x16x32_bf16 a[64:67], v[68:71], v[32:35], a[64:67]
    v_add_f32 v8, v8, v18
    v_add_f32 v8, v8, v19
    v_mfma_f32_16x16x32_bf16 a[64:67], v[84:87], v[36:39], a[64:67]
    v_exp_f32 v17, v109
    v_mfma_f32_16x16x32_bf16 a[112:115], v[72:75], v[32:35], a[112:115]
    s_add_u32 s26, s26, 12288
    ds_read_b128 v[28:31], v1 offset:18432
    v_mfma_f32_16x16x32_bf16 a[112:115], v[88:91], v[36:39], a[112:115]
    v_cvt_pk_bf16_f32 v173, v18, v19
    v_mfma_f32_16x16x32_bf16 a[160:163], v[76:79], v[32:35], a[160:163]
    v_exp_f32 v18, v110
    v_mfma_f32_16x16x32_bf16 a[160:163], v[92:95], v[36:39], a[160:163]
    s_waitcnt lgkmcnt(2)
    v_add_f32 v8, v8, v16
    v_mfma_f32_16x16x32_bf16 a[20:23], v[64:67], v[40:43], a[20:23]
    s_sub_u32 s3, s29, s28
    ds_read_b128 v[32:35], v1 offset:7168
    v_add_f32 v8, v8, v17
    v_mfma_f32_16x16x32_bf16 a[20:23], v[80:83], v[44:47], a[20:23]
    v_exp_f32 v19, v111
    v_mfma_f32_16x16x32_bf16 a[68:71], v[68:71], v[40:43], a[68:71]
    s_mov_b32 m0, s26
    v_mfma_f32_16x16x32_bf16 a[68:71], v[84:87], v[44:47], a[68:71]
    v_cvt_pk_bf16_f32 v174, v16, v17
    v_mfma_f32_16x16x32_bf16 a[116:119], v[72:75], v[40:43], a[116:119]
    ds_read_b128 v[36:39], v1 offset:19456
    v_add_f32 v8, v8, v18
    v_mfma_f32_16x16x32_bf16 a[116:119], v[88:91], v[44:47], a[116:119]
    v_add_f32 v8, v8, v19
    v_cvt_pk_bf16_f32 v175, v18, v19
    v_mfma_f32_16x16x32_bf16 a[164:167], v[76:79], v[40:43], a[164:167]
    s_mov_b32 s28, s29
    v_mfma_f32_16x16x32_bf16 a[164:167], v[92:95], v[44:47], a[164:167]
    s_waitcnt lgkmcnt(2)
    v_exp_f32 v16, v176
    v_mfma_f32_16x16x32_bf16 a[24:27], v[64:67], v[24:27], a[24:27]
    ds_read_b128 v[40:43], v1 offset:8192
    v_mfma_f32_16x16x32_bf16 a[24:27], v[80:83], v[28:31], a[24:27]
    v_exp_f32 v17, v177
    v_mfma_f32_16x16x32_bf16 a[72:75], v[68:71], v[24:27], a[72:75]
    v_exp_f32 v18, v178
    v_mfma_f32_16x16x32_bf16 a[72:75], v[84:87], v[28:31], a[72:75]
    buffer_load_dwordx4 v4, s[4:7], s32 offen offset:0 sc1 lds
    v_mfma_f32_16x16x32_bf16 a[120:123], v[72:75], v[24:27], a[120:123]
    ds_read_b128 v[44:47], v1 offset:20480
    v_add_f32 v5, v5, v16
    v_mfma_f32_16x16x32_bf16 a[120:123], v[88:91], v[28:31], a[120:123]
    v_add_f32 v5, v5, v17
    v_add_u32 v2, s3, v2
    v_mfma_f32_16x16x32_bf16 a[168:171], v[76:79], v[24:27], a[168:171]
    v_exp_f32 v19, v179
    v_mfma_f32_16x16x32_bf16 a[168:171], v[92:95], v[28:31], a[168:171]
    s_waitcnt lgkmcnt(2)
    v_cvt_pk_bf16_f32 v176, v16, v17
    v_mfma_f32_16x16x32_bf16 a[28:31], v[64:67], v[32:35], a[28:31]
    ds_read_b128 v[24:27], v1 offset:9216
    v_mfma_f32_16x16x32_bf16 a[28:31], v[80:83], v[36:39], a[28:31]
    v_exp_f32 v16, v112
    v_mfma_f32_16x16x32_bf16 a[76:79], v[68:71], v[32:35], a[76:79]
    v_add_f32 v5, v5, v18
    v_add_f32 v5, v5, v19
    v_mfma_f32_16x16x32_bf16 a[76:79], v[84:87], v[36:39], a[76:79]
    v_exp_f32 v17, v113
    v_mfma_f32_16x16x32_bf16 a[124:127], v[72:75], v[32:35], a[124:127]
    ds_read_b128 v[28:31], v1 offset:21504
    v_add_u32 v3, s3, v3
    v_mfma_f32_16x16x32_bf16 a[124:127], v[88:91], v[36:39], a[124:127]
    v_cvt_pk_bf16_f32 v177, v18, v19
    v_mfma_f32_16x16x32_bf16 a[172:175], v[76:79], v[32:35], a[172:175]
    v_exp_f32 v18, v114
    v_mfma_f32_16x16x32_bf16 a[172:175], v[92:95], v[36:39], a[172:175]
    s_waitcnt lgkmcnt(2)
    buffer_load_dwordx4 v4, s[4:7], s32 offen offset:1024 sc1 lds
    v_mfma_f32_16x16x32_bf16 a[32:35], v[64:67], v[40:43], a[32:35]
    ds_read_b128 v[32:35], v1 offset:10240
    v_add_f32 v5, v5, v16
    v_mfma_f32_16x16x32_bf16 a[32:35], v[80:83], v[44:47], a[32:35]
    v_add_f32 v5, v5, v17
    v_mfma_f32_16x16x32_bf16 a[80:83], v[68:71], v[40:43], a[80:83]
    v_exp_f32 v19, v115
    v_mfma_f32_16x16x32_bf16 a[80:83], v[84:87], v[44:47], a[80:83]
    v_cvt_pk_bf16_f32 v178, v16, v17
    v_mfma_f32_16x16x32_bf16 a[128:131], v[72:75], v[40:43], a[128:131]
    ds_read_b128 v[36:39], v1 offset:22528
    v_mfma_f32_16x16x32_bf16 a[128:131], v[88:91], v[44:47], a[128:131]
    v_exp_f32 v16, v180
    v_mfma_f32_16x16x32_bf16 a[176:179], v[76:79], v[40:43], a[176:179]
    v_add_f32 v5, v5, v18
    v_add_f32 v5, v5, v19
    v_mfma_f32_16x16x32_bf16 a[176:179], v[92:95], v[44:47], a[176:179]
    s_waitcnt lgkmcnt(2)
    v_exp_f32 v17, v181
    v_mfma_f32_16x16x32_bf16 a[36:39], v[64:67], v[24:27], a[36:39]
    ds_read_b128 v[40:43], v1 offset:11264
    v_mfma_f32_16x16x32_bf16 a[36:39], v[80:83], v[28:31], a[36:39]
    buffer_load_dwordx4 v4, s[4:7], s32 offen offset:2048 sc1 lds
    v_mfma_f32_16x16x32_bf16 a[84:87], v[68:71], v[24:27], a[84:87]
    v_cvt_pk_bf16_f32 v179, v18, v19
    v_mfma_f32_16x16x32_bf16 a[84:87], v[84:87], v[28:31], a[84:87]
    v_exp_f32 v18, v182
    v_mfma_f32_16x16x32_bf16 a[132:135], v[72:75], v[24:27], a[132:135]
    ds_read_b128 v[44:47], v1 offset:23552
    v_add_f32 v6, v6, v16
    v_mfma_f32_16x16x32_bf16 a[132:135], v[88:91], v[28:31], a[132:135]
    s_waitcnt lgkmcnt(2)
    v_add_f32 v6, v6, v17
    v_mfma_f32_16x16x32_bf16 a[180:183], v[76:79], v[24:27], a[180:183]
    s_waitcnt vmcnt(7)
    v_exp_f32 v19, v183
    v_mfma_f32_16x16x32_bf16 a[180:183], v[92:95], v[28:31], a[180:183]
    s_barrier
    v_cvt_pk_bf16_f32 v180, v16, v17
    v_mfma_f32_16x16x32_bf16 a[40:43], v[64:67], v[32:35], a[40:43]
    ds_read_b128 v[24:27], v2 offset:0
    v_mfma_f32_16x16x32_bf16 a[40:43], v[80:83], v[36:39], a[40:43]
    v_exp_f32 v16, v116
    v_mfma_f32_16x16x32_bf16 a[88:91], v[68:71], v[32:35], a[88:91]
    v_add_f32 v6, v6, v18
    v_add_f32 v6, v6, v19
    v_mfma_f32_16x16x32_bf16 a[88:91], v[84:87], v[36:39], a[88:91]
    v_exp_f32 v17, v117
    v_mfma_f32_16x16x32_bf16 a[136:139], v[72:75], v[32:35], a[136:139]
    ds_read_b128 v[28:31], v3 offset:0
    v_mfma_f32_16x16x32_bf16 a[136:139], v[88:91], v[36:39], a[136:139]
    v_cvt_pk_bf16_f32 v181, v18, v19
    v_mfma_f32_16x16x32_bf16 a[184:187], v[76:79], v[32:35], a[184:187]
    v_exp_f32 v18, v118
    v_mfma_f32_16x16x32_bf16 a[184:187], v[92:95], v[36:39], a[184:187]
    s_waitcnt lgkmcnt(2)
    v_add_f32 v6, v6, v16
    v_mfma_f32_16x16x32_bf16 a[44:47], v[64:67], v[40:43], a[44:47]
    ds_read_b128 v[32:35], v2 offset:6144
    v_add_f32 v6, v6, v17
    v_mfma_f32_16x16x32_bf16 a[44:47], v[80:83], v[44:47], a[44:47]
    v_exp_f32 v19, v119
    v_mfma_f32_16x16x32_bf16 a[92:95], v[68:71], v[40:43], a[92:95]
    v_mfma_f32_16x16x32_bf16 a[92:95], v[84:87], v[44:47], a[92:95]
    s_add_u32 s32, s32, 24576
    s_add_u32 s26, s26, 36864
    v_cvt_pk_bf16_f32 v182, v16, v17
    v_mfma_f32_16x16x32_bf16 a[140:143], v[72:75], v[40:43], a[140:143]
    s_sub_u32 s57, s26, 147456
    ds_read_b128 v[36:39], v3 offset:6144
    v_add_f32 v6, v6, v18
    v_mfma_f32_16x16x32_bf16 a[140:143], v[88:91], v[44:47], a[140:143]
    s_min_u32 s26, s26, s57
    v_add_f32 v6, v6, v19
    v_cvt_pk_bf16_f32 v183, v18, v19
    v_mfma_f32_16x16x32_bf16 a[188:191], v[76:79], v[40:43], a[188:191]
    v_mfma_f32_16x16x32_bf16 a[188:191], v[92:95], v[44:47], a[188:191]
    s_waitcnt lgkmcnt(2)
    v_mfma_f32_16x16x32_bf16 v[64:67], v[24:27], a[192:195], v[128:131]
    ds_read_b128 v[40:43], v2 offset:128
    v_mfma_f32_16x16x32_bf16 v[64:67], v[28:31], a[196:199], v[64:67]
    v_exp_f32 v16, v184
    v_mfma_f32_16x16x32_bf16 v[68:71], v[24:27], a[216:219], v[132:135]
    v_exp_f32 v17, v185
    v_mfma_f32_16x16x32_bf16 v[68:71], v[28:31], a[220:223], v[68:71]
    buffer_load_dword v52, v20, s[20:23], s44 offen sc1
    v_mfma_f32_16x16x32_bf16 v[72:75], v[24:27], a[240:243], v[136:139]
    ds_read_b128 v[44:47], v3 offset:128
    v_mfma_f32_16x16x32_bf16 v[72:75], v[28:31], a[244:247], v[72:75]
    v_exp_f32 v18, v186
    v_mfma_f32_16x16x32_bf16 v[76:79], v[24:27], v[200:203], v[140:143]
    v_add_f32 v7, v7, v16
    v_add_f32 v7, v7, v17
    v_mfma_f32_16x16x32_bf16 v[76:79], v[28:31], v[204:207], v[76:79]
    s_waitcnt lgkmcnt(2)
    v_exp_f32 v19, v187
    v_mfma_f32_16x16x32_bf16 v[96:99], v[32:35], a[192:195], v[128:131]
    ds_read_b128 v[24:27], v2 offset:6272
    v_cvt_pk_bf16_f32 v184, v16, v17
    v_mfma_f32_16x16x32_bf16 v[96:99], v[36:39], a[196:199], v[96:99]
    v_exp_f32 v16, v120
    v_mfma_f32_16x16x32_bf16 v[100:103], v[32:35], a[216:219], v[132:135]
    v_add_f32 v7, v7, v18
    v_add_f32 v7, v7, v19
    v_mfma_f32_16x16x32_bf16 v[100:103], v[36:39], a[220:223], v[100:103]
    s_mov_b32 m0, s26
    v_exp_f32 v17, v121
    v_mfma_f32_16x16x32_bf16 v[104:107], v[32:35], a[240:243], v[136:139]
    ds_read_b128 v[28:31], v3 offset:6272
    v_mfma_f32_16x16x32_bf16 v[104:107], v[36:39], a[244:247], v[104:107]
    buffer_load_dwordx4 v4, s[4:7], s32 offen offset:0 sc1 lds
    v_mfma_f32_16x16x32_bf16 v[108:111], v[32:35], v[200:203], v[140:143]
    v_cvt_pk_bf16_f32 v185, v18, v19
    v_mfma_f32_16x16x32_bf16 v[108:111], v[36:39], v[204:207], v[108:111]
    s_waitcnt lgkmcnt(2)
    v_exp_f32 v18, v122
    v_mfma_f32_16x16x32_bf16 v[64:67], v[40:43], a[200:203], v[64:67]
    ds_read_b128 v[32:35], v2 offset:256
    v_add_f32 v7, v7, v16
    v_mfma_f32_16x16x32_bf16 v[64:67], v[44:47], a[204:207], v[64:67]
    v_add_f32 v7, v7, v17
    v_mfma_f32_16x16x32_bf16 v[68:71], v[40:43], a[224:227], v[68:71]
    v_exp_f32 v19, v123
    v_mfma_f32_16x16x32_bf16 v[68:71], v[44:47], a[228:231], v[68:71]
    v_cvt_pk_bf16_f32 v186, v16, v17
    v_mfma_f32_16x16x32_bf16 v[72:75], v[40:43], a[248:251], v[72:75]
    ds_read_b128 v[36:39], v3 offset:256
    v_mfma_f32_16x16x32_bf16 v[72:75], v[44:47], a[252:255], v[72:75]
    buffer_load_dwordx4 v4, s[4:7], s32 offen offset:1024 sc1 lds
    v_mfma_f32_16x16x32_bf16 v[76:79], v[40:43], v[208:211], v[76:79]
    v_exp_f32 v16, v188
    v_mfma_f32_16x16x32_bf16 v[76:79], v[44:47], v[212:215], v[76:79]
    s_waitcnt lgkmcnt(2)
    v_add_f32 v7, v7, v18
    v_add_f32 v7, v7, v19
    v_mfma_f32_16x16x32_bf16 v[96:99], v[24:27], a[200:203], v[96:99]
    ds_read_b128 v[40:43], v2 offset:6400
    v_mfma_f32_16x16x32_bf16 v[96:99], v[28:31], a[204:207], v[96:99]
    v_exp_f32 v17, v189
    v_mfma_f32_16x16x32_bf16 v[100:103], v[24:27], a[224:227], v[100:103]
    v_cvt_pk_bf16_f32 v187, v18, v19
    v_mfma_f32_16x16x32_bf16 v[100:103], v[28:31], a[228:231], v[100:103]
    v_exp_f32 v18, v190
    v_mfma_f32_16x16x32_bf16 v[104:107], v[24:27], a[248:251], v[104:107]
    ds_read_b128 v[44:47], v3 offset:6400
    v_add_f32 v8, v8, v16
    v_mfma_f32_16x16x32_bf16 v[104:107], v[28:31], a[252:255], v[104:107]
    v_add_f32 v8, v8, v17
    v_mfma_f32_16x16x32_bf16 v[108:111], v[24:27], v[208:211], v[108:111]
    s_add_u32 s29, s30, 49152
    v_exp_f32 v19, v191
    v_mfma_f32_16x16x32_bf16 v[108:111], v[28:31], v[212:215], v[108:111]
    s_waitcnt lgkmcnt(2)
    buffer_load_dwordx4 v4, s[4:7], s32 offen offset:2048 sc1 lds
    v_mfma_f32_16x16x32_bf16 v[64:67], v[32:35], a[208:211], v[64:67]
    s_sub_u32 s3, s29, 147456
    ds_read_b128 v[24:27], v2 offset:12288
    v_cvt_pk_bf16_f32 v188, v16, v17
    v_mfma_f32_16x16x32_bf16 v[64:67], v[36:39], a[212:215], v[64:67]
    s_min_u32 s29, s29, s3
    v_exp_f32 v16, v124
    v_mfma_f32_16x16x32_bf16 v[68:71], v[32:35], a[232:235], v[68:71]
    v_add_f32 v8, v8, v18
    v_add_f32 v8, v8, v19
    v_mfma_f32_16x16x32_bf16 v[68:71], v[36:39], a[236:239], v[68:71]
    v_exp_f32 v17, v125
    v_mfma_f32_16x16x32_bf16 v[72:75], v[32:35], v[192:195], v[72:75]
    ds_read_b128 v[28:31], v3 offset:12288
    v_mfma_f32_16x16x32_bf16 v[72:75], v[36:39], v[196:199], v[72:75]
    v_cvt_pk_bf16_f32 v189, v18, v19
    v_mfma_f32_16x16x32_bf16 v[76:79], v[32:35], v[216:219], v[76:79]
    v_exp_f32 v18, v126
    v_mfma_f32_16x16x32_bf16 v[76:79], v[36:39], v[220:223], v[76:79]
    s_waitcnt lgkmcnt(2)
    v_add_f32 v8, v8, v16
    s_add_u32 s32, s32, 24576
    v_mfma_f32_16x16x32_bf16 v[96:99], v[40:43], a[208:211], v[96:99]
    ds_read_b128 v[32:35], v2 offset:18432
    v_add_f32 v8, v8, v17
    v_mfma_f32_16x16x32_bf16 v[96:99], v[44:47], a[212:215], v[96:99]
    s_sub_u32 s3, s29, s30
    v_exp_f32 v19, v127
    v_mfma_f32_16x16x32_bf16 v[100:103], v[40:43], a[232:235], v[100:103]
    v_mfma_f32_16x16x32_bf16 v[100:103], v[44:47], a[236:239], v[100:103]
    v_cvt_pk_bf16_f32 v190, v16, v17
    v_mfma_f32_16x16x32_bf16 v[104:107], v[40:43], v[192:195], v[104:107]
    s_add_u32 s26, s26, 12288
    ds_read_b128 v[36:39], v3 offset:18432
    v_add_f32 v8, v8, v18
    v_mfma_f32_16x16x32_bf16 v[104:107], v[44:47], v[196:199], v[104:107]
    v_add_f32 v8, v8, v19
    v_cvt_pk_bf16_f32 v191, v18, v19
    v_mfma_f32_16x16x32_bf16 v[108:111], v[40:43], v[216:219], v[108:111]
    v_mfma_f32_16x16x32_bf16 v[108:111], v[44:47], v[220:223], v[108:111]
    s_waitcnt lgkmcnt(2)
    v_exp_f32 v16, v64
    v_mfma_f32_16x16x32_bf16 v[80:83], v[24:27], a[192:195], v[128:131]
    ds_read_b128 v[40:43], v2 offset:12416
    v_mfma_f32_16x16x32_bf16 v[80:83], v[28:31], a[196:199], v[80:83]
    s_mov_b32 m0, s26
    v_exp_f32 v17, v65
    v_mfma_f32_16x16x32_bf16 v[84:87], v[24:27], a[216:219], v[132:135]
    s_mov_b32 s30, s29
    v_exp_f32 v18, v66
    v_mfma_f32_16x16x32_bf16 v[84:87], v[28:31], a[220:223], v[84:87]
    v_add_f32 v5, v5, v16
    v_mfma_f32_16x16x32_bf16 v[88:91], v[24:27], a[240:243], v[136:139]
    ds_read_b128 v[44:47], v3 offset:12416
    v_add_f32 v5, v5, v17
    v_mfma_f32_16x16x32_bf16 v[88:91], v[28:31], a[244:247], v[88:91]
    v_exp_f32 v19, v67
    v_mfma_f32_16x16x32_bf16 v[92:95], v[24:27], v[200:203], v[140:143]
    v_mfma_f32_16x16x32_bf16 v[92:95], v[28:31], v[204:207], v[92:95]
    s_waitcnt lgkmcnt(2)
    v_cvt_pk_bf16_f32 v64, v16, v17
    v_mfma_f32_16x16x32_bf16 v[112:115], v[32:35], a[192:195], v[128:131]
    ds_read_b128 v[24:27], v2 offset:18560
    v_mfma_f32_16x16x32_bf16 v[112:115], v[36:39], a[196:199], v[112:115]
    buffer_load_dwordx4 v4, s[4:7], s32 offen offset:0 sc1 lds
    v_mfma_f32_16x16x32_bf16 v[116:119], v[32:35], a[216:219], v[132:135]
    v_exp_f32 v16, v96
    v_mfma_f32_16x16x32_bf16 v[116:119], v[36:39], a[220:223], v[116:119]
    v_add_f32 v5, v5, v18
    v_add_f32 v5, v5, v19
    v_mfma_f32_16x16x32_bf16 v[120:123], v[32:35], a[240:243], v[136:139]
    ds_read_b128 v[28:31], v3 offset:18560
    v_add_u32 v1, s3, v1
    v_mfma_f32_16x16x32_bf16 v[120:123], v[36:39], a[244:247], v[120:123]
    v_exp_f32 v17, v97
    v_mfma_f32_16x16x32_bf16 v[124:127], v[32:35], v[200:203], v[140:143]
    v_cvt_pk_bf16_f32 v65, v18, v19
    v_mfma_f32_16x16x32_bf16 v[124:127], v[36:39], v[204:207], v[124:127]
    s_waitcnt lgkmcnt(2)
    v_exp_f32 v18, v98
    v_mfma_f32_16x16x32_bf16 v[80:83], v[40:43], a[200:203], v[80:83]
    ds_read_b128 v[32:35], v2 offset:12544
    v_add_f32 v5, v5, v16
    v_mfma_f32_16x16x32_bf16 v[80:83], v[44:47], a[204:207], v[80:83]
    v_add_f32 v5, v5, v17
    v_mfma_f32_16x16x32_bf16 v[84:87], v[40:43], a[224:227], v[84:87]
    v_exp_f32 v19, v99
    v_mfma_f32_16x16x32_bf16 v[84:87], v[44:47], a[228:231], v[84:87]
    buffer_load_dwordx4 v4, s[4:7], s32 offen offset:1024 sc1 lds
    v_mfma_f32_16x16x32_bf16 v[88:91], v[40:43], a[248:251], v[88:91]
    ds_read_b128 v[36:39], v3 offset:12544
    v_cvt_pk_bf16_f32 v66, v16, v17
    v_mfma_f32_16x16x32_bf16 v[88:91], v[44:47], a[252:255], v[88:91]
    v_exp_f32 v16, v68
    v_mfma_f32_16x16x32_bf16 v[92:95], v[40:43], v[208:211], v[92:95]
    v_add_f32 v5, v5, v18
    v_add_f32 v5, v5, v19
    v_mfma_f32_16x16x32_bf16 v[92:95], v[44:47], v[212:215], v[92:95]
    s_waitcnt lgkmcnt(2)
    v_exp_f32 v17, v69
    v_mfma_f32_16x16x32_bf16 v[112:115], v[24:27], a[200:203], v[112:115]
    ds_read_b128 v[40:43], v2 offset:18688
    v_mfma_f32_16x16x32_bf16 v[112:115], v[28:31], a[204:207], v[112:115]
    v_cvt_pk_bf16_f32 v67, v18, v19
    v_mfma_f32_16x16x32_bf16 v[116:119], v[24:27], a[224:227], v[116:119]
    v_exp_f32 v18, v70
    v_mfma_f32_16x16x32_bf16 v[116:119], v[28:31], a[228:231], v[116:119]
    v_add_f32 v6, v6, v16
    v_mfma_f32_16x16x32_bf16 v[120:123], v[24:27], a[248:251], v[120:123]
    ds_read_b128 v[44:47], v3 offset:18688
    v_add_f32 v6, v6, v17
    v_mfma_f32_16x16x32_bf16 v[120:123], v[28:31], a[252:255], v[120:123]
    s_waitcnt lgkmcnt(2)
    buffer_load_dwordx4 v4, s[4:7], s32 offen offset:2048 sc1 lds
    v_mfma_f32_16x16x32_bf16 v[124:127], v[24:27], v[208:211], v[124:127]
    s_waitcnt vmcnt(7)
    v_exp_f32 v19, v71
    v_mfma_f32_16x16x32_bf16 v[124:127], v[28:31], v[212:215], v[124:127]
    s_barrier
    v_cvt_pk_bf16_f32 v68, v16, v17
    v_mfma_f32_16x16x32_bf16 v[80:83], v[32:35], a[208:211], v[80:83]
    ds_read_b128 v[24:27], v1 offset:0
    v_mfma_f32_16x16x32_bf16 v[80:83], v[36:39], a[212:215], v[80:83]
    v_exp_f32 v16, v100
    v_mfma_f32_16x16x32_bf16 v[84:87], v[32:35], a[232:235], v[84:87]
    v_add_f32 v6, v6, v18
    v_add_f32 v6, v6, v19
    v_mfma_f32_16x16x32_bf16 v[84:87], v[36:39], a[236:239], v[84:87]
    v_exp_f32 v17, v101
    v_mfma_f32_16x16x32_bf16 v[88:91], v[32:35], v[192:195], v[88:91]
    ds_read_b128 v[28:31], v1 offset:12288
    v_mfma_f32_16x16x32_bf16 v[88:91], v[36:39], v[196:199], v[88:91]
    v_cvt_pk_bf16_f32 v69, v18, v19
    v_mfma_f32_16x16x32_bf16 v[92:95], v[32:35], v[216:219], v[92:95]
    v_exp_f32 v18, v102
    v_mfma_f32_16x16x32_bf16 v[92:95], v[36:39], v[220:223], v[92:95]
    s_waitcnt lgkmcnt(2)
    v_add_f32 v6, v6, v16
    v_mfma_f32_16x16x32_bf16 v[112:115], v[40:43], a[208:211], v[112:115]
    ds_read_b128 v[32:35], v1 offset:1024
    v_add_f32 v6, v6, v17
    v_mfma_f32_16x16x32_bf16 v[112:115], v[44:47], a[212:215], v[112:115]
    v_exp_f32 v19, v103
    v_mfma_f32_16x16x32_bf16 v[116:119], v[40:43], a[232:235], v[116:119]
    v_mfma_f32_16x16x32_bf16 v[116:119], v[44:47], a[236:239], v[116:119]
    v_cvt_pk_bf16_f32 v70, v16, v17
    v_mfma_f32_16x16x32_bf16 v[120:123], v[40:43], v[192:195], v[120:123]
    ds_read_b128 v[36:39], v1 offset:13312
    v_add_f32 v6, v6, v18
    v_mfma_f32_16x16x32_bf16 v[120:123], v[44:47], v[196:199], v[120:123]
    s_add_u32 s32, s32, 24576
    s_add_u32 s26, s26, 36864
    v_add_f32 v6, v6, v19
    v_mfma_f32_16x16x32_bf16 v[124:127], v[40:43], v[216:219], v[124:127]
    s_sub_u32 s57, s26, 147456
    v_cvt_pk_bf16_f32 v71, v18, v19
    s_min_u32 s26, s26, s57
    v_mfma_f32_16x16x32_bf16 v[124:127], v[44:47], v[220:223], v[124:127]
    s_waitcnt lgkmcnt(2)
    v_mfma_f32_16x16x32_bf16 a[0:3], v[160:163], v[24:27], a[0:3]
    ds_read_b128 v[40:43], v1 offset:2048
    v_mfma_f32_16x16x32_bf16 a[0:3], v[176:179], v[28:31], a[0:3]
    s_waitcnt vmcnt(6)
    v_subrev_u32 v52, s92, v52
    v_cmp_lt_u32 vcc, 15, v52
    v_mfma_f32_16x16x32_bf16 a[48:51], v[164:167], v[24:27], a[48:51]
    v_exp_f32 v16, v72
    v_mfma_f32_16x16x32_bf16 a[48:51], v[180:183], v[28:31], a[48:51]
    v_exp_f32 v17, v73
    v_mfma_f32_16x16x32_bf16 a[96:99], v[168:171], v[24:27], a[96:99]
    s_and_b32 s59, vcc_lo, 0xff
    ds_read_b128 v[44:47], v1 offset:14336
    v_mfma_f32_16x16x32_bf16 a[96:99], v[184:187], v[28:31], a[96:99]
    s_cbranch_scc1 L_pollslow4
L_pollok4:
    v_mfma_f32_16x16x32_bf16 a[144:147], v[172:175], v[24:27], a[144:147]
    s_add_u32 s92, s92, 1
    v_exp_f32 v18, v74
    v_mfma_f32_16x16x32_bf16 a[144:147], v[188:191], v[28:31], a[144:147]
    s_waitcnt lgkmcnt(2)
    v_add_f32 v7, v7, v16
    v_add_f32 v7, v7, v17
    v_mfma_f32_16x16x32_bf16 a[4:7], v[160:163], v[32:35], a[4:7]
    ds_read_b128 v[24:27], v1 offset:3072
    v_mfma_f32_16x16x32_bf16 a[4:7], v[176:179], v[36:39], a[4:7]
    v_exp_f32 v19, v75
    v_mfma_f32_16x16x32_bf16 a[52:55], v[164:167], v[32:35], a[52:55]
    v_cvt_pk_bf16_f32 v72, v16, v17
    v_mfma_f32_16x16x32_bf16 a[52:55], v[180:183], v[36:39], a[52:55]
    v_exp_f32 v16, v104
    v_mfma_f32_16x16x32_bf16 a[100:103], v[168:171], v[32:35], a[100:103]
    ds_read_b128 v[28:31], v1 offset:15360
    v_add_f32 v7, v7, v18
    v_mfma_f32_16x16x32_bf16 a[100:103], v[184:187], v[36:39], a[100:103]
    s_waitcnt lgkmcnt(2)
    v_add_f32 v7, v7, v19
    v_mfma_f32_16x16x32_bf16 a[148:151], v[172:175], v[32:35], a[148:151]
    s_waitcnt vmcnt(0)
    v_exp_f32 v17, v105
    v_mfma_f32_16x16x32_bf16 a[148:151], v[188:191], v[36:39], a[148:151]
    s_barrier
    v_cvt_pk_bf16_f32 v73, v18, v19
    v_mfma_f32_16x16x32_bf16 a[8:11], v[160:163], v[40:43], a[8:11]
    s_mov_b32 m0, s56
    ds_read_b128 v[32:35], v1 offset:4096
    v_mfma_f32_16x16x32_bf16 a[8:11], v[176:179], v[44:47], a[8:11]
    buffer_load_dwordx4 v4, s[4:7], s27 offen offset:0 sc1 lds
    v_mfma_f32_16x16x32_bf16 a[56:59], v[164:167], v[40:43], a[56:59]
    v_exp_f32 v18, v106
    v_mfma_f32_16x16x32_bf16 a[56:59], v[180:183], v[44:47], a[56:59]
    v_add_f32 v7, v7, v16
    v_add_f32 v7, v7, v17
    v_mfma_f32_16x16x32_bf16 a[104:107], v[168:171], v[40:43], a[104:107]
    ds_read_b128 v[36:39], v1 offset:16384
    v_mfma_f32_16x16x32_bf16 a[104:107], v[184:187], v[44:47], a[104:107]
    buffer_load_dwordx4 v4, s[4:7], s27 offen offset:1024 sc1 lds
    v_mfma_f32_16x16x32_bf16 a[152:155], v[172:175], v[40:43], a[152:155]
    v_exp_f32 v19, v107
    v_mfma_f32_16x16x32_bf16 a[152:155], v[188:191], v[44:47], a[152:155]
    s_waitcnt lgkmcnt(2)
    v_cvt_pk_bf16_f32 v74, v16, v17
    v_mfma_f32_16x16x32_bf16 a[12:15], v[160:163], v[24:27], a[12:15]
    ds_read_b128 v[40:43], v1 offset:5120
    v_mfma_f32_16x16x32_bf16 a[12:15], v[176:179], v[28:31], a[12:15]
    buffer_load_dwordx4 v4, s[4:7], s27 offen offset:2048 sc1 lds
    v_mfma_f32_16x16x32_bf16 a[60:63], v[164:167], v[24:27], a[60:63]
    v_exp_f32 v16, v76
    v_mfma_f32_16x16x32_bf16 a[60:63], v[180:183], v[28:31], a[60:63]
    s_add_u32 s27, s27, 24576
    v_add_f32 v7, v7, v18
    v_add_f32 v7, v7, v19
    v_mfma_f32_16x16x32_bf16 a[108:111], v[168:171], v[24:27], a[108:111]
    ds_read_b128 v[44:47], v1 offset:17408
    v_mfma_f32_16x16x32_bf16 a[108:111], v[184:187], v[28:31], a[108:111]
    s_add_u32 s56, s56, 12288
    v_exp_f32 v17, v77
    v_mfma_f32_16x16x32_bf16 a[156:159], v[172:175], v[24:27], a[156:159]
    s_add_u32 s29, s28, 49152
    v_cvt_pk_bf16_f32 v75, v18, v19
    v_mfma_f32_16x16x32_bf16 a[156:159], v[188:191], v[28:31], a[156:159]
    s_waitcnt lgkmcnt(2)
    v_exp_f32 v18, v78
    v_mfma_f32_16x16x32_bf16 a[16:19], v[160:163], v[32:35], a[16:19]
    s_sub_u32 s3, s29, 147456
    ds_read_b128 v[24:27], v1 offset:6144
    v_add_f32 v8, v8, v16
    v_mfma_f32_16x16x32_bf16 a[16:19], v[176:179], v[36:39], a[16:19]
    s_mov_b32 m0, s56
    v_add_f32 v8, v8, v17
    s_min_u32 s29, s29, s3
    v_mfma_f32_16x16x32_bf16 a[64:67], v[164:167], v[32:35], a[64:67]
    v_exp_f32 v19, v79
    v_mfma_f32_16x16x32_bf16 a[64:67], v[180:183], v[36:39], a[64:67]
    buffer_load_dwordx4 v4, s[4:7], s27 offen offset:0 sc1 lds
    v_mfma_f32_16x16x32_bf16 a[112:115], v[168:171], v[32:35], a[112:115]
    ds_read_b128 v[28:31], v1 offset:18432
    v_cvt_pk_bf16_f32 v76, v16, v17
    v_mfma_f32_16x16x32_bf16 a[112:115], v[184:187], v[36:39], a[112:115]
    v_exp_f32 v16, v108
    v_mfma_f32_16x16x32_bf16 a[160:163], v[172:175], v[32:35], a[160:163]
    v_add_f32 v8, v8, v18
    v_add_f32 v8, v8, v19
    v_mfma_f32_16x16x32_bf16 a[160:163], v[188:191], v[36:39], a[160:163]
    s_waitcnt lgkmcnt(2)
    buffer_load_dwordx4 v4, s[4:7], s27 offen offset:1024 sc1 lds
    v_mfma_f32_16x16x32_bf16 a[20:23], v[160:163], v[40:43], a[20:23]
    s_sub_u32 s3, s29, s28
    ds_read_b128 v[32:35], v1 offset:7168
    v_mfma_f32_16x16x32_bf16 a[20:23], v[176:179], v[44:47], a[20:23]
    v_exp_f32 v17, v109
    v_mfma_f32_16x16x32_bf16 a[68:71], v[164:167], v[40:43], a[68:71]
    v_cvt_pk_bf16_f32 v77, v18, v19
    v_mfma_f32_16x16x32_bf16 a[68:71], v[180:183], v[44:47], a[68:71]
    buffer_load_dwordx4 v4, s[4:7], s27 offen offset:2048 sc1 lds
    v_mfma_f32_16x16x32_bf16 a[116:119], v[168:171], v[40:43], a[116:119]
    ds_read_b128 v[36:39], v1 offset:19456
    v_mfma_f32_16x16x32_bf16 a[116:119], v[184:187], v[44:47], a[116:119]
L_pg10:
    s_cbranch_execz L_iwret
    v_exp_f32 v18, v110
    v_mfma_f32_16x16x32_bf16 a[164:167], v[172:175], v[40:43], a[164:167]
    s_add_u32 s27, s27, 24576
    v_add_f32 v8, v8, v16
    v_add_f32 v8, v8, v17
    v_mfma_f32_16x16x32_bf16 a[164:167], v[188:191], v[44:47], a[164:167]
    s_waitcnt lgkmcnt(2)
    v_exp_f32 v19, v111
    v_mfma_f32_16x16x32_bf16 a[24:27], v[160:163], v[24:27], a[24:27]
    s_add_u32 s56, s56, 36864
    ds_read_b128 v[40:43], v1 offset:8192
    v_cvt_pk_bf16_f32 v78, v16, v17
    v_mfma_f32_16x16x32_bf16 a[24:27], v[176:179], v[28:31], a[24:27]
    s_mov_b32 s28, s29
    v_add_f32 v8, v8, v18
    v_add_f32 v8, v8, v19
    v_mfma_f32_16x16x32_bf16 a[72:75], v[164:167], v[24:27], a[72:75]
    s_sub_u32 s58, s56, 147456
    v_cvt_pk_bf16_f32 v79, v18, v19
    v_mfma_f32_16x16x32_bf16 a[72:75], v[180:183], v[28:31], a[72:75]
    v_exp_f32 v16, v80
    v_mfma_f32_16x16x32_bf16 a[120:123], v[168:171], v[24:27], a[120:123]
    s_min_u32 s56, s56, s58
    ds_read_b128 v[44:47], v1 offset:20480
    v_mfma_f32_16x16x32_bf16 a[120:123], v[184:187], v[28:31], a[120:123]
    v_exp_f32 v17, v81
    v_mfma_f32_16x16x32_bf16 a[168:171], v[172:175], v[24:27], a[168:171]
    s_mov_b32 m0, s26
    v_exp_f32 v18, v82
    v_mfma_f32_16x16x32_bf16 a[168:171], v[188:191], v[28:31], a[168:171]
    s_waitcnt lgkmcnt(2)
    v_add_f32 v5, v5, v16
    v_add_f32 v5, v5, v17
    v_mfma_f32_16x16x32_bf16 a[28:31], v[160:163], v[32:35], a[28:31]
    ds_read_b128 v[24:27], v1 offset:9216
    v_add_u32 v2, s3, v2
    v_mfma_f32_16x16x32_bf16 a[28:31], v[176:179], v[36:39], a[28:31]
    buffer_load_dwordx4 v4, s[4:7], s32 offen offset:0 sc1 lds
    v_mfma_f32_16x16x32_bf16 a[76:79], v[164:167], v[32:35], a[76:79]
    v_exp_f32 v19, v83
    v_mfma_f32_16x16x32_bf16 a[76:79], v[180:183], v[36:39], a[76:79]
    v_cvt_pk_bf16_f32 v80, v16, v17
    v_mfma_f32_16x16x32_bf16 a[124:127], v[168:171], v[32:35], a[124:127]
    ds_read_b128 v[28:31], v1 offset:21504
    v_add_u32 v3, s3, v3
    v_mfma_f32_16x16x32_bf16 a[124:127], v[184:187], v[36:39], a[124:127]
    buffer_load_dwordx4 v4, s[4:7], s32 offen offset:1024 sc1 lds
    v_mfma_f32_16x16x32_bf16 a[172:175], v[172:175], v[32:35], a[172:175]
    v_exp_f32 v16, v112
    v_mfma_f32_16x16x32_bf16 a[172:175], v[188:191], v[36:39], a[172:175]
    s_waitcnt lgkmcnt(2)
    v_add_f32 v5, v5, v18
    v_add_f32 v5, v5, v19
    v_mfma_f32_16x16x32_bf16 a[32:35], v[160:163], v[40:43], a[32:35]
    ds_read_b128 v[32:35], v1 offset:10240
    v_mfma_f32_16x16x32_bf16 a[32:35], v[176:179], v[44:47], a[32:35]
    buffer_load_dwordx4 v4, s[4:7], s32 offen offset:2048 sc1 lds
    v_mfma_f32_16x16x32_bf16 a[80:83], v[164:167], v[40:43], a[80:83]
    v_exp_f32 v17, v113
    v_mfma_f32_16x16x32_bf16 a[80:83], v[180:183], v[44:47], a[80:83]
    v_cvt_pk_bf16_f32 v81, v18, v19
    v_mfma_f32_16x16x32_bf16 a[128:131], v[168:171], v[40:43], a[128:131]
    ds_read_b128 v[36:39], v1 offset:22528
    v_mfma_f32_16x16x32_bf16 a[128:131], v[184:187], v[44:47], a[128:131]
    s_add_u32 s32, s32, 24576
    v_exp_f32 v18, v114
    v_mfma_f32_16x16x32_bf16 a[176:179], v[172:175], v[40:43], a[176:179]
    v_add_f32 v5, v5, v16
    v_add_f32 v5, v5, v17
    v_mfma_f32_16x16x32_bf16 a[176:179], v[188:191], v[44:47], a[176:179]
    s_waitcnt lgkmcnt(2)
    v_exp_f32 v19, v115
    v_mfma_f32_16x16x32_bf16 a[36:39], v[160:163], v[24:27], a[36:39]
    s_add_u32 s26, s26, 12288
    ds_read_b128 v[40:43], v1 offset:11264
    v_cvt_pk_bf16_f32 v82, v16, v17
    v_mfma_f32_16x16x32_bf16 a[36:39], v[176:179], v[28:31], a[36:39]
    s_mov_b32 m0, s26
    v_exp_f32 v16, v84
    v_mfma_f32_16x16x32_bf16 a[84:87], v[164:167], v[24:27], a[84:87]
    v_add_f32 v5, v5, v18
    v_add_f32 v5, v5, v19
    v_mfma_f32_16x16x32_bf16 a[84:87], v[180:183], v[28:31], a[84:87]
    v_exp_f32 v17, v85
    v_mfma_f32_16x16x32_bf16 a[132:135], v[168:171], v[24:27], a[132:135]
    ds_read_b128 v[44:47], v1 offset:23552
    v_cvt_pk_bf16_f32 v83, v18, v19
    v_mfma_f32_16x16x32_bf16 a[132:135], v[184:187], v[28:31], a[132:135]
    buffer_load_dwordx4 v4, s[4:7], s32 offen offset:0 sc1 lds
    v_mfma_f32_16x16x32_bf16 a[180:183], v[172:175], v[24:27], a[180:183]
    v_exp_f32 v18, v86
    v_mfma_f32_16x16x32_bf16 a[180:183], v[188:191], v[28:31], a[180:183]
    s_waitcnt lgkmcnt(2)
    v_add_f32 v6, v6, v16
    v_add_f32 v6, v6, v17
    v_mfma_f32_16x16x32_bf16 a[40:43], v[160:163], v[32:35], a[40:43]
    ds_read_b128 v[24:27], v2 offset:0
    v_mfma_f32_16x16x32_bf16 a[40:43], v[176:179], v[36:39], a[40:43]
    buffer_load_dwordx4 v4, s[4:7], s32 offen offset:1024 sc1 lds
    v_mfma_f32_16x16x32_bf16 a[88:91], v[164:167], v[32:35], a[88:91]
    v_exp_f32 v19, v87
    v_mfma_f32_16x16x32_bf16 a[88:91], v[180:183], v[36:39], a[88:91]
    v_cvt_pk_bf16_f32 v84, v16, v17
    v_mfma_f32_16x16x32_bf16 a[136:139], v[168:171], v[32:35], a[136:139]
    ds_read_b128 v[28:31], v3 offset:0
    v_mfma_f32_16x16x32_bf16 a[136:139], v[184:187], v[36:39], a[136:139]
    buffer_load_dwordx4 v4, s[4:7], s32 offen offset:2048 sc1 lds
    v_mfma_f32_16x16x32_bf16 a[184:187], v[172:175], v[32:35], a[184:187]
    v_exp_f32 v16, v116
    v_mfma_f32_16x16x32_bf16 a[184:187], v[188:191], v[36:39], a[184:187]
    s_waitcnt lgkmcnt(2)
    v_add_f32 v6, v6, v18
    v_add_f32 v6, v6, v19
    v_mfma_f32_16x16x32_bf16 a[44:47], v[160:163], v[40:43], a[44:47]
    ds_read_b128 v[32:35], v2 offset:6144
    v_mfma_f32_16x16x32_bf16 a[44:47], v[176:179], v[44:47], a[44:47]
    v_exp_f32 v17, v117
    v_mfma_f32_16x16x32_bf16 a[92:95], v[164:167], v[40:43], a[92:95]
    v_cvt_pk_bf16_f32 v85, v18, v19
    v_mfma_f32_16x16x32_bf16 a[92:95], v[180:183], v[44:47], a[92:95]
    s_add_u32 s32, s32, 24576
    v_exp_f32 v18, v118
    v_mfma_f32_16x16x32_bf16 a[140:143], v[168:171], v[40:43], a[140:143]
    s_add_u32 s26, s26, 36864
    ds_read_b128 v[36:39], v3 offset:6144
    v_add_f32 v6, v6, v16
    v_mfma_f32_16x16x32_bf16 a[140:143], v[184:187], v[44:47], a[140:143]
    s_sub_u32 s57, s26, 147456
    v_add_f32 v6, v6, v17
    s_min_u32 s26, s26, s57
    v_mfma_f32_16x16x32_bf16 a[188:191], v[172:175], v[40:43], a[188:191]
    v_exp_f32 v19, v119
    v_mfma_f32_16x16x32_bf16 a[188:191], v[188:191], v[44:47], a[188:191]
    s_waitcnt lgkmcnt(2)
    v_cvt_pk_bf16_f32 v86, v16, v17
    v_add_f32 v6, v6, v18
    v_add_f32 v6, v6, v19
    v_cvt_pk_bf16_f32 v87, v18, v19
    v_mfma_f32_16x16x32_bf16 v[160:163], v[24:27], a[192:195], v[128:131]
    ds_read_b128 v[40:43], v2 offset:128
    v_mfma_f32_16x16x32_bf16 v[160:163], v[28:31], a[196:199], v[160:163]
    v_exp_f32 v16, v88
    v_mfma_f32_16x16x32_bf16 v[164:167], v[24:27], a[216:219], v[132:135]
    ds_read_b128 v[44:47], v3 offset:128
    v_mfma_f32_16x16x32_bf16 v[164:167], v[28:31], a[220:223], v[164:167]
    s_waitcnt lgkmcnt(2)
    v_exp_f32 v17, v89
    v_mfma_f32_16x16x32_bf16 v[96:99], v[32:35], a[192:195], v[128:131]
    ds_read_b128 v[24:27], v2 offset:6272
    v_mfma_f32_16x16x32_bf16 v[96:99], v[36:39], a[196:199], v[96:99]
    v_exp_f32 v18, v90
    v_mfma_f32_16x16x32_bf16 v[100:103], v[32:35], a[216:219], v[132:135]
    ds_read_b128 v[28:31], v3 offset:6272
    v_add_f32 v7, v7, v16
    v_mfma_f32_16x16x32_bf16 v[100:103], v[36:39], a[220:223], v[100:103]
    s_waitcnt lgkmcnt(2)
    v_add_f32 v7, v7, v17
    v_mfma_f32_16x16x32_bf16 v[160:163], v[40:43], a[200:203], v[160:163]
    ds_read_b128 v[32:35], v2 offset:256
    v_mfma_f32_16x16x32_bf16 v[160:163], v[44:47], a[204:207], v[160:163]
    v_exp_f32 v19, v91
    v_mfma_f32_16x16x32_bf16 v[164:167], v[40:43], a[224:227], v[164:167]
    ds_read_b128 v[36:39], v3 offset:256
    v_cvt_pk_bf16_f32 v88, v16, v17
    v_mfma_f32_16x16x32_bf16 v[164:167], v[44:47], a[228:231], v[164:167]
    s_waitcnt lgkmcnt(2)
    v_exp_f32 v16, v120
    v_mfma_f32_16x16x32_bf16 v[96:99], v[24:27], a[200:203], v[96:99]
    ds_read_b128 v[40:43], v2 offset:6400
    v_add_f32 v7, v7, v18
    v_mfma_f32_16x16x32_bf16 v[96:99], v[28:31], a[204:207], v[96:99]
    v_add_f32 v7, v7, v19
    v_mfma_f32_16x16x32_bf16 v[100:103], v[24:27], a[224:227], v[100:103]
    ds_read_b128 v[44:47], v3 offset:6400
    v_mfma_f32_16x16x32_bf16 v[100:103], v[28:31], a[228:231], v[100:103]
    s_waitcnt lgkmcnt(2)
    v_exp_f32 v17, v121
    v_mfma_f32_16x16x32_bf16 v[160:163], v[32:35], a[208:211], v[160:163]
    ds_read_b128 v[24:27], v2 offset:12288
    v_cvt_pk_bf16_f32 v89, v18, v19
    v_mfma_f32_16x16x32_bf16 v[160:163], v[36:39], a[212:215], v[160:163]
    v_exp_f32 v18, v122
    v_mfma_f32_16x16x32_bf16 v[164:167], v[32:35], a[232:235], v[164:167]
    ds_read_b128 v[28:31], v3 offset:12288
    v_add_f32 v7, v7, v16
    v_mfma_f32_16x16x32_bf16 v[164:167], v[36:39], a[236:239], v[164:167]
    s_waitcnt lgkmcnt(2)
    v_add_f32 v7, v7, v17
    v_mfma_f32_16x16x32_bf16 v[96:99], v[40:43], a[208:211], v[96:99]
    ds_read_b128 v[32:35], v2 offset:18432
    v_mfma_f32_16x16x32_bf16 v[96:99], v[44:47], a[212:215], v[96:99]
    v_exp_f32 v19, v123
    v_mfma_f32_16x16x32_bf16 v[100:103], v[40:43], a[232:235], v[100:103]
    ds_read_b128 v[36:39], v3 offset:18432
    v_cvt_pk_bf16_f32 v90, v16, v17
    v_mfma_f32_16x16x32_bf16 v[100:103], v[44:47], a[236:239], v[100:103]
    s_waitcnt lgkmcnt(2)
    v_exp_f32 v16, v92
    v_mfma_f32_16x16x32_bf16 v[168:171], v[24:27], a[192:195], v[128:131]
    ds_read_b128 v[40:43], v2 offset:12416
    v_add_f32 v7, v7, v18
    v_mfma_f32_16x16x32_bf16 v[168:171], v[28:31], a[196:199], v[168:171]
    v_add_f32 v7, v7, v19
    v_mfma_f32_16x16x32_bf16 v[172:175], v[24:27], a[216:219], v[132:135]
    ds_read_b128 v[44:47], v3 offset:12416
    v_mfma_f32_16x16x32_bf16 v[172:175], v[28:31], a[220:223], v[172:175]
    s_waitcnt lgkmcnt(2)
    v_exp_f32 v17, v93
    v_mfma_f32_16x16x32_bf16 v[104:107], v[32:35], a[192:195], v[128:131]
    ds_read_b128 v[24:27], v2 offset:18560
    v_cvt_pk_bf16_f32 v91, v18, v19
    v_mfma_f32_16x16x32_bf16 v[104:107], v[36:39], a[196:199], v[104:107]
    v_exp_f32 v18, v94
    v_mfma_f32_16x16x32_bf16 v[108:111], v[32:35], a[216:219], v[132:135]
    s_add_u32 s29, s30, 49152
    ds_read_b128 v[28:31], v3 offset:18560
    v_add_f32 v8, v8, v16
    v_mfma_f32_16x16x32_bf16 v[108:111], v[36:39], a[220:223], v[108:111]
    s_waitcnt lgkmcnt(2)
    v_add_f32 v8, v8, v17
    s_sub_u32 s3, s29, 147456
    v_mfma_f32_16x16x32_bf16 v[168:171], v[40:43], a[200:203], v[168:171]
    ds_read_b128 v[32:35], v2 offset:12544
    v_mfma_f32_16x16x32_bf16 v[168:171], v[44:47], a[204:207], v[168:171]
    s_min_u32 s29, s29, s3
    v_exp_f32 v19, v95
    v_mfma_f32_16x16x32_bf16 v[172:175], v[40:43], a[224:227], v[172:175]
    ds_read_b128 v[36:39], v3 offset:12544
    v_cvt_pk_bf16_f32 v92, v16, v17
    v_mfma_f32_16x16x32_bf16 v[172:175], v[44:47], a[228:231], v[172:175]
    s_waitcnt lgkmcnt(2)
    v_exp_f32 v16, v124
    v_mfma_f32_16x16x32_bf16 v[104:107], v[24:27], a[200:203], v[104:107]
    ds_read_b128 v[40:43], v2 offset:18688
    v_add_f32 v8, v8, v18
    v_mfma_f32_16x16x32_bf16 v[104:107], v[28:31], a[204:207], v[104:107]
    v_add_f32 v8, v8, v19
    v_mfma_f32_16x16x32_bf16 v[108:111], v[24:27], a[224:227], v[108:111]
    ds_read_b128 v[44:47], v3 offset:18688
    v_mfma_f32_16x16x32_bf16 v[108:111], v[28:31], a[228:231], v[108:111]
    s_waitcnt lgkmcnt(2)
    v_subrev_u32 v2, 98304, v2
    v_subrev_u32 v3, 98304, v3
    v_mfma_f32_16x16x32_bf16 v[168:171], v[32:35], a[208:211], v[168:171]
    ds_read_b128 v[24:27], v2 offset:0
    v_mfma_f32_16x16x32_bf16 v[168:171], v[36:39], a[212:215], v[168:171]
    s_sub_u32 s3, s29, s30
    v_exp_f32 v17, v125
    v_mfma_f32_16x16x32_bf16 v[172:175], v[32:35], a[232:235], v[172:175]
    ds_read_b128 v[28:31], v3 offset:0
    v_cvt_pk_bf16_f32 v93, v18, v19
    v_mfma_f32_16x16x32_bf16 v[172:175], v[36:39], a[236:239], v[172:175]
    s_waitcnt lgkmcnt(2)
    v_exp_f32 v18, v126
    v_mfma_f32_16x16x32_bf16 v[104:107], v[40:43], a[208:211], v[104:107]
    ds_read_b128 v[32:35], v2 offset:6144
    v_add_f32 v8, v8, v16
    v_mfma_f32_16x16x32_bf16 v[104:107], v[44:47], a[212:215], v[104:107]
    v_add_f32 v8, v8, v17
    v_mfma_f32_16x16x32_bf16 v[108:111], v[40:43], a[232:235], v[108:111]
    ds_read_b128 v[36:39], v3 offset:6144
    v_mfma_f32_16x16x32_bf16 v[108:111], v[44:47], a[236:239], v[108:111]
    s_waitcnt lgkmcnt(2)
    v_exp_f32 v19, v127
    v_mfma_f32_16x16x32_bf16 v[176:179], v[24:27], a[192:195], v[128:131]
    ds_read_b128 v[40:43], v2 offset:128
    v_cvt_pk_bf16_f32 v94, v16, v17
    v_mfma_f32_16x16x32_bf16 v[176:179], v[28:31], a[196:199], v[176:179]
    s_mov_b32 s30, s29
    v_add_f32 v8, v8, v18
    v_add_f32 v8, v8, v19
    v_mfma_f32_16x16x32_bf16 v[180:183], v[24:27], a[216:219], v[132:135]
    ds_read_b128 v[44:47], v3 offset:128
    v_cvt_pk_bf16_f32 v95, v18, v19
    v_mfma_f32_16x16x32_bf16 v[180:183], v[28:31], a[220:223], v[180:183]
    s_waitcnt lgkmcnt(2)
    v_exp_f32 v16, v160
    v_mfma_f32_16x16x32_bf16 v[112:115], v[32:35], a[192:195], v[128:131]
    ds_read_b128 v[24:27], v2 offset:6272
    v_mfma_f32_16x16x32_bf16 v[112:115], v[36:39], a[196:199], v[112:115]
    v_exp_f32 v17, v161
    v_mfma_f32_16x16x32_bf16 v[116:119], v[32:35], a[216:219], v[132:135]
    ds_read_b128 v[28:31], v3 offset:6272
    v_mfma_f32_16x16x32_bf16 v[116:119], v[36:39], a[220:223], v[116:119]
    s_waitcnt lgkmcnt(2)
    v_exp_f32 v18, v162
    v_mfma_f32_16x16x32_bf16 v[176:179], v[40:43], a[200:203], v[176:179]
    ds_read_b128 v[32:35], v2 offset:256
    v_add_f32 v5, v5, v16
    v_mfma_f32_16x16x32_bf16 v[176:179], v[44:47], a[204:207], v[176:179]
    v_add_f32 v5, v5, v17
    v_add_u32 v1, s3, v1
    v_mfma_f32_16x16x32_bf16 v[180:183], v[40:43], a[224:227], v[180:183]
    ds_read_b128 v[36:39], v3 offset:256
    v_mfma_f32_16x16x32_bf16 v[180:183], v[44:47], a[228:231], v[180:183]
    s_waitcnt lgkmcnt(2)
    v_exp_f32 v19, v163
    v_mfma_f32_16x16x32_bf16 v[112:115], v[24:27], a[200:203], v[112:115]
    ds_read_b128 v[40:43], v2 offset:6400
    v_cvt_pk_bf16_f32 v160, v16, v17
    v_mfma_f32_16x16x32_bf16 v[112:115], v[28:31], a[204:207], v[112:115]
    v_exp_f32 v16, v96
    v_mfma_f32_16x16x32_bf16 v[116:119], v[24:27], a[224:227], v[116:119]
    ds_read_b128 v[44:47], v3 offset:6400
    v_add_f32 v5, v5, v18
    v_mfma_f32_16x16x32_bf16 v[116:119], v[28:31], a[228:231], v[116:119]
    s_waitcnt lgkmcnt(2)
    v_add_f32 v5, v5, v19
    v_mfma_f32_16x16x32_bf16 v[176:179], v[32:35], a[208:211], v[176:179]
    ds_read_b128 v[24:27], v2 offset:12288
    v_mfma_f32_16x16x32_bf16 v[176:179], v[36:39], a[212:215], v[176:179]
    v_exp_f32 v17, v97
    v_mfma_f32_16x16x32_bf16 v[180:183], v[32:35], a[232:235], v[180:183]
    ds_read_b128 v[28:31], v3 offset:12288
    v_cvt_pk_bf16_f32 v161, v18, v19
    v_mfma_f32_16x16x32_bf16 v[180:183], v[36:39], a[236:239], v[180:183]
    s_waitcnt lgkmcnt(2)
    v_exp_f32 v18, v98
    v_mfma_f32_16x16x32_bf16 v[112:115], v[40:43], a[208:211], v[112:115]
    ds_read_b128 v[32:35], v2 offset:18432
    v_add_f32 v5, v5, v16
    v_mfma_f32_16x16x32_bf16 v[112:115], v[44:47], a[212:215], v[112:115]
    v_add_f32 v5, v5, v17
    v_mfma_f32_16x16x32_bf16 v[116:119], v[40:43], a[232:235], v[116:119]
    ds_read_b128 v[36:39], v3 offset:18432
    v_mfma_f32_16x16x32_bf16 v[116:119], v[44:47], a[236:239], v[116:119]
    s_waitcnt lgkmcnt(2)
    v_exp_f32 v19, v99
    v_mfma_f32_16x16x32_bf16 v[184:187], v[24:27], a[192:195], v[128:131]
    ds_read_b128 v[40:43], v2 offset:12416
    v_cvt_pk_bf16_f32 v162, v16, v17
    v_mfma_f32_16x16x32_bf16 v[184:187], v[28:31], a[196:199], v[184:187]
    v_exp_f32 v16, v164
    v_mfma_f32_16x16x32_bf16 v[188:191], v[24:27], a[216:219], v[132:135]
    ds_read_b128 v[44:47], v3 offset:12416
    v_add_f32 v5, v5, v18
    v_mfma_f32_16x16x32_bf16 v[188:191], v[28:31], a[220:223], v[188:191]
    s_waitcnt lgkmcnt(2)
    v_add_f32 v5, v5, v19
    v_mfma_f32_16x16x32_bf16 v[120:123], v[32:35], a[192:195], v[128:131]
    ds_read_b128 v[24:27], v2 offset:18560
    v_mfma_f32_16x16x32_bf16 v[120:123], v[36:39], a[196:199], v[120:123]
    s_waitcnt vmcnt(6)
    v_exp_f32 v17, v165
    v_mfma_f32_16x16x32_bf16 v[124:127], v[32:35], a[216:219], v[132:135]
    ds_read_b128 v[28:31], v3 offset:18560
    v_cvt_pk_bf16_f32 v163, v18, v19
    v_mfma_f32_16x16x32_bf16 v[124:127], v[36:39], a[220:223], v[124:127]
    s_waitcnt lgkmcnt(2)
    s_barrier
    v_mfma_f32_16x16x32_bf16 v[184:187], v[40:43], a[200:203], v[184:187]
    ds_read_b128 v[32:35], v2 offset:12544
    v_mfma_f32_16x16x32_bf16 v[184:187], v[44:47], a[204:207], v[184:187]
    v_exp_f32 v18, v166
    v_mfma_f32_16x16x32_bf16 v[188:191], v[40:43], a[224:227], v[188:191]
    ds_read_b128 v[36:39], v3 offset:12544
    v_add_f32 v6, v6, v16
    v_mfma_f32_16x16x32_bf16 v[188:191], v[44:47], a[228:231], v[188:191]
    s_waitcnt lgkmcnt(2)
    v_add_f32 v6, v6, v17
    v_mfma_f32_16x16x32_bf16 v[120:123], v[24:27], a[200:203], v[120:123]
    ds_read_b128 v[40:43], v2 offset:18688
    v_mfma_f32_16x16x32_bf16 v[120:123], v[28:31], a[204:207], v[120:123]
    v_exp_f32 v19, v167
    v_cvt_pk_bf16_f32 v164, v16, v17
    v_mfma_f32_16x16x32_bf16 v[124:127], v[24:27], a[224:227], v[124:127]
    ds_read_b128 v[44:47], v3 offset:18688
    v_mfma_f32_16x16x32_bf16 v[124:127], v[28:31], a[228:231], v[124:127]
    s_waitcnt lgkmcnt(2)
    v_exp_f32 v16, v100
    v_mfma_f32_16x16x32_bf16 v[184:187], v[32:35], a[208:211], v[184:187]
    ds_read_b128 v[24:27], v1 offset:0
    v_add_f32 v6, v6, v18
    v_mfma_f32_16x16x32_bf16 v[184:187], v[36:39], a[212:215], v[184:187]
    v_add_f32 v6, v6, v19
    v_mfma_f32_16x16x32_bf16 v[188:191], v[32:35], a[232:235], v[188:191]
    ds_read_b128 v[28:31], v1 offset:12288
    v_mfma_f32_16x16x32_bf16 v[188:191], v[36:39], a[236:239], v[188:191]
    s_waitcnt lgkmcnt(2)
    v_exp_f32 v17, v101
    v_cvt_pk_bf16_f32 v165, v18, v19
    v_mfma_f32_16x16x32_bf16 v[120:123], v[40:43], a[208:211], v[120:123]
    ds_read_b128 v[32:35], v1 offset:1024
    v_mfma_f32_16x16x32_bf16 v[120:123], v[44:47], a[212:215], v[120:123]
    v_exp_f32 v18, v102
    v_mfma_f32_16x16x32_bf16 v[124:127], v[40:43], a[232:235], v[124:127]
    ds_read_b128 v[36:39], v1 offset:13312
    v_add_f32 v6, v6, v16
    v_mfma_f32_16x16x32_bf16 v[124:127], v[44:47], a[236:239], v[124:127]
    s_waitcnt lgkmcnt(2)
    v_add_f32 v6, v6, v17
    v_exp_f32 v19, v103
    v_cvt_pk_bf16_f32 v166, v16, v17
    v_add_f32 v6, v6, v18
    v_add_f32 v6, v6, v19
    v_cvt_pk_bf16_f32 v167, v18, v19
    v_mfma_f32_16x16x32_bf16 a[0:3], v[64:67], v[24:27], a[0:3]
    s_mov_b32 m0, s56
    ds_read_b128 v[40:43], v1 offset:2048
    v_bfe_u32 v57, v4, 8, 2
    v_mfma_f32_16x16x32_bf16 a[0:3], v[80:83], v[28:31], a[0:3]
    buffer_load_dwordx4 v4, s[4:7], s27 offen offset:0 sc1 lds
    v_mfma_f32_16x16x32_bf16 a[48:51], v[68:71], v[24:27], a[48:51]
    v_exp_f32 v16, v168
    v_mfma_f32_16x16x32_bf16 a[48:51], v[84:87], v[28:31], a[48:51]
    v_exp_f32 v17, v169
    v_mfma_f32_16x16x32_bf16 a[96:99], v[72:75], v[24:27], a[96:99]
    ds_read_b128 v[44:47], v1 offset:14336
    v_mul_u32_u24 v56, 1536, v57
    v_mfma_f32_16x16x32_bf16 a[96:99], v[88:91], v[28:31], a[96:99]
    buffer_load_dwordx4 v4, s[4:7], s27 offen offset:1024 sc1 lds
    v_mfma_f32_16x16x32_bf16 a[144:147], v[76:79], v[24:27], a[144:147]
    v_exp_f32 v18, v170
    v_mfma_f32_16x16x32_bf16 a[144:147], v[92:95], v[28:31], a[144:147]
    s_waitcnt lgkmcnt(2)
    v_add_f32 v5, v5, v16
    v_add_f32 v5, v5, v17
    v_mfma_f32_16x16x32_bf16 a[4:7], v[64:67], v[32:35], a[4:7]
    ds_read_b128 v[24:27], v1 offset:3072
    v_lshlrev_b32 v58, 4, v57
    v_mfma_f32_16x16x32_bf16 a[4:7], v[80:83], v[36:39], a[4:7]
    buffer_load_dwordx4 v4, s[4:7], s27 offen offset:2048 sc1 lds
    v_mfma_f32_16x16x32_bf16 a[52:55], v[68:71], v[32:35], a[52:55]
    v_exp_f32 v19, v171
    v_mfma_f32_16x16x32_bf16 a[52:55], v[84:87], v[36:39], a[52:55]
    s_add_u32 s27, s27, 24576
    v_cvt_pk_bf16_f32 v168, v16, v17
    v_bfe_u32 v57, v4, 4, 4
    v_mfma_f32_16x16x32_bf16 a[100:103], v[72:75], v[32:35], a[100:103]
    ds_read_b128 v[28:31], v1 offset:15360
    v_mfma_f32_16x16x32_bf16 a[100:103], v[88:91], v[36:39], a[100:103]
    s_add_u32 s56, s56, 12288
    v_exp_f32 v16, v104
    v_mfma_f32_16x16x32_bf16 a[148:151], v[76:79], v[32:35], a[148:151]
    v_add_f32 v5, v5, v18
    v_add_f32 v5, v5, v19
    v_mfma_f32_16x16x32_bf16 a[148:151], v[92:95], v[36:39], a[148:151]
    s_waitcnt lgkmcnt(2)
    v_exp_f32 v17, v105
    v_mfma_f32_16x16x32_bf16 a[8:11], v[64:67], v[40:43], a[8:11]
    s_mov_b32 m0, s56
    ds_read_b128 v[32:35], v1 offset:4096
    v_cvt_pk_bf16_f32 v169, v18, v19
    v_mfma_f32_16x16x32_bf16 a[8:11], v[80:83], v[44:47], a[8:11]
    v_exp_f32 v18, v106
    v_mfma_f32_16x16x32_bf16 a[56:59], v[68:71], v[40:43], a[56:59]
    v_add_f32 v5, v5, v16
    v_add_f32 v5, v5, v17
    v_mfma_f32_16x16x32_bf16 a[56:59], v[84:87], v[44:47], a[56:59]
    buffer_load_dwordx4 v4, s[4:7], s27 offen offset:0 sc1 lds
    v_mfma_f32_16x16x32_bf16 a[104:107], v[72:75], v[40:43], a[104:107]
    ds_read_b128 v[36:39], v1 offset:16384
    v_mul_u32_u24 v57, 12, v57
    v_mfma_f32_16x16x32_bf16 a[104:107], v[88:91], v[44:47], a[104:107]
    v_exp_f32 v19, v107
    v_mfma_f32_16x16x32_bf16 a[152:155], v[76:79], v[40:43], a[152:155]
    v_cvt_pk_bf16_f32 v170, v16, v17
    v_add_u32 v56, v56, v57
    v_mfma_f32_16x16x32_bf16 a[152:155], v[92:95], v[44:47], a[152:155]
    s_waitcnt lgkmcnt(2)
    buffer_load_dwordx4 v4, s[4:7], s27 offen offset:1024 sc1 lds
    v_mfma_f32_16x16x32_bf16 a[12:15], v[64:67], v[24:27], a[12:15]
    ds_read_b128 v[40:43], v1 offset:5120
    v_mfma_f32_16x16x32_bf16 a[12:15], v[80:83], v[28:31], a[12:15]
    v_exp_f32 v16, v172
    v_mfma_f32_16x16x32_bf16 a[60:63], v[68:71], v[24:27], a[60:63]
    v_add_f32 v5, v5, v18
    v_add_f32 v5, v5, v19
    v_mfma_f32_16x16x32_bf16 a[60:63], v[84:87], v[28:31], a[60:63]
    buffer_load_dwordx4 v4, s[4:7], s27 offen offset:2048 sc1 lds
    v_mfma_f32_16x16x32_bf16 a[108:111], v[72:75], v[24:27], a[108:111]
    ds_read_b128 v[44:47], v1 offset:17408
    v_mov_b32 v57, 1.0
    v_mfma_f32_16x16x32_bf16 a[108:111], v[88:91], v[28:31], a[108:111]
    v_exp_f32 v17, v173
    v_mfma_f32_16x16x32_bf16 a[156:159], v[76:79], v[24:27], a[156:159]
    s_add_u32 s27, s27, 24576
    v_cvt_pk_bf16_f32 v171, v18, v19
    v_mfma_f32_16x16x32_bf16 a[156:159], v[92:95], v[28:31], a[156:159]
    s_waitcnt lgkmcnt(2)
    v_exp_f32 v18, v174
    v_mfma_f32_16x16x32_bf16 a[16:19], v[64:67], v[32:35], a[16:19]
    s_add_u32 s56, s56, 36864
    ds_read_b128 v[24:27], v1 offset:6144
    v_add_f32 v6, v6, v16
    v_mfma_f32_16x16x32_bf16 a[16:19], v[80:83], v[36:39], a[16:19]
    v_add_f32 v6, v6, v17
    v_mov_b32 v20, 0x3f803f80
    v_mfma_f32_16x16x32_bf16 a[64:67], v[68:71], v[32:35], a[64:67]
    s_sub_u32 s58, s56, 147456
    v_exp_f32 v19, v175
    v_mfma_f32_16x16x32_bf16 a[64:67], v[84:87], v[36:39], a[64:67]
    v_cvt_pk_bf16_f32 v172, v16, v17
    v_mfma_f32_16x16x32_bf16 a[112:115], v[72:75], v[32:35], a[112:115]
    s_min_u32 s56, s56, s58
    ds_read_b128 v[28:31], v1 offset:18432
    v_mov_b32 v21, 0x3f803f80
    v_mfma_f32_16x16x32_bf16 a[112:115], v[88:91], v[36:39], a[112:115]
    v_exp_f32 v16, v108
    v_mfma_f32_16x16x32_bf16 a[160:163], v[76:79], v[32:35], a[160:163]
    s_mov_b32 m0, s56
    v_add_f32 v6, v6, v18
    v_add_f32 v6, v6, v19
    v_mfma_f32_16x16x32_bf16 a[160:163], v[92:95], v[36:39], a[160:163]
    s_waitcnt lgkmcnt(2)
    v_exp_f32 v17, v109
    v_mfma_f32_16x16x32_bf16 a[20:23], v[64:67], v[40:43], a[20:23]
    ds_read_b128 v[32:35], v1 offset:7168
    v_cvt_pk_bf16_f32 v173, v18, v19
    v_mfma_f32_16x16x32_bf16 a[20:23], v[80:83], v[44:47], a[20:23]
    buffer_load_dwordx4 v4, s[4:7], s27 offen offset:0 sc1 lds
    v_mfma_f32_16x16x32_bf16 a[68:71], v[68:71], v[40:43], a[68:71]
    v_exp_f32 v18, v110
    v_mfma_f32_16x16x32_bf16 a[68:71], v[84:87], v[44:47], a[68:71]
    v_add_f32 v6, v6, v16
    v_add_f32 v6, v6, v17
    v_mfma_f32_16x16x32_bf16 a[116:119], v[72:75], v[40:43], a[116:119]
    ds_read_b128 v[36:39], v1 offset:19456
    v_mov_b32 v22, 0x3f803f80
    v_mfma_f32_16x16x32_bf16 a[116:119], v[88:91], v[44:47], a[116:119]
    buffer_load_dwordx4 v4, s[4:7], s27 offen offset:1024 sc1 lds
    v_mfma_f32_16x16x32_bf16 a[164:167], v[76:79], v[40:43], a[164:167]
    v_exp_f32 v19, v111
    v_mfma_f32_16x16x32_bf16 a[164:167], v[92:95], v[44:47], a[164:167]
    s_waitcnt lgkmcnt(2)
    v_cvt_pk_bf16_f32 v174, v16, v17
    v_add_f32 v6, v6, v18
    v_mfma_f32_16x16x32_bf16 a[24:27], v[64:67], v[24:27], a[24:27]
    ds_read_b128 v[40:43], v1 offset:8192
    v_add_f32 v6, v6, v19
    v_mfma_f32_16x16x32_bf16 a[24:27], v[80:83], v[28:31], a[24:27]
    buffer_load_dwordx4 v4, s[4:7], s27 offen offset:2048 sc1 lds
    v_mfma_f32_16x16x32_bf16 a[72:75], v[68:71], v[24:27], a[72:75]
    v_cvt_pk_bf16_f32 v175, v18, v19
    v_mov_b32 v23, 0x3f803f80
    v_mfma_f32_16x16x32_bf16 a[72:75], v[84:87], v[28:31], a[72:75]
    v_exp_f32 v16, v176
    v_mfma_f32_16x16x32_bf16 a[120:123], v[72:75], v[24:27], a[120:123]
    ds_read_b128 v[44:47], v1 offset:20480
    v_mfma_f32_16x16x32_bf16 a[120:123], v[88:91], v[28:31], a[120:123]
    s_lshl_b32 s24, s95, 2
    v_exp_f32 v17, v177
    v_mfma_f32_16x16x32_bf16 a[168:171], v[76:79], v[24:27], a[168:171]
    s_add_u32 s27, s27, 24576
    v_exp_f32 v18, v178
    v_mfma_f32_16x16x32_bf16 a[168:171], v[92:95], v[28:31], a[168:171]
    s_waitcnt lgkmcnt(2)
    v_add_f32 v5, v5, v16
    v_add_f32 v5, v5, v17
    v_mfma_f32_16x16x32_bf16 a[28:31], v[64:67], v[32:35], a[28:31]
    s_add_u32 s56, s56, 12288
    ds_read_b128 v[24:27], v1 offset:9216
    v_mfma_f32_16x16x32_bf16 a[28:31], v[80:83], v[36:39], a[28:31]
    s_mov_b32 m0, s56
    v_exp_f32 v19, v179
    v_mfma_f32_16x16x32_bf16 a[76:79], v[68:71], v[32:35], a[76:79]
    v_cvt_pk_bf16_f32 v176, v16, v17
    v_mfma_f32_16x16x32_bf16 a[76:79], v[84:87], v[36:39], a[76:79]
    s_add_u32 s24, s24, s25
    v_exp_f32 v16, v112
    v_mfma_f32_16x16x32_bf16 a[124:127], v[72:75], v[32:35], a[124:127]
    ds_read_b128 v[28:31], v1 offset:21504
    v_add_f32 v5, v5, v18
    v_mfma_f32_16x16x32_bf16 a[124:127], v[88:91], v[36:39], a[124:127]
    buffer_load_dwordx4 v4, s[4:7], s27 offen offset:0 sc1 lds
    v_mfma_f32_16x16x32_bf16 a[172:175], v[76:79], v[32:35], a[172:175]
    v_add_f32 v5, v5, v19
    v_mfma_f32_16x16x32_bf16 a[172:175], v[92:95], v[36:39], a[172:175]
    s_waitcnt lgkmcnt(2)
    v_exp_f32 v17, v113
    v_mfma_f32_16x16x32_bf16 a[32:35], v[64:67], v[40:43], a[32:35]
    s_mul_i32 s24, s24, 24576
    ds_read_b128 v[32:35], v1 offset:10240
    v_cvt_pk_bf16_f32 v177, v18, v19
    v_mfma_f32_16x16x32_bf16 a[32:35], v[80:83], v[44:47], a[32:35]
    buffer_load_dwordx4 v4, s[4:7], s27 offen offset:1024 sc1 lds
    v_mfma_f32_16x16x32_bf16 a[80:83], v[68:71], v[40:43], a[80:83]
    v_exp_f32 v18, v114
    v_mfma_f32_16x16x32_bf16 a[80:83], v[84:87], v[44:47], a[80:83]
    v_add_f32 v5, v5, v16
    v_add_f32 v5, v5, v17
    v_mfma_f32_16x16x32_bf16 a[128:131], v[72:75], v[40:43], a[128:131]
    ds_read_b128 v[36:39], v1 offset:22528
    v_mfma_f32_16x16x32_bf16 a[128:131], v[88:91], v[44:47], a[128:131]
    buffer_load_dwordx4 v4, s[4:7], s27 offen offset:2048 sc1 lds
    v_mfma_f32_16x16x32_bf16 a[176:179], v[76:79], v[40:43], a[176:179]
    s_add_u32 s40, s24, 6144
    v_exp_f32 v19, v115
    v_mfma_f32_16x16x32_bf16 a[176:179], v[92:95], v[44:47], a[176:179]
    s_waitcnt lgkmcnt(2)
    v_cvt_pk_bf16_f32 v178, v16, v17
    v_mfma_f32_16x16x32_bf16 a[36:39], v[64:67], v[24:27], a[36:39]
    ds_read_b128 v[40:43], v1 offset:11264
    v_mfma_f32_16x16x32_bf16 a[36:39], v[80:83], v[28:31], a[36:39]
    v_exp_f32 v16, v180
    v_mfma_f32_16x16x32_bf16 a[84:87], v[68:71], v[24:27], a[84:87]
    v_add_f32 v5, v5, v18
    v_add_f32 v5, v5, v19
    v_mfma_f32_16x16x32_bf16 a[84:87], v[84:87], v[28:31], a[84:87]
    s_add_u32 s27, s27, 24576
    v_exp_f32 v17, v181
    v_mfma_f32_16x16x32_bf16 a[132:135], v[72:75], v[24:27], a[132:135]
    s_add_u32 s56, s56, 36864
    ds_read_b128 v[44:47], v1 offset:23552
    v_cvt_pk_bf16_f32 v179, v18, v19
    v_mfma_f32_16x16x32_bf16 a[132:135], v[88:91], v[28:31], a[132:135]
    s_waitcnt lgkmcnt(2)
    v_exp_f32 v18, v182
    v_mfma_f32_16x16x32_bf16 a[180:183], v[76:79], v[24:27], a[180:183]
    s_waitcnt vmcnt(12)
    v_add_f32 v6, v6, v16
    v_add_f32 v6, v6, v17
    v_mfma_f32_16x16x32_bf16 a[180:183], v[92:95], v[28:31], a[180:183]
    s_barrier
    v_add_u32 v2, 49152, v2
    v_add_u32 v3, 49152, v3
    v_mfma_f32_16x16x32_bf16 a[40:43], v[64:67], v[32:35], a[40:43]
    s_sub_u32 s58, s56, 147456
    ds_read_b128 v[24:27], v2 offset:0
    s_add_u32 s41, s24, 12288
    v_mfma_f32_16x16x32_bf16 a[40:43], v[80:83], v[36:39], a[40:43]
    s_min_u32 s56, s56, s58
    v_exp_f32 v19, v183
    v_mfma_f32_16x16x32_bf16 a[88:91], v[68:71], v[32:35], a[88:91]
L_pg11:
    s_cbranch_execz L_iwret
    s_add_u32 s42, s24, 18432
    v_cvt_pk_bf16_f32 v180, v16, v17
    v_mfma_f32_16x16x32_bf16 a[88:91], v[84:87], v[36:39], a[88:91]
    v_exp_f32 v16, v116
    v_mfma_f32_16x16x32_bf16 a[136:139], v[72:75], v[32:35], a[136:139]
    ds_read_b128 v[28:31], v3 offset:0
    v_add_f32 v6, v6, v18
    v_mfma_f32_16x16x32_bf16 a[136:139], v[88:91], v[36:39], a[136:139]
    v_add_f32 v6, v6, v19
    v_mfma_f32_16x16x32_bf16 a[184:187], v[76:79], v[32:35], a[184:187]
    v_exp_f32 v17, v117
    v_mfma_f32_16x16x32_bf16 a[184:187], v[92:95], v[36:39], a[184:187]
    s_waitcnt lgkmcnt(2)
    v_cvt_pk_bf16_f32 v181, v18, v19
    v_mfma_f32_16x16x32_bf16 a[44:47], v[64:67], v[40:43], a[44:47]
    ds_read_b128 v[32:35], v2 offset:6144
    v_mfma_f32_16x16x32_bf16 a[44:47], v[80:83], v[44:47], a[44:47]
    v_exp_f32 v18, v118
    v_mfma_f32_16x16x32_bf16 a[92:95], v[68:71], v[40:43], a[92:95]
    v_add_f32 v6, v6, v16
    v_add_f32 v6, v6, v17
    v_mfma_f32_16x16x32_bf16 a[92:95], v[84:87], v[44:47], a[92:95]
    v_exp_f32 v19, v119
    v_mfma_f32_16x16x32_bf16 a[140:143], v[72:75], v[40:43], a[140:143]
    ds_read_b128 v[36:39], v3 offset:6144
    v_cvt_pk_bf16_f32 v182, v16, v17
    v_mfma_f32_16x16x32_bf16 a[140:143], v[88:91], v[44:47], a[140:143]
    v_add_f32 v6, v6, v18
    v_add_f32 v6, v6, v19
    v_mfma_f32_16x16x32_bf16 a[188:191], v[76:79], v[40:43], a[188:191]
    v_cvt_pk_bf16_f32 v183, v18, v19
    v_mfma_f32_16x16x32_bf16 a[188:191], v[92:95], v[44:47], a[188:191]
    s_waitcnt lgkmcnt(2)
    v_mfma_f32_16x16x32_bf16 v[64:67], v[24:27], a[192:195], v[128:131]
    ds_read_b128 v[40:43], v2 offset:128
    v_mfma_f32_16x16x32_bf16 v[64:67], v[28:31], a[196:199], v[64:67]
    v_exp_f32 v16, v184
    v_mfma_f32_16x16x32_bf16 v[68:71], v[24:27], a[216:219], v[132:135]
    ds_read_b128 v[44:47], v3 offset:128
    v_mfma_f32_16x16x32_bf16 v[68:71], v[28:31], a[220:223], v[68:71]
    s_waitcnt lgkmcnt(2)
    v_exp_f32 v17, v185
    v_mfma_f32_16x16x32_bf16 v[96:99], v[32:35], a[192:195], v[128:131]
    ds_read_b128 v[24:27], v2 offset:6272
    v_mfma_f32_16x16x32_bf16 v[96:99], v[36:39], a[196:199], v[96:99]
    v_exp_f32 v18, v186
    v_mfma_f32_16x16x32_bf16 v[100:103], v[32:35], a[216:219], v[132:135]
    ds_read_b128 v[28:31], v3 offset:6272
    v_add_f32 v5, v5, v16
    v_mfma_f32_16x16x32_bf16 v[100:103], v[36:39], a[220:223], v[100:103]
    s_waitcnt lgkmcnt(2)
    v_add_f32 v5, v5, v17
    v_mfma_f32_16x16x32_bf16 v[64:67], v[40:43], a[200:203], v[64:67]
    ds_read_b128 v[32:35], v2 offset:256
    v_mfma_f32_16x16x32_bf16 v[64:67], v[44:47], a[204:207], v[64:67]
    v_exp_f32 v19, v187
    v_mfma_f32_16x16x32_bf16 v[68:71], v[40:43], a[224:227], v[68:71]
    ds_read_b128 v[36:39], v3 offset:256
    v_cvt_pk_bf16_f32 v184, v16, v17
    v_mfma_f32_16x16x32_bf16 v[68:71], v[44:47], a[228:231], v[68:71]
    s_waitcnt lgkmcnt(2)
    v_exp_f32 v16, v120
    v_mfma_f32_16x16x32_bf16 v[96:99], v[24:27], a[200:203], v[96:99]
    ds_read_b128 v[40:43], v2 offset:6400
    v_add_f32 v5, v5, v18
    v_mfma_f32_16x16x32_bf16 v[96:99], v[28:31], a[204:207], v[96:99]
    s_waitcnt vmcnt(0)
    v_add_f32 v5, v5, v19
    v_mfma_f32_16x16x32_bf16 v[100:103], v[24:27], a[224:227], v[100:103]
    ds_read_b128 v[44:47], v3 offset:6400
    v_mfma_f32_16x16x32_bf16 v[100:103], v[28:31], a[228:231], v[100:103]
    s_waitcnt lgkmcnt(2)
    s_barrier
    v_mfma_f32_16x16x32_bf16 v[64:67], v[32:35], a[208:211], v[64:67]
    s_mov_b32 m0, s56
    ds_read_b128 v[24:27], v2 offset:12288
    v_mfma_f32_16x16x32_bf16 v[64:67], v[36:39], a[212:215], v[64:67]
    buffer_load_dwordx4 v4, s[4:7], s27 offen offset:0 sc1 lds
    v_mfma_f32_16x16x32_bf16 v[68:71], v[32:35], a[232:235], v[68:71]
    ds_read_b128 v[28:31], v3 offset:12288
    v_mfma_f32_16x16x32_bf16 v[68:71], v[36:39], a[236:239], v[68:71]
    s_waitcnt lgkmcnt(2)
    v_exp_f32 v17, v121
    v_cvt_pk_bf16_f32 v185, v18, v19
    v_mfma_f32_16x16x32_bf16 v[96:99], v[40:43], a[208:211], v[96:99]
    ds_read_b128 v[32:35], v2 offset:18432
    v_mfma_f32_16x16x32_bf16 v[96:99], v[44:47], a[212:215], v[96:99]
    buffer_load_dwordx4 v4, s[4:7], s27 offen offset:1024 sc1 lds
    v_mfma_f32_16x16x32_bf16 v[100:103], v[40:43], a[232:235], v[100:103]
    ds_read_b128 v[36:39], v3 offset:18432
    v_mfma_f32_16x16x32_bf16 v[100:103], v[44:47], a[236:239], v[100:103]
    s_waitcnt lgkmcnt(2)
    v_exp_f32 v18, v122
    v_add_f32 v5, v5, v16
    v_mfma_f32_16x16x32_bf16 v[72:75], v[24:27], a[192:195], v[128:131]
    ds_read_b128 v[40:43], v2 offset:12416
    v_add_f32 v5, v5, v17
    v_mfma_f32_16x16x32_bf16 v[72:75], v[28:31], a[196:199], v[72:75]
    v_exp_f32 v19, v123
    v_cvt_pk_bf16_f32 v186, v16, v17
    v_mfma_f32_16x16x32_bf16 v[76:79], v[24:27], a[216:219], v[132:135]
    ds_read_b128 v[44:47], v3 offset:12416
    v_mfma_f32_16x16x32_bf16 v[76:79], v[28:31], a[220:223], v[76:79]
    s_waitcnt lgkmcnt(2)
    buffer_load_dwordx4 v4, s[4:7], s27 offen offset:2048 sc1 lds
    v_mfma_f32_16x16x32_bf16 v[104:107], v[32:35], a[192:195], v[128:131]
    ds_read_b128 v[24:27], v2 offset:18560
    v_mfma_f32_16x16x32_bf16 v[104:107], v[36:39], a[196:199], v[104:107]
    v_exp_f32 v16, v188
    v_add_f32 v5, v5, v18
    v_mfma_f32_16x16x32_bf16 v[108:111], v[32:35], a[216:219], v[132:135]
    ds_read_b128 v[28:31], v3 offset:18560
    v_add_f32 v5, v5, v19
    v_mfma_f32_16x16x32_bf16 v[108:111], v[36:39], a[220:223], v[108:111]
    s_waitcnt lgkmcnt(2)
    v_exp_f32 v17, v189
    v_cvt_pk_bf16_f32 v187, v18, v19
    v_mfma_f32_16x16x32_bf16 v[72:75], v[40:43], a[200:203], v[72:75]
    s_add_u32 s27, s27, 24576
    ds_read_b128 v[32:35], v2 offset:12544
    v_mfma_f32_16x16x32_bf16 v[72:75], v[44:47], a[204:207], v[72:75]
    v_exp_f32 v18, v190
    v_mfma_f32_16x16x32_bf16 v[76:79], v[40:43], a[224:227], v[76:79]
    s_add_u32 s56, s56, 12288
    ds_read_b128 v[36:39], v3 offset:12544
    v_add_f32 v6, v6, v16
    v_mfma_f32_16x16x32_bf16 v[76:79], v[44:47], a[228:231], v[76:79]
    s_waitcnt lgkmcnt(2)
    v_add_f32 v6, v6, v17
    v_mfma_f32_16x16x32_bf16 v[104:107], v[24:27], a[200:203], v[104:107]
    ds_read_b128 v[40:43], v2 offset:18688
    v_mfma_f32_16x16x32_bf16 v[104:107], v[28:31], a[204:207], v[104:107]
    v_exp_f32 v19, v191
    v_cvt_pk_bf16_f32 v188, v16, v17
    v_mfma_f32_16x16x32_bf16 v[108:111], v[24:27], a[224:227], v[108:111]
    s_mov_b32 m0, s56
    ds_read_b128 v[44:47], v3 offset:18688
    v_mfma_f32_16x16x32_bf16 v[108:111], v[28:31], a[228:231], v[108:111]
    s_waitcnt lgkmcnt(2)
    v_add_u32 v2, 49152, v2
    v_add_u32 v3, 49152, v3
    v_mfma_f32_16x16x32_bf16 v[72:75], v[32:35], a[208:211], v[72:75]
    ds_read_b128 v[24:27], v2 offset:0
    v_mfma_f32_16x16x32_bf16 v[72:75], v[36:39], a[212:215], v[72:75]
    buffer_load_dwordx4 v4, s[4:7], s27 offen offset:0 sc1 lds
    v_mfma_f32_16x16x32_bf16 v[76:79], v[32:35], a[232:235], v[76:79]
    ds_read_b128 v[28:31], v3 offset:0
    v_mfma_f32_16x16x32_bf16 v[76:79], v[36:39], a[236:239], v[76:79]
    s_waitcnt lgkmcnt(2)
    v_exp_f32 v16, v124
    v_add_f32 v6, v6, v18
    v_mfma_f32_16x16x32_bf16 v[104:107], v[40:43], a[208:211], v[104:107]
    ds_read_b128 v[32:35], v2 offset:6144
    v_add_f32 v6, v6, v19
    v_mfma_f32_16x16x32_bf16 v[104:107], v[44:47], a[212:215], v[104:107]
    v_exp_f32 v17, v125
    v_cvt_pk_bf16_f32 v189, v18, v19
    v_mfma_f32_16x16x32_bf16 v[108:111], v[40:43], a[232:235], v[108:111]
    ds_read_b128 v[36:39], v3 offset:6144
    v_mfma_f32_16x16x32_bf16 v[108:111], v[44:47], a[236:239], v[108:111]
    s_waitcnt lgkmcnt(2)
    buffer_load_dwordx4 v4, s[4:7], s27 offen offset:1024 sc1 lds
    v_mfma_f32_16x16x32_bf16 v[80:83], v[24:27], a[240:243], v[136:139]
    ds_read_b128 v[40:43], v2 offset:128
    v_mfma_f32_16x16x32_bf16 v[80:83], v[28:31], a[244:247], v[80:83]
    v_exp_f32 v18, v126
    v_add_f32 v6, v6, v16
    v_mfma_f32_16x16x32_bf16 v[84:87], v[24:27], v[200:203], v[140:143]
    ds_read_b128 v[44:47], v3 offset:128
    v_add_f32 v6, v6, v17
    v_exp_f32 v19, v127
    v_cvt_pk_bf16_f32 v190, v16, v17
    v_add_f32 v6, v6, v18
    v_add_f32 v6, v6, v19
    v_cvt_pk_bf16_f32 v191, v18, v19
    v_mfma_f32_16x16x32_bf16 v[84:87], v[28:31], v[204:207], v[84:87]
    s_waitcnt lgkmcnt(2)
    v_exp_f32 v16, v64
    v_mfma_f32_16x16x32_bf16 v[112:115], v[32:35], a[240:243], v[136:139]
    ds_read_b128 v[24:27], v2 offset:6272
    v_mfma_f32_16x16x32_bf16 v[112:115], v[36:39], a[244:247], v[112:115]
    buffer_load_dwordx4 v4, s[4:7], s27 offen offset:2048 sc1 lds
    v_mfma_f32_16x16x32_bf16 v[116:119], v[32:35], v[200:203], v[140:143]
    ds_read_b128 v[28:31], v3 offset:6272
    v_mfma_f32_16x16x32_bf16 v[116:119], v[36:39], v[204:207], v[116:119]
    s_waitcnt lgkmcnt(2)
    v_exp_f32 v17, v65
    v_mfma_f32_16x16x32_bf16 v[80:83], v[40:43], a[248:251], v[80:83]
    ds_read_b128 v[32:35], v2 offset:256
    v_mfma_f32_16x16x32_bf16 v[80:83], v[44:47], a[252:255], v[80:83]
    v_exp_f32 v18, v66
    v_mfma_f32_16x16x32_bf16 v[84:87], v[40:43], v[208:211], v[84:87]
    ds_read_b128 v[36:39], v3 offset:256
    v_add_f32 v5, v5, v16
    v_mfma_f32_16x16x32_bf16 v[84:87], v[44:47], v[212:215], v[84:87]
    s_waitcnt lgkmcnt(2)
    v_add_f32 v5, v5, v17
    v_mfma_f32_16x16x32_bf16 v[112:115], v[24:27], a[248:251], v[112:115]
    ds_read_b128 v[40:43], v2 offset:6400
    v_mfma_f32_16x16x32_bf16 v[112:115], v[28:31], a[252:255], v[112:115]
    v_exp_f32 v19, v67
    v_cvt_pk_bf16_f32 v64, v16, v17
    v_mfma_f32_16x16x32_bf16 v[116:119], v[24:27], v[208:211], v[116:119]
    s_add_u32 s27, s27, 24576
    ds_read_b128 v[44:47], v3 offset:6400
    s_add_u32 s56, s56, 36864
    v_mfma_f32_16x16x32_bf16 v[116:119], v[28:31], v[212:215], v[116:119]
    s_waitcnt lgkmcnt(2)
    v_exp_f32 v16, v96
    v_mfma_f32_16x16x32_bf16 v[80:83], v[32:35], v[192:195], v[80:83]
    s_sub_u32 s58, s56, 147456
    ds_read_b128 v[24:27], v2 offset:12288
    v_add_f32 v5, v5, v18
    v_mfma_f32_16x16x32_bf16 v[80:83], v[36:39], v[196:199], v[80:83]
    s_min_u32 s56, s56, s58
    v_add_f32 v5, v5, v19
    v_mfma_f32_16x16x32_bf16 v[84:87], v[32:35], v[216:219], v[84:87]
    ds_read_b128 v[28:31], v3 offset:12288
    v_mfma_f32_16x16x32_bf16 v[84:87], v[36:39], v[220:223], v[84:87]
    s_waitcnt lgkmcnt(2)
    v_exp_f32 v17, v97
    v_cvt_pk_bf16_f32 v65, v18, v19
    v_mfma_f32_16x16x32_bf16 v[112:115], v[40:43], v[192:195], v[112:115]
    ds_read_b128 v[32:35], v2 offset:18432
    v_mfma_f32_16x16x32_bf16 v[112:115], v[44:47], v[196:199], v[112:115]
    v_exp_f32 v18, v98
    v_mfma_f32_16x16x32_bf16 v[116:119], v[40:43], v[216:219], v[116:119]
    ds_read_b128 v[36:39], v3 offset:18432
    v_add_f32 v5, v5, v16
    v_mfma_f32_16x16x32_bf16 v[116:119], v[44:47], v[220:223], v[116:119]
    s_waitcnt lgkmcnt(2)
    v_add_f32 v5, v5, v17
    v_mfma_f32_16x16x32_bf16 v[88:91], v[24:27], a[240:243], v[136:139]
    ds_read_b128 v[40:43], v2 offset:12416
    v_mfma_f32_16x16x32_bf16 v[88:91], v[28:31], a[244:247], v[88:91]
    v_exp_f32 v19, v99
    v_cvt_pk_bf16_f32 v66, v16, v17
    v_mfma_f32_16x16x32_bf16 v[92:95], v[24:27], v[200:203], v[140:143]
    ds_read_b128 v[44:47], v3 offset:12416
    v_mfma_f32_16x16x32_bf16 v[92:95], v[28:31], v[204:207], v[92:95]
    s_waitcnt lgkmcnt(2)
    v_exp_f32 v16, v68
    v_mfma_f32_16x16x32_bf16 v[120:123], v[32:35], a[240:243], v[136:139]
    ds_read_b128 v[24:27], v2 offset:18560
    v_add_f32 v5, v5, v18
    v_mfma_f32_16x16x32_bf16 v[120:123], v[36:39], a[244:247], v[120:123]
    v_add_f32 v5, v5, v19
    v_mfma_f32_16x16x32_bf16 v[124:127], v[32:35], v[200:203], v[140:143]
    ds_read_b128 v[28:31], v3 offset:18560
    v_mfma_f32_16x16x32_bf16 v[124:127], v[36:39], v[204:207], v[124:127]
    s_waitcnt lgkmcnt(2)
    v_exp_f32 v17, v69
    v_cvt_pk_bf16_f32 v67, v18, v19
    v_mfma_f32_16x16x32_bf16 v[88:91], v[40:43], a[248:251], v[88:91]
    ds_read_b128 v[32:35], v2 offset:12544
    v_mfma_f32_16x16x32_bf16 v[88:91], v[44:47], a[252:255], v[88:91]
    v_exp_f32 v18, v70
    v_mfma_f32_16x16x32_bf16 v[92:95], v[40:43], v[208:211], v[92:95]
    ds_read_b128 v[36:39], v3 offset:12544
    v_add_f32 v6, v6, v16
    v_mfma_f32_16x16x32_bf16 v[92:95], v[44:47], v[212:215], v[92:95]
    s_waitcnt lgkmcnt(2)
    v_add_f32 v6, v6, v17
    v_mfma_f32_16x16x32_bf16 v[120:123], v[24:27], a[248:251], v[120:123]
    ds_read_b128 v[40:43], v2 offset:18688
    v_mfma_f32_16x16x32_bf16 v[120:123], v[28:31], a[252:255], v[120:123]
    v_exp_f32 v19, v71
    v_cvt_pk_bf16_f32 v68, v16, v17
    v_mfma_f32_16x16x32_bf16 v[124:127], v[24:27], v[208:211], v[124:127]
    ds_read_b128 v[44:47], v3 offset:18688
    v_mfma_f32_16x16x32_bf16 v[124:127], v[28:31], v[212:215], v[124:127]
    s_waitcnt lgkmcnt(2)
    v_add_u32 v1, 49152, v1
    v_exp_f32 v16, v100
    v_mfma_f32_16x16x32_bf16 v[88:91], v[32:35], v[192:195], v[88:91]
    ds_read_b128 v[24:27], v1 offset:0
    v_add_f32 v6, v6, v18
    v_mfma_f32_16x16x32_bf16 v[88:91], v[36:39], v[196:199], v[88:91]
    v_add_f32 v6, v6, v19
    v_mfma_f32_16x16x32_bf16 v[92:95], v[32:35], v[216:219], v[92:95]
    ds_read_b128 v[28:31], v1 offset:12288
    v_mfma_f32_16x16x32_bf16 v[92:95], v[36:39], v[220:223], v[92:95]
    s_waitcnt lgkmcnt(2)
    v_exp_f32 v17, v101
    v_cvt_pk_bf16_f32 v69, v18, v19
    v_mfma_f32_16x16x32_bf16 v[120:123], v[40:43], v[192:195], v[120:123]
    ds_read_b128 v[32:35], v1 offset:1024
    v_mfma_f32_16x16x32_bf16 v[120:123], v[44:47], v[196:199], v[120:123]
    v_exp_f32 v18, v102
    v_mfma_f32_16x16x32_bf16 v[124:127], v[40:43], v[216:219], v[124:127]
    ds_read_b128 v[36:39], v1 offset:13312
    v_add_f32 v6, v6, v16
    v_mfma_f32_16x16x32_bf16 v[124:127], v[44:47], v[220:223], v[124:127]
    s_waitcnt lgkmcnt(2)
    v_add_f32 v6, v6, v17
    v_exp_f32 v19, v103
    v_cvt_pk_bf16_f32 v70, v16, v17
    v_add_f32 v6, v6, v18
    v_add_f32 v6, v6, v19
    v_cvt_pk_bf16_f32 v71, v18, v19
    v_mfma_f32_16x16x32_bf16 a[0:3], v[160:163], v[24:27], a[0:3]
    ds_read_b128 v[40:43], v1 offset:2048
    v_mfma_f32_16x16x32_bf16 a[0:3], v[168:171], v[28:31], a[0:3]
    v_exp_f32 v16, v72
    v_mfma_f32_16x16x32_bf16 a[48:51], v[164:167], v[24:27], a[48:51]
    ds_read_b128 v[44:47], v1 offset:14336
    v_mfma_f32_16x16x32_bf16 a[48:51], v[172:175], v[28:31], a[48:51]
    s_waitcnt lgkmcnt(2)
    v_exp_f32 v17, v73
    v_mfma_f32_16x16x32_bf16 a[4:7], v[160:163], v[32:35], a[4:7]
    ds_read_b128 v[24:27], v1 offset:3072
    v_mfma_f32_16x16x32_bf16 a[4:7], v[168:171], v[36:39], a[4:7]
    v_exp_f32 v18, v74
    v_mfma_f32_16x16x32_bf16 a[52:55], v[164:167], v[32:35], a[52:55]
    ds_read_b128 v[28:31], v1 offset:15360
    v_add_f32 v5, v5, v16
    v_mfma_f32_16x16x32_bf16 a[52:55], v[172:175], v[36:39], a[52:55]
    s_waitcnt lgkmcnt(2)
    v_add_f32 v5, v5, v17
    v_mfma_f32_16x16x32_bf16 a[8:11], v[160:163], v[40:43], a[8:11]
    ds_read_b128 v[32:35], v1 offset:4096
    v_mfma_f32_16x16x32_bf16 a[8:11], v[168:171], v[44:47], a[8:11]
    v_exp_f32 v19, v75
    v_mfma_f32_16x16x32_bf16 a[56:59], v[164:167], v[40:43], a[56:59]
    ds_read_b128 v[36:39], v1 offset:16384
    v_cvt_pk_bf16_f32 v72, v16, v17
    v_mfma_f32_16x16x32_bf16 a[56:59], v[172:175], v[44:47], a[56:59]
    s_waitcnt lgkmcnt(2)
    v_exp_f32 v16, v104
    v_mfma_f32_16x16x32_bf16 a[12:15], v[160:163], v[24:27], a[12:15]
    ds_read_b128 v[40:43], v1 offset:5120
    v_add_f32 v5, v5, v18
    v_mfma_f32_16x16x32_bf16 a[12:15], v[168:171], v[28:31], a[12:15]
    v_add_f32 v5, v5, v19
    v_mfma_f32_16x16x32_bf16 a[60:63], v[164:167], v[24:27], a[60:63]
    ds_read_b128 v[44:47], v1 offset:17408
    v_mfma_f32_16x16x32_bf16 a[60:63], v[172:175], v[28:31], a[60:63]
    s_waitcnt lgkmcnt(2)
    v_exp_f32 v17, v105
    v_mfma_f32_16x16x32_bf16 a[16:19], v[160:163], v[32:35], a[16:19]
    ds_read_b128 v[24:27], v1 offset:6144
    v_cvt_pk_bf16_f32 v73, v18, v19
    v_mfma_f32_16x16x32_bf16 a[16:19], v[168:171], v[36:39], a[16:19]
    v_exp_f32 v18, v106
    v_mfma_f32_16x16x32_bf16 a[64:67], v[164:167], v[32:35], a[64:67]
    ds_read_b128 v[28:31], v1 offset:18432
    v_add_f32 v5, v5, v16
    v_mfma_f32_16x16x32_bf16 a[64:67], v[172:175], v[36:39], a[64:67]
    s_waitcnt lgkmcnt(2)
    v_add_f32 v5, v5, v17
    v_mfma_f32_16x16x32_bf16 a[20:23], v[160:163], v[40:43], a[20:23]
    ds_read_b128 v[32:35], v1 offset:7168
    v_mfma_f32_16x16x32_bf16 a[20:23], v[168:171], v[44:47], a[20:23]
    v_exp_f32 v19, v107
    v_mfma_f32_16x16x32_bf16 a[68:71], v[164:167], v[40:43], a[68:71]
    ds_read_b128 v[36:39], v1 offset:19456
    v_cvt_pk_bf16_f32 v74, v16, v17
    v_mfma_f32_16x16x32_bf16 a[68:71], v[172:175], v[44:47], a[68:71]
    s_waitcnt lgkmcnt(2)
    v_exp_f32 v16, v76
    v_mfma_f32_16x16x32_bf16 a[24:27], v[160:163], v[24:27], a[24:27]
    ds_read_b128 v[40:43], v1 offset:8192
    v_add_f32 v5, v5, v18
    v_mfma_f32_16x16x32_bf16 a[24:27], v[168:171], v[28:31], a[24:27]
    v_add_f32 v5, v5, v19
    v_mfma_f32_16x16x32_bf16 a[72:75], v[164:167], v[24:27], a[72:75]
    ds_read_b128 v[44:47], v1 offset:20480
    v_mfma_f32_16x16x32_bf16 a[72:75], v[172:175], v[28:31], a[72:75]
    s_waitcnt lgkmcnt(2)
    v_exp_f32 v17, v77
    v_mfma_f32_16x16x32_bf16 a[28:31], v[160:163], v[32:35], a[28:31]
    ds_read_b128 v[24:27], v1 offset:9216
    v_cvt_pk_bf16_f32 v75, v18, v19
    v_mfma_f32_16x16x32_bf16 a[28:31], v[168:171], v[36:39], a[28:31]
    v_exp_f32 v18, v78
    v_mfma_f32_16x16x32_bf16 a[76:79], v[164:167], v[32:35], a[76:79]
    ds_read_b128 v[28:31], v1 offset:21504
    v_add_f32 v6, v6, v16
    v_mfma_f32_16x16x32_bf16 a[76:79], v[172:175], v[36:39], a[76:79]
    s_waitcnt lgkmcnt(2)
    v_add_f32 v6, v6, v17
    v_mfma_f32_16x16x32_bf16 a[32:35], v[160:163], v[40:43], a[32:35]
    ds_read_b128 v[32:35], v1 offset:10240
    v_mfma_f32_16x16x32_bf16 a[32:35], v[168:171], v[44:47], a[32:35]
    v_exp_f32 v19, v79
    v_mfma_f32_16x16x32_bf16 a[80:83], v[164:167], v[40:43], a[80:83]
    ds_read_b128 v[36:39], v1 offset:22528
    v_cvt_pk_bf16_f32 v76, v16, v17
    v_mfma_f32_16x16x32_bf16 a[80:83], v[172:175], v[44:47], a[80:83]
    s_waitcnt lgkmcnt(2)
    v_exp_f32 v16, v108
    v_mfma_f32_16x16x32_bf16 a[36:39], v[160:163], v[24:27], a[36:39]
    ds_read_b128 v[40:43], v1 offset:11264
    v_add_f32 v6, v6, v18
    v_mfma_f32_16x16x32_bf16 a[36:39], v[168:171], v[28:31], a[36:39]
    v_add_f32 v6, v6, v19
    v_mfma_f32_16x16x32_bf16 a[84:87], v[164:167], v[24:27], a[84:87]
    ds_read_b128 v[44:47], v1 offset:23552
    v_mfma_f32_16x16x32_bf16 a[84:87], v[172:175], v[28:31], a[84:87]
    s_waitcnt lgkmcnt(2)
    v_subrev_u32 v1, 98304, v1
    v_mfma_f32_16x16x32_bf16 a[40:43], v[160:163], v[32:35], a[40:43]
    ds_read_b128 v[24:27], v1 offset:0
    v_mfma_f32_16x16x32_bf16 a[40:43], v[168:171], v[36:39], a[40:43]
    v_exp_f32 v17, v109
    v_mfma_f32_16x16x32_bf16 a[88:91], v[164:167], v[32:35], a[88:91]
    ds_read_b128 v[28:31], v1 offset:12288
    v_cvt_pk_bf16_f32 v77, v18, v19
    v_mfma_f32_16x16x32_bf16 a[88:91], v[172:175], v[36:39], a[88:91]
    s_waitcnt lgkmcnt(2)
    v_exp_f32 v18, v110
    v_mfma_f32_16x16x32_bf16 a[44:47], v[160:163], v[40:43], a[44:47]
    ds_read_b128 v[32:35], v1 offset:1024
    v_add_f32 v6, v6, v16
    v_mfma_f32_16x16x32_bf16 a[44:47], v[168:171], v[44:47], a[44:47]
    v_add_f32 v6, v6, v17
    v_mfma_f32_16x16x32_bf16 a[92:95], v[164:167], v[40:43], a[92:95]
    ds_read_b128 v[36:39], v1 offset:13312
    v_mfma_f32_16x16x32_bf16 a[92:95], v[172:175], v[44:47], a[92:95]
    s_waitcnt lgkmcnt(2)
    v_exp_f32 v19, v111
    v_mfma_f32_16x16x32_bf16 a[0:3], v[176:179], v[24:27], a[0:3]
    ds_read_b128 v[40:43], v1 offset:2048
    v_cvt_pk_bf16_f32 v78, v16, v17
    v_mfma_f32_16x16x32_bf16 a[0:3], v[184:187], v[28:31], a[0:3]
    v_add_f32 v6, v6, v18
    v_add_f32 v6, v6, v19
    v_mfma_f32_16x16x32_bf16 a[48:51], v[180:183], v[24:27], a[48:51]
    ds_read_b128 v[44:47], v1 offset:14336
    v_cvt_pk_bf16_f32 v79, v18, v19
    v_mfma_f32_16x16x32_bf16 a[48:51], v[188:191], v[28:31], a[48:51]
    s_waitcnt lgkmcnt(2)
    v_exp_f32 v16, v80
    v_mfma_f32_16x16x32_bf16 a[4:7], v[176:179], v[32:35], a[4:7]
    ds_read_b128 v[24:27], v1 offset:3072
    v_mfma_f32_16x16x32_bf16 a[4:7], v[184:187], v[36:39], a[4:7]
    v_exp_f32 v17, v81
    v_mfma_f32_16x16x32_bf16 a[52:55], v[180:183], v[32:35], a[52:55]
    ds_read_b128 v[28:31], v1 offset:15360
    v_mfma_f32_16x16x32_bf16 a[52:55], v[188:191], v[36:39], a[52:55]
    s_waitcnt lgkmcnt(2)
    v_exp_f32 v18, v82
    v_mfma_f32_16x16x32_bf16 a[8:11], v[176:179], v[40:43], a[8:11]
    ds_read_b128 v[32:35], v1 offset:4096
    v_add_f32 v7, v7, v16
    v_mfma_f32_16x16x32_bf16 a[8:11], v[184:187], v[44:47], a[8:11]
    v_add_f32 v7, v7, v17
    v_mfma_f32_16x16x32_bf16 a[56:59], v[180:183], v[40:43], a[56:59]
    ds_read_b128 v[36:39], v1 offset:16384
    v_mfma_f32_16x16x32_bf16 a[56:59], v[188:191], v[44:47], a[56:59]
    s_waitcnt lgkmcnt(2)
    v_exp_f32 v19, v83
    v_mfma_f32_16x16x32_bf16 a[12:15], v[176:179], v[24:27], a[12:15]
    ds_read_b128 v[40:43], v1 offset:5120
    v_cvt_pk_bf16_f32 v80, v16, v17
    v_mfma_f32_16x16x32_bf16 a[12:15], v[184:187], v[28:31], a[12:15]
    v_exp_f32 v16, v112
    v_mfma_f32_16x16x32_bf16 a[60:63], v[180:183], v[24:27], a[60:63]
    ds_read_b128 v[44:47], v1 offset:17408
    v_add_f32 v7, v7, v18
    v_mfma_f32_16x16x32_bf16 a[60:63], v[188:191], v[28:31], a[60:63]
    s_waitcnt lgkmcnt(2)
    v_add_f32 v7, v7, v19
    v_mfma_f32_16x16x32_bf16 a[16:19], v[176:179], v[32:35], a[16:19]
    ds_read_b128 v[24:27], v1 offset:6144
    v_mfma_f32_16x16x32_bf16 a[16:19], v[184:187], v[36:39], a[16:19]
    v_exp_f32 v17, v113
    v_mfma_f32_16x16x32_bf16 a[64:67], v[180:183], v[32:35], a[64:67]
    ds_read_b128 v[28:31], v1 offset:18432
    v_cvt_pk_bf16_f32 v81, v18, v19
    v_mfma_f32_16x16x32_bf16 a[64:67], v[188:191], v[36:39], a[64:67]
    s_waitcnt lgkmcnt(2)
    v_exp_f32 v18, v114
    v_mfma_f32_16x16x32_bf16 a[20:23], v[176:179], v[40:43], a[20:23]
    ds_read_b128 v[32:35], v1 offset:7168
    v_add_f32 v7, v7, v16
    v_mfma_f32_16x16x32_bf16 a[20:23], v[184:187], v[44:47], a[20:23]
    v_add_f32 v7, v7, v17
    v_mfma_f32_16x16x32_bf16 a[68:71], v[180:183], v[40:43], a[68:71]
    ds_read_b128 v[36:39], v1 offset:19456
    v_mfma_f32_16x16x32_bf16 a[68:71], v[188:191], v[44:47], a[68:71]
    s_waitcnt lgkmcnt(2)
    v_exp_f32 v19, v115
    v_mfma_f32_16x16x32_bf16 a[24:27], v[176:179], v[24:27], a[24:27]
    ds_read_b128 v[40:43], v1 offset:8192
    v_cvt_pk_bf16_f32 v82, v16, v17
    v_mfma_f32_16x16x32_bf16 a[24:27], v[184:187], v[28:31], a[24:27]
    v_exp_f32 v16, v84
    v_mfma_f32_16x16x32_bf16 a[72:75], v[180:183], v[24:27], a[72:75]
    ds_read_b128 v[44:47], v1 offset:20480
    v_add_f32 v7, v7, v18
    v_mfma_f32_16x16x32_bf16 a[72:75], v[188:191], v[28:31], a[72:75]
    s_waitcnt lgkmcnt(2)
    v_add_f32 v7, v7, v19
    v_mfma_f32_16x16x32_bf16 a[28:31], v[176:179], v[32:35], a[28:31]
    ds_read_b128 v[24:27], v1 offset:9216
    v_mfma_f32_16x16x32_bf16 a[28:31], v[184:187], v[36:39], a[28:31]
    s_waitcnt vmcnt(0)
    v_exp_f32 v17, v85
    v_mfma_f32_16x16x32_bf16 a[76:79], v[180:183], v[32:35], a[76:79]
    ds_read_b128 v[28:31], v1 offset:21504
    v_cvt_pk_bf16_f32 v83, v18, v19
    v_mfma_f32_16x16x32_bf16 a[76:79], v[188:191], v[36:39], a[76:79]
    s_waitcnt lgkmcnt(2)
    s_barrier
    v_mfma_f32_16x16x32_bf16 a[32:35], v[176:179], v[40:43], a[32:35]
    ds_read_b128 v[32:35], v1 offset:10240
    v_mfma_f32_16x16x32_bf16 a[32:35], v[184:187], v[44:47], a[32:35]
    v_exp_f32 v18, v86
    v_mfma_f32_16x16x32_bf16 a[80:83], v[180:183], v[40:43], a[80:83]
    ds_read_b128 v[36:39], v1 offset:22528
    v_add_f32 v8, v8, v16
    v_mfma_f32_16x16x32_bf16 a[80:83], v[188:191], v[44:47], a[80:83]
    s_waitcnt lgkmcnt(2)
    v_add_f32 v8, v8, v17
    v_mfma_f32_16x16x32_bf16 a[36:39], v[176:179], v[24:27], a[36:39]
    ds_read_b128 v[40:43], v1 offset:11264
    v_mfma_f32_16x16x32_bf16 a[36:39], v[184:187], v[28:31], a[36:39]
    v_exp_f32 v19, v87
    v_cvt_pk_bf16_f32 v84, v16, v17
    v_mfma_f32_16x16x32_bf16 a[84:87], v[180:183], v[24:27], a[84:87]
    ds_read_b128 v[44:47], v1 offset:23552
    v_mfma_f32_16x16x32_bf16 a[84:87], v[188:191], v[28:31], a[84:87]
    s_waitcnt lgkmcnt(2)
    v_add_u32 v1, 49152, v1
    v_exp_f32 v16, v116
    v_mfma_f32_16x16x32_bf16 a[40:43], v[176:179], v[32:35], a[40:43]
    ds_read_b128 v[24:27], v1 offset:0
    v_add_f32 v8, v8, v18
    v_mfma_f32_16x16x32_bf16 a[40:43], v[184:187], v[36:39], a[40:43]
    v_add_f32 v8, v8, v19
    v_mfma_f32_16x16x32_bf16 a[88:91], v[180:183], v[32:35], a[88:91]
    ds_read_b128 v[28:31], v1 offset:12288
    v_mfma_f32_16x16x32_bf16 a[88:91], v[188:191], v[36:39], a[88:91]
    s_waitcnt lgkmcnt(2)
    v_exp_f32 v17, v117
    v_cvt_pk_bf16_f32 v85, v18, v19
    v_mfma_f32_16x16x32_bf16 a[44:47], v[176:179], v[40:43], a[44:47]
    ds_read_b128 v[32:35], v1 offset:1024
    v_mfma_f32_16x16x32_bf16 a[44:47], v[184:187], v[44:47], a[44:47]
    v_exp_f32 v18, v118
    v_mfma_f32_16x16x32_bf16 a[92:95], v[180:183], v[40:43], a[92:95]
    ds_read_b128 v[36:39], v1 offset:13312
    v_add_f32 v8, v8, v16
    v_mfma_f32_16x16x32_bf16 a[92:95], v[188:191], v[44:47], a[92:95]
    s_waitcnt lgkmcnt(2)
    v_add_f32 v8, v8, v17
    v_exp_f32 v19, v119
    v_cvt_pk_bf16_f32 v86, v16, v17
    v_add_f32 v8, v8, v18
    v_add_f32 v8, v8, v19
    v_cvt_pk_bf16_f32 v87, v18, v19
    v_mfma_f32_16x16x32_bf16 a[0:3], v[64:67], v[24:27], a[0:3]
    ds_read_b128 v[40:43], v1 offset:2048
    v_mfma_f32_16x16x32_bf16 a[0:3], v[72:75], v[28:31], a[0:3]
    v_exp_f32 v16, v88
    v_exp_f32 v17, v89
    v_exp_f32 v18, v90
    v_mfma_f32_16x16x4_f32 v[48:51], v5, v57, 0
    v_mfma_f32_16x16x32_bf16 a[48:51], v[68:71], v[24:27], a[48:51]
    ds_read_b128 v[44:47], v1 offset:14336
    v_mfma_f32_16x16x32_bf16 a[48:51], v[76:79], v[28:31], a[48:51]
    s_waitcnt lgkmcnt(2)
    v_exp_f32 v19, v91
    v_cvt_pk_bf16_f32 v88, v16, v17
    v_exp_f32 v16, v120
    v_mfma_f32_16x16x4_f32 v[52:55], v6, v57, 0
    v_mfma_f32_16x16x32_bf16 a[4:7], v[64:67], v[32:35], a[4:7]
    ds_read_b128 v[24:27], v1 offset:3072
    v_mfma_f32_16x16x32_bf16 a[4:7], v[72:75], v[36:39], a[4:7]
    v_exp_f32 v17, v121
    v_cvt_pk_bf16_f32 v89, v18, v19
    v_mfma_f32_16x16x32_bf16 a[52:55], v[68:71], v[32:35], a[52:55]
    ds_read_b128 v[28:31], v1 offset:15360
    v_mfma_f32_16x16x32_bf16 a[52:55], v[76:79], v[36:39], a[52:55]
    s_waitcnt lgkmcnt(2)
    v_exp_f32 v18, v122
    v_mfma_f32_16x16x32_bf16 a[8:11], v[64:67], v[40:43], a[8:11]
    ds_read_b128 v[32:35], v1 offset:4096
    v_mfma_f32_16x16x32_bf16 a[8:11], v[72:75], v[44:47], a[8:11]
    v_exp_f32 v19, v123
    v_mfma_f32_16x16x32_bf16 a[56:59], v[68:71], v[40:43], a[56:59]
    ds_read_b128 v[36:39], v1 offset:16384
    v_cvt_pk_bf16_f32 v90, v16, v17
    v_mfma_f32_16x16x32_bf16 a[56:59], v[76:79], v[44:47], a[56:59]
    s_waitcnt lgkmcnt(2)
    v_exp_f32 v16, v92
    v_mfma_f32_16x16x32_bf16 a[12:15], v[64:67], v[24:27], a[12:15]
    ds_read_b128 v[40:43], v1 offset:5120
    v_mfma_f32_16x16x32_bf16 a[12:15], v[72:75], v[28:31], a[12:15]
    v_exp_f32 v17, v93
    v_mfma_f32_16x16x32_bf16 a[60:63], v[68:71], v[24:27], a[60:63]
    ds_read_b128 v[44:47], v1 offset:17408
    v_cvt_pk_bf16_f32 v91, v18, v19
    v_mfma_f32_16x16x32_bf16 a[60:63], v[76:79], v[28:31], a[60:63]
    s_waitcnt lgkmcnt(2)
    v_exp_f32 v18, v94
    v_mfma_f32_16x16x32_bf16 a[16:19], v[64:67], v[32:35], a[16:19]
    ds_read_b128 v[24:27], v1 offset:6144
    v_mfma_f32_16x16x32_bf16 a[16:19], v[72:75], v[36:39], a[16:19]
    v_exp_f32 v19, v95
    v_mfma_f32_16x16x32_bf16 a[64:67], v[68:71], v[32:35], a[64:67]
    ds_read_b128 v[28:31], v1 offset:18432
    v_mfma_f32_16x16x32_bf16 a[64:67], v[76:79], v[36:39], a[64:67]
    s_waitcnt lgkmcnt(2)
    v_mfma_f32_16x16x32_bf16 v[128:131], v[88:91], v[20:23], 0
    v_mfma_f32_16x16x32_bf16 a[20:23], v[64:67], v[40:43], a[20:23]
    ds_read_b128 v[32:35], v1 offset:7168
    v_cvt_pk_bf16_f32 v92, v16, v17
    v_mfma_f32_16x16x32_bf16 a[20:23], v[72:75], v[44:47], a[20:23]
    v_exp_f32 v16, v124
    v_mfma_f32_16x16x32_bf16 a[68:71], v[68:71], v[40:43], a[68:71]
    ds_read_b128 v[36:39], v1 offset:19456
    v_mfma_f32_16x16x32_bf16 a[68:71], v[76:79], v[44:47], a[68:71]
    s_waitcnt lgkmcnt(2)
    v_exp_f32 v17, v125
    v_mfma_f32_16x16x32_bf16 a[24:27], v[64:67], v[24:27], a[24:27]
    ds_read_b128 v[40:43], v1 offset:8192
    v_cvt_pk_bf16_f32 v93, v18, v19
    v_mfma_f32_16x16x32_bf16 a[24:27], v[72:75], v[28:31], a[24:27]
L_pg12:
    s_cbranch_execz L_iwret
    v_exp_f32 v18, v126
    v_mfma_f32_16x16x32_bf16 a[72:75], v[68:71], v[24:27], a[72:75]
    ds_read_b128 v[44:47], v1 offset:20480
    v_mfma_f32_16x16x32_bf16 a[72:75], v[76:79], v[28:31], a[72:75]
    s_waitcnt lgkmcnt(2)
    v_exp_f32 v19, v127
    v_mfma_f32_16x16x32_bf16 a[28:31], v[64:67], v[32:35], a[28:31]
    ds_read_b128 v[24:27], v1 offset:9216
    v_cvt_pk_bf16_f32 v94, v16, v17
    v_mfma_f32_16x16x32_bf16 a[28:31], v[72:75], v[36:39], a[28:31]
    v_cvt_pk_bf16_f32 v95, v18, v19
    s_nop 1
    v_mfma_f32_16x16x32_bf16 a[76:79], v[68:71], v[32:35], a[76:79]
    ds_read_b128 v[28:31], v1 offset:21504
    v_mfma_f32_16x16x32_bf16 a[76:79], v[76:79], v[36:39], a[76:79]
    s_waitcnt lgkmcnt(2)
    v_mfma_f32_16x16x32_bf16 v[132:135], v[92:95], v[20:23], 0
    v_mfma_f32_16x16x32_bf16 a[32:35], v[64:67], v[40:43], a[32:35]
    ds_read_b128 v[32:35], v1 offset:10240
    v_mfma_f32_16x16x32_bf16 a[32:35], v[72:75], v[44:47], a[32:35]
    v_rcp_f32 v48, v48
    v_mfma_f32_16x16x32_bf16 a[80:83], v[68:71], v[40:43], a[80:83]
    ds_read_b128 v[36:39], v1 offset:22528
    v_mfma_f32_16x16x32_bf16 a[80:83], v[76:79], v[44:47], a[80:83]
    s_waitcnt lgkmcnt(2)
    v_rcp_f32 v49, v49
    v_mfma_f32_16x16x32_bf16 a[36:39], v[64:67], v[24:27], a[36:39]
    ds_read_b128 v[40:43], v1 offset:11264
    v_mfma_f32_16x16x32_bf16 a[36:39], v[72:75], v[28:31], a[36:39]
    v_rcp_f32 v50, v50
    v_mfma_f32_16x16x32_bf16 a[84:87], v[68:71], v[24:27], a[84:87]
    ds_read_b128 v[44:47], v1 offset:23552
    v_mfma_f32_16x16x32_bf16 a[84:87], v[76:79], v[28:31], a[84:87]
    s_waitcnt lgkmcnt(2)
    v_subrev_u32 v2, 98304, v2
    v_subrev_u32 v3, 98304, v3
    v_mfma_f32_16x16x32_bf16 a[40:43], v[64:67], v[32:35], a[40:43]
    ds_read_b128 v[24:27], v2 offset:0
    v_mfma_f32_16x16x32_bf16 a[40:43], v[72:75], v[36:39], a[40:43]
    v_rcp_f32 v51, v51
    v_mfma_f32_16x16x32_bf16 a[88:91], v[68:71], v[32:35], a[88:91]
    ds_read_b128 v[28:31], v3 offset:0
    v_mfma_f32_16x16x32_bf16 a[88:91], v[76:79], v[36:39], a[88:91]
    s_waitcnt lgkmcnt(2)
    v_rcp_f32 v52, v52
    v_mfma_f32_16x16x32_bf16 a[44:47], v[64:67], v[40:43], a[44:47]
    ds_read_b128 v[32:35], v2 offset:6144
    v_mfma_f32_16x16x32_bf16 a[44:47], v[72:75], v[44:47], a[44:47]
    v_rcp_f32 v53, v53
    v_mfma_f32_16x16x32_bf16 a[92:95], v[68:71], v[40:43], a[92:95]
    ds_read_b128 v[36:39], v3 offset:6144
    v_mfma_f32_16x16x32_bf16 a[92:95], v[76:79], v[44:47], a[92:95]
    s_waitcnt lgkmcnt(2)
    v_rcp_f32 v54, v54
    v_mfma_f32_16x16x32_bf16 v[160:163], v[24:27], a[240:243], v[136:139]
    ds_read_b128 v[40:43], v2 offset:128
    v_mfma_f32_16x16x32_bf16 v[160:163], v[28:31], a[244:247], v[160:163]
    v_rcp_f32 v55, v55
    v_mfma_f32_16x16x32_bf16 v[164:167], v[24:27], v[200:203], v[140:143]
    ds_read_b128 v[44:47], v3 offset:128
    v_mfma_f32_16x16x32_bf16 v[164:167], v[28:31], v[204:207], v[164:167]
    s_waitcnt lgkmcnt(2)
    v_mfma_f32_16x16x32_bf16 v[96:99], v[32:35], a[240:243], v[136:139]
    ds_read_b128 v[24:27], v2 offset:6272
    v_accvgpr_read_b32 v224, a0
    v_mfma_f32_16x16x32_bf16 v[96:99], v[36:39], a[244:247], v[96:99]
    v_accvgpr_read_b32 v225, a4
    v_accvgpr_read_b32 v226, a8
    v_accvgpr_read_b32 v227, a12
    v_accvgpr_read_b32 v228, a16
    v_accvgpr_read_b32 v229, a20
    v_mfma_f32_16x16x32_bf16 v[100:103], v[32:35], v[200:203], v[140:143]
    ds_read_b128 v[28:31], v3 offset:6272
    v_mul_f32 v224, v224, v48
    v_mfma_f32_16x16x32_bf16 v[100:103], v[36:39], v[204:207], v[100:103]
    s_waitcnt lgkmcnt(2)
    v_mul_f32 v225, v225, v48
    v_mul_f32 v226, v226, v48
    v_mul_f32 v227, v227, v48
    v_mul_f32 v228, v228, v48
    v_mul_f32 v229, v229, v48
    v_mfma_f32_16x16x32_bf16 v[160:163], v[40:43], a[248:251], v[160:163]
    ds_read_b128 v[32:35], v2 offset:256
    v_cvt_pk_bf16_f32 v224, v224, v225
    v_mfma_f32_16x16x32_bf16 v[160:163], v[44:47], a[252:255], v[160:163]
    v_cvt_pk_bf16_f32 v225, v226, v227
    v_cvt_pk_bf16_f32 v226, v228, v229
    v_accvgpr_read_b32 v230, a1
    v_accvgpr_read_b32 v231, a5
    v_accvgpr_read_b32 v232, a9
    v_mfma_f32_16x16x32_bf16 v[164:167], v[40:43], v[208:211], v[164:167]
    ds_read_b128 v[36:39], v3 offset:256
    v_accvgpr_read_b32 v233, a13
    v_mfma_f32_16x16x32_bf16 v[164:167], v[44:47], v[212:215], v[164:167]
    s_waitcnt lgkmcnt(2)
    buffer_store_dwordx3 v[224:226], v56, s[12:15], s24 offen offset:0 sc0 sc1
    v_accvgpr_read_b32 v234, a17
    v_accvgpr_read_b32 v235, a21
    v_mfma_f32_16x16x32_bf16 v[96:99], v[24:27], a[248:251], v[96:99]
    ds_read_b128 v[40:43], v2 offset:6400
    v_mul_f32 v230, v230, v49
    v_mfma_f32_16x16x32_bf16 v[96:99], v[28:31], a[252:255], v[96:99]
    v_mul_f32 v231, v231, v49
    v_mul_f32 v232, v232, v49
    v_mul_f32 v233, v233, v49
    v_mul_f32 v234, v234, v49
    v_mul_f32 v235, v235, v49
    v_mfma_f32_16x16x32_bf16 v[100:103], v[24:27], v[208:211], v[100:103]
    ds_read_b128 v[44:47], v3 offset:6400
    v_cvt_pk_bf16_f32 v230, v230, v231
    v_mfma_f32_16x16x32_bf16 v[100:103], v[28:31], v[212:215], v[100:103]
    s_waitcnt lgkmcnt(2)
    v_cvt_pk_bf16_f32 v231, v232, v233
    v_cvt_pk_bf16_f32 v232, v234, v235
    v_accvgpr_read_b32 v236, a2
    v_accvgpr_read_b32 v237, a6
    v_accvgpr_read_b32 v238, a10
    v_mfma_f32_16x16x32_bf16 v[160:163], v[32:35], v[192:195], v[160:163]
    ds_read_b128 v[24:27], v2 offset:12288
    v_accvgpr_read_b32 v239, a14
    v_mfma_f32_16x16x32_bf16 v[160:163], v[36:39], v[196:199], v[160:163]
    buffer_store_dwordx3 v[230:232], v56, s[12:15], s24 offen offset:384 sc0 sc1
    v_accvgpr_read_b32 v240, a18
    v_accvgpr_read_b32 v241, a22
    v_mfma_f32_16x16x32_bf16 v[164:167], v[32:35], v[216:219], v[164:167]
    ds_read_b128 v[28:31], v3 offset:12288
    v_mul_f32 v236, v236, v50
    v_mfma_f32_16x16x32_bf16 v[164:167], v[36:39], v[220:223], v[164:167]
    s_waitcnt lgkmcnt(2)
    v_mul_f32 v237, v237, v50
    v_mul_f32 v238, v238, v50
    v_mul_f32 v239, v239, v50
    v_mul_f32 v240, v240, v50
    v_mul_f32 v241, v241, v50
    v_mfma_f32_16x16x32_bf16 v[96:99], v[40:43], v[192:195], v[96:99]
    ds_read_b128 v[32:35], v2 offset:18432
    v_cvt_pk_bf16_f32 v236, v236, v237
    v_mfma_f32_16x16x32_bf16 v[96:99], v[44:47], v[196:199], v[96:99]
    v_cvt_pk_bf16_f32 v237, v238, v239
    v_cvt_pk_bf16_f32 v238, v240, v241
    v_accvgpr_read_b32 v242, a3
    v_accvgpr_read_b32 v243, a7
    v_accvgpr_read_b32 v244, a11
    v_mfma_f32_16x16x32_bf16 v[100:103], v[40:43], v[216:219], v[100:103]
    ds_read_b128 v[36:39], v3 offset:18432
    v_accvgpr_read_b32 v245, a15
    v_mfma_f32_16x16x32_bf16 v[100:103], v[44:47], v[220:223], v[100:103]
    s_waitcnt lgkmcnt(2)
    buffer_store_dwordx3 v[236:238], v56, s[12:15], s24 offen offset:768 sc0 sc1
    v_accvgpr_read_b32 v246, a19
    v_accvgpr_read_b32 v247, a23
    v_mfma_f32_16x16x32_bf16 v[168:171], v[24:27], a[240:243], v[136:139]
    ds_read_b128 v[40:43], v2 offset:12416
    v_mul_f32 v242, v242, v51
    v_mfma_f32_16x16x32_bf16 v[168:171], v[28:31], a[244:247], v[168:171]
    v_mul_f32 v243, v243, v51
    v_mul_f32 v244, v244, v51
    v_mul_f32 v245, v245, v51
    v_mul_f32 v246, v246, v51
    v_mul_f32 v247, v247, v51
    v_mfma_f32_16x16x32_bf16 v[172:175], v[24:27], v[200:203], v[140:143]
    ds_read_b128 v[44:47], v3 offset:12416
    v_cvt_pk_bf16_f32 v242, v242, v243
    v_mfma_f32_16x16x32_bf16 v[172:175], v[28:31], v[204:207], v[172:175]
    s_waitcnt lgkmcnt(2)
    v_cvt_pk_bf16_f32 v243, v244, v245
    v_cvt_pk_bf16_f32 v244, v246, v247
    v_accvgpr_read_b32 v248, a24
    v_accvgpr_read_b32 v249, a28
    v_accvgpr_read_b32 v250, a32
    v_mfma_f32_16x16x32_bf16 v[104:107], v[32:35], a[240:243], v[136:139]
    ds_read_b128 v[24:27], v2 offset:18560
    v_accvgpr_read_b32 v251, a36
    v_mfma_f32_16x16x32_bf16 v[104:107], v[36:39], a[244:247], v[104:107]
    buffer_store_dwordx3 v[242:244], v56, s[12:15], s24 offen offset:1152 sc0 sc1
    v_accvgpr_read_b32 v252, a40
    v_accvgpr_read_b32 v253, a44
    v_mfma_f32_16x16x32_bf16 v[108:111], v[32:35], v[200:203], v[140:143]
    ds_read_b128 v[28:31], v3 offset:18560
    v_mul_f32 v248, v248, v48
    v_mfma_f32_16x16x32_bf16 v[108:111], v[36:39], v[204:207], v[108:111]
    s_waitcnt lgkmcnt(2)
    v_mul_f32 v249, v249, v48
    v_mul_f32 v250, v250, v48
    v_mul_f32 v251, v251, v48
    v_mul_f32 v252, v252, v48
    v_mul_f32 v253, v253, v48
    v_mfma_f32_16x16x32_bf16 v[168:171], v[40:43], a[248:251], v[168:171]
    ds_read_b128 v[32:35], v2 offset:12544
    v_cvt_pk_bf16_f32 v248, v248, v249
    v_mfma_f32_16x16x32_bf16 v[168:171], v[44:47], a[252:255], v[168:171]
    v_cvt_pk_bf16_f32 v249, v250, v251
    v_cvt_pk_bf16_f32 v250, v252, v253
    v_accvgpr_read_b32 v224, a25
    v_accvgpr_read_b32 v225, a29
    v_accvgpr_read_b32 v226, a33
    v_mfma_f32_16x16x32_bf16 v[172:175], v[40:43], v[208:211], v[172:175]
    ds_read_b128 v[36:39], v3 offset:12544
    v_accvgpr_read_b32 v227, a37
    v_mfma_f32_16x16x32_bf16 v[172:175], v[44:47], v[212:215], v[172:175]
    s_waitcnt lgkmcnt(2)
    buffer_store_dwordx3 v[248:250], v56, s[12:15], s24 offen offset:192 sc0 sc1
    v_accvgpr_read_b32 v228, a41
    v_mfma_f32_16x16x32_bf16 v[104:107], v[24:27], a[248:251], v[104:107]
    ds_read_b128 v[40:43], v2 offset:18688
    v_accvgpr_read_b32 v229, a45
    v_mfma_f32_16x16x32_bf16 v[104:107], v[28:31], a[252:255], v[104:107]
    v_mul_f32 v224, v224, v49
    v_mul_f32 v225, v225, v49
    v_mul_f32 v226, v226, v49
    v_mul_f32 v227, v227, v49
    v_mul_f32 v228, v228, v49
    v_mul_f32 v229, v229, v49
    v_mfma_f32_16x16x32_bf16 v[108:111], v[24:27], v[208:211], v[108:111]
    ds_read_b128 v[44:47], v3 offset:18688
    v_cvt_pk_bf16_f32 v224, v224, v225
    v_mfma_f32_16x16x32_bf16 v[108:111], v[28:31], v[212:215], v[108:111]
    s_waitcnt lgkmcnt(2)
    v_add_u32 v2, 49152, v2
    v_add_u32 v3, 49152, v3
    v_exp_f32 v16, v160
    v_cvt_pk_bf16_f32 v225, v226, v227
    v_mfma_f32_16x16x32_bf16 v[168:171], v[32:35], v[192:195], v[168:171]
    ds_read_b128 v[24:27], v2 offset:0
    v_cvt_pk_bf16_f32 v226, v228, v229
    v_mfma_f32_16x16x32_bf16 v[168:171], v[36:39], v[196:199], v[168:171]
    buffer_store_dwordx3 v[224:226], v56, s[12:15], s24 offen offset:576 sc0 sc1
    v_accvgpr_read_b32 v230, a26
    v_mfma_f32_16x16x32_bf16 v[172:175], v[32:35], v[216:219], v[172:175]
    ds_read_b128 v[28:31], v3 offset:0
    v_accvgpr_read_b32 v231, a30
    v_mfma_f32_16x16x32_bf16 v[172:175], v[36:39], v[220:223], v[172:175]
    s_waitcnt lgkmcnt(2)
    v_exp_f32 v17, v161
    v_exp_f32 v18, v162
    v_exp_f32 v19, v163
    v_mfma_f32_16x16x32_bf16 v[104:107], v[40:43], v[192:195], v[104:107]
    ds_read_b128 v[32:35], v2 offset:6144
    v_accvgpr_read_b32 v232, a34
    v_mfma_f32_16x16x32_bf16 v[104:107], v[44:47], v[196:199], v[104:107]
    v_cvt_pk_bf16_f32 v160, v16, v17
    v_accvgpr_read_b32 v233, a38
    v_accvgpr_read_b32 v234, a42
    v_exp_f32 v16, v96
    v_mfma_f32_16x16x32_bf16 v[108:111], v[40:43], v[216:219], v[108:111]
    ds_read_b128 v[36:39], v3 offset:6144
    v_accvgpr_read_b32 v235, a46
    v_mfma_f32_16x16x32_bf16 v[108:111], v[44:47], v[220:223], v[108:111]
    s_waitcnt lgkmcnt(2)
    v_mul_f32 v230, v230, v50
    v_exp_f32 v17, v97
    v_mul_f32 v231, v231, v50
    v_mul_f32 v232, v232, v50
    v_mfma_f32_16x16x32_bf16 v[176:179], v[24:27], a[240:243], v[136:139]
    ds_read_b128 v[40:43], v2 offset:128
    v_cvt_pk_bf16_f32 v161, v18, v19
    v_mfma_f32_16x16x32_bf16 v[176:179], v[28:31], a[244:247], v[176:179]
    v_mul_f32 v233, v233, v50
    v_exp_f32 v18, v98
    v_mul_f32 v234, v234, v50
    v_mul_f32 v235, v235, v50
    v_cvt_pk_bf16_f32 v230, v230, v231
    v_mfma_f32_16x16x32_bf16 v[180:183], v[24:27], v[200:203], v[140:143]
    ds_read_b128 v[44:47], v3 offset:128
    v_cvt_pk_bf16_f32 v231, v232, v233
    v_mfma_f32_16x16x32_bf16 v[180:183], v[28:31], v[204:207], v[180:183]
    s_waitcnt lgkmcnt(2)
    v_exp_f32 v19, v99
    v_cvt_pk_bf16_f32 v232, v234, v235
    v_accvgpr_read_b32 v236, a27
    v_cvt_pk_bf16_f32 v162, v16, v17
    v_mfma_f32_16x16x32_bf16 v[112:115], v[32:35], a[240:243], v[136:139]
    ds_read_b128 v[24:27], v2 offset:6272
    v_accvgpr_read_b32 v237, a31
    v_mfma_f32_16x16x32_bf16 v[112:115], v[36:39], a[244:247], v[112:115]
    buffer_store_dwordx3 v[230:232], v56, s[12:15], s24 offen offset:960 sc0 sc1
    v_accvgpr_read_b32 v238, a35
    v_mfma_f32_16x16x32_bf16 v[116:119], v[32:35], v[200:203], v[140:143]
    ds_read_b128 v[28:31], v3 offset:6272
    v_accvgpr_read_b32 v239, a39
    v_mfma_f32_16x16x32_bf16 v[116:119], v[36:39], v[204:207], v[116:119]
    s_waitcnt lgkmcnt(2)
    v_exp_f32 v16, v164
    v_exp_f32 v17, v165
    v_accvgpr_read_b32 v240, a43
    v_accvgpr_read_b32 v241, a47
    v_mfma_f32_16x16x32_bf16 v[176:179], v[40:43], a[248:251], v[176:179]
    ds_read_b128 v[32:35], v2 offset:256
    v_cvt_pk_bf16_f32 v163, v18, v19
    v_mfma_f32_16x16x32_bf16 v[176:179], v[44:47], a[252:255], v[176:179]
    v_exp_f32 v18, v166
    v_mul_f32 v236, v236, v51
    v_mul_f32 v237, v237, v51
    v_mul_f32 v238, v238, v51
    v_mfma_f32_16x16x32_bf16 v[180:183], v[40:43], v[208:211], v[180:183]
    ds_read_b128 v[36:39], v3 offset:256
    v_mul_f32 v239, v239, v51
    v_mfma_f32_16x16x32_bf16 v[180:183], v[44:47], v[212:215], v[180:183]
    s_waitcnt lgkmcnt(2)
    v_exp_f32 v19, v167
    v_mul_f32 v240, v240, v51
    v_mul_f32 v241, v241, v51
    v_cvt_pk_bf16_f32 v236, v236, v237
    v_mfma_f32_16x16x32_bf16 v[112:115], v[24:27], a[248:251], v[112:115]
    ds_read_b128 v[40:43], v2 offset:6400
    v_cvt_pk_bf16_f32 v237, v238, v239
    v_mfma_f32_16x16x32_bf16 v[112:115], v[28:31], a[252:255], v[112:115]
    v_mfma_f32_16x16x32_bf16 v[128:131], v[160:163], v[20:23], v[128:131]
    v_cvt_pk_bf16_f32 v164, v16, v17
    v_cvt_pk_bf16_f32 v238, v240, v241
    v_accvgpr_read_b32 v242, a48
    v_mfma_f32_16x16x32_bf16 v[116:119], v[24:27], v[208:211], v[116:119]
    ds_read_b128 v[44:47], v3 offset:6400
    v_accvgpr_read_b32 v243, a52
    v_mfma_f32_16x16x32_bf16 v[116:119], v[28:31], v[212:215], v[116:119]
    s_waitcnt lgkmcnt(2)
    buffer_store_dwordx3 v[236:238], v56, s[12:15], s24 offen offset:1344 sc0 sc1
    v_exp_f32 v16, v100
    v_mfma_f32_16x16x32_bf16 v[176:179], v[32:35], v[192:195], v[176:179]
    ds_read_b128 v[24:27], v2 offset:12288
    v_accvgpr_read_b32 v244, a56
    v_mfma_f32_16x16x32_bf16 v[176:179], v[36:39], v[196:199], v[176:179]
    v_exp_f32 v17, v101
    v_accvgpr_read_b32 v245, a60
    v_cvt_pk_bf16_f32 v165, v18, v19
    v_accvgpr_read_b32 v246, a64
    v_mfma_f32_16x16x32_bf16 v[180:183], v[32:35], v[216:219], v[180:183]
    ds_read_b128 v[28:31], v3 offset:12288
    v_accvgpr_read_b32 v247, a68
    v_mfma_f32_16x16x32_bf16 v[180:183], v[36:39], v[220:223], v[180:183]
    s_waitcnt lgkmcnt(2)
    v_exp_f32 v18, v102
    v_mul_f32 v242, v242, v52
    v_mul_f32 v243, v243, v52
    v_mul_f32 v244, v244, v52
    v_mfma_f32_16x16x32_bf16 v[112:115], v[40:43], v[192:195], v[112:115]
    ds_read_b128 v[32:35], v2 offset:18432
    v_mul_f32 v245, v245, v52
    v_mfma_f32_16x16x32_bf16 v[112:115], v[44:47], v[196:199], v[112:115]
    v_exp_f32 v19, v103
    v_cvt_pk_bf16_f32 v166, v16, v17
    v_mul_f32 v246, v246, v52
    v_mul_f32 v247, v247, v52
    v_cvt_pk_bf16_f32 v167, v18, v19
    v_mfma_f32_16x16x32_bf16 v[116:119], v[40:43], v[216:219], v[116:119]
    ds_read_b128 v[36:39], v3 offset:18432
    v_cvt_pk_bf16_f32 v242, v242, v243
    v_mfma_f32_16x16x32_bf16 v[116:119], v[44:47], v[220:223], v[116:119]
    s_waitcnt lgkmcnt(2)
    s_nop 1
    v_cvt_pk_bf16_f32 v243, v244, v245
    v_cvt_pk_bf16_f32 v244, v246, v247
    v_accvgpr_read_b32 v248, a49
    v_mfma_f32_16x16x32_bf16 v[184:187], v[24:27], a[240:243], v[136:139]
    ds_read_b128 v[40:43], v2 offset:12416
    v_accvgpr_read_b32 v249, a53
    v_mfma_f32_16x16x32_bf16 v[184:187], v[28:31], a[244:247], v[184:187]
    buffer_store_dwordx3 v[242:244], v56, s[12:15], s40 offen offset:0 sc0 sc1
    v_accvgpr_read_b32 v250, a57
    v_mfma_f32_16x16x32_bf16 v[188:191], v[24:27], v[200:203], v[140:143]
    ds_read_b128 v[44:47], v3 offset:12416
    v_accvgpr_read_b32 v251, a61
    v_mfma_f32_16x16x32_bf16 v[188:191], v[28:31], v[204:207], v[188:191]
    s_waitcnt lgkmcnt(2)
    v_mfma_f32_16x16x32_bf16 v[132:135], v[164:167], v[20:23], v[132:135]
    v_exp_f32 v16, v168
    v_accvgpr_read_b32 v252, a65
    v_accvgpr_read_b32 v253, a69
    v_mfma_f32_16x16x32_bf16 v[120:123], v[32:35], a[240:243], v[136:139]
    ds_read_b128 v[24:27], v2 offset:18560
    v_mul_f32 v248, v248, v53
    v_mfma_f32_16x16x32_bf16 v[120:123], v[36:39], a[244:247], v[120:123]
    v_exp_f32 v17, v169
    v_exp_f32 v18, v170
    v_mul_f32 v249, v249, v53
    v_mfma_f32_16x16x32_bf16 v[124:127], v[32:35], v[200:203], v[140:143]
    ds_read_b128 v[28:31], v3 offset:18560
    v_mul_f32 v250, v250, v53
    v_mfma_f32_16x16x32_bf16 v[124:127], v[36:39], v[204:207], v[124:127]
    s_waitcnt lgkmcnt(2)
    v_exp_f32 v19, v171
    v_mul_f32 v251, v251, v53
    v_mul_f32 v252, v252, v53
    v_mul_f32 v253, v253, v53
    v_mfma_f32_16x16x32_bf16 v[184:187], v[40:43], a[248:251], v[184:187]
    ds_read_b128 v[32:35], v2 offset:12544
    v_cvt_pk_bf16_f32 v168, v16, v17
    v_mfma_f32_16x16x32_bf16 v[184:187], v[44:47], a[252:255], v[184:187]
    v_cvt_pk_bf16_f32 v248, v248, v249
    v_exp_f32 v16, v104
    v_cvt_pk_bf16_f32 v249, v250, v251
    v_cvt_pk_bf16_f32 v250, v252, v253
    v_accvgpr_read_b32 v224, a50
    v_mfma_f32_16x16x32_bf16 v[188:191], v[40:43], v[208:211], v[188:191]
    ds_read_b128 v[36:39], v3 offset:12544
    v_accvgpr_read_b32 v225, a54
    v_mfma_f32_16x16x32_bf16 v[188:191], v[44:47], v[212:215], v[188:191]
    s_waitcnt lgkmcnt(2)
    buffer_store_dwordx3 v[248:250], v56, s[12:15], s40 offen offset:384 sc0 sc1
    v_accvgpr_read_b32 v226, a58
    v_mfma_f32_16x16x32_bf16 v[120:123], v[24:27], a[248:251], v[120:123]
    ds_read_b128 v[40:43], v2 offset:18688
    v_accvgpr_read_b32 v227, a62
    v_mfma_f32_16x16x32_bf16 v[120:123], v[28:31], a[252:255], v[120:123]
    v_exp_f32 v17, v105
    v_cvt_pk_bf16_f32 v169, v18, v19
    v_accvgpr_read_b32 v228, a66
    v_accvgpr_read_b32 v229, a70
    v_mfma_f32_16x16x32_bf16 v[124:127], v[24:27], v[208:211], v[124:127]
    ds_read_b128 v[44:47], v3 offset:18688
    v_mul_f32 v224, v224, v54
    v_mfma_f32_16x16x32_bf16 v[124:127], v[28:31], v[212:215], v[124:127]
    s_waitcnt lgkmcnt(2)
    v_add_u32 v60, 49152, v1
    v_mov_b32 v59, v1
    v_subrev_u32 v1, 49152, v1
    v_exp_f32 v18, v106
    v_mfma_f32_16x16x32_bf16 v[184:187], v[32:35], v[192:195], v[184:187]
    ds_read_b128 v[24:27], v60 offset:0
    v_mul_f32 v225, v225, v54
    v_mfma_f32_16x16x32_bf16 v[184:187], v[36:39], v[196:199], v[184:187]
    v_exp_f32 v19, v107
    v_mul_f32 v226, v226, v54
    v_cvt_pk_bf16_f32 v170, v16, v17
    v_mul_f32 v227, v227, v54
    v_mul_f32 v228, v228, v54
    v_mfma_f32_16x16x32_bf16 v[188:191], v[32:35], v[216:219], v[188:191]
    ds_read_b128 v[28:31], v60 offset:12288
    v_mul_f32 v229, v229, v54
    v_mfma_f32_16x16x32_bf16 v[188:191], v[36:39], v[220:223], v[188:191]
    s_waitcnt lgkmcnt(2)
    v_exp_f32 v16, v172
    v_cvt_pk_bf16_f32 v224, v224, v225
    v_cvt_pk_bf16_f32 v225, v226, v227
    v_cvt_pk_bf16_f32 v226, v228, v229
    v_mfma_f32_16x16x32_bf16 v[120:123], v[40:43], v[192:195], v[120:123]
    ds_read_b128 v[32:35], v60 offset:1024
    v_accvgpr_read_b32 v230, a51
    v_mfma_f32_16x16x32_bf16 v[120:123], v[44:47], v[196:199], v[120:123]
    buffer_store_dwordx3 v[224:226], v56, s[12:15], s40 offen offset:768 sc0 sc1
    v_accvgpr_read_b32 v231, a55
    v_mfma_f32_16x16x32_bf16 v[124:127], v[40:43], v[216:219], v[124:127]
    ds_read_b128 v[36:39], v60 offset:13312
    v_accvgpr_read_b32 v232, a59
    v_mfma_f32_16x16x32_bf16 v[124:127], v[44:47], v[220:223], v[124:127]
    s_waitcnt lgkmcnt(2)
    v_exp_f32 v17, v173
    v_cvt_pk_bf16_f32 v171, v18, v19
    v_exp_f32 v18, v174
    v_accvgpr_read_b32 v233, a63
    v_mfma_f32_16x16x32_bf16 a[96:99], v[80:83], v[24:27], a[96:99]
    ds_read_b128 v[40:43], v60 offset:2048
    v_accvgpr_read_b32 v234, a67
    v_mfma_f32_16x16x32_bf16 a[96:99], v[88:91], v[28:31], a[96:99]
    v_exp_f32 v19, v175
    v_accvgpr_read_b32 v235, a71
    v_mul_f32 v230, v230, v55
    v_mul_f32 v231, v231, v55
    v_mfma_f32_16x16x32_bf16 a[144:147], v[84:87], v[24:27], a[144:147]
    ds_read_b128 v[44:47], v60 offset:14336
    v_mul_f32 v232, v232, v55
    v_mfma_f32_16x16x32_bf16 a[144:147], v[92:95], v[28:31], a[144:147]
    s_waitcnt lgkmcnt(2)
    v_mfma_f32_16x16x32_bf16 v[128:131], v[168:171], v[20:23], v[128:131]
    v_mul_f32 v233, v233, v55
    v_mul_f32 v234, v234, v55
    v_mul_f32 v235, v235, v55
    v_mfma_f32_16x16x32_bf16 a[100:103], v[80:83], v[32:35], a[100:103]
    ds_read_b128 v[24:27], v60 offset:3072
    v_cvt_pk_bf16_f32 v172, v16, v17
    v_mfma_f32_16x16x32_bf16 a[100:103], v[88:91], v[36:39], a[100:103]
    v_exp_f32 v16, v108
    v_cvt_pk_bf16_f32 v230, v230, v231
    v_cvt_pk_bf16_f32 v231, v232, v233
    v_cvt_pk_bf16_f32 v232, v234, v235
    v_accvgpr_read_b32 v236, a72
    v_mfma_f32_16x16x32_bf16 a[148:151], v[84:87], v[32:35], a[148:151]
    ds_read_b128 v[28:31], v60 offset:15360
    v_accvgpr_read_b32 v237, a76
    v_mfma_f32_16x16x32_bf16 a[148:151], v[92:95], v[36:39], a[148:151]
    s_waitcnt lgkmcnt(2)
    buffer_store_dwordx3 v[230:232], v56, s[12:15], s40 offen offset:1152 sc0 sc1
    v_accvgpr_read_b32 v238, a80
    v_mfma_f32_16x16x32_bf16 a[104:107], v[80:83], v[40:43], a[104:107]
    ds_read_b128 v[32:35], v60 offset:4096
    v_accvgpr_read_b32 v239, a84
    v_mfma_f32_16x16x32_bf16 a[104:107], v[88:91], v[44:47], a[104:107]
    v_exp_f32 v17, v109
    v_cvt_pk_bf16_f32 v173, v18, v19
    v_accvgpr_read_b32 v240, a88
    v_accvgpr_read_b32 v241, a92
    v_mfma_f32_16x16x32_bf16 a[152:155], v[84:87], v[40:43], a[152:155]
    ds_read_b128 v[36:39], v60 offset:16384
    v_mul_f32 v236, v236, v52
    v_mfma_f32_16x16x32_bf16 a[152:155], v[92:95], v[44:47], a[152:155]
    s_waitcnt lgkmcnt(2)
    v_exp_f32 v18, v110
    v_mul_f32 v237, v237, v52
    v_mul_f32 v238, v238, v52
    v_mul_f32 v239, v239, v52
    v_mul_f32 v240, v240, v52
    v_mfma_f32_16x16x32_bf16 a[108:111], v[80:83], v[24:27], a[108:111]
    ds_read_b128 v[40:43], v60 offset:5120
    v_mul_f32 v241, v241, v52
    v_mfma_f32_16x16x32_bf16 a[108:111], v[88:91], v[28:31], a[108:111]
    v_exp_f32 v19, v111
    v_cvt_pk_bf16_f32 v236, v236, v237
    v_cvt_pk_bf16_f32 v237, v238, v239
    v_cvt_pk_bf16_f32 v238, v240, v241
    v_mfma_f32_16x16x32_bf16 a[156:159], v[84:87], v[24:27], a[156:159]
    ds_read_b128 v[44:47], v60 offset:17408
    v_cvt_pk_bf16_f32 v174, v16, v17
    v_mfma_f32_16x16x32_bf16 a[156:159], v[92:95], v[28:31], a[156:159]
    s_waitcnt lgkmcnt(2)
    buffer_store_dwordx3 v[236:238], v56, s[12:15], s40 offen offset:192 sc0 sc1
    v_accvgpr_read_b32 v242, a73
    v_mfma_f32_16x16x32_bf16 a[112:115], v[80:83], v[32:35], a[112:115]
    ds_read_b128 v[24:27], v1 offset:0
    v_cvt_pk_bf16_f32 v175, v18, v19
    v_mfma_f32_16x16x32_bf16 a[112:115], v[88:91], v[36:39], a[112:115]
    s_nop 1
    v_accvgpr_read_b32 v243, a77
    v_accvgpr_read_b32 v244, a81
    v_accvgpr_read_b32 v245, a85
    v_accvgpr_read_b32 v246, a89
    v_mfma_f32_16x16x32_bf16 a[160:163], v[84:87], v[32:35], a[160:163]
    ds_read_b128 v[28:31], v1 offset:12288
    v_accvgpr_read_b32 v247, a93
    v_mfma_f32_16x16x32_bf16 a[160:163], v[92:95], v[36:39], a[160:163]
    s_waitcnt lgkmcnt(2)
    v_mul_f32 v242, v242, v53
    v_mfma_f32_16x16x32_bf16 v[132:135], v[172:175], v[20:23], v[132:135]
    v_exp_f32 v16, v176
    v_mul_f32 v243, v243, v53
    v_mfma_f32_16x16x32_bf16 a[116:119], v[80:83], v[40:43], a[116:119]
    ds_read_b128 v[32:35], v1 offset:1024
    v_mul_f32 v244, v244, v53
    v_mfma_f32_16x16x32_bf16 a[116:119], v[88:91], v[44:47], a[116:119]
    v_exp_f32 v17, v177
    v_exp_f32 v18, v178
    v_mul_f32 v245, v245, v53
    v_mfma_f32_16x16x32_bf16 a[164:167], v[84:87], v[40:43], a[164:167]
    ds_read_b128 v[36:39], v1 offset:13312
    v_mul_f32 v246, v246, v53
    v_mfma_f32_16x16x32_bf16 a[164:167], v[92:95], v[44:47], a[164:167]
    s_waitcnt lgkmcnt(2)
    v_exp_f32 v19, v179
    v_cvt_pk_bf16_f32 v176, v16, v17
    v_exp_f32 v16, v112
    v_mfma_f32_16x16x32_bf16 a[96:99], v[160:163], v[24:27], a[96:99]
    ds_read_b128 v[40:43], v1 offset:2048
    v_mul_f32 v247, v247, v53
    v_mfma_f32_16x16x32_bf16 a[96:99], v[168:171], v[28:31], a[96:99]
    v_exp_f32 v17, v113
    v_cvt_pk_bf16_f32 v177, v18, v19
    v_exp_f32 v18, v114
    v_cvt_pk_bf16_f32 v242, v242, v243
    v_mfma_f32_16x16x32_bf16 a[144:147], v[164:167], v[24:27], a[144:147]
    ds_read_b128 v[44:47], v1 offset:14336
    v_cvt_pk_bf16_f32 v243, v244, v245
    v_mfma_f32_16x16x32_bf16 a[144:147], v[172:175], v[28:31], a[144:147]
    s_waitcnt lgkmcnt(2)
    v_exp_f32 v19, v115
    v_cvt_pk_bf16_f32 v178, v16, v17
    v_exp_f32 v16, v180
    v_mfma_f32_16x16x32_bf16 a[100:103], v[160:163], v[32:35], a[100:103]
    ds_read_b128 v[24:27], v1 offset:3072
    v_cvt_pk_bf16_f32 v244, v246, v247
    v_mfma_f32_16x16x32_bf16 a[100:103], v[168:171], v[36:39], a[100:103]
    buffer_store_dwordx3 v[242:244], v56, s[12:15], s40 offen offset:576 sc0 sc1
    v_accvgpr_read_b32 v248, a74
    v_mfma_f32_16x16x32_bf16 a[148:151], v[164:167], v[32:35], a[148:151]
    ds_read_b128 v[28:31], v1 offset:15360
    v_accvgpr_read_b32 v249, a78
    v_mfma_f32_16x16x32_bf16 a[148:151], v[172:175], v[36:39], a[148:151]
    s_waitcnt lgkmcnt(2)
    v_exp_f32 v17, v181
    v_cvt_pk_bf16_f32 v179, v18, v19
    v_exp_f32 v18, v182
    v_accvgpr_read_b32 v250, a82
    v_mfma_f32_16x16x32_bf16 a[104:107], v[160:163], v[40:43], a[104:107]
    ds_read_b128 v[32:35], v1 offset:4096
    v_accvgpr_read_b32 v251, a86
    v_mfma_f32_16x16x32_bf16 a[104:107], v[168:171], v[44:47], a[104:107]
    v_exp_f32 v19, v183
    v_mfma_f32_16x16x32_bf16 v[128:131], v[176:179], v[20:23], v[128:131]
    v_cvt_pk_bf16_f32 v180, v16, v17
    v_mfma_f32_16x16x32_bf16 a[152:155], v[164:167], v[40:43], a[152:155]
    ds_read_b128 v[36:39], v1 offset:16384
    v_accvgpr_read_b32 v252, a90
    v_mfma_f32_16x16x32_bf16 a[152:155], v[172:175], v[44:47], a[152:155]
    s_waitcnt lgkmcnt(2)
    v_exp_f32 v16, v116
    v_exp_f32 v17, v117
    v_cvt_pk_bf16_f32 v181, v18, v19
    v_mfma_f32_16x16x32_bf16 a[108:111], v[160:163], v[24:27], a[108:111]
    ds_read_b128 v[40:43], v1 offset:5120
    v_accvgpr_read_b32 v253, a94
    v_mfma_f32_16x16x32_bf16 a[108:111], v[168:171], v[28:31], a[108:111]
    v_exp_f32 v18, v118
    v_exp_f32 v19, v119
    v_cvt_pk_bf16_f32 v182, v16, v17
    v_cvt_pk_bf16_f32 v183, v18, v19
    v_mfma_f32_16x16x32_bf16 a[156:159], v[164:167], v[24:27], a[156:159]
L_pg13:
    s_cbranch_execz L_iwret
    s_nop 1
    ds_read_b128 v[44:47], v1 offset:17408
    v_mfma_f32_16x16x32_bf16 a[156:159], v[172:175], v[28:31], a[156:159]
    s_waitcnt lgkmcnt(2)
    v_mfma_f32_16x16x32_bf16 v[132:135], v[180:183], v[20:23], v[132:135]
    v_exp_f32 v16, v184
    v_mul_f32 v248, v248, v54
    v_mfma_f32_16x16x32_bf16 a[112:115], v[160:163], v[32:35], a[112:115]
    ds_read_b128 v[24:27], v59 offset:0
    v_mul_f32 v249, v249, v54
    v_mfma_f32_16x16x32_bf16 a[112:115], v[168:171], v[36:39], a[112:115]
    v_exp_f32 v17, v185
    v_exp_f32 v18, v186
    v_mul_f32 v250, v250, v54
    v_mfma_f32_16x16x32_bf16 a[160:163], v[164:167], v[32:35], a[160:163]
    ds_read_b128 v[28:31], v59 offset:12288
    v_mul_f32 v251, v251, v54
    v_mfma_f32_16x16x32_bf16 a[160:163], v[172:175], v[36:39], a[160:163]
    s_waitcnt lgkmcnt(2)
    v_exp_f32 v19, v187
    v_cvt_pk_bf16_f32 v184, v16, v17
    v_exp_f32 v16, v120
    v_exp_f32 v17, v121
    v_cvt_pk_bf16_f32 v185, v18, v19
    v_exp_f32 v18, v122
    v_exp_f32 v19, v123
    v_cvt_pk_bf16_f32 v186, v16, v17
    v_exp_f32 v16, v188
    v_exp_f32 v17, v189
    v_cvt_pk_bf16_f32 v187, v18, v19
    v_exp_f32 v18, v190
    v_exp_f32 v19, v191
    v_mfma_f32_16x16x32_bf16 v[128:131], v[184:187], v[20:23], v[128:131]
    v_cvt_pk_bf16_f32 v188, v16, v17
    v_exp_f32 v16, v124
    v_exp_f32 v17, v125
    v_cvt_pk_bf16_f32 v189, v18, v19
    v_exp_f32 v18, v126
    v_exp_f32 v19, v127
    v_cvt_pk_bf16_f32 v190, v16, v17
    v_cvt_pk_bf16_f32 v191, v18, v19
    s_nop 1
    v_mfma_f32_16x16x32_bf16 v[132:135], v[188:191], v[20:23], v[132:135]
    v_mfma_f32_16x16x32_bf16 a[116:119], v[160:163], v[40:43], a[116:119]
    ds_read_b128 v[32:35], v59 offset:1024
    v_mul_f32 v252, v252, v54
    v_mfma_f32_16x16x32_bf16 a[116:119], v[168:171], v[44:47], a[116:119]
    v_mul_f32 v253, v253, v54
    v_cvt_pk_bf16_f32 v248, v248, v249
    v_cvt_pk_bf16_f32 v249, v250, v251
    v_cvt_pk_bf16_f32 v250, v252, v253
    v_accvgpr_read_b32 v224, a75
    v_mfma_f32_16x16x32_bf16 a[164:167], v[164:167], v[40:43], a[164:167]
    ds_read_b128 v[36:39], v59 offset:13312
    v_accvgpr_read_b32 v225, a79
    v_mfma_f32_16x16x32_bf16 a[164:167], v[172:175], v[44:47], a[164:167]
    s_waitcnt lgkmcnt(2)
    buffer_store_dwordx3 v[248:250], v56, s[12:15], s40 offen offset:960 sc0 sc1
    v_accvgpr_read_b32 v226, a83
    v_accvgpr_read_b32 v227, a87
    v_mfma_f32_16x16x4_f32 v[128:131], v7, v57, v[128:131]
    v_mfma_f32_16x16x32_bf16 a[96:99], v[176:179], v[24:27], a[96:99]
    ds_read_b128 v[40:43], v59 offset:2048
    v_accvgpr_read_b32 v228, a91
    v_mfma_f32_16x16x32_bf16 a[96:99], v[184:187], v[28:31], a[96:99]
    v_accvgpr_read_b32 v229, a95
    v_mul_f32 v224, v224, v55
    v_mul_f32 v225, v225, v55
    v_mul_f32 v226, v226, v55
    v_mul_f32 v227, v227, v55
    v_mul_f32 v228, v228, v55
    v_mfma_f32_16x16x4_f32 v[132:135], v8, v57, v[132:135]
    v_mfma_f32_16x16x32_bf16 a[144:147], v[180:183], v[24:27], a[144:147]
    ds_read_b128 v[44:47], v59 offset:14336
    v_mul_f32 v229, v229, v55
    v_mfma_f32_16x16x32_bf16 a[144:147], v[188:191], v[28:31], a[144:147]
    s_waitcnt lgkmcnt(2)
    v_cvt_pk_bf16_f32 v224, v224, v225
    v_cvt_pk_bf16_f32 v225, v226, v227
    v_cvt_pk_bf16_f32 v226, v228, v229
    v_mfma_f32_16x16x32_bf16 a[100:103], v[176:179], v[32:35], a[100:103]
    ds_read_b128 v[24:27], v59 offset:3072
    v_mfma_f32_16x16x32_bf16 a[100:103], v[184:187], v[36:39], a[100:103]
    buffer_store_dwordx3 v[224:226], v56, s[12:15], s40 offen offset:1344 sc0 sc1
    v_mfma_f32_16x16x32_bf16 a[148:151], v[180:183], v[32:35], a[148:151]
    ds_read_b128 v[28:31], v59 offset:15360
    v_max3_f32 v18, v5, v6, v128
    v_mfma_f32_16x16x32_bf16 a[148:151], v[188:191], v[36:39], a[148:151]
    s_waitcnt lgkmcnt(2)
    v_max3_f32 v18, v18, v129, v130
    v_max3_f32 v18, v18, v131, v132
    v_max3_f32 v18, v18, v133, v134
    v_max_f32 v18, v18, v135
    s_mov_b32 s29, 0x5f800000
    v_cmp_lt_f32 s[48:49], s29, v18
    v_rcp_f32 v128, v128
    v_mfma_f32_16x16x32_bf16 a[104:107], v[176:179], v[40:43], a[104:107]
    ds_read_b128 v[32:35], v59 offset:4096
    v_mfma_f32_16x16x32_bf16 a[104:107], v[184:187], v[44:47], a[104:107]
    v_rcp_f32 v129, v129
    v_rcp_f32 v130, v130
    v_rcp_f32 v131, v131
    v_mfma_f32_16x16x32_bf16 a[152:155], v[180:183], v[40:43], a[152:155]
    ds_read_b128 v[36:39], v59 offset:16384
    v_mfma_f32_16x16x32_bf16 a[152:155], v[188:191], v[44:47], a[152:155]
    s_waitcnt lgkmcnt(2)
    v_rcp_f32 v132, v132
    v_rcp_f32 v133, v133
    v_mfma_f32_16x16x32_bf16 a[108:111], v[176:179], v[24:27], a[108:111]
    ds_read_b128 v[40:43], v59 offset:5120
    v_mfma_f32_16x16x32_bf16 a[108:111], v[184:187], v[28:31], a[108:111]
    v_rcp_f32 v134, v134
    v_rcp_f32 v135, v135
    v_mfma_f32_16x16x32_bf16 a[156:159], v[180:183], v[24:27], a[156:159]
    ds_read_b128 v[44:47], v59 offset:17408
    v_mfma_f32_16x16x32_bf16 a[156:159], v[188:191], v[28:31], a[156:159]
    s_waitcnt lgkmcnt(2)
    v_mfma_f32_16x16x32_bf16 a[112:115], v[176:179], v[32:35], a[112:115]
    ds_read_b128 v[24:27], v60 offset:6144
    v_mfma_f32_16x16x32_bf16 a[112:115], v[184:187], v[36:39], a[112:115]
    v_mfma_f32_16x16x32_bf16 a[160:163], v[180:183], v[32:35], a[160:163]
    ds_read_b128 v[28:31], v60 offset:18432
    v_mfma_f32_16x16x32_bf16 a[160:163], v[188:191], v[36:39], a[160:163]
    s_waitcnt lgkmcnt(2)
    s_cmp_lg_u64 s[48:49], 0
    s_cbranch_scc1 L_slow
    v_mfma_f32_16x16x32_bf16 a[116:119], v[176:179], v[40:43], a[116:119]
    ds_read_b128 v[32:35], v60 offset:7168
    v_mfma_f32_16x16x32_bf16 a[116:119], v[184:187], v[44:47], a[116:119]
    v_mfma_f32_16x16x32_bf16 a[164:167], v[180:183], v[40:43], a[164:167]
    ds_read_b128 v[36:39], v60 offset:19456
    v_mfma_f32_16x16x32_bf16 a[164:167], v[188:191], v[44:47], a[164:167]
    s_waitcnt lgkmcnt(2)
    v_mfma_f32_16x16x32_bf16 a[120:123], v[80:83], v[24:27], a[120:123]
    ds_read_b128 v[40:43], v60 offset:8192
    v_mfma_f32_16x16x32_bf16 a[120:123], v[88:91], v[28:31], a[120:123]
    v_mfma_f32_16x16x32_bf16 a[168:171], v[84:87], v[24:27], a[168:171]
    ds_read_b128 v[44:47], v60 offset:20480
    v_mfma_f32_16x16x32_bf16 a[168:171], v[92:95], v[28:31], a[168:171]
    s_waitcnt lgkmcnt(2)
    v_mfma_f32_16x16x32_bf16 a[124:127], v[80:83], v[32:35], a[124:127]
    ds_read_b128 v[24:27], v1 offset:6144
    v_accvgpr_read_b32 v230, a96
    v_mfma_f32_16x16x32_bf16 a[124:127], v[88:91], v[36:39], a[124:127]
    v_accvgpr_read_b32 v231, a100
    v_accvgpr_read_b32 v232, a104
    v_accvgpr_read_b32 v233, a108
    v_accvgpr_read_b32 v234, a112
    v_accvgpr_read_b32 v235, a116
    v_mul_f32 v230, v230, v128
    v_mul_f32 v231, v231, v128
    v_mul_f32 v232, v232, v128
    v_mul_f32 v233, v233, v128
    v_mul_f32 v234, v234, v128
    v_mul_f32 v235, v235, v128
    v_cvt_pk_bf16_f32 v230, v230, v231
    v_cvt_pk_bf16_f32 v231, v232, v233
    v_cvt_pk_bf16_f32 v232, v234, v235
    v_accvgpr_read_b32 v236, a97
    v_accvgpr_read_b32 v237, a101
    v_accvgpr_read_b32 v238, a105
    v_accvgpr_read_b32 v239, a109
    v_accvgpr_read_b32 v240, a113
    v_accvgpr_read_b32 v241, a117
    v_mul_f32 v236, v236, v129
    v_mul_f32 v237, v237, v129
    v_mul_f32 v238, v238, v129
    v_mul_f32 v239, v239, v129
    v_mul_f32 v240, v240, v129
    v_mul_f32 v241, v241, v129
    v_cvt_pk_bf16_f32 v236, v236, v237
    v_cvt_pk_bf16_f32 v237, v238, v239
    v_cvt_pk_bf16_f32 v238, v240, v241
    v_accvgpr_read_b32 v242, a98
    v_mfma_f32_16x16x32_bf16 a[172:175], v[84:87], v[32:35], a[172:175]
    ds_read_b128 v[28:31], v1 offset:18432
    v_accvgpr_read_b32 v243, a102
    v_mfma_f32_16x16x32_bf16 a[172:175], v[92:95], v[36:39], a[172:175]
    s_waitcnt lgkmcnt(2)
    buffer_store_dwordx3 v[230:232], v56, s[12:15], s41 offen offset:0 sc0 sc1
    v_accvgpr_read_b32 v244, a106
    v_mfma_f32_16x16x32_bf16 a[128:131], v[80:83], v[40:43], a[128:131]
    ds_read_b128 v[32:35], v1 offset:7168
    v_accvgpr_read_b32 v245, a110
    v_mfma_f32_16x16x32_bf16 a[128:131], v[88:91], v[44:47], a[128:131]
    buffer_store_dwordx3 v[236:238], v56, s[12:15], s41 offen offset:384 sc0 sc1
    v_accvgpr_read_b32 v246, a114
    v_mfma_f32_16x16x32_bf16 a[176:179], v[84:87], v[40:43], a[176:179]
    ds_read_b128 v[36:39], v1 offset:19456
    v_accvgpr_read_b32 v247, a118
    v_mfma_f32_16x16x32_bf16 a[176:179], v[92:95], v[44:47], a[176:179]
    s_waitcnt lgkmcnt(2)
    v_mul_f32 v242, v242, v130
    v_mul_f32 v243, v243, v130
    v_mul_f32 v244, v244, v130
    v_mul_f32 v245, v245, v130
    v_mul_f32 v246, v246, v130
    v_mul_f32 v247, v247, v130
    v_mfma_f32_16x16x32_bf16 a[120:123], v[160:163], v[24:27], a[120:123]
    ds_read_b128 v[40:43], v1 offset:8192
    v_cvt_pk_bf16_f32 v242, v242, v243
    v_mfma_f32_16x16x32_bf16 a[120:123], v[168:171], v[28:31], a[120:123]
    v_cvt_pk_bf16_f32 v243, v244, v245
    v_cvt_pk_bf16_f32 v244, v246, v247
    v_accvgpr_read_b32 v248, a99
    v_accvgpr_read_b32 v249, a103
    v_accvgpr_read_b32 v250, a107
    v_mfma_f32_16x16x32_bf16 a[168:171], v[164:167], v[24:27], a[168:171]
    ds_read_b128 v[44:47], v1 offset:20480
    v_accvgpr_read_b32 v251, a111
    v_mfma_f32_16x16x32_bf16 a[168:171], v[172:175], v[28:31], a[168:171]
    s_waitcnt lgkmcnt(2)
    buffer_store_dwordx3 v[242:244], v56, s[12:15], s41 offen offset:768 sc0 sc1
    v_accvgpr_read_b32 v252, a115
    v_mfma_f32_16x16x32_bf16 a[124:127], v[160:163], v[32:35], a[124:127]
    ds_read_b128 v[24:27], v59 offset:6144
    v_accvgpr_read_b32 v253, a119
    v_mfma_f32_16x16x32_bf16 a[124:127], v[168:171], v[36:39], a[124:127]
    v_mul_f32 v248, v248, v131
    v_mul_f32 v249, v249, v131
    v_mul_f32 v250, v250, v131
    v_mul_f32 v251, v251, v131
    v_mul_f32 v252, v252, v131
    v_mul_f32 v253, v253, v131
    v_mfma_f32_16x16x32_bf16 a[172:175], v[164:167], v[32:35], a[172:175]
    ds_read_b128 v[28:31], v59 offset:18432
    v_cvt_pk_bf16_f32 v248, v248, v249
    v_mfma_f32_16x16x32_bf16 a[172:175], v[172:175], v[36:39], a[172:175]
    s_waitcnt lgkmcnt(2)
    v_cvt_pk_bf16_f32 v249, v250, v251
    v_cvt_pk_bf16_f32 v250, v252, v253
    v_accvgpr_read_b32 v224, a144
    v_accvgpr_read_b32 v225, a148
    v_accvgpr_read_b32 v226, a152
    v_mfma_f32_16x16x32_bf16 a[128:131], v[160:163], v[40:43], a[128:131]
    ds_read_b128 v[32:35], v59 offset:7168
    v_accvgpr_read_b32 v227, a156
    v_mfma_f32_16x16x32_bf16 a[128:131], v[168:171], v[44:47], a[128:131]
    buffer_store_dwordx3 v[248:250], v56, s[12:15], s41 offen offset:1152 sc0 sc1
    v_accvgpr_read_b32 v228, a160
    v_mfma_f32_16x16x32_bf16 a[176:179], v[164:167], v[40:43], a[176:179]
    ds_read_b128 v[36:39], v59 offset:19456
    v_accvgpr_read_b32 v229, a164
    v_mfma_f32_16x16x32_bf16 a[176:179], v[172:175], v[44:47], a[176:179]
    s_waitcnt lgkmcnt(2)
    v_mul_f32 v224, v224, v132
    v_mul_f32 v225, v225, v132
    v_mul_f32 v226, v226, v132
    v_mul_f32 v227, v227, v132
    v_mul_f32 v228, v228, v132
    v_mul_f32 v229, v229, v132
    v_mfma_f32_16x16x32_bf16 a[120:123], v[176:179], v[24:27], a[120:123]
    ds_read_b128 v[40:43], v59 offset:8192
    v_cvt_pk_bf16_f32 v224, v224, v225
    v_mfma_f32_16x16x32_bf16 a[120:123], v[184:187], v[28:31], a[120:123]
    v_cvt_pk_bf16_f32 v225, v226, v227
    v_cvt_pk_bf16_f32 v226, v228, v229
    v_accvgpr_read_b32 v230, a145
    v_accvgpr_read_b32 v231, a149
    v_accvgpr_read_b32 v232, a153
    v_mfma_f32_16x16x32_bf16 a[168:171], v[180:183], v[24:27], a[168:171]
    ds_read_b128 v[44:47], v59 offset:20480
    v_accvgpr_read_b32 v233, a157
    v_mfma_f32_16x16x32_bf16 a[168:171], v[188:191], v[28:31], a[168:171]
    s_waitcnt lgkmcnt(2)
    buffer_store_dwordx3 v[224:226], v56, s[12:15], s42 offen offset:0 sc0 sc1
    v_accvgpr_read_b32 v234, a161
    v_mfma_f32_16x16x32_bf16 a[124:127], v[176:179], v[32:35], a[124:127]
    ds_read_b128 v[24:27], v60 offset:9216
    v_accvgpr_read_b32 v235, a165
    v_mfma_f32_16x16x32_bf16 a[124:127], v[184:187], v[36:39], a[124:127]
    v_mul_f32 v230, v230, v133
    v_mul_f32 v231, v231, v133
    v_mul_f32 v232, v232, v133
    v_mul_f32 v233, v233, v133
    v_mul_f32 v234, v234, v133
    v_mul_f32 v235, v235, v133
    v_mfma_f32_16x16x32_bf16 a[172:175], v[180:183], v[32:35], a[172:175]
    ds_read_b128 v[28:31], v60 offset:21504
    v_cvt_pk_bf16_f32 v230, v230, v231
    v_mfma_f32_16x16x32_bf16 a[172:175], v[188:191], v[36:39], a[172:175]
    s_waitcnt lgkmcnt(2)
    v_cvt_pk_bf16_f32 v231, v232, v233
    v_cvt_pk_bf16_f32 v232, v234, v235
    v_accvgpr_read_b32 v236, a146
    v_accvgpr_read_b32 v237, a150
    v_accvgpr_read_b32 v238, a154
    v_mfma_f32_16x16x32_bf16 a[128:131], v[176:179], v[40:43], a[128:131]
    ds_read_b128 v[32:35], v60 offset:10240
    v_accvgpr_read_b32 v239, a158
    v_mfma_f32_16x16x32_bf16 a[128:131], v[184:187], v[44:47], a[128:131]
    buffer_store_dwordx3 v[230:232], v56, s[12:15], s42 offen offset:384 sc0 sc1
    v_accvgpr_read_b32 v240, a162
    v_mfma_f32_16x16x32_bf16 a[176:179], v[180:183], v[40:43], a[176:179]
    ds_read_b128 v[36:39], v60 offset:22528
    v_accvgpr_read_b32 v241, a166
    v_mfma_f32_16x16x32_bf16 a[176:179], v[188:191], v[44:47], a[176:179]
    s_waitcnt lgkmcnt(2)
    v_mul_f32 v236, v236, v134
    v_mul_f32 v237, v237, v134
    v_mul_f32 v238, v238, v134
    v_mul_f32 v239, v239, v134
    v_mul_f32 v240, v240, v134
    v_mfma_f32_16x16x32_bf16 a[132:135], v[80:83], v[24:27], a[132:135]
    ds_read_b128 v[40:43], v60 offset:11264
    v_mul_f32 v241, v241, v134
    v_mfma_f32_16x16x32_bf16 a[132:135], v[88:91], v[28:31], a[132:135]
    v_cvt_pk_bf16_f32 v236, v236, v237
    v_cvt_pk_bf16_f32 v237, v238, v239
    v_cvt_pk_bf16_f32 v238, v240, v241
    v_accvgpr_read_b32 v242, a147
    v_accvgpr_read_b32 v243, a151
    v_accvgpr_read_b32 v244, a155
    v_mfma_f32_16x16x32_bf16 a[180:183], v[84:87], v[24:27], a[180:183]
    ds_read_b128 v[44:47], v60 offset:23552
    v_accvgpr_read_b32 v245, a159
    v_mfma_f32_16x16x32_bf16 a[180:183], v[92:95], v[28:31], a[180:183]
    s_waitcnt lgkmcnt(2)
    buffer_store_dwordx3 v[236:238], v56, s[12:15], s42 offen offset:768 sc0 sc1
    v_accvgpr_read_b32 v246, a163
    v_mfma_f32_16x16x32_bf16 a[136:139], v[80:83], v[32:35], a[136:139]
    ds_read_b128 v[24:27], v1 offset:9216
    v_accvgpr_read_b32 v96, a120
    v_mfma_f32_16x16x32_bf16 a[136:139], v[88:91], v[36:39], a[136:139]
    v_accvgpr_read_b32 v97, a124
    v_accvgpr_read_b32 v98, a128
    v_mul_f32 v96, v96, v128
    v_mul_f32 v97, v97, v128
    v_mul_f32 v98, v98, v128
    v_mfma_f32_16x16x32_bf16 a[184:187], v[84:87], v[32:35], a[184:187]
    ds_read_b128 v[28:31], v1 offset:21504
    v_accvgpr_read_b32 v102, a121
    v_mfma_f32_16x16x32_bf16 a[184:187], v[92:95], v[36:39], a[184:187]
    s_waitcnt lgkmcnt(2)
    v_accvgpr_read_b32 v103, a125
    v_accvgpr_read_b32 v104, a129
    v_mul_f32 v102, v102, v129
    v_mul_f32 v103, v103, v129
    v_mul_f32 v104, v104, v129
    v_accvgpr_read_b32 v108, a122
    v_mfma_f32_16x16x32_bf16 a[140:143], v[80:83], v[40:43], a[140:143]
    ds_read_b128 v[32:35], v1 offset:10240
    v_accvgpr_read_b32 v109, a126
    v_mfma_f32_16x16x32_bf16 a[140:143], v[88:91], v[44:47], a[140:143]
    v_accvgpr_read_b32 v110, a130
    v_mul_f32 v108, v108, v130
    v_mul_f32 v109, v109, v130
    v_mul_f32 v110, v110, v130
    v_accvgpr_read_b32 v114, a123
    v_mfma_f32_16x16x32_bf16 a[188:191], v[84:87], v[40:43], a[188:191]
    ds_read_b128 v[36:39], v1 offset:22528
    v_accvgpr_read_b32 v115, a127
    v_mfma_f32_16x16x32_bf16 a[188:191], v[92:95], v[44:47], a[188:191]
    s_waitcnt lgkmcnt(2)
    v_accvgpr_read_b32 v116, a131
    v_mul_f32 v114, v114, v131
    v_mul_f32 v115, v115, v131
    v_mul_f32 v116, v116, v131
    v_accvgpr_read_b32 v120, a168
    v_mfma_f32_16x16x32_bf16 a[132:135], v[160:163], v[24:27], a[132:135]
    ds_read_b128 v[40:43], v1 offset:11264
    v_accvgpr_read_b32 v121, a172
    v_mfma_f32_16x16x32_bf16 a[132:135], v[168:171], v[28:31], a[132:135]
    v_accvgpr_read_b32 v122, a176
    v_mul_f32 v120, v120, v132
    v_mul_f32 v121, v121, v132
    v_mul_f32 v122, v122, v132
    v_accvgpr_read_b32 v64, a169
    v_accvgpr_read_b32 v65, a173
    v_mfma_f32_16x16x32_bf16 a[180:183], v[164:167], v[24:27], a[180:183]
    ds_read_b128 v[44:47], v1 offset:23552
    v_accvgpr_read_b32 v66, a177
    v_mfma_f32_16x16x32_bf16 a[180:183], v[172:175], v[28:31], a[180:183]
    s_waitcnt lgkmcnt(2)
    v_mul_f32 v64, v64, v133
    v_mul_f32 v65, v65, v133
    v_mul_f32 v66, v66, v133
    v_accvgpr_read_b32 v70, a170
    v_accvgpr_read_b32 v71, a174
    v_mfma_f32_16x16x32_bf16 a[136:139], v[160:163], v[32:35], a[136:139]
    ds_read_b128 v[24:27], v59 offset:9216
    v_accvgpr_read_b32 v247, a167
    v_mfma_f32_16x16x32_bf16 a[136:139], v[168:171], v[36:39], a[136:139]
    v_accvgpr_read_b32 v72, a178
    v_mul_f32 v242, v242, v135
    v_mul_f32 v70, v70, v134
    v_mul_f32 v243, v243, v135
    v_mul_f32 v71, v71, v134
    v_mfma_f32_16x16x32_bf16 a[184:187], v[164:167], v[32:35], a[184:187]
    ds_read_b128 v[28:31], v59 offset:21504
    v_mul_f32 v244, v244, v135
    v_mfma_f32_16x16x32_bf16 a[184:187], v[172:175], v[36:39], a[184:187]
    s_waitcnt lgkmcnt(2)
    v_mul_f32 v72, v72, v134
    v_mul_f32 v245, v245, v135
    v_accvgpr_read_b32 v144, a171
    v_mul_f32 v246, v246, v135
    v_accvgpr_read_b32 v145, a175
    v_mul_f32 v247, v247, v135
    v_mfma_f32_16x16x32_bf16 a[140:143], v[160:163], v[40:43], a[140:143]
    ds_read_b128 v[32:35], v59 offset:10240
    v_accvgpr_read_b32 v146, a179
    v_mfma_f32_16x16x32_bf16 a[140:143], v[168:171], v[44:47], a[140:143]
    v_cvt_pk_bf16_f32 v242, v242, v243
    v_mul_f32 v144, v144, v135
    v_cvt_pk_bf16_f32 v243, v244, v245
    v_mul_f32 v145, v145, v135
    v_cvt_pk_bf16_f32 v244, v246, v247
    v_mfma_f32_16x16x32_bf16 a[188:191], v[164:167], v[40:43], a[188:191]
    ds_read_b128 v[36:39], v59 offset:22528
    v_mul_f32 v146, v146, v135
    v_mfma_f32_16x16x32_bf16 a[188:191], v[172:175], v[44:47], a[188:191]
    s_waitcnt lgkmcnt(2)
    buffer_store_dwordx3 v[242:244], v56, s[12:15], s42 offen offset:1152 sc0 sc1
    v_mfma_f32_16x16x32_bf16 a[132:135], v[176:179], v[24:27], a[132:135]
    ds_read_b128 v[40:43], v59 offset:11264
    v_mfma_f32_16x16x32_bf16 a[132:135], v[184:187], v[28:31], a[132:135]
    v_mfma_f32_16x16x32_bf16 a[180:183], v[180:183], v[24:27], a[180:183]
    ds_read_b128 v[44:47], v59 offset:23552
    v_mfma_f32_16x16x32_bf16 a[180:183], v[188:191], v[28:31], a[180:183]
    s_waitcnt lgkmcnt(2)
    v_mfma_f32_16x16x32_bf16 a[136:139], v[176:179], v[32:35], a[136:139]
    v_mfma_f32_16x16x32_bf16 a[136:139], v[184:187], v[36:39], a[136:139]
    v_mfma_f32_16x16x32_bf16 a[184:187], v[180:183], v[32:35], a[184:187]
    v_mfma_f32_16x16x32_bf16 a[184:187], v[188:191], v[36:39], a[184:187]
    s_waitcnt lgkmcnt(0)
    v_mfma_f32_16x16x32_bf16 a[140:143], v[176:179], v[40:43], a[140:143]
    v_mfma_f32_16x16x32_bf16 a[140:143], v[184:187], v[44:47], a[140:143]
    v_mfma_f32_16x16x32_bf16 a[188:191], v[180:183], v[40:43], a[188:191]
    v_mfma_f32_16x16x32_bf16 a[188:191], v[188:191], v[44:47], a[188:191]
    s_nop 7
    v_accvgpr_read_b32 v99, a132
    v_accvgpr_read_b32 v100, a136
    v_accvgpr_read_b32 v101, a140
    v_cvt_pk_bf16_f32 v96, v96, v97
    v_mul_f32 v99, v99, v128
    v_mul_f32 v100, v100, v128
    v_mul_f32 v101, v101, v128
    v_cvt_pk_bf16_f32 v97, v98, v99
    v_cvt_pk_bf16_f32 v98, v100, v101
    buffer_store_dwordx3 v[96:98], v56, s[12:15], s41 offen offset:192 sc0 sc1
    v_accvgpr_read_b32 v105, a133
    v_accvgpr_read_b32 v106, a137
    v_accvgpr_read_b32 v107, a141
    v_cvt_pk_bf16_f32 v102, v102, v103
    v_mul_f32 v105, v105, v129
    v_mul_f32 v106, v106, v129
    v_mul_f32 v107, v107, v129
    v_cvt_pk_bf16_f32 v103, v104, v105
    v_cvt_pk_bf16_f32 v104, v106, v107
    buffer_store_dwordx3 v[102:104], v56, s[12:15], s41 offen offset:576 sc0 sc1
    v_accvgpr_read_b32 v111, a134
    v_accvgpr_read_b32 v112, a138
    v_accvgpr_read_b32 v113, a142
    v_cvt_pk_bf16_f32 v108, v108, v109
    v_mul_f32 v111, v111, v130
    v_mul_f32 v112, v112, v130
    v_mul_f32 v113, v113, v130
    v_cvt_pk_bf16_f32 v109, v110, v111
    v_cvt_pk_bf16_f32 v110, v112, v113
    buffer_store_dwordx3 v[108:110], v56, s[12:15], s41 offen offset:960 sc0 sc1
    v_accvgpr_read_b32 v117, a135
    v_accvgpr_read_b32 v118, a139
    v_accvgpr_read_b32 v119, a143
    v_cvt_pk_bf16_f32 v114, v114, v115
    v_mul_f32 v117, v117, v131
    v_mul_f32 v118, v118, v131
    v_mul_f32 v119, v119, v131
    v_cvt_pk_bf16_f32 v115, v116, v117
    v_cvt_pk_bf16_f32 v116, v118, v119
    buffer_store_dwordx3 v[114:116], v56, s[12:15], s41 offen offset:1344 sc0 sc1
    v_accvgpr_read_b32 v123, a180
    v_accvgpr_read_b32 v124, a184
    v_accvgpr_read_b32 v125, a188
    v_cvt_pk_bf16_f32 v120, v120, v121
    v_mul_f32 v123, v123, v132
    v_mul_f32 v124, v124, v132
    v_mul_f32 v125, v125, v132
    v_cvt_pk_bf16_f32 v121, v122, v123
    v_cvt_pk_bf16_f32 v122, v124, v125
    buffer_store_dwordx3 v[120:122], v56, s[12:15], s42 offen offset:192 sc0 sc1
    v_accvgpr_read_b32 v67, a181
    v_accvgpr_read_b32 v68, a185
    v_accvgpr_read_b32 v69, a189
    v_cvt_pk_bf16_f32 v64, v64, v65
    v_mul_f32 v67, v67, v133
    v_mul_f32 v68, v68, v133
    v_mul_f32 v69, v69, v133
    v_cvt_pk_bf16_f32 v65, v66, v67
    v_cvt_pk_bf16_f32 v66, v68, v69
    buffer_store_dwordx3 v[64:66], v56, s[12:15], s42 offen offset:576 sc0 sc1
    v_accvgpr_read_b32 v73, a182
    v_accvgpr_read_b32 v74, a186
    v_accvgpr_read_b32 v75, a190
    v_cvt_pk_bf16_f32 v70, v70, v71
    v_mul_f32 v73, v73, v134
    v_mul_f32 v74, v74, v134
    v_mul_f32 v75, v75, v134
    v_cvt_pk_bf16_f32 v71, v72, v73
    v_cvt_pk_bf16_f32 v72, v74, v75
    buffer_store_dwordx3 v[70:72], v56, s[12:15], s42 offen offset:960 sc0 sc1
    v_accvgpr_read_b32 v147, a183
    v_accvgpr_read_b32 v148, a187
    v_accvgpr_read_b32 v149, a191
    v_cvt_pk_bf16_f32 v144, v144, v145
    v_mul_f32 v147, v147, v135
    v_mul_f32 v148, v148, v135
    v_mul_f32 v149, v149, v135
    v_cvt_pk_bf16_f32 v145, v146, v147
    v_cvt_pk_bf16_f32 v146, v148, v149
    buffer_store_dwordx3 v[144:146], v56, s[12:15], s42 offen offset:1344 sc0 sc1
L_fin:
L_done:
    s_endpgm
L_pollslow0:
    s_mov_b32 s59, 60
L_pollsm0:
    s_buffer_load_dwordx8 s[48:55], s[20:23], s44 glc
    s_waitcnt lgkmcnt(0)
    s_sub_u32 s48, s48, s92
    s_sub_u32 s49, s49, s92
    s_sub_u32 s50, s50, s92
    s_sub_u32 s51, s51, s92
    s_sub_u32 s52, s52, s92
    s_sub_u32 s53, s53, s92
    s_sub_u32 s54, s54, s92
    s_sub_u32 s55, s55, s92
    s_max_u32 s48, s48, s49
    s_max_u32 s48, s48, s50
    s_max_u32 s48, s48, s51
    s_max_u32 s48, s48, s52
    s_max_u32 s48, s48, s53
    s_max_u32 s48, s48, s54
    s_max_u32 s48, s48, s55
    s_cmp_lt_u32 s48, 16
    s_cbranch_scc1 L_pollok0
    s_sub_u32 s59, s59, 1
    s_cbranch_scc1 L_pollvec0
    s_sleep 1
    s_branch L_pollsm0
L_pollvec0:
    v_bfe_u32 v53, v4, 4, 6
    v_lshlrev_b32 v53, 2, v53
    s_sub_u32 s96, s96, 1
    s_cbranch_scc1 L_pollgiveup0
    s_sleep 2
    buffer_load_dword v52, v53, s[20:23], s44 offen sc1
    s_waitcnt vmcnt(0)
    s_bitcmp1_b32 s92, 9
    s_cbranch_scc1 L_nomix
    v_xor_b32 v53, s92, v52
    v_lshrrev_b32 v53, 5, v53
    v_add_u32 v53, -1, v53
    v_cmp_gt_u32 vcc, 31, v53
    s_nop 1
    s_and_b32 s59, vcc_lo, 0xff
    s_cbranch_scc0 L_nomix
    buffer_store_dwordx4 v[224:227], v11, s[4:7], s33 offen offset:0 sc1
    v_xor_b32 v55, 16, v11
    buffer_store_dwordx4 v[228:231], v55, s[4:7], s33 offen offset:768 sc1
    v_xor_b32 v54, 32, v11
    buffer_store_dwordx4 v[232:235], v54, s[4:7], s33 offen offset:1536 sc1
    v_xor_b32 v55, 48, v11
    buffer_store_dwordx4 v[236:239], v55, s[4:7], s33 offen offset:2304 sc1
    buffer_store_dwordx4 v[112:115], v15, s[4:7], s35 offen offset:0 sc1
    buffer_store_dwordx4 v[116:119], v15, s[4:7], s35 offen offset:1024 sc1
    buffer_store_dwordx4 v[120:123], v15, s[4:7], s35 offen offset:2048 sc1
    s_waitcnt vmcnt(0)
    s_barrier
    s_and_b32 s92, s92, 0xfffffc00
    s_add_u32 s92, s92, 512
    v_mov_b32 v0, s92
    s_add_u32 s92, s92, 1
    s_mov_b32 s44, 32
    v_add_u32 v0, 1, v0
    buffer_store_dword v0, v13, s[20:23], 0 offen offset:32 sc1
    s_branch L_pollvec0
L_nomix:
    v_subrev_u32 v52, s92, v52
    v_cmp_lt_u32 vcc, 15, v52
    s_nop 0
    s_and_b32 s59, vcc_lo, 0xff
    s_cbranch_scc1 L_pollvec0
    s_branch L_pollok0
L_pollgiveup0:
    s_mov_b32 s96, 0
    s_branch L_pollok0
L_pollslow1:
    s_mov_b32 s59, 200
L_pollsm1:
    s_buffer_load_dwordx8 s[48:55], s[20:23], s44 glc
    s_waitcnt lgkmcnt(0)
    s_sub_u32 s48, s48, s92
    s_sub_u32 s49, s49, s92
    s_sub_u32 s50, s50, s92
    s_sub_u32 s51, s51, s92
    s_sub_u32 s52, s52, s92
    s_sub_u32 s53, s53, s92
    s_sub_u32 s54, s54, s92
    s_sub_u32 s55, s55, s92
    s_max_u32 s48, s48, s49
    s_max_u32 s48, s48, s50
    s_max_u32 s48, s48, s51
    s_max_u32 s48, s48, s52
    s_max_u32 s48, s48, s53
    s_max_u32 s48, s48, s54
    s_max_u32 s48, s48, s55
    s_cmp_lt_u32 s48, 16
    s_cbranch_scc1 L_pollok1
    s_sub_u32 s59, s59, 1
    s_cbranch_scc1 L_pollvec1
    s_sleep 1
    s_branch L_pollsm1
L_pollvec1:
    v_bfe_u32 v53, v4, 4, 6
    v_lshlrev_b32 v53, 2, v53
    s_sub_u32 s96, s96, 1
    s_cbranch_scc1 L_pollgiveup1
    s_sleep 2
    buffer_load_dword v52, v53, s[20:23], s44 offen sc1
    s_waitcnt vmcnt(0)
    v_subrev_u32 v52, s92, v52
    v_cmp_lt_u32 vcc, 15, v52
    s_nop 0
    s_and_b32 s59, vcc_lo, 0xff
    s_cbranch_scc1 L_pollvec1
    s_branch L_pollok1
L_pollgiveup1:
    s_mov_b32 s96, 0
    s_branch L_pollok1
L_pollslow2:
    s_mov_b32 s59, 200
L_pollsm2:
    s_buffer_load_dwordx8 s[48:55], s[20:23], s44 glc
    s_waitcnt lgkmcnt(0)
    s_sub_u32 s48, s48, s92
    s_sub_u32 s49, s49, s92
    s_sub_u32 s50, s50, s92
    s_sub_u32 s51, s51, s92
    s_sub_u32 s52, s52, s92
    s_sub_u32 s53, s53, s92
    s_sub_u32 s54, s54, s92
    s_sub_u32 s55, s55, s92
    s_max_u32 s48, s48, s49
    s_max_u32 s48, s48, s50
    s_max_u32 s48, s48, s51
    s_max_u32 s48, s48, s52
    s_max_u32 s48, s48, s53
    s_max_u32 s48, s48, s54
    s_max_u32 s48, s48, s55
    s_cmp_lt_u32 s48, 16
    s_cbranch_scc1 L_pollok2
    s_sub_u32 s59, s59, 1
    s_cbranch_scc1 L_pollvec2
    s_sleep 1
    s_branch L_pollsm2
L_pollvec2:
    v_bfe_u32 v53, v4, 4, 6
    v_lshlrev_b32 v53, 2, v53
    s_sub_u32 s96, s96, 1
    s_cbranch_scc1 L_pollgiveup2
    s_sleep 2
    buffer_load_dword v52, v53, s[20:23], s44 offen sc1
    s_waitcnt vmcnt(0)
    v_subrev_u32 v52, s92, v52
    v_cmp_lt_u32 vcc, 15, v52
    s_nop 0
    s_and_b32 s59, vcc_lo, 0xff
    s_cbranch_scc1 L_pollvec2
    s_branch L_pollok2
L_pollgiveup2:
    s_mov_b32 s96, 0
    s_branch L_pollok2
L_pollslow3:
    s_mov_b32 s59, 200
L_pollsm3:
    s_buffer_load_dwordx8 s[48:55], s[20:23], s44 glc
    s_waitcnt lgkmcnt(0)
    s_sub_u32 s48, s48, s92
    s_sub_u32 s49, s49, s92
    s_sub_u32 s50, s50, s92
    s_sub_u32 s51, s51, s92
    s_sub_u32 s52, s52, s92
    s_sub_u32 s53, s53, s92
    s_sub_u32 s54, s54, s92
    s_sub_u32 s55, s55, s92
    s_max_u32 s48, s48, s49
    s_max_u32 s48, s48, s50
    s_max_u32 s48, s48, s51
    s_max_u32 s48, s48, s52
    s_max_u32 s48, s48, s53
    s_max_u32 s48, s48, s54
    s_max_u32 s48, s48, s55
    s_cmp_lt_u32 s48, 16
    s_cbranch_scc1 L_pollok3
    s_sub_u32 s59, s59, 1
    s_cbranch_scc1 L_pollvec3
    s_sleep 1
    s_branch L_pollsm3
L_pollvec3:
    v_bfe_u32 v53, v4, 4, 6
    v_lshlrev_b32 v53, 2, v53
    s_sub_u32 s96, s96, 1
    s_cbranch_scc1 L_pollgiveup3
    s_sleep 2
    buffer_load_dword v52, v53, s[20:23], s44 offen sc1
    s_waitcnt vmcnt(0)
    v_subrev_u32 v52, s92, v52
    v_cmp_lt_u32 vcc, 15, v52
    s_nop 0
    s_and_b32 s59, vcc_lo, 0xff
    s_cbranch_scc1 L_pollvec3
    s_branch L_pollok3
L_pollgiveup3:
    s_mov_b32 s96, 0
    s_branch L_pollok3
L_pollslow4:
    s_mov_b32 s59, 200
L_pollsm4:
    s_buffer_load_dwordx8 s[48:55], s[20:23], s44 glc
    s_waitcnt lgkmcnt(0)
    s_sub_u32 s48, s48, s92
    s_sub_u32 s49, s49, s92
    s_sub_u32 s50, s50, s92
    s_sub_u32 s51, s51, s92
    s_sub_u32 s52, s52, s92
    s_sub_u32 s53, s53, s92
    s_sub_u32 s54, s54, s92
    s_sub_u32 s55, s55, s92
    s_max_u32 s48, s48, s49
    s_max_u32 s48, s48, s50
    s_max_u32 s48, s48, s51
    s_max_u32 s48, s48, s52
    s_max_u32 s48, s48, s53
    s_max_u32 s48, s48, s54
    s_max_u32 s48, s48, s55
    s_cmp_lt_u32 s48, 16
    s_cbranch_scc1 L_pollok4
    s_sub_u32 s59, s59, 1
    s_cbranch_scc1 L_pollvec4
    s_sleep 1
    s_branch L_pollsm4
L_pollvec4:
    v_bfe_u32 v53, v4, 4, 6
    v_lshlrev_b32 v53, 2, v53
    s_sub_u32 s96, s96, 1
    s_cbranch_scc1 L_pollgiveup4
    s_sleep 2
    buffer_load_dword v52, v53, s[20:23], s44 offen sc1
    s_waitcnt vmcnt(0)
    v_subrev_u32 v52, s92, v52
    v_cmp_lt_u32 vcc, 15, v52
    s_nop 0
    s_and_b32 s59, vcc_lo, 0xff
    s_cbranch_scc1 L_pollvec4
    s_branch L_pollok4
L_pollgiveup4:
    s_mov_b32 s96, 0
    s_branch L_pollok4
L_tagslow:
    s_sub_u32 s96, s96, 1
    s_cbranch_scc1 L_taggiveup
    s_sleep 2
    buffer_load_dword v0, off, s[88:91], s93 sc1
    s_waitcnt vmcnt(0)
    v_readfirstlane_b32 s42, v0
    s_nop 0
    s_cmp_eq_u32 s42, s46
    s_cbranch_scc1 L_tagslow
    s_cmp_eq_u32 s42, 0
    s_cbranch_scc1 L_tagslow
    s_branch L_tagok
L_taggiveup:
    s_mov_b32 s96, 0
    s_branch L_tagok
L_slow:
    s_waitcnt vmcnt(0) lgkmcnt(0)
    s_nop 15
    v_accvgpr_write_b32 a0, 0
    v_accvgpr_write_b32 a1, 0
    v_accvgpr_write_b32 a2, 0
    v_accvgpr_write_b32 a3, 0
    v_accvgpr_write_b32 a4, 0
    v_accvgpr_write_b32 a5, 0
    v_accvgpr_write_b32 a6, 0
    v_accvgpr_write_b32 a7, 0
    v_accvgpr_write_b32 a8, 0
    v_accvgpr_write_b32 a9, 0
    v_accvgpr_write_b32 a10, 0
    v_accvgpr_write_b32 a11, 0
    v_accvgpr_write_b32 a12, 0
    v_accvgpr_write_b32 a13, 0
    v_accvgpr_write_b32 a14, 0
    v_accvgpr_write_b32 a15, 0
    v_accvgpr_write_b32 a16, 0
    v_accvgpr_write_b32 a17, 0
    v_accvgpr_write_b32 a18, 0
    v_accvgpr_write_b32 a19, 0
    v_accvgpr_write_b32 a20, 0
    v_accvgpr_write_b32 a21, 0
    v_accvgpr_write_b32 a22, 0
    v_accvgpr_write_b32 a23, 0
    v_accvgpr_write_b32 a24, 0
    v_accvgpr_write_b32 a25, 0
    v_accvgpr_write_b32 a26, 0
    v_accvgpr_write_b32 a27, 0
    v_accvgpr_write_b32 a28, 0
    v_accvgpr_write_b32 a29, 0
    v_accvgpr_write_b32 a30, 0
    v_accvgpr_write_b32 a31, 0
    v_accvgpr_write_b32 a32, 0
    v_accvgpr_write_b32 a33, 0
    v_accvgpr_write_b32 a34, 0
    v_accvgpr_write_b32 a35, 0
    v_accvgpr_write_b32 a36, 0
    v_accvgpr_write_b32 a37, 0
    v_accvgpr_write_b32 a38, 0
    v_accvgpr_write_b32 a39, 0
    v_accvgpr_write_b32 a40, 0
    v_accvgpr_write_b32 a41, 0
    v_accvgpr_write_b32 a42, 0
    v_accvgpr_write_b32 a43, 0
    v_accvgpr_write_b32 a44, 0
    v_accvgpr_write_b32 a45, 0
    v_accvgpr_write_b32 a46, 0
    v_accvgpr_write_b32 a47, 0
    v_accvgpr_write_b32 a48, 0
    v_accvgpr_write_b32 a49, 0
    v_accvgpr_write_b32 a50, 0
    v_accvgpr_write_b32 a51, 0
    v_accvgpr_write_b32 a52, 0
    v_accvgpr_write_b32 a53, 0
    v_accvgpr_write_b32 a54, 0
    v_accvgpr_write_b32 a55, 0
    v_accvgpr_write_b32 a56, 0
    v_accvgpr_write_b32 a57, 0
    v_accvgpr_write_b32 a58, 0
    v_accvgpr_write_b32 a59, 0
    v_accvgpr_write_b32 a60, 0
    v_accvgpr_write_b32 a61, 0
    v_accvgpr_write_b32 a62, 0
    v_accvgpr_write_b32 a63, 0
    v_accvgpr_write_b32 a64, 0
    v_accvgpr_write_b32 a65, 0
    v_accvgpr_write_b32 a66, 0
    v_accvgpr_write_b32 a67, 0
    v_accvgpr_write_b32 a68, 0
    v_accvgpr_write_b32 a69, 0
    v_accvgpr_write_b32 a70, 0
    v_accvgpr_write_b32 a71, 0
    v_accvgpr_write_b32 a72, 0
    v_accvgpr_write_b32 a73, 0
    v_accvgpr_write_b32 a74, 0
    v_accvgpr_write_b32 a75, 0
    v_accvgpr_write_b32 a76, 0
    v_accvgpr_write_b32 a77, 0
    v_accvgpr_write_b32 a78, 0
    v_accvgpr_write_b32 a79, 0
    v_accvgpr_write_b32 a80, 0
    v_accvgpr_write_b32 a81, 0
    v_accvgpr_write_b32 a82, 0
    v_accvgpr_write_b32 a83, 0
    v_accvgpr_write_b32 a84, 0
    v_accvgpr_write_b32 a85, 0
    v_accvgpr_write_b32 a86, 0
    v_accvgpr_write_b32 a87, 0
    v_accvgpr_write_b32 a88, 0
    v_accvgpr_write_b32 a89, 0
    v_accvgpr_write_b32 a90, 0
    v_accvgpr_write_b32 a91, 0
    v_accvgpr_write_b32 a92, 0
    v_accvgpr_write_b32 a93, 0
    v_accvgpr_write_b32 a94, 0
    v_accvgpr_write_b32 a95, 0
    v_accvgpr_write_b32 a96, 0
    v_accvgpr_write_b32 a97, 0
    v_accvgpr_write_b32 a98, 0
    v_accvgpr_write_b32 a99, 0
    v_accvgpr_write_b32 a100, 0
    v_accvgpr_write_b32 a101, 0
    v_accvgpr_write_b32 a102, 0
    v_accvgpr_write_b32 a103, 0
    v_accvgpr_write_b32 a104, 0
    v_accvgpr_write_b32 a105, 0
    v_accvgpr_write_b32 a106, 0
    v_accvgpr_write_b32 a107, 0
    v_accvgpr_write_b32 a108, 0
    v_accvgpr_write_b32 a109, 0
    v_accvgpr_write_b32 a110, 0
    v_accvgpr_write_b32 a111, 0
    v_accvgpr_write_b32 a112, 0
    v_accvgpr_write_b32 a113, 0
    v_accvgpr_write_b32 a114, 0
    v_accvgpr_write_b32 a115, 0
    v_accvgpr_write_b32 a116, 0
    v_accvgpr_write_b32 a117, 0
    v_accvgpr_write_b32 a118, 0
    v_accvgpr_write_b32 a119, 0
    v_accvgpr_write_b32 a120, 0
    v_accvgpr_write_b32 a121, 0
    v_accvgpr_write_b32 a122, 0
    v_accvgpr_write_b32 a123, 0
    v_accvgpr_write_b32 a124, 0
    v_accvgpr_write_b32 a125, 0
    v_accvgpr_write_b32 a126, 0
    v_accvgpr_write_b32 a127, 0
    v_accvgpr_write_b32 a128, 0
    v_accvgpr_write_b32 a129, 0
    v_accvgpr_write_b32 a130, 0
    v_accvgpr_write_b32 a131, 0
    v_accvgpr_write_b32 a132, 0
    v_accvgpr_write_b32 a133, 0
    v_accvgpr_write_b32 a134, 0
    v_accvgpr_write_b32 a135, 0
    v_accvgpr_write_b32 a136, 0
    v_accvgpr_write_b32 a137, 0
    v_accvgpr_write_b32 a138, 0
    v_accvgpr_write_b32 a139, 0
    v_accvgpr_write_b32 a140, 0
    v_accvgpr_write_b32 a141, 0
    v_accvgpr_write_b32 a142, 0
    v_accvgpr_write_b32 a143, 0
    v_accvgpr_write_b32 a144, 0
    v_accvgpr_write_b32 a145, 0
    v_accvgpr_write_b32 a146, 0
    v_accvgpr_write_b32 a147, 0
    v_accvgpr_write_b32 a148, 0
    v_accvgpr_write_b32 a149, 0
    v_accvgpr_write_b32 a150, 0
    v_accvgpr_write_b32 a151, 0
    v_accvgpr_write_b32 a152, 0
    v_accvgpr_write_b32 a153, 0
    v_accvgpr_write_b32 a154, 0
    v_accvgpr_write_b32 a155, 0
    v_accvgpr_write_b32 a156, 0
    v_accvgpr_write_b32 a157, 0
    v_accvgpr_write_b32 a158, 0
    v_accvgpr_write_b32 a159, 0
    v_accvgpr_write_b32 a160, 0
    v_accvgpr_write_b32 a161, 0
    v_accvgpr_write_b32 a162, 0
    v_accvgpr_write_b32 a163, 0
    v_accvgpr_write_b32 a164, 0
    v_accvgpr_write_b32 a165, 0
    v_accvgpr_write_b32 a166, 0
    v_accvgpr_write_b32 a167, 0
    v_accvgpr_write_b32 a168, 0
    v_accvgpr_write_b32 a169, 0
    v_accvgpr_write_b32 a170, 0
    v_accvgpr_write_b32 a171, 0
    v_accvgpr_write_b32 a172, 0
    v_accvgpr_write_b32 a173, 0
    v_accvgpr_write_b32 a174, 0
    v_accvgpr_write_b32 a175, 0
    v_accvgpr_write_b32 a176, 0
    v_accvgpr_write_b32 a177, 0
    v_accvgpr_write_b32 a178, 0
    v_accvgpr_write_b32 a179, 0
    v_accvgpr_write_b32 a180, 0
    v_accvgpr_write_b32 a181, 0
    v_accvgpr_write_b32 a182, 0
    v_accvgpr_write_b32 a183, 0
    v_accvgpr_write_b32 a184, 0
    v_accvgpr_write_b32 a185, 0
    v_accvgpr_write_b32 a186, 0
    v_accvgpr_write_b32 a187, 0
    v_accvgpr_write_b32 a188, 0
    v_accvgpr_write_b32 a189, 0
    v_accvgpr_write_b32 a190, 0
    v_accvgpr_write_b32 a191, 0
    v_mov_b32 v5, 0
    v_mov_b32 v240, 0xff7fffff
    v_mov_b32 v6, 0
    v_mov_b32 v241, 0xff7fffff
    v_mov_b32 v7, 0
    v_mov_b32 v242, 0xff7fffff
    v_mov_b32 v8, 0
    v_mov_b32 v243, 0xff7fffff
    v_subrev_u32 v244, 49152, v2
    v_subrev_u32 v245, 49152, v3
    v_subrev_u32 v246, 24576, v1
    s_mov_b32 s48, 0
L_slowloop:
    s_add_u32 s49, s48, 6144
    s_add_u32 s50, s48, 12288
    s_add_u32 s51, s48, 16384
    s_add_u32 s52, s48, 20480
    buffer_load_dwordx4 v[64:67], v244, s[4:7], s48 offen offset:0 sc1
    buffer_load_dwordx4 v[68:71], v245, s[4:7], s48 offen offset:0 sc1
    buffer_load_dwordx4 v[72:75], v244, s[4:7], s49 offen offset:0 sc1
    buffer_load_dwordx4 v[76:79], v245, s[4:7], s49 offen offset:0 sc1
    buffer_load_dwordx4 v[80:83], v244, s[4:7], s48 offen offset:128 sc1
    buffer_load_dwordx4 v[84:87], v245, s[4:7], s48 offen offset:128 sc1
    buffer_load_dwordx4 v[88:91], v244, s[4:7], s49 offen offset:128 sc1
    buffer_load_dwordx4 v[92:95], v245, s[4:7], s49 offen offset:128 sc1
    buffer_load_dwordx4 v[96:99], v244, s[4:7], s48 offen offset:256 sc1
    buffer_load_dwordx4 v[100:103], v245, s[4:7], s48 offen offset:256 sc1
    buffer_load_dwordx4 v[104:107], v244, s[4:7], s49 offen offset:256 sc1
    buffer_load_dwordx4 v[108:111], v245, s[4:7], s49 offen offset:256 sc1
    buffer_load_dwordx4 v[112:115], v246, s[4:7], s50 offen offset:0 sc1
    buffer_load_dwordx4 v[116:119], v246, s[4:7], s50 offen offset:1024 sc1
    buffer_load_dwordx4 v[120:123], v246, s[4:7], s50 offen offset:2048 sc1
    buffer_load_dwordx4 v[124:127], v246, s[4:7], s50 offen offset:3072 sc1
    buffer_load_dwordx4 v[128:131], v246, s[4:7], s51 offen offset:0 sc1
    buffer_load_dwordx4 v[132:135], v246, s[4:7], s51 offen offset:1024 sc1
    buffer_load_dwordx4 v[136:139], v246, s[4:7], s51 offen offset:2048 sc1
    buffer_load_dwordx4 v[140:143], v246, s[4:7], s51 offen offset:3072 sc1
    buffer_load_dwordx4 v[144:147], v246, s[4:7], s52 offen offset:0 sc1
    buffer_load_dwordx4 v[148:151], v246, s[4:7], s52 offen offset:1024 sc1
    buffer_load_dwordx4 v[152:155], v246, s[4:7], s52 offen offset:2048 sc1
    buffer_load_dwordx4 v[156:159], v246, s[4:7], s52 offen offset:3072 sc1
    s_waitcnt vmcnt(12)
    v_mfma_f32_16x16x32_bf16 v[160:163], v[64:67], a[192:195], 0
    v_mfma_f32_16x16x32_bf16 v[168:171], v[64:67], a[216:219], 0
    v_mfma_f32_16x16x32_bf16 v[176:179], v[64:67], a[240:243], 0
    v_mfma_f32_16x16x32_bf16 v[184:187], v[64:67], v[200:203], 0
    v_mfma_f32_16x16x32_bf16 v[160:163], v[68:71], a[196:199], v[160:163]
    v_mfma_f32_16x16x32_bf16 v[168:171], v[68:71], a[220:223], v[168:171]
    v_mfma_f32_16x16x32_bf16 v[176:179], v[68:71], a[244:247], v[176:179]
    v_mfma_f32_16x16x32_bf16 v[184:187], v[68:71], v[204:207], v[184:187]
    v_mfma_f32_16x16x32_bf16 v[164:167], v[72:75], a[192:195], 0
    v_mfma_f32_16x16x32_bf16 v[172:175], v[72:75], a[216:219], 0
    v_mfma_f32_16x16x32_bf16 v[180:183], v[72:75], a[240:243], 0
    v_mfma_f32_16x16x32_bf16 v[188:191], v[72:75], v[200:203], 0
    v_mfma_f32_16x16x32_bf16 v[164:167], v[76:79], a[196:199], v[164:167]
    v_mfma_f32_16x16x32_bf16 v[172:175], v[76:79], a[220:223], v[172:175]
    v_mfma_f32_16x16x32_bf16 v[180:183], v[76:79], a[244:247], v[180:183]
    v_mfma_f32_16x16x32_bf16 v[188:191], v[76:79], v[204:207], v[188:191]
    v_mfma_f32_16x16x32_bf16 v[160:163], v[80:83], a[200:203], v[160:163]
    v_mfma_f32_16x16x32_bf16 v[168:171], v[80:83], a[224:227], v[168:171]
    v_mfma_f32_16x16x32_bf16 v[176:179], v[80:83], a[248:251], v[176:179]
    v_mfma_f32_16x16x32_bf16 v[184:187], v[80:83], v[208:211], v[184:187]
    v_mfma_f32_16x16x32_bf16 v[160:163], v[84:87], a[204:207], v[160:163]
    v_mfma_f32_16x16x32_bf16 v[168:171], v[84:87], a[228:231], v[168:171]
    v_mfma_f32_16x16x32_bf16 v[176:179], v[84:87], a[252:255], v[176:179]
    v_mfma_f32_16x16x32_bf16 v[184:187], v[84:87], v[212:215], v[184:187]
    v_mfma_f32_16x16x32_bf16 v[164:167], v[88:91], a[200:203], v[164:167]
    v_mfma_f32_16x16x32_bf16 v[172:175], v[88:91], a[224:227], v[172:175]
    v_mfma_f32_16x16x32_bf16 v[180:183], v[88:91], a[248:251], v[180:183]
    v_mfma_f32_16x16x32_bf16 v[188:191], v[88:91], v[208:211], v[188:191]
    v_mfma_f32_16x16x32_bf16 v[164:167], v[92:95], a[204:207], v[164:167]
    v_mfma_f32_16x16x32_bf16 v[172:175], v[92:95], a[228:231], v[172:175]
    v_mfma_f32_16x16x32_bf16 v[180:183], v[92:95], a[252:255], v[180:183]
    v_mfma_f32_16x16x32_bf16 v[188:191], v[92:95], v[212:215], v[188:191]
    v_mfma_f32_16x16x32_bf16 v[160:163], v[96:99], a[208:211], v[160:163]
    v_mfma_f32_16x16x32_bf16 v[168:171], v[96:99], a[232:235], v[168:171]
    v_mfma_f32_16x16x32_bf16 v[176:179], v[96:99], v[192:195], v[176:179]
    v_mfma_f32_16x16x32_bf16 v[184:187], v[96:99], v[216:219], v[184:187]
    v_mfma_f32_16x16x32_bf16 v[160:163], v[100:103], a[212:215], v[160:163]
    v_mfma_f32_16x16x32_bf16 v[168:171], v[100:103], a[236:239], v[168:171]
    v_mfma_f32_16x16x32_bf16 v[176:179], v[100:103], v[196:199], v[176:179]
    v_mfma_f32_16x16x32_bf16 v[184:187], v[100:103], v[220:223], v[184:187]
    v_mfma_f32_16x16x32_bf16 v[164:167], v[104:107], a[208:211], v[164:167]
    v_mfma_f32_16x16x32_bf16 v[172:175], v[104:107], a[232:235], v[172:175]
    v_mfma_f32_16x16x32_bf16 v[180:183], v[104:107], v[192:195], v[180:183]
    v_mfma_f32_16x16x32_bf16 v[188:191], v[104:107], v[216:219], v[188:191]
    v_mfma_f32_16x16x32_bf16 v[164:167], v[108:111], a[212:215], v[164:167]
    v_mfma_f32_16x16x32_bf16 v[172:175], v[108:111], a[236:239], v[172:175]
    v_mfma_f32_16x16x32_bf16 v[180:183], v[108:111], v[196:199], v[180:183]
    v_mfma_f32_16x16x32_bf16 v[188:191], v[108:111], v[220:223], v[188:191]
    s_nop 9
    v_max3_f32 v16, v160, v161, v162
    v_max3_f32 v16, v16, v163, v164
    v_max3_f32 v16, v16, v165, v166
    v_max3_f32 v16, v16, v167, v240
    v_mov_b32 v17, v16
    s_nop 1
    v_permlane16_swap_b32 v16, v17
    s_nop 1
    v_max_f32 v16, v16, v17
    v_mov_b32 v17, v16
    s_nop 1
    v_permlane32_swap_b32 v16, v17
    s_nop 1
    v_max_f32 v16, v16, v17
    v_sub_f32 v17, v240, v16
    v_exp_f32 v17, v17
    v_mov_b32 v240, v16
    v_sub_f32 v160, v160, v16
    v_sub_f32 v161, v161, v16
    v_sub_f32 v162, v162, v16
    v_sub_f32 v163, v163, v16
    v_sub_f32 v164, v164, v16
    v_sub_f32 v165, v165, v16
    v_sub_f32 v166, v166, v16
    v_sub_f32 v167, v167, v16
    v_exp_f32 v160, v160
    v_exp_f32 v161, v161
    v_exp_f32 v162, v162
    v_exp_f32 v163, v163
    v_exp_f32 v164, v164
    v_exp_f32 v165, v165
    v_exp_f32 v166, v166
    v_exp_f32 v167, v167
    v_mul_f32 v5, v5, v17
    v_add_f32 v5, v5, v160
    v_add_f32 v5, v5, v161
    v_add_f32 v5, v5, v162
    v_add_f32 v5, v5, v163
    v_add_f32 v5, v5, v164
    v_add_f32 v5, v5, v165
    v_add_f32 v5, v5, v166
    v_add_f32 v5, v5, v167
    v_cvt_pk_bf16_f32 v224, v160, v161
    v_cvt_pk_bf16_f32 v225, v162, v163
    v_cvt_pk_bf16_f32 v226, v164, v165
    v_cvt_pk_bf16_f32 v227, v166, v167
    ds_bpermute_b32 v248, v58, v17 offset:0
    ds_bpermute_b32 v249, v58, v17 offset:4
    ds_bpermute_b32 v250, v58, v17 offset:8
    ds_bpermute_b32 v251, v58, v17 offset:12
    s_waitcnt lgkmcnt(0)
    v_accvgpr_read_b32 v18, a0
    v_mul_f32 v18, v18, v248
    v_accvgpr_write_b32 a0, v18
    v_accvgpr_read_b32 v19, a1
    v_mul_f32 v19, v19, v249
    v_accvgpr_write_b32 a1, v19
    v_accvgpr_read_b32 v18, a2
    v_mul_f32 v18, v18, v250
    v_accvgpr_write_b32 a2, v18
    v_accvgpr_read_b32 v19, a3
    v_mul_f32 v19, v19, v251
    v_accvgpr_write_b32 a3, v19
    v_accvgpr_read_b32 v18, a4
    v_mul_f32 v18, v18, v248
    v_accvgpr_write_b32 a4, v18
    v_accvgpr_read_b32 v19, a5
    v_mul_f32 v19, v19, v249
    v_accvgpr_write_b32 a5, v19
    v_accvgpr_read_b32 v18, a6
    v_mul_f32 v18, v18, v250
    v_accvgpr_write_b32 a6, v18
    v_accvgpr_read_b32 v19, a7
    v_mul_f32 v19, v19, v251
    v_accvgpr_write_b32 a7, v19
    v_accvgpr_read_b32 v18, a8
    v_mul_f32 v18, v18, v248
    v_accvgpr_write_b32 a8, v18
    v_accvgpr_read_b32 v19, a9
    v_mul_f32 v19, v19, v249
    v_accvgpr_write_b32 a9, v19
    v_accvgpr_read_b32 v18, a10
    v_mul_f32 v18, v18, v250
    v_accvgpr_write_b32 a10, v18
    v_accvgpr_read_b32 v19, a11
    v_mul_f32 v19, v19, v251
    v_accvgpr_write_b32 a11, v19
    v_accvgpr_read_b32 v18, a12
    v_mul_f32 v18, v18, v248
    v_accvgpr_write_b32 a12, v18
    v_accvgpr_read_b32 v19, a13
    v_mul_f32 v19, v19, v249
    v_accvgpr_write_b32 a13, v19
    v_accvgpr_read_b32 v18, a14
    v_mul_f32 v18, v18, v250
    v_accvgpr_write_b32 a14, v18
    v_accvgpr_read_b32 v19, a15
    v_mul_f32 v19, v19, v251
    v_accvgpr_write_b32 a15, v19
    v_accvgpr_read_b32 v18, a16
    v_mul_f32 v18, v18, v248
    v_accvgpr_write_b32 a16, v18
    v_accvgpr_read_b32 v19, a17
    v_mul_f32 v19, v19, v249
    v_accvgpr_write_b32 a17, v19
    v_accvgpr_read_b32 v18, a18
    v_mul_f32 v18, v18, v250
    v_accvgpr_write_b32 a18, v18
    v_accvgpr_read_b32 v19, a19
    v_mul_f32 v19, v19, v251
    v_accvgpr_write_b32 a19, v19
    v_accvgpr_read_b32 v18, a20
    v_mul_f32 v18, v18, v248
    v_accvgpr_write_b32 a20, v18
    v_accvgpr_read_b32 v19, a21
    v_mul_f32 v19, v19, v249
    v_accvgpr_write_b32 a21, v19
    v_accvgpr_read_b32 v18, a22
    v_mul_f32 v18, v18, v250
    v_accvgpr_write_b32 a22, v18
    v_accvgpr_read_b32 v19, a23
    v_mul_f32 v19, v19, v251
    v_accvgpr_write_b32 a23, v19
    v_accvgpr_read_b32 v18, a24
    v_mul_f32 v18, v18, v248
    v_accvgpr_write_b32 a24, v18
    v_accvgpr_read_b32 v19, a25
    v_mul_f32 v19, v19, v249
    v_accvgpr_write_b32 a25, v19
    v_accvgpr_read_b32 v18, a26
    v_mul_f32 v18, v18, v250
    v_accvgpr_write_b32 a26, v18
    v_accvgpr_read_b32 v19, a27
    v_mul_f32 v19, v19, v251
    v_accvgpr_write_b32 a27, v19
    v_accvgpr_read_b32 v18, a28
    v_mul_f32 v18, v18, v248
    v_accvgpr_write_b32 a28, v18
    v_accvgpr_read_b32 v19, a29
    v_mul_f32 v19, v19, v249
    v_accvgpr_write_b32 a29, v19
    v_accvgpr_read_b32 v18, a30
    v_mul_f32 v18, v18, v250
    v_accvgpr_write_b32 a30, v18
    v_accvgpr_read_b32 v19, a31
    v_mul_f32 v19, v19, v251
    v_accvgpr_write_b32 a31, v19
    v_accvgpr_read_b32 v18, a32
    v_mul_f32 v18, v18, v248
    v_accvgpr_write_b32 a32, v18
    v_accvgpr_read_b32 v19, a33
    v_mul_f32 v19, v19, v249
    v_accvgpr_write_b32 a33, v19
    v_accvgpr_read_b32 v18, a34
    v_mul_f32 v18, v18, v250
    v_accvgpr_write_b32 a34, v18
    v_accvgpr_read_b32 v19, a35
    v_mul_f32 v19, v19, v251
    v_accvgpr_write_b32 a35, v19
    v_accvgpr_read_b32 v18, a36
    v_mul_f32 v18, v18, v248
    v_accvgpr_write_b32 a36, v18
    v_accvgpr_read_b32 v19, a37
    v_mul_f32 v19, v19, v249
    v_accvgpr_write_b32 a37, v19
    v_accvgpr_read_b32 v18, a38
    v_mul_f32 v18, v18, v250
    v_accvgpr_write_b32 a38, v18
    v_accvgpr_read_b32 v19, a39
    v_mul_f32 v19, v19, v251
    v_accvgpr_write_b32 a39, v19
    v_accvgpr_read_b32 v18, a40
    v_mul_f32 v18, v18, v248
    v_accvgpr_write_b32 a40, v18
    v_accvgpr_read_b32 v19, a41
    v_mul_f32 v19, v19, v249
    v_accvgpr_write_b32 a41, v19
    v_accvgpr_read_b32 v18, a42
    v_mul_f32 v18, v18, v250
    v_accvgpr_write_b32 a42, v18
    v_accvgpr_read_b32 v19, a43
    v_mul_f32 v19, v19, v251
    v_accvgpr_write_b32 a43, v19
    v_accvgpr_read_b32 v18, a44
    v_mul_f32 v18, v18, v248
    v_accvgpr_write_b32 a44, v18
    v_accvgpr_read_b32 v19, a45
    v_mul_f32 v19, v19, v249
    v_accvgpr_write_b32 a45, v19
    v_accvgpr_read_b32 v18, a46
    v_mul_f32 v18, v18, v250
    v_accvgpr_write_b32 a46, v18
    v_accvgpr_read_b32 v19, a47
    v_mul_f32 v19, v19, v251
    v_accvgpr_write_b32 a47, v19
    v_max3_f32 v16, v168, v169, v170
    v_max3_f32 v16, v16, v171, v172
    v_max3_f32 v16, v16, v173, v174
    v_max3_f32 v16, v16, v175, v241
    v_mov_b32 v17, v16
    s_nop 1
    v_permlane16_swap_b32 v16, v17
    s_nop 1
    v_max_f32 v16, v16, v17
    v_mov_b32 v17, v16
    s_nop 1
    v_permlane32_swap_b32 v16, v17
    s_nop 1
    v_max_f32 v16, v16, v17
    v_sub_f32 v17, v241, v16
    v_exp_f32 v17, v17
    v_mov_b32 v241, v16
    v_sub_f32 v168, v168, v16
    v_sub_f32 v169, v169, v16
    v_sub_f32 v170, v170, v16
    v_sub_f32 v171, v171, v16
    v_sub_f32 v172, v172, v16
    v_sub_f32 v173, v173, v16
    v_sub_f32 v174, v174, v16
    v_sub_f32 v175, v175, v16
    v_exp_f32 v168, v168
    v_exp_f32 v169, v169
    v_exp_f32 v170, v170
    v_exp_f32 v171, v171
    v_exp_f32 v172, v172
    v_exp_f32 v173, v173
    v_exp_f32 v174, v174
    v_exp_f32 v175, v175
    v_mul_f32 v6, v6, v17
    v_add_f32 v6, v6, v168
    v_add_f32 v6, v6, v169
    v_add_f32 v6, v6, v170
    v_add_f32 v6, v6, v171
    v_add_f32 v6, v6, v172
    v_add_f32 v6, v6, v173
    v_add_f32 v6, v6, v174
    v_add_f32 v6, v6, v175
    v_cvt_pk_bf16_f32 v228, v168, v169
    v_cvt_pk_bf16_f32 v229, v170, v171
    v_cvt_pk_bf16_f32 v230, v172, v173
    v_cvt_pk_bf16_f32 v231, v174, v175
    ds_bpermute_b32 v248, v58, v17 offset:0
    ds_bpermute_b32 v249, v58, v17 offset:4
    ds_bpermute_b32 v250, v58, v17 offset:8
    ds_bpermute_b32 v251, v58, v17 offset:12
    s_waitcnt lgkmcnt(0)
    v_accvgpr_read_b32 v18, a48
    v_mul_f32 v18, v18, v248
    v_accvgpr_write_b32 a48, v18
    v_accvgpr_read_b32 v19, a49
    v_mul_f32 v19, v19, v249
    v_accvgpr_write_b32 a49, v19
    v_accvgpr_read_b32 v18, a50
    v_mul_f32 v18, v18, v250
    v_accvgpr_write_b32 a50, v18
    v_accvgpr_read_b32 v19, a51
    v_mul_f32 v19, v19, v251
    v_accvgpr_write_b32 a51, v19
    v_accvgpr_read_b32 v18, a52
    v_mul_f32 v18, v18, v248
    v_accvgpr_write_b32 a52, v18
    v_accvgpr_read_b32 v19, a53
    v_mul_f32 v19, v19, v249
    v_accvgpr_write_b32 a53, v19
    v_accvgpr_read_b32 v18, a54
    v_mul_f32 v18, v18, v250
    v_accvgpr_write_b32 a54, v18
    v_accvgpr_read_b32 v19, a55
    v_mul_f32 v19, v19, v251
    v_accvgpr_write_b32 a55, v19
    v_accvgpr_read_b32 v18, a56
    v_mul_f32 v18, v18, v248
    v_accvgpr_write_b32 a56, v18
    v_accvgpr_read_b32 v19, a57
    v_mul_f32 v19, v19, v249
    v_accvgpr_write_b32 a57, v19
    v_accvgpr_read_b32 v18, a58
    v_mul_f32 v18, v18, v250
    v_accvgpr_write_b32 a58, v18
    v_accvgpr_read_b32 v19, a59
    v_mul_f32 v19, v19, v251
    v_accvgpr_write_b32 a59, v19
    v_accvgpr_read_b32 v18, a60
    v_mul_f32 v18, v18, v248
    v_accvgpr_write_b32 a60, v18
    v_accvgpr_read_b32 v19, a61
    v_mul_f32 v19, v19, v249
    v_accvgpr_write_b32 a61, v19
    v_accvgpr_read_b32 v18, a62
    v_mul_f32 v18, v18, v250
    v_accvgpr_write_b32 a62, v18
    v_accvgpr_read_b32 v19, a63
    v_mul_f32 v19, v19, v251
    v_accvgpr_write_b32 a63, v19
    v_accvgpr_read_b32 v18, a64
    v_mul_f32 v18, v18, v248
    v_accvgpr_write_b32 a64, v18
    v_accvgpr_read_b32 v19, a65
    v_mul_f32 v19, v19, v249
    v_accvgpr_write_b32 a65, v19
    v_accvgpr_read_b32 v18, a66
    v_mul_f32 v18, v18, v250
    v_accvgpr_write_b32 a66, v18
    v_accvgpr_read_b32 v19, a67
    v_mul_f32 v19, v19, v251
    v_accvgpr_write_b32 a67, v19
    v_accvgpr_read_b32 v18, a68
    v_mul_f32 v18, v18, v248
    v_accvgpr_write_b32 a68, v18
    v_accvgpr_read_b32 v19, a69
    v_mul_f32 v19, v19, v249
    v_accvgpr_write_b32 a69, v19
    v_accvgpr_read_b32 v18, a70
    v_mul_f32 v18, v18, v250
    v_accvgpr_write_b32 a70, v18
    v_accvgpr_read_b32 v19, a71
    v_mul_f32 v19, v19, v251
    v_accvgpr_write_b32 a71, v19
    v_accvgpr_read_b32 v18, a72
    v_mul_f32 v18, v18, v248
    v_accvgpr_write_b32 a72, v18
    v_accvgpr_read_b32 v19, a73
    v_mul_f32 v19, v19, v249
    v_accvgpr_write_b32 a73, v19
    v_accvgpr_read_b32 v18, a74
    v_mul_f32 v18, v18, v250
    v_accvgpr_write_b32 a74, v18
    v_accvgpr_read_b32 v19, a75
    v_mul_f32 v19, v19, v251
    v_accvgpr_write_b32 a75, v19
    v_accvgpr_read_b32 v18, a76
    v_mul_f32 v18, v18, v248
    v_accvgpr_write_b32 a76, v18
    v_accvgpr_read_b32 v19, a77
    v_mul_f32 v19, v19, v249
    v_accvgpr_write_b32 a77, v19
    v_accvgpr_read_b32 v18, a78
    v_mul_f32 v18, v18, v250
    v_accvgpr_write_b32 a78, v18
    v_accvgpr_read_b32 v19, a79
    v_mul_f32 v19, v19, v251
    v_accvgpr_write_b32 a79, v19
    v_accvgpr_read_b32 v18, a80
    v_mul_f32 v18, v18, v248
    v_accvgpr_write_b32 a80, v18
    v_accvgpr_read_b32 v19, a81
    v_mul_f32 v19, v19, v249
    v_accvgpr_write_b32 a81, v19
    v_accvgpr_read_b32 v18, a82
    v_mul_f32 v18, v18, v250
    v_accvgpr_write_b32 a82, v18
    v_accvgpr_read_b32 v19, a83
    v_mul_f32 v19, v19, v251
    v_accvgpr_write_b32 a83, v19
    v_accvgpr_read_b32 v18, a84
    v_mul_f32 v18, v18, v248
    v_accvgpr_write_b32 a84, v18
    v_accvgpr_read_b32 v19, a85
    v_mul_f32 v19, v19, v249
    v_accvgpr_write_b32 a85, v19
    v_accvgpr_read_b32 v18, a86
    v_mul_f32 v18, v18, v250
    v_accvgpr_write_b32 a86, v18
    v_accvgpr_read_b32 v19, a87
    v_mul_f32 v19, v19, v251
    v_accvgpr_write_b32 a87, v19
    v_accvgpr_read_b32 v18, a88
    v_mul_f32 v18, v18, v248
    v_accvgpr_write_b32 a88, v18
    v_accvgpr_read_b32 v19, a89
    v_mul_f32 v19, v19, v249
    v_accvgpr_write_b32 a89, v19
    v_accvgpr_read_b32 v18, a90
    v_mul_f32 v18, v18, v250
    v_accvgpr_write_b32 a90, v18
    v_accvgpr_read_b32 v19, a91
    v_mul_f32 v19, v19, v251
    v_accvgpr_write_b32 a91, v19
    v_accvgpr_read_b32 v18, a92
    v_mul_f32 v18, v18, v248
    v_accvgpr_write_b32 a92, v18
    v_accvgpr_read_b32 v19, a93
    v_mul_f32 v19, v19, v249
    v_accvgpr_write_b32 a93, v19
    v_accvgpr_read_b32 v18, a94
    v_mul_f32 v18, v18, v250
    v_accvgpr_write_b32 a94, v18
    v_accvgpr_read_b32 v19, a95
    v_mul_f32 v19, v19, v251
    v_accvgpr_write_b32 a95, v19
    v_max3_f32 v16, v176, v177, v178
    v_max3_f32 v16, v16, v179, v180
    v_max3_f32 v16, v16, v181, v182
    v_max3_f32 v16, v16, v183, v242
    v_mov_b32 v17, v16
    s_nop 1
    v_permlane16_swap_b32 v16, v17
    s_nop 1
    v_max_f32 v16, v16, v17
    v_mov_b32 v17, v16
    s_nop 1
    v_permlane32_swap_b32 v16, v17
    s_nop 1
    v_max_f32 v16, v16, v17
    v_sub_f32 v17, v242, v16
    v_exp_f32 v17, v17
    v_mov_b32 v242, v16
    v_sub_f32 v176, v176, v16
    v_sub_f32 v177, v177, v16
    v_sub_f32 v178, v178, v16
    v_sub_f32 v179, v179, v16
    v_sub_f32 v180, v180, v16
    v_sub_f32 v181, v181, v16
    v_sub_f32 v182, v182, v16
    v_sub_f32 v183, v183, v16
    v_exp_f32 v176, v176
    v_exp_f32 v177, v177
    v_exp_f32 v178, v178
    v_exp_f32 v179, v179
    v_exp_f32 v180, v180
    v_exp_f32 v181, v181
    v_exp_f32 v182, v182
    v_exp_f32 v183, v183
    v_mul_f32 v7, v7, v17
    v_add_f32 v7, v7, v176
    v_add_f32 v7, v7, v177
    v_add_f32 v7, v7, v178
    v_add_f32 v7, v7, v179
    v_add_f32 v7, v7, v180
    v_add_f32 v7, v7, v181
    v_add_f32 v7, v7, v182
    v_add_f32 v7, v7, v183
    v_cvt_pk_bf16_f32 v232, v176, v177
    v_cvt_pk_bf16_f32 v233, v178, v179
    v_cvt_pk_bf16_f32 v234, v180, v181
    v_cvt_pk_bf16_f32 v235, v182, v183
    ds_bpermute_b32 v248, v58, v17 offset:0
    ds_bpermute_b32 v249, v58, v17 offset:4
    ds_bpermute_b32 v250, v58, v17 offset:8
    ds_bpermute_b32 v251, v58, v17 offset:12
    s_waitcnt lgkmcnt(0)
    v_accvgpr_read_b32 v18, a96
    v_mul_f32 v18, v18, v248
    v_accvgpr_write_b32 a96, v18
    v_accvgpr_read_b32 v19, a97
    v_mul_f32 v19, v19, v249
    v_accvgpr_write_b32 a97, v19
    v_accvgpr_read_b32 v18, a98
    v_mul_f32 v18, v18, v250
    v_accvgpr_write_b32 a98, v18
    v_accvgpr_read_b32 v19, a99
    v_mul_f32 v19, v19, v251
    v_accvgpr_write_b32 a99, v19
    v_accvgpr_read_b32 v18, a100
    v_mul_f32 v18, v18, v248
    v_accvgpr_write_b32 a100, v18
    v_accvgpr_read_b32 v19, a101
    v_mul_f32 v19, v19, v249
    v_accvgpr_write_b32 a101, v19
    v_accvgpr_read_b32 v18, a102
    v_mul_f32 v18, v18, v250
    v_accvgpr_write_b32 a102, v18
    v_accvgpr_read_b32 v19, a103
    v_mul_f32 v19, v19, v251
    v_accvgpr_write_b32 a103, v19
    v_accvgpr_read_b32 v18, a104
    v_mul_f32 v18, v18, v248
    v_accvgpr_write_b32 a104, v18
    v_accvgpr_read_b32 v19, a105
    v_mul_f32 v19, v19, v249
    v_accvgpr_write_b32 a105, v19
    v_accvgpr_read_b32 v18, a106
    v_mul_f32 v18, v18, v250
    v_accvgpr_write_b32 a106, v18
    v_accvgpr_read_b32 v19, a107
    v_mul_f32 v19, v19, v251
    v_accvgpr_write_b32 a107, v19
    v_accvgpr_read_b32 v18, a108
    v_mul_f32 v18, v18, v248
    v_accvgpr_write_b32 a108, v18
    v_accvgpr_read_b32 v19, a109
    v_mul_f32 v19, v19, v249
    v_accvgpr_write_b32 a109, v19
    v_accvgpr_read_b32 v18, a110
    v_mul_f32 v18, v18, v250
    v_accvgpr_write_b32 a110, v18
    v_accvgpr_read_b32 v19, a111
    v_mul_f32 v19, v19, v251
    v_accvgpr_write_b32 a111, v19
    v_accvgpr_read_b32 v18, a112
    v_mul_f32 v18, v18, v248
    v_accvgpr_write_b32 a112, v18
    v_accvgpr_read_b32 v19, a113
    v_mul_f32 v19, v19, v249
    v_accvgpr_write_b32 a113, v19
    v_accvgpr_read_b32 v18, a114
    v_mul_f32 v18, v18, v250
    v_accvgpr_write_b32 a114, v18
    v_accvgpr_read_b32 v19, a115
    v_mul_f32 v19, v19, v251
    v_accvgpr_write_b32 a115, v19
    v_accvgpr_read_b32 v18, a116
    v_mul_f32 v18, v18, v248
    v_accvgpr_write_b32 a116, v18
    v_accvgpr_read_b32 v19, a117
    v_mul_f32 v19, v19, v249
    v_accvgpr_write_b32 a117, v19
    v_accvgpr_read_b32 v18, a118
    v_mul_f32 v18, v18, v250
    v_accvgpr_write_b32 a118, v18
    v_accvgpr_read_b32 v19, a119
    v_mul_f32 v19, v19, v251
    v_accvgpr_write_b32 a119, v19
    v_accvgpr_read_b32 v18, a120
    v_mul_f32 v18, v18, v248
    v_accvgpr_write_b32 a120, v18
    v_accvgpr_read_b32 v19, a121
    v_mul_f32 v19, v19, v249
    v_accvgpr_write_b32 a121, v19
    v_accvgpr_read_b32 v18, a122
    v_mul_f32 v18, v18, v250
    v_accvgpr_write_b32 a122, v18
    v_accvgpr_read_b32 v19, a123
    v_mul_f32 v19, v19, v251
    v_accvgpr_write_b32 a123, v19
    v_accvgpr_read_b32 v18, a124
    v_mul_f32 v18, v18, v248
    v_accvgpr_write_b32 a124, v18
    v_accvgpr_read_b32 v19, a125
    v_mul_f32 v19, v19, v249
    v_accvgpr_write_b32 a125, v19
    v_accvgpr_read_b32 v18, a126
    v_mul_f32 v18, v18, v250
    v_accvgpr_write_b32 a126, v18
    v_accvgpr_read_b32 v19, a127
    v_mul_f32 v19, v19, v251
    v_accvgpr_write_b32 a127, v19
    v_accvgpr_read_b32 v18, a128
    v_mul_f32 v18, v18, v248
    v_accvgpr_write_b32 a128, v18
    v_accvgpr_read_b32 v19, a129
    v_mul_f32 v19, v19, v249
    v_accvgpr_write_b32 a129, v19
    v_accvgpr_read_b32 v18, a130
    v_mul_f32 v18, v18, v250
    v_accvgpr_write_b32 a130, v18
    v_accvgpr_read_b32 v19, a131
    v_mul_f32 v19, v19, v251
    v_accvgpr_write_b32 a131, v19
    v_accvgpr_read_b32 v18, a132
    v_mul_f32 v18, v18, v248
    v_accvgpr_write_b32 a132, v18
    v_accvgpr_read_b32 v19, a133
    v_mul_f32 v19, v19, v249
    v_accvgpr_write_b32 a133, v19
    v_accvgpr_read_b32 v18, a134
    v_mul_f32 v18, v18, v250
    v_accvgpr_write_b32 a134, v18
    v_accvgpr_read_b32 v19, a135
    v_mul_f32 v19, v19, v251
    v_accvgpr_write_b32 a135, v19
    v_accvgpr_read_b32 v18, a136
    v_mul_f32 v18, v18, v248
    v_accvgpr_write_b32 a136, v18
    v_accvgpr_read_b32 v19, a137
    v_mul_f32 v19, v19, v249
    v_accvgpr_write_b32 a137, v19
    v_accvgpr_read_b32 v18, a138
    v_mul_f32 v18, v18, v250
    v_accvgpr_write_b32 a138, v18
    v_accvgpr_read_b32 v19, a139
    v_mul_f32 v19, v19, v251
    v_accvgpr_write_b32 a139, v19
    v_accvgpr_read_b32 v18, a140
    v_mul_f32 v18, v18, v248
    v_accvgpr_write_b32 a140, v18
    v_accvgpr_read_b32 v19, a141
    v_mul_f32 v19, v19, v249
    v_accvgpr_write_b32 a141, v19
    v_accvgpr_read_b32 v18, a142
    v_mul_f32 v18, v18, v250
    v_accvgpr_write_b32 a142, v18
    v_accvgpr_read_b32 v19, a143
    v_mul_f32 v19, v19, v251
    v_accvgpr_write_b32 a143, v19
    v_max3_f32 v16, v184, v185, v186
    v_max3_f32 v16, v16, v187, v188
    v_max3_f32 v16, v16, v189, v190
    v_max3_f32 v16, v16, v191, v243
    v_mov_b32 v17, v16
    s_nop 1
    v_permlane16_swap_b32 v16, v17
    s_nop 1
    v_max_f32 v16, v16, v17
    v_mov_b32 v17, v16
    s_nop 1
    v_permlane32_swap_b32 v16, v17
    s_nop 1
    v_max_f32 v16, v16, v17
    v_sub_f32 v17, v243, v16
    v_exp_f32 v17, v17
    v_mov_b32 v243, v16
    v_sub_f32 v184, v184, v16
    v_sub_f32 v185, v185, v16
    v_sub_f32 v186, v186, v16
    v_sub_f32 v187, v187, v16
    v_sub_f32 v188, v188, v16
    v_sub_f32 v189, v189, v16
    v_sub_f32 v190, v190, v16
    v_sub_f32 v191, v191, v16
    v_exp_f32 v184, v184
    v_exp_f32 v185, v185
    v_exp_f32 v186, v186
    v_exp_f32 v187, v187
    v_exp_f32 v188, v188
    v_exp_f32 v189, v189
    v_exp_f32 v190, v190
    v_exp_f32 v191, v191
    v_mul_f32 v8, v8, v17
    v_add_f32 v8, v8, v184
    v_add_f32 v8, v8, v185
    v_add_f32 v8, v8, v186
    v_add_f32 v8, v8, v187
    v_add_f32 v8, v8, v188
    v_add_f32 v8, v8, v189
    v_add_f32 v8, v8, v190
    v_add_f32 v8, v8, v191
    v_cvt_pk_bf16_f32 v236, v184, v185
    v_cvt_pk_bf16_f32 v237, v186, v187
    v_cvt_pk_bf16_f32 v238, v188, v189
    v_cvt_pk_bf16_f32 v239, v190, v191
    ds_bpermute_b32 v248, v58, v17 offset:0
    ds_bpermute_b32 v249, v58, v17 offset:4
    ds_bpermute_b32 v250, v58, v17 offset:8
    ds_bpermute_b32 v251, v58, v17 offset:12
    s_waitcnt lgkmcnt(0)
    v_accvgpr_read_b32 v18, a144
    v_mul_f32 v18, v18, v248
    v_accvgpr_write_b32 a144, v18
    v_accvgpr_read_b32 v19, a145
    v_mul_f32 v19, v19, v249
    v_accvgpr_write_b32 a145, v19
    v_accvgpr_read_b32 v18, a146
    v_mul_f32 v18, v18, v250
    v_accvgpr_write_b32 a146, v18
    v_accvgpr_read_b32 v19, a147
    v_mul_f32 v19, v19, v251
    v_accvgpr_write_b32 a147, v19
    v_accvgpr_read_b32 v18, a148
    v_mul_f32 v18, v18, v248
    v_accvgpr_write_b32 a148, v18
    v_accvgpr_read_b32 v19, a149
    v_mul_f32 v19, v19, v249
    v_accvgpr_write_b32 a149, v19
    v_accvgpr_read_b32 v18, a150
    v_mul_f32 v18, v18, v250
    v_accvgpr_write_b32 a150, v18
    v_accvgpr_read_b32 v19, a151
    v_mul_f32 v19, v19, v251
    v_accvgpr_write_b32 a151, v19
    v_accvgpr_read_b32 v18, a152
    v_mul_f32 v18, v18, v248
    v_accvgpr_write_b32 a152, v18
    v_accvgpr_read_b32 v19, a153
    v_mul_f32 v19, v19, v249
    v_accvgpr_write_b32 a153, v19
    v_accvgpr_read_b32 v18, a154
    v_mul_f32 v18, v18, v250
    v_accvgpr_write_b32 a154, v18
    v_accvgpr_read_b32 v19, a155
    v_mul_f32 v19, v19, v251
    v_accvgpr_write_b32 a155, v19
    v_accvgpr_read_b32 v18, a156
    v_mul_f32 v18, v18, v248
    v_accvgpr_write_b32 a156, v18
    v_accvgpr_read_b32 v19, a157
    v_mul_f32 v19, v19, v249
    v_accvgpr_write_b32 a157, v19
    v_accvgpr_read_b32 v18, a158
    v_mul_f32 v18, v18, v250
    v_accvgpr_write_b32 a158, v18
    v_accvgpr_read_b32 v19, a159
    v_mul_f32 v19, v19, v251
    v_accvgpr_write_b32 a159, v19
    v_accvgpr_read_b32 v18, a160
    v_mul_f32 v18, v18, v248
    v_accvgpr_write_b32 a160, v18
    v_accvgpr_read_b32 v19, a161
    v_mul_f32 v19, v19, v249
    v_accvgpr_write_b32 a161, v19
    v_accvgpr_read_b32 v18, a162
    v_mul_f32 v18, v18, v250
    v_accvgpr_write_b32 a162, v18
    v_accvgpr_read_b32 v19, a163
    v_mul_f32 v19, v19, v251
    v_accvgpr_write_b32 a163, v19
    v_accvgpr_read_b32 v18, a164
    v_mul_f32 v18, v18, v248
    v_accvgpr_write_b32 a164, v18
    v_accvgpr_read_b32 v19, a165
    v_mul_f32 v19, v19, v249
    v_accvgpr_write_b32 a165, v19
    v_accvgpr_read_b32 v18, a166
    v_mul_f32 v18, v18, v250
    v_accvgpr_write_b32 a166, v18
    v_accvgpr_read_b32 v19, a167
    v_mul_f32 v19, v19, v251
    v_accvgpr_write_b32 a167, v19
    v_accvgpr_read_b32 v18, a168
    v_mul_f32 v18, v18, v248
    v_accvgpr_write_b32 a168, v18
    v_accvgpr_read_b32 v19, a169
    v_mul_f32 v19, v19, v249
    v_accvgpr_write_b32 a169, v19
    v_accvgpr_read_b32 v18, a170
    v_mul_f32 v18, v18, v250
    v_accvgpr_write_b32 a170, v18
    v_accvgpr_read_b32 v19, a171
    v_mul_f32 v19, v19, v251
    v_accvgpr_write_b32 a171, v19
    v_accvgpr_read_b32 v18, a172
    v_mul_f32 v18, v18, v248
    v_accvgpr_write_b32 a172, v18
    v_accvgpr_read_b32 v19, a173
    v_mul_f32 v19, v19, v249
    v_accvgpr_write_b32 a173, v19
    v_accvgpr_read_b32 v18, a174
    v_mul_f32 v18, v18, v250
    v_accvgpr_write_b32 a174, v18
    v_accvgpr_read_b32 v19, a175
    v_mul_f32 v19, v19, v251
    v_accvgpr_write_b32 a175, v19
    v_accvgpr_read_b32 v18, a176
    v_mul_f32 v18, v18, v248
    v_accvgpr_write_b32 a176, v18
    v_accvgpr_read_b32 v19, a177
    v_mul_f32 v19, v19, v249
    v_accvgpr_write_b32 a177, v19
    v_accvgpr_read_b32 v18, a178
    v_mul_f32 v18, v18, v250
    v_accvgpr_write_b32 a178, v18
    v_accvgpr_read_b32 v19, a179
    v_mul_f32 v19, v19, v251
    v_accvgpr_write_b32 a179, v19
    v_accvgpr_read_b32 v18, a180
    v_mul_f32 v18, v18, v248
    v_accvgpr_write_b32 a180, v18
    v_accvgpr_read_b32 v19, a181
    v_mul_f32 v19, v19, v249
    v_accvgpr_write_b32 a181, v19
    v_accvgpr_read_b32 v18, a182
    v_mul_f32 v18, v18, v250
    v_accvgpr_write_b32 a182, v18
    v_accvgpr_read_b32 v19, a183
    v_mul_f32 v19, v19, v251
    v_accvgpr_write_b32 a183, v19
    v_accvgpr_read_b32 v18, a184
    v_mul_f32 v18, v18, v248
    v_accvgpr_write_b32 a184, v18
    v_accvgpr_read_b32 v19, a185
    v_mul_f32 v19, v19, v249
    v_accvgpr_write_b32 a185, v19
    v_accvgpr_read_b32 v18, a186
    v_mul_f32 v18, v18, v250
    v_accvgpr_write_b32 a186, v18
    v_accvgpr_read_b32 v19, a187
    v_mul_f32 v19, v19, v251
    v_accvgpr_write_b32 a187, v19
    v_accvgpr_read_b32 v18, a188
    v_mul_f32 v18, v18, v248
    v_accvgpr_write_b32 a188, v18
    v_accvgpr_read_b32 v19, a189
    v_mul_f32 v19, v19, v249
    v_accvgpr_write_b32 a189, v19
    v_accvgpr_read_b32 v18, a190
    v_mul_f32 v18, v18, v250
    v_accvgpr_write_b32 a190, v18
    v_accvgpr_read_b32 v19, a191
    v_mul_f32 v19, v19, v251
    v_accvgpr_write_b32 a191, v19
    s_waitcnt vmcnt(0)
    s_nop 1
    v_mfma_f32_16x16x32_bf16 a[0:3], v[224:227], v[112:115], a[0:3]
    v_mfma_f32_16x16x32_bf16 a[48:51], v[228:231], v[112:115], a[48:51]
    v_mfma_f32_16x16x32_bf16 a[96:99], v[232:235], v[112:115], a[96:99]
    v_mfma_f32_16x16x32_bf16 a[144:147], v[236:239], v[112:115], a[144:147]
    v_mfma_f32_16x16x32_bf16 a[4:7], v[224:227], v[116:119], a[4:7]
    v_mfma_f32_16x16x32_bf16 a[52:55], v[228:231], v[116:119], a[52:55]
    v_mfma_f32_16x16x32_bf16 a[100:103], v[232:235], v[116:119], a[100:103]
    v_mfma_f32_16x16x32_bf16 a[148:151], v[236:239], v[116:119], a[148:151]
    v_mfma_f32_16x16x32_bf16 a[8:11], v[224:227], v[120:123], a[8:11]
    v_mfma_f32_16x16x32_bf16 a[56:59], v[228:231], v[120:123], a[56:59]
    v_mfma_f32_16x16x32_bf16 a[104:107], v[232:235], v[120:123], a[104:107]
    v_mfma_f32_16x16x32_bf16 a[152:155], v[236:239], v[120:123], a[152:155]
    v_mfma_f32_16x16x32_bf16 a[12:15], v[224:227], v[124:127], a[12:15]
    v_mfma_f32_16x16x32_bf16 a[60:63], v[228:231], v[124:127], a[60:63]
    v_mfma_f32_16x16x32_bf16 a[108:111], v[232:235], v[124:127], a[108:111]
    v_mfma_f32_16x16x32_bf16 a[156:159], v[236:239], v[124:127], a[156:159]
    v_mfma_f32_16x16x32_bf16 a[16:19], v[224:227], v[128:131], a[16:19]
    v_mfma_f32_16x16x32_bf16 a[64:67], v[228:231], v[128:131], a[64:67]
    v_mfma_f32_16x16x32_bf16 a[112:115], v[232:235], v[128:131], a[112:115]
    v_mfma_f32_16x16x32_bf16 a[160:163], v[236:239], v[128:131], a[160:163]
    v_mfma_f32_16x16x32_bf16 a[20:23], v[224:227], v[132:135], a[20:23]
    v_mfma_f32_16x16x32_bf16 a[68:71], v[228:231], v[132:135], a[68:71]
    v_mfma_f32_16x16x32_bf16 a[116:119], v[232:235], v[132:135], a[116:119]
    v_mfma_f32_16x16x32_bf16 a[164:167], v[236:239], v[132:135], a[164:167]
    v_mfma_f32_16x16x32_bf16 a[24:27], v[224:227], v[136:139], a[24:27]
    v_mfma_f32_16x16x32_bf16 a[72:75], v[228:231], v[136:139], a[72:75]
    v_mfma_f32_16x16x32_bf16 a[120:123], v[232:235], v[136:139], a[120:123]
    v_mfma_f32_16x16x32_bf16 a[168:171], v[236:239], v[136:139], a[168:171]
    v_mfma_f32_16x16x32_bf16 a[28:31], v[224:227], v[140:143], a[28:31]
    v_mfma_f32_16x16x32_bf16 a[76:79], v[228:231], v[140:143], a[76:79]
    v_mfma_f32_16x16x32_bf16 a[124:127], v[232:235], v[140:143], a[124:127]
    v_mfma_f32_16x16x32_bf16 a[172:175], v[236:239], v[140:143], a[172:175]
    v_mfma_f32_16x16x32_bf16 a[32:35], v[224:227], v[144:147], a[32:35]
    v_mfma_f32_16x16x32_bf16 a[80:83], v[228:231], v[144:147], a[80:83]
    v_mfma_f32_16x16x32_bf16 a[128:131], v[232:235], v[144:147], a[128:131]
    v_mfma_f32_16x16x32_bf16 a[176:179], v[236:239], v[144:147], a[176:179]
    v_mfma_f32_16x16x32_bf16 a[36:39], v[224:227], v[148:151], a[36:39]
    v_mfma_f32_16x16x32_bf16 a[84:87], v[228:231], v[148:151], a[84:87]
    v_mfma_f32_16x16x32_bf16 a[132:135], v[232:235], v[148:151], a[132:135]
    v_mfma_f32_16x16x32_bf16 a[180:183], v[236:239], v[148:151], a[180:183]
    v_mfma_f32_16x16x32_bf16 a[40:43], v[224:227], v[152:155], a[40:43]
    v_mfma_f32_16x16x32_bf16 a[88:91], v[228:231], v[152:155], a[88:91]
    v_mfma_f32_16x16x32_bf16 a[136:139], v[232:235], v[152:155], a[136:139]
    v_mfma_f32_16x16x32_bf16 a[184:187], v[236:239], v[152:155], a[184:187]
    v_mfma_f32_16x16x32_bf16 a[44:47], v[224:227], v[156:159], a[44:47]
    v_mfma_f32_16x16x32_bf16 a[92:95], v[228:231], v[156:159], a[92:95]
    v_mfma_f32_16x16x32_bf16 a[140:143], v[232:235], v[156:159], a[140:143]
    v_mfma_f32_16x16x32_bf16 a[188:191], v[236:239], v[156:159], a[188:191]
    s_add_u32 s48, s48, 24576
    s_cmp_lt_u32 s48, 1572864
    s_nop 7
    s_cbranch_scc1 L_slowloop
    s_nop 1
    v_mfma_f32_16x16x4_f32 v[48:51], v5, v57, 0
    v_mfma_f32_16x16x4_f32 v[52:55], v6, v57, 0
    s_nop 7
    s_nop 1
    v_rcp_f32 v48, v48
    v_rcp_f32 v49, v49
    v_rcp_f32 v50, v50
    v_rcp_f32 v51, v51
    v_rcp_f32 v52, v52
    v_rcp_f32 v53, v53
    v_rcp_f32 v54, v54
    v_rcp_f32 v55, v55
    v_mfma_f32_16x16x4_f32 v[128:131], v7, v57, 0
    v_mfma_f32_16x16x4_f32 v[132:135], v8, v57, 0
    s_nop 7
    s_nop 1
    v_rcp_f32 v128, v128
    v_rcp_f32 v129, v129
    v_rcp_f32 v130, v130
    v_rcp_f32 v131, v131
    v_rcp_f32 v132, v132
    v_rcp_f32 v133, v133
    v_rcp_f32 v134, v134
    v_rcp_f32 v135, v135
    s_nop 0
    v_accvgpr_read_b32 v64, a0
    v_accvgpr_read_b32 v65, a4
    v_accvgpr_read_b32 v66, a8
    v_accvgpr_read_b32 v67, a12
    v_accvgpr_read_b32 v68, a16
    v_accvgpr_read_b32 v69, a20
    v_pk_mul_f32 v[64:65], v[64:65], v[48:49] op_sel_hi:[1,0]
    v_pk_mul_f32 v[66:67], v[66:67], v[48:49] op_sel_hi:[1,0]
    v_pk_mul_f32 v[68:69], v[68:69], v[48:49] op_sel_hi:[1,0]
    v_cvt_pk_bf16_f32 v64, v64, v65
    v_cvt_pk_bf16_f32 v65, v66, v67
    v_cvt_pk_bf16_f32 v66, v68, v69
    v_accvgpr_read_b32 v70, a1
    v_accvgpr_read_b32 v71, a5
    v_accvgpr_read_b32 v72, a9
    v_accvgpr_read_b32 v73, a13
    v_accvgpr_read_b32 v74, a17
    v_accvgpr_read_b32 v75, a21
    v_pk_mul_f32 v[70:71], v[70:71], v[48:49] op_sel:[0,1] op_sel_hi:[1,1]
    v_pk_mul_f32 v[72:73], v[72:73], v[48:49] op_sel:[0,1] op_sel_hi:[1,1]
    v_pk_mul_f32 v[74:75], v[74:75], v[48:49] op_sel:[0,1] op_sel_hi:[1,1]
    v_cvt_pk_bf16_f32 v70, v70, v71
    v_cvt_pk_bf16_f32 v71, v72, v73
    v_cvt_pk_bf16_f32 v72, v74, v75
    buffer_store_dwordx3 v[64:66], v56, s[12:15], s24 offen offset:0 sc0 sc1
    v_accvgpr_read_b32 v76, a2
    v_accvgpr_read_b32 v77, a6
    v_accvgpr_read_b32 v78, a10
    v_accvgpr_read_b32 v79, a14
    v_accvgpr_read_b32 v80, a18
    v_accvgpr_read_b32 v81, a22
    v_pk_mul_f32 v[76:77], v[76:77], v[50:51] op_sel_hi:[1,0]
    v_pk_mul_f32 v[78:79], v[78:79], v[50:51] op_sel_hi:[1,0]
    v_pk_mul_f32 v[80:81], v[80:81], v[50:51] op_sel_hi:[1,0]
    v_cvt_pk_bf16_f32 v76, v76, v77
    v_cvt_pk_bf16_f32 v77, v78, v79
    v_cvt_pk_bf16_f32 v78, v80, v81
    buffer_store_dwordx3 v[70:72], v56, s[12:15], s24 offen offset:384 sc0 sc1
    v_accvgpr_read_b32 v82, a3
    v_accvgpr_read_b32 v83, a7
    v_accvgpr_read_b32 v84, a11
    v_accvgpr_read_b32 v85, a15
    v_accvgpr_read_b32 v86, a19
    v_accvgpr_read_b32 v87, a23
    v_pk_mul_f32 v[82:83], v[82:83], v[50:51] op_sel:[0,1] op_sel_hi:[1,1]
    v_pk_mul_f32 v[84:85], v[84:85], v[50:51] op_sel:[0,1] op_sel_hi:[1,1]
    v_pk_mul_f32 v[86:87], v[86:87], v[50:51] op_sel:[0,1] op_sel_hi:[1,1]
    v_cvt_pk_bf16_f32 v82, v82, v83
    v_cvt_pk_bf16_f32 v83, v84, v85
    v_cvt_pk_bf16_f32 v84, v86, v87
    buffer_store_dwordx3 v[76:78], v56, s[12:15], s24 offen offset:768 sc0 sc1
    v_accvgpr_read_b32 v88, a24
    v_accvgpr_read_b32 v89, a28
    v_accvgpr_read_b32 v90, a32
    v_accvgpr_read_b32 v91, a36
    v_accvgpr_read_b32 v92, a40
    v_accvgpr_read_b32 v93, a44
    v_pk_mul_f32 v[88:89], v[88:89], v[48:49] op_sel_hi:[1,0]
    v_pk_mul_f32 v[90:91], v[90:91], v[48:49] op_sel_hi:[1,0]
    v_pk_mul_f32 v[92:93], v[92:93], v[48:49] op_sel_hi:[1,0]
    v_cvt_pk_bf16_f32 v88, v88, v89
    v_cvt_pk_bf16_f32 v89, v90, v91
    v_cvt_pk_bf16_f32 v90, v92, v93
    buffer_store_dwordx3 v[82:84], v56, s[12:15], s24 offen offset:1152 sc0 sc1
    v_accvgpr_read_b32 v94, a25
    v_accvgpr_read_b32 v95, a29
    v_accvgpr_read_b32 v96, a33
    v_accvgpr_read_b32 v97, a37
    v_accvgpr_read_b32 v98, a41
    v_accvgpr_read_b32 v99, a45
    v_pk_mul_f32 v[94:95], v[94:95], v[48:49] op_sel:[0,1] op_sel_hi:[1,1]
    v_pk_mul_f32 v[96:97], v[96:97], v[48:49] op_sel:[0,1] op_sel_hi:[1,1]
    v_pk_mul_f32 v[98:99], v[98:99], v[48:49] op_sel:[0,1] op_sel_hi:[1,1]
    v_cvt_pk_bf16_f32 v94, v94, v95
    v_cvt_pk_bf16_f32 v95, v96, v97
    v_cvt_pk_bf16_f32 v96, v98, v99
    buffer_store_dwordx3 v[88:90], v56, s[12:15], s24 offen offset:192 sc0 sc1
    v_accvgpr_read_b32 v100, a26
    v_accvgpr_read_b32 v101, a30
    v_accvgpr_read_b32 v102, a34
    v_accvgpr_read_b32 v103, a38
    v_accvgpr_read_b32 v104, a42
    v_accvgpr_read_b32 v105, a46
    v_pk_mul_f32 v[100:101], v[100:101], v[50:51] op_sel_hi:[1,0]
    v_pk_mul_f32 v[102:103], v[102:103], v[50:51] op_sel_hi:[1,0]
    v_pk_mul_f32 v[104:105], v[104:105], v[50:51] op_sel_hi:[1,0]
    v_cvt_pk_bf16_f32 v100, v100, v101
    v_cvt_pk_bf16_f32 v101, v102, v103
    v_cvt_pk_bf16_f32 v102, v104, v105
    buffer_store_dwordx3 v[94:96], v56, s[12:15], s24 offen offset:576 sc0 sc1
    v_accvgpr_read_b32 v106, a27
    v_accvgpr_read_b32 v107, a31
    v_accvgpr_read_b32 v108, a35
    v_accvgpr_read_b32 v109, a39
    v_accvgpr_read_b32 v110, a43
    v_accvgpr_read_b32 v111, a47
    v_pk_mul_f32 v[106:107], v[106:107], v[50:51] op_sel:[0,1] op_sel_hi:[1,1]
    v_pk_mul_f32 v[108:109], v[108:109], v[50:51] op_sel:[0,1] op_sel_hi:[1,1]
    v_pk_mul_f32 v[110:111], v[110:111], v[50:51] op_sel:[0,1] op_sel_hi:[1,1]
    v_cvt_pk_bf16_f32 v106, v106, v107
    v_cvt_pk_bf16_f32 v107, v108, v109
    v_cvt_pk_bf16_f32 v108, v110, v111
    buffer_store_dwordx3 v[100:102], v56, s[12:15], s24 offen offset:960 sc0 sc1
    v_accvgpr_read_b32 v64, a48
    v_accvgpr_read_b32 v65, a52
    v_accvgpr_read_b32 v66, a56
    v_accvgpr_read_b32 v67, a60
    v_accvgpr_read_b32 v68, a64
    v_accvgpr_read_b32 v69, a68
    v_pk_mul_f32 v[64:65], v[64:65], v[52:53] op_sel_hi:[1,0]
    v_pk_mul_f32 v[66:67], v[66:67], v[52:53] op_sel_hi:[1,0]
    v_pk_mul_f32 v[68:69], v[68:69], v[52:53] op_sel_hi:[1,0]
    v_cvt_pk_bf16_f32 v64, v64, v65
    v_cvt_pk_bf16_f32 v65, v66, v67
    v_cvt_pk_bf16_f32 v66, v68, v69
    buffer_store_dwordx3 v[106:108], v56, s[12:15], s24 offen offset:1344 sc0 sc1
    v_accvgpr_read_b32 v70, a49
    v_accvgpr_read_b32 v71, a53
    v_accvgpr_read_b32 v72, a57
    v_accvgpr_read_b32 v73, a61
    v_accvgpr_read_b32 v74, a65
    v_accvgpr_read_b32 v75, a69
    v_pk_mul_f32 v[70:71], v[70:71], v[52:53] op_sel:[0,1] op_sel_hi:[1,1]
    v_pk_mul_f32 v[72:73], v[72:73], v[52:53] op_sel:[0,1] op_sel_hi:[1,1]
    v_pk_mul_f32 v[74:75], v[74:75], v[52:53] op_sel:[0,1] op_sel_hi:[1,1]
    v_cvt_pk_bf16_f32 v70, v70, v71
    v_cvt_pk_bf16_f32 v71, v72, v73
    v_cvt_pk_bf16_f32 v72, v74, v75
    buffer_store_dwordx3 v[64:66], v56, s[12:15], s40 offen offset:0 sc0 sc1
    v_accvgpr_read_b32 v76, a50
    v_accvgpr_read_b32 v77, a54
    v_accvgpr_read_b32 v78, a58
    v_accvgpr_read_b32 v79, a62
    v_accvgpr_read_b32 v80, a66
    v_accvgpr_read_b32 v81, a70
    v_pk_mul_f32 v[76:77], v[76:77], v[54:55] op_sel_hi:[1,0]
    v_pk_mul_f32 v[78:79], v[78:79], v[54:55] op_sel_hi:[1,0]
    v_pk_mul_f32 v[80:81], v[80:81], v[54:55] op_sel_hi:[1,0]
    v_cvt_pk_bf16_f32 v76, v76, v77
    v_cvt_pk_bf16_f32 v77, v78, v79
    v_cvt_pk_bf16_f32 v78, v80, v81
    buffer_store_dwordx3 v[70:72], v56, s[12:15], s40 offen offset:384 sc0 sc1
    v_accvgpr_read_b32 v82, a51
    v_accvgpr_read_b32 v83, a55
    v_accvgpr_read_b32 v84, a59
    v_accvgpr_read_b32 v85, a63
    v_accvgpr_read_b32 v86, a67
    v_accvgpr_read_b32 v87, a71
    v_pk_mul_f32 v[82:83], v[82:83], v[54:55] op_sel:[0,1] op_sel_hi:[1,1]
    v_pk_mul_f32 v[84:85], v[84:85], v[54:55] op_sel:[0,1] op_sel_hi:[1,1]
    v_pk_mul_f32 v[86:87], v[86:87], v[54:55] op_sel:[0,1] op_sel_hi:[1,1]
    v_cvt_pk_bf16_f32 v82, v82, v83
    v_cvt_pk_bf16_f32 v83, v84, v85
    v_cvt_pk_bf16_f32 v84, v86, v87
    buffer_store_dwordx3 v[76:78], v56, s[12:15], s40 offen offset:768 sc0 sc1
    v_accvgpr_read_b32 v88, a72
    v_accvgpr_read_b32 v89, a76
    v_accvgpr_read_b32 v90, a80
    v_accvgpr_read_b32 v91, a84
    v_accvgpr_read_b32 v92, a88
    v_accvgpr_read_b32 v93, a92
    v_pk_mul_f32 v[88:89], v[88:89], v[52:53] op_sel_hi:[1,0]
    v_pk_mul_f32 v[90:91], v[90:91], v[52:53] op_sel_hi:[1,0]
    v_pk_mul_f32 v[92:93], v[92:93], v[52:53] op_sel_hi:[1,0]
    v_cvt_pk_bf16_f32 v88, v88, v89
    v_cvt_pk_bf16_f32 v89, v90, v91
    v_cvt_pk_bf16_f32 v90, v92, v93
    buffer_store_dwordx3 v[82:84], v56, s[12:15], s40 offen offset:1152 sc0 sc1
    v_accvgpr_read_b32 v94, a73
    v_accvgpr_read_b32 v95, a77
    v_accvgpr_read_b32 v96, a81
    v_accvgpr_read_b32 v97, a85
    v_accvgpr_read_b32 v98, a89
    v_accvgpr_read_b32 v99, a93
    v_pk_mul_f32 v[94:95], v[94:95], v[52:53] op_sel:[0,1] op_sel_hi:[1,1]
    v_pk_mul_f32 v[96:97], v[96:97], v[52:53] op_sel:[0,1] op_sel_hi:[1,1]
    v_pk_mul_f32 v[98:99], v[98:99], v[52:53] op_sel:[0,1] op_sel_hi:[1,1]
    v_cvt_pk_bf16_f32 v94, v94, v95
    v_cvt_pk_bf16_f32 v95, v96, v97
    v_cvt_pk_bf16_f32 v96, v98, v99
    buffer_store_dwordx3 v[88:90], v56, s[12:15], s40 offen offset:192 sc0 sc1
    v_accvgpr_read_b32 v100, a74
    v_accvgpr_read_b32 v101, a78
    v_accvgpr_read_b32 v102, a82
    v_accvgpr_read_b32 v103, a86
    v_accvgpr_read_b32 v104, a90
    v_accvgpr_read_b32 v105, a94
    v_pk_mul_f32 v[100:101], v[100:101], v[54:55] op_sel_hi:[1,0]
    v_pk_mul_f32 v[102:103], v[102:103], v[54:55] op_sel_hi:[1,0]
    v_pk_mul_f32 v[104:105], v[104:105], v[54:55] op_sel_hi:[1,0]
    v_cvt_pk_bf16_f32 v100, v100, v101
    v_cvt_pk_bf16_f32 v101, v102, v103
    v_cvt_pk_bf16_f32 v102, v104, v105
    buffer_store_dwordx3 v[94:96], v56, s[12:15], s40 offen offset:576 sc0 sc1
    v_accvgpr_read_b32 v106, a75
    v_accvgpr_read_b32 v107, a79
    v_accvgpr_read_b32 v108, a83
    v_accvgpr_read_b32 v109, a87
    v_accvgpr_read_b32 v110, a91
    v_accvgpr_read_b32 v111, a95
    v_pk_mul_f32 v[106:107], v[106:107], v[54:55] op_sel:[0,1] op_sel_hi:[1,1]
    v_pk_mul_f32 v[108:109], v[108:109], v[54:55] op_sel:[0,1] op_sel_hi:[1,1]
    v_pk_mul_f32 v[110:111], v[110:111], v[54:55] op_sel:[0,1] op_sel_hi:[1,1]
    v_cvt_pk_bf16_f32 v106, v106, v107
    v_cvt_pk_bf16_f32 v107, v108, v109
    v_cvt_pk_bf16_f32 v108, v110, v111
    buffer_store_dwordx3 v[100:102], v56, s[12:15], s40 offen offset:960 sc0 sc1
    v_accvgpr_read_b32 v64, a96
    v_accvgpr_read_b32 v65, a100
    v_accvgpr_read_b32 v66, a104
    v_accvgpr_read_b32 v67, a108
    v_accvgpr_read_b32 v68, a112
    v_accvgpr_read_b32 v69, a116
    v_pk_mul_f32 v[64:65], v[64:65], v[128:129] op_sel_hi:[1,0]
    v_pk_mul_f32 v[66:67], v[66:67], v[128:129] op_sel_hi:[1,0]
    v_pk_mul_f32 v[68:69], v[68:69], v[128:129] op_sel_hi:[1,0]
    v_cvt_pk_bf16_f32 v64, v64, v65
    v_cvt_pk_bf16_f32 v65, v66, v67
    v_cvt_pk_bf16_f32 v66, v68, v69
    buffer_store_dwordx3 v[106:108], v56, s[12:15], s40 offen offset:1344 sc0 sc1
    v_accvgpr_read_b32 v70, a97
    v_accvgpr_read_b32 v71, a101
    v_accvgpr_read_b32 v72, a105
    v_accvgpr_read_b32 v73, a109
    v_accvgpr_read_b32 v74, a113
    v_accvgpr_read_b32 v75, a117
    v_pk_mul_f32 v[70:71], v[70:71], v[128:129] op_sel:[0,1] op_sel_hi:[1,1]
    v_pk_mul_f32 v[72:73], v[72:73], v[128:129] op_sel:[0,1] op_sel_hi:[1,1]
    v_pk_mul_f32 v[74:75], v[74:75], v[128:129] op_sel:[0,1] op_sel_hi:[1,1]
    v_cvt_pk_bf16_f32 v70, v70, v71
    v_cvt_pk_bf16_f32 v71, v72, v73
    v_cvt_pk_bf16_f32 v72, v74, v75
    buffer_store_dwordx3 v[64:66], v56, s[12:15], s41 offen offset:0 sc0 sc1
    v_accvgpr_read_b32 v76, a98
    v_accvgpr_read_b32 v77, a102
    v_accvgpr_read_b32 v78, a106
    v_accvgpr_read_b32 v79, a110
    v_accvgpr_read_b32 v80, a114
    v_accvgpr_read_b32 v81, a118
    v_pk_mul_f32 v[76:77], v[76:77], v[130:131] op_sel_hi:[1,0]
    v_pk_mul_f32 v[78:79], v[78:79], v[130:131] op_sel_hi:[1,0]
    v_pk_mul_f32 v[80:81], v[80:81], v[130:131] op_sel_hi:[1,0]
    v_cvt_pk_bf16_f32 v76, v76, v77
    v_cvt_pk_bf16_f32 v77, v78, v79
    v_cvt_pk_bf16_f32 v78, v80, v81
    buffer_store_dwordx3 v[70:72], v56, s[12:15], s41 offen offset:384 sc0 sc1
    v_accvgpr_read_b32 v82, a99
    v_accvgpr_read_b32 v83, a103
    v_accvgpr_read_b32 v84, a107
    v_accvgpr_read_b32 v85, a111
    v_accvgpr_read_b32 v86, a115
    v_accvgpr_read_b32 v87, a119
    v_pk_mul_f32 v[82:83], v[82:83], v[130:131] op_sel:[0,1] op_sel_hi:[1,1]
    v_pk_mul_f32 v[84:85], v[84:85], v[130:131] op_sel:[0,1] op_sel_hi:[1,1]
    v_pk_mul_f32 v[86:87], v[86:87], v[130:131] op_sel:[0,1] op_sel_hi:[1,1]
    v_cvt_pk_bf16_f32 v82, v82, v83
    v_cvt_pk_bf16_f32 v83, v84, v85
    v_cvt_pk_bf16_f32 v84, v86, v87
    buffer_store_dwordx3 v[76:78], v56, s[12:15], s41 offen offset:768 sc0 sc1
    v_accvgpr_read_b32 v88, a120
    v_accvgpr_read_b32 v89, a124
    v_accvgpr_read_b32 v90, a128
    v_accvgpr_read_b32 v91, a132
    v_accvgpr_read_b32 v92, a136
    v_accvgpr_read_b32 v93, a140
    v_pk_mul_f32 v[88:89], v[88:89], v[128:129] op_sel_hi:[1,0]
    v_pk_mul_f32 v[90:91], v[90:91], v[128:129] op_sel_hi:[1,0]
    v_pk_mul_f32 v[92:93], v[92:93], v[128:129] op_sel_hi:[1,0]
    v_cvt_pk_bf16_f32 v88, v88, v89
    v_cvt_pk_bf16_f32 v89, v90, v91
    v_cvt_pk_bf16_f32 v90, v92, v93
    buffer_store_dwordx3 v[82:84], v56, s[12:15], s41 offen offset:1152 sc0 sc1
    v_accvgpr_read_b32 v94, a121
    v_accvgpr_read_b32 v95, a125
    v_accvgpr_read_b32 v96, a129
    v_accvgpr_read_b32 v97, a133
    v_accvgpr_read_b32 v98, a137
    v_accvgpr_read_b32 v99, a141
    v_pk_mul_f32 v[94:95], v[94:95], v[128:129] op_sel:[0,1] op_sel_hi:[1,1]
    v_pk_mul_f32 v[96:97], v[96:97], v[128:129] op_sel:[0,1] op_sel_hi:[1,1]
    v_pk_mul_f32 v[98:99], v[98:99], v[128:129] op_sel:[0,1] op_sel_hi:[1,1]
    v_cvt_pk_bf16_f32 v94, v94, v95
    v_cvt_pk_bf16_f32 v95, v96, v97
    v_cvt_pk_bf16_f32 v96, v98, v99
    buffer_store_dwordx3 v[88:90], v56, s[12:15], s41 offen offset:192 sc0 sc1
    v_accvgpr_read_b32 v100, a122
    v_accvgpr_read_b32 v101, a126
    v_accvgpr_read_b32 v102, a130
    v_accvgpr_read_b32 v103, a134
    v_accvgpr_read_b32 v104, a138
    v_accvgpr_read_b32 v105, a142
    v_pk_mul_f32 v[100:101], v[100:101], v[130:131] op_sel_hi:[1,0]
    v_pk_mul_f32 v[102:103], v[102:103], v[130:131] op_sel_hi:[1,0]
    v_pk_mul_f32 v[104:105], v[104:105], v[130:131] op_sel_hi:[1,0]
    v_cvt_pk_bf16_f32 v100, v100, v101
    v_cvt_pk_bf16_f32 v101, v102, v103
    v_cvt_pk_bf16_f32 v102, v104, v105
    buffer_store_dwordx3 v[94:96], v56, s[12:15], s41 offen offset:576 sc0 sc1
    v_accvgpr_read_b32 v106, a123
    v_accvgpr_read_b32 v107, a127
    v_accvgpr_read_b32 v108, a131
    v_accvgpr_read_b32 v109, a135
    v_accvgpr_read_b32 v110, a139
    v_accvgpr_read_b32 v111, a143
    v_pk_mul_f32 v[106:107], v[106:107], v[130:131] op_sel:[0,1] op_sel_hi:[1,1]
    v_pk_mul_f32 v[108:109], v[108:109], v[130:131] op_sel:[0,1] op_sel_hi:[1,1]
    v_pk_mul_f32 v[110:111], v[110:111], v[130:131] op_sel:[0,1] op_sel_hi:[1,1]
    v_cvt_pk_bf16_f32 v106, v106, v107
    v_cvt_pk_bf16_f32 v107, v108, v109
    v_cvt_pk_bf16_f32 v108, v110, v111
    buffer_store_dwordx3 v[100:102], v56, s[12:15], s41 offen offset:960 sc0 sc1
    v_accvgpr_read_b32 v64, a144
    v_accvgpr_read_b32 v65, a148
    v_accvgpr_read_b32 v66, a152
    v_accvgpr_read_b32 v67, a156
    v_accvgpr_read_b32 v68, a160
    v_accvgpr_read_b32 v69, a164
    v_pk_mul_f32 v[64:65], v[64:65], v[132:133] op_sel_hi:[1,0]
    v_pk_mul_f32 v[66:67], v[66:67], v[132:133] op_sel_hi:[1,0]
    v_pk_mul_f32 v[68:69], v[68:69], v[132:133] op_sel_hi:[1,0]
    v_cvt_pk_bf16_f32 v64, v64, v65
    v_cvt_pk_bf16_f32 v65, v66, v67
    v_cvt_pk_bf16_f32 v66, v68, v69
    buffer_store_dwordx3 v[106:108], v56, s[12:15], s41 offen offset:1344 sc0 sc1
    v_accvgpr_read_b32 v70, a145
    v_accvgpr_read_b32 v71, a149
    v_accvgpr_read_b32 v72, a153
    v_accvgpr_read_b32 v73, a157
    v_accvgpr_read_b32 v74, a161
    v_accvgpr_read_b32 v75, a165
    v_pk_mul_f32 v[70:71], v[70:71], v[132:133] op_sel:[0,1] op_sel_hi:[1,1]
    v_pk_mul_f32 v[72:73], v[72:73], v[132:133] op_sel:[0,1] op_sel_hi:[1,1]
    v_pk_mul_f32 v[74:75], v[74:75], v[132:133] op_sel:[0,1] op_sel_hi:[1,1]
    v_cvt_pk_bf16_f32 v70, v70, v71
    v_cvt_pk_bf16_f32 v71, v72, v73
    v_cvt_pk_bf16_f32 v72, v74, v75
    buffer_store_dwordx3 v[64:66], v56, s[12:15], s42 offen offset:0 sc0 sc1
    v_accvgpr_read_b32 v76, a146
    v_accvgpr_read_b32 v77, a150
    v_accvgpr_read_b32 v78, a154
    v_accvgpr_read_b32 v79, a158
    v_accvgpr_read_b32 v80, a162
    v_accvgpr_read_b32 v81, a166
    v_pk_mul_f32 v[76:77], v[76:77], v[134:135] op_sel_hi:[1,0]
    v_pk_mul_f32 v[78:79], v[78:79], v[134:135] op_sel_hi:[1,0]
    v_pk_mul_f32 v[80:81], v[80:81], v[134:135] op_sel_hi:[1,0]
    v_cvt_pk_bf16_f32 v76, v76, v77
    v_cvt_pk_bf16_f32 v77, v78, v79
    v_cvt_pk_bf16_f32 v78, v80, v81
    buffer_store_dwordx3 v[70:72], v56, s[12:15], s42 offen offset:384 sc0 sc1
    v_accvgpr_read_b32 v82, a147
    v_accvgpr_read_b32 v83, a151
    v_accvgpr_read_b32 v84, a155
    v_accvgpr_read_b32 v85, a159
    v_accvgpr_read_b32 v86, a163
    v_accvgpr_read_b32 v87, a167
    v_pk_mul_f32 v[82:83], v[82:83], v[134:135] op_sel:[0,1] op_sel_hi:[1,1]
    v_pk_mul_f32 v[84:85], v[84:85], v[134:135] op_sel:[0,1] op_sel_hi:[1,1]
    v_pk_mul_f32 v[86:87], v[86:87], v[134:135] op_sel:[0,1] op_sel_hi:[1,1]
    v_cvt_pk_bf16_f32 v82, v82, v83
    v_cvt_pk_bf16_f32 v83, v84, v85
    v_cvt_pk_bf16_f32 v84, v86, v87
    buffer_store_dwordx3 v[76:78], v56, s[12:15], s42 offen offset:768 sc0 sc1
    v_accvgpr_read_b32 v88, a168
    v_accvgpr_read_b32 v89, a172
    v_accvgpr_read_b32 v90, a176
    v_accvgpr_read_b32 v91, a180
    v_accvgpr_read_b32 v92, a184
    v_accvgpr_read_b32 v93, a188
    v_pk_mul_f32 v[88:89], v[88:89], v[132:133] op_sel_hi:[1,0]
    v_pk_mul_f32 v[90:91], v[90:91], v[132:133] op_sel_hi:[1,0]
    v_pk_mul_f32 v[92:93], v[92:93], v[132:133] op_sel_hi:[1,0]
    v_cvt_pk_bf16_f32 v88, v88, v89
    v_cvt_pk_bf16_f32 v89, v90, v91
    v_cvt_pk_bf16_f32 v90, v92, v93
    buffer_store_dwordx3 v[82:84], v56, s[12:15], s42 offen offset:1152 sc0 sc1
    v_accvgpr_read_b32 v94, a169
    v_accvgpr_read_b32 v95, a173
    v_accvgpr_read_b32 v96, a177
    v_accvgpr_read_b32 v97, a181
    v_accvgpr_read_b32 v98, a185
    v_accvgpr_read_b32 v99, a189
    v_pk_mul_f32 v[94:95], v[94:95], v[132:133] op_sel:[0,1] op_sel_hi:[1,1]
    v_pk_mul_f32 v[96:97], v[96:97], v[132:133] op_sel:[0,1] op_sel_hi:[1,1]
    v_pk_mul_f32 v[98:99], v[98:99], v[132:133] op_sel:[0,1] op_sel_hi:[1,1]
    v_cvt_pk_bf16_f32 v94, v94, v95
    v_cvt_pk_bf16_f32 v95, v96, v97
    v_cvt_pk_bf16_f32 v96, v98, v99
    buffer_store_dwordx3 v[88:90], v56, s[12:15], s42 offen offset:192 sc0 sc1
    v_accvgpr_read_b32 v100, a170
    v_accvgpr_read_b32 v101, a174
    v_accvgpr_read_b32 v102, a178
    v_accvgpr_read_b32 v103, a182
    v_accvgpr_read_b32 v104, a186
    v_accvgpr_read_b32 v105, a190
    v_pk_mul_f32 v[100:101], v[100:101], v[134:135] op_sel_hi:[1,0]
    v_pk_mul_f32 v[102:103], v[102:103], v[134:135] op_sel_hi:[1,0]
    v_pk_mul_f32 v[104:105], v[104:105], v[134:135] op_sel_hi:[1,0]
    v_cvt_pk_bf16_f32 v100, v100, v101
    v_cvt_pk_bf16_f32 v101, v102, v103
    v_cvt_pk_bf16_f32 v102, v104, v105
    buffer_store_dwordx3 v[94:96], v56, s[12:15], s42 offen offset:576 sc0 sc1
    v_accvgpr_read_b32 v106, a171
    v_accvgpr_read_b32 v107, a175
    v_accvgpr_read_b32 v108, a179
    v_accvgpr_read_b32 v109, a183
    v_accvgpr_read_b32 v110, a187
    v_accvgpr_read_b32 v111, a191
    v_pk_mul_f32 v[106:107], v[106:107], v[134:135] op_sel:[0,1] op_sel_hi:[1,1]
    v_pk_mul_f32 v[108:109], v[108:109], v[134:135] op_sel:[0,1] op_sel_hi:[1,1]
    v_pk_mul_f32 v[110:111], v[110:111], v[134:135] op_sel:[0,1] op_sel_hi:[1,1]
    v_cvt_pk_bf16_f32 v106, v106, v107
    v_cvt_pk_bf16_f32 v107, v108, v109
    v_cvt_pk_bf16_f32 v108, v110, v111
    buffer_store_dwordx3 v[100:102], v56, s[12:15], s42 offen offset:960 sc0 sc1
    buffer_store_dwordx3 v[106:108], v56, s[12:15], s42 offen offset:1344 sc0 sc1
    s_branch L_fin
.section .rodata,"a"
.p2align 6
.amdhsa_kernel standalone__kv_cache_quant_int4_int2_kv_with_per_channel_or_per_token_scales__prompt_kernel
  .amdhsa_next_free_vgpr 512
  .amdhsa_next_free_sgpr 102
  .amdhsa_accum_offset 256
  .amdhsa_group_segment_fixed_size 0
  .amdhsa_kernarg_size 80
  .amdhsa_user_sgpr_count 2
  .amdhsa_user_sgpr_kernarg_segment_ptr 1
  .amdhsa_system_sgpr_workgroup_id_x 1
.end_amdhsa_kernel
```

```asm
; @launch grid=(256,1,1) block=(256,1,1) lds=147584
.amdgcn_target "amdgcn-amd-amdhsa--gfx950"
.text
.globl standalone__kv_cache_quant_int4_int2_kv_with_per_channel_or_per_token_scales__prompt_kernel
.p2align 8
.type standalone__kv_cache_quant_int4_int2_kv_with_per_channel_or_per_token_scales__prompt_kernel,@function
standalone__kv_cache_quant_int4_int2_kv_with_per_channel_or_per_token_scales__prompt_kernel:
    s_cmp_ge_u32 s2, 256
    s_cbranch_scc1 L_done
    s_load_dwordx16 s[40:55], s[0:1], 0
    s_load_dwordx4 s[16:19], s[0:1], 64
    s_and_b32 s94, s2, 7
    s_lshr_b32 s95, s2, 3
    s_lshr_b32 s24, s95, 3
    s_lshl_b32 s94, s94, 2
    s_add_u32 s94, s94, s24
    s_and_b32 s95, s95, 7
    s_getpc_b64 s[60:61]
L_pc:
    s_sub_u32 s60, s60, L_pc-standalone__kv_cache_quant_int4_int2_kv_with_per_channel_or_per_token_scales__prompt_kernel
    s_subb_u32 s61, s61, 0
    s_mov_b32 s62, L_slow-standalone__kv_cache_quant_int4_int2_kv_with_per_channel_or_per_token_scales__prompt_kernel
    s_mov_b32 s63, 0x20000
    s_lshr_b32 s22, s2, 3
    s_lshl_b32 s22, s22, 12
    v_lshlrev_b32 v30, 4, v0
    buffer_load_dwordx4 v[128:131], v30, s[60:63], s22 offen
    v_lshrrev_b32 v24, 6, v0
    v_and_b32 v25, 63, v0
    v_readfirstlane_b32 s25, v24
    v_lshlrev_b32 v1, 4, v25
    v_mul_u32_u24 v26, 43, v25
    v_lshrrev_b32 v26, 10, v26
    v_mul_u32_u24 v27, 24, v26
    v_sub_u32 v27, v25, v27
    v_lshrrev_b32 v28, 1, v24
    v_and_b32 v29, 1, v24
    v_lshlrev_b32 v30, 4, v29
    v_lshl_add_u32 v30, v28, 2, v30
    v_add_u32 v30, v30, v26
    v_mul_u32_u24 v30, 768, v30
    v_lshrrev_b32 v48, 1, v26
    v_lshlrev_b32 v48, 30, v48
    v_lshl_add_u32 v30, v27, 4, v30
    v_or_b32 v9, v30, v48
    v_lshl_or_b32 v10, v27, 3, v48
    v_mul_u32_u24 v30, 6144, v24
    v_mul_u32_u24 v31, 12, v25
    v_add_u32 v12, v30, v31
    s_mov_b32 s66, 1572864
    s_mov_b32 s67, 0x20000
    s_mov_b32 s70, 1572864
    s_mov_b32 s71, 0x20000
    s_mov_b32 s74, 12288
    s_mov_b32 s75, 0x20000
    s_mov_b32 s78, 12288
    s_mov_b32 s79, 0x20000
    s_mov_b32 s82, 4096
    s_mov_b32 s83, 0x20000
    s_mov_b32 s86, 4096
    s_mov_b32 s87, 0x20000
    s_mov_b32 s22, 64
    s_mov_b32 s23, 0x20000
    s_mul_i32 s33, s95, 24576
    s_add_u32 s34, s33, 6144
    s_mov_b32 s35, s33
    s_lshr_b32 s36, s95, 1
    s_mul_i32 s36, s36, 384
    s_lshl_b32 s37, s95, 6
    s_lshl_b32 s24, s25, 4
    s_add_u32 s37, s37, s24
    s_mul_i32 s24, s94, 1572864
    s_mul_i32 s56, s94, 12288
    s_lshl_b32 s57, s94, 12
    s_lshl_b32 s58, s94, 10
    s_add_u32 s58, s58, 51380320
    s_or_b32 s39, s95, s25
    s_waitcnt lgkmcnt(0)
    s_add_u32 s64, s42, s24
    s_addc_u32 s65, s43, 0
    s_add_u32 s72, s46, s56
    s_addc_u32 s73, s47, 0
    s_add_u32 s76, s48, s56
    s_addc_u32 s77, s49, 0
    buffer_load_dwordx4 v[224:227], v9, s[64:67], s33 offen offset:0 nt
    buffer_load_dwordx4 v[228:231], v9, s[64:67], s33 offen offset:1536 nt
    buffer_load_dwordx4 v[232:235], v9, s[64:67], s34 offen offset:0 nt
    buffer_load_dwordx4 v[236:239], v9, s[64:67], s34 offen offset:1536 nt
    buffer_load_dwordx2 v[32:33], v10, s[72:75], s36 offen offset:0
    buffer_load_dwordx2 v[34:35], v10, s[76:79], s36 offen offset:0
    buffer_load_dwordx2 v[36:37], v10, s[72:75], s36 offen offset:192
    buffer_load_dwordx2 v[38:39], v10, s[76:79], s36 offen offset:192
    s_add_u32 s20, s18, s58
    s_addc_u32 s21, s19, 0
    s_add_u32 s80, s50, s57
    s_addc_u32 s81, s51, 0
    s_add_u32 s84, s52, s57
    s_addc_u32 s85, s53, 0
    s_add_u32 s68, s44, s24
    s_addc_u32 s69, s45, 0
    s_mul_i32 s59, s94, 786432
    s_add_u32 s12, s54, s59
    s_addc_u32 s13, s55, 0
    s_add_u32 s8, s40, s59
    s_addc_u32 s9, s41, 0
    s_cmp_lg_u32 s39, 0
    s_cbranch_scc1 L_notleader0
    s_buffer_load_dwordx16 s[40:55], s[20:23], 0 glc
L_notleader0:
    buffer_load_dwordx4 v[240:243], v9, s[64:67], s33 offen offset:384 nt
    buffer_load_dwordx4 v[244:247], v9, s[64:67], s33 offen offset:1920 nt
    buffer_load_dwordx4 v[248:251], v9, s[64:67], s34 offen offset:384 nt
    buffer_load_dwordx4 v[252:255], v9, s[64:67], s34 offen offset:1920 nt
    s_add_u32 s4, s18, s24
    s_addc_u32 s5, s19, 0
    s_mov_b32 s6, 1572864
    s_mov_b32 s7, 0x20000
    s_mov_b32 s10, 786432
    s_mov_b32 s11, 0x20000
    s_mov_b32 s88, s16
    s_mov_b32 s89, s17
    s_add_u32 s16, s33, 3072
    s_add_u32 s17, s33, 6144
    s_mov_b32 s90, 256
    s_mov_b32 s91, 0x20000
    s_lshl_b32 s93, s94, 3
    s_cmp_lg_u32 s39, 0
    s_cbranch_scc1 L_notleader
    s_waitcnt lgkmcnt(0)
    s_mov_b32 s59, 1
    s_lshr_b32 s40, s40, 10
    s_min_u32 s40, s40, 31
    s_bitset1_b32 s59, s40
    s_lshr_b32 s41, s41, 10
    s_min_u32 s41, s41, 31
    s_bitset1_b32 s59, s41
    s_lshr_b32 s42, s42, 10
    s_min_u32 s42, s42, 31
    s_bitset1_b32 s59, s42
    s_lshr_b32 s43, s43, 10
    s_min_u32 s43, s43, 31
    s_bitset1_b32 s59, s43
    s_lshr_b32 s44, s44, 10
    s_min_u32 s44, s44, 31
    s_bitset1_b32 s59, s44
    s_lshr_b32 s45, s45, 10
    s_min_u32 s45, s45, 31
    s_bitset1_b32 s59, s45
    s_lshr_b32 s46, s46, 10
    s_min_u32 s46, s46, 31
    s_bitset1_b32 s59, s46
    s_lshr_b32 s47, s47, 10
    s_min_u32 s47, s47, 31
    s_bitset1_b32 s59, s47
    s_lshr_b32 s48, s48, 10
    s_min_u32 s48, s48, 31
    s_bitset1_b32 s59, s48
    s_lshr_b32 s49, s49, 10
    s_min_u32 s49, s49, 31
    s_bitset1_b32 s59, s49
    s_lshr_b32 s50, s50, 10
    s_min_u32 s50, s50, 31
    s_bitset1_b32 s59, s50
    s_lshr_b32 s51, s51, 10
    s_min_u32 s51, s51, 31
    s_bitset1_b32 s59, s51
    s_lshr_b32 s52, s52, 10
    s_min_u32 s52, s52, 31
    s_bitset1_b32 s59, s52
    s_lshr_b32 s53, s53, 10
    s_min_u32 s53, s53, 31
    s_bitset1_b32 s59, s53
    s_lshr_b32 s54, s54, 10
    s_min_u32 s54, s54, 31
    s_bitset1_b32 s59, s54
    s_lshr_b32 s55, s55, 10
    s_min_u32 s55, s55, 31
    s_bitset1_b32 s59, s55
    s_ff0_i32_b32 s59, s59
    s_lshl_b32 s59, s59, 10
    v_mov_b32 v52, s59
    s_mov_b64 exec, 1
    buffer_store_dword v52, off, s[88:91], s93 sc1
    s_mov_b64 exec, -1
L_notleader:
    s_lshl_b32 s24, s95, 2
    s_add_u32 s24, s24, 32
    s_buffer_load_dword s46, s[20:23], s24 glc
    s_getreg_b32 s45, hwreg(HW_REG_XCC_ID, 0, 4)
    s_lshl_b32 s45, s45, 5
    s_mov_b32 s44, 32
    buffer_load_dwordx3 v[112:114], v12, s[68:71], s35 offen offset:0 nt
    buffer_load_dwordx3 v[116:118], v12, s[68:71], s35 offen offset:768 nt
    buffer_load_dwordx3 v[120:122], v12, s[68:71], s35 offen offset:1536 nt
    buffer_load_dwordx3 v[124:126], v12, s[68:71], s35 offen offset:2304 nt
    buffer_load_dwordx2 v[40:41], off, s[80:83], s37 offset:0
    buffer_load_dwordx2 v[42:43], off, s[84:87], s37 offset:0
    buffer_load_dwordx2 v[44:45], off, s[80:83], s37 offset:8
    buffer_load_dwordx2 v[46:47], off, s[84:87], s37 offset:8
    s_mov_b32 s14, 786432
    s_mov_b32 s15, 0x20000
    s_lshl_b32 s24, s25, 8
    s_add_u32 s93, s93, s24
    v_mul_u32_u24 v30, 3072, v24
    v_add_u32 v4, v30, v1
    v_lshl_add_u32 v30, v24, 3, v26
    v_mul_u32_u24 v30, 384, v30
    v_lshlrev_b32 v31, 2, v29
    v_xor_b32 v31, v27, v31
    v_lshl_add_u32 v30, v31, 4, v30
    v_or_b32 v11, v30, v48
    v_lshlrev_b32 v30, 8, v24
    v_add_u32 v30, 12288, v30
    v_lshrrev_b32 v31, 5, v25
    v_mul_u32_u24 v31, 6144, v31
    v_add_u32 v30, v30, v31
    v_and_b32 v31, 1, v25
    v_mul_u32_u24 v31, 3072, v31
    v_add_u32 v30, v30, v31
    v_bfe_u32 v31, v25, 1, 4
    v_lshl_add_u32 v15, v31, 4, v30
    s_lshl_b32 s24, s95, 2
    v_lshl_add_u32 v13, v0, 2, s24
    v_cmp_lt_u32 vcc, 0, v0
    v_mov_b32 v30, 0x40000000
    s_nop 0
    v_cndmask_b32 v13, v13, v30, vcc
    s_mul_i32 s26, s25, 3072
    s_add_u32 s26, s26, 12288
    s_add_u32 s56, s26, 24576
    s_add_u32 s24, s95, 1
    s_and_b32 s24, s24, 7
    s_mul_i32 s32, s24, 24576
    s_add_u32 s27, s32, 12288
    s_mov_b32 s28, 98304
    s_mov_b32 s30, 73728
    v_add_u32 v1, 24576, v1
    s_mov_b32 s38, 0x3dd53b95
    s_mov_b32 s97, 0xffff0000
    s_mov_b32 s96, 100000
    v_and_b32 v26, 15, v25
    v_lshrrev_b32 v27, 4, v25
    v_bfe_u32 v28, v25, 1, 3
    v_xor_b32 v29, v27, v28
    v_mul_u32_u24 v30, 384, v26
    v_lshl_add_u32 v2, v29, 4, v30
    v_xor_b32 v3, 64, v2
    s_mul_i32 s40, s25, 6144
    s_add_u32 s40, s40, 73728
    v_lshrrev_b32 v29, 1, v27
    v_xor_b32 v29, v29, v28
    v_lshl_add_u32 v31, v29, 4, v30
    v_and_b32 v29, 1, v27
    v_lshl_add_u32 v31, v29, 3, v31
    v_xor_b32 v22, 0, v31
    v_add_u32 v22, s40, v22
    v_xor_b32 v23, 32, v31
    v_add_u32 v23, s40, v23
    v_xor_b32 v142, 64, v31
    v_add_u32 v142, s40, v142
    v_xor_b32 v143, 96, v31
    v_add_u32 v143, s40, v143
    s_lshl_b32 s24, s95, 2
    s_add_u32 s24, s24, s25
    s_mul_i32 s24, s24, 24576
    v_add_u32 v26, 0, v25
    v_mul_u32_u24 v27, 2731, v26
    v_lshrrev_b32 v27, 17, v27
    v_and_b32 v27, 7, v27
    v_xor_b32 v26, v26, v27
    v_lshlrev_b32 v136, 4, v26
    v_add_u32 v136, s24, v136
    v_add_u32 v26, 64, v25
    v_mul_u32_u24 v27, 2731, v26
    v_lshrrev_b32 v27, 17, v27
    v_and_b32 v27, 7, v27
    v_xor_b32 v26, v26, v27
    v_lshlrev_b32 v137, 4, v26
    v_add_u32 v137, s24, v137
    v_add_u32 v26, 128, v25
    v_mul_u32_u24 v27, 2731, v26
    v_lshrrev_b32 v27, 17, v27
    v_and_b32 v27, 7, v27
    v_xor_b32 v26, v26, v27
    v_lshlrev_b32 v138, 4, v26
    v_add_u32 v138, s24, v138
    v_add_u32 v26, 192, v25
    v_mul_u32_u24 v27, 2731, v26
    v_lshrrev_b32 v27, 17, v27
    v_and_b32 v27, 7, v27
    v_xor_b32 v26, v26, v27
    v_lshlrev_b32 v139, 4, v26
    v_add_u32 v139, s24, v139
    v_add_u32 v26, 256, v25
    v_mul_u32_u24 v27, 2731, v26
    v_lshrrev_b32 v27, 17, v27
    v_and_b32 v27, 7, v27
    v_xor_b32 v26, v26, v27
    v_lshlrev_b32 v140, 4, v26
    v_add_u32 v140, s24, v140
    v_add_u32 v26, 320, v25
    v_mul_u32_u24 v27, 2731, v26
    v_lshrrev_b32 v27, 17, v27
    v_and_b32 v27, 7, v27
    v_xor_b32 v26, v26, v27
    v_lshlrev_b32 v141, 4, v26
    v_add_u32 v141, s24, v141
    v_mov_b32 v5, 0
    v_mov_b32 v6, 0
    v_mov_b32 v7, 0
    v_mov_b32 v8, 0
    s_mov_b32 s62, -1
    s_mov_b32 s63, 0xffff
    s_waitcnt vmcnt(12)
    buffer_load_dwordx3 v[80:82], v12, s[68:71], s16 offen offset:0 nt
    buffer_load_dwordx3 v[84:86], v12, s[68:71], s16 offen offset:768 nt
    buffer_load_dwordx3 v[88:90], v12, s[68:71], s16 offen offset:1536 nt
    buffer_load_dwordx3 v[92:94], v12, s[68:71], s16 offen offset:2304 nt
    v_lshlrev_b32 v48, 16, v32
    v_and_b32 v49, s97, v32
    v_lshlrev_b32 v50, 16, v34
    v_and_b32 v51, s97, v34
    v_mul_f32 v48, s38, v48
    v_mul_f32 v49, s38, v49
    v_mul_f32_e64 v50, -v50, v48
    v_mul_f32_e64 v51, -v51, v49
    v_cvt_f32_i32 v224, v224
    v_cvt_f32_i32 v225, v225
    v_fma_f32 v224, v224, v48, v50
    v_fma_f32 v225, v225, v49, v51
    v_cvt_pk_bf16_f32 v224, v224, v225
    v_cvt_f32_i32 v228, v228
    v_cvt_f32_i32 v229, v229
    v_fma_f32 v228, v228, v48, v50
    v_fma_f32 v229, v229, v49, v51
    v_cvt_pk_bf16_f32 v228, v228, v229
    v_cvt_f32_i32 v232, v232
    v_cvt_f32_i32 v233, v233
    v_fma_f32 v232, v232, v48, v50
    v_fma_f32 v233, v233, v49, v51
    v_cvt_pk_bf16_f32 v232, v232, v233
    v_cvt_f32_i32 v236, v236
    v_cvt_f32_i32 v237, v237
    v_fma_f32 v236, v236, v48, v50
    v_fma_f32 v237, v237, v49, v51
    v_cvt_pk_bf16_f32 v236, v236, v237
    v_lshlrev_b32 v48, 16, v33
    v_and_b32 v49, s97, v33
    v_lshlrev_b32 v50, 16, v35
    v_and_b32 v51, s97, v35
    v_mul_f32 v48, s38, v48
    v_mul_f32 v49, s38, v49
    v_mul_f32_e64 v50, -v50, v48
    v_mul_f32_e64 v51, -v51, v49
    v_cvt_f32_i32 v226, v226
    v_cvt_f32_i32 v227, v227
    v_fma_f32 v226, v226, v48, v50
    v_fma_f32 v227, v227, v49, v51
    v_cvt_pk_bf16_f32 v225, v226, v227
    v_cvt_f32_i32 v230, v230
    v_cvt_f32_i32 v231, v231
    v_fma_f32 v230, v230, v48, v50
    v_fma_f32 v231, v231, v49, v51
    v_cvt_pk_bf16_f32 v229, v230, v231
    v_cvt_f32_i32 v234, v234
    v_cvt_f32_i32 v235, v235
    v_fma_f32 v234, v234, v48, v50
    v_fma_f32 v235, v235, v49, v51
    v_cvt_pk_bf16_f32 v233, v234, v235
    v_cvt_f32_i32 v238, v238
    v_cvt_f32_i32 v239, v239
    v_fma_f32 v238, v238, v48, v50
    v_fma_f32 v239, v239, v49, v51
    v_cvt_pk_bf16_f32 v237, v238, v239
    s_waitcnt vmcnt(12)
    v_lshlrev_b32 v48, 16, v36
    v_and_b32 v49, s97, v36
    v_lshlrev_b32 v50, 16, v38
    v_and_b32 v51, s97, v38
    v_mul_f32 v48, s38, v48
    v_mul_f32 v49, s38, v49
    v_mul_f32_e64 v50, -v50, v48
    v_mul_f32_e64 v51, -v51, v49
    v_cvt_f32_i32 v240, v240
    v_cvt_f32_i32 v241, v241
    v_fma_f32 v240, v240, v48, v50
    v_fma_f32 v241, v241, v49, v51
    v_cvt_pk_bf16_f32 v226, v240, v241
    v_cvt_f32_i32 v244, v244
    v_cvt_f32_i32 v245, v245
    v_fma_f32 v244, v244, v48, v50
    v_fma_f32 v245, v245, v49, v51
    v_cvt_pk_bf16_f32 v230, v244, v245
    v_cvt_f32_i32 v248, v248
    v_cvt_f32_i32 v249, v249
    v_fma_f32 v248, v248, v48, v50
    v_fma_f32 v249, v249, v49, v51
    v_cvt_pk_bf16_f32 v234, v248, v249
    v_cvt_f32_i32 v252, v252
    v_cvt_f32_i32 v253, v253
    v_fma_f32 v252, v252, v48, v50
    v_fma_f32 v253, v253, v49, v51
    v_cvt_pk_bf16_f32 v238, v252, v253
    v_lshlrev_b32 v48, 16, v37
    v_and_b32 v49, s97, v37
    v_lshlrev_b32 v50, 16, v39
    v_and_b32 v51, s97, v39
    v_mul_f32 v48, s38, v48
    v_mul_f32 v49, s38, v49
    v_mul_f32_e64 v50, -v50, v48
    v_mul_f32_e64 v51, -v51, v49
    v_cvt_f32_i32 v242, v242
    v_cvt_f32_i32 v243, v243
    v_fma_f32 v242, v242, v48, v50
    v_fma_f32 v243, v243, v49, v51
    v_cvt_pk_bf16_f32 v227, v242, v243
    v_cvt_f32_i32 v246, v246
    v_cvt_f32_i32 v247, v247
    v_fma_f32 v246, v246, v48, v50
    v_fma_f32 v247, v247, v49, v51
    v_cvt_pk_bf16_f32 v231, v246, v247
    v_cvt_f32_i32 v250, v250
    v_cvt_f32_i32 v251, v251
    v_fma_f32 v250, v250, v48, v50
    v_fma_f32 v251, v251, v49, v51
    v_cvt_pk_bf16_f32 v235, v250, v251
    v_cvt_f32_i32 v254, v254
    v_cvt_f32_i32 v255, v255
    v_fma_f32 v254, v254, v48, v50
    v_fma_f32 v255, v255, v49, v51
    v_cvt_pk_bf16_f32 v239, v254, v255
    buffer_store_dwordx4 v[224:227], v11, s[4:7], s33 offen offset:0
    s_mov_b64 exec, s[62:63]
    ds_write_b128 v11, v[224:227] offset:0
    s_mov_b64 exec, -1
    v_xor_b32 v55, 16, v11
    buffer_store_dwordx4 v[228:231], v55, s[4:7], s33 offen offset:768
    s_mov_b64 exec, s[62:63]
    ds_write_b128 v55, v[228:231] offset:768
    s_mov_b64 exec, -1
    v_xor_b32 v54, 32, v11
    buffer_store_dwordx4 v[232:235], v54, s[4:7], s33 offen offset:1536
    s_mov_b64 exec, s[62:63]
    ds_write_b128 v54, v[232:235] offset:1536
    s_mov_b64 exec, -1
    v_xor_b32 v55, 48, v11
    buffer_store_dwordx4 v[236:239], v55, s[4:7], s33 offen offset:2304
    s_mov_b64 exec, s[62:63]
    ds_write_b128 v55, v[236:239] offset:2304
    s_mov_b64 exec, -1
    s_mov_b32 s41, 0
    s_add_u32 m0, s40, 24576
    s_nop 0
    buffer_load_dwordx4 v136, s[8:11], s41 offen nt lds
    s_add_u32 m0, s40, 25600
    s_nop 0
    buffer_load_dwordx4 v137, s[8:11], s41 offen nt lds
    s_add_u32 m0, s40, 26624
    s_nop 0
    buffer_load_dwordx4 v138, s[8:11], s41 offen nt lds
    s_add_u32 m0, s40, 27648
    s_nop 0
    buffer_load_dwordx4 v139, s[8:11], s41 offen nt lds
    s_add_u32 m0, s40, 28672
    s_nop 0
    buffer_load_dwordx4 v140, s[8:11], s41 offen nt lds
    s_add_u32 m0, s40, 29696
    s_waitcnt vmcnt(20)
    buffer_load_dwordx4 v141, s[8:11], s41 offen nt lds
    s_waitcnt vmcnt(14)
    v_lshlrev_b32 v48, 16, v40
    v_and_b32 v49, s97, v40
    v_lshlrev_b32 v50, 16, v42
    v_and_b32 v51, s97, v42
    v_mul_f32_e64 v50, -v50, v48
    v_mul_f32_e64 v51, -v51, v49
    v_cvt_f32_i32 v112, v112
    v_cvt_f32_i32 v116, v116
    v_fma_f32 v112, v112, v48, v50
    v_fma_f32 v116, v116, v49, v51
    v_cvt_f32_i32 v113, v113
    v_cvt_f32_i32 v117, v117
    v_fma_f32 v113, v113, v48, v50
    v_fma_f32 v117, v117, v49, v51
    v_cvt_f32_i32 v114, v114
    v_cvt_f32_i32 v118, v118
    v_fma_f32 v114, v114, v48, v50
    v_fma_f32 v118, v118, v49, v51
    v_lshlrev_b32 v48, 16, v41
    v_and_b32 v49, s97, v41
    v_lshlrev_b32 v50, 16, v43
    v_and_b32 v51, s97, v43
    v_mul_f32_e64 v50, -v50, v48
    v_mul_f32_e64 v51, -v51, v49
    v_cvt_f32_i32 v120, v120
    v_cvt_f32_i32 v124, v124
    v_fma_f32 v120, v120, v48, v50
    v_fma_f32 v124, v124, v49, v51
    v_cvt_f32_i32 v121, v121
    v_cvt_f32_i32 v125, v125
    v_fma_f32 v121, v121, v48, v50
    v_fma_f32 v125, v125, v49, v51
    v_cvt_f32_i32 v122, v122
    v_cvt_f32_i32 v126, v126
    v_fma_f32 v122, v122, v48, v50
    v_fma_f32 v126, v126, v49, v51
    v_cvt_pk_bf16_f32 v112, v112, v116
    v_cvt_pk_bf16_f32 v116, v113, v117
    v_cvt_pk_bf16_f32 v113, v120, v124
    v_cvt_pk_bf16_f32 v117, v121, v125
    v_cvt_pk_bf16_f32 v120, v114, v118
    v_cvt_pk_bf16_f32 v121, v122, v126
    s_waitcnt vmcnt(10)
    v_lshlrev_b32 v48, 16, v44
    v_and_b32 v49, s97, v44
    v_lshlrev_b32 v50, 16, v46
    v_and_b32 v51, s97, v46
    v_mul_f32_e64 v50, -v50, v48
    v_mul_f32_e64 v51, -v51, v49
    v_cvt_f32_i32 v80, v80
    v_cvt_f32_i32 v84, v84
    v_fma_f32 v80, v80, v48, v50
    v_fma_f32 v84, v84, v49, v51
    v_cvt_f32_i32 v81, v81
    v_cvt_f32_i32 v85, v85
    v_fma_f32 v81, v81, v48, v50
    v_fma_f32 v85, v85, v49, v51
    v_cvt_f32_i32 v82, v82
    v_cvt_f32_i32 v86, v86
    v_fma_f32 v82, v82, v48, v50
    v_fma_f32 v86, v86, v49, v51
    v_lshlrev_b32 v48, 16, v45
    v_and_b32 v49, s97, v45
    v_lshlrev_b32 v50, 16, v47
    v_and_b32 v51, s97, v47
    v_mul_f32_e64 v50, -v50, v48
    v_mul_f32_e64 v51, -v51, v49
    v_cvt_f32_i32 v88, v88
    v_cvt_f32_i32 v92, v92
    v_fma_f32 v88, v88, v48, v50
    v_fma_f32 v92, v92, v49, v51
    v_cvt_f32_i32 v89, v89
    v_cvt_f32_i32 v93, v93
    v_fma_f32 v89, v89, v48, v50
    v_fma_f32 v93, v93, v49, v51
    v_cvt_f32_i32 v90, v90
    v_cvt_f32_i32 v94, v94
    v_fma_f32 v90, v90, v48, v50
    v_fma_f32 v94, v94, v49, v51
    v_cvt_pk_bf16_f32 v114, v80, v84
    v_cvt_pk_bf16_f32 v118, v81, v85
    v_cvt_pk_bf16_f32 v115, v88, v92
    v_cvt_pk_bf16_f32 v119, v89, v93
    v_cvt_pk_bf16_f32 v122, v82, v86
    v_cvt_pk_bf16_f32 v123, v90, v94
    buffer_store_dwordx4 v[112:115], v15, s[4:7], s35 offen offset:0
    buffer_store_dwordx4 v[116:119], v15, s[4:7], s35 offen offset:1024
    buffer_store_dwordx4 v[120:123], v15, s[4:7], s35 offen offset:2048
    ds_write_b128 v15, v[112:115] offset:12288
    ds_write_b128 v15, v[116:119] offset:13312
    ds_write_b128 v15, v[120:123] offset:14336
    buffer_load_dword v0, off, s[88:91], s93 sc1
    s_mov_b32 s41, 6144
    s_add_u32 m0, s40, 0
    s_nop 0
    buffer_load_dwordx4 v136, s[8:11], s41 offen nt lds
    s_add_u32 m0, s40, 1024
    s_nop 0
    buffer_load_dwordx4 v137, s[8:11], s41 offen nt lds
    s_add_u32 m0, s40, 2048
    s_nop 0
    buffer_load_dwordx4 v138, s[8:11], s41 offen nt lds
    s_add_u32 m0, s40, 3072
    s_nop 0
    buffer_load_dwordx4 v139, s[8:11], s41 offen nt lds
    s_add_u32 m0, s40, 4096
    s_nop 0
    buffer_load_dwordx4 v140, s[8:11], s41 offen nt lds
    s_add_u32 m0, s40, 5120
    s_waitcnt vmcnt(14)
    buffer_load_dwordx4 v141, s[8:11], s41 offen nt lds
    s_mov_b64 exec, 0
    s_cmp_eq_u32 s25, 0
    s_cbranch_scc1 L_iw0
    s_cmp_eq_u32 s25, 1
    s_cbranch_scc1 L_iw1
    s_cmp_eq_u32 s25, 2
    s_cbranch_scc1 L_iw2
    s_branch L_iw3
L_iwret:
    s_mov_b64 exec, -1
    s_waitcnt vmcnt(6)
    s_cmp_lg_u32 s25, 0
    s_cbranch_scc1 L_tagdone
    v_readfirstlane_b32 s42, v0
    s_mov_b32 s39, 100
    s_waitcnt lgkmcnt(0)
    s_and_b32 s46, s46, 0xfffffc00
L_tagretry:
    s_cmp_eq_u32 s42, s46
    s_cselect_b32 s42, 0, s42
    s_cmp_lg_u32 s42, 0
    s_cbranch_scc1 L_tagok
    s_sub_u32 s39, s39, 1
    s_cbranch_scc1 L_tagslow
    s_sleep 4
    s_buffer_load_dword s42, s[88:91], s93 glc
    s_waitcnt lgkmcnt(0)
    s_branch L_tagretry
L_tagok:
    s_add_u32 s42, s42, s45
    v_mov_b32 v0, s42
    v_mov_b32 v16, 147456
    ds_write_b32 v16, v0
L_tagdone:
    s_waitcnt lgkmcnt(0)
    s_barrier
    v_add_u32 v0, 1, v0
    buffer_store_dword v0, v13, s[20:23], 0 offen offset:32 sc1
    v_mov_b32 v16, 147456
    ds_read_b32 v17, v16
    ds_read_b128 v[144:147], v2 offset:0
    ds_read_b128 v[148:151], v3 offset:0
    ds_read_b128 v[152:155], v2 offset:6144
    ds_read_b128 v[156:159], v3 offset:6144
    ds_read_b128 v[160:163], v2 offset:128
    ds_read_b128 v[164:167], v3 offset:128
    ds_read_b128 v[168:171], v2 offset:6272
    ds_read_b128 v[172:175], v3 offset:6272
    ds_read_b128 v[176:179], v2 offset:256
    ds_read_b128 v[180:183], v3 offset:256
    ds_read_b128 v[184:187], v2 offset:6400
    ds_read_b128 v[188:191], v3 offset:6400
    s_mov_b32 s41, 12288
    s_add_u32 m0, s40, 49152
    s_nop 0
    buffer_load_dwordx4 v136, s[8:11], s41 offen nt lds
    s_add_u32 m0, s40, 50176
    s_nop 0
    buffer_load_dwordx4 v137, s[8:11], s41 offen nt lds
    s_add_u32 m0, s40, 51200
    s_nop 0
    buffer_load_dwordx4 v138, s[8:11], s41 offen nt lds
    s_add_u32 m0, s40, 52224
    s_nop 0
    buffer_load_dwordx4 v139, s[8:11], s41 offen nt lds
    s_add_u32 m0, s40, 53248
    s_nop 0
    buffer_load_dwordx4 v140, s[8:11], s41 offen nt lds
    s_add_u32 m0, s40, 54272
    s_nop 0
    buffer_load_dwordx4 v141, s[8:11], s41 offen nt lds
    s_waitcnt vmcnt(17)
    ds_read_b64 a[192:193], v22 offset:24576
    ds_read_b64 a[194:195], v142 offset:24704
    ds_read_b64 a[196:197], v23 offset:24576
    ds_read_b64 a[198:199], v143 offset:24704
    ds_read_b64 a[200:201], v142 offset:24576
    ds_read_b64 a[202:203], v22 offset:24832
    ds_read_b64 a[204:205], v143 offset:24576
    ds_read_b64 a[206:207], v23 offset:24832
    ds_read_b64 a[208:209], v22 offset:24704
    ds_read_b64 a[210:211], v142 offset:24832
    ds_read_b64 a[212:213], v23 offset:24704
    ds_read_b64 a[214:215], v143 offset:24832
    s_waitcnt lgkmcnt(15)
    v_readfirstlane_b32 s92, v17
    s_add_u32 s92, s92, 1
    s_waitcnt lgkmcnt(0)
    s_mov_b32 s41, 18432
    s_add_u32 m0, s40, 24576
    s_waitcnt vmcnt(12)
    buffer_load_dwordx4 v136, s[8:11], s41 offen nt lds
    s_add_u32 m0, s40, 25600
    s_waitcnt vmcnt(12)
    buffer_load_dwordx4 v137, s[8:11], s41 offen nt lds
    s_add_u32 m0, s40, 26624
    s_waitcnt vmcnt(12)
    buffer_load_dwordx4 v138, s[8:11], s41 offen nt lds
    v_mfma_f32_16x16x32_bf16 v[64:67], v[144:147], a[192:195], 0
    v_mfma_f32_16x16x32_bf16 v[64:67], v[148:151], a[196:199], v[64:67]
    v_mfma_f32_16x16x32_bf16 v[64:67], v[160:163], a[200:203], v[64:67]
    v_mfma_f32_16x16x32_bf16 v[64:67], v[164:167], a[204:207], v[64:67]
    v_mfma_f32_16x16x32_bf16 v[64:67], v[176:179], a[208:211], v[64:67]
    v_mfma_f32_16x16x32_bf16 v[64:67], v[180:183], a[212:215], v[64:67]
    v_mfma_f32_16x16x32_bf16 v[96:99], v[152:155], a[192:195], 0
    v_mfma_f32_16x16x32_bf16 v[96:99], v[156:159], a[196:199], v[96:99]
    v_mfma_f32_16x16x32_bf16 v[96:99], v[168:171], a[200:203], v[96:99]
    v_mfma_f32_16x16x32_bf16 v[96:99], v[172:175], a[204:207], v[96:99]
    v_mfma_f32_16x16x32_bf16 v[96:99], v[184:187], a[208:211], v[96:99]
    v_mfma_f32_16x16x32_bf16 v[96:99], v[188:191], a[212:215], v[96:99]
    s_waitcnt vmcnt(10)
    ds_read_b64 a[216:217], v22 offset:0
    ds_read_b64 a[218:219], v142 offset:128
    ds_read_b64 a[220:221], v23 offset:0
    ds_read_b64 a[222:223], v143 offset:128
    ds_read_b64 a[224:225], v142 offset:0
    ds_read_b64 a[226:227], v22 offset:256
    ds_read_b64 a[228:229], v143 offset:0
    ds_read_b64 a[230:231], v23 offset:256
    ds_read_b64 a[232:233], v22 offset:128
    ds_read_b64 a[234:235], v142 offset:256
    ds_read_b64 a[236:237], v23 offset:128
    ds_read_b64 a[238:239], v143 offset:256
    s_mov_b32 s41, 18432
    s_add_u32 m0, s40, 27648
    s_nop 0
    buffer_load_dwordx4 v139, s[8:11], s41 offen nt lds
    s_add_u32 m0, s40, 28672
    s_nop 0
    buffer_load_dwordx4 v140, s[8:11], s41 offen nt lds
    s_add_u32 m0, s40, 29696
    s_nop 0
    buffer_load_dwordx4 v141, s[8:11], s41 offen nt lds
    v_max3_f32 v48, v64, v65, v66
L_iw0:
L_pg0:
    s_cbranch_execz L_pg4
    v_max3_f32 v50, v67, v96, v97
    v_max3_f32 v48, v48, v98, v99
    v_max_f32 v48, v48, v50
    v_mov_b32 v49, v48
    s_nop 1
    v_permlane16_swap_b32 v48, v49
    s_nop 1
    v_max_f32 v48, v48, v49
    v_mov_b32 v49, v48
    s_nop 1
    v_permlane32_swap_b32 v48, v49
    s_nop 1
    v_max_f32 v48, v48, v49
    s_waitcnt lgkmcnt(0)
    v_mfma_f32_16x16x32_bf16 v[68:71], v[144:147], a[216:219], 0
    v_sub_f32 v64, v64, v48
    v_sub_f32 v65, v65, v48
    v_sub_f32 v66, v66, v48
    v_mfma_f32_16x16x32_bf16 v[68:71], v[148:151], a[220:223], v[68:71]
    v_sub_f32 v67, v67, v48
    v_sub_f32 v96, v96, v48
    v_sub_f32 v97, v97, v48
    v_mfma_f32_16x16x32_bf16 v[68:71], v[160:163], a[224:227], v[68:71]
    v_sub_f32 v98, v98, v48
    v_sub_f32 v99, v99, v48
    v_mfma_f32_16x16x32_bf16 v[68:71], v[164:167], a[228:231], v[68:71]
    v_exp_f32 v64, v64
    v_mfma_f32_16x16x32_bf16 v[68:71], v[176:179], a[232:235], v[68:71]
    v_exp_f32 v65, v65
    v_mfma_f32_16x16x32_bf16 v[68:71], v[180:183], a[236:239], v[68:71]
    v_exp_f32 v66, v66
    v_mfma_f32_16x16x32_bf16 v[100:103], v[152:155], a[216:219], 0
    v_exp_f32 v67, v67
    v_mfma_f32_16x16x32_bf16 v[100:103], v[156:159], a[220:223], v[100:103]
    v_exp_f32 v96, v96
    v_mfma_f32_16x16x32_bf16 v[100:103], v[168:171], a[224:227], v[100:103]
    v_exp_f32 v97, v97
    v_mfma_f32_16x16x32_bf16 v[100:103], v[172:175], a[228:231], v[100:103]
    v_exp_f32 v98, v98
    v_mfma_f32_16x16x32_bf16 v[100:103], v[184:187], a[232:235], v[100:103]
    v_exp_f32 v99, v99
    v_sub_f32 v128, 0, v48
    v_mfma_f32_16x16x32_bf16 v[100:103], v[188:191], a[236:239], v[100:103]
    v_sub_f32 v129, 0, v48
    v_sub_f32 v130, 0, v48
    v_sub_f32 v131, 0, v48
    v_add_f32 v5, v5, v64
    v_add_f32 v5, v5, v65
    v_add_f32 v5, v5, v66
    v_add_f32 v5, v5, v67
    v_add_f32 v5, v5, v96
    v_add_f32 v5, v5, v97
    v_add_f32 v5, v5, v98
    v_add_f32 v5, v5, v99
    v_cvt_pk_bf16_f32 v64, v64, v65
    v_cvt_pk_bf16_f32 v65, v66, v67
    v_cvt_pk_bf16_f32 v66, v96, v97
    v_cvt_pk_bf16_f32 v67, v98, v99
    s_waitcnt vmcnt(6)
    ds_read_b64 a[240:241], v22 offset:49152
    ds_read_b64 a[242:243], v142 offset:49280
    ds_read_b64 a[244:245], v23 offset:49152
    ds_read_b64 a[246:247], v143 offset:49280
    ds_read_b64 a[248:249], v142 offset:49152
    ds_read_b64 a[250:251], v22 offset:49408
    ds_read_b64 a[252:253], v143 offset:49152
    ds_read_b64 a[254:255], v23 offset:49408
    ds_read_b64 v[192:193], v22 offset:49280
    ds_read_b64 v[194:195], v142 offset:49408
    ds_read_b64 v[196:197], v23 offset:49280
    ds_read_b64 v[198:199], v143 offset:49408
    s_buffer_load_dwordx8 s[48:55], s[20:23], s44 glc
    v_max3_f32 v48, v68, v69, v70
    v_max3_f32 v50, v71, v100, v101
    v_max3_f32 v48, v48, v102, v103
    v_max_f32 v48, v48, v50
    v_mov_b32 v49, v48
    s_nop 1
    v_permlane16_swap_b32 v48, v49
    s_nop 1
    v_max_f32 v48, v48, v49
    v_mov_b32 v49, v48
    s_nop 1
    v_permlane32_swap_b32 v48, v49
    s_nop 1
    v_max_f32 v48, v48, v49
    s_waitcnt lgkmcnt(0)
    v_mfma_f32_16x16x32_bf16 v[72:75], v[144:147], a[240:243], 0
    v_sub_f32 v68, v68, v48
    v_sub_f32 v69, v69, v48
    v_sub_f32 v70, v70, v48
    v_mfma_f32_16x16x32_bf16 v[72:75], v[148:151], a[244:247], v[72:75]
    v_sub_f32 v71, v71, v48
    v_sub_f32 v100, v100, v48
    v_sub_f32 v101, v101, v48
    v_mfma_f32_16x16x32_bf16 v[72:75], v[160:163], a[248:251], v[72:75]
    v_sub_f32 v102, v102, v48
    v_sub_f32 v103, v103, v48
    v_mfma_f32_16x16x32_bf16 v[72:75], v[164:167], a[252:255], v[72:75]
    v_exp_f32 v68, v68
    v_mfma_f32_16x16x32_bf16 v[72:75], v[176:179], v[192:195], v[72:75]
    v_exp_f32 v69, v69
    v_mfma_f32_16x16x32_bf16 v[72:75], v[180:183], v[196:199], v[72:75]
    v_exp_f32 v70, v70
    v_mfma_f32_16x16x32_bf16 v[104:107], v[152:155], a[240:243], 0
    v_exp_f32 v71, v71
    v_mfma_f32_16x16x32_bf16 v[104:107], v[156:159], a[244:247], v[104:107]
    v_exp_f32 v100, v100
    v_mfma_f32_16x16x32_bf16 v[104:107], v[168:171], a[248:251], v[104:107]
    v_exp_f32 v101, v101
    v_mfma_f32_16x16x32_bf16 v[104:107], v[172:175], a[252:255], v[104:107]
    v_exp_f32 v102, v102
    v_mfma_f32_16x16x32_bf16 v[104:107], v[184:187], v[192:195], v[104:107]
    v_exp_f32 v103, v103
    v_sub_f32 v132, 0, v48
    v_mfma_f32_16x16x32_bf16 v[104:107], v[188:191], v[196:199], v[104:107]
    v_sub_f32 v133, 0, v48
    v_sub_f32 v134, 0, v48
    v_sub_f32 v135, 0, v48
    v_add_f32 v6, v6, v68
    v_add_f32 v6, v6, v69
    v_add_f32 v6, v6, v70
    v_add_f32 v6, v6, v71
    v_add_f32 v6, v6, v100
    v_add_f32 v6, v6, v101
    v_add_f32 v6, v6, v102
    v_add_f32 v6, v6, v103
    v_cvt_pk_bf16_f32 v68, v68, v69
    v_cvt_pk_bf16_f32 v69, v70, v71
    v_cvt_pk_bf16_f32 v70, v100, v101
    v_cvt_pk_bf16_f32 v71, v102, v103
    ds_read_b128 v[24:27], v1 offset:0
    ds_read_b128 v[28:31], v1 offset:1024
    ds_read_b128 v[32:35], v1 offset:2048
    ds_read_b128 v[36:39], v1 offset:3072
    s_waitcnt lgkmcnt(0)
    s_sub_u32 s48, s48, s92
    s_sub_u32 s49, s49, s92
    s_sub_u32 s50, s50, s92
    s_sub_u32 s51, s51, s92
    s_sub_u32 s52, s52, s92
    s_sub_u32 s53, s53, s92
    s_sub_u32 s54, s54, s92
    s_sub_u32 s55, s55, s92
    s_max_u32 s48, s48, s49
    s_max_u32 s48, s48, s50
    s_max_u32 s48, s48, s51
    s_max_u32 s48, s48, s52
    s_max_u32 s48, s48, s53
    s_max_u32 s48, s48, s54
    s_max_u32 s48, s48, s55
    s_cmp_ge_u32 s48, 16
    s_cbranch_scc1 L_pollslow0
L_pollok0:
    s_add_u32 s92, s92, 1
    s_mov_b32 m0, s26
    s_nop 0
    buffer_load_dwordx4 v4, s[4:7], s32 offen offset:0 sc1 lds
    buffer_load_dwordx4 v4, s[4:7], s32 offen offset:1024 sc1 lds
    buffer_load_dwordx4 v4, s[4:7], s32 offen offset:2048 sc1 lds
    s_add_u32 s32, s32, 24576
    s_sub_u32 s57, s32, 196608
    s_min_u32 s32, s32, s57
    s_add_u32 s26, s26, 36864
    s_sub_u32 s57, s26, 147456
    s_min_u32 s26, s26, s57
    s_mov_b32 m0, s26
    s_nop 0
    buffer_load_dwordx4 v4, s[4:7], s32 offen offset:0 sc1 lds
    buffer_load_dwordx4 v4, s[4:7], s32 offen offset:1024 sc1 lds
    buffer_load_dwordx4 v4, s[4:7], s32 offen offset:2048 sc1 lds
    s_add_u32 s32, s32, 24576
    s_sub_u32 s57, s32, 196608
    s_min_u32 s32, s32, s57
    s_add_u32 s26, s26, 12288
    s_mov_b32 m0, s26
    s_waitcnt vmcnt(11)
    buffer_load_dwordx4 v4, s[4:7], s32 offen offset:0 sc1 lds
    s_waitcnt vmcnt(11)
    buffer_load_dwordx4 v4, s[4:7], s32 offen offset:1024 sc1 lds
    s_waitcnt vmcnt(11)
    buffer_load_dwordx4 v4, s[4:7], s32 offen offset:2048 sc1 lds
    s_add_u32 s32, s32, 24576
    s_sub_u32 s57, s32, 196608
    s_min_u32 s32, s32, s57
    s_add_u32 s26, s26, 36864
    s_sub_u32 s57, s26, 147456
    s_min_u32 s26, s26, s57
    s_mov_b32 m0, s56
    s_waitcnt vmcnt(11)
    buffer_load_dwordx4 v4, s[4:7], s27 offen offset:0 sc1 lds
    s_waitcnt vmcnt(11)
    buffer_load_dwordx4 v4, s[4:7], s27 offen offset:1024 sc1 lds
    s_waitcnt vmcnt(11)
    buffer_load_dwordx4 v4, s[4:7], s27 offen offset:2048 sc1 lds
    s_add_u32 s27, s27, 24576
    s_sub_u32 s58, s27, 196608
    s_min_u32 s27, s27, s58
    s_add_u32 s56, s56, 36864
    s_sub_u32 s58, s56, 147456
    s_min_u32 s56, s56, s58
    s_add_u32 s33, s33, 196608
    s_add_u32 s34, s34, 196608
    s_add_u32 s36, s36, 1536
    s_add_u32 s35, s35, 196608
    s_add_u32 s16, s16, 196608
    s_add_u32 s17, s17, 196608
    s_add_u32 s37, s37, 512
    v_mfma_f32_16x16x32_bf16 a[0:3], v[64:67], v[24:27], 0
    ds_read_b128 v[40:43], v1 offset:4096
    v_max3_f32 v48, v72, v73, v74
    v_mfma_f32_16x16x32_bf16 a[4:7], v[64:67], v[28:31], 0
    v_max3_f32 v50, v75, v104, v105
    v_max3_f32 v48, v48, v106, v107
    v_mfma_f32_16x16x32_bf16 a[48:51], v[68:71], v[24:27], 0
    ds_read_b128 v[44:47], v1 offset:5120
    v_max_f32 v48, v48, v50
    v_mfma_f32_16x16x32_bf16 a[52:55], v[68:71], v[28:31], 0
    s_waitcnt lgkmcnt(2)
    v_mov_b32 v49, v48
    v_mfma_f32_16x16x32_bf16 a[8:11], v[64:67], v[32:35], 0
    s_nop 1
    ds_read_b128 v[24:27], v1 offset:6144
    v_mfma_f32_16x16x32_bf16 a[12:15], v[64:67], v[36:39], 0
    v_permlane16_swap_b32 v48, v49
    s_nop 1
    v_mfma_f32_16x16x32_bf16 a[56:59], v[68:71], v[32:35], 0
    ds_read_b128 v[28:31], v1 offset:7168
    v_max_f32 v48, v48, v49
    v_mfma_f32_16x16x32_bf16 a[60:63], v[68:71], v[36:39], 0
    s_waitcnt lgkmcnt(2)
    v_mov_b32 v49, v48
    s_nop 1
    v_mfma_f32_16x16x32_bf16 a[16:19], v[64:67], v[40:43], 0
    ds_read_b128 v[32:35], v1 offset:8192
    v_permlane32_swap_b32 v48, v49
    v_mfma_f32_16x16x32_bf16 a[20:23], v[64:67], v[44:47], 0
    s_nop 1
    v_max_f32 v48, v48, v49
    v_sub_f32 v72, v72, v48
    v_mfma_f32_16x16x32_bf16 a[64:67], v[68:71], v[40:43], 0
    ds_read_b128 v[36:39], v1 offset:9216
    v_sub_f32 v73, v73, v48
    v_mfma_f32_16x16x32_bf16 a[68:71], v[68:71], v[44:47], 0
    s_waitcnt lgkmcnt(2)
    v_sub_f32 v74, v74, v48
    v_sub_f32 v75, v75, v48
    v_sub_f32 v104, v104, v48
    v_mfma_f32_16x16x32_bf16 a[24:27], v[64:67], v[24:27], 0
    ds_read_b128 v[40:43], v1 offset:10240
    v_sub_f32 v105, v105, v48
    v_mfma_f32_16x16x32_bf16 a[28:31], v[64:67], v[28:31], 0
    v_sub_f32 v106, v106, v48
    v_sub_f32 v107, v107, v48
    v_mfma_f32_16x16x32_bf16 a[72:75], v[68:71], v[24:27], 0
    ds_read_b128 v[44:47], v1 offset:11264
    v_mfma_f32_16x16x32_bf16 a[76:79], v[68:71], v[28:31], 0
    s_waitcnt lgkmcnt(2)
    v_exp_f32 v72, v72
    v_mfma_f32_16x16x32_bf16 a[32:35], v[64:67], v[32:35], 0
    v_exp_f32 v73, v73
    v_mfma_f32_16x16x32_bf16 a[36:39], v[64:67], v[36:39], 0
    v_exp_f32 v74, v74
    v_mfma_f32_16x16x32_bf16 a[80:83], v[68:71], v[32:35], 0
    v_exp_f32 v75, v75
    v_mfma_f32_16x16x32_bf16 a[84:87], v[68:71], v[36:39], 0
    s_waitcnt lgkmcnt(0)
    v_exp_f32 v104, v104
    v_mfma_f32_16x16x32_bf16 a[40:43], v[64:67], v[40:43], 0
    v_exp_f32 v105, v105
    v_mfma_f32_16x16x32_bf16 a[44:47], v[64:67], v[44:47], 0
    v_exp_f32 v106, v106
    v_mfma_f32_16x16x32_bf16 a[88:91], v[68:71], v[40:43], 0
    v_exp_f32 v107, v107
    v_mfma_f32_16x16x32_bf16 a[92:95], v[68:71], v[44:47], 0
    v_sub_f32 v136, 0, v48
    v_sub_f32 v137, 0, v48
    v_sub_f32 v138, 0, v48
    v_sub_f32 v139, 0, v48
    v_add_f32 v7, v7, v72
    v_add_f32 v7, v7, v73
    v_add_f32 v7, v7, v74
    v_add_f32 v7, v7, v75
    v_add_f32 v7, v7, v104
    v_add_f32 v7, v7, v105
    v_add_f32 v7, v7, v106
    v_add_f32 v7, v7, v107
    v_cvt_pk_bf16_f32 v72, v72, v73
    v_cvt_pk_bf16_f32 v73, v74, v75
    v_cvt_pk_bf16_f32 v74, v104, v105
    v_cvt_pk_bf16_f32 v75, v106, v107
    s_waitcnt vmcnt(12)
    ds_read_b64 v[200:201], v22 offset:24576
    ds_read_b64 v[202:203], v142 offset:24704
    ds_read_b64 v[204:205], v23 offset:24576
    ds_read_b64 v[206:207], v143 offset:24704
    ds_read_b64 v[208:209], v142 offset:24576
    ds_read_b64 v[210:211], v22 offset:24832
    ds_read_b64 v[212:213], v143 offset:24576
    ds_read_b64 v[214:215], v23 offset:24832
    ds_read_b64 v[216:217], v22 offset:24704
    ds_read_b64 v[218:219], v142 offset:24832
    ds_read_b64 v[220:221], v23 offset:24704
    ds_read_b64 v[222:223], v143 offset:24832
    s_waitcnt lgkmcnt(0)
    v_mfma_f32_16x16x32_bf16 v[76:79], v[144:147], v[200:203], 0
    v_mfma_f32_16x16x32_bf16 v[76:79], v[148:151], v[204:207], v[76:79]
    v_mfma_f32_16x16x32_bf16 v[76:79], v[160:163], v[208:211], v[76:79]
    v_mfma_f32_16x16x32_bf16 v[76:79], v[164:167], v[212:215], v[76:79]
    v_mfma_f32_16x16x32_bf16 v[76:79], v[176:179], v[216:219], v[76:79]
    v_mfma_f32_16x16x32_bf16 v[76:79], v[180:183], v[220:223], v[76:79]
    v_mfma_f32_16x16x32_bf16 v[108:111], v[152:155], v[200:203], 0
    v_mfma_f32_16x16x32_bf16 v[108:111], v[156:159], v[204:207], v[108:111]
    v_mfma_f32_16x16x32_bf16 v[108:111], v[168:171], v[208:211], v[108:111]
    v_mfma_f32_16x16x32_bf16 v[108:111], v[172:175], v[212:215], v[108:111]
    v_mfma_f32_16x16x32_bf16 v[108:111], v[184:187], v[216:219], v[108:111]
    v_mfma_f32_16x16x32_bf16 v[108:111], v[188:191], v[220:223], v[108:111]
    s_nop 7
    v_max3_f32 v48, v76, v77, v78
    v_max3_f32 v50, v79, v108, v109
    v_max3_f32 v48, v48, v110, v111
    v_max_f32 v48, v48, v50
    v_mov_b32 v49, v48
    s_nop 1
    v_permlane16_swap_b32 v48, v49
    s_nop 1
    v_max_f32 v48, v48, v49
    v_mov_b32 v49, v48
    s_nop 1
    v_permlane32_swap_b32 v48, v49
    s_nop 1
    v_max_f32 v48, v48, v49
    v_sub_f32 v140, 0, v48
    v_sub_f32 v141, 0, v48
    v_sub_f32 v142, 0, v48
    v_sub_f32 v143, 0, v48
    s_waitcnt vmcnt(9)
    s_barrier
    ds_read_b128 v[24:27], v2 offset:12288
    ds_read_b128 v[28:31], v3 offset:12288
    ds_read_b128 v[32:35], v2 offset:18432
    ds_read_b128 v[36:39], v3 offset:18432
    s_waitcnt lgkmcnt(2)
    v_mfma_f32_16x16x32_bf16 v[80:83], v[24:27], a[192:195], v[128:131]
    ds_read_b128 v[40:43], v2 offset:12416
    v_sub_f32 v76, v76, v48
    v_mfma_f32_16x16x32_bf16 v[80:83], v[28:31], a[196:199], v[80:83]
    buffer_load_dwordx2 v[56:57], v10, s[72:75], s36 offen offset:0
    v_mfma_f32_16x16x32_bf16 v[84:87], v[24:27], a[216:219], v[132:135]
    v_sub_f32 v77, v77, v48
    v_sub_f32 v78, v78, v48
    v_mfma_f32_16x16x32_bf16 v[84:87], v[28:31], a[220:223], v[84:87]
    buffer_load_dwordx2 v[58:59], v10, s[76:79], s36 offen offset:0
    v_mfma_f32_16x16x32_bf16 v[88:91], v[24:27], a[240:243], v[136:139]
    ds_read_b128 v[44:47], v3 offset:12416
    v_sub_f32 v79, v79, v48
    v_mfma_f32_16x16x32_bf16 v[88:91], v[28:31], a[244:247], v[88:91]
    buffer_load_dwordx4 v[224:227], v9, s[64:67], s33 offen offset:0 nt
    v_mfma_f32_16x16x32_bf16 v[92:95], v[24:27], v[200:203], v[140:143]
    v_sub_f32 v108, v108, v48
    v_sub_f32 v109, v109, v48
    v_mfma_f32_16x16x32_bf16 v[92:95], v[28:31], v[204:207], v[92:95]
    s_waitcnt lgkmcnt(2)
    buffer_load_dwordx4 v[228:231], v9, s[64:67], s33 offen offset:1536 nt
    v_mfma_f32_16x16x32_bf16 v[112:115], v[32:35], a[192:195], v[128:131]
    ds_read_b128 v[24:27], v2 offset:18560
    v_sub_f32 v110, v110, v48
    v_mfma_f32_16x16x32_bf16 v[112:115], v[36:39], a[196:199], v[112:115]
    buffer_load_dwordx4 v[232:235], v9, s[64:67], s34 offen offset:0 nt
    v_mfma_f32_16x16x32_bf16 v[116:119], v[32:35], a[216:219], v[132:135]
    v_sub_f32 v111, v111, v48
    v_mfma_f32_16x16x32_bf16 v[116:119], v[36:39], a[220:223], v[116:119]
    s_waitcnt vmcnt(13)
    buffer_load_dwordx4 v[236:239], v9, s[64:67], s34 offen offset:1536 nt
    v_mfma_f32_16x16x32_bf16 v[120:123], v[32:35], a[240:243], v[136:139]
    ds_read_b128 v[28:31], v3 offset:18560
    v_mfma_f32_16x16x32_bf16 v[120:123], v[36:39], a[244:247], v[120:123]
    v_exp_f32 v76, v76
    v_mfma_f32_16x16x32_bf16 v[124:127], v[32:35], v[200:203], v[140:143]
    v_exp_f32 v77, v77
    v_mfma_f32_16x16x32_bf16 v[124:127], v[36:39], v[204:207], v[124:127]
    s_waitcnt lgkmcnt(2)
    s_waitcnt vmcnt(13)
    buffer_load_dwordx2 v[60:61], v10, s[72:75], s36 offen offset:192
    v_mfma_f32_16x16x32_bf16 v[80:83], v[40:43], a[200:203], v[80:83]
    ds_read_b128 v[32:35], v2 offset:12544
    v_mfma_f32_16x16x32_bf16 v[80:83], v[44:47], a[204:207], v[80:83]
    buffer_load_dwordx2 v[62:63], v10, s[76:79], s36 offen offset:192
    v_mfma_f32_16x16x32_bf16 v[84:87], v[40:43], a[224:227], v[84:87]
    v_exp_f32 v78, v78
    v_mfma_f32_16x16x32_bf16 v[84:87], v[44:47], a[228:231], v[84:87]
    s_waitcnt vmcnt(14)
    buffer_load_dwordx4 v[240:243], v9, s[64:67], s33 offen offset:384 nt
    v_mfma_f32_16x16x32_bf16 v[88:91], v[40:43], a[248:251], v[88:91]
    ds_read_b128 v[36:39], v3 offset:12544
    v_mfma_f32_16x16x32_bf16 v[88:91], v[44:47], a[252:255], v[88:91]
    buffer_load_dwordx4 v[244:247], v9, s[64:67], s33 offen offset:1920 nt
    v_mfma_f32_16x16x32_bf16 v[92:95], v[40:43], v[208:211], v[92:95]
    v_exp_f32 v79, v79
    v_mfma_f32_16x16x32_bf16 v[92:95], v[44:47], v[212:215], v[92:95]
    s_waitcnt lgkmcnt(2)
    v_exp_f32 v108, v108
    v_mfma_f32_16x16x32_bf16 v[112:115], v[24:27], a[200:203], v[112:115]
    ds_read_b128 v[40:43], v2 offset:18688
    v_mfma_f32_16x16x32_bf16 v[112:115], v[28:31], a[204:207], v[112:115]
    s_waitcnt vmcnt(15)
    buffer_load_dwordx4 v[248:251], v9, s[64:67], s34 offen offset:384 nt
    v_mfma_f32_16x16x32_bf16 v[116:119], v[24:27], a[224:227], v[116:119]
    v_exp_f32 v109, v109
    v_mfma_f32_16x16x32_bf16 v[116:119], v[28:31], a[228:231], v[116:119]
    s_waitcnt vmcnt(15)
    buffer_load_dwordx4 v[252:255], v9, s[64:67], s34 offen offset:1920 nt
    v_mfma_f32_16x16x32_bf16 v[120:123], v[24:27], a[248:251], v[120:123]
    ds_read_b128 v[44:47], v3 offset:18688
    v_mfma_f32_16x16x32_bf16 v[120:123], v[28:31], a[252:255], v[120:123]
    s_waitcnt lgkmcnt(2)
    v_exp_f32 v110, v110
    v_mfma_f32_16x16x32_bf16 v[124:127], v[24:27], v[208:211], v[124:127]
    s_waitcnt vmcnt(15)
    v_exp_f32 v111, v111
    v_mfma_f32_16x16x32_bf16 v[124:127], v[28:31], v[212:215], v[124:127]
    s_barrier
    v_add_u32 v2, 49152, v2
    v_add_u32 v3, 49152, v3
    v_mfma_f32_16x16x32_bf16 v[80:83], v[32:35], a[208:211], v[80:83]
    s_mov_b32 m0, s26
    ds_read_b128 v[24:27], v2 offset:0
    v_add_f32 v8, v8, v76
    v_mfma_f32_16x16x32_bf16 v[80:83], v[36:39], a[212:215], v[80:83]
    buffer_load_dwordx4 v4, s[4:7], s32 offen offset:0 sc1 lds
    v_add_f32 v8, v8, v77
    v_mfma_f32_16x16x32_bf16 v[84:87], v[32:35], a[232:235], v[84:87]
    v_add_f32 v8, v8, v78
    v_add_f32 v8, v8, v79
    v_mfma_f32_16x16x32_bf16 v[84:87], v[36:39], a[236:239], v[84:87]
    s_waitcnt vmcnt(15)
    buffer_load_dwordx4 v4, s[4:7], s32 offen offset:1024 sc1 lds
    v_add_f32 v8, v8, v108
    v_mfma_f32_16x16x32_bf16 v[88:91], v[32:35], v[192:195], v[88:91]
    ds_read_b128 v[28:31], v3 offset:0
    v_add_f32 v8, v8, v109
    v_mfma_f32_16x16x32_bf16 v[88:91], v[36:39], v[196:199], v[88:91]
    s_waitcnt vmcnt(15)
    buffer_load_dwordx4 v4, s[4:7], s32 offen offset:2048 sc1 lds
    v_add_f32 v8, v8, v110
    v_mfma_f32_16x16x32_bf16 v[92:95], v[32:35], v[216:219], v[92:95]
    s_add_u32 s32, s32, 24576
    v_add_f32 v8, v8, v111
    v_cvt_pk_bf16_f32 v76, v76, v77
    v_mfma_f32_16x16x32_bf16 v[92:95], v[36:39], v[220:223], v[92:95]
    s_waitcnt lgkmcnt(2)
    v_cvt_pk_bf16_f32 v77, v78, v79
    v_cvt_pk_bf16_f32 v78, v108, v109
    v_mfma_f32_16x16x32_bf16 v[112:115], v[40:43], a[208:211], v[112:115]
    ds_read_b128 v[32:35], v2 offset:6144
    v_cvt_pk_bf16_f32 v79, v110, v111
    v_bfe_u32 v20, v4, 4, 6
    v_lshlrev_b32 v20, 2, v20
    v_xor_b32 v21, 16, v11
    v_xor_b32 v22, 32, v11
    v_xor_b32 v23, 48, v11
    v_mfma_f32_16x16x32_bf16 v[112:115], v[44:47], a[212:215], v[112:115]
    s_sub_u32 s57, s32, 196608
    s_min_u32 s32, s32, s57
    v_mfma_f32_16x16x32_bf16 v[116:119], v[40:43], a[232:235], v[116:119]
    s_add_u32 s26, s26, 12288
    s_mov_b32 m0, s26
    v_mfma_f32_16x16x32_bf16 v[116:119], v[44:47], a[236:239], v[116:119]
    s_waitcnt vmcnt(15)
    buffer_load_dwordx4 v4, s[4:7], s32 offen offset:0 sc1 lds
    v_mfma_f32_16x16x32_bf16 v[120:123], v[40:43], v[192:195], v[120:123]
    ds_read_b128 v[36:39], v3 offset:6144
    v_mfma_f32_16x16x32_bf16 v[120:123], v[44:47], v[196:199], v[120:123]
    s_waitcnt vmcnt(14)
    buffer_load_dwordx4 v4, s[4:7], s32 offen offset:1024 sc1 lds
    v_mfma_f32_16x16x32_bf16 v[124:127], v[40:43], v[216:219], v[124:127]
    s_waitcnt vmcnt(14)
    buffer_load_dwordx4 v4, s[4:7], s32 offen offset:2048 sc1 lds
    v_mfma_f32_16x16x32_bf16 v[124:127], v[44:47], v[220:223], v[124:127]
    s_waitcnt lgkmcnt(2)
    s_add_u32 s32, s32, 24576
    s_sub_u32 s57, s32, 196608
    s_min_u32 s32, s32, s57
    s_add_u32 s26, s26, 36864
    s_sub_u32 s57, s26, 147456
    s_min_u32 s26, s26, s57
    v_mfma_f32_16x16x32_bf16 v[160:163], v[24:27], a[192:195], v[128:131]
    s_mov_b32 m0, s56
    ds_read_b128 v[40:43], v2 offset:128
    v_mfma_f32_16x16x32_bf16 v[160:163], v[28:31], a[196:199], v[160:163]
    s_waitcnt vmcnt(13)
    buffer_load_dwordx4 v4, s[4:7], s27 offen offset:0 sc1 lds
    v_mfma_f32_16x16x32_bf16 v[164:167], v[24:27], a[216:219], v[132:135]
    v_exp_f32 v16, v80
    v_mfma_f32_16x16x32_bf16 v[164:167], v[28:31], a[220:223], v[164:167]
    s_waitcnt vmcnt(13)
    buffer_load_dwordx4 v4, s[4:7], s27 offen offset:1024 sc1 lds
    v_exp_f32 v17, v81
    v_exp_f32 v18, v82
    v_add_f32 v5, v5, v16
    v_add_f32 v5, v5, v17
    v_mfma_f32_16x16x32_bf16 v[168:171], v[24:27], a[240:243], v[136:139]
    ds_read_b128 v[44:47], v3 offset:128
    v_mfma_f32_16x16x32_bf16 v[168:171], v[28:31], a[244:247], v[168:171]
    s_waitcnt vmcnt(12)
    buffer_load_dwordx4 v4, s[4:7], s27 offen offset:2048 sc1 lds
    v_exp_f32 v19, v83
    v_cvt_pk_bf16_f32 v80, v16, v17
    v_mfma_f32_16x16x32_bf16 v[172:175], v[24:27], v[200:203], v[140:143]
    s_add_u32 s27, s27, 24576
    v_exp_f32 v16, v112
    v_mfma_f32_16x16x32_bf16 v[172:175], v[28:31], v[204:207], v[172:175]
    s_waitcnt lgkmcnt(2)
    v_add_f32 v5, v5, v18
    v_add_f32 v5, v5, v19
    v_exp_f32 v17, v113
    v_cvt_pk_bf16_f32 v81, v18, v19
    s_sub_u32 s58, s27, 196608
    v_mfma_f32_16x16x32_bf16 v[96:99], v[32:35], a[192:195], v[128:131]
    s_min_u32 s27, s27, s58
    ds_read_b128 v[24:27], v2 offset:6272
    s_add_u32 s56, s56, 12288
    v_mfma_f32_16x16x32_bf16 v[96:99], v[36:39], a[196:199], v[96:99]
    s_mov_b32 m0, s56
    v_exp_f32 v18, v114
    v_add_f32 v5, v5, v16
    v_add_f32 v5, v5, v17
    v_mfma_f32_16x16x32_bf16 v[100:103], v[32:35], a[216:219], v[132:135]
    v_exp_f32 v19, v115
    v_mfma_f32_16x16x32_bf16 v[100:103], v[36:39], a[220:223], v[100:103]
    s_waitcnt vmcnt(11)
    buffer_load_dwordx4 v4, s[4:7], s27 offen offset:0 sc1 lds
    v_cvt_pk_bf16_f32 v82, v16, v17
    v_exp_f32 v16, v84
    v_add_f32 v5, v5, v18
    v_mfma_f32_16x16x32_bf16 v[104:107], v[32:35], a[240:243], v[136:139]
    ds_read_b128 v[28:31], v3 offset:6272
    v_add_f32 v5, v5, v19
    v_mfma_f32_16x16x32_bf16 v[104:107], v[36:39], a[244:247], v[104:107]
    s_waitcnt vmcnt(11)
    buffer_load_dwordx4 v4, s[4:7], s27 offen offset:1024 sc1 lds
    v_exp_f32 v17, v85
    v_cvt_pk_bf16_f32 v83, v18, v19
    v_mfma_f32_16x16x32_bf16 v[108:111], v[32:35], v[200:203], v[140:143]
    v_exp_f32 v18, v86
    v_mfma_f32_16x16x32_bf16 v[108:111], v[36:39], v[204:207], v[108:111]
    s_waitcnt lgkmcnt(2)
    s_waitcnt vmcnt(11)
    buffer_load_dwordx4 v4, s[4:7], s27 offen offset:2048 sc1 lds
    v_add_f32 v6, v6, v16
    v_add_f32 v6, v6, v17
    v_exp_f32 v19, v87
    v_mfma_f32_16x16x32_bf16 v[160:163], v[40:43], a[200:203], v[160:163]
    ds_read_b128 v[32:35], v2 offset:256
    v_cvt_pk_bf16_f32 v84, v16, v17
    v_mfma_f32_16x16x32_bf16 v[160:163], v[44:47], a[204:207], v[160:163]
    v_exp_f32 v16, v116
    v_add_f32 v6, v6, v18
    v_add_f32 v6, v6, v19
    v_mfma_f32_16x16x32_bf16 v[164:167], v[40:43], a[224:227], v[164:167]
    v_exp_f32 v17, v117
    v_mfma_f32_16x16x32_bf16 v[164:167], v[44:47], a[228:231], v[164:167]
    s_add_u32 s27, s27, 24576
    v_cvt_pk_bf16_f32 v85, v18, v19
    v_exp_f32 v18, v118
    v_add_f32 v6, v6, v16
    v_add_f32 v6, v6, v17
    s_sub_u32 s58, s27, 196608
    v_mfma_f32_16x16x32_bf16 v[168:171], v[40:43], a[248:251], v[168:171]
    s_waitcnt vmcnt(18)
    ds_read_b128 v[36:39], v3 offset:256
    v_lshlrev_b32 v48, 16, v56
    v_mfma_f32_16x16x32_bf16 v[168:171], v[44:47], a[252:255], v[168:171]
    s_waitcnt vmcnt(11)
    buffer_load_dwordx3 v[144:146], v12, s[68:71], s35 offen offset:0 nt
    v_exp_f32 v19, v119
    v_cvt_pk_bf16_f32 v86, v16, v17
    v_mfma_f32_16x16x32_bf16 v[172:175], v[40:43], v[208:211], v[172:175]
    s_min_u32 s27, s27, s58
    v_add_f32 v6, v6, v18
    v_add_f32 v6, v6, v19
    v_mfma_f32_16x16x32_bf16 v[172:175], v[44:47], v[212:215], v[172:175]
    s_waitcnt lgkmcnt(2)
    s_waitcnt vmcnt(11)
    buffer_load_dwordx3 v[148:150], v12, s[68:71], s35 offen offset:768 nt
    v_cvt_pk_bf16_f32 v87, v18, v19
    v_exp_f32 v16, v88
    v_and_b32 v49, s97, v56
    v_mfma_f32_16x16x32_bf16 v[96:99], v[24:27], a[200:203], v[96:99]
    s_add_u32 s56, s56, 36864
    ds_read_b128 v[40:43], v2 offset:6400
    v_lshlrev_b32 v50, 16, v58
    v_mfma_f32_16x16x32_bf16 v[96:99], v[28:31], a[204:207], v[96:99]
    s_waitcnt vmcnt(11)
    buffer_load_dwordx3 v[152:154], v12, s[68:71], s35 offen offset:1536 nt
    v_exp_f32 v17, v89
    v_and_b32 v51, s97, v58
    v_mfma_f32_16x16x32_bf16 v[100:103], v[24:27], a[224:227], v[100:103]
    s_sub_u32 s58, s56, 147456
    v_exp_f32 v18, v90
    v_mfma_f32_16x16x32_bf16 v[100:103], v[28:31], a[228:231], v[100:103]
    buffer_load_dwordx3 v[156:158], v12, s[68:71], s35 offen offset:2304 nt
    v_add_f32 v7, v7, v16
    v_add_f32 v7, v7, v17
    v_mul_f32 v48, s38, v48
    v_mfma_f32_16x16x32_bf16 v[104:107], v[24:27], a[248:251], v[104:107]
    s_min_u32 s56, s56, s58
    ds_read_b128 v[44:47], v3 offset:6400
    v_mul_f32 v49, s38, v49
    v_mfma_f32_16x16x32_bf16 v[104:107], v[28:31], a[252:255], v[104:107]
    v_exp_f32 v19, v91
    v_cvt_pk_bf16_f32 v88, v16, v17
    v_exp_f32 v16, v120
    v_mfma_f32_16x16x32_bf16 v[108:111], v[24:27], v[208:211], v[108:111]
    v_add_f32 v7, v7, v18
    v_add_f32 v7, v7, v19
    v_mfma_f32_16x16x32_bf16 v[108:111], v[28:31], v[212:215], v[108:111]
    s_waitcnt lgkmcnt(2)
    v_exp_f32 v17, v121
    v_mul_f32_e64 v50, -v50, v48
    v_mul_f32_e64 v51, -v51, v49
    v_cvt_pk_bf16_f32 v89, v18, v19
    v_cvt_f32_i32 v224, v224
    v_mfma_f32_16x16x32_bf16 v[160:163], v[32:35], a[208:211], v[160:163]
    ds_read_b128 v[24:27], v2 offset:12288
    v_cvt_f32_i32 v225, v225
    v_mfma_f32_16x16x32_bf16 v[160:163], v[36:39], a[212:215], v[160:163]
    v_exp_f32 v18, v122
    v_fma_f32 v224, v224, v48, v50
    v_add_f32 v7, v7, v16
    v_fma_f32 v225, v225, v49, v51
    v_mfma_f32_16x16x32_bf16 v[164:167], v[32:35], a[232:235], v[164:167]
    v_add_f32 v7, v7, v17
    v_cvt_pk_bf16_f32 v224, v224, v225
    v_mfma_f32_16x16x32_bf16 v[164:167], v[36:39], a[236:239], v[164:167]
    v_exp_f32 v19, v123
    v_cvt_f32_i32 v228, v228
    v_cvt_f32_i32 v229, v229
    v_cvt_pk_bf16_f32 v90, v16, v17
    v_mfma_f32_16x16x32_bf16 v[168:171], v[32:35], v[192:195], v[168:171]
    ds_read_b128 v[28:31], v3 offset:12288
    v_fma_f32 v228, v228, v48, v50
    v_mfma_f32_16x16x32_bf16 v[168:171], v[36:39], v[196:199], v[168:171]
    v_exp_f32 v16, v92
    v_fma_f32 v229, v229, v49, v51
    v_cvt_pk_bf16_f32 v228, v228, v229
    v_add_f32 v7, v7, v18
    v_mfma_f32_16x16x32_bf16 v[172:175], v[32:35], v[216:219], v[172:175]
    v_cvt_f32_i32 v232, v232
    v_add_f32 v7, v7, v19
    v_mfma_f32_16x16x32_bf16 v[172:175], v[36:39], v[220:223], v[172:175]
    s_waitcnt lgkmcnt(2)
    v_exp_f32 v17, v93
    v_cvt_f32_i32 v233, v233
    v_fma_f32 v232, v232, v48, v50
    v_fma_f32 v233, v233, v49, v51
    v_cvt_pk_bf16_f32 v91, v18, v19
    v_mfma_f32_16x16x32_bf16 v[96:99], v[40:43], a[208:211], v[96:99]
    ds_read_b128 v[32:35], v2 offset:18432
    v_cvt_pk_bf16_f32 v232, v232, v233
    v_mfma_f32_16x16x32_bf16 v[96:99], v[44:47], a[212:215], v[96:99]
    v_exp_f32 v18, v94
    v_cvt_f32_i32 v236, v236
    v_cvt_f32_i32 v237, v237
    v_add_f32 v8, v8, v16
    v_mfma_f32_16x16x32_bf16 v[100:103], v[40:43], a[232:235], v[100:103]
    v_fma_f32 v236, v236, v48, v50
    v_add_f32 v8, v8, v17
    v_mfma_f32_16x16x32_bf16 v[100:103], v[44:47], a[236:239], v[100:103]
L_iw1:
L_pg1:
    s_cbranch_execz L_pg5
    v_exp_f32 v19, v95
    v_fma_f32 v237, v237, v49, v51
    v_cvt_pk_bf16_f32 v236, v236, v237
    v_lshlrev_b32 v48, 16, v57
    v_mfma_f32_16x16x32_bf16 v[104:107], v[40:43], v[192:195], v[104:107]
    ds_read_b128 v[36:39], v3 offset:18432
    v_cvt_pk_bf16_f32 v92, v16, v17
    v_mfma_f32_16x16x32_bf16 v[104:107], v[44:47], v[196:199], v[104:107]
    v_exp_f32 v16, v124
    v_and_b32 v49, s97, v57
    v_lshlrev_b32 v50, 16, v59
    v_and_b32 v51, s97, v59
    v_mfma_f32_16x16x32_bf16 v[108:111], v[40:43], v[216:219], v[108:111]
    v_add_f32 v8, v8, v18
    v_mul_f32 v48, s38, v48
    v_mfma_f32_16x16x32_bf16 v[108:111], v[44:47], v[220:223], v[108:111]
    s_waitcnt lgkmcnt(2)
    v_add_f32 v8, v8, v19
    v_mul_f32 v49, s38, v49
    v_exp_f32 v17, v125
    v_mul_f32_e64 v50, -v50, v48
    v_mul_f32_e64 v51, -v51, v49
    v_mfma_f32_16x16x32_bf16 v[176:179], v[24:27], a[192:195], v[128:131]
    ds_read_b128 v[40:43], v2 offset:12416
    v_cvt_pk_bf16_f32 v93, v18, v19
    v_mfma_f32_16x16x32_bf16 v[176:179], v[28:31], a[196:199], v[176:179]
    v_exp_f32 v18, v126
    v_cvt_f32_i32 v226, v226
    v_cvt_f32_i32 v227, v227
    v_fma_f32 v226, v226, v48, v50
    v_mfma_f32_16x16x32_bf16 v[180:183], v[24:27], a[216:219], v[132:135]
    v_add_f32 v8, v8, v16
    v_fma_f32 v227, v227, v49, v51
    v_mfma_f32_16x16x32_bf16 v[180:183], v[28:31], a[220:223], v[180:183]
    v_add_f32 v8, v8, v17
    v_cvt_pk_bf16_f32 v225, v226, v227
    v_exp_f32 v19, v127
    v_cvt_f32_i32 v230, v230
    v_mfma_f32_16x16x32_bf16 v[184:187], v[24:27], a[240:243], v[136:139]
    ds_read_b128 v[44:47], v3 offset:12416
    v_cvt_f32_i32 v231, v231
    v_mfma_f32_16x16x32_bf16 v[184:187], v[28:31], a[244:247], v[184:187]
    v_cvt_pk_bf16_f32 v94, v16, v17
    v_fma_f32 v230, v230, v48, v50
    v_add_f32 v8, v8, v18
    v_fma_f32 v231, v231, v49, v51
    v_cvt_pk_bf16_f32 v229, v230, v231
    v_mfma_f32_16x16x32_bf16 v[188:191], v[24:27], v[200:203], v[140:143]
    v_add_f32 v8, v8, v19
    v_cvt_pk_bf16_f32 v95, v18, v19
    v_mfma_f32_16x16x32_bf16 v[188:191], v[28:31], v[204:207], v[188:191]
    s_waitcnt lgkmcnt(2)
    v_cvt_f32_i32 v234, v234
    v_cvt_f32_i32 v235, v235
    v_exp_f32 v16, v160
    v_fma_f32 v234, v234, v48, v50
    v_fma_f32 v235, v235, v49, v51
    v_mfma_f32_16x16x32_bf16 v[112:115], v[32:35], a[192:195], v[128:131]
    ds_read_b128 v[24:27], v2 offset:18560
    v_cvt_pk_bf16_f32 v233, v234, v235
    v_mfma_f32_16x16x32_bf16 v[112:115], v[36:39], a[196:199], v[112:115]
    v_exp_f32 v17, v161
    v_exp_f32 v18, v162
    v_add_f32 v5, v5, v16
    v_mfma_f32_16x16x32_bf16 v[116:119], v[32:35], a[216:219], v[132:135]
    v_cvt_f32_i32 v238, v238
    v_cvt_f32_i32 v239, v239
    v_mfma_f32_16x16x32_bf16 v[116:119], v[36:39], a[220:223], v[116:119]
    v_fma_f32 v238, v238, v48, v50
    v_add_f32 v5, v5, v17
    v_exp_f32 v19, v163
    v_cvt_pk_bf16_f32 v160, v16, v17
    v_mfma_f32_16x16x32_bf16 v[120:123], v[32:35], a[240:243], v[136:139]
    ds_read_b128 v[28:31], v3 offset:18560
    v_fma_f32 v239, v239, v49, v51
    v_cvt_pk_bf16_f32 v237, v238, v239
    v_mfma_f32_16x16x32_bf16 v[120:123], v[36:39], a[244:247], v[120:123]
    s_waitcnt vmcnt(16)
    v_lshlrev_b32 v48, 16, v60
    v_and_b32 v49, s97, v60
    v_lshlrev_b32 v50, 16, v62
    v_and_b32 v51, s97, v62
    v_mul_f32 v48, s38, v48
    v_mfma_f32_16x16x32_bf16 v[124:127], v[32:35], v[200:203], v[140:143]
    v_mul_f32 v49, s38, v49
    v_mul_f32_e64 v50, -v50, v48
    v_mfma_f32_16x16x32_bf16 v[124:127], v[36:39], v[204:207], v[124:127]
    s_waitcnt lgkmcnt(2)
    s_waitcnt vmcnt(12)
    buffer_load_dwordx2 v[56:57], off, s[80:83], s37 offset:0
    v_mul_f32_e64 v51, -v51, v49
    v_cvt_f32_i32 v240, v240
    v_cvt_f32_i32 v241, v241
    v_mfma_f32_16x16x32_bf16 v[176:179], v[40:43], a[200:203], v[176:179]
    ds_read_b128 v[32:35], v2 offset:12544
    v_fma_f32 v240, v240, v48, v50
    v_mfma_f32_16x16x32_bf16 v[176:179], v[44:47], a[204:207], v[176:179]
    buffer_load_dwordx2 v[58:59], off, s[84:87], s37 offset:0
    v_exp_f32 v16, v96
    v_fma_f32 v241, v241, v49, v51
    v_mfma_f32_16x16x32_bf16 v[180:183], v[40:43], a[224:227], v[180:183]
    v_cvt_pk_bf16_f32 v226, v240, v241
    v_add_f32 v5, v5, v18
    v_mfma_f32_16x16x32_bf16 v[180:183], v[44:47], a[228:231], v[180:183]
    v_cvt_f32_i32 v244, v244
    v_add_f32 v5, v5, v19
    v_cvt_f32_i32 v245, v245
    v_exp_f32 v17, v97
    v_fma_f32 v244, v244, v48, v50
    v_mfma_f32_16x16x32_bf16 v[184:187], v[40:43], a[248:251], v[184:187]
    ds_read_b128 v[36:39], v3 offset:12544
    v_fma_f32 v245, v245, v49, v51
    v_mfma_f32_16x16x32_bf16 v[184:187], v[44:47], a[252:255], v[184:187]
    v_cvt_pk_bf16_f32 v161, v18, v19
    v_cvt_pk_bf16_f32 v230, v244, v245
    v_exp_f32 v18, v98
    v_cvt_f32_i32 v248, v248
    v_mfma_f32_16x16x32_bf16 v[188:191], v[40:43], v[208:211], v[188:191]
    v_cvt_f32_i32 v249, v249
    v_add_f32 v5, v5, v16
    v_mfma_f32_16x16x32_bf16 v[188:191], v[44:47], v[212:215], v[188:191]
    s_waitcnt lgkmcnt(2)
    v_fma_f32 v248, v248, v48, v50
    v_add_f32 v5, v5, v17
    v_fma_f32 v249, v249, v49, v51
    v_exp_f32 v19, v99
    v_mfma_f32_16x16x32_bf16 v[112:115], v[24:27], a[200:203], v[112:115]
    ds_read_b128 v[40:43], v2 offset:18688
    v_cvt_pk_bf16_f32 v234, v248, v249
    v_mfma_f32_16x16x32_bf16 v[112:115], v[28:31], a[204:207], v[112:115]
    v_cvt_f32_i32 v252, v252
    v_cvt_pk_bf16_f32 v162, v16, v17
    v_cvt_f32_i32 v253, v253
    v_exp_f32 v16, v164
    v_mfma_f32_16x16x32_bf16 v[116:119], v[24:27], a[224:227], v[116:119]
    v_fma_f32 v252, v252, v48, v50
    v_fma_f32 v253, v253, v49, v51
    v_mfma_f32_16x16x32_bf16 v[116:119], v[28:31], a[228:231], v[116:119]
    v_add_f32 v5, v5, v18
    v_cvt_pk_bf16_f32 v238, v252, v253
    v_add_f32 v5, v5, v19
    v_lshlrev_b32 v48, 16, v61
    v_exp_f32 v17, v165
    v_mfma_f32_16x16x32_bf16 v[120:123], v[24:27], a[248:251], v[120:123]
    ds_read_b128 v[44:47], v3 offset:18688
    v_and_b32 v49, s97, v61
    v_mfma_f32_16x16x32_bf16 v[120:123], v[28:31], a[252:255], v[120:123]
    s_waitcnt lgkmcnt(2)
    v_lshlrev_b32 v50, 16, v63
    v_cvt_pk_bf16_f32 v163, v18, v19
    v_and_b32 v51, s97, v63
    v_exp_f32 v18, v166
    v_mfma_f32_16x16x32_bf16 v[124:127], v[24:27], v[208:211], v[124:127]
    s_waitcnt vmcnt(30)
    v_mul_f32 v48, s38, v48
    v_mul_f32 v49, s38, v49
    v_mfma_f32_16x16x32_bf16 v[124:127], v[28:31], v[212:215], v[124:127]
    s_barrier
    v_add_f32 v6, v6, v16
    v_mul_f32_e64 v50, -v50, v48
    v_add_f32 v6, v6, v17
    v_mul_f32_e64 v51, -v51, v49
    v_mfma_f32_16x16x32_bf16 v[176:179], v[32:35], a[208:211], v[176:179]
    ds_read_b128 v[24:27], v1 offset:0
    v_cvt_f32_i32 v242, v242
    v_mfma_f32_16x16x32_bf16 v[176:179], v[36:39], a[212:215], v[176:179]
    v_exp_f32 v19, v167
    v_cvt_f32_i32 v243, v243
    v_cvt_pk_bf16_f32 v164, v16, v17
    v_fma_f32 v242, v242, v48, v50
    v_mfma_f32_16x16x32_bf16 v[180:183], v[32:35], a[232:235], v[180:183]
    v_exp_f32 v16, v100
    v_mfma_f32_16x16x32_bf16 v[180:183], v[36:39], a[236:239], v[180:183]
    v_fma_f32 v243, v243, v49, v51
    v_cvt_pk_bf16_f32 v227, v242, v243
    v_add_f32 v6, v6, v18
    v_cvt_f32_i32 v246, v246
    v_add_f32 v6, v6, v19
    v_cvt_f32_i32 v247, v247
    v_mfma_f32_16x16x32_bf16 v[184:187], v[32:35], v[192:195], v[184:187]
    ds_read_b128 v[28:31], v1 offset:12288
    v_fma_f32 v246, v246, v48, v50
    v_mfma_f32_16x16x32_bf16 v[184:187], v[36:39], v[196:199], v[184:187]
    v_exp_f32 v17, v101
    v_fma_f32 v247, v247, v49, v51
    v_cvt_pk_bf16_f32 v165, v18, v19
    v_cvt_pk_bf16_f32 v231, v246, v247
    v_mfma_f32_16x16x32_bf16 v[188:191], v[32:35], v[216:219], v[188:191]
    v_exp_f32 v18, v102
    v_mfma_f32_16x16x32_bf16 v[188:191], v[36:39], v[220:223], v[188:191]
    s_waitcnt lgkmcnt(2)
    v_cvt_f32_i32 v250, v250
    v_cvt_f32_i32 v251, v251
    v_add_f32 v6, v6, v16
    v_fma_f32 v250, v250, v48, v50
    v_add_f32 v6, v6, v17
    v_mfma_f32_16x16x32_bf16 v[112:115], v[40:43], a[208:211], v[112:115]
    ds_read_b128 v[32:35], v1 offset:1024
    v_fma_f32 v251, v251, v49, v51
    v_mfma_f32_16x16x32_bf16 v[112:115], v[44:47], a[212:215], v[112:115]
    v_exp_f32 v19, v103
    v_cvt_pk_bf16_f32 v235, v250, v251
    v_cvt_f32_i32 v254, v254
    v_cvt_pk_bf16_f32 v166, v16, v17
    v_mfma_f32_16x16x32_bf16 v[116:119], v[40:43], a[232:235], v[116:119]
    v_cvt_f32_i32 v255, v255
    v_add_f32 v6, v6, v18
    v_mfma_f32_16x16x32_bf16 v[116:119], v[44:47], a[236:239], v[116:119]
    v_fma_f32 v254, v254, v48, v50
    v_add_f32 v6, v6, v19
    v_fma_f32 v255, v255, v49, v51
    v_cvt_pk_bf16_f32 v167, v18, v19
    v_cvt_pk_bf16_f32 v239, v254, v255
    v_mfma_f32_16x16x32_bf16 v[120:123], v[40:43], v[192:195], v[120:123]
    ds_read_b128 v[36:39], v1 offset:13312
    v_mfma_f32_16x16x32_bf16 v[120:123], v[44:47], v[196:199], v[120:123]
    v_mfma_f32_16x16x32_bf16 v[124:127], v[40:43], v[216:219], v[124:127]
    v_mfma_f32_16x16x32_bf16 v[124:127], v[44:47], v[220:223], v[124:127]
    s_waitcnt lgkmcnt(2)
    v_mfma_f32_16x16x32_bf16 a[144:147], v[76:79], v[24:27], 0
    ds_read_b128 v[40:43], v1 offset:2048
    v_mfma_f32_16x16x32_bf16 a[144:147], v[92:95], v[28:31], a[144:147]
    buffer_store_dwordx4 v[224:227], v11, s[4:7], s33 offen offset:0 sc1
    v_mfma_f32_16x16x32_bf16 a[96:99], v[72:75], v[24:27], 0
    v_exp_f32 v16, v168
    v_mfma_f32_16x16x32_bf16 a[96:99], v[88:91], v[28:31], a[96:99]
    ds_read_b128 v[44:47], v1 offset:14336
    v_mfma_f32_16x16x32_bf16 a[0:3], v[80:83], v[28:31], a[0:3]
    v_exp_f32 v17, v169
    v_mfma_f32_16x16x32_bf16 a[48:51], v[84:87], v[28:31], a[48:51]
    s_waitcnt lgkmcnt(2)
    v_exp_f32 v18, v170
    v_mfma_f32_16x16x32_bf16 a[148:151], v[76:79], v[32:35], 0
    ds_read_b128 v[24:27], v1 offset:3072
    v_add_f32 v7, v7, v16
    v_mfma_f32_16x16x32_bf16 a[148:151], v[92:95], v[36:39], a[148:151]
    v_add_f32 v7, v7, v17
    v_mfma_f32_16x16x32_bf16 a[100:103], v[72:75], v[32:35], 0
    v_exp_f32 v19, v171
    v_mfma_f32_16x16x32_bf16 a[100:103], v[88:91], v[36:39], a[100:103]
    ds_read_b128 v[28:31], v1 offset:15360
    v_cvt_pk_bf16_f32 v168, v16, v17
    v_mfma_f32_16x16x32_bf16 a[4:7], v[80:83], v[36:39], a[4:7]
    v_exp_f32 v16, v104
    v_mfma_f32_16x16x32_bf16 a[52:55], v[84:87], v[36:39], a[52:55]
    s_waitcnt lgkmcnt(2)
    v_add_f32 v7, v7, v18
    v_add_f32 v7, v7, v19
    v_mfma_f32_16x16x32_bf16 a[152:155], v[76:79], v[40:43], 0
    ds_read_b128 v[32:35], v1 offset:4096
    v_mfma_f32_16x16x32_bf16 a[152:155], v[92:95], v[44:47], a[152:155]
    buffer_store_dwordx4 v[228:231], v21, s[4:7], s33 offen offset:768 sc1
    v_mfma_f32_16x16x32_bf16 a[104:107], v[72:75], v[40:43], 0
    v_exp_f32 v17, v105
    v_mfma_f32_16x16x32_bf16 a[104:107], v[88:91], v[44:47], a[104:107]
    ds_read_b128 v[36:39], v1 offset:16384
    v_cvt_pk_bf16_f32 v169, v18, v19
    v_mfma_f32_16x16x32_bf16 a[8:11], v[80:83], v[44:47], a[8:11]
    v_exp_f32 v18, v106
    v_mfma_f32_16x16x32_bf16 a[56:59], v[84:87], v[44:47], a[56:59]
    s_waitcnt lgkmcnt(2)
    v_add_f32 v7, v7, v16
    v_add_f32 v7, v7, v17
    v_mfma_f32_16x16x32_bf16 a[156:159], v[76:79], v[24:27], 0
    ds_read_b128 v[40:43], v1 offset:5120
    v_mfma_f32_16x16x32_bf16 a[156:159], v[92:95], v[28:31], a[156:159]
    v_exp_f32 v19, v107
    v_cvt_pk_bf16_f32 v170, v16, v17
    v_mfma_f32_16x16x32_bf16 a[108:111], v[72:75], v[24:27], 0
    v_exp_f32 v16, v172
    v_mfma_f32_16x16x32_bf16 a[108:111], v[88:91], v[28:31], a[108:111]
    ds_read_b128 v[44:47], v1 offset:17408
    v_add_f32 v7, v7, v18
    v_add_f32 v7, v7, v19
    v_mfma_f32_16x16x32_bf16 a[12:15], v[80:83], v[28:31], a[12:15]
    v_exp_f32 v17, v173
    v_mfma_f32_16x16x32_bf16 a[60:63], v[84:87], v[28:31], a[60:63]
    s_waitcnt lgkmcnt(2)
    v_cvt_pk_bf16_f32 v171, v18, v19
    v_mfma_f32_16x16x32_bf16 a[160:163], v[76:79], v[32:35], 0
    ds_read_b128 v[24:27], v1 offset:6144
    v_mfma_f32_16x16x32_bf16 a[160:163], v[92:95], v[36:39], a[160:163]
    buffer_store_dwordx4 v[232:235], v22, s[4:7], s33 offen offset:1536 sc1
    v_mfma_f32_16x16x32_bf16 a[112:115], v[72:75], v[32:35], 0
    v_exp_f32 v18, v174
    v_mfma_f32_16x16x32_bf16 a[112:115], v[88:91], v[36:39], a[112:115]
    ds_read_b128 v[28:31], v1 offset:18432
    v_add_f32 v8, v8, v16
    v_add_f32 v8, v8, v17
    v_mfma_f32_16x16x32_bf16 a[16:19], v[80:83], v[36:39], a[16:19]
    v_exp_f32 v19, v175
    v_mfma_f32_16x16x32_bf16 a[64:67], v[84:87], v[36:39], a[64:67]
    s_waitcnt lgkmcnt(2)
    v_cvt_pk_bf16_f32 v172, v16, v17
    v_exp_f32 v16, v108
    v_mfma_f32_16x16x32_bf16 a[164:167], v[76:79], v[40:43], 0
    ds_read_b128 v[32:35], v1 offset:7168
    v_add_f32 v8, v8, v18
    v_mfma_f32_16x16x32_bf16 a[164:167], v[92:95], v[44:47], a[164:167]
    v_add_f32 v8, v8, v19
    v_exp_f32 v17, v109
    v_mfma_f32_16x16x32_bf16 a[116:119], v[72:75], v[40:43], 0
    v_cvt_pk_bf16_f32 v173, v18, v19
    v_mfma_f32_16x16x32_bf16 a[116:119], v[88:91], v[44:47], a[116:119]
    ds_read_b128 v[36:39], v1 offset:19456
    v_exp_f32 v18, v110
    v_mfma_f32_16x16x32_bf16 a[20:23], v[80:83], v[44:47], a[20:23]
    v_add_f32 v8, v8, v16
    v_add_f32 v8, v8, v17
    v_mfma_f32_16x16x32_bf16 a[68:71], v[84:87], v[44:47], a[68:71]
    s_waitcnt lgkmcnt(2)
    v_exp_f32 v19, v111
    v_mfma_f32_16x16x32_bf16 a[168:171], v[76:79], v[24:27], 0
    ds_read_b128 v[40:43], v1 offset:8192
    v_cvt_pk_bf16_f32 v174, v16, v17
    v_mfma_f32_16x16x32_bf16 a[168:171], v[92:95], v[28:31], a[168:171]
    buffer_store_dwordx4 v[236:239], v23, s[4:7], s33 offen offset:2304 sc1
    v_mfma_f32_16x16x32_bf16 a[120:123], v[72:75], v[24:27], 0
    v_add_f32 v8, v8, v18
    v_add_f32 v8, v8, v19
    v_mfma_f32_16x16x32_bf16 a[120:123], v[88:91], v[28:31], a[120:123]
    ds_read_b128 v[44:47], v1 offset:20480
    v_cvt_pk_bf16_f32 v175, v18, v19
    v_mfma_f32_16x16x32_bf16 a[24:27], v[80:83], v[28:31], a[24:27]
    v_exp_f32 v16, v176
    v_mfma_f32_16x16x32_bf16 a[72:75], v[84:87], v[28:31], a[72:75]
    s_waitcnt lgkmcnt(2)
    v_exp_f32 v17, v177
    v_mfma_f32_16x16x32_bf16 a[172:175], v[76:79], v[32:35], 0
    ds_read_b128 v[24:27], v1 offset:9216
    v_mfma_f32_16x16x32_bf16 a[172:175], v[92:95], v[36:39], a[172:175]
    v_exp_f32 v18, v178
    v_add_f32 v5, v5, v16
    v_mfma_f32_16x16x32_bf16 a[124:127], v[72:75], v[32:35], 0
    v_add_f32 v5, v5, v17
    v_mfma_f32_16x16x32_bf16 a[124:127], v[88:91], v[36:39], a[124:127]
    ds_read_b128 v[28:31], v1 offset:21504
    v_exp_f32 v19, v179
    v_mfma_f32_16x16x32_bf16 a[28:31], v[80:83], v[36:39], a[28:31]
    v_cvt_pk_bf16_f32 v176, v16, v17
    v_mfma_f32_16x16x32_bf16 a[76:79], v[84:87], v[36:39], a[76:79]
    s_waitcnt lgkmcnt(2)
    buffer_load_dwordx2 v[60:61], off, s[80:83], s37 offset:8
    v_mfma_f32_16x16x32_bf16 a[176:179], v[76:79], v[40:43], 0
    ds_read_b128 v[32:35], v1 offset:10240
    v_mfma_f32_16x16x32_bf16 a[176:179], v[92:95], v[44:47], a[176:179]
    buffer_load_dwordx2 v[62:63], off, s[84:87], s37 offset:8
    v_mfma_f32_16x16x32_bf16 a[128:131], v[72:75], v[40:43], 0
    v_exp_f32 v16, v112
    v_mfma_f32_16x16x32_bf16 a[128:131], v[88:91], v[44:47], a[128:131]
    ds_read_b128 v[36:39], v1 offset:22528
    v_add_f32 v5, v5, v18
    v_add_f32 v5, v5, v19
    v_mfma_f32_16x16x32_bf16 a[32:35], v[80:83], v[44:47], a[32:35]
    v_exp_f32 v17, v113
    v_mfma_f32_16x16x32_bf16 a[80:83], v[84:87], v[44:47], a[80:83]
    s_waitcnt lgkmcnt(2)
    s_waitcnt vmcnt(19)
    buffer_load_dwordx3 v[240:242], v12, s[68:71], s16 offen offset:0 nt
    v_cvt_pk_bf16_f32 v177, v18, v19
    v_mfma_f32_16x16x32_bf16 a[180:183], v[76:79], v[24:27], 0
    ds_read_b128 v[40:43], v1 offset:11264
    v_mfma_f32_16x16x32_bf16 a[180:183], v[92:95], v[28:31], a[180:183]
    buffer_load_dwordx3 v[244:246], v12, s[68:71], s16 offen offset:768 nt
    v_mfma_f32_16x16x32_bf16 a[132:135], v[72:75], v[24:27], 0
    v_exp_f32 v18, v114
    v_mfma_f32_16x16x32_bf16 a[132:135], v[88:91], v[28:31], a[132:135]
    s_waitcnt vmcnt(20)
    ds_read_b128 v[44:47], v1 offset:23552
    v_add_f32 v5, v5, v16
    v_add_f32 v5, v5, v17
    v_mfma_f32_16x16x32_bf16 a[36:39], v[80:83], v[28:31], a[36:39]
    v_exp_f32 v19, v115
    v_mfma_f32_16x16x32_bf16 a[84:87], v[84:87], v[28:31], a[84:87]
    s_waitcnt lgkmcnt(2)
    s_barrier
    v_add_u32 v2, 49152, v2
    v_add_u32 v3, 49152, v3
    v_mfma_f32_16x16x32_bf16 a[184:187], v[76:79], v[32:35], 0
    ds_read_b128 v[24:27], v2 offset:0
    v_cvt_pk_bf16_f32 v178, v16, v17
    v_mfma_f32_16x16x32_bf16 a[184:187], v[92:95], v[36:39], a[184:187]
    buffer_load_dwordx3 v[248:250], v12, s[68:71], s16 offen offset:1536 nt
    v_mfma_f32_16x16x32_bf16 a[136:139], v[72:75], v[32:35], 0
    v_exp_f32 v16, v180
    v_mfma_f32_16x16x32_bf16 a[136:139], v[88:91], v[36:39], a[136:139]
    ds_read_b128 v[28:31], v3 offset:0
    v_add_f32 v5, v5, v18
    v_add_f32 v5, v5, v19
    v_mfma_f32_16x16x32_bf16 a[40:43], v[80:83], v[36:39], a[40:43]
    v_exp_f32 v17, v181
    v_mfma_f32_16x16x32_bf16 a[88:91], v[84:87], v[36:39], a[88:91]
    s_waitcnt lgkmcnt(2)
    s_waitcnt vmcnt(20)
    buffer_load_dwordx3 v[252:254], v12, s[68:71], s16 offen offset:2304 nt
    v_cvt_pk_bf16_f32 v179, v18, v19
    v_mfma_f32_16x16x32_bf16 a[188:191], v[76:79], v[40:43], 0
    ds_read_b128 v[32:35], v2 offset:6144
    v_mfma_f32_16x16x32_bf16 a[188:191], v[92:95], v[44:47], a[188:191]
    v_exp_f32 v18, v182
    v_add_f32 v6, v6, v16
    v_mfma_f32_16x16x32_bf16 a[140:143], v[72:75], v[40:43], 0
    v_add_f32 v6, v6, v17
    v_mfma_f32_16x16x32_bf16 a[140:143], v[88:91], v[44:47], a[140:143]
    ds_read_b128 v[36:39], v3 offset:6144
    v_exp_f32 v19, v183
    v_mfma_f32_16x16x32_bf16 a[44:47], v[80:83], v[44:47], a[44:47]
    v_cvt_pk_bf16_f32 v180, v16, v17
    v_mfma_f32_16x16x32_bf16 a[92:95], v[84:87], v[44:47], a[92:95]
    s_waitcnt lgkmcnt(2)
    v_exp_f32 v16, v116
    v_add_f32 v6, v6, v18
    v_add_f32 v6, v6, v19
    v_exp_f32 v17, v117
    v_cvt_pk_bf16_f32 v181, v18, v19
    v_exp_f32 v18, v118
    v_add_f32 v6, v6, v16
    v_add_f32 v6, v6, v17
    v_exp_f32 v19, v119
    v_cvt_pk_bf16_f32 v182, v16, v17
    v_add_f32 v6, v6, v18
    v_add_f32 v6, v6, v19
    v_cvt_pk_bf16_f32 v183, v18, v19
    v_mfma_f32_16x16x32_bf16 v[64:67], v[24:27], a[192:195], v[128:131]
    s_waitcnt vmcnt(10)
    ds_read_b128 v[40:43], v2 offset:128
    v_lshlrev_b32 v48, 16, v56
    v_mfma_f32_16x16x32_bf16 v[64:67], v[28:31], a[196:199], v[64:67]
    v_exp_f32 v16, v184
    v_mfma_f32_16x16x32_bf16 v[68:71], v[24:27], a[216:219], v[132:135]
    v_exp_f32 v17, v185
    v_mfma_f32_16x16x32_bf16 v[68:71], v[28:31], a[220:223], v[68:71]
    v_exp_f32 v18, v186
    v_mfma_f32_16x16x32_bf16 v[72:75], v[24:27], a[240:243], v[136:139]
    ds_read_b128 v[44:47], v3 offset:128
    v_and_b32 v49, s97, v56
    v_mfma_f32_16x16x32_bf16 v[72:75], v[28:31], a[244:247], v[72:75]
    v_add_f32 v7, v7, v16
    v_add_f32 v7, v7, v17
    v_mfma_f32_16x16x32_bf16 v[76:79], v[24:27], v[200:203], v[140:143]
    v_exp_f32 v19, v187
    v_mfma_f32_16x16x32_bf16 v[76:79], v[28:31], v[204:207], v[76:79]
    s_waitcnt lgkmcnt(2)
    v_lshlrev_b32 v50, 16, v58
    v_and_b32 v51, s97, v58
    v_mfma_f32_16x16x32_bf16 v[96:99], v[32:35], a[192:195], v[128:131]
    ds_read_b128 v[24:27], v2 offset:6272
    v_cvt_pk_bf16_f32 v184, v16, v17
    v_mfma_f32_16x16x32_bf16 v[96:99], v[36:39], a[196:199], v[96:99]
    v_exp_f32 v16, v120
    v_mfma_f32_16x16x32_bf16 v[100:103], v[32:35], a[216:219], v[132:135]
    v_mul_f32_e64 v50, -v50, v48
    v_add_f32 v7, v7, v18
    v_mfma_f32_16x16x32_bf16 v[100:103], v[36:39], a[220:223], v[100:103]
    v_add_f32 v7, v7, v19
    v_mul_f32_e64 v51, -v51, v49
    v_mfma_f32_16x16x32_bf16 v[104:107], v[32:35], a[240:243], v[136:139]
    ds_read_b128 v[28:31], v3 offset:6272
    v_cvt_f32_i32 v144, v144
    v_mfma_f32_16x16x32_bf16 v[104:107], v[36:39], a[244:247], v[104:107]
    s_waitcnt lgkmcnt(2)
    v_exp_f32 v17, v121
    v_mfma_f32_16x16x32_bf16 v[108:111], v[32:35], v[200:203], v[140:143]
    s_waitcnt vmcnt(6)
    v_cvt_pk_bf16_f32 v185, v18, v19
    v_cvt_f32_i32 v148, v148
    v_mfma_f32_16x16x32_bf16 v[108:111], v[36:39], v[204:207], v[108:111]
    s_barrier
    v_mfma_f32_16x16x32_bf16 v[64:67], v[40:43], a[200:203], v[64:67]
    ds_read_b128 v[32:35], v2 offset:256
    v_add_u32 v0, 1, v0
    v_mfma_f32_16x16x32_bf16 v[64:67], v[44:47], a[204:207], v[64:67]
    buffer_store_dword v0, v13, s[20:23], 0 offen offset:32 sc1
    v_mfma_f32_16x16x32_bf16 v[68:71], v[40:43], a[224:227], v[68:71]
    s_mov_b32 m0, s26
    v_exp_f32 v18, v122
    v_mfma_f32_16x16x32_bf16 v[68:71], v[44:47], a[228:231], v[68:71]
    v_add_f32 v7, v7, v16
    v_add_f32 v7, v7, v17
    v_mfma_f32_16x16x32_bf16 v[72:75], v[40:43], a[248:251], v[72:75]
    ds_read_b128 v[36:39], v3 offset:256
    v_fma_f32 v144, v144, v48, v50
    v_mfma_f32_16x16x32_bf16 v[72:75], v[44:47], a[252:255], v[72:75]
    buffer_load_dwordx4 v4, s[4:7], s32 offen offset:0 sc1 lds
    v_mfma_f32_16x16x32_bf16 v[76:79], v[40:43], v[208:211], v[76:79]
    v_exp_f32 v19, v123
    v_mfma_f32_16x16x32_bf16 v[76:79], v[44:47], v[212:215], v[76:79]
    s_waitcnt lgkmcnt(2)
    v_cvt_pk_bf16_f32 v186, v16, v17
    v_fma_f32 v148, v148, v49, v51
    v_mfma_f32_16x16x32_bf16 v[96:99], v[24:27], a[200:203], v[96:99]
    ds_read_b128 v[40:43], v2 offset:6400
    v_cvt_f32_i32 v145, v145
    v_mfma_f32_16x16x32_bf16 v[96:99], v[28:31], a[204:207], v[96:99]
    buffer_load_dwordx4 v4, s[4:7], s32 offen offset:1024 sc1 lds
    v_mfma_f32_16x16x32_bf16 v[100:103], v[24:27], a[224:227], v[100:103]
    v_exp_f32 v16, v188
    v_mfma_f32_16x16x32_bf16 v[100:103], v[28:31], a[228:231], v[100:103]
    v_add_f32 v7, v7, v18
    v_add_f32 v7, v7, v19
    v_mfma_f32_16x16x32_bf16 v[104:107], v[24:27], a[248:251], v[104:107]
    ds_read_b128 v[44:47], v3 offset:6400
    v_cvt_f32_i32 v149, v149
    v_mfma_f32_16x16x32_bf16 v[104:107], v[28:31], a[252:255], v[104:107]
    buffer_load_dwordx4 v4, s[4:7], s32 offen offset:2048 sc1 lds
    v_mfma_f32_16x16x32_bf16 v[108:111], v[24:27], v[208:211], v[108:111]
    s_add_u32 s32, s32, 24576
    v_exp_f32 v17, v189
    v_mfma_f32_16x16x32_bf16 v[108:111], v[28:31], v[212:215], v[108:111]
    s_waitcnt lgkmcnt(2)
    v_cvt_pk_bf16_f32 v187, v18, v19
    v_fma_f32 v145, v145, v48, v50
    v_mfma_f32_16x16x32_bf16 v[64:67], v[32:35], a[208:211], v[64:67]
    s_sub_u32 s57, s32, 196608
    ds_read_b128 v[24:27], v2 offset:12288
    v_fma_f32 v149, v149, v49, v51
    v_mfma_f32_16x16x32_bf16 v[64:67], v[36:39], a[212:215], v[64:67]
    s_min_u32 s32, s32, s57
    v_exp_f32 v18, v190
    v_mfma_f32_16x16x32_bf16 v[68:71], v[32:35], a[232:235], v[68:71]
    s_add_u32 s26, s26, 12288
    v_add_f32 v8, v8, v16
    v_add_f32 v8, v8, v17
    v_mfma_f32_16x16x32_bf16 v[68:71], v[36:39], a[236:239], v[68:71]
    s_mov_b32 m0, s26
    v_exp_f32 v19, v191
    v_mfma_f32_16x16x32_bf16 v[72:75], v[32:35], v[192:195], v[72:75]
    ds_read_b128 v[28:31], v3 offset:12288
    v_cvt_pk_bf16_f32 v188, v16, v17
    v_mfma_f32_16x16x32_bf16 v[72:75], v[36:39], v[196:199], v[72:75]
    v_exp_f32 v16, v124
    v_mfma_f32_16x16x32_bf16 v[76:79], v[32:35], v[216:219], v[76:79]
    v_add_f32 v8, v8, v18
    v_add_f32 v8, v8, v19
    v_mfma_f32_16x16x32_bf16 v[76:79], v[36:39], v[220:223], v[76:79]
    s_waitcnt lgkmcnt(2)
    buffer_load_dwordx4 v4, s[4:7], s32 offen offset:0 sc1 lds
    v_mfma_f32_16x16x32_bf16 v[96:99], v[40:43], a[208:211], v[96:99]
    ds_read_b128 v[32:35], v2 offset:18432
    v_cvt_f32_i32 v146, v146
    v_mfma_f32_16x16x32_bf16 v[96:99], v[44:47], a[212:215], v[96:99]
    v_exp_f32 v17, v125
    v_mfma_f32_16x16x32_bf16 v[100:103], v[40:43], a[232:235], v[100:103]
    v_cvt_pk_bf16_f32 v189, v18, v19
    v_cvt_f32_i32 v150, v150
    v_mfma_f32_16x16x32_bf16 v[100:103], v[44:47], a[236:239], v[100:103]
    buffer_load_dwordx4 v4, s[4:7], s32 offen offset:1024 sc1 lds
    v_mfma_f32_16x16x32_bf16 v[104:107], v[40:43], v[192:195], v[104:107]
    ds_read_b128 v[36:39], v3 offset:18432
    v_fma_f32 v146, v146, v48, v50
    v_mfma_f32_16x16x32_bf16 v[104:107], v[44:47], v[196:199], v[104:107]
    v_exp_f32 v18, v126
    v_mfma_f32_16x16x32_bf16 v[108:111], v[40:43], v[216:219], v[108:111]
    v_add_f32 v8, v8, v16
    v_add_f32 v8, v8, v17
    v_mfma_f32_16x16x32_bf16 v[108:111], v[44:47], v[220:223], v[108:111]
    s_waitcnt lgkmcnt(2)
    buffer_load_dwordx4 v4, s[4:7], s32 offen offset:2048 sc1 lds
    v_mfma_f32_16x16x32_bf16 v[80:83], v[24:27], a[192:195], v[128:131]
    s_mov_b32 s32, 196608
    ds_read_b128 v[40:43], v2 offset:12416
    v_fma_f32 v150, v150, v49, v51
    v_mfma_f32_16x16x32_bf16 v[80:83], v[28:31], a[196:199], v[80:83]
    v_exp_f32 v19, v127
    v_cvt_pk_bf16_f32 v190, v16, v17
    v_mfma_f32_16x16x32_bf16 v[84:87], v[24:27], a[216:219], v[132:135]
    s_add_u32 s26, s26, 36864
    v_add_f32 v8, v8, v18
    v_add_f32 v8, v8, v19
    v_mfma_f32_16x16x32_bf16 v[84:87], v[28:31], a[220:223], v[84:87]
    s_sub_u32 s57, s26, 147456
    v_cvt_pk_bf16_f32 v191, v18, v19
    v_lshlrev_b32 v48, 16, v57
    v_mfma_f32_16x16x32_bf16 v[88:91], v[24:27], a[240:243], v[136:139]
    ds_read_b128 v[44:47], v3 offset:12416
    v_and_b32 v49, s97, v57
    v_mfma_f32_16x16x32_bf16 v[88:91], v[28:31], a[244:247], v[88:91]
    s_min_u32 s26, s26, s57
    v_exp_f32 v16, v64
    v_mfma_f32_16x16x32_bf16 v[92:95], v[24:27], v[200:203], v[140:143]
    v_exp_f32 v17, v65
    v_mfma_f32_16x16x32_bf16 v[92:95], v[28:31], v[204:207], v[92:95]
    s_waitcnt lgkmcnt(2)
    v_exp_f32 v18, v66
    v_mfma_f32_16x16x32_bf16 v[112:115], v[32:35], a[192:195], v[128:131]
    s_mov_b32 m0, s56
    ds_read_b128 v[24:27], v2 offset:18560
    v_lshlrev_b32 v50, 16, v59
    v_mfma_f32_16x16x32_bf16 v[112:115], v[36:39], a[196:199], v[112:115]
    v_add_f32 v5, v5, v16
    v_add_f32 v5, v5, v17
    v_mfma_f32_16x16x32_bf16 v[116:119], v[32:35], a[216:219], v[132:135]
    v_exp_f32 v19, v67
    v_mfma_f32_16x16x32_bf16 v[116:119], v[36:39], a[220:223], v[116:119]
    buffer_load_dwordx4 v4, s[4:7], s27 offen offset:0 sc1 lds
    v_mfma_f32_16x16x32_bf16 v[120:123], v[32:35], a[240:243], v[136:139]
    ds_read_b128 v[28:31], v3 offset:18560
    v_and_b32 v51, s97, v59
    v_mfma_f32_16x16x32_bf16 v[120:123], v[36:39], a[244:247], v[120:123]
    v_cvt_pk_bf16_f32 v64, v16, v17
    v_mul_f32_e64 v50, -v50, v48
    v_mfma_f32_16x16x32_bf16 v[124:127], v[32:35], v[200:203], v[140:143]
    v_exp_f32 v16, v96
    v_mfma_f32_16x16x32_bf16 v[124:127], v[36:39], v[204:207], v[124:127]
    s_waitcnt lgkmcnt(2)
    buffer_load_dwordx4 v4, s[4:7], s27 offen offset:1024 sc1 lds
    v_mfma_f32_16x16x32_bf16 v[80:83], v[40:43], a[200:203], v[80:83]
    ds_read_b128 v[32:35], v2 offset:12544
    v_add_f32 v5, v5, v18
    v_mfma_f32_16x16x32_bf16 v[80:83], v[44:47], a[204:207], v[80:83]
    v_add_f32 v5, v5, v19
    v_mul_f32_e64 v51, -v51, v49
    v_mfma_f32_16x16x32_bf16 v[84:87], v[40:43], a[224:227], v[84:87]
    v_exp_f32 v17, v97
    v_mfma_f32_16x16x32_bf16 v[84:87], v[44:47], a[228:231], v[84:87]
    s_waitcnt vmcnt(13)
    buffer_load_dwordx4 v4, s[4:7], s27 offen offset:2048 sc1 lds
    v_cvt_pk_bf16_f32 v65, v18, v19
    v_mfma_f32_16x16x32_bf16 v[88:91], v[40:43], a[248:251], v[88:91]
    s_add_u32 s27, s27, 24576
    ds_read_b128 v[36:39], v3 offset:12544
    v_cvt_f32_i32 v152, v152
    v_mfma_f32_16x16x32_bf16 v[88:91], v[44:47], a[252:255], v[88:91]
    v_exp_f32 v18, v98
    v_mfma_f32_16x16x32_bf16 v[92:95], v[40:43], v[208:211], v[92:95]
    s_sub_u32 s58, s27, 196608
    v_add_f32 v5, v5, v16
    v_add_f32 v5, v5, v17
    v_mfma_f32_16x16x32_bf16 v[92:95], v[44:47], v[212:215], v[92:95]
    s_waitcnt lgkmcnt(2)
    v_cvt_f32_i32 v156, v156
    v_fma_f32 v152, v152, v48, v50
    v_mfma_f32_16x16x32_bf16 v[112:115], v[24:27], a[200:203], v[112:115]
    s_min_u32 s27, s27, s58
    ds_read_b128 v[40:43], v2 offset:18688
    v_fma_f32 v156, v156, v49, v51
    v_mfma_f32_16x16x32_bf16 v[112:115], v[28:31], a[204:207], v[112:115]
    v_exp_f32 v19, v99
    v_cvt_pk_bf16_f32 v66, v16, v17
    v_mfma_f32_16x16x32_bf16 v[116:119], v[24:27], a[224:227], v[116:119]
L_iw2:
L_pg2:
    s_cbranch_execz L_pg6
    s_add_u32 s56, s56, 12288
    v_exp_f32 v16, v68
    v_mfma_f32_16x16x32_bf16 v[116:119], v[28:31], a[228:231], v[116:119]
    s_mov_b32 m0, s56
    v_add_f32 v5, v5, v18
    v_cvt_f32_i32 v153, v153
    v_mfma_f32_16x16x32_bf16 v[120:123], v[24:27], a[248:251], v[120:123]
    ds_read_b128 v[44:47], v3 offset:18688
    v_add_f32 v5, v5, v19
    v_mfma_f32_16x16x32_bf16 v[120:123], v[28:31], a[252:255], v[120:123]
    s_waitcnt lgkmcnt(2)
    v_exp_f32 v17, v69
    v_mfma_f32_16x16x32_bf16 v[124:127], v[24:27], v[208:211], v[124:127]
    s_waitcnt vmcnt(26)
    v_cvt_f32_i32 v157, v157
    v_cvt_pk_bf16_f32 v67, v18, v19
    v_mfma_f32_16x16x32_bf16 v[124:127], v[28:31], v[212:215], v[124:127]
    s_barrier
    v_add_u32 v1, 49152, v1
    v_mfma_f32_16x16x32_bf16 v[80:83], v[32:35], a[208:211], v[80:83]
    ds_read_b128 v[24:27], v1 offset:0
    v_fma_f32 v153, v153, v48, v50
    v_mfma_f32_16x16x32_bf16 v[80:83], v[36:39], a[212:215], v[80:83]
    s_waitcnt vmcnt(12)
    buffer_load_dwordx4 v4, s[4:7], s27 offen offset:0 sc1 lds
    v_mfma_f32_16x16x32_bf16 v[84:87], v[32:35], a[232:235], v[84:87]
    v_exp_f32 v18, v70
    v_mfma_f32_16x16x32_bf16 v[84:87], v[36:39], a[236:239], v[84:87]
    v_add_f32 v6, v6, v16
    v_add_f32 v6, v6, v17
    v_mfma_f32_16x16x32_bf16 v[88:91], v[32:35], v[192:195], v[88:91]
    ds_read_b128 v[28:31], v1 offset:12288
    v_fma_f32 v157, v157, v49, v51
    v_mfma_f32_16x16x32_bf16 v[88:91], v[36:39], v[196:199], v[88:91]
    s_waitcnt vmcnt(12)
    buffer_load_dwordx4 v4, s[4:7], s27 offen offset:1024 sc1 lds
    v_mfma_f32_16x16x32_bf16 v[92:95], v[32:35], v[216:219], v[92:95]
    v_exp_f32 v19, v71
    v_mfma_f32_16x16x32_bf16 v[92:95], v[36:39], v[220:223], v[92:95]
    s_waitcnt lgkmcnt(2)
    v_cvt_pk_bf16_f32 v68, v16, v17
    v_exp_f32 v16, v100
    v_mfma_f32_16x16x32_bf16 v[112:115], v[40:43], a[208:211], v[112:115]
    ds_read_b128 v[32:35], v1 offset:1024
    v_cvt_f32_i32 v154, v154
    v_mfma_f32_16x16x32_bf16 v[112:115], v[44:47], a[212:215], v[112:115]
    s_waitcnt vmcnt(12)
    buffer_load_dwordx4 v4, s[4:7], s27 offen offset:2048 sc1 lds
    v_add_f32 v6, v6, v18
    v_mfma_f32_16x16x32_bf16 v[116:119], v[40:43], a[232:235], v[116:119]
    v_add_f32 v6, v6, v19
    v_cvt_f32_i32 v158, v158
    v_mfma_f32_16x16x32_bf16 v[116:119], v[44:47], a[236:239], v[116:119]
    v_exp_f32 v17, v101
    v_cvt_pk_bf16_f32 v69, v18, v19
    v_mfma_f32_16x16x32_bf16 v[120:123], v[40:43], v[192:195], v[120:123]
    s_add_u32 s27, s27, 24576
    ds_read_b128 v[36:39], v1 offset:13312
    v_fma_f32 v154, v154, v48, v50
    v_mfma_f32_16x16x32_bf16 v[120:123], v[44:47], v[196:199], v[120:123]
    v_exp_f32 v18, v102
    v_fma_f32 v158, v158, v49, v51
    v_mfma_f32_16x16x32_bf16 v[124:127], v[40:43], v[216:219], v[124:127]
    s_sub_u32 s58, s27, 196608
    v_add_f32 v6, v6, v16
    v_add_f32 v6, v6, v17
    v_mfma_f32_16x16x32_bf16 v[124:127], v[44:47], v[220:223], v[124:127]
    s_waitcnt lgkmcnt(2)
    v_exp_f32 v19, v103
    v_cvt_pk_bf16_f32 v144, v144, v148
    v_cvt_pk_bf16_f32 v148, v145, v149
    v_cvt_pk_bf16_f32 v70, v16, v17
    s_min_u32 s27, s27, s58
    v_cvt_pk_bf16_f32 v145, v152, v156
    v_add_f32 v6, v6, v18
    s_add_u32 s56, s56, 36864
    v_cvt_pk_bf16_f32 v149, v153, v157
    v_add_f32 v6, v6, v19
    s_sub_u32 s58, s56, 147456
    v_cvt_pk_bf16_f32 v152, v146, v150
    v_cvt_pk_bf16_f32 v71, v18, v19
    s_min_u32 s56, s56, s58
    v_cvt_pk_bf16_f32 v153, v154, v158
    s_mov_b32 s31, 6
    v_mfma_f32_16x16x32_bf16 a[0:3], v[160:163], v[24:27], a[0:3]
    s_add_u32 s33, s33, 196608
    ds_read_b128 v[40:43], v1 offset:2048
    v_mfma_f32_16x16x32_bf16 a[0:3], v[176:179], v[28:31], a[0:3]
    s_add_u32 s34, s34, 196608
    v_exp_f32 v16, v72
    v_mfma_f32_16x16x32_bf16 a[48:51], v[164:167], v[24:27], a[48:51]
    s_add_u32 s36, s36, 1536
    v_exp_f32 v17, v73
    v_mfma_f32_16x16x32_bf16 a[48:51], v[180:183], v[28:31], a[48:51]
    v_exp_f32 v18, v74
    v_mfma_f32_16x16x32_bf16 a[96:99], v[168:171], v[24:27], a[96:99]
    ds_read_b128 v[44:47], v1 offset:14336
    v_add_f32 v7, v7, v16
    v_mfma_f32_16x16x32_bf16 a[96:99], v[184:187], v[28:31], a[96:99]
    s_waitcnt vmcnt(11)
    buffer_load_dwordx2 v[56:57], v10, s[72:75], s36 offen offset:0
    v_mfma_f32_16x16x32_bf16 a[144:147], v[172:175], v[24:27], a[144:147]
    v_add_f32 v7, v7, v17
    v_mfma_f32_16x16x32_bf16 a[144:147], v[188:191], v[28:31], a[144:147]
    s_waitcnt lgkmcnt(2)
    v_exp_f32 v19, v75
    v_mfma_f32_16x16x32_bf16 a[4:7], v[160:163], v[32:35], a[4:7]
    ds_read_b128 v[24:27], v1 offset:3072
    v_cvt_pk_bf16_f32 v72, v16, v17
    v_mfma_f32_16x16x32_bf16 a[4:7], v[176:179], v[36:39], a[4:7]
    buffer_load_dwordx2 v[58:59], v10, s[76:79], s36 offen offset:0
    v_mfma_f32_16x16x32_bf16 a[52:55], v[164:167], v[32:35], a[52:55]
    v_exp_f32 v16, v104
    v_mfma_f32_16x16x32_bf16 a[52:55], v[180:183], v[36:39], a[52:55]
    v_add_f32 v7, v7, v18
    v_add_f32 v7, v7, v19
    v_mfma_f32_16x16x32_bf16 a[100:103], v[168:171], v[32:35], a[100:103]
    ds_read_b128 v[28:31], v1 offset:15360
    v_mfma_f32_16x16x32_bf16 a[100:103], v[184:187], v[36:39], a[100:103]
    s_waitcnt vmcnt(12)
    buffer_load_dwordx4 v[224:227], v9, s[64:67], s33 offen offset:0 nt
    v_mfma_f32_16x16x32_bf16 a[148:151], v[172:175], v[32:35], a[148:151]
    v_exp_f32 v17, v105
    v_mfma_f32_16x16x32_bf16 a[148:151], v[188:191], v[36:39], a[148:151]
    s_waitcnt lgkmcnt(2)
    v_cvt_pk_bf16_f32 v73, v18, v19
    v_mfma_f32_16x16x32_bf16 a[8:11], v[160:163], v[40:43], a[8:11]
    ds_read_b128 v[32:35], v1 offset:4096
    v_mfma_f32_16x16x32_bf16 a[8:11], v[176:179], v[44:47], a[8:11]
    s_waitcnt vmcnt(12)
    buffer_load_dwordx4 v[228:231], v9, s[64:67], s33 offen offset:1536 nt
    v_mfma_f32_16x16x32_bf16 a[56:59], v[164:167], v[40:43], a[56:59]
    v_exp_f32 v18, v106
    v_mfma_f32_16x16x32_bf16 a[56:59], v[180:183], v[44:47], a[56:59]
    v_add_f32 v7, v7, v16
    v_add_f32 v7, v7, v17
    v_mfma_f32_16x16x32_bf16 a[104:107], v[168:171], v[40:43], a[104:107]
    s_waitcnt vmcnt(17)
    ds_read_b128 v[36:39], v1 offset:16384
    v_lshlrev_b32 v48, 16, v60
    v_mfma_f32_16x16x32_bf16 a[104:107], v[184:187], v[44:47], a[104:107]
    buffer_load_dwordx4 v[232:235], v9, s[64:67], s34 offen offset:0 nt
    v_mfma_f32_16x16x32_bf16 a[152:155], v[172:175], v[40:43], a[152:155]
    v_exp_f32 v19, v107
    v_mfma_f32_16x16x32_bf16 a[152:155], v[188:191], v[44:47], a[152:155]
    s_waitcnt lgkmcnt(2)
    v_cvt_pk_bf16_f32 v74, v16, v17
    v_and_b32 v49, s97, v60
    v_mfma_f32_16x16x32_bf16 a[12:15], v[160:163], v[24:27], a[12:15]
    ds_read_b128 v[40:43], v1 offset:5120
    v_lshlrev_b32 v50, 16, v62
    v_mfma_f32_16x16x32_bf16 a[12:15], v[176:179], v[28:31], a[12:15]
    s_waitcnt vmcnt(13)
    buffer_load_dwordx4 v[236:239], v9, s[64:67], s34 offen offset:1536 nt
    v_mfma_f32_16x16x32_bf16 a[60:63], v[164:167], v[24:27], a[60:63]
    v_exp_f32 v16, v76
    v_mfma_f32_16x16x32_bf16 a[60:63], v[180:183], v[28:31], a[60:63]
    v_add_f32 v7, v7, v18
    v_add_f32 v7, v7, v19
    v_mfma_f32_16x16x32_bf16 a[108:111], v[168:171], v[24:27], a[108:111]
    ds_read_b128 v[44:47], v1 offset:17408
    v_and_b32 v51, s97, v62
    v_mfma_f32_16x16x32_bf16 a[108:111], v[184:187], v[28:31], a[108:111]
    v_exp_f32 v17, v77
    v_mfma_f32_16x16x32_bf16 a[156:159], v[172:175], v[24:27], a[156:159]
    s_add_u32 s29, s28, 49152
    v_cvt_pk_bf16_f32 v75, v18, v19
    v_mul_f32_e64 v50, -v50, v48
    v_mfma_f32_16x16x32_bf16 a[156:159], v[188:191], v[28:31], a[156:159]
    s_waitcnt lgkmcnt(2)
    v_exp_f32 v18, v78
    v_mfma_f32_16x16x32_bf16 a[16:19], v[160:163], v[32:35], a[16:19]
    s_mov_b32 m0, s56
    ds_read_b128 v[24:27], v1 offset:6144
    v_add_f32 v8, v8, v16
    v_mfma_f32_16x16x32_bf16 a[16:19], v[176:179], v[36:39], a[16:19]
    s_sub_u32 s3, s29, 147456
    s_waitcnt vmcnt(13)
    buffer_load_dwordx4 v4, s[4:7], s27 offen offset:0 sc1 lds
    v_mfma_f32_16x16x32_bf16 a[64:67], v[164:167], v[32:35], a[64:67]
    s_min_u32 s29, s29, s3
    v_add_f32 v8, v8, v17
    v_mul_f32_e64 v51, -v51, v49
    v_mfma_f32_16x16x32_bf16 a[64:67], v[180:183], v[36:39], a[64:67]
    v_exp_f32 v19, v79
    v_mfma_f32_16x16x32_bf16 a[112:115], v[168:171], v[32:35], a[112:115]
    ds_read_b128 v[28:31], v1 offset:18432
    v_cvt_pk_bf16_f32 v76, v16, v17
    v_mfma_f32_16x16x32_bf16 a[112:115], v[184:187], v[36:39], a[112:115]
    s_waitcnt vmcnt(13)
    buffer_load_dwordx4 v4, s[4:7], s27 offen offset:1024 sc1 lds
    v_mfma_f32_16x16x32_bf16 a[160:163], v[172:175], v[32:35], a[160:163]
    s_sub_u32 s3, s29, s28
    v_exp_f32 v16, v108
    v_mfma_f32_16x16x32_bf16 a[160:163], v[188:191], v[36:39], a[160:163]
    s_waitcnt lgkmcnt(2)
    v_add_f32 v8, v8, v18
    v_add_f32 v8, v8, v19
    v_mfma_f32_16x16x32_bf16 a[20:23], v[160:163], v[40:43], a[20:23]
    ds_read_b128 v[32:35], v1 offset:7168
    v_cvt_f32_i32 v240, v240
    v_mfma_f32_16x16x32_bf16 a[20:23], v[176:179], v[44:47], a[20:23]
    buffer_load_dword v52, v20, s[20:23], s44 offen sc1
    v_mfma_f32_16x16x32_bf16 a[68:71], v[164:167], v[40:43], a[68:71]
    v_exp_f32 v17, v109
    v_mfma_f32_16x16x32_bf16 a[68:71], v[180:183], v[44:47], a[68:71]
    v_cvt_pk_bf16_f32 v77, v18, v19
    v_cvt_f32_i32 v244, v244
    v_mfma_f32_16x16x32_bf16 a[116:119], v[168:171], v[40:43], a[116:119]
    s_mov_b32 s28, s29
    ds_read_b128 v[36:39], v1 offset:19456
    v_fma_f32 v240, v240, v48, v50
    v_mfma_f32_16x16x32_bf16 a[116:119], v[184:187], v[44:47], a[116:119]
    s_waitcnt vmcnt(14)
    buffer_load_dwordx4 v4, s[4:7], s27 offen offset:2048 sc1 lds
    v_mfma_f32_16x16x32_bf16 a[164:167], v[172:175], v[40:43], a[164:167]
    s_add_u32 s27, s27, 24576
    v_exp_f32 v18, v110
    v_mfma_f32_16x16x32_bf16 a[164:167], v[188:191], v[44:47], a[164:167]
    s_waitcnt lgkmcnt(2)
    v_add_f32 v8, v8, v16
    v_add_f32 v8, v8, v17
    v_fma_f32 v244, v244, v49, v51
    v_mfma_f32_16x16x32_bf16 a[24:27], v[160:163], v[24:27], a[24:27]
    s_sub_u32 s58, s27, 196608
    ds_read_b128 v[40:43], v1 offset:8192
    v_cvt_f32_i32 v241, v241
    v_mfma_f32_16x16x32_bf16 a[24:27], v[176:179], v[28:31], a[24:27]
    v_exp_f32 v19, v111
    v_cvt_pk_bf16_f32 v78, v16, v17
    v_mfma_f32_16x16x32_bf16 a[72:75], v[164:167], v[24:27], a[72:75]
    s_min_u32 s27, s27, s58
    v_add_f32 v8, v8, v18
    v_add_f32 v8, v8, v19
    v_mfma_f32_16x16x32_bf16 a[72:75], v[180:183], v[28:31], a[72:75]
    v_cvt_f32_i32 v245, v245
    v_cvt_pk_bf16_f32 v79, v18, v19
    v_mfma_f32_16x16x32_bf16 a[120:123], v[168:171], v[24:27], a[120:123]
    s_add_u32 s56, s56, 12288
    ds_read_b128 v[44:47], v1 offset:20480
    v_fma_f32 v241, v241, v48, v50
    v_mfma_f32_16x16x32_bf16 a[120:123], v[184:187], v[28:31], a[120:123]
    v_exp_f32 v16, v80
    v_mfma_f32_16x16x32_bf16 a[168:171], v[172:175], v[24:27], a[168:171]
    s_mov_b32 m0, s56
    v_exp_f32 v17, v81
    v_mfma_f32_16x16x32_bf16 a[168:171], v[188:191], v[28:31], a[168:171]
    s_waitcnt lgkmcnt(2)
    v_fma_f32 v245, v245, v49, v51
    v_exp_f32 v18, v82
    v_mfma_f32_16x16x32_bf16 a[28:31], v[160:163], v[32:35], a[28:31]
    ds_read_b128 v[24:27], v1 offset:9216
    v_cvt_f32_i32 v242, v242
    v_mfma_f32_16x16x32_bf16 a[28:31], v[176:179], v[36:39], a[28:31]
    v_add_f32 v5, v5, v16
    v_cvt_f32_i32 v246, v246
    v_mfma_f32_16x16x32_bf16 a[76:79], v[164:167], v[32:35], a[76:79]
    v_add_f32 v5, v5, v17
    v_fma_f32 v242, v242, v48, v50
    v_mfma_f32_16x16x32_bf16 a[76:79], v[180:183], v[36:39], a[76:79]
    s_waitcnt vmcnt(14)
    buffer_load_dwordx4 v4, s[4:7], s27 offen offset:0 sc1 lds
    v_mfma_f32_16x16x32_bf16 a[124:127], v[168:171], v[32:35], a[124:127]
    ds_read_b128 v[28:31], v1 offset:21504
    v_fma_f32 v246, v246, v49, v51
    v_mfma_f32_16x16x32_bf16 a[124:127], v[184:187], v[36:39], a[124:127]
    v_exp_f32 v19, v83
    v_cvt_pk_bf16_f32 v80, v16, v17
    v_mfma_f32_16x16x32_bf16 a[172:175], v[172:175], v[32:35], a[172:175]
    v_exp_f32 v16, v112
    v_mfma_f32_16x16x32_bf16 a[172:175], v[188:191], v[36:39], a[172:175]
    s_waitcnt lgkmcnt(2)
    s_waitcnt vmcnt(14)
    buffer_load_dwordx4 v4, s[4:7], s27 offen offset:1024 sc1 lds
    v_add_f32 v5, v5, v18
    v_mfma_f32_16x16x32_bf16 a[32:35], v[160:163], v[40:43], a[32:35]
    ds_read_b128 v[32:35], v1 offset:10240
    v_lshlrev_b32 v48, 16, v61
    v_mfma_f32_16x16x32_bf16 a[32:35], v[176:179], v[44:47], a[32:35]
    v_add_f32 v5, v5, v19
    v_exp_f32 v17, v113
    v_mfma_f32_16x16x32_bf16 a[80:83], v[164:167], v[40:43], a[80:83]
    v_and_b32 v49, s97, v61
    v_cvt_pk_bf16_f32 v81, v18, v19
    v_mfma_f32_16x16x32_bf16 a[80:83], v[180:183], v[44:47], a[80:83]
    s_waitcnt vmcnt(14)
    buffer_load_dwordx4 v4, s[4:7], s27 offen offset:2048 sc1 lds
    v_lshlrev_b32 v50, 16, v63
    v_mfma_f32_16x16x32_bf16 a[128:131], v[168:171], v[40:43], a[128:131]
    ds_read_b128 v[36:39], v1 offset:22528
    v_and_b32 v51, s97, v63
    v_mfma_f32_16x16x32_bf16 a[128:131], v[184:187], v[44:47], a[128:131]
    v_exp_f32 v18, v114
    v_add_f32 v5, v5, v16
    v_mfma_f32_16x16x32_bf16 a[176:179], v[172:175], v[40:43], a[176:179]
    v_add_u32 v2, s3, v2
    v_add_u32 v3, s3, v3
    v_mfma_f32_16x16x32_bf16 a[176:179], v[188:191], v[44:47], a[176:179]
    s_waitcnt lgkmcnt(2)
    v_add_f32 v5, v5, v17
    v_exp_f32 v19, v115
    v_mfma_f32_16x16x32_bf16 a[36:39], v[160:163], v[24:27], a[36:39]
    ds_read_b128 v[40:43], v1 offset:11264
    v_mul_f32_e64 v50, -v50, v48
    v_mfma_f32_16x16x32_bf16 a[36:39], v[176:179], v[28:31], a[36:39]
    v_cvt_pk_bf16_f32 v82, v16, v17
    v_mul_f32_e64 v51, -v51, v49
    v_mfma_f32_16x16x32_bf16 a[84:87], v[164:167], v[24:27], a[84:87]
    v_exp_f32 v16, v84
    v_mfma_f32_16x16x32_bf16 a[84:87], v[180:183], v[28:31], a[84:87]
    v_cvt_f32_i32 v248, v248
    v_add_f32 v5, v5, v18
    v_cvt_f32_i32 v252, v252
    v_mfma_f32_16x16x32_bf16 a[132:135], v[168:171], v[24:27], a[132:135]
    s_mov_b32 s27, 208896
    ds_read_b128 v[44:47], v1 offset:23552
    v_add_f32 v5, v5, v19
    v_mfma_f32_16x16x32_bf16 a[132:135], v[184:187], v[28:31], a[132:135]
    s_waitcnt lgkmcnt(2)
    v_exp_f32 v17, v85
    v_fma_f32 v248, v248, v48, v50
    v_mfma_f32_16x16x32_bf16 a[180:183], v[172:175], v[24:27], a[180:183]
    s_waitcnt vmcnt(19)
    v_cvt_pk_bf16_f32 v83, v18, v19
    v_fma_f32 v252, v252, v49, v51
    v_mfma_f32_16x16x32_bf16 a[180:183], v[188:191], v[28:31], a[180:183]
    s_barrier
    v_mfma_f32_16x16x32_bf16 a[40:43], v[160:163], v[32:35], a[40:43]
    s_add_u32 s56, s56, 36864
    ds_read_b128 v[24:27], v2 offset:0
    v_cvt_f32_i32 v249, v249
    v_mfma_f32_16x16x32_bf16 a[40:43], v[176:179], v[36:39], a[40:43]
    v_exp_f32 v18, v86
    v_add_f32 v6, v6, v16
    v_mfma_f32_16x16x32_bf16 a[88:91], v[164:167], v[32:35], a[88:91]
    s_sub_u32 s58, s56, 147456
    v_add_f32 v6, v6, v17
    v_cvt_f32_i32 v253, v253
    v_mfma_f32_16x16x32_bf16 a[88:91], v[180:183], v[36:39], a[88:91]
    s_min_u32 s56, s56, s58
    v_exp_f32 v19, v87
    v_mfma_f32_16x16x32_bf16 a[136:139], v[168:171], v[32:35], a[136:139]
    ds_read_b128 v[28:31], v3 offset:0
    v_fma_f32 v249, v249, v48, v50
    v_mfma_f32_16x16x32_bf16 a[136:139], v[184:187], v[36:39], a[136:139]
    v_cvt_pk_bf16_f32 v84, v16, v17
    v_exp_f32 v16, v116
    v_mfma_f32_16x16x32_bf16 a[184:187], v[172:175], v[32:35], a[184:187]
    v_fma_f32 v253, v253, v49, v51
    v_add_f32 v6, v6, v18
    v_mfma_f32_16x16x32_bf16 a[184:187], v[188:191], v[36:39], a[184:187]
    s_waitcnt lgkmcnt(2)
    v_cvt_f32_i32 v250, v250
    v_add_f32 v6, v6, v19
    v_mfma_f32_16x16x32_bf16 a[44:47], v[160:163], v[40:43], a[44:47]
    ds_read_b128 v[32:35], v2 offset:6144
    v_cvt_f32_i32 v254, v254
    v_mfma_f32_16x16x32_bf16 a[44:47], v[176:179], v[44:47], a[44:47]
    v_exp_f32 v17, v117
    v_mfma_f32_16x16x32_bf16 a[92:95], v[164:167], v[40:43], a[92:95]
    v_cvt_pk_bf16_f32 v85, v18, v19
    v_fma_f32 v250, v250, v48, v50
    v_mfma_f32_16x16x32_bf16 a[92:95], v[180:183], v[44:47], a[92:95]
    v_exp_f32 v18, v118
    v_mfma_f32_16x16x32_bf16 a[140:143], v[168:171], v[40:43], a[140:143]
    s_nop 0
    ds_read_b128 v[36:39], v3 offset:6144
    v_fma_f32 v254, v254, v49, v51
    v_mfma_f32_16x16x32_bf16 a[140:143], v[184:187], v[44:47], a[140:143]
    v_add_f32 v6, v6, v16
    v_add_f32 v6, v6, v17
    v_mfma_f32_16x16x32_bf16 a[188:191], v[172:175], v[40:43], a[188:191]
    s_waitcnt lgkmcnt(2)
    v_exp_f32 v19, v119
    v_cvt_pk_bf16_f32 v146, v240, v244
    v_cvt_pk_bf16_f32 v150, v241, v245
    v_cvt_pk_bf16_f32 v86, v16, v17
    v_cvt_pk_bf16_f32 v147, v248, v252
    v_add_f32 v6, v6, v18
    v_cvt_pk_bf16_f32 v151, v249, v253
    v_add_f32 v6, v6, v19
    v_cvt_pk_bf16_f32 v154, v242, v246
    v_cvt_pk_bf16_f32 v87, v18, v19
    v_cvt_pk_bf16_f32 v155, v250, v254
    v_mfma_f32_16x16x32_bf16 a[188:191], v[188:191], v[44:47], a[188:191]
    s_branch L_join
.p2align 6
L_loop:
    v_mfma_f32_16x16x32_bf16 v[160:163], v[24:27], a[192:195], v[128:131]
    s_mov_b32 m0, s56
    ds_read_b128 v[40:43], v2 offset:128
    v_cvt_f32_i32 v247, v247
    v_mfma_f32_16x16x32_bf16 v[160:163], v[28:31], a[196:199], v[160:163]
    buffer_load_dwordx4 v4, s[4:7], s27 offen offset:0 sc1 lds
    v_mfma_f32_16x16x32_bf16 v[164:167], v[24:27], a[216:219], v[132:135]
    v_exp_f32 v16, v88
    v_mfma_f32_16x16x32_bf16 v[164:167], v[28:31], a[220:223], v[164:167]
    v_exp_f32 v17, v89
    v_mfma_f32_16x16x32_bf16 v[168:171], v[24:27], a[240:243], v[136:139]
    ds_read_b128 v[44:47], v3 offset:128
    v_fma_f32 v246, v246, v48, v50
    v_mfma_f32_16x16x32_bf16 v[168:171], v[28:31], a[244:247], v[168:171]
    v_exp_f32 v18, v90
    v_mfma_f32_16x16x32_bf16 v[172:175], v[24:27], v[200:203], v[140:143]
    v_fma_f32 v247, v247, v49, v51
    v_add_f32 v7, v7, v16
    v_mfma_f32_16x16x32_bf16 v[172:175], v[28:31], v[204:207], v[172:175]
    s_waitcnt lgkmcnt(2)
    v_add_f32 v7, v7, v17
    v_cvt_pk_bf16_f32 v231, v246, v247
    v_mfma_f32_16x16x32_bf16 v[96:99], v[32:35], a[192:195], v[128:131]
    ds_read_b128 v[24:27], v2 offset:6272
    v_cvt_f32_i32 v250, v250
    v_mfma_f32_16x16x32_bf16 v[96:99], v[36:39], a[196:199], v[96:99]
    buffer_load_dwordx4 v4, s[4:7], s27 offen offset:1024 sc1 lds
    v_mfma_f32_16x16x32_bf16 v[100:103], v[32:35], a[216:219], v[132:135]
    v_exp_f32 v19, v91
    v_mfma_f32_16x16x32_bf16 v[100:103], v[36:39], a[220:223], v[100:103]
    v_cvt_pk_bf16_f32 v88, v16, v17
    v_cvt_f32_i32 v251, v251
    v_mfma_f32_16x16x32_bf16 v[104:107], v[32:35], a[240:243], v[136:139]
    ds_read_b128 v[28:31], v3 offset:6272
    v_fma_f32 v250, v250, v48, v50
    v_mfma_f32_16x16x32_bf16 v[104:107], v[36:39], a[244:247], v[104:107]
    v_exp_f32 v16, v120
    v_mfma_f32_16x16x32_bf16 v[108:111], v[32:35], v[200:203], v[140:143]
    v_add_f32 v7, v7, v18
    v_add_f32 v7, v7, v19
    v_mfma_f32_16x16x32_bf16 v[108:111], v[36:39], v[204:207], v[108:111]
    s_waitcnt lgkmcnt(2)
    v_exp_f32 v17, v121
    v_mfma_f32_16x16x32_bf16 v[160:163], v[40:43], a[200:203], v[160:163]
    ds_read_b128 v[32:35], v2 offset:256
    v_cvt_pk_bf16_f32 v89, v18, v19
    v_mfma_f32_16x16x32_bf16 v[160:163], v[44:47], a[204:207], v[160:163]
    v_exp_f32 v18, v122
    v_mfma_f32_16x16x32_bf16 v[164:167], v[40:43], a[224:227], v[164:167]
    v_fma_f32 v251, v251, v49, v51
    v_add_f32 v7, v7, v16
    v_mfma_f32_16x16x32_bf16 v[164:167], v[44:47], a[228:231], v[164:167]
    buffer_load_dwordx4 v4, s[4:7], s27 offen offset:2048 sc1 lds
    v_mfma_f32_16x16x32_bf16 v[168:171], v[40:43], a[248:251], v[168:171]
    ds_read_b128 v[36:39], v3 offset:256
    v_cvt_pk_bf16_f32 v235, v250, v251
    v_mfma_f32_16x16x32_bf16 v[168:171], v[44:47], a[252:255], v[168:171]
    v_add_f32 v7, v7, v17
    v_cvt_f32_i32 v254, v254
    v_mfma_f32_16x16x32_bf16 v[172:175], v[40:43], v[208:211], v[172:175]
    v_exp_f32 v19, v123
    v_mfma_f32_16x16x32_bf16 v[172:175], v[44:47], v[212:215], v[172:175]
    s_waitcnt lgkmcnt(2)
    v_cvt_pk_bf16_f32 v90, v16, v17
    v_cvt_f32_i32 v255, v255
    v_mfma_f32_16x16x32_bf16 v[96:99], v[24:27], a[200:203], v[96:99]
    ds_read_b128 v[40:43], v2 offset:6400
    v_fma_f32 v254, v254, v48, v50
    v_mfma_f32_16x16x32_bf16 v[96:99], v[28:31], a[204:207], v[96:99]
    s_add_u32 s27, s27, 24576
    v_exp_f32 v16, v92
    v_mfma_f32_16x16x32_bf16 v[100:103], v[24:27], a[224:227], v[100:103]
    v_add_f32 v7, v7, v18
    v_add_f32 v7, v7, v19
    v_mfma_f32_16x16x32_bf16 v[100:103], v[28:31], a[228:231], v[100:103]
    v_exp_f32 v17, v93
    v_mfma_f32_16x16x32_bf16 v[104:107], v[24:27], a[248:251], v[104:107]
    ds_read_b128 v[44:47], v3 offset:6400
    v_fma_f32 v255, v255, v49, v51
    v_mfma_f32_16x16x32_bf16 v[104:107], v[28:31], a[252:255], v[104:107]
    v_cvt_pk_bf16_f32 v91, v18, v19
    v_cvt_pk_bf16_f32 v239, v254, v255
    v_mfma_f32_16x16x32_bf16 v[108:111], v[24:27], v[208:211], v[108:111]
    s_add_u32 s29, s30, 49152
    v_exp_f32 v18, v94
    v_mfma_f32_16x16x32_bf16 v[108:111], v[28:31], v[212:215], v[108:111]
    s_waitcnt lgkmcnt(2)
    v_add_f32 v8, v8, v16
    v_add_f32 v8, v8, v17
    v_mfma_f32_16x16x32_bf16 v[160:163], v[32:35], a[208:211], v[160:163]
    s_waitcnt vmcnt(11)
    ds_read_b128 v[24:27], v2 offset:12288
    v_lshlrev_b32 v48, 16, v56
    v_mfma_f32_16x16x32_bf16 v[160:163], v[36:39], a[212:215], v[160:163]
    s_sub_u32 s3, s29, 147456
    buffer_load_dwordx2 v[60:61], off, s[80:83], s37 offset:8
    v_mfma_f32_16x16x32_bf16 v[164:167], v[32:35], a[232:235], v[164:167]
    s_add_u32 s56, s56, 12288
    v_exp_f32 v19, v95
    v_mfma_f32_16x16x32_bf16 v[164:167], v[36:39], a[236:239], v[164:167]
    s_min_u32 s29, s29, s3
    v_cvt_pk_bf16_f32 v92, v16, v17
    v_and_b32 v49, s97, v56
    v_mfma_f32_16x16x32_bf16 v[168:171], v[32:35], v[192:195], v[168:171]
    s_mov_b32 m0, s56
    ds_read_b128 v[28:31], v3 offset:12288
    v_mfma_f32_16x16x32_bf16 v[168:171], v[36:39], v[196:199], v[168:171]
    buffer_load_dwordx2 v[62:63], off, s[84:87], s37 offset:8
    v_mfma_f32_16x16x32_bf16 v[172:175], v[32:35], v[216:219], v[172:175]
    v_exp_f32 v16, v124
    v_mfma_f32_16x16x32_bf16 v[172:175], v[36:39], v[220:223], v[172:175]
    s_waitcnt lgkmcnt(2)
    v_add_f32 v8, v8, v18
    v_add_f32 v8, v8, v19
    v_mfma_f32_16x16x32_bf16 v[96:99], v[40:43], a[208:211], v[96:99]
    ds_read_b128 v[32:35], v2 offset:18432
    v_lshlrev_b32 v50, 16, v58
    v_mfma_f32_16x16x32_bf16 v[96:99], v[44:47], a[212:215], v[96:99]
    s_sub_u32 s3, s29, s30
    v_exp_f32 v17, v125
    v_mfma_f32_16x16x32_bf16 v[100:103], v[40:43], a[232:235], v[100:103]
    v_cvt_pk_bf16_f32 v93, v18, v19
    v_mfma_f32_16x16x32_bf16 v[100:103], v[44:47], a[236:239], v[100:103]
    buffer_load_dwordx4 v4, s[4:7], s27 offen offset:0 sc1 lds
    v_mfma_f32_16x16x32_bf16 v[104:107], v[40:43], v[192:195], v[104:107]
    ds_read_b128 v[36:39], v3 offset:18432
    v_mfma_f32_16x16x32_bf16 v[104:107], v[44:47], v[196:199], v[104:107]
    v_exp_f32 v18, v126
    v_mfma_f32_16x16x32_bf16 v[108:111], v[40:43], v[216:219], v[108:111]
    v_add_f32 v8, v8, v16
    v_add_f32 v8, v8, v17
    v_mfma_f32_16x16x32_bf16 v[108:111], v[44:47], v[220:223], v[108:111]
    s_waitcnt lgkmcnt(2)
    buffer_load_dwordx3 v[240:242], v12, s[68:71], s16 offen offset:0 nt
    v_mfma_f32_16x16x32_bf16 v[176:179], v[24:27], a[192:195], v[128:131]
    ds_read_b128 v[40:43], v2 offset:12416
    v_and_b32 v51, s97, v58
    v_mfma_f32_16x16x32_bf16 v[176:179], v[28:31], a[196:199], v[176:179]
    v_exp_f32 v19, v127
    v_cvt_pk_bf16_f32 v94, v16, v17
    v_mfma_f32_16x16x32_bf16 v[180:183], v[24:27], a[216:219], v[132:135]
    s_mov_b32 s30, s29
    v_add_f32 v8, v8, v18
    v_add_f32 v8, v8, v19
    v_mfma_f32_16x16x32_bf16 v[180:183], v[28:31], a[220:223], v[180:183]
    buffer_load_dwordx4 v4, s[4:7], s27 offen offset:1024 sc1 lds
    v_mfma_f32_16x16x32_bf16 v[184:187], v[24:27], a[240:243], v[136:139]
    ds_read_b128 v[44:47], v3 offset:12416
    v_cvt_pk_bf16_f32 v95, v18, v19
    v_mfma_f32_16x16x32_bf16 v[184:187], v[28:31], a[244:247], v[184:187]
    v_exp_f32 v16, v160
    v_mfma_f32_16x16x32_bf16 v[188:191], v[24:27], v[200:203], v[140:143]
    v_exp_f32 v17, v161
    v_mfma_f32_16x16x32_bf16 v[188:191], v[28:31], v[204:207], v[188:191]
    s_waitcnt lgkmcnt(2)
    buffer_load_dwordx3 v[244:246], v12, s[68:71], s16 offen offset:768 nt
    v_mfma_f32_16x16x32_bf16 v[112:115], v[32:35], a[192:195], v[128:131]
    ds_read_b128 v[24:27], v2 offset:18560
    v_mul_f32_e64 v50, -v50, v48
    v_mfma_f32_16x16x32_bf16 v[112:115], v[36:39], a[196:199], v[112:115]
    v_exp_f32 v18, v162
    v_mfma_f32_16x16x32_bf16 v[116:119], v[32:35], a[216:219], v[132:135]
    v_add_f32 v5, v5, v16
    v_add_f32 v5, v5, v17
    v_mfma_f32_16x16x32_bf16 v[116:119], v[36:39], a[220:223], v[116:119]
    v_exp_f32 v19, v163
    v_mfma_f32_16x16x32_bf16 v[120:123], v[32:35], a[240:243], v[136:139]
    ds_read_b128 v[28:31], v3 offset:18560
    v_cvt_pk_bf16_f32 v160, v16, v17
    v_mfma_f32_16x16x32_bf16 v[120:123], v[36:39], a[244:247], v[120:123]
    buffer_load_dwordx3 v[248:250], v12, s[68:71], s16 offen offset:1536 nt
    v_mfma_f32_16x16x32_bf16 v[124:127], v[32:35], v[200:203], v[140:143]
    v_exp_f32 v16, v96
    v_mfma_f32_16x16x32_bf16 v[124:127], v[36:39], v[204:207], v[124:127]
    s_waitcnt lgkmcnt(2)
    v_add_f32 v5, v5, v18
    v_add_f32 v5, v5, v19
    v_mfma_f32_16x16x32_bf16 v[176:179], v[40:43], a[200:203], v[176:179]
    ds_read_b128 v[32:35], v2 offset:12544
    v_mul_f32_e64 v51, -v51, v49
    v_mfma_f32_16x16x32_bf16 v[176:179], v[44:47], a[204:207], v[176:179]
    buffer_load_dwordx4 v4, s[4:7], s27 offen offset:2048 sc1 lds
    v_mfma_f32_16x16x32_bf16 v[180:183], v[40:43], a[224:227], v[180:183]
    v_exp_f32 v17, v97
    v_mfma_f32_16x16x32_bf16 v[180:183], v[44:47], a[228:231], v[180:183]
    v_cvt_pk_bf16_f32 v161, v18, v19
    v_add_u32 v1, s3, v1
    v_mfma_f32_16x16x32_bf16 v[184:187], v[40:43], a[248:251], v[184:187]
    ds_read_b128 v[36:39], v3 offset:12544
    v_cvt_f32_i32 v144, v144
    v_mfma_f32_16x16x32_bf16 v[184:187], v[44:47], a[252:255], v[184:187]
    buffer_load_dwordx3 v[252:254], v12, s[68:71], s16 offen offset:2304 nt
    v_mfma_f32_16x16x32_bf16 v[188:191], v[40:43], v[208:211], v[188:191]
    v_exp_f32 v18, v98
    v_mfma_f32_16x16x32_bf16 v[188:191], v[44:47], v[212:215], v[188:191]
    s_waitcnt lgkmcnt(2)
    v_add_f32 v5, v5, v16
    v_add_f32 v5, v5, v17
    v_mfma_f32_16x16x32_bf16 v[112:115], v[24:27], a[200:203], v[112:115]
    ds_read_b128 v[40:43], v2 offset:18688
    v_cvt_f32_i32 v148, v148
    v_mfma_f32_16x16x32_bf16 v[112:115], v[28:31], a[204:207], v[112:115]
    v_exp_f32 v19, v99
    v_cvt_pk_bf16_f32 v162, v16, v17
    v_mfma_f32_16x16x32_bf16 v[116:119], v[24:27], a[224:227], v[116:119]
    v_exp_f32 v16, v164
    v_mfma_f32_16x16x32_bf16 v[116:119], v[28:31], a[228:231], v[116:119]
    s_add_u32 s27, s27, 24576
    v_add_f32 v5, v5, v18
    v_add_f32 v5, v5, v19
    v_mfma_f32_16x16x32_bf16 v[120:123], v[24:27], a[248:251], v[120:123]
    s_add_u32 s56, s56, 36864
    ds_read_b128 v[44:47], v3 offset:18688
    v_fma_f32 v144, v144, v48, v50
    v_mfma_f32_16x16x32_bf16 v[120:123], v[28:31], a[252:255], v[120:123]
    s_waitcnt lgkmcnt(2)
    v_exp_f32 v17, v165
    v_mfma_f32_16x16x32_bf16 v[124:127], v[24:27], v[208:211], v[124:127]
    s_waitcnt vmcnt(12)
    v_cvt_pk_bf16_f32 v163, v18, v19
    s_sub_u32 s58, s56, 147456
    v_mfma_f32_16x16x32_bf16 v[124:127], v[28:31], v[212:215], v[124:127]
    s_barrier
    v_mfma_f32_16x16x32_bf16 v[176:179], v[32:35], a[208:211], v[176:179]
    s_min_u32 s56, s56, s58
    ds_read_b128 v[24:27], v1 offset:0
    v_mfma_f32_16x16x32_bf16 v[176:179], v[36:39], a[212:215], v[176:179]
    v_exp_f32 v18, v166
    v_mfma_f32_16x16x32_bf16 v[180:183], v[32:35], a[232:235], v[180:183]
    v_add_f32 v6, v6, v16
    v_add_f32 v6, v6, v17
    v_mfma_f32_16x16x32_bf16 v[180:183], v[36:39], a[236:239], v[180:183]
    v_exp_f32 v19, v167
    v_mfma_f32_16x16x32_bf16 v[184:187], v[32:35], v[192:195], v[184:187]
    ds_read_b128 v[28:31], v1 offset:12288
    v_cvt_pk_bf16_f32 v164, v16, v17
    v_mfma_f32_16x16x32_bf16 v[184:187], v[36:39], v[196:199], v[184:187]
    v_exp_f32 v16, v100
    v_mfma_f32_16x16x32_bf16 v[188:191], v[32:35], v[216:219], v[188:191]
    v_add_f32 v6, v6, v18
    v_add_f32 v6, v6, v19
    v_mfma_f32_16x16x32_bf16 v[188:191], v[36:39], v[220:223], v[188:191]
    s_waitcnt lgkmcnt(2)
    v_exp_f32 v17, v101
    v_mfma_f32_16x16x32_bf16 v[112:115], v[40:43], a[208:211], v[112:115]
L_iw3:
L_pg3:
    s_cbranch_execz L_pg7
    ds_read_b128 v[32:35], v1 offset:1024
    v_cvt_pk_bf16_f32 v165, v18, v19
    v_mfma_f32_16x16x32_bf16 v[112:115], v[44:47], a[212:215], v[112:115]
    v_exp_f32 v18, v102
    v_mfma_f32_16x16x32_bf16 v[116:119], v[40:43], a[232:235], v[116:119]
    v_add_f32 v6, v6, v16
    v_add_f32 v6, v6, v17
    v_mfma_f32_16x16x32_bf16 v[116:119], v[44:47], a[236:239], v[116:119]
    v_exp_f32 v19, v103
    v_mfma_f32_16x16x32_bf16 v[120:123], v[40:43], v[192:195], v[120:123]
    ds_read_b128 v[36:39], v1 offset:13312
    v_cvt_pk_bf16_f32 v166, v16, v17
    v_mfma_f32_16x16x32_bf16 v[120:123], v[44:47], v[196:199], v[120:123]
    v_add_f32 v6, v6, v18
    v_fma_f32 v148, v148, v49, v51
    v_mfma_f32_16x16x32_bf16 v[124:127], v[40:43], v[216:219], v[124:127]
    v_add_f32 v6, v6, v19
    v_cvt_pk_bf16_f32 v167, v18, v19
    v_mfma_f32_16x16x32_bf16 v[124:127], v[44:47], v[220:223], v[124:127]
    s_waitcnt lgkmcnt(2)
    v_mfma_f32_16x16x32_bf16 a[0:3], v[64:67], v[24:27], a[0:3]
    ds_read_b128 v[40:43], v1 offset:2048
    v_cvt_f32_i32 v145, v145
    v_mfma_f32_16x16x32_bf16 a[0:3], v[80:83], v[28:31], a[0:3]
    buffer_store_dwordx4 v[224:227], v11, s[4:7], s33 offen offset:0 sc1
    v_mfma_f32_16x16x32_bf16 a[48:51], v[68:71], v[24:27], a[48:51]
    v_exp_f32 v16, v168
    v_mfma_f32_16x16x32_bf16 a[48:51], v[84:87], v[28:31], a[48:51]
    v_exp_f32 v17, v169
    v_mfma_f32_16x16x32_bf16 a[96:99], v[72:75], v[24:27], a[96:99]
    ds_read_b128 v[44:47], v1 offset:14336
    v_cvt_f32_i32 v149, v149
    v_mfma_f32_16x16x32_bf16 a[96:99], v[88:91], v[28:31], a[96:99]
    v_exp_f32 v18, v170
    v_mfma_f32_16x16x32_bf16 a[144:147], v[76:79], v[24:27], a[144:147]
    v_add_f32 v7, v7, v16
    v_add_f32 v7, v7, v17
    v_mfma_f32_16x16x32_bf16 a[144:147], v[92:95], v[28:31], a[144:147]
    s_waitcnt lgkmcnt(2)
    v_exp_f32 v19, v171
    v_mfma_f32_16x16x32_bf16 a[4:7], v[64:67], v[32:35], a[4:7]
    ds_read_b128 v[24:27], v1 offset:3072
    v_cvt_pk_bf16_f32 v168, v16, v17
    v_mfma_f32_16x16x32_bf16 a[4:7], v[80:83], v[36:39], a[4:7]
    buffer_store_dwordx4 v[228:231], v21, s[4:7], s33 offen offset:768 sc1
    v_mfma_f32_16x16x32_bf16 a[52:55], v[68:71], v[32:35], a[52:55]
    v_exp_f32 v16, v104
    v_mfma_f32_16x16x32_bf16 a[52:55], v[84:87], v[36:39], a[52:55]
    v_add_f32 v7, v7, v18
    v_fma_f32 v145, v145, v48, v50
    v_mfma_f32_16x16x32_bf16 a[100:103], v[72:75], v[32:35], a[100:103]
    ds_read_b128 v[28:31], v1 offset:15360
    v_add_f32 v7, v7, v19
    v_mfma_f32_16x16x32_bf16 a[100:103], v[88:91], v[36:39], a[100:103]
    v_exp_f32 v17, v105
    v_mfma_f32_16x16x32_bf16 a[148:151], v[76:79], v[32:35], a[148:151]
    v_cvt_pk_bf16_f32 v169, v18, v19
    v_fma_f32 v149, v149, v49, v51
    v_mfma_f32_16x16x32_bf16 a[148:151], v[92:95], v[36:39], a[148:151]
    s_waitcnt lgkmcnt(2)
    v_exp_f32 v18, v106
    v_mfma_f32_16x16x32_bf16 a[8:11], v[64:67], v[40:43], a[8:11]
    ds_read_b128 v[32:35], v1 offset:4096
    v_add_f32 v7, v7, v16
    v_mfma_f32_16x16x32_bf16 a[8:11], v[80:83], v[44:47], a[8:11]
    buffer_store_dwordx4 v[232:235], v22, s[4:7], s33 offen offset:1536 sc1
    v_mfma_f32_16x16x32_bf16 a[56:59], v[68:71], v[40:43], a[56:59]
    v_add_f32 v7, v7, v17
    v_cvt_f32_i32 v146, v146
    v_mfma_f32_16x16x32_bf16 a[56:59], v[84:87], v[44:47], a[56:59]
    v_exp_f32 v19, v107
    v_mfma_f32_16x16x32_bf16 a[104:107], v[72:75], v[40:43], a[104:107]
    ds_read_b128 v[36:39], v1 offset:16384
    v_cvt_pk_bf16_f32 v170, v16, v17
    v_mfma_f32_16x16x32_bf16 a[104:107], v[88:91], v[44:47], a[104:107]
    v_exp_f32 v16, v172
    v_mfma_f32_16x16x32_bf16 a[152:155], v[76:79], v[40:43], a[152:155]
    v_add_f32 v7, v7, v18
    v_cvt_f32_i32 v150, v150
    v_mfma_f32_16x16x32_bf16 a[152:155], v[92:95], v[44:47], a[152:155]
    s_waitcnt lgkmcnt(2)
    v_add_f32 v7, v7, v19
    v_fma_f32 v146, v146, v48, v50
    v_mfma_f32_16x16x32_bf16 a[12:15], v[64:67], v[24:27], a[12:15]
    ds_read_b128 v[40:43], v1 offset:5120
    v_mfma_f32_16x16x32_bf16 a[12:15], v[80:83], v[28:31], a[12:15]
    buffer_store_dwordx4 v[236:239], v23, s[4:7], s33 offen offset:2304 sc1
    v_mfma_f32_16x16x32_bf16 a[60:63], v[68:71], v[24:27], a[60:63]
    v_exp_f32 v17, v173
    v_mfma_f32_16x16x32_bf16 a[60:63], v[84:87], v[28:31], a[60:63]
    v_cvt_pk_bf16_f32 v171, v18, v19
    v_fma_f32 v150, v150, v49, v51
    v_mfma_f32_16x16x32_bf16 a[108:111], v[72:75], v[24:27], a[108:111]
    ds_read_b128 v[44:47], v1 offset:17408
    v_mfma_f32_16x16x32_bf16 a[108:111], v[88:91], v[28:31], a[108:111]
    v_exp_f32 v18, v174
    v_mfma_f32_16x16x32_bf16 a[156:159], v[76:79], v[24:27], a[156:159]
    s_add_u32 s29, s28, 49152
    v_add_f32 v8, v8, v16
    v_add_f32 v8, v8, v17
    v_mfma_f32_16x16x32_bf16 a[156:159], v[92:95], v[28:31], a[156:159]
    s_waitcnt lgkmcnt(2)
    v_exp_f32 v19, v175
    v_mfma_f32_16x16x32_bf16 a[16:19], v[64:67], v[32:35], a[16:19]
    s_sub_u32 s3, s29, 147456
    ds_read_b128 v[24:27], v1 offset:6144
    v_cvt_pk_bf16_f32 v172, v16, v17
    v_mfma_f32_16x16x32_bf16 a[16:19], v[80:83], v[36:39], a[16:19]
    s_mov_b32 m0, s26
    v_exp_f32 v16, v108
    v_mfma_f32_16x16x32_bf16 a[64:67], v[68:71], v[32:35], a[64:67]
    s_min_u32 s29, s29, s3
    v_add_f32 v8, v8, v18
    v_lshlrev_b32 v48, 16, v57
    v_mfma_f32_16x16x32_bf16 a[64:67], v[84:87], v[36:39], a[64:67]
    buffer_load_dwordx4 v4, s[4:7], s32 offen offset:0 sc1 lds
    v_mfma_f32_16x16x32_bf16 a[112:115], v[72:75], v[32:35], a[112:115]
    ds_read_b128 v[28:31], v1 offset:18432
    v_add_f32 v8, v8, v19
    v_mfma_f32_16x16x32_bf16 a[112:115], v[88:91], v[36:39], a[112:115]
    v_exp_f32 v17, v109
    v_mfma_f32_16x16x32_bf16 a[160:163], v[76:79], v[32:35], a[160:163]
    v_cvt_pk_bf16_f32 v173, v18, v19
    v_and_b32 v49, s97, v57
    v_mfma_f32_16x16x32_bf16 a[160:163], v[92:95], v[36:39], a[160:163]
    s_waitcnt lgkmcnt(2)
    buffer_load_dwordx4 v4, s[4:7], s32 offen offset:1024 sc1 lds
    v_mfma_f32_16x16x32_bf16 a[20:23], v[64:67], v[40:43], a[20:23]
    s_sub_u32 s3, s29, s28
    ds_read_b128 v[32:35], v1 offset:7168
    v_lshlrev_b32 v50, 16, v59
    v_mfma_f32_16x16x32_bf16 a[20:23], v[80:83], v[44:47], a[20:23]
    v_exp_f32 v18, v110
    v_mfma_f32_16x16x32_bf16 a[68:71], v[68:71], v[40:43], a[68:71]
    v_add_f32 v8, v8, v16
    v_add_f32 v8, v8, v17
    v_mfma_f32_16x16x32_bf16 a[68:71], v[84:87], v[44:47], a[68:71]
    buffer_load_dwordx4 v4, s[4:7], s32 offen offset:2048 sc1 lds
    v_mfma_f32_16x16x32_bf16 a[116:119], v[72:75], v[40:43], a[116:119]
    ds_read_b128 v[36:39], v1 offset:19456
    v_mfma_f32_16x16x32_bf16 a[116:119], v[88:91], v[44:47], a[116:119]
    v_exp_f32 v19, v111
    v_mfma_f32_16x16x32_bf16 a[164:167], v[76:79], v[40:43], a[164:167]
    s_mov_b32 s28, s29
    v_cvt_pk_bf16_f32 v174, v16, v17
    v_add_f32 v8, v8, v18
    v_mfma_f32_16x16x32_bf16 a[164:167], v[92:95], v[44:47], a[164:167]
    s_waitcnt lgkmcnt(2)
    v_add_f32 v8, v8, v19
    v_cvt_pk_bf16_f32 v175, v18, v19
    v_mfma_f32_16x16x32_bf16 a[24:27], v[64:67], v[24:27], a[24:27]
    s_add_u32 s32, s32, 24576
    ds_read_b128 v[40:43], v1 offset:8192
    v_and_b32 v51, s97, v59
    v_mfma_f32_16x16x32_bf16 a[24:27], v[80:83], v[28:31], a[24:27]
    v_exp_f32 v16, v176
    v_mfma_f32_16x16x32_bf16 a[72:75], v[68:71], v[24:27], a[72:75]
    s_add_u32 s26, s26, 12288
    v_exp_f32 v17, v177
    v_mfma_f32_16x16x32_bf16 a[72:75], v[84:87], v[28:31], a[72:75]
    v_exp_f32 v18, v178
    v_mfma_f32_16x16x32_bf16 a[120:123], v[72:75], v[24:27], a[120:123]
    s_mov_b32 m0, s26
    ds_read_b128 v[44:47], v1 offset:20480
    v_add_f32 v5, v5, v16
    v_mfma_f32_16x16x32_bf16 a[120:123], v[88:91], v[28:31], a[120:123]
    v_add_f32 v5, v5, v17
    v_mul_f32_e64 v50, -v50, v48
    v_mfma_f32_16x16x32_bf16 a[168:171], v[76:79], v[24:27], a[168:171]
    v_exp_f32 v19, v179
    v_mfma_f32_16x16x32_bf16 a[168:171], v[92:95], v[28:31], a[168:171]
    s_waitcnt lgkmcnt(2)
    v_cvt_pk_bf16_f32 v176, v16, v17
    v_mul_f32_e64 v51, -v51, v49
    v_mfma_f32_16x16x32_bf16 a[28:31], v[64:67], v[32:35], a[28:31]
    ds_read_b128 v[24:27], v1 offset:9216
    v_add_u32 v2, s3, v2
    v_mfma_f32_16x16x32_bf16 a[28:31], v[80:83], v[36:39], a[28:31]
    buffer_load_dwordx4 v4, s[4:7], s32 offen offset:0 sc1 lds
    v_mfma_f32_16x16x32_bf16 a[76:79], v[68:71], v[32:35], a[76:79]
    v_exp_f32 v16, v112
    v_mfma_f32_16x16x32_bf16 a[76:79], v[84:87], v[36:39], a[76:79]
    v_add_f32 v5, v5, v18
    v_add_f32 v5, v5, v19
    v_mfma_f32_16x16x32_bf16 a[124:127], v[72:75], v[32:35], a[124:127]
    ds_read_b128 v[28:31], v1 offset:21504
    v_cvt_f32_i32 v152, v152
    v_mfma_f32_16x16x32_bf16 a[124:127], v[88:91], v[36:39], a[124:127]
    buffer_load_dwordx4 v4, s[4:7], s32 offen offset:1024 sc1 lds
    v_mfma_f32_16x16x32_bf16 a[172:175], v[76:79], v[32:35], a[172:175]
    v_exp_f32 v17, v113
    v_mfma_f32_16x16x32_bf16 a[172:175], v[92:95], v[36:39], a[172:175]
    s_waitcnt lgkmcnt(2)
    v_cvt_pk_bf16_f32 v177, v18, v19
    v_add_u32 v3, s3, v3
    v_mfma_f32_16x16x32_bf16 a[32:35], v[64:67], v[40:43], a[32:35]
    ds_read_b128 v[32:35], v1 offset:10240
    v_cvt_f32_i32 v156, v156
    v_mfma_f32_16x16x32_bf16 a[32:35], v[80:83], v[44:47], a[32:35]
    v_exp_f32 v18, v114
    v_mfma_f32_16x16x32_bf16 a[80:83], v[68:71], v[40:43], a[80:83]
    v_add_f32 v5, v5, v16
    v_add_f32 v5, v5, v17
    v_mfma_f32_16x16x32_bf16 a[80:83], v[84:87], v[44:47], a[80:83]
    buffer_load_dwordx4 v4, s[4:7], s32 offen offset:2048 sc1 lds
    v_mfma_f32_16x16x32_bf16 a[128:131], v[72:75], v[40:43], a[128:131]
    ds_read_b128 v[36:39], v1 offset:22528
    v_mfma_f32_16x16x32_bf16 a[128:131], v[88:91], v[44:47], a[128:131]
    v_exp_f32 v19, v115
    v_mfma_f32_16x16x32_bf16 a[176:179], v[76:79], v[40:43], a[176:179]
    v_cvt_pk_bf16_f32 v178, v16, v17
    v_fma_f32 v152, v152, v48, v50
    v_mfma_f32_16x16x32_bf16 a[176:179], v[92:95], v[44:47], a[176:179]
    s_waitcnt lgkmcnt(2)
    v_exp_f32 v16, v180
    v_mfma_f32_16x16x32_bf16 a[36:39], v[64:67], v[24:27], a[36:39]
    ds_read_b128 v[40:43], v1 offset:11264
    v_add_f32 v5, v5, v18
    v_mfma_f32_16x16x32_bf16 a[36:39], v[80:83], v[28:31], a[36:39]
    v_add_f32 v5, v5, v19
    v_mfma_f32_16x16x32_bf16 a[84:87], v[68:71], v[24:27], a[84:87]
    v_exp_f32 v17, v181
    v_mfma_f32_16x16x32_bf16 a[84:87], v[84:87], v[28:31], a[84:87]
    s_add_u32 s32, s32, 24576
    v_cvt_pk_bf16_f32 v179, v18, v19
    s_add_u32 s26, s26, 36864
    v_mfma_f32_16x16x32_bf16 a[132:135], v[72:75], v[24:27], a[132:135]
    s_sub_u32 s57, s26, 147456
    ds_read_b128 v[44:47], v1 offset:23552
    v_fma_f32 v156, v156, v49, v51
    v_mfma_f32_16x16x32_bf16 a[132:135], v[88:91], v[28:31], a[132:135]
    s_waitcnt lgkmcnt(2)
    v_exp_f32 v18, v182
    v_mfma_f32_16x16x32_bf16 a[180:183], v[76:79], v[24:27], a[180:183]
    s_waitcnt vmcnt(6)
    v_add_f32 v6, v6, v16
    v_add_f32 v6, v6, v17
    v_mfma_f32_16x16x32_bf16 a[180:183], v[92:95], v[28:31], a[180:183]
    s_barrier
    v_mfma_f32_16x16x32_bf16 a[40:43], v[64:67], v[32:35], a[40:43]
    s_min_u32 s26, s26, s57
    ds_read_b128 v[24:27], v2 offset:0
    v_add_u32 v0, 1, v0
    v_mfma_f32_16x16x32_bf16 a[40:43], v[80:83], v[36:39], a[40:43]
    buffer_store_dword v0, v13, s[20:23], 0 offen offset:32 sc1
    v_mfma_f32_16x16x32_bf16 a[88:91], v[68:71], v[32:35], a[88:91]
    v_exp_f32 v19, v183
    v_mfma_f32_16x16x32_bf16 a[88:91], v[84:87], v[36:39], a[88:91]
    v_cvt_pk_bf16_f32 v180, v16, v17
    v_cvt_f32_i32 v153, v153
    v_mfma_f32_16x16x32_bf16 a[136:139], v[72:75], v[32:35], a[136:139]
    ds_read_b128 v[28:31], v3 offset:0
    v_cvt_f32_i32 v157, v157
    v_mfma_f32_16x16x32_bf16 a[136:139], v[88:91], v[36:39], a[136:139]
    v_exp_f32 v16, v116
    v_mfma_f32_16x16x32_bf16 a[184:187], v[76:79], v[32:35], a[184:187]
    v_add_f32 v6, v6, v18
    v_add_f32 v6, v6, v19
    v_mfma_f32_16x16x32_bf16 a[184:187], v[92:95], v[36:39], a[184:187]
    s_waitcnt lgkmcnt(2)
    v_exp_f32 v17, v117
    v_mfma_f32_16x16x32_bf16 a[44:47], v[64:67], v[40:43], a[44:47]
    ds_read_b128 v[32:35], v2 offset:6144
    v_cvt_pk_bf16_f32 v181, v18, v19
    v_mfma_f32_16x16x32_bf16 a[44:47], v[80:83], v[44:47], a[44:47]
    v_exp_f32 v18, v118
    v_mfma_f32_16x16x32_bf16 a[92:95], v[68:71], v[40:43], a[92:95]
    v_add_f32 v6, v6, v16
    v_add_f32 v6, v6, v17
    v_mfma_f32_16x16x32_bf16 a[92:95], v[84:87], v[44:47], a[92:95]
    v_exp_f32 v19, v119
    v_mfma_f32_16x16x32_bf16 a[140:143], v[72:75], v[40:43], a[140:143]
    ds_read_b128 v[36:39], v3 offset:6144
    v_cvt_pk_bf16_f32 v182, v16, v17
    v_mfma_f32_16x16x32_bf16 a[140:143], v[88:91], v[44:47], a[140:143]
    v_add_f32 v6, v6, v18
    v_add_f32 v6, v6, v19
    v_mfma_f32_16x16x32_bf16 a[188:191], v[76:79], v[40:43], a[188:191]
    v_cvt_pk_bf16_f32 v183, v18, v19
    v_mfma_f32_16x16x32_bf16 a[188:191], v[92:95], v[44:47], a[188:191]
    s_waitcnt lgkmcnt(2)
    v_mfma_f32_16x16x32_bf16 v[64:67], v[24:27], a[192:195], v[128:131]
    s_add_u32 s33, s33, 196608
    ds_read_b128 v[40:43], v2 offset:128
    v_fma_f32 v153, v153, v48, v50
    v_mfma_f32_16x16x32_bf16 v[64:67], v[28:31], a[196:199], v[64:67]
    s_mov_b32 m0, s56
    v_exp_f32 v16, v184
    v_mfma_f32_16x16x32_bf16 v[68:71], v[24:27], a[216:219], v[132:135]
    s_add_u32 s34, s34, 196608
    v_exp_f32 v17, v185
    v_mfma_f32_16x16x32_bf16 v[68:71], v[28:31], a[220:223], v[68:71]
    s_add_u32 s36, s36, 1536
    buffer_load_dwordx4 v4, s[4:7], s27 offen offset:0 sc1 lds
    v_mfma_f32_16x16x32_bf16 v[72:75], v[24:27], a[240:243], v[136:139]
    ds_read_b128 v[44:47], v3 offset:128
    v_fma_f32 v157, v157, v49, v51
    v_mfma_f32_16x16x32_bf16 v[72:75], v[28:31], a[244:247], v[72:75]
    v_exp_f32 v18, v186
    v_mfma_f32_16x16x32_bf16 v[76:79], v[24:27], v[200:203], v[140:143]
    v_add_f32 v7, v7, v16
    v_add_f32 v7, v7, v17
    v_mfma_f32_16x16x32_bf16 v[76:79], v[28:31], v[204:207], v[76:79]
    s_waitcnt lgkmcnt(2)
    buffer_load_dwordx2 v[56:57], v10, s[72:75], s36 offen offset:0
    v_mfma_f32_16x16x32_bf16 v[96:99], v[32:35], a[192:195], v[128:131]
    ds_read_b128 v[24:27], v2 offset:6272
    v_cvt_f32_i32 v154, v154
    v_mfma_f32_16x16x32_bf16 v[96:99], v[36:39], a[196:199], v[96:99]
    v_exp_f32 v19, v187
    v_mfma_f32_16x16x32_bf16 v[100:103], v[32:35], a[216:219], v[132:135]
    v_cvt_pk_bf16_f32 v184, v16, v17
    v_cvt_f32_i32 v158, v158
    v_mfma_f32_16x16x32_bf16 v[100:103], v[36:39], a[220:223], v[100:103]
    buffer_load_dwordx4 v4, s[4:7], s27 offen offset:1024 sc1 lds
    v_mfma_f32_16x16x32_bf16 v[104:107], v[32:35], a[240:243], v[136:139]
    ds_read_b128 v[28:31], v3 offset:6272
    v_fma_f32 v154, v154, v48, v50
    v_mfma_f32_16x16x32_bf16 v[104:107], v[36:39], a[244:247], v[104:107]
    v_exp_f32 v16, v120
    v_mfma_f32_16x16x32_bf16 v[108:111], v[32:35], v[200:203], v[140:143]
    v_add_f32 v7, v7, v18
    v_add_f32 v7, v7, v19
    v_mfma_f32_16x16x32_bf16 v[108:111], v[36:39], v[204:207], v[108:111]
    s_waitcnt lgkmcnt(2)
    buffer_load_dwordx2 v[58:59], v10, s[76:79], s36 offen offset:0
    v_mfma_f32_16x16x32_bf16 v[64:67], v[40:43], a[200:203], v[64:67]
    ds_read_b128 v[32:35], v2 offset:256
    v_fma_f32 v158, v158, v49, v51
    v_mfma_f32_16x16x32_bf16 v[64:67], v[44:47], a[204:207], v[64:67]
    v_exp_f32 v17, v121
    v_mfma_f32_16x16x32_bf16 v[68:71], v[40:43], a[224:227], v[68:71]
    v_cvt_pk_bf16_f32 v185, v18, v19
    v_mfma_f32_16x16x32_bf16 v[68:71], v[44:47], a[228:231], v[68:71]
    buffer_load_dwordx4 v[224:227], v9, s[64:67], s33 offen offset:0 nt
    v_mfma_f32_16x16x32_bf16 v[72:75], v[40:43], a[248:251], v[72:75]
    ds_read_b128 v[36:39], v3 offset:256
    v_cvt_pk_bf16_f32 v144, v144, v148
    v_mfma_f32_16x16x32_bf16 v[72:75], v[44:47], a[252:255], v[72:75]
    v_exp_f32 v18, v122
    v_mfma_f32_16x16x32_bf16 v[76:79], v[40:43], v[208:211], v[76:79]
    v_add_f32 v7, v7, v16
    v_add_f32 v7, v7, v17
    v_mfma_f32_16x16x32_bf16 v[76:79], v[44:47], v[212:215], v[76:79]
    s_waitcnt lgkmcnt(2)
    buffer_load_dwordx4 v4, s[4:7], s27 offen offset:2048 sc1 lds
    v_mfma_f32_16x16x32_bf16 v[96:99], v[24:27], a[200:203], v[96:99]
    ds_read_b128 v[40:43], v2 offset:6400
    v_cvt_pk_bf16_f32 v148, v145, v149
    v_mfma_f32_16x16x32_bf16 v[96:99], v[28:31], a[204:207], v[96:99]
    v_exp_f32 v19, v123
    v_cvt_pk_bf16_f32 v186, v16, v17
    v_mfma_f32_16x16x32_bf16 v[100:103], v[24:27], a[224:227], v[100:103]
    v_exp_f32 v16, v188
    v_mfma_f32_16x16x32_bf16 v[100:103], v[28:31], a[228:231], v[100:103]
    buffer_load_dwordx4 v[228:231], v9, s[64:67], s33 offen offset:1536 nt
    v_mfma_f32_16x16x32_bf16 v[104:107], v[24:27], a[248:251], v[104:107]
    ds_read_b128 v[44:47], v3 offset:6400
    v_add_f32 v7, v7, v18
    v_mfma_f32_16x16x32_bf16 v[104:107], v[28:31], a[252:255], v[104:107]
    v_add_f32 v7, v7, v19
    v_cvt_pk_bf16_f32 v145, v152, v156
    v_mfma_f32_16x16x32_bf16 v[108:111], v[24:27], v[208:211], v[108:111]
    s_add_u32 s29, s30, 49152
    v_exp_f32 v17, v189
    v_mfma_f32_16x16x32_bf16 v[108:111], v[28:31], v[212:215], v[108:111]
    s_waitcnt lgkmcnt(2)
    buffer_load_dwordx4 v[232:235], v9, s[64:67], s34 offen offset:0 nt
    v_cvt_pk_bf16_f32 v187, v18, v19
    v_mfma_f32_16x16x32_bf16 v[64:67], v[32:35], a[208:211], v[64:67]
    s_sub_u32 s3, s29, 147456
    ds_read_b128 v[24:27], v2 offset:12288
    s_add_u32 s27, s27, 24576
    v_mfma_f32_16x16x32_bf16 v[64:67], v[36:39], a[212:215], v[64:67]
    s_min_u32 s29, s29, s3
    v_exp_f32 v18, v190
    v_mfma_f32_16x16x32_bf16 v[68:71], v[32:35], a[232:235], v[68:71]
    v_add_f32 v8, v8, v16
    v_add_f32 v8, v8, v17
    v_mfma_f32_16x16x32_bf16 v[68:71], v[36:39], a[236:239], v[68:71]
    buffer_load_dwordx4 v[236:239], v9, s[64:67], s34 offen offset:1536 nt
    v_mfma_f32_16x16x32_bf16 v[72:75], v[32:35], v[192:195], v[72:75]
    s_add_u32 s56, s56, 12288
    ds_read_b128 v[28:31], v3 offset:12288
    v_cvt_pk_bf16_f32 v149, v153, v157
    v_mfma_f32_16x16x32_bf16 v[72:75], v[36:39], v[196:199], v[72:75]
    v_exp_f32 v19, v191
    v_cvt_pk_bf16_f32 v188, v16, v17
    v_mfma_f32_16x16x32_bf16 v[76:79], v[32:35], v[216:219], v[76:79]
    v_exp_f32 v16, v124
    v_mfma_f32_16x16x32_bf16 v[76:79], v[36:39], v[220:223], v[76:79]
    s_waitcnt lgkmcnt(2)
    v_add_f32 v8, v8, v18
    v_add_f32 v8, v8, v19
    v_mfma_f32_16x16x32_bf16 v[96:99], v[40:43], a[208:211], v[96:99]
    ds_read_b128 v[32:35], v2 offset:18432
    v_cvt_pk_bf16_f32 v152, v146, v150
    v_mfma_f32_16x16x32_bf16 v[96:99], v[44:47], a[212:215], v[96:99]
    s_sub_u32 s3, s29, s30
    v_exp_f32 v17, v125
    v_mfma_f32_16x16x32_bf16 v[100:103], v[40:43], a[232:235], v[100:103]
    s_mov_b32 m0, s56
    v_cvt_pk_bf16_f32 v189, v18, v19
    v_cvt_pk_bf16_f32 v153, v154, v158
    v_mfma_f32_16x16x32_bf16 v[100:103], v[44:47], a[236:239], v[100:103]
    v_exp_f32 v18, v126
    v_mfma_f32_16x16x32_bf16 v[104:107], v[40:43], v[192:195], v[104:107]
    ds_read_b128 v[36:39], v3 offset:18432
    v_add_f32 v8, v8, v16
    v_mfma_f32_16x16x32_bf16 v[104:107], v[44:47], v[196:199], v[104:107]
    v_add_f32 v8, v8, v17
    v_mfma_f32_16x16x32_bf16 v[108:111], v[40:43], v[216:219], v[108:111]
    v_exp_f32 v19, v127
    v_mfma_f32_16x16x32_bf16 v[108:111], v[44:47], v[220:223], v[108:111]
    s_waitcnt lgkmcnt(2)
    v_cvt_pk_bf16_f32 v190, v16, v17
    v_add_f32 v8, v8, v18
    v_mfma_f32_16x16x32_bf16 v[80:83], v[24:27], a[192:195], v[128:131]
    ds_read_b128 v[40:43], v2 offset:12416
    v_add_f32 v8, v8, v19
    v_mfma_f32_16x16x32_bf16 v[80:83], v[28:31], a[196:199], v[80:83]
    s_mov_b32 s30, s29
    v_cvt_pk_bf16_f32 v191, v18, v19
    v_mfma_f32_16x16x32_bf16 v[84:87], v[24:27], a[216:219], v[132:135]
    v_exp_f32 v16, v64
    v_mfma_f32_16x16x32_bf16 v[84:87], v[28:31], a[220:223], v[84:87]
    s_waitcnt vmcnt(20)
    buffer_load_dwordx4 v4, s[4:7], s27 offen offset:0 sc1 lds
    v_mfma_f32_16x16x32_bf16 v[88:91], v[24:27], a[240:243], v[136:139]
    ds_read_b128 v[44:47], v3 offset:12416
    v_lshlrev_b32 v48, 16, v60
    v_mfma_f32_16x16x32_bf16 v[88:91], v[28:31], a[244:247], v[88:91]
    v_exp_f32 v17, v65
    v_mfma_f32_16x16x32_bf16 v[92:95], v[24:27], v[200:203], v[140:143]
    v_exp_f32 v18, v66
    v_mfma_f32_16x16x32_bf16 v[92:95], v[28:31], v[204:207], v[92:95]
    s_waitcnt lgkmcnt(2)
    v_add_f32 v5, v5, v16
    v_add_f32 v5, v5, v17
    v_mfma_f32_16x16x32_bf16 v[112:115], v[32:35], a[192:195], v[128:131]
    ds_read_b128 v[24:27], v2 offset:18560
    v_and_b32 v49, s97, v60
    v_mfma_f32_16x16x32_bf16 v[112:115], v[36:39], a[196:199], v[112:115]
    v_exp_f32 v19, v67
    v_mfma_f32_16x16x32_bf16 v[116:119], v[32:35], a[216:219], v[132:135]
    v_cvt_pk_bf16_f32 v64, v16, v17
    v_lshlrev_b32 v50, 16, v62
    v_mfma_f32_16x16x32_bf16 v[116:119], v[36:39], a[220:223], v[116:119]
    v_exp_f32 v16, v96
    v_mfma_f32_16x16x32_bf16 v[120:123], v[32:35], a[240:243], v[136:139]
    ds_read_b128 v[28:31], v3 offset:18560
    v_add_f32 v5, v5, v18
    v_mfma_f32_16x16x32_bf16 v[120:123], v[36:39], a[244:247], v[120:123]
    v_add_f32 v5, v5, v19
    v_and_b32 v51, s97, v62
    v_mfma_f32_16x16x32_bf16 v[124:127], v[32:35], v[200:203], v[140:143]
    v_exp_f32 v17, v97
    v_mfma_f32_16x16x32_bf16 v[124:127], v[36:39], v[204:207], v[124:127]
    s_waitcnt lgkmcnt(2)
    buffer_load_dwordx4 v4, s[4:7], s27 offen offset:1024 sc1 lds
    v_mfma_f32_16x16x32_bf16 v[80:83], v[40:43], a[200:203], v[80:83]
    ds_read_b128 v[32:35], v2 offset:12544
    v_cvt_pk_bf16_f32 v65, v18, v19
    v_mfma_f32_16x16x32_bf16 v[80:83], v[44:47], a[204:207], v[80:83]
    v_exp_f32 v18, v98
    v_mfma_f32_16x16x32_bf16 v[84:87], v[40:43], a[224:227], v[84:87]
    v_add_f32 v5, v5, v16
    v_add_f32 v5, v5, v17
    v_mfma_f32_16x16x32_bf16 v[84:87], v[44:47], a[228:231], v[84:87]
    v_exp_f32 v19, v99
    v_mfma_f32_16x16x32_bf16 v[88:91], v[40:43], a[248:251], v[88:91]
    ds_read_b128 v[36:39], v3 offset:12544
    v_cvt_pk_bf16_f32 v66, v16, v17
    v_mfma_f32_16x16x32_bf16 v[88:91], v[44:47], a[252:255], v[88:91]
    v_exp_f32 v16, v68
    v_mfma_f32_16x16x32_bf16 v[92:95], v[40:43], v[208:211], v[92:95]
    v_add_u32 v1, s3, v1
    v_mul_f32_e64 v50, -v50, v48
    v_mfma_f32_16x16x32_bf16 v[92:95], v[44:47], v[212:215], v[92:95]
    s_waitcnt lgkmcnt(2)
    v_add_f32 v5, v5, v18
    v_add_f32 v5, v5, v19
    v_mfma_f32_16x16x32_bf16 v[112:115], v[24:27], a[200:203], v[112:115]
    ds_read_b128 v[40:43], v2 offset:18688
    v_mul_f32_e64 v51, -v51, v49
    v_mfma_f32_16x16x32_bf16 v[112:115], v[28:31], a[204:207], v[112:115]
    buffer_load_dwordx4 v4, s[4:7], s27 offen offset:2048 sc1 lds
    v_mfma_f32_16x16x32_bf16 v[116:119], v[24:27], a[224:227], v[116:119]
    v_exp_f32 v17, v69
    v_mfma_f32_16x16x32_bf16 v[116:119], v[28:31], a[228:231], v[116:119]
    v_cvt_pk_bf16_f32 v67, v18, v19
    v_cvt_f32_i32 v240, v240
    v_mfma_f32_16x16x32_bf16 v[120:123], v[24:27], a[248:251], v[120:123]
    ds_read_b128 v[44:47], v3 offset:18688
    v_mfma_f32_16x16x32_bf16 v[120:123], v[28:31], a[252:255], v[120:123]
    s_waitcnt lgkmcnt(2)
    v_exp_f32 v18, v70
    v_mfma_f32_16x16x32_bf16 v[124:127], v[24:27], v[208:211], v[124:127]
    s_waitcnt vmcnt(13)
    v_add_f32 v6, v6, v16
    v_add_f32 v6, v6, v17
    v_mfma_f32_16x16x32_bf16 v[124:127], v[28:31], v[212:215], v[124:127]
    s_barrier
    v_mfma_f32_16x16x32_bf16 v[80:83], v[32:35], a[208:211], v[80:83]
    ds_read_b128 v[24:27], v1 offset:0
    v_cvt_f32_i32 v244, v244
    v_mfma_f32_16x16x32_bf16 v[80:83], v[36:39], a[212:215], v[80:83]
    v_exp_f32 v19, v71
    v_mfma_f32_16x16x32_bf16 v[84:87], v[32:35], a[232:235], v[84:87]
    v_cvt_pk_bf16_f32 v68, v16, v17
    v_fma_f32 v240, v240, v48, v50
    v_mfma_f32_16x16x32_bf16 v[84:87], v[36:39], a[236:239], v[84:87]
    v_exp_f32 v16, v100
    v_mfma_f32_16x16x32_bf16 v[88:91], v[32:35], v[192:195], v[88:91]
    ds_read_b128 v[28:31], v1 offset:12288
    v_add_f32 v6, v6, v18
    v_mfma_f32_16x16x32_bf16 v[88:91], v[36:39], v[196:199], v[88:91]
    v_add_f32 v6, v6, v19
    v_fma_f32 v244, v244, v49, v51
    v_mfma_f32_16x16x32_bf16 v[92:95], v[32:35], v[216:219], v[92:95]
    v_exp_f32 v17, v101
    v_mfma_f32_16x16x32_bf16 v[92:95], v[36:39], v[220:223], v[92:95]
    s_waitcnt lgkmcnt(2)
    v_cvt_pk_bf16_f32 v69, v18, v19
    v_mfma_f32_16x16x32_bf16 v[112:115], v[40:43], a[208:211], v[112:115]
    ds_read_b128 v[32:35], v1 offset:1024
    v_mfma_f32_16x16x32_bf16 v[112:115], v[44:47], a[212:215], v[112:115]
    v_exp_f32 v18, v102
    v_mfma_f32_16x16x32_bf16 v[116:119], v[40:43], a[232:235], v[116:119]
    v_add_f32 v6, v6, v16
    v_add_f32 v6, v6, v17
    v_mfma_f32_16x16x32_bf16 v[116:119], v[44:47], a[236:239], v[116:119]
    s_add_u32 s27, s27, 24576
    v_exp_f32 v19, v103
    v_mfma_f32_16x16x32_bf16 v[120:123], v[40:43], v[192:195], v[120:123]
    s_add_u32 s56, s56, 36864
    ds_read_b128 v[36:39], v1 offset:13312
    v_cvt_pk_bf16_f32 v70, v16, v17
    v_mfma_f32_16x16x32_bf16 v[120:123], v[44:47], v[196:199], v[120:123]
    s_sub_u32 s58, s56, 147456
    v_add_f32 v6, v6, v18
    v_add_f32 v6, v6, v19
    v_mfma_f32_16x16x32_bf16 v[124:127], v[40:43], v[216:219], v[124:127]
    s_min_u32 s56, s56, s58
    v_cvt_pk_bf16_f32 v71, v18, v19
    v_mfma_f32_16x16x32_bf16 v[124:127], v[44:47], v[220:223], v[124:127]
    s_waitcnt lgkmcnt(2)
    v_mfma_f32_16x16x32_bf16 a[0:3], v[160:163], v[24:27], a[0:3]
    s_mov_b32 m0, s56
    ds_read_b128 v[40:43], v1 offset:2048
    v_cvt_f32_i32 v241, v241
    v_mfma_f32_16x16x32_bf16 a[0:3], v[176:179], v[28:31], a[0:3]
    buffer_load_dwordx4 v4, s[4:7], s27 offen offset:0 sc1 lds
    v_mfma_f32_16x16x32_bf16 a[48:51], v[164:167], v[24:27], a[48:51]
    v_exp_f32 v16, v72
    v_mfma_f32_16x16x32_bf16 a[48:51], v[180:183], v[28:31], a[48:51]
    v_exp_f32 v17, v73
    v_mfma_f32_16x16x32_bf16 a[96:99], v[168:171], v[24:27], a[96:99]
    ds_read_b128 v[44:47], v1 offset:14336
    v_cvt_f32_i32 v245, v245
    v_mfma_f32_16x16x32_bf16 a[96:99], v[184:187], v[28:31], a[96:99]
    v_exp_f32 v18, v74
    v_mfma_f32_16x16x32_bf16 a[144:147], v[172:175], v[24:27], a[144:147]
    v_add_f32 v7, v7, v16
    v_add_f32 v7, v7, v17
    v_mfma_f32_16x16x32_bf16 a[144:147], v[188:191], v[28:31], a[144:147]
    s_waitcnt lgkmcnt(2)
    v_exp_f32 v19, v75
    v_mfma_f32_16x16x32_bf16 a[4:7], v[160:163], v[32:35], a[4:7]
    ds_read_b128 v[24:27], v1 offset:3072
    v_fma_f32 v241, v241, v48, v50
    v_mfma_f32_16x16x32_bf16 a[4:7], v[176:179], v[36:39], a[4:7]
    buffer_load_dwordx4 v4, s[4:7], s27 offen offset:1024 sc1 lds
    v_mfma_f32_16x16x32_bf16 a[52:55], v[164:167], v[32:35], a[52:55]
    v_cvt_pk_bf16_f32 v72, v16, v17
    v_fma_f32 v245, v245, v49, v51
    v_mfma_f32_16x16x32_bf16 a[52:55], v[180:183], v[36:39], a[52:55]
    v_exp_f32 v16, v104
    v_mfma_f32_16x16x32_bf16 a[100:103], v[168:171], v[32:35], a[100:103]
    ds_read_b128 v[28:31], v1 offset:15360
    v_add_f32 v7, v7, v18
    v_mfma_f32_16x16x32_bf16 a[100:103], v[184:187], v[36:39], a[100:103]
    buffer_load_dword v52, v20, s[20:23], s44 offen sc1
    v_mfma_f32_16x16x32_bf16 a[148:151], v[172:175], v[32:35], a[148:151]
    v_add_f32 v7, v7, v19
    v_cvt_f32_i32 v242, v242
    v_mfma_f32_16x16x32_bf16 a[148:151], v[188:191], v[36:39], a[148:151]
    s_waitcnt lgkmcnt(2)
    v_exp_f32 v17, v105
    v_mfma_f32_16x16x32_bf16 a[8:11], v[160:163], v[40:43], a[8:11]
    ds_read_b128 v[32:35], v1 offset:4096
    v_cvt_pk_bf16_f32 v73, v18, v19
    v_mfma_f32_16x16x32_bf16 a[8:11], v[176:179], v[44:47], a[8:11]
    v_exp_f32 v18, v106
    v_mfma_f32_16x16x32_bf16 a[56:59], v[164:167], v[40:43], a[56:59]
    v_add_f32 v7, v7, v16
    v_cvt_f32_i32 v246, v246
    v_mfma_f32_16x16x32_bf16 a[56:59], v[180:183], v[44:47], a[56:59]
    buffer_load_dwordx4 v4, s[4:7], s27 offen offset:2048 sc1 lds
    v_mfma_f32_16x16x32_bf16 a[104:107], v[168:171], v[40:43], a[104:107]
    ds_read_b128 v[36:39], v1 offset:16384
    v_add_f32 v7, v7, v17
    v_mfma_f32_16x16x32_bf16 a[104:107], v[184:187], v[44:47], a[104:107]
    v_exp_f32 v19, v107
    v_mfma_f32_16x16x32_bf16 a[152:155], v[172:175], v[40:43], a[152:155]
    v_cvt_pk_bf16_f32 v74, v16, v17
    v_fma_f32 v242, v242, v48, v50
    v_mfma_f32_16x16x32_bf16 a[152:155], v[188:191], v[44:47], a[152:155]
    s_waitcnt lgkmcnt(2)
    v_exp_f32 v16, v76
    v_mfma_f32_16x16x32_bf16 a[12:15], v[160:163], v[24:27], a[12:15]
    ds_read_b128 v[40:43], v1 offset:5120
    v_add_f32 v7, v7, v18
    v_mfma_f32_16x16x32_bf16 a[12:15], v[176:179], v[28:31], a[12:15]
    s_add_u32 s27, s27, 24576
    v_add_f32 v7, v7, v19
    v_fma_f32 v246, v246, v49, v51
    v_mfma_f32_16x16x32_bf16 a[60:63], v[164:167], v[24:27], a[60:63]
    v_exp_f32 v17, v77
    v_mfma_f32_16x16x32_bf16 a[60:63], v[180:183], v[28:31], a[60:63]
    v_cvt_pk_bf16_f32 v75, v18, v19
    v_lshlrev_b32 v48, 16, v61
    v_mfma_f32_16x16x32_bf16 a[108:111], v[168:171], v[24:27], a[108:111]
    ds_read_b128 v[44:47], v1 offset:17408
    v_and_b32 v49, s97, v61
    v_mfma_f32_16x16x32_bf16 a[108:111], v[184:187], v[28:31], a[108:111]
L_pg4:
    s_cbranch_execz L_pg8
    v_exp_f32 v18, v78
    v_mfma_f32_16x16x32_bf16 a[156:159], v[172:175], v[24:27], a[156:159]
    s_add_u32 s29, s28, 49152
    v_add_f32 v8, v8, v16
    v_add_f32 v8, v8, v17
    v_mfma_f32_16x16x32_bf16 a[156:159], v[188:191], v[28:31], a[156:159]
    s_waitcnt lgkmcnt(2)
    v_exp_f32 v19, v79
    v_mfma_f32_16x16x32_bf16 a[16:19], v[160:163], v[32:35], a[16:19]
    s_sub_u32 s3, s29, 147456
    ds_read_b128 v[24:27], v1 offset:6144
    v_lshlrev_b32 v50, 16, v63
    v_mfma_f32_16x16x32_bf16 a[16:19], v[176:179], v[36:39], a[16:19]
    s_add_u32 s56, s56, 12288
    v_cvt_pk_bf16_f32 v76, v16, v17
    v_and_b32 v51, s97, v63
    v_mfma_f32_16x16x32_bf16 a[64:67], v[164:167], v[32:35], a[64:67]
    s_min_u32 s29, s29, s3
    v_exp_f32 v16, v108
    v_mfma_f32_16x16x32_bf16 a[64:67], v[180:183], v[36:39], a[64:67]
    s_mov_b32 m0, s56
    v_add_f32 v8, v8, v18
    v_add_f32 v8, v8, v19
    v_mfma_f32_16x16x32_bf16 a[112:115], v[168:171], v[32:35], a[112:115]
    ds_read_b128 v[28:31], v1 offset:18432
    v_mul_f32_e64 v50, -v50, v48
    v_mfma_f32_16x16x32_bf16 a[112:115], v[184:187], v[36:39], a[112:115]
    v_exp_f32 v17, v109
    v_mfma_f32_16x16x32_bf16 a[160:163], v[172:175], v[32:35], a[160:163]
    v_cvt_pk_bf16_f32 v77, v18, v19
    v_mul_f32_e64 v51, -v51, v49
    v_mfma_f32_16x16x32_bf16 a[160:163], v[188:191], v[36:39], a[160:163]
    s_waitcnt lgkmcnt(2)
    v_exp_f32 v18, v110
    v_mfma_f32_16x16x32_bf16 a[20:23], v[160:163], v[40:43], a[20:23]
    s_sub_u32 s3, s29, s28
    ds_read_b128 v[32:35], v1 offset:7168
    v_add_f32 v8, v8, v16
    v_mfma_f32_16x16x32_bf16 a[20:23], v[176:179], v[44:47], a[20:23]
    v_add_f32 v8, v8, v17
    v_cvt_f32_i32 v248, v248
    v_mfma_f32_16x16x32_bf16 a[68:71], v[164:167], v[40:43], a[68:71]
    v_exp_f32 v19, v111
    v_mfma_f32_16x16x32_bf16 a[68:71], v[180:183], v[44:47], a[68:71]
    buffer_load_dwordx4 v4, s[4:7], s27 offen offset:0 sc1 lds
    v_mfma_f32_16x16x32_bf16 a[116:119], v[168:171], v[40:43], a[116:119]
    ds_read_b128 v[36:39], v1 offset:19456
    v_cvt_pk_bf16_f32 v78, v16, v17
    v_mfma_f32_16x16x32_bf16 a[116:119], v[184:187], v[44:47], a[116:119]
    v_add_f32 v8, v8, v18
    v_cvt_f32_i32 v252, v252
    v_mfma_f32_16x16x32_bf16 a[164:167], v[172:175], v[40:43], a[164:167]
    s_mov_b32 s28, s29
    v_add_f32 v8, v8, v19
    v_cvt_pk_bf16_f32 v79, v18, v19
    v_mfma_f32_16x16x32_bf16 a[164:167], v[188:191], v[44:47], a[164:167]
    s_waitcnt lgkmcnt(2)
    v_exp_f32 v16, v80
    v_mfma_f32_16x16x32_bf16 a[24:27], v[160:163], v[24:27], a[24:27]
    ds_read_b128 v[40:43], v1 offset:8192
    v_fma_f32 v248, v248, v48, v50
    v_mfma_f32_16x16x32_bf16 a[24:27], v[176:179], v[28:31], a[24:27]
    v_exp_f32 v17, v81
    v_mfma_f32_16x16x32_bf16 a[72:75], v[164:167], v[24:27], a[72:75]
    v_fma_f32 v252, v252, v49, v51
    v_cvt_f32_i32 v249, v249
    v_mfma_f32_16x16x32_bf16 a[72:75], v[180:183], v[28:31], a[72:75]
    buffer_load_dwordx4 v4, s[4:7], s27 offen offset:1024 sc1 lds
    v_mfma_f32_16x16x32_bf16 a[120:123], v[168:171], v[24:27], a[120:123]
    ds_read_b128 v[44:47], v1 offset:20480
    v_cvt_f32_i32 v253, v253
    v_mfma_f32_16x16x32_bf16 a[120:123], v[184:187], v[28:31], a[120:123]
    v_exp_f32 v18, v82
    v_mfma_f32_16x16x32_bf16 a[168:171], v[172:175], v[24:27], a[168:171]
    v_add_f32 v5, v5, v16
    v_add_f32 v5, v5, v17
    v_mfma_f32_16x16x32_bf16 a[168:171], v[188:191], v[28:31], a[168:171]
    s_waitcnt lgkmcnt(2)
    v_exp_f32 v19, v83
    v_mfma_f32_16x16x32_bf16 a[28:31], v[160:163], v[32:35], a[28:31]
    ds_read_b128 v[24:27], v1 offset:9216
    v_cvt_pk_bf16_f32 v80, v16, v17
    v_mfma_f32_16x16x32_bf16 a[28:31], v[176:179], v[36:39], a[28:31]
    v_exp_f32 v16, v112
    v_mfma_f32_16x16x32_bf16 a[76:79], v[164:167], v[32:35], a[76:79]
    v_add_f32 v5, v5, v18
    v_fma_f32 v249, v249, v48, v50
    v_mfma_f32_16x16x32_bf16 a[76:79], v[180:183], v[36:39], a[76:79]
    v_add_f32 v5, v5, v19
    v_add_u32 v2, s3, v2
    v_mfma_f32_16x16x32_bf16 a[124:127], v[168:171], v[32:35], a[124:127]
    ds_read_b128 v[28:31], v1 offset:21504
    v_fma_f32 v253, v253, v49, v51
    v_mfma_f32_16x16x32_bf16 a[124:127], v[184:187], v[36:39], a[124:127]
    buffer_load_dwordx4 v4, s[4:7], s27 offen offset:2048 sc1 lds
    v_mfma_f32_16x16x32_bf16 a[172:175], v[172:175], v[32:35], a[172:175]
    v_exp_f32 v17, v113
    v_mfma_f32_16x16x32_bf16 a[172:175], v[188:191], v[36:39], a[172:175]
    s_waitcnt lgkmcnt(2)
    v_cvt_pk_bf16_f32 v81, v18, v19
    v_cvt_f32_i32 v250, v250
    v_mfma_f32_16x16x32_bf16 a[32:35], v[160:163], v[40:43], a[32:35]
    ds_read_b128 v[32:35], v1 offset:10240
    v_add_u32 v3, s3, v3
    v_mfma_f32_16x16x32_bf16 a[32:35], v[176:179], v[44:47], a[32:35]
    v_exp_f32 v18, v114
    v_mfma_f32_16x16x32_bf16 a[80:83], v[164:167], v[40:43], a[80:83]
    v_add_f32 v5, v5, v16
    v_add_f32 v5, v5, v17
    v_mfma_f32_16x16x32_bf16 a[80:83], v[180:183], v[44:47], a[80:83]
    v_exp_f32 v19, v115
    v_mfma_f32_16x16x32_bf16 a[128:131], v[168:171], v[40:43], a[128:131]
    ds_read_b128 v[36:39], v1 offset:22528
    v_cvt_pk_bf16_f32 v82, v16, v17
    v_mfma_f32_16x16x32_bf16 a[128:131], v[184:187], v[44:47], a[128:131]
    v_exp_f32 v16, v84
    v_mfma_f32_16x16x32_bf16 a[176:179], v[172:175], v[40:43], a[176:179]
    v_cvt_f32_i32 v254, v254
    v_add_f32 v5, v5, v18
    v_mfma_f32_16x16x32_bf16 a[176:179], v[188:191], v[44:47], a[176:179]
    s_waitcnt lgkmcnt(2)
    v_add_f32 v5, v5, v19
    v_fma_f32 v250, v250, v48, v50
    v_mfma_f32_16x16x32_bf16 a[36:39], v[160:163], v[24:27], a[36:39]
    ds_read_b128 v[40:43], v1 offset:11264
    v_fma_f32 v254, v254, v49, v51
    v_mfma_f32_16x16x32_bf16 a[36:39], v[176:179], v[28:31], a[36:39]
    v_exp_f32 v17, v85
    v_mfma_f32_16x16x32_bf16 a[84:87], v[164:167], v[24:27], a[84:87]
    v_cvt_pk_bf16_f32 v83, v18, v19
    v_cvt_pk_bf16_f32 v146, v240, v244
    v_mfma_f32_16x16x32_bf16 a[84:87], v[180:183], v[28:31], a[84:87]
    s_add_u32 s27, s27, 24576
    v_exp_f32 v18, v86
    v_mfma_f32_16x16x32_bf16 a[132:135], v[168:171], v[24:27], a[132:135]
    s_add_u32 s56, s56, 36864
    ds_read_b128 v[44:47], v1 offset:23552
    v_add_f32 v6, v6, v16
    v_mfma_f32_16x16x32_bf16 a[132:135], v[184:187], v[28:31], a[132:135]
    s_sub_u32 s58, s56, 147456
    v_add_f32 v6, v6, v17
    v_cvt_pk_bf16_f32 v150, v241, v245
    v_mfma_f32_16x16x32_bf16 a[180:183], v[172:175], v[24:27], a[180:183]
    v_exp_f32 v19, v87
    v_mfma_f32_16x16x32_bf16 a[180:183], v[188:191], v[28:31], a[180:183]
    s_waitcnt lgkmcnt(2)
    v_cvt_pk_bf16_f32 v84, v16, v17
    v_cvt_pk_bf16_f32 v147, v248, v252
    v_mfma_f32_16x16x32_bf16 a[40:43], v[160:163], v[32:35], a[40:43]
    s_min_u32 s56, s56, s58
    ds_read_b128 v[24:27], v2 offset:0
    v_mfma_f32_16x16x32_bf16 a[40:43], v[176:179], v[36:39], a[40:43]
    v_exp_f32 v16, v116
    v_mfma_f32_16x16x32_bf16 a[88:91], v[164:167], v[32:35], a[88:91]
    v_add_f32 v6, v6, v18
    v_add_f32 v6, v6, v19
    v_mfma_f32_16x16x32_bf16 a[88:91], v[180:183], v[36:39], a[88:91]
    v_exp_f32 v17, v117
    v_mfma_f32_16x16x32_bf16 a[136:139], v[168:171], v[32:35], a[136:139]
    ds_read_b128 v[28:31], v3 offset:0
    v_cvt_pk_bf16_f32 v151, v249, v253
    v_mfma_f32_16x16x32_bf16 a[136:139], v[184:187], v[36:39], a[136:139]
    v_cvt_pk_bf16_f32 v85, v18, v19
    v_cvt_pk_bf16_f32 v154, v242, v246
    v_mfma_f32_16x16x32_bf16 a[184:187], v[172:175], v[32:35], a[184:187]
    v_exp_f32 v18, v118
    v_mfma_f32_16x16x32_bf16 a[184:187], v[188:191], v[36:39], a[184:187]
    s_waitcnt lgkmcnt(2)
    v_add_f32 v6, v6, v16
    v_mfma_f32_16x16x32_bf16 a[44:47], v[160:163], v[40:43], a[44:47]
    ds_read_b128 v[32:35], v2 offset:6144
    v_add_f32 v6, v6, v17
    v_mfma_f32_16x16x32_bf16 a[44:47], v[176:179], v[44:47], a[44:47]
    v_exp_f32 v19, v119
    v_mfma_f32_16x16x32_bf16 a[92:95], v[164:167], v[40:43], a[92:95]
    v_cvt_pk_bf16_f32 v155, v250, v254
    v_mfma_f32_16x16x32_bf16 a[92:95], v[180:183], v[44:47], a[92:95]
    v_cvt_pk_bf16_f32 v86, v16, v17
    v_mfma_f32_16x16x32_bf16 a[140:143], v[168:171], v[40:43], a[140:143]
    ds_read_b128 v[36:39], v3 offset:6144
    v_add_f32 v6, v6, v18
    v_mfma_f32_16x16x32_bf16 a[140:143], v[184:187], v[44:47], a[140:143]
    v_add_f32 v6, v6, v19
    v_cvt_pk_bf16_f32 v87, v18, v19
    v_mfma_f32_16x16x32_bf16 a[188:191], v[172:175], v[40:43], a[188:191]
    v_mfma_f32_16x16x32_bf16 a[188:191], v[188:191], v[44:47], a[188:191]
    s_waitcnt lgkmcnt(2)
L_join:
    v_mfma_f32_16x16x32_bf16 v[160:163], v[24:27], a[192:195], v[128:131]
L_pg5:
    s_cbranch_execz L_pg9
    ds_read_b128 v[40:43], v2 offset:128
    v_mfma_f32_16x16x32_bf16 v[160:163], v[28:31], a[196:199], v[160:163]
    s_waitcnt vmcnt(4)
    v_subrev_u32 v52, s92, v52
    v_cmp_lt_u32 vcc, 15, v52
    v_mfma_f32_16x16x32_bf16 v[164:167], v[24:27], a[216:219], v[132:135]
    v_exp_f32 v16, v88
    v_mfma_f32_16x16x32_bf16 v[164:167], v[28:31], a[220:223], v[164:167]
    v_exp_f32 v17, v89
    v_mfma_f32_16x16x32_bf16 v[168:171], v[24:27], a[240:243], v[136:139]
    s_and_b32 s59, vcc_lo, 0xff
    ds_read_b128 v[44:47], v3 offset:128
    v_mfma_f32_16x16x32_bf16 v[168:171], v[28:31], a[244:247], v[168:171]
    s_cbranch_scc1 L_pollslow1
L_pollok1:
    v_mfma_f32_16x16x32_bf16 v[172:175], v[24:27], v[200:203], v[140:143]
    s_add_u32 s92, s92, 1
    v_exp_f32 v18, v90
    v_mfma_f32_16x16x32_bf16 v[172:175], v[28:31], v[204:207], v[172:175]
    s_waitcnt lgkmcnt(2)
    v_add_f32 v7, v7, v16
    v_add_f32 v7, v7, v17
    v_mfma_f32_16x16x32_bf16 v[96:99], v[32:35], a[192:195], v[128:131]
    ds_read_b128 v[24:27], v2 offset:6272
    v_mfma_f32_16x16x32_bf16 v[96:99], v[36:39], a[196:199], v[96:99]
    buffer_store_dwordx4 v[144:147], v15, s[4:7], s35 offen offset:0 sc1
    v_mfma_f32_16x16x32_bf16 v[100:103], v[32:35], a[216:219], v[132:135]
    v_exp_f32 v19, v91
    v_mfma_f32_16x16x32_bf16 v[100:103], v[36:39], a[220:223], v[100:103]
    v_cvt_pk_bf16_f32 v88, v16, v17
    v_mfma_f32_16x16x32_bf16 v[104:107], v[32:35], a[240:243], v[136:139]
    ds_read_b128 v[28:31], v3 offset:6272
    v_mfma_f32_16x16x32_bf16 v[104:107], v[36:39], a[244:247], v[104:107]
    v_exp_f32 v16, v120
    v_mfma_f32_16x16x32_bf16 v[108:111], v[32:35], v[200:203], v[140:143]
    v_add_f32 v7, v7, v18
    v_add_f32 v7, v7, v19
    v_mfma_f32_16x16x32_bf16 v[108:111], v[36:39], v[204:207], v[108:111]
    s_waitcnt lgkmcnt(2)
    v_exp_f32 v17, v121
    v_mfma_f32_16x16x32_bf16 v[160:163], v[40:43], a[200:203], v[160:163]
    ds_read_b128 v[32:35], v2 offset:256
    v_cvt_pk_bf16_f32 v89, v18, v19
    v_mfma_f32_16x16x32_bf16 v[160:163], v[44:47], a[204:207], v[160:163]
    buffer_store_dwordx4 v[148:151], v15, s[4:7], s35 offen offset:1024 sc1
    v_mfma_f32_16x16x32_bf16 v[164:167], v[40:43], a[224:227], v[164:167]
    v_exp_f32 v18, v122
    v_mfma_f32_16x16x32_bf16 v[164:167], v[44:47], a[228:231], v[164:167]
    v_add_f32 v7, v7, v16
    v_add_f32 v7, v7, v17
    v_mfma_f32_16x16x32_bf16 v[168:171], v[40:43], a[248:251], v[168:171]
    ds_read_b128 v[36:39], v3 offset:256
    v_mfma_f32_16x16x32_bf16 v[168:171], v[44:47], a[252:255], v[168:171]
    v_exp_f32 v19, v123
    v_mfma_f32_16x16x32_bf16 v[172:175], v[40:43], v[208:211], v[172:175]
    v_cvt_pk_bf16_f32 v90, v16, v17
    v_mfma_f32_16x16x32_bf16 v[172:175], v[44:47], v[212:215], v[172:175]
    s_waitcnt lgkmcnt(2)
    v_exp_f32 v16, v92
    v_mfma_f32_16x16x32_bf16 v[96:99], v[24:27], a[200:203], v[96:99]
    ds_read_b128 v[40:43], v2 offset:6400
    v_add_f32 v7, v7, v18
    v_mfma_f32_16x16x32_bf16 v[96:99], v[28:31], a[204:207], v[96:99]
    buffer_store_dwordx4 v[152:155], v15, s[4:7], s35 offen offset:2048 sc1
    v_mfma_f32_16x16x32_bf16 v[100:103], v[24:27], a[224:227], v[100:103]
    v_add_f32 v7, v7, v19
    v_mfma_f32_16x16x32_bf16 v[100:103], v[28:31], a[228:231], v[100:103]
    v_exp_f32 v17, v93
    v_mfma_f32_16x16x32_bf16 v[104:107], v[24:27], a[248:251], v[104:107]
    ds_read_b128 v[44:47], v3 offset:6400
    v_cvt_pk_bf16_f32 v91, v18, v19
    v_mfma_f32_16x16x32_bf16 v[104:107], v[28:31], a[252:255], v[104:107]
    v_exp_f32 v18, v94
    v_mfma_f32_16x16x32_bf16 v[108:111], v[24:27], v[208:211], v[108:111]
    s_add_u32 s29, s30, 49152
    v_add_f32 v8, v8, v16
    v_add_f32 v8, v8, v17
    v_mfma_f32_16x16x32_bf16 v[108:111], v[28:31], v[212:215], v[108:111]
    s_waitcnt lgkmcnt(2)
    v_exp_f32 v19, v95
    v_mfma_f32_16x16x32_bf16 v[160:163], v[32:35], a[208:211], v[160:163]
    s_sub_u32 s3, s29, 147456
    ds_read_b128 v[24:27], v2 offset:12288
    v_cvt_pk_bf16_f32 v92, v16, v17
    v_mfma_f32_16x16x32_bf16 v[160:163], v[36:39], a[212:215], v[160:163]
    s_min_u32 s29, s29, s3
    v_exp_f32 v16, v124
    v_mfma_f32_16x16x32_bf16 v[164:167], v[32:35], a[232:235], v[164:167]
    v_add_f32 v8, v8, v18
    v_add_f32 v8, v8, v19
    v_mfma_f32_16x16x32_bf16 v[164:167], v[36:39], a[236:239], v[164:167]
    v_exp_f32 v17, v125
    v_mfma_f32_16x16x32_bf16 v[168:171], v[32:35], v[192:195], v[168:171]
    ds_read_b128 v[28:31], v3 offset:12288
    v_mfma_f32_16x16x32_bf16 v[168:171], v[36:39], v[196:199], v[168:171]
    v_cvt_pk_bf16_f32 v93, v18, v19
    v_mfma_f32_16x16x32_bf16 v[172:175], v[32:35], v[216:219], v[172:175]
    v_exp_f32 v18, v126
    v_mfma_f32_16x16x32_bf16 v[172:175], v[36:39], v[220:223], v[172:175]
    s_waitcnt lgkmcnt(2)
    v_add_f32 v8, v8, v16
    v_mfma_f32_16x16x32_bf16 v[96:99], v[40:43], a[208:211], v[96:99]
    s_waitcnt vmcnt(10)
    ds_read_b128 v[32:35], v2 offset:18432
    v_lshlrev_b32 v48, 16, v56
    v_mfma_f32_16x16x32_bf16 v[96:99], v[44:47], a[212:215], v[96:99]
    s_mov_b32 m0, s26
    v_add_f32 v8, v8, v17
    v_and_b32 v49, s97, v56
    v_mfma_f32_16x16x32_bf16 v[100:103], v[40:43], a[232:235], v[100:103]
    s_sub_u32 s3, s29, s30
    v_exp_f32 v19, v127
    v_mfma_f32_16x16x32_bf16 v[100:103], v[44:47], a[236:239], v[100:103]
    buffer_load_dwordx4 v4, s[4:7], s32 offen offset:0 sc1 lds
    v_mfma_f32_16x16x32_bf16 v[104:107], v[40:43], v[192:195], v[104:107]
    ds_read_b128 v[36:39], v3 offset:18432
    v_cvt_pk_bf16_f32 v94, v16, v17
    v_mfma_f32_16x16x32_bf16 v[104:107], v[44:47], v[196:199], v[104:107]
    v_add_f32 v8, v8, v18
    v_add_f32 v8, v8, v19
    v_mfma_f32_16x16x32_bf16 v[108:111], v[40:43], v[216:219], v[108:111]
    v_lshlrev_b32 v50, 16, v58
    v_cvt_pk_bf16_f32 v95, v18, v19
    v_mfma_f32_16x16x32_bf16 v[108:111], v[44:47], v[220:223], v[108:111]
    s_waitcnt lgkmcnt(2)
    buffer_load_dwordx4 v4, s[4:7], s32 offen offset:1024 sc1 lds
    v_mfma_f32_16x16x32_bf16 v[176:179], v[24:27], a[192:195], v[128:131]
    ds_read_b128 v[40:43], v2 offset:12416
    v_and_b32 v51, s97, v58
    v_mfma_f32_16x16x32_bf16 v[176:179], v[28:31], a[196:199], v[176:179]
    s_mov_b32 s30, s29
    v_exp_f32 v16, v160
    v_mfma_f32_16x16x32_bf16 v[180:183], v[24:27], a[216:219], v[132:135]
    v_exp_f32 v17, v161
    v_mfma_f32_16x16x32_bf16 v[180:183], v[28:31], a[220:223], v[180:183]
    buffer_load_dwordx4 v4, s[4:7], s32 offen offset:2048 sc1 lds
    v_mfma_f32_16x16x32_bf16 v[184:187], v[24:27], a[240:243], v[136:139]
    s_add_u32 s32, s32, 24576
    ds_read_b128 v[44:47], v3 offset:12416
    v_mul_f32 v48, s38, v48
    v_mfma_f32_16x16x32_bf16 v[184:187], v[28:31], a[244:247], v[184:187]
    v_exp_f32 v18, v162
    v_mfma_f32_16x16x32_bf16 v[188:191], v[24:27], v[200:203], v[140:143]
    s_add_u32 s26, s26, 12288
    v_add_f32 v5, v5, v16
    v_add_f32 v5, v5, v17
    v_mfma_f32_16x16x32_bf16 v[188:191], v[28:31], v[204:207], v[188:191]
    s_waitcnt lgkmcnt(2)
    v_exp_f32 v19, v163
    v_mfma_f32_16x16x32_bf16 v[112:115], v[32:35], a[192:195], v[128:131]
    s_mov_b32 m0, s26
    ds_read_b128 v[24:27], v2 offset:18560
    v_mul_f32 v49, s38, v49
    v_mfma_f32_16x16x32_bf16 v[112:115], v[36:39], a[196:199], v[112:115]
    v_cvt_pk_bf16_f32 v160, v16, v17
    v_mul_f32_e64 v50, -v50, v48
    v_mfma_f32_16x16x32_bf16 v[116:119], v[32:35], a[216:219], v[132:135]
    v_exp_f32 v16, v96
    v_mfma_f32_16x16x32_bf16 v[116:119], v[36:39], a[220:223], v[116:119]
    v_add_f32 v5, v5, v18
    v_mul_f32_e64 v51, -v51, v49
    v_mfma_f32_16x16x32_bf16 v[120:123], v[32:35], a[240:243], v[136:139]
    ds_read_b128 v[28:31], v3 offset:18560
    v_add_f32 v5, v5, v19
    v_mfma_f32_16x16x32_bf16 v[120:123], v[36:39], a[244:247], v[120:123]
    buffer_load_dwordx4 v4, s[4:7], s32 offen offset:0 sc1 lds
    v_mfma_f32_16x16x32_bf16 v[124:127], v[32:35], v[200:203], v[140:143]
    v_exp_f32 v17, v97
    v_mfma_f32_16x16x32_bf16 v[124:127], v[36:39], v[204:207], v[124:127]
    s_waitcnt lgkmcnt(2)
    v_cvt_pk_bf16_f32 v161, v18, v19
    v_cvt_f32_i32 v224, v224
    v_mfma_f32_16x16x32_bf16 v[176:179], v[40:43], a[200:203], v[176:179]
    ds_read_b128 v[32:35], v2 offset:12544
    v_cvt_f32_i32 v225, v225
    v_mfma_f32_16x16x32_bf16 v[176:179], v[44:47], a[204:207], v[176:179]
    buffer_load_dwordx4 v4, s[4:7], s32 offen offset:1024 sc1 lds
    v_mfma_f32_16x16x32_bf16 v[180:183], v[40:43], a[224:227], v[180:183]
    v_exp_f32 v18, v98
    v_mfma_f32_16x16x32_bf16 v[180:183], v[44:47], a[228:231], v[180:183]
    v_add_f32 v5, v5, v16
    v_add_f32 v5, v5, v17
    v_mfma_f32_16x16x32_bf16 v[184:187], v[40:43], a[248:251], v[184:187]
    ds_read_b128 v[36:39], v3 offset:12544
    v_fma_f32 v224, v224, v48, v50
    v_mfma_f32_16x16x32_bf16 v[184:187], v[44:47], a[252:255], v[184:187]
    buffer_load_dwordx4 v4, s[4:7], s32 offen offset:2048 sc1 lds
    v_mfma_f32_16x16x32_bf16 v[188:191], v[40:43], v[208:211], v[188:191]
    v_exp_f32 v19, v99
    v_mfma_f32_16x16x32_bf16 v[188:191], v[44:47], v[212:215], v[188:191]
    s_waitcnt lgkmcnt(2)
    v_cvt_pk_bf16_f32 v162, v16, v17
    v_fma_f32 v225, v225, v49, v51
    v_mfma_f32_16x16x32_bf16 v[112:115], v[24:27], a[200:203], v[112:115]
    ds_read_b128 v[40:43], v2 offset:18688
    v_add_u32 v1, s3, v1
    v_mfma_f32_16x16x32_bf16 v[112:115], v[28:31], a[204:207], v[112:115]
    v_exp_f32 v16, v164
    v_mfma_f32_16x16x32_bf16 v[116:119], v[24:27], a[224:227], v[116:119]
    v_add_f32 v5, v5, v18
    v_add_f32 v5, v5, v19
    v_mfma_f32_16x16x32_bf16 v[116:119], v[28:31], a[228:231], v[116:119]
    s_add_u32 s32, s32, 24576
    v_exp_f32 v17, v165
    v_mfma_f32_16x16x32_bf16 v[120:123], v[24:27], a[248:251], v[120:123]
    s_add_u32 s26, s26, 36864
    ds_read_b128 v[44:47], v3 offset:18688
    v_cvt_pk_bf16_f32 v163, v18, v19
    v_mfma_f32_16x16x32_bf16 v[120:123], v[28:31], a[252:255], v[120:123]
    s_waitcnt lgkmcnt(2)
    v_exp_f32 v18, v166
    v_mfma_f32_16x16x32_bf16 v[124:127], v[24:27], v[208:211], v[124:127]
    s_waitcnt vmcnt(6)
    v_cvt_pk_bf16_f32 v224, v224, v225
    v_add_f32 v6, v6, v16
    v_mfma_f32_16x16x32_bf16 v[124:127], v[28:31], v[212:215], v[124:127]
    s_barrier
    v_mfma_f32_16x16x32_bf16 v[176:179], v[32:35], a[208:211], v[176:179]
    s_sub_u32 s57, s26, 147456
    ds_read_b128 v[24:27], v1 offset:0
    v_add_f32 v6, v6, v17
    v_mfma_f32_16x16x32_bf16 v[176:179], v[36:39], a[212:215], v[176:179]
    s_min_u32 s26, s26, s57
    v_exp_f32 v19, v167
    v_mfma_f32_16x16x32_bf16 v[180:183], v[32:35], a[232:235], v[180:183]
    v_cvt_f32_i32 v228, v228
    v_cvt_pk_bf16_f32 v164, v16, v17
    v_mfma_f32_16x16x32_bf16 v[180:183], v[36:39], a[236:239], v[180:183]
    v_cvt_f32_i32 v229, v229
    v_fma_f32 v228, v228, v48, v50
    v_mfma_f32_16x16x32_bf16 v[184:187], v[32:35], v[192:195], v[184:187]
    ds_read_b128 v[28:31], v1 offset:12288
    v_fma_f32 v229, v229, v49, v51
    v_mfma_f32_16x16x32_bf16 v[184:187], v[36:39], v[196:199], v[184:187]
    v_exp_f32 v16, v100
    v_mfma_f32_16x16x32_bf16 v[188:191], v[32:35], v[216:219], v[188:191]
    v_add_f32 v6, v6, v18
    v_add_f32 v6, v6, v19
    v_mfma_f32_16x16x32_bf16 v[188:191], v[36:39], v[220:223], v[188:191]
    s_waitcnt lgkmcnt(2)
    v_exp_f32 v17, v101
    v_mfma_f32_16x16x32_bf16 v[112:115], v[40:43], a[208:211], v[112:115]
    ds_read_b128 v[32:35], v1 offset:1024
    v_cvt_pk_bf16_f32 v165, v18, v19
    v_mfma_f32_16x16x32_bf16 v[112:115], v[44:47], a[212:215], v[112:115]
    v_exp_f32 v18, v102
    v_mfma_f32_16x16x32_bf16 v[116:119], v[40:43], a[232:235], v[116:119]
    v_cvt_pk_bf16_f32 v228, v228, v229
    v_add_u32 v0, 1, v0
    v_mfma_f32_16x16x32_bf16 v[116:119], v[44:47], a[236:239], v[116:119]
    buffer_store_dword v0, v13, s[20:23], 0 offen offset:32 sc1
    v_mfma_f32_16x16x32_bf16 v[120:123], v[40:43], v[192:195], v[120:123]
    ds_read_b128 v[36:39], v1 offset:13312
    v_add_f32 v6, v6, v16
    v_mfma_f32_16x16x32_bf16 v[120:123], v[44:47], v[196:199], v[120:123]
    v_add_f32 v6, v6, v17
    v_cvt_f32_i32 v232, v232
    v_mfma_f32_16x16x32_bf16 v[124:127], v[40:43], v[216:219], v[124:127]
    v_exp_f32 v19, v103
    v_mfma_f32_16x16x32_bf16 v[124:127], v[44:47], v[220:223], v[124:127]
    s_waitcnt lgkmcnt(2)
    v_cvt_pk_bf16_f32 v166, v16, v17
    v_add_f32 v6, v6, v18
    v_cvt_f32_i32 v233, v233
    v_add_f32 v6, v6, v19
    v_fma_f32 v232, v232, v48, v50
    v_cvt_pk_bf16_f32 v167, v18, v19
    v_fma_f32 v233, v233, v49, v51
    v_mfma_f32_16x16x32_bf16 a[0:3], v[64:67], v[24:27], a[0:3]
    s_mov_b32 m0, s26
    ds_read_b128 v[40:43], v1 offset:2048
    v_cvt_pk_bf16_f32 v232, v232, v233
    v_mfma_f32_16x16x32_bf16 a[0:3], v[80:83], v[28:31], a[0:3]
    buffer_load_dwordx2 v[60:61], v10, s[72:75], s36 offen offset:192
    v_mfma_f32_16x16x32_bf16 a[48:51], v[68:71], v[24:27], a[48:51]
    v_exp_f32 v16, v168
    v_mfma_f32_16x16x32_bf16 a[48:51], v[84:87], v[28:31], a[48:51]
    v_exp_f32 v17, v169
    v_mfma_f32_16x16x32_bf16 a[96:99], v[72:75], v[24:27], a[96:99]
    ds_read_b128 v[44:47], v1 offset:14336
    v_cvt_f32_i32 v236, v236
    v_mfma_f32_16x16x32_bf16 a[96:99], v[88:91], v[28:31], a[96:99]
    buffer_load_dwordx4 v4, s[4:7], s32 offen offset:0 sc1 lds
    v_mfma_f32_16x16x32_bf16 a[144:147], v[76:79], v[24:27], a[144:147]
    v_exp_f32 v18, v170
    v_mfma_f32_16x16x32_bf16 a[144:147], v[92:95], v[28:31], a[144:147]
    s_waitcnt lgkmcnt(2)
    v_add_f32 v7, v7, v16
    v_add_f32 v7, v7, v17
    v_mfma_f32_16x16x32_bf16 a[4:7], v[64:67], v[32:35], a[4:7]
    ds_read_b128 v[24:27], v1 offset:3072
    v_cvt_f32_i32 v237, v237
    v_mfma_f32_16x16x32_bf16 a[4:7], v[80:83], v[36:39], a[4:7]
    buffer_load_dwordx2 v[62:63], v10, s[76:79], s36 offen offset:192
    v_mfma_f32_16x16x32_bf16 a[52:55], v[68:71], v[32:35], a[52:55]
    v_exp_f32 v19, v171
    v_mfma_f32_16x16x32_bf16 a[52:55], v[84:87], v[36:39], a[52:55]
    v_cvt_pk_bf16_f32 v168, v16, v17
    v_fma_f32 v236, v236, v48, v50
    v_mfma_f32_16x16x32_bf16 a[100:103], v[72:75], v[32:35], a[100:103]
    ds_read_b128 v[28:31], v1 offset:15360
    v_fma_f32 v237, v237, v49, v51
    v_mfma_f32_16x16x32_bf16 a[100:103], v[88:91], v[36:39], a[100:103]
    buffer_load_dwordx4 v[240:243], v9, s[64:67], s33 offen offset:384 nt
    v_mfma_f32_16x16x32_bf16 a[148:151], v[76:79], v[32:35], a[148:151]
    v_exp_f32 v16, v104
    v_mfma_f32_16x16x32_bf16 a[148:151], v[92:95], v[36:39], a[148:151]
    s_waitcnt lgkmcnt(2)
    v_add_f32 v7, v7, v18
    v_add_f32 v7, v7, v19
    v_mfma_f32_16x16x32_bf16 a[8:11], v[64:67], v[40:43], a[8:11]
    ds_read_b128 v[32:35], v1 offset:4096
    v_cvt_pk_bf16_f32 v236, v236, v237
    v_mfma_f32_16x16x32_bf16 a[8:11], v[80:83], v[44:47], a[8:11]
    buffer_load_dwordx4 v4, s[4:7], s32 offen offset:1024 sc1 lds
    v_mfma_f32_16x16x32_bf16 a[56:59], v[68:71], v[40:43], a[56:59]
    v_exp_f32 v17, v105
    v_mfma_f32_16x16x32_bf16 a[56:59], v[84:87], v[44:47], a[56:59]
    v_cvt_pk_bf16_f32 v169, v18, v19
    v_lshlrev_b32 v48, 16, v57
    v_mfma_f32_16x16x32_bf16 a[104:107], v[72:75], v[40:43], a[104:107]
    ds_read_b128 v[36:39], v1 offset:16384
    v_mfma_f32_16x16x32_bf16 a[104:107], v[88:91], v[44:47], a[104:107]
    buffer_load_dwordx4 v[244:247], v9, s[64:67], s33 offen offset:1920 nt
    v_mfma_f32_16x16x32_bf16 a[152:155], v[76:79], v[40:43], a[152:155]
    v_exp_f32 v18, v106
    v_mfma_f32_16x16x32_bf16 a[152:155], v[92:95], v[44:47], a[152:155]
    s_waitcnt lgkmcnt(2)
    v_add_f32 v7, v7, v16
    v_add_f32 v7, v7, v17
    v_mfma_f32_16x16x32_bf16 a[12:15], v[64:67], v[24:27], a[12:15]
    ds_read_b128 v[40:43], v1 offset:5120
    v_and_b32 v49, s97, v57
    v_mfma_f32_16x16x32_bf16 a[12:15], v[80:83], v[28:31], a[12:15]
    buffer_load_dwordx4 v4, s[4:7], s32 offen offset:2048 sc1 lds
    v_mfma_f32_16x16x32_bf16 a[60:63], v[68:71], v[24:27], a[60:63]
    v_exp_f32 v19, v107
    v_mfma_f32_16x16x32_bf16 a[60:63], v[84:87], v[28:31], a[60:63]
    v_cvt_pk_bf16_f32 v170, v16, v17
    v_exp_f32 v16, v172
    v_mfma_f32_16x16x32_bf16 a[108:111], v[72:75], v[24:27], a[108:111]
    ds_read_b128 v[44:47], v1 offset:17408
    v_add_f32 v7, v7, v18
    v_mfma_f32_16x16x32_bf16 a[108:111], v[88:91], v[28:31], a[108:111]
    buffer_load_dwordx4 v[248:251], v9, s[64:67], s34 offen offset:384 nt
    v_add_f32 v7, v7, v19
    v_mfma_f32_16x16x32_bf16 a[156:159], v[76:79], v[24:27], a[156:159]
    s_add_u32 s29, s28, 49152
    v_exp_f32 v17, v173
    v_mfma_f32_16x16x32_bf16 a[156:159], v[92:95], v[28:31], a[156:159]
    s_waitcnt lgkmcnt(2)
    v_cvt_pk_bf16_f32 v171, v18, v19
    v_lshlrev_b32 v50, 16, v59
    v_mfma_f32_16x16x32_bf16 a[16:19], v[64:67], v[32:35], a[16:19]
    s_sub_u32 s3, s29, 147456
    ds_read_b128 v[24:27], v1 offset:6144
    v_and_b32 v51, s97, v59
    v_mfma_f32_16x16x32_bf16 a[16:19], v[80:83], v[36:39], a[16:19]
    s_add_u32 s32, s32, 24576
    buffer_load_dwordx4 v[252:255], v9, s[64:67], s34 offen offset:1920 nt
    v_mfma_f32_16x16x32_bf16 a[64:67], v[68:71], v[32:35], a[64:67]
    s_min_u32 s29, s29, s3
    v_exp_f32 v18, v174
    v_mfma_f32_16x16x32_bf16 a[64:67], v[84:87], v[36:39], a[64:67]
    v_add_f32 v8, v8, v16
    v_add_f32 v8, v8, v17
    v_mfma_f32_16x16x32_bf16 a[112:115], v[72:75], v[32:35], a[112:115]
    s_add_u32 s26, s26, 12288
    ds_read_b128 v[28:31], v1 offset:18432
    v_mul_f32 v48, s38, v48
    v_mfma_f32_16x16x32_bf16 a[112:115], v[88:91], v[36:39], a[112:115]
    v_exp_f32 v19, v175
    v_cvt_pk_bf16_f32 v172, v16, v17
    v_mfma_f32_16x16x32_bf16 a[160:163], v[76:79], v[32:35], a[160:163]
    v_exp_f32 v16, v108
    v_mfma_f32_16x16x32_bf16 a[160:163], v[92:95], v[36:39], a[160:163]
    s_waitcnt lgkmcnt(2)
    v_add_f32 v8, v8, v18
    v_add_f32 v8, v8, v19
    v_mfma_f32_16x16x32_bf16 a[20:23], v[64:67], v[40:43], a[20:23]
    s_sub_u32 s3, s29, s28
    ds_read_b128 v[32:35], v1 offset:7168
    v_mul_f32 v49, s38, v49
    v_mfma_f32_16x16x32_bf16 a[20:23], v[80:83], v[44:47], a[20:23]
    v_exp_f32 v17, v109
    v_mfma_f32_16x16x32_bf16 a[68:71], v[68:71], v[40:43], a[68:71]
    s_mov_b32 m0, s26
    v_cvt_pk_bf16_f32 v173, v18, v19
    v_mul_f32_e64 v50, -v50, v48
    v_mfma_f32_16x16x32_bf16 a[68:71], v[84:87], v[44:47], a[68:71]
    v_exp_f32 v18, v110
    v_mfma_f32_16x16x32_bf16 a[116:119], v[72:75], v[40:43], a[116:119]
    ds_read_b128 v[36:39], v1 offset:19456
    v_add_f32 v8, v8, v16
    v_mfma_f32_16x16x32_bf16 a[116:119], v[88:91], v[44:47], a[116:119]
    v_add_f32 v8, v8, v17
    v_mul_f32_e64 v51, -v51, v49
    v_mfma_f32_16x16x32_bf16 a[164:167], v[76:79], v[40:43], a[164:167]
    s_mov_b32 s28, s29
    v_exp_f32 v19, v111
    v_mfma_f32_16x16x32_bf16 a[164:167], v[92:95], v[44:47], a[164:167]
    s_waitcnt lgkmcnt(2)
    v_cvt_pk_bf16_f32 v174, v16, v17
    v_add_f32 v8, v8, v18
    v_mfma_f32_16x16x32_bf16 a[24:27], v[64:67], v[24:27], a[24:27]
    ds_read_b128 v[40:43], v1 offset:8192
    v_add_f32 v8, v8, v19
    v_mfma_f32_16x16x32_bf16 a[24:27], v[80:83], v[28:31], a[24:27]
    v_cvt_pk_bf16_f32 v175, v18, v19
    v_cvt_f32_i32 v226, v226
    v_mfma_f32_16x16x32_bf16 a[72:75], v[68:71], v[24:27], a[72:75]
    v_exp_f32 v16, v176
    v_mfma_f32_16x16x32_bf16 a[72:75], v[84:87], v[28:31], a[72:75]
    buffer_load_dwordx4 v4, s[4:7], s32 offen offset:0 sc1 lds
    v_mfma_f32_16x16x32_bf16 a[120:123], v[72:75], v[24:27], a[120:123]
    ds_read_b128 v[44:47], v1 offset:20480
    v_mfma_f32_16x16x32_bf16 a[120:123], v[88:91], v[28:31], a[120:123]
    v_exp_f32 v17, v177
    v_mfma_f32_16x16x32_bf16 a[168:171], v[76:79], v[24:27], a[168:171]
    v_exp_f32 v18, v178
    v_mfma_f32_16x16x32_bf16 a[168:171], v[92:95], v[28:31], a[168:171]
    s_waitcnt lgkmcnt(2)
    v_add_f32 v5, v5, v16
    v_add_f32 v5, v5, v17
    v_mfma_f32_16x16x32_bf16 a[28:31], v[64:67], v[32:35], a[28:31]
    ds_read_b128 v[24:27], v1 offset:9216
    v_cvt_f32_i32 v227, v227
    v_mfma_f32_16x16x32_bf16 a[28:31], v[80:83], v[36:39], a[28:31]
    v_exp_f32 v19, v179
    v_mfma_f32_16x16x32_bf16 a[76:79], v[68:71], v[32:35], a[76:79]
    v_cvt_pk_bf16_f32 v176, v16, v17
    v_add_u32 v2, s3, v2
    v_mfma_f32_16x16x32_bf16 a[76:79], v[84:87], v[36:39], a[76:79]
    v_exp_f32 v16, v112
    v_mfma_f32_16x16x32_bf16 a[124:127], v[72:75], v[32:35], a[124:127]
    ds_read_b128 v[28:31], v1 offset:21504
    v_add_f32 v5, v5, v18
    v_mfma_f32_16x16x32_bf16 a[124:127], v[88:91], v[36:39], a[124:127]
    v_add_f32 v5, v5, v19
    v_fma_f32 v226, v226, v48, v50
    v_mfma_f32_16x16x32_bf16 a[172:175], v[76:79], v[32:35], a[172:175]
    v_exp_f32 v17, v113
    v_mfma_f32_16x16x32_bf16 a[172:175], v[92:95], v[36:39], a[172:175]
L_pg6:
    s_cbranch_execz L_pg10
    s_waitcnt lgkmcnt(2)
    buffer_load_dwordx4 v4, s[4:7], s32 offen offset:1024 sc1 lds
    v_mfma_f32_16x16x32_bf16 a[32:35], v[64:67], v[40:43], a[32:35]
    ds_read_b128 v[32:35], v1 offset:10240
    v_cvt_pk_bf16_f32 v177, v18, v19
    v_mfma_f32_16x16x32_bf16 a[32:35], v[80:83], v[44:47], a[32:35]
    v_exp_f32 v18, v114
    v_mfma_f32_16x16x32_bf16 a[80:83], v[68:71], v[40:43], a[80:83]
    v_add_f32 v5, v5, v16
    v_add_f32 v5, v5, v17
    v_mfma_f32_16x16x32_bf16 a[80:83], v[84:87], v[44:47], a[80:83]
    v_exp_f32 v19, v115
    v_mfma_f32_16x16x32_bf16 a[128:131], v[72:75], v[40:43], a[128:131]
    ds_read_b128 v[36:39], v1 offset:22528
    v_cvt_pk_bf16_f32 v178, v16, v17
    v_mfma_f32_16x16x32_bf16 a[128:131], v[88:91], v[44:47], a[128:131]
    v_exp_f32 v16, v180
    v_mfma_f32_16x16x32_bf16 a[176:179], v[76:79], v[40:43], a[176:179]
    v_fma_f32 v227, v227, v49, v51
    v_add_u32 v3, s3, v3
    v_mfma_f32_16x16x32_bf16 a[176:179], v[92:95], v[44:47], a[176:179]
    s_waitcnt lgkmcnt(2)
    v_add_f32 v5, v5, v18
    v_add_f32 v5, v5, v19
    v_mfma_f32_16x16x32_bf16 a[36:39], v[64:67], v[24:27], a[36:39]
    ds_read_b128 v[40:43], v1 offset:11264
    v_cvt_pk_bf16_f32 v225, v226, v227
    v_mfma_f32_16x16x32_bf16 a[36:39], v[80:83], v[28:31], a[36:39]
    buffer_load_dwordx4 v4, s[4:7], s32 offen offset:2048 sc1 lds
    v_mfma_f32_16x16x32_bf16 a[84:87], v[68:71], v[24:27], a[84:87]
    v_exp_f32 v17, v181
    v_mfma_f32_16x16x32_bf16 a[84:87], v[84:87], v[28:31], a[84:87]
    v_cvt_pk_bf16_f32 v179, v18, v19
    v_cvt_f32_i32 v230, v230
    v_mfma_f32_16x16x32_bf16 a[132:135], v[72:75], v[24:27], a[132:135]
    ds_read_b128 v[44:47], v1 offset:23552
    v_cvt_f32_i32 v231, v231
    v_mfma_f32_16x16x32_bf16 a[132:135], v[88:91], v[28:31], a[132:135]
    s_waitcnt lgkmcnt(2)
    v_exp_f32 v18, v182
    v_mfma_f32_16x16x32_bf16 a[180:183], v[76:79], v[24:27], a[180:183]
    s_waitcnt vmcnt(13)
    v_add_f32 v6, v6, v16
    v_add_f32 v6, v6, v17
    v_mfma_f32_16x16x32_bf16 a[180:183], v[92:95], v[28:31], a[180:183]
    s_barrier
    v_mfma_f32_16x16x32_bf16 a[40:43], v[64:67], v[32:35], a[40:43]
    ds_read_b128 v[24:27], v2 offset:0
    v_fma_f32 v230, v230, v48, v50
    v_mfma_f32_16x16x32_bf16 a[40:43], v[80:83], v[36:39], a[40:43]
    v_exp_f32 v19, v183
    v_mfma_f32_16x16x32_bf16 a[88:91], v[68:71], v[32:35], a[88:91]
    v_cvt_pk_bf16_f32 v180, v16, v17
    v_fma_f32 v231, v231, v49, v51
    v_mfma_f32_16x16x32_bf16 a[88:91], v[84:87], v[36:39], a[88:91]
    v_exp_f32 v16, v116
    v_mfma_f32_16x16x32_bf16 a[136:139], v[72:75], v[32:35], a[136:139]
    ds_read_b128 v[28:31], v3 offset:0
    v_add_f32 v6, v6, v18
    v_mfma_f32_16x16x32_bf16 a[136:139], v[88:91], v[36:39], a[136:139]
    v_add_f32 v6, v6, v19
    v_cvt_pk_bf16_f32 v229, v230, v231
    v_mfma_f32_16x16x32_bf16 a[184:187], v[76:79], v[32:35], a[184:187]
    v_exp_f32 v17, v117
    v_mfma_f32_16x16x32_bf16 a[184:187], v[92:95], v[36:39], a[184:187]
    s_waitcnt lgkmcnt(2)
    v_cvt_pk_bf16_f32 v181, v18, v19
    v_mfma_f32_16x16x32_bf16 a[44:47], v[64:67], v[40:43], a[44:47]
    ds_read_b128 v[32:35], v2 offset:6144
    v_mfma_f32_16x16x32_bf16 a[44:47], v[80:83], v[44:47], a[44:47]
    v_exp_f32 v18, v118
    v_mfma_f32_16x16x32_bf16 a[92:95], v[68:71], v[40:43], a[92:95]
    v_add_f32 v6, v6, v16
    v_add_f32 v6, v6, v17
    v_mfma_f32_16x16x32_bf16 a[92:95], v[84:87], v[44:47], a[92:95]
    s_add_u32 s32, s32, 24576
    v_exp_f32 v19, v119
    v_mfma_f32_16x16x32_bf16 a[140:143], v[72:75], v[40:43], a[140:143]
    s_add_u32 s26, s26, 36864
    ds_read_b128 v[36:39], v3 offset:6144
    v_cvt_pk_bf16_f32 v182, v16, v17
    v_mfma_f32_16x16x32_bf16 a[140:143], v[88:91], v[44:47], a[140:143]
    s_sub_u32 s57, s26, 147456
    v_add_f32 v6, v6, v18
    v_add_f32 v6, v6, v19
    v_mfma_f32_16x16x32_bf16 a[188:191], v[76:79], v[40:43], a[188:191]
    s_min_u32 s26, s26, s57
    v_cvt_pk_bf16_f32 v183, v18, v19
    v_mfma_f32_16x16x32_bf16 a[188:191], v[92:95], v[44:47], a[188:191]
    s_waitcnt lgkmcnt(2)
    v_mfma_f32_16x16x32_bf16 v[64:67], v[24:27], a[192:195], v[128:131]
    ds_read_b128 v[40:43], v2 offset:128
    v_cvt_f32_i32 v234, v234
    v_mfma_f32_16x16x32_bf16 v[64:67], v[28:31], a[196:199], v[64:67]
    v_exp_f32 v16, v184
    v_mfma_f32_16x16x32_bf16 v[68:71], v[24:27], a[216:219], v[132:135]
    v_exp_f32 v17, v185
    v_mfma_f32_16x16x32_bf16 v[68:71], v[28:31], a[220:223], v[68:71]
    buffer_load_dword v52, v20, s[20:23], s44 offen sc1
    v_mfma_f32_16x16x32_bf16 v[72:75], v[24:27], a[240:243], v[136:139]
    ds_read_b128 v[44:47], v3 offset:128
    v_cvt_f32_i32 v235, v235
    v_mfma_f32_16x16x32_bf16 v[72:75], v[28:31], a[244:247], v[72:75]
    v_exp_f32 v18, v186
    v_mfma_f32_16x16x32_bf16 v[76:79], v[24:27], v[200:203], v[140:143]
    v_add_f32 v7, v7, v16
    v_add_f32 v7, v7, v17
    v_mfma_f32_16x16x32_bf16 v[76:79], v[28:31], v[204:207], v[76:79]
    s_waitcnt lgkmcnt(2)
    v_exp_f32 v19, v187
    v_mfma_f32_16x16x32_bf16 v[96:99], v[32:35], a[192:195], v[128:131]
    ds_read_b128 v[24:27], v2 offset:6272
    v_cvt_pk_bf16_f32 v184, v16, v17
    v_mfma_f32_16x16x32_bf16 v[96:99], v[36:39], a[196:199], v[96:99]
    v_exp_f32 v16, v120
    v_mfma_f32_16x16x32_bf16 v[100:103], v[32:35], a[216:219], v[132:135]
    v_add_f32 v7, v7, v18
    v_fma_f32 v234, v234, v48, v50
    v_mfma_f32_16x16x32_bf16 v[100:103], v[36:39], a[220:223], v[100:103]
    s_add_u32 s35, s35, 196608
    s_mov_b32 m0, s26
    v_add_f32 v7, v7, v19
    v_mfma_f32_16x16x32_bf16 v[104:107], v[32:35], a[240:243], v[136:139]
    s_add_u32 s16, s16, 196608
    ds_read_b128 v[28:31], v3 offset:6272
    v_fma_f32 v235, v235, v49, v51
    v_mfma_f32_16x16x32_bf16 v[104:107], v[36:39], a[244:247], v[104:107]
    s_add_u32 s17, s17, 196608
    buffer_load_dwordx4 v4, s[4:7], s32 offen offset:0 sc1 lds
    v_mfma_f32_16x16x32_bf16 v[108:111], v[32:35], v[200:203], v[140:143]
    v_exp_f32 v17, v121
    v_mfma_f32_16x16x32_bf16 v[108:111], v[36:39], v[204:207], v[108:111]
    s_waitcnt lgkmcnt(2)
    v_cvt_pk_bf16_f32 v185, v18, v19
    v_cvt_pk_bf16_f32 v233, v234, v235
    v_mfma_f32_16x16x32_bf16 v[64:67], v[40:43], a[200:203], v[64:67]
    s_add_u32 s37, s37, 512
    ds_read_b128 v[32:35], v2 offset:256
    v_mfma_f32_16x16x32_bf16 v[64:67], v[44:47], a[204:207], v[64:67]
    v_exp_f32 v18, v122
    v_mfma_f32_16x16x32_bf16 v[68:71], v[40:43], a[224:227], v[68:71]
    v_add_f32 v7, v7, v16
    v_add_f32 v7, v7, v17
    v_mfma_f32_16x16x32_bf16 v[68:71], v[44:47], a[228:231], v[68:71]
    v_exp_f32 v19, v123
    v_mfma_f32_16x16x32_bf16 v[72:75], v[40:43], a[248:251], v[72:75]
    ds_read_b128 v[36:39], v3 offset:256
    v_cvt_pk_bf16_f32 v186, v16, v17
    v_mfma_f32_16x16x32_bf16 v[72:75], v[44:47], a[252:255], v[72:75]
    buffer_load_dwordx4 v4, s[4:7], s32 offen offset:1024 sc1 lds
    v_mfma_f32_16x16x32_bf16 v[76:79], v[40:43], v[208:211], v[76:79]
    v_exp_f32 v16, v188
    v_mfma_f32_16x16x32_bf16 v[76:79], v[44:47], v[212:215], v[76:79]
    s_waitcnt lgkmcnt(2)
    v_add_f32 v7, v7, v18
    v_add_f32 v7, v7, v19
    v_mfma_f32_16x16x32_bf16 v[96:99], v[24:27], a[200:203], v[96:99]
    ds_read_b128 v[40:43], v2 offset:6400
    v_cvt_f32_i32 v238, v238
    v_mfma_f32_16x16x32_bf16 v[96:99], v[28:31], a[204:207], v[96:99]
    buffer_load_dwordx2 v[56:57], off, s[80:83], s37 offset:0
    v_mfma_f32_16x16x32_bf16 v[100:103], v[24:27], a[224:227], v[100:103]
    v_exp_f32 v17, v189
    v_mfma_f32_16x16x32_bf16 v[100:103], v[28:31], a[228:231], v[100:103]
    v_cvt_pk_bf16_f32 v187, v18, v19
    v_cvt_f32_i32 v239, v239
    v_mfma_f32_16x16x32_bf16 v[104:107], v[24:27], a[248:251], v[104:107]
    ds_read_b128 v[44:47], v3 offset:6400
    v_mfma_f32_16x16x32_bf16 v[104:107], v[28:31], a[252:255], v[104:107]
    buffer_load_dwordx2 v[58:59], off, s[84:87], s37 offset:0
    v_mfma_f32_16x16x32_bf16 v[108:111], v[24:27], v[208:211], v[108:111]
    s_add_u32 s29, s30, 49152
    v_exp_f32 v18, v190
    v_mfma_f32_16x16x32_bf16 v[108:111], v[28:31], v[212:215], v[108:111]
    s_waitcnt lgkmcnt(2)
    v_add_f32 v8, v8, v16
    v_add_f32 v8, v8, v17
    v_mfma_f32_16x16x32_bf16 v[64:67], v[32:35], a[208:211], v[64:67]
    s_sub_u32 s3, s29, 147456
    ds_read_b128 v[24:27], v2 offset:12288
    v_mfma_f32_16x16x32_bf16 v[64:67], v[36:39], a[212:215], v[64:67]
    s_min_u32 s29, s29, s3
    buffer_load_dwordx4 v4, s[4:7], s32 offen offset:2048 sc1 lds
    v_mfma_f32_16x16x32_bf16 v[68:71], v[32:35], a[232:235], v[68:71]
    v_exp_f32 v19, v191
    v_mfma_f32_16x16x32_bf16 v[68:71], v[36:39], a[236:239], v[68:71]
    v_cvt_pk_bf16_f32 v188, v16, v17
    v_fma_f32 v238, v238, v48, v50
    v_mfma_f32_16x16x32_bf16 v[72:75], v[32:35], v[192:195], v[72:75]
    ds_read_b128 v[28:31], v3 offset:12288
    v_mfma_f32_16x16x32_bf16 v[72:75], v[36:39], v[196:199], v[72:75]
    buffer_load_dwordx3 v[144:146], v12, s[68:71], s35 offen offset:0 nt
    v_mfma_f32_16x16x32_bf16 v[76:79], v[32:35], v[216:219], v[76:79]
    v_exp_f32 v16, v124
    v_mfma_f32_16x16x32_bf16 v[76:79], v[36:39], v[220:223], v[76:79]
    s_waitcnt lgkmcnt(2)
    v_add_f32 v8, v8, v18
    v_add_f32 v8, v8, v19
    v_mfma_f32_16x16x32_bf16 v[96:99], v[40:43], a[208:211], v[96:99]
    s_add_u32 s32, s32, 24576
    ds_read_b128 v[32:35], v2 offset:18432
    v_fma_f32 v239, v239, v49, v51
    v_mfma_f32_16x16x32_bf16 v[96:99], v[44:47], a[212:215], v[96:99]
    s_sub_u32 s3, s29, s30
    v_exp_f32 v17, v125
    v_mfma_f32_16x16x32_bf16 v[100:103], v[40:43], a[232:235], v[100:103]
    v_cvt_pk_bf16_f32 v189, v18, v19
    v_mfma_f32_16x16x32_bf16 v[100:103], v[44:47], a[236:239], v[100:103]
    v_exp_f32 v18, v126
    v_mfma_f32_16x16x32_bf16 v[104:107], v[40:43], v[192:195], v[104:107]
    s_add_u32 s26, s26, 12288
    ds_read_b128 v[36:39], v3 offset:18432
    v_add_f32 v8, v8, v16
    v_mfma_f32_16x16x32_bf16 v[104:107], v[44:47], v[196:199], v[104:107]
    buffer_load_dwordx3 v[148:150], v12, s[68:71], s35 offen offset:768 nt
    v_mfma_f32_16x16x32_bf16 v[108:111], v[40:43], v[216:219], v[108:111]
    v_add_f32 v8, v8, v17
    v_cvt_pk_bf16_f32 v237, v238, v239
    v_mfma_f32_16x16x32_bf16 v[108:111], v[44:47], v[220:223], v[108:111]
    s_waitcnt lgkmcnt(2)
    v_exp_f32 v19, v127
    v_mfma_f32_16x16x32_bf16 v[80:83], v[24:27], a[192:195], v[128:131]
    ds_read_b128 v[40:43], v2 offset:12416
    v_cvt_pk_bf16_f32 v190, v16, v17
    v_mfma_f32_16x16x32_bf16 v[80:83], v[28:31], a[196:199], v[80:83]
    s_mov_b32 m0, s26
    v_add_f32 v8, v8, v18
    v_add_f32 v8, v8, v19
    v_mfma_f32_16x16x32_bf16 v[84:87], v[24:27], a[216:219], v[132:135]
    s_mov_b32 s30, s29
    v_cvt_pk_bf16_f32 v191, v18, v19
    v_mfma_f32_16x16x32_bf16 v[84:87], v[28:31], a[220:223], v[84:87]
    v_exp_f32 v16, v64
    v_mfma_f32_16x16x32_bf16 v[88:91], v[24:27], a[240:243], v[136:139]
    ds_read_b128 v[44:47], v3 offset:12416
    v_mfma_f32_16x16x32_bf16 v[88:91], v[28:31], a[244:247], v[88:91]
    buffer_load_dwordx3 v[152:154], v12, s[68:71], s35 offen offset:1536 nt
    v_mfma_f32_16x16x32_bf16 v[92:95], v[24:27], v[200:203], v[140:143]
    v_exp_f32 v17, v65
    v_mfma_f32_16x16x32_bf16 v[92:95], v[28:31], v[204:207], v[92:95]
    s_waitcnt lgkmcnt(2)
    v_exp_f32 v18, v66
    v_mfma_f32_16x16x32_bf16 v[112:115], v[32:35], a[192:195], v[128:131]
    ds_read_b128 v[24:27], v2 offset:18560
    v_add_f32 v5, v5, v16
    v_mfma_f32_16x16x32_bf16 v[112:115], v[36:39], a[196:199], v[112:115]
    buffer_load_dwordx4 v4, s[4:7], s32 offen offset:0 sc1 lds
    v_mfma_f32_16x16x32_bf16 v[116:119], v[32:35], a[216:219], v[132:135]
    v_add_f32 v5, v5, v17
    v_add_u32 v1, s3, v1
    v_mfma_f32_16x16x32_bf16 v[116:119], v[36:39], a[220:223], v[116:119]
    v_exp_f32 v19, v67
    v_mfma_f32_16x16x32_bf16 v[120:123], v[32:35], a[240:243], v[136:139]
    ds_read_b128 v[28:31], v3 offset:18560
    v_cvt_pk_bf16_f32 v64, v16, v17
    v_mfma_f32_16x16x32_bf16 v[120:123], v[36:39], a[244:247], v[120:123]
    s_waitcnt vmcnt(13)
    buffer_load_dwordx3 v[156:158], v12, s[68:71], s35 offen offset:2304 nt
    v_mfma_f32_16x16x32_bf16 v[124:127], v[32:35], v[200:203], v[140:143]
    v_exp_f32 v16, v96
    v_mfma_f32_16x16x32_bf16 v[124:127], v[36:39], v[204:207], v[124:127]
    s_waitcnt lgkmcnt(2)
    v_add_f32 v5, v5, v18
    v_add_f32 v5, v5, v19
    v_mfma_f32_16x16x32_bf16 v[80:83], v[40:43], a[200:203], v[80:83]
    ds_read_b128 v[32:35], v2 offset:12544
    v_lshlrev_b32 v48, 16, v60
    v_mfma_f32_16x16x32_bf16 v[80:83], v[44:47], a[204:207], v[80:83]
    v_exp_f32 v17, v97
    v_mfma_f32_16x16x32_bf16 v[84:87], v[40:43], a[224:227], v[84:87]
    v_cvt_pk_bf16_f32 v65, v18, v19
    v_and_b32 v49, s97, v60
    v_mfma_f32_16x16x32_bf16 v[84:87], v[44:47], a[228:231], v[84:87]
    buffer_load_dwordx4 v4, s[4:7], s32 offen offset:1024 sc1 lds
    v_mfma_f32_16x16x32_bf16 v[88:91], v[40:43], a[248:251], v[88:91]
    ds_read_b128 v[36:39], v3 offset:12544
    v_lshlrev_b32 v50, 16, v62
    v_mfma_f32_16x16x32_bf16 v[88:91], v[44:47], a[252:255], v[88:91]
    v_exp_f32 v18, v98
    v_mfma_f32_16x16x32_bf16 v[92:95], v[40:43], v[208:211], v[92:95]
    v_add_f32 v5, v5, v16
    v_add_f32 v5, v5, v17
    v_mfma_f32_16x16x32_bf16 v[92:95], v[44:47], v[212:215], v[92:95]
    s_waitcnt lgkmcnt(2)
    v_exp_f32 v19, v99
    v_mfma_f32_16x16x32_bf16 v[112:115], v[24:27], a[200:203], v[112:115]
    ds_read_b128 v[40:43], v2 offset:18688
    v_cvt_pk_bf16_f32 v66, v16, v17
    v_mfma_f32_16x16x32_bf16 v[112:115], v[28:31], a[204:207], v[112:115]
    v_exp_f32 v16, v68
    v_mfma_f32_16x16x32_bf16 v[116:119], v[24:27], a[224:227], v[116:119]
    v_add_f32 v5, v5, v18
    v_add_f32 v5, v5, v19
    v_mfma_f32_16x16x32_bf16 v[116:119], v[28:31], a[228:231], v[116:119]
    v_exp_f32 v17, v69
    v_mfma_f32_16x16x32_bf16 v[120:123], v[24:27], a[248:251], v[120:123]
    ds_read_b128 v[44:47], v3 offset:18688
    v_cvt_pk_bf16_f32 v67, v18, v19
    v_mfma_f32_16x16x32_bf16 v[120:123], v[28:31], a[252:255], v[120:123]
    s_waitcnt lgkmcnt(2)
    buffer_load_dwordx4 v4, s[4:7], s32 offen offset:2048 sc1 lds
    v_mfma_f32_16x16x32_bf16 v[124:127], v[24:27], v[208:211], v[124:127]
    s_waitcnt vmcnt(13)
    v_exp_f32 v18, v70
    v_mfma_f32_16x16x32_bf16 v[124:127], v[28:31], v[212:215], v[124:127]
    s_barrier
    v_mfma_f32_16x16x32_bf16 v[80:83], v[32:35], a[208:211], v[80:83]
    ds_read_b128 v[24:27], v1 offset:0
    v_add_f32 v6, v6, v16
    v_mfma_f32_16x16x32_bf16 v[80:83], v[36:39], a[212:215], v[80:83]
    v_add_f32 v6, v6, v17
    v_and_b32 v51, s97, v62
    v_mfma_f32_16x16x32_bf16 v[84:87], v[32:35], a[232:235], v[84:87]
    v_exp_f32 v19, v71
    v_mfma_f32_16x16x32_bf16 v[84:87], v[36:39], a[236:239], v[84:87]
    v_cvt_pk_bf16_f32 v68, v16, v17
    v_mul_f32 v48, s38, v48
    v_mfma_f32_16x16x32_bf16 v[88:91], v[32:35], v[192:195], v[88:91]
    ds_read_b128 v[28:31], v1 offset:12288
    v_mul_f32 v49, s38, v49
    v_mfma_f32_16x16x32_bf16 v[88:91], v[36:39], v[196:199], v[88:91]
    v_exp_f32 v16, v100
    v_mfma_f32_16x16x32_bf16 v[92:95], v[32:35], v[216:219], v[92:95]
    v_add_f32 v6, v6, v18
    v_add_f32 v6, v6, v19
    v_mfma_f32_16x16x32_bf16 v[92:95], v[36:39], v[220:223], v[92:95]
    s_waitcnt lgkmcnt(2)
    v_exp_f32 v17, v101
    v_mfma_f32_16x16x32_bf16 v[112:115], v[40:43], a[208:211], v[112:115]
    ds_read_b128 v[32:35], v1 offset:1024
    v_cvt_pk_bf16_f32 v69, v18, v19
    v_mfma_f32_16x16x32_bf16 v[112:115], v[44:47], a[212:215], v[112:115]
    v_exp_f32 v18, v102
    v_mfma_f32_16x16x32_bf16 v[116:119], v[40:43], a[232:235], v[116:119]
    v_add_f32 v6, v6, v16
    v_add_f32 v6, v6, v17
    v_mfma_f32_16x16x32_bf16 v[116:119], v[44:47], a[236:239], v[116:119]
    v_exp_f32 v19, v103
    v_mfma_f32_16x16x32_bf16 v[120:123], v[40:43], v[192:195], v[120:123]
    ds_read_b128 v[36:39], v1 offset:13312
    v_cvt_pk_bf16_f32 v70, v16, v17
    v_mfma_f32_16x16x32_bf16 v[120:123], v[44:47], v[196:199], v[120:123]
    s_add_u32 s32, s32, 24576
    v_add_f32 v6, v6, v18
    s_add_u32 s26, s26, 36864
    v_mfma_f32_16x16x32_bf16 v[124:127], v[40:43], v[216:219], v[124:127]
    s_sub_u32 s57, s26, 147456
    v_add_f32 v6, v6, v19
    v_cvt_pk_bf16_f32 v71, v18, v19
    v_mfma_f32_16x16x32_bf16 v[124:127], v[44:47], v[220:223], v[124:127]
    s_waitcnt lgkmcnt(2)
    s_min_u32 s26, s26, s57
    v_mfma_f32_16x16x32_bf16 a[0:3], v[160:163], v[24:27], a[0:3]
    ds_read_b128 v[40:43], v1 offset:2048
    v_mul_f32_e64 v50, -v50, v48
    v_mfma_f32_16x16x32_bf16 a[0:3], v[176:179], v[28:31], a[0:3]
    s_waitcnt vmcnt(12)
    v_subrev_u32 v52, s92, v52
    v_cmp_lt_u32 vcc, 15, v52
    v_mfma_f32_16x16x32_bf16 a[48:51], v[164:167], v[24:27], a[48:51]
    v_exp_f32 v16, v72
    v_mfma_f32_16x16x32_bf16 a[48:51], v[180:183], v[28:31], a[48:51]
    v_exp_f32 v17, v73
    v_mfma_f32_16x16x32_bf16 a[96:99], v[168:171], v[24:27], a[96:99]
    s_and_b32 s59, vcc_lo, 0xff
    ds_read_b128 v[44:47], v1 offset:14336
    v_mul_f32_e64 v51, -v51, v49
    v_mfma_f32_16x16x32_bf16 a[96:99], v[184:187], v[28:31], a[96:99]
    s_cbranch_scc1 L_pollslow2
L_pollok2:
    v_mfma_f32_16x16x32_bf16 a[144:147], v[172:175], v[24:27], a[144:147]
    s_add_u32 s92, s92, 1
    v_exp_f32 v18, v74
    v_mfma_f32_16x16x32_bf16 a[144:147], v[188:191], v[28:31], a[144:147]
    s_waitcnt lgkmcnt(2)
    v_add_f32 v7, v7, v16
    v_add_f32 v7, v7, v17
    v_mfma_f32_16x16x32_bf16 a[4:7], v[160:163], v[32:35], a[4:7]
    s_mov_b32 m0, s56
    ds_read_b128 v[24:27], v1 offset:3072
    v_cvt_f32_i32 v240, v240
    v_mfma_f32_16x16x32_bf16 a[4:7], v[176:179], v[36:39], a[4:7]
    buffer_load_dwordx4 v4, s[4:7], s27 offen offset:0 sc1 lds
    v_mfma_f32_16x16x32_bf16 a[52:55], v[164:167], v[32:35], a[52:55]
    v_exp_f32 v19, v75
    v_mfma_f32_16x16x32_bf16 a[52:55], v[180:183], v[36:39], a[52:55]
    v_cvt_pk_bf16_f32 v72, v16, v17
    v_cvt_f32_i32 v241, v241
    v_mfma_f32_16x16x32_bf16 a[100:103], v[168:171], v[32:35], a[100:103]
    ds_read_b128 v[28:31], v1 offset:15360
    v_fma_f32 v240, v240, v48, v50
    v_mfma_f32_16x16x32_bf16 a[100:103], v[184:187], v[36:39], a[100:103]
    v_exp_f32 v16, v104
    v_mfma_f32_16x16x32_bf16 a[148:151], v[172:175], v[32:35], a[148:151]
    v_add_f32 v7, v7, v18
    v_add_f32 v7, v7, v19
    v_mfma_f32_16x16x32_bf16 a[148:151], v[188:191], v[36:39], a[148:151]
    s_waitcnt lgkmcnt(2)
    v_exp_f32 v17, v105
    v_mfma_f32_16x16x32_bf16 a[8:11], v[160:163], v[40:43], a[8:11]
    ds_read_b128 v[32:35], v1 offset:4096
    v_cvt_pk_bf16_f32 v73, v18, v19
    v_mfma_f32_16x16x32_bf16 a[8:11], v[176:179], v[44:47], a[8:11]
    buffer_load_dwordx4 v4, s[4:7], s27 offen offset:1024 sc1 lds
    v_mfma_f32_16x16x32_bf16 a[56:59], v[164:167], v[40:43], a[56:59]
    v_exp_f32 v18, v106
    v_mfma_f32_16x16x32_bf16 a[56:59], v[180:183], v[44:47], a[56:59]
    v_add_f32 v7, v7, v16
    v_fma_f32 v241, v241, v49, v51
    v_mfma_f32_16x16x32_bf16 a[104:107], v[168:171], v[40:43], a[104:107]
    ds_read_b128 v[36:39], v1 offset:16384
    v_add_f32 v7, v7, v17
    v_mfma_f32_16x16x32_bf16 a[104:107], v[184:187], v[44:47], a[104:107]
    v_exp_f32 v19, v107
    v_mfma_f32_16x16x32_bf16 a[152:155], v[172:175], v[40:43], a[152:155]
    v_cvt_pk_bf16_f32 v74, v16, v17
    v_cvt_pk_bf16_f32 v226, v240, v241
    v_mfma_f32_16x16x32_bf16 a[152:155], v[188:191], v[44:47], a[152:155]
    s_waitcnt lgkmcnt(2)
    v_exp_f32 v16, v76
    v_mfma_f32_16x16x32_bf16 a[12:15], v[160:163], v[24:27], a[12:15]
    ds_read_b128 v[40:43], v1 offset:5120
    v_add_f32 v7, v7, v18
    v_mfma_f32_16x16x32_bf16 a[12:15], v[176:179], v[28:31], a[12:15]
    buffer_load_dwordx4 v4, s[4:7], s27 offen offset:2048 sc1 lds
    v_mfma_f32_16x16x32_bf16 a[60:63], v[164:167], v[24:27], a[60:63]
    v_add_f32 v7, v7, v19
    v_cvt_f32_i32 v244, v244
    v_mfma_f32_16x16x32_bf16 a[60:63], v[180:183], v[28:31], a[60:63]
    v_exp_f32 v17, v77
    v_mfma_f32_16x16x32_bf16 a[108:111], v[168:171], v[24:27], a[108:111]
    ds_read_b128 v[44:47], v1 offset:17408
    v_cvt_pk_bf16_f32 v75, v18, v19
    v_mfma_f32_16x16x32_bf16 a[108:111], v[184:187], v[28:31], a[108:111]
    v_exp_f32 v18, v78
    v_mfma_f32_16x16x32_bf16 a[156:159], v[172:175], v[24:27], a[156:159]
    s_add_u32 s29, s28, 49152
    v_cvt_f32_i32 v245, v245
    v_fma_f32 v244, v244, v48, v50
    v_mfma_f32_16x16x32_bf16 a[156:159], v[188:191], v[28:31], a[156:159]
    s_waitcnt lgkmcnt(2)
    v_add_f32 v8, v8, v16
    v_add_f32 v8, v8, v17
    v_mfma_f32_16x16x32_bf16 a[16:19], v[160:163], v[32:35], a[16:19]
    s_sub_u32 s3, s29, 147456
    ds_read_b128 v[24:27], v1 offset:6144
    v_fma_f32 v245, v245, v49, v51
    v_mfma_f32_16x16x32_bf16 a[16:19], v[176:179], v[36:39], a[16:19]
    s_add_u32 s27, s27, 24576
    v_exp_f32 v19, v79
    v_mfma_f32_16x16x32_bf16 a[64:67], v[164:167], v[32:35], a[64:67]
    s_min_u32 s29, s29, s3
    v_cvt_pk_bf16_f32 v76, v16, v17
    v_cvt_pk_bf16_f32 v230, v244, v245
    v_mfma_f32_16x16x32_bf16 a[64:67], v[180:183], v[36:39], a[64:67]
    s_add_u32 s56, s56, 12288
    v_exp_f32 v16, v108
    v_mfma_f32_16x16x32_bf16 a[112:115], v[168:171], v[32:35], a[112:115]
    ds_read_b128 v[28:31], v1 offset:18432
    v_add_f32 v8, v8, v18
    v_mfma_f32_16x16x32_bf16 a[112:115], v[184:187], v[36:39], a[112:115]
    v_add_f32 v8, v8, v19
    v_cvt_f32_i32 v248, v248
    v_mfma_f32_16x16x32_bf16 a[160:163], v[172:175], v[32:35], a[160:163]
    v_exp_f32 v17, v109
    v_mfma_f32_16x16x32_bf16 a[160:163], v[188:191], v[36:39], a[160:163]
    s_waitcnt lgkmcnt(2)
    v_cvt_f32_i32 v249, v249
    v_cvt_pk_bf16_f32 v77, v18, v19
    v_mfma_f32_16x16x32_bf16 a[20:23], v[160:163], v[40:43], a[20:23]
    s_mov_b32 m0, s56
    ds_read_b128 v[32:35], v1 offset:7168
    v_fma_f32 v248, v248, v48, v50
    v_mfma_f32_16x16x32_bf16 a[20:23], v[176:179], v[44:47], a[20:23]
    s_sub_u32 s3, s29, s28
    v_exp_f32 v18, v110
    v_mfma_f32_16x16x32_bf16 a[68:71], v[164:167], v[40:43], a[68:71]
    v_add_f32 v8, v8, v16
    v_add_f32 v8, v8, v17
    v_mfma_f32_16x16x32_bf16 a[68:71], v[180:183], v[44:47], a[68:71]
    v_exp_f32 v19, v111
    v_mfma_f32_16x16x32_bf16 a[116:119], v[168:171], v[40:43], a[116:119]
    ds_read_b128 v[36:39], v1 offset:19456
    v_fma_f32 v249, v249, v49, v51
    v_mfma_f32_16x16x32_bf16 a[116:119], v[184:187], v[44:47], a[116:119]
    buffer_load_dwordx4 v4, s[4:7], s27 offen offset:0 sc1 lds
    v_mfma_f32_16x16x32_bf16 a[164:167], v[172:175], v[40:43], a[164:167]
    s_mov_b32 s28, s29
    v_cvt_pk_bf16_f32 v78, v16, v17
    v_add_f32 v8, v8, v18
    v_mfma_f32_16x16x32_bf16 a[164:167], v[188:191], v[44:47], a[164:167]
    s_waitcnt lgkmcnt(2)
    v_add_f32 v8, v8, v19
    v_cvt_pk_bf16_f32 v234, v248, v249
    v_mfma_f32_16x16x32_bf16 a[24:27], v[160:163], v[24:27], a[24:27]
    ds_read_b128 v[40:43], v1 offset:8192
    v_cvt_pk_bf16_f32 v79, v18, v19
    v_mfma_f32_16x16x32_bf16 a[24:27], v[176:179], v[28:31], a[24:27]
    v_exp_f32 v16, v80
    v_mfma_f32_16x16x32_bf16 a[72:75], v[164:167], v[24:27], a[72:75]
    v_cvt_f32_i32 v252, v252
    v_cvt_f32_i32 v253, v253
    v_mfma_f32_16x16x32_bf16 a[72:75], v[180:183], v[28:31], a[72:75]
    v_exp_f32 v17, v81
    v_mfma_f32_16x16x32_bf16 a[120:123], v[168:171], v[24:27], a[120:123]
    ds_read_b128 v[44:47], v1 offset:20480
    v_fma_f32 v252, v252, v48, v50
    v_mfma_f32_16x16x32_bf16 a[120:123], v[184:187], v[28:31], a[120:123]
    v_exp_f32 v18, v82
    v_mfma_f32_16x16x32_bf16 a[168:171], v[172:175], v[24:27], a[168:171]
    v_add_f32 v5, v5, v16
    v_add_f32 v5, v5, v17
    v_mfma_f32_16x16x32_bf16 a[168:171], v[188:191], v[28:31], a[168:171]
    s_waitcnt lgkmcnt(2)
    buffer_load_dwordx4 v4, s[4:7], s27 offen offset:1024 sc1 lds
    v_mfma_f32_16x16x32_bf16 a[28:31], v[160:163], v[32:35], a[28:31]
    ds_read_b128 v[24:27], v1 offset:9216
    v_fma_f32 v253, v253, v49, v51
    v_mfma_f32_16x16x32_bf16 a[28:31], v[176:179], v[36:39], a[28:31]
    v_exp_f32 v19, v83
    v_mfma_f32_16x16x32_bf16 a[76:79], v[164:167], v[32:35], a[76:79]
    v_cvt_pk_bf16_f32 v80, v16, v17
    v_cvt_pk_bf16_f32 v238, v252, v253
    v_mfma_f32_16x16x32_bf16 a[76:79], v[180:183], v[36:39], a[76:79]
    v_exp_f32 v16, v112
    v_mfma_f32_16x16x32_bf16 a[124:127], v[168:171], v[32:35], a[124:127]
    ds_read_b128 v[28:31], v1 offset:21504
    v_add_f32 v5, v5, v18
    v_mfma_f32_16x16x32_bf16 a[124:127], v[184:187], v[36:39], a[124:127]
    v_add_f32 v5, v5, v19
    v_lshlrev_b32 v48, 16, v61
    v_mfma_f32_16x16x32_bf16 a[172:175], v[172:175], v[32:35], a[172:175]
    v_exp_f32 v17, v113
    v_mfma_f32_16x16x32_bf16 a[172:175], v[188:191], v[36:39], a[172:175]
    s_waitcnt lgkmcnt(2)
    buffer_load_dwordx4 v4, s[4:7], s27 offen offset:2048 sc1 lds
    v_mfma_f32_16x16x32_bf16 a[32:35], v[160:163], v[40:43], a[32:35]
    ds_read_b128 v[32:35], v1 offset:10240
    v_cvt_pk_bf16_f32 v81, v18, v19
    v_mfma_f32_16x16x32_bf16 a[32:35], v[176:179], v[44:47], a[32:35]
    v_exp_f32 v18, v114
    v_mfma_f32_16x16x32_bf16 a[80:83], v[164:167], v[40:43], a[80:83]
    v_add_f32 v5, v5, v16
    v_and_b32 v49, s97, v61
    v_mfma_f32_16x16x32_bf16 a[80:83], v[180:183], v[44:47], a[80:83]
    v_add_f32 v5, v5, v17
    v_lshlrev_b32 v50, 16, v63
    v_mfma_f32_16x16x32_bf16 a[128:131], v[168:171], v[40:43], a[128:131]
    ds_read_b128 v[36:39], v1 offset:22528
    v_add_u32 v2, s3, v2
    v_mfma_f32_16x16x32_bf16 a[128:131], v[184:187], v[44:47], a[128:131]
    v_exp_f32 v19, v115
    v_mfma_f32_16x16x32_bf16 a[176:179], v[172:175], v[40:43], a[176:179]
    v_cvt_pk_bf16_f32 v82, v16, v17
    v_and_b32 v51, s97, v63
    v_mfma_f32_16x16x32_bf16 a[176:179], v[188:191], v[44:47], a[176:179]
    s_waitcnt lgkmcnt(2)
    v_exp_f32 v16, v84
    v_mfma_f32_16x16x32_bf16 a[36:39], v[160:163], v[24:27], a[36:39]
    ds_read_b128 v[40:43], v1 offset:11264
    v_add_f32 v5, v5, v18
    v_mfma_f32_16x16x32_bf16 a[36:39], v[176:179], v[28:31], a[36:39]
    v_add_f32 v5, v5, v19
    v_mul_f32 v48, s38, v48
    v_mfma_f32_16x16x32_bf16 a[84:87], v[164:167], v[24:27], a[84:87]
    v_exp_f32 v17, v85
    v_mfma_f32_16x16x32_bf16 a[84:87], v[180:183], v[28:31], a[84:87]
    s_add_u32 s27, s27, 24576
    v_add_u32 v3, s3, v3
    v_cvt_pk_bf16_f32 v83, v18, v19
    v_mfma_f32_16x16x32_bf16 a[132:135], v[168:171], v[24:27], a[132:135]
    s_add_u32 s56, s56, 36864
    ds_read_b128 v[44:47], v1 offset:23552
    v_mul_f32 v49, s38, v49
    v_mfma_f32_16x16x32_bf16 a[132:135], v[184:187], v[28:31], a[132:135]
    s_sub_u32 s58, s56, 147456
    v_exp_f32 v18, v86
    v_mfma_f32_16x16x32_bf16 a[180:183], v[172:175], v[24:27], a[180:183]
    v_add_f32 v6, v6, v16
    v_add_f32 v6, v6, v17
    v_mfma_f32_16x16x32_bf16 a[180:183], v[188:191], v[28:31], a[180:183]
    s_waitcnt lgkmcnt(2)
    v_mul_f32_e64 v50, -v50, v48
    v_mul_f32_e64 v51, -v51, v49
    v_mfma_f32_16x16x32_bf16 a[40:43], v[160:163], v[32:35], a[40:43]
    s_min_u32 s56, s56, s58
    ds_read_b128 v[24:27], v2 offset:0
    v_cvt_f32_i32 v242, v242
    v_mfma_f32_16x16x32_bf16 a[40:43], v[176:179], v[36:39], a[40:43]
    v_exp_f32 v19, v87
    v_mfma_f32_16x16x32_bf16 a[88:91], v[164:167], v[32:35], a[88:91]
    v_cvt_pk_bf16_f32 v84, v16, v17
    v_cvt_f32_i32 v243, v243
    v_mfma_f32_16x16x32_bf16 a[88:91], v[180:183], v[36:39], a[88:91]
    v_exp_f32 v16, v116
    v_mfma_f32_16x16x32_bf16 a[136:139], v[168:171], v[32:35], a[136:139]
    ds_read_b128 v[28:31], v3 offset:0
    v_add_f32 v6, v6, v18
    v_mfma_f32_16x16x32_bf16 a[136:139], v[184:187], v[36:39], a[136:139]
    v_add_f32 v6, v6, v19
    v_fma_f32 v242, v242, v48, v50
    v_mfma_f32_16x16x32_bf16 a[184:187], v[172:175], v[32:35], a[184:187]
    v_exp_f32 v17, v117
    v_mfma_f32_16x16x32_bf16 a[184:187], v[188:191], v[36:39], a[184:187]
    s_waitcnt lgkmcnt(2)
    v_cvt_pk_bf16_f32 v85, v18, v19
    v_fma_f32 v243, v243, v49, v51
    v_mfma_f32_16x16x32_bf16 a[44:47], v[160:163], v[40:43], a[44:47]
    ds_read_b128 v[32:35], v2 offset:6144
    v_cvt_pk_bf16_f32 v227, v242, v243
    v_mfma_f32_16x16x32_bf16 a[44:47], v[176:179], v[44:47], a[44:47]
    v_exp_f32 v18, v118
    v_mfma_f32_16x16x32_bf16 a[92:95], v[164:167], v[40:43], a[92:95]
    v_add_f32 v6, v6, v16
    v_add_f32 v6, v6, v17
    v_mfma_f32_16x16x32_bf16 a[92:95], v[180:183], v[44:47], a[92:95]
    v_exp_f32 v19, v119
    v_mfma_f32_16x16x32_bf16 a[140:143], v[168:171], v[40:43], a[140:143]
    s_sub_u32 s31, s31, 1
    ds_read_b128 v[36:39], v3 offset:6144
    v_cvt_pk_bf16_f32 v86, v16, v17
    v_mfma_f32_16x16x32_bf16 a[140:143], v[184:187], v[44:47], a[140:143]
    v_add_f32 v6, v6, v18
    v_add_f32 v6, v6, v19
    v_mfma_f32_16x16x32_bf16 a[188:191], v[172:175], v[40:43], a[188:191]
    s_waitcnt lgkmcnt(2)
    s_cmp_lg_u32 s31, 0
    v_cvt_pk_bf16_f32 v87, v18, v19
    v_cvt_f32_i32 v246, v246
    v_mfma_f32_16x16x32_bf16 a[188:191], v[188:191], v[44:47], a[188:191]
    s_cbranch_scc1 L_loop
    v_mfma_f32_16x16x32_bf16 v[160:163], v[24:27], a[192:195], v[128:131]
L_pg7:
    s_cbranch_execz L_pg11
    s_mov_b32 m0, s56
    ds_read_b128 v[40:43], v2 offset:128
    v_cvt_f32_i32 v247, v247
    v_mfma_f32_16x16x32_bf16 v[160:163], v[28:31], a[196:199], v[160:163]
    buffer_load_dwordx4 v4, s[4:7], s27 offen offset:0 sc1 lds
    v_mfma_f32_16x16x32_bf16 v[164:167], v[24:27], a[216:219], v[132:135]
    v_exp_f32 v16, v88
    v_mfma_f32_16x16x32_bf16 v[164:167], v[28:31], a[220:223], v[164:167]
    v_exp_f32 v17, v89
    v_mfma_f32_16x16x32_bf16 v[168:171], v[24:27], a[240:243], v[136:139]
    ds_read_b128 v[44:47], v3 offset:128
    v_fma_f32 v246, v246, v48, v50
    v_mfma_f32_16x16x32_bf16 v[168:171], v[28:31], a[244:247], v[168:171]
    v_exp_f32 v18, v90
    v_mfma_f32_16x16x32_bf16 v[172:175], v[24:27], v[200:203], v[140:143]
    v_fma_f32 v247, v247, v49, v51
    v_add_f32 v7, v7, v16
    v_mfma_f32_16x16x32_bf16 v[172:175], v[28:31], v[204:207], v[172:175]
    s_waitcnt lgkmcnt(2)
    v_add_f32 v7, v7, v17
    v_cvt_pk_bf16_f32 v231, v246, v247
    v_mfma_f32_16x16x32_bf16 v[96:99], v[32:35], a[192:195], v[128:131]
    ds_read_b128 v[24:27], v2 offset:6272
    v_cvt_f32_i32 v250, v250
    v_mfma_f32_16x16x32_bf16 v[96:99], v[36:39], a[196:199], v[96:99]
    buffer_load_dwordx4 v4, s[4:7], s27 offen offset:1024 sc1 lds
    v_mfma_f32_16x16x32_bf16 v[100:103], v[32:35], a[216:219], v[132:135]
    v_exp_f32 v19, v91
    v_mfma_f32_16x16x32_bf16 v[100:103], v[36:39], a[220:223], v[100:103]
    v_cvt_pk_bf16_f32 v88, v16, v17
    v_cvt_f32_i32 v251, v251
    v_mfma_f32_16x16x32_bf16 v[104:107], v[32:35], a[240:243], v[136:139]
    ds_read_b128 v[28:31], v3 offset:6272
    v_fma_f32 v250, v250, v48, v50
    v_mfma_f32_16x16x32_bf16 v[104:107], v[36:39], a[244:247], v[104:107]
    v_exp_f32 v16, v120
    v_mfma_f32_16x16x32_bf16 v[108:111], v[32:35], v[200:203], v[140:143]
    v_add_f32 v7, v7, v18
    v_add_f32 v7, v7, v19
    v_mfma_f32_16x16x32_bf16 v[108:111], v[36:39], v[204:207], v[108:111]
    s_waitcnt lgkmcnt(2)
    v_exp_f32 v17, v121
    v_mfma_f32_16x16x32_bf16 v[160:163], v[40:43], a[200:203], v[160:163]
    ds_read_b128 v[32:35], v2 offset:256
    v_cvt_pk_bf16_f32 v89, v18, v19
    v_mfma_f32_16x16x32_bf16 v[160:163], v[44:47], a[204:207], v[160:163]
    v_exp_f32 v18, v122
    v_mfma_f32_16x16x32_bf16 v[164:167], v[40:43], a[224:227], v[164:167]
    v_fma_f32 v251, v251, v49, v51
    v_add_f32 v7, v7, v16
    v_mfma_f32_16x16x32_bf16 v[164:167], v[44:47], a[228:231], v[164:167]
    buffer_load_dwordx4 v4, s[4:7], s27 offen offset:2048 sc1 lds
    v_mfma_f32_16x16x32_bf16 v[168:171], v[40:43], a[248:251], v[168:171]
    ds_read_b128 v[36:39], v3 offset:256
    v_cvt_pk_bf16_f32 v235, v250, v251
    v_mfma_f32_16x16x32_bf16 v[168:171], v[44:47], a[252:255], v[168:171]
    v_add_f32 v7, v7, v17
    v_cvt_f32_i32 v254, v254
    v_mfma_f32_16x16x32_bf16 v[172:175], v[40:43], v[208:211], v[172:175]
    v_exp_f32 v19, v123
    v_mfma_f32_16x16x32_bf16 v[172:175], v[44:47], v[212:215], v[172:175]
    s_waitcnt lgkmcnt(2)
    v_cvt_pk_bf16_f32 v90, v16, v17
    v_cvt_f32_i32 v255, v255
    v_mfma_f32_16x16x32_bf16 v[96:99], v[24:27], a[200:203], v[96:99]
    ds_read_b128 v[40:43], v2 offset:6400
    v_fma_f32 v254, v254, v48, v50
    v_mfma_f32_16x16x32_bf16 v[96:99], v[28:31], a[204:207], v[96:99]
    s_add_u32 s27, s27, 24576
    v_exp_f32 v16, v92
    v_mfma_f32_16x16x32_bf16 v[100:103], v[24:27], a[224:227], v[100:103]
    v_add_f32 v7, v7, v18
    v_add_f32 v7, v7, v19
    v_mfma_f32_16x16x32_bf16 v[100:103], v[28:31], a[228:231], v[100:103]
    v_exp_f32 v17, v93
    v_mfma_f32_16x16x32_bf16 v[104:107], v[24:27], a[248:251], v[104:107]
    ds_read_b128 v[44:47], v3 offset:6400
    v_fma_f32 v255, v255, v49, v51
    v_mfma_f32_16x16x32_bf16 v[104:107], v[28:31], a[252:255], v[104:107]
    v_cvt_pk_bf16_f32 v91, v18, v19
    v_cvt_pk_bf16_f32 v239, v254, v255
    v_mfma_f32_16x16x32_bf16 v[108:111], v[24:27], v[208:211], v[108:111]
    s_add_u32 s29, s30, 49152
    v_exp_f32 v18, v94
    v_mfma_f32_16x16x32_bf16 v[108:111], v[28:31], v[212:215], v[108:111]
    s_waitcnt lgkmcnt(2)
    v_add_f32 v8, v8, v16
    v_add_f32 v8, v8, v17
    v_mfma_f32_16x16x32_bf16 v[160:163], v[32:35], a[208:211], v[160:163]
    s_waitcnt vmcnt(11)
    ds_read_b128 v[24:27], v2 offset:12288
    v_lshlrev_b32 v48, 16, v56
    v_mfma_f32_16x16x32_bf16 v[160:163], v[36:39], a[212:215], v[160:163]
    s_sub_u32 s3, s29, 147456
    buffer_load_dwordx2 v[60:61], off, s[80:83], s37 offset:8
    v_mfma_f32_16x16x32_bf16 v[164:167], v[32:35], a[232:235], v[164:167]
    s_add_u32 s56, s56, 12288
    v_exp_f32 v19, v95
    v_mfma_f32_16x16x32_bf16 v[164:167], v[36:39], a[236:239], v[164:167]
    s_min_u32 s29, s29, s3
    v_cvt_pk_bf16_f32 v92, v16, v17
    v_and_b32 v49, s97, v56
    v_mfma_f32_16x16x32_bf16 v[168:171], v[32:35], v[192:195], v[168:171]
    s_mov_b32 m0, s56
    ds_read_b128 v[28:31], v3 offset:12288
    v_mfma_f32_16x16x32_bf16 v[168:171], v[36:39], v[196:199], v[168:171]
    buffer_load_dwordx2 v[62:63], off, s[84:87], s37 offset:8
    v_mfma_f32_16x16x32_bf16 v[172:175], v[32:35], v[216:219], v[172:175]
    v_exp_f32 v16, v124
    v_mfma_f32_16x16x32_bf16 v[172:175], v[36:39], v[220:223], v[172:175]
    s_waitcnt lgkmcnt(2)
    v_add_f32 v8, v8, v18
    v_add_f32 v8, v8, v19
    v_mfma_f32_16x16x32_bf16 v[96:99], v[40:43], a[208:211], v[96:99]
    ds_read_b128 v[32:35], v2 offset:18432
    v_lshlrev_b32 v50, 16, v58
    v_mfma_f32_16x16x32_bf16 v[96:99], v[44:47], a[212:215], v[96:99]
    s_sub_u32 s3, s29, s30
    v_exp_f32 v17, v125
    v_mfma_f32_16x16x32_bf16 v[100:103], v[40:43], a[232:235], v[100:103]
    v_cvt_pk_bf16_f32 v93, v18, v19
    v_mfma_f32_16x16x32_bf16 v[100:103], v[44:47], a[236:239], v[100:103]
    buffer_load_dwordx4 v4, s[4:7], s27 offen offset:0 sc1 lds
    v_mfma_f32_16x16x32_bf16 v[104:107], v[40:43], v[192:195], v[104:107]
    ds_read_b128 v[36:39], v3 offset:18432
    v_mfma_f32_16x16x32_bf16 v[104:107], v[44:47], v[196:199], v[104:107]
    v_exp_f32 v18, v126
    v_mfma_f32_16x16x32_bf16 v[108:111], v[40:43], v[216:219], v[108:111]
    v_add_f32 v8, v8, v16
    v_add_f32 v8, v8, v17
    v_mfma_f32_16x16x32_bf16 v[108:111], v[44:47], v[220:223], v[108:111]
    s_waitcnt lgkmcnt(2)
    buffer_load_dwordx3 v[240:242], v12, s[68:71], s16 offen offset:0 nt
    v_mfma_f32_16x16x32_bf16 v[176:179], v[24:27], a[192:195], v[128:131]
    ds_read_b128 v[40:43], v2 offset:12416
    v_and_b32 v51, s97, v58
    v_mfma_f32_16x16x32_bf16 v[176:179], v[28:31], a[196:199], v[176:179]
    v_exp_f32 v19, v127
    v_cvt_pk_bf16_f32 v94, v16, v17
    v_mfma_f32_16x16x32_bf16 v[180:183], v[24:27], a[216:219], v[132:135]
    s_mov_b32 s30, s29
    v_add_f32 v8, v8, v18
    v_add_f32 v8, v8, v19
    v_mfma_f32_16x16x32_bf16 v[180:183], v[28:31], a[220:223], v[180:183]
    buffer_load_dwordx4 v4, s[4:7], s27 offen offset:1024 sc1 lds
    v_mfma_f32_16x16x32_bf16 v[184:187], v[24:27], a[240:243], v[136:139]
    ds_read_b128 v[44:47], v3 offset:12416
    v_cvt_pk_bf16_f32 v95, v18, v19
    v_mfma_f32_16x16x32_bf16 v[184:187], v[28:31], a[244:247], v[184:187]
    v_exp_f32 v16, v160
    v_mfma_f32_16x16x32_bf16 v[188:191], v[24:27], v[200:203], v[140:143]
    v_exp_f32 v17, v161
    v_mfma_f32_16x16x32_bf16 v[188:191], v[28:31], v[204:207], v[188:191]
    s_waitcnt lgkmcnt(2)
    buffer_load_dwordx3 v[244:246], v12, s[68:71], s16 offen offset:768 nt
    v_mfma_f32_16x16x32_bf16 v[112:115], v[32:35], a[192:195], v[128:131]
    ds_read_b128 v[24:27], v2 offset:18560
    v_mul_f32_e64 v50, -v50, v48
    v_mfma_f32_16x16x32_bf16 v[112:115], v[36:39], a[196:199], v[112:115]
    v_exp_f32 v18, v162
    v_mfma_f32_16x16x32_bf16 v[116:119], v[32:35], a[216:219], v[132:135]
    v_add_f32 v5, v5, v16
    v_add_f32 v5, v5, v17
    v_mfma_f32_16x16x32_bf16 v[116:119], v[36:39], a[220:223], v[116:119]
    v_exp_f32 v19, v163
    v_mfma_f32_16x16x32_bf16 v[120:123], v[32:35], a[240:243], v[136:139]
    ds_read_b128 v[28:31], v3 offset:18560
    v_cvt_pk_bf16_f32 v160, v16, v17
    v_mfma_f32_16x16x32_bf16 v[120:123], v[36:39], a[244:247], v[120:123]
    buffer_load_dwordx3 v[248:250], v12, s[68:71], s16 offen offset:1536 nt
    v_mfma_f32_16x16x32_bf16 v[124:127], v[32:35], v[200:203], v[140:143]
    v_exp_f32 v16, v96
    v_mfma_f32_16x16x32_bf16 v[124:127], v[36:39], v[204:207], v[124:127]
    s_waitcnt lgkmcnt(2)
    v_add_f32 v5, v5, v18
    v_add_f32 v5, v5, v19
    v_mfma_f32_16x16x32_bf16 v[176:179], v[40:43], a[200:203], v[176:179]
    ds_read_b128 v[32:35], v2 offset:12544
    v_mul_f32_e64 v51, -v51, v49
    v_mfma_f32_16x16x32_bf16 v[176:179], v[44:47], a[204:207], v[176:179]
    buffer_load_dwordx4 v4, s[4:7], s27 offen offset:2048 sc1 lds
    v_mfma_f32_16x16x32_bf16 v[180:183], v[40:43], a[224:227], v[180:183]
    v_exp_f32 v17, v97
    v_mfma_f32_16x16x32_bf16 v[180:183], v[44:47], a[228:231], v[180:183]
    v_cvt_pk_bf16_f32 v161, v18, v19
    v_add_u32 v1, s3, v1
    v_mfma_f32_16x16x32_bf16 v[184:187], v[40:43], a[248:251], v[184:187]
    ds_read_b128 v[36:39], v3 offset:12544
    v_cvt_f32_i32 v144, v144
    v_mfma_f32_16x16x32_bf16 v[184:187], v[44:47], a[252:255], v[184:187]
    buffer_load_dwordx3 v[252:254], v12, s[68:71], s16 offen offset:2304 nt
    v_mfma_f32_16x16x32_bf16 v[188:191], v[40:43], v[208:211], v[188:191]
    v_exp_f32 v18, v98
    v_mfma_f32_16x16x32_bf16 v[188:191], v[44:47], v[212:215], v[188:191]
    s_waitcnt lgkmcnt(2)
    v_add_f32 v5, v5, v16
    v_add_f32 v5, v5, v17
    v_mfma_f32_16x16x32_bf16 v[112:115], v[24:27], a[200:203], v[112:115]
    ds_read_b128 v[40:43], v2 offset:18688
    v_cvt_f32_i32 v148, v148
    v_mfma_f32_16x16x32_bf16 v[112:115], v[28:31], a[204:207], v[112:115]
    v_exp_f32 v19, v99
    v_cvt_pk_bf16_f32 v162, v16, v17
    v_mfma_f32_16x16x32_bf16 v[116:119], v[24:27], a[224:227], v[116:119]
    v_exp_f32 v16, v164
    v_mfma_f32_16x16x32_bf16 v[116:119], v[28:31], a[228:231], v[116:119]
    s_add_u32 s27, s27, 24576
    v_add_f32 v5, v5, v18
    v_add_f32 v5, v5, v19
    v_mfma_f32_16x16x32_bf16 v[120:123], v[24:27], a[248:251], v[120:123]
    s_add_u32 s56, s56, 36864
    ds_read_b128 v[44:47], v3 offset:18688
    v_fma_f32 v144, v144, v48, v50
    v_mfma_f32_16x16x32_bf16 v[120:123], v[28:31], a[252:255], v[120:123]
    s_waitcnt lgkmcnt(2)
    v_exp_f32 v17, v165
    v_mfma_f32_16x16x32_bf16 v[124:127], v[24:27], v[208:211], v[124:127]
    s_waitcnt vmcnt(12)
    v_cvt_pk_bf16_f32 v163, v18, v19
    s_sub_u32 s58, s56, 147456
    v_mfma_f32_16x16x32_bf16 v[124:127], v[28:31], v[212:215], v[124:127]
    s_barrier
    v_mfma_f32_16x16x32_bf16 v[176:179], v[32:35], a[208:211], v[176:179]
    s_min_u32 s56, s56, s58
    ds_read_b128 v[24:27], v1 offset:0
    v_mfma_f32_16x16x32_bf16 v[176:179], v[36:39], a[212:215], v[176:179]
    v_exp_f32 v18, v166
    v_mfma_f32_16x16x32_bf16 v[180:183], v[32:35], a[232:235], v[180:183]
    v_add_f32 v6, v6, v16
    v_add_f32 v6, v6, v17
    v_mfma_f32_16x16x32_bf16 v[180:183], v[36:39], a[236:239], v[180:183]
    v_exp_f32 v19, v167
    v_mfma_f32_16x16x32_bf16 v[184:187], v[32:35], v[192:195], v[184:187]
    ds_read_b128 v[28:31], v1 offset:12288
    v_cvt_pk_bf16_f32 v164, v16, v17
    v_mfma_f32_16x16x32_bf16 v[184:187], v[36:39], v[196:199], v[184:187]
    v_exp_f32 v16, v100
    v_mfma_f32_16x16x32_bf16 v[188:191], v[32:35], v[216:219], v[188:191]
    v_add_f32 v6, v6, v18
    v_add_f32 v6, v6, v19
    v_mfma_f32_16x16x32_bf16 v[188:191], v[36:39], v[220:223], v[188:191]
    s_waitcnt lgkmcnt(2)
    v_exp_f32 v17, v101
    v_mfma_f32_16x16x32_bf16 v[112:115], v[40:43], a[208:211], v[112:115]
    ds_read_b128 v[32:35], v1 offset:1024
    v_cvt_pk_bf16_f32 v165, v18, v19
    v_mfma_f32_16x16x32_bf16 v[112:115], v[44:47], a[212:215], v[112:115]
    v_exp_f32 v18, v102
    v_mfma_f32_16x16x32_bf16 v[116:119], v[40:43], a[232:235], v[116:119]
    v_add_f32 v6, v6, v16
    v_add_f32 v6, v6, v17
    v_mfma_f32_16x16x32_bf16 v[116:119], v[44:47], a[236:239], v[116:119]
    v_exp_f32 v19, v103
    v_mfma_f32_16x16x32_bf16 v[120:123], v[40:43], v[192:195], v[120:123]
    ds_read_b128 v[36:39], v1 offset:13312
    v_cvt_pk_bf16_f32 v166, v16, v17
    v_mfma_f32_16x16x32_bf16 v[120:123], v[44:47], v[196:199], v[120:123]
    v_add_f32 v6, v6, v18
    v_fma_f32 v148, v148, v49, v51
    v_mfma_f32_16x16x32_bf16 v[124:127], v[40:43], v[216:219], v[124:127]
    v_add_f32 v6, v6, v19
    v_cvt_pk_bf16_f32 v167, v18, v19
    v_mfma_f32_16x16x32_bf16 v[124:127], v[44:47], v[220:223], v[124:127]
    s_waitcnt lgkmcnt(2)
    v_mfma_f32_16x16x32_bf16 a[0:3], v[64:67], v[24:27], a[0:3]
    ds_read_b128 v[40:43], v1 offset:2048
    v_cvt_f32_i32 v145, v145
    v_mfma_f32_16x16x32_bf16 a[0:3], v[80:83], v[28:31], a[0:3]
    buffer_store_dwordx4 v[224:227], v11, s[4:7], s33 offen offset:0 sc1
    v_mfma_f32_16x16x32_bf16 a[48:51], v[68:71], v[24:27], a[48:51]
    v_exp_f32 v16, v168
    v_mfma_f32_16x16x32_bf16 a[48:51], v[84:87], v[28:31], a[48:51]
    v_exp_f32 v17, v169
    v_mfma_f32_16x16x32_bf16 a[96:99], v[72:75], v[24:27], a[96:99]
    ds_read_b128 v[44:47], v1 offset:14336
    v_cvt_f32_i32 v149, v149
    v_mfma_f32_16x16x32_bf16 a[96:99], v[88:91], v[28:31], a[96:99]
    v_exp_f32 v18, v170
    v_mfma_f32_16x16x32_bf16 a[144:147], v[76:79], v[24:27], a[144:147]
    v_add_f32 v7, v7, v16
    v_add_f32 v7, v7, v17
    v_mfma_f32_16x16x32_bf16 a[144:147], v[92:95], v[28:31], a[144:147]
    s_waitcnt lgkmcnt(2)
    v_exp_f32 v19, v171
    v_mfma_f32_16x16x32_bf16 a[4:7], v[64:67], v[32:35], a[4:7]
    ds_read_b128 v[24:27], v1 offset:3072
    v_cvt_pk_bf16_f32 v168, v16, v17
    v_mfma_f32_16x16x32_bf16 a[4:7], v[80:83], v[36:39], a[4:7]
    buffer_store_dwordx4 v[228:231], v21, s[4:7], s33 offen offset:768 sc1
    v_mfma_f32_16x16x32_bf16 a[52:55], v[68:71], v[32:35], a[52:55]
    v_exp_f32 v16, v104
    v_mfma_f32_16x16x32_bf16 a[52:55], v[84:87], v[36:39], a[52:55]
    v_add_f32 v7, v7, v18
    v_fma_f32 v145, v145, v48, v50
    v_mfma_f32_16x16x32_bf16 a[100:103], v[72:75], v[32:35], a[100:103]
    ds_read_b128 v[28:31], v1 offset:15360
    v_add_f32 v7, v7, v19
    v_mfma_f32_16x16x32_bf16 a[100:103], v[88:91], v[36:39], a[100:103]
    v_exp_f32 v17, v105
    v_mfma_f32_16x16x32_bf16 a[148:151], v[76:79], v[32:35], a[148:151]
    v_cvt_pk_bf16_f32 v169, v18, v19
    v_fma_f32 v149, v149, v49, v51
    v_mfma_f32_16x16x32_bf16 a[148:151], v[92:95], v[36:39], a[148:151]
    s_waitcnt lgkmcnt(2)
    v_exp_f32 v18, v106
    v_mfma_f32_16x16x32_bf16 a[8:11], v[64:67], v[40:43], a[8:11]
    ds_read_b128 v[32:35], v1 offset:4096
    v_add_f32 v7, v7, v16
    v_mfma_f32_16x16x32_bf16 a[8:11], v[80:83], v[44:47], a[8:11]
    buffer_store_dwordx4 v[232:235], v22, s[4:7], s33 offen offset:1536 sc1
    v_mfma_f32_16x16x32_bf16 a[56:59], v[68:71], v[40:43], a[56:59]
    v_add_f32 v7, v7, v17
    v_cvt_f32_i32 v146, v146
    v_mfma_f32_16x16x32_bf16 a[56:59], v[84:87], v[44:47], a[56:59]
    v_exp_f32 v19, v107
    v_mfma_f32_16x16x32_bf16 a[104:107], v[72:75], v[40:43], a[104:107]
    ds_read_b128 v[36:39], v1 offset:16384
    v_cvt_pk_bf16_f32 v170, v16, v17
    v_mfma_f32_16x16x32_bf16 a[104:107], v[88:91], v[44:47], a[104:107]
    v_exp_f32 v16, v172
    v_mfma_f32_16x16x32_bf16 a[152:155], v[76:79], v[40:43], a[152:155]
    v_add_f32 v7, v7, v18
    v_cvt_f32_i32 v150, v150
    v_mfma_f32_16x16x32_bf16 a[152:155], v[92:95], v[44:47], a[152:155]
    s_waitcnt lgkmcnt(2)
    v_add_f32 v7, v7, v19
    v_fma_f32 v146, v146, v48, v50
    v_mfma_f32_16x16x32_bf16 a[12:15], v[64:67], v[24:27], a[12:15]
    ds_read_b128 v[40:43], v1 offset:5120
    v_mfma_f32_16x16x32_bf16 a[12:15], v[80:83], v[28:31], a[12:15]
    buffer_store_dwordx4 v[236:239], v23, s[4:7], s33 offen offset:2304 sc1
    v_mfma_f32_16x16x32_bf16 a[60:63], v[68:71], v[24:27], a[60:63]
    v_exp_f32 v17, v173
    v_mfma_f32_16x16x32_bf16 a[60:63], v[84:87], v[28:31], a[60:63]
    v_cvt_pk_bf16_f32 v171, v18, v19
    v_fma_f32 v150, v150, v49, v51
    v_mfma_f32_16x16x32_bf16 a[108:111], v[72:75], v[24:27], a[108:111]
    ds_read_b128 v[44:47], v1 offset:17408
    v_mfma_f32_16x16x32_bf16 a[108:111], v[88:91], v[28:31], a[108:111]
    v_exp_f32 v18, v174
    v_mfma_f32_16x16x32_bf16 a[156:159], v[76:79], v[24:27], a[156:159]
    s_add_u32 s29, s28, 49152
    v_add_f32 v8, v8, v16
    v_add_f32 v8, v8, v17
    v_mfma_f32_16x16x32_bf16 a[156:159], v[92:95], v[28:31], a[156:159]
    s_waitcnt lgkmcnt(2)
    v_exp_f32 v19, v175
    v_mfma_f32_16x16x32_bf16 a[16:19], v[64:67], v[32:35], a[16:19]
    s_sub_u32 s3, s29, 147456
    ds_read_b128 v[24:27], v1 offset:6144
    v_cvt_pk_bf16_f32 v172, v16, v17
    v_mfma_f32_16x16x32_bf16 a[16:19], v[80:83], v[36:39], a[16:19]
    s_mov_b32 m0, s26
    v_exp_f32 v16, v108
    v_mfma_f32_16x16x32_bf16 a[64:67], v[68:71], v[32:35], a[64:67]
    s_min_u32 s29, s29, s3
    v_add_f32 v8, v8, v18
    v_lshlrev_b32 v48, 16, v57
    v_mfma_f32_16x16x32_bf16 a[64:67], v[84:87], v[36:39], a[64:67]
    buffer_load_dwordx4 v4, s[4:7], s32 offen offset:0 sc1 lds
    v_mfma_f32_16x16x32_bf16 a[112:115], v[72:75], v[32:35], a[112:115]
    ds_read_b128 v[28:31], v1 offset:18432
    v_add_f32 v8, v8, v19
    v_mfma_f32_16x16x32_bf16 a[112:115], v[88:91], v[36:39], a[112:115]
    v_exp_f32 v17, v109
    v_mfma_f32_16x16x32_bf16 a[160:163], v[76:79], v[32:35], a[160:163]
    v_cvt_pk_bf16_f32 v173, v18, v19
    v_and_b32 v49, s97, v57
    v_mfma_f32_16x16x32_bf16 a[160:163], v[92:95], v[36:39], a[160:163]
    s_waitcnt lgkmcnt(2)
    buffer_load_dwordx4 v4, s[4:7], s32 offen offset:1024 sc1 lds
    v_mfma_f32_16x16x32_bf16 a[20:23], v[64:67], v[40:43], a[20:23]
    s_sub_u32 s3, s29, s28
    ds_read_b128 v[32:35], v1 offset:7168
    v_lshlrev_b32 v50, 16, v59
    v_mfma_f32_16x16x32_bf16 a[20:23], v[80:83], v[44:47], a[20:23]
    v_exp_f32 v18, v110
    v_mfma_f32_16x16x32_bf16 a[68:71], v[68:71], v[40:43], a[68:71]
    v_add_f32 v8, v8, v16
    v_add_f32 v8, v8, v17
    v_mfma_f32_16x16x32_bf16 a[68:71], v[84:87], v[44:47], a[68:71]
    buffer_load_dwordx4 v4, s[4:7], s32 offen offset:2048 sc1 lds
    v_mfma_f32_16x16x32_bf16 a[116:119], v[72:75], v[40:43], a[116:119]
    ds_read_b128 v[36:39], v1 offset:19456
    v_mfma_f32_16x16x32_bf16 a[116:119], v[88:91], v[44:47], a[116:119]
    v_exp_f32 v19, v111
    v_mfma_f32_16x16x32_bf16 a[164:167], v[76:79], v[40:43], a[164:167]
    s_mov_b32 s28, s29
    v_cvt_pk_bf16_f32 v174, v16, v17
    v_add_f32 v8, v8, v18
    v_mfma_f32_16x16x32_bf16 a[164:167], v[92:95], v[44:47], a[164:167]
    s_waitcnt lgkmcnt(2)
    v_add_f32 v8, v8, v19
    v_cvt_pk_bf16_f32 v175, v18, v19
    v_mfma_f32_16x16x32_bf16 a[24:27], v[64:67], v[24:27], a[24:27]
    s_add_u32 s32, s32, 24576
    ds_read_b128 v[40:43], v1 offset:8192
    v_and_b32 v51, s97, v59
    v_mfma_f32_16x16x32_bf16 a[24:27], v[80:83], v[28:31], a[24:27]
    v_exp_f32 v16, v176
    v_mfma_f32_16x16x32_bf16 a[72:75], v[68:71], v[24:27], a[72:75]
    s_add_u32 s26, s26, 12288
    v_exp_f32 v17, v177
    v_mfma_f32_16x16x32_bf16 a[72:75], v[84:87], v[28:31], a[72:75]
    v_exp_f32 v18, v178
    v_mfma_f32_16x16x32_bf16 a[120:123], v[72:75], v[24:27], a[120:123]
    s_mov_b32 m0, s26
    ds_read_b128 v[44:47], v1 offset:20480
    v_add_f32 v5, v5, v16
    v_mfma_f32_16x16x32_bf16 a[120:123], v[88:91], v[28:31], a[120:123]
    v_add_f32 v5, v5, v17
    v_mul_f32_e64 v50, -v50, v48
    v_mfma_f32_16x16x32_bf16 a[168:171], v[76:79], v[24:27], a[168:171]
    v_exp_f32 v19, v179
    v_mfma_f32_16x16x32_bf16 a[168:171], v[92:95], v[28:31], a[168:171]
    s_waitcnt lgkmcnt(2)
    v_cvt_pk_bf16_f32 v176, v16, v17
    v_mul_f32_e64 v51, -v51, v49
    v_mfma_f32_16x16x32_bf16 a[28:31], v[64:67], v[32:35], a[28:31]
    ds_read_b128 v[24:27], v1 offset:9216
    v_add_u32 v2, s3, v2
    v_mfma_f32_16x16x32_bf16 a[28:31], v[80:83], v[36:39], a[28:31]
    buffer_load_dwordx4 v4, s[4:7], s32 offen offset:0 sc1 lds
    v_mfma_f32_16x16x32_bf16 a[76:79], v[68:71], v[32:35], a[76:79]
    v_exp_f32 v16, v112
    v_mfma_f32_16x16x32_bf16 a[76:79], v[84:87], v[36:39], a[76:79]
    v_add_f32 v5, v5, v18
    v_add_f32 v5, v5, v19
    v_mfma_f32_16x16x32_bf16 a[124:127], v[72:75], v[32:35], a[124:127]
    ds_read_b128 v[28:31], v1 offset:21504
    v_cvt_f32_i32 v152, v152
    v_mfma_f32_16x16x32_bf16 a[124:127], v[88:91], v[36:39], a[124:127]
    buffer_load_dwordx4 v4, s[4:7], s32 offen offset:1024 sc1 lds
    v_mfma_f32_16x16x32_bf16 a[172:175], v[76:79], v[32:35], a[172:175]
    v_exp_f32 v17, v113
    v_mfma_f32_16x16x32_bf16 a[172:175], v[92:95], v[36:39], a[172:175]
    s_waitcnt lgkmcnt(2)
    v_cvt_pk_bf16_f32 v177, v18, v19
    v_add_u32 v3, s3, v3
    v_mfma_f32_16x16x32_bf16 a[32:35], v[64:67], v[40:43], a[32:35]
    ds_read_b128 v[32:35], v1 offset:10240
    v_cvt_f32_i32 v156, v156
    v_mfma_f32_16x16x32_bf16 a[32:35], v[80:83], v[44:47], a[32:35]
    v_exp_f32 v18, v114
    v_mfma_f32_16x16x32_bf16 a[80:83], v[68:71], v[40:43], a[80:83]
    v_add_f32 v5, v5, v16
    v_add_f32 v5, v5, v17
    v_mfma_f32_16x16x32_bf16 a[80:83], v[84:87], v[44:47], a[80:83]
    buffer_load_dwordx4 v4, s[4:7], s32 offen offset:2048 sc1 lds
    v_mfma_f32_16x16x32_bf16 a[128:131], v[72:75], v[40:43], a[128:131]
    ds_read_b128 v[36:39], v1 offset:22528
    v_mfma_f32_16x16x32_bf16 a[128:131], v[88:91], v[44:47], a[128:131]
    v_exp_f32 v19, v115
    v_mfma_f32_16x16x32_bf16 a[176:179], v[76:79], v[40:43], a[176:179]
    v_cvt_pk_bf16_f32 v178, v16, v17
    v_fma_f32 v152, v152, v48, v50
    v_mfma_f32_16x16x32_bf16 a[176:179], v[92:95], v[44:47], a[176:179]
    s_waitcnt lgkmcnt(2)
    v_exp_f32 v16, v180
    v_mfma_f32_16x16x32_bf16 a[36:39], v[64:67], v[24:27], a[36:39]
    ds_read_b128 v[40:43], v1 offset:11264
    v_add_f32 v5, v5, v18
    v_mfma_f32_16x16x32_bf16 a[36:39], v[80:83], v[28:31], a[36:39]
    v_add_f32 v5, v5, v19
    v_mfma_f32_16x16x32_bf16 a[84:87], v[68:71], v[24:27], a[84:87]
    v_exp_f32 v17, v181
    v_mfma_f32_16x16x32_bf16 a[84:87], v[84:87], v[28:31], a[84:87]
    s_add_u32 s32, s32, 24576
    v_cvt_pk_bf16_f32 v179, v18, v19
    s_add_u32 s26, s26, 36864
    v_mfma_f32_16x16x32_bf16 a[132:135], v[72:75], v[24:27], a[132:135]
    s_sub_u32 s57, s26, 147456
    ds_read_b128 v[44:47], v1 offset:23552
    v_fma_f32 v156, v156, v49, v51
    v_mfma_f32_16x16x32_bf16 a[132:135], v[88:91], v[28:31], a[132:135]
    s_waitcnt lgkmcnt(2)
    v_exp_f32 v18, v182
    v_mfma_f32_16x16x32_bf16 a[180:183], v[76:79], v[24:27], a[180:183]
    s_waitcnt vmcnt(6)
    v_add_f32 v6, v6, v16
    v_add_f32 v6, v6, v17
    v_mfma_f32_16x16x32_bf16 a[180:183], v[92:95], v[28:31], a[180:183]
    s_barrier
    v_mfma_f32_16x16x32_bf16 a[40:43], v[64:67], v[32:35], a[40:43]
    s_min_u32 s26, s26, s57
    ds_read_b128 v[24:27], v2 offset:0
    v_add_u32 v0, 1, v0
    v_mfma_f32_16x16x32_bf16 a[40:43], v[80:83], v[36:39], a[40:43]
    buffer_store_dword v0, v13, s[20:23], 0 offen offset:32 sc1
    v_mfma_f32_16x16x32_bf16 a[88:91], v[68:71], v[32:35], a[88:91]
    v_exp_f32 v19, v183
    v_mfma_f32_16x16x32_bf16 a[88:91], v[84:87], v[36:39], a[88:91]
    v_cvt_pk_bf16_f32 v180, v16, v17
    v_cvt_f32_i32 v153, v153
    v_mfma_f32_16x16x32_bf16 a[136:139], v[72:75], v[32:35], a[136:139]
    ds_read_b128 v[28:31], v3 offset:0
    v_cvt_f32_i32 v157, v157
    v_mfma_f32_16x16x32_bf16 a[136:139], v[88:91], v[36:39], a[136:139]
    v_exp_f32 v16, v116
    v_mfma_f32_16x16x32_bf16 a[184:187], v[76:79], v[32:35], a[184:187]
    v_add_f32 v6, v6, v18
    v_add_f32 v6, v6, v19
    v_mfma_f32_16x16x32_bf16 a[184:187], v[92:95], v[36:39], a[184:187]
    s_waitcnt lgkmcnt(2)
    v_exp_f32 v17, v117
    v_mfma_f32_16x16x32_bf16 a[44:47], v[64:67], v[40:43], a[44:47]
    ds_read_b128 v[32:35], v2 offset:6144
    v_cvt_pk_bf16_f32 v181, v18, v19
    v_mfma_f32_16x16x32_bf16 a[44:47], v[80:83], v[44:47], a[44:47]
    v_exp_f32 v18, v118
    v_mfma_f32_16x16x32_bf16 a[92:95], v[68:71], v[40:43], a[92:95]
    v_add_f32 v6, v6, v16
    v_add_f32 v6, v6, v17
    v_mfma_f32_16x16x32_bf16 a[92:95], v[84:87], v[44:47], a[92:95]
    v_exp_f32 v19, v119
    v_mfma_f32_16x16x32_bf16 a[140:143], v[72:75], v[40:43], a[140:143]
    ds_read_b128 v[36:39], v3 offset:6144
    v_cvt_pk_bf16_f32 v182, v16, v17
    v_mfma_f32_16x16x32_bf16 a[140:143], v[88:91], v[44:47], a[140:143]
    v_add_f32 v6, v6, v18
    v_add_f32 v6, v6, v19
    v_mfma_f32_16x16x32_bf16 a[188:191], v[76:79], v[40:43], a[188:191]
    v_cvt_pk_bf16_f32 v183, v18, v19
    v_mfma_f32_16x16x32_bf16 a[188:191], v[92:95], v[44:47], a[188:191]
    s_waitcnt lgkmcnt(2)
    v_mfma_f32_16x16x32_bf16 v[64:67], v[24:27], a[192:195], v[128:131]
    s_mov_b32 m0, s56
    ds_read_b128 v[40:43], v2 offset:128
    v_fma_f32 v153, v153, v48, v50
    v_mfma_f32_16x16x32_bf16 v[64:67], v[28:31], a[196:199], v[64:67]
    buffer_load_dwordx4 v4, s[4:7], s27 offen offset:0 sc1 lds
    v_mfma_f32_16x16x32_bf16 v[68:71], v[24:27], a[216:219], v[132:135]
    v_exp_f32 v16, v184
    v_mfma_f32_16x16x32_bf16 v[68:71], v[28:31], a[220:223], v[68:71]
    v_exp_f32 v17, v185
    v_mfma_f32_16x16x32_bf16 v[72:75], v[24:27], a[240:243], v[136:139]
    ds_read_b128 v[44:47], v3 offset:128
    v_fma_f32 v157, v157, v49, v51
    v_mfma_f32_16x16x32_bf16 v[72:75], v[28:31], a[244:247], v[72:75]
    v_exp_f32 v18, v186
    v_mfma_f32_16x16x32_bf16 v[76:79], v[24:27], v[200:203], v[140:143]
    v_add_f32 v7, v7, v16
    v_add_f32 v7, v7, v17
    v_mfma_f32_16x16x32_bf16 v[76:79], v[28:31], v[204:207], v[76:79]
    s_waitcnt lgkmcnt(2)
    v_exp_f32 v19, v187
    v_mfma_f32_16x16x32_bf16 v[96:99], v[32:35], a[192:195], v[128:131]
    ds_read_b128 v[24:27], v2 offset:6272
    v_cvt_pk_bf16_f32 v184, v16, v17
    v_mfma_f32_16x16x32_bf16 v[96:99], v[36:39], a[196:199], v[96:99]
    v_exp_f32 v16, v120
    v_mfma_f32_16x16x32_bf16 v[100:103], v[32:35], a[216:219], v[132:135]
    v_cvt_f32_i32 v154, v154
    v_add_f32 v7, v7, v18
    v_mfma_f32_16x16x32_bf16 v[100:103], v[36:39], a[220:223], v[100:103]
    buffer_load_dwordx4 v4, s[4:7], s27 offen offset:1024 sc1 lds
    v_mfma_f32_16x16x32_bf16 v[104:107], v[32:35], a[240:243], v[136:139]
    ds_read_b128 v[28:31], v3 offset:6272
    v_add_f32 v7, v7, v19
    v_mfma_f32_16x16x32_bf16 v[104:107], v[36:39], a[244:247], v[104:107]
    v_exp_f32 v17, v121
    v_mfma_f32_16x16x32_bf16 v[108:111], v[32:35], v[200:203], v[140:143]
    v_cvt_f32_i32 v158, v158
    v_cvt_pk_bf16_f32 v185, v18, v19
    v_mfma_f32_16x16x32_bf16 v[108:111], v[36:39], v[204:207], v[108:111]
    s_waitcnt lgkmcnt(2)
    v_exp_f32 v18, v122
    v_mfma_f32_16x16x32_bf16 v[64:67], v[40:43], a[200:203], v[64:67]
    ds_read_b128 v[32:35], v2 offset:256
    v_fma_f32 v154, v154, v48, v50
    v_mfma_f32_16x16x32_bf16 v[64:67], v[44:47], a[204:207], v[64:67]
    v_add_f32 v7, v7, v16
    v_add_f32 v7, v7, v17
    v_mfma_f32_16x16x32_bf16 v[68:71], v[40:43], a[224:227], v[68:71]
    v_exp_f32 v19, v123
    v_mfma_f32_16x16x32_bf16 v[68:71], v[44:47], a[228:231], v[68:71]
    v_fma_f32 v158, v158, v49, v51
    v_cvt_pk_bf16_f32 v186, v16, v17
    v_mfma_f32_16x16x32_bf16 v[72:75], v[40:43], a[248:251], v[72:75]
    ds_read_b128 v[36:39], v3 offset:256
    v_cvt_pk_bf16_f32 v144, v144, v148
    v_mfma_f32_16x16x32_bf16 v[72:75], v[44:47], a[252:255], v[72:75]
    v_exp_f32 v16, v188
    v_mfma_f32_16x16x32_bf16 v[76:79], v[40:43], v[208:211], v[76:79]
    v_add_f32 v7, v7, v18
    v_add_f32 v7, v7, v19
    v_mfma_f32_16x16x32_bf16 v[76:79], v[44:47], v[212:215], v[76:79]
    s_waitcnt lgkmcnt(2)
    buffer_load_dwordx4 v4, s[4:7], s27 offen offset:2048 sc1 lds
    v_mfma_f32_16x16x32_bf16 v[96:99], v[24:27], a[200:203], v[96:99]
    ds_read_b128 v[40:43], v2 offset:6400
    v_cvt_pk_bf16_f32 v148, v145, v149
    v_mfma_f32_16x16x32_bf16 v[96:99], v[28:31], a[204:207], v[96:99]
    v_exp_f32 v17, v189
    v_mfma_f32_16x16x32_bf16 v[100:103], v[24:27], a[224:227], v[100:103]
    v_cvt_pk_bf16_f32 v187, v18, v19
    v_mfma_f32_16x16x32_bf16 v[100:103], v[28:31], a[228:231], v[100:103]
    v_exp_f32 v18, v190
    v_mfma_f32_16x16x32_bf16 v[104:107], v[24:27], a[248:251], v[104:107]
    ds_read_b128 v[44:47], v3 offset:6400
    v_add_f32 v8, v8, v16
    v_mfma_f32_16x16x32_bf16 v[104:107], v[28:31], a[252:255], v[104:107]
    v_add_f32 v8, v8, v17
    v_cvt_pk_bf16_f32 v145, v152, v156
    v_mfma_f32_16x16x32_bf16 v[108:111], v[24:27], v[208:211], v[108:111]
    s_add_u32 s29, s30, 49152
    v_exp_f32 v19, v191
    v_mfma_f32_16x16x32_bf16 v[108:111], v[28:31], v[212:215], v[108:111]
    s_waitcnt lgkmcnt(2)
    v_cvt_pk_bf16_f32 v188, v16, v17
    s_sub_u32 s3, s29, 147456
    v_mfma_f32_16x16x32_bf16 v[64:67], v[32:35], a[208:211], v[64:67]
    s_add_u32 s27, s27, 24576
    ds_read_b128 v[24:27], v2 offset:12288
    v_cvt_pk_bf16_f32 v149, v153, v157
    v_mfma_f32_16x16x32_bf16 v[64:67], v[36:39], a[212:215], v[64:67]
    s_min_u32 s29, s29, s3
    v_exp_f32 v16, v124
    v_mfma_f32_16x16x32_bf16 v[68:71], v[32:35], a[232:235], v[68:71]
    v_add_f32 v8, v8, v18
    v_add_f32 v8, v8, v19
    v_mfma_f32_16x16x32_bf16 v[68:71], v[36:39], a[236:239], v[68:71]
    v_exp_f32 v17, v125
    v_mfma_f32_16x16x32_bf16 v[72:75], v[32:35], v[192:195], v[72:75]
    s_add_u32 s56, s56, 12288
    ds_read_b128 v[28:31], v3 offset:12288
    v_cvt_pk_bf16_f32 v152, v146, v150
    v_mfma_f32_16x16x32_bf16 v[72:75], v[36:39], v[196:199], v[72:75]
L_pg8:
    s_cbranch_execz L_pg12
    v_cvt_pk_bf16_f32 v189, v18, v19
    v_mfma_f32_16x16x32_bf16 v[76:79], v[32:35], v[216:219], v[76:79]
    v_exp_f32 v18, v126
    v_mfma_f32_16x16x32_bf16 v[76:79], v[36:39], v[220:223], v[76:79]
    s_waitcnt lgkmcnt(2)
    v_add_f32 v8, v8, v16
    v_mfma_f32_16x16x32_bf16 v[96:99], v[40:43], a[208:211], v[96:99]
    ds_read_b128 v[32:35], v2 offset:18432
    v_add_f32 v8, v8, v17
    v_mfma_f32_16x16x32_bf16 v[96:99], v[44:47], a[212:215], v[96:99]
    s_sub_u32 s3, s29, s30
    v_exp_f32 v19, v127
    v_mfma_f32_16x16x32_bf16 v[100:103], v[40:43], a[232:235], v[100:103]
    s_mov_b32 m0, s56
    v_cvt_pk_bf16_f32 v153, v154, v158
    v_mfma_f32_16x16x32_bf16 v[100:103], v[44:47], a[236:239], v[100:103]
    v_cvt_pk_bf16_f32 v190, v16, v17
    v_mfma_f32_16x16x32_bf16 v[104:107], v[40:43], v[192:195], v[104:107]
    ds_read_b128 v[36:39], v3 offset:18432
    v_add_f32 v8, v8, v18
    v_mfma_f32_16x16x32_bf16 v[104:107], v[44:47], v[196:199], v[104:107]
    v_add_f32 v8, v8, v19
    v_cvt_pk_bf16_f32 v191, v18, v19
    v_mfma_f32_16x16x32_bf16 v[108:111], v[40:43], v[216:219], v[108:111]
    v_mfma_f32_16x16x32_bf16 v[108:111], v[44:47], v[220:223], v[108:111]
    s_waitcnt lgkmcnt(2)
    v_exp_f32 v16, v64
    v_mfma_f32_16x16x32_bf16 v[80:83], v[24:27], a[192:195], v[128:131]
    ds_read_b128 v[40:43], v2 offset:12416
    v_mfma_f32_16x16x32_bf16 v[80:83], v[28:31], a[196:199], v[80:83]
    s_mov_b32 s30, s29
    v_exp_f32 v17, v65
    v_mfma_f32_16x16x32_bf16 v[84:87], v[24:27], a[216:219], v[132:135]
    v_exp_f32 v18, v66
    v_mfma_f32_16x16x32_bf16 v[84:87], v[28:31], a[220:223], v[84:87]
    s_waitcnt vmcnt(14)
    buffer_load_dwordx4 v4, s[4:7], s27 offen offset:0 sc1 lds
    v_mfma_f32_16x16x32_bf16 v[88:91], v[24:27], a[240:243], v[136:139]
    ds_read_b128 v[44:47], v3 offset:12416
    v_add_f32 v5, v5, v16
    v_mfma_f32_16x16x32_bf16 v[88:91], v[28:31], a[244:247], v[88:91]
    v_add_f32 v5, v5, v17
    v_lshlrev_b32 v48, 16, v60
    v_mfma_f32_16x16x32_bf16 v[92:95], v[24:27], v[200:203], v[140:143]
    v_exp_f32 v19, v67
    v_mfma_f32_16x16x32_bf16 v[92:95], v[28:31], v[204:207], v[92:95]
    s_waitcnt lgkmcnt(2)
    v_cvt_pk_bf16_f32 v64, v16, v17
    v_and_b32 v49, s97, v60
    v_mfma_f32_16x16x32_bf16 v[112:115], v[32:35], a[192:195], v[128:131]
    ds_read_b128 v[24:27], v2 offset:18560
    v_mfma_f32_16x16x32_bf16 v[112:115], v[36:39], a[196:199], v[112:115]
    v_exp_f32 v16, v96
    v_mfma_f32_16x16x32_bf16 v[116:119], v[32:35], a[216:219], v[132:135]
    v_add_f32 v5, v5, v18
    v_lshlrev_b32 v50, 16, v62
    v_mfma_f32_16x16x32_bf16 v[116:119], v[36:39], a[220:223], v[116:119]
    v_add_f32 v5, v5, v19
    v_add_u32 v1, s3, v1
    v_mfma_f32_16x16x32_bf16 v[120:123], v[32:35], a[240:243], v[136:139]
    ds_read_b128 v[28:31], v3 offset:18560
    v_mfma_f32_16x16x32_bf16 v[120:123], v[36:39], a[244:247], v[120:123]
    v_exp_f32 v17, v97
    v_mfma_f32_16x16x32_bf16 v[124:127], v[32:35], v[200:203], v[140:143]
    v_cvt_pk_bf16_f32 v65, v18, v19
    v_and_b32 v51, s97, v62
    v_mfma_f32_16x16x32_bf16 v[124:127], v[36:39], v[204:207], v[124:127]
    s_waitcnt lgkmcnt(2)
    buffer_load_dwordx4 v4, s[4:7], s27 offen offset:1024 sc1 lds
    v_mfma_f32_16x16x32_bf16 v[80:83], v[40:43], a[200:203], v[80:83]
    ds_read_b128 v[32:35], v2 offset:12544
    v_mfma_f32_16x16x32_bf16 v[80:83], v[44:47], a[204:207], v[80:83]
    v_exp_f32 v18, v98
    v_mfma_f32_16x16x32_bf16 v[84:87], v[40:43], a[224:227], v[84:87]
    v_add_f32 v5, v5, v16
    v_add_f32 v5, v5, v17
    v_mfma_f32_16x16x32_bf16 v[84:87], v[44:47], a[228:231], v[84:87]
    v_exp_f32 v19, v99
    v_mfma_f32_16x16x32_bf16 v[88:91], v[40:43], a[248:251], v[88:91]
    ds_read_b128 v[36:39], v3 offset:12544
    v_cvt_pk_bf16_f32 v66, v16, v17
    v_mfma_f32_16x16x32_bf16 v[88:91], v[44:47], a[252:255], v[88:91]
    v_exp_f32 v16, v68
    v_mfma_f32_16x16x32_bf16 v[92:95], v[40:43], v[208:211], v[92:95]
    v_mul_f32_e64 v50, -v50, v48
    v_add_f32 v5, v5, v18
    v_mfma_f32_16x16x32_bf16 v[92:95], v[44:47], v[212:215], v[92:95]
    s_waitcnt lgkmcnt(2)
    v_add_f32 v5, v5, v19
    v_mul_f32_e64 v51, -v51, v49
    v_mfma_f32_16x16x32_bf16 v[112:115], v[24:27], a[200:203], v[112:115]
    ds_read_b128 v[40:43], v2 offset:18688
    v_mfma_f32_16x16x32_bf16 v[112:115], v[28:31], a[204:207], v[112:115]
    buffer_load_dwordx4 v4, s[4:7], s27 offen offset:2048 sc1 lds
    v_mfma_f32_16x16x32_bf16 v[116:119], v[24:27], a[224:227], v[116:119]
    v_exp_f32 v17, v69
    v_mfma_f32_16x16x32_bf16 v[116:119], v[28:31], a[228:231], v[116:119]
    v_cvt_pk_bf16_f32 v67, v18, v19
    v_cvt_f32_i32 v240, v240
    v_mfma_f32_16x16x32_bf16 v[120:123], v[24:27], a[248:251], v[120:123]
    ds_read_b128 v[44:47], v3 offset:18688
    v_mfma_f32_16x16x32_bf16 v[120:123], v[28:31], a[252:255], v[120:123]
    s_waitcnt lgkmcnt(2)
    v_exp_f32 v18, v70
    v_mfma_f32_16x16x32_bf16 v[124:127], v[24:27], v[208:211], v[124:127]
    s_waitcnt vmcnt(7)
    v_add_f32 v6, v6, v16
    v_add_f32 v6, v6, v17
    v_mfma_f32_16x16x32_bf16 v[124:127], v[28:31], v[212:215], v[124:127]
    s_barrier
    v_mfma_f32_16x16x32_bf16 v[80:83], v[32:35], a[208:211], v[80:83]
    ds_read_b128 v[24:27], v1 offset:0
    v_cvt_f32_i32 v244, v244
    v_mfma_f32_16x16x32_bf16 v[80:83], v[36:39], a[212:215], v[80:83]
    v_exp_f32 v19, v71
    v_mfma_f32_16x16x32_bf16 v[84:87], v[32:35], a[232:235], v[84:87]
    v_cvt_pk_bf16_f32 v68, v16, v17
    v_fma_f32 v240, v240, v48, v50
    v_mfma_f32_16x16x32_bf16 v[84:87], v[36:39], a[236:239], v[84:87]
    v_exp_f32 v16, v100
    v_mfma_f32_16x16x32_bf16 v[88:91], v[32:35], v[192:195], v[88:91]
    ds_read_b128 v[28:31], v1 offset:12288
    v_add_f32 v6, v6, v18
    v_mfma_f32_16x16x32_bf16 v[88:91], v[36:39], v[196:199], v[88:91]
    v_add_f32 v6, v6, v19
    v_fma_f32 v244, v244, v49, v51
    v_mfma_f32_16x16x32_bf16 v[92:95], v[32:35], v[216:219], v[92:95]
    v_exp_f32 v17, v101
    v_mfma_f32_16x16x32_bf16 v[92:95], v[36:39], v[220:223], v[92:95]
    s_waitcnt lgkmcnt(2)
    v_cvt_pk_bf16_f32 v69, v18, v19
    v_mfma_f32_16x16x32_bf16 v[112:115], v[40:43], a[208:211], v[112:115]
    ds_read_b128 v[32:35], v1 offset:1024
    v_mfma_f32_16x16x32_bf16 v[112:115], v[44:47], a[212:215], v[112:115]
    v_exp_f32 v18, v102
    v_mfma_f32_16x16x32_bf16 v[116:119], v[40:43], a[232:235], v[116:119]
    v_add_f32 v6, v6, v16
    v_add_f32 v6, v6, v17
    v_mfma_f32_16x16x32_bf16 v[116:119], v[44:47], a[236:239], v[116:119]
    s_add_u32 s27, s27, 24576
    v_exp_f32 v19, v103
    v_mfma_f32_16x16x32_bf16 v[120:123], v[40:43], v[192:195], v[120:123]
    s_add_u32 s56, s56, 36864
    ds_read_b128 v[36:39], v1 offset:13312
    v_cvt_pk_bf16_f32 v70, v16, v17
    v_mfma_f32_16x16x32_bf16 v[120:123], v[44:47], v[196:199], v[120:123]
    s_sub_u32 s58, s56, 147456
    v_add_f32 v6, v6, v18
    v_add_f32 v6, v6, v19
    v_mfma_f32_16x16x32_bf16 v[124:127], v[40:43], v[216:219], v[124:127]
    s_min_u32 s56, s56, s58
    v_cvt_pk_bf16_f32 v71, v18, v19
    v_mfma_f32_16x16x32_bf16 v[124:127], v[44:47], v[220:223], v[124:127]
    s_waitcnt lgkmcnt(2)
    v_mfma_f32_16x16x32_bf16 a[0:3], v[160:163], v[24:27], a[0:3]
    s_mov_b32 m0, s56
    ds_read_b128 v[40:43], v1 offset:2048
    v_cvt_f32_i32 v241, v241
    v_mfma_f32_16x16x32_bf16 a[0:3], v[176:179], v[28:31], a[0:3]
    buffer_load_dwordx4 v4, s[4:7], s27 offen offset:0 sc1 lds
    v_mfma_f32_16x16x32_bf16 a[48:51], v[164:167], v[24:27], a[48:51]
    v_exp_f32 v16, v72
    v_mfma_f32_16x16x32_bf16 a[48:51], v[180:183], v[28:31], a[48:51]
    v_exp_f32 v17, v73
    v_mfma_f32_16x16x32_bf16 a[96:99], v[168:171], v[24:27], a[96:99]
    ds_read_b128 v[44:47], v1 offset:14336
    v_cvt_f32_i32 v245, v245
    v_mfma_f32_16x16x32_bf16 a[96:99], v[184:187], v[28:31], a[96:99]
    v_exp_f32 v18, v74
    v_mfma_f32_16x16x32_bf16 a[144:147], v[172:175], v[24:27], a[144:147]
    v_add_f32 v7, v7, v16
    v_add_f32 v7, v7, v17
    v_mfma_f32_16x16x32_bf16 a[144:147], v[188:191], v[28:31], a[144:147]
    s_waitcnt lgkmcnt(2)
    v_exp_f32 v19, v75
    v_mfma_f32_16x16x32_bf16 a[4:7], v[160:163], v[32:35], a[4:7]
    ds_read_b128 v[24:27], v1 offset:3072
    v_fma_f32 v241, v241, v48, v50
    v_mfma_f32_16x16x32_bf16 a[4:7], v[176:179], v[36:39], a[4:7]
    buffer_load_dwordx4 v4, s[4:7], s27 offen offset:1024 sc1 lds
    v_mfma_f32_16x16x32_bf16 a[52:55], v[164:167], v[32:35], a[52:55]
    v_cvt_pk_bf16_f32 v72, v16, v17
    v_fma_f32 v245, v245, v49, v51
    v_mfma_f32_16x16x32_bf16 a[52:55], v[180:183], v[36:39], a[52:55]
    v_exp_f32 v16, v104
    v_mfma_f32_16x16x32_bf16 a[100:103], v[168:171], v[32:35], a[100:103]
    ds_read_b128 v[28:31], v1 offset:15360
    v_add_f32 v7, v7, v18
    v_mfma_f32_16x16x32_bf16 a[100:103], v[184:187], v[36:39], a[100:103]
    buffer_load_dword v52, v20, s[20:23], s44 offen sc1
    v_mfma_f32_16x16x32_bf16 a[148:151], v[172:175], v[32:35], a[148:151]
    v_add_f32 v7, v7, v19
    v_cvt_f32_i32 v242, v242
    v_mfma_f32_16x16x32_bf16 a[148:151], v[188:191], v[36:39], a[148:151]
    s_waitcnt lgkmcnt(2)
    v_exp_f32 v17, v105
    v_mfma_f32_16x16x32_bf16 a[8:11], v[160:163], v[40:43], a[8:11]
    ds_read_b128 v[32:35], v1 offset:4096
    v_cvt_pk_bf16_f32 v73, v18, v19
    v_mfma_f32_16x16x32_bf16 a[8:11], v[176:179], v[44:47], a[8:11]
    v_exp_f32 v18, v106
    v_mfma_f32_16x16x32_bf16 a[56:59], v[164:167], v[40:43], a[56:59]
    v_add_f32 v7, v7, v16
    v_cvt_f32_i32 v246, v246
    v_mfma_f32_16x16x32_bf16 a[56:59], v[180:183], v[44:47], a[56:59]
    buffer_load_dwordx4 v4, s[4:7], s27 offen offset:2048 sc1 lds
    v_mfma_f32_16x16x32_bf16 a[104:107], v[168:171], v[40:43], a[104:107]
    ds_read_b128 v[36:39], v1 offset:16384
    v_add_f32 v7, v7, v17
    v_mfma_f32_16x16x32_bf16 a[104:107], v[184:187], v[44:47], a[104:107]
    v_exp_f32 v19, v107
    v_mfma_f32_16x16x32_bf16 a[152:155], v[172:175], v[40:43], a[152:155]
    v_cvt_pk_bf16_f32 v74, v16, v17
    v_fma_f32 v242, v242, v48, v50
    v_mfma_f32_16x16x32_bf16 a[152:155], v[188:191], v[44:47], a[152:155]
    s_waitcnt lgkmcnt(2)
    v_exp_f32 v16, v76
    v_mfma_f32_16x16x32_bf16 a[12:15], v[160:163], v[24:27], a[12:15]
    ds_read_b128 v[40:43], v1 offset:5120
    v_add_f32 v7, v7, v18
    v_mfma_f32_16x16x32_bf16 a[12:15], v[176:179], v[28:31], a[12:15]
    s_add_u32 s27, s27, 24576
    v_add_f32 v7, v7, v19
    v_fma_f32 v246, v246, v49, v51
    v_mfma_f32_16x16x32_bf16 a[60:63], v[164:167], v[24:27], a[60:63]
    v_exp_f32 v17, v77
    v_mfma_f32_16x16x32_bf16 a[60:63], v[180:183], v[28:31], a[60:63]
    v_cvt_pk_bf16_f32 v75, v18, v19
    v_lshlrev_b32 v48, 16, v61
    v_mfma_f32_16x16x32_bf16 a[108:111], v[168:171], v[24:27], a[108:111]
    ds_read_b128 v[44:47], v1 offset:17408
    v_and_b32 v49, s97, v61
    v_mfma_f32_16x16x32_bf16 a[108:111], v[184:187], v[28:31], a[108:111]
    v_exp_f32 v18, v78
    v_mfma_f32_16x16x32_bf16 a[156:159], v[172:175], v[24:27], a[156:159]
    s_add_u32 s29, s28, 49152
    v_add_f32 v8, v8, v16
    v_add_f32 v8, v8, v17
    v_mfma_f32_16x16x32_bf16 a[156:159], v[188:191], v[28:31], a[156:159]
    s_waitcnt lgkmcnt(2)
    v_exp_f32 v19, v79
    v_mfma_f32_16x16x32_bf16 a[16:19], v[160:163], v[32:35], a[16:19]
    s_sub_u32 s3, s29, 147456
    ds_read_b128 v[24:27], v1 offset:6144
    v_lshlrev_b32 v50, 16, v63
    v_mfma_f32_16x16x32_bf16 a[16:19], v[176:179], v[36:39], a[16:19]
    s_add_u32 s56, s56, 12288
    v_cvt_pk_bf16_f32 v76, v16, v17
    v_and_b32 v51, s97, v63
    v_mfma_f32_16x16x32_bf16 a[64:67], v[164:167], v[32:35], a[64:67]
    s_min_u32 s29, s29, s3
    v_exp_f32 v16, v108
    v_mfma_f32_16x16x32_bf16 a[64:67], v[180:183], v[36:39], a[64:67]
    s_mov_b32 m0, s56
    v_add_f32 v8, v8, v18
    v_add_f32 v8, v8, v19
    v_mfma_f32_16x16x32_bf16 a[112:115], v[168:171], v[32:35], a[112:115]
    ds_read_b128 v[28:31], v1 offset:18432
    v_mul_f32_e64 v50, -v50, v48
    v_mfma_f32_16x16x32_bf16 a[112:115], v[184:187], v[36:39], a[112:115]
    v_exp_f32 v17, v109
    v_mfma_f32_16x16x32_bf16 a[160:163], v[172:175], v[32:35], a[160:163]
    v_cvt_pk_bf16_f32 v77, v18, v19
    v_mul_f32_e64 v51, -v51, v49
    v_mfma_f32_16x16x32_bf16 a[160:163], v[188:191], v[36:39], a[160:163]
    s_waitcnt lgkmcnt(2)
    v_exp_f32 v18, v110
    v_mfma_f32_16x16x32_bf16 a[20:23], v[160:163], v[40:43], a[20:23]
    s_sub_u32 s3, s29, s28
    ds_read_b128 v[32:35], v1 offset:7168
    v_add_f32 v8, v8, v16
    v_mfma_f32_16x16x32_bf16 a[20:23], v[176:179], v[44:47], a[20:23]
    v_add_f32 v8, v8, v17
    v_cvt_f32_i32 v248, v248
    v_mfma_f32_16x16x32_bf16 a[68:71], v[164:167], v[40:43], a[68:71]
    v_exp_f32 v19, v111
    v_mfma_f32_16x16x32_bf16 a[68:71], v[180:183], v[44:47], a[68:71]
    buffer_load_dwordx4 v4, s[4:7], s27 offen offset:0 sc1 lds
    v_mfma_f32_16x16x32_bf16 a[116:119], v[168:171], v[40:43], a[116:119]
    ds_read_b128 v[36:39], v1 offset:19456
    v_cvt_pk_bf16_f32 v78, v16, v17
    v_mfma_f32_16x16x32_bf16 a[116:119], v[184:187], v[44:47], a[116:119]
    v_add_f32 v8, v8, v18
    v_cvt_f32_i32 v252, v252
    v_mfma_f32_16x16x32_bf16 a[164:167], v[172:175], v[40:43], a[164:167]
    s_mov_b32 s28, s29
    v_add_f32 v8, v8, v19
    v_cvt_pk_bf16_f32 v79, v18, v19
    v_mfma_f32_16x16x32_bf16 a[164:167], v[188:191], v[44:47], a[164:167]
    s_waitcnt lgkmcnt(2)
    v_exp_f32 v16, v80
    v_mfma_f32_16x16x32_bf16 a[24:27], v[160:163], v[24:27], a[24:27]
    ds_read_b128 v[40:43], v1 offset:8192
    v_fma_f32 v248, v248, v48, v50
    v_mfma_f32_16x16x32_bf16 a[24:27], v[176:179], v[28:31], a[24:27]
    v_exp_f32 v17, v81
    v_mfma_f32_16x16x32_bf16 a[72:75], v[164:167], v[24:27], a[72:75]
    v_fma_f32 v252, v252, v49, v51
    v_cvt_f32_i32 v249, v249
    v_mfma_f32_16x16x32_bf16 a[72:75], v[180:183], v[28:31], a[72:75]
    buffer_load_dwordx4 v4, s[4:7], s27 offen offset:1024 sc1 lds
    v_mfma_f32_16x16x32_bf16 a[120:123], v[168:171], v[24:27], a[120:123]
    ds_read_b128 v[44:47], v1 offset:20480
    v_cvt_f32_i32 v253, v253
    v_mfma_f32_16x16x32_bf16 a[120:123], v[184:187], v[28:31], a[120:123]
    v_exp_f32 v18, v82
    v_mfma_f32_16x16x32_bf16 a[168:171], v[172:175], v[24:27], a[168:171]
    v_add_f32 v5, v5, v16
    v_add_f32 v5, v5, v17
    v_mfma_f32_16x16x32_bf16 a[168:171], v[188:191], v[28:31], a[168:171]
    s_waitcnt lgkmcnt(2)
    v_exp_f32 v19, v83
    v_mfma_f32_16x16x32_bf16 a[28:31], v[160:163], v[32:35], a[28:31]
    ds_read_b128 v[24:27], v1 offset:9216
    v_cvt_pk_bf16_f32 v80, v16, v17
    v_mfma_f32_16x16x32_bf16 a[28:31], v[176:179], v[36:39], a[28:31]
    v_exp_f32 v16, v112
    v_mfma_f32_16x16x32_bf16 a[76:79], v[164:167], v[32:35], a[76:79]
    v_add_f32 v5, v5, v18
    v_fma_f32 v249, v249, v48, v50
    v_mfma_f32_16x16x32_bf16 a[76:79], v[180:183], v[36:39], a[76:79]
    v_add_f32 v5, v5, v19
    v_add_u32 v2, s3, v2
    v_mfma_f32_16x16x32_bf16 a[124:127], v[168:171], v[32:35], a[124:127]
    ds_read_b128 v[28:31], v1 offset:21504
    v_fma_f32 v253, v253, v49, v51
    v_mfma_f32_16x16x32_bf16 a[124:127], v[184:187], v[36:39], a[124:127]
    buffer_load_dwordx4 v4, s[4:7], s27 offen offset:2048 sc1 lds
    v_mfma_f32_16x16x32_bf16 a[172:175], v[172:175], v[32:35], a[172:175]
    v_exp_f32 v17, v113
    v_mfma_f32_16x16x32_bf16 a[172:175], v[188:191], v[36:39], a[172:175]
    s_waitcnt lgkmcnt(2)
    v_cvt_pk_bf16_f32 v81, v18, v19
    v_cvt_f32_i32 v250, v250
    v_mfma_f32_16x16x32_bf16 a[32:35], v[160:163], v[40:43], a[32:35]
    ds_read_b128 v[32:35], v1 offset:10240
    v_add_u32 v3, s3, v3
    v_mfma_f32_16x16x32_bf16 a[32:35], v[176:179], v[44:47], a[32:35]
    v_exp_f32 v18, v114
    v_mfma_f32_16x16x32_bf16 a[80:83], v[164:167], v[40:43], a[80:83]
    v_add_f32 v5, v5, v16
    v_add_f32 v5, v5, v17
    v_mfma_f32_16x16x32_bf16 a[80:83], v[180:183], v[44:47], a[80:83]
    v_exp_f32 v19, v115
    v_mfma_f32_16x16x32_bf16 a[128:131], v[168:171], v[40:43], a[128:131]
    ds_read_b128 v[36:39], v1 offset:22528
    v_cvt_pk_bf16_f32 v82, v16, v17
    v_mfma_f32_16x16x32_bf16 a[128:131], v[184:187], v[44:47], a[128:131]
    v_exp_f32 v16, v84
    v_mfma_f32_16x16x32_bf16 a[176:179], v[172:175], v[40:43], a[176:179]
    v_cvt_f32_i32 v254, v254
    v_add_f32 v5, v5, v18
    v_mfma_f32_16x16x32_bf16 a[176:179], v[188:191], v[44:47], a[176:179]
    s_waitcnt lgkmcnt(2)
    v_add_f32 v5, v5, v19
    v_fma_f32 v250, v250, v48, v50
    v_mfma_f32_16x16x32_bf16 a[36:39], v[160:163], v[24:27], a[36:39]
    ds_read_b128 v[40:43], v1 offset:11264
    v_fma_f32 v254, v254, v49, v51
    v_mfma_f32_16x16x32_bf16 a[36:39], v[176:179], v[28:31], a[36:39]
    v_exp_f32 v17, v85
    v_mfma_f32_16x16x32_bf16 a[84:87], v[164:167], v[24:27], a[84:87]
    v_cvt_pk_bf16_f32 v83, v18, v19
    v_cvt_pk_bf16_f32 v146, v240, v244
    v_mfma_f32_16x16x32_bf16 a[84:87], v[180:183], v[28:31], a[84:87]
    s_add_u32 s27, s27, 24576
    v_exp_f32 v18, v86
    v_mfma_f32_16x16x32_bf16 a[132:135], v[168:171], v[24:27], a[132:135]
    s_add_u32 s56, s56, 36864
    ds_read_b128 v[44:47], v1 offset:23552
    v_add_f32 v6, v6, v16
    v_mfma_f32_16x16x32_bf16 a[132:135], v[184:187], v[28:31], a[132:135]
    s_sub_u32 s58, s56, 147456
    v_add_f32 v6, v6, v17
    v_cvt_pk_bf16_f32 v150, v241, v245
    v_mfma_f32_16x16x32_bf16 a[180:183], v[172:175], v[24:27], a[180:183]
    v_exp_f32 v19, v87
    v_mfma_f32_16x16x32_bf16 a[180:183], v[188:191], v[28:31], a[180:183]
    s_waitcnt lgkmcnt(2)
    v_cvt_pk_bf16_f32 v84, v16, v17
    v_cvt_pk_bf16_f32 v147, v248, v252
    v_mfma_f32_16x16x32_bf16 a[40:43], v[160:163], v[32:35], a[40:43]
    s_min_u32 s56, s56, s58
    ds_read_b128 v[24:27], v2 offset:0
    v_mfma_f32_16x16x32_bf16 a[40:43], v[176:179], v[36:39], a[40:43]
    v_exp_f32 v16, v116
    v_mfma_f32_16x16x32_bf16 a[88:91], v[164:167], v[32:35], a[88:91]
    v_add_f32 v6, v6, v18
    v_add_f32 v6, v6, v19
    v_mfma_f32_16x16x32_bf16 a[88:91], v[180:183], v[36:39], a[88:91]
    v_exp_f32 v17, v117
    v_mfma_f32_16x16x32_bf16 a[136:139], v[168:171], v[32:35], a[136:139]
    ds_read_b128 v[28:31], v3 offset:0
    v_cvt_pk_bf16_f32 v151, v249, v253
    v_mfma_f32_16x16x32_bf16 a[136:139], v[184:187], v[36:39], a[136:139]
    v_cvt_pk_bf16_f32 v85, v18, v19
    v_cvt_pk_bf16_f32 v154, v242, v246
    v_mfma_f32_16x16x32_bf16 a[184:187], v[172:175], v[32:35], a[184:187]
    v_exp_f32 v18, v118
    v_mfma_f32_16x16x32_bf16 a[184:187], v[188:191], v[36:39], a[184:187]
    s_waitcnt lgkmcnt(2)
    v_add_f32 v6, v6, v16
    v_mfma_f32_16x16x32_bf16 a[44:47], v[160:163], v[40:43], a[44:47]
    ds_read_b128 v[32:35], v2 offset:6144
    v_add_f32 v6, v6, v17
    v_mfma_f32_16x16x32_bf16 a[44:47], v[176:179], v[44:47], a[44:47]
    v_exp_f32 v19, v119
    v_mfma_f32_16x16x32_bf16 a[92:95], v[164:167], v[40:43], a[92:95]
    v_cvt_pk_bf16_f32 v155, v250, v254
    v_mfma_f32_16x16x32_bf16 a[92:95], v[180:183], v[44:47], a[92:95]
    v_cvt_pk_bf16_f32 v86, v16, v17
    v_mfma_f32_16x16x32_bf16 a[140:143], v[168:171], v[40:43], a[140:143]
    ds_read_b128 v[36:39], v3 offset:6144
    v_add_f32 v6, v6, v18
    v_mfma_f32_16x16x32_bf16 a[140:143], v[184:187], v[44:47], a[140:143]
    v_add_f32 v6, v6, v19
    v_cvt_pk_bf16_f32 v87, v18, v19
    v_mfma_f32_16x16x32_bf16 a[188:191], v[172:175], v[40:43], a[188:191]
    v_mfma_f32_16x16x32_bf16 a[188:191], v[188:191], v[44:47], a[188:191]
    s_waitcnt lgkmcnt(2)
    v_mfma_f32_16x16x32_bf16 v[160:163], v[24:27], a[192:195], v[128:131]
    ds_read_b128 v[40:43], v2 offset:128
    v_mfma_f32_16x16x32_bf16 v[160:163], v[28:31], a[196:199], v[160:163]
    s_waitcnt vmcnt(4)
    v_subrev_u32 v52, s92, v52
    v_cmp_lt_u32 vcc, 15, v52
    v_mfma_f32_16x16x32_bf16 v[164:167], v[24:27], a[216:219], v[132:135]
    v_exp_f32 v16, v88
    v_mfma_f32_16x16x32_bf16 v[164:167], v[28:31], a[220:223], v[164:167]
    v_exp_f32 v17, v89
    v_mfma_f32_16x16x32_bf16 v[168:171], v[24:27], a[240:243], v[136:139]
    s_and_b32 s59, vcc_lo, 0xff
    ds_read_b128 v[44:47], v3 offset:128
    v_mfma_f32_16x16x32_bf16 v[168:171], v[28:31], a[244:247], v[168:171]
    s_cbranch_scc1 L_pollslow3
L_pollok3:
    v_mfma_f32_16x16x32_bf16 v[172:175], v[24:27], v[200:203], v[140:143]
    s_add_u32 s92, s92, 1
    v_exp_f32 v18, v90
    v_mfma_f32_16x16x32_bf16 v[172:175], v[28:31], v[204:207], v[172:175]
    s_waitcnt lgkmcnt(2)
    v_add_f32 v7, v7, v16
    v_add_f32 v7, v7, v17
    v_mfma_f32_16x16x32_bf16 v[96:99], v[32:35], a[192:195], v[128:131]
    ds_read_b128 v[24:27], v2 offset:6272
    v_mfma_f32_16x16x32_bf16 v[96:99], v[36:39], a[196:199], v[96:99]
    buffer_store_dwordx4 v[144:147], v15, s[4:7], s35 offen offset:0 sc1
    v_mfma_f32_16x16x32_bf16 v[100:103], v[32:35], a[216:219], v[132:135]
    v_exp_f32 v19, v91
    v_mfma_f32_16x16x32_bf16 v[100:103], v[36:39], a[220:223], v[100:103]
    v_cvt_pk_bf16_f32 v88, v16, v17
    v_mfma_f32_16x16x32_bf16 v[104:107], v[32:35], a[240:243], v[136:139]
    ds_read_b128 v[28:31], v3 offset:6272
    v_mfma_f32_16x16x32_bf16 v[104:107], v[36:39], a[244:247], v[104:107]
    v_exp_f32 v16, v120
    v_mfma_f32_16x16x32_bf16 v[108:111], v[32:35], v[200:203], v[140:143]
    v_add_f32 v7, v7, v18
    v_add_f32 v7, v7, v19
    v_mfma_f32_16x16x32_bf16 v[108:111], v[36:39], v[204:207], v[108:111]
    s_waitcnt lgkmcnt(2)
    v_exp_f32 v17, v121
    v_mfma_f32_16x16x32_bf16 v[160:163], v[40:43], a[200:203], v[160:163]
    ds_read_b128 v[32:35], v2 offset:256
    v_cvt_pk_bf16_f32 v89, v18, v19
    v_mfma_f32_16x16x32_bf16 v[160:163], v[44:47], a[204:207], v[160:163]
    buffer_store_dwordx4 v[148:151], v15, s[4:7], s35 offen offset:1024 sc1
    v_mfma_f32_16x16x32_bf16 v[164:167], v[40:43], a[224:227], v[164:167]
    v_exp_f32 v18, v122
    v_mfma_f32_16x16x32_bf16 v[164:167], v[44:47], a[228:231], v[164:167]
    v_add_f32 v7, v7, v16
    v_add_f32 v7, v7, v17
    v_mfma_f32_16x16x32_bf16 v[168:171], v[40:43], a[248:251], v[168:171]
    ds_read_b128 v[36:39], v3 offset:256
    v_mfma_f32_16x16x32_bf16 v[168:171], v[44:47], a[252:255], v[168:171]
    v_exp_f32 v19, v123
    v_mfma_f32_16x16x32_bf16 v[172:175], v[40:43], v[208:211], v[172:175]
    v_cvt_pk_bf16_f32 v90, v16, v17
    v_mfma_f32_16x16x32_bf16 v[172:175], v[44:47], v[212:215], v[172:175]
    s_waitcnt lgkmcnt(2)
    v_exp_f32 v16, v92
    v_mfma_f32_16x16x32_bf16 v[96:99], v[24:27], a[200:203], v[96:99]
    ds_read_b128 v[40:43], v2 offset:6400
    v_add_f32 v7, v7, v18
    v_mfma_f32_16x16x32_bf16 v[96:99], v[28:31], a[204:207], v[96:99]
    buffer_store_dwordx4 v[152:155], v15, s[4:7], s35 offen offset:2048 sc1
    v_mfma_f32_16x16x32_bf16 v[100:103], v[24:27], a[224:227], v[100:103]
    v_add_f32 v7, v7, v19
    v_mfma_f32_16x16x32_bf16 v[100:103], v[28:31], a[228:231], v[100:103]
    v_exp_f32 v17, v93
    v_mfma_f32_16x16x32_bf16 v[104:107], v[24:27], a[248:251], v[104:107]
    ds_read_b128 v[44:47], v3 offset:6400
    v_cvt_pk_bf16_f32 v91, v18, v19
    v_mfma_f32_16x16x32_bf16 v[104:107], v[28:31], a[252:255], v[104:107]
    v_exp_f32 v18, v94
    v_mfma_f32_16x16x32_bf16 v[108:111], v[24:27], v[208:211], v[108:111]
    s_add_u32 s29, s30, 49152
    v_add_f32 v8, v8, v16
    v_add_f32 v8, v8, v17
    v_mfma_f32_16x16x32_bf16 v[108:111], v[28:31], v[212:215], v[108:111]
    s_waitcnt lgkmcnt(2)
    v_exp_f32 v19, v95
    v_mfma_f32_16x16x32_bf16 v[160:163], v[32:35], a[208:211], v[160:163]
    s_sub_u32 s3, s29, 147456
    ds_read_b128 v[24:27], v2 offset:12288
    v_cvt_pk_bf16_f32 v92, v16, v17
    v_mfma_f32_16x16x32_bf16 v[160:163], v[36:39], a[212:215], v[160:163]
    s_min_u32 s29, s29, s3
    v_exp_f32 v16, v124
    v_mfma_f32_16x16x32_bf16 v[164:167], v[32:35], a[232:235], v[164:167]
    v_add_f32 v8, v8, v18
    v_add_f32 v8, v8, v19
    v_mfma_f32_16x16x32_bf16 v[164:167], v[36:39], a[236:239], v[164:167]
    v_exp_f32 v17, v125
    v_mfma_f32_16x16x32_bf16 v[168:171], v[32:35], v[192:195], v[168:171]
    ds_read_b128 v[28:31], v3 offset:12288
    v_mfma_f32_16x16x32_bf16 v[168:171], v[36:39], v[196:199], v[168:171]
    v_cvt_pk_bf16_f32 v93, v18, v19
    v_mfma_f32_16x16x32_bf16 v[172:175], v[32:35], v[216:219], v[172:175]
    v_exp_f32 v18, v126
    v_mfma_f32_16x16x32_bf16 v[172:175], v[36:39], v[220:223], v[172:175]
    s_waitcnt lgkmcnt(2)
    v_add_f32 v8, v8, v16
    v_mfma_f32_16x16x32_bf16 v[96:99], v[40:43], a[208:211], v[96:99]
    ds_read_b128 v[32:35], v2 offset:18432
    v_add_f32 v8, v8, v17
    v_mfma_f32_16x16x32_bf16 v[96:99], v[44:47], a[212:215], v[96:99]
    s_mov_b32 m0, s26
    v_exp_f32 v19, v127
    v_mfma_f32_16x16x32_bf16 v[100:103], v[40:43], a[232:235], v[100:103]
    s_sub_u32 s3, s29, s30
    v_mfma_f32_16x16x32_bf16 v[100:103], v[44:47], a[236:239], v[100:103]
    buffer_load_dwordx4 v4, s[4:7], s32 offen offset:0 sc1 lds
    v_mfma_f32_16x16x32_bf16 v[104:107], v[40:43], v[192:195], v[104:107]
    ds_read_b128 v[36:39], v3 offset:18432
    v_cvt_pk_bf16_f32 v94, v16, v17
    v_mfma_f32_16x16x32_bf16 v[104:107], v[44:47], v[196:199], v[104:107]
    v_add_f32 v8, v8, v18
    v_add_f32 v8, v8, v19
    v_mfma_f32_16x16x32_bf16 v[108:111], v[40:43], v[216:219], v[108:111]
    v_cvt_pk_bf16_f32 v95, v18, v19
    v_mfma_f32_16x16x32_bf16 v[108:111], v[44:47], v[220:223], v[108:111]
    s_waitcnt lgkmcnt(2)
    buffer_load_dwordx4 v4, s[4:7], s32 offen offset:1024 sc1 lds
    v_mfma_f32_16x16x32_bf16 v[176:179], v[24:27], a[192:195], v[128:131]
    ds_read_b128 v[40:43], v2 offset:12416
    v_mfma_f32_16x16x32_bf16 v[176:179], v[28:31], a[196:199], v[176:179]
    s_mov_b32 s30, s29
    v_exp_f32 v16, v160
    v_mfma_f32_16x16x32_bf16 v[180:183], v[24:27], a[216:219], v[132:135]
    v_exp_f32 v17, v161
    v_mfma_f32_16x16x32_bf16 v[180:183], v[28:31], a[220:223], v[180:183]
    buffer_load_dwordx4 v4, s[4:7], s32 offen offset:2048 sc1 lds
    v_mfma_f32_16x16x32_bf16 v[184:187], v[24:27], a[240:243], v[136:139]
    s_add_u32 s32, s32, 24576
    ds_read_b128 v[44:47], v3 offset:12416
    v_mfma_f32_16x16x32_bf16 v[184:187], v[28:31], a[244:247], v[184:187]
    v_exp_f32 v18, v162
    v_mfma_f32_16x16x32_bf16 v[188:191], v[24:27], v[200:203], v[140:143]
    s_add_u32 s26, s26, 12288
    v_add_f32 v5, v5, v16
    v_add_f32 v5, v5, v17
    v_mfma_f32_16x16x32_bf16 v[188:191], v[28:31], v[204:207], v[188:191]
    s_waitcnt lgkmcnt(2)
    v_exp_f32 v19, v163
    v_mfma_f32_16x16x32_bf16 v[112:115], v[32:35], a[192:195], v[128:131]
    s_mov_b32 m0, s26
    ds_read_b128 v[24:27], v2 offset:18560
    v_cvt_pk_bf16_f32 v160, v16, v17
    v_mfma_f32_16x16x32_bf16 v[112:115], v[36:39], a[196:199], v[112:115]
    v_exp_f32 v16, v96
    v_mfma_f32_16x16x32_bf16 v[116:119], v[32:35], a[216:219], v[132:135]
    v_add_f32 v5, v5, v18
    v_add_f32 v5, v5, v19
    v_mfma_f32_16x16x32_bf16 v[116:119], v[36:39], a[220:223], v[116:119]
    v_exp_f32 v17, v97
    v_mfma_f32_16x16x32_bf16 v[120:123], v[32:35], a[240:243], v[136:139]
    ds_read_b128 v[28:31], v3 offset:18560
    v_add_u32 v1, s3, v1
    v_mfma_f32_16x16x32_bf16 v[120:123], v[36:39], a[244:247], v[120:123]
    buffer_load_dwordx4 v4, s[4:7], s32 offen offset:0 sc1 lds
    v_mfma_f32_16x16x32_bf16 v[124:127], v[32:35], v[200:203], v[140:143]
    v_cvt_pk_bf16_f32 v161, v18, v19
    v_mfma_f32_16x16x32_bf16 v[124:127], v[36:39], v[204:207], v[124:127]
    s_waitcnt lgkmcnt(2)
    v_exp_f32 v18, v98
    v_mfma_f32_16x16x32_bf16 v[176:179], v[40:43], a[200:203], v[176:179]
    ds_read_b128 v[32:35], v2 offset:12544
    v_add_f32 v5, v5, v16
    v_mfma_f32_16x16x32_bf16 v[176:179], v[44:47], a[204:207], v[176:179]
    buffer_load_dwordx4 v4, s[4:7], s32 offen offset:1024 sc1 lds
    v_mfma_f32_16x16x32_bf16 v[180:183], v[40:43], a[224:227], v[180:183]
    v_add_f32 v5, v5, v17
    v_mfma_f32_16x16x32_bf16 v[180:183], v[44:47], a[228:231], v[180:183]
    v_exp_f32 v19, v99
    v_mfma_f32_16x16x32_bf16 v[184:187], v[40:43], a[248:251], v[184:187]
    ds_read_b128 v[36:39], v3 offset:12544
    v_cvt_pk_bf16_f32 v162, v16, v17
    v_mfma_f32_16x16x32_bf16 v[184:187], v[44:47], a[252:255], v[184:187]
    buffer_load_dwordx4 v4, s[4:7], s32 offen offset:2048 sc1 lds
    v_mfma_f32_16x16x32_bf16 v[188:191], v[40:43], v[208:211], v[188:191]
    v_exp_f32 v16, v164
    v_mfma_f32_16x16x32_bf16 v[188:191], v[44:47], v[212:215], v[188:191]
    s_waitcnt lgkmcnt(2)
    v_add_f32 v5, v5, v18
    v_add_f32 v5, v5, v19
    v_mfma_f32_16x16x32_bf16 v[112:115], v[24:27], a[200:203], v[112:115]
    ds_read_b128 v[40:43], v2 offset:18688
    v_mfma_f32_16x16x32_bf16 v[112:115], v[28:31], a[204:207], v[112:115]
    v_exp_f32 v17, v165
    v_mfma_f32_16x16x32_bf16 v[116:119], v[24:27], a[224:227], v[116:119]
    v_cvt_pk_bf16_f32 v163, v18, v19
    v_mfma_f32_16x16x32_bf16 v[116:119], v[28:31], a[228:231], v[116:119]
    s_add_u32 s32, s32, 24576
    v_exp_f32 v18, v166
    v_mfma_f32_16x16x32_bf16 v[120:123], v[24:27], a[248:251], v[120:123]
    s_add_u32 s26, s26, 36864
    ds_read_b128 v[44:47], v3 offset:18688
    v_add_f32 v6, v6, v16
    v_mfma_f32_16x16x32_bf16 v[120:123], v[28:31], a[252:255], v[120:123]
    s_waitcnt lgkmcnt(2)
    v_add_f32 v6, v6, v17
    s_sub_u32 s57, s26, 147456
    v_mfma_f32_16x16x32_bf16 v[124:127], v[24:27], v[208:211], v[124:127]
    s_waitcnt vmcnt(6)
    v_exp_f32 v19, v167
    v_mfma_f32_16x16x32_bf16 v[124:127], v[28:31], v[212:215], v[124:127]
    s_barrier
    v_mfma_f32_16x16x32_bf16 v[176:179], v[32:35], a[208:211], v[176:179]
L_pg9:
    s_cbranch_execz L_pg13
    s_min_u32 s26, s26, s57
    ds_read_b128 v[24:27], v1 offset:0
    v_cvt_pk_bf16_f32 v164, v16, v17
    v_mfma_f32_16x16x32_bf16 v[176:179], v[36:39], a[212:215], v[176:179]
    v_exp_f32 v16, v100
    v_mfma_f32_16x16x32_bf16 v[180:183], v[32:35], a[232:235], v[180:183]
    v_add_u32 v0, 1, v0
    v_add_f32 v6, v6, v18
    v_mfma_f32_16x16x32_bf16 v[180:183], v[36:39], a[236:239], v[180:183]
    buffer_store_dword v0, v13, s[20:23], 0 offen offset:32 sc1
    v_mfma_f32_16x16x32_bf16 v[184:187], v[32:35], v[192:195], v[184:187]
    ds_read_b128 v[28:31], v1 offset:12288
    v_add_f32 v6, v6, v19
    v_mfma_f32_16x16x32_bf16 v[184:187], v[36:39], v[196:199], v[184:187]
    v_exp_f32 v17, v101
    v_mfma_f32_16x16x32_bf16 v[188:191], v[32:35], v[216:219], v[188:191]
    v_cvt_pk_bf16_f32 v165, v18, v19
    v_mfma_f32_16x16x32_bf16 v[188:191], v[36:39], v[220:223], v[188:191]
    s_waitcnt lgkmcnt(2)
    v_exp_f32 v18, v102
    v_mfma_f32_16x16x32_bf16 v[112:115], v[40:43], a[208:211], v[112:115]
    ds_read_b128 v[32:35], v1 offset:1024
    v_add_f32 v6, v6, v16
    v_mfma_f32_16x16x32_bf16 v[112:115], v[44:47], a[212:215], v[112:115]
    v_add_f32 v6, v6, v17
    v_mfma_f32_16x16x32_bf16 v[116:119], v[40:43], a[232:235], v[116:119]
    v_exp_f32 v19, v103
    v_mfma_f32_16x16x32_bf16 v[116:119], v[44:47], a[236:239], v[116:119]
    v_cvt_pk_bf16_f32 v166, v16, v17
    v_mfma_f32_16x16x32_bf16 v[120:123], v[40:43], v[192:195], v[120:123]
    ds_read_b128 v[36:39], v1 offset:13312
    v_add_f32 v6, v6, v18
    v_mfma_f32_16x16x32_bf16 v[120:123], v[44:47], v[196:199], v[120:123]
    v_add_f32 v6, v6, v19
    v_cvt_pk_bf16_f32 v167, v18, v19
    v_mfma_f32_16x16x32_bf16 v[124:127], v[40:43], v[216:219], v[124:127]
    v_mfma_f32_16x16x32_bf16 v[124:127], v[44:47], v[220:223], v[124:127]
    s_waitcnt lgkmcnt(2)
    v_mfma_f32_16x16x32_bf16 a[0:3], v[64:67], v[24:27], a[0:3]
    s_mov_b32 m0, s26
    ds_read_b128 v[40:43], v1 offset:2048
    v_mfma_f32_16x16x32_bf16 a[0:3], v[80:83], v[28:31], a[0:3]
    buffer_load_dwordx4 v4, s[4:7], s32 offen offset:0 sc1 lds
    v_mfma_f32_16x16x32_bf16 a[48:51], v[68:71], v[24:27], a[48:51]
    v_exp_f32 v16, v168
    v_mfma_f32_16x16x32_bf16 a[48:51], v[84:87], v[28:31], a[48:51]
    v_exp_f32 v17, v169
    v_mfma_f32_16x16x32_bf16 a[96:99], v[72:75], v[24:27], a[96:99]
    ds_read_b128 v[44:47], v1 offset:14336
    v_mfma_f32_16x16x32_bf16 a[96:99], v[88:91], v[28:31], a[96:99]
    v_exp_f32 v18, v170
    v_mfma_f32_16x16x32_bf16 a[144:147], v[76:79], v[24:27], a[144:147]
    v_add_f32 v7, v7, v16
    v_add_f32 v7, v7, v17
    v_mfma_f32_16x16x32_bf16 a[144:147], v[92:95], v[28:31], a[144:147]
    s_waitcnt lgkmcnt(2)
    v_exp_f32 v19, v171
    v_mfma_f32_16x16x32_bf16 a[4:7], v[64:67], v[32:35], a[4:7]
    ds_read_b128 v[24:27], v1 offset:3072
    v_cvt_pk_bf16_f32 v168, v16, v17
    v_mfma_f32_16x16x32_bf16 a[4:7], v[80:83], v[36:39], a[4:7]
    v_exp_f32 v16, v104
    v_mfma_f32_16x16x32_bf16 a[52:55], v[68:71], v[32:35], a[52:55]
    v_add_f32 v7, v7, v18
    v_add_f32 v7, v7, v19
    v_mfma_f32_16x16x32_bf16 a[52:55], v[84:87], v[36:39], a[52:55]
    buffer_load_dwordx4 v4, s[4:7], s32 offen offset:1024 sc1 lds
    v_mfma_f32_16x16x32_bf16 a[100:103], v[72:75], v[32:35], a[100:103]
    ds_read_b128 v[28:31], v1 offset:15360
    v_mfma_f32_16x16x32_bf16 a[100:103], v[88:91], v[36:39], a[100:103]
    v_exp_f32 v17, v105
    v_mfma_f32_16x16x32_bf16 a[148:151], v[76:79], v[32:35], a[148:151]
    v_cvt_pk_bf16_f32 v169, v18, v19
    v_mfma_f32_16x16x32_bf16 a[148:151], v[92:95], v[36:39], a[148:151]
    s_waitcnt lgkmcnt(2)
    v_exp_f32 v18, v106
    v_mfma_f32_16x16x32_bf16 a[8:11], v[64:67], v[40:43], a[8:11]
    ds_read_b128 v[32:35], v1 offset:4096
    v_add_f32 v7, v7, v16
    v_mfma_f32_16x16x32_bf16 a[8:11], v[80:83], v[44:47], a[8:11]
    v_add_f32 v7, v7, v17
    v_mfma_f32_16x16x32_bf16 a[56:59], v[68:71], v[40:43], a[56:59]
    v_exp_f32 v19, v107
    v_mfma_f32_16x16x32_bf16 a[56:59], v[84:87], v[44:47], a[56:59]
    v_cvt_pk_bf16_f32 v170, v16, v17
    v_mfma_f32_16x16x32_bf16 a[104:107], v[72:75], v[40:43], a[104:107]
    ds_read_b128 v[36:39], v1 offset:16384
    v_mfma_f32_16x16x32_bf16 a[104:107], v[88:91], v[44:47], a[104:107]
    v_exp_f32 v16, v172
    v_mfma_f32_16x16x32_bf16 a[152:155], v[76:79], v[40:43], a[152:155]
    v_add_f32 v7, v7, v18
    v_add_f32 v7, v7, v19
    v_mfma_f32_16x16x32_bf16 a[152:155], v[92:95], v[44:47], a[152:155]
    s_waitcnt lgkmcnt(2)
    buffer_load_dwordx4 v4, s[4:7], s32 offen offset:2048 sc1 lds
    v_mfma_f32_16x16x32_bf16 a[12:15], v[64:67], v[24:27], a[12:15]
    ds_read_b128 v[40:43], v1 offset:5120
    v_mfma_f32_16x16x32_bf16 a[12:15], v[80:83], v[28:31], a[12:15]
    v_exp_f32 v17, v173
    v_mfma_f32_16x16x32_bf16 a[60:63], v[68:71], v[24:27], a[60:63]
    v_cvt_pk_bf16_f32 v171, v18, v19
    v_mfma_f32_16x16x32_bf16 a[60:63], v[84:87], v[28:31], a[60:63]
    v_exp_f32 v18, v174
    v_mfma_f32_16x16x32_bf16 a[108:111], v[72:75], v[24:27], a[108:111]
    ds_read_b128 v[44:47], v1 offset:17408
    v_add_f32 v8, v8, v16
    v_mfma_f32_16x16x32_bf16 a[108:111], v[88:91], v[28:31], a[108:111]
    v_add_f32 v8, v8, v17
    v_mfma_f32_16x16x32_bf16 a[156:159], v[76:79], v[24:27], a[156:159]
    s_add_u32 s29, s28, 49152
    v_exp_f32 v19, v175
    v_mfma_f32_16x16x32_bf16 a[156:159], v[92:95], v[28:31], a[156:159]
    s_waitcnt lgkmcnt(2)
    v_cvt_pk_bf16_f32 v172, v16, v17
    s_sub_u32 s3, s29, 147456
    v_mfma_f32_16x16x32_bf16 a[16:19], v[64:67], v[32:35], a[16:19]
    s_add_u32 s32, s32, 24576
    ds_read_b128 v[24:27], v1 offset:6144
    v_mfma_f32_16x16x32_bf16 a[16:19], v[80:83], v[36:39], a[16:19]
    s_min_u32 s29, s29, s3
    v_exp_f32 v16, v108
    v_mfma_f32_16x16x32_bf16 a[64:67], v[68:71], v[32:35], a[64:67]
    v_add_f32 v8, v8, v18
    v_add_f32 v8, v8, v19
    v_mfma_f32_16x16x32_bf16 a[64:67], v[84:87], v[36:39], a[64:67]
    v_exp_f32 v17, v109
    v_mfma_f32_16x16x32_bf16 a[112:115], v[72:75], v[32:35], a[112:115]
    s_add_u32 s26, s26, 12288
    ds_read_b128 v[28:31], v1 offset:18432
    v_mfma_f32_16x16x32_bf16 a[112:115], v[88:91], v[36:39], a[112:115]
    v_cvt_pk_bf16_f32 v173, v18, v19
    v_mfma_f32_16x16x32_bf16 a[160:163], v[76:79], v[32:35], a[160:163]
    v_exp_f32 v18, v110
    v_mfma_f32_16x16x32_bf16 a[160:163], v[92:95], v[36:39], a[160:163]
    s_waitcnt lgkmcnt(2)
    v_add_f32 v8, v8, v16
    v_mfma_f32_16x16x32_bf16 a[20:23], v[64:67], v[40:43], a[20:23]
    s_sub_u32 s3, s29, s28
    ds_read_b128 v[32:35], v1 offset:7168
    v_add_f32 v8, v8, v17
    v_mfma_f32_16x16x32_bf16 a[20:23], v[80:83], v[44:47], a[20:23]
    v_exp_f32 v19, v111
    v_mfma_f32_16x16x32_bf16 a[68:71], v[68:71], v[40:43], a[68:71]
    s_mov_b32 m0, s26
    v_mfma_f32_16x16x32_bf16 a[68:71], v[84:87], v[44:47], a[68:71]
    v_cvt_pk_bf16_f32 v174, v16, v17
    v_mfma_f32_16x16x32_bf16 a[116:119], v[72:75], v[40:43], a[116:119]
    ds_read_b128 v[36:39], v1 offset:19456
    v_add_f32 v8, v8, v18
    v_mfma_f32_16x16x32_bf16 a[116:119], v[88:91], v[44:47], a[116:119]
    v_add_f32 v8, v8, v19
    v_cvt_pk_bf16_f32 v175, v18, v19
    v_mfma_f32_16x16x32_bf16 a[164:167], v[76:79], v[40:43], a[164:167]
    s_mov_b32 s28, s29
    v_mfma_f32_16x16x32_bf16 a[164:167], v[92:95], v[44:47], a[164:167]
    s_waitcnt lgkmcnt(2)
    v_exp_f32 v16, v176
    v_mfma_f32_16x16x32_bf16 a[24:27], v[64:67], v[24:27], a[24:27]
    ds_read_b128 v[40:43], v1 offset:8192
    v_mfma_f32_16x16x32_bf16 a[24:27], v[80:83], v[28:31], a[24:27]
    v_exp_f32 v17, v177
    v_mfma_f32_16x16x32_bf16 a[72:75], v[68:71], v[24:27], a[72:75]
    v_exp_f32 v18, v178
    v_mfma_f32_16x16x32_bf16 a[72:75], v[84:87], v[28:31], a[72:75]
    buffer_load_dwordx4 v4, s[4:7], s32 offen offset:0 sc1 lds
    v_mfma_f32_16x16x32_bf16 a[120:123], v[72:75], v[24:27], a[120:123]
    ds_read_b128 v[44:47], v1 offset:20480
    v_add_f32 v5, v5, v16
    v_mfma_f32_16x16x32_bf16 a[120:123], v[88:91], v[28:31], a[120:123]
    v_add_f32 v5, v5, v17
    v_add_u32 v2, s3, v2
    v_mfma_f32_16x16x32_bf16 a[168:171], v[76:79], v[24:27], a[168:171]
    v_exp_f32 v19, v179
    v_mfma_f32_16x16x32_bf16 a[168:171], v[92:95], v[28:31], a[168:171]
    s_waitcnt lgkmcnt(2)
    v_cvt_pk_bf16_f32 v176, v16, v17
    v_mfma_f32_16x16x32_bf16 a[28:31], v[64:67], v[32:35], a[28:31]
    ds_read_b128 v[24:27], v1 offset:9216
    v_mfma_f32_16x16x32_bf16 a[28:31], v[80:83], v[36:39], a[28:31]
    v_exp_f32 v16, v112
    v_mfma_f32_16x16x32_bf16 a[76:79], v[68:71], v[32:35], a[76:79]
    v_add_f32 v5, v5, v18
    v_add_f32 v5, v5, v19
    v_mfma_f32_16x16x32_bf16 a[76:79], v[84:87], v[36:39], a[76:79]
    v_exp_f32 v17, v113
    v_mfma_f32_16x16x32_bf16 a[124:127], v[72:75], v[32:35], a[124:127]
    ds_read_b128 v[28:31], v1 offset:21504
    v_add_u32 v3, s3, v3
    v_mfma_f32_16x16x32_bf16 a[124:127], v[88:91], v[36:39], a[124:127]
    v_cvt_pk_bf16_f32 v177, v18, v19
    v_mfma_f32_16x16x32_bf16 a[172:175], v[76:79], v[32:35], a[172:175]
    v_exp_f32 v18, v114
    v_mfma_f32_16x16x32_bf16 a[172:175], v[92:95], v[36:39], a[172:175]
    s_waitcnt lgkmcnt(2)
    buffer_load_dwordx4 v4, s[4:7], s32 offen offset:1024 sc1 lds
    v_mfma_f32_16x16x32_bf16 a[32:35], v[64:67], v[40:43], a[32:35]
    ds_read_b128 v[32:35], v1 offset:10240
    v_add_f32 v5, v5, v16
    v_mfma_f32_16x16x32_bf16 a[32:35], v[80:83], v[44:47], a[32:35]
    v_add_f32 v5, v5, v17
    v_mfma_f32_16x16x32_bf16 a[80:83], v[68:71], v[40:43], a[80:83]
    v_exp_f32 v19, v115
    v_mfma_f32_16x16x32_bf16 a[80:83], v[84:87], v[44:47], a[80:83]
    v_cvt_pk_bf16_f32 v178, v16, v17
    v_mfma_f32_16x16x32_bf16 a[128:131], v[72:75], v[40:43], a[128:131]
    ds_read_b128 v[36:39], v1 offset:22528
    v_mfma_f32_16x16x32_bf16 a[128:131], v[88:91], v[44:47], a[128:131]
    v_exp_f32 v16, v180
    v_mfma_f32_16x16x32_bf16 a[176:179], v[76:79], v[40:43], a[176:179]
    v_add_f32 v5, v5, v18
    v_add_f32 v5, v5, v19
    v_mfma_f32_16x16x32_bf16 a[176:179], v[92:95], v[44:47], a[176:179]
    s_waitcnt lgkmcnt(2)
    v_exp_f32 v17, v181
    v_mfma_f32_16x16x32_bf16 a[36:39], v[64:67], v[24:27], a[36:39]
    ds_read_b128 v[40:43], v1 offset:11264
    v_mfma_f32_16x16x32_bf16 a[36:39], v[80:83], v[28:31], a[36:39]
    buffer_load_dwordx4 v4, s[4:7], s32 offen offset:2048 sc1 lds
    v_mfma_f32_16x16x32_bf16 a[84:87], v[68:71], v[24:27], a[84:87]
    v_cvt_pk_bf16_f32 v179, v18, v19
    v_mfma_f32_16x16x32_bf16 a[84:87], v[84:87], v[28:31], a[84:87]
    v_exp_f32 v18, v182
    v_mfma_f32_16x16x32_bf16 a[132:135], v[72:75], v[24:27], a[132:135]
    ds_read_b128 v[44:47], v1 offset:23552
    v_add_f32 v6, v6, v16
    v_mfma_f32_16x16x32_bf16 a[132:135], v[88:91], v[28:31], a[132:135]
    s_waitcnt lgkmcnt(2)
    v_add_f32 v6, v6, v17
    v_mfma_f32_16x16x32_bf16 a[180:183], v[76:79], v[24:27], a[180:183]
    s_waitcnt vmcnt(7)
    v_exp_f32 v19, v183
    v_mfma_f32_16x16x32_bf16 a[180:183], v[92:95], v[28:31], a[180:183]
    s_barrier
    v_mfma_f32_16x16x32_bf16 a[40:43], v[64:67], v[32:35], a[40:43]
    ds_read_b128 v[24:27], v2 offset:0
    v_cvt_pk_bf16_f32 v180, v16, v17
    v_mfma_f32_16x16x32_bf16 a[40:43], v[80:83], v[36:39], a[40:43]
    v_exp_f32 v16, v116
    v_mfma_f32_16x16x32_bf16 a[88:91], v[68:71], v[32:35], a[88:91]
    v_add_f32 v6, v6, v18
    v_add_f32 v6, v6, v19
    v_mfma_f32_16x16x32_bf16 a[88:91], v[84:87], v[36:39], a[88:91]
    v_exp_f32 v17, v117
    v_mfma_f32_16x16x32_bf16 a[136:139], v[72:75], v[32:35], a[136:139]
    ds_read_b128 v[28:31], v3 offset:0
    v_mfma_f32_16x16x32_bf16 a[136:139], v[88:91], v[36:39], a[136:139]
    v_cvt_pk_bf16_f32 v181, v18, v19
    v_mfma_f32_16x16x32_bf16 a[184:187], v[76:79], v[32:35], a[184:187]
    v_exp_f32 v18, v118
    v_mfma_f32_16x16x32_bf16 a[184:187], v[92:95], v[36:39], a[184:187]
    s_waitcnt lgkmcnt(2)
    v_add_f32 v6, v6, v16
    v_mfma_f32_16x16x32_bf16 a[44:47], v[64:67], v[40:43], a[44:47]
    ds_read_b128 v[32:35], v2 offset:6144
    v_add_f32 v6, v6, v17
    v_mfma_f32_16x16x32_bf16 a[44:47], v[80:83], v[44:47], a[44:47]
    v_exp_f32 v19, v119
    v_mfma_f32_16x16x32_bf16 a[92:95], v[68:71], v[40:43], a[92:95]
    v_mfma_f32_16x16x32_bf16 a[92:95], v[84:87], v[44:47], a[92:95]
    s_add_u32 s32, s32, 24576
    s_add_u32 s26, s26, 36864
    v_cvt_pk_bf16_f32 v182, v16, v17
    v_mfma_f32_16x16x32_bf16 a[140:143], v[72:75], v[40:43], a[140:143]
    s_sub_u32 s57, s26, 147456
    ds_read_b128 v[36:39], v3 offset:6144
    v_add_f32 v6, v6, v18
    v_mfma_f32_16x16x32_bf16 a[140:143], v[88:91], v[44:47], a[140:143]
    s_min_u32 s26, s26, s57
    v_add_f32 v6, v6, v19
    v_cvt_pk_bf16_f32 v183, v18, v19
    v_mfma_f32_16x16x32_bf16 a[188:191], v[76:79], v[40:43], a[188:191]
    v_mfma_f32_16x16x32_bf16 a[188:191], v[92:95], v[44:47], a[188:191]
    s_waitcnt lgkmcnt(2)
    v_mfma_f32_16x16x32_bf16 v[64:67], v[24:27], a[192:195], v[128:131]
    ds_read_b128 v[40:43], v2 offset:128
    v_mfma_f32_16x16x32_bf16 v[64:67], v[28:31], a[196:199], v[64:67]
    v_exp_f32 v16, v184
    v_mfma_f32_16x16x32_bf16 v[68:71], v[24:27], a[216:219], v[132:135]
    v_exp_f32 v17, v185
    v_mfma_f32_16x16x32_bf16 v[68:71], v[28:31], a[220:223], v[68:71]
    buffer_load_dword v52, v20, s[20:23], s44 offen sc1
    v_mfma_f32_16x16x32_bf16 v[72:75], v[24:27], a[240:243], v[136:139]
    ds_read_b128 v[44:47], v3 offset:128
    v_mfma_f32_16x16x32_bf16 v[72:75], v[28:31], a[244:247], v[72:75]
    v_exp_f32 v18, v186
    v_mfma_f32_16x16x32_bf16 v[76:79], v[24:27], v[200:203], v[140:143]
    v_add_f32 v7, v7, v16
    v_add_f32 v7, v7, v17
    v_mfma_f32_16x16x32_bf16 v[76:79], v[28:31], v[204:207], v[76:79]
    s_waitcnt lgkmcnt(2)
    v_exp_f32 v19, v187
    v_mfma_f32_16x16x32_bf16 v[96:99], v[32:35], a[192:195], v[128:131]
    ds_read_b128 v[24:27], v2 offset:6272
    v_cvt_pk_bf16_f32 v184, v16, v17
    v_mfma_f32_16x16x32_bf16 v[96:99], v[36:39], a[196:199], v[96:99]
    v_exp_f32 v16, v120
    v_mfma_f32_16x16x32_bf16 v[100:103], v[32:35], a[216:219], v[132:135]
    v_add_f32 v7, v7, v18
    v_add_f32 v7, v7, v19
    v_mfma_f32_16x16x32_bf16 v[100:103], v[36:39], a[220:223], v[100:103]
    s_mov_b32 m0, s26
    v_exp_f32 v17, v121
    v_mfma_f32_16x16x32_bf16 v[104:107], v[32:35], a[240:243], v[136:139]
    ds_read_b128 v[28:31], v3 offset:6272
    v_mfma_f32_16x16x32_bf16 v[104:107], v[36:39], a[244:247], v[104:107]
    buffer_load_dwordx4 v4, s[4:7], s32 offen offset:0 sc1 lds
    v_mfma_f32_16x16x32_bf16 v[108:111], v[32:35], v[200:203], v[140:143]
    v_cvt_pk_bf16_f32 v185, v18, v19
    v_mfma_f32_16x16x32_bf16 v[108:111], v[36:39], v[204:207], v[108:111]
    s_waitcnt lgkmcnt(2)
    v_exp_f32 v18, v122
    v_mfma_f32_16x16x32_bf16 v[64:67], v[40:43], a[200:203], v[64:67]
    ds_read_b128 v[32:35], v2 offset:256
    v_add_f32 v7, v7, v16
    v_mfma_f32_16x16x32_bf16 v[64:67], v[44:47], a[204:207], v[64:67]
    v_add_f32 v7, v7, v17
    v_mfma_f32_16x16x32_bf16 v[68:71], v[40:43], a[224:227], v[68:71]
    v_exp_f32 v19, v123
    v_mfma_f32_16x16x32_bf16 v[68:71], v[44:47], a[228:231], v[68:71]
    v_cvt_pk_bf16_f32 v186, v16, v17
    v_mfma_f32_16x16x32_bf16 v[72:75], v[40:43], a[248:251], v[72:75]
    ds_read_b128 v[36:39], v3 offset:256
    v_mfma_f32_16x16x32_bf16 v[72:75], v[44:47], a[252:255], v[72:75]
    buffer_load_dwordx4 v4, s[4:7], s32 offen offset:1024 sc1 lds
    v_mfma_f32_16x16x32_bf16 v[76:79], v[40:43], v[208:211], v[76:79]
    v_exp_f32 v16, v188
    v_mfma_f32_16x16x32_bf16 v[76:79], v[44:47], v[212:215], v[76:79]
    s_waitcnt lgkmcnt(2)
    v_add_f32 v7, v7, v18
    v_add_f32 v7, v7, v19
    v_mfma_f32_16x16x32_bf16 v[96:99], v[24:27], a[200:203], v[96:99]
    ds_read_b128 v[40:43], v2 offset:6400
    v_mfma_f32_16x16x32_bf16 v[96:99], v[28:31], a[204:207], v[96:99]
    v_exp_f32 v17, v189
    v_mfma_f32_16x16x32_bf16 v[100:103], v[24:27], a[224:227], v[100:103]
    v_cvt_pk_bf16_f32 v187, v18, v19
    v_mfma_f32_16x16x32_bf16 v[100:103], v[28:31], a[228:231], v[100:103]
    v_exp_f32 v18, v190
    v_mfma_f32_16x16x32_bf16 v[104:107], v[24:27], a[248:251], v[104:107]
    ds_read_b128 v[44:47], v3 offset:6400
    v_add_f32 v8, v8, v16
    v_mfma_f32_16x16x32_bf16 v[104:107], v[28:31], a[252:255], v[104:107]
    v_add_f32 v8, v8, v17
    v_mfma_f32_16x16x32_bf16 v[108:111], v[24:27], v[208:211], v[108:111]
    s_add_u32 s29, s30, 49152
    v_exp_f32 v19, v191
    v_mfma_f32_16x16x32_bf16 v[108:111], v[28:31], v[212:215], v[108:111]
    s_waitcnt lgkmcnt(2)
    buffer_load_dwordx4 v4, s[4:7], s32 offen offset:2048 sc1 lds
    v_mfma_f32_16x16x32_bf16 v[64:67], v[32:35], a[208:211], v[64:67]
    s_sub_u32 s3, s29, 147456
    ds_read_b128 v[24:27], v2 offset:12288
    v_cvt_pk_bf16_f32 v188, v16, v17
    v_mfma_f32_16x16x32_bf16 v[64:67], v[36:39], a[212:215], v[64:67]
    s_min_u32 s29, s29, s3
    v_exp_f32 v16, v124
    v_mfma_f32_16x16x32_bf16 v[68:71], v[32:35], a[232:235], v[68:71]
    v_add_f32 v8, v8, v18
    v_add_f32 v8, v8, v19
    v_mfma_f32_16x16x32_bf16 v[68:71], v[36:39], a[236:239], v[68:71]
    v_exp_f32 v17, v125
    v_mfma_f32_16x16x32_bf16 v[72:75], v[32:35], v[192:195], v[72:75]
    ds_read_b128 v[28:31], v3 offset:12288
    v_mfma_f32_16x16x32_bf16 v[72:75], v[36:39], v[196:199], v[72:75]
    v_cvt_pk_bf16_f32 v189, v18, v19
    v_mfma_f32_16x16x32_bf16 v[76:79], v[32:35], v[216:219], v[76:79]
    v_exp_f32 v18, v126
    v_mfma_f32_16x16x32_bf16 v[76:79], v[36:39], v[220:223], v[76:79]
    s_waitcnt lgkmcnt(2)
    v_add_f32 v8, v8, v16
    s_add_u32 s32, s32, 24576
    v_mfma_f32_16x16x32_bf16 v[96:99], v[40:43], a[208:211], v[96:99]
    ds_read_b128 v[32:35], v2 offset:18432
    v_add_f32 v8, v8, v17
    v_mfma_f32_16x16x32_bf16 v[96:99], v[44:47], a[212:215], v[96:99]
    s_sub_u32 s3, s29, s30
    v_exp_f32 v19, v127
    v_mfma_f32_16x16x32_bf16 v[100:103], v[40:43], a[232:235], v[100:103]
    v_mfma_f32_16x16x32_bf16 v[100:103], v[44:47], a[236:239], v[100:103]
    v_cvt_pk_bf16_f32 v190, v16, v17
    v_mfma_f32_16x16x32_bf16 v[104:107], v[40:43], v[192:195], v[104:107]
    s_add_u32 s26, s26, 12288
    ds_read_b128 v[36:39], v3 offset:18432
    v_add_f32 v8, v8, v18
    v_mfma_f32_16x16x32_bf16 v[104:107], v[44:47], v[196:199], v[104:107]
    v_add_f32 v8, v8, v19
    v_cvt_pk_bf16_f32 v191, v18, v19
    v_mfma_f32_16x16x32_bf16 v[108:111], v[40:43], v[216:219], v[108:111]
    v_mfma_f32_16x16x32_bf16 v[108:111], v[44:47], v[220:223], v[108:111]
    s_waitcnt lgkmcnt(2)
    v_exp_f32 v16, v64
    v_mfma_f32_16x16x32_bf16 v[80:83], v[24:27], a[192:195], v[128:131]
    ds_read_b128 v[40:43], v2 offset:12416
    v_mfma_f32_16x16x32_bf16 v[80:83], v[28:31], a[196:199], v[80:83]
    s_mov_b32 m0, s26
    v_exp_f32 v17, v65
    v_mfma_f32_16x16x32_bf16 v[84:87], v[24:27], a[216:219], v[132:135]
    s_mov_b32 s30, s29
    v_exp_f32 v18, v66
    v_mfma_f32_16x16x32_bf16 v[84:87], v[28:31], a[220:223], v[84:87]
    v_add_f32 v5, v5, v16
    v_mfma_f32_16x16x32_bf16 v[88:91], v[24:27], a[240:243], v[136:139]
    ds_read_b128 v[44:47], v3 offset:12416
    v_add_f32 v5, v5, v17
    v_mfma_f32_16x16x32_bf16 v[88:91], v[28:31], a[244:247], v[88:91]
    v_exp_f32 v19, v67
    v_mfma_f32_16x16x32_bf16 v[92:95], v[24:27], v[200:203], v[140:143]
    v_mfma_f32_16x16x32_bf16 v[92:95], v[28:31], v[204:207], v[92:95]
    s_waitcnt lgkmcnt(2)
    v_cvt_pk_bf16_f32 v64, v16, v17
    v_mfma_f32_16x16x32_bf16 v[112:115], v[32:35], a[192:195], v[128:131]
    ds_read_b128 v[24:27], v2 offset:18560
    v_mfma_f32_16x16x32_bf16 v[112:115], v[36:39], a[196:199], v[112:115]
    buffer_load_dwordx4 v4, s[4:7], s32 offen offset:0 sc1 lds
    v_mfma_f32_16x16x32_bf16 v[116:119], v[32:35], a[216:219], v[132:135]
    v_exp_f32 v16, v96
    v_mfma_f32_16x16x32_bf16 v[116:119], v[36:39], a[220:223], v[116:119]
    v_add_f32 v5, v5, v18
    v_add_f32 v5, v5, v19
    v_mfma_f32_16x16x32_bf16 v[120:123], v[32:35], a[240:243], v[136:139]
    ds_read_b128 v[28:31], v3 offset:18560
    v_add_u32 v1, s3, v1
    v_mfma_f32_16x16x32_bf16 v[120:123], v[36:39], a[244:247], v[120:123]
    v_exp_f32 v17, v97
    v_mfma_f32_16x16x32_bf16 v[124:127], v[32:35], v[200:203], v[140:143]
    v_cvt_pk_bf16_f32 v65, v18, v19
    v_mfma_f32_16x16x32_bf16 v[124:127], v[36:39], v[204:207], v[124:127]
    s_waitcnt lgkmcnt(2)
    v_exp_f32 v18, v98
    v_mfma_f32_16x16x32_bf16 v[80:83], v[40:43], a[200:203], v[80:83]
    ds_read_b128 v[32:35], v2 offset:12544
    v_add_f32 v5, v5, v16
    v_mfma_f32_16x16x32_bf16 v[80:83], v[44:47], a[204:207], v[80:83]
    v_add_f32 v5, v5, v17
    v_mfma_f32_16x16x32_bf16 v[84:87], v[40:43], a[224:227], v[84:87]
    v_exp_f32 v19, v99
    v_mfma_f32_16x16x32_bf16 v[84:87], v[44:47], a[228:231], v[84:87]
    buffer_load_dwordx4 v4, s[4:7], s32 offen offset:1024 sc1 lds
    v_mfma_f32_16x16x32_bf16 v[88:91], v[40:43], a[248:251], v[88:91]
    ds_read_b128 v[36:39], v3 offset:12544
    v_cvt_pk_bf16_f32 v66, v16, v17
    v_mfma_f32_16x16x32_bf16 v[88:91], v[44:47], a[252:255], v[88:91]
    v_exp_f32 v16, v68
    v_mfma_f32_16x16x32_bf16 v[92:95], v[40:43], v[208:211], v[92:95]
    v_add_f32 v5, v5, v18
    v_add_f32 v5, v5, v19
    v_mfma_f32_16x16x32_bf16 v[92:95], v[44:47], v[212:215], v[92:95]
    s_waitcnt lgkmcnt(2)
    v_exp_f32 v17, v69
    v_mfma_f32_16x16x32_bf16 v[112:115], v[24:27], a[200:203], v[112:115]
    ds_read_b128 v[40:43], v2 offset:18688
    v_mfma_f32_16x16x32_bf16 v[112:115], v[28:31], a[204:207], v[112:115]
    v_cvt_pk_bf16_f32 v67, v18, v19
    v_mfma_f32_16x16x32_bf16 v[116:119], v[24:27], a[224:227], v[116:119]
    v_exp_f32 v18, v70
    v_mfma_f32_16x16x32_bf16 v[116:119], v[28:31], a[228:231], v[116:119]
    v_add_f32 v6, v6, v16
    v_mfma_f32_16x16x32_bf16 v[120:123], v[24:27], a[248:251], v[120:123]
    ds_read_b128 v[44:47], v3 offset:18688
    v_add_f32 v6, v6, v17
    v_mfma_f32_16x16x32_bf16 v[120:123], v[28:31], a[252:255], v[120:123]
    s_waitcnt lgkmcnt(2)
    buffer_load_dwordx4 v4, s[4:7], s32 offen offset:2048 sc1 lds
    v_mfma_f32_16x16x32_bf16 v[124:127], v[24:27], v[208:211], v[124:127]
    s_waitcnt vmcnt(7)
    v_exp_f32 v19, v71
    v_mfma_f32_16x16x32_bf16 v[124:127], v[28:31], v[212:215], v[124:127]
    s_barrier
    v_mfma_f32_16x16x32_bf16 v[80:83], v[32:35], a[208:211], v[80:83]
    ds_read_b128 v[24:27], v1 offset:0
    v_cvt_pk_bf16_f32 v68, v16, v17
    v_mfma_f32_16x16x32_bf16 v[80:83], v[36:39], a[212:215], v[80:83]
    v_exp_f32 v16, v100
    v_mfma_f32_16x16x32_bf16 v[84:87], v[32:35], a[232:235], v[84:87]
    v_add_f32 v6, v6, v18
    v_add_f32 v6, v6, v19
    v_mfma_f32_16x16x32_bf16 v[84:87], v[36:39], a[236:239], v[84:87]
    v_exp_f32 v17, v101
    v_mfma_f32_16x16x32_bf16 v[88:91], v[32:35], v[192:195], v[88:91]
    ds_read_b128 v[28:31], v1 offset:12288
    v_mfma_f32_16x16x32_bf16 v[88:91], v[36:39], v[196:199], v[88:91]
    v_cvt_pk_bf16_f32 v69, v18, v19
    v_mfma_f32_16x16x32_bf16 v[92:95], v[32:35], v[216:219], v[92:95]
    v_exp_f32 v18, v102
    v_mfma_f32_16x16x32_bf16 v[92:95], v[36:39], v[220:223], v[92:95]
    s_waitcnt lgkmcnt(2)
    v_add_f32 v6, v6, v16
    v_mfma_f32_16x16x32_bf16 v[112:115], v[40:43], a[208:211], v[112:115]
    ds_read_b128 v[32:35], v1 offset:1024
    v_add_f32 v6, v6, v17
    v_mfma_f32_16x16x32_bf16 v[112:115], v[44:47], a[212:215], v[112:115]
    v_exp_f32 v19, v103
    v_mfma_f32_16x16x32_bf16 v[116:119], v[40:43], a[232:235], v[116:119]
    v_mfma_f32_16x16x32_bf16 v[116:119], v[44:47], a[236:239], v[116:119]
    v_cvt_pk_bf16_f32 v70, v16, v17
    v_mfma_f32_16x16x32_bf16 v[120:123], v[40:43], v[192:195], v[120:123]
    ds_read_b128 v[36:39], v1 offset:13312
    v_add_f32 v6, v6, v18
    v_mfma_f32_16x16x32_bf16 v[120:123], v[44:47], v[196:199], v[120:123]
    s_add_u32 s32, s32, 24576
    s_add_u32 s26, s26, 36864
    v_add_f32 v6, v6, v19
    v_mfma_f32_16x16x32_bf16 v[124:127], v[40:43], v[216:219], v[124:127]
    s_sub_u32 s57, s26, 147456
    v_cvt_pk_bf16_f32 v71, v18, v19
    s_min_u32 s26, s26, s57
    v_mfma_f32_16x16x32_bf16 v[124:127], v[44:47], v[220:223], v[124:127]
    s_waitcnt lgkmcnt(2)
    v_mfma_f32_16x16x32_bf16 a[0:3], v[160:163], v[24:27], a[0:3]
    ds_read_b128 v[40:43], v1 offset:2048
    v_mfma_f32_16x16x32_bf16 a[0:3], v[176:179], v[28:31], a[0:3]
    s_waitcnt vmcnt(6)
    v_subrev_u32 v52, s92, v52
    v_cmp_lt_u32 vcc, 15, v52
    v_mfma_f32_16x16x32_bf16 a[48:51], v[164:167], v[24:27], a[48:51]
    v_exp_f32 v16, v72
    v_mfma_f32_16x16x32_bf16 a[48:51], v[180:183], v[28:31], a[48:51]
    v_exp_f32 v17, v73
    v_mfma_f32_16x16x32_bf16 a[96:99], v[168:171], v[24:27], a[96:99]
    s_and_b32 s59, vcc_lo, 0xff
    ds_read_b128 v[44:47], v1 offset:14336
    v_mfma_f32_16x16x32_bf16 a[96:99], v[184:187], v[28:31], a[96:99]
    s_cbranch_scc1 L_pollslow4
L_pollok4:
    v_mfma_f32_16x16x32_bf16 a[144:147], v[172:175], v[24:27], a[144:147]
    s_add_u32 s92, s92, 1
    v_exp_f32 v18, v74
    v_mfma_f32_16x16x32_bf16 a[144:147], v[188:191], v[28:31], a[144:147]
    s_waitcnt lgkmcnt(2)
    v_add_f32 v7, v7, v16
    v_add_f32 v7, v7, v17
    v_mfma_f32_16x16x32_bf16 a[4:7], v[160:163], v[32:35], a[4:7]
    ds_read_b128 v[24:27], v1 offset:3072
    v_mfma_f32_16x16x32_bf16 a[4:7], v[176:179], v[36:39], a[4:7]
    v_exp_f32 v19, v75
    v_mfma_f32_16x16x32_bf16 a[52:55], v[164:167], v[32:35], a[52:55]
    v_cvt_pk_bf16_f32 v72, v16, v17
    v_mfma_f32_16x16x32_bf16 a[52:55], v[180:183], v[36:39], a[52:55]
    v_exp_f32 v16, v104
    v_mfma_f32_16x16x32_bf16 a[100:103], v[168:171], v[32:35], a[100:103]
    ds_read_b128 v[28:31], v1 offset:15360
    v_add_f32 v7, v7, v18
    v_mfma_f32_16x16x32_bf16 a[100:103], v[184:187], v[36:39], a[100:103]
    s_waitcnt lgkmcnt(2)
    v_add_f32 v7, v7, v19
    v_mfma_f32_16x16x32_bf16 a[148:151], v[172:175], v[32:35], a[148:151]
    s_waitcnt vmcnt(0)
    v_exp_f32 v17, v105
    v_mfma_f32_16x16x32_bf16 a[148:151], v[188:191], v[36:39], a[148:151]
    s_barrier
    v_mfma_f32_16x16x32_bf16 a[8:11], v[160:163], v[40:43], a[8:11]
    s_mov_b32 m0, s56
    ds_read_b128 v[32:35], v1 offset:4096
    v_cvt_pk_bf16_f32 v73, v18, v19
    v_mfma_f32_16x16x32_bf16 a[8:11], v[176:179], v[44:47], a[8:11]
    buffer_load_dwordx4 v4, s[4:7], s27 offen offset:0 sc1 lds
    v_mfma_f32_16x16x32_bf16 a[56:59], v[164:167], v[40:43], a[56:59]
    v_exp_f32 v18, v106
    v_mfma_f32_16x16x32_bf16 a[56:59], v[180:183], v[44:47], a[56:59]
    v_add_f32 v7, v7, v16
    v_add_f32 v7, v7, v17
    v_mfma_f32_16x16x32_bf16 a[104:107], v[168:171], v[40:43], a[104:107]
    ds_read_b128 v[36:39], v1 offset:16384
    v_mfma_f32_16x16x32_bf16 a[104:107], v[184:187], v[44:47], a[104:107]
    buffer_load_dwordx4 v4, s[4:7], s27 offen offset:1024 sc1 lds
    v_mfma_f32_16x16x32_bf16 a[152:155], v[172:175], v[40:43], a[152:155]
    v_exp_f32 v19, v107
    v_mfma_f32_16x16x32_bf16 a[152:155], v[188:191], v[44:47], a[152:155]
    s_waitcnt lgkmcnt(2)
    v_cvt_pk_bf16_f32 v74, v16, v17
    v_mfma_f32_16x16x32_bf16 a[12:15], v[160:163], v[24:27], a[12:15]
    ds_read_b128 v[40:43], v1 offset:5120
    v_mfma_f32_16x16x32_bf16 a[12:15], v[176:179], v[28:31], a[12:15]
    buffer_load_dwordx4 v4, s[4:7], s27 offen offset:2048 sc1 lds
    v_mfma_f32_16x16x32_bf16 a[60:63], v[164:167], v[24:27], a[60:63]
    v_exp_f32 v16, v76
    v_mfma_f32_16x16x32_bf16 a[60:63], v[180:183], v[28:31], a[60:63]
    s_add_u32 s27, s27, 24576
    v_add_f32 v7, v7, v18
    v_add_f32 v7, v7, v19
    v_mfma_f32_16x16x32_bf16 a[108:111], v[168:171], v[24:27], a[108:111]
    ds_read_b128 v[44:47], v1 offset:17408
    v_mfma_f32_16x16x32_bf16 a[108:111], v[184:187], v[28:31], a[108:111]
    s_add_u32 s56, s56, 12288
    v_exp_f32 v17, v77
    v_mfma_f32_16x16x32_bf16 a[156:159], v[172:175], v[24:27], a[156:159]
    s_add_u32 s29, s28, 49152
    v_cvt_pk_bf16_f32 v75, v18, v19
    v_mfma_f32_16x16x32_bf16 a[156:159], v[188:191], v[28:31], a[156:159]
    s_waitcnt lgkmcnt(2)
    v_exp_f32 v18, v78
    v_mfma_f32_16x16x32_bf16 a[16:19], v[160:163], v[32:35], a[16:19]
    s_sub_u32 s3, s29, 147456
    ds_read_b128 v[24:27], v1 offset:6144
    v_add_f32 v8, v8, v16
    v_mfma_f32_16x16x32_bf16 a[16:19], v[176:179], v[36:39], a[16:19]
    s_mov_b32 m0, s56
    v_add_f32 v8, v8, v17
    s_min_u32 s29, s29, s3
    v_mfma_f32_16x16x32_bf16 a[64:67], v[164:167], v[32:35], a[64:67]
    v_exp_f32 v19, v79
    v_mfma_f32_16x16x32_bf16 a[64:67], v[180:183], v[36:39], a[64:67]
    buffer_load_dwordx4 v4, s[4:7], s27 offen offset:0 sc1 lds
    v_mfma_f32_16x16x32_bf16 a[112:115], v[168:171], v[32:35], a[112:115]
    ds_read_b128 v[28:31], v1 offset:18432
    v_cvt_pk_bf16_f32 v76, v16, v17
    v_mfma_f32_16x16x32_bf16 a[112:115], v[184:187], v[36:39], a[112:115]
    v_exp_f32 v16, v108
    v_mfma_f32_16x16x32_bf16 a[160:163], v[172:175], v[32:35], a[160:163]
    v_add_f32 v8, v8, v18
    v_add_f32 v8, v8, v19
    v_mfma_f32_16x16x32_bf16 a[160:163], v[188:191], v[36:39], a[160:163]
    s_waitcnt lgkmcnt(2)
    buffer_load_dwordx4 v4, s[4:7], s27 offen offset:1024 sc1 lds
    v_mfma_f32_16x16x32_bf16 a[20:23], v[160:163], v[40:43], a[20:23]
    s_sub_u32 s3, s29, s28
    ds_read_b128 v[32:35], v1 offset:7168
    v_mfma_f32_16x16x32_bf16 a[20:23], v[176:179], v[44:47], a[20:23]
    v_exp_f32 v17, v109
    v_mfma_f32_16x16x32_bf16 a[68:71], v[164:167], v[40:43], a[68:71]
    v_cvt_pk_bf16_f32 v77, v18, v19
    v_mfma_f32_16x16x32_bf16 a[68:71], v[180:183], v[44:47], a[68:71]
    buffer_load_dwordx4 v4, s[4:7], s27 offen offset:2048 sc1 lds
    v_mfma_f32_16x16x32_bf16 a[116:119], v[168:171], v[40:43], a[116:119]
    ds_read_b128 v[36:39], v1 offset:19456
    v_mfma_f32_16x16x32_bf16 a[116:119], v[184:187], v[44:47], a[116:119]
L_pg10:
    s_cbranch_execz L_iwret
    v_exp_f32 v18, v110
    v_mfma_f32_16x16x32_bf16 a[164:167], v[172:175], v[40:43], a[164:167]
    s_add_u32 s27, s27, 24576
    v_add_f32 v8, v8, v16
    v_add_f32 v8, v8, v17
    v_mfma_f32_16x16x32_bf16 a[164:167], v[188:191], v[44:47], a[164:167]
    s_waitcnt lgkmcnt(2)
    v_exp_f32 v19, v111
    v_mfma_f32_16x16x32_bf16 a[24:27], v[160:163], v[24:27], a[24:27]
    s_add_u32 s56, s56, 36864
    ds_read_b128 v[40:43], v1 offset:8192
    v_cvt_pk_bf16_f32 v78, v16, v17
    v_mfma_f32_16x16x32_bf16 a[24:27], v[176:179], v[28:31], a[24:27]
    s_mov_b32 s28, s29
    v_add_f32 v8, v8, v18
    v_add_f32 v8, v8, v19
    v_mfma_f32_16x16x32_bf16 a[72:75], v[164:167], v[24:27], a[72:75]
    s_sub_u32 s58, s56, 147456
    v_cvt_pk_bf16_f32 v79, v18, v19
    v_mfma_f32_16x16x32_bf16 a[72:75], v[180:183], v[28:31], a[72:75]
    v_exp_f32 v16, v80
    v_mfma_f32_16x16x32_bf16 a[120:123], v[168:171], v[24:27], a[120:123]
    s_min_u32 s56, s56, s58
    ds_read_b128 v[44:47], v1 offset:20480
    v_mfma_f32_16x16x32_bf16 a[120:123], v[184:187], v[28:31], a[120:123]
    v_exp_f32 v17, v81
    v_mfma_f32_16x16x32_bf16 a[168:171], v[172:175], v[24:27], a[168:171]
    s_mov_b32 m0, s26
    v_exp_f32 v18, v82
    v_mfma_f32_16x16x32_bf16 a[168:171], v[188:191], v[28:31], a[168:171]
    s_waitcnt lgkmcnt(2)
    v_add_f32 v5, v5, v16
    v_add_f32 v5, v5, v17
    v_mfma_f32_16x16x32_bf16 a[28:31], v[160:163], v[32:35], a[28:31]
    ds_read_b128 v[24:27], v1 offset:9216
    v_add_u32 v2, s3, v2
    v_mfma_f32_16x16x32_bf16 a[28:31], v[176:179], v[36:39], a[28:31]
    buffer_load_dwordx4 v4, s[4:7], s32 offen offset:0 sc1 lds
    v_mfma_f32_16x16x32_bf16 a[76:79], v[164:167], v[32:35], a[76:79]
    v_exp_f32 v19, v83
    v_mfma_f32_16x16x32_bf16 a[76:79], v[180:183], v[36:39], a[76:79]
    v_cvt_pk_bf16_f32 v80, v16, v17
    v_mfma_f32_16x16x32_bf16 a[124:127], v[168:171], v[32:35], a[124:127]
    ds_read_b128 v[28:31], v1 offset:21504
    v_add_u32 v3, s3, v3
    v_mfma_f32_16x16x32_bf16 a[124:127], v[184:187], v[36:39], a[124:127]
    buffer_load_dwordx4 v4, s[4:7], s32 offen offset:1024 sc1 lds
    v_mfma_f32_16x16x32_bf16 a[172:175], v[172:175], v[32:35], a[172:175]
    v_exp_f32 v16, v112
    v_mfma_f32_16x16x32_bf16 a[172:175], v[188:191], v[36:39], a[172:175]
    s_waitcnt lgkmcnt(2)
    v_add_f32 v5, v5, v18
    v_add_f32 v5, v5, v19
    v_mfma_f32_16x16x32_bf16 a[32:35], v[160:163], v[40:43], a[32:35]
    ds_read_b128 v[32:35], v1 offset:10240
    v_mfma_f32_16x16x32_bf16 a[32:35], v[176:179], v[44:47], a[32:35]
    buffer_load_dwordx4 v4, s[4:7], s32 offen offset:2048 sc1 lds
    v_mfma_f32_16x16x32_bf16 a[80:83], v[164:167], v[40:43], a[80:83]
    v_exp_f32 v17, v113
    v_mfma_f32_16x16x32_bf16 a[80:83], v[180:183], v[44:47], a[80:83]
    v_cvt_pk_bf16_f32 v81, v18, v19
    v_mfma_f32_16x16x32_bf16 a[128:131], v[168:171], v[40:43], a[128:131]
    ds_read_b128 v[36:39], v1 offset:22528
    v_mfma_f32_16x16x32_bf16 a[128:131], v[184:187], v[44:47], a[128:131]
    s_add_u32 s32, s32, 24576
    v_exp_f32 v18, v114
    v_mfma_f32_16x16x32_bf16 a[176:179], v[172:175], v[40:43], a[176:179]
    v_add_f32 v5, v5, v16
    v_add_f32 v5, v5, v17
    v_mfma_f32_16x16x32_bf16 a[176:179], v[188:191], v[44:47], a[176:179]
    s_waitcnt lgkmcnt(2)
    v_exp_f32 v19, v115
    v_mfma_f32_16x16x32_bf16 a[36:39], v[160:163], v[24:27], a[36:39]
    s_add_u32 s26, s26, 12288
    ds_read_b128 v[40:43], v1 offset:11264
    v_cvt_pk_bf16_f32 v82, v16, v17
    v_mfma_f32_16x16x32_bf16 a[36:39], v[176:179], v[28:31], a[36:39]
    s_mov_b32 m0, s26
    v_exp_f32 v16, v84
    v_mfma_f32_16x16x32_bf16 a[84:87], v[164:167], v[24:27], a[84:87]
    v_add_f32 v5, v5, v18
    v_add_f32 v5, v5, v19
    v_mfma_f32_16x16x32_bf16 a[84:87], v[180:183], v[28:31], a[84:87]
    v_exp_f32 v17, v85
    v_mfma_f32_16x16x32_bf16 a[132:135], v[168:171], v[24:27], a[132:135]
    ds_read_b128 v[44:47], v1 offset:23552
    v_cvt_pk_bf16_f32 v83, v18, v19
    v_mfma_f32_16x16x32_bf16 a[132:135], v[184:187], v[28:31], a[132:135]
    buffer_load_dwordx4 v4, s[4:7], s32 offen offset:0 sc1 lds
    v_mfma_f32_16x16x32_bf16 a[180:183], v[172:175], v[24:27], a[180:183]
    v_exp_f32 v18, v86
    v_mfma_f32_16x16x32_bf16 a[180:183], v[188:191], v[28:31], a[180:183]
    s_waitcnt lgkmcnt(2)
    v_add_f32 v6, v6, v16
    v_add_f32 v6, v6, v17
    v_mfma_f32_16x16x32_bf16 a[40:43], v[160:163], v[32:35], a[40:43]
    ds_read_b128 v[24:27], v2 offset:0
    v_mfma_f32_16x16x32_bf16 a[40:43], v[176:179], v[36:39], a[40:43]
    buffer_load_dwordx4 v4, s[4:7], s32 offen offset:1024 sc1 lds
    v_mfma_f32_16x16x32_bf16 a[88:91], v[164:167], v[32:35], a[88:91]
    v_exp_f32 v19, v87
    v_mfma_f32_16x16x32_bf16 a[88:91], v[180:183], v[36:39], a[88:91]
    v_cvt_pk_bf16_f32 v84, v16, v17
    v_mfma_f32_16x16x32_bf16 a[136:139], v[168:171], v[32:35], a[136:139]
    ds_read_b128 v[28:31], v3 offset:0
    v_mfma_f32_16x16x32_bf16 a[136:139], v[184:187], v[36:39], a[136:139]
    buffer_load_dwordx4 v4, s[4:7], s32 offen offset:2048 sc1 lds
    v_mfma_f32_16x16x32_bf16 a[184:187], v[172:175], v[32:35], a[184:187]
    v_exp_f32 v16, v116
    v_mfma_f32_16x16x32_bf16 a[184:187], v[188:191], v[36:39], a[184:187]
    s_waitcnt lgkmcnt(2)
    v_add_f32 v6, v6, v18
    v_add_f32 v6, v6, v19
    v_mfma_f32_16x16x32_bf16 a[44:47], v[160:163], v[40:43], a[44:47]
    ds_read_b128 v[32:35], v2 offset:6144
    v_mfma_f32_16x16x32_bf16 a[44:47], v[176:179], v[44:47], a[44:47]
    v_exp_f32 v17, v117
    v_mfma_f32_16x16x32_bf16 a[92:95], v[164:167], v[40:43], a[92:95]
    v_cvt_pk_bf16_f32 v85, v18, v19
    v_mfma_f32_16x16x32_bf16 a[92:95], v[180:183], v[44:47], a[92:95]
    s_add_u32 s32, s32, 24576
    v_exp_f32 v18, v118
    v_mfma_f32_16x16x32_bf16 a[140:143], v[168:171], v[40:43], a[140:143]
    s_add_u32 s26, s26, 36864
    ds_read_b128 v[36:39], v3 offset:6144
    v_add_f32 v6, v6, v16
    v_mfma_f32_16x16x32_bf16 a[140:143], v[184:187], v[44:47], a[140:143]
    s_sub_u32 s57, s26, 147456
    v_add_f32 v6, v6, v17
    s_min_u32 s26, s26, s57
    v_mfma_f32_16x16x32_bf16 a[188:191], v[172:175], v[40:43], a[188:191]
    v_exp_f32 v19, v119
    v_mfma_f32_16x16x32_bf16 a[188:191], v[188:191], v[44:47], a[188:191]
    s_waitcnt lgkmcnt(2)
    v_cvt_pk_bf16_f32 v86, v16, v17
    v_add_f32 v6, v6, v18
    v_add_f32 v6, v6, v19
    v_cvt_pk_bf16_f32 v87, v18, v19
    v_mfma_f32_16x16x32_bf16 v[160:163], v[24:27], a[192:195], v[128:131]
    ds_read_b128 v[40:43], v2 offset:128
    v_mfma_f32_16x16x32_bf16 v[160:163], v[28:31], a[196:199], v[160:163]
    v_exp_f32 v16, v88
    v_mfma_f32_16x16x32_bf16 v[164:167], v[24:27], a[216:219], v[132:135]
    ds_read_b128 v[44:47], v3 offset:128
    v_mfma_f32_16x16x32_bf16 v[164:167], v[28:31], a[220:223], v[164:167]
    s_waitcnt lgkmcnt(2)
    v_exp_f32 v17, v89
    v_mfma_f32_16x16x32_bf16 v[96:99], v[32:35], a[192:195], v[128:131]
    ds_read_b128 v[24:27], v2 offset:6272
    v_mfma_f32_16x16x32_bf16 v[96:99], v[36:39], a[196:199], v[96:99]
    v_exp_f32 v18, v90
    v_mfma_f32_16x16x32_bf16 v[100:103], v[32:35], a[216:219], v[132:135]
    ds_read_b128 v[28:31], v3 offset:6272
    v_add_f32 v7, v7, v16
    v_mfma_f32_16x16x32_bf16 v[100:103], v[36:39], a[220:223], v[100:103]
    s_waitcnt lgkmcnt(2)
    v_add_f32 v7, v7, v17
    v_mfma_f32_16x16x32_bf16 v[160:163], v[40:43], a[200:203], v[160:163]
    ds_read_b128 v[32:35], v2 offset:256
    v_mfma_f32_16x16x32_bf16 v[160:163], v[44:47], a[204:207], v[160:163]
    v_exp_f32 v19, v91
    v_mfma_f32_16x16x32_bf16 v[164:167], v[40:43], a[224:227], v[164:167]
    ds_read_b128 v[36:39], v3 offset:256
    v_cvt_pk_bf16_f32 v88, v16, v17
    v_mfma_f32_16x16x32_bf16 v[164:167], v[44:47], a[228:231], v[164:167]
    s_waitcnt lgkmcnt(2)
    v_exp_f32 v16, v120
    v_mfma_f32_16x16x32_bf16 v[96:99], v[24:27], a[200:203], v[96:99]
    ds_read_b128 v[40:43], v2 offset:6400
    v_add_f32 v7, v7, v18
    v_mfma_f32_16x16x32_bf16 v[96:99], v[28:31], a[204:207], v[96:99]
    v_add_f32 v7, v7, v19
    v_mfma_f32_16x16x32_bf16 v[100:103], v[24:27], a[224:227], v[100:103]
    ds_read_b128 v[44:47], v3 offset:6400
    v_mfma_f32_16x16x32_bf16 v[100:103], v[28:31], a[228:231], v[100:103]
    s_waitcnt lgkmcnt(2)
    v_exp_f32 v17, v121
    v_mfma_f32_16x16x32_bf16 v[160:163], v[32:35], a[208:211], v[160:163]
    ds_read_b128 v[24:27], v2 offset:12288
    v_cvt_pk_bf16_f32 v89, v18, v19
    v_mfma_f32_16x16x32_bf16 v[160:163], v[36:39], a[212:215], v[160:163]
    v_exp_f32 v18, v122
    v_mfma_f32_16x16x32_bf16 v[164:167], v[32:35], a[232:235], v[164:167]
    ds_read_b128 v[28:31], v3 offset:12288
    v_add_f32 v7, v7, v16
    v_mfma_f32_16x16x32_bf16 v[164:167], v[36:39], a[236:239], v[164:167]
    s_waitcnt lgkmcnt(2)
    v_add_f32 v7, v7, v17
    v_mfma_f32_16x16x32_bf16 v[96:99], v[40:43], a[208:211], v[96:99]
    ds_read_b128 v[32:35], v2 offset:18432
    v_mfma_f32_16x16x32_bf16 v[96:99], v[44:47], a[212:215], v[96:99]
    v_exp_f32 v19, v123
    v_mfma_f32_16x16x32_bf16 v[100:103], v[40:43], a[232:235], v[100:103]
    ds_read_b128 v[36:39], v3 offset:18432
    v_cvt_pk_bf16_f32 v90, v16, v17
    v_mfma_f32_16x16x32_bf16 v[100:103], v[44:47], a[236:239], v[100:103]
    s_waitcnt lgkmcnt(2)
    v_exp_f32 v16, v92
    v_mfma_f32_16x16x32_bf16 v[168:171], v[24:27], a[192:195], v[128:131]
    ds_read_b128 v[40:43], v2 offset:12416
    v_add_f32 v7, v7, v18
    v_mfma_f32_16x16x32_bf16 v[168:171], v[28:31], a[196:199], v[168:171]
    v_add_f32 v7, v7, v19
    v_mfma_f32_16x16x32_bf16 v[172:175], v[24:27], a[216:219], v[132:135]
    ds_read_b128 v[44:47], v3 offset:12416
    v_mfma_f32_16x16x32_bf16 v[172:175], v[28:31], a[220:223], v[172:175]
    s_waitcnt lgkmcnt(2)
    v_exp_f32 v17, v93
    v_mfma_f32_16x16x32_bf16 v[104:107], v[32:35], a[192:195], v[128:131]
    ds_read_b128 v[24:27], v2 offset:18560
    v_cvt_pk_bf16_f32 v91, v18, v19
    v_mfma_f32_16x16x32_bf16 v[104:107], v[36:39], a[196:199], v[104:107]
    v_exp_f32 v18, v94
    v_mfma_f32_16x16x32_bf16 v[108:111], v[32:35], a[216:219], v[132:135]
    s_add_u32 s29, s30, 49152
    ds_read_b128 v[28:31], v3 offset:18560
    v_add_f32 v8, v8, v16
    v_mfma_f32_16x16x32_bf16 v[108:111], v[36:39], a[220:223], v[108:111]
    s_waitcnt lgkmcnt(2)
    v_add_f32 v8, v8, v17
    s_sub_u32 s3, s29, 147456
    v_mfma_f32_16x16x32_bf16 v[168:171], v[40:43], a[200:203], v[168:171]
    ds_read_b128 v[32:35], v2 offset:12544
    v_mfma_f32_16x16x32_bf16 v[168:171], v[44:47], a[204:207], v[168:171]
    s_min_u32 s29, s29, s3
    v_exp_f32 v19, v95
    v_mfma_f32_16x16x32_bf16 v[172:175], v[40:43], a[224:227], v[172:175]
    ds_read_b128 v[36:39], v3 offset:12544
    v_cvt_pk_bf16_f32 v92, v16, v17
    v_mfma_f32_16x16x32_bf16 v[172:175], v[44:47], a[228:231], v[172:175]
    s_waitcnt lgkmcnt(2)
    v_exp_f32 v16, v124
    v_mfma_f32_16x16x32_bf16 v[104:107], v[24:27], a[200:203], v[104:107]
    ds_read_b128 v[40:43], v2 offset:18688
    v_add_f32 v8, v8, v18
    v_mfma_f32_16x16x32_bf16 v[104:107], v[28:31], a[204:207], v[104:107]
    v_add_f32 v8, v8, v19
    v_mfma_f32_16x16x32_bf16 v[108:111], v[24:27], a[224:227], v[108:111]
    ds_read_b128 v[44:47], v3 offset:18688
    v_mfma_f32_16x16x32_bf16 v[108:111], v[28:31], a[228:231], v[108:111]
    s_waitcnt lgkmcnt(2)
    v_subrev_u32 v2, 98304, v2
    v_subrev_u32 v3, 98304, v3
    v_mfma_f32_16x16x32_bf16 v[168:171], v[32:35], a[208:211], v[168:171]
    ds_read_b128 v[24:27], v2 offset:0
    v_mfma_f32_16x16x32_bf16 v[168:171], v[36:39], a[212:215], v[168:171]
    s_sub_u32 s3, s29, s30
    v_exp_f32 v17, v125
    v_mfma_f32_16x16x32_bf16 v[172:175], v[32:35], a[232:235], v[172:175]
    ds_read_b128 v[28:31], v3 offset:0
    v_cvt_pk_bf16_f32 v93, v18, v19
    v_mfma_f32_16x16x32_bf16 v[172:175], v[36:39], a[236:239], v[172:175]
    s_waitcnt lgkmcnt(2)
    v_exp_f32 v18, v126
    v_mfma_f32_16x16x32_bf16 v[104:107], v[40:43], a[208:211], v[104:107]
    ds_read_b128 v[32:35], v2 offset:6144
    v_add_f32 v8, v8, v16
    v_mfma_f32_16x16x32_bf16 v[104:107], v[44:47], a[212:215], v[104:107]
    v_add_f32 v8, v8, v17
    v_mfma_f32_16x16x32_bf16 v[108:111], v[40:43], a[232:235], v[108:111]
    ds_read_b128 v[36:39], v3 offset:6144
    v_mfma_f32_16x16x32_bf16 v[108:111], v[44:47], a[236:239], v[108:111]
    s_waitcnt lgkmcnt(2)
    v_exp_f32 v19, v127
    v_mfma_f32_16x16x32_bf16 v[176:179], v[24:27], a[192:195], v[128:131]
    ds_read_b128 v[40:43], v2 offset:128
    v_cvt_pk_bf16_f32 v94, v16, v17
    v_mfma_f32_16x16x32_bf16 v[176:179], v[28:31], a[196:199], v[176:179]
    s_mov_b32 s30, s29
    v_add_f32 v8, v8, v18
    v_add_f32 v8, v8, v19
    v_mfma_f32_16x16x32_bf16 v[180:183], v[24:27], a[216:219], v[132:135]
    ds_read_b128 v[44:47], v3 offset:128
    v_cvt_pk_bf16_f32 v95, v18, v19
    v_mfma_f32_16x16x32_bf16 v[180:183], v[28:31], a[220:223], v[180:183]
    s_waitcnt lgkmcnt(2)
    v_exp_f32 v16, v160
    v_mfma_f32_16x16x32_bf16 v[112:115], v[32:35], a[192:195], v[128:131]
    ds_read_b128 v[24:27], v2 offset:6272
    v_mfma_f32_16x16x32_bf16 v[112:115], v[36:39], a[196:199], v[112:115]
    v_exp_f32 v17, v161
    v_mfma_f32_16x16x32_bf16 v[116:119], v[32:35], a[216:219], v[132:135]
    ds_read_b128 v[28:31], v3 offset:6272
    v_mfma_f32_16x16x32_bf16 v[116:119], v[36:39], a[220:223], v[116:119]
    s_waitcnt lgkmcnt(2)
    v_exp_f32 v18, v162
    v_mfma_f32_16x16x32_bf16 v[176:179], v[40:43], a[200:203], v[176:179]
    ds_read_b128 v[32:35], v2 offset:256
    v_add_f32 v5, v5, v16
    v_mfma_f32_16x16x32_bf16 v[176:179], v[44:47], a[204:207], v[176:179]
    v_add_f32 v5, v5, v17
    v_add_u32 v1, s3, v1
    v_mfma_f32_16x16x32_bf16 v[180:183], v[40:43], a[224:227], v[180:183]
    ds_read_b128 v[36:39], v3 offset:256
    v_mfma_f32_16x16x32_bf16 v[180:183], v[44:47], a[228:231], v[180:183]
    s_waitcnt lgkmcnt(2)
    v_exp_f32 v19, v163
    v_mfma_f32_16x16x32_bf16 v[112:115], v[24:27], a[200:203], v[112:115]
    ds_read_b128 v[40:43], v2 offset:6400
    v_cvt_pk_bf16_f32 v160, v16, v17
    v_mfma_f32_16x16x32_bf16 v[112:115], v[28:31], a[204:207], v[112:115]
    v_exp_f32 v16, v96
    v_mfma_f32_16x16x32_bf16 v[116:119], v[24:27], a[224:227], v[116:119]
    ds_read_b128 v[44:47], v3 offset:6400
    v_add_f32 v5, v5, v18
    v_mfma_f32_16x16x32_bf16 v[116:119], v[28:31], a[228:231], v[116:119]
    s_waitcnt lgkmcnt(2)
    v_add_f32 v5, v5, v19
    v_mfma_f32_16x16x32_bf16 v[176:179], v[32:35], a[208:211], v[176:179]
    ds_read_b128 v[24:27], v2 offset:12288
    v_mfma_f32_16x16x32_bf16 v[176:179], v[36:39], a[212:215], v[176:179]
    v_exp_f32 v17, v97
    v_mfma_f32_16x16x32_bf16 v[180:183], v[32:35], a[232:235], v[180:183]
    ds_read_b128 v[28:31], v3 offset:12288
    v_cvt_pk_bf16_f32 v161, v18, v19
    v_mfma_f32_16x16x32_bf16 v[180:183], v[36:39], a[236:239], v[180:183]
    s_waitcnt lgkmcnt(2)
    v_exp_f32 v18, v98
    v_mfma_f32_16x16x32_bf16 v[112:115], v[40:43], a[208:211], v[112:115]
    ds_read_b128 v[32:35], v2 offset:18432
    v_add_f32 v5, v5, v16
    v_mfma_f32_16x16x32_bf16 v[112:115], v[44:47], a[212:215], v[112:115]
    v_add_f32 v5, v5, v17
    v_mfma_f32_16x16x32_bf16 v[116:119], v[40:43], a[232:235], v[116:119]
    ds_read_b128 v[36:39], v3 offset:18432
    v_mfma_f32_16x16x32_bf16 v[116:119], v[44:47], a[236:239], v[116:119]
    s_waitcnt lgkmcnt(2)
    v_exp_f32 v19, v99
    v_mfma_f32_16x16x32_bf16 v[184:187], v[24:27], a[192:195], v[128:131]
    ds_read_b128 v[40:43], v2 offset:12416
    v_cvt_pk_bf16_f32 v162, v16, v17
    v_mfma_f32_16x16x32_bf16 v[184:187], v[28:31], a[196:199], v[184:187]
    v_exp_f32 v16, v164
    v_mfma_f32_16x16x32_bf16 v[188:191], v[24:27], a[216:219], v[132:135]
    ds_read_b128 v[44:47], v3 offset:12416
    v_add_f32 v5, v5, v18
    v_mfma_f32_16x16x32_bf16 v[188:191], v[28:31], a[220:223], v[188:191]
    s_waitcnt lgkmcnt(2)
    v_add_f32 v5, v5, v19
    v_mfma_f32_16x16x32_bf16 v[120:123], v[32:35], a[192:195], v[128:131]
    ds_read_b128 v[24:27], v2 offset:18560
    v_mfma_f32_16x16x32_bf16 v[120:123], v[36:39], a[196:199], v[120:123]
    s_waitcnt vmcnt(6)
    v_exp_f32 v17, v165
    v_mfma_f32_16x16x32_bf16 v[124:127], v[32:35], a[216:219], v[132:135]
    ds_read_b128 v[28:31], v3 offset:18560
    v_cvt_pk_bf16_f32 v163, v18, v19
    v_mfma_f32_16x16x32_bf16 v[124:127], v[36:39], a[220:223], v[124:127]
    s_waitcnt lgkmcnt(2)
    s_barrier
    v_mfma_f32_16x16x32_bf16 v[184:187], v[40:43], a[200:203], v[184:187]
    ds_read_b128 v[32:35], v2 offset:12544
    v_mfma_f32_16x16x32_bf16 v[184:187], v[44:47], a[204:207], v[184:187]
    v_exp_f32 v18, v166
    v_mfma_f32_16x16x32_bf16 v[188:191], v[40:43], a[224:227], v[188:191]
    ds_read_b128 v[36:39], v3 offset:12544
    v_add_f32 v6, v6, v16
    v_mfma_f32_16x16x32_bf16 v[188:191], v[44:47], a[228:231], v[188:191]
    s_waitcnt lgkmcnt(2)
    v_add_f32 v6, v6, v17
    v_mfma_f32_16x16x32_bf16 v[120:123], v[24:27], a[200:203], v[120:123]
    ds_read_b128 v[40:43], v2 offset:18688
    v_mfma_f32_16x16x32_bf16 v[120:123], v[28:31], a[204:207], v[120:123]
    v_exp_f32 v19, v167
    v_cvt_pk_bf16_f32 v164, v16, v17
    v_mfma_f32_16x16x32_bf16 v[124:127], v[24:27], a[224:227], v[124:127]
    ds_read_b128 v[44:47], v3 offset:18688
    v_mfma_f32_16x16x32_bf16 v[124:127], v[28:31], a[228:231], v[124:127]
    s_waitcnt lgkmcnt(2)
    v_exp_f32 v16, v100
    v_mfma_f32_16x16x32_bf16 v[184:187], v[32:35], a[208:211], v[184:187]
    ds_read_b128 v[24:27], v1 offset:0
    v_add_f32 v6, v6, v18
    v_mfma_f32_16x16x32_bf16 v[184:187], v[36:39], a[212:215], v[184:187]
    v_add_f32 v6, v6, v19
    v_mfma_f32_16x16x32_bf16 v[188:191], v[32:35], a[232:235], v[188:191]
    ds_read_b128 v[28:31], v1 offset:12288
    v_mfma_f32_16x16x32_bf16 v[188:191], v[36:39], a[236:239], v[188:191]
    s_waitcnt lgkmcnt(2)
    v_exp_f32 v17, v101
    v_cvt_pk_bf16_f32 v165, v18, v19
    v_mfma_f32_16x16x32_bf16 v[120:123], v[40:43], a[208:211], v[120:123]
    ds_read_b128 v[32:35], v1 offset:1024
    v_mfma_f32_16x16x32_bf16 v[120:123], v[44:47], a[212:215], v[120:123]
    v_exp_f32 v18, v102
    v_mfma_f32_16x16x32_bf16 v[124:127], v[40:43], a[232:235], v[124:127]
    ds_read_b128 v[36:39], v1 offset:13312
    v_add_f32 v6, v6, v16
    v_mfma_f32_16x16x32_bf16 v[124:127], v[44:47], a[236:239], v[124:127]
    s_waitcnt lgkmcnt(2)
    v_add_f32 v6, v6, v17
    v_exp_f32 v19, v103
    v_cvt_pk_bf16_f32 v166, v16, v17
    v_add_f32 v6, v6, v18
    v_add_f32 v6, v6, v19
    v_cvt_pk_bf16_f32 v167, v18, v19
    v_mfma_f32_16x16x32_bf16 a[0:3], v[64:67], v[24:27], a[0:3]
    s_mov_b32 m0, s56
    ds_read_b128 v[40:43], v1 offset:2048
    v_bfe_u32 v57, v4, 8, 2
    v_mfma_f32_16x16x32_bf16 a[0:3], v[80:83], v[28:31], a[0:3]
    buffer_load_dwordx4 v4, s[4:7], s27 offen offset:0 sc1 lds
    v_mfma_f32_16x16x32_bf16 a[48:51], v[68:71], v[24:27], a[48:51]
    v_exp_f32 v16, v168
    v_mfma_f32_16x16x32_bf16 a[48:51], v[84:87], v[28:31], a[48:51]
    v_exp_f32 v17, v169
    v_mfma_f32_16x16x32_bf16 a[96:99], v[72:75], v[24:27], a[96:99]
    ds_read_b128 v[44:47], v1 offset:14336
    v_mul_u32_u24 v56, 1536, v57
    v_mfma_f32_16x16x32_bf16 a[96:99], v[88:91], v[28:31], a[96:99]
    buffer_load_dwordx4 v4, s[4:7], s27 offen offset:1024 sc1 lds
    v_mfma_f32_16x16x32_bf16 a[144:147], v[76:79], v[24:27], a[144:147]
    v_exp_f32 v18, v170
    v_mfma_f32_16x16x32_bf16 a[144:147], v[92:95], v[28:31], a[144:147]
    s_waitcnt lgkmcnt(2)
    v_add_f32 v5, v5, v16
    v_add_f32 v5, v5, v17
    v_mfma_f32_16x16x32_bf16 a[4:7], v[64:67], v[32:35], a[4:7]
    ds_read_b128 v[24:27], v1 offset:3072
    v_lshlrev_b32 v58, 4, v57
    v_mfma_f32_16x16x32_bf16 a[4:7], v[80:83], v[36:39], a[4:7]
    buffer_load_dwordx4 v4, s[4:7], s27 offen offset:2048 sc1 lds
    v_mfma_f32_16x16x32_bf16 a[52:55], v[68:71], v[32:35], a[52:55]
    v_exp_f32 v19, v171
    v_mfma_f32_16x16x32_bf16 a[52:55], v[84:87], v[36:39], a[52:55]
    s_add_u32 s27, s27, 24576
    v_cvt_pk_bf16_f32 v168, v16, v17
    v_bfe_u32 v57, v4, 4, 4
    v_mfma_f32_16x16x32_bf16 a[100:103], v[72:75], v[32:35], a[100:103]
    ds_read_b128 v[28:31], v1 offset:15360
    v_mfma_f32_16x16x32_bf16 a[100:103], v[88:91], v[36:39], a[100:103]
    s_add_u32 s56, s56, 12288
    v_exp_f32 v16, v104
    v_mfma_f32_16x16x32_bf16 a[148:151], v[76:79], v[32:35], a[148:151]
    v_add_f32 v5, v5, v18
    v_add_f32 v5, v5, v19
    v_mfma_f32_16x16x32_bf16 a[148:151], v[92:95], v[36:39], a[148:151]
    s_waitcnt lgkmcnt(2)
    v_exp_f32 v17, v105
    v_mfma_f32_16x16x32_bf16 a[8:11], v[64:67], v[40:43], a[8:11]
    s_mov_b32 m0, s56
    ds_read_b128 v[32:35], v1 offset:4096
    v_cvt_pk_bf16_f32 v169, v18, v19
    v_mfma_f32_16x16x32_bf16 a[8:11], v[80:83], v[44:47], a[8:11]
    v_exp_f32 v18, v106
    v_mfma_f32_16x16x32_bf16 a[56:59], v[68:71], v[40:43], a[56:59]
    v_add_f32 v5, v5, v16
    v_add_f32 v5, v5, v17
    v_mfma_f32_16x16x32_bf16 a[56:59], v[84:87], v[44:47], a[56:59]
    buffer_load_dwordx4 v4, s[4:7], s27 offen offset:0 sc1 lds
    v_mfma_f32_16x16x32_bf16 a[104:107], v[72:75], v[40:43], a[104:107]
    ds_read_b128 v[36:39], v1 offset:16384
    v_mul_u32_u24 v57, 12, v57
    v_mfma_f32_16x16x32_bf16 a[104:107], v[88:91], v[44:47], a[104:107]
    v_exp_f32 v19, v107
    v_mfma_f32_16x16x32_bf16 a[152:155], v[76:79], v[40:43], a[152:155]
    v_cvt_pk_bf16_f32 v170, v16, v17
    v_add_u32 v56, v56, v57
    v_mfma_f32_16x16x32_bf16 a[152:155], v[92:95], v[44:47], a[152:155]
    s_waitcnt lgkmcnt(2)
    buffer_load_dwordx4 v4, s[4:7], s27 offen offset:1024 sc1 lds
    v_mfma_f32_16x16x32_bf16 a[12:15], v[64:67], v[24:27], a[12:15]
    ds_read_b128 v[40:43], v1 offset:5120
    v_mfma_f32_16x16x32_bf16 a[12:15], v[80:83], v[28:31], a[12:15]
    v_exp_f32 v16, v172
    v_mfma_f32_16x16x32_bf16 a[60:63], v[68:71], v[24:27], a[60:63]
    v_add_f32 v5, v5, v18
    v_add_f32 v5, v5, v19
    v_mfma_f32_16x16x32_bf16 a[60:63], v[84:87], v[28:31], a[60:63]
    buffer_load_dwordx4 v4, s[4:7], s27 offen offset:2048 sc1 lds
    v_mfma_f32_16x16x32_bf16 a[108:111], v[72:75], v[24:27], a[108:111]
    ds_read_b128 v[44:47], v1 offset:17408
    v_mov_b32 v57, 1.0
    v_mfma_f32_16x16x32_bf16 a[108:111], v[88:91], v[28:31], a[108:111]
    v_exp_f32 v17, v173
    v_mfma_f32_16x16x32_bf16 a[156:159], v[76:79], v[24:27], a[156:159]
    s_add_u32 s27, s27, 24576
    v_cvt_pk_bf16_f32 v171, v18, v19
    v_mfma_f32_16x16x32_bf16 a[156:159], v[92:95], v[28:31], a[156:159]
    s_waitcnt lgkmcnt(2)
    v_exp_f32 v18, v174
    v_mfma_f32_16x16x32_bf16 a[16:19], v[64:67], v[32:35], a[16:19]
    s_add_u32 s56, s56, 36864
    ds_read_b128 v[24:27], v1 offset:6144
    v_add_f32 v6, v6, v16
    v_mfma_f32_16x16x32_bf16 a[16:19], v[80:83], v[36:39], a[16:19]
    v_add_f32 v6, v6, v17
    v_mov_b32 v20, 0x3f803f80
    v_mfma_f32_16x16x32_bf16 a[64:67], v[68:71], v[32:35], a[64:67]
    s_sub_u32 s58, s56, 147456
    v_exp_f32 v19, v175
    v_mfma_f32_16x16x32_bf16 a[64:67], v[84:87], v[36:39], a[64:67]
    v_cvt_pk_bf16_f32 v172, v16, v17
    v_mfma_f32_16x16x32_bf16 a[112:115], v[72:75], v[32:35], a[112:115]
    s_min_u32 s56, s56, s58
    ds_read_b128 v[28:31], v1 offset:18432
    v_mov_b32 v21, 0x3f803f80
    v_mfma_f32_16x16x32_bf16 a[112:115], v[88:91], v[36:39], a[112:115]
    v_exp_f32 v16, v108
    v_mfma_f32_16x16x32_bf16 a[160:163], v[76:79], v[32:35], a[160:163]
    s_mov_b32 m0, s56
    v_add_f32 v6, v6, v18
    v_add_f32 v6, v6, v19
    v_mfma_f32_16x16x32_bf16 a[160:163], v[92:95], v[36:39], a[160:163]
    s_waitcnt lgkmcnt(2)
    v_exp_f32 v17, v109
    v_mfma_f32_16x16x32_bf16 a[20:23], v[64:67], v[40:43], a[20:23]
    ds_read_b128 v[32:35], v1 offset:7168
    v_cvt_pk_bf16_f32 v173, v18, v19
    v_mfma_f32_16x16x32_bf16 a[20:23], v[80:83], v[44:47], a[20:23]
    buffer_load_dwordx4 v4, s[4:7], s27 offen offset:0 sc1 lds
    v_mfma_f32_16x16x32_bf16 a[68:71], v[68:71], v[40:43], a[68:71]
    v_exp_f32 v18, v110
    v_mfma_f32_16x16x32_bf16 a[68:71], v[84:87], v[44:47], a[68:71]
    v_add_f32 v6, v6, v16
    v_add_f32 v6, v6, v17
    v_mfma_f32_16x16x32_bf16 a[116:119], v[72:75], v[40:43], a[116:119]
    ds_read_b128 v[36:39], v1 offset:19456
    v_mov_b32 v22, 0x3f803f80
    v_mfma_f32_16x16x32_bf16 a[116:119], v[88:91], v[44:47], a[116:119]
    buffer_load_dwordx4 v4, s[4:7], s27 offen offset:1024 sc1 lds
    v_mfma_f32_16x16x32_bf16 a[164:167], v[76:79], v[40:43], a[164:167]
    v_exp_f32 v19, v111
    v_mfma_f32_16x16x32_bf16 a[164:167], v[92:95], v[44:47], a[164:167]
    s_waitcnt lgkmcnt(2)
    v_cvt_pk_bf16_f32 v174, v16, v17
    v_add_f32 v6, v6, v18
    v_mfma_f32_16x16x32_bf16 a[24:27], v[64:67], v[24:27], a[24:27]
    ds_read_b128 v[40:43], v1 offset:8192
    v_add_f32 v6, v6, v19
    v_mfma_f32_16x16x32_bf16 a[24:27], v[80:83], v[28:31], a[24:27]
    buffer_load_dwordx4 v4, s[4:7], s27 offen offset:2048 sc1 lds
    v_mfma_f32_16x16x32_bf16 a[72:75], v[68:71], v[24:27], a[72:75]
    v_cvt_pk_bf16_f32 v175, v18, v19
    v_mov_b32 v23, 0x3f803f80
    v_mfma_f32_16x16x32_bf16 a[72:75], v[84:87], v[28:31], a[72:75]
    v_exp_f32 v16, v176
    v_mfma_f32_16x16x32_bf16 a[120:123], v[72:75], v[24:27], a[120:123]
    ds_read_b128 v[44:47], v1 offset:20480
    v_mfma_f32_16x16x32_bf16 a[120:123], v[88:91], v[28:31], a[120:123]
    s_lshl_b32 s24, s95, 2
    v_exp_f32 v17, v177
    v_mfma_f32_16x16x32_bf16 a[168:171], v[76:79], v[24:27], a[168:171]
    s_add_u32 s27, s27, 24576
    v_exp_f32 v18, v178
    v_mfma_f32_16x16x32_bf16 a[168:171], v[92:95], v[28:31], a[168:171]
    s_waitcnt lgkmcnt(2)
    v_add_f32 v5, v5, v16
    v_add_f32 v5, v5, v17
    v_mfma_f32_16x16x32_bf16 a[28:31], v[64:67], v[32:35], a[28:31]
    s_add_u32 s56, s56, 12288
    ds_read_b128 v[24:27], v1 offset:9216
    v_mfma_f32_16x16x32_bf16 a[28:31], v[80:83], v[36:39], a[28:31]
    s_mov_b32 m0, s56
    v_exp_f32 v19, v179
    v_mfma_f32_16x16x32_bf16 a[76:79], v[68:71], v[32:35], a[76:79]
    v_cvt_pk_bf16_f32 v176, v16, v17
    v_mfma_f32_16x16x32_bf16 a[76:79], v[84:87], v[36:39], a[76:79]
    s_add_u32 s24, s24, s25
    v_exp_f32 v16, v112
    v_mfma_f32_16x16x32_bf16 a[124:127], v[72:75], v[32:35], a[124:127]
    ds_read_b128 v[28:31], v1 offset:21504
    v_add_f32 v5, v5, v18
    v_mfma_f32_16x16x32_bf16 a[124:127], v[88:91], v[36:39], a[124:127]
    buffer_load_dwordx4 v4, s[4:7], s27 offen offset:0 sc1 lds
    v_mfma_f32_16x16x32_bf16 a[172:175], v[76:79], v[32:35], a[172:175]
    v_add_f32 v5, v5, v19
    v_mfma_f32_16x16x32_bf16 a[172:175], v[92:95], v[36:39], a[172:175]
    s_waitcnt lgkmcnt(2)
    v_exp_f32 v17, v113
    v_mfma_f32_16x16x32_bf16 a[32:35], v[64:67], v[40:43], a[32:35]
    s_mul_i32 s24, s24, 24576
    ds_read_b128 v[32:35], v1 offset:10240
    v_cvt_pk_bf16_f32 v177, v18, v19
    v_mfma_f32_16x16x32_bf16 a[32:35], v[80:83], v[44:47], a[32:35]
    buffer_load_dwordx4 v4, s[4:7], s27 offen offset:1024 sc1 lds
    v_mfma_f32_16x16x32_bf16 a[80:83], v[68:71], v[40:43], a[80:83]
    v_exp_f32 v18, v114
    v_mfma_f32_16x16x32_bf16 a[80:83], v[84:87], v[44:47], a[80:83]
    v_add_f32 v5, v5, v16
    v_add_f32 v5, v5, v17
    v_mfma_f32_16x16x32_bf16 a[128:131], v[72:75], v[40:43], a[128:131]
    ds_read_b128 v[36:39], v1 offset:22528
    v_mfma_f32_16x16x32_bf16 a[128:131], v[88:91], v[44:47], a[128:131]
    buffer_load_dwordx4 v4, s[4:7], s27 offen offset:2048 sc1 lds
    v_mfma_f32_16x16x32_bf16 a[176:179], v[76:79], v[40:43], a[176:179]
    s_add_u32 s40, s24, 6144
    v_exp_f32 v19, v115
    v_mfma_f32_16x16x32_bf16 a[176:179], v[92:95], v[44:47], a[176:179]
    s_waitcnt lgkmcnt(2)
    v_cvt_pk_bf16_f32 v178, v16, v17
    v_mfma_f32_16x16x32_bf16 a[36:39], v[64:67], v[24:27], a[36:39]
    ds_read_b128 v[40:43], v1 offset:11264
    v_mfma_f32_16x16x32_bf16 a[36:39], v[80:83], v[28:31], a[36:39]
    v_exp_f32 v16, v180
    v_mfma_f32_16x16x32_bf16 a[84:87], v[68:71], v[24:27], a[84:87]
    v_add_f32 v5, v5, v18
    v_add_f32 v5, v5, v19
    v_mfma_f32_16x16x32_bf16 a[84:87], v[84:87], v[28:31], a[84:87]
    s_add_u32 s27, s27, 24576
    v_exp_f32 v17, v181
    v_mfma_f32_16x16x32_bf16 a[132:135], v[72:75], v[24:27], a[132:135]
    s_add_u32 s56, s56, 36864
    ds_read_b128 v[44:47], v1 offset:23552
    v_cvt_pk_bf16_f32 v179, v18, v19
    v_mfma_f32_16x16x32_bf16 a[132:135], v[88:91], v[28:31], a[132:135]
    s_waitcnt lgkmcnt(2)
    v_exp_f32 v18, v182
    v_mfma_f32_16x16x32_bf16 a[180:183], v[76:79], v[24:27], a[180:183]
    s_waitcnt vmcnt(12)
    v_add_f32 v6, v6, v16
    v_add_f32 v6, v6, v17
    v_mfma_f32_16x16x32_bf16 a[180:183], v[92:95], v[28:31], a[180:183]
    s_barrier
    v_add_u32 v2, 49152, v2
    v_add_u32 v3, 49152, v3
    v_mfma_f32_16x16x32_bf16 a[40:43], v[64:67], v[32:35], a[40:43]
    s_sub_u32 s58, s56, 147456
    ds_read_b128 v[24:27], v2 offset:0
    s_add_u32 s41, s24, 12288
    v_mfma_f32_16x16x32_bf16 a[40:43], v[80:83], v[36:39], a[40:43]
    s_min_u32 s56, s56, s58
    v_exp_f32 v19, v183
    v_mfma_f32_16x16x32_bf16 a[88:91], v[68:71], v[32:35], a[88:91]
L_pg11:
    s_cbranch_execz L_iwret
    s_add_u32 s42, s24, 18432
    v_cvt_pk_bf16_f32 v180, v16, v17
    v_mfma_f32_16x16x32_bf16 a[88:91], v[84:87], v[36:39], a[88:91]
    v_exp_f32 v16, v116
    v_mfma_f32_16x16x32_bf16 a[136:139], v[72:75], v[32:35], a[136:139]
    ds_read_b128 v[28:31], v3 offset:0
    v_add_f32 v6, v6, v18
    v_mfma_f32_16x16x32_bf16 a[136:139], v[88:91], v[36:39], a[136:139]
    v_add_f32 v6, v6, v19
    v_mfma_f32_16x16x32_bf16 a[184:187], v[76:79], v[32:35], a[184:187]
    v_exp_f32 v17, v117
    v_mfma_f32_16x16x32_bf16 a[184:187], v[92:95], v[36:39], a[184:187]
    s_waitcnt lgkmcnt(2)
    v_cvt_pk_bf16_f32 v181, v18, v19
    v_mfma_f32_16x16x32_bf16 a[44:47], v[64:67], v[40:43], a[44:47]
    ds_read_b128 v[32:35], v2 offset:6144
    v_mfma_f32_16x16x32_bf16 a[44:47], v[80:83], v[44:47], a[44:47]
    v_exp_f32 v18, v118
    v_mfma_f32_16x16x32_bf16 a[92:95], v[68:71], v[40:43], a[92:95]
    v_add_f32 v6, v6, v16
    v_add_f32 v6, v6, v17
    v_mfma_f32_16x16x32_bf16 a[92:95], v[84:87], v[44:47], a[92:95]
    v_exp_f32 v19, v119
    v_mfma_f32_16x16x32_bf16 a[140:143], v[72:75], v[40:43], a[140:143]
    ds_read_b128 v[36:39], v3 offset:6144
    v_cvt_pk_bf16_f32 v182, v16, v17
    v_mfma_f32_16x16x32_bf16 a[140:143], v[88:91], v[44:47], a[140:143]
    v_add_f32 v6, v6, v18
    v_add_f32 v6, v6, v19
    v_mfma_f32_16x16x32_bf16 a[188:191], v[76:79], v[40:43], a[188:191]
    v_cvt_pk_bf16_f32 v183, v18, v19
    v_mfma_f32_16x16x32_bf16 a[188:191], v[92:95], v[44:47], a[188:191]
    s_waitcnt lgkmcnt(2)
    v_mfma_f32_16x16x32_bf16 v[64:67], v[24:27], a[192:195], v[128:131]
    ds_read_b128 v[40:43], v2 offset:128
    v_mfma_f32_16x16x32_bf16 v[64:67], v[28:31], a[196:199], v[64:67]
    v_exp_f32 v16, v184
    v_mfma_f32_16x16x32_bf16 v[68:71], v[24:27], a[216:219], v[132:135]
    ds_read_b128 v[44:47], v3 offset:128
    v_mfma_f32_16x16x32_bf16 v[68:71], v[28:31], a[220:223], v[68:71]
    s_waitcnt lgkmcnt(2)
    v_exp_f32 v17, v185
    v_mfma_f32_16x16x32_bf16 v[96:99], v[32:35], a[192:195], v[128:131]
    ds_read_b128 v[24:27], v2 offset:6272
    v_mfma_f32_16x16x32_bf16 v[96:99], v[36:39], a[196:199], v[96:99]
    v_exp_f32 v18, v186
    v_mfma_f32_16x16x32_bf16 v[100:103], v[32:35], a[216:219], v[132:135]
    ds_read_b128 v[28:31], v3 offset:6272
    v_add_f32 v5, v5, v16
    v_mfma_f32_16x16x32_bf16 v[100:103], v[36:39], a[220:223], v[100:103]
    s_waitcnt lgkmcnt(2)
    v_add_f32 v5, v5, v17
    v_mfma_f32_16x16x32_bf16 v[64:67], v[40:43], a[200:203], v[64:67]
    ds_read_b128 v[32:35], v2 offset:256
    v_mfma_f32_16x16x32_bf16 v[64:67], v[44:47], a[204:207], v[64:67]
    v_exp_f32 v19, v187
    v_mfma_f32_16x16x32_bf16 v[68:71], v[40:43], a[224:227], v[68:71]
    ds_read_b128 v[36:39], v3 offset:256
    v_cvt_pk_bf16_f32 v184, v16, v17
    v_mfma_f32_16x16x32_bf16 v[68:71], v[44:47], a[228:231], v[68:71]
    s_waitcnt lgkmcnt(2)
    v_exp_f32 v16, v120
    v_mfma_f32_16x16x32_bf16 v[96:99], v[24:27], a[200:203], v[96:99]
    ds_read_b128 v[40:43], v2 offset:6400
    v_add_f32 v5, v5, v18
    v_mfma_f32_16x16x32_bf16 v[96:99], v[28:31], a[204:207], v[96:99]
    s_waitcnt vmcnt(0)
    v_add_f32 v5, v5, v19
    v_mfma_f32_16x16x32_bf16 v[100:103], v[24:27], a[224:227], v[100:103]
    ds_read_b128 v[44:47], v3 offset:6400
    v_mfma_f32_16x16x32_bf16 v[100:103], v[28:31], a[228:231], v[100:103]
    s_waitcnt lgkmcnt(2)
    s_barrier
    v_mfma_f32_16x16x32_bf16 v[64:67], v[32:35], a[208:211], v[64:67]
    s_mov_b32 m0, s56
    ds_read_b128 v[24:27], v2 offset:12288
    v_mfma_f32_16x16x32_bf16 v[64:67], v[36:39], a[212:215], v[64:67]
    buffer_load_dwordx4 v4, s[4:7], s27 offen offset:0 sc1 lds
    v_mfma_f32_16x16x32_bf16 v[68:71], v[32:35], a[232:235], v[68:71]
    ds_read_b128 v[28:31], v3 offset:12288
    v_mfma_f32_16x16x32_bf16 v[68:71], v[36:39], a[236:239], v[68:71]
    s_waitcnt lgkmcnt(2)
    v_exp_f32 v17, v121
    v_cvt_pk_bf16_f32 v185, v18, v19
    v_mfma_f32_16x16x32_bf16 v[96:99], v[40:43], a[208:211], v[96:99]
    ds_read_b128 v[32:35], v2 offset:18432
    v_mfma_f32_16x16x32_bf16 v[96:99], v[44:47], a[212:215], v[96:99]
    buffer_load_dwordx4 v4, s[4:7], s27 offen offset:1024 sc1 lds
    v_mfma_f32_16x16x32_bf16 v[100:103], v[40:43], a[232:235], v[100:103]
    ds_read_b128 v[36:39], v3 offset:18432
    v_mfma_f32_16x16x32_bf16 v[100:103], v[44:47], a[236:239], v[100:103]
    s_waitcnt lgkmcnt(2)
    v_exp_f32 v18, v122
    v_add_f32 v5, v5, v16
    v_mfma_f32_16x16x32_bf16 v[72:75], v[24:27], a[192:195], v[128:131]
    ds_read_b128 v[40:43], v2 offset:12416
    v_add_f32 v5, v5, v17
    v_mfma_f32_16x16x32_bf16 v[72:75], v[28:31], a[196:199], v[72:75]
    v_exp_f32 v19, v123
    v_cvt_pk_bf16_f32 v186, v16, v17
    v_mfma_f32_16x16x32_bf16 v[76:79], v[24:27], a[216:219], v[132:135]
    ds_read_b128 v[44:47], v3 offset:12416
    v_mfma_f32_16x16x32_bf16 v[76:79], v[28:31], a[220:223], v[76:79]
    s_waitcnt lgkmcnt(2)
    buffer_load_dwordx4 v4, s[4:7], s27 offen offset:2048 sc1 lds
    v_mfma_f32_16x16x32_bf16 v[104:107], v[32:35], a[192:195], v[128:131]
    ds_read_b128 v[24:27], v2 offset:18560
    v_mfma_f32_16x16x32_bf16 v[104:107], v[36:39], a[196:199], v[104:107]
    v_exp_f32 v16, v188
    v_add_f32 v5, v5, v18
    v_mfma_f32_16x16x32_bf16 v[108:111], v[32:35], a[216:219], v[132:135]
    ds_read_b128 v[28:31], v3 offset:18560
    v_add_f32 v5, v5, v19
    v_mfma_f32_16x16x32_bf16 v[108:111], v[36:39], a[220:223], v[108:111]
    s_waitcnt lgkmcnt(2)
    v_exp_f32 v17, v189
    v_cvt_pk_bf16_f32 v187, v18, v19
    v_mfma_f32_16x16x32_bf16 v[72:75], v[40:43], a[200:203], v[72:75]
    s_add_u32 s27, s27, 24576
    ds_read_b128 v[32:35], v2 offset:12544
    v_mfma_f32_16x16x32_bf16 v[72:75], v[44:47], a[204:207], v[72:75]
    v_exp_f32 v18, v190
    v_mfma_f32_16x16x32_bf16 v[76:79], v[40:43], a[224:227], v[76:79]
    s_add_u32 s56, s56, 12288
    ds_read_b128 v[36:39], v3 offset:12544
    v_add_f32 v6, v6, v16
    v_mfma_f32_16x16x32_bf16 v[76:79], v[44:47], a[228:231], v[76:79]
    s_waitcnt lgkmcnt(2)
    v_add_f32 v6, v6, v17
    v_mfma_f32_16x16x32_bf16 v[104:107], v[24:27], a[200:203], v[104:107]
    ds_read_b128 v[40:43], v2 offset:18688
    v_mfma_f32_16x16x32_bf16 v[104:107], v[28:31], a[204:207], v[104:107]
    v_exp_f32 v19, v191
    v_cvt_pk_bf16_f32 v188, v16, v17
    v_mfma_f32_16x16x32_bf16 v[108:111], v[24:27], a[224:227], v[108:111]
    s_mov_b32 m0, s56
    ds_read_b128 v[44:47], v3 offset:18688
    v_mfma_f32_16x16x32_bf16 v[108:111], v[28:31], a[228:231], v[108:111]
    s_waitcnt lgkmcnt(2)
    v_add_u32 v2, 49152, v2
    v_add_u32 v3, 49152, v3
    v_mfma_f32_16x16x32_bf16 v[72:75], v[32:35], a[208:211], v[72:75]
    ds_read_b128 v[24:27], v2 offset:0
    v_mfma_f32_16x16x32_bf16 v[72:75], v[36:39], a[212:215], v[72:75]
    buffer_load_dwordx4 v4, s[4:7], s27 offen offset:0 sc1 lds
    v_mfma_f32_16x16x32_bf16 v[76:79], v[32:35], a[232:235], v[76:79]
    ds_read_b128 v[28:31], v3 offset:0
    v_mfma_f32_16x16x32_bf16 v[76:79], v[36:39], a[236:239], v[76:79]
    s_waitcnt lgkmcnt(2)
    v_exp_f32 v16, v124
    v_add_f32 v6, v6, v18
    v_mfma_f32_16x16x32_bf16 v[104:107], v[40:43], a[208:211], v[104:107]
    ds_read_b128 v[32:35], v2 offset:6144
    v_add_f32 v6, v6, v19
    v_mfma_f32_16x16x32_bf16 v[104:107], v[44:47], a[212:215], v[104:107]
    v_exp_f32 v17, v125
    v_cvt_pk_bf16_f32 v189, v18, v19
    v_mfma_f32_16x16x32_bf16 v[108:111], v[40:43], a[232:235], v[108:111]
    ds_read_b128 v[36:39], v3 offset:6144
    v_mfma_f32_16x16x32_bf16 v[108:111], v[44:47], a[236:239], v[108:111]
    s_waitcnt lgkmcnt(2)
    buffer_load_dwordx4 v4, s[4:7], s27 offen offset:1024 sc1 lds
    v_mfma_f32_16x16x32_bf16 v[80:83], v[24:27], a[240:243], v[136:139]
    ds_read_b128 v[40:43], v2 offset:128
    v_mfma_f32_16x16x32_bf16 v[80:83], v[28:31], a[244:247], v[80:83]
    v_exp_f32 v18, v126
    v_add_f32 v6, v6, v16
    v_mfma_f32_16x16x32_bf16 v[84:87], v[24:27], v[200:203], v[140:143]
    ds_read_b128 v[44:47], v3 offset:128
    v_add_f32 v6, v6, v17
    v_exp_f32 v19, v127
    v_cvt_pk_bf16_f32 v190, v16, v17
    v_add_f32 v6, v6, v18
    v_add_f32 v6, v6, v19
    v_cvt_pk_bf16_f32 v191, v18, v19
    v_mfma_f32_16x16x32_bf16 v[84:87], v[28:31], v[204:207], v[84:87]
    s_waitcnt lgkmcnt(2)
    v_exp_f32 v16, v64
    v_mfma_f32_16x16x32_bf16 v[112:115], v[32:35], a[240:243], v[136:139]
    ds_read_b128 v[24:27], v2 offset:6272
    v_mfma_f32_16x16x32_bf16 v[112:115], v[36:39], a[244:247], v[112:115]
    buffer_load_dwordx4 v4, s[4:7], s27 offen offset:2048 sc1 lds
    v_mfma_f32_16x16x32_bf16 v[116:119], v[32:35], v[200:203], v[140:143]
    ds_read_b128 v[28:31], v3 offset:6272
    v_mfma_f32_16x16x32_bf16 v[116:119], v[36:39], v[204:207], v[116:119]
    s_waitcnt lgkmcnt(2)
    v_exp_f32 v17, v65
    v_mfma_f32_16x16x32_bf16 v[80:83], v[40:43], a[248:251], v[80:83]
    ds_read_b128 v[32:35], v2 offset:256
    v_mfma_f32_16x16x32_bf16 v[80:83], v[44:47], a[252:255], v[80:83]
    v_exp_f32 v18, v66
    v_mfma_f32_16x16x32_bf16 v[84:87], v[40:43], v[208:211], v[84:87]
    ds_read_b128 v[36:39], v3 offset:256
    v_add_f32 v5, v5, v16
    v_mfma_f32_16x16x32_bf16 v[84:87], v[44:47], v[212:215], v[84:87]
    s_waitcnt lgkmcnt(2)
    v_add_f32 v5, v5, v17
    v_mfma_f32_16x16x32_bf16 v[112:115], v[24:27], a[248:251], v[112:115]
    ds_read_b128 v[40:43], v2 offset:6400
    v_mfma_f32_16x16x32_bf16 v[112:115], v[28:31], a[252:255], v[112:115]
    v_exp_f32 v19, v67
    v_cvt_pk_bf16_f32 v64, v16, v17
    v_mfma_f32_16x16x32_bf16 v[116:119], v[24:27], v[208:211], v[116:119]
    s_add_u32 s27, s27, 24576
    ds_read_b128 v[44:47], v3 offset:6400
    s_add_u32 s56, s56, 36864
    v_mfma_f32_16x16x32_bf16 v[116:119], v[28:31], v[212:215], v[116:119]
    s_waitcnt lgkmcnt(2)
    v_exp_f32 v16, v96
    v_mfma_f32_16x16x32_bf16 v[80:83], v[32:35], v[192:195], v[80:83]
    s_sub_u32 s58, s56, 147456
    ds_read_b128 v[24:27], v2 offset:12288
    v_add_f32 v5, v5, v18
    v_mfma_f32_16x16x32_bf16 v[80:83], v[36:39], v[196:199], v[80:83]
    s_min_u32 s56, s56, s58
    v_add_f32 v5, v5, v19
    v_mfma_f32_16x16x32_bf16 v[84:87], v[32:35], v[216:219], v[84:87]
    ds_read_b128 v[28:31], v3 offset:12288
    v_mfma_f32_16x16x32_bf16 v[84:87], v[36:39], v[220:223], v[84:87]
    s_waitcnt lgkmcnt(2)
    v_exp_f32 v17, v97
    v_cvt_pk_bf16_f32 v65, v18, v19
    v_mfma_f32_16x16x32_bf16 v[112:115], v[40:43], v[192:195], v[112:115]
    ds_read_b128 v[32:35], v2 offset:18432
    v_mfma_f32_16x16x32_bf16 v[112:115], v[44:47], v[196:199], v[112:115]
    v_exp_f32 v18, v98
    v_mfma_f32_16x16x32_bf16 v[116:119], v[40:43], v[216:219], v[116:119]
    ds_read_b128 v[36:39], v3 offset:18432
    v_add_f32 v5, v5, v16
    v_mfma_f32_16x16x32_bf16 v[116:119], v[44:47], v[220:223], v[116:119]
    s_waitcnt lgkmcnt(2)
    v_add_f32 v5, v5, v17
    v_mfma_f32_16x16x32_bf16 v[88:91], v[24:27], a[240:243], v[136:139]
    ds_read_b128 v[40:43], v2 offset:12416
    v_mfma_f32_16x16x32_bf16 v[88:91], v[28:31], a[244:247], v[88:91]
    v_exp_f32 v19, v99
    v_cvt_pk_bf16_f32 v66, v16, v17
    v_mfma_f32_16x16x32_bf16 v[92:95], v[24:27], v[200:203], v[140:143]
    ds_read_b128 v[44:47], v3 offset:12416
    v_mfma_f32_16x16x32_bf16 v[92:95], v[28:31], v[204:207], v[92:95]
    s_waitcnt lgkmcnt(2)
    v_exp_f32 v16, v68
    v_mfma_f32_16x16x32_bf16 v[120:123], v[32:35], a[240:243], v[136:139]
    ds_read_b128 v[24:27], v2 offset:18560
    v_add_f32 v5, v5, v18
    v_mfma_f32_16x16x32_bf16 v[120:123], v[36:39], a[244:247], v[120:123]
    v_add_f32 v5, v5, v19
    v_mfma_f32_16x16x32_bf16 v[124:127], v[32:35], v[200:203], v[140:143]
    ds_read_b128 v[28:31], v3 offset:18560
    v_mfma_f32_16x16x32_bf16 v[124:127], v[36:39], v[204:207], v[124:127]
    s_waitcnt lgkmcnt(2)
    v_exp_f32 v17, v69
    v_cvt_pk_bf16_f32 v67, v18, v19
    v_mfma_f32_16x16x32_bf16 v[88:91], v[40:43], a[248:251], v[88:91]
    ds_read_b128 v[32:35], v2 offset:12544
    v_mfma_f32_16x16x32_bf16 v[88:91], v[44:47], a[252:255], v[88:91]
    v_exp_f32 v18, v70
    v_mfma_f32_16x16x32_bf16 v[92:95], v[40:43], v[208:211], v[92:95]
    ds_read_b128 v[36:39], v3 offset:12544
    v_add_f32 v6, v6, v16
    v_mfma_f32_16x16x32_bf16 v[92:95], v[44:47], v[212:215], v[92:95]
    s_waitcnt lgkmcnt(2)
    v_add_f32 v6, v6, v17
    v_mfma_f32_16x16x32_bf16 v[120:123], v[24:27], a[248:251], v[120:123]
    ds_read_b128 v[40:43], v2 offset:18688
    v_mfma_f32_16x16x32_bf16 v[120:123], v[28:31], a[252:255], v[120:123]
    v_exp_f32 v19, v71
    v_cvt_pk_bf16_f32 v68, v16, v17
    v_mfma_f32_16x16x32_bf16 v[124:127], v[24:27], v[208:211], v[124:127]
    ds_read_b128 v[44:47], v3 offset:18688
    v_mfma_f32_16x16x32_bf16 v[124:127], v[28:31], v[212:215], v[124:127]
    s_waitcnt lgkmcnt(2)
    v_add_u32 v1, 49152, v1
    v_exp_f32 v16, v100
    v_mfma_f32_16x16x32_bf16 v[88:91], v[32:35], v[192:195], v[88:91]
    ds_read_b128 v[24:27], v1 offset:0
    v_add_f32 v6, v6, v18
    v_mfma_f32_16x16x32_bf16 v[88:91], v[36:39], v[196:199], v[88:91]
    v_add_f32 v6, v6, v19
    v_mfma_f32_16x16x32_bf16 v[92:95], v[32:35], v[216:219], v[92:95]
    ds_read_b128 v[28:31], v1 offset:12288
    v_mfma_f32_16x16x32_bf16 v[92:95], v[36:39], v[220:223], v[92:95]
    s_waitcnt lgkmcnt(2)
    v_exp_f32 v17, v101
    v_cvt_pk_bf16_f32 v69, v18, v19
    v_mfma_f32_16x16x32_bf16 v[120:123], v[40:43], v[192:195], v[120:123]
    ds_read_b128 v[32:35], v1 offset:1024
    v_mfma_f32_16x16x32_bf16 v[120:123], v[44:47], v[196:199], v[120:123]
    v_exp_f32 v18, v102
    v_mfma_f32_16x16x32_bf16 v[124:127], v[40:43], v[216:219], v[124:127]
    ds_read_b128 v[36:39], v1 offset:13312
    v_add_f32 v6, v6, v16
    v_mfma_f32_16x16x32_bf16 v[124:127], v[44:47], v[220:223], v[124:127]
    s_waitcnt lgkmcnt(2)
    v_add_f32 v6, v6, v17
    v_exp_f32 v19, v103
    v_cvt_pk_bf16_f32 v70, v16, v17
    v_add_f32 v6, v6, v18
    v_add_f32 v6, v6, v19
    v_cvt_pk_bf16_f32 v71, v18, v19
    v_mfma_f32_16x16x32_bf16 a[0:3], v[160:163], v[24:27], a[0:3]
    ds_read_b128 v[40:43], v1 offset:2048
    v_mfma_f32_16x16x32_bf16 a[0:3], v[168:171], v[28:31], a[0:3]
    v_exp_f32 v16, v72
    v_mfma_f32_16x16x32_bf16 a[48:51], v[164:167], v[24:27], a[48:51]
    ds_read_b128 v[44:47], v1 offset:14336
    v_mfma_f32_16x16x32_bf16 a[48:51], v[172:175], v[28:31], a[48:51]
    s_waitcnt lgkmcnt(2)
    v_exp_f32 v17, v73
    v_mfma_f32_16x16x32_bf16 a[4:7], v[160:163], v[32:35], a[4:7]
    ds_read_b128 v[24:27], v1 offset:3072
    v_mfma_f32_16x16x32_bf16 a[4:7], v[168:171], v[36:39], a[4:7]
    v_exp_f32 v18, v74
    v_mfma_f32_16x16x32_bf16 a[52:55], v[164:167], v[32:35], a[52:55]
    ds_read_b128 v[28:31], v1 offset:15360
    v_add_f32 v5, v5, v16
    v_mfma_f32_16x16x32_bf16 a[52:55], v[172:175], v[36:39], a[52:55]
    s_waitcnt lgkmcnt(2)
    v_add_f32 v5, v5, v17
    v_mfma_f32_16x16x32_bf16 a[8:11], v[160:163], v[40:43], a[8:11]
    ds_read_b128 v[32:35], v1 offset:4096
    v_mfma_f32_16x16x32_bf16 a[8:11], v[168:171], v[44:47], a[8:11]
    v_exp_f32 v19, v75
    v_mfma_f32_16x16x32_bf16 a[56:59], v[164:167], v[40:43], a[56:59]
    ds_read_b128 v[36:39], v1 offset:16384
    v_cvt_pk_bf16_f32 v72, v16, v17
    v_mfma_f32_16x16x32_bf16 a[56:59], v[172:175], v[44:47], a[56:59]
    s_waitcnt lgkmcnt(2)
    v_exp_f32 v16, v104
    v_mfma_f32_16x16x32_bf16 a[12:15], v[160:163], v[24:27], a[12:15]
    ds_read_b128 v[40:43], v1 offset:5120
    v_add_f32 v5, v5, v18
    v_mfma_f32_16x16x32_bf16 a[12:15], v[168:171], v[28:31], a[12:15]
    v_add_f32 v5, v5, v19
    v_mfma_f32_16x16x32_bf16 a[60:63], v[164:167], v[24:27], a[60:63]
    ds_read_b128 v[44:47], v1 offset:17408
    v_mfma_f32_16x16x32_bf16 a[60:63], v[172:175], v[28:31], a[60:63]
    s_waitcnt lgkmcnt(2)
    v_exp_f32 v17, v105
    v_mfma_f32_16x16x32_bf16 a[16:19], v[160:163], v[32:35], a[16:19]
    ds_read_b128 v[24:27], v1 offset:6144
    v_cvt_pk_bf16_f32 v73, v18, v19
    v_mfma_f32_16x16x32_bf16 a[16:19], v[168:171], v[36:39], a[16:19]
    v_exp_f32 v18, v106
    v_mfma_f32_16x16x32_bf16 a[64:67], v[164:167], v[32:35], a[64:67]
    ds_read_b128 v[28:31], v1 offset:18432
    v_add_f32 v5, v5, v16
    v_mfma_f32_16x16x32_bf16 a[64:67], v[172:175], v[36:39], a[64:67]
    s_waitcnt lgkmcnt(2)
    v_add_f32 v5, v5, v17
    v_mfma_f32_16x16x32_bf16 a[20:23], v[160:163], v[40:43], a[20:23]
    ds_read_b128 v[32:35], v1 offset:7168
    v_mfma_f32_16x16x32_bf16 a[20:23], v[168:171], v[44:47], a[20:23]
    v_exp_f32 v19, v107
    v_mfma_f32_16x16x32_bf16 a[68:71], v[164:167], v[40:43], a[68:71]
    ds_read_b128 v[36:39], v1 offset:19456
    v_cvt_pk_bf16_f32 v74, v16, v17
    v_mfma_f32_16x16x32_bf16 a[68:71], v[172:175], v[44:47], a[68:71]
    s_waitcnt lgkmcnt(2)
    v_exp_f32 v16, v76
    v_mfma_f32_16x16x32_bf16 a[24:27], v[160:163], v[24:27], a[24:27]
    ds_read_b128 v[40:43], v1 offset:8192
    v_add_f32 v5, v5, v18
    v_mfma_f32_16x16x32_bf16 a[24:27], v[168:171], v[28:31], a[24:27]
    v_add_f32 v5, v5, v19
    v_mfma_f32_16x16x32_bf16 a[72:75], v[164:167], v[24:27], a[72:75]
    ds_read_b128 v[44:47], v1 offset:20480
    v_mfma_f32_16x16x32_bf16 a[72:75], v[172:175], v[28:31], a[72:75]
    s_waitcnt lgkmcnt(2)
    v_exp_f32 v17, v77
    v_mfma_f32_16x16x32_bf16 a[28:31], v[160:163], v[32:35], a[28:31]
    ds_read_b128 v[24:27], v1 offset:9216
    v_cvt_pk_bf16_f32 v75, v18, v19
    v_mfma_f32_16x16x32_bf16 a[28:31], v[168:171], v[36:39], a[28:31]
    v_exp_f32 v18, v78
    v_mfma_f32_16x16x32_bf16 a[76:79], v[164:167], v[32:35], a[76:79]
    ds_read_b128 v[28:31], v1 offset:21504
    v_add_f32 v6, v6, v16
    v_mfma_f32_16x16x32_bf16 a[76:79], v[172:175], v[36:39], a[76:79]
    s_waitcnt lgkmcnt(2)
    v_add_f32 v6, v6, v17
    v_mfma_f32_16x16x32_bf16 a[32:35], v[160:163], v[40:43], a[32:35]
    ds_read_b128 v[32:35], v1 offset:10240
    v_mfma_f32_16x16x32_bf16 a[32:35], v[168:171], v[44:47], a[32:35]
    v_exp_f32 v19, v79
    v_mfma_f32_16x16x32_bf16 a[80:83], v[164:167], v[40:43], a[80:83]
    ds_read_b128 v[36:39], v1 offset:22528
    v_cvt_pk_bf16_f32 v76, v16, v17
    v_mfma_f32_16x16x32_bf16 a[80:83], v[172:175], v[44:47], a[80:83]
    s_waitcnt lgkmcnt(2)
    v_exp_f32 v16, v108
    v_mfma_f32_16x16x32_bf16 a[36:39], v[160:163], v[24:27], a[36:39]
    ds_read_b128 v[40:43], v1 offset:11264
    v_add_f32 v6, v6, v18
    v_mfma_f32_16x16x32_bf16 a[36:39], v[168:171], v[28:31], a[36:39]
    v_add_f32 v6, v6, v19
    v_mfma_f32_16x16x32_bf16 a[84:87], v[164:167], v[24:27], a[84:87]
    ds_read_b128 v[44:47], v1 offset:23552
    v_mfma_f32_16x16x32_bf16 a[84:87], v[172:175], v[28:31], a[84:87]
    s_waitcnt lgkmcnt(2)
    v_subrev_u32 v1, 98304, v1
    v_mfma_f32_16x16x32_bf16 a[40:43], v[160:163], v[32:35], a[40:43]
    ds_read_b128 v[24:27], v1 offset:0
    v_mfma_f32_16x16x32_bf16 a[40:43], v[168:171], v[36:39], a[40:43]
    v_exp_f32 v17, v109
    v_mfma_f32_16x16x32_bf16 a[88:91], v[164:167], v[32:35], a[88:91]
    ds_read_b128 v[28:31], v1 offset:12288
    v_cvt_pk_bf16_f32 v77, v18, v19
    v_mfma_f32_16x16x32_bf16 a[88:91], v[172:175], v[36:39], a[88:91]
    s_waitcnt lgkmcnt(2)
    v_exp_f32 v18, v110
    v_mfma_f32_16x16x32_bf16 a[44:47], v[160:163], v[40:43], a[44:47]
    ds_read_b128 v[32:35], v1 offset:1024
    v_add_f32 v6, v6, v16
    v_mfma_f32_16x16x32_bf16 a[44:47], v[168:171], v[44:47], a[44:47]
    v_add_f32 v6, v6, v17
    v_mfma_f32_16x16x32_bf16 a[92:95], v[164:167], v[40:43], a[92:95]
    ds_read_b128 v[36:39], v1 offset:13312
    v_mfma_f32_16x16x32_bf16 a[92:95], v[172:175], v[44:47], a[92:95]
    s_waitcnt lgkmcnt(2)
    v_exp_f32 v19, v111
    v_mfma_f32_16x16x32_bf16 a[0:3], v[176:179], v[24:27], a[0:3]
    ds_read_b128 v[40:43], v1 offset:2048
    v_cvt_pk_bf16_f32 v78, v16, v17
    v_mfma_f32_16x16x32_bf16 a[0:3], v[184:187], v[28:31], a[0:3]
    v_add_f32 v6, v6, v18
    v_add_f32 v6, v6, v19
    v_mfma_f32_16x16x32_bf16 a[48:51], v[180:183], v[24:27], a[48:51]
    ds_read_b128 v[44:47], v1 offset:14336
    v_cvt_pk_bf16_f32 v79, v18, v19
    v_mfma_f32_16x16x32_bf16 a[48:51], v[188:191], v[28:31], a[48:51]
    s_waitcnt lgkmcnt(2)
    v_exp_f32 v16, v80
    v_mfma_f32_16x16x32_bf16 a[4:7], v[176:179], v[32:35], a[4:7]
    ds_read_b128 v[24:27], v1 offset:3072
    v_mfma_f32_16x16x32_bf16 a[4:7], v[184:187], v[36:39], a[4:7]
    v_exp_f32 v17, v81
    v_mfma_f32_16x16x32_bf16 a[52:55], v[180:183], v[32:35], a[52:55]
    ds_read_b128 v[28:31], v1 offset:15360
    v_mfma_f32_16x16x32_bf16 a[52:55], v[188:191], v[36:39], a[52:55]
    s_waitcnt lgkmcnt(2)
    v_exp_f32 v18, v82
    v_mfma_f32_16x16x32_bf16 a[8:11], v[176:179], v[40:43], a[8:11]
    ds_read_b128 v[32:35], v1 offset:4096
    v_add_f32 v7, v7, v16
    v_mfma_f32_16x16x32_bf16 a[8:11], v[184:187], v[44:47], a[8:11]
    v_add_f32 v7, v7, v17
    v_mfma_f32_16x16x32_bf16 a[56:59], v[180:183], v[40:43], a[56:59]
    ds_read_b128 v[36:39], v1 offset:16384
    v_mfma_f32_16x16x32_bf16 a[56:59], v[188:191], v[44:47], a[56:59]
    s_waitcnt lgkmcnt(2)
    v_exp_f32 v19, v83
    v_mfma_f32_16x16x32_bf16 a[12:15], v[176:179], v[24:27], a[12:15]
    ds_read_b128 v[40:43], v1 offset:5120
    v_cvt_pk_bf16_f32 v80, v16, v17
    v_mfma_f32_16x16x32_bf16 a[12:15], v[184:187], v[28:31], a[12:15]
    v_exp_f32 v16, v112
    v_mfma_f32_16x16x32_bf16 a[60:63], v[180:183], v[24:27], a[60:63]
    ds_read_b128 v[44:47], v1 offset:17408
    v_add_f32 v7, v7, v18
    v_mfma_f32_16x16x32_bf16 a[60:63], v[188:191], v[28:31], a[60:63]
    s_waitcnt lgkmcnt(2)
    v_add_f32 v7, v7, v19
    v_mfma_f32_16x16x32_bf16 a[16:19], v[176:179], v[32:35], a[16:19]
    ds_read_b128 v[24:27], v1 offset:6144
    v_mfma_f32_16x16x32_bf16 a[16:19], v[184:187], v[36:39], a[16:19]
    v_exp_f32 v17, v113
    v_mfma_f32_16x16x32_bf16 a[64:67], v[180:183], v[32:35], a[64:67]
    ds_read_b128 v[28:31], v1 offset:18432
    v_cvt_pk_bf16_f32 v81, v18, v19
    v_mfma_f32_16x16x32_bf16 a[64:67], v[188:191], v[36:39], a[64:67]
    s_waitcnt lgkmcnt(2)
    v_exp_f32 v18, v114
    v_mfma_f32_16x16x32_bf16 a[20:23], v[176:179], v[40:43], a[20:23]
    ds_read_b128 v[32:35], v1 offset:7168
    v_add_f32 v7, v7, v16
    v_mfma_f32_16x16x32_bf16 a[20:23], v[184:187], v[44:47], a[20:23]
    v_add_f32 v7, v7, v17
    v_mfma_f32_16x16x32_bf16 a[68:71], v[180:183], v[40:43], a[68:71]
    ds_read_b128 v[36:39], v1 offset:19456
    v_mfma_f32_16x16x32_bf16 a[68:71], v[188:191], v[44:47], a[68:71]
    s_waitcnt lgkmcnt(2)
    v_exp_f32 v19, v115
    v_mfma_f32_16x16x32_bf16 a[24:27], v[176:179], v[24:27], a[24:27]
    ds_read_b128 v[40:43], v1 offset:8192
    v_cvt_pk_bf16_f32 v82, v16, v17
    v_mfma_f32_16x16x32_bf16 a[24:27], v[184:187], v[28:31], a[24:27]
    v_exp_f32 v16, v84
    v_mfma_f32_16x16x32_bf16 a[72:75], v[180:183], v[24:27], a[72:75]
    ds_read_b128 v[44:47], v1 offset:20480
    v_add_f32 v7, v7, v18
    v_mfma_f32_16x16x32_bf16 a[72:75], v[188:191], v[28:31], a[72:75]
    s_waitcnt lgkmcnt(2)
    v_add_f32 v7, v7, v19
    v_mfma_f32_16x16x32_bf16 a[28:31], v[176:179], v[32:35], a[28:31]
    ds_read_b128 v[24:27], v1 offset:9216
    v_mfma_f32_16x16x32_bf16 a[28:31], v[184:187], v[36:39], a[28:31]
    s_waitcnt vmcnt(0)
    v_exp_f32 v17, v85
    v_mfma_f32_16x16x32_bf16 a[76:79], v[180:183], v[32:35], a[76:79]
    ds_read_b128 v[28:31], v1 offset:21504
    v_cvt_pk_bf16_f32 v83, v18, v19
    v_mfma_f32_16x16x32_bf16 a[76:79], v[188:191], v[36:39], a[76:79]
    s_waitcnt lgkmcnt(2)
    s_barrier
    v_mfma_f32_16x16x32_bf16 a[32:35], v[176:179], v[40:43], a[32:35]
    ds_read_b128 v[32:35], v1 offset:10240
    v_mfma_f32_16x16x32_bf16 a[32:35], v[184:187], v[44:47], a[32:35]
    v_exp_f32 v18, v86
    v_mfma_f32_16x16x32_bf16 a[80:83], v[180:183], v[40:43], a[80:83]
    ds_read_b128 v[36:39], v1 offset:22528
    v_add_f32 v8, v8, v16
    v_mfma_f32_16x16x32_bf16 a[80:83], v[188:191], v[44:47], a[80:83]
    s_waitcnt lgkmcnt(2)
    v_add_f32 v8, v8, v17
    v_mfma_f32_16x16x32_bf16 a[36:39], v[176:179], v[24:27], a[36:39]
    ds_read_b128 v[40:43], v1 offset:11264
    v_mfma_f32_16x16x32_bf16 a[36:39], v[184:187], v[28:31], a[36:39]
    v_exp_f32 v19, v87
    v_cvt_pk_bf16_f32 v84, v16, v17
    v_mfma_f32_16x16x32_bf16 a[84:87], v[180:183], v[24:27], a[84:87]
    ds_read_b128 v[44:47], v1 offset:23552
    v_mfma_f32_16x16x32_bf16 a[84:87], v[188:191], v[28:31], a[84:87]
    s_waitcnt lgkmcnt(2)
    v_add_u32 v1, 49152, v1
    v_exp_f32 v16, v116
    v_mfma_f32_16x16x32_bf16 a[40:43], v[176:179], v[32:35], a[40:43]
    ds_read_b128 v[24:27], v1 offset:0
    v_add_f32 v8, v8, v18
    v_mfma_f32_16x16x32_bf16 a[40:43], v[184:187], v[36:39], a[40:43]
    v_add_f32 v8, v8, v19
    v_mfma_f32_16x16x32_bf16 a[88:91], v[180:183], v[32:35], a[88:91]
    ds_read_b128 v[28:31], v1 offset:12288
    v_mfma_f32_16x16x32_bf16 a[88:91], v[188:191], v[36:39], a[88:91]
    s_waitcnt lgkmcnt(2)
    v_exp_f32 v17, v117
    v_cvt_pk_bf16_f32 v85, v18, v19
    v_mfma_f32_16x16x32_bf16 a[44:47], v[176:179], v[40:43], a[44:47]
    ds_read_b128 v[32:35], v1 offset:1024
    v_mfma_f32_16x16x32_bf16 a[44:47], v[184:187], v[44:47], a[44:47]
    v_exp_f32 v18, v118
    v_mfma_f32_16x16x32_bf16 a[92:95], v[180:183], v[40:43], a[92:95]
    ds_read_b128 v[36:39], v1 offset:13312
    v_add_f32 v8, v8, v16
    v_mfma_f32_16x16x32_bf16 a[92:95], v[188:191], v[44:47], a[92:95]
    s_waitcnt lgkmcnt(2)
    v_add_f32 v8, v8, v17
    v_exp_f32 v19, v119
    v_cvt_pk_bf16_f32 v86, v16, v17
    v_add_f32 v8, v8, v18
    v_add_f32 v8, v8, v19
    v_cvt_pk_bf16_f32 v87, v18, v19
    v_mfma_f32_16x16x32_bf16 a[0:3], v[64:67], v[24:27], a[0:3]
    ds_read_b128 v[40:43], v1 offset:2048
    v_mfma_f32_16x16x32_bf16 a[0:3], v[72:75], v[28:31], a[0:3]
    v_exp_f32 v16, v88
    v_exp_f32 v17, v89
    v_exp_f32 v18, v90
    v_mfma_f32_16x16x4_f32 v[48:51], v5, v57, 0
    v_mfma_f32_16x16x32_bf16 a[48:51], v[68:71], v[24:27], a[48:51]
    ds_read_b128 v[44:47], v1 offset:14336
    v_mfma_f32_16x16x32_bf16 a[48:51], v[76:79], v[28:31], a[48:51]
    s_waitcnt lgkmcnt(2)
    v_exp_f32 v19, v91
    v_cvt_pk_bf16_f32 v88, v16, v17
    v_exp_f32 v16, v120
    v_mfma_f32_16x16x4_f32 v[52:55], v6, v57, 0
    v_mfma_f32_16x16x32_bf16 a[4:7], v[64:67], v[32:35], a[4:7]
    ds_read_b128 v[24:27], v1 offset:3072
    v_mfma_f32_16x16x32_bf16 a[4:7], v[72:75], v[36:39], a[4:7]
    v_exp_f32 v17, v121
    v_cvt_pk_bf16_f32 v89, v18, v19
    v_mfma_f32_16x16x32_bf16 a[52:55], v[68:71], v[32:35], a[52:55]
    ds_read_b128 v[28:31], v1 offset:15360
    v_mfma_f32_16x16x32_bf16 a[52:55], v[76:79], v[36:39], a[52:55]
    s_waitcnt lgkmcnt(2)
    v_exp_f32 v18, v122
    v_mfma_f32_16x16x32_bf16 a[8:11], v[64:67], v[40:43], a[8:11]
    ds_read_b128 v[32:35], v1 offset:4096
    v_mfma_f32_16x16x32_bf16 a[8:11], v[72:75], v[44:47], a[8:11]
    v_exp_f32 v19, v123
    v_mfma_f32_16x16x32_bf16 a[56:59], v[68:71], v[40:43], a[56:59]
    ds_read_b128 v[36:39], v1 offset:16384
    v_cvt_pk_bf16_f32 v90, v16, v17
    v_mfma_f32_16x16x32_bf16 a[56:59], v[76:79], v[44:47], a[56:59]
    s_waitcnt lgkmcnt(2)
    v_exp_f32 v16, v92
    v_mfma_f32_16x16x32_bf16 a[12:15], v[64:67], v[24:27], a[12:15]
    ds_read_b128 v[40:43], v1 offset:5120
    v_mfma_f32_16x16x32_bf16 a[12:15], v[72:75], v[28:31], a[12:15]
    v_exp_f32 v17, v93
    v_mfma_f32_16x16x32_bf16 a[60:63], v[68:71], v[24:27], a[60:63]
    ds_read_b128 v[44:47], v1 offset:17408
    v_cvt_pk_bf16_f32 v91, v18, v19
    v_mfma_f32_16x16x32_bf16 a[60:63], v[76:79], v[28:31], a[60:63]
    s_waitcnt lgkmcnt(2)
    v_exp_f32 v18, v94
    v_mfma_f32_16x16x32_bf16 a[16:19], v[64:67], v[32:35], a[16:19]
    ds_read_b128 v[24:27], v1 offset:6144
    v_mfma_f32_16x16x32_bf16 a[16:19], v[72:75], v[36:39], a[16:19]
    v_exp_f32 v19, v95
    v_mfma_f32_16x16x32_bf16 a[64:67], v[68:71], v[32:35], a[64:67]
    ds_read_b128 v[28:31], v1 offset:18432
    v_mfma_f32_16x16x32_bf16 a[64:67], v[76:79], v[36:39], a[64:67]
    s_waitcnt lgkmcnt(2)
    v_mfma_f32_16x16x32_bf16 v[128:131], v[88:91], v[20:23], 0
    v_mfma_f32_16x16x32_bf16 a[20:23], v[64:67], v[40:43], a[20:23]
    ds_read_b128 v[32:35], v1 offset:7168
    v_cvt_pk_bf16_f32 v92, v16, v17
    v_mfma_f32_16x16x32_bf16 a[20:23], v[72:75], v[44:47], a[20:23]
    v_exp_f32 v16, v124
    v_mfma_f32_16x16x32_bf16 a[68:71], v[68:71], v[40:43], a[68:71]
    ds_read_b128 v[36:39], v1 offset:19456
    v_mfma_f32_16x16x32_bf16 a[68:71], v[76:79], v[44:47], a[68:71]
    s_waitcnt lgkmcnt(2)
    v_exp_f32 v17, v125
    v_mfma_f32_16x16x32_bf16 a[24:27], v[64:67], v[24:27], a[24:27]
    ds_read_b128 v[40:43], v1 offset:8192
    v_cvt_pk_bf16_f32 v93, v18, v19
    v_mfma_f32_16x16x32_bf16 a[24:27], v[72:75], v[28:31], a[24:27]
L_pg12:
    s_cbranch_execz L_iwret
    v_exp_f32 v18, v126
    v_mfma_f32_16x16x32_bf16 a[72:75], v[68:71], v[24:27], a[72:75]
    ds_read_b128 v[44:47], v1 offset:20480
    v_mfma_f32_16x16x32_bf16 a[72:75], v[76:79], v[28:31], a[72:75]
    s_waitcnt lgkmcnt(2)
    v_exp_f32 v19, v127
    v_mfma_f32_16x16x32_bf16 a[28:31], v[64:67], v[32:35], a[28:31]
    ds_read_b128 v[24:27], v1 offset:9216
    v_cvt_pk_bf16_f32 v94, v16, v17
    v_mfma_f32_16x16x32_bf16 a[28:31], v[72:75], v[36:39], a[28:31]
    v_cvt_pk_bf16_f32 v95, v18, v19
    s_nop 1
    v_mfma_f32_16x16x32_bf16 a[76:79], v[68:71], v[32:35], a[76:79]
    ds_read_b128 v[28:31], v1 offset:21504
    v_mfma_f32_16x16x32_bf16 a[76:79], v[76:79], v[36:39], a[76:79]
    s_waitcnt lgkmcnt(2)
    v_mfma_f32_16x16x32_bf16 v[132:135], v[92:95], v[20:23], 0
    v_mfma_f32_16x16x32_bf16 a[32:35], v[64:67], v[40:43], a[32:35]
    ds_read_b128 v[32:35], v1 offset:10240
    v_mfma_f32_16x16x32_bf16 a[32:35], v[72:75], v[44:47], a[32:35]
    v_rcp_f32 v48, v48
    v_mfma_f32_16x16x32_bf16 a[80:83], v[68:71], v[40:43], a[80:83]
    ds_read_b128 v[36:39], v1 offset:22528
    v_mfma_f32_16x16x32_bf16 a[80:83], v[76:79], v[44:47], a[80:83]
    s_waitcnt lgkmcnt(2)
    v_rcp_f32 v49, v49
    v_mfma_f32_16x16x32_bf16 a[36:39], v[64:67], v[24:27], a[36:39]
    ds_read_b128 v[40:43], v1 offset:11264
    v_mfma_f32_16x16x32_bf16 a[36:39], v[72:75], v[28:31], a[36:39]
    v_rcp_f32 v50, v50
    v_mfma_f32_16x16x32_bf16 a[84:87], v[68:71], v[24:27], a[84:87]
    ds_read_b128 v[44:47], v1 offset:23552
    v_mfma_f32_16x16x32_bf16 a[84:87], v[76:79], v[28:31], a[84:87]
    s_waitcnt lgkmcnt(2)
    v_subrev_u32 v2, 98304, v2
    v_subrev_u32 v3, 98304, v3
    v_mfma_f32_16x16x32_bf16 a[40:43], v[64:67], v[32:35], a[40:43]
    ds_read_b128 v[24:27], v2 offset:0
    v_mfma_f32_16x16x32_bf16 a[40:43], v[72:75], v[36:39], a[40:43]
    v_rcp_f32 v51, v51
    v_mfma_f32_16x16x32_bf16 a[88:91], v[68:71], v[32:35], a[88:91]
    ds_read_b128 v[28:31], v3 offset:0
    v_mfma_f32_16x16x32_bf16 a[88:91], v[76:79], v[36:39], a[88:91]
    s_waitcnt lgkmcnt(2)
    v_rcp_f32 v52, v52
    v_mfma_f32_16x16x32_bf16 a[44:47], v[64:67], v[40:43], a[44:47]
    ds_read_b128 v[32:35], v2 offset:6144
    v_mfma_f32_16x16x32_bf16 a[44:47], v[72:75], v[44:47], a[44:47]
    v_rcp_f32 v53, v53
    v_mfma_f32_16x16x32_bf16 a[92:95], v[68:71], v[40:43], a[92:95]
    ds_read_b128 v[36:39], v3 offset:6144
    v_mfma_f32_16x16x32_bf16 a[92:95], v[76:79], v[44:47], a[92:95]
    s_waitcnt lgkmcnt(2)
    v_rcp_f32 v54, v54
    v_mfma_f32_16x16x32_bf16 v[160:163], v[24:27], a[240:243], v[136:139]
    ds_read_b128 v[40:43], v2 offset:128
    v_mfma_f32_16x16x32_bf16 v[160:163], v[28:31], a[244:247], v[160:163]
    v_rcp_f32 v55, v55
    v_mfma_f32_16x16x32_bf16 v[164:167], v[24:27], v[200:203], v[140:143]
    ds_read_b128 v[44:47], v3 offset:128
    v_mfma_f32_16x16x32_bf16 v[164:167], v[28:31], v[204:207], v[164:167]
    s_waitcnt lgkmcnt(2)
    v_mfma_f32_16x16x32_bf16 v[96:99], v[32:35], a[240:243], v[136:139]
    ds_read_b128 v[24:27], v2 offset:6272
    v_accvgpr_read_b32 v224, a0
    v_mfma_f32_16x16x32_bf16 v[96:99], v[36:39], a[244:247], v[96:99]
    v_accvgpr_read_b32 v225, a4
    v_accvgpr_read_b32 v226, a8
    v_accvgpr_read_b32 v227, a12
    v_accvgpr_read_b32 v228, a16
    v_accvgpr_read_b32 v229, a20
    v_mfma_f32_16x16x32_bf16 v[100:103], v[32:35], v[200:203], v[140:143]
    ds_read_b128 v[28:31], v3 offset:6272
    v_mul_f32 v224, v224, v48
    v_mfma_f32_16x16x32_bf16 v[100:103], v[36:39], v[204:207], v[100:103]
    s_waitcnt lgkmcnt(2)
    v_mul_f32 v225, v225, v48
    v_mul_f32 v226, v226, v48
    v_mul_f32 v227, v227, v48
    v_mul_f32 v228, v228, v48
    v_mul_f32 v229, v229, v48
    v_mfma_f32_16x16x32_bf16 v[160:163], v[40:43], a[248:251], v[160:163]
    ds_read_b128 v[32:35], v2 offset:256
    v_cvt_pk_bf16_f32 v224, v224, v225
    v_mfma_f32_16x16x32_bf16 v[160:163], v[44:47], a[252:255], v[160:163]
    v_cvt_pk_bf16_f32 v225, v226, v227
    v_cvt_pk_bf16_f32 v226, v228, v229
    v_accvgpr_read_b32 v230, a1
    v_accvgpr_read_b32 v231, a5
    v_accvgpr_read_b32 v232, a9
    v_mfma_f32_16x16x32_bf16 v[164:167], v[40:43], v[208:211], v[164:167]
    ds_read_b128 v[36:39], v3 offset:256
    v_accvgpr_read_b32 v233, a13
    v_mfma_f32_16x16x32_bf16 v[164:167], v[44:47], v[212:215], v[164:167]
    s_waitcnt lgkmcnt(2)
    buffer_store_dwordx3 v[224:226], v56, s[12:15], s24 offen offset:0 sc0 sc1
    v_accvgpr_read_b32 v234, a17
    v_accvgpr_read_b32 v235, a21
    v_mfma_f32_16x16x32_bf16 v[96:99], v[24:27], a[248:251], v[96:99]
    ds_read_b128 v[40:43], v2 offset:6400
    v_mul_f32 v230, v230, v49
    v_mfma_f32_16x16x32_bf16 v[96:99], v[28:31], a[252:255], v[96:99]
    v_mul_f32 v231, v231, v49
    v_mul_f32 v232, v232, v49
    v_mul_f32 v233, v233, v49
    v_mul_f32 v234, v234, v49
    v_mul_f32 v235, v235, v49
    v_mfma_f32_16x16x32_bf16 v[100:103], v[24:27], v[208:211], v[100:103]
    ds_read_b128 v[44:47], v3 offset:6400
    v_cvt_pk_bf16_f32 v230, v230, v231
    v_mfma_f32_16x16x32_bf16 v[100:103], v[28:31], v[212:215], v[100:103]
    s_waitcnt lgkmcnt(2)
    v_cvt_pk_bf16_f32 v231, v232, v233
    v_cvt_pk_bf16_f32 v232, v234, v235
    v_accvgpr_read_b32 v236, a2
    v_accvgpr_read_b32 v237, a6
    v_accvgpr_read_b32 v238, a10
    v_mfma_f32_16x16x32_bf16 v[160:163], v[32:35], v[192:195], v[160:163]
    ds_read_b128 v[24:27], v2 offset:12288
    v_accvgpr_read_b32 v239, a14
    v_mfma_f32_16x16x32_bf16 v[160:163], v[36:39], v[196:199], v[160:163]
    buffer_store_dwordx3 v[230:232], v56, s[12:15], s24 offen offset:384 sc0 sc1
    v_accvgpr_read_b32 v240, a18
    v_accvgpr_read_b32 v241, a22
    v_mfma_f32_16x16x32_bf16 v[164:167], v[32:35], v[216:219], v[164:167]
    ds_read_b128 v[28:31], v3 offset:12288
    v_mul_f32 v236, v236, v50
    v_mfma_f32_16x16x32_bf16 v[164:167], v[36:39], v[220:223], v[164:167]
    s_waitcnt lgkmcnt(2)
    v_mul_f32 v237, v237, v50
    v_mul_f32 v238, v238, v50
    v_mul_f32 v239, v239, v50
    v_mul_f32 v240, v240, v50
    v_mul_f32 v241, v241, v50
    v_mfma_f32_16x16x32_bf16 v[96:99], v[40:43], v[192:195], v[96:99]
    ds_read_b128 v[32:35], v2 offset:18432
    v_cvt_pk_bf16_f32 v236, v236, v237
    v_mfma_f32_16x16x32_bf16 v[96:99], v[44:47], v[196:199], v[96:99]
    v_cvt_pk_bf16_f32 v237, v238, v239
    v_cvt_pk_bf16_f32 v238, v240, v241
    v_accvgpr_read_b32 v242, a3
    v_accvgpr_read_b32 v243, a7
    v_accvgpr_read_b32 v244, a11
    v_mfma_f32_16x16x32_bf16 v[100:103], v[40:43], v[216:219], v[100:103]
    ds_read_b128 v[36:39], v3 offset:18432
    v_accvgpr_read_b32 v245, a15
    v_mfma_f32_16x16x32_bf16 v[100:103], v[44:47], v[220:223], v[100:103]
    s_waitcnt lgkmcnt(2)
    buffer_store_dwordx3 v[236:238], v56, s[12:15], s24 offen offset:768 sc0 sc1
    v_accvgpr_read_b32 v246, a19
    v_accvgpr_read_b32 v247, a23
    v_mfma_f32_16x16x32_bf16 v[168:171], v[24:27], a[240:243], v[136:139]
    ds_read_b128 v[40:43], v2 offset:12416
    v_mul_f32 v242, v242, v51
    v_mfma_f32_16x16x32_bf16 v[168:171], v[28:31], a[244:247], v[168:171]
    v_mul_f32 v243, v243, v51
    v_mul_f32 v244, v244, v51
    v_mul_f32 v245, v245, v51
    v_mul_f32 v246, v246, v51
    v_mul_f32 v247, v247, v51
    v_mfma_f32_16x16x32_bf16 v[172:175], v[24:27], v[200:203], v[140:143]
    ds_read_b128 v[44:47], v3 offset:12416
    v_cvt_pk_bf16_f32 v242, v242, v243
    v_mfma_f32_16x16x32_bf16 v[172:175], v[28:31], v[204:207], v[172:175]
    s_waitcnt lgkmcnt(2)
    v_cvt_pk_bf16_f32 v243, v244, v245
    v_cvt_pk_bf16_f32 v244, v246, v247
    v_accvgpr_read_b32 v248, a24
    v_accvgpr_read_b32 v249, a28
    v_accvgpr_read_b32 v250, a32
    v_mfma_f32_16x16x32_bf16 v[104:107], v[32:35], a[240:243], v[136:139]
    ds_read_b128 v[24:27], v2 offset:18560
    v_accvgpr_read_b32 v251, a36
    v_mfma_f32_16x16x32_bf16 v[104:107], v[36:39], a[244:247], v[104:107]
    buffer_store_dwordx3 v[242:244], v56, s[12:15], s24 offen offset:1152 sc0 sc1
    v_accvgpr_read_b32 v252, a40
    v_accvgpr_read_b32 v253, a44
    v_mfma_f32_16x16x32_bf16 v[108:111], v[32:35], v[200:203], v[140:143]
    ds_read_b128 v[28:31], v3 offset:18560
    v_mul_f32 v248, v248, v48
    v_mfma_f32_16x16x32_bf16 v[108:111], v[36:39], v[204:207], v[108:111]
    s_waitcnt lgkmcnt(2)
    v_mul_f32 v249, v249, v48
    v_mul_f32 v250, v250, v48
    v_mul_f32 v251, v251, v48
    v_mul_f32 v252, v252, v48
    v_mul_f32 v253, v253, v48
    v_mfma_f32_16x16x32_bf16 v[168:171], v[40:43], a[248:251], v[168:171]
    ds_read_b128 v[32:35], v2 offset:12544
    v_cvt_pk_bf16_f32 v248, v248, v249
    v_mfma_f32_16x16x32_bf16 v[168:171], v[44:47], a[252:255], v[168:171]
    v_cvt_pk_bf16_f32 v249, v250, v251
    v_cvt_pk_bf16_f32 v250, v252, v253
    v_accvgpr_read_b32 v224, a25
    v_accvgpr_read_b32 v225, a29
    v_accvgpr_read_b32 v226, a33
    v_mfma_f32_16x16x32_bf16 v[172:175], v[40:43], v[208:211], v[172:175]
    ds_read_b128 v[36:39], v3 offset:12544
    v_accvgpr_read_b32 v227, a37
    v_mfma_f32_16x16x32_bf16 v[172:175], v[44:47], v[212:215], v[172:175]
    s_waitcnt lgkmcnt(2)
    buffer_store_dwordx3 v[248:250], v56, s[12:15], s24 offen offset:192 sc0 sc1
    v_accvgpr_read_b32 v228, a41
    v_mfma_f32_16x16x32_bf16 v[104:107], v[24:27], a[248:251], v[104:107]
    ds_read_b128 v[40:43], v2 offset:18688
    v_accvgpr_read_b32 v229, a45
    v_mfma_f32_16x16x32_bf16 v[104:107], v[28:31], a[252:255], v[104:107]
    v_mul_f32 v224, v224, v49
    v_mul_f32 v225, v225, v49
    v_mul_f32 v226, v226, v49
    v_mul_f32 v227, v227, v49
    v_mul_f32 v228, v228, v49
    v_mul_f32 v229, v229, v49
    v_mfma_f32_16x16x32_bf16 v[108:111], v[24:27], v[208:211], v[108:111]
    ds_read_b128 v[44:47], v3 offset:18688
    v_cvt_pk_bf16_f32 v224, v224, v225
    v_mfma_f32_16x16x32_bf16 v[108:111], v[28:31], v[212:215], v[108:111]
    s_waitcnt lgkmcnt(2)
    v_add_u32 v2, 49152, v2
    v_add_u32 v3, 49152, v3
    v_exp_f32 v16, v160
    v_cvt_pk_bf16_f32 v225, v226, v227
    v_mfma_f32_16x16x32_bf16 v[168:171], v[32:35], v[192:195], v[168:171]
    ds_read_b128 v[24:27], v2 offset:0
    v_cvt_pk_bf16_f32 v226, v228, v229
    v_mfma_f32_16x16x32_bf16 v[168:171], v[36:39], v[196:199], v[168:171]
    buffer_store_dwordx3 v[224:226], v56, s[12:15], s24 offen offset:576 sc0 sc1
    v_accvgpr_read_b32 v230, a26
    v_mfma_f32_16x16x32_bf16 v[172:175], v[32:35], v[216:219], v[172:175]
    ds_read_b128 v[28:31], v3 offset:0
    v_accvgpr_read_b32 v231, a30
    v_mfma_f32_16x16x32_bf16 v[172:175], v[36:39], v[220:223], v[172:175]
    s_waitcnt lgkmcnt(2)
    v_exp_f32 v17, v161
    v_exp_f32 v18, v162
    v_exp_f32 v19, v163
    v_mfma_f32_16x16x32_bf16 v[104:107], v[40:43], v[192:195], v[104:107]
    ds_read_b128 v[32:35], v2 offset:6144
    v_accvgpr_read_b32 v232, a34
    v_mfma_f32_16x16x32_bf16 v[104:107], v[44:47], v[196:199], v[104:107]
    v_cvt_pk_bf16_f32 v160, v16, v17
    v_accvgpr_read_b32 v233, a38
    v_accvgpr_read_b32 v234, a42
    v_exp_f32 v16, v96
    v_mfma_f32_16x16x32_bf16 v[108:111], v[40:43], v[216:219], v[108:111]
    ds_read_b128 v[36:39], v3 offset:6144
    v_accvgpr_read_b32 v235, a46
    v_mfma_f32_16x16x32_bf16 v[108:111], v[44:47], v[220:223], v[108:111]
    s_waitcnt lgkmcnt(2)
    v_mul_f32 v230, v230, v50
    v_exp_f32 v17, v97
    v_mul_f32 v231, v231, v50
    v_mul_f32 v232, v232, v50
    v_mfma_f32_16x16x32_bf16 v[176:179], v[24:27], a[240:243], v[136:139]
    ds_read_b128 v[40:43], v2 offset:128
    v_cvt_pk_bf16_f32 v161, v18, v19
    v_mfma_f32_16x16x32_bf16 v[176:179], v[28:31], a[244:247], v[176:179]
    v_mul_f32 v233, v233, v50
    v_exp_f32 v18, v98
    v_mul_f32 v234, v234, v50
    v_mul_f32 v235, v235, v50
    v_cvt_pk_bf16_f32 v230, v230, v231
    v_mfma_f32_16x16x32_bf16 v[180:183], v[24:27], v[200:203], v[140:143]
    ds_read_b128 v[44:47], v3 offset:128
    v_cvt_pk_bf16_f32 v231, v232, v233
    v_mfma_f32_16x16x32_bf16 v[180:183], v[28:31], v[204:207], v[180:183]
    s_waitcnt lgkmcnt(2)
    v_exp_f32 v19, v99
    v_cvt_pk_bf16_f32 v232, v234, v235
    v_accvgpr_read_b32 v236, a27
    v_cvt_pk_bf16_f32 v162, v16, v17
    v_mfma_f32_16x16x32_bf16 v[112:115], v[32:35], a[240:243], v[136:139]
    ds_read_b128 v[24:27], v2 offset:6272
    v_accvgpr_read_b32 v237, a31
    v_mfma_f32_16x16x32_bf16 v[112:115], v[36:39], a[244:247], v[112:115]
    buffer_store_dwordx3 v[230:232], v56, s[12:15], s24 offen offset:960 sc0 sc1
    v_accvgpr_read_b32 v238, a35
    v_mfma_f32_16x16x32_bf16 v[116:119], v[32:35], v[200:203], v[140:143]
    ds_read_b128 v[28:31], v3 offset:6272
    v_accvgpr_read_b32 v239, a39
    v_mfma_f32_16x16x32_bf16 v[116:119], v[36:39], v[204:207], v[116:119]
    s_waitcnt lgkmcnt(2)
    v_exp_f32 v16, v164
    v_exp_f32 v17, v165
    v_accvgpr_read_b32 v240, a43
    v_accvgpr_read_b32 v241, a47
    v_mfma_f32_16x16x32_bf16 v[176:179], v[40:43], a[248:251], v[176:179]
    ds_read_b128 v[32:35], v2 offset:256
    v_cvt_pk_bf16_f32 v163, v18, v19
    v_mfma_f32_16x16x32_bf16 v[176:179], v[44:47], a[252:255], v[176:179]
    v_exp_f32 v18, v166
    v_mul_f32 v236, v236, v51
    v_mul_f32 v237, v237, v51
    v_mul_f32 v238, v238, v51
    v_mfma_f32_16x16x32_bf16 v[180:183], v[40:43], v[208:211], v[180:183]
    ds_read_b128 v[36:39], v3 offset:256
    v_mul_f32 v239, v239, v51
    v_mfma_f32_16x16x32_bf16 v[180:183], v[44:47], v[212:215], v[180:183]
    s_waitcnt lgkmcnt(2)
    v_exp_f32 v19, v167
    v_mul_f32 v240, v240, v51
    v_mul_f32 v241, v241, v51
    v_cvt_pk_bf16_f32 v236, v236, v237
    v_mfma_f32_16x16x32_bf16 v[112:115], v[24:27], a[248:251], v[112:115]
    ds_read_b128 v[40:43], v2 offset:6400
    v_cvt_pk_bf16_f32 v237, v238, v239
    v_mfma_f32_16x16x32_bf16 v[112:115], v[28:31], a[252:255], v[112:115]
    v_mfma_f32_16x16x32_bf16 v[128:131], v[160:163], v[20:23], v[128:131]
    v_cvt_pk_bf16_f32 v164, v16, v17
    v_cvt_pk_bf16_f32 v238, v240, v241
    v_accvgpr_read_b32 v242, a48
    v_mfma_f32_16x16x32_bf16 v[116:119], v[24:27], v[208:211], v[116:119]
    ds_read_b128 v[44:47], v3 offset:6400
    v_accvgpr_read_b32 v243, a52
    v_mfma_f32_16x16x32_bf16 v[116:119], v[28:31], v[212:215], v[116:119]
    s_waitcnt lgkmcnt(2)
    buffer_store_dwordx3 v[236:238], v56, s[12:15], s24 offen offset:1344 sc0 sc1
    v_exp_f32 v16, v100
    v_mfma_f32_16x16x32_bf16 v[176:179], v[32:35], v[192:195], v[176:179]
    ds_read_b128 v[24:27], v2 offset:12288
    v_accvgpr_read_b32 v244, a56
    v_mfma_f32_16x16x32_bf16 v[176:179], v[36:39], v[196:199], v[176:179]
    v_exp_f32 v17, v101
    v_accvgpr_read_b32 v245, a60
    v_cvt_pk_bf16_f32 v165, v18, v19
    v_accvgpr_read_b32 v246, a64
    v_mfma_f32_16x16x32_bf16 v[180:183], v[32:35], v[216:219], v[180:183]
    ds_read_b128 v[28:31], v3 offset:12288
    v_accvgpr_read_b32 v247, a68
    v_mfma_f32_16x16x32_bf16 v[180:183], v[36:39], v[220:223], v[180:183]
    s_waitcnt lgkmcnt(2)
    v_exp_f32 v18, v102
    v_mul_f32 v242, v242, v52
    v_mul_f32 v243, v243, v52
    v_mul_f32 v244, v244, v52
    v_mfma_f32_16x16x32_bf16 v[112:115], v[40:43], v[192:195], v[112:115]
    ds_read_b128 v[32:35], v2 offset:18432
    v_mul_f32 v245, v245, v52
    v_mfma_f32_16x16x32_bf16 v[112:115], v[44:47], v[196:199], v[112:115]
    v_exp_f32 v19, v103
    v_cvt_pk_bf16_f32 v166, v16, v17
    v_mul_f32 v246, v246, v52
    v_mul_f32 v247, v247, v52
    v_cvt_pk_bf16_f32 v167, v18, v19
    v_mfma_f32_16x16x32_bf16 v[116:119], v[40:43], v[216:219], v[116:119]
    ds_read_b128 v[36:39], v3 offset:18432
    v_cvt_pk_bf16_f32 v242, v242, v243
    v_mfma_f32_16x16x32_bf16 v[116:119], v[44:47], v[220:223], v[116:119]
    s_waitcnt lgkmcnt(2)
    s_nop 1
    v_cvt_pk_bf16_f32 v243, v244, v245
    v_cvt_pk_bf16_f32 v244, v246, v247
    v_accvgpr_read_b32 v248, a49
    v_mfma_f32_16x16x32_bf16 v[184:187], v[24:27], a[240:243], v[136:139]
    ds_read_b128 v[40:43], v2 offset:12416
    v_accvgpr_read_b32 v249, a53
    v_mfma_f32_16x16x32_bf16 v[184:187], v[28:31], a[244:247], v[184:187]
    buffer_store_dwordx3 v[242:244], v56, s[12:15], s40 offen offset:0 sc0 sc1
    v_accvgpr_read_b32 v250, a57
    v_mfma_f32_16x16x32_bf16 v[188:191], v[24:27], v[200:203], v[140:143]
    ds_read_b128 v[44:47], v3 offset:12416
    v_accvgpr_read_b32 v251, a61
    v_mfma_f32_16x16x32_bf16 v[188:191], v[28:31], v[204:207], v[188:191]
    s_waitcnt lgkmcnt(2)
    v_mfma_f32_16x16x32_bf16 v[132:135], v[164:167], v[20:23], v[132:135]
    v_exp_f32 v16, v168
    v_accvgpr_read_b32 v252, a65
    v_accvgpr_read_b32 v253, a69
    v_mfma_f32_16x16x32_bf16 v[120:123], v[32:35], a[240:243], v[136:139]
    ds_read_b128 v[24:27], v2 offset:18560
    v_mul_f32 v248, v248, v53
    v_mfma_f32_16x16x32_bf16 v[120:123], v[36:39], a[244:247], v[120:123]
    v_exp_f32 v17, v169
    v_exp_f32 v18, v170
    v_mul_f32 v249, v249, v53
    v_mfma_f32_16x16x32_bf16 v[124:127], v[32:35], v[200:203], v[140:143]
    ds_read_b128 v[28:31], v3 offset:18560
    v_mul_f32 v250, v250, v53
    v_mfma_f32_16x16x32_bf16 v[124:127], v[36:39], v[204:207], v[124:127]
    s_waitcnt lgkmcnt(2)
    v_exp_f32 v19, v171
    v_mul_f32 v251, v251, v53
    v_mul_f32 v252, v252, v53
    v_mul_f32 v253, v253, v53
    v_mfma_f32_16x16x32_bf16 v[184:187], v[40:43], a[248:251], v[184:187]
    ds_read_b128 v[32:35], v2 offset:12544
    v_cvt_pk_bf16_f32 v168, v16, v17
    v_mfma_f32_16x16x32_bf16 v[184:187], v[44:47], a[252:255], v[184:187]
    v_cvt_pk_bf16_f32 v248, v248, v249
    v_exp_f32 v16, v104
    v_cvt_pk_bf16_f32 v249, v250, v251
    v_cvt_pk_bf16_f32 v250, v252, v253
    v_accvgpr_read_b32 v224, a50
    v_mfma_f32_16x16x32_bf16 v[188:191], v[40:43], v[208:211], v[188:191]
    ds_read_b128 v[36:39], v3 offset:12544
    v_accvgpr_read_b32 v225, a54
    v_mfma_f32_16x16x32_bf16 v[188:191], v[44:47], v[212:215], v[188:191]
    s_waitcnt lgkmcnt(2)
    buffer_store_dwordx3 v[248:250], v56, s[12:15], s40 offen offset:384 sc0 sc1
    v_accvgpr_read_b32 v226, a58
    v_mfma_f32_16x16x32_bf16 v[120:123], v[24:27], a[248:251], v[120:123]
    ds_read_b128 v[40:43], v2 offset:18688
    v_accvgpr_read_b32 v227, a62
    v_mfma_f32_16x16x32_bf16 v[120:123], v[28:31], a[252:255], v[120:123]
    v_exp_f32 v17, v105
    v_cvt_pk_bf16_f32 v169, v18, v19
    v_accvgpr_read_b32 v228, a66
    v_accvgpr_read_b32 v229, a70
    v_mfma_f32_16x16x32_bf16 v[124:127], v[24:27], v[208:211], v[124:127]
    ds_read_b128 v[44:47], v3 offset:18688
    v_mul_f32 v224, v224, v54
    v_mfma_f32_16x16x32_bf16 v[124:127], v[28:31], v[212:215], v[124:127]
    s_waitcnt lgkmcnt(2)
    v_add_u32 v60, 49152, v1
    v_mov_b32 v59, v1
    v_subrev_u32 v1, 49152, v1
    v_exp_f32 v18, v106
    v_mfma_f32_16x16x32_bf16 v[184:187], v[32:35], v[192:195], v[184:187]
    ds_read_b128 v[24:27], v60 offset:0
    v_mul_f32 v225, v225, v54
    v_mfma_f32_16x16x32_bf16 v[184:187], v[36:39], v[196:199], v[184:187]
    v_exp_f32 v19, v107
    v_mul_f32 v226, v226, v54
    v_cvt_pk_bf16_f32 v170, v16, v17
    v_mul_f32 v227, v227, v54
    v_mul_f32 v228, v228, v54
    v_mfma_f32_16x16x32_bf16 v[188:191], v[32:35], v[216:219], v[188:191]
    ds_read_b128 v[28:31], v60 offset:12288
    v_mul_f32 v229, v229, v54
    v_mfma_f32_16x16x32_bf16 v[188:191], v[36:39], v[220:223], v[188:191]
    s_waitcnt lgkmcnt(2)
    v_exp_f32 v16, v172
    v_cvt_pk_bf16_f32 v224, v224, v225
    v_cvt_pk_bf16_f32 v225, v226, v227
    v_cvt_pk_bf16_f32 v226, v228, v229
    v_mfma_f32_16x16x32_bf16 v[120:123], v[40:43], v[192:195], v[120:123]
    ds_read_b128 v[32:35], v60 offset:1024
    v_accvgpr_read_b32 v230, a51
    v_mfma_f32_16x16x32_bf16 v[120:123], v[44:47], v[196:199], v[120:123]
    buffer_store_dwordx3 v[224:226], v56, s[12:15], s40 offen offset:768 sc0 sc1
    v_accvgpr_read_b32 v231, a55
    v_mfma_f32_16x16x32_bf16 v[124:127], v[40:43], v[216:219], v[124:127]
    ds_read_b128 v[36:39], v60 offset:13312
    v_accvgpr_read_b32 v232, a59
    v_mfma_f32_16x16x32_bf16 v[124:127], v[44:47], v[220:223], v[124:127]
    s_waitcnt lgkmcnt(2)
    v_exp_f32 v17, v173
    v_cvt_pk_bf16_f32 v171, v18, v19
    v_exp_f32 v18, v174
    v_accvgpr_read_b32 v233, a63
    v_mfma_f32_16x16x32_bf16 a[96:99], v[80:83], v[24:27], a[96:99]
    ds_read_b128 v[40:43], v60 offset:2048
    v_accvgpr_read_b32 v234, a67
    v_mfma_f32_16x16x32_bf16 a[96:99], v[88:91], v[28:31], a[96:99]
    v_exp_f32 v19, v175
    v_accvgpr_read_b32 v235, a71
    v_mul_f32 v230, v230, v55
    v_mul_f32 v231, v231, v55
    v_mfma_f32_16x16x32_bf16 a[144:147], v[84:87], v[24:27], a[144:147]
    ds_read_b128 v[44:47], v60 offset:14336
    v_mul_f32 v232, v232, v55
    v_mfma_f32_16x16x32_bf16 a[144:147], v[92:95], v[28:31], a[144:147]
    s_waitcnt lgkmcnt(2)
    v_mfma_f32_16x16x32_bf16 v[128:131], v[168:171], v[20:23], v[128:131]
    v_mul_f32 v233, v233, v55
    v_mul_f32 v234, v234, v55
    v_mul_f32 v235, v235, v55
    v_mfma_f32_16x16x32_bf16 a[100:103], v[80:83], v[32:35], a[100:103]
    ds_read_b128 v[24:27], v60 offset:3072
    v_cvt_pk_bf16_f32 v172, v16, v17
    v_mfma_f32_16x16x32_bf16 a[100:103], v[88:91], v[36:39], a[100:103]
    v_exp_f32 v16, v108
    v_cvt_pk_bf16_f32 v230, v230, v231
    v_cvt_pk_bf16_f32 v231, v232, v233
    v_cvt_pk_bf16_f32 v232, v234, v235
    v_accvgpr_read_b32 v236, a72
    v_mfma_f32_16x16x32_bf16 a[148:151], v[84:87], v[32:35], a[148:151]
    ds_read_b128 v[28:31], v60 offset:15360
    v_accvgpr_read_b32 v237, a76
    v_mfma_f32_16x16x32_bf16 a[148:151], v[92:95], v[36:39], a[148:151]
    s_waitcnt lgkmcnt(2)
    buffer_store_dwordx3 v[230:232], v56, s[12:15], s40 offen offset:1152 sc0 sc1
    v_accvgpr_read_b32 v238, a80
    v_mfma_f32_16x16x32_bf16 a[104:107], v[80:83], v[40:43], a[104:107]
    ds_read_b128 v[32:35], v60 offset:4096
    v_accvgpr_read_b32 v239, a84
    v_mfma_f32_16x16x32_bf16 a[104:107], v[88:91], v[44:47], a[104:107]
    v_exp_f32 v17, v109
    v_cvt_pk_bf16_f32 v173, v18, v19
    v_accvgpr_read_b32 v240, a88
    v_accvgpr_read_b32 v241, a92
    v_mfma_f32_16x16x32_bf16 a[152:155], v[84:87], v[40:43], a[152:155]
    ds_read_b128 v[36:39], v60 offset:16384
    v_mul_f32 v236, v236, v52
    v_mfma_f32_16x16x32_bf16 a[152:155], v[92:95], v[44:47], a[152:155]
    s_waitcnt lgkmcnt(2)
    v_exp_f32 v18, v110
    v_mul_f32 v237, v237, v52
    v_mul_f32 v238, v238, v52
    v_mul_f32 v239, v239, v52
    v_mul_f32 v240, v240, v52
    v_mfma_f32_16x16x32_bf16 a[108:111], v[80:83], v[24:27], a[108:111]
    ds_read_b128 v[40:43], v60 offset:5120
    v_mul_f32 v241, v241, v52
    v_mfma_f32_16x16x32_bf16 a[108:111], v[88:91], v[28:31], a[108:111]
    v_exp_f32 v19, v111
    v_cvt_pk_bf16_f32 v236, v236, v237
    v_cvt_pk_bf16_f32 v237, v238, v239
    v_cvt_pk_bf16_f32 v238, v240, v241
    v_mfma_f32_16x16x32_bf16 a[156:159], v[84:87], v[24:27], a[156:159]
    ds_read_b128 v[44:47], v60 offset:17408
    v_cvt_pk_bf16_f32 v174, v16, v17
    v_mfma_f32_16x16x32_bf16 a[156:159], v[92:95], v[28:31], a[156:159]
    s_waitcnt lgkmcnt(2)
    buffer_store_dwordx3 v[236:238], v56, s[12:15], s40 offen offset:192 sc0 sc1
    v_accvgpr_read_b32 v242, a73
    v_mfma_f32_16x16x32_bf16 a[112:115], v[80:83], v[32:35], a[112:115]
    ds_read_b128 v[24:27], v1 offset:0
    v_cvt_pk_bf16_f32 v175, v18, v19
    v_mfma_f32_16x16x32_bf16 a[112:115], v[88:91], v[36:39], a[112:115]
    s_nop 1
    v_accvgpr_read_b32 v243, a77
    v_accvgpr_read_b32 v244, a81
    v_accvgpr_read_b32 v245, a85
    v_accvgpr_read_b32 v246, a89
    v_mfma_f32_16x16x32_bf16 a[160:163], v[84:87], v[32:35], a[160:163]
    ds_read_b128 v[28:31], v1 offset:12288
    v_accvgpr_read_b32 v247, a93
    v_mfma_f32_16x16x32_bf16 a[160:163], v[92:95], v[36:39], a[160:163]
    s_waitcnt lgkmcnt(2)
    v_mul_f32 v242, v242, v53
    v_mfma_f32_16x16x32_bf16 v[132:135], v[172:175], v[20:23], v[132:135]
    v_exp_f32 v16, v176
    v_mul_f32 v243, v243, v53
    v_mfma_f32_16x16x32_bf16 a[116:119], v[80:83], v[40:43], a[116:119]
    ds_read_b128 v[32:35], v1 offset:1024
    v_mul_f32 v244, v244, v53
    v_mfma_f32_16x16x32_bf16 a[116:119], v[88:91], v[44:47], a[116:119]
    v_exp_f32 v17, v177
    v_exp_f32 v18, v178
    v_mul_f32 v245, v245, v53
    v_mfma_f32_16x16x32_bf16 a[164:167], v[84:87], v[40:43], a[164:167]
    ds_read_b128 v[36:39], v1 offset:13312
    v_mul_f32 v246, v246, v53
    v_mfma_f32_16x16x32_bf16 a[164:167], v[92:95], v[44:47], a[164:167]
    s_waitcnt lgkmcnt(2)
    v_exp_f32 v19, v179
    v_cvt_pk_bf16_f32 v176, v16, v17
    v_exp_f32 v16, v112
    v_mfma_f32_16x16x32_bf16 a[96:99], v[160:163], v[24:27], a[96:99]
    ds_read_b128 v[40:43], v1 offset:2048
    v_mul_f32 v247, v247, v53
    v_mfma_f32_16x16x32_bf16 a[96:99], v[168:171], v[28:31], a[96:99]
    v_exp_f32 v17, v113
    v_cvt_pk_bf16_f32 v177, v18, v19
    v_exp_f32 v18, v114
    v_cvt_pk_bf16_f32 v242, v242, v243
    v_mfma_f32_16x16x32_bf16 a[144:147], v[164:167], v[24:27], a[144:147]
    ds_read_b128 v[44:47], v1 offset:14336
    v_cvt_pk_bf16_f32 v243, v244, v245
    v_mfma_f32_16x16x32_bf16 a[144:147], v[172:175], v[28:31], a[144:147]
    s_waitcnt lgkmcnt(2)
    v_exp_f32 v19, v115
    v_cvt_pk_bf16_f32 v178, v16, v17
    v_exp_f32 v16, v180
    v_mfma_f32_16x16x32_bf16 a[100:103], v[160:163], v[32:35], a[100:103]
    ds_read_b128 v[24:27], v1 offset:3072
    v_cvt_pk_bf16_f32 v244, v246, v247
    v_mfma_f32_16x16x32_bf16 a[100:103], v[168:171], v[36:39], a[100:103]
    buffer_store_dwordx3 v[242:244], v56, s[12:15], s40 offen offset:576 sc0 sc1
    v_accvgpr_read_b32 v248, a74
    v_mfma_f32_16x16x32_bf16 a[148:151], v[164:167], v[32:35], a[148:151]
    ds_read_b128 v[28:31], v1 offset:15360
    v_accvgpr_read_b32 v249, a78
    v_mfma_f32_16x16x32_bf16 a[148:151], v[172:175], v[36:39], a[148:151]
    s_waitcnt lgkmcnt(2)
    v_exp_f32 v17, v181
    v_cvt_pk_bf16_f32 v179, v18, v19
    v_exp_f32 v18, v182
    v_accvgpr_read_b32 v250, a82
    v_mfma_f32_16x16x32_bf16 a[104:107], v[160:163], v[40:43], a[104:107]
    ds_read_b128 v[32:35], v1 offset:4096
    v_accvgpr_read_b32 v251, a86
    v_mfma_f32_16x16x32_bf16 a[104:107], v[168:171], v[44:47], a[104:107]
    v_exp_f32 v19, v183
    v_mfma_f32_16x16x32_bf16 v[128:131], v[176:179], v[20:23], v[128:131]
    v_cvt_pk_bf16_f32 v180, v16, v17
    v_mfma_f32_16x16x32_bf16 a[152:155], v[164:167], v[40:43], a[152:155]
    ds_read_b128 v[36:39], v1 offset:16384
    v_accvgpr_read_b32 v252, a90
    v_mfma_f32_16x16x32_bf16 a[152:155], v[172:175], v[44:47], a[152:155]
    s_waitcnt lgkmcnt(2)
    v_exp_f32 v16, v116
    v_exp_f32 v17, v117
    v_cvt_pk_bf16_f32 v181, v18, v19
    v_mfma_f32_16x16x32_bf16 a[108:111], v[160:163], v[24:27], a[108:111]
    ds_read_b128 v[40:43], v1 offset:5120
    v_accvgpr_read_b32 v253, a94
    v_mfma_f32_16x16x32_bf16 a[108:111], v[168:171], v[28:31], a[108:111]
    v_exp_f32 v18, v118
    v_exp_f32 v19, v119
    v_cvt_pk_bf16_f32 v182, v16, v17
    v_cvt_pk_bf16_f32 v183, v18, v19
    v_mfma_f32_16x16x32_bf16 a[156:159], v[164:167], v[24:27], a[156:159]
L_pg13:
    s_cbranch_execz L_iwret
    s_nop 1
    ds_read_b128 v[44:47], v1 offset:17408
    v_mfma_f32_16x16x32_bf16 a[156:159], v[172:175], v[28:31], a[156:159]
    s_waitcnt lgkmcnt(2)
    v_mfma_f32_16x16x32_bf16 v[132:135], v[180:183], v[20:23], v[132:135]
    v_exp_f32 v16, v184
    v_mul_f32 v248, v248, v54
    v_mfma_f32_16x16x32_bf16 a[112:115], v[160:163], v[32:35], a[112:115]
    ds_read_b128 v[24:27], v59 offset:0
    v_mul_f32 v249, v249, v54
    v_mfma_f32_16x16x32_bf16 a[112:115], v[168:171], v[36:39], a[112:115]
    v_exp_f32 v17, v185
    v_exp_f32 v18, v186
    v_mul_f32 v250, v250, v54
    v_mfma_f32_16x16x32_bf16 a[160:163], v[164:167], v[32:35], a[160:163]
    ds_read_b128 v[28:31], v59 offset:12288
    v_mul_f32 v251, v251, v54
    v_mfma_f32_16x16x32_bf16 a[160:163], v[172:175], v[36:39], a[160:163]
    s_waitcnt lgkmcnt(2)
    v_exp_f32 v19, v187
    v_cvt_pk_bf16_f32 v184, v16, v17
    v_exp_f32 v16, v120
    v_exp_f32 v17, v121
    v_cvt_pk_bf16_f32 v185, v18, v19
    v_exp_f32 v18, v122
    v_exp_f32 v19, v123
    v_cvt_pk_bf16_f32 v186, v16, v17
    v_exp_f32 v16, v188
    v_exp_f32 v17, v189
    v_cvt_pk_bf16_f32 v187, v18, v19
    v_exp_f32 v18, v190
    v_exp_f32 v19, v191
    v_mfma_f32_16x16x32_bf16 v[128:131], v[184:187], v[20:23], v[128:131]
    v_cvt_pk_bf16_f32 v188, v16, v17
    v_exp_f32 v16, v124
    v_exp_f32 v17, v125
    v_cvt_pk_bf16_f32 v189, v18, v19
    v_exp_f32 v18, v126
    v_exp_f32 v19, v127
    v_cvt_pk_bf16_f32 v190, v16, v17
    v_cvt_pk_bf16_f32 v191, v18, v19
    s_nop 1
    v_mfma_f32_16x16x32_bf16 v[132:135], v[188:191], v[20:23], v[132:135]
    v_mfma_f32_16x16x32_bf16 a[116:119], v[160:163], v[40:43], a[116:119]
    ds_read_b128 v[32:35], v59 offset:1024
    v_mul_f32 v252, v252, v54
    v_mfma_f32_16x16x32_bf16 a[116:119], v[168:171], v[44:47], a[116:119]
    v_mul_f32 v253, v253, v54
    v_cvt_pk_bf16_f32 v248, v248, v249
    v_cvt_pk_bf16_f32 v249, v250, v251
    v_cvt_pk_bf16_f32 v250, v252, v253
    v_accvgpr_read_b32 v224, a75
    v_mfma_f32_16x16x32_bf16 a[164:167], v[164:167], v[40:43], a[164:167]
    ds_read_b128 v[36:39], v59 offset:13312
    v_accvgpr_read_b32 v225, a79
    v_mfma_f32_16x16x32_bf16 a[164:167], v[172:175], v[44:47], a[164:167]
    s_waitcnt lgkmcnt(2)
    buffer_store_dwordx3 v[248:250], v56, s[12:15], s40 offen offset:960 sc0 sc1
    v_accvgpr_read_b32 v226, a83
    v_accvgpr_read_b32 v227, a87
    v_mfma_f32_16x16x4_f32 v[128:131], v7, v57, v[128:131]
    v_mfma_f32_16x16x32_bf16 a[96:99], v[176:179], v[24:27], a[96:99]
    ds_read_b128 v[40:43], v59 offset:2048
    v_accvgpr_read_b32 v228, a91
    v_mfma_f32_16x16x32_bf16 a[96:99], v[184:187], v[28:31], a[96:99]
    v_accvgpr_read_b32 v229, a95
    v_mul_f32 v224, v224, v55
    v_mul_f32 v225, v225, v55
    v_mul_f32 v226, v226, v55
    v_mul_f32 v227, v227, v55
    v_mul_f32 v228, v228, v55
    v_mfma_f32_16x16x4_f32 v[132:135], v8, v57, v[132:135]
    v_mfma_f32_16x16x32_bf16 a[144:147], v[180:183], v[24:27], a[144:147]
    ds_read_b128 v[44:47], v59 offset:14336
    v_mul_f32 v229, v229, v55
    v_mfma_f32_16x16x32_bf16 a[144:147], v[188:191], v[28:31], a[144:147]
    s_waitcnt lgkmcnt(2)
    v_cvt_pk_bf16_f32 v224, v224, v225
    v_cvt_pk_bf16_f32 v225, v226, v227
    v_cvt_pk_bf16_f32 v226, v228, v229
    v_mfma_f32_16x16x32_bf16 a[100:103], v[176:179], v[32:35], a[100:103]
    ds_read_b128 v[24:27], v59 offset:3072
    v_mfma_f32_16x16x32_bf16 a[100:103], v[184:187], v[36:39], a[100:103]
    buffer_store_dwordx3 v[224:226], v56, s[12:15], s40 offen offset:1344 sc0 sc1
    v_mfma_f32_16x16x32_bf16 a[148:151], v[180:183], v[32:35], a[148:151]
    ds_read_b128 v[28:31], v59 offset:15360
    v_max3_f32 v18, v5, v6, v128
    v_mfma_f32_16x16x32_bf16 a[148:151], v[188:191], v[36:39], a[148:151]
    s_waitcnt lgkmcnt(2)
    v_max3_f32 v18, v18, v129, v130
    v_max3_f32 v18, v18, v131, v132
    v_max3_f32 v18, v18, v133, v134
    v_max_f32 v18, v18, v135
    s_mov_b32 s29, 0x5f800000
    v_cmp_lt_f32 s[48:49], s29, v18
    v_rcp_f32 v128, v128
    v_mfma_f32_16x16x32_bf16 a[104:107], v[176:179], v[40:43], a[104:107]
    ds_read_b128 v[32:35], v59 offset:4096
    v_mfma_f32_16x16x32_bf16 a[104:107], v[184:187], v[44:47], a[104:107]
    v_rcp_f32 v129, v129
    v_rcp_f32 v130, v130
    v_rcp_f32 v131, v131
    v_mfma_f32_16x16x32_bf16 a[152:155], v[180:183], v[40:43], a[152:155]
    ds_read_b128 v[36:39], v59 offset:16384
    v_mfma_f32_16x16x32_bf16 a[152:155], v[188:191], v[44:47], a[152:155]
    s_waitcnt lgkmcnt(2)
    v_rcp_f32 v132, v132
    v_rcp_f32 v133, v133
    v_mfma_f32_16x16x32_bf16 a[108:111], v[176:179], v[24:27], a[108:111]
    ds_read_b128 v[40:43], v59 offset:5120
    v_mfma_f32_16x16x32_bf16 a[108:111], v[184:187], v[28:31], a[108:111]
    v_rcp_f32 v134, v134
    v_rcp_f32 v135, v135
    v_mfma_f32_16x16x32_bf16 a[156:159], v[180:183], v[24:27], a[156:159]
    ds_read_b128 v[44:47], v59 offset:17408
    v_mfma_f32_16x16x32_bf16 a[156:159], v[188:191], v[28:31], a[156:159]
    s_waitcnt lgkmcnt(2)
    v_mfma_f32_16x16x32_bf16 a[112:115], v[176:179], v[32:35], a[112:115]
    ds_read_b128 v[24:27], v60 offset:6144
    v_mfma_f32_16x16x32_bf16 a[112:115], v[184:187], v[36:39], a[112:115]
    v_mfma_f32_16x16x32_bf16 a[160:163], v[180:183], v[32:35], a[160:163]
    ds_read_b128 v[28:31], v60 offset:18432
    v_mfma_f32_16x16x32_bf16 a[160:163], v[188:191], v[36:39], a[160:163]
    s_waitcnt lgkmcnt(2)
    s_cmp_lg_u64 s[48:49], 0
    s_cbranch_scc1 L_slow
    v_mfma_f32_16x16x32_bf16 a[116:119], v[176:179], v[40:43], a[116:119]
    ds_read_b128 v[32:35], v60 offset:7168
    v_mfma_f32_16x16x32_bf16 a[116:119], v[184:187], v[44:47], a[116:119]
    v_mfma_f32_16x16x32_bf16 a[164:167], v[180:183], v[40:43], a[164:167]
    ds_read_b128 v[36:39], v60 offset:19456
    v_mfma_f32_16x16x32_bf16 a[164:167], v[188:191], v[44:47], a[164:167]
    s_waitcnt lgkmcnt(2)
    v_mfma_f32_16x16x32_bf16 a[120:123], v[80:83], v[24:27], a[120:123]
    ds_read_b128 v[40:43], v60 offset:8192
    v_mfma_f32_16x16x32_bf16 a[120:123], v[88:91], v[28:31], a[120:123]
    v_mfma_f32_16x16x32_bf16 a[168:171], v[84:87], v[24:27], a[168:171]
    ds_read_b128 v[44:47], v60 offset:20480
    v_mfma_f32_16x16x32_bf16 a[168:171], v[92:95], v[28:31], a[168:171]
    s_waitcnt lgkmcnt(2)
    v_mfma_f32_16x16x32_bf16 a[124:127], v[80:83], v[32:35], a[124:127]
    ds_read_b128 v[24:27], v1 offset:6144
    v_accvgpr_read_b32 v230, a96
    v_mfma_f32_16x16x32_bf16 a[124:127], v[88:91], v[36:39], a[124:127]
    v_accvgpr_read_b32 v231, a100
    v_accvgpr_read_b32 v232, a104
    v_accvgpr_read_b32 v233, a108
    v_accvgpr_read_b32 v234, a112
    v_accvgpr_read_b32 v235, a116
    v_mul_f32 v230, v230, v128
    v_mul_f32 v231, v231, v128
    v_mul_f32 v232, v232, v128
    v_mul_f32 v233, v233, v128
    v_mul_f32 v234, v234, v128
    v_mul_f32 v235, v235, v128
    v_cvt_pk_bf16_f32 v230, v230, v231
    v_cvt_pk_bf16_f32 v231, v232, v233
    v_cvt_pk_bf16_f32 v232, v234, v235
    v_accvgpr_read_b32 v236, a97
    v_accvgpr_read_b32 v237, a101
    v_accvgpr_read_b32 v238, a105
    v_accvgpr_read_b32 v239, a109
    v_accvgpr_read_b32 v240, a113
    v_accvgpr_read_b32 v241, a117
    v_mul_f32 v236, v236, v129
    v_mul_f32 v237, v237, v129
    v_mul_f32 v238, v238, v129
    v_mul_f32 v239, v239, v129
    v_mul_f32 v240, v240, v129
    v_mul_f32 v241, v241, v129
    v_cvt_pk_bf16_f32 v236, v236, v237
    v_cvt_pk_bf16_f32 v237, v238, v239
    v_cvt_pk_bf16_f32 v238, v240, v241
    v_accvgpr_read_b32 v242, a98
    v_mfma_f32_16x16x32_bf16 a[172:175], v[84:87], v[32:35], a[172:175]
    ds_read_b128 v[28:31], v1 offset:18432
    v_accvgpr_read_b32 v243, a102
    v_mfma_f32_16x16x32_bf16 a[172:175], v[92:95], v[36:39], a[172:175]
    s_waitcnt lgkmcnt(2)
    buffer_store_dwordx3 v[230:232], v56, s[12:15], s41 offen offset:0 sc0 sc1
    v_accvgpr_read_b32 v244, a106
    v_mfma_f32_16x16x32_bf16 a[128:131], v[80:83], v[40:43], a[128:131]
    ds_read_b128 v[32:35], v1 offset:7168
    v_accvgpr_read_b32 v245, a110
    v_mfma_f32_16x16x32_bf16 a[128:131], v[88:91], v[44:47], a[128:131]
    buffer_store_dwordx3 v[236:238], v56, s[12:15], s41 offen offset:384 sc0 sc1
    v_accvgpr_read_b32 v246, a114
    v_mfma_f32_16x16x32_bf16 a[176:179], v[84:87], v[40:43], a[176:179]
    ds_read_b128 v[36:39], v1 offset:19456
    v_accvgpr_read_b32 v247, a118
    v_mfma_f32_16x16x32_bf16 a[176:179], v[92:95], v[44:47], a[176:179]
    s_waitcnt lgkmcnt(2)
    v_mul_f32 v242, v242, v130
    v_mul_f32 v243, v243, v130
    v_mul_f32 v244, v244, v130
    v_mul_f32 v245, v245, v130
    v_mul_f32 v246, v246, v130
    v_mul_f32 v247, v247, v130
    v_mfma_f32_16x16x32_bf16 a[120:123], v[160:163], v[24:27], a[120:123]
    ds_read_b128 v[40:43], v1 offset:8192
    v_cvt_pk_bf16_f32 v242, v242, v243
    v_mfma_f32_16x16x32_bf16 a[120:123], v[168:171], v[28:31], a[120:123]
    v_cvt_pk_bf16_f32 v243, v244, v245
    v_cvt_pk_bf16_f32 v244, v246, v247
    v_accvgpr_read_b32 v248, a99
    v_accvgpr_read_b32 v249, a103
    v_accvgpr_read_b32 v250, a107
    v_mfma_f32_16x16x32_bf16 a[168:171], v[164:167], v[24:27], a[168:171]
    ds_read_b128 v[44:47], v1 offset:20480
    v_accvgpr_read_b32 v251, a111
    v_mfma_f32_16x16x32_bf16 a[168:171], v[172:175], v[28:31], a[168:171]
    s_waitcnt lgkmcnt(2)
    buffer_store_dwordx3 v[242:244], v56, s[12:15], s41 offen offset:768 sc0 sc1
    v_accvgpr_read_b32 v252, a115
    v_mfma_f32_16x16x32_bf16 a[124:127], v[160:163], v[32:35], a[124:127]
    ds_read_b128 v[24:27], v59 offset:6144
    v_accvgpr_read_b32 v253, a119
    v_mfma_f32_16x16x32_bf16 a[124:127], v[168:171], v[36:39], a[124:127]
    v_mul_f32 v248, v248, v131
    v_mul_f32 v249, v249, v131
    v_mul_f32 v250, v250, v131
    v_mul_f32 v251, v251, v131
    v_mul_f32 v252, v252, v131
    v_mul_f32 v253, v253, v131
    v_mfma_f32_16x16x32_bf16 a[172:175], v[164:167], v[32:35], a[172:175]
    ds_read_b128 v[28:31], v59 offset:18432
    v_cvt_pk_bf16_f32 v248, v248, v249
    v_mfma_f32_16x16x32_bf16 a[172:175], v[172:175], v[36:39], a[172:175]
    s_waitcnt lgkmcnt(2)
    v_cvt_pk_bf16_f32 v249, v250, v251
    v_cvt_pk_bf16_f32 v250, v252, v253
    v_accvgpr_read_b32 v224, a144
    v_accvgpr_read_b32 v225, a148
    v_accvgpr_read_b32 v226, a152
    v_mfma_f32_16x16x32_bf16 a[128:131], v[160:163], v[40:43], a[128:131]
    ds_read_b128 v[32:35], v59 offset:7168
    v_accvgpr_read_b32 v227, a156
    v_mfma_f32_16x16x32_bf16 a[128:131], v[168:171], v[44:47], a[128:131]
    buffer_store_dwordx3 v[248:250], v56, s[12:15], s41 offen offset:1152 sc0 sc1
    v_accvgpr_read_b32 v228, a160
    v_mfma_f32_16x16x32_bf16 a[176:179], v[164:167], v[40:43], a[176:179]
    ds_read_b128 v[36:39], v59 offset:19456
    v_accvgpr_read_b32 v229, a164
    v_mfma_f32_16x16x32_bf16 a[176:179], v[172:175], v[44:47], a[176:179]
    s_waitcnt lgkmcnt(2)
    v_mul_f32 v224, v224, v132
    v_mul_f32 v225, v225, v132
    v_mul_f32 v226, v226, v132
    v_mul_f32 v227, v227, v132
    v_mul_f32 v228, v228, v132
    v_mul_f32 v229, v229, v132
    v_mfma_f32_16x16x32_bf16 a[120:123], v[176:179], v[24:27], a[120:123]
    ds_read_b128 v[40:43], v59 offset:8192
    v_cvt_pk_bf16_f32 v224, v224, v225
    v_mfma_f32_16x16x32_bf16 a[120:123], v[184:187], v[28:31], a[120:123]
    v_cvt_pk_bf16_f32 v225, v226, v227
    v_cvt_pk_bf16_f32 v226, v228, v229
    v_accvgpr_read_b32 v230, a145
    v_accvgpr_read_b32 v231, a149
    v_accvgpr_read_b32 v232, a153
    v_mfma_f32_16x16x32_bf16 a[168:171], v[180:183], v[24:27], a[168:171]
    ds_read_b128 v[44:47], v59 offset:20480
    v_accvgpr_read_b32 v233, a157
    v_mfma_f32_16x16x32_bf16 a[168:171], v[188:191], v[28:31], a[168:171]
    s_waitcnt lgkmcnt(2)
    buffer_store_dwordx3 v[224:226], v56, s[12:15], s42 offen offset:0 sc0 sc1
    v_accvgpr_read_b32 v234, a161
    v_mfma_f32_16x16x32_bf16 a[124:127], v[176:179], v[32:35], a[124:127]
    ds_read_b128 v[24:27], v60 offset:9216
    v_accvgpr_read_b32 v235, a165
    v_mfma_f32_16x16x32_bf16 a[124:127], v[184:187], v[36:39], a[124:127]
    v_mul_f32 v230, v230, v133
    v_mul_f32 v231, v231, v133
    v_mul_f32 v232, v232, v133
    v_mul_f32 v233, v233, v133
    v_mul_f32 v234, v234, v133
    v_mul_f32 v235, v235, v133
    v_mfma_f32_16x16x32_bf16 a[172:175], v[180:183], v[32:35], a[172:175]
    ds_read_b128 v[28:31], v60 offset:21504
    v_cvt_pk_bf16_f32 v230, v230, v231
    v_mfma_f32_16x16x32_bf16 a[172:175], v[188:191], v[36:39], a[172:175]
    s_waitcnt lgkmcnt(2)
    v_cvt_pk_bf16_f32 v231, v232, v233
    v_cvt_pk_bf16_f32 v232, v234, v235
    v_accvgpr_read_b32 v236, a146
    v_accvgpr_read_b32 v237, a150
    v_accvgpr_read_b32 v238, a154
    v_mfma_f32_16x16x32_bf16 a[128:131], v[176:179], v[40:43], a[128:131]
    ds_read_b128 v[32:35], v60 offset:10240
    v_accvgpr_read_b32 v239, a158
    v_mfma_f32_16x16x32_bf16 a[128:131], v[184:187], v[44:47], a[128:131]
    buffer_store_dwordx3 v[230:232], v56, s[12:15], s42 offen offset:384 sc0 sc1
    v_accvgpr_read_b32 v240, a162
    v_mfma_f32_16x16x32_bf16 a[176:179], v[180:183], v[40:43], a[176:179]
    ds_read_b128 v[36:39], v60 offset:22528
    v_accvgpr_read_b32 v241, a166
    v_mfma_f32_16x16x32_bf16 a[176:179], v[188:191], v[44:47], a[176:179]
    s_waitcnt lgkmcnt(2)
    v_mul_f32 v236, v236, v134
    v_mul_f32 v237, v237, v134
    v_mul_f32 v238, v238, v134
    v_mul_f32 v239, v239, v134
    v_mul_f32 v240, v240, v134
    v_mfma_f32_16x16x32_bf16 a[132:135], v[80:83], v[24:27], a[132:135]
    ds_read_b128 v[40:43], v60 offset:11264
    v_mul_f32 v241, v241, v134
    v_mfma_f32_16x16x32_bf16 a[132:135], v[88:91], v[28:31], a[132:135]
    v_cvt_pk_bf16_f32 v236, v236, v237
    v_cvt_pk_bf16_f32 v237, v238, v239
    v_cvt_pk_bf16_f32 v238, v240, v241
    v_accvgpr_read_b32 v242, a147
    v_accvgpr_read_b32 v243, a151
    v_accvgpr_read_b32 v244, a155
    v_mfma_f32_16x16x32_bf16 a[180:183], v[84:87], v[24:27], a[180:183]
    ds_read_b128 v[44:47], v60 offset:23552
    v_accvgpr_read_b32 v245, a159
    v_mfma_f32_16x16x32_bf16 a[180:183], v[92:95], v[28:31], a[180:183]
    s_waitcnt lgkmcnt(2)
    buffer_store_dwordx3 v[236:238], v56, s[12:15], s42 offen offset:768 sc0 sc1
    v_accvgpr_read_b32 v246, a163
    v_mfma_f32_16x16x32_bf16 a[136:139], v[80:83], v[32:35], a[136:139]
    ds_read_b128 v[24:27], v1 offset:9216
    v_accvgpr_read_b32 v96, a120
    v_mfma_f32_16x16x32_bf16 a[136:139], v[88:91], v[36:39], a[136:139]
    v_accvgpr_read_b32 v97, a124
    v_accvgpr_read_b32 v98, a128
    v_mul_f32 v96, v96, v128
    v_mul_f32 v97, v97, v128
    v_mul_f32 v98, v98, v128
    v_mfma_f32_16x16x32_bf16 a[184:187], v[84:87], v[32:35], a[184:187]
    ds_read_b128 v[28:31], v1 offset:21504
    v_accvgpr_read_b32 v102, a121
    v_mfma_f32_16x16x32_bf16 a[184:187], v[92:95], v[36:39], a[184:187]
    s_waitcnt lgkmcnt(2)
    v_accvgpr_read_b32 v103, a125
    v_accvgpr_read_b32 v104, a129
    v_mul_f32 v102, v102, v129
    v_mul_f32 v103, v103, v129
    v_mul_f32 v104, v104, v129
    v_accvgpr_read_b32 v108, a122
    v_mfma_f32_16x16x32_bf16 a[140:143], v[80:83], v[40:43], a[140:143]
    ds_read_b128 v[32:35], v1 offset:10240
    v_accvgpr_read_b32 v109, a126
    v_mfma_f32_16x16x32_bf16 a[140:143], v[88:91], v[44:47], a[140:143]
    v_accvgpr_read_b32 v110, a130
    v_mul_f32 v108, v108, v130
    v_mul_f32 v109, v109, v130
    v_mul_f32 v110, v110, v130
    v_accvgpr_read_b32 v114, a123
    v_mfma_f32_16x16x32_bf16 a[188:191], v[84:87], v[40:43], a[188:191]
    ds_read_b128 v[36:39], v1 offset:22528
    v_accvgpr_read_b32 v115, a127
    v_mfma_f32_16x16x32_bf16 a[188:191], v[92:95], v[44:47], a[188:191]
    s_waitcnt lgkmcnt(2)
    v_accvgpr_read_b32 v116, a131
    v_mul_f32 v114, v114, v131
    v_mul_f32 v115, v115, v131
    v_mul_f32 v116, v116, v131
    v_accvgpr_read_b32 v120, a168
    v_mfma_f32_16x16x32_bf16 a[132:135], v[160:163], v[24:27], a[132:135]
    ds_read_b128 v[40:43], v1 offset:11264
    v_accvgpr_read_b32 v121, a172
    v_mfma_f32_16x16x32_bf16 a[132:135], v[168:171], v[28:31], a[132:135]
    v_accvgpr_read_b32 v122, a176
    v_mul_f32 v120, v120, v132
    v_mul_f32 v121, v121, v132
    v_mul_f32 v122, v122, v132
    v_accvgpr_read_b32 v64, a169
    v_accvgpr_read_b32 v65, a173
    v_mfma_f32_16x16x32_bf16 a[180:183], v[164:167], v[24:27], a[180:183]
    ds_read_b128 v[44:47], v1 offset:23552
    v_accvgpr_read_b32 v66, a177
    v_mfma_f32_16x16x32_bf16 a[180:183], v[172:175], v[28:31], a[180:183]
    s_waitcnt lgkmcnt(2)
    v_mul_f32 v64, v64, v133
    v_mul_f32 v65, v65, v133
    v_mul_f32 v66, v66, v133
    v_accvgpr_read_b32 v70, a170
    v_accvgpr_read_b32 v71, a174
    v_mfma_f32_16x16x32_bf16 a[136:139], v[160:163], v[32:35], a[136:139]
    ds_read_b128 v[24:27], v59 offset:9216
    v_accvgpr_read_b32 v247, a167
    v_mfma_f32_16x16x32_bf16 a[136:139], v[168:171], v[36:39], a[136:139]
    v_accvgpr_read_b32 v72, a178
    v_mul_f32 v242, v242, v135
    v_mul_f32 v70, v70, v134
    v_mul_f32 v243, v243, v135
    v_mul_f32 v71, v71, v134
    v_mfma_f32_16x16x32_bf16 a[184:187], v[164:167], v[32:35], a[184:187]
    ds_read_b128 v[28:31], v59 offset:21504
    v_mul_f32 v244, v244, v135
    v_mfma_f32_16x16x32_bf16 a[184:187], v[172:175], v[36:39], a[184:187]
    s_waitcnt lgkmcnt(2)
    v_mul_f32 v72, v72, v134
    v_mul_f32 v245, v245, v135
    v_accvgpr_read_b32 v144, a171
    v_mul_f32 v246, v246, v135
    v_accvgpr_read_b32 v145, a175
    v_mul_f32 v247, v247, v135
    v_mfma_f32_16x16x32_bf16 a[140:143], v[160:163], v[40:43], a[140:143]
    ds_read_b128 v[32:35], v59 offset:10240
    v_accvgpr_read_b32 v146, a179
    v_mfma_f32_16x16x32_bf16 a[140:143], v[168:171], v[44:47], a[140:143]
    v_cvt_pk_bf16_f32 v242, v242, v243
    v_mul_f32 v144, v144, v135
    v_cvt_pk_bf16_f32 v243, v244, v245
    v_mul_f32 v145, v145, v135
    v_cvt_pk_bf16_f32 v244, v246, v247
    v_mfma_f32_16x16x32_bf16 a[188:191], v[164:167], v[40:43], a[188:191]
    ds_read_b128 v[36:39], v59 offset:22528
    v_mul_f32 v146, v146, v135
    v_mfma_f32_16x16x32_bf16 a[188:191], v[172:175], v[44:47], a[188:191]
    s_waitcnt lgkmcnt(2)
    buffer_store_dwordx3 v[242:244], v56, s[12:15], s42 offen offset:1152 sc0 sc1
    v_mfma_f32_16x16x32_bf16 a[132:135], v[176:179], v[24:27], a[132:135]
    ds_read_b128 v[40:43], v59 offset:11264
    v_mfma_f32_16x16x32_bf16 a[132:135], v[184:187], v[28:31], a[132:135]
    v_mfma_f32_16x16x32_bf16 a[180:183], v[180:183], v[24:27], a[180:183]
    ds_read_b128 v[44:47], v59 offset:23552
    v_mfma_f32_16x16x32_bf16 a[180:183], v[188:191], v[28:31], a[180:183]
    s_waitcnt lgkmcnt(2)
    v_mfma_f32_16x16x32_bf16 a[136:139], v[176:179], v[32:35], a[136:139]
    v_mfma_f32_16x16x32_bf16 a[136:139], v[184:187], v[36:39], a[136:139]
    v_mfma_f32_16x16x32_bf16 a[184:187], v[180:183], v[32:35], a[184:187]
    v_mfma_f32_16x16x32_bf16 a[184:187], v[188:191], v[36:39], a[184:187]
    s_waitcnt lgkmcnt(0)
    v_mfma_f32_16x16x32_bf16 a[140:143], v[176:179], v[40:43], a[140:143]
    v_mfma_f32_16x16x32_bf16 a[140:143], v[184:187], v[44:47], a[140:143]
    v_mfma_f32_16x16x32_bf16 a[188:191], v[180:183], v[40:43], a[188:191]
    v_mfma_f32_16x16x32_bf16 a[188:191], v[188:191], v[44:47], a[188:191]
    s_nop 7
    v_accvgpr_read_b32 v99, a132
    v_accvgpr_read_b32 v100, a136
    v_accvgpr_read_b32 v101, a140
    v_cvt_pk_bf16_f32 v96, v96, v97
    v_mul_f32 v99, v99, v128
    v_mul_f32 v100, v100, v128
    v_mul_f32 v101, v101, v128
    v_cvt_pk_bf16_f32 v97, v98, v99
    v_cvt_pk_bf16_f32 v98, v100, v101
    buffer_store_dwordx3 v[96:98], v56, s[12:15], s41 offen offset:192 sc0 sc1
    v_accvgpr_read_b32 v105, a133
    v_accvgpr_read_b32 v106, a137
    v_accvgpr_read_b32 v107, a141
    v_cvt_pk_bf16_f32 v102, v102, v103
    v_mul_f32 v105, v105, v129
    v_mul_f32 v106, v106, v129
    v_mul_f32 v107, v107, v129
    v_cvt_pk_bf16_f32 v103, v104, v105
    v_cvt_pk_bf16_f32 v104, v106, v107
    buffer_store_dwordx3 v[102:104], v56, s[12:15], s41 offen offset:576 sc0 sc1
    v_accvgpr_read_b32 v111, a134
    v_accvgpr_read_b32 v112, a138
    v_accvgpr_read_b32 v113, a142
    v_cvt_pk_bf16_f32 v108, v108, v109
    v_mul_f32 v111, v111, v130
    v_mul_f32 v112, v112, v130
    v_mul_f32 v113, v113, v130
    v_cvt_pk_bf16_f32 v109, v110, v111
    v_cvt_pk_bf16_f32 v110, v112, v113
    buffer_store_dwordx3 v[108:110], v56, s[12:15], s41 offen offset:960 sc0 sc1
    v_accvgpr_read_b32 v117, a135
    v_accvgpr_read_b32 v118, a139
    v_accvgpr_read_b32 v119, a143
    v_cvt_pk_bf16_f32 v114, v114, v115
    v_mul_f32 v117, v117, v131
    v_mul_f32 v118, v118, v131
    v_mul_f32 v119, v119, v131
    v_cvt_pk_bf16_f32 v115, v116, v117
    v_cvt_pk_bf16_f32 v116, v118, v119
    buffer_store_dwordx3 v[114:116], v56, s[12:15], s41 offen offset:1344 sc0 sc1
    v_accvgpr_read_b32 v123, a180
    v_accvgpr_read_b32 v124, a184
    v_accvgpr_read_b32 v125, a188
    v_cvt_pk_bf16_f32 v120, v120, v121
    v_mul_f32 v123, v123, v132
    v_mul_f32 v124, v124, v132
    v_mul_f32 v125, v125, v132
    v_cvt_pk_bf16_f32 v121, v122, v123
    v_cvt_pk_bf16_f32 v122, v124, v125
    buffer_store_dwordx3 v[120:122], v56, s[12:15], s42 offen offset:192 sc0 sc1
    v_accvgpr_read_b32 v67, a181
    v_accvgpr_read_b32 v68, a185
    v_accvgpr_read_b32 v69, a189
    v_cvt_pk_bf16_f32 v64, v64, v65
    v_mul_f32 v67, v67, v133
    v_mul_f32 v68, v68, v133
    v_mul_f32 v69, v69, v133
    v_cvt_pk_bf16_f32 v65, v66, v67
    v_cvt_pk_bf16_f32 v66, v68, v69
    buffer_store_dwordx3 v[64:66], v56, s[12:15], s42 offen offset:576 sc0 sc1
    v_accvgpr_read_b32 v73, a182
    v_accvgpr_read_b32 v74, a186
    v_accvgpr_read_b32 v75, a190
    v_cvt_pk_bf16_f32 v70, v70, v71
    v_mul_f32 v73, v73, v134
    v_mul_f32 v74, v74, v134
    v_mul_f32 v75, v75, v134
    v_cvt_pk_bf16_f32 v71, v72, v73
    v_cvt_pk_bf16_f32 v72, v74, v75
    buffer_store_dwordx3 v[70:72], v56, s[12:15], s42 offen offset:960 sc0 sc1
    v_accvgpr_read_b32 v147, a183
    v_accvgpr_read_b32 v148, a187
    v_accvgpr_read_b32 v149, a191
    v_cvt_pk_bf16_f32 v144, v144, v145
    v_mul_f32 v147, v147, v135
    v_mul_f32 v148, v148, v135
    v_mul_f32 v149, v149, v135
    v_cvt_pk_bf16_f32 v145, v146, v147
    v_cvt_pk_bf16_f32 v146, v148, v149
    buffer_store_dwordx3 v[144:146], v56, s[12:15], s42 offen offset:1344 sc0 sc1
L_fin:
L_done:
    s_endpgm
L_pollslow0:
    s_mov_b32 s59, 60
L_pollsm0:
    s_buffer_load_dwordx8 s[48:55], s[20:23], s44 glc
    s_waitcnt lgkmcnt(0)
    s_sub_u32 s48, s48, s92
    s_sub_u32 s49, s49, s92
    s_sub_u32 s50, s50, s92
    s_sub_u32 s51, s51, s92
    s_sub_u32 s52, s52, s92
    s_sub_u32 s53, s53, s92
    s_sub_u32 s54, s54, s92
    s_sub_u32 s55, s55, s92
    s_max_u32 s48, s48, s49
    s_max_u32 s48, s48, s50
    s_max_u32 s48, s48, s51
    s_max_u32 s48, s48, s52
    s_max_u32 s48, s48, s53
    s_max_u32 s48, s48, s54
    s_max_u32 s48, s48, s55
    s_cmp_lt_u32 s48, 16
    s_cbranch_scc1 L_pollok0
    s_sub_u32 s59, s59, 1
    s_cbranch_scc1 L_pollvec0
    s_sleep 1
    s_branch L_pollsm0
L_pollvec0:
    v_bfe_u32 v53, v4, 4, 6
    v_lshlrev_b32 v53, 2, v53
    s_sub_u32 s96, s96, 1
    s_cbranch_scc1 L_pollgiveup0
    s_sleep 2
    buffer_load_dword v52, v53, s[20:23], s44 offen sc1
    s_waitcnt vmcnt(0)
    s_bitcmp1_b32 s92, 9
    s_cbranch_scc1 L_nomix
    v_xor_b32 v53, s92, v52
    v_lshrrev_b32 v53, 5, v53
    v_add_u32 v53, -1, v53
    v_cmp_gt_u32 vcc, 31, v53
    s_nop 1
    s_and_b32 s59, vcc_lo, 0xff
    s_cbranch_scc0 L_nomix
    buffer_store_dwordx4 v[224:227], v11, s[4:7], s33 offen offset:0 sc1
    v_xor_b32 v55, 16, v11
    buffer_store_dwordx4 v[228:231], v55, s[4:7], s33 offen offset:768 sc1
    v_xor_b32 v54, 32, v11
    buffer_store_dwordx4 v[232:235], v54, s[4:7], s33 offen offset:1536 sc1
    v_xor_b32 v55, 48, v11
    buffer_store_dwordx4 v[236:239], v55, s[4:7], s33 offen offset:2304 sc1
    buffer_store_dwordx4 v[112:115], v15, s[4:7], s35 offen offset:0 sc1
    buffer_store_dwordx4 v[116:119], v15, s[4:7], s35 offen offset:1024 sc1
    buffer_store_dwordx4 v[120:123], v15, s[4:7], s35 offen offset:2048 sc1
    s_waitcnt vmcnt(0)
    s_barrier
    s_and_b32 s92, s92, 0xfffffc00
    s_add_u32 s92, s92, 512
    v_mov_b32 v0, s92
    s_add_u32 s92, s92, 1
    s_mov_b32 s44, 32
    v_add_u32 v0, 1, v0
    buffer_store_dword v0, v13, s[20:23], 0 offen offset:32 sc1
    s_branch L_pollvec0
L_nomix:
    v_subrev_u32 v52, s92, v52
    v_cmp_lt_u32 vcc, 15, v52
    s_nop 0
    s_and_b32 s59, vcc_lo, 0xff
    s_cbranch_scc1 L_pollvec0
    s_branch L_pollok0
L_pollgiveup0:
    s_mov_b32 s96, 0
    s_branch L_pollok0
L_pollslow1:
    s_mov_b32 s59, 200
L_pollsm1:
    s_buffer_load_dwordx8 s[48:55], s[20:23], s44 glc
    s_waitcnt lgkmcnt(0)
    s_sub_u32 s48, s48, s92
    s_sub_u32 s49, s49, s92
    s_sub_u32 s50, s50, s92
    s_sub_u32 s51, s51, s92
    s_sub_u32 s52, s52, s92
    s_sub_u32 s53, s53, s92
    s_sub_u32 s54, s54, s92
    s_sub_u32 s55, s55, s92
    s_max_u32 s48, s48, s49
    s_max_u32 s48, s48, s50
    s_max_u32 s48, s48, s51
    s_max_u32 s48, s48, s52
    s_max_u32 s48, s48, s53
    s_max_u32 s48, s48, s54
    s_max_u32 s48, s48, s55
    s_cmp_lt_u32 s48, 16
    s_cbranch_scc1 L_pollok1
    s_sub_u32 s59, s59, 1
    s_cbranch_scc1 L_pollvec1
    s_sleep 1
    s_branch L_pollsm1
L_pollvec1:
    v_bfe_u32 v53, v4, 4, 6
    v_lshlrev_b32 v53, 2, v53
    s_sub_u32 s96, s96, 1
    s_cbranch_scc1 L_pollgiveup1
    s_sleep 2
    buffer_load_dword v52, v53, s[20:23], s44 offen sc1
    s_waitcnt vmcnt(0)
    v_subrev_u32 v52, s92, v52
    v_cmp_lt_u32 vcc, 15, v52
    s_nop 0
    s_and_b32 s59, vcc_lo, 0xff
    s_cbranch_scc1 L_pollvec1
    s_branch L_pollok1
L_pollgiveup1:
    s_mov_b32 s96, 0
    s_branch L_pollok1
L_pollslow2:
    s_mov_b32 s59, 200
L_pollsm2:
    s_buffer_load_dwordx8 s[48:55], s[20:23], s44 glc
    s_waitcnt lgkmcnt(0)
    s_sub_u32 s48, s48, s92
    s_sub_u32 s49, s49, s92
    s_sub_u32 s50, s50, s92
    s_sub_u32 s51, s51, s92
    s_sub_u32 s52, s52, s92
    s_sub_u32 s53, s53, s92
    s_sub_u32 s54, s54, s92
    s_sub_u32 s55, s55, s92
    s_max_u32 s48, s48, s49
    s_max_u32 s48, s48, s50
    s_max_u32 s48, s48, s51
    s_max_u32 s48, s48, s52
    s_max_u32 s48, s48, s53
    s_max_u32 s48, s48, s54
    s_max_u32 s48, s48, s55
    s_cmp_lt_u32 s48, 16
    s_cbranch_scc1 L_pollok2
    s_sub_u32 s59, s59, 1
    s_cbranch_scc1 L_pollvec2
    s_sleep 1
    s_branch L_pollsm2
L_pollvec2:
    v_bfe_u32 v53, v4, 4, 6
    v_lshlrev_b32 v53, 2, v53
    s_sub_u32 s96, s96, 1
    s_cbranch_scc1 L_pollgiveup2
    s_sleep 2
    buffer_load_dword v52, v53, s[20:23], s44 offen sc1
    s_waitcnt vmcnt(0)
    v_subrev_u32 v52, s92, v52
    v_cmp_lt_u32 vcc, 15, v52
    s_nop 0
    s_and_b32 s59, vcc_lo, 0xff
    s_cbranch_scc1 L_pollvec2
    s_branch L_pollok2
L_pollgiveup2:
    s_mov_b32 s96, 0
    s_branch L_pollok2
L_pollslow3:
    s_mov_b32 s59, 200
L_pollsm3:
    s_buffer_load_dwordx8 s[48:55], s[20:23], s44 glc
    s_waitcnt lgkmcnt(0)
    s_sub_u32 s48, s48, s92
    s_sub_u32 s49, s49, s92
    s_sub_u32 s50, s50, s92
    s_sub_u32 s51, s51, s92
    s_sub_u32 s52, s52, s92
    s_sub_u32 s53, s53, s92
    s_sub_u32 s54, s54, s92
    s_sub_u32 s55, s55, s92
    s_max_u32 s48, s48, s49
    s_max_u32 s48, s48, s50
    s_max_u32 s48, s48, s51
    s_max_u32 s48, s48, s52
    s_max_u32 s48, s48, s53
    s_max_u32 s48, s48, s54
    s_max_u32 s48, s48, s55
    s_cmp_lt_u32 s48, 16
    s_cbranch_scc1 L_pollok3
    s_sub_u32 s59, s59, 1
    s_cbranch_scc1 L_pollvec3
    s_sleep 1
    s_branch L_pollsm3
L_pollvec3:
    v_bfe_u32 v53, v4, 4, 6
    v_lshlrev_b32 v53, 2, v53
    s_sub_u32 s96, s96, 1
    s_cbranch_scc1 L_pollgiveup3
    s_sleep 2
    buffer_load_dword v52, v53, s[20:23], s44 offen sc1
    s_waitcnt vmcnt(0)
    v_subrev_u32 v52, s92, v52
    v_cmp_lt_u32 vcc, 15, v52
    s_nop 0
    s_and_b32 s59, vcc_lo, 0xff
    s_cbranch_scc1 L_pollvec3
    s_branch L_pollok3
L_pollgiveup3:
    s_mov_b32 s96, 0
    s_branch L_pollok3
L_pollslow4:
    s_mov_b32 s59, 200
L_pollsm4:
    s_buffer_load_dwordx8 s[48:55], s[20:23], s44 glc
    s_waitcnt lgkmcnt(0)
    s_sub_u32 s48, s48, s92
    s_sub_u32 s49, s49, s92
    s_sub_u32 s50, s50, s92
    s_sub_u32 s51, s51, s92
    s_sub_u32 s52, s52, s92
    s_sub_u32 s53, s53, s92
    s_sub_u32 s54, s54, s92
    s_sub_u32 s55, s55, s92
    s_max_u32 s48, s48, s49
    s_max_u32 s48, s48, s50
    s_max_u32 s48, s48, s51
    s_max_u32 s48, s48, s52
    s_max_u32 s48, s48, s53
    s_max_u32 s48, s48, s54
    s_max_u32 s48, s48, s55
    s_cmp_lt_u32 s48, 16
    s_cbranch_scc1 L_pollok4
    s_sub_u32 s59, s59, 1
    s_cbranch_scc1 L_pollvec4
    s_sleep 1
    s_branch L_pollsm4
L_pollvec4:
    v_bfe_u32 v53, v4, 4, 6
    v_lshlrev_b32 v53, 2, v53
    s_sub_u32 s96, s96, 1
    s_cbranch_scc1 L_pollgiveup4
    s_sleep 2
    buffer_load_dword v52, v53, s[20:23], s44 offen sc1
    s_waitcnt vmcnt(0)
    v_subrev_u32 v52, s92, v52
    v_cmp_lt_u32 vcc, 15, v52
    s_nop 0
    s_and_b32 s59, vcc_lo, 0xff
    s_cbranch_scc1 L_pollvec4
    s_branch L_pollok4
L_pollgiveup4:
    s_mov_b32 s96, 0
    s_branch L_pollok4
L_tagslow:
    s_sub_u32 s96, s96, 1
    s_cbranch_scc1 L_taggiveup
    s_sleep 2
    buffer_load_dword v0, off, s[88:91], s93 sc1
    s_waitcnt vmcnt(0)
    v_readfirstlane_b32 s42, v0
    s_nop 0
    s_cmp_eq_u32 s42, s46
    s_cbranch_scc1 L_tagslow
    s_cmp_eq_u32 s42, 0
    s_cbranch_scc1 L_tagslow
    s_branch L_tagok
L_taggiveup:
    s_mov_b32 s96, 0
    s_branch L_tagok
L_slow:
    s_waitcnt vmcnt(0) lgkmcnt(0)
    s_nop 15
    v_accvgpr_write_b32 a0, 0
    v_accvgpr_write_b32 a1, 0
    v_accvgpr_write_b32 a2, 0
    v_accvgpr_write_b32 a3, 0
    v_accvgpr_write_b32 a4, 0
    v_accvgpr_write_b32 a5, 0
    v_accvgpr_write_b32 a6, 0
    v_accvgpr_write_b32 a7, 0
    v_accvgpr_write_b32 a8, 0
    v_accvgpr_write_b32 a9, 0
    v_accvgpr_write_b32 a10, 0
    v_accvgpr_write_b32 a11, 0
    v_accvgpr_write_b32 a12, 0
    v_accvgpr_write_b32 a13, 0
    v_accvgpr_write_b32 a14, 0
    v_accvgpr_write_b32 a15, 0
    v_accvgpr_write_b32 a16, 0
    v_accvgpr_write_b32 a17, 0
    v_accvgpr_write_b32 a18, 0
    v_accvgpr_write_b32 a19, 0
    v_accvgpr_write_b32 a20, 0
    v_accvgpr_write_b32 a21, 0
    v_accvgpr_write_b32 a22, 0
    v_accvgpr_write_b32 a23, 0
    v_accvgpr_write_b32 a24, 0
    v_accvgpr_write_b32 a25, 0
    v_accvgpr_write_b32 a26, 0
    v_accvgpr_write_b32 a27, 0
    v_accvgpr_write_b32 a28, 0
    v_accvgpr_write_b32 a29, 0
    v_accvgpr_write_b32 a30, 0
    v_accvgpr_write_b32 a31, 0
    v_accvgpr_write_b32 a32, 0
    v_accvgpr_write_b32 a33, 0
    v_accvgpr_write_b32 a34, 0
    v_accvgpr_write_b32 a35, 0
    v_accvgpr_write_b32 a36, 0
    v_accvgpr_write_b32 a37, 0
    v_accvgpr_write_b32 a38, 0
    v_accvgpr_write_b32 a39, 0
    v_accvgpr_write_b32 a40, 0
    v_accvgpr_write_b32 a41, 0
    v_accvgpr_write_b32 a42, 0
    v_accvgpr_write_b32 a43, 0
    v_accvgpr_write_b32 a44, 0
    v_accvgpr_write_b32 a45, 0
    v_accvgpr_write_b32 a46, 0
    v_accvgpr_write_b32 a47, 0
    v_accvgpr_write_b32 a48, 0
    v_accvgpr_write_b32 a49, 0
    v_accvgpr_write_b32 a50, 0
    v_accvgpr_write_b32 a51, 0
    v_accvgpr_write_b32 a52, 0
    v_accvgpr_write_b32 a53, 0
    v_accvgpr_write_b32 a54, 0
    v_accvgpr_write_b32 a55, 0
    v_accvgpr_write_b32 a56, 0
    v_accvgpr_write_b32 a57, 0
    v_accvgpr_write_b32 a58, 0
    v_accvgpr_write_b32 a59, 0
    v_accvgpr_write_b32 a60, 0
    v_accvgpr_write_b32 a61, 0
    v_accvgpr_write_b32 a62, 0
    v_accvgpr_write_b32 a63, 0
    v_accvgpr_write_b32 a64, 0
    v_accvgpr_write_b32 a65, 0
    v_accvgpr_write_b32 a66, 0
    v_accvgpr_write_b32 a67, 0
    v_accvgpr_write_b32 a68, 0
    v_accvgpr_write_b32 a69, 0
    v_accvgpr_write_b32 a70, 0
    v_accvgpr_write_b32 a71, 0
    v_accvgpr_write_b32 a72, 0
    v_accvgpr_write_b32 a73, 0
    v_accvgpr_write_b32 a74, 0
    v_accvgpr_write_b32 a75, 0
    v_accvgpr_write_b32 a76, 0
    v_accvgpr_write_b32 a77, 0
    v_accvgpr_write_b32 a78, 0
    v_accvgpr_write_b32 a79, 0
    v_accvgpr_write_b32 a80, 0
    v_accvgpr_write_b32 a81, 0
    v_accvgpr_write_b32 a82, 0
    v_accvgpr_write_b32 a83, 0
    v_accvgpr_write_b32 a84, 0
    v_accvgpr_write_b32 a85, 0
    v_accvgpr_write_b32 a86, 0
    v_accvgpr_write_b32 a87, 0
    v_accvgpr_write_b32 a88, 0
    v_accvgpr_write_b32 a89, 0
    v_accvgpr_write_b32 a90, 0
    v_accvgpr_write_b32 a91, 0
    v_accvgpr_write_b32 a92, 0
    v_accvgpr_write_b32 a93, 0
    v_accvgpr_write_b32 a94, 0
    v_accvgpr_write_b32 a95, 0
    v_accvgpr_write_b32 a96, 0
    v_accvgpr_write_b32 a97, 0
    v_accvgpr_write_b32 a98, 0
    v_accvgpr_write_b32 a99, 0
    v_accvgpr_write_b32 a100, 0
    v_accvgpr_write_b32 a101, 0
    v_accvgpr_write_b32 a102, 0
    v_accvgpr_write_b32 a103, 0
    v_accvgpr_write_b32 a104, 0
    v_accvgpr_write_b32 a105, 0
    v_accvgpr_write_b32 a106, 0
    v_accvgpr_write_b32 a107, 0
    v_accvgpr_write_b32 a108, 0
    v_accvgpr_write_b32 a109, 0
    v_accvgpr_write_b32 a110, 0
    v_accvgpr_write_b32 a111, 0
    v_accvgpr_write_b32 a112, 0
    v_accvgpr_write_b32 a113, 0
    v_accvgpr_write_b32 a114, 0
    v_accvgpr_write_b32 a115, 0
    v_accvgpr_write_b32 a116, 0
    v_accvgpr_write_b32 a117, 0
    v_accvgpr_write_b32 a118, 0
    v_accvgpr_write_b32 a119, 0
    v_accvgpr_write_b32 a120, 0
    v_accvgpr_write_b32 a121, 0
    v_accvgpr_write_b32 a122, 0
    v_accvgpr_write_b32 a123, 0
    v_accvgpr_write_b32 a124, 0
    v_accvgpr_write_b32 a125, 0
    v_accvgpr_write_b32 a126, 0
    v_accvgpr_write_b32 a127, 0
    v_accvgpr_write_b32 a128, 0
    v_accvgpr_write_b32 a129, 0
    v_accvgpr_write_b32 a130, 0
    v_accvgpr_write_b32 a131, 0
    v_accvgpr_write_b32 a132, 0
    v_accvgpr_write_b32 a133, 0
    v_accvgpr_write_b32 a134, 0
    v_accvgpr_write_b32 a135, 0
    v_accvgpr_write_b32 a136, 0
    v_accvgpr_write_b32 a137, 0
    v_accvgpr_write_b32 a138, 0
    v_accvgpr_write_b32 a139, 0
    v_accvgpr_write_b32 a140, 0
    v_accvgpr_write_b32 a141, 0
    v_accvgpr_write_b32 a142, 0
    v_accvgpr_write_b32 a143, 0
    v_accvgpr_write_b32 a144, 0
    v_accvgpr_write_b32 a145, 0
    v_accvgpr_write_b32 a146, 0
    v_accvgpr_write_b32 a147, 0
    v_accvgpr_write_b32 a148, 0
    v_accvgpr_write_b32 a149, 0
    v_accvgpr_write_b32 a150, 0
    v_accvgpr_write_b32 a151, 0
    v_accvgpr_write_b32 a152, 0
    v_accvgpr_write_b32 a153, 0
    v_accvgpr_write_b32 a154, 0
    v_accvgpr_write_b32 a155, 0
    v_accvgpr_write_b32 a156, 0
    v_accvgpr_write_b32 a157, 0
    v_accvgpr_write_b32 a158, 0
    v_accvgpr_write_b32 a159, 0
    v_accvgpr_write_b32 a160, 0
    v_accvgpr_write_b32 a161, 0
    v_accvgpr_write_b32 a162, 0
    v_accvgpr_write_b32 a163, 0
    v_accvgpr_write_b32 a164, 0
    v_accvgpr_write_b32 a165, 0
    v_accvgpr_write_b32 a166, 0
    v_accvgpr_write_b32 a167, 0
    v_accvgpr_write_b32 a168, 0
    v_accvgpr_write_b32 a169, 0
    v_accvgpr_write_b32 a170, 0
    v_accvgpr_write_b32 a171, 0
    v_accvgpr_write_b32 a172, 0
    v_accvgpr_write_b32 a173, 0
    v_accvgpr_write_b32 a174, 0
    v_accvgpr_write_b32 a175, 0
    v_accvgpr_write_b32 a176, 0
    v_accvgpr_write_b32 a177, 0
    v_accvgpr_write_b32 a178, 0
    v_accvgpr_write_b32 a179, 0
    v_accvgpr_write_b32 a180, 0
    v_accvgpr_write_b32 a181, 0
    v_accvgpr_write_b32 a182, 0
    v_accvgpr_write_b32 a183, 0
    v_accvgpr_write_b32 a184, 0
    v_accvgpr_write_b32 a185, 0
    v_accvgpr_write_b32 a186, 0
    v_accvgpr_write_b32 a187, 0
    v_accvgpr_write_b32 a188, 0
    v_accvgpr_write_b32 a189, 0
    v_accvgpr_write_b32 a190, 0
    v_accvgpr_write_b32 a191, 0
    v_mov_b32 v5, 0
    v_mov_b32 v240, 0xff7fffff
    v_mov_b32 v6, 0
    v_mov_b32 v241, 0xff7fffff
    v_mov_b32 v7, 0
    v_mov_b32 v242, 0xff7fffff
    v_mov_b32 v8, 0
    v_mov_b32 v243, 0xff7fffff
    v_subrev_u32 v244, 49152, v2
    v_subrev_u32 v245, 49152, v3
    v_subrev_u32 v246, 24576, v1
    s_mov_b32 s48, 0
L_slowloop:
    s_add_u32 s49, s48, 6144
    s_add_u32 s50, s48, 12288
    s_add_u32 s51, s48, 16384
    s_add_u32 s52, s48, 20480
    buffer_load_dwordx4 v[64:67], v244, s[4:7], s48 offen offset:0 sc1
    buffer_load_dwordx4 v[68:71], v245, s[4:7], s48 offen offset:0 sc1
    buffer_load_dwordx4 v[72:75], v244, s[4:7], s49 offen offset:0 sc1
    buffer_load_dwordx4 v[76:79], v245, s[4:7], s49 offen offset:0 sc1
    buffer_load_dwordx4 v[80:83], v244, s[4:7], s48 offen offset:128 sc1
    buffer_load_dwordx4 v[84:87], v245, s[4:7], s48 offen offset:128 sc1
    buffer_load_dwordx4 v[88:91], v244, s[4:7], s49 offen offset:128 sc1
    buffer_load_dwordx4 v[92:95], v245, s[4:7], s49 offen offset:128 sc1
    buffer_load_dwordx4 v[96:99], v244, s[4:7], s48 offen offset:256 sc1
    buffer_load_dwordx4 v[100:103], v245, s[4:7], s48 offen offset:256 sc1
    buffer_load_dwordx4 v[104:107], v244, s[4:7], s49 offen offset:256 sc1
    buffer_load_dwordx4 v[108:111], v245, s[4:7], s49 offen offset:256 sc1
    buffer_load_dwordx4 v[112:115], v246, s[4:7], s50 offen offset:0 sc1
    buffer_load_dwordx4 v[116:119], v246, s[4:7], s50 offen offset:1024 sc1
    buffer_load_dwordx4 v[120:123], v246, s[4:7], s50 offen offset:2048 sc1
    buffer_load_dwordx4 v[124:127], v246, s[4:7], s50 offen offset:3072 sc1
    buffer_load_dwordx4 v[128:131], v246, s[4:7], s51 offen offset:0 sc1
    buffer_load_dwordx4 v[132:135], v246, s[4:7], s51 offen offset:1024 sc1
    buffer_load_dwordx4 v[136:139], v246, s[4:7], s51 offen offset:2048 sc1
    buffer_load_dwordx4 v[140:143], v246, s[4:7], s51 offen offset:3072 sc1
    buffer_load_dwordx4 v[144:147], v246, s[4:7], s52 offen offset:0 sc1
    buffer_load_dwordx4 v[148:151], v246, s[4:7], s52 offen offset:1024 sc1
    buffer_load_dwordx4 v[152:155], v246, s[4:7], s52 offen offset:2048 sc1
    buffer_load_dwordx4 v[156:159], v246, s[4:7], s52 offen offset:3072 sc1
    s_waitcnt vmcnt(12)
    v_mfma_f32_16x16x32_bf16 v[160:163], v[64:67], a[192:195], 0
    v_mfma_f32_16x16x32_bf16 v[168:171], v[64:67], a[216:219], 0
    v_mfma_f32_16x16x32_bf16 v[176:179], v[64:67], a[240:243], 0
    v_mfma_f32_16x16x32_bf16 v[184:187], v[64:67], v[200:203], 0
    v_mfma_f32_16x16x32_bf16 v[160:163], v[68:71], a[196:199], v[160:163]
    v_mfma_f32_16x16x32_bf16 v[168:171], v[68:71], a[220:223], v[168:171]
    v_mfma_f32_16x16x32_bf16 v[176:179], v[68:71], a[244:247], v[176:179]
    v_mfma_f32_16x16x32_bf16 v[184:187], v[68:71], v[204:207], v[184:187]
    v_mfma_f32_16x16x32_bf16 v[164:167], v[72:75], a[192:195], 0
    v_mfma_f32_16x16x32_bf16 v[172:175], v[72:75], a[216:219], 0
    v_mfma_f32_16x16x32_bf16 v[180:183], v[72:75], a[240:243], 0
    v_mfma_f32_16x16x32_bf16 v[188:191], v[72:75], v[200:203], 0
    v_mfma_f32_16x16x32_bf16 v[164:167], v[76:79], a[196:199], v[164:167]
    v_mfma_f32_16x16x32_bf16 v[172:175], v[76:79], a[220:223], v[172:175]
    v_mfma_f32_16x16x32_bf16 v[180:183], v[76:79], a[244:247], v[180:183]
    v_mfma_f32_16x16x32_bf16 v[188:191], v[76:79], v[204:207], v[188:191]
    v_mfma_f32_16x16x32_bf16 v[160:163], v[80:83], a[200:203], v[160:163]
    v_mfma_f32_16x16x32_bf16 v[168:171], v[80:83], a[224:227], v[168:171]
    v_mfma_f32_16x16x32_bf16 v[176:179], v[80:83], a[248:251], v[176:179]
    v_mfma_f32_16x16x32_bf16 v[184:187], v[80:83], v[208:211], v[184:187]
    v_mfma_f32_16x16x32_bf16 v[160:163], v[84:87], a[204:207], v[160:163]
    v_mfma_f32_16x16x32_bf16 v[168:171], v[84:87], a[228:231], v[168:171]
    v_mfma_f32_16x16x32_bf16 v[176:179], v[84:87], a[252:255], v[176:179]
    v_mfma_f32_16x16x32_bf16 v[184:187], v[84:87], v[212:215], v[184:187]
    v_mfma_f32_16x16x32_bf16 v[164:167], v[88:91], a[200:203], v[164:167]
    v_mfma_f32_16x16x32_bf16 v[172:175], v[88:91], a[224:227], v[172:175]
    v_mfma_f32_16x16x32_bf16 v[180:183], v[88:91], a[248:251], v[180:183]
    v_mfma_f32_16x16x32_bf16 v[188:191], v[88:91], v[208:211], v[188:191]
    v_mfma_f32_16x16x32_bf16 v[164:167], v[92:95], a[204:207], v[164:167]
    v_mfma_f32_16x16x32_bf16 v[172:175], v[92:95], a[228:231], v[172:175]
    v_mfma_f32_16x16x32_bf16 v[180:183], v[92:95], a[252:255], v[180:183]
    v_mfma_f32_16x16x32_bf16 v[188:191], v[92:95], v[212:215], v[188:191]
    v_mfma_f32_16x16x32_bf16 v[160:163], v[96:99], a[208:211], v[160:163]
    v_mfma_f32_16x16x32_bf16 v[168:171], v[96:99], a[232:235], v[168:171]
    v_mfma_f32_16x16x32_bf16 v[176:179], v[96:99], v[192:195], v[176:179]
    v_mfma_f32_16x16x32_bf16 v[184:187], v[96:99], v[216:219], v[184:187]
    v_mfma_f32_16x16x32_bf16 v[160:163], v[100:103], a[212:215], v[160:163]
    v_mfma_f32_16x16x32_bf16 v[168:171], v[100:103], a[236:239], v[168:171]
    v_mfma_f32_16x16x32_bf16 v[176:179], v[100:103], v[196:199], v[176:179]
    v_mfma_f32_16x16x32_bf16 v[184:187], v[100:103], v[220:223], v[184:187]
    v_mfma_f32_16x16x32_bf16 v[164:167], v[104:107], a[208:211], v[164:167]
    v_mfma_f32_16x16x32_bf16 v[172:175], v[104:107], a[232:235], v[172:175]
    v_mfma_f32_16x16x32_bf16 v[180:183], v[104:107], v[192:195], v[180:183]
    v_mfma_f32_16x16x32_bf16 v[188:191], v[104:107], v[216:219], v[188:191]
    v_mfma_f32_16x16x32_bf16 v[164:167], v[108:111], a[212:215], v[164:167]
    v_mfma_f32_16x16x32_bf16 v[172:175], v[108:111], a[236:239], v[172:175]
    v_mfma_f32_16x16x32_bf16 v[180:183], v[108:111], v[196:199], v[180:183]
    v_mfma_f32_16x16x32_bf16 v[188:191], v[108:111], v[220:223], v[188:191]
    s_nop 9
    v_max3_f32 v16, v160, v161, v162
    v_max3_f32 v16, v16, v163, v164
    v_max3_f32 v16, v16, v165, v166
    v_max3_f32 v16, v16, v167, v240
    v_mov_b32 v17, v16
    s_nop 1
    v_permlane16_swap_b32 v16, v17
    s_nop 1
    v_max_f32 v16, v16, v17
    v_mov_b32 v17, v16
    s_nop 1
    v_permlane32_swap_b32 v16, v17
    s_nop 1
    v_max_f32 v16, v16, v17
    v_sub_f32 v17, v240, v16
    v_exp_f32 v17, v17
    v_mov_b32 v240, v16
    v_sub_f32 v160, v160, v16
    v_sub_f32 v161, v161, v16
    v_sub_f32 v162, v162, v16
    v_sub_f32 v163, v163, v16
    v_sub_f32 v164, v164, v16
    v_sub_f32 v165, v165, v16
    v_sub_f32 v166, v166, v16
    v_sub_f32 v167, v167, v16
    v_exp_f32 v160, v160
    v_exp_f32 v161, v161
    v_exp_f32 v162, v162
    v_exp_f32 v163, v163
    v_exp_f32 v164, v164
    v_exp_f32 v165, v165
    v_exp_f32 v166, v166
    v_exp_f32 v167, v167
    v_mul_f32 v5, v5, v17
    v_add_f32 v5, v5, v160
    v_add_f32 v5, v5, v161
    v_add_f32 v5, v5, v162
    v_add_f32 v5, v5, v163
    v_add_f32 v5, v5, v164
    v_add_f32 v5, v5, v165
    v_add_f32 v5, v5, v166
    v_add_f32 v5, v5, v167
    v_cvt_pk_bf16_f32 v224, v160, v161
    v_cvt_pk_bf16_f32 v225, v162, v163
    v_cvt_pk_bf16_f32 v226, v164, v165
    v_cvt_pk_bf16_f32 v227, v166, v167
    ds_bpermute_b32 v248, v58, v17 offset:0
    ds_bpermute_b32 v249, v58, v17 offset:4
    ds_bpermute_b32 v250, v58, v17 offset:8
    ds_bpermute_b32 v251, v58, v17 offset:12
    s_waitcnt lgkmcnt(0)
    v_accvgpr_read_b32 v18, a0
    v_mul_f32 v18, v18, v248
    v_accvgpr_write_b32 a0, v18
    v_accvgpr_read_b32 v19, a1
    v_mul_f32 v19, v19, v249
    v_accvgpr_write_b32 a1, v19
    v_accvgpr_read_b32 v18, a2
    v_mul_f32 v18, v18, v250
    v_accvgpr_write_b32 a2, v18
    v_accvgpr_read_b32 v19, a3
    v_mul_f32 v19, v19, v251
    v_accvgpr_write_b32 a3, v19
    v_accvgpr_read_b32 v18, a4
    v_mul_f32 v18, v18, v248
    v_accvgpr_write_b32 a4, v18
    v_accvgpr_read_b32 v19, a5
    v_mul_f32 v19, v19, v249
    v_accvgpr_write_b32 a5, v19
    v_accvgpr_read_b32 v18, a6
    v_mul_f32 v18, v18, v250
    v_accvgpr_write_b32 a6, v18
    v_accvgpr_read_b32 v19, a7
    v_mul_f32 v19, v19, v251
    v_accvgpr_write_b32 a7, v19
    v_accvgpr_read_b32 v18, a8
    v_mul_f32 v18, v18, v248
    v_accvgpr_write_b32 a8, v18
    v_accvgpr_read_b32 v19, a9
    v_mul_f32 v19, v19, v249
    v_accvgpr_write_b32 a9, v19
    v_accvgpr_read_b32 v18, a10
    v_mul_f32 v18, v18, v250
    v_accvgpr_write_b32 a10, v18
    v_accvgpr_read_b32 v19, a11
    v_mul_f32 v19, v19, v251
    v_accvgpr_write_b32 a11, v19
    v_accvgpr_read_b32 v18, a12
    v_mul_f32 v18, v18, v248
    v_accvgpr_write_b32 a12, v18
    v_accvgpr_read_b32 v19, a13
    v_mul_f32 v19, v19, v249
    v_accvgpr_write_b32 a13, v19
    v_accvgpr_read_b32 v18, a14
    v_mul_f32 v18, v18, v250
    v_accvgpr_write_b32 a14, v18
    v_accvgpr_read_b32 v19, a15
    v_mul_f32 v19, v19, v251
    v_accvgpr_write_b32 a15, v19
    v_accvgpr_read_b32 v18, a16
    v_mul_f32 v18, v18, v248
    v_accvgpr_write_b32 a16, v18
    v_accvgpr_read_b32 v19, a17
    v_mul_f32 v19, v19, v249
    v_accvgpr_write_b32 a17, v19
    v_accvgpr_read_b32 v18, a18
    v_mul_f32 v18, v18, v250
    v_accvgpr_write_b32 a18, v18
    v_accvgpr_read_b32 v19, a19
    v_mul_f32 v19, v19, v251
    v_accvgpr_write_b32 a19, v19
    v_accvgpr_read_b32 v18, a20
    v_mul_f32 v18, v18, v248
    v_accvgpr_write_b32 a20, v18
    v_accvgpr_read_b32 v19, a21
    v_mul_f32 v19, v19, v249
    v_accvgpr_write_b32 a21, v19
    v_accvgpr_read_b32 v18, a22
    v_mul_f32 v18, v18, v250
    v_accvgpr_write_b32 a22, v18
    v_accvgpr_read_b32 v19, a23
    v_mul_f32 v19, v19, v251
    v_accvgpr_write_b32 a23, v19
    v_accvgpr_read_b32 v18, a24
    v_mul_f32 v18, v18, v248
    v_accvgpr_write_b32 a24, v18
    v_accvgpr_read_b32 v19, a25
    v_mul_f32 v19, v19, v249
    v_accvgpr_write_b32 a25, v19
    v_accvgpr_read_b32 v18, a26
    v_mul_f32 v18, v18, v250
    v_accvgpr_write_b32 a26, v18
    v_accvgpr_read_b32 v19, a27
    v_mul_f32 v19, v19, v251
    v_accvgpr_write_b32 a27, v19
    v_accvgpr_read_b32 v18, a28
    v_mul_f32 v18, v18, v248
    v_accvgpr_write_b32 a28, v18
    v_accvgpr_read_b32 v19, a29
    v_mul_f32 v19, v19, v249
    v_accvgpr_write_b32 a29, v19
    v_accvgpr_read_b32 v18, a30
    v_mul_f32 v18, v18, v250
    v_accvgpr_write_b32 a30, v18
    v_accvgpr_read_b32 v19, a31
    v_mul_f32 v19, v19, v251
    v_accvgpr_write_b32 a31, v19
    v_accvgpr_read_b32 v18, a32
    v_mul_f32 v18, v18, v248
    v_accvgpr_write_b32 a32, v18
    v_accvgpr_read_b32 v19, a33
    v_mul_f32 v19, v19, v249
    v_accvgpr_write_b32 a33, v19
    v_accvgpr_read_b32 v18, a34
    v_mul_f32 v18, v18, v250
    v_accvgpr_write_b32 a34, v18
    v_accvgpr_read_b32 v19, a35
    v_mul_f32 v19, v19, v251
    v_accvgpr_write_b32 a35, v19
    v_accvgpr_read_b32 v18, a36
    v_mul_f32 v18, v18, v248
    v_accvgpr_write_b32 a36, v18
    v_accvgpr_read_b32 v19, a37
    v_mul_f32 v19, v19, v249
    v_accvgpr_write_b32 a37, v19
    v_accvgpr_read_b32 v18, a38
    v_mul_f32 v18, v18, v250
    v_accvgpr_write_b32 a38, v18
    v_accvgpr_read_b32 v19, a39
    v_mul_f32 v19, v19, v251
    v_accvgpr_write_b32 a39, v19
    v_accvgpr_read_b32 v18, a40
    v_mul_f32 v18, v18, v248
    v_accvgpr_write_b32 a40, v18
    v_accvgpr_read_b32 v19, a41
    v_mul_f32 v19, v19, v249
    v_accvgpr_write_b32 a41, v19
    v_accvgpr_read_b32 v18, a42
    v_mul_f32 v18, v18, v250
    v_accvgpr_write_b32 a42, v18
    v_accvgpr_read_b32 v19, a43
    v_mul_f32 v19, v19, v251
    v_accvgpr_write_b32 a43, v19
    v_accvgpr_read_b32 v18, a44
    v_mul_f32 v18, v18, v248
    v_accvgpr_write_b32 a44, v18
    v_accvgpr_read_b32 v19, a45
    v_mul_f32 v19, v19, v249
    v_accvgpr_write_b32 a45, v19
    v_accvgpr_read_b32 v18, a46
    v_mul_f32 v18, v18, v250
    v_accvgpr_write_b32 a46, v18
    v_accvgpr_read_b32 v19, a47
    v_mul_f32 v19, v19, v251
    v_accvgpr_write_b32 a47, v19
    v_max3_f32 v16, v168, v169, v170
    v_max3_f32 v16, v16, v171, v172
    v_max3_f32 v16, v16, v173, v174
    v_max3_f32 v16, v16, v175, v241
    v_mov_b32 v17, v16
    s_nop 1
    v_permlane16_swap_b32 v16, v17
    s_nop 1
    v_max_f32 v16, v16, v17
    v_mov_b32 v17, v16
    s_nop 1
    v_permlane32_swap_b32 v16, v17
    s_nop 1
    v_max_f32 v16, v16, v17
    v_sub_f32 v17, v241, v16
    v_exp_f32 v17, v17
    v_mov_b32 v241, v16
    v_sub_f32 v168, v168, v16
    v_sub_f32 v169, v169, v16
    v_sub_f32 v170, v170, v16
    v_sub_f32 v171, v171, v16
    v_sub_f32 v172, v172, v16
    v_sub_f32 v173, v173, v16
    v_sub_f32 v174, v174, v16
    v_sub_f32 v175, v175, v16
    v_exp_f32 v168, v168
    v_exp_f32 v169, v169
    v_exp_f32 v170, v170
    v_exp_f32 v171, v171
    v_exp_f32 v172, v172
    v_exp_f32 v173, v173
    v_exp_f32 v174, v174
    v_exp_f32 v175, v175
    v_mul_f32 v6, v6, v17
    v_add_f32 v6, v6, v168
    v_add_f32 v6, v6, v169
    v_add_f32 v6, v6, v170
    v_add_f32 v6, v6, v171
    v_add_f32 v6, v6, v172
    v_add_f32 v6, v6, v173
    v_add_f32 v6, v6, v174
    v_add_f32 v6, v6, v175
    v_cvt_pk_bf16_f32 v228, v168, v169
    v_cvt_pk_bf16_f32 v229, v170, v171
    v_cvt_pk_bf16_f32 v230, v172, v173
    v_cvt_pk_bf16_f32 v231, v174, v175
    ds_bpermute_b32 v248, v58, v17 offset:0
    ds_bpermute_b32 v249, v58, v17 offset:4
    ds_bpermute_b32 v250, v58, v17 offset:8
    ds_bpermute_b32 v251, v58, v17 offset:12
    s_waitcnt lgkmcnt(0)
    v_accvgpr_read_b32 v18, a48
    v_mul_f32 v18, v18, v248
    v_accvgpr_write_b32 a48, v18
    v_accvgpr_read_b32 v19, a49
    v_mul_f32 v19, v19, v249
    v_accvgpr_write_b32 a49, v19
    v_accvgpr_read_b32 v18, a50
    v_mul_f32 v18, v18, v250
    v_accvgpr_write_b32 a50, v18
    v_accvgpr_read_b32 v19, a51
    v_mul_f32 v19, v19, v251
    v_accvgpr_write_b32 a51, v19
    v_accvgpr_read_b32 v18, a52
    v_mul_f32 v18, v18, v248
    v_accvgpr_write_b32 a52, v18
    v_accvgpr_read_b32 v19, a53
    v_mul_f32 v19, v19, v249
    v_accvgpr_write_b32 a53, v19
    v_accvgpr_read_b32 v18, a54
    v_mul_f32 v18, v18, v250
    v_accvgpr_write_b32 a54, v18
    v_accvgpr_read_b32 v19, a55
    v_mul_f32 v19, v19, v251
    v_accvgpr_write_b32 a55, v19
    v_accvgpr_read_b32 v18, a56
    v_mul_f32 v18, v18, v248
    v_accvgpr_write_b32 a56, v18
    v_accvgpr_read_b32 v19, a57
    v_mul_f32 v19, v19, v249
    v_accvgpr_write_b32 a57, v19
    v_accvgpr_read_b32 v18, a58
    v_mul_f32 v18, v18, v250
    v_accvgpr_write_b32 a58, v18
    v_accvgpr_read_b32 v19, a59
    v_mul_f32 v19, v19, v251
    v_accvgpr_write_b32 a59, v19
    v_accvgpr_read_b32 v18, a60
    v_mul_f32 v18, v18, v248
    v_accvgpr_write_b32 a60, v18
    v_accvgpr_read_b32 v19, a61
    v_mul_f32 v19, v19, v249
    v_accvgpr_write_b32 a61, v19
    v_accvgpr_read_b32 v18, a62
    v_mul_f32 v18, v18, v250
    v_accvgpr_write_b32 a62, v18
    v_accvgpr_read_b32 v19, a63
    v_mul_f32 v19, v19, v251
    v_accvgpr_write_b32 a63, v19
    v_accvgpr_read_b32 v18, a64
    v_mul_f32 v18, v18, v248
    v_accvgpr_write_b32 a64, v18
    v_accvgpr_read_b32 v19, a65
    v_mul_f32 v19, v19, v249
    v_accvgpr_write_b32 a65, v19
    v_accvgpr_read_b32 v18, a66
    v_mul_f32 v18, v18, v250
    v_accvgpr_write_b32 a66, v18
    v_accvgpr_read_b32 v19, a67
    v_mul_f32 v19, v19, v251
    v_accvgpr_write_b32 a67, v19
    v_accvgpr_read_b32 v18, a68
    v_mul_f32 v18, v18, v248
    v_accvgpr_write_b32 a68, v18
    v_accvgpr_read_b32 v19, a69
    v_mul_f32 v19, v19, v249
    v_accvgpr_write_b32 a69, v19
    v_accvgpr_read_b32 v18, a70
    v_mul_f32 v18, v18, v250
    v_accvgpr_write_b32 a70, v18
    v_accvgpr_read_b32 v19, a71
    v_mul_f32 v19, v19, v251
    v_accvgpr_write_b32 a71, v19
    v_accvgpr_read_b32 v18, a72
    v_mul_f32 v18, v18, v248
    v_accvgpr_write_b32 a72, v18
    v_accvgpr_read_b32 v19, a73
    v_mul_f32 v19, v19, v249
    v_accvgpr_write_b32 a73, v19
    v_accvgpr_read_b32 v18, a74
    v_mul_f32 v18, v18, v250
    v_accvgpr_write_b32 a74, v18
    v_accvgpr_read_b32 v19, a75
    v_mul_f32 v19, v19, v251
    v_accvgpr_write_b32 a75, v19
    v_accvgpr_read_b32 v18, a76
    v_mul_f32 v18, v18, v248
    v_accvgpr_write_b32 a76, v18
    v_accvgpr_read_b32 v19, a77
    v_mul_f32 v19, v19, v249
    v_accvgpr_write_b32 a77, v19
    v_accvgpr_read_b32 v18, a78
    v_mul_f32 v18, v18, v250
    v_accvgpr_write_b32 a78, v18
    v_accvgpr_read_b32 v19, a79
    v_mul_f32 v19, v19, v251
    v_accvgpr_write_b32 a79, v19
    v_accvgpr_read_b32 v18, a80
    v_mul_f32 v18, v18, v248
    v_accvgpr_write_b32 a80, v18
    v_accvgpr_read_b32 v19, a81
    v_mul_f32 v19, v19, v249
    v_accvgpr_write_b32 a81, v19
    v_accvgpr_read_b32 v18, a82
    v_mul_f32 v18, v18, v250
    v_accvgpr_write_b32 a82, v18
    v_accvgpr_read_b32 v19, a83
    v_mul_f32 v19, v19, v251
    v_accvgpr_write_b32 a83, v19
    v_accvgpr_read_b32 v18, a84
    v_mul_f32 v18, v18, v248
    v_accvgpr_write_b32 a84, v18
    v_accvgpr_read_b32 v19, a85
    v_mul_f32 v19, v19, v249
    v_accvgpr_write_b32 a85, v19
    v_accvgpr_read_b32 v18, a86
    v_mul_f32 v18, v18, v250
    v_accvgpr_write_b32 a86, v18
    v_accvgpr_read_b32 v19, a87
    v_mul_f32 v19, v19, v251
    v_accvgpr_write_b32 a87, v19
    v_accvgpr_read_b32 v18, a88
    v_mul_f32 v18, v18, v248
    v_accvgpr_write_b32 a88, v18
    v_accvgpr_read_b32 v19, a89
    v_mul_f32 v19, v19, v249
    v_accvgpr_write_b32 a89, v19
    v_accvgpr_read_b32 v18, a90
    v_mul_f32 v18, v18, v250
    v_accvgpr_write_b32 a90, v18
    v_accvgpr_read_b32 v19, a91
    v_mul_f32 v19, v19, v251
    v_accvgpr_write_b32 a91, v19
    v_accvgpr_read_b32 v18, a92
    v_mul_f32 v18, v18, v248
    v_accvgpr_write_b32 a92, v18
    v_accvgpr_read_b32 v19, a93
    v_mul_f32 v19, v19, v249
    v_accvgpr_write_b32 a93, v19
    v_accvgpr_read_b32 v18, a94
    v_mul_f32 v18, v18, v250
    v_accvgpr_write_b32 a94, v18
    v_accvgpr_read_b32 v19, a95
    v_mul_f32 v19, v19, v251
    v_accvgpr_write_b32 a95, v19
    v_max3_f32 v16, v176, v177, v178
    v_max3_f32 v16, v16, v179, v180
    v_max3_f32 v16, v16, v181, v182
    v_max3_f32 v16, v16, v183, v242
    v_mov_b32 v17, v16
    s_nop 1
    v_permlane16_swap_b32 v16, v17
    s_nop 1
    v_max_f32 v16, v16, v17
    v_mov_b32 v17, v16
    s_nop 1
    v_permlane32_swap_b32 v16, v17
    s_nop 1
    v_max_f32 v16, v16, v17
    v_sub_f32 v17, v242, v16
    v_exp_f32 v17, v17
    v_mov_b32 v242, v16
    v_sub_f32 v176, v176, v16
    v_sub_f32 v177, v177, v16
    v_sub_f32 v178, v178, v16
    v_sub_f32 v179, v179, v16
    v_sub_f32 v180, v180, v16
    v_sub_f32 v181, v181, v16
    v_sub_f32 v182, v182, v16
    v_sub_f32 v183, v183, v16
    v_exp_f32 v176, v176
    v_exp_f32 v177, v177
    v_exp_f32 v178, v178
    v_exp_f32 v179, v179
    v_exp_f32 v180, v180
    v_exp_f32 v181, v181
    v_exp_f32 v182, v182
    v_exp_f32 v183, v183
    v_mul_f32 v7, v7, v17
    v_add_f32 v7, v7, v176
    v_add_f32 v7, v7, v177
    v_add_f32 v7, v7, v178
    v_add_f32 v7, v7, v179
    v_add_f32 v7, v7, v180
    v_add_f32 v7, v7, v181
    v_add_f32 v7, v7, v182
    v_add_f32 v7, v7, v183
    v_cvt_pk_bf16_f32 v232, v176, v177
    v_cvt_pk_bf16_f32 v233, v178, v179
    v_cvt_pk_bf16_f32 v234, v180, v181
    v_cvt_pk_bf16_f32 v235, v182, v183
    ds_bpermute_b32 v248, v58, v17 offset:0
    ds_bpermute_b32 v249, v58, v17 offset:4
    ds_bpermute_b32 v250, v58, v17 offset:8
    ds_bpermute_b32 v251, v58, v17 offset:12
    s_waitcnt lgkmcnt(0)
    v_accvgpr_read_b32 v18, a96
    v_mul_f32 v18, v18, v248
    v_accvgpr_write_b32 a96, v18
    v_accvgpr_read_b32 v19, a97
    v_mul_f32 v19, v19, v249
    v_accvgpr_write_b32 a97, v19
    v_accvgpr_read_b32 v18, a98
    v_mul_f32 v18, v18, v250
    v_accvgpr_write_b32 a98, v18
    v_accvgpr_read_b32 v19, a99
    v_mul_f32 v19, v19, v251
    v_accvgpr_write_b32 a99, v19
    v_accvgpr_read_b32 v18, a100
    v_mul_f32 v18, v18, v248
    v_accvgpr_write_b32 a100, v18
    v_accvgpr_read_b32 v19, a101
    v_mul_f32 v19, v19, v249
    v_accvgpr_write_b32 a101, v19
    v_accvgpr_read_b32 v18, a102
    v_mul_f32 v18, v18, v250
    v_accvgpr_write_b32 a102, v18
    v_accvgpr_read_b32 v19, a103
    v_mul_f32 v19, v19, v251
    v_accvgpr_write_b32 a103, v19
    v_accvgpr_read_b32 v18, a104
    v_mul_f32 v18, v18, v248
    v_accvgpr_write_b32 a104, v18
    v_accvgpr_read_b32 v19, a105
    v_mul_f32 v19, v19, v249
    v_accvgpr_write_b32 a105, v19
    v_accvgpr_read_b32 v18, a106
    v_mul_f32 v18, v18, v250
    v_accvgpr_write_b32 a106, v18
    v_accvgpr_read_b32 v19, a107
    v_mul_f32 v19, v19, v251
    v_accvgpr_write_b32 a107, v19
    v_accvgpr_read_b32 v18, a108
    v_mul_f32 v18, v18, v248
    v_accvgpr_write_b32 a108, v18
    v_accvgpr_read_b32 v19, a109
    v_mul_f32 v19, v19, v249
    v_accvgpr_write_b32 a109, v19
    v_accvgpr_read_b32 v18, a110
    v_mul_f32 v18, v18, v250
    v_accvgpr_write_b32 a110, v18
    v_accvgpr_read_b32 v19, a111
    v_mul_f32 v19, v19, v251
    v_accvgpr_write_b32 a111, v19
    v_accvgpr_read_b32 v18, a112
    v_mul_f32 v18, v18, v248
    v_accvgpr_write_b32 a112, v18
    v_accvgpr_read_b32 v19, a113
    v_mul_f32 v19, v19, v249
    v_accvgpr_write_b32 a113, v19
    v_accvgpr_read_b32 v18, a114
    v_mul_f32 v18, v18, v250
    v_accvgpr_write_b32 a114, v18
    v_accvgpr_read_b32 v19, a115
    v_mul_f32 v19, v19, v251
    v_accvgpr_write_b32 a115, v19
    v_accvgpr_read_b32 v18, a116
    v_mul_f32 v18, v18, v248
    v_accvgpr_write_b32 a116, v18
    v_accvgpr_read_b32 v19, a117
    v_mul_f32 v19, v19, v249
    v_accvgpr_write_b32 a117, v19
    v_accvgpr_read_b32 v18, a118
    v_mul_f32 v18, v18, v250
    v_accvgpr_write_b32 a118, v18
    v_accvgpr_read_b32 v19, a119
    v_mul_f32 v19, v19, v251
    v_accvgpr_write_b32 a119, v19
    v_accvgpr_read_b32 v18, a120
    v_mul_f32 v18, v18, v248
    v_accvgpr_write_b32 a120, v18
    v_accvgpr_read_b32 v19, a121
    v_mul_f32 v19, v19, v249
    v_accvgpr_write_b32 a121, v19
    v_accvgpr_read_b32 v18, a122
    v_mul_f32 v18, v18, v250
    v_accvgpr_write_b32 a122, v18
    v_accvgpr_read_b32 v19, a123
    v_mul_f32 v19, v19, v251
    v_accvgpr_write_b32 a123, v19
    v_accvgpr_read_b32 v18, a124
    v_mul_f32 v18, v18, v248
    v_accvgpr_write_b32 a124, v18
    v_accvgpr_read_b32 v19, a125
    v_mul_f32 v19, v19, v249
    v_accvgpr_write_b32 a125, v19
    v_accvgpr_read_b32 v18, a126
    v_mul_f32 v18, v18, v250
    v_accvgpr_write_b32 a126, v18
    v_accvgpr_read_b32 v19, a127
    v_mul_f32 v19, v19, v251
    v_accvgpr_write_b32 a127, v19
    v_accvgpr_read_b32 v18, a128
    v_mul_f32 v18, v18, v248
    v_accvgpr_write_b32 a128, v18
    v_accvgpr_read_b32 v19, a129
    v_mul_f32 v19, v19, v249
    v_accvgpr_write_b32 a129, v19
    v_accvgpr_read_b32 v18, a130
    v_mul_f32 v18, v18, v250
    v_accvgpr_write_b32 a130, v18
    v_accvgpr_read_b32 v19, a131
    v_mul_f32 v19, v19, v251
    v_accvgpr_write_b32 a131, v19
    v_accvgpr_read_b32 v18, a132
    v_mul_f32 v18, v18, v248
    v_accvgpr_write_b32 a132, v18
    v_accvgpr_read_b32 v19, a133
    v_mul_f32 v19, v19, v249
    v_accvgpr_write_b32 a133, v19
    v_accvgpr_read_b32 v18, a134
    v_mul_f32 v18, v18, v250
    v_accvgpr_write_b32 a134, v18
    v_accvgpr_read_b32 v19, a135
    v_mul_f32 v19, v19, v251
    v_accvgpr_write_b32 a135, v19
    v_accvgpr_read_b32 v18, a136
    v_mul_f32 v18, v18, v248
    v_accvgpr_write_b32 a136, v18
    v_accvgpr_read_b32 v19, a137
    v_mul_f32 v19, v19, v249
    v_accvgpr_write_b32 a137, v19
    v_accvgpr_read_b32 v18, a138
    v_mul_f32 v18, v18, v250
    v_accvgpr_write_b32 a138, v18
    v_accvgpr_read_b32 v19, a139
    v_mul_f32 v19, v19, v251
    v_accvgpr_write_b32 a139, v19
    v_accvgpr_read_b32 v18, a140
    v_mul_f32 v18, v18, v248
    v_accvgpr_write_b32 a140, v18
    v_accvgpr_read_b32 v19, a141
    v_mul_f32 v19, v19, v249
    v_accvgpr_write_b32 a141, v19
    v_accvgpr_read_b32 v18, a142
    v_mul_f32 v18, v18, v250
    v_accvgpr_write_b32 a142, v18
    v_accvgpr_read_b32 v19, a143
    v_mul_f32 v19, v19, v251
    v_accvgpr_write_b32 a143, v19
    v_max3_f32 v16, v184, v185, v186
    v_max3_f32 v16, v16, v187, v188
    v_max3_f32 v16, v16, v189, v190
    v_max3_f32 v16, v16, v191, v243
    v_mov_b32 v17, v16
    s_nop 1
    v_permlane16_swap_b32 v16, v17
    s_nop 1
    v_max_f32 v16, v16, v17
    v_mov_b32 v17, v16
    s_nop 1
    v_permlane32_swap_b32 v16, v17
    s_nop 1
    v_max_f32 v16, v16, v17
    v_sub_f32 v17, v243, v16
    v_exp_f32 v17, v17
    v_mov_b32 v243, v16
    v_sub_f32 v184, v184, v16
    v_sub_f32 v185, v185, v16
    v_sub_f32 v186, v186, v16
    v_sub_f32 v187, v187, v16
    v_sub_f32 v188, v188, v16
    v_sub_f32 v189, v189, v16
    v_sub_f32 v190, v190, v16
    v_sub_f32 v191, v191, v16
    v_exp_f32 v184, v184
    v_exp_f32 v185, v185
    v_exp_f32 v186, v186
    v_exp_f32 v187, v187
    v_exp_f32 v188, v188
    v_exp_f32 v189, v189
    v_exp_f32 v190, v190
    v_exp_f32 v191, v191
    v_mul_f32 v8, v8, v17
    v_add_f32 v8, v8, v184
    v_add_f32 v8, v8, v185
    v_add_f32 v8, v8, v186
    v_add_f32 v8, v8, v187
    v_add_f32 v8, v8, v188
    v_add_f32 v8, v8, v189
    v_add_f32 v8, v8, v190
    v_add_f32 v8, v8, v191
    v_cvt_pk_bf16_f32 v236, v184, v185
    v_cvt_pk_bf16_f32 v237, v186, v187
    v_cvt_pk_bf16_f32 v238, v188, v189
    v_cvt_pk_bf16_f32 v239, v190, v191
    ds_bpermute_b32 v248, v58, v17 offset:0
    ds_bpermute_b32 v249, v58, v17 offset:4
    ds_bpermute_b32 v250, v58, v17 offset:8
    ds_bpermute_b32 v251, v58, v17 offset:12
    s_waitcnt lgkmcnt(0)
    v_accvgpr_read_b32 v18, a144
    v_mul_f32 v18, v18, v248
    v_accvgpr_write_b32 a144, v18
    v_accvgpr_read_b32 v19, a145
    v_mul_f32 v19, v19, v249
    v_accvgpr_write_b32 a145, v19
    v_accvgpr_read_b32 v18, a146
    v_mul_f32 v18, v18, v250
    v_accvgpr_write_b32 a146, v18
    v_accvgpr_read_b32 v19, a147
    v_mul_f32 v19, v19, v251
    v_accvgpr_write_b32 a147, v19
    v_accvgpr_read_b32 v18, a148
    v_mul_f32 v18, v18, v248
    v_accvgpr_write_b32 a148, v18
    v_accvgpr_read_b32 v19, a149
    v_mul_f32 v19, v19, v249
    v_accvgpr_write_b32 a149, v19
    v_accvgpr_read_b32 v18, a150
    v_mul_f32 v18, v18, v250
    v_accvgpr_write_b32 a150, v18
    v_accvgpr_read_b32 v19, a151
    v_mul_f32 v19, v19, v251
    v_accvgpr_write_b32 a151, v19
    v_accvgpr_read_b32 v18, a152
    v_mul_f32 v18, v18, v248
    v_accvgpr_write_b32 a152, v18
    v_accvgpr_read_b32 v19, a153
    v_mul_f32 v19, v19, v249
    v_accvgpr_write_b32 a153, v19
    v_accvgpr_read_b32 v18, a154
    v_mul_f32 v18, v18, v250
    v_accvgpr_write_b32 a154, v18
    v_accvgpr_read_b32 v19, a155
    v_mul_f32 v19, v19, v251
    v_accvgpr_write_b32 a155, v19
    v_accvgpr_read_b32 v18, a156
    v_mul_f32 v18, v18, v248
    v_accvgpr_write_b32 a156, v18
    v_accvgpr_read_b32 v19, a157
    v_mul_f32 v19, v19, v249
    v_accvgpr_write_b32 a157, v19
    v_accvgpr_read_b32 v18, a158
    v_mul_f32 v18, v18, v250
    v_accvgpr_write_b32 a158, v18
    v_accvgpr_read_b32 v19, a159
    v_mul_f32 v19, v19, v251
    v_accvgpr_write_b32 a159, v19
    v_accvgpr_read_b32 v18, a160
    v_mul_f32 v18, v18, v248
    v_accvgpr_write_b32 a160, v18
    v_accvgpr_read_b32 v19, a161
    v_mul_f32 v19, v19, v249
    v_accvgpr_write_b32 a161, v19
    v_accvgpr_read_b32 v18, a162
    v_mul_f32 v18, v18, v250
    v_accvgpr_write_b32 a162, v18
    v_accvgpr_read_b32 v19, a163
    v_mul_f32 v19, v19, v251
    v_accvgpr_write_b32 a163, v19
    v_accvgpr_read_b32 v18, a164
    v_mul_f32 v18, v18, v248
    v_accvgpr_write_b32 a164, v18
    v_accvgpr_read_b32 v19, a165
    v_mul_f32 v19, v19, v249
    v_accvgpr_write_b32 a165, v19
    v_accvgpr_read_b32 v18, a166
    v_mul_f32 v18, v18, v250
    v_accvgpr_write_b32 a166, v18
    v_accvgpr_read_b32 v19, a167
    v_mul_f32 v19, v19, v251
    v_accvgpr_write_b32 a167, v19
    v_accvgpr_read_b32 v18, a168
    v_mul_f32 v18, v18, v248
    v_accvgpr_write_b32 a168, v18
    v_accvgpr_read_b32 v19, a169
    v_mul_f32 v19, v19, v249
    v_accvgpr_write_b32 a169, v19
    v_accvgpr_read_b32 v18, a170
    v_mul_f32 v18, v18, v250
    v_accvgpr_write_b32 a170, v18
    v_accvgpr_read_b32 v19, a171
    v_mul_f32 v19, v19, v251
    v_accvgpr_write_b32 a171, v19
    v_accvgpr_read_b32 v18, a172
    v_mul_f32 v18, v18, v248
    v_accvgpr_write_b32 a172, v18
    v_accvgpr_read_b32 v19, a173
    v_mul_f32 v19, v19, v249
    v_accvgpr_write_b32 a173, v19
    v_accvgpr_read_b32 v18, a174
    v_mul_f32 v18, v18, v250
    v_accvgpr_write_b32 a174, v18
    v_accvgpr_read_b32 v19, a175
    v_mul_f32 v19, v19, v251
    v_accvgpr_write_b32 a175, v19
    v_accvgpr_read_b32 v18, a176
    v_mul_f32 v18, v18, v248
    v_accvgpr_write_b32 a176, v18
    v_accvgpr_read_b32 v19, a177
    v_mul_f32 v19, v19, v249
    v_accvgpr_write_b32 a177, v19
    v_accvgpr_read_b32 v18, a178
    v_mul_f32 v18, v18, v250
    v_accvgpr_write_b32 a178, v18
    v_accvgpr_read_b32 v19, a179
    v_mul_f32 v19, v19, v251
    v_accvgpr_write_b32 a179, v19
    v_accvgpr_read_b32 v18, a180
    v_mul_f32 v18, v18, v248
    v_accvgpr_write_b32 a180, v18
    v_accvgpr_read_b32 v19, a181
    v_mul_f32 v19, v19, v249
    v_accvgpr_write_b32 a181, v19
    v_accvgpr_read_b32 v18, a182
    v_mul_f32 v18, v18, v250
    v_accvgpr_write_b32 a182, v18
    v_accvgpr_read_b32 v19, a183
    v_mul_f32 v19, v19, v251
    v_accvgpr_write_b32 a183, v19
    v_accvgpr_read_b32 v18, a184
    v_mul_f32 v18, v18, v248
    v_accvgpr_write_b32 a184, v18
    v_accvgpr_read_b32 v19, a185
    v_mul_f32 v19, v19, v249
    v_accvgpr_write_b32 a185, v19
    v_accvgpr_read_b32 v18, a186
    v_mul_f32 v18, v18, v250
    v_accvgpr_write_b32 a186, v18
    v_accvgpr_read_b32 v19, a187
    v_mul_f32 v19, v19, v251
    v_accvgpr_write_b32 a187, v19
    v_accvgpr_read_b32 v18, a188
    v_mul_f32 v18, v18, v248
    v_accvgpr_write_b32 a188, v18
    v_accvgpr_read_b32 v19, a189
    v_mul_f32 v19, v19, v249
    v_accvgpr_write_b32 a189, v19
    v_accvgpr_read_b32 v18, a190
    v_mul_f32 v18, v18, v250
    v_accvgpr_write_b32 a190, v18
    v_accvgpr_read_b32 v19, a191
    v_mul_f32 v19, v19, v251
    v_accvgpr_write_b32 a191, v19
    s_waitcnt vmcnt(0)
    s_nop 1
    v_mfma_f32_16x16x32_bf16 a[0:3], v[224:227], v[112:115], a[0:3]
    v_mfma_f32_16x16x32_bf16 a[48:51], v[228:231], v[112:115], a[48:51]
    v_mfma_f32_16x16x32_bf16 a[96:99], v[232:235], v[112:115], a[96:99]
    v_mfma_f32_16x16x32_bf16 a[144:147], v[236:239], v[112:115], a[144:147]
    v_mfma_f32_16x16x32_bf16 a[4:7], v[224:227], v[116:119], a[4:7]
    v_mfma_f32_16x16x32_bf16 a[52:55], v[228:231], v[116:119], a[52:55]
    v_mfma_f32_16x16x32_bf16 a[100:103], v[232:235], v[116:119], a[100:103]
    v_mfma_f32_16x16x32_bf16 a[148:151], v[236:239], v[116:119], a[148:151]
    v_mfma_f32_16x16x32_bf16 a[8:11], v[224:227], v[120:123], a[8:11]
    v_mfma_f32_16x16x32_bf16 a[56:59], v[228:231], v[120:123], a[56:59]
    v_mfma_f32_16x16x32_bf16 a[104:107], v[232:235], v[120:123], a[104:107]
    v_mfma_f32_16x16x32_bf16 a[152:155], v[236:239], v[120:123], a[152:155]
    v_mfma_f32_16x16x32_bf16 a[12:15], v[224:227], v[124:127], a[12:15]
    v_mfma_f32_16x16x32_bf16 a[60:63], v[228:231], v[124:127], a[60:63]
    v_mfma_f32_16x16x32_bf16 a[108:111], v[232:235], v[124:127], a[108:111]
    v_mfma_f32_16x16x32_bf16 a[156:159], v[236:239], v[124:127], a[156:159]
    v_mfma_f32_16x16x32_bf16 a[16:19], v[224:227], v[128:131], a[16:19]
    v_mfma_f32_16x16x32_bf16 a[64:67], v[228:231], v[128:131], a[64:67]
    v_mfma_f32_16x16x32_bf16 a[112:115], v[232:235], v[128:131], a[112:115]
    v_mfma_f32_16x16x32_bf16 a[160:163], v[236:239], v[128:131], a[160:163]
    v_mfma_f32_16x16x32_bf16 a[20:23], v[224:227], v[132:135], a[20:23]
    v_mfma_f32_16x16x32_bf16 a[68:71], v[228:231], v[132:135], a[68:71]
    v_mfma_f32_16x16x32_bf16 a[116:119], v[232:235], v[132:135], a[116:119]
    v_mfma_f32_16x16x32_bf16 a[164:167], v[236:239], v[132:135], a[164:167]
    v_mfma_f32_16x16x32_bf16 a[24:27], v[224:227], v[136:139], a[24:27]
    v_mfma_f32_16x16x32_bf16 a[72:75], v[228:231], v[136:139], a[72:75]
    v_mfma_f32_16x16x32_bf16 a[120:123], v[232:235], v[136:139], a[120:123]
    v_mfma_f32_16x16x32_bf16 a[168:171], v[236:239], v[136:139], a[168:171]
    v_mfma_f32_16x16x32_bf16 a[28:31], v[224:227], v[140:143], a[28:31]
    v_mfma_f32_16x16x32_bf16 a[76:79], v[228:231], v[140:143], a[76:79]
    v_mfma_f32_16x16x32_bf16 a[124:127], v[232:235], v[140:143], a[124:127]
    v_mfma_f32_16x16x32_bf16 a[172:175], v[236:239], v[140:143], a[172:175]
    v_mfma_f32_16x16x32_bf16 a[32:35], v[224:227], v[144:147], a[32:35]
    v_mfma_f32_16x16x32_bf16 a[80:83], v[228:231], v[144:147], a[80:83]
    v_mfma_f32_16x16x32_bf16 a[128:131], v[232:235], v[144:147], a[128:131]
    v_mfma_f32_16x16x32_bf16 a[176:179], v[236:239], v[144:147], a[176:179]
    v_mfma_f32_16x16x32_bf16 a[36:39], v[224:227], v[148:151], a[36:39]
    v_mfma_f32_16x16x32_bf16 a[84:87], v[228:231], v[148:151], a[84:87]
    v_mfma_f32_16x16x32_bf16 a[132:135], v[232:235], v[148:151], a[132:135]
    v_mfma_f32_16x16x32_bf16 a[180:183], v[236:239], v[148:151], a[180:183]
    v_mfma_f32_16x16x32_bf16 a[40:43], v[224:227], v[152:155], a[40:43]
    v_mfma_f32_16x16x32_bf16 a[88:91], v[228:231], v[152:155], a[88:91]
    v_mfma_f32_16x16x32_bf16 a[136:139], v[232:235], v[152:155], a[136:139]
    v_mfma_f32_16x16x32_bf16 a[184:187], v[236:239], v[152:155], a[184:187]
    v_mfma_f32_16x16x32_bf16 a[44:47], v[224:227], v[156:159], a[44:47]
    v_mfma_f32_16x16x32_bf16 a[92:95], v[228:231], v[156:159], a[92:95]
    v_mfma_f32_16x16x32_bf16 a[140:143], v[232:235], v[156:159], a[140:143]
    v_mfma_f32_16x16x32_bf16 a[188:191], v[236:239], v[156:159], a[188:191]
    s_add_u32 s48, s48, 24576
    s_cmp_lt_u32 s48, 1572864
    s_nop 7
    s_cbranch_scc1 L_slowloop
    s_nop 1
    v_mfma_f32_16x16x4_f32 v[48:51], v5, v57, 0
    v_mfma_f32_16x16x4_f32 v[52:55], v6, v57, 0
    s_nop 7
    s_nop 1
    v_rcp_f32 v48, v48
    v_rcp_f32 v49, v49
    v_rcp_f32 v50, v50
    v_rcp_f32 v51, v51
    v_rcp_f32 v52, v52
    v_rcp_f32 v53, v53
    v_rcp_f32 v54, v54
    v_rcp_f32 v55, v55
    v_mfma_f32_16x16x4_f32 v[128:131], v7, v57, 0
    v_mfma_f32_16x16x4_f32 v[132:135], v8, v57, 0
    s_nop 7
    s_nop 1
    v_rcp_f32 v128, v128
    v_rcp_f32 v129, v129
    v_rcp_f32 v130, v130
    v_rcp_f32 v131, v131
    v_rcp_f32 v132, v132
    v_rcp_f32 v133, v133
    v_rcp_f32 v134, v134
    v_rcp_f32 v135, v135
    s_nop 0
    v_accvgpr_read_b32 v64, a0
    v_accvgpr_read_b32 v65, a4
    v_accvgpr_read_b32 v66, a8
    v_accvgpr_read_b32 v67, a12
    v_accvgpr_read_b32 v68, a16
    v_accvgpr_read_b32 v69, a20
    v_pk_mul_f32 v[64:65], v[64:65], v[48:49] op_sel_hi:[1,0]
    v_pk_mul_f32 v[66:67], v[66:67], v[48:49] op_sel_hi:[1,0]
    v_pk_mul_f32 v[68:69], v[68:69], v[48:49] op_sel_hi:[1,0]
    v_cvt_pk_bf16_f32 v64, v64, v65
    v_cvt_pk_bf16_f32 v65, v66, v67
    v_cvt_pk_bf16_f32 v66, v68, v69
    v_accvgpr_read_b32 v70, a1
    v_accvgpr_read_b32 v71, a5
    v_accvgpr_read_b32 v72, a9
    v_accvgpr_read_b32 v73, a13
    v_accvgpr_read_b32 v74, a17
    v_accvgpr_read_b32 v75, a21
    v_pk_mul_f32 v[70:71], v[70:71], v[48:49] op_sel:[0,1] op_sel_hi:[1,1]
    v_pk_mul_f32 v[72:73], v[72:73], v[48:49] op_sel:[0,1] op_sel_hi:[1,1]
    v_pk_mul_f32 v[74:75], v[74:75], v[48:49] op_sel:[0,1] op_sel_hi:[1,1]
    v_cvt_pk_bf16_f32 v70, v70, v71
    v_cvt_pk_bf16_f32 v71, v72, v73
    v_cvt_pk_bf16_f32 v72, v74, v75
    buffer_store_dwordx3 v[64:66], v56, s[12:15], s24 offen offset:0 sc0 sc1
    v_accvgpr_read_b32 v76, a2
    v_accvgpr_read_b32 v77, a6
    v_accvgpr_read_b32 v78, a10
    v_accvgpr_read_b32 v79, a14
    v_accvgpr_read_b32 v80, a18
    v_accvgpr_read_b32 v81, a22
    v_pk_mul_f32 v[76:77], v[76:77], v[50:51] op_sel_hi:[1,0]
    v_pk_mul_f32 v[78:79], v[78:79], v[50:51] op_sel_hi:[1,0]
    v_pk_mul_f32 v[80:81], v[80:81], v[50:51] op_sel_hi:[1,0]
    v_cvt_pk_bf16_f32 v76, v76, v77
    v_cvt_pk_bf16_f32 v77, v78, v79
    v_cvt_pk_bf16_f32 v78, v80, v81
    buffer_store_dwordx3 v[70:72], v56, s[12:15], s24 offen offset:384 sc0 sc1
    v_accvgpr_read_b32 v82, a3
    v_accvgpr_read_b32 v83, a7
    v_accvgpr_read_b32 v84, a11
    v_accvgpr_read_b32 v85, a15
    v_accvgpr_read_b32 v86, a19
    v_accvgpr_read_b32 v87, a23
    v_pk_mul_f32 v[82:83], v[82:83], v[50:51] op_sel:[0,1] op_sel_hi:[1,1]
    v_pk_mul_f32 v[84:85], v[84:85], v[50:51] op_sel:[0,1] op_sel_hi:[1,1]
    v_pk_mul_f32 v[86:87], v[86:87], v[50:51] op_sel:[0,1] op_sel_hi:[1,1]
    v_cvt_pk_bf16_f32 v82, v82, v83
    v_cvt_pk_bf16_f32 v83, v84, v85
    v_cvt_pk_bf16_f32 v84, v86, v87
    buffer_store_dwordx3 v[76:78], v56, s[12:15], s24 offen offset:768 sc0 sc1
    v_accvgpr_read_b32 v88, a24
    v_accvgpr_read_b32 v89, a28
    v_accvgpr_read_b32 v90, a32
    v_accvgpr_read_b32 v91, a36
    v_accvgpr_read_b32 v92, a40
    v_accvgpr_read_b32 v93, a44
    v_pk_mul_f32 v[88:89], v[88:89], v[48:49] op_sel_hi:[1,0]
    v_pk_mul_f32 v[90:91], v[90:91], v[48:49] op_sel_hi:[1,0]
    v_pk_mul_f32 v[92:93], v[92:93], v[48:49] op_sel_hi:[1,0]
    v_cvt_pk_bf16_f32 v88, v88, v89
    v_cvt_pk_bf16_f32 v89, v90, v91
    v_cvt_pk_bf16_f32 v90, v92, v93
    buffer_store_dwordx3 v[82:84], v56, s[12:15], s24 offen offset:1152 sc0 sc1
    v_accvgpr_read_b32 v94, a25
    v_accvgpr_read_b32 v95, a29
    v_accvgpr_read_b32 v96, a33
    v_accvgpr_read_b32 v97, a37
    v_accvgpr_read_b32 v98, a41
    v_accvgpr_read_b32 v99, a45
    v_pk_mul_f32 v[94:95], v[94:95], v[48:49] op_sel:[0,1] op_sel_hi:[1,1]
    v_pk_mul_f32 v[96:97], v[96:97], v[48:49] op_sel:[0,1] op_sel_hi:[1,1]
    v_pk_mul_f32 v[98:99], v[98:99], v[48:49] op_sel:[0,1] op_sel_hi:[1,1]
    v_cvt_pk_bf16_f32 v94, v94, v95
    v_cvt_pk_bf16_f32 v95, v96, v97
    v_cvt_pk_bf16_f32 v96, v98, v99
    buffer_store_dwordx3 v[88:90], v56, s[12:15], s24 offen offset:192 sc0 sc1
    v_accvgpr_read_b32 v100, a26
    v_accvgpr_read_b32 v101, a30
    v_accvgpr_read_b32 v102, a34
    v_accvgpr_read_b32 v103, a38
    v_accvgpr_read_b32 v104, a42
    v_accvgpr_read_b32 v105, a46
    v_pk_mul_f32 v[100:101], v[100:101], v[50:51] op_sel_hi:[1,0]
    v_pk_mul_f32 v[102:103], v[102:103], v[50:51] op_sel_hi:[1,0]
    v_pk_mul_f32 v[104:105], v[104:105], v[50:51] op_sel_hi:[1,0]
    v_cvt_pk_bf16_f32 v100, v100, v101
    v_cvt_pk_bf16_f32 v101, v102, v103
    v_cvt_pk_bf16_f32 v102, v104, v105
    buffer_store_dwordx3 v[94:96], v56, s[12:15], s24 offen offset:576 sc0 sc1
    v_accvgpr_read_b32 v106, a27
    v_accvgpr_read_b32 v107, a31
    v_accvgpr_read_b32 v108, a35
    v_accvgpr_read_b32 v109, a39
    v_accvgpr_read_b32 v110, a43
    v_accvgpr_read_b32 v111, a47
    v_pk_mul_f32 v[106:107], v[106:107], v[50:51] op_sel:[0,1] op_sel_hi:[1,1]
    v_pk_mul_f32 v[108:109], v[108:109], v[50:51] op_sel:[0,1] op_sel_hi:[1,1]
    v_pk_mul_f32 v[110:111], v[110:111], v[50:51] op_sel:[0,1] op_sel_hi:[1,1]
    v_cvt_pk_bf16_f32 v106, v106, v107
    v_cvt_pk_bf16_f32 v107, v108, v109
    v_cvt_pk_bf16_f32 v108, v110, v111
    buffer_store_dwordx3 v[100:102], v56, s[12:15], s24 offen offset:960 sc0 sc1
    v_accvgpr_read_b32 v64, a48
    v_accvgpr_read_b32 v65, a52
    v_accvgpr_read_b32 v66, a56
    v_accvgpr_read_b32 v67, a60
    v_accvgpr_read_b32 v68, a64
    v_accvgpr_read_b32 v69, a68
    v_pk_mul_f32 v[64:65], v[64:65], v[52:53] op_sel_hi:[1,0]
    v_pk_mul_f32 v[66:67], v[66:67], v[52:53] op_sel_hi:[1,0]
    v_pk_mul_f32 v[68:69], v[68:69], v[52:53] op_sel_hi:[1,0]
    v_cvt_pk_bf16_f32 v64, v64, v65
    v_cvt_pk_bf16_f32 v65, v66, v67
    v_cvt_pk_bf16_f32 v66, v68, v69
    buffer_store_dwordx3 v[106:108], v56, s[12:15], s24 offen offset:1344 sc0 sc1
    v_accvgpr_read_b32 v70, a49
    v_accvgpr_read_b32 v71, a53
    v_accvgpr_read_b32 v72, a57
    v_accvgpr_read_b32 v73, a61
    v_accvgpr_read_b32 v74, a65
    v_accvgpr_read_b32 v75, a69
    v_pk_mul_f32 v[70:71], v[70:71], v[52:53] op_sel:[0,1] op_sel_hi:[1,1]
    v_pk_mul_f32 v[72:73], v[72:73], v[52:53] op_sel:[0,1] op_sel_hi:[1,1]
    v_pk_mul_f32 v[74:75], v[74:75], v[52:53] op_sel:[0,1] op_sel_hi:[1,1]
    v_cvt_pk_bf16_f32 v70, v70, v71
    v_cvt_pk_bf16_f32 v71, v72, v73
    v_cvt_pk_bf16_f32 v72, v74, v75
    buffer_store_dwordx3 v[64:66], v56, s[12:15], s40 offen offset:0 sc0 sc1
    v_accvgpr_read_b32 v76, a50
    v_accvgpr_read_b32 v77, a54
    v_accvgpr_read_b32 v78, a58
    v_accvgpr_read_b32 v79, a62
    v_accvgpr_read_b32 v80, a66
    v_accvgpr_read_b32 v81, a70
    v_pk_mul_f32 v[76:77], v[76:77], v[54:55] op_sel_hi:[1,0]
    v_pk_mul_f32 v[78:79], v[78:79], v[54:55] op_sel_hi:[1,0]
    v_pk_mul_f32 v[80:81], v[80:81], v[54:55] op_sel_hi:[1,0]
    v_cvt_pk_bf16_f32 v76, v76, v77
    v_cvt_pk_bf16_f32 v77, v78, v79
    v_cvt_pk_bf16_f32 v78, v80, v81
    buffer_store_dwordx3 v[70:72], v56, s[12:15], s40 offen offset:384 sc0 sc1
    v_accvgpr_read_b32 v82, a51
    v_accvgpr_read_b32 v83, a55
    v_accvgpr_read_b32 v84, a59
    v_accvgpr_read_b32 v85, a63
    v_accvgpr_read_b32 v86, a67
    v_accvgpr_read_b32 v87, a71
    v_pk_mul_f32 v[82:83], v[82:83], v[54:55] op_sel:[0,1] op_sel_hi:[1,1]
    v_pk_mul_f32 v[84:85], v[84:85], v[54:55] op_sel:[0,1] op_sel_hi:[1,1]
    v_pk_mul_f32 v[86:87], v[86:87], v[54:55] op_sel:[0,1] op_sel_hi:[1,1]
    v_cvt_pk_bf16_f32 v82, v82, v83
    v_cvt_pk_bf16_f32 v83, v84, v85
    v_cvt_pk_bf16_f32 v84, v86, v87
    buffer_store_dwordx3 v[76:78], v56, s[12:15], s40 offen offset:768 sc0 sc1
    v_accvgpr_read_b32 v88, a72
    v_accvgpr_read_b32 v89, a76
    v_accvgpr_read_b32 v90, a80
    v_accvgpr_read_b32 v91, a84
    v_accvgpr_read_b32 v92, a88
    v_accvgpr_read_b32 v93, a92
    v_pk_mul_f32 v[88:89], v[88:89], v[52:53] op_sel_hi:[1,0]
    v_pk_mul_f32 v[90:91], v[90:91], v[52:53] op_sel_hi:[1,0]
    v_pk_mul_f32 v[92:93], v[92:93], v[52:53] op_sel_hi:[1,0]
    v_cvt_pk_bf16_f32 v88, v88, v89
    v_cvt_pk_bf16_f32 v89, v90, v91
    v_cvt_pk_bf16_f32 v90, v92, v93
    buffer_store_dwordx3 v[82:84], v56, s[12:15], s40 offen offset:1152 sc0 sc1
    v_accvgpr_read_b32 v94, a73
    v_accvgpr_read_b32 v95, a77
    v_accvgpr_read_b32 v96, a81
    v_accvgpr_read_b32 v97, a85
    v_accvgpr_read_b32 v98, a89
    v_accvgpr_read_b32 v99, a93
    v_pk_mul_f32 v[94:95], v[94:95], v[52:53] op_sel:[0,1] op_sel_hi:[1,1]
    v_pk_mul_f32 v[96:97], v[96:97], v[52:53] op_sel:[0,1] op_sel_hi:[1,1]
    v_pk_mul_f32 v[98:99], v[98:99], v[52:53] op_sel:[0,1] op_sel_hi:[1,1]
    v_cvt_pk_bf16_f32 v94, v94, v95
    v_cvt_pk_bf16_f32 v95, v96, v97
    v_cvt_pk_bf16_f32 v96, v98, v99
    buffer_store_dwordx3 v[88:90], v56, s[12:15], s40 offen offset:192 sc0 sc1
    v_accvgpr_read_b32 v100, a74
    v_accvgpr_read_b32 v101, a78
    v_accvgpr_read_b32 v102, a82
    v_accvgpr_read_b32 v103, a86
    v_accvgpr_read_b32 v104, a90
    v_accvgpr_read_b32 v105, a94
    v_pk_mul_f32 v[100:101], v[100:101], v[54:55] op_sel_hi:[1,0]
    v_pk_mul_f32 v[102:103], v[102:103], v[54:55] op_sel_hi:[1,0]
    v_pk_mul_f32 v[104:105], v[104:105], v[54:55] op_sel_hi:[1,0]
    v_cvt_pk_bf16_f32 v100, v100, v101
    v_cvt_pk_bf16_f32 v101, v102, v103
    v_cvt_pk_bf16_f32 v102, v104, v105
    buffer_store_dwordx3 v[94:96], v56, s[12:15], s40 offen offset:576 sc0 sc1
    v_accvgpr_read_b32 v106, a75
    v_accvgpr_read_b32 v107, a79
    v_accvgpr_read_b32 v108, a83
    v_accvgpr_read_b32 v109, a87
    v_accvgpr_read_b32 v110, a91
    v_accvgpr_read_b32 v111, a95
    v_pk_mul_f32 v[106:107], v[106:107], v[54:55] op_sel:[0,1] op_sel_hi:[1,1]
    v_pk_mul_f32 v[108:109], v[108:109], v[54:55] op_sel:[0,1] op_sel_hi:[1,1]
    v_pk_mul_f32 v[110:111], v[110:111], v[54:55] op_sel:[0,1] op_sel_hi:[1,1]
    v_cvt_pk_bf16_f32 v106, v106, v107
    v_cvt_pk_bf16_f32 v107, v108, v109
    v_cvt_pk_bf16_f32 v108, v110, v111
    buffer_store_dwordx3 v[100:102], v56, s[12:15], s40 offen offset:960 sc0 sc1
    v_accvgpr_read_b32 v64, a96
    v_accvgpr_read_b32 v65, a100
    v_accvgpr_read_b32 v66, a104
    v_accvgpr_read_b32 v67, a108
    v_accvgpr_read_b32 v68, a112
    v_accvgpr_read_b32 v69, a116
    v_pk_mul_f32 v[64:65], v[64:65], v[128:129] op_sel_hi:[1,0]
    v_pk_mul_f32 v[66:67], v[66:67], v[128:129] op_sel_hi:[1,0]
    v_pk_mul_f32 v[68:69], v[68:69], v[128:129] op_sel_hi:[1,0]
    v_cvt_pk_bf16_f32 v64, v64, v65
    v_cvt_pk_bf16_f32 v65, v66, v67
    v_cvt_pk_bf16_f32 v66, v68, v69
    buffer_store_dwordx3 v[106:108], v56, s[12:15], s40 offen offset:1344 sc0 sc1
    v_accvgpr_read_b32 v70, a97
    v_accvgpr_read_b32 v71, a101
    v_accvgpr_read_b32 v72, a105
    v_accvgpr_read_b32 v73, a109
    v_accvgpr_read_b32 v74, a113
    v_accvgpr_read_b32 v75, a117
    v_pk_mul_f32 v[70:71], v[70:71], v[128:129] op_sel:[0,1] op_sel_hi:[1,1]
    v_pk_mul_f32 v[72:73], v[72:73], v[128:129] op_sel:[0,1] op_sel_hi:[1,1]
    v_pk_mul_f32 v[74:75], v[74:75], v[128:129] op_sel:[0,1] op_sel_hi:[1,1]
    v_cvt_pk_bf16_f32 v70, v70, v71
    v_cvt_pk_bf16_f32 v71, v72, v73
    v_cvt_pk_bf16_f32 v72, v74, v75
    buffer_store_dwordx3 v[64:66], v56, s[12:15], s41 offen offset:0 sc0 sc1
    v_accvgpr_read_b32 v76, a98
    v_accvgpr_read_b32 v77, a102
    v_accvgpr_read_b32 v78, a106
    v_accvgpr_read_b32 v79, a110
    v_accvgpr_read_b32 v80, a114
    v_accvgpr_read_b32 v81, a118
    v_pk_mul_f32 v[76:77], v[76:77], v[130:131] op_sel_hi:[1,0]
    v_pk_mul_f32 v[78:79], v[78:79], v[130:131] op_sel_hi:[1,0]
    v_pk_mul_f32 v[80:81], v[80:81], v[130:131] op_sel_hi:[1,0]
    v_cvt_pk_bf16_f32 v76, v76, v77
    v_cvt_pk_bf16_f32 v77, v78, v79
    v_cvt_pk_bf16_f32 v78, v80, v81
    buffer_store_dwordx3 v[70:72], v56, s[12:15], s41 offen offset:384 sc0 sc1
    v_accvgpr_read_b32 v82, a99
    v_accvgpr_read_b32 v83, a103
    v_accvgpr_read_b32 v84, a107
    v_accvgpr_read_b32 v85, a111
    v_accvgpr_read_b32 v86, a115
    v_accvgpr_read_b32 v87, a119
    v_pk_mul_f32 v[82:83], v[82:83], v[130:131] op_sel:[0,1] op_sel_hi:[1,1]
    v_pk_mul_f32 v[84:85], v[84:85], v[130:131] op_sel:[0,1] op_sel_hi:[1,1]
    v_pk_mul_f32 v[86:87], v[86:87], v[130:131] op_sel:[0,1] op_sel_hi:[1,1]
    v_cvt_pk_bf16_f32 v82, v82, v83
    v_cvt_pk_bf16_f32 v83, v84, v85
    v_cvt_pk_bf16_f32 v84, v86, v87
    buffer_store_dwordx3 v[76:78], v56, s[12:15], s41 offen offset:768 sc0 sc1
    v_accvgpr_read_b32 v88, a120
    v_accvgpr_read_b32 v89, a124
    v_accvgpr_read_b32 v90, a128
    v_accvgpr_read_b32 v91, a132
    v_accvgpr_read_b32 v92, a136
    v_accvgpr_read_b32 v93, a140
    v_pk_mul_f32 v[88:89], v[88:89], v[128:129] op_sel_hi:[1,0]
    v_pk_mul_f32 v[90:91], v[90:91], v[128:129] op_sel_hi:[1,0]
    v_pk_mul_f32 v[92:93], v[92:93], v[128:129] op_sel_hi:[1,0]
    v_cvt_pk_bf16_f32 v88, v88, v89
    v_cvt_pk_bf16_f32 v89, v90, v91
    v_cvt_pk_bf16_f32 v90, v92, v93
    buffer_store_dwordx3 v[82:84], v56, s[12:15], s41 offen offset:1152 sc0 sc1
    v_accvgpr_read_b32 v94, a121
    v_accvgpr_read_b32 v95, a125
    v_accvgpr_read_b32 v96, a129
    v_accvgpr_read_b32 v97, a133
    v_accvgpr_read_b32 v98, a137
    v_accvgpr_read_b32 v99, a141
    v_pk_mul_f32 v[94:95], v[94:95], v[128:129] op_sel:[0,1] op_sel_hi:[1,1]
    v_pk_mul_f32 v[96:97], v[96:97], v[128:129] op_sel:[0,1] op_sel_hi:[1,1]
    v_pk_mul_f32 v[98:99], v[98:99], v[128:129] op_sel:[0,1] op_sel_hi:[1,1]
    v_cvt_pk_bf16_f32 v94, v94, v95
    v_cvt_pk_bf16_f32 v95, v96, v97
    v_cvt_pk_bf16_f32 v96, v98, v99
    buffer_store_dwordx3 v[88:90], v56, s[12:15], s41 offen offset:192 sc0 sc1
    v_accvgpr_read_b32 v100, a122
    v_accvgpr_read_b32 v101, a126
    v_accvgpr_read_b32 v102, a130
    v_accvgpr_read_b32 v103, a134
    v_accvgpr_read_b32 v104, a138
    v_accvgpr_read_b32 v105, a142
    v_pk_mul_f32 v[100:101], v[100:101], v[130:131] op_sel_hi:[1,0]
    v_pk_mul_f32 v[102:103], v[102:103], v[130:131] op_sel_hi:[1,0]
    v_pk_mul_f32 v[104:105], v[104:105], v[130:131] op_sel_hi:[1,0]
    v_cvt_pk_bf16_f32 v100, v100, v101
    v_cvt_pk_bf16_f32 v101, v102, v103
    v_cvt_pk_bf16_f32 v102, v104, v105
    buffer_store_dwordx3 v[94:96], v56, s[12:15], s41 offen offset:576 sc0 sc1
    v_accvgpr_read_b32 v106, a123
    v_accvgpr_read_b32 v107, a127
    v_accvgpr_read_b32 v108, a131
    v_accvgpr_read_b32 v109, a135
    v_accvgpr_read_b32 v110, a139
    v_accvgpr_read_b32 v111, a143
    v_pk_mul_f32 v[106:107], v[106:107], v[130:131] op_sel:[0,1] op_sel_hi:[1,1]
    v_pk_mul_f32 v[108:109], v[108:109], v[130:131] op_sel:[0,1] op_sel_hi:[1,1]
    v_pk_mul_f32 v[110:111], v[110:111], v[130:131] op_sel:[0,1] op_sel_hi:[1,1]
    v_cvt_pk_bf16_f32 v106, v106, v107
    v_cvt_pk_bf16_f32 v107, v108, v109
    v_cvt_pk_bf16_f32 v108, v110, v111
    buffer_store_dwordx3 v[100:102], v56, s[12:15], s41 offen offset:960 sc0 sc1
    v_accvgpr_read_b32 v64, a144
    v_accvgpr_read_b32 v65, a148
    v_accvgpr_read_b32 v66, a152
    v_accvgpr_read_b32 v67, a156
    v_accvgpr_read_b32 v68, a160
    v_accvgpr_read_b32 v69, a164
    v_pk_mul_f32 v[64:65], v[64:65], v[132:133] op_sel_hi:[1,0]
    v_pk_mul_f32 v[66:67], v[66:67], v[132:133] op_sel_hi:[1,0]
    v_pk_mul_f32 v[68:69], v[68:69], v[132:133] op_sel_hi:[1,0]
    v_cvt_pk_bf16_f32 v64, v64, v65
    v_cvt_pk_bf16_f32 v65, v66, v67
    v_cvt_pk_bf16_f32 v66, v68, v69
    buffer_store_dwordx3 v[106:108], v56, s[12:15], s41 offen offset:1344 sc0 sc1
    v_accvgpr_read_b32 v70, a145
    v_accvgpr_read_b32 v71, a149
    v_accvgpr_read_b32 v72, a153
    v_accvgpr_read_b32 v73, a157
    v_accvgpr_read_b32 v74, a161
    v_accvgpr_read_b32 v75, a165
    v_pk_mul_f32 v[70:71], v[70:71], v[132:133] op_sel:[0,1] op_sel_hi:[1,1]
    v_pk_mul_f32 v[72:73], v[72:73], v[132:133] op_sel:[0,1] op_sel_hi:[1,1]
    v_pk_mul_f32 v[74:75], v[74:75], v[132:133] op_sel:[0,1] op_sel_hi:[1,1]
    v_cvt_pk_bf16_f32 v70, v70, v71
    v_cvt_pk_bf16_f32 v71, v72, v73
    v_cvt_pk_bf16_f32 v72, v74, v75
    buffer_store_dwordx3 v[64:66], v56, s[12:15], s42 offen offset:0 sc0 sc1
    v_accvgpr_read_b32 v76, a146
    v_accvgpr_read_b32 v77, a150
    v_accvgpr_read_b32 v78, a154
    v_accvgpr_read_b32 v79, a158
    v_accvgpr_read_b32 v80, a162
    v_accvgpr_read_b32 v81, a166
    v_pk_mul_f32 v[76:77], v[76:77], v[134:135] op_sel_hi:[1,0]
    v_pk_mul_f32 v[78:79], v[78:79], v[134:135] op_sel_hi:[1,0]
    v_pk_mul_f32 v[80:81], v[80:81], v[134:135] op_sel_hi:[1,0]
    v_cvt_pk_bf16_f32 v76, v76, v77
    v_cvt_pk_bf16_f32 v77, v78, v79
    v_cvt_pk_bf16_f32 v78, v80, v81
    buffer_store_dwordx3 v[70:72], v56, s[12:15], s42 offen offset:384 sc0 sc1
    v_accvgpr_read_b32 v82, a147
    v_accvgpr_read_b32 v83, a151
    v_accvgpr_read_b32 v84, a155
    v_accvgpr_read_b32 v85, a159
    v_accvgpr_read_b32 v86, a163
    v_accvgpr_read_b32 v87, a167
    v_pk_mul_f32 v[82:83], v[82:83], v[134:135] op_sel:[0,1] op_sel_hi:[1,1]
    v_pk_mul_f32 v[84:85], v[84:85], v[134:135] op_sel:[0,1] op_sel_hi:[1,1]
    v_pk_mul_f32 v[86:87], v[86:87], v[134:135] op_sel:[0,1] op_sel_hi:[1,1]
    v_cvt_pk_bf16_f32 v82, v82, v83
    v_cvt_pk_bf16_f32 v83, v84, v85
    v_cvt_pk_bf16_f32 v84, v86, v87
    buffer_store_dwordx3 v[76:78], v56, s[12:15], s42 offen offset:768 sc0 sc1
    v_accvgpr_read_b32 v88, a168
    v_accvgpr_read_b32 v89, a172
    v_accvgpr_read_b32 v90, a176
    v_accvgpr_read_b32 v91, a180
    v_accvgpr_read_b32 v92, a184
    v_accvgpr_read_b32 v93, a188
    v_pk_mul_f32 v[88:89], v[88:89], v[132:133] op_sel_hi:[1,0]
    v_pk_mul_f32 v[90:91], v[90:91], v[132:133] op_sel_hi:[1,0]
    v_pk_mul_f32 v[92:93], v[92:93], v[132:133] op_sel_hi:[1,0]
    v_cvt_pk_bf16_f32 v88, v88, v89
    v_cvt_pk_bf16_f32 v89, v90, v91
    v_cvt_pk_bf16_f32 v90, v92, v93
    buffer_store_dwordx3 v[82:84], v56, s[12:15], s42 offen offset:1152 sc0 sc1
    v_accvgpr_read_b32 v94, a169
    v_accvgpr_read_b32 v95, a173
    v_accvgpr_read_b32 v96, a177
    v_accvgpr_read_b32 v97, a181
    v_accvgpr_read_b32 v98, a185
    v_accvgpr_read_b32 v99, a189
    v_pk_mul_f32 v[94:95], v[94:95], v[132:133] op_sel:[0,1] op_sel_hi:[1,1]
    v_pk_mul_f32 v[96:97], v[96:97], v[132:133] op_sel:[0,1] op_sel_hi:[1,1]
    v_pk_mul_f32 v[98:99], v[98:99], v[132:133] op_sel:[0,1] op_sel_hi:[1,1]
    v_cvt_pk_bf16_f32 v94, v94, v95
    v_cvt_pk_bf16_f32 v95, v96, v97
    v_cvt_pk_bf16_f32 v96, v98, v99
    buffer_store_dwordx3 v[88:90], v56, s[12:15], s42 offen offset:192 sc0 sc1
    v_accvgpr_read_b32 v100, a170
    v_accvgpr_read_b32 v101, a174
    v_accvgpr_read_b32 v102, a178
    v_accvgpr_read_b32 v103, a182
    v_accvgpr_read_b32 v104, a186
    v_accvgpr_read_b32 v105, a190
    v_pk_mul_f32 v[100:101], v[100:101], v[134:135] op_sel_hi:[1,0]
    v_pk_mul_f32 v[102:103], v[102:103], v[134:135] op_sel_hi:[1,0]
    v_pk_mul_f32 v[104:105], v[104:105], v[134:135] op_sel_hi:[1,0]
    v_cvt_pk_bf16_f32 v100, v100, v101
    v_cvt_pk_bf16_f32 v101, v102, v103
    v_cvt_pk_bf16_f32 v102, v104, v105
    buffer_store_dwordx3 v[94:96], v56, s[12:15], s42 offen offset:576 sc0 sc1
    v_accvgpr_read_b32 v106, a171
    v_accvgpr_read_b32 v107, a175
    v_accvgpr_read_b32 v108, a179
    v_accvgpr_read_b32 v109, a183
    v_accvgpr_read_b32 v110, a187
    v_accvgpr_read_b32 v111, a191
    v_pk_mul_f32 v[106:107], v[106:107], v[134:135] op_sel:[0,1] op_sel_hi:[1,1]
    v_pk_mul_f32 v[108:109], v[108:109], v[134:135] op_sel:[0,1] op_sel_hi:[1,1]
    v_pk_mul_f32 v[110:111], v[110:111], v[134:135] op_sel:[0,1] op_sel_hi:[1,1]
    v_cvt_pk_bf16_f32 v106, v106, v107
    v_cvt_pk_bf16_f32 v107, v108, v109
    v_cvt_pk_bf16_f32 v108, v110, v111
    buffer_store_dwordx3 v[100:102], v56, s[12:15], s42 offen offset:960 sc0 sc1
    buffer_store_dwordx3 v[106:108], v56, s[12:15], s42 offen offset:1344 sc0 sc1
    s_branch L_fin
.section .rodata,"a"
.p2align 6
.amdhsa_kernel standalone__kv_cache_quant_int4_int2_kv_with_per_channel_or_per_token_scales__prompt_kernel
  .amdhsa_next_free_vgpr 512
  .amdhsa_next_free_sgpr 102
  .amdhsa_accum_offset 256
  .amdhsa_group_segment_fixed_size 0
  .amdhsa_kernarg_size 80
  .amdhsa_user_sgpr_count 2
  .amdhsa_user_sgpr_kernarg_segment_ptr 1
  .amdhsa_system_sgpr_workgroup_id_x 1
.end_amdhsa_kernel
```

```asm
; @launch grid=(256,1,1) block=(256,1,1) lds=147584
.amdgcn_target "amdgcn-amd-amdhsa--gfx950"
.text
.globl standalone__kv_cache_quant_int4_int2_kv_with_per_channel_or_per_token_scales__prompt_kernel
.p2align 8
.type standalone__kv_cache_quant_int4_int2_kv_with_per_channel_or_per_token_scales__prompt_kernel,@function
standalone__kv_cache_quant_int4_int2_kv_with_per_channel_or_per_token_scales__prompt_kernel:
    s_cmp_ge_u32 s2, 256
    s_cbranch_scc1 L_done
    s_load_dwordx16 s[40:55], s[0:1], 0
    s_load_dwordx4 s[16:19], s[0:1], 64
    s_and_b32 s94, s2, 7
    s_lshr_b32 s95, s2, 3
    s_lshr_b32 s24, s95, 3
    s_lshl_b32 s94, s94, 2
    s_add_u32 s94, s94, s24
    s_and_b32 s95, s95, 7
    s_getpc_b64 s[60:61]
L_pc:
    s_sub_u32 s60, s60, L_pc-standalone__kv_cache_quant_int4_int2_kv_with_per_channel_or_per_token_scales__prompt_kernel
    s_subb_u32 s61, s61, 0
    s_mov_b32 s62, L_slow-standalone__kv_cache_quant_int4_int2_kv_with_per_channel_or_per_token_scales__prompt_kernel
    s_mov_b32 s63, 0x20000
    s_lshr_b32 s22, s2, 3
    s_lshl_b32 s22, s22, 12
    v_lshlrev_b32 v30, 4, v0
    buffer_load_dwordx4 v[128:131], v30, s[60:63], s22 offen
    v_lshrrev_b32 v24, 6, v0
    v_and_b32 v25, 63, v0
    v_readfirstlane_b32 s25, v24
    v_lshlrev_b32 v1, 4, v25
    v_mul_u32_u24 v26, 43, v25
    v_lshrrev_b32 v26, 10, v26
    v_mul_u32_u24 v27, 24, v26
    v_sub_u32 v27, v25, v27
    v_lshrrev_b32 v28, 1, v24
    v_and_b32 v29, 1, v24
    v_lshlrev_b32 v30, 4, v29
    v_lshl_add_u32 v30, v28, 2, v30
    v_add_u32 v30, v30, v26
    v_mul_u32_u24 v30, 768, v30
    v_lshrrev_b32 v48, 1, v26
    v_lshlrev_b32 v48, 30, v48
    v_lshl_add_u32 v30, v27, 4, v30
    v_or_b32 v9, v30, v48
    v_lshl_or_b32 v10, v27, 3, v48
    v_mul_u32_u24 v30, 6144, v24
    v_mul_u32_u24 v31, 12, v25
    v_add_u32 v12, v30, v31
    s_mov_b32 s66, 1572864
    s_mov_b32 s67, 0x20000
    s_mov_b32 s70, 1572864
    s_mov_b32 s71, 0x20000
    s_mov_b32 s74, 12288
    s_mov_b32 s75, 0x20000
    s_mov_b32 s78, 12288
    s_mov_b32 s79, 0x20000
    s_mov_b32 s82, 4096
    s_mov_b32 s83, 0x20000
    s_mov_b32 s86, 4096
    s_mov_b32 s87, 0x20000
    s_mov_b32 s22, 64
    s_mov_b32 s23, 0x20000
    s_mul_i32 s33, s95, 24576
    s_add_u32 s34, s33, 6144
    s_mov_b32 s35, s33
    s_lshr_b32 s36, s95, 1
    s_mul_i32 s36, s36, 384
    s_lshl_b32 s37, s95, 6
    s_lshl_b32 s24, s25, 4
    s_add_u32 s37, s37, s24
    s_mul_i32 s24, s94, 1572864
    s_mul_i32 s56, s94, 12288
    s_lshl_b32 s57, s94, 12
    s_lshl_b32 s58, s94, 10
    s_add_u32 s58, s58, 51380320
    s_or_b32 s39, s95, s25
    s_waitcnt lgkmcnt(0)
    s_add_u32 s64, s42, s24
    s_addc_u32 s65, s43, 0
    s_add_u32 s72, s46, s56
    s_addc_u32 s73, s47, 0
    s_add_u32 s76, s48, s56
    s_addc_u32 s77, s49, 0
    buffer_load_dwordx4 v[224:227], v9, s[64:67], s33 offen offset:0 nt
    buffer_load_dwordx4 v[228:231], v9, s[64:67], s33 offen offset:1536 nt
    buffer_load_dwordx4 v[232:235], v9, s[64:67], s34 offen offset:0 nt
    buffer_load_dwordx4 v[236:239], v9, s[64:67], s34 offen offset:1536 nt
    buffer_load_dwordx2 v[32:33], v10, s[72:75], s36 offen offset:0
    buffer_load_dwordx2 v[34:35], v10, s[76:79], s36 offen offset:0
    buffer_load_dwordx2 v[36:37], v10, s[72:75], s36 offen offset:192
    buffer_load_dwordx2 v[38:39], v10, s[76:79], s36 offen offset:192
    s_add_u32 s20, s18, s58
    s_addc_u32 s21, s19, 0
    s_add_u32 s80, s50, s57
    s_addc_u32 s81, s51, 0
    s_add_u32 s84, s52, s57
    s_addc_u32 s85, s53, 0
    s_add_u32 s68, s44, s24
    s_addc_u32 s69, s45, 0
    s_mul_i32 s59, s94, 786432
    s_add_u32 s12, s54, s59
    s_addc_u32 s13, s55, 0
    s_add_u32 s8, s40, s59
    s_addc_u32 s9, s41, 0
    s_cmp_lg_u32 s39, 0
    s_cbranch_scc1 L_notleader0
    s_buffer_load_dwordx16 s[40:55], s[20:23], 0 glc
L_notleader0:
    buffer_load_dwordx4 v[240:243], v9, s[64:67], s33 offen offset:384 nt
    buffer_load_dwordx4 v[244:247], v9, s[64:67], s33 offen offset:1920 nt
    buffer_load_dwordx4 v[248:251], v9, s[64:67], s34 offen offset:384 nt
    buffer_load_dwordx4 v[252:255], v9, s[64:67], s34 offen offset:1920 nt
    s_add_u32 s4, s18, s24
    s_addc_u32 s5, s19, 0
    s_mov_b32 s6, 1572864
    s_mov_b32 s7, 0x20000
    s_mov_b32 s10, 786432
    s_mov_b32 s11, 0x20000
    s_mov_b32 s88, s16
    s_mov_b32 s89, s17
    s_add_u32 s16, s33, 3072
    s_add_u32 s17, s33, 6144
    s_mov_b32 s90, 256
    s_mov_b32 s91, 0x20000
    s_lshl_b32 s93, s94, 3
    s_cmp_lg_u32 s39, 0
    s_cbranch_scc1 L_notleader
    s_waitcnt lgkmcnt(0)
    s_mov_b32 s59, 1
    s_lshr_b32 s40, s40, 10
    s_min_u32 s40, s40, 31
    s_bitset1_b32 s59, s40
    s_lshr_b32 s41, s41, 10
    s_min_u32 s41, s41, 31
    s_bitset1_b32 s59, s41
    s_lshr_b32 s42, s42, 10
    s_min_u32 s42, s42, 31
    s_bitset1_b32 s59, s42
    s_lshr_b32 s43, s43, 10
    s_min_u32 s43, s43, 31
    s_bitset1_b32 s59, s43
    s_lshr_b32 s44, s44, 10
    s_min_u32 s44, s44, 31
    s_bitset1_b32 s59, s44
    s_lshr_b32 s45, s45, 10
    s_min_u32 s45, s45, 31
    s_bitset1_b32 s59, s45
    s_lshr_b32 s46, s46, 10
    s_min_u32 s46, s46, 31
    s_bitset1_b32 s59, s46
    s_lshr_b32 s47, s47, 10
    s_min_u32 s47, s47, 31
    s_bitset1_b32 s59, s47
    s_lshr_b32 s48, s48, 10
    s_min_u32 s48, s48, 31
    s_bitset1_b32 s59, s48
    s_lshr_b32 s49, s49, 10
    s_min_u32 s49, s49, 31
    s_bitset1_b32 s59, s49
    s_lshr_b32 s50, s50, 10
    s_min_u32 s50, s50, 31
    s_bitset1_b32 s59, s50
    s_lshr_b32 s51, s51, 10
    s_min_u32 s51, s51, 31
    s_bitset1_b32 s59, s51
    s_lshr_b32 s52, s52, 10
    s_min_u32 s52, s52, 31
    s_bitset1_b32 s59, s52
    s_lshr_b32 s53, s53, 10
    s_min_u32 s53, s53, 31
    s_bitset1_b32 s59, s53
    s_lshr_b32 s54, s54, 10
    s_min_u32 s54, s54, 31
    s_bitset1_b32 s59, s54
    s_lshr_b32 s55, s55, 10
    s_min_u32 s55, s55, 31
    s_bitset1_b32 s59, s55
    s_ff0_i32_b32 s59, s59
    s_lshl_b32 s59, s59, 10
    v_mov_b32 v52, s59
    s_mov_b64 exec, 1
    buffer_store_dword v52, off, s[88:91], s93 sc1
    s_mov_b64 exec, -1
L_notleader:
    s_lshl_b32 s24, s95, 2
    s_add_u32 s24, s24, 32
    s_buffer_load_dword s46, s[20:23], s24 glc
    s_getreg_b32 s45, hwreg(HW_REG_XCC_ID, 0, 4)
    s_lshl_b32 s45, s45, 5
    s_mov_b32 s44, 32
    buffer_load_dwordx3 v[112:114], v12, s[68:71], s35 offen offset:0 nt
    buffer_load_dwordx3 v[116:118], v12, s[68:71], s35 offen offset:768 nt
    buffer_load_dwordx3 v[120:122], v12, s[68:71], s35 offen offset:1536 nt
    buffer_load_dwordx3 v[124:126], v12, s[68:71], s35 offen offset:2304 nt
    buffer_load_dwordx2 v[40:41], off, s[80:83], s37 offset:0
    buffer_load_dwordx2 v[42:43], off, s[84:87], s37 offset:0
    buffer_load_dwordx2 v[44:45], off, s[80:83], s37 offset:8
    buffer_load_dwordx2 v[46:47], off, s[84:87], s37 offset:8
    s_mov_b32 s14, 786432
    s_mov_b32 s15, 0x20000
    s_lshl_b32 s24, s25, 8
    s_add_u32 s93, s93, s24
    v_mul_u32_u24 v30, 3072, v24
    v_add_u32 v4, v30, v1
    v_lshl_add_u32 v30, v24, 3, v26
    v_mul_u32_u24 v30, 384, v30
    v_lshlrev_b32 v31, 2, v29
    v_xor_b32 v31, v27, v31
    v_lshl_add_u32 v30, v31, 4, v30
    v_or_b32 v11, v30, v48
    v_lshlrev_b32 v30, 8, v24
    v_add_u32 v30, 12288, v30
    v_lshrrev_b32 v31, 5, v25
    v_mul_u32_u24 v31, 6144, v31
    v_add_u32 v30, v30, v31
    v_and_b32 v31, 1, v25
    v_mul_u32_u24 v31, 3072, v31
    v_add_u32 v30, v30, v31
    v_bfe_u32 v31, v25, 1, 4
    v_lshl_add_u32 v15, v31, 4, v30
    s_lshl_b32 s24, s95, 2
    v_lshl_add_u32 v13, v0, 2, s24
    v_cmp_lt_u32 vcc, 0, v0
    v_mov_b32 v30, 0x40000000
    s_nop 0
    v_cndmask_b32 v13, v13, v30, vcc
    s_mul_i32 s26, s25, 3072
    s_add_u32 s26, s26, 12288
    s_add_u32 s56, s26, 24576
    s_add_u32 s24, s95, 1
    s_and_b32 s24, s24, 7
    s_mul_i32 s32, s24, 24576
    s_add_u32 s27, s32, 12288
    s_mov_b32 s28, 98304
    s_mov_b32 s30, 73728
    v_add_u32 v1, 24576, v1
    s_mov_b32 s38, 0x3dd53b95
    s_mov_b32 s97, 0xffff0000
    s_mov_b32 s96, 100000
    v_and_b32 v26, 15, v25
    v_lshrrev_b32 v27, 4, v25
    v_bfe_u32 v28, v25, 1, 3
    v_xor_b32 v29, v27, v28
    v_mul_u32_u24 v30, 384, v26
    v_lshl_add_u32 v2, v29, 4, v30
    v_xor_b32 v3, 64, v2
    s_mul_i32 s40, s25, 6144
    s_add_u32 s40, s40, 73728
    v_lshrrev_b32 v29, 1, v27
    v_xor_b32 v29, v29, v28
    v_lshl_add_u32 v31, v29, 4, v30
    v_and_b32 v29, 1, v27
    v_lshl_add_u32 v31, v29, 3, v31
    v_xor_b32 v22, 0, v31
    v_add_u32 v22, s40, v22
    v_xor_b32 v23, 32, v31
    v_add_u32 v23, s40, v23
    v_xor_b32 v142, 64, v31
    v_add_u32 v142, s40, v142
    v_xor_b32 v143, 96, v31
    v_add_u32 v143, s40, v143
    s_lshl_b32 s24, s95, 2
    s_add_u32 s24, s24, s25
    s_mul_i32 s24, s24, 24576
    v_add_u32 v26, 0, v25
    v_mul_u32_u24 v27, 2731, v26
    v_lshrrev_b32 v27, 17, v27
    v_and_b32 v27, 7, v27
    v_xor_b32 v26, v26, v27
    v_lshlrev_b32 v136, 4, v26
    v_add_u32 v136, s24, v136
    v_add_u32 v26, 64, v25
    v_mul_u32_u24 v27, 2731, v26
    v_lshrrev_b32 v27, 17, v27
    v_and_b32 v27, 7, v27
    v_xor_b32 v26, v26, v27
    v_lshlrev_b32 v137, 4, v26
    v_add_u32 v137, s24, v137
    v_add_u32 v26, 128, v25
    v_mul_u32_u24 v27, 2731, v26
    v_lshrrev_b32 v27, 17, v27
    v_and_b32 v27, 7, v27
    v_xor_b32 v26, v26, v27
    v_lshlrev_b32 v138, 4, v26
    v_add_u32 v138, s24, v138
    v_add_u32 v26, 192, v25
    v_mul_u32_u24 v27, 2731, v26
    v_lshrrev_b32 v27, 17, v27
    v_and_b32 v27, 7, v27
    v_xor_b32 v26, v26, v27
    v_lshlrev_b32 v139, 4, v26
    v_add_u32 v139, s24, v139
    v_add_u32 v26, 256, v25
    v_mul_u32_u24 v27, 2731, v26
    v_lshrrev_b32 v27, 17, v27
    v_and_b32 v27, 7, v27
    v_xor_b32 v26, v26, v27
    v_lshlrev_b32 v140, 4, v26
    v_add_u32 v140, s24, v140
    v_add_u32 v26, 320, v25
    v_mul_u32_u24 v27, 2731, v26
    v_lshrrev_b32 v27, 17, v27
    v_and_b32 v27, 7, v27
    v_xor_b32 v26, v26, v27
    v_lshlrev_b32 v141, 4, v26
    v_add_u32 v141, s24, v141
    v_mov_b32 v5, 0
    v_mov_b32 v6, 0
    v_mov_b32 v7, 0
    v_mov_b32 v8, 0
    s_mov_b32 s62, -1
    s_mov_b32 s63, 0xffff
    s_waitcnt vmcnt(12)
    buffer_load_dwordx3 v[80:82], v12, s[68:71], s16 offen offset:0 nt
    buffer_load_dwordx3 v[84:86], v12, s[68:71], s16 offen offset:768 nt
    buffer_load_dwordx3 v[88:90], v12, s[68:71], s16 offen offset:1536 nt
    buffer_load_dwordx3 v[92:94], v12, s[68:71], s16 offen offset:2304 nt
    v_lshlrev_b32 v48, 16, v32
    v_and_b32 v49, s97, v32
    v_lshlrev_b32 v50, 16, v34
    v_and_b32 v51, s97, v34
    v_mul_f32 v48, s38, v48
    v_mul_f32 v49, s38, v49
    v_mul_f32_e64 v50, -v50, v48
    v_mul_f32_e64 v51, -v51, v49
    v_cvt_f32_i32 v224, v224
    v_cvt_f32_i32 v225, v225
    v_fma_f32 v224, v224, v48, v50
    v_fma_f32 v225, v225, v49, v51
    v_cvt_pk_bf16_f32 v224, v224, v225
    v_cvt_f32_i32 v228, v228
    v_cvt_f32_i32 v229, v229
    v_fma_f32 v228, v228, v48, v50
    v_fma_f32 v229, v229, v49, v51
    v_cvt_pk_bf16_f32 v228, v228, v229
    v_cvt_f32_i32 v232, v232
    v_cvt_f32_i32 v233, v233
    v_fma_f32 v232, v232, v48, v50
    v_fma_f32 v233, v233, v49, v51
    v_cvt_pk_bf16_f32 v232, v232, v233
    v_cvt_f32_i32 v236, v236
    v_cvt_f32_i32 v237, v237
    v_fma_f32 v236, v236, v48, v50
    v_fma_f32 v237, v237, v49, v51
    v_cvt_pk_bf16_f32 v236, v236, v237
    v_lshlrev_b32 v48, 16, v33
    v_and_b32 v49, s97, v33
    v_lshlrev_b32 v50, 16, v35
    v_and_b32 v51, s97, v35
    v_mul_f32 v48, s38, v48
    v_mul_f32 v49, s38, v49
    v_mul_f32_e64 v50, -v50, v48
    v_mul_f32_e64 v51, -v51, v49
    v_cvt_f32_i32 v226, v226
    v_cvt_f32_i32 v227, v227
    v_fma_f32 v226, v226, v48, v50
    v_fma_f32 v227, v227, v49, v51
    v_cvt_pk_bf16_f32 v225, v226, v227
    v_cvt_f32_i32 v230, v230
    v_cvt_f32_i32 v231, v231
    v_fma_f32 v230, v230, v48, v50
    v_fma_f32 v231, v231, v49, v51
    v_cvt_pk_bf16_f32 v229, v230, v231
    v_cvt_f32_i32 v234, v234
    v_cvt_f32_i32 v235, v235
    v_fma_f32 v234, v234, v48, v50
    v_fma_f32 v235, v235, v49, v51
    v_cvt_pk_bf16_f32 v233, v234, v235
    v_cvt_f32_i32 v238, v238
    v_cvt_f32_i32 v239, v239
    v_fma_f32 v238, v238, v48, v50
    v_fma_f32 v239, v239, v49, v51
    v_cvt_pk_bf16_f32 v237, v238, v239
    s_waitcnt vmcnt(12)
    v_lshlrev_b32 v48, 16, v36
    v_and_b32 v49, s97, v36
    v_lshlrev_b32 v50, 16, v38
    v_and_b32 v51, s97, v38
    v_mul_f32 v48, s38, v48
    v_mul_f32 v49, s38, v49
    v_mul_f32_e64 v50, -v50, v48
    v_mul_f32_e64 v51, -v51, v49
    v_cvt_f32_i32 v240, v240
    v_cvt_f32_i32 v241, v241
    v_fma_f32 v240, v240, v48, v50
    v_fma_f32 v241, v241, v49, v51
    v_cvt_pk_bf16_f32 v226, v240, v241
    v_cvt_f32_i32 v244, v244
    v_cvt_f32_i32 v245, v245
    v_fma_f32 v244, v244, v48, v50
    v_fma_f32 v245, v245, v49, v51
    v_cvt_pk_bf16_f32 v230, v244, v245
    v_cvt_f32_i32 v248, v248
    v_cvt_f32_i32 v249, v249
    v_fma_f32 v248, v248, v48, v50
    v_fma_f32 v249, v249, v49, v51
    v_cvt_pk_bf16_f32 v234, v248, v249
    v_cvt_f32_i32 v252, v252
    v_cvt_f32_i32 v253, v253
    v_fma_f32 v252, v252, v48, v50
    v_fma_f32 v253, v253, v49, v51
    v_cvt_pk_bf16_f32 v238, v252, v253
    v_lshlrev_b32 v48, 16, v37
    v_and_b32 v49, s97, v37
    v_lshlrev_b32 v50, 16, v39
    v_and_b32 v51, s97, v39
    v_mul_f32 v48, s38, v48
    v_mul_f32 v49, s38, v49
    v_mul_f32_e64 v50, -v50, v48
    v_mul_f32_e64 v51, -v51, v49
    v_cvt_f32_i32 v242, v242
    v_cvt_f32_i32 v243, v243
    v_fma_f32 v242, v242, v48, v50
    v_fma_f32 v243, v243, v49, v51
    v_cvt_pk_bf16_f32 v227, v242, v243
    v_cvt_f32_i32 v246, v246
    v_cvt_f32_i32 v247, v247
    v_fma_f32 v246, v246, v48, v50
    v_fma_f32 v247, v247, v49, v51
    v_cvt_pk_bf16_f32 v231, v246, v247
    v_cvt_f32_i32 v250, v250
    v_cvt_f32_i32 v251, v251
    v_fma_f32 v250, v250, v48, v50
    v_fma_f32 v251, v251, v49, v51
    v_cvt_pk_bf16_f32 v235, v250, v251
    v_cvt_f32_i32 v254, v254
    v_cvt_f32_i32 v255, v255
    v_fma_f32 v254, v254, v48, v50
    v_fma_f32 v255, v255, v49, v51
    v_cvt_pk_bf16_f32 v239, v254, v255
    buffer_store_dwordx4 v[224:227], v11, s[4:7], s33 offen offset:0
    s_mov_b64 exec, s[62:63]
    ds_write_b128 v11, v[224:227] offset:0
    s_mov_b64 exec, -1
    v_xor_b32 v55, 16, v11
    buffer_store_dwordx4 v[228:231], v55, s[4:7], s33 offen offset:768
    s_mov_b64 exec, s[62:63]
    ds_write_b128 v55, v[228:231] offset:768
    s_mov_b64 exec, -1
    v_xor_b32 v54, 32, v11
    buffer_store_dwordx4 v[232:235], v54, s[4:7], s33 offen offset:1536
    s_mov_b64 exec, s[62:63]
    ds_write_b128 v54, v[232:235] offset:1536
    s_mov_b64 exec, -1
    v_xor_b32 v55, 48, v11
    buffer_store_dwordx4 v[236:239], v55, s[4:7], s33 offen offset:2304
    s_mov_b64 exec, s[62:63]
    ds_write_b128 v55, v[236:239] offset:2304
    s_mov_b64 exec, -1
    s_mov_b32 s41, 0
    s_add_u32 m0, s40, 24576
    s_nop 0
    buffer_load_dwordx4 v136, s[8:11], s41 offen nt lds
    s_add_u32 m0, s40, 25600
    s_nop 0
    buffer_load_dwordx4 v137, s[8:11], s41 offen nt lds
    s_add_u32 m0, s40, 26624
    s_nop 0
    buffer_load_dwordx4 v138, s[8:11], s41 offen nt lds
    s_add_u32 m0, s40, 27648
    s_nop 0
    buffer_load_dwordx4 v139, s[8:11], s41 offen nt lds
    s_add_u32 m0, s40, 28672
    s_nop 0
    buffer_load_dwordx4 v140, s[8:11], s41 offen nt lds
    s_add_u32 m0, s40, 29696
    s_waitcnt vmcnt(20)
    buffer_load_dwordx4 v141, s[8:11], s41 offen nt lds
    s_waitcnt vmcnt(14)
    v_lshlrev_b32 v48, 16, v40
    v_and_b32 v49, s97, v40
    v_lshlrev_b32 v50, 16, v42
    v_and_b32 v51, s97, v42
    v_mul_f32_e64 v50, -v50, v48
    v_mul_f32_e64 v51, -v51, v49
    v_cvt_f32_i32 v112, v112
    v_cvt_f32_i32 v116, v116
    v_fma_f32 v112, v112, v48, v50
    v_fma_f32 v116, v116, v49, v51
    v_cvt_f32_i32 v113, v113
    v_cvt_f32_i32 v117, v117
    v_fma_f32 v113, v113, v48, v50
    v_fma_f32 v117, v117, v49, v51
    v_cvt_f32_i32 v114, v114
    v_cvt_f32_i32 v118, v118
    v_fma_f32 v114, v114, v48, v50
    v_fma_f32 v118, v118, v49, v51
    v_lshlrev_b32 v48, 16, v41
    v_and_b32 v49, s97, v41
    v_lshlrev_b32 v50, 16, v43
    v_and_b32 v51, s97, v43
    v_mul_f32_e64 v50, -v50, v48
    v_mul_f32_e64 v51, -v51, v49
    v_cvt_f32_i32 v120, v120
    v_cvt_f32_i32 v124, v124
    v_fma_f32 v120, v120, v48, v50
    v_fma_f32 v124, v124, v49, v51
    v_cvt_f32_i32 v121, v121
    v_cvt_f32_i32 v125, v125
    v_fma_f32 v121, v121, v48, v50
    v_fma_f32 v125, v125, v49, v51
    v_cvt_f32_i32 v122, v122
    v_cvt_f32_i32 v126, v126
    v_fma_f32 v122, v122, v48, v50
    v_fma_f32 v126, v126, v49, v51
    v_cvt_pk_bf16_f32 v112, v112, v116
    v_cvt_pk_bf16_f32 v116, v113, v117
    v_cvt_pk_bf16_f32 v113, v120, v124
    v_cvt_pk_bf16_f32 v117, v121, v125
    v_cvt_pk_bf16_f32 v120, v114, v118
    v_cvt_pk_bf16_f32 v121, v122, v126
    s_waitcnt vmcnt(10)
    v_lshlrev_b32 v48, 16, v44
    v_and_b32 v49, s97, v44
    v_lshlrev_b32 v50, 16, v46
    v_and_b32 v51, s97, v46
    v_mul_f32_e64 v50, -v50, v48
    v_mul_f32_e64 v51, -v51, v49
    v_cvt_f32_i32 v80, v80
    v_cvt_f32_i32 v84, v84
    v_fma_f32 v80, v80, v48, v50
    v_fma_f32 v84, v84, v49, v51
    v_cvt_f32_i32 v81, v81
    v_cvt_f32_i32 v85, v85
    v_fma_f32 v81, v81, v48, v50
    v_fma_f32 v85, v85, v49, v51
    v_cvt_f32_i32 v82, v82
    v_cvt_f32_i32 v86, v86
    v_fma_f32 v82, v82, v48, v50
    v_fma_f32 v86, v86, v49, v51
    v_lshlrev_b32 v48, 16, v45
    v_and_b32 v49, s97, v45
    v_lshlrev_b32 v50, 16, v47
    v_and_b32 v51, s97, v47
    v_mul_f32_e64 v50, -v50, v48
    v_mul_f32_e64 v51, -v51, v49
    v_cvt_f32_i32 v88, v88
    v_cvt_f32_i32 v92, v92
    v_fma_f32 v88, v88, v48, v50
    v_fma_f32 v92, v92, v49, v51
    v_cvt_f32_i32 v89, v89
    v_cvt_f32_i32 v93, v93
    v_fma_f32 v89, v89, v48, v50
    v_fma_f32 v93, v93, v49, v51
    v_cvt_f32_i32 v90, v90
    v_cvt_f32_i32 v94, v94
    v_fma_f32 v90, v90, v48, v50
    v_fma_f32 v94, v94, v49, v51
    v_cvt_pk_bf16_f32 v114, v80, v84
    v_cvt_pk_bf16_f32 v118, v81, v85
    v_cvt_pk_bf16_f32 v115, v88, v92
    v_cvt_pk_bf16_f32 v119, v89, v93
    v_cvt_pk_bf16_f32 v122, v82, v86
    v_cvt_pk_bf16_f32 v123, v90, v94
    buffer_store_dwordx4 v[112:115], v15, s[4:7], s35 offen offset:0
    buffer_store_dwordx4 v[116:119], v15, s[4:7], s35 offen offset:1024
    buffer_store_dwordx4 v[120:123], v15, s[4:7], s35 offen offset:2048
    ds_write_b128 v15, v[112:115] offset:12288
    ds_write_b128 v15, v[116:119] offset:13312
    ds_write_b128 v15, v[120:123] offset:14336
    buffer_load_dword v0, off, s[88:91], s93 sc1
    s_mov_b32 s41, 6144
    s_add_u32 m0, s40, 0
    s_nop 0
    buffer_load_dwordx4 v136, s[8:11], s41 offen nt lds
    s_add_u32 m0, s40, 1024
    s_nop 0
    buffer_load_dwordx4 v137, s[8:11], s41 offen nt lds
    s_add_u32 m0, s40, 2048
    s_nop 0
    buffer_load_dwordx4 v138, s[8:11], s41 offen nt lds
    s_add_u32 m0, s40, 3072
    s_nop 0
    buffer_load_dwordx4 v139, s[8:11], s41 offen nt lds
    s_add_u32 m0, s40, 4096
    s_nop 0
    buffer_load_dwordx4 v140, s[8:11], s41 offen nt lds
    s_add_u32 m0, s40, 5120
    s_waitcnt vmcnt(14)
    buffer_load_dwordx4 v141, s[8:11], s41 offen nt lds
    s_mov_b64 exec, 0
    s_cmp_eq_u32 s25, 0
    s_cbranch_scc1 L_iw0
    s_cmp_eq_u32 s25, 1
    s_cbranch_scc1 L_iw1
    s_cmp_eq_u32 s25, 2
    s_cbranch_scc1 L_iw2
    s_branch L_iw3
L_iwret:
    s_mov_b64 exec, -1
    s_waitcnt vmcnt(6)
    s_cmp_lg_u32 s25, 0
    s_cbranch_scc1 L_tagdone
    v_readfirstlane_b32 s42, v0
    s_mov_b32 s39, 100
    s_waitcnt lgkmcnt(0)
    s_and_b32 s46, s46, 0xfffffc00
L_tagretry:
    s_cmp_eq_u32 s42, s46
    s_cselect_b32 s42, 0, s42
    s_cmp_lg_u32 s42, 0
    s_cbranch_scc1 L_tagok
    s_sub_u32 s39, s39, 1
    s_cbranch_scc1 L_tagslow
    s_sleep 4
    s_buffer_load_dword s42, s[88:91], s93 glc
    s_waitcnt lgkmcnt(0)
    s_branch L_tagretry
L_tagok:
    s_add_u32 s42, s42, s45
    v_mov_b32 v0, s42
    v_mov_b32 v16, 147456
    ds_write_b32 v16, v0
L_tagdone:
    s_waitcnt lgkmcnt(0)
    s_barrier
    v_add_u32 v0, 1, v0
    buffer_store_dword v0, v13, s[20:23], 0 offen offset:32 sc1
    v_mov_b32 v16, 147456
    ds_read_b32 v17, v16
    ds_read_b128 v[144:147], v2 offset:0
    ds_read_b128 v[148:151], v3 offset:0
    ds_read_b128 v[152:155], v2 offset:6144
    ds_read_b128 v[156:159], v3 offset:6144
    ds_read_b128 v[160:163], v2 offset:128
    ds_read_b128 v[164:167], v3 offset:128
    ds_read_b128 v[168:171], v2 offset:6272
    ds_read_b128 v[172:175], v3 offset:6272
    ds_read_b128 v[176:179], v2 offset:256
    ds_read_b128 v[180:183], v3 offset:256
    ds_read_b128 v[184:187], v2 offset:6400
    ds_read_b128 v[188:191], v3 offset:6400
    s_mov_b32 s41, 12288
    s_add_u32 m0, s40, 49152
    s_nop 0
    buffer_load_dwordx4 v136, s[8:11], s41 offen nt lds
    s_add_u32 m0, s40, 50176
    s_nop 0
    buffer_load_dwordx4 v137, s[8:11], s41 offen nt lds
    s_add_u32 m0, s40, 51200
    s_nop 0
    buffer_load_dwordx4 v138, s[8:11], s41 offen nt lds
    s_add_u32 m0, s40, 52224
    s_nop 0
    buffer_load_dwordx4 v139, s[8:11], s41 offen nt lds
    s_add_u32 m0, s40, 53248
    s_nop 0
    buffer_load_dwordx4 v140, s[8:11], s41 offen nt lds
    s_add_u32 m0, s40, 54272
    s_nop 0
    buffer_load_dwordx4 v141, s[8:11], s41 offen nt lds
    s_waitcnt vmcnt(17)
    ds_read_b64 a[192:193], v22 offset:24576
    ds_read_b64 a[194:195], v142 offset:24704
    ds_read_b64 a[196:197], v23 offset:24576
    ds_read_b64 a[198:199], v143 offset:24704
    ds_read_b64 a[200:201], v142 offset:24576
    ds_read_b64 a[202:203], v22 offset:24832
    ds_read_b64 a[204:205], v143 offset:24576
    ds_read_b64 a[206:207], v23 offset:24832
    ds_read_b64 a[208:209], v22 offset:24704
    ds_read_b64 a[210:211], v142 offset:24832
    ds_read_b64 a[212:213], v23 offset:24704
    ds_read_b64 a[214:215], v143 offset:24832
    s_waitcnt lgkmcnt(15)
    v_readfirstlane_b32 s92, v17
    s_add_u32 s92, s92, 1
    s_waitcnt lgkmcnt(0)
    s_mov_b32 s41, 18432
    s_add_u32 m0, s40, 24576
    s_waitcnt vmcnt(12)
    buffer_load_dwordx4 v136, s[8:11], s41 offen nt lds
    s_add_u32 m0, s40, 25600
    s_waitcnt vmcnt(12)
    buffer_load_dwordx4 v137, s[8:11], s41 offen nt lds
    s_add_u32 m0, s40, 26624
    s_waitcnt vmcnt(12)
    buffer_load_dwordx4 v138, s[8:11], s41 offen nt lds
    v_mfma_f32_16x16x32_bf16 v[64:67], v[144:147], a[192:195], 0
    v_mfma_f32_16x16x32_bf16 v[64:67], v[148:151], a[196:199], v[64:67]
    v_mfma_f32_16x16x32_bf16 v[64:67], v[160:163], a[200:203], v[64:67]
    v_mfma_f32_16x16x32_bf16 v[64:67], v[164:167], a[204:207], v[64:67]
    v_mfma_f32_16x16x32_bf16 v[64:67], v[176:179], a[208:211], v[64:67]
    v_mfma_f32_16x16x32_bf16 v[64:67], v[180:183], a[212:215], v[64:67]
    v_mfma_f32_16x16x32_bf16 v[96:99], v[152:155], a[192:195], 0
    v_mfma_f32_16x16x32_bf16 v[96:99], v[156:159], a[196:199], v[96:99]
    v_mfma_f32_16x16x32_bf16 v[96:99], v[168:171], a[200:203], v[96:99]
    v_mfma_f32_16x16x32_bf16 v[96:99], v[172:175], a[204:207], v[96:99]
    v_mfma_f32_16x16x32_bf16 v[96:99], v[184:187], a[208:211], v[96:99]
    v_mfma_f32_16x16x32_bf16 v[96:99], v[188:191], a[212:215], v[96:99]
    s_waitcnt vmcnt(10)
    ds_read_b64 a[216:217], v22 offset:0
    ds_read_b64 a[218:219], v142 offset:128
    ds_read_b64 a[220:221], v23 offset:0
    ds_read_b64 a[222:223], v143 offset:128
    ds_read_b64 a[224:225], v142 offset:0
    ds_read_b64 a[226:227], v22 offset:256
    ds_read_b64 a[228:229], v143 offset:0
    ds_read_b64 a[230:231], v23 offset:256
    ds_read_b64 a[232:233], v22 offset:128
    ds_read_b64 a[234:235], v142 offset:256
    ds_read_b64 a[236:237], v23 offset:128
    ds_read_b64 a[238:239], v143 offset:256
    s_mov_b32 s41, 18432
    s_add_u32 m0, s40, 27648
    s_nop 0
    buffer_load_dwordx4 v139, s[8:11], s41 offen nt lds
    s_add_u32 m0, s40, 28672
    s_nop 0
    buffer_load_dwordx4 v140, s[8:11], s41 offen nt lds
    s_add_u32 m0, s40, 29696
    s_nop 0
    buffer_load_dwordx4 v141, s[8:11], s41 offen nt lds
    v_max3_f32 v48, v64, v65, v66
L_iw0:
L_pg0:
    s_cbranch_execz L_pg4
    v_max3_f32 v50, v67, v96, v97
    v_max3_f32 v48, v48, v98, v99
    v_max_f32 v48, v48, v50
    v_mov_b32 v49, v48
    s_nop 1
    v_permlane16_swap_b32 v48, v49
    s_nop 1
    v_max_f32 v48, v48, v49
    v_mov_b32 v49, v48
    s_nop 1
    v_permlane32_swap_b32 v48, v49
    s_nop 1
    v_max_f32 v48, v48, v49
    s_waitcnt lgkmcnt(0)
    v_mfma_f32_16x16x32_bf16 v[68:71], v[144:147], a[216:219], 0
    v_sub_f32 v64, v64, v48
    v_sub_f32 v65, v65, v48
    v_sub_f32 v66, v66, v48
    v_mfma_f32_16x16x32_bf16 v[68:71], v[148:151], a[220:223], v[68:71]
    v_sub_f32 v67, v67, v48
    v_sub_f32 v96, v96, v48
    v_sub_f32 v97, v97, v48
    v_mfma_f32_16x16x32_bf16 v[68:71], v[160:163], a[224:227], v[68:71]
    v_sub_f32 v98, v98, v48
    v_sub_f32 v99, v99, v48
    v_mfma_f32_16x16x32_bf16 v[68:71], v[164:167], a[228:231], v[68:71]
    v_exp_f32 v64, v64
    v_mfma_f32_16x16x32_bf16 v[68:71], v[176:179], a[232:235], v[68:71]
    v_exp_f32 v65, v65
    v_mfma_f32_16x16x32_bf16 v[68:71], v[180:183], a[236:239], v[68:71]
    v_exp_f32 v66, v66
    v_mfma_f32_16x16x32_bf16 v[100:103], v[152:155], a[216:219], 0
    v_exp_f32 v67, v67
    v_mfma_f32_16x16x32_bf16 v[100:103], v[156:159], a[220:223], v[100:103]
    v_exp_f32 v96, v96
    v_mfma_f32_16x16x32_bf16 v[100:103], v[168:171], a[224:227], v[100:103]
    v_exp_f32 v97, v97
    v_mfma_f32_16x16x32_bf16 v[100:103], v[172:175], a[228:231], v[100:103]
    v_exp_f32 v98, v98
    v_mfma_f32_16x16x32_bf16 v[100:103], v[184:187], a[232:235], v[100:103]
    v_exp_f32 v99, v99
    v_sub_f32 v128, 0, v48
    v_mfma_f32_16x16x32_bf16 v[100:103], v[188:191], a[236:239], v[100:103]
    v_sub_f32 v129, 0, v48
    v_sub_f32 v130, 0, v48
    v_sub_f32 v131, 0, v48
    v_add_f32 v5, v5, v64
    v_add_f32 v5, v5, v65
    v_add_f32 v5, v5, v66
    v_add_f32 v5, v5, v67
    v_add_f32 v5, v5, v96
    v_add_f32 v5, v5, v97
    v_add_f32 v5, v5, v98
    v_add_f32 v5, v5, v99
    v_cvt_pk_bf16_f32 v64, v64, v65
    v_cvt_pk_bf16_f32 v65, v66, v67
    v_cvt_pk_bf16_f32 v66, v96, v97
    v_cvt_pk_bf16_f32 v67, v98, v99
    s_waitcnt vmcnt(6)
    ds_read_b64 a[240:241], v22 offset:49152
    ds_read_b64 a[242:243], v142 offset:49280
    ds_read_b64 a[244:245], v23 offset:49152
    ds_read_b64 a[246:247], v143 offset:49280
    ds_read_b64 a[248:249], v142 offset:49152
    ds_read_b64 a[250:251], v22 offset:49408
    ds_read_b64 a[252:253], v143 offset:49152
    ds_read_b64 a[254:255], v23 offset:49408
    ds_read_b64 v[192:193], v22 offset:49280
    ds_read_b64 v[194:195], v142 offset:49408
    ds_read_b64 v[196:197], v23 offset:49280
    ds_read_b64 v[198:199], v143 offset:49408
    s_buffer_load_dwordx8 s[48:55], s[20:23], s44 glc
    v_max3_f32 v48, v68, v69, v70
    v_max3_f32 v50, v71, v100, v101
    v_max3_f32 v48, v48, v102, v103
    v_max_f32 v48, v48, v50
    v_mov_b32 v49, v48
    s_nop 1
    v_permlane16_swap_b32 v48, v49
    s_nop 1
    v_max_f32 v48, v48, v49
    v_mov_b32 v49, v48
    s_nop 1
    v_permlane32_swap_b32 v48, v49
    s_nop 1
    v_max_f32 v48, v48, v49
    s_waitcnt lgkmcnt(0)
    v_mfma_f32_16x16x32_bf16 v[72:75], v[144:147], a[240:243], 0
    v_sub_f32 v68, v68, v48
    v_sub_f32 v69, v69, v48
    v_sub_f32 v70, v70, v48
    v_mfma_f32_16x16x32_bf16 v[72:75], v[148:151], a[244:247], v[72:75]
    v_sub_f32 v71, v71, v48
    v_sub_f32 v100, v100, v48
    v_sub_f32 v101, v101, v48
    v_mfma_f32_16x16x32_bf16 v[72:75], v[160:163], a[248:251], v[72:75]
    v_sub_f32 v102, v102, v48
    v_sub_f32 v103, v103, v48
    v_mfma_f32_16x16x32_bf16 v[72:75], v[164:167], a[252:255], v[72:75]
    v_exp_f32 v68, v68
    v_mfma_f32_16x16x32_bf16 v[72:75], v[176:179], v[192:195], v[72:75]
    v_exp_f32 v69, v69
    v_mfma_f32_16x16x32_bf16 v[72:75], v[180:183], v[196:199], v[72:75]
    v_exp_f32 v70, v70
    v_mfma_f32_16x16x32_bf16 v[104:107], v[152:155], a[240:243], 0
    v_exp_f32 v71, v71
    v_mfma_f32_16x16x32_bf16 v[104:107], v[156:159], a[244:247], v[104:107]
    v_exp_f32 v100, v100
    v_mfma_f32_16x16x32_bf16 v[104:107], v[168:171], a[248:251], v[104:107]
    v_exp_f32 v101, v101
    v_mfma_f32_16x16x32_bf16 v[104:107], v[172:175], a[252:255], v[104:107]
    v_exp_f32 v102, v102
    v_mfma_f32_16x16x32_bf16 v[104:107], v[184:187], v[192:195], v[104:107]
    v_exp_f32 v103, v103
    v_sub_f32 v132, 0, v48
    v_mfma_f32_16x16x32_bf16 v[104:107], v[188:191], v[196:199], v[104:107]
    v_sub_f32 v133, 0, v48
    v_sub_f32 v134, 0, v48
    v_sub_f32 v135, 0, v48
    v_add_f32 v6, v6, v68
    v_add_f32 v6, v6, v69
    v_add_f32 v6, v6, v70
    v_add_f32 v6, v6, v71
    v_add_f32 v6, v6, v100
    v_add_f32 v6, v6, v101
    v_add_f32 v6, v6, v102
    v_add_f32 v6, v6, v103
    v_cvt_pk_bf16_f32 v68, v68, v69
    v_cvt_pk_bf16_f32 v69, v70, v71
    v_cvt_pk_bf16_f32 v70, v100, v101
    v_cvt_pk_bf16_f32 v71, v102, v103
    ds_read_b128 v[24:27], v1 offset:0
    ds_read_b128 v[28:31], v1 offset:1024
    ds_read_b128 v[32:35], v1 offset:2048
    ds_read_b128 v[36:39], v1 offset:3072
    s_waitcnt lgkmcnt(0)
    s_sub_u32 s48, s48, s92
    s_sub_u32 s49, s49, s92
    s_sub_u32 s50, s50, s92
    s_sub_u32 s51, s51, s92
    s_sub_u32 s52, s52, s92
    s_sub_u32 s53, s53, s92
    s_sub_u32 s54, s54, s92
    s_sub_u32 s55, s55, s92
    s_max_u32 s48, s48, s49
    s_max_u32 s48, s48, s50
    s_max_u32 s48, s48, s51
    s_max_u32 s48, s48, s52
    s_max_u32 s48, s48, s53
    s_max_u32 s48, s48, s54
    s_max_u32 s48, s48, s55
    s_cmp_ge_u32 s48, 16
    s_cbranch_scc1 L_pollslow0
L_pollok0:
    s_add_u32 s92, s92, 1
    s_mov_b32 m0, s26
    s_nop 0
    buffer_load_dwordx4 v4, s[4:7], s32 offen offset:0 sc1 lds
    buffer_load_dwordx4 v4, s[4:7], s32 offen offset:1024 sc1 lds
    buffer_load_dwordx4 v4, s[4:7], s32 offen offset:2048 sc1 lds
    s_add_u32 s32, s32, 24576
    s_sub_u32 s57, s32, 196608
    s_min_u32 s32, s32, s57
    s_add_u32 s26, s26, 36864
    s_sub_u32 s57, s26, 147456
    s_min_u32 s26, s26, s57
    s_mov_b32 m0, s26
    s_nop 0
    buffer_load_dwordx4 v4, s[4:7], s32 offen offset:0 sc1 lds
    buffer_load_dwordx4 v4, s[4:7], s32 offen offset:1024 sc1 lds
    buffer_load_dwordx4 v4, s[4:7], s32 offen offset:2048 sc1 lds
    s_add_u32 s32, s32, 24576
    s_sub_u32 s57, s32, 196608
    s_min_u32 s32, s32, s57
    s_add_u32 s26, s26, 12288
    s_mov_b32 m0, s26
    s_waitcnt vmcnt(11)
    buffer_load_dwordx4 v4, s[4:7], s32 offen offset:0 sc1 lds
    s_waitcnt vmcnt(11)
    buffer_load_dwordx4 v4, s[4:7], s32 offen offset:1024 sc1 lds
    s_waitcnt vmcnt(11)
    buffer_load_dwordx4 v4, s[4:7], s32 offen offset:2048 sc1 lds
    s_add_u32 s32, s32, 24576
    s_sub_u32 s57, s32, 196608
    s_min_u32 s32, s32, s57
    s_add_u32 s26, s26, 36864
    s_sub_u32 s57, s26, 147456
    s_min_u32 s26, s26, s57
    s_mov_b32 m0, s56
    s_waitcnt vmcnt(11)
    buffer_load_dwordx4 v4, s[4:7], s27 offen offset:0 sc1 lds
    s_waitcnt vmcnt(11)
    buffer_load_dwordx4 v4, s[4:7], s27 offen offset:1024 sc1 lds
    s_waitcnt vmcnt(11)
    buffer_load_dwordx4 v4, s[4:7], s27 offen offset:2048 sc1 lds
    s_add_u32 s27, s27, 24576
    s_sub_u32 s58, s27, 196608
    s_min_u32 s27, s27, s58
    s_add_u32 s56, s56, 36864
    s_sub_u32 s58, s56, 147456
    s_min_u32 s56, s56, s58
    s_add_u32 s33, s33, 196608
    s_add_u32 s34, s34, 196608
    s_add_u32 s36, s36, 1536
    s_add_u32 s35, s35, 196608
    s_add_u32 s16, s16, 196608
    s_add_u32 s17, s17, 196608
    s_add_u32 s37, s37, 512
    v_mfma_f32_16x16x32_bf16 a[0:3], v[64:67], v[24:27], 0
    ds_read_b128 v[40:43], v1 offset:4096
    v_max3_f32 v48, v72, v73, v74
    v_mfma_f32_16x16x32_bf16 a[4:7], v[64:67], v[28:31], 0
    v_max3_f32 v50, v75, v104, v105
    v_max3_f32 v48, v48, v106, v107
    v_mfma_f32_16x16x32_bf16 a[48:51], v[68:71], v[24:27], 0
    ds_read_b128 v[44:47], v1 offset:5120
    v_max_f32 v48, v48, v50
    v_mfma_f32_16x16x32_bf16 a[52:55], v[68:71], v[28:31], 0
    s_waitcnt lgkmcnt(2)
    v_mov_b32 v49, v48
    v_mfma_f32_16x16x32_bf16 a[8:11], v[64:67], v[32:35], 0
    s_nop 1
    ds_read_b128 v[24:27], v1 offset:6144
    v_mfma_f32_16x16x32_bf16 a[12:15], v[64:67], v[36:39], 0
    v_permlane16_swap_b32 v48, v49
    s_nop 1
    v_mfma_f32_16x16x32_bf16 a[56:59], v[68:71], v[32:35], 0
    ds_read_b128 v[28:31], v1 offset:7168
    v_max_f32 v48, v48, v49
    v_mfma_f32_16x16x32_bf16 a[60:63], v[68:71], v[36:39], 0
    s_waitcnt lgkmcnt(2)
    v_mov_b32 v49, v48
    s_nop 1
    v_mfma_f32_16x16x32_bf16 a[16:19], v[64:67], v[40:43], 0
    ds_read_b128 v[32:35], v1 offset:8192
    v_permlane32_swap_b32 v48, v49
    v_mfma_f32_16x16x32_bf16 a[20:23], v[64:67], v[44:47], 0
    s_nop 1
    v_max_f32 v48, v48, v49
    v_sub_f32 v72, v72, v48
    v_mfma_f32_16x16x32_bf16 a[64:67], v[68:71], v[40:43], 0
    ds_read_b128 v[36:39], v1 offset:9216
    v_sub_f32 v73, v73, v48
    v_mfma_f32_16x16x32_bf16 a[68:71], v[68:71], v[44:47], 0
    s_waitcnt lgkmcnt(2)
    v_sub_f32 v74, v74, v48
    v_sub_f32 v75, v75, v48
    v_sub_f32 v104, v104, v48
    v_mfma_f32_16x16x32_bf16 a[24:27], v[64:67], v[24:27], 0
    ds_read_b128 v[40:43], v1 offset:10240
    v_sub_f32 v105, v105, v48
    v_mfma_f32_16x16x32_bf16 a[28:31], v[64:67], v[28:31], 0
    v_sub_f32 v106, v106, v48
    v_sub_f32 v107, v107, v48
    v_mfma_f32_16x16x32_bf16 a[72:75], v[68:71], v[24:27], 0
    ds_read_b128 v[44:47], v1 offset:11264
    v_mfma_f32_16x16x32_bf16 a[76:79], v[68:71], v[28:31], 0
    s_waitcnt lgkmcnt(2)
    v_exp_f32 v72, v72
    v_mfma_f32_16x16x32_bf16 a[32:35], v[64:67], v[32:35], 0
    v_exp_f32 v73, v73
    v_mfma_f32_16x16x32_bf16 a[36:39], v[64:67], v[36:39], 0
    v_exp_f32 v74, v74
    v_mfma_f32_16x16x32_bf16 a[80:83], v[68:71], v[32:35], 0
    v_exp_f32 v75, v75
    v_mfma_f32_16x16x32_bf16 a[84:87], v[68:71], v[36:39], 0
    s_waitcnt lgkmcnt(0)
    v_exp_f32 v104, v104
    v_mfma_f32_16x16x32_bf16 a[40:43], v[64:67], v[40:43], 0
    v_exp_f32 v105, v105
    v_mfma_f32_16x16x32_bf16 a[44:47], v[64:67], v[44:47], 0
    v_exp_f32 v106, v106
    v_mfma_f32_16x16x32_bf16 a[88:91], v[68:71], v[40:43], 0
    v_exp_f32 v107, v107
    v_mfma_f32_16x16x32_bf16 a[92:95], v[68:71], v[44:47], 0
    v_sub_f32 v136, 0, v48
    v_sub_f32 v137, 0, v48
    v_sub_f32 v138, 0, v48
    v_sub_f32 v139, 0, v48
    v_add_f32 v7, v7, v72
    v_add_f32 v7, v7, v73
    v_add_f32 v7, v7, v74
    v_add_f32 v7, v7, v75
    v_add_f32 v7, v7, v104
    v_add_f32 v7, v7, v105
    v_add_f32 v7, v7, v106
    v_add_f32 v7, v7, v107
    v_cvt_pk_bf16_f32 v72, v72, v73
    v_cvt_pk_bf16_f32 v73, v74, v75
    v_cvt_pk_bf16_f32 v74, v104, v105
    v_cvt_pk_bf16_f32 v75, v106, v107
    s_waitcnt vmcnt(12)
    ds_read_b64 v[200:201], v22 offset:24576
    ds_read_b64 v[202:203], v142 offset:24704
    ds_read_b64 v[204:205], v23 offset:24576
    ds_read_b64 v[206:207], v143 offset:24704
    ds_read_b64 v[208:209], v142 offset:24576
    ds_read_b64 v[210:211], v22 offset:24832
    ds_read_b64 v[212:213], v143 offset:24576
    ds_read_b64 v[214:215], v23 offset:24832
    ds_read_b64 v[216:217], v22 offset:24704
    ds_read_b64 v[218:219], v142 offset:24832
    ds_read_b64 v[220:221], v23 offset:24704
    ds_read_b64 v[222:223], v143 offset:24832
    s_waitcnt lgkmcnt(0)
    v_mfma_f32_16x16x32_bf16 v[76:79], v[144:147], v[200:203], 0
    v_mfma_f32_16x16x32_bf16 v[76:79], v[148:151], v[204:207], v[76:79]
    v_mfma_f32_16x16x32_bf16 v[76:79], v[160:163], v[208:211], v[76:79]
    v_mfma_f32_16x16x32_bf16 v[76:79], v[164:167], v[212:215], v[76:79]
    v_mfma_f32_16x16x32_bf16 v[76:79], v[176:179], v[216:219], v[76:79]
    v_mfma_f32_16x16x32_bf16 v[76:79], v[180:183], v[220:223], v[76:79]
    v_mfma_f32_16x16x32_bf16 v[108:111], v[152:155], v[200:203], 0
    v_mfma_f32_16x16x32_bf16 v[108:111], v[156:159], v[204:207], v[108:111]
    v_mfma_f32_16x16x32_bf16 v[108:111], v[168:171], v[208:211], v[108:111]
    v_mfma_f32_16x16x32_bf16 v[108:111], v[172:175], v[212:215], v[108:111]
    v_mfma_f32_16x16x32_bf16 v[108:111], v[184:187], v[216:219], v[108:111]
    v_mfma_f32_16x16x32_bf16 v[108:111], v[188:191], v[220:223], v[108:111]
    s_nop 7
    v_max3_f32 v48, v76, v77, v78
    v_max3_f32 v50, v79, v108, v109
    v_max3_f32 v48, v48, v110, v111
    v_max_f32 v48, v48, v50
    v_mov_b32 v49, v48
    s_nop 1
    v_permlane16_swap_b32 v48, v49
    s_nop 1
    v_max_f32 v48, v48, v49
    v_mov_b32 v49, v48
    s_nop 1
    v_permlane32_swap_b32 v48, v49
    s_nop 1
    v_max_f32 v48, v48, v49
    v_sub_f32 v140, 0, v48
    v_sub_f32 v141, 0, v48
    v_sub_f32 v142, 0, v48
    v_sub_f32 v143, 0, v48
    s_waitcnt vmcnt(9)
    s_barrier
    ds_read_b128 v[24:27], v2 offset:12288
    ds_read_b128 v[28:31], v3 offset:12288
    ds_read_b128 v[32:35], v2 offset:18432
    ds_read_b128 v[36:39], v3 offset:18432
    s_waitcnt lgkmcnt(2)
    v_mfma_f32_16x16x32_bf16 v[80:83], v[24:27], a[192:195], v[128:131]
    ds_read_b128 v[40:43], v2 offset:12416
    v_sub_f32 v76, v76, v48
    v_mfma_f32_16x16x32_bf16 v[80:83], v[28:31], a[196:199], v[80:83]
    buffer_load_dwordx2 v[56:57], v10, s[72:75], s36 offen offset:0
    v_mfma_f32_16x16x32_bf16 v[84:87], v[28:31], a[220:223], v[132:135]
    v_sub_f32 v77, v77, v48
    v_sub_f32 v78, v78, v48
    v_mfma_f32_16x16x32_bf16 v[84:87], v[24:27], a[216:219], v[84:87]
    buffer_load_dwordx2 v[58:59], v10, s[76:79], s36 offen offset:0
    v_mfma_f32_16x16x32_bf16 v[88:91], v[24:27], a[240:243], v[136:139]
    ds_read_b128 v[44:47], v3 offset:12416
    v_sub_f32 v79, v79, v48
    v_mfma_f32_16x16x32_bf16 v[88:91], v[28:31], a[244:247], v[88:91]
    buffer_load_dwordx4 v[224:227], v9, s[64:67], s33 offen offset:0 nt
    v_mfma_f32_16x16x32_bf16 v[92:95], v[28:31], v[204:207], v[140:143]
    v_sub_f32 v108, v108, v48
    v_sub_f32 v109, v109, v48
    v_mfma_f32_16x16x32_bf16 v[92:95], v[24:27], v[200:203], v[92:95]
    s_waitcnt lgkmcnt(2)
    buffer_load_dwordx4 v[228:231], v9, s[64:67], s33 offen offset:1536 nt
    v_mfma_f32_16x16x32_bf16 v[112:115], v[32:35], a[192:195], v[128:131]
    ds_read_b128 v[24:27], v2 offset:18560
    v_sub_f32 v110, v110, v48
    v_mfma_f32_16x16x32_bf16 v[112:115], v[36:39], a[196:199], v[112:115]
    buffer_load_dwordx4 v[232:235], v9, s[64:67], s34 offen offset:0 nt
    v_mfma_f32_16x16x32_bf16 v[116:119], v[36:39], a[220:223], v[132:135]
    v_sub_f32 v111, v111, v48
    v_mfma_f32_16x16x32_bf16 v[116:119], v[32:35], a[216:219], v[116:119]
    s_waitcnt vmcnt(13)
    buffer_load_dwordx4 v[236:239], v9, s[64:67], s34 offen offset:1536 nt
    v_mfma_f32_16x16x32_bf16 v[120:123], v[32:35], a[240:243], v[136:139]
    ds_read_b128 v[28:31], v3 offset:18560
    v_mfma_f32_16x16x32_bf16 v[120:123], v[36:39], a[244:247], v[120:123]
    v_exp_f32 v76, v76
    v_mfma_f32_16x16x32_bf16 v[124:127], v[36:39], v[204:207], v[140:143]
    v_exp_f32 v77, v77
    v_mfma_f32_16x16x32_bf16 v[124:127], v[32:35], v[200:203], v[124:127]
    s_waitcnt lgkmcnt(2)
    s_waitcnt vmcnt(13)
    buffer_load_dwordx2 v[60:61], v10, s[72:75], s36 offen offset:192
    v_mfma_f32_16x16x32_bf16 v[80:83], v[40:43], a[200:203], v[80:83]
    ds_read_b128 v[32:35], v2 offset:12544
    v_mfma_f32_16x16x32_bf16 v[80:83], v[44:47], a[204:207], v[80:83]
    buffer_load_dwordx2 v[62:63], v10, s[76:79], s36 offen offset:192
    v_mfma_f32_16x16x32_bf16 v[84:87], v[44:47], a[228:231], v[84:87]
    v_exp_f32 v78, v78
    v_mfma_f32_16x16x32_bf16 v[84:87], v[40:43], a[224:227], v[84:87]
    s_waitcnt vmcnt(14)
    buffer_load_dwordx4 v[240:243], v9, s[64:67], s33 offen offset:384 nt
    v_mfma_f32_16x16x32_bf16 v[88:91], v[40:43], a[248:251], v[88:91]
    ds_read_b128 v[36:39], v3 offset:12544
    v_mfma_f32_16x16x32_bf16 v[88:91], v[44:47], a[252:255], v[88:91]
    buffer_load_dwordx4 v[244:247], v9, s[64:67], s33 offen offset:1920 nt
    v_mfma_f32_16x16x32_bf16 v[92:95], v[44:47], v[212:215], v[92:95]
    v_exp_f32 v79, v79
    v_mfma_f32_16x16x32_bf16 v[92:95], v[40:43], v[208:211], v[92:95]
    s_waitcnt lgkmcnt(2)
    v_exp_f32 v108, v108
    v_mfma_f32_16x16x32_bf16 v[112:115], v[24:27], a[200:203], v[112:115]
    ds_read_b128 v[40:43], v2 offset:18688
    v_mfma_f32_16x16x32_bf16 v[112:115], v[28:31], a[204:207], v[112:115]
    s_waitcnt vmcnt(15)
    buffer_load_dwordx4 v[248:251], v9, s[64:67], s34 offen offset:384 nt
    v_mfma_f32_16x16x32_bf16 v[116:119], v[28:31], a[228:231], v[116:119]
    v_exp_f32 v109, v109
    v_mfma_f32_16x16x32_bf16 v[116:119], v[24:27], a[224:227], v[116:119]
    s_waitcnt vmcnt(15)
    buffer_load_dwordx4 v[252:255], v9, s[64:67], s34 offen offset:1920 nt
    v_mfma_f32_16x16x32_bf16 v[120:123], v[24:27], a[248:251], v[120:123]
    ds_read_b128 v[44:47], v3 offset:18688
    v_mfma_f32_16x16x32_bf16 v[120:123], v[28:31], a[252:255], v[120:123]
    s_waitcnt lgkmcnt(2)
    v_exp_f32 v110, v110
    v_mfma_f32_16x16x32_bf16 v[124:127], v[28:31], v[212:215], v[124:127]
    s_waitcnt vmcnt(15)
    v_exp_f32 v111, v111
    v_mfma_f32_16x16x32_bf16 v[124:127], v[24:27], v[208:211], v[124:127]
    s_barrier
    v_add_u32 v2, 49152, v2
    v_add_u32 v3, 49152, v3
    v_mfma_f32_16x16x32_bf16 v[80:83], v[32:35], a[208:211], v[80:83]
    s_mov_b32 m0, s26
    ds_read_b128 v[24:27], v2 offset:0
    v_add_f32 v8, v8, v76
    v_mfma_f32_16x16x32_bf16 v[80:83], v[36:39], a[212:215], v[80:83]
    buffer_load_dwordx4 v4, s[4:7], s32 offen offset:0 sc1 lds
    v_add_f32 v8, v8, v77
    v_mfma_f32_16x16x32_bf16 v[84:87], v[36:39], a[236:239], v[84:87]
    v_add_f32 v8, v8, v78
    v_add_f32 v8, v8, v79
    v_mfma_f32_16x16x32_bf16 v[84:87], v[32:35], a[232:235], v[84:87]
    s_waitcnt vmcnt(15)
    buffer_load_dwordx4 v4, s[4:7], s32 offen offset:1024 sc1 lds
    v_add_f32 v8, v8, v108
    v_mfma_f32_16x16x32_bf16 v[88:91], v[32:35], v[192:195], v[88:91]
    ds_read_b128 v[28:31], v3 offset:0
    v_add_f32 v8, v8, v109
    v_mfma_f32_16x16x32_bf16 v[88:91], v[36:39], v[196:199], v[88:91]
    s_waitcnt vmcnt(15)
    buffer_load_dwordx4 v4, s[4:7], s32 offen offset:2048 sc1 lds
    v_add_f32 v8, v8, v110
    v_mfma_f32_16x16x32_bf16 v[92:95], v[36:39], v[220:223], v[92:95]
    s_add_u32 s32, s32, 24576
    v_add_f32 v8, v8, v111
    v_cvt_pk_bf16_f32 v76, v76, v77
    v_mfma_f32_16x16x32_bf16 v[92:95], v[32:35], v[216:219], v[92:95]
    s_waitcnt lgkmcnt(2)
    v_cvt_pk_bf16_f32 v77, v78, v79
    v_cvt_pk_bf16_f32 v78, v108, v109
    v_mfma_f32_16x16x32_bf16 v[112:115], v[40:43], a[208:211], v[112:115]
    ds_read_b128 v[32:35], v2 offset:6144
    v_cvt_pk_bf16_f32 v79, v110, v111
    v_bfe_u32 v20, v4, 4, 6
    v_lshlrev_b32 v20, 2, v20
    v_xor_b32 v21, 16, v11
    v_xor_b32 v22, 32, v11
    v_xor_b32 v23, 48, v11
    v_mfma_f32_16x16x32_bf16 v[112:115], v[44:47], a[212:215], v[112:115]
    s_sub_u32 s57, s32, 196608
    s_min_u32 s32, s32, s57
    v_mfma_f32_16x16x32_bf16 v[116:119], v[44:47], a[236:239], v[116:119]
    s_add_u32 s26, s26, 12288
    s_mov_b32 m0, s26
    v_mfma_f32_16x16x32_bf16 v[116:119], v[40:43], a[232:235], v[116:119]
    s_waitcnt vmcnt(15)
    buffer_load_dwordx4 v4, s[4:7], s32 offen offset:0 sc1 lds
    v_mfma_f32_16x16x32_bf16 v[120:123], v[40:43], v[192:195], v[120:123]
    ds_read_b128 v[36:39], v3 offset:6144
    v_mfma_f32_16x16x32_bf16 v[120:123], v[44:47], v[196:199], v[120:123]
    s_waitcnt vmcnt(14)
    buffer_load_dwordx4 v4, s[4:7], s32 offen offset:1024 sc1 lds
    v_mfma_f32_16x16x32_bf16 v[124:127], v[44:47], v[220:223], v[124:127]
    s_waitcnt vmcnt(14)
    buffer_load_dwordx4 v4, s[4:7], s32 offen offset:2048 sc1 lds
    v_mfma_f32_16x16x32_bf16 v[124:127], v[40:43], v[216:219], v[124:127]
    s_waitcnt lgkmcnt(2)
    s_add_u32 s32, s32, 24576
    s_sub_u32 s57, s32, 196608
    s_min_u32 s32, s32, s57
    s_add_u32 s26, s26, 36864
    s_sub_u32 s57, s26, 147456
    s_min_u32 s26, s26, s57
    v_mfma_f32_16x16x32_bf16 v[160:163], v[24:27], a[192:195], v[128:131]
    s_mov_b32 m0, s56
    ds_read_b128 v[40:43], v2 offset:128
    v_mfma_f32_16x16x32_bf16 v[160:163], v[28:31], a[196:199], v[160:163]
    s_waitcnt vmcnt(13)
    buffer_load_dwordx4 v4, s[4:7], s27 offen offset:0 sc1 lds
    v_mfma_f32_16x16x32_bf16 v[164:167], v[28:31], a[220:223], v[132:135]
    v_exp_f32 v16, v80
    v_mfma_f32_16x16x32_bf16 v[164:167], v[24:27], a[216:219], v[164:167]
    s_waitcnt vmcnt(13)
    buffer_load_dwordx4 v4, s[4:7], s27 offen offset:1024 sc1 lds
    v_exp_f32 v17, v81
    v_exp_f32 v18, v82
    v_add_f32 v5, v5, v16
    v_add_f32 v5, v5, v17
    v_mfma_f32_16x16x32_bf16 v[168:171], v[24:27], a[240:243], v[136:139]
    ds_read_b128 v[44:47], v3 offset:128
    v_mfma_f32_16x16x32_bf16 v[168:171], v[28:31], a[244:247], v[168:171]
    s_waitcnt vmcnt(12)
    buffer_load_dwordx4 v4, s[4:7], s27 offen offset:2048 sc1 lds
    v_exp_f32 v19, v83
    v_cvt_pk_bf16_f32 v80, v16, v17
    v_mfma_f32_16x16x32_bf16 v[172:175], v[28:31], v[204:207], v[140:143]
    s_add_u32 s27, s27, 24576
    v_exp_f32 v16, v112
    v_mfma_f32_16x16x32_bf16 v[172:175], v[24:27], v[200:203], v[172:175]
    s_waitcnt lgkmcnt(2)
    v_add_f32 v5, v5, v18
    v_add_f32 v5, v5, v19
    v_exp_f32 v17, v113
    v_cvt_pk_bf16_f32 v81, v18, v19
    s_sub_u32 s58, s27, 196608
    v_mfma_f32_16x16x32_bf16 v[96:99], v[32:35], a[192:195], v[128:131]
    s_min_u32 s27, s27, s58
    ds_read_b128 v[24:27], v2 offset:6272
    s_add_u32 s56, s56, 12288
    v_mfma_f32_16x16x32_bf16 v[96:99], v[36:39], a[196:199], v[96:99]
    s_mov_b32 m0, s56
    v_exp_f32 v18, v114
    v_add_f32 v5, v5, v16
    v_add_f32 v5, v5, v17
    v_mfma_f32_16x16x32_bf16 v[100:103], v[36:39], a[220:223], v[132:135]
    v_exp_f32 v19, v115
    v_mfma_f32_16x16x32_bf16 v[100:103], v[32:35], a[216:219], v[100:103]
    s_waitcnt vmcnt(11)
    buffer_load_dwordx4 v4, s[4:7], s27 offen offset:0 sc1 lds
    v_cvt_pk_bf16_f32 v82, v16, v17
    v_exp_f32 v16, v84
    v_add_f32 v5, v5, v18
    v_mfma_f32_16x16x32_bf16 v[104:107], v[32:35], a[240:243], v[136:139]
    ds_read_b128 v[28:31], v3 offset:6272
    v_add_f32 v5, v5, v19
    v_mfma_f32_16x16x32_bf16 v[104:107], v[36:39], a[244:247], v[104:107]
    s_waitcnt vmcnt(11)
    buffer_load_dwordx4 v4, s[4:7], s27 offen offset:1024 sc1 lds
    v_exp_f32 v17, v85
    v_cvt_pk_bf16_f32 v83, v18, v19
    v_mfma_f32_16x16x32_bf16 v[108:111], v[36:39], v[204:207], v[140:143]
    v_exp_f32 v18, v86
    v_mfma_f32_16x16x32_bf16 v[108:111], v[32:35], v[200:203], v[108:111]
    s_waitcnt lgkmcnt(2)
    s_waitcnt vmcnt(11)
    buffer_load_dwordx4 v4, s[4:7], s27 offen offset:2048 sc1 lds
    v_add_f32 v6, v6, v16
    v_add_f32 v6, v6, v17
    v_exp_f32 v19, v87
    v_mfma_f32_16x16x32_bf16 v[160:163], v[40:43], a[200:203], v[160:163]
    ds_read_b128 v[32:35], v2 offset:256
    v_cvt_pk_bf16_f32 v84, v16, v17
    v_mfma_f32_16x16x32_bf16 v[160:163], v[44:47], a[204:207], v[160:163]
    v_exp_f32 v16, v116
    v_add_f32 v6, v6, v18
    v_add_f32 v6, v6, v19
    v_mfma_f32_16x16x32_bf16 v[164:167], v[44:47], a[228:231], v[164:167]
    v_exp_f32 v17, v117
    v_mfma_f32_16x16x32_bf16 v[164:167], v[40:43], a[224:227], v[164:167]
    s_add_u32 s27, s27, 24576
    v_cvt_pk_bf16_f32 v85, v18, v19
    v_exp_f32 v18, v118
    v_add_f32 v6, v6, v16
    v_add_f32 v6, v6, v17
    s_sub_u32 s58, s27, 196608
    v_mfma_f32_16x16x32_bf16 v[168:171], v[40:43], a[248:251], v[168:171]
    s_waitcnt vmcnt(18)
    ds_read_b128 v[36:39], v3 offset:256
    v_lshlrev_b32 v48, 16, v56
    v_mfma_f32_16x16x32_bf16 v[168:171], v[44:47], a[252:255], v[168:171]
    s_waitcnt vmcnt(11)
    buffer_load_dwordx3 v[144:146], v12, s[68:71], s35 offen offset:0 nt
    v_exp_f32 v19, v119
    v_cvt_pk_bf16_f32 v86, v16, v17
    v_mfma_f32_16x16x32_bf16 v[172:175], v[44:47], v[212:215], v[172:175]
    s_min_u32 s27, s27, s58
    v_add_f32 v6, v6, v18
    v_add_f32 v6, v6, v19
    v_mfma_f32_16x16x32_bf16 v[172:175], v[40:43], v[208:211], v[172:175]
    s_waitcnt lgkmcnt(2)
    s_waitcnt vmcnt(11)
    buffer_load_dwordx3 v[148:150], v12, s[68:71], s35 offen offset:768 nt
    v_cvt_pk_bf16_f32 v87, v18, v19
    v_exp_f32 v16, v88
    v_and_b32 v49, s97, v56
    v_mfma_f32_16x16x32_bf16 v[96:99], v[24:27], a[200:203], v[96:99]
    s_add_u32 s56, s56, 36864
    ds_read_b128 v[40:43], v2 offset:6400
    v_lshlrev_b32 v50, 16, v58
    v_mfma_f32_16x16x32_bf16 v[96:99], v[28:31], a[204:207], v[96:99]
    s_waitcnt vmcnt(11)
    buffer_load_dwordx3 v[152:154], v12, s[68:71], s35 offen offset:1536 nt
    v_exp_f32 v17, v89
    v_and_b32 v51, s97, v58
    v_mfma_f32_16x16x32_bf16 v[100:103], v[28:31], a[228:231], v[100:103]
    s_sub_u32 s58, s56, 147456
    v_exp_f32 v18, v90
    v_mfma_f32_16x16x32_bf16 v[100:103], v[24:27], a[224:227], v[100:103]
    buffer_load_dwordx3 v[156:158], v12, s[68:71], s35 offen offset:2304 nt
    v_add_f32 v7, v7, v16
    v_add_f32 v7, v7, v17
    v_mul_f32 v48, s38, v48
    v_mfma_f32_16x16x32_bf16 v[104:107], v[24:27], a[248:251], v[104:107]
    s_min_u32 s56, s56, s58
    ds_read_b128 v[44:47], v3 offset:6400
    v_mul_f32 v49, s38, v49
    v_mfma_f32_16x16x32_bf16 v[104:107], v[28:31], a[252:255], v[104:107]
    v_exp_f32 v19, v91
    v_cvt_pk_bf16_f32 v88, v16, v17
    v_exp_f32 v16, v120
    v_mfma_f32_16x16x32_bf16 v[108:111], v[28:31], v[212:215], v[108:111]
    v_add_f32 v7, v7, v18
    v_add_f32 v7, v7, v19
    v_mfma_f32_16x16x32_bf16 v[108:111], v[24:27], v[208:211], v[108:111]
    s_waitcnt lgkmcnt(2)
    v_exp_f32 v17, v121
    v_mul_f32_e64 v50, -v50, v48
    v_mul_f32_e64 v51, -v51, v49
    v_cvt_pk_bf16_f32 v89, v18, v19
    v_cvt_f32_i32 v224, v224
    v_mfma_f32_16x16x32_bf16 v[160:163], v[32:35], a[208:211], v[160:163]
    ds_read_b128 v[24:27], v2 offset:12288
    v_cvt_f32_i32 v225, v225
    v_mfma_f32_16x16x32_bf16 v[160:163], v[36:39], a[212:215], v[160:163]
    v_exp_f32 v18, v122
    v_fma_f32 v224, v224, v48, v50
    v_add_f32 v7, v7, v16
    v_fma_f32 v225, v225, v49, v51
    v_mfma_f32_16x16x32_bf16 v[164:167], v[36:39], a[236:239], v[164:167]
    v_add_f32 v7, v7, v17
    v_cvt_pk_bf16_f32 v224, v224, v225
    v_mfma_f32_16x16x32_bf16 v[164:167], v[32:35], a[232:235], v[164:167]
    v_exp_f32 v19, v123
    v_cvt_f32_i32 v228, v228
    v_cvt_f32_i32 v229, v229
    v_cvt_pk_bf16_f32 v90, v16, v17
    v_mfma_f32_16x16x32_bf16 v[168:171], v[32:35], v[192:195], v[168:171]
    ds_read_b128 v[28:31], v3 offset:12288
    v_fma_f32 v228, v228, v48, v50
    v_mfma_f32_16x16x32_bf16 v[168:171], v[36:39], v[196:199], v[168:171]
    v_exp_f32 v16, v92
    v_fma_f32 v229, v229, v49, v51
    v_cvt_pk_bf16_f32 v228, v228, v229
    v_add_f32 v7, v7, v18
    v_mfma_f32_16x16x32_bf16 v[172:175], v[36:39], v[220:223], v[172:175]
    v_cvt_f32_i32 v232, v232
    v_add_f32 v7, v7, v19
    v_mfma_f32_16x16x32_bf16 v[172:175], v[32:35], v[216:219], v[172:175]
    s_waitcnt lgkmcnt(2)
    v_exp_f32 v17, v93
    v_cvt_f32_i32 v233, v233
    v_fma_f32 v232, v232, v48, v50
    v_fma_f32 v233, v233, v49, v51
    v_cvt_pk_bf16_f32 v91, v18, v19
    v_mfma_f32_16x16x32_bf16 v[96:99], v[40:43], a[208:211], v[96:99]
    ds_read_b128 v[32:35], v2 offset:18432
    v_cvt_pk_bf16_f32 v232, v232, v233
    v_mfma_f32_16x16x32_bf16 v[96:99], v[44:47], a[212:215], v[96:99]
    v_exp_f32 v18, v94
    v_cvt_f32_i32 v236, v236
    v_cvt_f32_i32 v237, v237
    v_add_f32 v8, v8, v16
    v_mfma_f32_16x16x32_bf16 v[100:103], v[44:47], a[236:239], v[100:103]
    v_fma_f32 v236, v236, v48, v50
    v_add_f32 v8, v8, v17
    v_mfma_f32_16x16x32_bf16 v[100:103], v[40:43], a[232:235], v[100:103]
L_iw1:
L_pg1:
    s_cbranch_execz L_pg5
    v_exp_f32 v19, v95
    v_fma_f32 v237, v237, v49, v51
    v_cvt_pk_bf16_f32 v236, v236, v237
    v_lshlrev_b32 v48, 16, v57
    v_mfma_f32_16x16x32_bf16 v[104:107], v[40:43], v[192:195], v[104:107]
    ds_read_b128 v[36:39], v3 offset:18432
    v_cvt_pk_bf16_f32 v92, v16, v17
    v_mfma_f32_16x16x32_bf16 v[104:107], v[44:47], v[196:199], v[104:107]
    v_exp_f32 v16, v124
    v_and_b32 v49, s97, v57
    v_lshlrev_b32 v50, 16, v59
    v_and_b32 v51, s97, v59
    v_mfma_f32_16x16x32_bf16 v[108:111], v[44:47], v[220:223], v[108:111]
    v_add_f32 v8, v8, v18
    v_mul_f32 v48, s38, v48
    v_mfma_f32_16x16x32_bf16 v[108:111], v[40:43], v[216:219], v[108:111]
    s_waitcnt lgkmcnt(2)
    v_add_f32 v8, v8, v19
    v_mul_f32 v49, s38, v49
    v_exp_f32 v17, v125
    v_mul_f32_e64 v50, -v50, v48
    v_mul_f32_e64 v51, -v51, v49
    v_mfma_f32_16x16x32_bf16 v[176:179], v[24:27], a[192:195], v[128:131]
    ds_read_b128 v[40:43], v2 offset:12416
    v_cvt_pk_bf16_f32 v93, v18, v19
    v_mfma_f32_16x16x32_bf16 v[176:179], v[28:31], a[196:199], v[176:179]
    v_exp_f32 v18, v126
    v_cvt_f32_i32 v226, v226
    v_cvt_f32_i32 v227, v227
    v_fma_f32 v226, v226, v48, v50
    v_mfma_f32_16x16x32_bf16 v[180:183], v[28:31], a[220:223], v[132:135]
    v_add_f32 v8, v8, v16
    v_fma_f32 v227, v227, v49, v51
    v_mfma_f32_16x16x32_bf16 v[180:183], v[24:27], a[216:219], v[180:183]
    v_add_f32 v8, v8, v17
    v_cvt_pk_bf16_f32 v225, v226, v227
    v_exp_f32 v19, v127
    v_cvt_f32_i32 v230, v230
    v_mfma_f32_16x16x32_bf16 v[184:187], v[24:27], a[240:243], v[136:139]
    ds_read_b128 v[44:47], v3 offset:12416
    v_cvt_f32_i32 v231, v231
    v_mfma_f32_16x16x32_bf16 v[184:187], v[28:31], a[244:247], v[184:187]
    v_cvt_pk_bf16_f32 v94, v16, v17
    v_fma_f32 v230, v230, v48, v50
    v_add_f32 v8, v8, v18
    v_fma_f32 v231, v231, v49, v51
    v_cvt_pk_bf16_f32 v229, v230, v231
    v_mfma_f32_16x16x32_bf16 v[188:191], v[28:31], v[204:207], v[140:143]
    v_add_f32 v8, v8, v19
    v_cvt_pk_bf16_f32 v95, v18, v19
    v_mfma_f32_16x16x32_bf16 v[188:191], v[24:27], v[200:203], v[188:191]
    s_waitcnt lgkmcnt(2)
    v_cvt_f32_i32 v234, v234
    v_cvt_f32_i32 v235, v235
    v_exp_f32 v16, v160
    v_fma_f32 v234, v234, v48, v50
    v_fma_f32 v235, v235, v49, v51
    v_mfma_f32_16x16x32_bf16 v[112:115], v[32:35], a[192:195], v[128:131]
    ds_read_b128 v[24:27], v2 offset:18560
    v_cvt_pk_bf16_f32 v233, v234, v235
    v_mfma_f32_16x16x32_bf16 v[112:115], v[36:39], a[196:199], v[112:115]
    v_exp_f32 v17, v161
    v_exp_f32 v18, v162
    v_add_f32 v5, v5, v16
    v_mfma_f32_16x16x32_bf16 v[116:119], v[36:39], a[220:223], v[132:135]
    v_cvt_f32_i32 v238, v238
    v_cvt_f32_i32 v239, v239
    v_mfma_f32_16x16x32_bf16 v[116:119], v[32:35], a[216:219], v[116:119]
    v_fma_f32 v238, v238, v48, v50
    v_add_f32 v5, v5, v17
    v_exp_f32 v19, v163
    v_cvt_pk_bf16_f32 v160, v16, v17
    v_mfma_f32_16x16x32_bf16 v[120:123], v[32:35], a[240:243], v[136:139]
    ds_read_b128 v[28:31], v3 offset:18560
    v_fma_f32 v239, v239, v49, v51
    v_cvt_pk_bf16_f32 v237, v238, v239
    v_mfma_f32_16x16x32_bf16 v[120:123], v[36:39], a[244:247], v[120:123]
    s_waitcnt vmcnt(16)
    v_lshlrev_b32 v48, 16, v60
    v_and_b32 v49, s97, v60
    v_lshlrev_b32 v50, 16, v62
    v_and_b32 v51, s97, v62
    v_mul_f32 v48, s38, v48
    v_mfma_f32_16x16x32_bf16 v[124:127], v[36:39], v[204:207], v[140:143]
    v_mul_f32 v49, s38, v49
    v_mul_f32_e64 v50, -v50, v48
    v_mfma_f32_16x16x32_bf16 v[124:127], v[32:35], v[200:203], v[124:127]
    s_waitcnt lgkmcnt(2)
    s_waitcnt vmcnt(12)
    buffer_load_dwordx2 v[56:57], off, s[80:83], s37 offset:0
    v_mul_f32_e64 v51, -v51, v49
    v_cvt_f32_i32 v240, v240
    v_cvt_f32_i32 v241, v241
    v_mfma_f32_16x16x32_bf16 v[176:179], v[40:43], a[200:203], v[176:179]
    ds_read_b128 v[32:35], v2 offset:12544
    v_fma_f32 v240, v240, v48, v50
    v_mfma_f32_16x16x32_bf16 v[176:179], v[44:47], a[204:207], v[176:179]
    buffer_load_dwordx2 v[58:59], off, s[84:87], s37 offset:0
    v_exp_f32 v16, v96
    v_fma_f32 v241, v241, v49, v51
    v_mfma_f32_16x16x32_bf16 v[180:183], v[44:47], a[228:231], v[180:183]
    v_cvt_pk_bf16_f32 v226, v240, v241
    v_add_f32 v5, v5, v18
    v_mfma_f32_16x16x32_bf16 v[180:183], v[40:43], a[224:227], v[180:183]
    v_cvt_f32_i32 v244, v244
    v_add_f32 v5, v5, v19
    v_cvt_f32_i32 v245, v245
    v_exp_f32 v17, v97
    v_fma_f32 v244, v244, v48, v50
    v_mfma_f32_16x16x32_bf16 v[184:187], v[40:43], a[248:251], v[184:187]
    ds_read_b128 v[36:39], v3 offset:12544
    v_fma_f32 v245, v245, v49, v51
    v_mfma_f32_16x16x32_bf16 v[184:187], v[44:47], a[252:255], v[184:187]
    v_cvt_pk_bf16_f32 v161, v18, v19
    v_cvt_pk_bf16_f32 v230, v244, v245
    v_exp_f32 v18, v98
    v_cvt_f32_i32 v248, v248
    v_mfma_f32_16x16x32_bf16 v[188:191], v[44:47], v[212:215], v[188:191]
    v_cvt_f32_i32 v249, v249
    v_add_f32 v5, v5, v16
    v_mfma_f32_16x16x32_bf16 v[188:191], v[40:43], v[208:211], v[188:191]
    s_waitcnt lgkmcnt(2)
    v_fma_f32 v248, v248, v48, v50
    v_add_f32 v5, v5, v17
    v_fma_f32 v249, v249, v49, v51
    v_exp_f32 v19, v99
    v_mfma_f32_16x16x32_bf16 v[112:115], v[24:27], a[200:203], v[112:115]
    ds_read_b128 v[40:43], v2 offset:18688
    v_cvt_pk_bf16_f32 v234, v248, v249
    v_mfma_f32_16x16x32_bf16 v[112:115], v[28:31], a[204:207], v[112:115]
    v_cvt_f32_i32 v252, v252
    v_cvt_pk_bf16_f32 v162, v16, v17
    v_cvt_f32_i32 v253, v253
    v_exp_f32 v16, v164
    v_mfma_f32_16x16x32_bf16 v[116:119], v[28:31], a[228:231], v[116:119]
    v_fma_f32 v252, v252, v48, v50
    v_fma_f32 v253, v253, v49, v51
    v_mfma_f32_16x16x32_bf16 v[116:119], v[24:27], a[224:227], v[116:119]
    v_add_f32 v5, v5, v18
    v_cvt_pk_bf16_f32 v238, v252, v253
    v_add_f32 v5, v5, v19
    v_lshlrev_b32 v48, 16, v61
    v_exp_f32 v17, v165
    v_mfma_f32_16x16x32_bf16 v[120:123], v[24:27], a[248:251], v[120:123]
    ds_read_b128 v[44:47], v3 offset:18688
    v_and_b32 v49, s97, v61
    v_mfma_f32_16x16x32_bf16 v[120:123], v[28:31], a[252:255], v[120:123]
    s_waitcnt lgkmcnt(2)
    v_lshlrev_b32 v50, 16, v63
    v_cvt_pk_bf16_f32 v163, v18, v19
    v_and_b32 v51, s97, v63
    v_exp_f32 v18, v166
    v_mfma_f32_16x16x32_bf16 v[124:127], v[28:31], v[212:215], v[124:127]
    s_waitcnt vmcnt(30)
    v_mul_f32 v48, s38, v48
    v_mul_f32 v49, s38, v49
    v_mfma_f32_16x16x32_bf16 v[124:127], v[24:27], v[208:211], v[124:127]
    s_barrier
    v_add_f32 v6, v6, v16
    v_mul_f32_e64 v50, -v50, v48
    v_add_f32 v6, v6, v17
    v_mul_f32_e64 v51, -v51, v49
    v_mfma_f32_16x16x32_bf16 v[176:179], v[32:35], a[208:211], v[176:179]
    ds_read_b128 v[24:27], v1 offset:0
    v_cvt_f32_i32 v242, v242
    v_mfma_f32_16x16x32_bf16 v[176:179], v[36:39], a[212:215], v[176:179]
    v_exp_f32 v19, v167
    v_cvt_f32_i32 v243, v243
    v_cvt_pk_bf16_f32 v164, v16, v17
    v_fma_f32 v242, v242, v48, v50
    v_mfma_f32_16x16x32_bf16 v[180:183], v[36:39], a[236:239], v[180:183]
    v_exp_f32 v16, v100
    v_mfma_f32_16x16x32_bf16 v[180:183], v[32:35], a[232:235], v[180:183]
    v_fma_f32 v243, v243, v49, v51
    v_cvt_pk_bf16_f32 v227, v242, v243
    v_add_f32 v6, v6, v18
    v_cvt_f32_i32 v246, v246
    v_add_f32 v6, v6, v19
    v_cvt_f32_i32 v247, v247
    v_mfma_f32_16x16x32_bf16 v[184:187], v[32:35], v[192:195], v[184:187]
    ds_read_b128 v[28:31], v1 offset:12288
    v_fma_f32 v246, v246, v48, v50
    v_mfma_f32_16x16x32_bf16 v[184:187], v[36:39], v[196:199], v[184:187]
    v_exp_f32 v17, v101
    v_fma_f32 v247, v247, v49, v51
    v_cvt_pk_bf16_f32 v165, v18, v19
    v_cvt_pk_bf16_f32 v231, v246, v247
    v_mfma_f32_16x16x32_bf16 v[188:191], v[36:39], v[220:223], v[188:191]
    v_exp_f32 v18, v102
    v_mfma_f32_16x16x32_bf16 v[188:191], v[32:35], v[216:219], v[188:191]
    s_waitcnt lgkmcnt(2)
    v_cvt_f32_i32 v250, v250
    v_cvt_f32_i32 v251, v251
    v_add_f32 v6, v6, v16
    v_fma_f32 v250, v250, v48, v50
    v_add_f32 v6, v6, v17
    v_mfma_f32_16x16x32_bf16 v[112:115], v[40:43], a[208:211], v[112:115]
    ds_read_b128 v[32:35], v1 offset:1024
    v_fma_f32 v251, v251, v49, v51
    v_mfma_f32_16x16x32_bf16 v[112:115], v[44:47], a[212:215], v[112:115]
    v_exp_f32 v19, v103
    v_cvt_pk_bf16_f32 v235, v250, v251
    v_cvt_f32_i32 v254, v254
    v_cvt_pk_bf16_f32 v166, v16, v17
    v_mfma_f32_16x16x32_bf16 v[116:119], v[44:47], a[236:239], v[116:119]
    v_cvt_f32_i32 v255, v255
    v_add_f32 v6, v6, v18
    v_mfma_f32_16x16x32_bf16 v[116:119], v[40:43], a[232:235], v[116:119]
    v_fma_f32 v254, v254, v48, v50
    v_add_f32 v6, v6, v19
    v_fma_f32 v255, v255, v49, v51
    v_cvt_pk_bf16_f32 v167, v18, v19
    v_cvt_pk_bf16_f32 v239, v254, v255
    v_mfma_f32_16x16x32_bf16 v[120:123], v[40:43], v[192:195], v[120:123]
    ds_read_b128 v[36:39], v1 offset:13312
    v_mfma_f32_16x16x32_bf16 v[120:123], v[44:47], v[196:199], v[120:123]
    v_mfma_f32_16x16x32_bf16 v[124:127], v[44:47], v[220:223], v[124:127]
    v_mfma_f32_16x16x32_bf16 v[124:127], v[40:43], v[216:219], v[124:127]
    s_waitcnt lgkmcnt(2)
    v_mfma_f32_16x16x32_bf16 a[144:147], v[76:79], v[24:27], 0
    ds_read_b128 v[40:43], v1 offset:2048
    v_mfma_f32_16x16x32_bf16 a[144:147], v[92:95], v[28:31], a[144:147]
    buffer_store_dwordx4 v[224:227], v11, s[4:7], s33 offen offset:0 sc1
    v_mfma_f32_16x16x32_bf16 a[96:99], v[72:75], v[24:27], 0
    v_exp_f32 v16, v168
    v_mfma_f32_16x16x32_bf16 a[96:99], v[88:91], v[28:31], a[96:99]
    ds_read_b128 v[44:47], v1 offset:14336
    v_mfma_f32_16x16x32_bf16 a[0:3], v[80:83], v[28:31], a[0:3]
    v_exp_f32 v17, v169
    v_mfma_f32_16x16x32_bf16 a[48:51], v[84:87], v[28:31], a[48:51]
    s_waitcnt lgkmcnt(2)
    v_exp_f32 v18, v170
    v_mfma_f32_16x16x32_bf16 a[148:151], v[76:79], v[32:35], 0
    ds_read_b128 v[24:27], v1 offset:3072
    v_add_f32 v7, v7, v16
    v_mfma_f32_16x16x32_bf16 a[148:151], v[92:95], v[36:39], a[148:151]
    v_add_f32 v7, v7, v17
    v_mfma_f32_16x16x32_bf16 a[100:103], v[72:75], v[32:35], 0
    v_exp_f32 v19, v171
    v_mfma_f32_16x16x32_bf16 a[100:103], v[88:91], v[36:39], a[100:103]
    ds_read_b128 v[28:31], v1 offset:15360
    v_cvt_pk_bf16_f32 v168, v16, v17
    v_mfma_f32_16x16x32_bf16 a[4:7], v[80:83], v[36:39], a[4:7]
    v_exp_f32 v16, v104
    v_mfma_f32_16x16x32_bf16 a[52:55], v[84:87], v[36:39], a[52:55]
    s_waitcnt lgkmcnt(2)
    v_add_f32 v7, v7, v18
    v_add_f32 v7, v7, v19
    v_mfma_f32_16x16x32_bf16 a[152:155], v[76:79], v[40:43], 0
    ds_read_b128 v[32:35], v1 offset:4096
    v_mfma_f32_16x16x32_bf16 a[152:155], v[92:95], v[44:47], a[152:155]
    buffer_store_dwordx4 v[228:231], v21, s[4:7], s33 offen offset:768 sc1
    v_mfma_f32_16x16x32_bf16 a[104:107], v[72:75], v[40:43], 0
    v_exp_f32 v17, v105
    v_mfma_f32_16x16x32_bf16 a[104:107], v[88:91], v[44:47], a[104:107]
    ds_read_b128 v[36:39], v1 offset:16384
    v_cvt_pk_bf16_f32 v169, v18, v19
    v_mfma_f32_16x16x32_bf16 a[8:11], v[80:83], v[44:47], a[8:11]
    v_exp_f32 v18, v106
    v_mfma_f32_16x16x32_bf16 a[56:59], v[84:87], v[44:47], a[56:59]
    s_waitcnt lgkmcnt(2)
    v_add_f32 v7, v7, v16
    v_add_f32 v7, v7, v17
    v_mfma_f32_16x16x32_bf16 a[156:159], v[76:79], v[24:27], 0
    ds_read_b128 v[40:43], v1 offset:5120
    v_mfma_f32_16x16x32_bf16 a[156:159], v[92:95], v[28:31], a[156:159]
    v_exp_f32 v19, v107
    v_cvt_pk_bf16_f32 v170, v16, v17
    v_mfma_f32_16x16x32_bf16 a[108:111], v[72:75], v[24:27], 0
    v_exp_f32 v16, v172
    v_mfma_f32_16x16x32_bf16 a[108:111], v[88:91], v[28:31], a[108:111]
    ds_read_b128 v[44:47], v1 offset:17408
    v_add_f32 v7, v7, v18
    v_add_f32 v7, v7, v19
    v_mfma_f32_16x16x32_bf16 a[12:15], v[80:83], v[28:31], a[12:15]
    v_exp_f32 v17, v173
    v_mfma_f32_16x16x32_bf16 a[60:63], v[84:87], v[28:31], a[60:63]
    s_waitcnt lgkmcnt(2)
    v_cvt_pk_bf16_f32 v171, v18, v19
    v_mfma_f32_16x16x32_bf16 a[160:163], v[76:79], v[32:35], 0
    ds_read_b128 v[24:27], v1 offset:6144
    v_mfma_f32_16x16x32_bf16 a[160:163], v[92:95], v[36:39], a[160:163]
    buffer_store_dwordx4 v[232:235], v22, s[4:7], s33 offen offset:1536 sc1
    v_mfma_f32_16x16x32_bf16 a[112:115], v[72:75], v[32:35], 0
    v_exp_f32 v18, v174
    v_mfma_f32_16x16x32_bf16 a[112:115], v[88:91], v[36:39], a[112:115]
    ds_read_b128 v[28:31], v1 offset:18432
    v_add_f32 v8, v8, v16
    v_add_f32 v8, v8, v17
    v_mfma_f32_16x16x32_bf16 a[16:19], v[80:83], v[36:39], a[16:19]
    v_exp_f32 v19, v175
    v_mfma_f32_16x16x32_bf16 a[64:67], v[84:87], v[36:39], a[64:67]
    s_waitcnt lgkmcnt(2)
    v_cvt_pk_bf16_f32 v172, v16, v17
    v_exp_f32 v16, v108
    v_mfma_f32_16x16x32_bf16 a[164:167], v[76:79], v[40:43], 0
    ds_read_b128 v[32:35], v1 offset:7168
    v_add_f32 v8, v8, v18
    v_mfma_f32_16x16x32_bf16 a[164:167], v[92:95], v[44:47], a[164:167]
    v_add_f32 v8, v8, v19
    v_exp_f32 v17, v109
    v_mfma_f32_16x16x32_bf16 a[116:119], v[72:75], v[40:43], 0
    v_cvt_pk_bf16_f32 v173, v18, v19
    v_mfma_f32_16x16x32_bf16 a[116:119], v[88:91], v[44:47], a[116:119]
    ds_read_b128 v[36:39], v1 offset:19456
    v_exp_f32 v18, v110
    v_mfma_f32_16x16x32_bf16 a[20:23], v[80:83], v[44:47], a[20:23]
    v_add_f32 v8, v8, v16
    v_add_f32 v8, v8, v17
    v_mfma_f32_16x16x32_bf16 a[68:71], v[84:87], v[44:47], a[68:71]
    s_waitcnt lgkmcnt(2)
    v_exp_f32 v19, v111
    v_mfma_f32_16x16x32_bf16 a[168:171], v[76:79], v[24:27], 0
    ds_read_b128 v[40:43], v1 offset:8192
    v_cvt_pk_bf16_f32 v174, v16, v17
    v_mfma_f32_16x16x32_bf16 a[168:171], v[92:95], v[28:31], a[168:171]
    buffer_store_dwordx4 v[236:239], v23, s[4:7], s33 offen offset:2304 sc1
    v_mfma_f32_16x16x32_bf16 a[120:123], v[72:75], v[24:27], 0
    v_add_f32 v8, v8, v18
    v_add_f32 v8, v8, v19
    v_mfma_f32_16x16x32_bf16 a[120:123], v[88:91], v[28:31], a[120:123]
    ds_read_b128 v[44:47], v1 offset:20480
    v_cvt_pk_bf16_f32 v175, v18, v19
    v_mfma_f32_16x16x32_bf16 a[24:27], v[80:83], v[28:31], a[24:27]
    v_exp_f32 v16, v176
    v_mfma_f32_16x16x32_bf16 a[72:75], v[84:87], v[28:31], a[72:75]
    s_waitcnt lgkmcnt(2)
    v_exp_f32 v17, v177
    v_mfma_f32_16x16x32_bf16 a[172:175], v[76:79], v[32:35], 0
    ds_read_b128 v[24:27], v1 offset:9216
    v_mfma_f32_16x16x32_bf16 a[172:175], v[92:95], v[36:39], a[172:175]
    v_exp_f32 v18, v178
    v_add_f32 v5, v5, v16
    v_mfma_f32_16x16x32_bf16 a[124:127], v[72:75], v[32:35], 0
    v_add_f32 v5, v5, v17
    v_mfma_f32_16x16x32_bf16 a[124:127], v[88:91], v[36:39], a[124:127]
    ds_read_b128 v[28:31], v1 offset:21504
    v_exp_f32 v19, v179
    v_mfma_f32_16x16x32_bf16 a[28:31], v[80:83], v[36:39], a[28:31]
    v_cvt_pk_bf16_f32 v176, v16, v17
    v_mfma_f32_16x16x32_bf16 a[76:79], v[84:87], v[36:39], a[76:79]
    s_waitcnt lgkmcnt(2)
    buffer_load_dwordx2 v[60:61], off, s[80:83], s37 offset:8
    v_mfma_f32_16x16x32_bf16 a[176:179], v[76:79], v[40:43], 0
    ds_read_b128 v[32:35], v1 offset:10240
    v_mfma_f32_16x16x32_bf16 a[176:179], v[92:95], v[44:47], a[176:179]
    buffer_load_dwordx2 v[62:63], off, s[84:87], s37 offset:8
    v_mfma_f32_16x16x32_bf16 a[128:131], v[72:75], v[40:43], 0
    v_exp_f32 v16, v112
    v_mfma_f32_16x16x32_bf16 a[128:131], v[88:91], v[44:47], a[128:131]
    ds_read_b128 v[36:39], v1 offset:22528
    v_add_f32 v5, v5, v18
    v_add_f32 v5, v5, v19
    v_mfma_f32_16x16x32_bf16 a[32:35], v[80:83], v[44:47], a[32:35]
    v_exp_f32 v17, v113
    v_mfma_f32_16x16x32_bf16 a[80:83], v[84:87], v[44:47], a[80:83]
    s_waitcnt lgkmcnt(2)
    s_waitcnt vmcnt(19)
    buffer_load_dwordx3 v[240:242], v12, s[68:71], s16 offen offset:0 nt
    v_cvt_pk_bf16_f32 v177, v18, v19
    v_mfma_f32_16x16x32_bf16 a[180:183], v[76:79], v[24:27], 0
    ds_read_b128 v[40:43], v1 offset:11264
    v_mfma_f32_16x16x32_bf16 a[180:183], v[92:95], v[28:31], a[180:183]
    buffer_load_dwordx3 v[244:246], v12, s[68:71], s16 offen offset:768 nt
    v_mfma_f32_16x16x32_bf16 a[132:135], v[72:75], v[24:27], 0
    v_exp_f32 v18, v114
    v_mfma_f32_16x16x32_bf16 a[132:135], v[88:91], v[28:31], a[132:135]
    s_waitcnt vmcnt(20)
    ds_read_b128 v[44:47], v1 offset:23552
    v_add_f32 v5, v5, v16
    v_add_f32 v5, v5, v17
    v_mfma_f32_16x16x32_bf16 a[36:39], v[80:83], v[28:31], a[36:39]
    v_exp_f32 v19, v115
    v_mfma_f32_16x16x32_bf16 a[84:87], v[84:87], v[28:31], a[84:87]
    s_waitcnt lgkmcnt(2)
    s_barrier
    v_add_u32 v2, 49152, v2
    v_add_u32 v3, 49152, v3
    v_mfma_f32_16x16x32_bf16 a[184:187], v[76:79], v[32:35], 0
    ds_read_b128 v[24:27], v2 offset:0
    v_cvt_pk_bf16_f32 v178, v16, v17
    v_mfma_f32_16x16x32_bf16 a[184:187], v[92:95], v[36:39], a[184:187]
    buffer_load_dwordx3 v[248:250], v12, s[68:71], s16 offen offset:1536 nt
    v_mfma_f32_16x16x32_bf16 a[136:139], v[72:75], v[32:35], 0
    v_exp_f32 v16, v180
    v_mfma_f32_16x16x32_bf16 a[136:139], v[88:91], v[36:39], a[136:139]
    ds_read_b128 v[28:31], v3 offset:0
    v_add_f32 v5, v5, v18
    v_add_f32 v5, v5, v19
    v_mfma_f32_16x16x32_bf16 a[40:43], v[80:83], v[36:39], a[40:43]
    v_exp_f32 v17, v181
    v_mfma_f32_16x16x32_bf16 a[88:91], v[84:87], v[36:39], a[88:91]
    s_waitcnt lgkmcnt(2)
    s_waitcnt vmcnt(20)
    buffer_load_dwordx3 v[252:254], v12, s[68:71], s16 offen offset:2304 nt
    v_cvt_pk_bf16_f32 v179, v18, v19
    v_mfma_f32_16x16x32_bf16 a[188:191], v[76:79], v[40:43], 0
    ds_read_b128 v[32:35], v2 offset:6144
    v_mfma_f32_16x16x32_bf16 a[188:191], v[92:95], v[44:47], a[188:191]
    v_exp_f32 v18, v182
    v_add_f32 v6, v6, v16
    v_mfma_f32_16x16x32_bf16 a[140:143], v[72:75], v[40:43], 0
    v_add_f32 v6, v6, v17
    v_mfma_f32_16x16x32_bf16 a[140:143], v[88:91], v[44:47], a[140:143]
    ds_read_b128 v[36:39], v3 offset:6144
    v_exp_f32 v19, v183
    v_mfma_f32_16x16x32_bf16 a[44:47], v[80:83], v[44:47], a[44:47]
    v_cvt_pk_bf16_f32 v180, v16, v17
    v_mfma_f32_16x16x32_bf16 a[92:95], v[84:87], v[44:47], a[92:95]
    s_waitcnt lgkmcnt(2)
    v_exp_f32 v16, v116
    v_add_f32 v6, v6, v18
    v_add_f32 v6, v6, v19
    v_exp_f32 v17, v117
    v_cvt_pk_bf16_f32 v181, v18, v19
    v_exp_f32 v18, v118
    v_add_f32 v6, v6, v16
    v_add_f32 v6, v6, v17
    v_exp_f32 v19, v119
    v_cvt_pk_bf16_f32 v182, v16, v17
    v_add_f32 v6, v6, v18
    v_add_f32 v6, v6, v19
    v_cvt_pk_bf16_f32 v183, v18, v19
    v_mfma_f32_16x16x32_bf16 v[64:67], v[24:27], a[192:195], v[128:131]
    s_waitcnt vmcnt(10)
    ds_read_b128 v[40:43], v2 offset:128
    v_lshlrev_b32 v48, 16, v56
    v_mfma_f32_16x16x32_bf16 v[64:67], v[28:31], a[196:199], v[64:67]
    v_exp_f32 v16, v184
    v_mfma_f32_16x16x32_bf16 v[68:71], v[28:31], a[220:223], v[132:135]
    v_exp_f32 v17, v185
    v_mfma_f32_16x16x32_bf16 v[68:71], v[24:27], a[216:219], v[68:71]
    v_exp_f32 v18, v186
    v_mfma_f32_16x16x32_bf16 v[72:75], v[24:27], a[240:243], v[136:139]
    ds_read_b128 v[44:47], v3 offset:128
    v_and_b32 v49, s97, v56
    v_mfma_f32_16x16x32_bf16 v[72:75], v[28:31], a[244:247], v[72:75]
    v_add_f32 v7, v7, v16
    v_add_f32 v7, v7, v17
    v_mfma_f32_16x16x32_bf16 v[76:79], v[28:31], v[204:207], v[140:143]
    v_exp_f32 v19, v187
    v_mfma_f32_16x16x32_bf16 v[76:79], v[24:27], v[200:203], v[76:79]
    s_waitcnt lgkmcnt(2)
    v_lshlrev_b32 v50, 16, v58
    v_and_b32 v51, s97, v58
    v_mfma_f32_16x16x32_bf16 v[96:99], v[32:35], a[192:195], v[128:131]
    ds_read_b128 v[24:27], v2 offset:6272
    v_cvt_pk_bf16_f32 v184, v16, v17
    v_mfma_f32_16x16x32_bf16 v[96:99], v[36:39], a[196:199], v[96:99]
    v_exp_f32 v16, v120
    v_mfma_f32_16x16x32_bf16 v[100:103], v[36:39], a[220:223], v[132:135]
    v_mul_f32_e64 v50, -v50, v48
    v_add_f32 v7, v7, v18
    v_mfma_f32_16x16x32_bf16 v[100:103], v[32:35], a[216:219], v[100:103]
    v_add_f32 v7, v7, v19
    v_mul_f32_e64 v51, -v51, v49
    v_mfma_f32_16x16x32_bf16 v[104:107], v[32:35], a[240:243], v[136:139]
    ds_read_b128 v[28:31], v3 offset:6272
    v_cvt_f32_i32 v144, v144
    v_mfma_f32_16x16x32_bf16 v[104:107], v[36:39], a[244:247], v[104:107]
    s_waitcnt lgkmcnt(2)
    v_exp_f32 v17, v121
    v_mfma_f32_16x16x32_bf16 v[108:111], v[36:39], v[204:207], v[140:143]
    s_waitcnt vmcnt(6)
    v_cvt_pk_bf16_f32 v185, v18, v19
    v_cvt_f32_i32 v148, v148
    v_mfma_f32_16x16x32_bf16 v[108:111], v[32:35], v[200:203], v[108:111]
    s_barrier
    v_mfma_f32_16x16x32_bf16 v[64:67], v[40:43], a[200:203], v[64:67]
    ds_read_b128 v[32:35], v2 offset:256
    v_add_u32 v0, 1, v0
    v_mfma_f32_16x16x32_bf16 v[64:67], v[44:47], a[204:207], v[64:67]
    buffer_store_dword v0, v13, s[20:23], 0 offen offset:32 sc1
    v_mfma_f32_16x16x32_bf16 v[68:71], v[44:47], a[228:231], v[68:71]
    s_mov_b32 m0, s26
    v_exp_f32 v18, v122
    v_mfma_f32_16x16x32_bf16 v[68:71], v[40:43], a[224:227], v[68:71]
    v_add_f32 v7, v7, v16
    v_add_f32 v7, v7, v17
    v_mfma_f32_16x16x32_bf16 v[72:75], v[40:43], a[248:251], v[72:75]
    ds_read_b128 v[36:39], v3 offset:256
    v_fma_f32 v144, v144, v48, v50
    v_mfma_f32_16x16x32_bf16 v[72:75], v[44:47], a[252:255], v[72:75]
    buffer_load_dwordx4 v4, s[4:7], s32 offen offset:0 sc1 lds
    v_mfma_f32_16x16x32_bf16 v[76:79], v[44:47], v[212:215], v[76:79]
    v_exp_f32 v19, v123
    v_mfma_f32_16x16x32_bf16 v[76:79], v[40:43], v[208:211], v[76:79]
    s_waitcnt lgkmcnt(2)
    v_cvt_pk_bf16_f32 v186, v16, v17
    v_fma_f32 v148, v148, v49, v51
    v_mfma_f32_16x16x32_bf16 v[96:99], v[24:27], a[200:203], v[96:99]
    ds_read_b128 v[40:43], v2 offset:6400
    v_cvt_f32_i32 v145, v145
    v_mfma_f32_16x16x32_bf16 v[96:99], v[28:31], a[204:207], v[96:99]
    buffer_load_dwordx4 v4, s[4:7], s32 offen offset:1024 sc1 lds
    v_mfma_f32_16x16x32_bf16 v[100:103], v[28:31], a[228:231], v[100:103]
    v_exp_f32 v16, v188
    v_mfma_f32_16x16x32_bf16 v[100:103], v[24:27], a[224:227], v[100:103]
    v_add_f32 v7, v7, v18
    v_add_f32 v7, v7, v19
    v_mfma_f32_16x16x32_bf16 v[104:107], v[24:27], a[248:251], v[104:107]
    ds_read_b128 v[44:47], v3 offset:6400
    v_cvt_f32_i32 v149, v149
    v_mfma_f32_16x16x32_bf16 v[104:107], v[28:31], a[252:255], v[104:107]
    buffer_load_dwordx4 v4, s[4:7], s32 offen offset:2048 sc1 lds
    v_mfma_f32_16x16x32_bf16 v[108:111], v[28:31], v[212:215], v[108:111]
    s_add_u32 s32, s32, 24576
    v_exp_f32 v17, v189
    v_mfma_f32_16x16x32_bf16 v[108:111], v[24:27], v[208:211], v[108:111]
    s_waitcnt lgkmcnt(2)
    v_cvt_pk_bf16_f32 v187, v18, v19
    v_fma_f32 v145, v145, v48, v50
    v_mfma_f32_16x16x32_bf16 v[64:67], v[32:35], a[208:211], v[64:67]
    s_sub_u32 s57, s32, 196608
    ds_read_b128 v[24:27], v2 offset:12288
    v_fma_f32 v149, v149, v49, v51
    v_mfma_f32_16x16x32_bf16 v[64:67], v[36:39], a[212:215], v[64:67]
    s_min_u32 s32, s32, s57
    v_exp_f32 v18, v190
    v_mfma_f32_16x16x32_bf16 v[68:71], v[36:39], a[236:239], v[68:71]
    s_add_u32 s26, s26, 12288
    v_add_f32 v8, v8, v16
    v_add_f32 v8, v8, v17
    v_mfma_f32_16x16x32_bf16 v[68:71], v[32:35], a[232:235], v[68:71]
    s_mov_b32 m0, s26
    v_exp_f32 v19, v191
    v_mfma_f32_16x16x32_bf16 v[72:75], v[32:35], v[192:195], v[72:75]
    ds_read_b128 v[28:31], v3 offset:12288
    v_cvt_pk_bf16_f32 v188, v16, v17
    v_mfma_f32_16x16x32_bf16 v[72:75], v[36:39], v[196:199], v[72:75]
    v_exp_f32 v16, v124
    v_mfma_f32_16x16x32_bf16 v[76:79], v[36:39], v[220:223], v[76:79]
    v_add_f32 v8, v8, v18
    v_add_f32 v8, v8, v19
    v_mfma_f32_16x16x32_bf16 v[76:79], v[32:35], v[216:219], v[76:79]
    s_waitcnt lgkmcnt(2)
    buffer_load_dwordx4 v4, s[4:7], s32 offen offset:0 sc1 lds
    v_mfma_f32_16x16x32_bf16 v[96:99], v[40:43], a[208:211], v[96:99]
    ds_read_b128 v[32:35], v2 offset:18432
    v_cvt_f32_i32 v146, v146
    v_mfma_f32_16x16x32_bf16 v[96:99], v[44:47], a[212:215], v[96:99]
    v_exp_f32 v17, v125
    v_mfma_f32_16x16x32_bf16 v[100:103], v[44:47], a[236:239], v[100:103]
    v_cvt_pk_bf16_f32 v189, v18, v19
    v_cvt_f32_i32 v150, v150
    v_mfma_f32_16x16x32_bf16 v[100:103], v[40:43], a[232:235], v[100:103]
    buffer_load_dwordx4 v4, s[4:7], s32 offen offset:1024 sc1 lds
    v_mfma_f32_16x16x32_bf16 v[104:107], v[40:43], v[192:195], v[104:107]
    ds_read_b128 v[36:39], v3 offset:18432
    v_fma_f32 v146, v146, v48, v50
    v_mfma_f32_16x16x32_bf16 v[104:107], v[44:47], v[196:199], v[104:107]
    v_exp_f32 v18, v126
    v_mfma_f32_16x16x32_bf16 v[108:111], v[44:47], v[220:223], v[108:111]
    v_add_f32 v8, v8, v16
    v_add_f32 v8, v8, v17
    v_mfma_f32_16x16x32_bf16 v[108:111], v[40:43], v[216:219], v[108:111]
    s_waitcnt lgkmcnt(2)
    buffer_load_dwordx4 v4, s[4:7], s32 offen offset:2048 sc1 lds
    v_mfma_f32_16x16x32_bf16 v[80:83], v[24:27], a[192:195], v[128:131]
    s_mov_b32 s32, 196608
    ds_read_b128 v[40:43], v2 offset:12416
    v_fma_f32 v150, v150, v49, v51
    v_mfma_f32_16x16x32_bf16 v[80:83], v[28:31], a[196:199], v[80:83]
    v_exp_f32 v19, v127
    v_cvt_pk_bf16_f32 v190, v16, v17
    v_mfma_f32_16x16x32_bf16 v[84:87], v[28:31], a[220:223], v[132:135]
    s_add_u32 s26, s26, 36864
    v_add_f32 v8, v8, v18
    v_add_f32 v8, v8, v19
    v_mfma_f32_16x16x32_bf16 v[84:87], v[24:27], a[216:219], v[84:87]
    s_sub_u32 s57, s26, 147456
    v_cvt_pk_bf16_f32 v191, v18, v19
    v_lshlrev_b32 v48, 16, v57
    v_mfma_f32_16x16x32_bf16 v[88:91], v[24:27], a[240:243], v[136:139]
    ds_read_b128 v[44:47], v3 offset:12416
    v_and_b32 v49, s97, v57
    v_mfma_f32_16x16x32_bf16 v[88:91], v[28:31], a[244:247], v[88:91]
    s_min_u32 s26, s26, s57
    v_exp_f32 v16, v64
    v_mfma_f32_16x16x32_bf16 v[92:95], v[28:31], v[204:207], v[140:143]
    v_exp_f32 v17, v65
    v_mfma_f32_16x16x32_bf16 v[92:95], v[24:27], v[200:203], v[92:95]
    s_waitcnt lgkmcnt(2)
    v_exp_f32 v18, v66
    v_mfma_f32_16x16x32_bf16 v[112:115], v[32:35], a[192:195], v[128:131]
    s_mov_b32 m0, s56
    ds_read_b128 v[24:27], v2 offset:18560
    v_lshlrev_b32 v50, 16, v59
    v_mfma_f32_16x16x32_bf16 v[112:115], v[36:39], a[196:199], v[112:115]
    v_add_f32 v5, v5, v16
    v_add_f32 v5, v5, v17
    v_mfma_f32_16x16x32_bf16 v[116:119], v[36:39], a[220:223], v[132:135]
    v_exp_f32 v19, v67
    v_mfma_f32_16x16x32_bf16 v[116:119], v[32:35], a[216:219], v[116:119]
    buffer_load_dwordx4 v4, s[4:7], s27 offen offset:0 sc1 lds
    v_mfma_f32_16x16x32_bf16 v[120:123], v[32:35], a[240:243], v[136:139]
    ds_read_b128 v[28:31], v3 offset:18560
    v_and_b32 v51, s97, v59
    v_mfma_f32_16x16x32_bf16 v[120:123], v[36:39], a[244:247], v[120:123]
    v_cvt_pk_bf16_f32 v64, v16, v17
    v_mul_f32_e64 v50, -v50, v48
    v_mfma_f32_16x16x32_bf16 v[124:127], v[36:39], v[204:207], v[140:143]
    v_exp_f32 v16, v96
    v_mfma_f32_16x16x32_bf16 v[124:127], v[32:35], v[200:203], v[124:127]
    s_waitcnt lgkmcnt(2)
    buffer_load_dwordx4 v4, s[4:7], s27 offen offset:1024 sc1 lds
    v_mfma_f32_16x16x32_bf16 v[80:83], v[40:43], a[200:203], v[80:83]
    ds_read_b128 v[32:35], v2 offset:12544
    v_add_f32 v5, v5, v18
    v_mfma_f32_16x16x32_bf16 v[80:83], v[44:47], a[204:207], v[80:83]
    v_add_f32 v5, v5, v19
    v_mul_f32_e64 v51, -v51, v49
    v_mfma_f32_16x16x32_bf16 v[84:87], v[44:47], a[228:231], v[84:87]
    v_exp_f32 v17, v97
    v_mfma_f32_16x16x32_bf16 v[84:87], v[40:43], a[224:227], v[84:87]
    s_waitcnt vmcnt(13)
    buffer_load_dwordx4 v4, s[4:7], s27 offen offset:2048 sc1 lds
    v_cvt_pk_bf16_f32 v65, v18, v19
    v_mfma_f32_16x16x32_bf16 v[88:91], v[40:43], a[248:251], v[88:91]
    s_add_u32 s27, s27, 24576
    ds_read_b128 v[36:39], v3 offset:12544
    v_cvt_f32_i32 v152, v152
    v_mfma_f32_16x16x32_bf16 v[88:91], v[44:47], a[252:255], v[88:91]
    v_exp_f32 v18, v98
    v_mfma_f32_16x16x32_bf16 v[92:95], v[44:47], v[212:215], v[92:95]
    s_sub_u32 s58, s27, 196608
    v_add_f32 v5, v5, v16
    v_add_f32 v5, v5, v17
    v_mfma_f32_16x16x32_bf16 v[92:95], v[40:43], v[208:211], v[92:95]
    s_waitcnt lgkmcnt(2)
    v_cvt_f32_i32 v156, v156
    v_fma_f32 v152, v152, v48, v50
    v_mfma_f32_16x16x32_bf16 v[112:115], v[24:27], a[200:203], v[112:115]
    s_min_u32 s27, s27, s58
    ds_read_b128 v[40:43], v2 offset:18688
    v_fma_f32 v156, v156, v49, v51
    v_mfma_f32_16x16x32_bf16 v[112:115], v[28:31], a[204:207], v[112:115]
    v_exp_f32 v19, v99
    v_cvt_pk_bf16_f32 v66, v16, v17
    v_mfma_f32_16x16x32_bf16 v[116:119], v[28:31], a[228:231], v[116:119]
L_iw2:
L_pg2:
    s_cbranch_execz L_pg6
    s_add_u32 s56, s56, 12288
    v_exp_f32 v16, v68
    v_mfma_f32_16x16x32_bf16 v[116:119], v[24:27], a[224:227], v[116:119]
    s_mov_b32 m0, s56
    v_add_f32 v5, v5, v18
    v_cvt_f32_i32 v153, v153
    v_mfma_f32_16x16x32_bf16 v[120:123], v[24:27], a[248:251], v[120:123]
    ds_read_b128 v[44:47], v3 offset:18688
    v_add_f32 v5, v5, v19
    v_mfma_f32_16x16x32_bf16 v[120:123], v[28:31], a[252:255], v[120:123]
    s_waitcnt lgkmcnt(2)
    v_exp_f32 v17, v69
    v_mfma_f32_16x16x32_bf16 v[124:127], v[28:31], v[212:215], v[124:127]
    s_waitcnt vmcnt(26)
    v_cvt_f32_i32 v157, v157
    v_cvt_pk_bf16_f32 v67, v18, v19
    v_mfma_f32_16x16x32_bf16 v[124:127], v[24:27], v[208:211], v[124:127]
    s_barrier
    v_add_u32 v1, 49152, v1
    v_mfma_f32_16x16x32_bf16 v[80:83], v[32:35], a[208:211], v[80:83]
    ds_read_b128 v[24:27], v1 offset:0
    v_fma_f32 v153, v153, v48, v50
    v_mfma_f32_16x16x32_bf16 v[80:83], v[36:39], a[212:215], v[80:83]
    s_waitcnt vmcnt(12)
    buffer_load_dwordx4 v4, s[4:7], s27 offen offset:0 sc1 lds
    v_mfma_f32_16x16x32_bf16 v[84:87], v[36:39], a[236:239], v[84:87]
    v_exp_f32 v18, v70
    v_mfma_f32_16x16x32_bf16 v[84:87], v[32:35], a[232:235], v[84:87]
    v_add_f32 v6, v6, v16
    v_add_f32 v6, v6, v17
    v_mfma_f32_16x16x32_bf16 v[88:91], v[32:35], v[192:195], v[88:91]
    ds_read_b128 v[28:31], v1 offset:12288
    v_fma_f32 v157, v157, v49, v51
    v_mfma_f32_16x16x32_bf16 v[88:91], v[36:39], v[196:199], v[88:91]
    s_waitcnt vmcnt(12)
    buffer_load_dwordx4 v4, s[4:7], s27 offen offset:1024 sc1 lds
    v_mfma_f32_16x16x32_bf16 v[92:95], v[36:39], v[220:223], v[92:95]
    v_exp_f32 v19, v71
    v_mfma_f32_16x16x32_bf16 v[92:95], v[32:35], v[216:219], v[92:95]
    s_waitcnt lgkmcnt(2)
    v_cvt_pk_bf16_f32 v68, v16, v17
    v_exp_f32 v16, v100
    v_mfma_f32_16x16x32_bf16 v[112:115], v[40:43], a[208:211], v[112:115]
    ds_read_b128 v[32:35], v1 offset:1024
    v_cvt_f32_i32 v154, v154
    v_mfma_f32_16x16x32_bf16 v[112:115], v[44:47], a[212:215], v[112:115]
    s_waitcnt vmcnt(12)
    buffer_load_dwordx4 v4, s[4:7], s27 offen offset:2048 sc1 lds
    v_add_f32 v6, v6, v18
    v_mfma_f32_16x16x32_bf16 v[116:119], v[44:47], a[236:239], v[116:119]
    v_add_f32 v6, v6, v19
    v_cvt_f32_i32 v158, v158
    v_mfma_f32_16x16x32_bf16 v[116:119], v[40:43], a[232:235], v[116:119]
    v_exp_f32 v17, v101
    v_cvt_pk_bf16_f32 v69, v18, v19
    v_mfma_f32_16x16x32_bf16 v[120:123], v[40:43], v[192:195], v[120:123]
    s_add_u32 s27, s27, 24576
    ds_read_b128 v[36:39], v1 offset:13312
    v_fma_f32 v154, v154, v48, v50
    v_mfma_f32_16x16x32_bf16 v[120:123], v[44:47], v[196:199], v[120:123]
    v_exp_f32 v18, v102
    v_fma_f32 v158, v158, v49, v51
    v_mfma_f32_16x16x32_bf16 v[124:127], v[44:47], v[220:223], v[124:127]
    s_sub_u32 s58, s27, 196608
    v_add_f32 v6, v6, v16
    v_add_f32 v6, v6, v17
    v_mfma_f32_16x16x32_bf16 v[124:127], v[40:43], v[216:219], v[124:127]
    s_waitcnt lgkmcnt(2)
    v_exp_f32 v19, v103
    v_cvt_pk_bf16_f32 v144, v144, v148
    v_cvt_pk_bf16_f32 v148, v145, v149
    v_cvt_pk_bf16_f32 v70, v16, v17
    s_min_u32 s27, s27, s58
    v_cvt_pk_bf16_f32 v145, v152, v156
    v_add_f32 v6, v6, v18
    s_add_u32 s56, s56, 36864
    v_cvt_pk_bf16_f32 v149, v153, v157
    v_add_f32 v6, v6, v19
    s_sub_u32 s58, s56, 147456
    v_cvt_pk_bf16_f32 v152, v146, v150
    v_cvt_pk_bf16_f32 v71, v18, v19
    s_min_u32 s56, s56, s58
    v_cvt_pk_bf16_f32 v153, v154, v158
    s_mov_b32 s31, 6
    v_mfma_f32_16x16x32_bf16 a[0:3], v[160:163], v[24:27], a[0:3]
    s_add_u32 s33, s33, 196608
    ds_read_b128 v[40:43], v1 offset:2048
    v_mfma_f32_16x16x32_bf16 a[0:3], v[176:179], v[28:31], a[0:3]
    s_add_u32 s34, s34, 196608
    v_exp_f32 v16, v72
    v_mfma_f32_16x16x32_bf16 a[48:51], v[180:183], v[28:31], a[48:51]
    s_add_u32 s36, s36, 1536
    v_exp_f32 v17, v73
    v_mfma_f32_16x16x32_bf16 a[48:51], v[164:167], v[24:27], a[48:51]
    v_exp_f32 v18, v74
    v_mfma_f32_16x16x32_bf16 a[96:99], v[168:171], v[24:27], a[96:99]
    ds_read_b128 v[44:47], v1 offset:14336
    v_add_f32 v7, v7, v16
    v_mfma_f32_16x16x32_bf16 a[96:99], v[184:187], v[28:31], a[96:99]
    s_waitcnt vmcnt(11)
    buffer_load_dwordx2 v[56:57], v10, s[72:75], s36 offen offset:0
    v_mfma_f32_16x16x32_bf16 a[144:147], v[188:191], v[28:31], a[144:147]
    v_add_f32 v7, v7, v17
    v_mfma_f32_16x16x32_bf16 a[144:147], v[172:175], v[24:27], a[144:147]
    s_waitcnt lgkmcnt(2)
    v_exp_f32 v19, v75
    v_mfma_f32_16x16x32_bf16 a[4:7], v[160:163], v[32:35], a[4:7]
    ds_read_b128 v[24:27], v1 offset:3072
    v_cvt_pk_bf16_f32 v72, v16, v17
    v_mfma_f32_16x16x32_bf16 a[4:7], v[176:179], v[36:39], a[4:7]
    buffer_load_dwordx2 v[58:59], v10, s[76:79], s36 offen offset:0
    v_mfma_f32_16x16x32_bf16 a[52:55], v[180:183], v[36:39], a[52:55]
    v_exp_f32 v16, v104
    v_mfma_f32_16x16x32_bf16 a[52:55], v[164:167], v[32:35], a[52:55]
    v_add_f32 v7, v7, v18
    v_add_f32 v7, v7, v19
    v_mfma_f32_16x16x32_bf16 a[100:103], v[168:171], v[32:35], a[100:103]
    ds_read_b128 v[28:31], v1 offset:15360
    v_mfma_f32_16x16x32_bf16 a[100:103], v[184:187], v[36:39], a[100:103]
    s_waitcnt vmcnt(12)
    buffer_load_dwordx4 v[224:227], v9, s[64:67], s33 offen offset:0 nt
    v_mfma_f32_16x16x32_bf16 a[148:151], v[188:191], v[36:39], a[148:151]
    v_exp_f32 v17, v105
    v_mfma_f32_16x16x32_bf16 a[148:151], v[172:175], v[32:35], a[148:151]
    s_waitcnt lgkmcnt(2)
    v_cvt_pk_bf16_f32 v73, v18, v19
    v_mfma_f32_16x16x32_bf16 a[8:11], v[160:163], v[40:43], a[8:11]
    ds_read_b128 v[32:35], v1 offset:4096
    v_mfma_f32_16x16x32_bf16 a[8:11], v[176:179], v[44:47], a[8:11]
    s_waitcnt vmcnt(12)
    buffer_load_dwordx4 v[228:231], v9, s[64:67], s33 offen offset:1536 nt
    v_mfma_f32_16x16x32_bf16 a[56:59], v[180:183], v[44:47], a[56:59]
    v_exp_f32 v18, v106
    v_mfma_f32_16x16x32_bf16 a[56:59], v[164:167], v[40:43], a[56:59]
    v_add_f32 v7, v7, v16
    v_add_f32 v7, v7, v17
    v_mfma_f32_16x16x32_bf16 a[104:107], v[168:171], v[40:43], a[104:107]
    s_waitcnt vmcnt(17)
    ds_read_b128 v[36:39], v1 offset:16384
    v_lshlrev_b32 v48, 16, v60
    v_mfma_f32_16x16x32_bf16 a[104:107], v[184:187], v[44:47], a[104:107]
    buffer_load_dwordx4 v[232:235], v9, s[64:67], s34 offen offset:0 nt
    v_mfma_f32_16x16x32_bf16 a[152:155], v[188:191], v[44:47], a[152:155]
    v_exp_f32 v19, v107
    v_mfma_f32_16x16x32_bf16 a[152:155], v[172:175], v[40:43], a[152:155]
    s_waitcnt lgkmcnt(2)
    v_cvt_pk_bf16_f32 v74, v16, v17
    v_and_b32 v49, s97, v60
    v_mfma_f32_16x16x32_bf16 a[12:15], v[160:163], v[24:27], a[12:15]
    ds_read_b128 v[40:43], v1 offset:5120
    v_lshlrev_b32 v50, 16, v62
    v_mfma_f32_16x16x32_bf16 a[12:15], v[176:179], v[28:31], a[12:15]
    s_waitcnt vmcnt(13)
    buffer_load_dwordx4 v[236:239], v9, s[64:67], s34 offen offset:1536 nt
    v_mfma_f32_16x16x32_bf16 a[60:63], v[180:183], v[28:31], a[60:63]
    v_exp_f32 v16, v76
    v_mfma_f32_16x16x32_bf16 a[60:63], v[164:167], v[24:27], a[60:63]
    v_add_f32 v7, v7, v18
    v_add_f32 v7, v7, v19
    v_mfma_f32_16x16x32_bf16 a[108:111], v[168:171], v[24:27], a[108:111]
    ds_read_b128 v[44:47], v1 offset:17408
    v_and_b32 v51, s97, v62
    v_mfma_f32_16x16x32_bf16 a[108:111], v[184:187], v[28:31], a[108:111]
    v_exp_f32 v17, v77
    v_mfma_f32_16x16x32_bf16 a[156:159], v[188:191], v[28:31], a[156:159]
    s_add_u32 s29, s28, 49152
    v_cvt_pk_bf16_f32 v75, v18, v19
    v_mul_f32_e64 v50, -v50, v48
    v_mfma_f32_16x16x32_bf16 a[156:159], v[172:175], v[24:27], a[156:159]
    s_waitcnt lgkmcnt(2)
    v_exp_f32 v18, v78
    v_mfma_f32_16x16x32_bf16 a[16:19], v[160:163], v[32:35], a[16:19]
    s_mov_b32 m0, s56
    ds_read_b128 v[24:27], v1 offset:6144
    v_add_f32 v8, v8, v16
    v_mfma_f32_16x16x32_bf16 a[16:19], v[176:179], v[36:39], a[16:19]
    s_sub_u32 s3, s29, 147456
    s_waitcnt vmcnt(13)
    buffer_load_dwordx4 v4, s[4:7], s27 offen offset:0 sc1 lds
    v_mfma_f32_16x16x32_bf16 a[64:67], v[180:183], v[36:39], a[64:67]
    s_min_u32 s29, s29, s3
    v_add_f32 v8, v8, v17
    v_mul_f32_e64 v51, -v51, v49
    v_mfma_f32_16x16x32_bf16 a[64:67], v[164:167], v[32:35], a[64:67]
    v_exp_f32 v19, v79
    v_mfma_f32_16x16x32_bf16 a[112:115], v[168:171], v[32:35], a[112:115]
    ds_read_b128 v[28:31], v1 offset:18432
    v_cvt_pk_bf16_f32 v76, v16, v17
    v_mfma_f32_16x16x32_bf16 a[112:115], v[184:187], v[36:39], a[112:115]
    s_waitcnt vmcnt(13)
    buffer_load_dwordx4 v4, s[4:7], s27 offen offset:1024 sc1 lds
    v_mfma_f32_16x16x32_bf16 a[160:163], v[188:191], v[36:39], a[160:163]
    s_sub_u32 s3, s29, s28
    v_exp_f32 v16, v108
    v_mfma_f32_16x16x32_bf16 a[160:163], v[172:175], v[32:35], a[160:163]
    s_waitcnt lgkmcnt(2)
    v_add_f32 v8, v8, v18
    v_add_f32 v8, v8, v19
    v_mfma_f32_16x16x32_bf16 a[20:23], v[160:163], v[40:43], a[20:23]
    ds_read_b128 v[32:35], v1 offset:7168
    v_cvt_f32_i32 v240, v240
    v_mfma_f32_16x16x32_bf16 a[20:23], v[176:179], v[44:47], a[20:23]
    buffer_load_dword v52, v20, s[20:23], s44 offen sc1
    v_mfma_f32_16x16x32_bf16 a[68:71], v[180:183], v[44:47], a[68:71]
    v_exp_f32 v17, v109
    v_mfma_f32_16x16x32_bf16 a[68:71], v[164:167], v[40:43], a[68:71]
    v_cvt_pk_bf16_f32 v77, v18, v19
    v_cvt_f32_i32 v244, v244
    v_mfma_f32_16x16x32_bf16 a[116:119], v[168:171], v[40:43], a[116:119]
    s_mov_b32 s28, s29
    ds_read_b128 v[36:39], v1 offset:19456
    v_fma_f32 v240, v240, v48, v50
    v_mfma_f32_16x16x32_bf16 a[116:119], v[184:187], v[44:47], a[116:119]
    s_waitcnt vmcnt(14)
    buffer_load_dwordx4 v4, s[4:7], s27 offen offset:2048 sc1 lds
    v_mfma_f32_16x16x32_bf16 a[164:167], v[188:191], v[44:47], a[164:167]
    s_add_u32 s27, s27, 24576
    v_exp_f32 v18, v110
    v_mfma_f32_16x16x32_bf16 a[164:167], v[172:175], v[40:43], a[164:167]
    s_waitcnt lgkmcnt(2)
    v_add_f32 v8, v8, v16
    v_add_f32 v8, v8, v17
    v_fma_f32 v244, v244, v49, v51
    v_mfma_f32_16x16x32_bf16 a[24:27], v[160:163], v[24:27], a[24:27]
    s_sub_u32 s58, s27, 196608
    ds_read_b128 v[40:43], v1 offset:8192
    v_cvt_f32_i32 v241, v241
    v_mfma_f32_16x16x32_bf16 a[24:27], v[176:179], v[28:31], a[24:27]
    v_exp_f32 v19, v111
    v_cvt_pk_bf16_f32 v78, v16, v17
    v_mfma_f32_16x16x32_bf16 a[72:75], v[180:183], v[28:31], a[72:75]
    s_min_u32 s27, s27, s58
    v_add_f32 v8, v8, v18
    v_add_f32 v8, v8, v19
    v_mfma_f32_16x16x32_bf16 a[72:75], v[164:167], v[24:27], a[72:75]
    v_cvt_f32_i32 v245, v245
    v_cvt_pk_bf16_f32 v79, v18, v19
    v_mfma_f32_16x16x32_bf16 a[120:123], v[168:171], v[24:27], a[120:123]
    s_add_u32 s56, s56, 12288
    ds_read_b128 v[44:47], v1 offset:20480
    v_fma_f32 v241, v241, v48, v50
    v_mfma_f32_16x16x32_bf16 a[120:123], v[184:187], v[28:31], a[120:123]
    v_exp_f32 v16, v80
    v_mfma_f32_16x16x32_bf16 a[168:171], v[188:191], v[28:31], a[168:171]
    s_mov_b32 m0, s56
    v_exp_f32 v17, v81
    v_mfma_f32_16x16x32_bf16 a[168:171], v[172:175], v[24:27], a[168:171]
    s_waitcnt lgkmcnt(2)
    v_fma_f32 v245, v245, v49, v51
    v_exp_f32 v18, v82
    v_mfma_f32_16x16x32_bf16 a[28:31], v[160:163], v[32:35], a[28:31]
    ds_read_b128 v[24:27], v1 offset:9216
    v_cvt_f32_i32 v242, v242
    v_mfma_f32_16x16x32_bf16 a[28:31], v[176:179], v[36:39], a[28:31]
    v_add_f32 v5, v5, v16
    v_cvt_f32_i32 v246, v246
    v_mfma_f32_16x16x32_bf16 a[76:79], v[180:183], v[36:39], a[76:79]
    v_add_f32 v5, v5, v17
    v_fma_f32 v242, v242, v48, v50
    v_mfma_f32_16x16x32_bf16 a[76:79], v[164:167], v[32:35], a[76:79]
    s_waitcnt vmcnt(14)
    buffer_load_dwordx4 v4, s[4:7], s27 offen offset:0 sc1 lds
    v_mfma_f32_16x16x32_bf16 a[124:127], v[168:171], v[32:35], a[124:127]
    ds_read_b128 v[28:31], v1 offset:21504
    v_fma_f32 v246, v246, v49, v51
    v_mfma_f32_16x16x32_bf16 a[124:127], v[184:187], v[36:39], a[124:127]
    v_exp_f32 v19, v83
    v_cvt_pk_bf16_f32 v80, v16, v17
    v_mfma_f32_16x16x32_bf16 a[172:175], v[188:191], v[36:39], a[172:175]
    v_exp_f32 v16, v112
    v_mfma_f32_16x16x32_bf16 a[172:175], v[172:175], v[32:35], a[172:175]
    s_waitcnt lgkmcnt(2)
    s_waitcnt vmcnt(14)
    buffer_load_dwordx4 v4, s[4:7], s27 offen offset:1024 sc1 lds
    v_add_f32 v5, v5, v18
    v_mfma_f32_16x16x32_bf16 a[32:35], v[160:163], v[40:43], a[32:35]
    ds_read_b128 v[32:35], v1 offset:10240
    v_lshlrev_b32 v48, 16, v61
    v_mfma_f32_16x16x32_bf16 a[32:35], v[176:179], v[44:47], a[32:35]
    v_add_f32 v5, v5, v19
    v_exp_f32 v17, v113
    v_mfma_f32_16x16x32_bf16 a[80:83], v[180:183], v[44:47], a[80:83]
    v_and_b32 v49, s97, v61
    v_cvt_pk_bf16_f32 v81, v18, v19
    v_mfma_f32_16x16x32_bf16 a[80:83], v[164:167], v[40:43], a[80:83]
    s_waitcnt vmcnt(14)
    buffer_load_dwordx4 v4, s[4:7], s27 offen offset:2048 sc1 lds
    v_lshlrev_b32 v50, 16, v63
    v_mfma_f32_16x16x32_bf16 a[128:131], v[168:171], v[40:43], a[128:131]
    ds_read_b128 v[36:39], v1 offset:22528
    v_and_b32 v51, s97, v63
    v_mfma_f32_16x16x32_bf16 a[128:131], v[184:187], v[44:47], a[128:131]
    v_exp_f32 v18, v114
    v_add_f32 v5, v5, v16
    v_mfma_f32_16x16x32_bf16 a[176:179], v[188:191], v[44:47], a[176:179]
    v_add_u32 v2, s3, v2
    v_add_u32 v3, s3, v3
    v_mfma_f32_16x16x32_bf16 a[176:179], v[172:175], v[40:43], a[176:179]
    s_waitcnt lgkmcnt(2)
    v_add_f32 v5, v5, v17
    v_exp_f32 v19, v115
    v_mfma_f32_16x16x32_bf16 a[36:39], v[160:163], v[24:27], a[36:39]
    ds_read_b128 v[40:43], v1 offset:11264
    v_mul_f32_e64 v50, -v50, v48
    v_mfma_f32_16x16x32_bf16 a[36:39], v[176:179], v[28:31], a[36:39]
    v_cvt_pk_bf16_f32 v82, v16, v17
    v_mul_f32_e64 v51, -v51, v49
    v_mfma_f32_16x16x32_bf16 a[84:87], v[180:183], v[28:31], a[84:87]
    v_exp_f32 v16, v84
    v_mfma_f32_16x16x32_bf16 a[84:87], v[164:167], v[24:27], a[84:87]
    v_cvt_f32_i32 v248, v248
    v_add_f32 v5, v5, v18
    v_cvt_f32_i32 v252, v252
    v_mfma_f32_16x16x32_bf16 a[132:135], v[168:171], v[24:27], a[132:135]
    s_mov_b32 s27, 208896
    ds_read_b128 v[44:47], v1 offset:23552
    v_add_f32 v5, v5, v19
    v_mfma_f32_16x16x32_bf16 a[132:135], v[184:187], v[28:31], a[132:135]
    s_waitcnt lgkmcnt(2)
    v_exp_f32 v17, v85
    v_fma_f32 v248, v248, v48, v50
    v_mfma_f32_16x16x32_bf16 a[180:183], v[188:191], v[28:31], a[180:183]
    s_waitcnt vmcnt(19)
    v_cvt_pk_bf16_f32 v83, v18, v19
    v_fma_f32 v252, v252, v49, v51
    v_mfma_f32_16x16x32_bf16 a[180:183], v[172:175], v[24:27], a[180:183]
    s_barrier
    v_mfma_f32_16x16x32_bf16 a[40:43], v[160:163], v[32:35], a[40:43]
    s_add_u32 s56, s56, 36864
    ds_read_b128 v[24:27], v2 offset:0
    v_cvt_f32_i32 v249, v249
    v_mfma_f32_16x16x32_bf16 a[40:43], v[176:179], v[36:39], a[40:43]
    v_exp_f32 v18, v86
    v_add_f32 v6, v6, v16
    v_mfma_f32_16x16x32_bf16 a[88:91], v[180:183], v[36:39], a[88:91]
    s_sub_u32 s58, s56, 147456
    v_add_f32 v6, v6, v17
    v_cvt_f32_i32 v253, v253
    v_mfma_f32_16x16x32_bf16 a[88:91], v[164:167], v[32:35], a[88:91]
    s_min_u32 s56, s56, s58
    v_exp_f32 v19, v87
    v_mfma_f32_16x16x32_bf16 a[136:139], v[168:171], v[32:35], a[136:139]
    ds_read_b128 v[28:31], v3 offset:0
    v_fma_f32 v249, v249, v48, v50
    v_mfma_f32_16x16x32_bf16 a[136:139], v[184:187], v[36:39], a[136:139]
    v_cvt_pk_bf16_f32 v84, v16, v17
    v_exp_f32 v16, v116
    v_mfma_f32_16x16x32_bf16 a[184:187], v[188:191], v[36:39], a[184:187]
    v_fma_f32 v253, v253, v49, v51
    v_add_f32 v6, v6, v18
    v_mfma_f32_16x16x32_bf16 a[184:187], v[172:175], v[32:35], a[184:187]
    s_waitcnt lgkmcnt(2)
    v_cvt_f32_i32 v250, v250
    v_add_f32 v6, v6, v19
    v_mfma_f32_16x16x32_bf16 a[44:47], v[160:163], v[40:43], a[44:47]
    ds_read_b128 v[32:35], v2 offset:6144
    v_cvt_f32_i32 v254, v254
    v_mfma_f32_16x16x32_bf16 a[44:47], v[176:179], v[44:47], a[44:47]
    v_exp_f32 v17, v117
    v_mfma_f32_16x16x32_bf16 a[92:95], v[180:183], v[44:47], a[92:95]
    v_cvt_pk_bf16_f32 v85, v18, v19
    v_fma_f32 v250, v250, v48, v50
    v_mfma_f32_16x16x32_bf16 a[92:95], v[164:167], v[40:43], a[92:95]
    v_exp_f32 v18, v118
    v_mfma_f32_16x16x32_bf16 a[140:143], v[168:171], v[40:43], a[140:143]
    s_nop 0
    ds_read_b128 v[36:39], v3 offset:6144
    v_fma_f32 v254, v254, v49, v51
    v_mfma_f32_16x16x32_bf16 a[140:143], v[184:187], v[44:47], a[140:143]
    v_add_f32 v6, v6, v16
    v_add_f32 v6, v6, v17
    v_mfma_f32_16x16x32_bf16 a[188:191], v[188:191], v[44:47], a[188:191]
    s_waitcnt lgkmcnt(2)
    v_exp_f32 v19, v119
    v_cvt_pk_bf16_f32 v146, v240, v244
    v_cvt_pk_bf16_f32 v150, v241, v245
    v_cvt_pk_bf16_f32 v86, v16, v17
    v_cvt_pk_bf16_f32 v147, v248, v252
    v_add_f32 v6, v6, v18
    v_cvt_pk_bf16_f32 v151, v249, v253
    v_add_f32 v6, v6, v19
    v_cvt_pk_bf16_f32 v154, v242, v246
    v_cvt_pk_bf16_f32 v87, v18, v19
    v_cvt_pk_bf16_f32 v155, v250, v254
    v_mfma_f32_16x16x32_bf16 a[188:191], v[172:175], v[40:43], a[188:191]
    s_branch L_join
.p2align 6
L_loop:
    v_mfma_f32_16x16x32_bf16 v[160:163], v[24:27], a[192:195], v[128:131]
    s_mov_b32 m0, s56
    ds_read_b128 v[40:43], v2 offset:128
    v_cvt_f32_i32 v247, v247
    v_mfma_f32_16x16x32_bf16 v[160:163], v[28:31], a[196:199], v[160:163]
    buffer_load_dwordx4 v4, s[4:7], s27 offen offset:0 sc1 lds
    v_mfma_f32_16x16x32_bf16 v[164:167], v[28:31], a[220:223], v[132:135]
    v_exp_f32 v16, v88
    v_mfma_f32_16x16x32_bf16 v[164:167], v[24:27], a[216:219], v[164:167]
    v_exp_f32 v17, v89
    v_mfma_f32_16x16x32_bf16 v[168:171], v[24:27], a[240:243], v[136:139]
    ds_read_b128 v[44:47], v3 offset:128
    v_fma_f32 v246, v246, v48, v50
    v_mfma_f32_16x16x32_bf16 v[168:171], v[28:31], a[244:247], v[168:171]
    v_exp_f32 v18, v90
    v_mfma_f32_16x16x32_bf16 v[172:175], v[28:31], v[204:207], v[140:143]
    v_fma_f32 v247, v247, v49, v51
    v_add_f32 v7, v7, v16
    v_mfma_f32_16x16x32_bf16 v[172:175], v[24:27], v[200:203], v[172:175]
    s_waitcnt lgkmcnt(2)
    v_add_f32 v7, v7, v17
    v_cvt_pk_bf16_f32 v231, v246, v247
    v_mfma_f32_16x16x32_bf16 v[96:99], v[32:35], a[192:195], v[128:131]
    ds_read_b128 v[24:27], v2 offset:6272
    v_cvt_f32_i32 v250, v250
    v_mfma_f32_16x16x32_bf16 v[96:99], v[36:39], a[196:199], v[96:99]
    buffer_load_dwordx4 v4, s[4:7], s27 offen offset:1024 sc1 lds
    v_mfma_f32_16x16x32_bf16 v[100:103], v[36:39], a[220:223], v[132:135]
    v_exp_f32 v19, v91
    v_mfma_f32_16x16x32_bf16 v[100:103], v[32:35], a[216:219], v[100:103]
    v_cvt_pk_bf16_f32 v88, v16, v17
    v_cvt_f32_i32 v251, v251
    v_mfma_f32_16x16x32_bf16 v[104:107], v[32:35], a[240:243], v[136:139]
    ds_read_b128 v[28:31], v3 offset:6272
    v_fma_f32 v250, v250, v48, v50
    v_mfma_f32_16x16x32_bf16 v[104:107], v[36:39], a[244:247], v[104:107]
    v_exp_f32 v16, v120
    v_mfma_f32_16x16x32_bf16 v[108:111], v[36:39], v[204:207], v[140:143]
    v_add_f32 v7, v7, v18
    v_add_f32 v7, v7, v19
    v_mfma_f32_16x16x32_bf16 v[108:111], v[32:35], v[200:203], v[108:111]
    s_waitcnt lgkmcnt(2)
    v_exp_f32 v17, v121
    v_mfma_f32_16x16x32_bf16 v[160:163], v[40:43], a[200:203], v[160:163]
    ds_read_b128 v[32:35], v2 offset:256
    v_cvt_pk_bf16_f32 v89, v18, v19
    v_mfma_f32_16x16x32_bf16 v[160:163], v[44:47], a[204:207], v[160:163]
    v_exp_f32 v18, v122
    v_mfma_f32_16x16x32_bf16 v[164:167], v[44:47], a[228:231], v[164:167]
    v_fma_f32 v251, v251, v49, v51
    v_add_f32 v7, v7, v16
    v_mfma_f32_16x16x32_bf16 v[164:167], v[40:43], a[224:227], v[164:167]
    buffer_load_dwordx4 v4, s[4:7], s27 offen offset:2048 sc1 lds
    v_mfma_f32_16x16x32_bf16 v[168:171], v[40:43], a[248:251], v[168:171]
    ds_read_b128 v[36:39], v3 offset:256
    v_cvt_pk_bf16_f32 v235, v250, v251
    v_mfma_f32_16x16x32_bf16 v[168:171], v[44:47], a[252:255], v[168:171]
    v_add_f32 v7, v7, v17
    v_cvt_f32_i32 v254, v254
    v_mfma_f32_16x16x32_bf16 v[172:175], v[44:47], v[212:215], v[172:175]
    v_exp_f32 v19, v123
    v_mfma_f32_16x16x32_bf16 v[172:175], v[40:43], v[208:211], v[172:175]
    s_waitcnt lgkmcnt(2)
    v_cvt_pk_bf16_f32 v90, v16, v17
    v_cvt_f32_i32 v255, v255
    v_mfma_f32_16x16x32_bf16 v[96:99], v[24:27], a[200:203], v[96:99]
    ds_read_b128 v[40:43], v2 offset:6400
    v_fma_f32 v254, v254, v48, v50
    v_mfma_f32_16x16x32_bf16 v[96:99], v[28:31], a[204:207], v[96:99]
    s_add_u32 s27, s27, 24576
    v_exp_f32 v16, v92
    v_mfma_f32_16x16x32_bf16 v[100:103], v[28:31], a[228:231], v[100:103]
    v_add_f32 v7, v7, v18
    v_add_f32 v7, v7, v19
    v_mfma_f32_16x16x32_bf16 v[100:103], v[24:27], a[224:227], v[100:103]
    v_exp_f32 v17, v93
    v_mfma_f32_16x16x32_bf16 v[104:107], v[24:27], a[248:251], v[104:107]
    ds_read_b128 v[44:47], v3 offset:6400
    v_fma_f32 v255, v255, v49, v51
    v_mfma_f32_16x16x32_bf16 v[104:107], v[28:31], a[252:255], v[104:107]
    v_cvt_pk_bf16_f32 v91, v18, v19
    v_cvt_pk_bf16_f32 v239, v254, v255
    v_mfma_f32_16x16x32_bf16 v[108:111], v[28:31], v[212:215], v[108:111]
    s_add_u32 s29, s30, 49152
    v_exp_f32 v18, v94
    v_mfma_f32_16x16x32_bf16 v[108:111], v[24:27], v[208:211], v[108:111]
    s_waitcnt lgkmcnt(2)
    v_add_f32 v8, v8, v16
    v_add_f32 v8, v8, v17
    v_mfma_f32_16x16x32_bf16 v[160:163], v[32:35], a[208:211], v[160:163]
    s_waitcnt vmcnt(11)
    ds_read_b128 v[24:27], v2 offset:12288
    v_lshlrev_b32 v48, 16, v56
    v_mfma_f32_16x16x32_bf16 v[160:163], v[36:39], a[212:215], v[160:163]
    s_sub_u32 s3, s29, 147456
    buffer_load_dwordx2 v[60:61], off, s[80:83], s37 offset:8
    v_mfma_f32_16x16x32_bf16 v[164:167], v[36:39], a[236:239], v[164:167]
    s_add_u32 s56, s56, 12288
    v_exp_f32 v19, v95
    v_mfma_f32_16x16x32_bf16 v[164:167], v[32:35], a[232:235], v[164:167]
    s_min_u32 s29, s29, s3
    v_cvt_pk_bf16_f32 v92, v16, v17
    v_and_b32 v49, s97, v56
    v_mfma_f32_16x16x32_bf16 v[168:171], v[32:35], v[192:195], v[168:171]
    s_mov_b32 m0, s56
    ds_read_b128 v[28:31], v3 offset:12288
    v_mfma_f32_16x16x32_bf16 v[168:171], v[36:39], v[196:199], v[168:171]
    buffer_load_dwordx2 v[62:63], off, s[84:87], s37 offset:8
    v_mfma_f32_16x16x32_bf16 v[172:175], v[36:39], v[220:223], v[172:175]
    v_exp_f32 v16, v124
    v_mfma_f32_16x16x32_bf16 v[172:175], v[32:35], v[216:219], v[172:175]
    s_waitcnt lgkmcnt(2)
    v_add_f32 v8, v8, v18
    v_add_f32 v8, v8, v19
    v_mfma_f32_16x16x32_bf16 v[96:99], v[40:43], a[208:211], v[96:99]
    ds_read_b128 v[32:35], v2 offset:18432
    v_lshlrev_b32 v50, 16, v58
    v_mfma_f32_16x16x32_bf16 v[96:99], v[44:47], a[212:215], v[96:99]
    s_sub_u32 s3, s29, s30
    v_exp_f32 v17, v125
    v_mfma_f32_16x16x32_bf16 v[100:103], v[44:47], a[236:239], v[100:103]
    v_cvt_pk_bf16_f32 v93, v18, v19
    v_mfma_f32_16x16x32_bf16 v[100:103], v[40:43], a[232:235], v[100:103]
    buffer_load_dwordx4 v4, s[4:7], s27 offen offset:0 sc1 lds
    v_mfma_f32_16x16x32_bf16 v[104:107], v[40:43], v[192:195], v[104:107]
    ds_read_b128 v[36:39], v3 offset:18432
    v_mfma_f32_16x16x32_bf16 v[104:107], v[44:47], v[196:199], v[104:107]
    v_exp_f32 v18, v126
    v_mfma_f32_16x16x32_bf16 v[108:111], v[44:47], v[220:223], v[108:111]
    v_add_f32 v8, v8, v16
    v_add_f32 v8, v8, v17
    v_mfma_f32_16x16x32_bf16 v[108:111], v[40:43], v[216:219], v[108:111]
    s_waitcnt lgkmcnt(2)
    buffer_load_dwordx3 v[240:242], v12, s[68:71], s16 offen offset:0 nt
    v_mfma_f32_16x16x32_bf16 v[176:179], v[24:27], a[192:195], v[128:131]
    ds_read_b128 v[40:43], v2 offset:12416
    v_and_b32 v51, s97, v58
    v_mfma_f32_16x16x32_bf16 v[176:179], v[28:31], a[196:199], v[176:179]
    v_exp_f32 v19, v127
    v_cvt_pk_bf16_f32 v94, v16, v17
    v_mfma_f32_16x16x32_bf16 v[180:183], v[28:31], a[220:223], v[132:135]
    s_mov_b32 s30, s29
    v_add_f32 v8, v8, v18
    v_add_f32 v8, v8, v19
    v_mfma_f32_16x16x32_bf16 v[180:183], v[24:27], a[216:219], v[180:183]
    buffer_load_dwordx4 v4, s[4:7], s27 offen offset:1024 sc1 lds
    v_mfma_f32_16x16x32_bf16 v[184:187], v[24:27], a[240:243], v[136:139]
    ds_read_b128 v[44:47], v3 offset:12416
    v_cvt_pk_bf16_f32 v95, v18, v19
    v_mfma_f32_16x16x32_bf16 v[184:187], v[28:31], a[244:247], v[184:187]
    v_exp_f32 v16, v160
    v_mfma_f32_16x16x32_bf16 v[188:191], v[28:31], v[204:207], v[140:143]
    v_exp_f32 v17, v161
    v_mfma_f32_16x16x32_bf16 v[188:191], v[24:27], v[200:203], v[188:191]
    s_waitcnt lgkmcnt(2)
    buffer_load_dwordx3 v[244:246], v12, s[68:71], s16 offen offset:768 nt
    v_mfma_f32_16x16x32_bf16 v[112:115], v[32:35], a[192:195], v[128:131]
    ds_read_b128 v[24:27], v2 offset:18560
    v_mul_f32_e64 v50, -v50, v48
    v_mfma_f32_16x16x32_bf16 v[112:115], v[36:39], a[196:199], v[112:115]
    v_exp_f32 v18, v162
    v_mfma_f32_16x16x32_bf16 v[116:119], v[36:39], a[220:223], v[132:135]
    v_add_f32 v5, v5, v16
    v_add_f32 v5, v5, v17
    v_mfma_f32_16x16x32_bf16 v[116:119], v[32:35], a[216:219], v[116:119]
    v_exp_f32 v19, v163
    v_mfma_f32_16x16x32_bf16 v[120:123], v[32:35], a[240:243], v[136:139]
    ds_read_b128 v[28:31], v3 offset:18560
    v_cvt_pk_bf16_f32 v160, v16, v17
    v_mfma_f32_16x16x32_bf16 v[120:123], v[36:39], a[244:247], v[120:123]
    buffer_load_dwordx3 v[248:250], v12, s[68:71], s16 offen offset:1536 nt
    v_mfma_f32_16x16x32_bf16 v[124:127], v[36:39], v[204:207], v[140:143]
    v_exp_f32 v16, v96
    v_mfma_f32_16x16x32_bf16 v[124:127], v[32:35], v[200:203], v[124:127]
    s_waitcnt lgkmcnt(2)
    v_add_f32 v5, v5, v18
    v_add_f32 v5, v5, v19
    v_mfma_f32_16x16x32_bf16 v[176:179], v[40:43], a[200:203], v[176:179]
    ds_read_b128 v[32:35], v2 offset:12544
    v_mul_f32_e64 v51, -v51, v49
    v_mfma_f32_16x16x32_bf16 v[176:179], v[44:47], a[204:207], v[176:179]
    buffer_load_dwordx4 v4, s[4:7], s27 offen offset:2048 sc1 lds
    v_mfma_f32_16x16x32_bf16 v[180:183], v[44:47], a[228:231], v[180:183]
    v_exp_f32 v17, v97
    v_mfma_f32_16x16x32_bf16 v[180:183], v[40:43], a[224:227], v[180:183]
    v_cvt_pk_bf16_f32 v161, v18, v19
    v_add_u32 v1, s3, v1
    v_mfma_f32_16x16x32_bf16 v[184:187], v[40:43], a[248:251], v[184:187]
    ds_read_b128 v[36:39], v3 offset:12544
    v_cvt_f32_i32 v144, v144
    v_mfma_f32_16x16x32_bf16 v[184:187], v[44:47], a[252:255], v[184:187]
    buffer_load_dwordx3 v[252:254], v12, s[68:71], s16 offen offset:2304 nt
    v_mfma_f32_16x16x32_bf16 v[188:191], v[44:47], v[212:215], v[188:191]
    v_exp_f32 v18, v98
    v_mfma_f32_16x16x32_bf16 v[188:191], v[40:43], v[208:211], v[188:191]
    s_waitcnt lgkmcnt(2)
    v_add_f32 v5, v5, v16
    v_add_f32 v5, v5, v17
    v_mfma_f32_16x16x32_bf16 v[112:115], v[24:27], a[200:203], v[112:115]
    ds_read_b128 v[40:43], v2 offset:18688
    v_cvt_f32_i32 v148, v148
    v_mfma_f32_16x16x32_bf16 v[112:115], v[28:31], a[204:207], v[112:115]
    v_exp_f32 v19, v99
    v_cvt_pk_bf16_f32 v162, v16, v17
    v_mfma_f32_16x16x32_bf16 v[116:119], v[28:31], a[228:231], v[116:119]
    v_exp_f32 v16, v164
    v_mfma_f32_16x16x32_bf16 v[116:119], v[24:27], a[224:227], v[116:119]
    s_add_u32 s27, s27, 24576
    v_add_f32 v5, v5, v18
    v_add_f32 v5, v5, v19
    v_mfma_f32_16x16x32_bf16 v[120:123], v[24:27], a[248:251], v[120:123]
    s_add_u32 s56, s56, 36864
    ds_read_b128 v[44:47], v3 offset:18688
    v_fma_f32 v144, v144, v48, v50
    v_mfma_f32_16x16x32_bf16 v[120:123], v[28:31], a[252:255], v[120:123]
    s_waitcnt lgkmcnt(2)
    v_exp_f32 v17, v165
    v_mfma_f32_16x16x32_bf16 v[124:127], v[28:31], v[212:215], v[124:127]
    s_waitcnt vmcnt(12)
    v_cvt_pk_bf16_f32 v163, v18, v19
    s_sub_u32 s58, s56, 147456
    v_mfma_f32_16x16x32_bf16 v[124:127], v[24:27], v[208:211], v[124:127]
    s_barrier
    v_mfma_f32_16x16x32_bf16 v[176:179], v[32:35], a[208:211], v[176:179]
    s_min_u32 s56, s56, s58
    ds_read_b128 v[24:27], v1 offset:0
    v_mfma_f32_16x16x32_bf16 v[176:179], v[36:39], a[212:215], v[176:179]
    v_exp_f32 v18, v166
    v_mfma_f32_16x16x32_bf16 v[180:183], v[36:39], a[236:239], v[180:183]
    v_add_f32 v6, v6, v16
    v_add_f32 v6, v6, v17
    v_mfma_f32_16x16x32_bf16 v[180:183], v[32:35], a[232:235], v[180:183]
    v_exp_f32 v19, v167
    v_mfma_f32_16x16x32_bf16 v[184:187], v[32:35], v[192:195], v[184:187]
    ds_read_b128 v[28:31], v1 offset:12288
    v_cvt_pk_bf16_f32 v164, v16, v17
    v_mfma_f32_16x16x32_bf16 v[184:187], v[36:39], v[196:199], v[184:187]
    v_exp_f32 v16, v100
    v_mfma_f32_16x16x32_bf16 v[188:191], v[36:39], v[220:223], v[188:191]
    v_add_f32 v6, v6, v18
    v_add_f32 v6, v6, v19
    v_mfma_f32_16x16x32_bf16 v[188:191], v[32:35], v[216:219], v[188:191]
    s_waitcnt lgkmcnt(2)
    v_exp_f32 v17, v101
    v_mfma_f32_16x16x32_bf16 v[112:115], v[40:43], a[208:211], v[112:115]
L_iw3:
L_pg3:
    s_cbranch_execz L_pg7
    ds_read_b128 v[32:35], v1 offset:1024
    v_cvt_pk_bf16_f32 v165, v18, v19
    v_mfma_f32_16x16x32_bf16 v[112:115], v[44:47], a[212:215], v[112:115]
    v_exp_f32 v18, v102
    v_mfma_f32_16x16x32_bf16 v[116:119], v[44:47], a[236:239], v[116:119]
    v_add_f32 v6, v6, v16
    v_add_f32 v6, v6, v17
    v_mfma_f32_16x16x32_bf16 v[116:119], v[40:43], a[232:235], v[116:119]
    v_exp_f32 v19, v103
    v_mfma_f32_16x16x32_bf16 v[120:123], v[40:43], v[192:195], v[120:123]
    ds_read_b128 v[36:39], v1 offset:13312
    v_cvt_pk_bf16_f32 v166, v16, v17
    v_mfma_f32_16x16x32_bf16 v[120:123], v[44:47], v[196:199], v[120:123]
    v_add_f32 v6, v6, v18
    v_fma_f32 v148, v148, v49, v51
    v_mfma_f32_16x16x32_bf16 v[124:127], v[44:47], v[220:223], v[124:127]
    v_add_f32 v6, v6, v19
    v_cvt_pk_bf16_f32 v167, v18, v19
    v_mfma_f32_16x16x32_bf16 v[124:127], v[40:43], v[216:219], v[124:127]
    s_waitcnt lgkmcnt(2)
    v_mfma_f32_16x16x32_bf16 a[0:3], v[64:67], v[24:27], a[0:3]
    ds_read_b128 v[40:43], v1 offset:2048
    v_cvt_f32_i32 v145, v145
    v_mfma_f32_16x16x32_bf16 a[0:3], v[80:83], v[28:31], a[0:3]
    buffer_store_dwordx4 v[224:227], v11, s[4:7], s33 offen offset:0 sc1
    v_mfma_f32_16x16x32_bf16 a[48:51], v[84:87], v[28:31], a[48:51]
    v_exp_f32 v16, v168
    v_mfma_f32_16x16x32_bf16 a[48:51], v[68:71], v[24:27], a[48:51]
    v_exp_f32 v17, v169
    v_mfma_f32_16x16x32_bf16 a[96:99], v[72:75], v[24:27], a[96:99]
    ds_read_b128 v[44:47], v1 offset:14336
    v_cvt_f32_i32 v149, v149
    v_mfma_f32_16x16x32_bf16 a[96:99], v[88:91], v[28:31], a[96:99]
    v_exp_f32 v18, v170
    v_mfma_f32_16x16x32_bf16 a[144:147], v[92:95], v[28:31], a[144:147]
    v_add_f32 v7, v7, v16
    v_add_f32 v7, v7, v17
    v_mfma_f32_16x16x32_bf16 a[144:147], v[76:79], v[24:27], a[144:147]
    s_waitcnt lgkmcnt(2)
    v_exp_f32 v19, v171
    v_mfma_f32_16x16x32_bf16 a[4:7], v[64:67], v[32:35], a[4:7]
    ds_read_b128 v[24:27], v1 offset:3072
    v_cvt_pk_bf16_f32 v168, v16, v17
    v_mfma_f32_16x16x32_bf16 a[4:7], v[80:83], v[36:39], a[4:7]
    buffer_store_dwordx4 v[228:231], v21, s[4:7], s33 offen offset:768 sc1
    v_mfma_f32_16x16x32_bf16 a[52:55], v[84:87], v[36:39], a[52:55]
    v_exp_f32 v16, v104
    v_mfma_f32_16x16x32_bf16 a[52:55], v[68:71], v[32:35], a[52:55]
    v_add_f32 v7, v7, v18
    v_fma_f32 v145, v145, v48, v50
    v_mfma_f32_16x16x32_bf16 a[100:103], v[72:75], v[32:35], a[100:103]
    ds_read_b128 v[28:31], v1 offset:15360
    v_add_f32 v7, v7, v19
    v_mfma_f32_16x16x32_bf16 a[100:103], v[88:91], v[36:39], a[100:103]
    v_exp_f32 v17, v105
    v_mfma_f32_16x16x32_bf16 a[148:151], v[92:95], v[36:39], a[148:151]
    v_cvt_pk_bf16_f32 v169, v18, v19
    v_fma_f32 v149, v149, v49, v51
    v_mfma_f32_16x16x32_bf16 a[148:151], v[76:79], v[32:35], a[148:151]
    s_waitcnt lgkmcnt(2)
    v_exp_f32 v18, v106
    v_mfma_f32_16x16x32_bf16 a[8:11], v[64:67], v[40:43], a[8:11]
    ds_read_b128 v[32:35], v1 offset:4096
    v_add_f32 v7, v7, v16
    v_mfma_f32_16x16x32_bf16 a[8:11], v[80:83], v[44:47], a[8:11]
    buffer_store_dwordx4 v[232:235], v22, s[4:7], s33 offen offset:1536 sc1
    v_mfma_f32_16x16x32_bf16 a[56:59], v[84:87], v[44:47], a[56:59]
    v_add_f32 v7, v7, v17
    v_cvt_f32_i32 v146, v146
    v_mfma_f32_16x16x32_bf16 a[56:59], v[68:71], v[40:43], a[56:59]
    v_exp_f32 v19, v107
    v_mfma_f32_16x16x32_bf16 a[104:107], v[72:75], v[40:43], a[104:107]
    ds_read_b128 v[36:39], v1 offset:16384
    v_cvt_pk_bf16_f32 v170, v16, v17
    v_mfma_f32_16x16x32_bf16 a[104:107], v[88:91], v[44:47], a[104:107]
    v_exp_f32 v16, v172
    v_mfma_f32_16x16x32_bf16 a[152:155], v[92:95], v[44:47], a[152:155]
    v_add_f32 v7, v7, v18
    v_cvt_f32_i32 v150, v150
    v_mfma_f32_16x16x32_bf16 a[152:155], v[76:79], v[40:43], a[152:155]
    s_waitcnt lgkmcnt(2)
    v_add_f32 v7, v7, v19
    v_fma_f32 v146, v146, v48, v50
    v_mfma_f32_16x16x32_bf16 a[12:15], v[64:67], v[24:27], a[12:15]
    ds_read_b128 v[40:43], v1 offset:5120
    v_mfma_f32_16x16x32_bf16 a[12:15], v[80:83], v[28:31], a[12:15]
    buffer_store_dwordx4 v[236:239], v23, s[4:7], s33 offen offset:2304 sc1
    v_mfma_f32_16x16x32_bf16 a[60:63], v[84:87], v[28:31], a[60:63]
    v_exp_f32 v17, v173
    v_mfma_f32_16x16x32_bf16 a[60:63], v[68:71], v[24:27], a[60:63]
    v_cvt_pk_bf16_f32 v171, v18, v19
    v_fma_f32 v150, v150, v49, v51
    v_mfma_f32_16x16x32_bf16 a[108:111], v[72:75], v[24:27], a[108:111]
    ds_read_b128 v[44:47], v1 offset:17408
    v_mfma_f32_16x16x32_bf16 a[108:111], v[88:91], v[28:31], a[108:111]
    v_exp_f32 v18, v174
    v_mfma_f32_16x16x32_bf16 a[156:159], v[92:95], v[28:31], a[156:159]
    s_add_u32 s29, s28, 49152
    v_add_f32 v8, v8, v16
    v_add_f32 v8, v8, v17
    v_mfma_f32_16x16x32_bf16 a[156:159], v[76:79], v[24:27], a[156:159]
    s_waitcnt lgkmcnt(2)
    v_exp_f32 v19, v175
    v_mfma_f32_16x16x32_bf16 a[16:19], v[64:67], v[32:35], a[16:19]
    s_sub_u32 s3, s29, 147456
    ds_read_b128 v[24:27], v1 offset:6144
    v_cvt_pk_bf16_f32 v172, v16, v17
    v_mfma_f32_16x16x32_bf16 a[16:19], v[80:83], v[36:39], a[16:19]
    s_mov_b32 m0, s26
    v_exp_f32 v16, v108
    v_mfma_f32_16x16x32_bf16 a[64:67], v[84:87], v[36:39], a[64:67]
    s_min_u32 s29, s29, s3
    v_add_f32 v8, v8, v18
    v_lshlrev_b32 v48, 16, v57
    v_mfma_f32_16x16x32_bf16 a[64:67], v[68:71], v[32:35], a[64:67]
    buffer_load_dwordx4 v4, s[4:7], s32 offen offset:0 sc1 lds
    v_mfma_f32_16x16x32_bf16 a[112:115], v[72:75], v[32:35], a[112:115]
    ds_read_b128 v[28:31], v1 offset:18432
    v_add_f32 v8, v8, v19
    v_mfma_f32_16x16x32_bf16 a[112:115], v[88:91], v[36:39], a[112:115]
    v_exp_f32 v17, v109
    v_mfma_f32_16x16x32_bf16 a[160:163], v[92:95], v[36:39], a[160:163]
    v_cvt_pk_bf16_f32 v173, v18, v19
    v_and_b32 v49, s97, v57
    v_mfma_f32_16x16x32_bf16 a[160:163], v[76:79], v[32:35], a[160:163]
    s_waitcnt lgkmcnt(2)
    buffer_load_dwordx4 v4, s[4:7], s32 offen offset:1024 sc1 lds
    v_mfma_f32_16x16x32_bf16 a[20:23], v[64:67], v[40:43], a[20:23]
    s_sub_u32 s3, s29, s28
    ds_read_b128 v[32:35], v1 offset:7168
    v_lshlrev_b32 v50, 16, v59
    v_mfma_f32_16x16x32_bf16 a[20:23], v[80:83], v[44:47], a[20:23]
    v_exp_f32 v18, v110
    v_mfma_f32_16x16x32_bf16 a[68:71], v[84:87], v[44:47], a[68:71]
    v_add_f32 v8, v8, v16
    v_add_f32 v8, v8, v17
    v_mfma_f32_16x16x32_bf16 a[68:71], v[68:71], v[40:43], a[68:71]
    buffer_load_dwordx4 v4, s[4:7], s32 offen offset:2048 sc1 lds
    v_mfma_f32_16x16x32_bf16 a[116:119], v[72:75], v[40:43], a[116:119]
    ds_read_b128 v[36:39], v1 offset:19456
    v_mfma_f32_16x16x32_bf16 a[116:119], v[88:91], v[44:47], a[116:119]
    v_exp_f32 v19, v111
    v_mfma_f32_16x16x32_bf16 a[164:167], v[92:95], v[44:47], a[164:167]
    s_mov_b32 s28, s29
    v_cvt_pk_bf16_f32 v174, v16, v17
    v_add_f32 v8, v8, v18
    v_mfma_f32_16x16x32_bf16 a[164:167], v[76:79], v[40:43], a[164:167]
    s_waitcnt lgkmcnt(2)
    v_add_f32 v8, v8, v19
    v_cvt_pk_bf16_f32 v175, v18, v19
    v_mfma_f32_16x16x32_bf16 a[24:27], v[64:67], v[24:27], a[24:27]
    s_add_u32 s32, s32, 24576
    ds_read_b128 v[40:43], v1 offset:8192
    v_and_b32 v51, s97, v59
    v_mfma_f32_16x16x32_bf16 a[24:27], v[80:83], v[28:31], a[24:27]
    v_exp_f32 v16, v176
    v_mfma_f32_16x16x32_bf16 a[72:75], v[84:87], v[28:31], a[72:75]
    s_add_u32 s26, s26, 12288
    v_exp_f32 v17, v177
    v_mfma_f32_16x16x32_bf16 a[72:75], v[68:71], v[24:27], a[72:75]
    v_exp_f32 v18, v178
    v_mfma_f32_16x16x32_bf16 a[120:123], v[72:75], v[24:27], a[120:123]
    s_mov_b32 m0, s26
    ds_read_b128 v[44:47], v1 offset:20480
    v_add_f32 v5, v5, v16
    v_mfma_f32_16x16x32_bf16 a[120:123], v[88:91], v[28:31], a[120:123]
    v_add_f32 v5, v5, v17
    v_mul_f32_e64 v50, -v50, v48
    v_mfma_f32_16x16x32_bf16 a[168:171], v[92:95], v[28:31], a[168:171]
    v_exp_f32 v19, v179
    v_mfma_f32_16x16x32_bf16 a[168:171], v[76:79], v[24:27], a[168:171]
    s_waitcnt lgkmcnt(2)
    v_cvt_pk_bf16_f32 v176, v16, v17
    v_mul_f32_e64 v51, -v51, v49
    v_mfma_f32_16x16x32_bf16 a[28:31], v[64:67], v[32:35], a[28:31]
    ds_read_b128 v[24:27], v1 offset:9216
    v_add_u32 v2, s3, v2
    v_mfma_f32_16x16x32_bf16 a[28:31], v[80:83], v[36:39], a[28:31]
    buffer_load_dwordx4 v4, s[4:7], s32 offen offset:0 sc1 lds
    v_mfma_f32_16x16x32_bf16 a[76:79], v[84:87], v[36:39], a[76:79]
    v_exp_f32 v16, v112
    v_mfma_f32_16x16x32_bf16 a[76:79], v[68:71], v[32:35], a[76:79]
    v_add_f32 v5, v5, v18
    v_add_f32 v5, v5, v19
    v_mfma_f32_16x16x32_bf16 a[124:127], v[72:75], v[32:35], a[124:127]
    ds_read_b128 v[28:31], v1 offset:21504
    v_cvt_f32_i32 v152, v152
    v_mfma_f32_16x16x32_bf16 a[124:127], v[88:91], v[36:39], a[124:127]
    buffer_load_dwordx4 v4, s[4:7], s32 offen offset:1024 sc1 lds
    v_mfma_f32_16x16x32_bf16 a[172:175], v[92:95], v[36:39], a[172:175]
    v_exp_f32 v17, v113
    v_mfma_f32_16x16x32_bf16 a[172:175], v[76:79], v[32:35], a[172:175]
    s_waitcnt lgkmcnt(2)
    v_cvt_pk_bf16_f32 v177, v18, v19
    v_add_u32 v3, s3, v3
    v_mfma_f32_16x16x32_bf16 a[32:35], v[64:67], v[40:43], a[32:35]
    ds_read_b128 v[32:35], v1 offset:10240
    v_cvt_f32_i32 v156, v156
    v_mfma_f32_16x16x32_bf16 a[32:35], v[80:83], v[44:47], a[32:35]
    v_exp_f32 v18, v114
    v_mfma_f32_16x16x32_bf16 a[80:83], v[84:87], v[44:47], a[80:83]
    v_add_f32 v5, v5, v16
    v_add_f32 v5, v5, v17
    v_mfma_f32_16x16x32_bf16 a[80:83], v[68:71], v[40:43], a[80:83]
    buffer_load_dwordx4 v4, s[4:7], s32 offen offset:2048 sc1 lds
    v_mfma_f32_16x16x32_bf16 a[128:131], v[72:75], v[40:43], a[128:131]
    ds_read_b128 v[36:39], v1 offset:22528
    v_mfma_f32_16x16x32_bf16 a[128:131], v[88:91], v[44:47], a[128:131]
    v_exp_f32 v19, v115
    v_mfma_f32_16x16x32_bf16 a[176:179], v[92:95], v[44:47], a[176:179]
    v_cvt_pk_bf16_f32 v178, v16, v17
    v_fma_f32 v152, v152, v48, v50
    v_mfma_f32_16x16x32_bf16 a[176:179], v[76:79], v[40:43], a[176:179]
    s_waitcnt lgkmcnt(2)
    v_exp_f32 v16, v180
    v_mfma_f32_16x16x32_bf16 a[36:39], v[64:67], v[24:27], a[36:39]
    ds_read_b128 v[40:43], v1 offset:11264
    v_add_f32 v5, v5, v18
    v_mfma_f32_16x16x32_bf16 a[36:39], v[80:83], v[28:31], a[36:39]
    v_add_f32 v5, v5, v19
    v_mfma_f32_16x16x32_bf16 a[84:87], v[84:87], v[28:31], a[84:87]
    v_exp_f32 v17, v181
    v_mfma_f32_16x16x32_bf16 a[84:87], v[68:71], v[24:27], a[84:87]
    s_add_u32 s32, s32, 24576
    v_cvt_pk_bf16_f32 v179, v18, v19
    s_add_u32 s26, s26, 36864
    v_mfma_f32_16x16x32_bf16 a[132:135], v[72:75], v[24:27], a[132:135]
    s_sub_u32 s57, s26, 147456
    ds_read_b128 v[44:47], v1 offset:23552
    v_fma_f32 v156, v156, v49, v51
    v_mfma_f32_16x16x32_bf16 a[132:135], v[88:91], v[28:31], a[132:135]
    s_waitcnt lgkmcnt(2)
    v_exp_f32 v18, v182
    v_mfma_f32_16x16x32_bf16 a[180:183], v[92:95], v[28:31], a[180:183]
    s_waitcnt vmcnt(6)
    v_add_f32 v6, v6, v16
    v_add_f32 v6, v6, v17
    v_mfma_f32_16x16x32_bf16 a[180:183], v[76:79], v[24:27], a[180:183]
    s_barrier
    v_mfma_f32_16x16x32_bf16 a[40:43], v[64:67], v[32:35], a[40:43]
    s_min_u32 s26, s26, s57
    ds_read_b128 v[24:27], v2 offset:0
    v_add_u32 v0, 1, v0
    v_mfma_f32_16x16x32_bf16 a[40:43], v[80:83], v[36:39], a[40:43]
    buffer_store_dword v0, v13, s[20:23], 0 offen offset:32 sc1
    v_mfma_f32_16x16x32_bf16 a[88:91], v[84:87], v[36:39], a[88:91]
    v_exp_f32 v19, v183
    v_mfma_f32_16x16x32_bf16 a[88:91], v[68:71], v[32:35], a[88:91]
    v_cvt_pk_bf16_f32 v180, v16, v17
    v_cvt_f32_i32 v153, v153
    v_mfma_f32_16x16x32_bf16 a[136:139], v[72:75], v[32:35], a[136:139]
    ds_read_b128 v[28:31], v3 offset:0
    v_cvt_f32_i32 v157, v157
    v_mfma_f32_16x16x32_bf16 a[136:139], v[88:91], v[36:39], a[136:139]
    v_exp_f32 v16, v116
    v_mfma_f32_16x16x32_bf16 a[184:187], v[92:95], v[36:39], a[184:187]
    v_add_f32 v6, v6, v18
    v_add_f32 v6, v6, v19
    v_mfma_f32_16x16x32_bf16 a[184:187], v[76:79], v[32:35], a[184:187]
    s_waitcnt lgkmcnt(2)
    v_exp_f32 v17, v117
    v_mfma_f32_16x16x32_bf16 a[44:47], v[64:67], v[40:43], a[44:47]
    ds_read_b128 v[32:35], v2 offset:6144
    v_cvt_pk_bf16_f32 v181, v18, v19
    v_mfma_f32_16x16x32_bf16 a[44:47], v[80:83], v[44:47], a[44:47]
    v_exp_f32 v18, v118
    v_mfma_f32_16x16x32_bf16 a[92:95], v[84:87], v[44:47], a[92:95]
    v_add_f32 v6, v6, v16
    v_add_f32 v6, v6, v17
    v_mfma_f32_16x16x32_bf16 a[92:95], v[68:71], v[40:43], a[92:95]
    v_exp_f32 v19, v119
    v_mfma_f32_16x16x32_bf16 a[140:143], v[72:75], v[40:43], a[140:143]
    ds_read_b128 v[36:39], v3 offset:6144
    v_cvt_pk_bf16_f32 v182, v16, v17
    v_mfma_f32_16x16x32_bf16 a[140:143], v[88:91], v[44:47], a[140:143]
    v_add_f32 v6, v6, v18
    v_add_f32 v6, v6, v19
    v_mfma_f32_16x16x32_bf16 a[188:191], v[92:95], v[44:47], a[188:191]
    v_cvt_pk_bf16_f32 v183, v18, v19
    v_mfma_f32_16x16x32_bf16 a[188:191], v[76:79], v[40:43], a[188:191]
    s_waitcnt lgkmcnt(2)
    v_mfma_f32_16x16x32_bf16 v[64:67], v[24:27], a[192:195], v[128:131]
    s_add_u32 s33, s33, 196608
    ds_read_b128 v[40:43], v2 offset:128
    v_fma_f32 v153, v153, v48, v50
    v_mfma_f32_16x16x32_bf16 v[64:67], v[28:31], a[196:199], v[64:67]
    s_mov_b32 m0, s56
    v_exp_f32 v16, v184
    v_mfma_f32_16x16x32_bf16 v[68:71], v[28:31], a[220:223], v[132:135]
    s_add_u32 s34, s34, 196608
    v_exp_f32 v17, v185
    v_mfma_f32_16x16x32_bf16 v[68:71], v[24:27], a[216:219], v[68:71]
    s_add_u32 s36, s36, 1536
    buffer_load_dwordx4 v4, s[4:7], s27 offen offset:0 sc1 lds
    v_mfma_f32_16x16x32_bf16 v[72:75], v[24:27], a[240:243], v[136:139]
    ds_read_b128 v[44:47], v3 offset:128
    v_fma_f32 v157, v157, v49, v51
    v_mfma_f32_16x16x32_bf16 v[72:75], v[28:31], a[244:247], v[72:75]
    v_exp_f32 v18, v186
    v_mfma_f32_16x16x32_bf16 v[76:79], v[28:31], v[204:207], v[140:143]
    v_add_f32 v7, v7, v16
    v_add_f32 v7, v7, v17
    v_mfma_f32_16x16x32_bf16 v[76:79], v[24:27], v[200:203], v[76:79]
    s_waitcnt lgkmcnt(2)
    buffer_load_dwordx2 v[56:57], v10, s[72:75], s36 offen offset:0
    v_mfma_f32_16x16x32_bf16 v[96:99], v[32:35], a[192:195], v[128:131]
    ds_read_b128 v[24:27], v2 offset:6272
    v_cvt_f32_i32 v154, v154
    v_mfma_f32_16x16x32_bf16 v[96:99], v[36:39], a[196:199], v[96:99]
    v_exp_f32 v19, v187
    v_mfma_f32_16x16x32_bf16 v[100:103], v[36:39], a[220:223], v[132:135]
    v_cvt_pk_bf16_f32 v184, v16, v17
    v_cvt_f32_i32 v158, v158
    v_mfma_f32_16x16x32_bf16 v[100:103], v[32:35], a[216:219], v[100:103]
    buffer_load_dwordx4 v4, s[4:7], s27 offen offset:1024 sc1 lds
    v_mfma_f32_16x16x32_bf16 v[104:107], v[32:35], a[240:243], v[136:139]
    ds_read_b128 v[28:31], v3 offset:6272
    v_fma_f32 v154, v154, v48, v50
    v_mfma_f32_16x16x32_bf16 v[104:107], v[36:39], a[244:247], v[104:107]
    v_exp_f32 v16, v120
    v_mfma_f32_16x16x32_bf16 v[108:111], v[36:39], v[204:207], v[140:143]
    v_add_f32 v7, v7, v18
    v_add_f32 v7, v7, v19
    v_mfma_f32_16x16x32_bf16 v[108:111], v[32:35], v[200:203], v[108:111]
    s_waitcnt lgkmcnt(2)
    buffer_load_dwordx2 v[58:59], v10, s[76:79], s36 offen offset:0
    v_mfma_f32_16x16x32_bf16 v[64:67], v[40:43], a[200:203], v[64:67]
    ds_read_b128 v[32:35], v2 offset:256
    v_fma_f32 v158, v158, v49, v51
    v_mfma_f32_16x16x32_bf16 v[64:67], v[44:47], a[204:207], v[64:67]
    v_exp_f32 v17, v121
    v_mfma_f32_16x16x32_bf16 v[68:71], v[44:47], a[228:231], v[68:71]
    v_cvt_pk_bf16_f32 v185, v18, v19
    v_mfma_f32_16x16x32_bf16 v[68:71], v[40:43], a[224:227], v[68:71]
    buffer_load_dwordx4 v[224:227], v9, s[64:67], s33 offen offset:0 nt
    v_mfma_f32_16x16x32_bf16 v[72:75], v[40:43], a[248:251], v[72:75]
    ds_read_b128 v[36:39], v3 offset:256
    v_cvt_pk_bf16_f32 v144, v144, v148
    v_mfma_f32_16x16x32_bf16 v[72:75], v[44:47], a[252:255], v[72:75]
    v_exp_f32 v18, v122
    v_mfma_f32_16x16x32_bf16 v[76:79], v[44:47], v[212:215], v[76:79]
    v_add_f32 v7, v7, v16
    v_add_f32 v7, v7, v17
    v_mfma_f32_16x16x32_bf16 v[76:79], v[40:43], v[208:211], v[76:79]
    s_waitcnt lgkmcnt(2)
    buffer_load_dwordx4 v4, s[4:7], s27 offen offset:2048 sc1 lds
    v_mfma_f32_16x16x32_bf16 v[96:99], v[24:27], a[200:203], v[96:99]
    ds_read_b128 v[40:43], v2 offset:6400
    v_cvt_pk_bf16_f32 v148, v145, v149
    v_mfma_f32_16x16x32_bf16 v[96:99], v[28:31], a[204:207], v[96:99]
    v_exp_f32 v19, v123
    v_cvt_pk_bf16_f32 v186, v16, v17
    v_mfma_f32_16x16x32_bf16 v[100:103], v[28:31], a[228:231], v[100:103]
    v_exp_f32 v16, v188
    v_mfma_f32_16x16x32_bf16 v[100:103], v[24:27], a[224:227], v[100:103]
    buffer_load_dwordx4 v[228:231], v9, s[64:67], s33 offen offset:1536 nt
    v_mfma_f32_16x16x32_bf16 v[104:107], v[24:27], a[248:251], v[104:107]
    ds_read_b128 v[44:47], v3 offset:6400
    v_add_f32 v7, v7, v18
    v_mfma_f32_16x16x32_bf16 v[104:107], v[28:31], a[252:255], v[104:107]
    v_add_f32 v7, v7, v19
    v_cvt_pk_bf16_f32 v145, v152, v156
    v_mfma_f32_16x16x32_bf16 v[108:111], v[28:31], v[212:215], v[108:111]
    s_add_u32 s29, s30, 49152
    v_exp_f32 v17, v189
    v_mfma_f32_16x16x32_bf16 v[108:111], v[24:27], v[208:211], v[108:111]
    s_waitcnt lgkmcnt(2)
    buffer_load_dwordx4 v[232:235], v9, s[64:67], s34 offen offset:0 nt
    v_cvt_pk_bf16_f32 v187, v18, v19
    v_mfma_f32_16x16x32_bf16 v[64:67], v[32:35], a[208:211], v[64:67]
    s_sub_u32 s3, s29, 147456
    ds_read_b128 v[24:27], v2 offset:12288
    s_add_u32 s27, s27, 24576
    v_mfma_f32_16x16x32_bf16 v[64:67], v[36:39], a[212:215], v[64:67]
    s_min_u32 s29, s29, s3
    v_exp_f32 v18, v190
    v_mfma_f32_16x16x32_bf16 v[68:71], v[36:39], a[236:239], v[68:71]
    v_add_f32 v8, v8, v16
    v_add_f32 v8, v8, v17
    v_mfma_f32_16x16x32_bf16 v[68:71], v[32:35], a[232:235], v[68:71]
    buffer_load_dwordx4 v[236:239], v9, s[64:67], s34 offen offset:1536 nt
    v_mfma_f32_16x16x32_bf16 v[72:75], v[32:35], v[192:195], v[72:75]
    s_add_u32 s56, s56, 12288
    ds_read_b128 v[28:31], v3 offset:12288
    v_cvt_pk_bf16_f32 v149, v153, v157
    v_mfma_f32_16x16x32_bf16 v[72:75], v[36:39], v[196:199], v[72:75]
    v_exp_f32 v19, v191
    v_cvt_pk_bf16_f32 v188, v16, v17
    v_mfma_f32_16x16x32_bf16 v[76:79], v[36:39], v[220:223], v[76:79]
    v_exp_f32 v16, v124
    v_mfma_f32_16x16x32_bf16 v[76:79], v[32:35], v[216:219], v[76:79]
    s_waitcnt lgkmcnt(2)
    v_add_f32 v8, v8, v18
    v_add_f32 v8, v8, v19
    v_mfma_f32_16x16x32_bf16 v[96:99], v[40:43], a[208:211], v[96:99]
    ds_read_b128 v[32:35], v2 offset:18432
    v_cvt_pk_bf16_f32 v152, v146, v150
    v_mfma_f32_16x16x32_bf16 v[96:99], v[44:47], a[212:215], v[96:99]
    s_sub_u32 s3, s29, s30
    v_exp_f32 v17, v125
    v_mfma_f32_16x16x32_bf16 v[100:103], v[44:47], a[236:239], v[100:103]
    s_mov_b32 m0, s56
    v_cvt_pk_bf16_f32 v189, v18, v19
    v_cvt_pk_bf16_f32 v153, v154, v158
    v_mfma_f32_16x16x32_bf16 v[100:103], v[40:43], a[232:235], v[100:103]
    v_exp_f32 v18, v126
    v_mfma_f32_16x16x32_bf16 v[104:107], v[40:43], v[192:195], v[104:107]
    ds_read_b128 v[36:39], v3 offset:18432
    v_add_f32 v8, v8, v16
    v_mfma_f32_16x16x32_bf16 v[104:107], v[44:47], v[196:199], v[104:107]
    v_add_f32 v8, v8, v17
    v_mfma_f32_16x16x32_bf16 v[108:111], v[44:47], v[220:223], v[108:111]
    v_exp_f32 v19, v127
    v_mfma_f32_16x16x32_bf16 v[108:111], v[40:43], v[216:219], v[108:111]
    s_waitcnt lgkmcnt(2)
    v_cvt_pk_bf16_f32 v190, v16, v17
    v_add_f32 v8, v8, v18
    v_mfma_f32_16x16x32_bf16 v[80:83], v[24:27], a[192:195], v[128:131]
    ds_read_b128 v[40:43], v2 offset:12416
    v_add_f32 v8, v8, v19
    v_mfma_f32_16x16x32_bf16 v[80:83], v[28:31], a[196:199], v[80:83]
    s_mov_b32 s30, s29
    v_cvt_pk_bf16_f32 v191, v18, v19
    v_mfma_f32_16x16x32_bf16 v[84:87], v[28:31], a[220:223], v[132:135]
    v_exp_f32 v16, v64
    v_mfma_f32_16x16x32_bf16 v[84:87], v[24:27], a[216:219], v[84:87]
    s_waitcnt vmcnt(20)
    buffer_load_dwordx4 v4, s[4:7], s27 offen offset:0 sc1 lds
    v_mfma_f32_16x16x32_bf16 v[88:91], v[24:27], a[240:243], v[136:139]
    ds_read_b128 v[44:47], v3 offset:12416
    v_lshlrev_b32 v48, 16, v60
    v_mfma_f32_16x16x32_bf16 v[88:91], v[28:31], a[244:247], v[88:91]
    v_exp_f32 v17, v65
    v_mfma_f32_16x16x32_bf16 v[92:95], v[28:31], v[204:207], v[140:143]
    v_exp_f32 v18, v66
    v_mfma_f32_16x16x32_bf16 v[92:95], v[24:27], v[200:203], v[92:95]
    s_waitcnt lgkmcnt(2)
    v_add_f32 v5, v5, v16
    v_add_f32 v5, v5, v17
    v_mfma_f32_16x16x32_bf16 v[112:115], v[32:35], a[192:195], v[128:131]
    ds_read_b128 v[24:27], v2 offset:18560
    v_and_b32 v49, s97, v60
    v_mfma_f32_16x16x32_bf16 v[112:115], v[36:39], a[196:199], v[112:115]
    v_exp_f32 v19, v67
    v_mfma_f32_16x16x32_bf16 v[116:119], v[36:39], a[220:223], v[132:135]
    v_cvt_pk_bf16_f32 v64, v16, v17
    v_lshlrev_b32 v50, 16, v62
    v_mfma_f32_16x16x32_bf16 v[116:119], v[32:35], a[216:219], v[116:119]
    v_exp_f32 v16, v96
    v_mfma_f32_16x16x32_bf16 v[120:123], v[32:35], a[240:243], v[136:139]
    ds_read_b128 v[28:31], v3 offset:18560
    v_add_f32 v5, v5, v18
    v_mfma_f32_16x16x32_bf16 v[120:123], v[36:39], a[244:247], v[120:123]
    v_add_f32 v5, v5, v19
    v_and_b32 v51, s97, v62
    v_mfma_f32_16x16x32_bf16 v[124:127], v[36:39], v[204:207], v[140:143]
    v_exp_f32 v17, v97
    v_mfma_f32_16x16x32_bf16 v[124:127], v[32:35], v[200:203], v[124:127]
    s_waitcnt lgkmcnt(2)
    buffer_load_dwordx4 v4, s[4:7], s27 offen offset:1024 sc1 lds
    v_mfma_f32_16x16x32_bf16 v[80:83], v[40:43], a[200:203], v[80:83]
    ds_read_b128 v[32:35], v2 offset:12544
    v_cvt_pk_bf16_f32 v65, v18, v19
    v_mfma_f32_16x16x32_bf16 v[80:83], v[44:47], a[204:207], v[80:83]
    v_exp_f32 v18, v98
    v_mfma_f32_16x16x32_bf16 v[84:87], v[44:47], a[228:231], v[84:87]
    v_add_f32 v5, v5, v16
    v_add_f32 v5, v5, v17
    v_mfma_f32_16x16x32_bf16 v[84:87], v[40:43], a[224:227], v[84:87]
    v_exp_f32 v19, v99
    v_mfma_f32_16x16x32_bf16 v[88:91], v[40:43], a[248:251], v[88:91]
    ds_read_b128 v[36:39], v3 offset:12544
    v_cvt_pk_bf16_f32 v66, v16, v17
    v_mfma_f32_16x16x32_bf16 v[88:91], v[44:47], a[252:255], v[88:91]
    v_exp_f32 v16, v68
    v_mfma_f32_16x16x32_bf16 v[92:95], v[44:47], v[212:215], v[92:95]
    v_add_u32 v1, s3, v1
    v_mul_f32_e64 v50, -v50, v48
    v_mfma_f32_16x16x32_bf16 v[92:95], v[40:43], v[208:211], v[92:95]
    s_waitcnt lgkmcnt(2)
    v_add_f32 v5, v5, v18
    v_add_f32 v5, v5, v19
    v_mfma_f32_16x16x32_bf16 v[112:115], v[24:27], a[200:203], v[112:115]
    ds_read_b128 v[40:43], v2 offset:18688
    v_mul_f32_e64 v51, -v51, v49
    v_mfma_f32_16x16x32_bf16 v[112:115], v[28:31], a[204:207], v[112:115]
    buffer_load_dwordx4 v4, s[4:7], s27 offen offset:2048 sc1 lds
    v_mfma_f32_16x16x32_bf16 v[116:119], v[28:31], a[228:231], v[116:119]
    v_exp_f32 v17, v69
    v_mfma_f32_16x16x32_bf16 v[116:119], v[24:27], a[224:227], v[116:119]
    v_cvt_pk_bf16_f32 v67, v18, v19
    v_cvt_f32_i32 v240, v240
    v_mfma_f32_16x16x32_bf16 v[120:123], v[24:27], a[248:251], v[120:123]
    ds_read_b128 v[44:47], v3 offset:18688
    v_mfma_f32_16x16x32_bf16 v[120:123], v[28:31], a[252:255], v[120:123]
    s_waitcnt lgkmcnt(2)
    v_exp_f32 v18, v70
    v_mfma_f32_16x16x32_bf16 v[124:127], v[28:31], v[212:215], v[124:127]
    s_waitcnt vmcnt(13)
    v_add_f32 v6, v6, v16
    v_add_f32 v6, v6, v17
    v_mfma_f32_16x16x32_bf16 v[124:127], v[24:27], v[208:211], v[124:127]
    s_barrier
    v_mfma_f32_16x16x32_bf16 v[80:83], v[32:35], a[208:211], v[80:83]
    ds_read_b128 v[24:27], v1 offset:0
    v_cvt_f32_i32 v244, v244
    v_mfma_f32_16x16x32_bf16 v[80:83], v[36:39], a[212:215], v[80:83]
    v_exp_f32 v19, v71
    v_mfma_f32_16x16x32_bf16 v[84:87], v[36:39], a[236:239], v[84:87]
    v_cvt_pk_bf16_f32 v68, v16, v17
    v_fma_f32 v240, v240, v48, v50
    v_mfma_f32_16x16x32_bf16 v[84:87], v[32:35], a[232:235], v[84:87]
    v_exp_f32 v16, v100
    v_mfma_f32_16x16x32_bf16 v[88:91], v[32:35], v[192:195], v[88:91]
    ds_read_b128 v[28:31], v1 offset:12288
    v_add_f32 v6, v6, v18
    v_mfma_f32_16x16x32_bf16 v[88:91], v[36:39], v[196:199], v[88:91]
    v_add_f32 v6, v6, v19
    v_fma_f32 v244, v244, v49, v51
    v_mfma_f32_16x16x32_bf16 v[92:95], v[36:39], v[220:223], v[92:95]
    v_exp_f32 v17, v101
    v_mfma_f32_16x16x32_bf16 v[92:95], v[32:35], v[216:219], v[92:95]
    s_waitcnt lgkmcnt(2)
    v_cvt_pk_bf16_f32 v69, v18, v19
    v_mfma_f32_16x16x32_bf16 v[112:115], v[40:43], a[208:211], v[112:115]
    ds_read_b128 v[32:35], v1 offset:1024
    v_mfma_f32_16x16x32_bf16 v[112:115], v[44:47], a[212:215], v[112:115]
    v_exp_f32 v18, v102
    v_mfma_f32_16x16x32_bf16 v[116:119], v[44:47], a[236:239], v[116:119]
    v_add_f32 v6, v6, v16
    v_add_f32 v6, v6, v17
    v_mfma_f32_16x16x32_bf16 v[116:119], v[40:43], a[232:235], v[116:119]
    s_add_u32 s27, s27, 24576
    v_exp_f32 v19, v103
    v_mfma_f32_16x16x32_bf16 v[120:123], v[40:43], v[192:195], v[120:123]
    s_add_u32 s56, s56, 36864
    ds_read_b128 v[36:39], v1 offset:13312
    v_cvt_pk_bf16_f32 v70, v16, v17
    v_mfma_f32_16x16x32_bf16 v[120:123], v[44:47], v[196:199], v[120:123]
    s_sub_u32 s58, s56, 147456
    v_add_f32 v6, v6, v18
    v_add_f32 v6, v6, v19
    v_mfma_f32_16x16x32_bf16 v[124:127], v[44:47], v[220:223], v[124:127]
    s_min_u32 s56, s56, s58
    v_cvt_pk_bf16_f32 v71, v18, v19
    v_mfma_f32_16x16x32_bf16 v[124:127], v[40:43], v[216:219], v[124:127]
    s_waitcnt lgkmcnt(2)
    v_mfma_f32_16x16x32_bf16 a[0:3], v[160:163], v[24:27], a[0:3]
    s_mov_b32 m0, s56
    ds_read_b128 v[40:43], v1 offset:2048
    v_cvt_f32_i32 v241, v241
    v_mfma_f32_16x16x32_bf16 a[0:3], v[176:179], v[28:31], a[0:3]
    buffer_load_dwordx4 v4, s[4:7], s27 offen offset:0 sc1 lds
    v_mfma_f32_16x16x32_bf16 a[48:51], v[180:183], v[28:31], a[48:51]
    v_exp_f32 v16, v72
    v_mfma_f32_16x16x32_bf16 a[48:51], v[164:167], v[24:27], a[48:51]
    v_exp_f32 v17, v73
    v_mfma_f32_16x16x32_bf16 a[96:99], v[168:171], v[24:27], a[96:99]
    ds_read_b128 v[44:47], v1 offset:14336
    v_cvt_f32_i32 v245, v245
    v_mfma_f32_16x16x32_bf16 a[96:99], v[184:187], v[28:31], a[96:99]
    v_exp_f32 v18, v74
    v_mfma_f32_16x16x32_bf16 a[144:147], v[188:191], v[28:31], a[144:147]
    v_add_f32 v7, v7, v16
    v_add_f32 v7, v7, v17
    v_mfma_f32_16x16x32_bf16 a[144:147], v[172:175], v[24:27], a[144:147]
    s_waitcnt lgkmcnt(2)
    v_exp_f32 v19, v75
    v_mfma_f32_16x16x32_bf16 a[4:7], v[160:163], v[32:35], a[4:7]
    ds_read_b128 v[24:27], v1 offset:3072
    v_fma_f32 v241, v241, v48, v50
    v_mfma_f32_16x16x32_bf16 a[4:7], v[176:179], v[36:39], a[4:7]
    buffer_load_dwordx4 v4, s[4:7], s27 offen offset:1024 sc1 lds
    v_mfma_f32_16x16x32_bf16 a[52:55], v[180:183], v[36:39], a[52:55]
    v_cvt_pk_bf16_f32 v72, v16, v17
    v_fma_f32 v245, v245, v49, v51
    v_mfma_f32_16x16x32_bf16 a[52:55], v[164:167], v[32:35], a[52:55]
    v_exp_f32 v16, v104
    v_mfma_f32_16x16x32_bf16 a[100:103], v[168:171], v[32:35], a[100:103]
    ds_read_b128 v[28:31], v1 offset:15360
    v_add_f32 v7, v7, v18
    v_mfma_f32_16x16x32_bf16 a[100:103], v[184:187], v[36:39], a[100:103]
    buffer_load_dword v52, v20, s[20:23], s44 offen sc1
    v_mfma_f32_16x16x32_bf16 a[148:151], v[188:191], v[36:39], a[148:151]
    v_add_f32 v7, v7, v19
    v_cvt_f32_i32 v242, v242
    v_mfma_f32_16x16x32_bf16 a[148:151], v[172:175], v[32:35], a[148:151]
    s_waitcnt lgkmcnt(2)
    v_exp_f32 v17, v105
    v_mfma_f32_16x16x32_bf16 a[8:11], v[160:163], v[40:43], a[8:11]
    ds_read_b128 v[32:35], v1 offset:4096
    v_cvt_pk_bf16_f32 v73, v18, v19
    v_mfma_f32_16x16x32_bf16 a[8:11], v[176:179], v[44:47], a[8:11]
    v_exp_f32 v18, v106
    v_mfma_f32_16x16x32_bf16 a[56:59], v[180:183], v[44:47], a[56:59]
    v_add_f32 v7, v7, v16
    v_cvt_f32_i32 v246, v246
    v_mfma_f32_16x16x32_bf16 a[56:59], v[164:167], v[40:43], a[56:59]
    buffer_load_dwordx4 v4, s[4:7], s27 offen offset:2048 sc1 lds
    v_mfma_f32_16x16x32_bf16 a[104:107], v[168:171], v[40:43], a[104:107]
    ds_read_b128 v[36:39], v1 offset:16384
    v_add_f32 v7, v7, v17
    v_mfma_f32_16x16x32_bf16 a[104:107], v[184:187], v[44:47], a[104:107]
    v_exp_f32 v19, v107
    v_mfma_f32_16x16x32_bf16 a[152:155], v[188:191], v[44:47], a[152:155]
    v_cvt_pk_bf16_f32 v74, v16, v17
    v_fma_f32 v242, v242, v48, v50
    v_mfma_f32_16x16x32_bf16 a[152:155], v[172:175], v[40:43], a[152:155]
    s_waitcnt lgkmcnt(2)
    v_exp_f32 v16, v76
    v_mfma_f32_16x16x32_bf16 a[12:15], v[160:163], v[24:27], a[12:15]
    ds_read_b128 v[40:43], v1 offset:5120
    v_add_f32 v7, v7, v18
    v_mfma_f32_16x16x32_bf16 a[12:15], v[176:179], v[28:31], a[12:15]
    s_add_u32 s27, s27, 24576
    v_add_f32 v7, v7, v19
    v_fma_f32 v246, v246, v49, v51
    v_mfma_f32_16x16x32_bf16 a[60:63], v[180:183], v[28:31], a[60:63]
    v_exp_f32 v17, v77
    v_mfma_f32_16x16x32_bf16 a[60:63], v[164:167], v[24:27], a[60:63]
    v_cvt_pk_bf16_f32 v75, v18, v19
    v_lshlrev_b32 v48, 16, v61
    v_mfma_f32_16x16x32_bf16 a[108:111], v[168:171], v[24:27], a[108:111]
    ds_read_b128 v[44:47], v1 offset:17408
    v_and_b32 v49, s97, v61
    v_mfma_f32_16x16x32_bf16 a[108:111], v[184:187], v[28:31], a[108:111]
L_pg4:
    s_cbranch_execz L_pg8
    v_exp_f32 v18, v78
    v_mfma_f32_16x16x32_bf16 a[156:159], v[188:191], v[28:31], a[156:159]
    s_add_u32 s29, s28, 49152
    v_add_f32 v8, v8, v16
    v_add_f32 v8, v8, v17
    v_mfma_f32_16x16x32_bf16 a[156:159], v[172:175], v[24:27], a[156:159]
    s_waitcnt lgkmcnt(2)
    v_exp_f32 v19, v79
    v_mfma_f32_16x16x32_bf16 a[16:19], v[160:163], v[32:35], a[16:19]
    s_sub_u32 s3, s29, 147456
    ds_read_b128 v[24:27], v1 offset:6144
    v_lshlrev_b32 v50, 16, v63
    v_mfma_f32_16x16x32_bf16 a[16:19], v[176:179], v[36:39], a[16:19]
    s_add_u32 s56, s56, 12288
    v_cvt_pk_bf16_f32 v76, v16, v17
    v_and_b32 v51, s97, v63
    v_mfma_f32_16x16x32_bf16 a[64:67], v[180:183], v[36:39], a[64:67]
    s_min_u32 s29, s29, s3
    v_exp_f32 v16, v108
    v_mfma_f32_16x16x32_bf16 a[64:67], v[164:167], v[32:35], a[64:67]
    s_mov_b32 m0, s56
    v_add_f32 v8, v8, v18
    v_add_f32 v8, v8, v19
    v_mfma_f32_16x16x32_bf16 a[112:115], v[168:171], v[32:35], a[112:115]
    ds_read_b128 v[28:31], v1 offset:18432
    v_mul_f32_e64 v50, -v50, v48
    v_mfma_f32_16x16x32_bf16 a[112:115], v[184:187], v[36:39], a[112:115]
    v_exp_f32 v17, v109
    v_mfma_f32_16x16x32_bf16 a[160:163], v[188:191], v[36:39], a[160:163]
    v_cvt_pk_bf16_f32 v77, v18, v19
    v_mul_f32_e64 v51, -v51, v49
    v_mfma_f32_16x16x32_bf16 a[160:163], v[172:175], v[32:35], a[160:163]
    s_waitcnt lgkmcnt(2)
    v_exp_f32 v18, v110
    v_mfma_f32_16x16x32_bf16 a[20:23], v[160:163], v[40:43], a[20:23]
    s_sub_u32 s3, s29, s28
    ds_read_b128 v[32:35], v1 offset:7168
    v_add_f32 v8, v8, v16
    v_mfma_f32_16x16x32_bf16 a[20:23], v[176:179], v[44:47], a[20:23]
    v_add_f32 v8, v8, v17
    v_cvt_f32_i32 v248, v248
    v_mfma_f32_16x16x32_bf16 a[68:71], v[180:183], v[44:47], a[68:71]
    v_exp_f32 v19, v111
    v_mfma_f32_16x16x32_bf16 a[68:71], v[164:167], v[40:43], a[68:71]
    buffer_load_dwordx4 v4, s[4:7], s27 offen offset:0 sc1 lds
    v_mfma_f32_16x16x32_bf16 a[116:119], v[168:171], v[40:43], a[116:119]
    ds_read_b128 v[36:39], v1 offset:19456
    v_cvt_pk_bf16_f32 v78, v16, v17
    v_mfma_f32_16x16x32_bf16 a[116:119], v[184:187], v[44:47], a[116:119]
    v_add_f32 v8, v8, v18
    v_cvt_f32_i32 v252, v252
    v_mfma_f32_16x16x32_bf16 a[164:167], v[188:191], v[44:47], a[164:167]
    s_mov_b32 s28, s29
    v_add_f32 v8, v8, v19
    v_cvt_pk_bf16_f32 v79, v18, v19
    v_mfma_f32_16x16x32_bf16 a[164:167], v[172:175], v[40:43], a[164:167]
    s_waitcnt lgkmcnt(2)
    v_exp_f32 v16, v80
    v_mfma_f32_16x16x32_bf16 a[24:27], v[160:163], v[24:27], a[24:27]
    ds_read_b128 v[40:43], v1 offset:8192
    v_fma_f32 v248, v248, v48, v50
    v_mfma_f32_16x16x32_bf16 a[24:27], v[176:179], v[28:31], a[24:27]
    v_exp_f32 v17, v81
    v_mfma_f32_16x16x32_bf16 a[72:75], v[180:183], v[28:31], a[72:75]
    v_fma_f32 v252, v252, v49, v51
    v_cvt_f32_i32 v249, v249
    v_mfma_f32_16x16x32_bf16 a[72:75], v[164:167], v[24:27], a[72:75]
    buffer_load_dwordx4 v4, s[4:7], s27 offen offset:1024 sc1 lds
    v_mfma_f32_16x16x32_bf16 a[120:123], v[168:171], v[24:27], a[120:123]
    ds_read_b128 v[44:47], v1 offset:20480
    v_cvt_f32_i32 v253, v253
    v_mfma_f32_16x16x32_bf16 a[120:123], v[184:187], v[28:31], a[120:123]
    v_exp_f32 v18, v82
    v_mfma_f32_16x16x32_bf16 a[168:171], v[188:191], v[28:31], a[168:171]
    v_add_f32 v5, v5, v16
    v_add_f32 v5, v5, v17
    v_mfma_f32_16x16x32_bf16 a[168:171], v[172:175], v[24:27], a[168:171]
    s_waitcnt lgkmcnt(2)
    v_exp_f32 v19, v83
    v_mfma_f32_16x16x32_bf16 a[28:31], v[160:163], v[32:35], a[28:31]
    ds_read_b128 v[24:27], v1 offset:9216
    v_cvt_pk_bf16_f32 v80, v16, v17
    v_mfma_f32_16x16x32_bf16 a[28:31], v[176:179], v[36:39], a[28:31]
    v_exp_f32 v16, v112
    v_mfma_f32_16x16x32_bf16 a[76:79], v[180:183], v[36:39], a[76:79]
    v_add_f32 v5, v5, v18
    v_fma_f32 v249, v249, v48, v50
    v_mfma_f32_16x16x32_bf16 a[76:79], v[164:167], v[32:35], a[76:79]
    v_add_f32 v5, v5, v19
    v_add_u32 v2, s3, v2
    v_mfma_f32_16x16x32_bf16 a[124:127], v[168:171], v[32:35], a[124:127]
    ds_read_b128 v[28:31], v1 offset:21504
    v_fma_f32 v253, v253, v49, v51
    v_mfma_f32_16x16x32_bf16 a[124:127], v[184:187], v[36:39], a[124:127]
    buffer_load_dwordx4 v4, s[4:7], s27 offen offset:2048 sc1 lds
    v_mfma_f32_16x16x32_bf16 a[172:175], v[188:191], v[36:39], a[172:175]
    v_exp_f32 v17, v113
    v_mfma_f32_16x16x32_bf16 a[172:175], v[172:175], v[32:35], a[172:175]
    s_waitcnt lgkmcnt(2)
    v_cvt_pk_bf16_f32 v81, v18, v19
    v_cvt_f32_i32 v250, v250
    v_mfma_f32_16x16x32_bf16 a[32:35], v[160:163], v[40:43], a[32:35]
    ds_read_b128 v[32:35], v1 offset:10240
    v_add_u32 v3, s3, v3
    v_mfma_f32_16x16x32_bf16 a[32:35], v[176:179], v[44:47], a[32:35]
    v_exp_f32 v18, v114
    v_mfma_f32_16x16x32_bf16 a[80:83], v[180:183], v[44:47], a[80:83]
    v_add_f32 v5, v5, v16
    v_add_f32 v5, v5, v17
    v_mfma_f32_16x16x32_bf16 a[80:83], v[164:167], v[40:43], a[80:83]
    v_exp_f32 v19, v115
    v_mfma_f32_16x16x32_bf16 a[128:131], v[168:171], v[40:43], a[128:131]
    ds_read_b128 v[36:39], v1 offset:22528
    v_cvt_pk_bf16_f32 v82, v16, v17
    v_mfma_f32_16x16x32_bf16 a[128:131], v[184:187], v[44:47], a[128:131]
    v_exp_f32 v16, v84
    v_mfma_f32_16x16x32_bf16 a[176:179], v[188:191], v[44:47], a[176:179]
    v_cvt_f32_i32 v254, v254
    v_add_f32 v5, v5, v18
    v_mfma_f32_16x16x32_bf16 a[176:179], v[172:175], v[40:43], a[176:179]
    s_waitcnt lgkmcnt(2)
    v_add_f32 v5, v5, v19
    v_fma_f32 v250, v250, v48, v50
    v_mfma_f32_16x16x32_bf16 a[36:39], v[160:163], v[24:27], a[36:39]
    ds_read_b128 v[40:43], v1 offset:11264
    v_fma_f32 v254, v254, v49, v51
    v_mfma_f32_16x16x32_bf16 a[36:39], v[176:179], v[28:31], a[36:39]
    v_exp_f32 v17, v85
    v_mfma_f32_16x16x32_bf16 a[84:87], v[180:183], v[28:31], a[84:87]
    v_cvt_pk_bf16_f32 v83, v18, v19
    v_cvt_pk_bf16_f32 v146, v240, v244
    v_mfma_f32_16x16x32_bf16 a[84:87], v[164:167], v[24:27], a[84:87]
    s_add_u32 s27, s27, 24576
    v_exp_f32 v18, v86
    v_mfma_f32_16x16x32_bf16 a[132:135], v[168:171], v[24:27], a[132:135]
    s_add_u32 s56, s56, 36864
    ds_read_b128 v[44:47], v1 offset:23552
    v_add_f32 v6, v6, v16
    v_mfma_f32_16x16x32_bf16 a[132:135], v[184:187], v[28:31], a[132:135]
    s_sub_u32 s58, s56, 147456
    v_add_f32 v6, v6, v17
    v_cvt_pk_bf16_f32 v150, v241, v245
    v_mfma_f32_16x16x32_bf16 a[180:183], v[188:191], v[28:31], a[180:183]
    v_exp_f32 v19, v87
    v_mfma_f32_16x16x32_bf16 a[180:183], v[172:175], v[24:27], a[180:183]
    s_waitcnt lgkmcnt(2)
    v_cvt_pk_bf16_f32 v84, v16, v17
    v_cvt_pk_bf16_f32 v147, v248, v252
    v_mfma_f32_16x16x32_bf16 a[40:43], v[160:163], v[32:35], a[40:43]
    s_min_u32 s56, s56, s58
    ds_read_b128 v[24:27], v2 offset:0
    v_mfma_f32_16x16x32_bf16 a[40:43], v[176:179], v[36:39], a[40:43]
    v_exp_f32 v16, v116
    v_mfma_f32_16x16x32_bf16 a[88:91], v[180:183], v[36:39], a[88:91]
    v_add_f32 v6, v6, v18
    v_add_f32 v6, v6, v19
    v_mfma_f32_16x16x32_bf16 a[88:91], v[164:167], v[32:35], a[88:91]
    v_exp_f32 v17, v117
    v_mfma_f32_16x16x32_bf16 a[136:139], v[168:171], v[32:35], a[136:139]
    ds_read_b128 v[28:31], v3 offset:0
    v_cvt_pk_bf16_f32 v151, v249, v253
    v_mfma_f32_16x16x32_bf16 a[136:139], v[184:187], v[36:39], a[136:139]
    v_cvt_pk_bf16_f32 v85, v18, v19
    v_cvt_pk_bf16_f32 v154, v242, v246
    v_mfma_f32_16x16x32_bf16 a[184:187], v[188:191], v[36:39], a[184:187]
    v_exp_f32 v18, v118
    v_mfma_f32_16x16x32_bf16 a[184:187], v[172:175], v[32:35], a[184:187]
    s_waitcnt lgkmcnt(2)
    v_add_f32 v6, v6, v16
    v_mfma_f32_16x16x32_bf16 a[44:47], v[160:163], v[40:43], a[44:47]
    ds_read_b128 v[32:35], v2 offset:6144
    v_add_f32 v6, v6, v17
    v_mfma_f32_16x16x32_bf16 a[44:47], v[176:179], v[44:47], a[44:47]
    v_exp_f32 v19, v119
    v_mfma_f32_16x16x32_bf16 a[92:95], v[180:183], v[44:47], a[92:95]
    v_cvt_pk_bf16_f32 v155, v250, v254
    v_mfma_f32_16x16x32_bf16 a[92:95], v[164:167], v[40:43], a[92:95]
    v_cvt_pk_bf16_f32 v86, v16, v17
    v_mfma_f32_16x16x32_bf16 a[140:143], v[168:171], v[40:43], a[140:143]
    ds_read_b128 v[36:39], v3 offset:6144
    v_add_f32 v6, v6, v18
    v_mfma_f32_16x16x32_bf16 a[140:143], v[184:187], v[44:47], a[140:143]
    v_add_f32 v6, v6, v19
    v_cvt_pk_bf16_f32 v87, v18, v19
    v_mfma_f32_16x16x32_bf16 a[188:191], v[188:191], v[44:47], a[188:191]
    v_mfma_f32_16x16x32_bf16 a[188:191], v[172:175], v[40:43], a[188:191]
    s_waitcnt lgkmcnt(2)
L_join:
    v_mfma_f32_16x16x32_bf16 v[160:163], v[24:27], a[192:195], v[128:131]
L_pg5:
    s_cbranch_execz L_pg9
    ds_read_b128 v[40:43], v2 offset:128
    v_mfma_f32_16x16x32_bf16 v[160:163], v[28:31], a[196:199], v[160:163]
    s_waitcnt vmcnt(4)
    v_subrev_u32 v52, s92, v52
    v_cmp_lt_u32 vcc, 15, v52
    v_mfma_f32_16x16x32_bf16 v[164:167], v[28:31], a[220:223], v[132:135]
    v_exp_f32 v16, v88
    v_mfma_f32_16x16x32_bf16 v[164:167], v[24:27], a[216:219], v[164:167]
    v_exp_f32 v17, v89
    v_mfma_f32_16x16x32_bf16 v[168:171], v[24:27], a[240:243], v[136:139]
    s_and_b32 s59, vcc_lo, 0xff
    ds_read_b128 v[44:47], v3 offset:128
    v_mfma_f32_16x16x32_bf16 v[168:171], v[28:31], a[244:247], v[168:171]
    s_cbranch_scc1 L_pollslow1
L_pollok1:
    v_mfma_f32_16x16x32_bf16 v[172:175], v[28:31], v[204:207], v[140:143]
    s_add_u32 s92, s92, 1
    v_exp_f32 v18, v90
    v_mfma_f32_16x16x32_bf16 v[172:175], v[24:27], v[200:203], v[172:175]
    s_waitcnt lgkmcnt(2)
    v_add_f32 v7, v7, v16
    v_add_f32 v7, v7, v17
    v_mfma_f32_16x16x32_bf16 v[96:99], v[32:35], a[192:195], v[128:131]
    ds_read_b128 v[24:27], v2 offset:6272
    v_mfma_f32_16x16x32_bf16 v[96:99], v[36:39], a[196:199], v[96:99]
    buffer_store_dwordx4 v[144:147], v15, s[4:7], s35 offen offset:0 sc1
    v_mfma_f32_16x16x32_bf16 v[100:103], v[36:39], a[220:223], v[132:135]
    v_exp_f32 v19, v91
    v_mfma_f32_16x16x32_bf16 v[100:103], v[32:35], a[216:219], v[100:103]
    v_cvt_pk_bf16_f32 v88, v16, v17
    v_mfma_f32_16x16x32_bf16 v[104:107], v[32:35], a[240:243], v[136:139]
    ds_read_b128 v[28:31], v3 offset:6272
    v_mfma_f32_16x16x32_bf16 v[104:107], v[36:39], a[244:247], v[104:107]
    v_exp_f32 v16, v120
    v_mfma_f32_16x16x32_bf16 v[108:111], v[36:39], v[204:207], v[140:143]
    v_add_f32 v7, v7, v18
    v_add_f32 v7, v7, v19
    v_mfma_f32_16x16x32_bf16 v[108:111], v[32:35], v[200:203], v[108:111]
    s_waitcnt lgkmcnt(2)
    v_exp_f32 v17, v121
    v_mfma_f32_16x16x32_bf16 v[160:163], v[40:43], a[200:203], v[160:163]
    ds_read_b128 v[32:35], v2 offset:256
    v_cvt_pk_bf16_f32 v89, v18, v19
    v_mfma_f32_16x16x32_bf16 v[160:163], v[44:47], a[204:207], v[160:163]
    buffer_store_dwordx4 v[148:151], v15, s[4:7], s35 offen offset:1024 sc1
    v_mfma_f32_16x16x32_bf16 v[164:167], v[44:47], a[228:231], v[164:167]
    v_exp_f32 v18, v122
    v_mfma_f32_16x16x32_bf16 v[164:167], v[40:43], a[224:227], v[164:167]
    v_add_f32 v7, v7, v16
    v_add_f32 v7, v7, v17
    v_mfma_f32_16x16x32_bf16 v[168:171], v[40:43], a[248:251], v[168:171]
    ds_read_b128 v[36:39], v3 offset:256
    v_mfma_f32_16x16x32_bf16 v[168:171], v[44:47], a[252:255], v[168:171]
    v_exp_f32 v19, v123
    v_mfma_f32_16x16x32_bf16 v[172:175], v[44:47], v[212:215], v[172:175]
    v_cvt_pk_bf16_f32 v90, v16, v17
    v_mfma_f32_16x16x32_bf16 v[172:175], v[40:43], v[208:211], v[172:175]
    s_waitcnt lgkmcnt(2)
    v_exp_f32 v16, v92
    v_mfma_f32_16x16x32_bf16 v[96:99], v[24:27], a[200:203], v[96:99]
    ds_read_b128 v[40:43], v2 offset:6400
    v_add_f32 v7, v7, v18
    v_mfma_f32_16x16x32_bf16 v[96:99], v[28:31], a[204:207], v[96:99]
    buffer_store_dwordx4 v[152:155], v15, s[4:7], s35 offen offset:2048 sc1
    v_mfma_f32_16x16x32_bf16 v[100:103], v[28:31], a[228:231], v[100:103]
    v_add_f32 v7, v7, v19
    v_mfma_f32_16x16x32_bf16 v[100:103], v[24:27], a[224:227], v[100:103]
    v_exp_f32 v17, v93
    v_mfma_f32_16x16x32_bf16 v[104:107], v[24:27], a[248:251], v[104:107]
    ds_read_b128 v[44:47], v3 offset:6400
    v_cvt_pk_bf16_f32 v91, v18, v19
    v_mfma_f32_16x16x32_bf16 v[104:107], v[28:31], a[252:255], v[104:107]
    v_exp_f32 v18, v94
    v_mfma_f32_16x16x32_bf16 v[108:111], v[28:31], v[212:215], v[108:111]
    s_add_u32 s29, s30, 49152
    v_add_f32 v8, v8, v16
    v_add_f32 v8, v8, v17
    v_mfma_f32_16x16x32_bf16 v[108:111], v[24:27], v[208:211], v[108:111]
    s_waitcnt lgkmcnt(2)
    v_exp_f32 v19, v95
    v_mfma_f32_16x16x32_bf16 v[160:163], v[32:35], a[208:211], v[160:163]
    s_sub_u32 s3, s29, 147456
    ds_read_b128 v[24:27], v2 offset:12288
    v_cvt_pk_bf16_f32 v92, v16, v17
    v_mfma_f32_16x16x32_bf16 v[160:163], v[36:39], a[212:215], v[160:163]
    s_min_u32 s29, s29, s3
    v_exp_f32 v16, v124
    v_mfma_f32_16x16x32_bf16 v[164:167], v[36:39], a[236:239], v[164:167]
    v_add_f32 v8, v8, v18
    v_add_f32 v8, v8, v19
    v_mfma_f32_16x16x32_bf16 v[164:167], v[32:35], a[232:235], v[164:167]
    v_exp_f32 v17, v125
    v_mfma_f32_16x16x32_bf16 v[168:171], v[32:35], v[192:195], v[168:171]
    ds_read_b128 v[28:31], v3 offset:12288
    v_mfma_f32_16x16x32_bf16 v[168:171], v[36:39], v[196:199], v[168:171]
    v_cvt_pk_bf16_f32 v93, v18, v19
    v_mfma_f32_16x16x32_bf16 v[172:175], v[36:39], v[220:223], v[172:175]
    v_exp_f32 v18, v126
    v_mfma_f32_16x16x32_bf16 v[172:175], v[32:35], v[216:219], v[172:175]
    s_waitcnt lgkmcnt(2)
    v_add_f32 v8, v8, v16
    v_mfma_f32_16x16x32_bf16 v[96:99], v[40:43], a[208:211], v[96:99]
    s_waitcnt vmcnt(10)
    ds_read_b128 v[32:35], v2 offset:18432
    v_lshlrev_b32 v48, 16, v56
    v_mfma_f32_16x16x32_bf16 v[96:99], v[44:47], a[212:215], v[96:99]
    s_mov_b32 m0, s26
    v_add_f32 v8, v8, v17
    v_and_b32 v49, s97, v56
    v_mfma_f32_16x16x32_bf16 v[100:103], v[44:47], a[236:239], v[100:103]
    s_sub_u32 s3, s29, s30
    v_exp_f32 v19, v127
    v_mfma_f32_16x16x32_bf16 v[100:103], v[40:43], a[232:235], v[100:103]
    buffer_load_dwordx4 v4, s[4:7], s32 offen offset:0 sc1 lds
    v_mfma_f32_16x16x32_bf16 v[104:107], v[40:43], v[192:195], v[104:107]
    ds_read_b128 v[36:39], v3 offset:18432
    v_cvt_pk_bf16_f32 v94, v16, v17
    v_mfma_f32_16x16x32_bf16 v[104:107], v[44:47], v[196:199], v[104:107]
    v_add_f32 v8, v8, v18
    v_add_f32 v8, v8, v19
    v_mfma_f32_16x16x32_bf16 v[108:111], v[44:47], v[220:223], v[108:111]
    v_lshlrev_b32 v50, 16, v58
    v_cvt_pk_bf16_f32 v95, v18, v19
    v_mfma_f32_16x16x32_bf16 v[108:111], v[40:43], v[216:219], v[108:111]
    s_waitcnt lgkmcnt(2)
    buffer_load_dwordx4 v4, s[4:7], s32 offen offset:1024 sc1 lds
    v_mfma_f32_16x16x32_bf16 v[176:179], v[24:27], a[192:195], v[128:131]
    ds_read_b128 v[40:43], v2 offset:12416
    v_and_b32 v51, s97, v58
    v_mfma_f32_16x16x32_bf16 v[176:179], v[28:31], a[196:199], v[176:179]
    s_mov_b32 s30, s29
    v_exp_f32 v16, v160
    v_mfma_f32_16x16x32_bf16 v[180:183], v[28:31], a[220:223], v[132:135]
    v_exp_f32 v17, v161
    v_mfma_f32_16x16x32_bf16 v[180:183], v[24:27], a[216:219], v[180:183]
    buffer_load_dwordx4 v4, s[4:7], s32 offen offset:2048 sc1 lds
    v_mfma_f32_16x16x32_bf16 v[184:187], v[24:27], a[240:243], v[136:139]
    s_add_u32 s32, s32, 24576
    ds_read_b128 v[44:47], v3 offset:12416
    v_mul_f32 v48, s38, v48
    v_mfma_f32_16x16x32_bf16 v[184:187], v[28:31], a[244:247], v[184:187]
    v_exp_f32 v18, v162
    v_mfma_f32_16x16x32_bf16 v[188:191], v[28:31], v[204:207], v[140:143]
    s_add_u32 s26, s26, 12288
    v_add_f32 v5, v5, v16
    v_add_f32 v5, v5, v17
    v_mfma_f32_16x16x32_bf16 v[188:191], v[24:27], v[200:203], v[188:191]
    s_waitcnt lgkmcnt(2)
    v_exp_f32 v19, v163
    v_mfma_f32_16x16x32_bf16 v[112:115], v[32:35], a[192:195], v[128:131]
    s_mov_b32 m0, s26
    ds_read_b128 v[24:27], v2 offset:18560
    v_mul_f32 v49, s38, v49
    v_mfma_f32_16x16x32_bf16 v[112:115], v[36:39], a[196:199], v[112:115]
    v_cvt_pk_bf16_f32 v160, v16, v17
    v_mul_f32_e64 v50, -v50, v48
    v_mfma_f32_16x16x32_bf16 v[116:119], v[36:39], a[220:223], v[132:135]
    v_exp_f32 v16, v96
    v_mfma_f32_16x16x32_bf16 v[116:119], v[32:35], a[216:219], v[116:119]
    v_add_f32 v5, v5, v18
    v_mul_f32_e64 v51, -v51, v49
    v_mfma_f32_16x16x32_bf16 v[120:123], v[32:35], a[240:243], v[136:139]
    ds_read_b128 v[28:31], v3 offset:18560
    v_add_f32 v5, v5, v19
    v_mfma_f32_16x16x32_bf16 v[120:123], v[36:39], a[244:247], v[120:123]
    buffer_load_dwordx4 v4, s[4:7], s32 offen offset:0 sc1 lds
    v_mfma_f32_16x16x32_bf16 v[124:127], v[36:39], v[204:207], v[140:143]
    v_exp_f32 v17, v97
    v_mfma_f32_16x16x32_bf16 v[124:127], v[32:35], v[200:203], v[124:127]
    s_waitcnt lgkmcnt(2)
    v_cvt_pk_bf16_f32 v161, v18, v19
    v_cvt_f32_i32 v224, v224
    v_mfma_f32_16x16x32_bf16 v[176:179], v[40:43], a[200:203], v[176:179]
    ds_read_b128 v[32:35], v2 offset:12544
    v_cvt_f32_i32 v225, v225
    v_mfma_f32_16x16x32_bf16 v[176:179], v[44:47], a[204:207], v[176:179]
    buffer_load_dwordx4 v4, s[4:7], s32 offen offset:1024 sc1 lds
    v_mfma_f32_16x16x32_bf16 v[180:183], v[44:47], a[228:231], v[180:183]
    v_exp_f32 v18, v98
    v_mfma_f32_16x16x32_bf16 v[180:183], v[40:43], a[224:227], v[180:183]
    v_add_f32 v5, v5, v16
    v_add_f32 v5, v5, v17
    v_mfma_f32_16x16x32_bf16 v[184:187], v[40:43], a[248:251], v[184:187]
    ds_read_b128 v[36:39], v3 offset:12544
    v_fma_f32 v224, v224, v48, v50
    v_mfma_f32_16x16x32_bf16 v[184:187], v[44:47], a[252:255], v[184:187]
    buffer_load_dwordx4 v4, s[4:7], s32 offen offset:2048 sc1 lds
    v_mfma_f32_16x16x32_bf16 v[188:191], v[44:47], v[212:215], v[188:191]
    v_exp_f32 v19, v99
    v_mfma_f32_16x16x32_bf16 v[188:191], v[40:43], v[208:211], v[188:191]
    s_waitcnt lgkmcnt(2)
    v_cvt_pk_bf16_f32 v162, v16, v17
    v_fma_f32 v225, v225, v49, v51
    v_mfma_f32_16x16x32_bf16 v[112:115], v[24:27], a[200:203], v[112:115]
    ds_read_b128 v[40:43], v2 offset:18688
    v_add_u32 v1, s3, v1
    v_mfma_f32_16x16x32_bf16 v[112:115], v[28:31], a[204:207], v[112:115]
    v_exp_f32 v16, v164
    v_mfma_f32_16x16x32_bf16 v[116:119], v[28:31], a[228:231], v[116:119]
    v_add_f32 v5, v5, v18
    v_add_f32 v5, v5, v19
    v_mfma_f32_16x16x32_bf16 v[116:119], v[24:27], a[224:227], v[116:119]
    s_add_u32 s32, s32, 24576
    v_exp_f32 v17, v165
    v_mfma_f32_16x16x32_bf16 v[120:123], v[24:27], a[248:251], v[120:123]
    s_add_u32 s26, s26, 36864
    ds_read_b128 v[44:47], v3 offset:18688
    v_cvt_pk_bf16_f32 v163, v18, v19
    v_mfma_f32_16x16x32_bf16 v[120:123], v[28:31], a[252:255], v[120:123]
    s_waitcnt lgkmcnt(2)
    v_exp_f32 v18, v166
    v_mfma_f32_16x16x32_bf16 v[124:127], v[28:31], v[212:215], v[124:127]
    s_waitcnt vmcnt(6)
    v_cvt_pk_bf16_f32 v224, v224, v225
    v_add_f32 v6, v6, v16
    v_mfma_f32_16x16x32_bf16 v[124:127], v[24:27], v[208:211], v[124:127]
    s_barrier
    v_mfma_f32_16x16x32_bf16 v[176:179], v[32:35], a[208:211], v[176:179]
    s_sub_u32 s57, s26, 147456
    ds_read_b128 v[24:27], v1 offset:0
    v_add_f32 v6, v6, v17
    v_mfma_f32_16x16x32_bf16 v[176:179], v[36:39], a[212:215], v[176:179]
    s_min_u32 s26, s26, s57
    v_exp_f32 v19, v167
    v_mfma_f32_16x16x32_bf16 v[180:183], v[36:39], a[236:239], v[180:183]
    v_cvt_f32_i32 v228, v228
    v_cvt_pk_bf16_f32 v164, v16, v17
    v_mfma_f32_16x16x32_bf16 v[180:183], v[32:35], a[232:235], v[180:183]
    v_cvt_f32_i32 v229, v229
    v_fma_f32 v228, v228, v48, v50
    v_mfma_f32_16x16x32_bf16 v[184:187], v[32:35], v[192:195], v[184:187]
    ds_read_b128 v[28:31], v1 offset:12288
    v_fma_f32 v229, v229, v49, v51
    v_mfma_f32_16x16x32_bf16 v[184:187], v[36:39], v[196:199], v[184:187]
    v_exp_f32 v16, v100
    v_mfma_f32_16x16x32_bf16 v[188:191], v[36:39], v[220:223], v[188:191]
    v_add_f32 v6, v6, v18
    v_add_f32 v6, v6, v19
    v_mfma_f32_16x16x32_bf16 v[188:191], v[32:35], v[216:219], v[188:191]
    s_waitcnt lgkmcnt(2)
    v_exp_f32 v17, v101
    v_mfma_f32_16x16x32_bf16 v[112:115], v[40:43], a[208:211], v[112:115]
    ds_read_b128 v[32:35], v1 offset:1024
    v_cvt_pk_bf16_f32 v165, v18, v19
    v_mfma_f32_16x16x32_bf16 v[112:115], v[44:47], a[212:215], v[112:115]
    v_exp_f32 v18, v102
    v_mfma_f32_16x16x32_bf16 v[116:119], v[44:47], a[236:239], v[116:119]
    v_cvt_pk_bf16_f32 v228, v228, v229
    v_add_u32 v0, 1, v0
    v_mfma_f32_16x16x32_bf16 v[116:119], v[40:43], a[232:235], v[116:119]
    buffer_store_dword v0, v13, s[20:23], 0 offen offset:32 sc1
    v_mfma_f32_16x16x32_bf16 v[120:123], v[40:43], v[192:195], v[120:123]
    ds_read_b128 v[36:39], v1 offset:13312
    v_add_f32 v6, v6, v16
    v_mfma_f32_16x16x32_bf16 v[120:123], v[44:47], v[196:199], v[120:123]
    v_add_f32 v6, v6, v17
    v_cvt_f32_i32 v232, v232
    v_mfma_f32_16x16x32_bf16 v[124:127], v[44:47], v[220:223], v[124:127]
    v_exp_f32 v19, v103
    v_mfma_f32_16x16x32_bf16 v[124:127], v[40:43], v[216:219], v[124:127]
    s_waitcnt lgkmcnt(2)
    v_cvt_pk_bf16_f32 v166, v16, v17
    v_add_f32 v6, v6, v18
    v_cvt_f32_i32 v233, v233
    v_add_f32 v6, v6, v19
    v_fma_f32 v232, v232, v48, v50
    v_cvt_pk_bf16_f32 v167, v18, v19
    v_fma_f32 v233, v233, v49, v51
    v_mfma_f32_16x16x32_bf16 a[0:3], v[64:67], v[24:27], a[0:3]
    s_mov_b32 m0, s26
    ds_read_b128 v[40:43], v1 offset:2048
    v_cvt_pk_bf16_f32 v232, v232, v233
    v_mfma_f32_16x16x32_bf16 a[0:3], v[80:83], v[28:31], a[0:3]
    buffer_load_dwordx2 v[60:61], v10, s[72:75], s36 offen offset:192
    v_mfma_f32_16x16x32_bf16 a[48:51], v[84:87], v[28:31], a[48:51]
    v_exp_f32 v16, v168
    v_mfma_f32_16x16x32_bf16 a[48:51], v[68:71], v[24:27], a[48:51]
    v_exp_f32 v17, v169
    v_mfma_f32_16x16x32_bf16 a[96:99], v[72:75], v[24:27], a[96:99]
    ds_read_b128 v[44:47], v1 offset:14336
    v_cvt_f32_i32 v236, v236
    v_mfma_f32_16x16x32_bf16 a[96:99], v[88:91], v[28:31], a[96:99]
    buffer_load_dwordx4 v4, s[4:7], s32 offen offset:0 sc1 lds
    v_mfma_f32_16x16x32_bf16 a[144:147], v[92:95], v[28:31], a[144:147]
    v_exp_f32 v18, v170
    v_mfma_f32_16x16x32_bf16 a[144:147], v[76:79], v[24:27], a[144:147]
    s_waitcnt lgkmcnt(2)
    v_add_f32 v7, v7, v16
    v_add_f32 v7, v7, v17
    v_mfma_f32_16x16x32_bf16 a[4:7], v[64:67], v[32:35], a[4:7]
    ds_read_b128 v[24:27], v1 offset:3072
    v_cvt_f32_i32 v237, v237
    v_mfma_f32_16x16x32_bf16 a[4:7], v[80:83], v[36:39], a[4:7]
    buffer_load_dwordx2 v[62:63], v10, s[76:79], s36 offen offset:192
    v_mfma_f32_16x16x32_bf16 a[52:55], v[84:87], v[36:39], a[52:55]
    v_exp_f32 v19, v171
    v_mfma_f32_16x16x32_bf16 a[52:55], v[68:71], v[32:35], a[52:55]
    v_cvt_pk_bf16_f32 v168, v16, v17
    v_fma_f32 v236, v236, v48, v50
    v_mfma_f32_16x16x32_bf16 a[100:103], v[72:75], v[32:35], a[100:103]
    ds_read_b128 v[28:31], v1 offset:15360
    v_fma_f32 v237, v237, v49, v51
    v_mfma_f32_16x16x32_bf16 a[100:103], v[88:91], v[36:39], a[100:103]
    buffer_load_dwordx4 v[240:243], v9, s[64:67], s33 offen offset:384 nt
    v_mfma_f32_16x16x32_bf16 a[148:151], v[92:95], v[36:39], a[148:151]
    v_exp_f32 v16, v104
    v_mfma_f32_16x16x32_bf16 a[148:151], v[76:79], v[32:35], a[148:151]
    s_waitcnt lgkmcnt(2)
    v_add_f32 v7, v7, v18
    v_add_f32 v7, v7, v19
    v_mfma_f32_16x16x32_bf16 a[8:11], v[64:67], v[40:43], a[8:11]
    ds_read_b128 v[32:35], v1 offset:4096
    v_cvt_pk_bf16_f32 v236, v236, v237
    v_mfma_f32_16x16x32_bf16 a[8:11], v[80:83], v[44:47], a[8:11]
    buffer_load_dwordx4 v4, s[4:7], s32 offen offset:1024 sc1 lds
    v_mfma_f32_16x16x32_bf16 a[56:59], v[84:87], v[44:47], a[56:59]
    v_exp_f32 v17, v105
    v_mfma_f32_16x16x32_bf16 a[56:59], v[68:71], v[40:43], a[56:59]
    v_cvt_pk_bf16_f32 v169, v18, v19
    v_lshlrev_b32 v48, 16, v57
    v_mfma_f32_16x16x32_bf16 a[104:107], v[72:75], v[40:43], a[104:107]
    ds_read_b128 v[36:39], v1 offset:16384
    v_mfma_f32_16x16x32_bf16 a[104:107], v[88:91], v[44:47], a[104:107]
    buffer_load_dwordx4 v[244:247], v9, s[64:67], s33 offen offset:1920 nt
    v_mfma_f32_16x16x32_bf16 a[152:155], v[92:95], v[44:47], a[152:155]
    v_exp_f32 v18, v106
    v_mfma_f32_16x16x32_bf16 a[152:155], v[76:79], v[40:43], a[152:155]
    s_waitcnt lgkmcnt(2)
    v_add_f32 v7, v7, v16
    v_add_f32 v7, v7, v17
    v_mfma_f32_16x16x32_bf16 a[12:15], v[64:67], v[24:27], a[12:15]
    ds_read_b128 v[40:43], v1 offset:5120
    v_and_b32 v49, s97, v57
    v_mfma_f32_16x16x32_bf16 a[12:15], v[80:83], v[28:31], a[12:15]
    buffer_load_dwordx4 v4, s[4:7], s32 offen offset:2048 sc1 lds
    v_mfma_f32_16x16x32_bf16 a[60:63], v[84:87], v[28:31], a[60:63]
    v_exp_f32 v19, v107
    v_mfma_f32_16x16x32_bf16 a[60:63], v[68:71], v[24:27], a[60:63]
    v_cvt_pk_bf16_f32 v170, v16, v17
    v_exp_f32 v16, v172
    v_mfma_f32_16x16x32_bf16 a[108:111], v[72:75], v[24:27], a[108:111]
    ds_read_b128 v[44:47], v1 offset:17408
    v_add_f32 v7, v7, v18
    v_mfma_f32_16x16x32_bf16 a[108:111], v[88:91], v[28:31], a[108:111]
    buffer_load_dwordx4 v[248:251], v9, s[64:67], s34 offen offset:384 nt
    v_add_f32 v7, v7, v19
    v_mfma_f32_16x16x32_bf16 a[156:159], v[92:95], v[28:31], a[156:159]
    s_add_u32 s29, s28, 49152
    v_exp_f32 v17, v173
    v_mfma_f32_16x16x32_bf16 a[156:159], v[76:79], v[24:27], a[156:159]
    s_waitcnt lgkmcnt(2)
    v_cvt_pk_bf16_f32 v171, v18, v19
    v_lshlrev_b32 v50, 16, v59
    v_mfma_f32_16x16x32_bf16 a[16:19], v[64:67], v[32:35], a[16:19]
    s_sub_u32 s3, s29, 147456
    ds_read_b128 v[24:27], v1 offset:6144
    v_and_b32 v51, s97, v59
    v_mfma_f32_16x16x32_bf16 a[16:19], v[80:83], v[36:39], a[16:19]
    s_add_u32 s32, s32, 24576
    buffer_load_dwordx4 v[252:255], v9, s[64:67], s34 offen offset:1920 nt
    v_mfma_f32_16x16x32_bf16 a[64:67], v[84:87], v[36:39], a[64:67]
    s_min_u32 s29, s29, s3
    v_exp_f32 v18, v174
    v_mfma_f32_16x16x32_bf16 a[64:67], v[68:71], v[32:35], a[64:67]
    v_add_f32 v8, v8, v16
    v_add_f32 v8, v8, v17
    v_mfma_f32_16x16x32_bf16 a[112:115], v[72:75], v[32:35], a[112:115]
    s_add_u32 s26, s26, 12288
    ds_read_b128 v[28:31], v1 offset:18432
    v_mul_f32 v48, s38, v48
    v_mfma_f32_16x16x32_bf16 a[112:115], v[88:91], v[36:39], a[112:115]
    v_exp_f32 v19, v175
    v_cvt_pk_bf16_f32 v172, v16, v17
    v_mfma_f32_16x16x32_bf16 a[160:163], v[92:95], v[36:39], a[160:163]
    v_exp_f32 v16, v108
    v_mfma_f32_16x16x32_bf16 a[160:163], v[76:79], v[32:35], a[160:163]
    s_waitcnt lgkmcnt(2)
    v_add_f32 v8, v8, v18
    v_add_f32 v8, v8, v19
    v_mfma_f32_16x16x32_bf16 a[20:23], v[64:67], v[40:43], a[20:23]
    s_sub_u32 s3, s29, s28
    ds_read_b128 v[32:35], v1 offset:7168
    v_mul_f32 v49, s38, v49
    v_mfma_f32_16x16x32_bf16 a[20:23], v[80:83], v[44:47], a[20:23]
    v_exp_f32 v17, v109
    v_mfma_f32_16x16x32_bf16 a[68:71], v[84:87], v[44:47], a[68:71]
    s_mov_b32 m0, s26
    v_cvt_pk_bf16_f32 v173, v18, v19
    v_mul_f32_e64 v50, -v50, v48
    v_mfma_f32_16x16x32_bf16 a[68:71], v[68:71], v[40:43], a[68:71]
    v_exp_f32 v18, v110
    v_mfma_f32_16x16x32_bf16 a[116:119], v[72:75], v[40:43], a[116:119]
    ds_read_b128 v[36:39], v1 offset:19456
    v_add_f32 v8, v8, v16
    v_mfma_f32_16x16x32_bf16 a[116:119], v[88:91], v[44:47], a[116:119]
    v_add_f32 v8, v8, v17
    v_mul_f32_e64 v51, -v51, v49
    v_mfma_f32_16x16x32_bf16 a[164:167], v[92:95], v[44:47], a[164:167]
    s_mov_b32 s28, s29
    v_exp_f32 v19, v111
    v_mfma_f32_16x16x32_bf16 a[164:167], v[76:79], v[40:43], a[164:167]
    s_waitcnt lgkmcnt(2)
    v_cvt_pk_bf16_f32 v174, v16, v17
    v_add_f32 v8, v8, v18
    v_mfma_f32_16x16x32_bf16 a[24:27], v[64:67], v[24:27], a[24:27]
    ds_read_b128 v[40:43], v1 offset:8192
    v_add_f32 v8, v8, v19
    v_mfma_f32_16x16x32_bf16 a[24:27], v[80:83], v[28:31], a[24:27]
    v_cvt_pk_bf16_f32 v175, v18, v19
    v_cvt_f32_i32 v226, v226
    v_mfma_f32_16x16x32_bf16 a[72:75], v[84:87], v[28:31], a[72:75]
    v_exp_f32 v16, v176
    v_mfma_f32_16x16x32_bf16 a[72:75], v[68:71], v[24:27], a[72:75]
    buffer_load_dwordx4 v4, s[4:7], s32 offen offset:0 sc1 lds
    v_mfma_f32_16x16x32_bf16 a[120:123], v[72:75], v[24:27], a[120:123]
    ds_read_b128 v[44:47], v1 offset:20480
    v_mfma_f32_16x16x32_bf16 a[120:123], v[88:91], v[28:31], a[120:123]
    v_exp_f32 v17, v177
    v_mfma_f32_16x16x32_bf16 a[168:171], v[92:95], v[28:31], a[168:171]
    v_exp_f32 v18, v178
    v_mfma_f32_16x16x32_bf16 a[168:171], v[76:79], v[24:27], a[168:171]
    s_waitcnt lgkmcnt(2)
    v_add_f32 v5, v5, v16
    v_add_f32 v5, v5, v17
    v_mfma_f32_16x16x32_bf16 a[28:31], v[64:67], v[32:35], a[28:31]
    ds_read_b128 v[24:27], v1 offset:9216
    v_cvt_f32_i32 v227, v227
    v_mfma_f32_16x16x32_bf16 a[28:31], v[80:83], v[36:39], a[28:31]
    v_exp_f32 v19, v179
    v_mfma_f32_16x16x32_bf16 a[76:79], v[84:87], v[36:39], a[76:79]
    v_cvt_pk_bf16_f32 v176, v16, v17
    v_add_u32 v2, s3, v2
    v_mfma_f32_16x16x32_bf16 a[76:79], v[68:71], v[32:35], a[76:79]
    v_exp_f32 v16, v112
    v_mfma_f32_16x16x32_bf16 a[124:127], v[72:75], v[32:35], a[124:127]
    ds_read_b128 v[28:31], v1 offset:21504
    v_add_f32 v5, v5, v18
    v_mfma_f32_16x16x32_bf16 a[124:127], v[88:91], v[36:39], a[124:127]
    v_add_f32 v5, v5, v19
    v_fma_f32 v226, v226, v48, v50
    v_mfma_f32_16x16x32_bf16 a[172:175], v[92:95], v[36:39], a[172:175]
    v_exp_f32 v17, v113
    v_mfma_f32_16x16x32_bf16 a[172:175], v[76:79], v[32:35], a[172:175]
L_pg6:
    s_cbranch_execz L_pg10
    s_waitcnt lgkmcnt(2)
    buffer_load_dwordx4 v4, s[4:7], s32 offen offset:1024 sc1 lds
    v_mfma_f32_16x16x32_bf16 a[32:35], v[64:67], v[40:43], a[32:35]
    ds_read_b128 v[32:35], v1 offset:10240
    v_cvt_pk_bf16_f32 v177, v18, v19
    v_mfma_f32_16x16x32_bf16 a[32:35], v[80:83], v[44:47], a[32:35]
    v_exp_f32 v18, v114
    v_mfma_f32_16x16x32_bf16 a[80:83], v[84:87], v[44:47], a[80:83]
    v_add_f32 v5, v5, v16
    v_add_f32 v5, v5, v17
    v_mfma_f32_16x16x32_bf16 a[80:83], v[68:71], v[40:43], a[80:83]
    v_exp_f32 v19, v115
    v_mfma_f32_16x16x32_bf16 a[128:131], v[72:75], v[40:43], a[128:131]
    ds_read_b128 v[36:39], v1 offset:22528
    v_cvt_pk_bf16_f32 v178, v16, v17
    v_mfma_f32_16x16x32_bf16 a[128:131], v[88:91], v[44:47], a[128:131]
    v_exp_f32 v16, v180
    v_mfma_f32_16x16x32_bf16 a[176:179], v[92:95], v[44:47], a[176:179]
    v_fma_f32 v227, v227, v49, v51
    v_add_u32 v3, s3, v3
    v_mfma_f32_16x16x32_bf16 a[176:179], v[76:79], v[40:43], a[176:179]
    s_waitcnt lgkmcnt(2)
    v_add_f32 v5, v5, v18
    v_add_f32 v5, v5, v19
    v_mfma_f32_16x16x32_bf16 a[36:39], v[64:67], v[24:27], a[36:39]
    ds_read_b128 v[40:43], v1 offset:11264
    v_cvt_pk_bf16_f32 v225, v226, v227
    v_mfma_f32_16x16x32_bf16 a[36:39], v[80:83], v[28:31], a[36:39]
    buffer_load_dwordx4 v4, s[4:7], s32 offen offset:2048 sc1 lds
    v_mfma_f32_16x16x32_bf16 a[84:87], v[84:87], v[28:31], a[84:87]
    v_exp_f32 v17, v181
    v_mfma_f32_16x16x32_bf16 a[84:87], v[68:71], v[24:27], a[84:87]
    v_cvt_pk_bf16_f32 v179, v18, v19
    v_cvt_f32_i32 v230, v230
    v_mfma_f32_16x16x32_bf16 a[132:135], v[72:75], v[24:27], a[132:135]
    ds_read_b128 v[44:47], v1 offset:23552
    v_cvt_f32_i32 v231, v231
    v_mfma_f32_16x16x32_bf16 a[132:135], v[88:91], v[28:31], a[132:135]
    s_waitcnt lgkmcnt(2)
    v_exp_f32 v18, v182
    v_mfma_f32_16x16x32_bf16 a[180:183], v[92:95], v[28:31], a[180:183]
    s_waitcnt vmcnt(13)
    v_add_f32 v6, v6, v16
    v_add_f32 v6, v6, v17
    v_mfma_f32_16x16x32_bf16 a[180:183], v[76:79], v[24:27], a[180:183]
    s_barrier
    v_mfma_f32_16x16x32_bf16 a[40:43], v[64:67], v[32:35], a[40:43]
    ds_read_b128 v[24:27], v2 offset:0
    v_fma_f32 v230, v230, v48, v50
    v_mfma_f32_16x16x32_bf16 a[40:43], v[80:83], v[36:39], a[40:43]
    v_exp_f32 v19, v183
    v_mfma_f32_16x16x32_bf16 a[88:91], v[84:87], v[36:39], a[88:91]
    v_cvt_pk_bf16_f32 v180, v16, v17
    v_fma_f32 v231, v231, v49, v51
    v_mfma_f32_16x16x32_bf16 a[88:91], v[68:71], v[32:35], a[88:91]
    v_exp_f32 v16, v116
    v_mfma_f32_16x16x32_bf16 a[136:139], v[72:75], v[32:35], a[136:139]
    ds_read_b128 v[28:31], v3 offset:0
    v_add_f32 v6, v6, v18
    v_mfma_f32_16x16x32_bf16 a[136:139], v[88:91], v[36:39], a[136:139]
    v_add_f32 v6, v6, v19
    v_cvt_pk_bf16_f32 v229, v230, v231
    v_mfma_f32_16x16x32_bf16 a[184:187], v[92:95], v[36:39], a[184:187]
    v_exp_f32 v17, v117
    v_mfma_f32_16x16x32_bf16 a[184:187], v[76:79], v[32:35], a[184:187]
    s_waitcnt lgkmcnt(2)
    v_cvt_pk_bf16_f32 v181, v18, v19
    v_mfma_f32_16x16x32_bf16 a[44:47], v[64:67], v[40:43], a[44:47]
    ds_read_b128 v[32:35], v2 offset:6144
    v_mfma_f32_16x16x32_bf16 a[44:47], v[80:83], v[44:47], a[44:47]
    v_exp_f32 v18, v118
    v_mfma_f32_16x16x32_bf16 a[92:95], v[84:87], v[44:47], a[92:95]
    v_add_f32 v6, v6, v16
    v_add_f32 v6, v6, v17
    v_mfma_f32_16x16x32_bf16 a[92:95], v[68:71], v[40:43], a[92:95]
    s_add_u32 s32, s32, 24576
    v_exp_f32 v19, v119
    v_mfma_f32_16x16x32_bf16 a[140:143], v[72:75], v[40:43], a[140:143]
    s_add_u32 s26, s26, 36864
    ds_read_b128 v[36:39], v3 offset:6144
    v_cvt_pk_bf16_f32 v182, v16, v17
    v_mfma_f32_16x16x32_bf16 a[140:143], v[88:91], v[44:47], a[140:143]
    s_sub_u32 s57, s26, 147456
    v_add_f32 v6, v6, v18
    v_add_f32 v6, v6, v19
    v_mfma_f32_16x16x32_bf16 a[188:191], v[92:95], v[44:47], a[188:191]
    s_min_u32 s26, s26, s57
    v_cvt_pk_bf16_f32 v183, v18, v19
    v_mfma_f32_16x16x32_bf16 a[188:191], v[76:79], v[40:43], a[188:191]
    s_waitcnt lgkmcnt(2)
    v_mfma_f32_16x16x32_bf16 v[64:67], v[24:27], a[192:195], v[128:131]
    ds_read_b128 v[40:43], v2 offset:128
    v_cvt_f32_i32 v234, v234
    v_mfma_f32_16x16x32_bf16 v[64:67], v[28:31], a[196:199], v[64:67]
    v_exp_f32 v16, v184
    v_mfma_f32_16x16x32_bf16 v[68:71], v[28:31], a[220:223], v[132:135]
    v_exp_f32 v17, v185
    v_mfma_f32_16x16x32_bf16 v[68:71], v[24:27], a[216:219], v[68:71]
    buffer_load_dword v52, v20, s[20:23], s44 offen sc1
    v_mfma_f32_16x16x32_bf16 v[72:75], v[24:27], a[240:243], v[136:139]
    ds_read_b128 v[44:47], v3 offset:128
    v_cvt_f32_i32 v235, v235
    v_mfma_f32_16x16x32_bf16 v[72:75], v[28:31], a[244:247], v[72:75]
    v_exp_f32 v18, v186
    v_mfma_f32_16x16x32_bf16 v[76:79], v[28:31], v[204:207], v[140:143]
    v_add_f32 v7, v7, v16
    v_add_f32 v7, v7, v17
    v_mfma_f32_16x16x32_bf16 v[76:79], v[24:27], v[200:203], v[76:79]
    s_waitcnt lgkmcnt(2)
    v_exp_f32 v19, v187
    v_mfma_f32_16x16x32_bf16 v[96:99], v[32:35], a[192:195], v[128:131]
    ds_read_b128 v[24:27], v2 offset:6272
    v_cvt_pk_bf16_f32 v184, v16, v17
    v_mfma_f32_16x16x32_bf16 v[96:99], v[36:39], a[196:199], v[96:99]
    v_exp_f32 v16, v120
    v_mfma_f32_16x16x32_bf16 v[100:103], v[36:39], a[220:223], v[132:135]
    v_add_f32 v7, v7, v18
    v_fma_f32 v234, v234, v48, v50
    v_mfma_f32_16x16x32_bf16 v[100:103], v[32:35], a[216:219], v[100:103]
    s_add_u32 s35, s35, 196608
    s_mov_b32 m0, s26
    v_add_f32 v7, v7, v19
    v_mfma_f32_16x16x32_bf16 v[104:107], v[32:35], a[240:243], v[136:139]
    s_add_u32 s16, s16, 196608
    ds_read_b128 v[28:31], v3 offset:6272
    v_fma_f32 v235, v235, v49, v51
    v_mfma_f32_16x16x32_bf16 v[104:107], v[36:39], a[244:247], v[104:107]
    s_add_u32 s17, s17, 196608
    buffer_load_dwordx4 v4, s[4:7], s32 offen offset:0 sc1 lds
    v_mfma_f32_16x16x32_bf16 v[108:111], v[36:39], v[204:207], v[140:143]
    v_exp_f32 v17, v121
    v_mfma_f32_16x16x32_bf16 v[108:111], v[32:35], v[200:203], v[108:111]
    s_waitcnt lgkmcnt(2)
    v_cvt_pk_bf16_f32 v185, v18, v19
    v_cvt_pk_bf16_f32 v233, v234, v235
    v_mfma_f32_16x16x32_bf16 v[64:67], v[40:43], a[200:203], v[64:67]
    s_add_u32 s37, s37, 512
    ds_read_b128 v[32:35], v2 offset:256
    v_mfma_f32_16x16x32_bf16 v[64:67], v[44:47], a[204:207], v[64:67]
    v_exp_f32 v18, v122
    v_mfma_f32_16x16x32_bf16 v[68:71], v[44:47], a[228:231], v[68:71]
    v_add_f32 v7, v7, v16
    v_add_f32 v7, v7, v17
    v_mfma_f32_16x16x32_bf16 v[68:71], v[40:43], a[224:227], v[68:71]
    v_exp_f32 v19, v123
    v_mfma_f32_16x16x32_bf16 v[72:75], v[40:43], a[248:251], v[72:75]
    ds_read_b128 v[36:39], v3 offset:256
    v_cvt_pk_bf16_f32 v186, v16, v17
    v_mfma_f32_16x16x32_bf16 v[72:75], v[44:47], a[252:255], v[72:75]
    buffer_load_dwordx4 v4, s[4:7], s32 offen offset:1024 sc1 lds
    v_mfma_f32_16x16x32_bf16 v[76:79], v[44:47], v[212:215], v[76:79]
    v_exp_f32 v16, v188
    v_mfma_f32_16x16x32_bf16 v[76:79], v[40:43], v[208:211], v[76:79]
    s_waitcnt lgkmcnt(2)
    v_add_f32 v7, v7, v18
    v_add_f32 v7, v7, v19
    v_mfma_f32_16x16x32_bf16 v[96:99], v[24:27], a[200:203], v[96:99]
    ds_read_b128 v[40:43], v2 offset:6400
    v_cvt_f32_i32 v238, v238
    v_mfma_f32_16x16x32_bf16 v[96:99], v[28:31], a[204:207], v[96:99]
    buffer_load_dwordx2 v[56:57], off, s[80:83], s37 offset:0
    v_mfma_f32_16x16x32_bf16 v[100:103], v[28:31], a[228:231], v[100:103]
    v_exp_f32 v17, v189
    v_mfma_f32_16x16x32_bf16 v[100:103], v[24:27], a[224:227], v[100:103]
    v_cvt_pk_bf16_f32 v187, v18, v19
    v_cvt_f32_i32 v239, v239
    v_mfma_f32_16x16x32_bf16 v[104:107], v[24:27], a[248:251], v[104:107]
    ds_read_b128 v[44:47], v3 offset:6400
    v_mfma_f32_16x16x32_bf16 v[104:107], v[28:31], a[252:255], v[104:107]
    buffer_load_dwordx2 v[58:59], off, s[84:87], s37 offset:0
    v_mfma_f32_16x16x32_bf16 v[108:111], v[28:31], v[212:215], v[108:111]
    s_add_u32 s29, s30, 49152
    v_exp_f32 v18, v190
    v_mfma_f32_16x16x32_bf16 v[108:111], v[24:27], v[208:211], v[108:111]
    s_waitcnt lgkmcnt(2)
    v_add_f32 v8, v8, v16
    v_add_f32 v8, v8, v17
    v_mfma_f32_16x16x32_bf16 v[64:67], v[32:35], a[208:211], v[64:67]
    s_sub_u32 s3, s29, 147456
    ds_read_b128 v[24:27], v2 offset:12288
    v_mfma_f32_16x16x32_bf16 v[64:67], v[36:39], a[212:215], v[64:67]
    s_min_u32 s29, s29, s3
    buffer_load_dwordx4 v4, s[4:7], s32 offen offset:2048 sc1 lds
    v_mfma_f32_16x16x32_bf16 v[68:71], v[36:39], a[236:239], v[68:71]
    v_exp_f32 v19, v191
    v_mfma_f32_16x16x32_bf16 v[68:71], v[32:35], a[232:235], v[68:71]
    v_cvt_pk_bf16_f32 v188, v16, v17
    v_fma_f32 v238, v238, v48, v50
    v_mfma_f32_16x16x32_bf16 v[72:75], v[32:35], v[192:195], v[72:75]
    ds_read_b128 v[28:31], v3 offset:12288
    v_mfma_f32_16x16x32_bf16 v[72:75], v[36:39], v[196:199], v[72:75]
    buffer_load_dwordx3 v[144:146], v12, s[68:71], s35 offen offset:0 nt
    v_mfma_f32_16x16x32_bf16 v[76:79], v[36:39], v[220:223], v[76:79]
    v_exp_f32 v16, v124
    v_mfma_f32_16x16x32_bf16 v[76:79], v[32:35], v[216:219], v[76:79]
    s_waitcnt lgkmcnt(2)
    v_add_f32 v8, v8, v18
    v_add_f32 v8, v8, v19
    v_mfma_f32_16x16x32_bf16 v[96:99], v[40:43], a[208:211], v[96:99]
    s_add_u32 s32, s32, 24576
    ds_read_b128 v[32:35], v2 offset:18432
    v_fma_f32 v239, v239, v49, v51
    v_mfma_f32_16x16x32_bf16 v[96:99], v[44:47], a[212:215], v[96:99]
    s_sub_u32 s3, s29, s30
    v_exp_f32 v17, v125
    v_mfma_f32_16x16x32_bf16 v[100:103], v[44:47], a[236:239], v[100:103]
    v_cvt_pk_bf16_f32 v189, v18, v19
    v_mfma_f32_16x16x32_bf16 v[100:103], v[40:43], a[232:235], v[100:103]
    v_exp_f32 v18, v126
    v_mfma_f32_16x16x32_bf16 v[104:107], v[40:43], v[192:195], v[104:107]
    s_add_u32 s26, s26, 12288
    ds_read_b128 v[36:39], v3 offset:18432
    v_add_f32 v8, v8, v16
    v_mfma_f32_16x16x32_bf16 v[104:107], v[44:47], v[196:199], v[104:107]
    buffer_load_dwordx3 v[148:150], v12, s[68:71], s35 offen offset:768 nt
    v_mfma_f32_16x16x32_bf16 v[108:111], v[44:47], v[220:223], v[108:111]
    v_add_f32 v8, v8, v17
    v_cvt_pk_bf16_f32 v237, v238, v239
    v_mfma_f32_16x16x32_bf16 v[108:111], v[40:43], v[216:219], v[108:111]
    s_waitcnt lgkmcnt(2)
    v_exp_f32 v19, v127
    v_mfma_f32_16x16x32_bf16 v[80:83], v[24:27], a[192:195], v[128:131]
    ds_read_b128 v[40:43], v2 offset:12416
    v_cvt_pk_bf16_f32 v190, v16, v17
    v_mfma_f32_16x16x32_bf16 v[80:83], v[28:31], a[196:199], v[80:83]
    s_mov_b32 m0, s26
    v_add_f32 v8, v8, v18
    v_add_f32 v8, v8, v19
    v_mfma_f32_16x16x32_bf16 v[84:87], v[28:31], a[220:223], v[132:135]
    s_mov_b32 s30, s29
    v_cvt_pk_bf16_f32 v191, v18, v19
    v_mfma_f32_16x16x32_bf16 v[84:87], v[24:27], a[216:219], v[84:87]
    v_exp_f32 v16, v64
    v_mfma_f32_16x16x32_bf16 v[88:91], v[24:27], a[240:243], v[136:139]
    ds_read_b128 v[44:47], v3 offset:12416
    v_mfma_f32_16x16x32_bf16 v[88:91], v[28:31], a[244:247], v[88:91]
    buffer_load_dwordx3 v[152:154], v12, s[68:71], s35 offen offset:1536 nt
    v_mfma_f32_16x16x32_bf16 v[92:95], v[28:31], v[204:207], v[140:143]
    v_exp_f32 v17, v65
    v_mfma_f32_16x16x32_bf16 v[92:95], v[24:27], v[200:203], v[92:95]
    s_waitcnt lgkmcnt(2)
    v_exp_f32 v18, v66
    v_mfma_f32_16x16x32_bf16 v[112:115], v[32:35], a[192:195], v[128:131]
    ds_read_b128 v[24:27], v2 offset:18560
    v_add_f32 v5, v5, v16
    v_mfma_f32_16x16x32_bf16 v[112:115], v[36:39], a[196:199], v[112:115]
    buffer_load_dwordx4 v4, s[4:7], s32 offen offset:0 sc1 lds
    v_mfma_f32_16x16x32_bf16 v[116:119], v[36:39], a[220:223], v[132:135]
    v_add_f32 v5, v5, v17
    v_add_u32 v1, s3, v1
    v_mfma_f32_16x16x32_bf16 v[116:119], v[32:35], a[216:219], v[116:119]
    v_exp_f32 v19, v67
    v_mfma_f32_16x16x32_bf16 v[120:123], v[32:35], a[240:243], v[136:139]
    ds_read_b128 v[28:31], v3 offset:18560
    v_cvt_pk_bf16_f32 v64, v16, v17
    v_mfma_f32_16x16x32_bf16 v[120:123], v[36:39], a[244:247], v[120:123]
    s_waitcnt vmcnt(13)
    buffer_load_dwordx3 v[156:158], v12, s[68:71], s35 offen offset:2304 nt
    v_mfma_f32_16x16x32_bf16 v[124:127], v[36:39], v[204:207], v[140:143]
    v_exp_f32 v16, v96
    v_mfma_f32_16x16x32_bf16 v[124:127], v[32:35], v[200:203], v[124:127]
    s_waitcnt lgkmcnt(2)
    v_add_f32 v5, v5, v18
    v_add_f32 v5, v5, v19
    v_mfma_f32_16x16x32_bf16 v[80:83], v[40:43], a[200:203], v[80:83]
    ds_read_b128 v[32:35], v2 offset:12544
    v_lshlrev_b32 v48, 16, v60
    v_mfma_f32_16x16x32_bf16 v[80:83], v[44:47], a[204:207], v[80:83]
    v_exp_f32 v17, v97
    v_mfma_f32_16x16x32_bf16 v[84:87], v[44:47], a[228:231], v[84:87]
    v_cvt_pk_bf16_f32 v65, v18, v19
    v_and_b32 v49, s97, v60
    v_mfma_f32_16x16x32_bf16 v[84:87], v[40:43], a[224:227], v[84:87]
    buffer_load_dwordx4 v4, s[4:7], s32 offen offset:1024 sc1 lds
    v_mfma_f32_16x16x32_bf16 v[88:91], v[40:43], a[248:251], v[88:91]
    ds_read_b128 v[36:39], v3 offset:12544
    v_lshlrev_b32 v50, 16, v62
    v_mfma_f32_16x16x32_bf16 v[88:91], v[44:47], a[252:255], v[88:91]
    v_exp_f32 v18, v98
    v_mfma_f32_16x16x32_bf16 v[92:95], v[44:47], v[212:215], v[92:95]
    v_add_f32 v5, v5, v16
    v_add_f32 v5, v5, v17
    v_mfma_f32_16x16x32_bf16 v[92:95], v[40:43], v[208:211], v[92:95]
    s_waitcnt lgkmcnt(2)
    v_exp_f32 v19, v99
    v_mfma_f32_16x16x32_bf16 v[112:115], v[24:27], a[200:203], v[112:115]
    ds_read_b128 v[40:43], v2 offset:18688
    v_cvt_pk_bf16_f32 v66, v16, v17
    v_mfma_f32_16x16x32_bf16 v[112:115], v[28:31], a[204:207], v[112:115]
    v_exp_f32 v16, v68
    v_mfma_f32_16x16x32_bf16 v[116:119], v[28:31], a[228:231], v[116:119]
    v_add_f32 v5, v5, v18
    v_add_f32 v5, v5, v19
    v_mfma_f32_16x16x32_bf16 v[116:119], v[24:27], a[224:227], v[116:119]
    v_exp_f32 v17, v69
    v_mfma_f32_16x16x32_bf16 v[120:123], v[24:27], a[248:251], v[120:123]
    ds_read_b128 v[44:47], v3 offset:18688
    v_cvt_pk_bf16_f32 v67, v18, v19
    v_mfma_f32_16x16x32_bf16 v[120:123], v[28:31], a[252:255], v[120:123]
    s_waitcnt lgkmcnt(2)
    buffer_load_dwordx4 v4, s[4:7], s32 offen offset:2048 sc1 lds
    v_mfma_f32_16x16x32_bf16 v[124:127], v[28:31], v[212:215], v[124:127]
    s_waitcnt vmcnt(13)
    v_exp_f32 v18, v70
    v_mfma_f32_16x16x32_bf16 v[124:127], v[24:27], v[208:211], v[124:127]
    s_barrier
    v_mfma_f32_16x16x32_bf16 v[80:83], v[32:35], a[208:211], v[80:83]
    ds_read_b128 v[24:27], v1 offset:0
    v_add_f32 v6, v6, v16
    v_mfma_f32_16x16x32_bf16 v[80:83], v[36:39], a[212:215], v[80:83]
    v_add_f32 v6, v6, v17
    v_and_b32 v51, s97, v62
    v_mfma_f32_16x16x32_bf16 v[84:87], v[36:39], a[236:239], v[84:87]
    v_exp_f32 v19, v71
    v_mfma_f32_16x16x32_bf16 v[84:87], v[32:35], a[232:235], v[84:87]
    v_cvt_pk_bf16_f32 v68, v16, v17
    v_mul_f32 v48, s38, v48
    v_mfma_f32_16x16x32_bf16 v[88:91], v[32:35], v[192:195], v[88:91]
    ds_read_b128 v[28:31], v1 offset:12288
    v_mul_f32 v49, s38, v49
    v_mfma_f32_16x16x32_bf16 v[88:91], v[36:39], v[196:199], v[88:91]
    v_exp_f32 v16, v100
    v_mfma_f32_16x16x32_bf16 v[92:95], v[36:39], v[220:223], v[92:95]
    v_add_f32 v6, v6, v18
    v_add_f32 v6, v6, v19
    v_mfma_f32_16x16x32_bf16 v[92:95], v[32:35], v[216:219], v[92:95]
    s_waitcnt lgkmcnt(2)
    v_exp_f32 v17, v101
    v_mfma_f32_16x16x32_bf16 v[112:115], v[40:43], a[208:211], v[112:115]
    ds_read_b128 v[32:35], v1 offset:1024
    v_cvt_pk_bf16_f32 v69, v18, v19
    v_mfma_f32_16x16x32_bf16 v[112:115], v[44:47], a[212:215], v[112:115]
    v_exp_f32 v18, v102
    v_mfma_f32_16x16x32_bf16 v[116:119], v[44:47], a[236:239], v[116:119]
    v_add_f32 v6, v6, v16
    v_add_f32 v6, v6, v17
    v_mfma_f32_16x16x32_bf16 v[116:119], v[40:43], a[232:235], v[116:119]
    v_exp_f32 v19, v103
    v_mfma_f32_16x16x32_bf16 v[120:123], v[40:43], v[192:195], v[120:123]
    ds_read_b128 v[36:39], v1 offset:13312
    v_cvt_pk_bf16_f32 v70, v16, v17
    v_mfma_f32_16x16x32_bf16 v[120:123], v[44:47], v[196:199], v[120:123]
    s_add_u32 s32, s32, 24576
    v_add_f32 v6, v6, v18
    s_add_u32 s26, s26, 36864
    v_mfma_f32_16x16x32_bf16 v[124:127], v[44:47], v[220:223], v[124:127]
    s_sub_u32 s57, s26, 147456
    v_add_f32 v6, v6, v19
    v_cvt_pk_bf16_f32 v71, v18, v19
    v_mfma_f32_16x16x32_bf16 v[124:127], v[40:43], v[216:219], v[124:127]
    s_waitcnt lgkmcnt(2)
    s_min_u32 s26, s26, s57
    v_mfma_f32_16x16x32_bf16 a[0:3], v[160:163], v[24:27], a[0:3]
    ds_read_b128 v[40:43], v1 offset:2048
    v_mul_f32_e64 v50, -v50, v48
    v_mfma_f32_16x16x32_bf16 a[0:3], v[176:179], v[28:31], a[0:3]
    s_waitcnt vmcnt(12)
    v_subrev_u32 v52, s92, v52
    v_cmp_lt_u32 vcc, 15, v52
    v_mfma_f32_16x16x32_bf16 a[48:51], v[180:183], v[28:31], a[48:51]
    v_exp_f32 v16, v72
    v_mfma_f32_16x16x32_bf16 a[48:51], v[164:167], v[24:27], a[48:51]
    v_exp_f32 v17, v73
    v_mfma_f32_16x16x32_bf16 a[96:99], v[168:171], v[24:27], a[96:99]
    s_and_b32 s59, vcc_lo, 0xff
    ds_read_b128 v[44:47], v1 offset:14336
    v_mul_f32_e64 v51, -v51, v49
    v_mfma_f32_16x16x32_bf16 a[96:99], v[184:187], v[28:31], a[96:99]
    s_cbranch_scc1 L_pollslow2
L_pollok2:
    v_mfma_f32_16x16x32_bf16 a[144:147], v[188:191], v[28:31], a[144:147]
    s_add_u32 s92, s92, 1
    v_exp_f32 v18, v74
    v_mfma_f32_16x16x32_bf16 a[144:147], v[172:175], v[24:27], a[144:147]
    s_waitcnt lgkmcnt(2)
    v_add_f32 v7, v7, v16
    v_add_f32 v7, v7, v17
    v_mfma_f32_16x16x32_bf16 a[4:7], v[160:163], v[32:35], a[4:7]
    s_mov_b32 m0, s56
    ds_read_b128 v[24:27], v1 offset:3072
    v_cvt_f32_i32 v240, v240
    v_mfma_f32_16x16x32_bf16 a[4:7], v[176:179], v[36:39], a[4:7]
    buffer_load_dwordx4 v4, s[4:7], s27 offen offset:0 sc1 lds
    v_mfma_f32_16x16x32_bf16 a[52:55], v[180:183], v[36:39], a[52:55]
    v_exp_f32 v19, v75
    v_mfma_f32_16x16x32_bf16 a[52:55], v[164:167], v[32:35], a[52:55]
    v_cvt_pk_bf16_f32 v72, v16, v17
    v_cvt_f32_i32 v241, v241
    v_mfma_f32_16x16x32_bf16 a[100:103], v[168:171], v[32:35], a[100:103]
    ds_read_b128 v[28:31], v1 offset:15360
    v_fma_f32 v240, v240, v48, v50
    v_mfma_f32_16x16x32_bf16 a[100:103], v[184:187], v[36:39], a[100:103]
    v_exp_f32 v16, v104
    v_mfma_f32_16x16x32_bf16 a[148:151], v[188:191], v[36:39], a[148:151]
    v_add_f32 v7, v7, v18
    v_add_f32 v7, v7, v19
    v_mfma_f32_16x16x32_bf16 a[148:151], v[172:175], v[32:35], a[148:151]
    s_waitcnt lgkmcnt(2)
    v_exp_f32 v17, v105
    v_mfma_f32_16x16x32_bf16 a[8:11], v[160:163], v[40:43], a[8:11]
    ds_read_b128 v[32:35], v1 offset:4096
    v_cvt_pk_bf16_f32 v73, v18, v19
    v_mfma_f32_16x16x32_bf16 a[8:11], v[176:179], v[44:47], a[8:11]
    buffer_load_dwordx4 v4, s[4:7], s27 offen offset:1024 sc1 lds
    v_mfma_f32_16x16x32_bf16 a[56:59], v[180:183], v[44:47], a[56:59]
    v_exp_f32 v18, v106
    v_mfma_f32_16x16x32_bf16 a[56:59], v[164:167], v[40:43], a[56:59]
    v_add_f32 v7, v7, v16
    v_fma_f32 v241, v241, v49, v51
    v_mfma_f32_16x16x32_bf16 a[104:107], v[168:171], v[40:43], a[104:107]
    ds_read_b128 v[36:39], v1 offset:16384
    v_add_f32 v7, v7, v17
    v_mfma_f32_16x16x32_bf16 a[104:107], v[184:187], v[44:47], a[104:107]
    v_exp_f32 v19, v107
    v_mfma_f32_16x16x32_bf16 a[152:155], v[188:191], v[44:47], a[152:155]
    v_cvt_pk_bf16_f32 v74, v16, v17
    v_cvt_pk_bf16_f32 v226, v240, v241
    v_mfma_f32_16x16x32_bf16 a[152:155], v[172:175], v[40:43], a[152:155]
    s_waitcnt lgkmcnt(2)
    v_exp_f32 v16, v76
    v_mfma_f32_16x16x32_bf16 a[12:15], v[160:163], v[24:27], a[12:15]
    ds_read_b128 v[40:43], v1 offset:5120
    v_add_f32 v7, v7, v18
    v_mfma_f32_16x16x32_bf16 a[12:15], v[176:179], v[28:31], a[12:15]
    buffer_load_dwordx4 v4, s[4:7], s27 offen offset:2048 sc1 lds
    v_mfma_f32_16x16x32_bf16 a[60:63], v[180:183], v[28:31], a[60:63]
    v_add_f32 v7, v7, v19
    v_cvt_f32_i32 v244, v244
    v_mfma_f32_16x16x32_bf16 a[60:63], v[164:167], v[24:27], a[60:63]
    v_exp_f32 v17, v77
    v_mfma_f32_16x16x32_bf16 a[108:111], v[168:171], v[24:27], a[108:111]
    ds_read_b128 v[44:47], v1 offset:17408
    v_cvt_pk_bf16_f32 v75, v18, v19
    v_mfma_f32_16x16x32_bf16 a[108:111], v[184:187], v[28:31], a[108:111]
    v_exp_f32 v18, v78
    v_mfma_f32_16x16x32_bf16 a[156:159], v[188:191], v[28:31], a[156:159]
    s_add_u32 s29, s28, 49152
    v_cvt_f32_i32 v245, v245
    v_fma_f32 v244, v244, v48, v50
    v_mfma_f32_16x16x32_bf16 a[156:159], v[172:175], v[24:27], a[156:159]
    s_waitcnt lgkmcnt(2)
    v_add_f32 v8, v8, v16
    v_add_f32 v8, v8, v17
    v_mfma_f32_16x16x32_bf16 a[16:19], v[160:163], v[32:35], a[16:19]
    s_sub_u32 s3, s29, 147456
    ds_read_b128 v[24:27], v1 offset:6144
    v_fma_f32 v245, v245, v49, v51
    v_mfma_f32_16x16x32_bf16 a[16:19], v[176:179], v[36:39], a[16:19]
    s_add_u32 s27, s27, 24576
    v_exp_f32 v19, v79
    v_mfma_f32_16x16x32_bf16 a[64:67], v[180:183], v[36:39], a[64:67]
    s_min_u32 s29, s29, s3
    v_cvt_pk_bf16_f32 v76, v16, v17
    v_cvt_pk_bf16_f32 v230, v244, v245
    v_mfma_f32_16x16x32_bf16 a[64:67], v[164:167], v[32:35], a[64:67]
    s_add_u32 s56, s56, 12288
    v_exp_f32 v16, v108
    v_mfma_f32_16x16x32_bf16 a[112:115], v[168:171], v[32:35], a[112:115]
    ds_read_b128 v[28:31], v1 offset:18432
    v_add_f32 v8, v8, v18
    v_mfma_f32_16x16x32_bf16 a[112:115], v[184:187], v[36:39], a[112:115]
    v_add_f32 v8, v8, v19
    v_cvt_f32_i32 v248, v248
    v_mfma_f32_16x16x32_bf16 a[160:163], v[188:191], v[36:39], a[160:163]
    v_exp_f32 v17, v109
    v_mfma_f32_16x16x32_bf16 a[160:163], v[172:175], v[32:35], a[160:163]
    s_waitcnt lgkmcnt(2)
    v_cvt_f32_i32 v249, v249
    v_cvt_pk_bf16_f32 v77, v18, v19
    v_mfma_f32_16x16x32_bf16 a[20:23], v[160:163], v[40:43], a[20:23]
    s_mov_b32 m0, s56
    ds_read_b128 v[32:35], v1 offset:7168
    v_fma_f32 v248, v248, v48, v50
    v_mfma_f32_16x16x32_bf16 a[20:23], v[176:179], v[44:47], a[20:23]
    s_sub_u32 s3, s29, s28
    v_exp_f32 v18, v110
    v_mfma_f32_16x16x32_bf16 a[68:71], v[180:183], v[44:47], a[68:71]
    v_add_f32 v8, v8, v16
    v_add_f32 v8, v8, v17
    v_mfma_f32_16x16x32_bf16 a[68:71], v[164:167], v[40:43], a[68:71]
    v_exp_f32 v19, v111
    v_mfma_f32_16x16x32_bf16 a[116:119], v[168:171], v[40:43], a[116:119]
    ds_read_b128 v[36:39], v1 offset:19456
    v_fma_f32 v249, v249, v49, v51
    v_mfma_f32_16x16x32_bf16 a[116:119], v[184:187], v[44:47], a[116:119]
    buffer_load_dwordx4 v4, s[4:7], s27 offen offset:0 sc1 lds
    v_mfma_f32_16x16x32_bf16 a[164:167], v[188:191], v[44:47], a[164:167]
    s_mov_b32 s28, s29
    v_cvt_pk_bf16_f32 v78, v16, v17
    v_add_f32 v8, v8, v18
    v_mfma_f32_16x16x32_bf16 a[164:167], v[172:175], v[40:43], a[164:167]
    s_waitcnt lgkmcnt(2)
    v_add_f32 v8, v8, v19
    v_cvt_pk_bf16_f32 v234, v248, v249
    v_mfma_f32_16x16x32_bf16 a[24:27], v[160:163], v[24:27], a[24:27]
    ds_read_b128 v[40:43], v1 offset:8192
    v_cvt_pk_bf16_f32 v79, v18, v19
    v_mfma_f32_16x16x32_bf16 a[24:27], v[176:179], v[28:31], a[24:27]
    v_exp_f32 v16, v80
    v_mfma_f32_16x16x32_bf16 a[72:75], v[180:183], v[28:31], a[72:75]
    v_cvt_f32_i32 v252, v252
    v_cvt_f32_i32 v253, v253
    v_mfma_f32_16x16x32_bf16 a[72:75], v[164:167], v[24:27], a[72:75]
    v_exp_f32 v17, v81
    v_mfma_f32_16x16x32_bf16 a[120:123], v[168:171], v[24:27], a[120:123]
    ds_read_b128 v[44:47], v1 offset:20480
    v_fma_f32 v252, v252, v48, v50
    v_mfma_f32_16x16x32_bf16 a[120:123], v[184:187], v[28:31], a[120:123]
    v_exp_f32 v18, v82
    v_mfma_f32_16x16x32_bf16 a[168:171], v[188:191], v[28:31], a[168:171]
    v_add_f32 v5, v5, v16
    v_add_f32 v5, v5, v17
    v_mfma_f32_16x16x32_bf16 a[168:171], v[172:175], v[24:27], a[168:171]
    s_waitcnt lgkmcnt(2)
    buffer_load_dwordx4 v4, s[4:7], s27 offen offset:1024 sc1 lds
    v_mfma_f32_16x16x32_bf16 a[28:31], v[160:163], v[32:35], a[28:31]
    ds_read_b128 v[24:27], v1 offset:9216
    v_fma_f32 v253, v253, v49, v51
    v_mfma_f32_16x16x32_bf16 a[28:31], v[176:179], v[36:39], a[28:31]
    v_exp_f32 v19, v83
    v_mfma_f32_16x16x32_bf16 a[76:79], v[180:183], v[36:39], a[76:79]
    v_cvt_pk_bf16_f32 v80, v16, v17
    v_cvt_pk_bf16_f32 v238, v252, v253
    v_mfma_f32_16x16x32_bf16 a[76:79], v[164:167], v[32:35], a[76:79]
    v_exp_f32 v16, v112
    v_mfma_f32_16x16x32_bf16 a[124:127], v[168:171], v[32:35], a[124:127]
    ds_read_b128 v[28:31], v1 offset:21504
    v_add_f32 v5, v5, v18
    v_mfma_f32_16x16x32_bf16 a[124:127], v[184:187], v[36:39], a[124:127]
    v_add_f32 v5, v5, v19
    v_lshlrev_b32 v48, 16, v61
    v_mfma_f32_16x16x32_bf16 a[172:175], v[188:191], v[36:39], a[172:175]
    v_exp_f32 v17, v113
    v_mfma_f32_16x16x32_bf16 a[172:175], v[172:175], v[32:35], a[172:175]
    s_waitcnt lgkmcnt(2)
    buffer_load_dwordx4 v4, s[4:7], s27 offen offset:2048 sc1 lds
    v_mfma_f32_16x16x32_bf16 a[32:35], v[160:163], v[40:43], a[32:35]
    ds_read_b128 v[32:35], v1 offset:10240
    v_cvt_pk_bf16_f32 v81, v18, v19
    v_mfma_f32_16x16x32_bf16 a[32:35], v[176:179], v[44:47], a[32:35]
    v_exp_f32 v18, v114
    v_mfma_f32_16x16x32_bf16 a[80:83], v[180:183], v[44:47], a[80:83]
    v_add_f32 v5, v5, v16
    v_and_b32 v49, s97, v61
    v_mfma_f32_16x16x32_bf16 a[80:83], v[164:167], v[40:43], a[80:83]
    v_add_f32 v5, v5, v17
    v_lshlrev_b32 v50, 16, v63
    v_mfma_f32_16x16x32_bf16 a[128:131], v[168:171], v[40:43], a[128:131]
    ds_read_b128 v[36:39], v1 offset:22528
    v_add_u32 v2, s3, v2
    v_mfma_f32_16x16x32_bf16 a[128:131], v[184:187], v[44:47], a[128:131]
    v_exp_f32 v19, v115
    v_mfma_f32_16x16x32_bf16 a[176:179], v[188:191], v[44:47], a[176:179]
    v_cvt_pk_bf16_f32 v82, v16, v17
    v_and_b32 v51, s97, v63
    v_mfma_f32_16x16x32_bf16 a[176:179], v[172:175], v[40:43], a[176:179]
    s_waitcnt lgkmcnt(2)
    v_exp_f32 v16, v84
    v_mfma_f32_16x16x32_bf16 a[36:39], v[160:163], v[24:27], a[36:39]
    ds_read_b128 v[40:43], v1 offset:11264
    v_add_f32 v5, v5, v18
    v_mfma_f32_16x16x32_bf16 a[36:39], v[176:179], v[28:31], a[36:39]
    v_add_f32 v5, v5, v19
    v_mul_f32 v48, s38, v48
    v_mfma_f32_16x16x32_bf16 a[84:87], v[180:183], v[28:31], a[84:87]
    v_exp_f32 v17, v85
    v_mfma_f32_16x16x32_bf16 a[84:87], v[164:167], v[24:27], a[84:87]
    s_add_u32 s27, s27, 24576
    v_add_u32 v3, s3, v3
    v_cvt_pk_bf16_f32 v83, v18, v19
    v_mfma_f32_16x16x32_bf16 a[132:135], v[168:171], v[24:27], a[132:135]
    s_add_u32 s56, s56, 36864
    ds_read_b128 v[44:47], v1 offset:23552
    v_mul_f32 v49, s38, v49
    v_mfma_f32_16x16x32_bf16 a[132:135], v[184:187], v[28:31], a[132:135]
    s_sub_u32 s58, s56, 147456
    v_exp_f32 v18, v86
    v_mfma_f32_16x16x32_bf16 a[180:183], v[188:191], v[28:31], a[180:183]
    v_add_f32 v6, v6, v16
    v_add_f32 v6, v6, v17
    v_mfma_f32_16x16x32_bf16 a[180:183], v[172:175], v[24:27], a[180:183]
    s_waitcnt lgkmcnt(2)
    v_mul_f32_e64 v50, -v50, v48
    v_mul_f32_e64 v51, -v51, v49
    v_mfma_f32_16x16x32_bf16 a[40:43], v[160:163], v[32:35], a[40:43]
    s_min_u32 s56, s56, s58
    ds_read_b128 v[24:27], v2 offset:0
    v_cvt_f32_i32 v242, v242
    v_mfma_f32_16x16x32_bf16 a[40:43], v[176:179], v[36:39], a[40:43]
    v_exp_f32 v19, v87
    v_mfma_f32_16x16x32_bf16 a[88:91], v[180:183], v[36:39], a[88:91]
    v_cvt_pk_bf16_f32 v84, v16, v17
    v_cvt_f32_i32 v243, v243
    v_mfma_f32_16x16x32_bf16 a[88:91], v[164:167], v[32:35], a[88:91]
    v_exp_f32 v16, v116
    v_mfma_f32_16x16x32_bf16 a[136:139], v[168:171], v[32:35], a[136:139]
    ds_read_b128 v[28:31], v3 offset:0
    v_add_f32 v6, v6, v18
    v_mfma_f32_16x16x32_bf16 a[136:139], v[184:187], v[36:39], a[136:139]
    v_add_f32 v6, v6, v19
    v_fma_f32 v242, v242, v48, v50
    v_mfma_f32_16x16x32_bf16 a[184:187], v[188:191], v[36:39], a[184:187]
    v_exp_f32 v17, v117
    v_mfma_f32_16x16x32_bf16 a[184:187], v[172:175], v[32:35], a[184:187]
    s_waitcnt lgkmcnt(2)
    v_cvt_pk_bf16_f32 v85, v18, v19
    v_fma_f32 v243, v243, v49, v51
    v_mfma_f32_16x16x32_bf16 a[44:47], v[160:163], v[40:43], a[44:47]
    ds_read_b128 v[32:35], v2 offset:6144
    v_cvt_pk_bf16_f32 v227, v242, v243
    v_mfma_f32_16x16x32_bf16 a[44:47], v[176:179], v[44:47], a[44:47]
    v_exp_f32 v18, v118
    v_mfma_f32_16x16x32_bf16 a[92:95], v[180:183], v[44:47], a[92:95]
    v_add_f32 v6, v6, v16
    v_add_f32 v6, v6, v17
    v_mfma_f32_16x16x32_bf16 a[92:95], v[164:167], v[40:43], a[92:95]
    v_exp_f32 v19, v119
    v_mfma_f32_16x16x32_bf16 a[140:143], v[168:171], v[40:43], a[140:143]
    s_sub_u32 s31, s31, 1
    ds_read_b128 v[36:39], v3 offset:6144
    v_cvt_pk_bf16_f32 v86, v16, v17
    v_mfma_f32_16x16x32_bf16 a[140:143], v[184:187], v[44:47], a[140:143]
    v_add_f32 v6, v6, v18
    v_add_f32 v6, v6, v19
    v_mfma_f32_16x16x32_bf16 a[188:191], v[188:191], v[44:47], a[188:191]
    s_waitcnt lgkmcnt(2)
    s_cmp_lg_u32 s31, 0
    v_cvt_pk_bf16_f32 v87, v18, v19
    v_cvt_f32_i32 v246, v246
    v_mfma_f32_16x16x32_bf16 a[188:191], v[172:175], v[40:43], a[188:191]
    s_cbranch_scc1 L_loop
    v_mfma_f32_16x16x32_bf16 v[160:163], v[24:27], a[192:195], v[128:131]
L_pg7:
    s_cbranch_execz L_pg11
    s_mov_b32 m0, s56
    ds_read_b128 v[40:43], v2 offset:128
    v_cvt_f32_i32 v247, v247
    v_mfma_f32_16x16x32_bf16 v[160:163], v[28:31], a[196:199], v[160:163]
    buffer_load_dwordx4 v4, s[4:7], s27 offen offset:0 sc1 lds
    v_mfma_f32_16x16x32_bf16 v[164:167], v[28:31], a[220:223], v[132:135]
    v_exp_f32 v16, v88
    v_mfma_f32_16x16x32_bf16 v[164:167], v[24:27], a[216:219], v[164:167]
    v_exp_f32 v17, v89
    v_mfma_f32_16x16x32_bf16 v[168:171], v[24:27], a[240:243], v[136:139]
    ds_read_b128 v[44:47], v3 offset:128
    v_fma_f32 v246, v246, v48, v50
    v_mfma_f32_16x16x32_bf16 v[168:171], v[28:31], a[244:247], v[168:171]
    v_exp_f32 v18, v90
    v_mfma_f32_16x16x32_bf16 v[172:175], v[28:31], v[204:207], v[140:143]
    v_fma_f32 v247, v247, v49, v51
    v_add_f32 v7, v7, v16
    v_mfma_f32_16x16x32_bf16 v[172:175], v[24:27], v[200:203], v[172:175]
    s_waitcnt lgkmcnt(2)
    v_add_f32 v7, v7, v17
    v_cvt_pk_bf16_f32 v231, v246, v247
    v_mfma_f32_16x16x32_bf16 v[96:99], v[32:35], a[192:195], v[128:131]
    ds_read_b128 v[24:27], v2 offset:6272
    v_cvt_f32_i32 v250, v250
    v_mfma_f32_16x16x32_bf16 v[96:99], v[36:39], a[196:199], v[96:99]
    buffer_load_dwordx4 v4, s[4:7], s27 offen offset:1024 sc1 lds
    v_mfma_f32_16x16x32_bf16 v[100:103], v[36:39], a[220:223], v[132:135]
    v_exp_f32 v19, v91
    v_mfma_f32_16x16x32_bf16 v[100:103], v[32:35], a[216:219], v[100:103]
    v_cvt_pk_bf16_f32 v88, v16, v17
    v_cvt_f32_i32 v251, v251
    v_mfma_f32_16x16x32_bf16 v[104:107], v[32:35], a[240:243], v[136:139]
    ds_read_b128 v[28:31], v3 offset:6272
    v_fma_f32 v250, v250, v48, v50
    v_mfma_f32_16x16x32_bf16 v[104:107], v[36:39], a[244:247], v[104:107]
    v_exp_f32 v16, v120
    v_mfma_f32_16x16x32_bf16 v[108:111], v[36:39], v[204:207], v[140:143]
    v_add_f32 v7, v7, v18
    v_add_f32 v7, v7, v19
    v_mfma_f32_16x16x32_bf16 v[108:111], v[32:35], v[200:203], v[108:111]
    s_waitcnt lgkmcnt(2)
    v_exp_f32 v17, v121
    v_mfma_f32_16x16x32_bf16 v[160:163], v[40:43], a[200:203], v[160:163]
    ds_read_b128 v[32:35], v2 offset:256
    v_cvt_pk_bf16_f32 v89, v18, v19
    v_mfma_f32_16x16x32_bf16 v[160:163], v[44:47], a[204:207], v[160:163]
    v_exp_f32 v18, v122
    v_mfma_f32_16x16x32_bf16 v[164:167], v[44:47], a[228:231], v[164:167]
    v_fma_f32 v251, v251, v49, v51
    v_add_f32 v7, v7, v16
    v_mfma_f32_16x16x32_bf16 v[164:167], v[40:43], a[224:227], v[164:167]
    buffer_load_dwordx4 v4, s[4:7], s27 offen offset:2048 sc1 lds
    v_mfma_f32_16x16x32_bf16 v[168:171], v[40:43], a[248:251], v[168:171]
    ds_read_b128 v[36:39], v3 offset:256
    v_cvt_pk_bf16_f32 v235, v250, v251
    v_mfma_f32_16x16x32_bf16 v[168:171], v[44:47], a[252:255], v[168:171]
    v_add_f32 v7, v7, v17
    v_cvt_f32_i32 v254, v254
    v_mfma_f32_16x16x32_bf16 v[172:175], v[44:47], v[212:215], v[172:175]
    v_exp_f32 v19, v123
    v_mfma_f32_16x16x32_bf16 v[172:175], v[40:43], v[208:211], v[172:175]
    s_waitcnt lgkmcnt(2)
    v_cvt_pk_bf16_f32 v90, v16, v17
    v_cvt_f32_i32 v255, v255
    v_mfma_f32_16x16x32_bf16 v[96:99], v[24:27], a[200:203], v[96:99]
    ds_read_b128 v[40:43], v2 offset:6400
    v_fma_f32 v254, v254, v48, v50
    v_mfma_f32_16x16x32_bf16 v[96:99], v[28:31], a[204:207], v[96:99]
    s_add_u32 s27, s27, 24576
    v_exp_f32 v16, v92
    v_mfma_f32_16x16x32_bf16 v[100:103], v[28:31], a[228:231], v[100:103]
    v_add_f32 v7, v7, v18
    v_add_f32 v7, v7, v19
    v_mfma_f32_16x16x32_bf16 v[100:103], v[24:27], a[224:227], v[100:103]
    v_exp_f32 v17, v93
    v_mfma_f32_16x16x32_bf16 v[104:107], v[24:27], a[248:251], v[104:107]
    ds_read_b128 v[44:47], v3 offset:6400
    v_fma_f32 v255, v255, v49, v51
    v_mfma_f32_16x16x32_bf16 v[104:107], v[28:31], a[252:255], v[104:107]
    v_cvt_pk_bf16_f32 v91, v18, v19
    v_cvt_pk_bf16_f32 v239, v254, v255
    v_mfma_f32_16x16x32_bf16 v[108:111], v[28:31], v[212:215], v[108:111]
    s_add_u32 s29, s30, 49152
    v_exp_f32 v18, v94
    v_mfma_f32_16x16x32_bf16 v[108:111], v[24:27], v[208:211], v[108:111]
    s_waitcnt lgkmcnt(2)
    v_add_f32 v8, v8, v16
    v_add_f32 v8, v8, v17
    v_mfma_f32_16x16x32_bf16 v[160:163], v[32:35], a[208:211], v[160:163]
    s_waitcnt vmcnt(11)
    ds_read_b128 v[24:27], v2 offset:12288
    v_lshlrev_b32 v48, 16, v56
    v_mfma_f32_16x16x32_bf16 v[160:163], v[36:39], a[212:215], v[160:163]
    s_sub_u32 s3, s29, 147456
    buffer_load_dwordx2 v[60:61], off, s[80:83], s37 offset:8
    v_mfma_f32_16x16x32_bf16 v[164:167], v[36:39], a[236:239], v[164:167]
    s_add_u32 s56, s56, 12288
    v_exp_f32 v19, v95
    v_mfma_f32_16x16x32_bf16 v[164:167], v[32:35], a[232:235], v[164:167]
    s_min_u32 s29, s29, s3
    v_cvt_pk_bf16_f32 v92, v16, v17
    v_and_b32 v49, s97, v56
    v_mfma_f32_16x16x32_bf16 v[168:171], v[32:35], v[192:195], v[168:171]
    s_mov_b32 m0, s56
    ds_read_b128 v[28:31], v3 offset:12288
    v_mfma_f32_16x16x32_bf16 v[168:171], v[36:39], v[196:199], v[168:171]
    buffer_load_dwordx2 v[62:63], off, s[84:87], s37 offset:8
    v_mfma_f32_16x16x32_bf16 v[172:175], v[36:39], v[220:223], v[172:175]
    v_exp_f32 v16, v124
    v_mfma_f32_16x16x32_bf16 v[172:175], v[32:35], v[216:219], v[172:175]
    s_waitcnt lgkmcnt(2)
    v_add_f32 v8, v8, v18
    v_add_f32 v8, v8, v19
    v_mfma_f32_16x16x32_bf16 v[96:99], v[40:43], a[208:211], v[96:99]
    ds_read_b128 v[32:35], v2 offset:18432
    v_lshlrev_b32 v50, 16, v58
    v_mfma_f32_16x16x32_bf16 v[96:99], v[44:47], a[212:215], v[96:99]
    s_sub_u32 s3, s29, s30
    v_exp_f32 v17, v125
    v_mfma_f32_16x16x32_bf16 v[100:103], v[44:47], a[236:239], v[100:103]
    v_cvt_pk_bf16_f32 v93, v18, v19
    v_mfma_f32_16x16x32_bf16 v[100:103], v[40:43], a[232:235], v[100:103]
    buffer_load_dwordx4 v4, s[4:7], s27 offen offset:0 sc1 lds
    v_mfma_f32_16x16x32_bf16 v[104:107], v[40:43], v[192:195], v[104:107]
    ds_read_b128 v[36:39], v3 offset:18432
    v_mfma_f32_16x16x32_bf16 v[104:107], v[44:47], v[196:199], v[104:107]
    v_exp_f32 v18, v126
    v_mfma_f32_16x16x32_bf16 v[108:111], v[44:47], v[220:223], v[108:111]
    v_add_f32 v8, v8, v16
    v_add_f32 v8, v8, v17
    v_mfma_f32_16x16x32_bf16 v[108:111], v[40:43], v[216:219], v[108:111]
    s_waitcnt lgkmcnt(2)
    buffer_load_dwordx3 v[240:242], v12, s[68:71], s16 offen offset:0 nt
    v_mfma_f32_16x16x32_bf16 v[176:179], v[24:27], a[192:195], v[128:131]
    ds_read_b128 v[40:43], v2 offset:12416
    v_and_b32 v51, s97, v58
    v_mfma_f32_16x16x32_bf16 v[176:179], v[28:31], a[196:199], v[176:179]
    v_exp_f32 v19, v127
    v_cvt_pk_bf16_f32 v94, v16, v17
    v_mfma_f32_16x16x32_bf16 v[180:183], v[28:31], a[220:223], v[132:135]
    s_mov_b32 s30, s29
    v_add_f32 v8, v8, v18
    v_add_f32 v8, v8, v19
    v_mfma_f32_16x16x32_bf16 v[180:183], v[24:27], a[216:219], v[180:183]
    buffer_load_dwordx4 v4, s[4:7], s27 offen offset:1024 sc1 lds
    v_mfma_f32_16x16x32_bf16 v[184:187], v[24:27], a[240:243], v[136:139]
    ds_read_b128 v[44:47], v3 offset:12416
    v_cvt_pk_bf16_f32 v95, v18, v19
    v_mfma_f32_16x16x32_bf16 v[184:187], v[28:31], a[244:247], v[184:187]
    v_exp_f32 v16, v160
    v_mfma_f32_16x16x32_bf16 v[188:191], v[28:31], v[204:207], v[140:143]
    v_exp_f32 v17, v161
    v_mfma_f32_16x16x32_bf16 v[188:191], v[24:27], v[200:203], v[188:191]
    s_waitcnt lgkmcnt(2)
    buffer_load_dwordx3 v[244:246], v12, s[68:71], s16 offen offset:768 nt
    v_mfma_f32_16x16x32_bf16 v[112:115], v[32:35], a[192:195], v[128:131]
    ds_read_b128 v[24:27], v2 offset:18560
    v_mul_f32_e64 v50, -v50, v48
    v_mfma_f32_16x16x32_bf16 v[112:115], v[36:39], a[196:199], v[112:115]
    v_exp_f32 v18, v162
    v_mfma_f32_16x16x32_bf16 v[116:119], v[36:39], a[220:223], v[132:135]
    v_add_f32 v5, v5, v16
    v_add_f32 v5, v5, v17
    v_mfma_f32_16x16x32_bf16 v[116:119], v[32:35], a[216:219], v[116:119]
    v_exp_f32 v19, v163
    v_mfma_f32_16x16x32_bf16 v[120:123], v[32:35], a[240:243], v[136:139]
    ds_read_b128 v[28:31], v3 offset:18560
    v_cvt_pk_bf16_f32 v160, v16, v17
    v_mfma_f32_16x16x32_bf16 v[120:123], v[36:39], a[244:247], v[120:123]
    buffer_load_dwordx3 v[248:250], v12, s[68:71], s16 offen offset:1536 nt
    v_mfma_f32_16x16x32_bf16 v[124:127], v[36:39], v[204:207], v[140:143]
    v_exp_f32 v16, v96
    v_mfma_f32_16x16x32_bf16 v[124:127], v[32:35], v[200:203], v[124:127]
    s_waitcnt lgkmcnt(2)
    v_add_f32 v5, v5, v18
    v_add_f32 v5, v5, v19
    v_mfma_f32_16x16x32_bf16 v[176:179], v[40:43], a[200:203], v[176:179]
    ds_read_b128 v[32:35], v2 offset:12544
    v_mul_f32_e64 v51, -v51, v49
    v_mfma_f32_16x16x32_bf16 v[176:179], v[44:47], a[204:207], v[176:179]
    buffer_load_dwordx4 v4, s[4:7], s27 offen offset:2048 sc1 lds
    v_mfma_f32_16x16x32_bf16 v[180:183], v[44:47], a[228:231], v[180:183]
    v_exp_f32 v17, v97
    v_mfma_f32_16x16x32_bf16 v[180:183], v[40:43], a[224:227], v[180:183]
    v_cvt_pk_bf16_f32 v161, v18, v19
    v_add_u32 v1, s3, v1
    v_mfma_f32_16x16x32_bf16 v[184:187], v[40:43], a[248:251], v[184:187]
    ds_read_b128 v[36:39], v3 offset:12544
    v_cvt_f32_i32 v144, v144
    v_mfma_f32_16x16x32_bf16 v[184:187], v[44:47], a[252:255], v[184:187]
    buffer_load_dwordx3 v[252:254], v12, s[68:71], s16 offen offset:2304 nt
    v_mfma_f32_16x16x32_bf16 v[188:191], v[44:47], v[212:215], v[188:191]
    v_exp_f32 v18, v98
    v_mfma_f32_16x16x32_bf16 v[188:191], v[40:43], v[208:211], v[188:191]
    s_waitcnt lgkmcnt(2)
    v_add_f32 v5, v5, v16
    v_add_f32 v5, v5, v17
    v_mfma_f32_16x16x32_bf16 v[112:115], v[24:27], a[200:203], v[112:115]
    ds_read_b128 v[40:43], v2 offset:18688
    v_cvt_f32_i32 v148, v148
    v_mfma_f32_16x16x32_bf16 v[112:115], v[28:31], a[204:207], v[112:115]
    v_exp_f32 v19, v99
    v_cvt_pk_bf16_f32 v162, v16, v17
    v_mfma_f32_16x16x32_bf16 v[116:119], v[28:31], a[228:231], v[116:119]
    v_exp_f32 v16, v164
    v_mfma_f32_16x16x32_bf16 v[116:119], v[24:27], a[224:227], v[116:119]
    s_add_u32 s27, s27, 24576
    v_add_f32 v5, v5, v18
    v_add_f32 v5, v5, v19
    v_mfma_f32_16x16x32_bf16 v[120:123], v[24:27], a[248:251], v[120:123]
    s_add_u32 s56, s56, 36864
    ds_read_b128 v[44:47], v3 offset:18688
    v_fma_f32 v144, v144, v48, v50
    v_mfma_f32_16x16x32_bf16 v[120:123], v[28:31], a[252:255], v[120:123]
    s_waitcnt lgkmcnt(2)
    v_exp_f32 v17, v165
    v_mfma_f32_16x16x32_bf16 v[124:127], v[28:31], v[212:215], v[124:127]
    s_waitcnt vmcnt(12)
    v_cvt_pk_bf16_f32 v163, v18, v19
    s_sub_u32 s58, s56, 147456
    v_mfma_f32_16x16x32_bf16 v[124:127], v[24:27], v[208:211], v[124:127]
    s_barrier
    v_mfma_f32_16x16x32_bf16 v[176:179], v[32:35], a[208:211], v[176:179]
    s_min_u32 s56, s56, s58
    ds_read_b128 v[24:27], v1 offset:0
    v_mfma_f32_16x16x32_bf16 v[176:179], v[36:39], a[212:215], v[176:179]
    v_exp_f32 v18, v166
    v_mfma_f32_16x16x32_bf16 v[180:183], v[36:39], a[236:239], v[180:183]
    v_add_f32 v6, v6, v16
    v_add_f32 v6, v6, v17
    v_mfma_f32_16x16x32_bf16 v[180:183], v[32:35], a[232:235], v[180:183]
    v_exp_f32 v19, v167
    v_mfma_f32_16x16x32_bf16 v[184:187], v[32:35], v[192:195], v[184:187]
    ds_read_b128 v[28:31], v1 offset:12288
    v_cvt_pk_bf16_f32 v164, v16, v17
    v_mfma_f32_16x16x32_bf16 v[184:187], v[36:39], v[196:199], v[184:187]
    v_exp_f32 v16, v100
    v_mfma_f32_16x16x32_bf16 v[188:191], v[36:39], v[220:223], v[188:191]
    v_add_f32 v6, v6, v18
    v_add_f32 v6, v6, v19
    v_mfma_f32_16x16x32_bf16 v[188:191], v[32:35], v[216:219], v[188:191]
    s_waitcnt lgkmcnt(2)
    v_exp_f32 v17, v101
    v_mfma_f32_16x16x32_bf16 v[112:115], v[40:43], a[208:211], v[112:115]
    ds_read_b128 v[32:35], v1 offset:1024
    v_cvt_pk_bf16_f32 v165, v18, v19
    v_mfma_f32_16x16x32_bf16 v[112:115], v[44:47], a[212:215], v[112:115]
    v_exp_f32 v18, v102
    v_mfma_f32_16x16x32_bf16 v[116:119], v[44:47], a[236:239], v[116:119]
    v_add_f32 v6, v6, v16
    v_add_f32 v6, v6, v17
    v_mfma_f32_16x16x32_bf16 v[116:119], v[40:43], a[232:235], v[116:119]
    v_exp_f32 v19, v103
    v_mfma_f32_16x16x32_bf16 v[120:123], v[40:43], v[192:195], v[120:123]
    ds_read_b128 v[36:39], v1 offset:13312
    v_cvt_pk_bf16_f32 v166, v16, v17
    v_mfma_f32_16x16x32_bf16 v[120:123], v[44:47], v[196:199], v[120:123]
    v_add_f32 v6, v6, v18
    v_fma_f32 v148, v148, v49, v51
    v_mfma_f32_16x16x32_bf16 v[124:127], v[44:47], v[220:223], v[124:127]
    v_add_f32 v6, v6, v19
    v_cvt_pk_bf16_f32 v167, v18, v19
    v_mfma_f32_16x16x32_bf16 v[124:127], v[40:43], v[216:219], v[124:127]
    s_waitcnt lgkmcnt(2)
    v_mfma_f32_16x16x32_bf16 a[0:3], v[64:67], v[24:27], a[0:3]
    ds_read_b128 v[40:43], v1 offset:2048
    v_cvt_f32_i32 v145, v145
    v_mfma_f32_16x16x32_bf16 a[0:3], v[80:83], v[28:31], a[0:3]
    buffer_store_dwordx4 v[224:227], v11, s[4:7], s33 offen offset:0 sc1
    v_mfma_f32_16x16x32_bf16 a[48:51], v[84:87], v[28:31], a[48:51]
    v_exp_f32 v16, v168
    v_mfma_f32_16x16x32_bf16 a[48:51], v[68:71], v[24:27], a[48:51]
    v_exp_f32 v17, v169
    v_mfma_f32_16x16x32_bf16 a[96:99], v[72:75], v[24:27], a[96:99]
    ds_read_b128 v[44:47], v1 offset:14336
    v_cvt_f32_i32 v149, v149
    v_mfma_f32_16x16x32_bf16 a[96:99], v[88:91], v[28:31], a[96:99]
    v_exp_f32 v18, v170
    v_mfma_f32_16x16x32_bf16 a[144:147], v[92:95], v[28:31], a[144:147]
    v_add_f32 v7, v7, v16
    v_add_f32 v7, v7, v17
    v_mfma_f32_16x16x32_bf16 a[144:147], v[76:79], v[24:27], a[144:147]
    s_waitcnt lgkmcnt(2)
    v_exp_f32 v19, v171
    v_mfma_f32_16x16x32_bf16 a[4:7], v[64:67], v[32:35], a[4:7]
    ds_read_b128 v[24:27], v1 offset:3072
    v_cvt_pk_bf16_f32 v168, v16, v17
    v_mfma_f32_16x16x32_bf16 a[4:7], v[80:83], v[36:39], a[4:7]
    buffer_store_dwordx4 v[228:231], v21, s[4:7], s33 offen offset:768 sc1
    v_mfma_f32_16x16x32_bf16 a[52:55], v[84:87], v[36:39], a[52:55]
    v_exp_f32 v16, v104
    v_mfma_f32_16x16x32_bf16 a[52:55], v[68:71], v[32:35], a[52:55]
    v_add_f32 v7, v7, v18
    v_fma_f32 v145, v145, v48, v50
    v_mfma_f32_16x16x32_bf16 a[100:103], v[72:75], v[32:35], a[100:103]
    ds_read_b128 v[28:31], v1 offset:15360
    v_add_f32 v7, v7, v19
    v_mfma_f32_16x16x32_bf16 a[100:103], v[88:91], v[36:39], a[100:103]
    v_exp_f32 v17, v105
    v_mfma_f32_16x16x32_bf16 a[148:151], v[92:95], v[36:39], a[148:151]
    v_cvt_pk_bf16_f32 v169, v18, v19
    v_fma_f32 v149, v149, v49, v51
    v_mfma_f32_16x16x32_bf16 a[148:151], v[76:79], v[32:35], a[148:151]
    s_waitcnt lgkmcnt(2)
    v_exp_f32 v18, v106
    v_mfma_f32_16x16x32_bf16 a[8:11], v[64:67], v[40:43], a[8:11]
    ds_read_b128 v[32:35], v1 offset:4096
    v_add_f32 v7, v7, v16
    v_mfma_f32_16x16x32_bf16 a[8:11], v[80:83], v[44:47], a[8:11]
    buffer_store_dwordx4 v[232:235], v22, s[4:7], s33 offen offset:1536 sc1
    v_mfma_f32_16x16x32_bf16 a[56:59], v[84:87], v[44:47], a[56:59]
    v_add_f32 v7, v7, v17
    v_cvt_f32_i32 v146, v146
    v_mfma_f32_16x16x32_bf16 a[56:59], v[68:71], v[40:43], a[56:59]
    v_exp_f32 v19, v107
    v_mfma_f32_16x16x32_bf16 a[104:107], v[72:75], v[40:43], a[104:107]
    ds_read_b128 v[36:39], v1 offset:16384
    v_cvt_pk_bf16_f32 v170, v16, v17
    v_mfma_f32_16x16x32_bf16 a[104:107], v[88:91], v[44:47], a[104:107]
    v_exp_f32 v16, v172
    v_mfma_f32_16x16x32_bf16 a[152:155], v[92:95], v[44:47], a[152:155]
    v_add_f32 v7, v7, v18
    v_cvt_f32_i32 v150, v150
    v_mfma_f32_16x16x32_bf16 a[152:155], v[76:79], v[40:43], a[152:155]
    s_waitcnt lgkmcnt(2)
    v_add_f32 v7, v7, v19
    v_fma_f32 v146, v146, v48, v50
    v_mfma_f32_16x16x32_bf16 a[12:15], v[64:67], v[24:27], a[12:15]
    ds_read_b128 v[40:43], v1 offset:5120
    v_mfma_f32_16x16x32_bf16 a[12:15], v[80:83], v[28:31], a[12:15]
    buffer_store_dwordx4 v[236:239], v23, s[4:7], s33 offen offset:2304 sc1
    v_mfma_f32_16x16x32_bf16 a[60:63], v[84:87], v[28:31], a[60:63]
    v_exp_f32 v17, v173
    v_mfma_f32_16x16x32_bf16 a[60:63], v[68:71], v[24:27], a[60:63]
    v_cvt_pk_bf16_f32 v171, v18, v19
    v_fma_f32 v150, v150, v49, v51
    v_mfma_f32_16x16x32_bf16 a[108:111], v[72:75], v[24:27], a[108:111]
    ds_read_b128 v[44:47], v1 offset:17408
    v_mfma_f32_16x16x32_bf16 a[108:111], v[88:91], v[28:31], a[108:111]
    v_exp_f32 v18, v174
    v_mfma_f32_16x16x32_bf16 a[156:159], v[92:95], v[28:31], a[156:159]
    s_add_u32 s29, s28, 49152
    v_add_f32 v8, v8, v16
    v_add_f32 v8, v8, v17
    v_mfma_f32_16x16x32_bf16 a[156:159], v[76:79], v[24:27], a[156:159]
    s_waitcnt lgkmcnt(2)
    v_exp_f32 v19, v175
    v_mfma_f32_16x16x32_bf16 a[16:19], v[64:67], v[32:35], a[16:19]
    s_sub_u32 s3, s29, 147456
    ds_read_b128 v[24:27], v1 offset:6144
    v_cvt_pk_bf16_f32 v172, v16, v17
    v_mfma_f32_16x16x32_bf16 a[16:19], v[80:83], v[36:39], a[16:19]
    s_mov_b32 m0, s26
    v_exp_f32 v16, v108
    v_mfma_f32_16x16x32_bf16 a[64:67], v[84:87], v[36:39], a[64:67]
    s_min_u32 s29, s29, s3
    v_add_f32 v8, v8, v18
    v_lshlrev_b32 v48, 16, v57
    v_mfma_f32_16x16x32_bf16 a[64:67], v[68:71], v[32:35], a[64:67]
    buffer_load_dwordx4 v4, s[4:7], s32 offen offset:0 sc1 lds
    v_mfma_f32_16x16x32_bf16 a[112:115], v[72:75], v[32:35], a[112:115]
    ds_read_b128 v[28:31], v1 offset:18432
    v_add_f32 v8, v8, v19
    v_mfma_f32_16x16x32_bf16 a[112:115], v[88:91], v[36:39], a[112:115]
    v_exp_f32 v17, v109
    v_mfma_f32_16x16x32_bf16 a[160:163], v[92:95], v[36:39], a[160:163]
    v_cvt_pk_bf16_f32 v173, v18, v19
    v_and_b32 v49, s97, v57
    v_mfma_f32_16x16x32_bf16 a[160:163], v[76:79], v[32:35], a[160:163]
    s_waitcnt lgkmcnt(2)
    buffer_load_dwordx4 v4, s[4:7], s32 offen offset:1024 sc1 lds
    v_mfma_f32_16x16x32_bf16 a[20:23], v[64:67], v[40:43], a[20:23]
    s_sub_u32 s3, s29, s28
    ds_read_b128 v[32:35], v1 offset:7168
    v_lshlrev_b32 v50, 16, v59
    v_mfma_f32_16x16x32_bf16 a[20:23], v[80:83], v[44:47], a[20:23]
    v_exp_f32 v18, v110
    v_mfma_f32_16x16x32_bf16 a[68:71], v[84:87], v[44:47], a[68:71]
    v_add_f32 v8, v8, v16
    v_add_f32 v8, v8, v17
    v_mfma_f32_16x16x32_bf16 a[68:71], v[68:71], v[40:43], a[68:71]
    buffer_load_dwordx4 v4, s[4:7], s32 offen offset:2048 sc1 lds
    v_mfma_f32_16x16x32_bf16 a[116:119], v[72:75], v[40:43], a[116:119]
    ds_read_b128 v[36:39], v1 offset:19456
    v_mfma_f32_16x16x32_bf16 a[116:119], v[88:91], v[44:47], a[116:119]
    v_exp_f32 v19, v111
    v_mfma_f32_16x16x32_bf16 a[164:167], v[92:95], v[44:47], a[164:167]
    s_mov_b32 s28, s29
    v_cvt_pk_bf16_f32 v174, v16, v17
    v_add_f32 v8, v8, v18
    v_mfma_f32_16x16x32_bf16 a[164:167], v[76:79], v[40:43], a[164:167]
    s_waitcnt lgkmcnt(2)
    v_add_f32 v8, v8, v19
    v_cvt_pk_bf16_f32 v175, v18, v19
    v_mfma_f32_16x16x32_bf16 a[24:27], v[64:67], v[24:27], a[24:27]
    s_add_u32 s32, s32, 24576
    ds_read_b128 v[40:43], v1 offset:8192
    v_and_b32 v51, s97, v59
    v_mfma_f32_16x16x32_bf16 a[24:27], v[80:83], v[28:31], a[24:27]
    v_exp_f32 v16, v176
    v_mfma_f32_16x16x32_bf16 a[72:75], v[84:87], v[28:31], a[72:75]
    s_add_u32 s26, s26, 12288
    v_exp_f32 v17, v177
    v_mfma_f32_16x16x32_bf16 a[72:75], v[68:71], v[24:27], a[72:75]
    v_exp_f32 v18, v178
    v_mfma_f32_16x16x32_bf16 a[120:123], v[72:75], v[24:27], a[120:123]
    s_mov_b32 m0, s26
    ds_read_b128 v[44:47], v1 offset:20480
    v_add_f32 v5, v5, v16
    v_mfma_f32_16x16x32_bf16 a[120:123], v[88:91], v[28:31], a[120:123]
    v_add_f32 v5, v5, v17
    v_mul_f32_e64 v50, -v50, v48
    v_mfma_f32_16x16x32_bf16 a[168:171], v[92:95], v[28:31], a[168:171]
    v_exp_f32 v19, v179
    v_mfma_f32_16x16x32_bf16 a[168:171], v[76:79], v[24:27], a[168:171]
    s_waitcnt lgkmcnt(2)
    v_cvt_pk_bf16_f32 v176, v16, v17
    v_mul_f32_e64 v51, -v51, v49
    v_mfma_f32_16x16x32_bf16 a[28:31], v[64:67], v[32:35], a[28:31]
    ds_read_b128 v[24:27], v1 offset:9216
    v_add_u32 v2, s3, v2
    v_mfma_f32_16x16x32_bf16 a[28:31], v[80:83], v[36:39], a[28:31]
    buffer_load_dwordx4 v4, s[4:7], s32 offen offset:0 sc1 lds
    v_mfma_f32_16x16x32_bf16 a[76:79], v[84:87], v[36:39], a[76:79]
    v_exp_f32 v16, v112
    v_mfma_f32_16x16x32_bf16 a[76:79], v[68:71], v[32:35], a[76:79]
    v_add_f32 v5, v5, v18
    v_add_f32 v5, v5, v19
    v_mfma_f32_16x16x32_bf16 a[124:127], v[72:75], v[32:35], a[124:127]
    ds_read_b128 v[28:31], v1 offset:21504
    v_cvt_f32_i32 v152, v152
    v_mfma_f32_16x16x32_bf16 a[124:127], v[88:91], v[36:39], a[124:127]
    buffer_load_dwordx4 v4, s[4:7], s32 offen offset:1024 sc1 lds
    v_mfma_f32_16x16x32_bf16 a[172:175], v[92:95], v[36:39], a[172:175]
    v_exp_f32 v17, v113
    v_mfma_f32_16x16x32_bf16 a[172:175], v[76:79], v[32:35], a[172:175]
    s_waitcnt lgkmcnt(2)
    v_cvt_pk_bf16_f32 v177, v18, v19
    v_add_u32 v3, s3, v3
    v_mfma_f32_16x16x32_bf16 a[32:35], v[64:67], v[40:43], a[32:35]
    ds_read_b128 v[32:35], v1 offset:10240
    v_cvt_f32_i32 v156, v156
    v_mfma_f32_16x16x32_bf16 a[32:35], v[80:83], v[44:47], a[32:35]
    v_exp_f32 v18, v114
    v_mfma_f32_16x16x32_bf16 a[80:83], v[84:87], v[44:47], a[80:83]
    v_add_f32 v5, v5, v16
    v_add_f32 v5, v5, v17
    v_mfma_f32_16x16x32_bf16 a[80:83], v[68:71], v[40:43], a[80:83]
    buffer_load_dwordx4 v4, s[4:7], s32 offen offset:2048 sc1 lds
    v_mfma_f32_16x16x32_bf16 a[128:131], v[72:75], v[40:43], a[128:131]
    ds_read_b128 v[36:39], v1 offset:22528
    v_mfma_f32_16x16x32_bf16 a[128:131], v[88:91], v[44:47], a[128:131]
    v_exp_f32 v19, v115
    v_mfma_f32_16x16x32_bf16 a[176:179], v[92:95], v[44:47], a[176:179]
    v_cvt_pk_bf16_f32 v178, v16, v17
    v_fma_f32 v152, v152, v48, v50
    v_mfma_f32_16x16x32_bf16 a[176:179], v[76:79], v[40:43], a[176:179]
    s_waitcnt lgkmcnt(2)
    v_exp_f32 v16, v180
    v_mfma_f32_16x16x32_bf16 a[36:39], v[64:67], v[24:27], a[36:39]
    ds_read_b128 v[40:43], v1 offset:11264
    v_add_f32 v5, v5, v18
    v_mfma_f32_16x16x32_bf16 a[36:39], v[80:83], v[28:31], a[36:39]
    v_add_f32 v5, v5, v19
    v_mfma_f32_16x16x32_bf16 a[84:87], v[84:87], v[28:31], a[84:87]
    v_exp_f32 v17, v181
    v_mfma_f32_16x16x32_bf16 a[84:87], v[68:71], v[24:27], a[84:87]
    s_add_u32 s32, s32, 24576
    v_cvt_pk_bf16_f32 v179, v18, v19
    s_add_u32 s26, s26, 36864
    v_mfma_f32_16x16x32_bf16 a[132:135], v[72:75], v[24:27], a[132:135]
    s_sub_u32 s57, s26, 147456
    ds_read_b128 v[44:47], v1 offset:23552
    v_fma_f32 v156, v156, v49, v51
    v_mfma_f32_16x16x32_bf16 a[132:135], v[88:91], v[28:31], a[132:135]
    s_waitcnt lgkmcnt(2)
    v_exp_f32 v18, v182
    v_mfma_f32_16x16x32_bf16 a[180:183], v[92:95], v[28:31], a[180:183]
    s_waitcnt vmcnt(6)
    v_add_f32 v6, v6, v16
    v_add_f32 v6, v6, v17
    v_mfma_f32_16x16x32_bf16 a[180:183], v[76:79], v[24:27], a[180:183]
    s_barrier
    v_mfma_f32_16x16x32_bf16 a[40:43], v[64:67], v[32:35], a[40:43]
    s_min_u32 s26, s26, s57
    ds_read_b128 v[24:27], v2 offset:0
    v_add_u32 v0, 1, v0
    v_mfma_f32_16x16x32_bf16 a[40:43], v[80:83], v[36:39], a[40:43]
    buffer_store_dword v0, v13, s[20:23], 0 offen offset:32 sc1
    v_mfma_f32_16x16x32_bf16 a[88:91], v[84:87], v[36:39], a[88:91]
    v_exp_f32 v19, v183
    v_mfma_f32_16x16x32_bf16 a[88:91], v[68:71], v[32:35], a[88:91]
    v_cvt_pk_bf16_f32 v180, v16, v17
    v_cvt_f32_i32 v153, v153
    v_mfma_f32_16x16x32_bf16 a[136:139], v[72:75], v[32:35], a[136:139]
    ds_read_b128 v[28:31], v3 offset:0
    v_cvt_f32_i32 v157, v157
    v_mfma_f32_16x16x32_bf16 a[136:139], v[88:91], v[36:39], a[136:139]
    v_exp_f32 v16, v116
    v_mfma_f32_16x16x32_bf16 a[184:187], v[92:95], v[36:39], a[184:187]
    v_add_f32 v6, v6, v18
    v_add_f32 v6, v6, v19
    v_mfma_f32_16x16x32_bf16 a[184:187], v[76:79], v[32:35], a[184:187]
    s_waitcnt lgkmcnt(2)
    v_exp_f32 v17, v117
    v_mfma_f32_16x16x32_bf16 a[44:47], v[64:67], v[40:43], a[44:47]
    ds_read_b128 v[32:35], v2 offset:6144
    v_cvt_pk_bf16_f32 v181, v18, v19
    v_mfma_f32_16x16x32_bf16 a[44:47], v[80:83], v[44:47], a[44:47]
    v_exp_f32 v18, v118
    v_mfma_f32_16x16x32_bf16 a[92:95], v[84:87], v[44:47], a[92:95]
    v_add_f32 v6, v6, v16
    v_add_f32 v6, v6, v17
    v_mfma_f32_16x16x32_bf16 a[92:95], v[68:71], v[40:43], a[92:95]
    v_exp_f32 v19, v119
    v_mfma_f32_16x16x32_bf16 a[140:143], v[72:75], v[40:43], a[140:143]
    ds_read_b128 v[36:39], v3 offset:6144
    v_cvt_pk_bf16_f32 v182, v16, v17
    v_mfma_f32_16x16x32_bf16 a[140:143], v[88:91], v[44:47], a[140:143]
    v_add_f32 v6, v6, v18
    v_add_f32 v6, v6, v19
    v_mfma_f32_16x16x32_bf16 a[188:191], v[92:95], v[44:47], a[188:191]
    v_cvt_pk_bf16_f32 v183, v18, v19
    v_mfma_f32_16x16x32_bf16 a[188:191], v[76:79], v[40:43], a[188:191]
    s_waitcnt lgkmcnt(2)
    v_mfma_f32_16x16x32_bf16 v[64:67], v[24:27], a[192:195], v[128:131]
    s_mov_b32 m0, s56
    ds_read_b128 v[40:43], v2 offset:128
    v_fma_f32 v153, v153, v48, v50
    v_mfma_f32_16x16x32_bf16 v[64:67], v[28:31], a[196:199], v[64:67]
    buffer_load_dwordx4 v4, s[4:7], s27 offen offset:0 sc1 lds
    v_mfma_f32_16x16x32_bf16 v[68:71], v[28:31], a[220:223], v[132:135]
    v_exp_f32 v16, v184
    v_mfma_f32_16x16x32_bf16 v[68:71], v[24:27], a[216:219], v[68:71]
    v_exp_f32 v17, v185
    v_mfma_f32_16x16x32_bf16 v[72:75], v[24:27], a[240:243], v[136:139]
    ds_read_b128 v[44:47], v3 offset:128
    v_fma_f32 v157, v157, v49, v51
    v_mfma_f32_16x16x32_bf16 v[72:75], v[28:31], a[244:247], v[72:75]
    v_exp_f32 v18, v186
    v_mfma_f32_16x16x32_bf16 v[76:79], v[28:31], v[204:207], v[140:143]
    v_add_f32 v7, v7, v16
    v_add_f32 v7, v7, v17
    v_mfma_f32_16x16x32_bf16 v[76:79], v[24:27], v[200:203], v[76:79]
    s_waitcnt lgkmcnt(2)
    v_exp_f32 v19, v187
    v_mfma_f32_16x16x32_bf16 v[96:99], v[32:35], a[192:195], v[128:131]
    ds_read_b128 v[24:27], v2 offset:6272
    v_cvt_pk_bf16_f32 v184, v16, v17
    v_mfma_f32_16x16x32_bf16 v[96:99], v[36:39], a[196:199], v[96:99]
    v_exp_f32 v16, v120
    v_mfma_f32_16x16x32_bf16 v[100:103], v[36:39], a[220:223], v[132:135]
    v_cvt_f32_i32 v154, v154
    v_add_f32 v7, v7, v18
    v_mfma_f32_16x16x32_bf16 v[100:103], v[32:35], a[216:219], v[100:103]
    buffer_load_dwordx4 v4, s[4:7], s27 offen offset:1024 sc1 lds
    v_mfma_f32_16x16x32_bf16 v[104:107], v[32:35], a[240:243], v[136:139]
    ds_read_b128 v[28:31], v3 offset:6272
    v_add_f32 v7, v7, v19
    v_mfma_f32_16x16x32_bf16 v[104:107], v[36:39], a[244:247], v[104:107]
    v_exp_f32 v17, v121
    v_mfma_f32_16x16x32_bf16 v[108:111], v[36:39], v[204:207], v[140:143]
    v_cvt_f32_i32 v158, v158
    v_cvt_pk_bf16_f32 v185, v18, v19
    v_mfma_f32_16x16x32_bf16 v[108:111], v[32:35], v[200:203], v[108:111]
    s_waitcnt lgkmcnt(2)
    v_exp_f32 v18, v122
    v_mfma_f32_16x16x32_bf16 v[64:67], v[40:43], a[200:203], v[64:67]
    ds_read_b128 v[32:35], v2 offset:256
    v_fma_f32 v154, v154, v48, v50
    v_mfma_f32_16x16x32_bf16 v[64:67], v[44:47], a[204:207], v[64:67]
    v_add_f32 v7, v7, v16
    v_add_f32 v7, v7, v17
    v_mfma_f32_16x16x32_bf16 v[68:71], v[44:47], a[228:231], v[68:71]
    v_exp_f32 v19, v123
    v_mfma_f32_16x16x32_bf16 v[68:71], v[40:43], a[224:227], v[68:71]
    v_fma_f32 v158, v158, v49, v51
    v_cvt_pk_bf16_f32 v186, v16, v17
    v_mfma_f32_16x16x32_bf16 v[72:75], v[40:43], a[248:251], v[72:75]
    ds_read_b128 v[36:39], v3 offset:256
    v_cvt_pk_bf16_f32 v144, v144, v148
    v_mfma_f32_16x16x32_bf16 v[72:75], v[44:47], a[252:255], v[72:75]
    v_exp_f32 v16, v188
    v_mfma_f32_16x16x32_bf16 v[76:79], v[44:47], v[212:215], v[76:79]
    v_add_f32 v7, v7, v18
    v_add_f32 v7, v7, v19
    v_mfma_f32_16x16x32_bf16 v[76:79], v[40:43], v[208:211], v[76:79]
    s_waitcnt lgkmcnt(2)
    buffer_load_dwordx4 v4, s[4:7], s27 offen offset:2048 sc1 lds
    v_mfma_f32_16x16x32_bf16 v[96:99], v[24:27], a[200:203], v[96:99]
    ds_read_b128 v[40:43], v2 offset:6400
    v_cvt_pk_bf16_f32 v148, v145, v149
    v_mfma_f32_16x16x32_bf16 v[96:99], v[28:31], a[204:207], v[96:99]
    v_exp_f32 v17, v189
    v_mfma_f32_16x16x32_bf16 v[100:103], v[28:31], a[228:231], v[100:103]
    v_cvt_pk_bf16_f32 v187, v18, v19
    v_mfma_f32_16x16x32_bf16 v[100:103], v[24:27], a[224:227], v[100:103]
    v_exp_f32 v18, v190
    v_mfma_f32_16x16x32_bf16 v[104:107], v[24:27], a[248:251], v[104:107]
    ds_read_b128 v[44:47], v3 offset:6400
    v_add_f32 v8, v8, v16
    v_mfma_f32_16x16x32_bf16 v[104:107], v[28:31], a[252:255], v[104:107]
    v_add_f32 v8, v8, v17
    v_cvt_pk_bf16_f32 v145, v152, v156
    v_mfma_f32_16x16x32_bf16 v[108:111], v[28:31], v[212:215], v[108:111]
    s_add_u32 s29, s30, 49152
    v_exp_f32 v19, v191
    v_mfma_f32_16x16x32_bf16 v[108:111], v[24:27], v[208:211], v[108:111]
    s_waitcnt lgkmcnt(2)
    v_cvt_pk_bf16_f32 v188, v16, v17
    s_sub_u32 s3, s29, 147456
    v_mfma_f32_16x16x32_bf16 v[64:67], v[32:35], a[208:211], v[64:67]
    s_add_u32 s27, s27, 24576
    ds_read_b128 v[24:27], v2 offset:12288
    v_cvt_pk_bf16_f32 v149, v153, v157
    v_mfma_f32_16x16x32_bf16 v[64:67], v[36:39], a[212:215], v[64:67]
    s_min_u32 s29, s29, s3
    v_exp_f32 v16, v124
    v_mfma_f32_16x16x32_bf16 v[68:71], v[36:39], a[236:239], v[68:71]
    v_add_f32 v8, v8, v18
    v_add_f32 v8, v8, v19
    v_mfma_f32_16x16x32_bf16 v[68:71], v[32:35], a[232:235], v[68:71]
    v_exp_f32 v17, v125
    v_mfma_f32_16x16x32_bf16 v[72:75], v[32:35], v[192:195], v[72:75]
    s_add_u32 s56, s56, 12288
    ds_read_b128 v[28:31], v3 offset:12288
    v_cvt_pk_bf16_f32 v152, v146, v150
    v_mfma_f32_16x16x32_bf16 v[72:75], v[36:39], v[196:199], v[72:75]
L_pg8:
    s_cbranch_execz L_pg12
    v_cvt_pk_bf16_f32 v189, v18, v19
    v_mfma_f32_16x16x32_bf16 v[76:79], v[36:39], v[220:223], v[76:79]
    v_exp_f32 v18, v126
    v_mfma_f32_16x16x32_bf16 v[76:79], v[32:35], v[216:219], v[76:79]
    s_waitcnt lgkmcnt(2)
    v_add_f32 v8, v8, v16
    v_mfma_f32_16x16x32_bf16 v[96:99], v[40:43], a[208:211], v[96:99]
    ds_read_b128 v[32:35], v2 offset:18432
    v_add_f32 v8, v8, v17
    v_mfma_f32_16x16x32_bf16 v[96:99], v[44:47], a[212:215], v[96:99]
    s_sub_u32 s3, s29, s30
    v_exp_f32 v19, v127
    v_mfma_f32_16x16x32_bf16 v[100:103], v[44:47], a[236:239], v[100:103]
    s_mov_b32 m0, s56
    v_cvt_pk_bf16_f32 v153, v154, v158
    v_mfma_f32_16x16x32_bf16 v[100:103], v[40:43], a[232:235], v[100:103]
    v_cvt_pk_bf16_f32 v190, v16, v17
    v_mfma_f32_16x16x32_bf16 v[104:107], v[40:43], v[192:195], v[104:107]
    ds_read_b128 v[36:39], v3 offset:18432
    v_add_f32 v8, v8, v18
    v_mfma_f32_16x16x32_bf16 v[104:107], v[44:47], v[196:199], v[104:107]
    v_add_f32 v8, v8, v19
    v_cvt_pk_bf16_f32 v191, v18, v19
    v_mfma_f32_16x16x32_bf16 v[108:111], v[44:47], v[220:223], v[108:111]
    v_mfma_f32_16x16x32_bf16 v[108:111], v[40:43], v[216:219], v[108:111]
    s_waitcnt lgkmcnt(2)
    v_exp_f32 v16, v64
    v_mfma_f32_16x16x32_bf16 v[80:83], v[24:27], a[192:195], v[128:131]
    ds_read_b128 v[40:43], v2 offset:12416
    v_mfma_f32_16x16x32_bf16 v[80:83], v[28:31], a[196:199], v[80:83]
    s_mov_b32 s30, s29
    v_exp_f32 v17, v65
    v_mfma_f32_16x16x32_bf16 v[84:87], v[28:31], a[220:223], v[132:135]
    v_exp_f32 v18, v66
    v_mfma_f32_16x16x32_bf16 v[84:87], v[24:27], a[216:219], v[84:87]
    s_waitcnt vmcnt(14)
    buffer_load_dwordx4 v4, s[4:7], s27 offen offset:0 sc1 lds
    v_mfma_f32_16x16x32_bf16 v[88:91], v[24:27], a[240:243], v[136:139]
    ds_read_b128 v[44:47], v3 offset:12416
    v_add_f32 v5, v5, v16
    v_mfma_f32_16x16x32_bf16 v[88:91], v[28:31], a[244:247], v[88:91]
    v_add_f32 v5, v5, v17
    v_lshlrev_b32 v48, 16, v60
    v_mfma_f32_16x16x32_bf16 v[92:95], v[28:31], v[204:207], v[140:143]
    v_exp_f32 v19, v67
    v_mfma_f32_16x16x32_bf16 v[92:95], v[24:27], v[200:203], v[92:95]
    s_waitcnt lgkmcnt(2)
    v_cvt_pk_bf16_f32 v64, v16, v17
    v_and_b32 v49, s97, v60
    v_mfma_f32_16x16x32_bf16 v[112:115], v[32:35], a[192:195], v[128:131]
    ds_read_b128 v[24:27], v2 offset:18560
    v_mfma_f32_16x16x32_bf16 v[112:115], v[36:39], a[196:199], v[112:115]
    v_exp_f32 v16, v96
    v_mfma_f32_16x16x32_bf16 v[116:119], v[36:39], a[220:223], v[132:135]
    v_add_f32 v5, v5, v18
    v_lshlrev_b32 v50, 16, v62
    v_mfma_f32_16x16x32_bf16 v[116:119], v[32:35], a[216:219], v[116:119]
    v_add_f32 v5, v5, v19
    v_add_u32 v1, s3, v1
    v_mfma_f32_16x16x32_bf16 v[120:123], v[32:35], a[240:243], v[136:139]
    ds_read_b128 v[28:31], v3 offset:18560
    v_mfma_f32_16x16x32_bf16 v[120:123], v[36:39], a[244:247], v[120:123]
    v_exp_f32 v17, v97
    v_mfma_f32_16x16x32_bf16 v[124:127], v[36:39], v[204:207], v[140:143]
    v_cvt_pk_bf16_f32 v65, v18, v19
    v_and_b32 v51, s97, v62
    v_mfma_f32_16x16x32_bf16 v[124:127], v[32:35], v[200:203], v[124:127]
    s_waitcnt lgkmcnt(2)
    buffer_load_dwordx4 v4, s[4:7], s27 offen offset:1024 sc1 lds
    v_mfma_f32_16x16x32_bf16 v[80:83], v[40:43], a[200:203], v[80:83]
    ds_read_b128 v[32:35], v2 offset:12544
    v_mfma_f32_16x16x32_bf16 v[80:83], v[44:47], a[204:207], v[80:83]
    v_exp_f32 v18, v98
    v_mfma_f32_16x16x32_bf16 v[84:87], v[44:47], a[228:231], v[84:87]
    v_add_f32 v5, v5, v16
    v_add_f32 v5, v5, v17
    v_mfma_f32_16x16x32_bf16 v[84:87], v[40:43], a[224:227], v[84:87]
    v_exp_f32 v19, v99
    v_mfma_f32_16x16x32_bf16 v[88:91], v[40:43], a[248:251], v[88:91]
    ds_read_b128 v[36:39], v3 offset:12544
    v_cvt_pk_bf16_f32 v66, v16, v17
    v_mfma_f32_16x16x32_bf16 v[88:91], v[44:47], a[252:255], v[88:91]
    v_exp_f32 v16, v68
    v_mfma_f32_16x16x32_bf16 v[92:95], v[44:47], v[212:215], v[92:95]
    v_mul_f32_e64 v50, -v50, v48
    v_add_f32 v5, v5, v18
    v_mfma_f32_16x16x32_bf16 v[92:95], v[40:43], v[208:211], v[92:95]
    s_waitcnt lgkmcnt(2)
    v_add_f32 v5, v5, v19
    v_mul_f32_e64 v51, -v51, v49
    v_mfma_f32_16x16x32_bf16 v[112:115], v[24:27], a[200:203], v[112:115]
    ds_read_b128 v[40:43], v2 offset:18688
    v_mfma_f32_16x16x32_bf16 v[112:115], v[28:31], a[204:207], v[112:115]
    buffer_load_dwordx4 v4, s[4:7], s27 offen offset:2048 sc1 lds
    v_mfma_f32_16x16x32_bf16 v[116:119], v[28:31], a[228:231], v[116:119]
    v_exp_f32 v17, v69
    v_mfma_f32_16x16x32_bf16 v[116:119], v[24:27], a[224:227], v[116:119]
    v_cvt_pk_bf16_f32 v67, v18, v19
    v_cvt_f32_i32 v240, v240
    v_mfma_f32_16x16x32_bf16 v[120:123], v[24:27], a[248:251], v[120:123]
    ds_read_b128 v[44:47], v3 offset:18688
    v_mfma_f32_16x16x32_bf16 v[120:123], v[28:31], a[252:255], v[120:123]
    s_waitcnt lgkmcnt(2)
    v_exp_f32 v18, v70
    v_mfma_f32_16x16x32_bf16 v[124:127], v[28:31], v[212:215], v[124:127]
    s_waitcnt vmcnt(7)
    v_add_f32 v6, v6, v16
    v_add_f32 v6, v6, v17
    v_mfma_f32_16x16x32_bf16 v[124:127], v[24:27], v[208:211], v[124:127]
    s_barrier
    v_mfma_f32_16x16x32_bf16 v[80:83], v[32:35], a[208:211], v[80:83]
    ds_read_b128 v[24:27], v1 offset:0
    v_cvt_f32_i32 v244, v244
    v_mfma_f32_16x16x32_bf16 v[80:83], v[36:39], a[212:215], v[80:83]
    v_exp_f32 v19, v71
    v_mfma_f32_16x16x32_bf16 v[84:87], v[36:39], a[236:239], v[84:87]
    v_cvt_pk_bf16_f32 v68, v16, v17
    v_fma_f32 v240, v240, v48, v50
    v_mfma_f32_16x16x32_bf16 v[84:87], v[32:35], a[232:235], v[84:87]
    v_exp_f32 v16, v100
    v_mfma_f32_16x16x32_bf16 v[88:91], v[32:35], v[192:195], v[88:91]
    ds_read_b128 v[28:31], v1 offset:12288
    v_add_f32 v6, v6, v18
    v_mfma_f32_16x16x32_bf16 v[88:91], v[36:39], v[196:199], v[88:91]
    v_add_f32 v6, v6, v19
    v_fma_f32 v244, v244, v49, v51
    v_mfma_f32_16x16x32_bf16 v[92:95], v[36:39], v[220:223], v[92:95]
    v_exp_f32 v17, v101
    v_mfma_f32_16x16x32_bf16 v[92:95], v[32:35], v[216:219], v[92:95]
    s_waitcnt lgkmcnt(2)
    v_cvt_pk_bf16_f32 v69, v18, v19
    v_mfma_f32_16x16x32_bf16 v[112:115], v[40:43], a[208:211], v[112:115]
    ds_read_b128 v[32:35], v1 offset:1024
    v_mfma_f32_16x16x32_bf16 v[112:115], v[44:47], a[212:215], v[112:115]
    v_exp_f32 v18, v102
    v_mfma_f32_16x16x32_bf16 v[116:119], v[44:47], a[236:239], v[116:119]
    v_add_f32 v6, v6, v16
    v_add_f32 v6, v6, v17
    v_mfma_f32_16x16x32_bf16 v[116:119], v[40:43], a[232:235], v[116:119]
    s_add_u32 s27, s27, 24576
    v_exp_f32 v19, v103
    v_mfma_f32_16x16x32_bf16 v[120:123], v[40:43], v[192:195], v[120:123]
    s_add_u32 s56, s56, 36864
    ds_read_b128 v[36:39], v1 offset:13312
    v_cvt_pk_bf16_f32 v70, v16, v17
    v_mfma_f32_16x16x32_bf16 v[120:123], v[44:47], v[196:199], v[120:123]
    s_sub_u32 s58, s56, 147456
    v_add_f32 v6, v6, v18
    v_add_f32 v6, v6, v19
    v_mfma_f32_16x16x32_bf16 v[124:127], v[44:47], v[220:223], v[124:127]
    s_min_u32 s56, s56, s58
    v_cvt_pk_bf16_f32 v71, v18, v19
    v_mfma_f32_16x16x32_bf16 v[124:127], v[40:43], v[216:219], v[124:127]
    s_waitcnt lgkmcnt(2)
    v_mfma_f32_16x16x32_bf16 a[0:3], v[160:163], v[24:27], a[0:3]
    s_mov_b32 m0, s56
    ds_read_b128 v[40:43], v1 offset:2048
    v_cvt_f32_i32 v241, v241
    v_mfma_f32_16x16x32_bf16 a[0:3], v[176:179], v[28:31], a[0:3]
    buffer_load_dwordx4 v4, s[4:7], s27 offen offset:0 sc1 lds
    v_mfma_f32_16x16x32_bf16 a[48:51], v[180:183], v[28:31], a[48:51]
    v_exp_f32 v16, v72
    v_mfma_f32_16x16x32_bf16 a[48:51], v[164:167], v[24:27], a[48:51]
    v_exp_f32 v17, v73
    v_mfma_f32_16x16x32_bf16 a[96:99], v[168:171], v[24:27], a[96:99]
    ds_read_b128 v[44:47], v1 offset:14336
    v_cvt_f32_i32 v245, v245
    v_mfma_f32_16x16x32_bf16 a[96:99], v[184:187], v[28:31], a[96:99]
    v_exp_f32 v18, v74
    v_mfma_f32_16x16x32_bf16 a[144:147], v[188:191], v[28:31], a[144:147]
    v_add_f32 v7, v7, v16
    v_add_f32 v7, v7, v17
    v_mfma_f32_16x16x32_bf16 a[144:147], v[172:175], v[24:27], a[144:147]
    s_waitcnt lgkmcnt(2)
    v_exp_f32 v19, v75
    v_mfma_f32_16x16x32_bf16 a[4:7], v[160:163], v[32:35], a[4:7]
    ds_read_b128 v[24:27], v1 offset:3072
    v_fma_f32 v241, v241, v48, v50
    v_mfma_f32_16x16x32_bf16 a[4:7], v[176:179], v[36:39], a[4:7]
    buffer_load_dwordx4 v4, s[4:7], s27 offen offset:1024 sc1 lds
    v_mfma_f32_16x16x32_bf16 a[52:55], v[180:183], v[36:39], a[52:55]
    v_cvt_pk_bf16_f32 v72, v16, v17
    v_fma_f32 v245, v245, v49, v51
    v_mfma_f32_16x16x32_bf16 a[52:55], v[164:167], v[32:35], a[52:55]
    v_exp_f32 v16, v104
    v_mfma_f32_16x16x32_bf16 a[100:103], v[168:171], v[32:35], a[100:103]
    ds_read_b128 v[28:31], v1 offset:15360
    v_add_f32 v7, v7, v18
    v_mfma_f32_16x16x32_bf16 a[100:103], v[184:187], v[36:39], a[100:103]
    buffer_load_dword v52, v20, s[20:23], s44 offen sc1
    v_mfma_f32_16x16x32_bf16 a[148:151], v[188:191], v[36:39], a[148:151]
    v_add_f32 v7, v7, v19
    v_cvt_f32_i32 v242, v242
    v_mfma_f32_16x16x32_bf16 a[148:151], v[172:175], v[32:35], a[148:151]
    s_waitcnt lgkmcnt(2)
    v_exp_f32 v17, v105
    v_mfma_f32_16x16x32_bf16 a[8:11], v[160:163], v[40:43], a[8:11]
    ds_read_b128 v[32:35], v1 offset:4096
    v_cvt_pk_bf16_f32 v73, v18, v19
    v_mfma_f32_16x16x32_bf16 a[8:11], v[176:179], v[44:47], a[8:11]
    v_exp_f32 v18, v106
    v_mfma_f32_16x16x32_bf16 a[56:59], v[180:183], v[44:47], a[56:59]
    v_add_f32 v7, v7, v16
    v_cvt_f32_i32 v246, v246
    v_mfma_f32_16x16x32_bf16 a[56:59], v[164:167], v[40:43], a[56:59]
    buffer_load_dwordx4 v4, s[4:7], s27 offen offset:2048 sc1 lds
    v_mfma_f32_16x16x32_bf16 a[104:107], v[168:171], v[40:43], a[104:107]
    ds_read_b128 v[36:39], v1 offset:16384
    v_add_f32 v7, v7, v17
    v_mfma_f32_16x16x32_bf16 a[104:107], v[184:187], v[44:47], a[104:107]
    v_exp_f32 v19, v107
    v_mfma_f32_16x16x32_bf16 a[152:155], v[188:191], v[44:47], a[152:155]
    v_cvt_pk_bf16_f32 v74, v16, v17
    v_fma_f32 v242, v242, v48, v50
    v_mfma_f32_16x16x32_bf16 a[152:155], v[172:175], v[40:43], a[152:155]
    s_waitcnt lgkmcnt(2)
    v_exp_f32 v16, v76
    v_mfma_f32_16x16x32_bf16 a[12:15], v[160:163], v[24:27], a[12:15]
    ds_read_b128 v[40:43], v1 offset:5120
    v_add_f32 v7, v7, v18
    v_mfma_f32_16x16x32_bf16 a[12:15], v[176:179], v[28:31], a[12:15]
    s_add_u32 s27, s27, 24576
    v_add_f32 v7, v7, v19
    v_fma_f32 v246, v246, v49, v51
    v_mfma_f32_16x16x32_bf16 a[60:63], v[180:183], v[28:31], a[60:63]
    v_exp_f32 v17, v77
    v_mfma_f32_16x16x32_bf16 a[60:63], v[164:167], v[24:27], a[60:63]
    v_cvt_pk_bf16_f32 v75, v18, v19
    v_lshlrev_b32 v48, 16, v61
    v_mfma_f32_16x16x32_bf16 a[108:111], v[168:171], v[24:27], a[108:111]
    ds_read_b128 v[44:47], v1 offset:17408
    v_and_b32 v49, s97, v61
    v_mfma_f32_16x16x32_bf16 a[108:111], v[184:187], v[28:31], a[108:111]
    v_exp_f32 v18, v78
    v_mfma_f32_16x16x32_bf16 a[156:159], v[188:191], v[28:31], a[156:159]
    s_add_u32 s29, s28, 49152
    v_add_f32 v8, v8, v16
    v_add_f32 v8, v8, v17
    v_mfma_f32_16x16x32_bf16 a[156:159], v[172:175], v[24:27], a[156:159]
    s_waitcnt lgkmcnt(2)
    v_exp_f32 v19, v79
    v_mfma_f32_16x16x32_bf16 a[16:19], v[160:163], v[32:35], a[16:19]
    s_sub_u32 s3, s29, 147456
    ds_read_b128 v[24:27], v1 offset:6144
    v_lshlrev_b32 v50, 16, v63
    v_mfma_f32_16x16x32_bf16 a[16:19], v[176:179], v[36:39], a[16:19]
    s_add_u32 s56, s56, 12288
    v_cvt_pk_bf16_f32 v76, v16, v17
    v_and_b32 v51, s97, v63
    v_mfma_f32_16x16x32_bf16 a[64:67], v[180:183], v[36:39], a[64:67]
    s_min_u32 s29, s29, s3
    v_exp_f32 v16, v108
    v_mfma_f32_16x16x32_bf16 a[64:67], v[164:167], v[32:35], a[64:67]
    s_mov_b32 m0, s56
    v_add_f32 v8, v8, v18
    v_add_f32 v8, v8, v19
    v_mfma_f32_16x16x32_bf16 a[112:115], v[168:171], v[32:35], a[112:115]
    ds_read_b128 v[28:31], v1 offset:18432
    v_mul_f32_e64 v50, -v50, v48
    v_mfma_f32_16x16x32_bf16 a[112:115], v[184:187], v[36:39], a[112:115]
    v_exp_f32 v17, v109
    v_mfma_f32_16x16x32_bf16 a[160:163], v[188:191], v[36:39], a[160:163]
    v_cvt_pk_bf16_f32 v77, v18, v19
    v_mul_f32_e64 v51, -v51, v49
    v_mfma_f32_16x16x32_bf16 a[160:163], v[172:175], v[32:35], a[160:163]
    s_waitcnt lgkmcnt(2)
    v_exp_f32 v18, v110
    v_mfma_f32_16x16x32_bf16 a[20:23], v[160:163], v[40:43], a[20:23]
    s_sub_u32 s3, s29, s28
    ds_read_b128 v[32:35], v1 offset:7168
    v_add_f32 v8, v8, v16
    v_mfma_f32_16x16x32_bf16 a[20:23], v[176:179], v[44:47], a[20:23]
    v_add_f32 v8, v8, v17
    v_cvt_f32_i32 v248, v248
    v_mfma_f32_16x16x32_bf16 a[68:71], v[180:183], v[44:47], a[68:71]
    v_exp_f32 v19, v111
    v_mfma_f32_16x16x32_bf16 a[68:71], v[164:167], v[40:43], a[68:71]
    buffer_load_dwordx4 v4, s[4:7], s27 offen offset:0 sc1 lds
    v_mfma_f32_16x16x32_bf16 a[116:119], v[168:171], v[40:43], a[116:119]
    ds_read_b128 v[36:39], v1 offset:19456
    v_cvt_pk_bf16_f32 v78, v16, v17
    v_mfma_f32_16x16x32_bf16 a[116:119], v[184:187], v[44:47], a[116:119]
    v_add_f32 v8, v8, v18
    v_cvt_f32_i32 v252, v252
    v_mfma_f32_16x16x32_bf16 a[164:167], v[188:191], v[44:47], a[164:167]
    s_mov_b32 s28, s29
    v_add_f32 v8, v8, v19
    v_cvt_pk_bf16_f32 v79, v18, v19
    v_mfma_f32_16x16x32_bf16 a[164:167], v[172:175], v[40:43], a[164:167]
    s_waitcnt lgkmcnt(2)
    v_exp_f32 v16, v80
    v_mfma_f32_16x16x32_bf16 a[24:27], v[160:163], v[24:27], a[24:27]
    ds_read_b128 v[40:43], v1 offset:8192
    v_fma_f32 v248, v248, v48, v50
    v_mfma_f32_16x16x32_bf16 a[24:27], v[176:179], v[28:31], a[24:27]
    v_exp_f32 v17, v81
    v_mfma_f32_16x16x32_bf16 a[72:75], v[180:183], v[28:31], a[72:75]
    v_fma_f32 v252, v252, v49, v51
    v_cvt_f32_i32 v249, v249
    v_mfma_f32_16x16x32_bf16 a[72:75], v[164:167], v[24:27], a[72:75]
    buffer_load_dwordx4 v4, s[4:7], s27 offen offset:1024 sc1 lds
    v_mfma_f32_16x16x32_bf16 a[120:123], v[168:171], v[24:27], a[120:123]
    ds_read_b128 v[44:47], v1 offset:20480
    v_cvt_f32_i32 v253, v253
    v_mfma_f32_16x16x32_bf16 a[120:123], v[184:187], v[28:31], a[120:123]
    v_exp_f32 v18, v82
    v_mfma_f32_16x16x32_bf16 a[168:171], v[188:191], v[28:31], a[168:171]
    v_add_f32 v5, v5, v16
    v_add_f32 v5, v5, v17
    v_mfma_f32_16x16x32_bf16 a[168:171], v[172:175], v[24:27], a[168:171]
    s_waitcnt lgkmcnt(2)
    v_exp_f32 v19, v83
    v_mfma_f32_16x16x32_bf16 a[28:31], v[160:163], v[32:35], a[28:31]
    ds_read_b128 v[24:27], v1 offset:9216
    v_cvt_pk_bf16_f32 v80, v16, v17
    v_mfma_f32_16x16x32_bf16 a[28:31], v[176:179], v[36:39], a[28:31]
    v_exp_f32 v16, v112
    v_mfma_f32_16x16x32_bf16 a[76:79], v[180:183], v[36:39], a[76:79]
    v_add_f32 v5, v5, v18
    v_fma_f32 v249, v249, v48, v50
    v_mfma_f32_16x16x32_bf16 a[76:79], v[164:167], v[32:35], a[76:79]
    v_add_f32 v5, v5, v19
    v_add_u32 v2, s3, v2
    v_mfma_f32_16x16x32_bf16 a[124:127], v[168:171], v[32:35], a[124:127]
    ds_read_b128 v[28:31], v1 offset:21504
    v_fma_f32 v253, v253, v49, v51
    v_mfma_f32_16x16x32_bf16 a[124:127], v[184:187], v[36:39], a[124:127]
    buffer_load_dwordx4 v4, s[4:7], s27 offen offset:2048 sc1 lds
    v_mfma_f32_16x16x32_bf16 a[172:175], v[188:191], v[36:39], a[172:175]
    v_exp_f32 v17, v113
    v_mfma_f32_16x16x32_bf16 a[172:175], v[172:175], v[32:35], a[172:175]
    s_waitcnt lgkmcnt(2)
    v_cvt_pk_bf16_f32 v81, v18, v19
    v_cvt_f32_i32 v250, v250
    v_mfma_f32_16x16x32_bf16 a[32:35], v[160:163], v[40:43], a[32:35]
    ds_read_b128 v[32:35], v1 offset:10240
    v_add_u32 v3, s3, v3
    v_mfma_f32_16x16x32_bf16 a[32:35], v[176:179], v[44:47], a[32:35]
    v_exp_f32 v18, v114
    v_mfma_f32_16x16x32_bf16 a[80:83], v[180:183], v[44:47], a[80:83]
    v_add_f32 v5, v5, v16
    v_add_f32 v5, v5, v17
    v_mfma_f32_16x16x32_bf16 a[80:83], v[164:167], v[40:43], a[80:83]
    v_exp_f32 v19, v115
    v_mfma_f32_16x16x32_bf16 a[128:131], v[168:171], v[40:43], a[128:131]
    ds_read_b128 v[36:39], v1 offset:22528
    v_cvt_pk_bf16_f32 v82, v16, v17
    v_mfma_f32_16x16x32_bf16 a[128:131], v[184:187], v[44:47], a[128:131]
    v_exp_f32 v16, v84
    v_mfma_f32_16x16x32_bf16 a[176:179], v[188:191], v[44:47], a[176:179]
    v_cvt_f32_i32 v254, v254
    v_add_f32 v5, v5, v18
    v_mfma_f32_16x16x32_bf16 a[176:179], v[172:175], v[40:43], a[176:179]
    s_waitcnt lgkmcnt(2)
    v_add_f32 v5, v5, v19
    v_fma_f32 v250, v250, v48, v50
    v_mfma_f32_16x16x32_bf16 a[36:39], v[160:163], v[24:27], a[36:39]
    ds_read_b128 v[40:43], v1 offset:11264
    v_fma_f32 v254, v254, v49, v51
    v_mfma_f32_16x16x32_bf16 a[36:39], v[176:179], v[28:31], a[36:39]
    v_exp_f32 v17, v85
    v_mfma_f32_16x16x32_bf16 a[84:87], v[180:183], v[28:31], a[84:87]
    v_cvt_pk_bf16_f32 v83, v18, v19
    v_cvt_pk_bf16_f32 v146, v240, v244
    v_mfma_f32_16x16x32_bf16 a[84:87], v[164:167], v[24:27], a[84:87]
    s_add_u32 s27, s27, 24576
    v_exp_f32 v18, v86
    v_mfma_f32_16x16x32_bf16 a[132:135], v[168:171], v[24:27], a[132:135]
    s_add_u32 s56, s56, 36864
    ds_read_b128 v[44:47], v1 offset:23552
    v_add_f32 v6, v6, v16
    v_mfma_f32_16x16x32_bf16 a[132:135], v[184:187], v[28:31], a[132:135]
    s_sub_u32 s58, s56, 147456
    v_add_f32 v6, v6, v17
    v_cvt_pk_bf16_f32 v150, v241, v245
    v_mfma_f32_16x16x32_bf16 a[180:183], v[188:191], v[28:31], a[180:183]
    v_exp_f32 v19, v87
    v_mfma_f32_16x16x32_bf16 a[180:183], v[172:175], v[24:27], a[180:183]
    s_waitcnt lgkmcnt(2)
    v_cvt_pk_bf16_f32 v84, v16, v17
    v_cvt_pk_bf16_f32 v147, v248, v252
    v_mfma_f32_16x16x32_bf16 a[40:43], v[160:163], v[32:35], a[40:43]
    s_min_u32 s56, s56, s58
    ds_read_b128 v[24:27], v2 offset:0
    v_mfma_f32_16x16x32_bf16 a[40:43], v[176:179], v[36:39], a[40:43]
    v_exp_f32 v16, v116
    v_mfma_f32_16x16x32_bf16 a[88:91], v[180:183], v[36:39], a[88:91]
    v_add_f32 v6, v6, v18
    v_add_f32 v6, v6, v19
    v_mfma_f32_16x16x32_bf16 a[88:91], v[164:167], v[32:35], a[88:91]
    v_exp_f32 v17, v117
    v_mfma_f32_16x16x32_bf16 a[136:139], v[168:171], v[32:35], a[136:139]
    ds_read_b128 v[28:31], v3 offset:0
    v_cvt_pk_bf16_f32 v151, v249, v253
    v_mfma_f32_16x16x32_bf16 a[136:139], v[184:187], v[36:39], a[136:139]
    v_cvt_pk_bf16_f32 v85, v18, v19
    v_cvt_pk_bf16_f32 v154, v242, v246
    v_mfma_f32_16x16x32_bf16 a[184:187], v[188:191], v[36:39], a[184:187]
    v_exp_f32 v18, v118
    v_mfma_f32_16x16x32_bf16 a[184:187], v[172:175], v[32:35], a[184:187]
    s_waitcnt lgkmcnt(2)
    v_add_f32 v6, v6, v16
    v_mfma_f32_16x16x32_bf16 a[44:47], v[160:163], v[40:43], a[44:47]
    ds_read_b128 v[32:35], v2 offset:6144
    v_add_f32 v6, v6, v17
    v_mfma_f32_16x16x32_bf16 a[44:47], v[176:179], v[44:47], a[44:47]
    v_exp_f32 v19, v119
    v_mfma_f32_16x16x32_bf16 a[92:95], v[180:183], v[44:47], a[92:95]
    v_cvt_pk_bf16_f32 v155, v250, v254
    v_mfma_f32_16x16x32_bf16 a[92:95], v[164:167], v[40:43], a[92:95]
    v_cvt_pk_bf16_f32 v86, v16, v17
    v_mfma_f32_16x16x32_bf16 a[140:143], v[168:171], v[40:43], a[140:143]
    ds_read_b128 v[36:39], v3 offset:6144
    v_add_f32 v6, v6, v18
    v_mfma_f32_16x16x32_bf16 a[140:143], v[184:187], v[44:47], a[140:143]
    v_add_f32 v6, v6, v19
    v_cvt_pk_bf16_f32 v87, v18, v19
    v_mfma_f32_16x16x32_bf16 a[188:191], v[188:191], v[44:47], a[188:191]
    v_mfma_f32_16x16x32_bf16 a[188:191], v[172:175], v[40:43], a[188:191]
    s_waitcnt lgkmcnt(2)
    v_mfma_f32_16x16x32_bf16 v[160:163], v[24:27], a[192:195], v[128:131]
    ds_read_b128 v[40:43], v2 offset:128
    v_mfma_f32_16x16x32_bf16 v[160:163], v[28:31], a[196:199], v[160:163]
    s_waitcnt vmcnt(4)
    v_subrev_u32 v52, s92, v52
    v_cmp_lt_u32 vcc, 15, v52
    v_mfma_f32_16x16x32_bf16 v[164:167], v[28:31], a[220:223], v[132:135]
    v_exp_f32 v16, v88
    v_mfma_f32_16x16x32_bf16 v[164:167], v[24:27], a[216:219], v[164:167]
    v_exp_f32 v17, v89
    v_mfma_f32_16x16x32_bf16 v[168:171], v[24:27], a[240:243], v[136:139]
    s_and_b32 s59, vcc_lo, 0xff
    ds_read_b128 v[44:47], v3 offset:128
    v_mfma_f32_16x16x32_bf16 v[168:171], v[28:31], a[244:247], v[168:171]
    s_cbranch_scc1 L_pollslow3
L_pollok3:
    v_mfma_f32_16x16x32_bf16 v[172:175], v[28:31], v[204:207], v[140:143]
    s_add_u32 s92, s92, 1
    v_exp_f32 v18, v90
    v_mfma_f32_16x16x32_bf16 v[172:175], v[24:27], v[200:203], v[172:175]
    s_waitcnt lgkmcnt(2)
    v_add_f32 v7, v7, v16
    v_add_f32 v7, v7, v17
    v_mfma_f32_16x16x32_bf16 v[96:99], v[32:35], a[192:195], v[128:131]
    ds_read_b128 v[24:27], v2 offset:6272
    v_mfma_f32_16x16x32_bf16 v[96:99], v[36:39], a[196:199], v[96:99]
    buffer_store_dwordx4 v[144:147], v15, s[4:7], s35 offen offset:0 sc1
    v_mfma_f32_16x16x32_bf16 v[100:103], v[36:39], a[220:223], v[132:135]
    v_exp_f32 v19, v91
    v_mfma_f32_16x16x32_bf16 v[100:103], v[32:35], a[216:219], v[100:103]
    v_cvt_pk_bf16_f32 v88, v16, v17
    v_mfma_f32_16x16x32_bf16 v[104:107], v[32:35], a[240:243], v[136:139]
    ds_read_b128 v[28:31], v3 offset:6272
    v_mfma_f32_16x16x32_bf16 v[104:107], v[36:39], a[244:247], v[104:107]
    v_exp_f32 v16, v120
    v_mfma_f32_16x16x32_bf16 v[108:111], v[36:39], v[204:207], v[140:143]
    v_add_f32 v7, v7, v18
    v_add_f32 v7, v7, v19
    v_mfma_f32_16x16x32_bf16 v[108:111], v[32:35], v[200:203], v[108:111]
    s_waitcnt lgkmcnt(2)
    v_exp_f32 v17, v121
    v_mfma_f32_16x16x32_bf16 v[160:163], v[40:43], a[200:203], v[160:163]
    ds_read_b128 v[32:35], v2 offset:256
    v_cvt_pk_bf16_f32 v89, v18, v19
    v_mfma_f32_16x16x32_bf16 v[160:163], v[44:47], a[204:207], v[160:163]
    buffer_store_dwordx4 v[148:151], v15, s[4:7], s35 offen offset:1024 sc1
    v_mfma_f32_16x16x32_bf16 v[164:167], v[44:47], a[228:231], v[164:167]
    v_exp_f32 v18, v122
    v_mfma_f32_16x16x32_bf16 v[164:167], v[40:43], a[224:227], v[164:167]
    v_add_f32 v7, v7, v16
    v_add_f32 v7, v7, v17
    v_mfma_f32_16x16x32_bf16 v[168:171], v[40:43], a[248:251], v[168:171]
    ds_read_b128 v[36:39], v3 offset:256
    v_mfma_f32_16x16x32_bf16 v[168:171], v[44:47], a[252:255], v[168:171]
    v_exp_f32 v19, v123
    v_mfma_f32_16x16x32_bf16 v[172:175], v[44:47], v[212:215], v[172:175]
    v_cvt_pk_bf16_f32 v90, v16, v17
    v_mfma_f32_16x16x32_bf16 v[172:175], v[40:43], v[208:211], v[172:175]
    s_waitcnt lgkmcnt(2)
    v_exp_f32 v16, v92
    v_mfma_f32_16x16x32_bf16 v[96:99], v[24:27], a[200:203], v[96:99]
    ds_read_b128 v[40:43], v2 offset:6400
    v_add_f32 v7, v7, v18
    v_mfma_f32_16x16x32_bf16 v[96:99], v[28:31], a[204:207], v[96:99]
    buffer_store_dwordx4 v[152:155], v15, s[4:7], s35 offen offset:2048 sc1
    v_mfma_f32_16x16x32_bf16 v[100:103], v[28:31], a[228:231], v[100:103]
    v_add_f32 v7, v7, v19
    v_mfma_f32_16x16x32_bf16 v[100:103], v[24:27], a[224:227], v[100:103]
    v_exp_f32 v17, v93
    v_mfma_f32_16x16x32_bf16 v[104:107], v[24:27], a[248:251], v[104:107]
    ds_read_b128 v[44:47], v3 offset:6400
    v_cvt_pk_bf16_f32 v91, v18, v19
    v_mfma_f32_16x16x32_bf16 v[104:107], v[28:31], a[252:255], v[104:107]
    v_exp_f32 v18, v94
    v_mfma_f32_16x16x32_bf16 v[108:111], v[28:31], v[212:215], v[108:111]
    s_add_u32 s29, s30, 49152
    v_add_f32 v8, v8, v16
    v_add_f32 v8, v8, v17
    v_mfma_f32_16x16x32_bf16 v[108:111], v[24:27], v[208:211], v[108:111]
    s_waitcnt lgkmcnt(2)
    v_exp_f32 v19, v95
    v_mfma_f32_16x16x32_bf16 v[160:163], v[32:35], a[208:211], v[160:163]
    s_sub_u32 s3, s29, 147456
    ds_read_b128 v[24:27], v2 offset:12288
    v_cvt_pk_bf16_f32 v92, v16, v17
    v_mfma_f32_16x16x32_bf16 v[160:163], v[36:39], a[212:215], v[160:163]
    s_min_u32 s29, s29, s3
    v_exp_f32 v16, v124
    v_mfma_f32_16x16x32_bf16 v[164:167], v[36:39], a[236:239], v[164:167]
    v_add_f32 v8, v8, v18
    v_add_f32 v8, v8, v19
    v_mfma_f32_16x16x32_bf16 v[164:167], v[32:35], a[232:235], v[164:167]
    v_exp_f32 v17, v125
    v_mfma_f32_16x16x32_bf16 v[168:171], v[32:35], v[192:195], v[168:171]
    ds_read_b128 v[28:31], v3 offset:12288
    v_mfma_f32_16x16x32_bf16 v[168:171], v[36:39], v[196:199], v[168:171]
    v_cvt_pk_bf16_f32 v93, v18, v19
    v_mfma_f32_16x16x32_bf16 v[172:175], v[36:39], v[220:223], v[172:175]
    v_exp_f32 v18, v126
    v_mfma_f32_16x16x32_bf16 v[172:175], v[32:35], v[216:219], v[172:175]
    s_waitcnt lgkmcnt(2)
    v_add_f32 v8, v8, v16
    v_mfma_f32_16x16x32_bf16 v[96:99], v[40:43], a[208:211], v[96:99]
    ds_read_b128 v[32:35], v2 offset:18432
    v_add_f32 v8, v8, v17
    v_mfma_f32_16x16x32_bf16 v[96:99], v[44:47], a[212:215], v[96:99]
    s_mov_b32 m0, s26
    v_exp_f32 v19, v127
    v_mfma_f32_16x16x32_bf16 v[100:103], v[44:47], a[236:239], v[100:103]
    s_sub_u32 s3, s29, s30
    v_mfma_f32_16x16x32_bf16 v[100:103], v[40:43], a[232:235], v[100:103]
    buffer_load_dwordx4 v4, s[4:7], s32 offen offset:0 sc1 lds
    v_mfma_f32_16x16x32_bf16 v[104:107], v[40:43], v[192:195], v[104:107]
    ds_read_b128 v[36:39], v3 offset:18432
    v_cvt_pk_bf16_f32 v94, v16, v17
    v_mfma_f32_16x16x32_bf16 v[104:107], v[44:47], v[196:199], v[104:107]
    v_add_f32 v8, v8, v18
    v_add_f32 v8, v8, v19
    v_mfma_f32_16x16x32_bf16 v[108:111], v[44:47], v[220:223], v[108:111]
    v_cvt_pk_bf16_f32 v95, v18, v19
    v_mfma_f32_16x16x32_bf16 v[108:111], v[40:43], v[216:219], v[108:111]
    s_waitcnt lgkmcnt(2)
    buffer_load_dwordx4 v4, s[4:7], s32 offen offset:1024 sc1 lds
    v_mfma_f32_16x16x32_bf16 v[176:179], v[24:27], a[192:195], v[128:131]
    ds_read_b128 v[40:43], v2 offset:12416
    v_mfma_f32_16x16x32_bf16 v[176:179], v[28:31], a[196:199], v[176:179]
    s_mov_b32 s30, s29
    v_exp_f32 v16, v160
    v_mfma_f32_16x16x32_bf16 v[180:183], v[28:31], a[220:223], v[132:135]
    v_exp_f32 v17, v161
    v_mfma_f32_16x16x32_bf16 v[180:183], v[24:27], a[216:219], v[180:183]
    buffer_load_dwordx4 v4, s[4:7], s32 offen offset:2048 sc1 lds
    v_mfma_f32_16x16x32_bf16 v[184:187], v[24:27], a[240:243], v[136:139]
    s_add_u32 s32, s32, 24576
    ds_read_b128 v[44:47], v3 offset:12416
    v_mfma_f32_16x16x32_bf16 v[184:187], v[28:31], a[244:247], v[184:187]
    v_exp_f32 v18, v162
    v_mfma_f32_16x16x32_bf16 v[188:191], v[28:31], v[204:207], v[140:143]
    s_add_u32 s26, s26, 12288
    v_add_f32 v5, v5, v16
    v_add_f32 v5, v5, v17
    v_mfma_f32_16x16x32_bf16 v[188:191], v[24:27], v[200:203], v[188:191]
    s_waitcnt lgkmcnt(2)
    v_exp_f32 v19, v163
    v_mfma_f32_16x16x32_bf16 v[112:115], v[32:35], a[192:195], v[128:131]
    s_mov_b32 m0, s26
    ds_read_b128 v[24:27], v2 offset:18560
    v_cvt_pk_bf16_f32 v160, v16, v17
    v_mfma_f32_16x16x32_bf16 v[112:115], v[36:39], a[196:199], v[112:115]
    v_exp_f32 v16, v96
    v_mfma_f32_16x16x32_bf16 v[116:119], v[36:39], a[220:223], v[132:135]
    v_add_f32 v5, v5, v18
    v_add_f32 v5, v5, v19
    v_mfma_f32_16x16x32_bf16 v[116:119], v[32:35], a[216:219], v[116:119]
    v_exp_f32 v17, v97
    v_mfma_f32_16x16x32_bf16 v[120:123], v[32:35], a[240:243], v[136:139]
    ds_read_b128 v[28:31], v3 offset:18560
    v_add_u32 v1, s3, v1
    v_mfma_f32_16x16x32_bf16 v[120:123], v[36:39], a[244:247], v[120:123]
    buffer_load_dwordx4 v4, s[4:7], s32 offen offset:0 sc1 lds
    v_mfma_f32_16x16x32_bf16 v[124:127], v[36:39], v[204:207], v[140:143]
    v_cvt_pk_bf16_f32 v161, v18, v19
    v_mfma_f32_16x16x32_bf16 v[124:127], v[32:35], v[200:203], v[124:127]
    s_waitcnt lgkmcnt(2)
    v_exp_f32 v18, v98
    v_mfma_f32_16x16x32_bf16 v[176:179], v[40:43], a[200:203], v[176:179]
    ds_read_b128 v[32:35], v2 offset:12544
    v_add_f32 v5, v5, v16
    v_mfma_f32_16x16x32_bf16 v[176:179], v[44:47], a[204:207], v[176:179]
    buffer_load_dwordx4 v4, s[4:7], s32 offen offset:1024 sc1 lds
    v_mfma_f32_16x16x32_bf16 v[180:183], v[44:47], a[228:231], v[180:183]
    v_add_f32 v5, v5, v17
    v_mfma_f32_16x16x32_bf16 v[180:183], v[40:43], a[224:227], v[180:183]
    v_exp_f32 v19, v99
    v_mfma_f32_16x16x32_bf16 v[184:187], v[40:43], a[248:251], v[184:187]
    ds_read_b128 v[36:39], v3 offset:12544
    v_cvt_pk_bf16_f32 v162, v16, v17
    v_mfma_f32_16x16x32_bf16 v[184:187], v[44:47], a[252:255], v[184:187]
    buffer_load_dwordx4 v4, s[4:7], s32 offen offset:2048 sc1 lds
    v_mfma_f32_16x16x32_bf16 v[188:191], v[44:47], v[212:215], v[188:191]
    v_exp_f32 v16, v164
    v_mfma_f32_16x16x32_bf16 v[188:191], v[40:43], v[208:211], v[188:191]
    s_waitcnt lgkmcnt(2)
    v_add_f32 v5, v5, v18
    v_add_f32 v5, v5, v19
    v_mfma_f32_16x16x32_bf16 v[112:115], v[24:27], a[200:203], v[112:115]
    ds_read_b128 v[40:43], v2 offset:18688
    v_mfma_f32_16x16x32_bf16 v[112:115], v[28:31], a[204:207], v[112:115]
    v_exp_f32 v17, v165
    v_mfma_f32_16x16x32_bf16 v[116:119], v[28:31], a[228:231], v[116:119]
    v_cvt_pk_bf16_f32 v163, v18, v19
    v_mfma_f32_16x16x32_bf16 v[116:119], v[24:27], a[224:227], v[116:119]
    s_add_u32 s32, s32, 24576
    v_exp_f32 v18, v166
    v_mfma_f32_16x16x32_bf16 v[120:123], v[24:27], a[248:251], v[120:123]
    s_add_u32 s26, s26, 36864
    ds_read_b128 v[44:47], v3 offset:18688
    v_add_f32 v6, v6, v16
    v_mfma_f32_16x16x32_bf16 v[120:123], v[28:31], a[252:255], v[120:123]
    s_waitcnt lgkmcnt(2)
    v_add_f32 v6, v6, v17
    s_sub_u32 s57, s26, 147456
    v_mfma_f32_16x16x32_bf16 v[124:127], v[28:31], v[212:215], v[124:127]
    s_waitcnt vmcnt(6)
    v_exp_f32 v19, v167
    v_mfma_f32_16x16x32_bf16 v[124:127], v[24:27], v[208:211], v[124:127]
    s_barrier
    v_mfma_f32_16x16x32_bf16 v[176:179], v[32:35], a[208:211], v[176:179]
L_pg9:
    s_cbranch_execz L_pg13
    s_min_u32 s26, s26, s57
    ds_read_b128 v[24:27], v1 offset:0
    v_cvt_pk_bf16_f32 v164, v16, v17
    v_mfma_f32_16x16x32_bf16 v[176:179], v[36:39], a[212:215], v[176:179]
    v_exp_f32 v16, v100
    v_mfma_f32_16x16x32_bf16 v[180:183], v[36:39], a[236:239], v[180:183]
    v_add_u32 v0, 1, v0
    v_add_f32 v6, v6, v18
    v_mfma_f32_16x16x32_bf16 v[180:183], v[32:35], a[232:235], v[180:183]
    buffer_store_dword v0, v13, s[20:23], 0 offen offset:32 sc1
    v_mfma_f32_16x16x32_bf16 v[184:187], v[32:35], v[192:195], v[184:187]
    ds_read_b128 v[28:31], v1 offset:12288
    v_add_f32 v6, v6, v19
    v_mfma_f32_16x16x32_bf16 v[184:187], v[36:39], v[196:199], v[184:187]
    v_exp_f32 v17, v101
    v_mfma_f32_16x16x32_bf16 v[188:191], v[36:39], v[220:223], v[188:191]
    v_cvt_pk_bf16_f32 v165, v18, v19
    v_mfma_f32_16x16x32_bf16 v[188:191], v[32:35], v[216:219], v[188:191]
    s_waitcnt lgkmcnt(2)
    v_exp_f32 v18, v102
    v_mfma_f32_16x16x32_bf16 v[112:115], v[40:43], a[208:211], v[112:115]
    ds_read_b128 v[32:35], v1 offset:1024
    v_add_f32 v6, v6, v16
    v_mfma_f32_16x16x32_bf16 v[112:115], v[44:47], a[212:215], v[112:115]
    v_add_f32 v6, v6, v17
    v_mfma_f32_16x16x32_bf16 v[116:119], v[44:47], a[236:239], v[116:119]
    v_exp_f32 v19, v103
    v_mfma_f32_16x16x32_bf16 v[116:119], v[40:43], a[232:235], v[116:119]
    v_cvt_pk_bf16_f32 v166, v16, v17
    v_mfma_f32_16x16x32_bf16 v[120:123], v[40:43], v[192:195], v[120:123]
    ds_read_b128 v[36:39], v1 offset:13312
    v_add_f32 v6, v6, v18
    v_mfma_f32_16x16x32_bf16 v[120:123], v[44:47], v[196:199], v[120:123]
    v_add_f32 v6, v6, v19
    v_cvt_pk_bf16_f32 v167, v18, v19
    v_mfma_f32_16x16x32_bf16 v[124:127], v[44:47], v[220:223], v[124:127]
    v_mfma_f32_16x16x32_bf16 v[124:127], v[40:43], v[216:219], v[124:127]
    s_waitcnt lgkmcnt(2)
    v_mfma_f32_16x16x32_bf16 a[0:3], v[64:67], v[24:27], a[0:3]
    s_mov_b32 m0, s26
    ds_read_b128 v[40:43], v1 offset:2048
    v_mfma_f32_16x16x32_bf16 a[0:3], v[80:83], v[28:31], a[0:3]
    buffer_load_dwordx4 v4, s[4:7], s32 offen offset:0 sc1 lds
    v_mfma_f32_16x16x32_bf16 a[48:51], v[84:87], v[28:31], a[48:51]
    v_exp_f32 v16, v168
    v_mfma_f32_16x16x32_bf16 a[48:51], v[68:71], v[24:27], a[48:51]
    v_exp_f32 v17, v169
    v_mfma_f32_16x16x32_bf16 a[96:99], v[72:75], v[24:27], a[96:99]
    ds_read_b128 v[44:47], v1 offset:14336
    v_mfma_f32_16x16x32_bf16 a[96:99], v[88:91], v[28:31], a[96:99]
    v_exp_f32 v18, v170
    v_mfma_f32_16x16x32_bf16 a[144:147], v[92:95], v[28:31], a[144:147]
    v_add_f32 v7, v7, v16
    v_add_f32 v7, v7, v17
    v_mfma_f32_16x16x32_bf16 a[144:147], v[76:79], v[24:27], a[144:147]
    s_waitcnt lgkmcnt(2)
    v_exp_f32 v19, v171
    v_mfma_f32_16x16x32_bf16 a[4:7], v[64:67], v[32:35], a[4:7]
    ds_read_b128 v[24:27], v1 offset:3072
    v_cvt_pk_bf16_f32 v168, v16, v17
    v_mfma_f32_16x16x32_bf16 a[4:7], v[80:83], v[36:39], a[4:7]
    v_exp_f32 v16, v104
    v_mfma_f32_16x16x32_bf16 a[52:55], v[84:87], v[36:39], a[52:55]
    v_add_f32 v7, v7, v18
    v_add_f32 v7, v7, v19
    v_mfma_f32_16x16x32_bf16 a[52:55], v[68:71], v[32:35], a[52:55]
    buffer_load_dwordx4 v4, s[4:7], s32 offen offset:1024 sc1 lds
    v_mfma_f32_16x16x32_bf16 a[100:103], v[72:75], v[32:35], a[100:103]
    ds_read_b128 v[28:31], v1 offset:15360
    v_mfma_f32_16x16x32_bf16 a[100:103], v[88:91], v[36:39], a[100:103]
    v_exp_f32 v17, v105
    v_mfma_f32_16x16x32_bf16 a[148:151], v[92:95], v[36:39], a[148:151]
    v_cvt_pk_bf16_f32 v169, v18, v19
    v_mfma_f32_16x16x32_bf16 a[148:151], v[76:79], v[32:35], a[148:151]
    s_waitcnt lgkmcnt(2)
    v_exp_f32 v18, v106
    v_mfma_f32_16x16x32_bf16 a[8:11], v[64:67], v[40:43], a[8:11]
    ds_read_b128 v[32:35], v1 offset:4096
    v_add_f32 v7, v7, v16
    v_mfma_f32_16x16x32_bf16 a[8:11], v[80:83], v[44:47], a[8:11]
    v_add_f32 v7, v7, v17
    v_mfma_f32_16x16x32_bf16 a[56:59], v[84:87], v[44:47], a[56:59]
    v_exp_f32 v19, v107
    v_mfma_f32_16x16x32_bf16 a[56:59], v[68:71], v[40:43], a[56:59]
    v_cvt_pk_bf16_f32 v170, v16, v17
    v_mfma_f32_16x16x32_bf16 a[104:107], v[72:75], v[40:43], a[104:107]
    ds_read_b128 v[36:39], v1 offset:16384
    v_mfma_f32_16x16x32_bf16 a[104:107], v[88:91], v[44:47], a[104:107]
    v_exp_f32 v16, v172
    v_mfma_f32_16x16x32_bf16 a[152:155], v[92:95], v[44:47], a[152:155]
    v_add_f32 v7, v7, v18
    v_add_f32 v7, v7, v19
    v_mfma_f32_16x16x32_bf16 a[152:155], v[76:79], v[40:43], a[152:155]
    s_waitcnt lgkmcnt(2)
    buffer_load_dwordx4 v4, s[4:7], s32 offen offset:2048 sc1 lds
    v_mfma_f32_16x16x32_bf16 a[12:15], v[64:67], v[24:27], a[12:15]
    ds_read_b128 v[40:43], v1 offset:5120
    v_mfma_f32_16x16x32_bf16 a[12:15], v[80:83], v[28:31], a[12:15]
    v_exp_f32 v17, v173
    v_mfma_f32_16x16x32_bf16 a[60:63], v[84:87], v[28:31], a[60:63]
    v_cvt_pk_bf16_f32 v171, v18, v19
    v_mfma_f32_16x16x32_bf16 a[60:63], v[68:71], v[24:27], a[60:63]
    v_exp_f32 v18, v174
    v_mfma_f32_16x16x32_bf16 a[108:111], v[72:75], v[24:27], a[108:111]
    ds_read_b128 v[44:47], v1 offset:17408
    v_add_f32 v8, v8, v16
    v_mfma_f32_16x16x32_bf16 a[108:111], v[88:91], v[28:31], a[108:111]
    v_add_f32 v8, v8, v17
    v_mfma_f32_16x16x32_bf16 a[156:159], v[92:95], v[28:31], a[156:159]
    s_add_u32 s29, s28, 49152
    v_exp_f32 v19, v175
    v_mfma_f32_16x16x32_bf16 a[156:159], v[76:79], v[24:27], a[156:159]
    s_waitcnt lgkmcnt(2)
    v_cvt_pk_bf16_f32 v172, v16, v17
    s_sub_u32 s3, s29, 147456
    v_mfma_f32_16x16x32_bf16 a[16:19], v[64:67], v[32:35], a[16:19]
    s_add_u32 s32, s32, 24576
    ds_read_b128 v[24:27], v1 offset:6144
    v_mfma_f32_16x16x32_bf16 a[16:19], v[80:83], v[36:39], a[16:19]
    s_min_u32 s29, s29, s3
    v_exp_f32 v16, v108
    v_mfma_f32_16x16x32_bf16 a[64:67], v[84:87], v[36:39], a[64:67]
    v_add_f32 v8, v8, v18
    v_add_f32 v8, v8, v19
    v_mfma_f32_16x16x32_bf16 a[64:67], v[68:71], v[32:35], a[64:67]
    v_exp_f32 v17, v109
    v_mfma_f32_16x16x32_bf16 a[112:115], v[72:75], v[32:35], a[112:115]
    s_add_u32 s26, s26, 12288
    ds_read_b128 v[28:31], v1 offset:18432
    v_mfma_f32_16x16x32_bf16 a[112:115], v[88:91], v[36:39], a[112:115]
    v_cvt_pk_bf16_f32 v173, v18, v19
    v_mfma_f32_16x16x32_bf16 a[160:163], v[92:95], v[36:39], a[160:163]
    v_exp_f32 v18, v110
    v_mfma_f32_16x16x32_bf16 a[160:163], v[76:79], v[32:35], a[160:163]
    s_waitcnt lgkmcnt(2)
    v_add_f32 v8, v8, v16
    v_mfma_f32_16x16x32_bf16 a[20:23], v[64:67], v[40:43], a[20:23]
    s_sub_u32 s3, s29, s28
    ds_read_b128 v[32:35], v1 offset:7168
    v_add_f32 v8, v8, v17
    v_mfma_f32_16x16x32_bf16 a[20:23], v[80:83], v[44:47], a[20:23]
    v_exp_f32 v19, v111
    v_mfma_f32_16x16x32_bf16 a[68:71], v[84:87], v[44:47], a[68:71]
    s_mov_b32 m0, s26
    v_mfma_f32_16x16x32_bf16 a[68:71], v[68:71], v[40:43], a[68:71]
    v_cvt_pk_bf16_f32 v174, v16, v17
    v_mfma_f32_16x16x32_bf16 a[116:119], v[72:75], v[40:43], a[116:119]
    ds_read_b128 v[36:39], v1 offset:19456
    v_add_f32 v8, v8, v18
    v_mfma_f32_16x16x32_bf16 a[116:119], v[88:91], v[44:47], a[116:119]
    v_add_f32 v8, v8, v19
    v_cvt_pk_bf16_f32 v175, v18, v19
    v_mfma_f32_16x16x32_bf16 a[164:167], v[92:95], v[44:47], a[164:167]
    s_mov_b32 s28, s29
    v_mfma_f32_16x16x32_bf16 a[164:167], v[76:79], v[40:43], a[164:167]
    s_waitcnt lgkmcnt(2)
    v_exp_f32 v16, v176
    v_mfma_f32_16x16x32_bf16 a[24:27], v[64:67], v[24:27], a[24:27]
    ds_read_b128 v[40:43], v1 offset:8192
    v_mfma_f32_16x16x32_bf16 a[24:27], v[80:83], v[28:31], a[24:27]
    v_exp_f32 v17, v177
    v_mfma_f32_16x16x32_bf16 a[72:75], v[84:87], v[28:31], a[72:75]
    v_exp_f32 v18, v178
    v_mfma_f32_16x16x32_bf16 a[72:75], v[68:71], v[24:27], a[72:75]
    buffer_load_dwordx4 v4, s[4:7], s32 offen offset:0 sc1 lds
    v_mfma_f32_16x16x32_bf16 a[120:123], v[72:75], v[24:27], a[120:123]
    ds_read_b128 v[44:47], v1 offset:20480
    v_add_f32 v5, v5, v16
    v_mfma_f32_16x16x32_bf16 a[120:123], v[88:91], v[28:31], a[120:123]
    v_add_f32 v5, v5, v17
    v_add_u32 v2, s3, v2
    v_mfma_f32_16x16x32_bf16 a[168:171], v[92:95], v[28:31], a[168:171]
    v_exp_f32 v19, v179
    v_mfma_f32_16x16x32_bf16 a[168:171], v[76:79], v[24:27], a[168:171]
    s_waitcnt lgkmcnt(2)
    v_cvt_pk_bf16_f32 v176, v16, v17
    v_mfma_f32_16x16x32_bf16 a[28:31], v[64:67], v[32:35], a[28:31]
    ds_read_b128 v[24:27], v1 offset:9216
    v_mfma_f32_16x16x32_bf16 a[28:31], v[80:83], v[36:39], a[28:31]
    v_exp_f32 v16, v112
    v_mfma_f32_16x16x32_bf16 a[76:79], v[84:87], v[36:39], a[76:79]
    v_add_f32 v5, v5, v18
    v_add_f32 v5, v5, v19
    v_mfma_f32_16x16x32_bf16 a[76:79], v[68:71], v[32:35], a[76:79]
    v_exp_f32 v17, v113
    v_mfma_f32_16x16x32_bf16 a[124:127], v[72:75], v[32:35], a[124:127]
    ds_read_b128 v[28:31], v1 offset:21504
    v_add_u32 v3, s3, v3
    v_mfma_f32_16x16x32_bf16 a[124:127], v[88:91], v[36:39], a[124:127]
    v_cvt_pk_bf16_f32 v177, v18, v19
    v_mfma_f32_16x16x32_bf16 a[172:175], v[92:95], v[36:39], a[172:175]
    v_exp_f32 v18, v114
    v_mfma_f32_16x16x32_bf16 a[172:175], v[76:79], v[32:35], a[172:175]
    s_waitcnt lgkmcnt(2)
    buffer_load_dwordx4 v4, s[4:7], s32 offen offset:1024 sc1 lds
    v_mfma_f32_16x16x32_bf16 a[32:35], v[64:67], v[40:43], a[32:35]
    ds_read_b128 v[32:35], v1 offset:10240
    v_add_f32 v5, v5, v16
    v_mfma_f32_16x16x32_bf16 a[32:35], v[80:83], v[44:47], a[32:35]
    v_add_f32 v5, v5, v17
    v_mfma_f32_16x16x32_bf16 a[80:83], v[84:87], v[44:47], a[80:83]
    v_exp_f32 v19, v115
    v_mfma_f32_16x16x32_bf16 a[80:83], v[68:71], v[40:43], a[80:83]
    v_cvt_pk_bf16_f32 v178, v16, v17
    v_mfma_f32_16x16x32_bf16 a[128:131], v[72:75], v[40:43], a[128:131]
    ds_read_b128 v[36:39], v1 offset:22528
    v_mfma_f32_16x16x32_bf16 a[128:131], v[88:91], v[44:47], a[128:131]
    v_exp_f32 v16, v180
    v_mfma_f32_16x16x32_bf16 a[176:179], v[92:95], v[44:47], a[176:179]
    v_add_f32 v5, v5, v18
    v_add_f32 v5, v5, v19
    v_mfma_f32_16x16x32_bf16 a[176:179], v[76:79], v[40:43], a[176:179]
    s_waitcnt lgkmcnt(2)
    v_exp_f32 v17, v181
    v_mfma_f32_16x16x32_bf16 a[36:39], v[64:67], v[24:27], a[36:39]
    ds_read_b128 v[40:43], v1 offset:11264
    v_mfma_f32_16x16x32_bf16 a[36:39], v[80:83], v[28:31], a[36:39]
    buffer_load_dwordx4 v4, s[4:7], s32 offen offset:2048 sc1 lds
    v_mfma_f32_16x16x32_bf16 a[84:87], v[84:87], v[28:31], a[84:87]
    v_cvt_pk_bf16_f32 v179, v18, v19
    v_mfma_f32_16x16x32_bf16 a[84:87], v[68:71], v[24:27], a[84:87]
    v_exp_f32 v18, v182
    v_mfma_f32_16x16x32_bf16 a[132:135], v[72:75], v[24:27], a[132:135]
    ds_read_b128 v[44:47], v1 offset:23552
    v_add_f32 v6, v6, v16
    v_mfma_f32_16x16x32_bf16 a[132:135], v[88:91], v[28:31], a[132:135]
    s_waitcnt lgkmcnt(2)
    v_add_f32 v6, v6, v17
    v_mfma_f32_16x16x32_bf16 a[180:183], v[92:95], v[28:31], a[180:183]
    s_waitcnt vmcnt(7)
    v_exp_f32 v19, v183
    v_mfma_f32_16x16x32_bf16 a[180:183], v[76:79], v[24:27], a[180:183]
    s_barrier
    v_mfma_f32_16x16x32_bf16 a[40:43], v[64:67], v[32:35], a[40:43]
    ds_read_b128 v[24:27], v2 offset:0
    v_cvt_pk_bf16_f32 v180, v16, v17
    v_mfma_f32_16x16x32_bf16 a[40:43], v[80:83], v[36:39], a[40:43]
    v_exp_f32 v16, v116
    v_mfma_f32_16x16x32_bf16 a[88:91], v[84:87], v[36:39], a[88:91]
    v_add_f32 v6, v6, v18
    v_add_f32 v6, v6, v19
    v_mfma_f32_16x16x32_bf16 a[88:91], v[68:71], v[32:35], a[88:91]
    v_exp_f32 v17, v117
    v_mfma_f32_16x16x32_bf16 a[136:139], v[72:75], v[32:35], a[136:139]
    ds_read_b128 v[28:31], v3 offset:0
    v_mfma_f32_16x16x32_bf16 a[136:139], v[88:91], v[36:39], a[136:139]
    v_cvt_pk_bf16_f32 v181, v18, v19
    v_mfma_f32_16x16x32_bf16 a[184:187], v[92:95], v[36:39], a[184:187]
    v_exp_f32 v18, v118
    v_mfma_f32_16x16x32_bf16 a[184:187], v[76:79], v[32:35], a[184:187]
    s_waitcnt lgkmcnt(2)
    v_add_f32 v6, v6, v16
    v_mfma_f32_16x16x32_bf16 a[44:47], v[64:67], v[40:43], a[44:47]
    ds_read_b128 v[32:35], v2 offset:6144
    v_add_f32 v6, v6, v17
    v_mfma_f32_16x16x32_bf16 a[44:47], v[80:83], v[44:47], a[44:47]
    v_exp_f32 v19, v119
    v_mfma_f32_16x16x32_bf16 a[92:95], v[84:87], v[44:47], a[92:95]
    v_mfma_f32_16x16x32_bf16 a[92:95], v[68:71], v[40:43], a[92:95]
    s_add_u32 s32, s32, 24576
    s_add_u32 s26, s26, 36864
    v_cvt_pk_bf16_f32 v182, v16, v17
    v_mfma_f32_16x16x32_bf16 a[140:143], v[72:75], v[40:43], a[140:143]
    s_sub_u32 s57, s26, 147456
    ds_read_b128 v[36:39], v3 offset:6144
    v_add_f32 v6, v6, v18
    v_mfma_f32_16x16x32_bf16 a[140:143], v[88:91], v[44:47], a[140:143]
    s_min_u32 s26, s26, s57
    v_add_f32 v6, v6, v19
    v_cvt_pk_bf16_f32 v183, v18, v19
    v_mfma_f32_16x16x32_bf16 a[188:191], v[92:95], v[44:47], a[188:191]
    v_mfma_f32_16x16x32_bf16 a[188:191], v[76:79], v[40:43], a[188:191]
    s_waitcnt lgkmcnt(2)
    v_mfma_f32_16x16x32_bf16 v[64:67], v[24:27], a[192:195], v[128:131]
    ds_read_b128 v[40:43], v2 offset:128
    v_mfma_f32_16x16x32_bf16 v[64:67], v[28:31], a[196:199], v[64:67]
    v_exp_f32 v16, v184
    v_mfma_f32_16x16x32_bf16 v[68:71], v[28:31], a[220:223], v[132:135]
    v_exp_f32 v17, v185
    v_mfma_f32_16x16x32_bf16 v[68:71], v[24:27], a[216:219], v[68:71]
    buffer_load_dword v52, v20, s[20:23], s44 offen sc1
    v_mfma_f32_16x16x32_bf16 v[72:75], v[24:27], a[240:243], v[136:139]
    ds_read_b128 v[44:47], v3 offset:128
    v_mfma_f32_16x16x32_bf16 v[72:75], v[28:31], a[244:247], v[72:75]
    v_exp_f32 v18, v186
    v_mfma_f32_16x16x32_bf16 v[76:79], v[28:31], v[204:207], v[140:143]
    v_add_f32 v7, v7, v16
    v_add_f32 v7, v7, v17
    v_mfma_f32_16x16x32_bf16 v[76:79], v[24:27], v[200:203], v[76:79]
    s_waitcnt lgkmcnt(2)
    v_exp_f32 v19, v187
    v_mfma_f32_16x16x32_bf16 v[96:99], v[32:35], a[192:195], v[128:131]
    ds_read_b128 v[24:27], v2 offset:6272
    v_cvt_pk_bf16_f32 v184, v16, v17
    v_mfma_f32_16x16x32_bf16 v[96:99], v[36:39], a[196:199], v[96:99]
    v_exp_f32 v16, v120
    v_mfma_f32_16x16x32_bf16 v[100:103], v[36:39], a[220:223], v[132:135]
    v_add_f32 v7, v7, v18
    v_add_f32 v7, v7, v19
    v_mfma_f32_16x16x32_bf16 v[100:103], v[32:35], a[216:219], v[100:103]
    s_mov_b32 m0, s26
    v_exp_f32 v17, v121
    v_mfma_f32_16x16x32_bf16 v[104:107], v[32:35], a[240:243], v[136:139]
    ds_read_b128 v[28:31], v3 offset:6272
    v_mfma_f32_16x16x32_bf16 v[104:107], v[36:39], a[244:247], v[104:107]
    buffer_load_dwordx4 v4, s[4:7], s32 offen offset:0 sc1 lds
    v_mfma_f32_16x16x32_bf16 v[108:111], v[36:39], v[204:207], v[140:143]
    v_cvt_pk_bf16_f32 v185, v18, v19
    v_mfma_f32_16x16x32_bf16 v[108:111], v[32:35], v[200:203], v[108:111]
    s_waitcnt lgkmcnt(2)
    v_exp_f32 v18, v122
    v_mfma_f32_16x16x32_bf16 v[64:67], v[40:43], a[200:203], v[64:67]
    ds_read_b128 v[32:35], v2 offset:256
    v_add_f32 v7, v7, v16
    v_mfma_f32_16x16x32_bf16 v[64:67], v[44:47], a[204:207], v[64:67]
    v_add_f32 v7, v7, v17
    v_mfma_f32_16x16x32_bf16 v[68:71], v[44:47], a[228:231], v[68:71]
    v_exp_f32 v19, v123
    v_mfma_f32_16x16x32_bf16 v[68:71], v[40:43], a[224:227], v[68:71]
    v_cvt_pk_bf16_f32 v186, v16, v17
    v_mfma_f32_16x16x32_bf16 v[72:75], v[40:43], a[248:251], v[72:75]
    ds_read_b128 v[36:39], v3 offset:256
    v_mfma_f32_16x16x32_bf16 v[72:75], v[44:47], a[252:255], v[72:75]
    buffer_load_dwordx4 v4, s[4:7], s32 offen offset:1024 sc1 lds
    v_mfma_f32_16x16x32_bf16 v[76:79], v[44:47], v[212:215], v[76:79]
    v_exp_f32 v16, v188
    v_mfma_f32_16x16x32_bf16 v[76:79], v[40:43], v[208:211], v[76:79]
    s_waitcnt lgkmcnt(2)
    v_add_f32 v7, v7, v18
    v_add_f32 v7, v7, v19
    v_mfma_f32_16x16x32_bf16 v[96:99], v[24:27], a[200:203], v[96:99]
    ds_read_b128 v[40:43], v2 offset:6400
    v_mfma_f32_16x16x32_bf16 v[96:99], v[28:31], a[204:207], v[96:99]
    v_exp_f32 v17, v189
    v_mfma_f32_16x16x32_bf16 v[100:103], v[28:31], a[228:231], v[100:103]
    v_cvt_pk_bf16_f32 v187, v18, v19
    v_mfma_f32_16x16x32_bf16 v[100:103], v[24:27], a[224:227], v[100:103]
    v_exp_f32 v18, v190
    v_mfma_f32_16x16x32_bf16 v[104:107], v[24:27], a[248:251], v[104:107]
    ds_read_b128 v[44:47], v3 offset:6400
    v_add_f32 v8, v8, v16
    v_mfma_f32_16x16x32_bf16 v[104:107], v[28:31], a[252:255], v[104:107]
    v_add_f32 v8, v8, v17
    v_mfma_f32_16x16x32_bf16 v[108:111], v[28:31], v[212:215], v[108:111]
    s_add_u32 s29, s30, 49152
    v_exp_f32 v19, v191
    v_mfma_f32_16x16x32_bf16 v[108:111], v[24:27], v[208:211], v[108:111]
    s_waitcnt lgkmcnt(2)
    buffer_load_dwordx4 v4, s[4:7], s32 offen offset:2048 sc1 lds
    v_mfma_f32_16x16x32_bf16 v[64:67], v[32:35], a[208:211], v[64:67]
    s_sub_u32 s3, s29, 147456
    ds_read_b128 v[24:27], v2 offset:12288
    v_cvt_pk_bf16_f32 v188, v16, v17
    v_mfma_f32_16x16x32_bf16 v[64:67], v[36:39], a[212:215], v[64:67]
    s_min_u32 s29, s29, s3
    v_exp_f32 v16, v124
    v_mfma_f32_16x16x32_bf16 v[68:71], v[36:39], a[236:239], v[68:71]
    v_add_f32 v8, v8, v18
    v_add_f32 v8, v8, v19
    v_mfma_f32_16x16x32_bf16 v[68:71], v[32:35], a[232:235], v[68:71]
    v_exp_f32 v17, v125
    v_mfma_f32_16x16x32_bf16 v[72:75], v[32:35], v[192:195], v[72:75]
    ds_read_b128 v[28:31], v3 offset:12288
    v_mfma_f32_16x16x32_bf16 v[72:75], v[36:39], v[196:199], v[72:75]
    v_cvt_pk_bf16_f32 v189, v18, v19
    v_mfma_f32_16x16x32_bf16 v[76:79], v[36:39], v[220:223], v[76:79]
    v_exp_f32 v18, v126
    v_mfma_f32_16x16x32_bf16 v[76:79], v[32:35], v[216:219], v[76:79]
    s_waitcnt lgkmcnt(2)
    v_add_f32 v8, v8, v16
    s_add_u32 s32, s32, 24576
    v_mfma_f32_16x16x32_bf16 v[96:99], v[40:43], a[208:211], v[96:99]
    ds_read_b128 v[32:35], v2 offset:18432
    v_add_f32 v8, v8, v17
    v_mfma_f32_16x16x32_bf16 v[96:99], v[44:47], a[212:215], v[96:99]
    s_sub_u32 s3, s29, s30
    v_exp_f32 v19, v127
    v_mfma_f32_16x16x32_bf16 v[100:103], v[44:47], a[236:239], v[100:103]
    v_mfma_f32_16x16x32_bf16 v[100:103], v[40:43], a[232:235], v[100:103]
    v_cvt_pk_bf16_f32 v190, v16, v17
    v_mfma_f32_16x16x32_bf16 v[104:107], v[40:43], v[192:195], v[104:107]
    s_add_u32 s26, s26, 12288
    ds_read_b128 v[36:39], v3 offset:18432
    v_add_f32 v8, v8, v18
    v_mfma_f32_16x16x32_bf16 v[104:107], v[44:47], v[196:199], v[104:107]
    v_add_f32 v8, v8, v19
    v_cvt_pk_bf16_f32 v191, v18, v19
    v_mfma_f32_16x16x32_bf16 v[108:111], v[44:47], v[220:223], v[108:111]
    v_mfma_f32_16x16x32_bf16 v[108:111], v[40:43], v[216:219], v[108:111]
    s_waitcnt lgkmcnt(2)
    v_exp_f32 v16, v64
    v_mfma_f32_16x16x32_bf16 v[80:83], v[24:27], a[192:195], v[128:131]
    ds_read_b128 v[40:43], v2 offset:12416
    v_mfma_f32_16x16x32_bf16 v[80:83], v[28:31], a[196:199], v[80:83]
    s_mov_b32 m0, s26
    v_exp_f32 v17, v65
    v_mfma_f32_16x16x32_bf16 v[84:87], v[28:31], a[220:223], v[132:135]
    s_mov_b32 s30, s29
    v_exp_f32 v18, v66
    v_mfma_f32_16x16x32_bf16 v[84:87], v[24:27], a[216:219], v[84:87]
    v_add_f32 v5, v5, v16
    v_mfma_f32_16x16x32_bf16 v[88:91], v[24:27], a[240:243], v[136:139]
    ds_read_b128 v[44:47], v3 offset:12416
    v_add_f32 v5, v5, v17
    v_mfma_f32_16x16x32_bf16 v[88:91], v[28:31], a[244:247], v[88:91]
    v_exp_f32 v19, v67
    v_mfma_f32_16x16x32_bf16 v[92:95], v[28:31], v[204:207], v[140:143]
    v_mfma_f32_16x16x32_bf16 v[92:95], v[24:27], v[200:203], v[92:95]
    s_waitcnt lgkmcnt(2)
    v_cvt_pk_bf16_f32 v64, v16, v17
    v_mfma_f32_16x16x32_bf16 v[112:115], v[32:35], a[192:195], v[128:131]
    ds_read_b128 v[24:27], v2 offset:18560
    v_mfma_f32_16x16x32_bf16 v[112:115], v[36:39], a[196:199], v[112:115]
    buffer_load_dwordx4 v4, s[4:7], s32 offen offset:0 sc1 lds
    v_mfma_f32_16x16x32_bf16 v[116:119], v[36:39], a[220:223], v[132:135]
    v_exp_f32 v16, v96
    v_mfma_f32_16x16x32_bf16 v[116:119], v[32:35], a[216:219], v[116:119]
    v_add_f32 v5, v5, v18
    v_add_f32 v5, v5, v19
    v_mfma_f32_16x16x32_bf16 v[120:123], v[32:35], a[240:243], v[136:139]
    ds_read_b128 v[28:31], v3 offset:18560
    v_add_u32 v1, s3, v1
    v_mfma_f32_16x16x32_bf16 v[120:123], v[36:39], a[244:247], v[120:123]
    v_exp_f32 v17, v97
    v_mfma_f32_16x16x32_bf16 v[124:127], v[36:39], v[204:207], v[140:143]
    v_cvt_pk_bf16_f32 v65, v18, v19
    v_mfma_f32_16x16x32_bf16 v[124:127], v[32:35], v[200:203], v[124:127]
    s_waitcnt lgkmcnt(2)
    v_exp_f32 v18, v98
    v_mfma_f32_16x16x32_bf16 v[80:83], v[40:43], a[200:203], v[80:83]
    ds_read_b128 v[32:35], v2 offset:12544
    v_add_f32 v5, v5, v16
    v_mfma_f32_16x16x32_bf16 v[80:83], v[44:47], a[204:207], v[80:83]
    v_add_f32 v5, v5, v17
    v_mfma_f32_16x16x32_bf16 v[84:87], v[44:47], a[228:231], v[84:87]
    v_exp_f32 v19, v99
    v_mfma_f32_16x16x32_bf16 v[84:87], v[40:43], a[224:227], v[84:87]
    buffer_load_dwordx4 v4, s[4:7], s32 offen offset:1024 sc1 lds
    v_mfma_f32_16x16x32_bf16 v[88:91], v[40:43], a[248:251], v[88:91]
    ds_read_b128 v[36:39], v3 offset:12544
    v_cvt_pk_bf16_f32 v66, v16, v17
    v_mfma_f32_16x16x32_bf16 v[88:91], v[44:47], a[252:255], v[88:91]
    v_exp_f32 v16, v68
    v_mfma_f32_16x16x32_bf16 v[92:95], v[44:47], v[212:215], v[92:95]
    v_add_f32 v5, v5, v18
    v_add_f32 v5, v5, v19
    v_mfma_f32_16x16x32_bf16 v[92:95], v[40:43], v[208:211], v[92:95]
    s_waitcnt lgkmcnt(2)
    v_exp_f32 v17, v69
    v_mfma_f32_16x16x32_bf16 v[112:115], v[24:27], a[200:203], v[112:115]
    ds_read_b128 v[40:43], v2 offset:18688
    v_mfma_f32_16x16x32_bf16 v[112:115], v[28:31], a[204:207], v[112:115]
    v_cvt_pk_bf16_f32 v67, v18, v19
    v_mfma_f32_16x16x32_bf16 v[116:119], v[28:31], a[228:231], v[116:119]
    v_exp_f32 v18, v70
    v_mfma_f32_16x16x32_bf16 v[116:119], v[24:27], a[224:227], v[116:119]
    v_add_f32 v6, v6, v16
    v_mfma_f32_16x16x32_bf16 v[120:123], v[24:27], a[248:251], v[120:123]
    ds_read_b128 v[44:47], v3 offset:18688
    v_add_f32 v6, v6, v17
    v_mfma_f32_16x16x32_bf16 v[120:123], v[28:31], a[252:255], v[120:123]
    s_waitcnt lgkmcnt(2)
    buffer_load_dwordx4 v4, s[4:7], s32 offen offset:2048 sc1 lds
    v_mfma_f32_16x16x32_bf16 v[124:127], v[28:31], v[212:215], v[124:127]
    s_waitcnt vmcnt(7)
    v_exp_f32 v19, v71
    v_mfma_f32_16x16x32_bf16 v[124:127], v[24:27], v[208:211], v[124:127]
    s_barrier
    v_mfma_f32_16x16x32_bf16 v[80:83], v[32:35], a[208:211], v[80:83]
    ds_read_b128 v[24:27], v1 offset:0
    v_cvt_pk_bf16_f32 v68, v16, v17
    v_mfma_f32_16x16x32_bf16 v[80:83], v[36:39], a[212:215], v[80:83]
    v_exp_f32 v16, v100
    v_mfma_f32_16x16x32_bf16 v[84:87], v[36:39], a[236:239], v[84:87]
    v_add_f32 v6, v6, v18
    v_add_f32 v6, v6, v19
    v_mfma_f32_16x16x32_bf16 v[84:87], v[32:35], a[232:235], v[84:87]
    v_exp_f32 v17, v101
    v_mfma_f32_16x16x32_bf16 v[88:91], v[32:35], v[192:195], v[88:91]
    ds_read_b128 v[28:31], v1 offset:12288
    v_mfma_f32_16x16x32_bf16 v[88:91], v[36:39], v[196:199], v[88:91]
    v_cvt_pk_bf16_f32 v69, v18, v19
    v_mfma_f32_16x16x32_bf16 v[92:95], v[36:39], v[220:223], v[92:95]
    v_exp_f32 v18, v102
    v_mfma_f32_16x16x32_bf16 v[92:95], v[32:35], v[216:219], v[92:95]
    s_waitcnt lgkmcnt(2)
    v_add_f32 v6, v6, v16
    v_mfma_f32_16x16x32_bf16 v[112:115], v[40:43], a[208:211], v[112:115]
    ds_read_b128 v[32:35], v1 offset:1024
    v_add_f32 v6, v6, v17
    v_mfma_f32_16x16x32_bf16 v[112:115], v[44:47], a[212:215], v[112:115]
    v_exp_f32 v19, v103
    v_mfma_f32_16x16x32_bf16 v[116:119], v[44:47], a[236:239], v[116:119]
    v_mfma_f32_16x16x32_bf16 v[116:119], v[40:43], a[232:235], v[116:119]
    v_cvt_pk_bf16_f32 v70, v16, v17
    v_mfma_f32_16x16x32_bf16 v[120:123], v[40:43], v[192:195], v[120:123]
    ds_read_b128 v[36:39], v1 offset:13312
    v_add_f32 v6, v6, v18
    v_mfma_f32_16x16x32_bf16 v[120:123], v[44:47], v[196:199], v[120:123]
    s_add_u32 s32, s32, 24576
    s_add_u32 s26, s26, 36864
    v_add_f32 v6, v6, v19
    v_mfma_f32_16x16x32_bf16 v[124:127], v[44:47], v[220:223], v[124:127]
    s_sub_u32 s57, s26, 147456
    v_cvt_pk_bf16_f32 v71, v18, v19
    s_min_u32 s26, s26, s57
    v_mfma_f32_16x16x32_bf16 v[124:127], v[40:43], v[216:219], v[124:127]
    s_waitcnt lgkmcnt(2)
    v_mfma_f32_16x16x32_bf16 a[0:3], v[160:163], v[24:27], a[0:3]
    ds_read_b128 v[40:43], v1 offset:2048
    v_mfma_f32_16x16x32_bf16 a[0:3], v[176:179], v[28:31], a[0:3]
    s_waitcnt vmcnt(6)
    v_subrev_u32 v52, s92, v52
    v_cmp_lt_u32 vcc, 15, v52
    v_mfma_f32_16x16x32_bf16 a[48:51], v[180:183], v[28:31], a[48:51]
    v_exp_f32 v16, v72
    v_mfma_f32_16x16x32_bf16 a[48:51], v[164:167], v[24:27], a[48:51]
    v_exp_f32 v17, v73
    v_mfma_f32_16x16x32_bf16 a[96:99], v[168:171], v[24:27], a[96:99]
    s_and_b32 s59, vcc_lo, 0xff
    ds_read_b128 v[44:47], v1 offset:14336
    v_mfma_f32_16x16x32_bf16 a[96:99], v[184:187], v[28:31], a[96:99]
    s_cbranch_scc1 L_pollslow4
L_pollok4:
    v_mfma_f32_16x16x32_bf16 a[144:147], v[188:191], v[28:31], a[144:147]
    s_add_u32 s92, s92, 1
    v_exp_f32 v18, v74
    v_mfma_f32_16x16x32_bf16 a[144:147], v[172:175], v[24:27], a[144:147]
    s_waitcnt lgkmcnt(2)
    v_add_f32 v7, v7, v16
    v_add_f32 v7, v7, v17
    v_mfma_f32_16x16x32_bf16 a[4:7], v[160:163], v[32:35], a[4:7]
    ds_read_b128 v[24:27], v1 offset:3072
    v_mfma_f32_16x16x32_bf16 a[4:7], v[176:179], v[36:39], a[4:7]
    v_exp_f32 v19, v75
    v_mfma_f32_16x16x32_bf16 a[52:55], v[180:183], v[36:39], a[52:55]
    v_cvt_pk_bf16_f32 v72, v16, v17
    v_mfma_f32_16x16x32_bf16 a[52:55], v[164:167], v[32:35], a[52:55]
    v_exp_f32 v16, v104
    v_mfma_f32_16x16x32_bf16 a[100:103], v[168:171], v[32:35], a[100:103]
    ds_read_b128 v[28:31], v1 offset:15360
    v_add_f32 v7, v7, v18
    v_mfma_f32_16x16x32_bf16 a[100:103], v[184:187], v[36:39], a[100:103]
    s_waitcnt lgkmcnt(2)
    v_add_f32 v7, v7, v19
    v_mfma_f32_16x16x32_bf16 a[148:151], v[188:191], v[36:39], a[148:151]
    s_waitcnt vmcnt(0)
    v_exp_f32 v17, v105
    v_mfma_f32_16x16x32_bf16 a[148:151], v[172:175], v[32:35], a[148:151]
    s_barrier
    v_mfma_f32_16x16x32_bf16 a[8:11], v[160:163], v[40:43], a[8:11]
    s_mov_b32 m0, s56
    ds_read_b128 v[32:35], v1 offset:4096
    v_cvt_pk_bf16_f32 v73, v18, v19
    v_mfma_f32_16x16x32_bf16 a[8:11], v[176:179], v[44:47], a[8:11]
    buffer_load_dwordx4 v4, s[4:7], s27 offen offset:0 sc1 lds
    v_mfma_f32_16x16x32_bf16 a[56:59], v[180:183], v[44:47], a[56:59]
    v_exp_f32 v18, v106
    v_mfma_f32_16x16x32_bf16 a[56:59], v[164:167], v[40:43], a[56:59]
    v_add_f32 v7, v7, v16
    v_add_f32 v7, v7, v17
    v_mfma_f32_16x16x32_bf16 a[104:107], v[168:171], v[40:43], a[104:107]
    ds_read_b128 v[36:39], v1 offset:16384
    v_mfma_f32_16x16x32_bf16 a[104:107], v[184:187], v[44:47], a[104:107]
    buffer_load_dwordx4 v4, s[4:7], s27 offen offset:1024 sc1 lds
    v_mfma_f32_16x16x32_bf16 a[152:155], v[188:191], v[44:47], a[152:155]
    v_exp_f32 v19, v107
    v_mfma_f32_16x16x32_bf16 a[152:155], v[172:175], v[40:43], a[152:155]
    s_waitcnt lgkmcnt(2)
    v_cvt_pk_bf16_f32 v74, v16, v17
    v_mfma_f32_16x16x32_bf16 a[12:15], v[160:163], v[24:27], a[12:15]
    ds_read_b128 v[40:43], v1 offset:5120
    v_mfma_f32_16x16x32_bf16 a[12:15], v[176:179], v[28:31], a[12:15]
    buffer_load_dwordx4 v4, s[4:7], s27 offen offset:2048 sc1 lds
    v_mfma_f32_16x16x32_bf16 a[60:63], v[180:183], v[28:31], a[60:63]
    v_exp_f32 v16, v76
    v_mfma_f32_16x16x32_bf16 a[60:63], v[164:167], v[24:27], a[60:63]
    s_add_u32 s27, s27, 24576
    v_add_f32 v7, v7, v18
    v_add_f32 v7, v7, v19
    v_mfma_f32_16x16x32_bf16 a[108:111], v[168:171], v[24:27], a[108:111]
    ds_read_b128 v[44:47], v1 offset:17408
    v_mfma_f32_16x16x32_bf16 a[108:111], v[184:187], v[28:31], a[108:111]
    s_add_u32 s56, s56, 12288
    v_exp_f32 v17, v77
    v_mfma_f32_16x16x32_bf16 a[156:159], v[188:191], v[28:31], a[156:159]
    s_add_u32 s29, s28, 49152
    v_cvt_pk_bf16_f32 v75, v18, v19
    v_mfma_f32_16x16x32_bf16 a[156:159], v[172:175], v[24:27], a[156:159]
    s_waitcnt lgkmcnt(2)
    v_exp_f32 v18, v78
    v_mfma_f32_16x16x32_bf16 a[16:19], v[160:163], v[32:35], a[16:19]
    s_sub_u32 s3, s29, 147456
    ds_read_b128 v[24:27], v1 offset:6144
    v_add_f32 v8, v8, v16
    v_mfma_f32_16x16x32_bf16 a[16:19], v[176:179], v[36:39], a[16:19]
    s_mov_b32 m0, s56
    v_add_f32 v8, v8, v17
    s_min_u32 s29, s29, s3
    v_mfma_f32_16x16x32_bf16 a[64:67], v[180:183], v[36:39], a[64:67]
    v_exp_f32 v19, v79
    v_mfma_f32_16x16x32_bf16 a[64:67], v[164:167], v[32:35], a[64:67]
    buffer_load_dwordx4 v4, s[4:7], s27 offen offset:0 sc1 lds
    v_mfma_f32_16x16x32_bf16 a[112:115], v[168:171], v[32:35], a[112:115]
    ds_read_b128 v[28:31], v1 offset:18432
    v_cvt_pk_bf16_f32 v76, v16, v17
    v_mfma_f32_16x16x32_bf16 a[112:115], v[184:187], v[36:39], a[112:115]
    v_exp_f32 v16, v108
    v_mfma_f32_16x16x32_bf16 a[160:163], v[188:191], v[36:39], a[160:163]
    v_add_f32 v8, v8, v18
    v_add_f32 v8, v8, v19
    v_mfma_f32_16x16x32_bf16 a[160:163], v[172:175], v[32:35], a[160:163]
    s_waitcnt lgkmcnt(2)
    buffer_load_dwordx4 v4, s[4:7], s27 offen offset:1024 sc1 lds
    v_mfma_f32_16x16x32_bf16 a[20:23], v[160:163], v[40:43], a[20:23]
    s_sub_u32 s3, s29, s28
    ds_read_b128 v[32:35], v1 offset:7168
    v_mfma_f32_16x16x32_bf16 a[20:23], v[176:179], v[44:47], a[20:23]
    v_exp_f32 v17, v109
    v_mfma_f32_16x16x32_bf16 a[68:71], v[180:183], v[44:47], a[68:71]
    v_cvt_pk_bf16_f32 v77, v18, v19
    v_mfma_f32_16x16x32_bf16 a[68:71], v[164:167], v[40:43], a[68:71]
    buffer_load_dwordx4 v4, s[4:7], s27 offen offset:2048 sc1 lds
    v_mfma_f32_16x16x32_bf16 a[116:119], v[168:171], v[40:43], a[116:119]
    ds_read_b128 v[36:39], v1 offset:19456
    v_mfma_f32_16x16x32_bf16 a[116:119], v[184:187], v[44:47], a[116:119]
L_pg10:
    s_cbranch_execz L_iwret
    v_exp_f32 v18, v110
    v_mfma_f32_16x16x32_bf16 a[164:167], v[188:191], v[44:47], a[164:167]
    s_add_u32 s27, s27, 24576
    v_add_f32 v8, v8, v16
    v_add_f32 v8, v8, v17
    v_mfma_f32_16x16x32_bf16 a[164:167], v[172:175], v[40:43], a[164:167]
    s_waitcnt lgkmcnt(2)
    v_exp_f32 v19, v111
    v_mfma_f32_16x16x32_bf16 a[24:27], v[160:163], v[24:27], a[24:27]
    s_add_u32 s56, s56, 36864
    ds_read_b128 v[40:43], v1 offset:8192
    v_cvt_pk_bf16_f32 v78, v16, v17
    v_mfma_f32_16x16x32_bf16 a[24:27], v[176:179], v[28:31], a[24:27]
    s_mov_b32 s28, s29
    v_add_f32 v8, v8, v18
    v_add_f32 v8, v8, v19
    v_mfma_f32_16x16x32_bf16 a[72:75], v[180:183], v[28:31], a[72:75]
    s_sub_u32 s58, s56, 147456
    v_cvt_pk_bf16_f32 v79, v18, v19
    v_mfma_f32_16x16x32_bf16 a[72:75], v[164:167], v[24:27], a[72:75]
    v_exp_f32 v16, v80
    v_mfma_f32_16x16x32_bf16 a[120:123], v[168:171], v[24:27], a[120:123]
    s_min_u32 s56, s56, s58
    ds_read_b128 v[44:47], v1 offset:20480
    v_mfma_f32_16x16x32_bf16 a[120:123], v[184:187], v[28:31], a[120:123]
    v_exp_f32 v17, v81
    v_mfma_f32_16x16x32_bf16 a[168:171], v[188:191], v[28:31], a[168:171]
    s_mov_b32 m0, s26
    v_exp_f32 v18, v82
    v_mfma_f32_16x16x32_bf16 a[168:171], v[172:175], v[24:27], a[168:171]
    s_waitcnt lgkmcnt(2)
    v_add_f32 v5, v5, v16
    v_add_f32 v5, v5, v17
    v_mfma_f32_16x16x32_bf16 a[28:31], v[160:163], v[32:35], a[28:31]
    ds_read_b128 v[24:27], v1 offset:9216
    v_add_u32 v2, s3, v2
    v_mfma_f32_16x16x32_bf16 a[28:31], v[176:179], v[36:39], a[28:31]
    buffer_load_dwordx4 v4, s[4:7], s32 offen offset:0 sc1 lds
    v_mfma_f32_16x16x32_bf16 a[76:79], v[180:183], v[36:39], a[76:79]
    v_exp_f32 v19, v83
    v_mfma_f32_16x16x32_bf16 a[76:79], v[164:167], v[32:35], a[76:79]
    v_cvt_pk_bf16_f32 v80, v16, v17
    v_mfma_f32_16x16x32_bf16 a[124:127], v[168:171], v[32:35], a[124:127]
    ds_read_b128 v[28:31], v1 offset:21504
    v_add_u32 v3, s3, v3
    v_mfma_f32_16x16x32_bf16 a[124:127], v[184:187], v[36:39], a[124:127]
    buffer_load_dwordx4 v4, s[4:7], s32 offen offset:1024 sc1 lds
    v_mfma_f32_16x16x32_bf16 a[172:175], v[188:191], v[36:39], a[172:175]
    v_exp_f32 v16, v112
    v_mfma_f32_16x16x32_bf16 a[172:175], v[172:175], v[32:35], a[172:175]
    s_waitcnt lgkmcnt(2)
    v_add_f32 v5, v5, v18
    v_add_f32 v5, v5, v19
    v_mfma_f32_16x16x32_bf16 a[32:35], v[160:163], v[40:43], a[32:35]
    ds_read_b128 v[32:35], v1 offset:10240
    v_mfma_f32_16x16x32_bf16 a[32:35], v[176:179], v[44:47], a[32:35]
    buffer_load_dwordx4 v4, s[4:7], s32 offen offset:2048 sc1 lds
    v_mfma_f32_16x16x32_bf16 a[80:83], v[180:183], v[44:47], a[80:83]
    v_exp_f32 v17, v113
    v_mfma_f32_16x16x32_bf16 a[80:83], v[164:167], v[40:43], a[80:83]
    v_cvt_pk_bf16_f32 v81, v18, v19
    v_mfma_f32_16x16x32_bf16 a[128:131], v[168:171], v[40:43], a[128:131]
    ds_read_b128 v[36:39], v1 offset:22528
    v_mfma_f32_16x16x32_bf16 a[128:131], v[184:187], v[44:47], a[128:131]
    s_add_u32 s32, s32, 24576
    v_exp_f32 v18, v114
    v_mfma_f32_16x16x32_bf16 a[176:179], v[188:191], v[44:47], a[176:179]
    v_add_f32 v5, v5, v16
    v_add_f32 v5, v5, v17
    v_mfma_f32_16x16x32_bf16 a[176:179], v[172:175], v[40:43], a[176:179]
    s_waitcnt lgkmcnt(2)
    v_exp_f32 v19, v115
    v_mfma_f32_16x16x32_bf16 a[36:39], v[160:163], v[24:27], a[36:39]
    s_add_u32 s26, s26, 12288
    ds_read_b128 v[40:43], v1 offset:11264
    v_cvt_pk_bf16_f32 v82, v16, v17
    v_mfma_f32_16x16x32_bf16 a[36:39], v[176:179], v[28:31], a[36:39]
    s_mov_b32 m0, s26
    v_exp_f32 v16, v84
    v_mfma_f32_16x16x32_bf16 a[84:87], v[180:183], v[28:31], a[84:87]
    v_add_f32 v5, v5, v18
    v_add_f32 v5, v5, v19
    v_mfma_f32_16x16x32_bf16 a[84:87], v[164:167], v[24:27], a[84:87]
    v_exp_f32 v17, v85
    v_mfma_f32_16x16x32_bf16 a[132:135], v[168:171], v[24:27], a[132:135]
    ds_read_b128 v[44:47], v1 offset:23552
    v_cvt_pk_bf16_f32 v83, v18, v19
    v_mfma_f32_16x16x32_bf16 a[132:135], v[184:187], v[28:31], a[132:135]
    buffer_load_dwordx4 v4, s[4:7], s32 offen offset:0 sc1 lds
    v_mfma_f32_16x16x32_bf16 a[180:183], v[188:191], v[28:31], a[180:183]
    v_exp_f32 v18, v86
    v_mfma_f32_16x16x32_bf16 a[180:183], v[172:175], v[24:27], a[180:183]
    s_waitcnt lgkmcnt(2)
    v_add_f32 v6, v6, v16
    v_add_f32 v6, v6, v17
    v_mfma_f32_16x16x32_bf16 a[40:43], v[160:163], v[32:35], a[40:43]
    ds_read_b128 v[24:27], v2 offset:0
    v_mfma_f32_16x16x32_bf16 a[40:43], v[176:179], v[36:39], a[40:43]
    buffer_load_dwordx4 v4, s[4:7], s32 offen offset:1024 sc1 lds
    v_mfma_f32_16x16x32_bf16 a[88:91], v[180:183], v[36:39], a[88:91]
    v_exp_f32 v19, v87
    v_mfma_f32_16x16x32_bf16 a[88:91], v[164:167], v[32:35], a[88:91]
    v_cvt_pk_bf16_f32 v84, v16, v17
    v_mfma_f32_16x16x32_bf16 a[136:139], v[168:171], v[32:35], a[136:139]
    ds_read_b128 v[28:31], v3 offset:0
    v_mfma_f32_16x16x32_bf16 a[136:139], v[184:187], v[36:39], a[136:139]
    buffer_load_dwordx4 v4, s[4:7], s32 offen offset:2048 sc1 lds
    v_mfma_f32_16x16x32_bf16 a[184:187], v[188:191], v[36:39], a[184:187]
    v_exp_f32 v16, v116
    v_mfma_f32_16x16x32_bf16 a[184:187], v[172:175], v[32:35], a[184:187]
    s_waitcnt lgkmcnt(2)
    v_add_f32 v6, v6, v18
    v_add_f32 v6, v6, v19
    v_mfma_f32_16x16x32_bf16 a[44:47], v[160:163], v[40:43], a[44:47]
    ds_read_b128 v[32:35], v2 offset:6144
    v_mfma_f32_16x16x32_bf16 a[44:47], v[176:179], v[44:47], a[44:47]
    v_exp_f32 v17, v117
    v_mfma_f32_16x16x32_bf16 a[92:95], v[180:183], v[44:47], a[92:95]
    v_cvt_pk_bf16_f32 v85, v18, v19
    v_mfma_f32_16x16x32_bf16 a[92:95], v[164:167], v[40:43], a[92:95]
    s_add_u32 s32, s32, 24576
    v_exp_f32 v18, v118
    v_mfma_f32_16x16x32_bf16 a[140:143], v[168:171], v[40:43], a[140:143]
    s_add_u32 s26, s26, 36864
    ds_read_b128 v[36:39], v3 offset:6144
    v_add_f32 v6, v6, v16
    v_mfma_f32_16x16x32_bf16 a[140:143], v[184:187], v[44:47], a[140:143]
    s_sub_u32 s57, s26, 147456
    v_add_f32 v6, v6, v17
    s_min_u32 s26, s26, s57
    v_mfma_f32_16x16x32_bf16 a[188:191], v[188:191], v[44:47], a[188:191]
    v_exp_f32 v19, v119
    v_mfma_f32_16x16x32_bf16 a[188:191], v[172:175], v[40:43], a[188:191]
    s_waitcnt lgkmcnt(2)
    v_cvt_pk_bf16_f32 v86, v16, v17
    v_add_f32 v6, v6, v18
    v_add_f32 v6, v6, v19
    v_cvt_pk_bf16_f32 v87, v18, v19
    v_mfma_f32_16x16x32_bf16 v[160:163], v[24:27], a[192:195], v[128:131]
    ds_read_b128 v[40:43], v2 offset:128
    v_mfma_f32_16x16x32_bf16 v[160:163], v[28:31], a[196:199], v[160:163]
    v_exp_f32 v16, v88
    v_mfma_f32_16x16x32_bf16 v[164:167], v[28:31], a[220:223], v[132:135]
    ds_read_b128 v[44:47], v3 offset:128
    v_mfma_f32_16x16x32_bf16 v[164:167], v[24:27], a[216:219], v[164:167]
    s_waitcnt lgkmcnt(2)
    v_exp_f32 v17, v89
    v_mfma_f32_16x16x32_bf16 v[96:99], v[32:35], a[192:195], v[128:131]
    ds_read_b128 v[24:27], v2 offset:6272
    v_mfma_f32_16x16x32_bf16 v[96:99], v[36:39], a[196:199], v[96:99]
    v_exp_f32 v18, v90
    v_mfma_f32_16x16x32_bf16 v[100:103], v[36:39], a[220:223], v[132:135]
    ds_read_b128 v[28:31], v3 offset:6272
    v_add_f32 v7, v7, v16
    v_mfma_f32_16x16x32_bf16 v[100:103], v[32:35], a[216:219], v[100:103]
    s_waitcnt lgkmcnt(2)
    v_add_f32 v7, v7, v17
    v_mfma_f32_16x16x32_bf16 v[160:163], v[40:43], a[200:203], v[160:163]
    ds_read_b128 v[32:35], v2 offset:256
    v_mfma_f32_16x16x32_bf16 v[160:163], v[44:47], a[204:207], v[160:163]
    v_exp_f32 v19, v91
    v_mfma_f32_16x16x32_bf16 v[164:167], v[44:47], a[228:231], v[164:167]
    ds_read_b128 v[36:39], v3 offset:256
    v_cvt_pk_bf16_f32 v88, v16, v17
    v_mfma_f32_16x16x32_bf16 v[164:167], v[40:43], a[224:227], v[164:167]
    s_waitcnt lgkmcnt(2)
    v_exp_f32 v16, v120
    v_mfma_f32_16x16x32_bf16 v[96:99], v[24:27], a[200:203], v[96:99]
    ds_read_b128 v[40:43], v2 offset:6400
    v_add_f32 v7, v7, v18
    v_mfma_f32_16x16x32_bf16 v[96:99], v[28:31], a[204:207], v[96:99]
    v_add_f32 v7, v7, v19
    v_mfma_f32_16x16x32_bf16 v[100:103], v[28:31], a[228:231], v[100:103]
    ds_read_b128 v[44:47], v3 offset:6400
    v_mfma_f32_16x16x32_bf16 v[100:103], v[24:27], a[224:227], v[100:103]
    s_waitcnt lgkmcnt(2)
    v_exp_f32 v17, v121
    v_mfma_f32_16x16x32_bf16 v[160:163], v[32:35], a[208:211], v[160:163]
    ds_read_b128 v[24:27], v2 offset:12288
    v_cvt_pk_bf16_f32 v89, v18, v19
    v_mfma_f32_16x16x32_bf16 v[160:163], v[36:39], a[212:215], v[160:163]
    v_exp_f32 v18, v122
    v_mfma_f32_16x16x32_bf16 v[164:167], v[36:39], a[236:239], v[164:167]
    ds_read_b128 v[28:31], v3 offset:12288
    v_add_f32 v7, v7, v16
    v_mfma_f32_16x16x32_bf16 v[164:167], v[32:35], a[232:235], v[164:167]
    s_waitcnt lgkmcnt(2)
    v_add_f32 v7, v7, v17
    v_mfma_f32_16x16x32_bf16 v[96:99], v[40:43], a[208:211], v[96:99]
    ds_read_b128 v[32:35], v2 offset:18432
    v_mfma_f32_16x16x32_bf16 v[96:99], v[44:47], a[212:215], v[96:99]
    v_exp_f32 v19, v123
    v_mfma_f32_16x16x32_bf16 v[100:103], v[44:47], a[236:239], v[100:103]
    ds_read_b128 v[36:39], v3 offset:18432
    v_cvt_pk_bf16_f32 v90, v16, v17
    v_mfma_f32_16x16x32_bf16 v[100:103], v[40:43], a[232:235], v[100:103]
    s_waitcnt lgkmcnt(2)
    v_exp_f32 v16, v92
    v_mfma_f32_16x16x32_bf16 v[168:171], v[24:27], a[192:195], v[128:131]
    ds_read_b128 v[40:43], v2 offset:12416
    v_add_f32 v7, v7, v18
    v_mfma_f32_16x16x32_bf16 v[168:171], v[28:31], a[196:199], v[168:171]
    v_add_f32 v7, v7, v19
    v_mfma_f32_16x16x32_bf16 v[172:175], v[28:31], a[220:223], v[132:135]
    ds_read_b128 v[44:47], v3 offset:12416
    v_mfma_f32_16x16x32_bf16 v[172:175], v[24:27], a[216:219], v[172:175]
    s_waitcnt lgkmcnt(2)
    v_exp_f32 v17, v93
    v_mfma_f32_16x16x32_bf16 v[104:107], v[32:35], a[192:195], v[128:131]
    ds_read_b128 v[24:27], v2 offset:18560
    v_cvt_pk_bf16_f32 v91, v18, v19
    v_mfma_f32_16x16x32_bf16 v[104:107], v[36:39], a[196:199], v[104:107]
    v_exp_f32 v18, v94
    v_mfma_f32_16x16x32_bf16 v[108:111], v[36:39], a[220:223], v[132:135]
    s_add_u32 s29, s30, 49152
    ds_read_b128 v[28:31], v3 offset:18560
    v_add_f32 v8, v8, v16
    v_mfma_f32_16x16x32_bf16 v[108:111], v[32:35], a[216:219], v[108:111]
    s_waitcnt lgkmcnt(2)
    v_add_f32 v8, v8, v17
    s_sub_u32 s3, s29, 147456
    v_mfma_f32_16x16x32_bf16 v[168:171], v[40:43], a[200:203], v[168:171]
    ds_read_b128 v[32:35], v2 offset:12544
    v_mfma_f32_16x16x32_bf16 v[168:171], v[44:47], a[204:207], v[168:171]
    s_min_u32 s29, s29, s3
    v_exp_f32 v19, v95
    v_mfma_f32_16x16x32_bf16 v[172:175], v[44:47], a[228:231], v[172:175]
    ds_read_b128 v[36:39], v3 offset:12544
    v_cvt_pk_bf16_f32 v92, v16, v17
    v_mfma_f32_16x16x32_bf16 v[172:175], v[40:43], a[224:227], v[172:175]
    s_waitcnt lgkmcnt(2)
    v_exp_f32 v16, v124
    v_mfma_f32_16x16x32_bf16 v[104:107], v[24:27], a[200:203], v[104:107]
    ds_read_b128 v[40:43], v2 offset:18688
    v_add_f32 v8, v8, v18
    v_mfma_f32_16x16x32_bf16 v[104:107], v[28:31], a[204:207], v[104:107]
    v_add_f32 v8, v8, v19
    v_mfma_f32_16x16x32_bf16 v[108:111], v[28:31], a[228:231], v[108:111]
    ds_read_b128 v[44:47], v3 offset:18688
    v_mfma_f32_16x16x32_bf16 v[108:111], v[24:27], a[224:227], v[108:111]
    s_waitcnt lgkmcnt(2)
    v_subrev_u32 v2, 98304, v2
    v_subrev_u32 v3, 98304, v3
    v_mfma_f32_16x16x32_bf16 v[168:171], v[32:35], a[208:211], v[168:171]
    ds_read_b128 v[24:27], v2 offset:0
    v_mfma_f32_16x16x32_bf16 v[168:171], v[36:39], a[212:215], v[168:171]
    s_sub_u32 s3, s29, s30
    v_exp_f32 v17, v125
    v_mfma_f32_16x16x32_bf16 v[172:175], v[36:39], a[236:239], v[172:175]
    ds_read_b128 v[28:31], v3 offset:0
    v_cvt_pk_bf16_f32 v93, v18, v19
    v_mfma_f32_16x16x32_bf16 v[172:175], v[32:35], a[232:235], v[172:175]
    s_waitcnt lgkmcnt(2)
    v_exp_f32 v18, v126
    v_mfma_f32_16x16x32_bf16 v[104:107], v[40:43], a[208:211], v[104:107]
    ds_read_b128 v[32:35], v2 offset:6144
    v_add_f32 v8, v8, v16
    v_mfma_f32_16x16x32_bf16 v[104:107], v[44:47], a[212:215], v[104:107]
    v_add_f32 v8, v8, v17
    v_mfma_f32_16x16x32_bf16 v[108:111], v[44:47], a[236:239], v[108:111]
    ds_read_b128 v[36:39], v3 offset:6144
    v_mfma_f32_16x16x32_bf16 v[108:111], v[40:43], a[232:235], v[108:111]
    s_waitcnt lgkmcnt(2)
    v_exp_f32 v19, v127
    v_mfma_f32_16x16x32_bf16 v[176:179], v[24:27], a[192:195], v[128:131]
    ds_read_b128 v[40:43], v2 offset:128
    v_cvt_pk_bf16_f32 v94, v16, v17
    v_mfma_f32_16x16x32_bf16 v[176:179], v[28:31], a[196:199], v[176:179]
    s_mov_b32 s30, s29
    v_add_f32 v8, v8, v18
    v_add_f32 v8, v8, v19
    v_mfma_f32_16x16x32_bf16 v[180:183], v[28:31], a[220:223], v[132:135]
    ds_read_b128 v[44:47], v3 offset:128
    v_cvt_pk_bf16_f32 v95, v18, v19
    v_mfma_f32_16x16x32_bf16 v[180:183], v[24:27], a[216:219], v[180:183]
    s_waitcnt lgkmcnt(2)
    v_exp_f32 v16, v160
    v_mfma_f32_16x16x32_bf16 v[112:115], v[32:35], a[192:195], v[128:131]
    ds_read_b128 v[24:27], v2 offset:6272
    v_mfma_f32_16x16x32_bf16 v[112:115], v[36:39], a[196:199], v[112:115]
    v_exp_f32 v17, v161
    v_mfma_f32_16x16x32_bf16 v[116:119], v[36:39], a[220:223], v[132:135]
    ds_read_b128 v[28:31], v3 offset:6272
    v_mfma_f32_16x16x32_bf16 v[116:119], v[32:35], a[216:219], v[116:119]
    s_waitcnt lgkmcnt(2)
    v_exp_f32 v18, v162
    v_mfma_f32_16x16x32_bf16 v[176:179], v[40:43], a[200:203], v[176:179]
    ds_read_b128 v[32:35], v2 offset:256
    v_add_f32 v5, v5, v16
    v_mfma_f32_16x16x32_bf16 v[176:179], v[44:47], a[204:207], v[176:179]
    v_add_f32 v5, v5, v17
    v_add_u32 v1, s3, v1
    v_mfma_f32_16x16x32_bf16 v[180:183], v[44:47], a[228:231], v[180:183]
    ds_read_b128 v[36:39], v3 offset:256
    v_mfma_f32_16x16x32_bf16 v[180:183], v[40:43], a[224:227], v[180:183]
    s_waitcnt lgkmcnt(2)
    v_exp_f32 v19, v163
    v_mfma_f32_16x16x32_bf16 v[112:115], v[24:27], a[200:203], v[112:115]
    ds_read_b128 v[40:43], v2 offset:6400
    v_cvt_pk_bf16_f32 v160, v16, v17
    v_mfma_f32_16x16x32_bf16 v[112:115], v[28:31], a[204:207], v[112:115]
    v_exp_f32 v16, v96
    v_mfma_f32_16x16x32_bf16 v[116:119], v[28:31], a[228:231], v[116:119]
    ds_read_b128 v[44:47], v3 offset:6400
    v_add_f32 v5, v5, v18
    v_mfma_f32_16x16x32_bf16 v[116:119], v[24:27], a[224:227], v[116:119]
    s_waitcnt lgkmcnt(2)
    v_add_f32 v5, v5, v19
    v_mfma_f32_16x16x32_bf16 v[176:179], v[32:35], a[208:211], v[176:179]
    ds_read_b128 v[24:27], v2 offset:12288
    v_mfma_f32_16x16x32_bf16 v[176:179], v[36:39], a[212:215], v[176:179]
    v_exp_f32 v17, v97
    v_mfma_f32_16x16x32_bf16 v[180:183], v[36:39], a[236:239], v[180:183]
    ds_read_b128 v[28:31], v3 offset:12288
    v_cvt_pk_bf16_f32 v161, v18, v19
    v_mfma_f32_16x16x32_bf16 v[180:183], v[32:35], a[232:235], v[180:183]
    s_waitcnt lgkmcnt(2)
    v_exp_f32 v18, v98
    v_mfma_f32_16x16x32_bf16 v[112:115], v[40:43], a[208:211], v[112:115]
    ds_read_b128 v[32:35], v2 offset:18432
    v_add_f32 v5, v5, v16
    v_mfma_f32_16x16x32_bf16 v[112:115], v[44:47], a[212:215], v[112:115]
    v_add_f32 v5, v5, v17
    v_mfma_f32_16x16x32_bf16 v[116:119], v[44:47], a[236:239], v[116:119]
    ds_read_b128 v[36:39], v3 offset:18432
    v_mfma_f32_16x16x32_bf16 v[116:119], v[40:43], a[232:235], v[116:119]
    s_waitcnt lgkmcnt(2)
    v_exp_f32 v19, v99
    v_mfma_f32_16x16x32_bf16 v[184:187], v[24:27], a[192:195], v[128:131]
    ds_read_b128 v[40:43], v2 offset:12416
    v_cvt_pk_bf16_f32 v162, v16, v17
    v_mfma_f32_16x16x32_bf16 v[184:187], v[28:31], a[196:199], v[184:187]
    v_exp_f32 v16, v164
    v_mfma_f32_16x16x32_bf16 v[188:191], v[28:31], a[220:223], v[132:135]
    ds_read_b128 v[44:47], v3 offset:12416
    v_add_f32 v5, v5, v18
    v_mfma_f32_16x16x32_bf16 v[188:191], v[24:27], a[216:219], v[188:191]
    s_waitcnt lgkmcnt(2)
    v_add_f32 v5, v5, v19
    v_mfma_f32_16x16x32_bf16 v[120:123], v[32:35], a[192:195], v[128:131]
    ds_read_b128 v[24:27], v2 offset:18560
    v_mfma_f32_16x16x32_bf16 v[120:123], v[36:39], a[196:199], v[120:123]
    s_waitcnt vmcnt(6)
    v_exp_f32 v17, v165
    v_mfma_f32_16x16x32_bf16 v[124:127], v[36:39], a[220:223], v[132:135]
    ds_read_b128 v[28:31], v3 offset:18560
    v_cvt_pk_bf16_f32 v163, v18, v19
    v_mfma_f32_16x16x32_bf16 v[124:127], v[32:35], a[216:219], v[124:127]
    s_waitcnt lgkmcnt(2)
    s_barrier
    v_mfma_f32_16x16x32_bf16 v[184:187], v[40:43], a[200:203], v[184:187]
    ds_read_b128 v[32:35], v2 offset:12544
    v_mfma_f32_16x16x32_bf16 v[184:187], v[44:47], a[204:207], v[184:187]
    v_exp_f32 v18, v166
    v_mfma_f32_16x16x32_bf16 v[188:191], v[44:47], a[228:231], v[188:191]
    ds_read_b128 v[36:39], v3 offset:12544
    v_add_f32 v6, v6, v16
    v_mfma_f32_16x16x32_bf16 v[188:191], v[40:43], a[224:227], v[188:191]
    s_waitcnt lgkmcnt(2)
    v_add_f32 v6, v6, v17
    v_mfma_f32_16x16x32_bf16 v[120:123], v[24:27], a[200:203], v[120:123]
    ds_read_b128 v[40:43], v2 offset:18688
    v_mfma_f32_16x16x32_bf16 v[120:123], v[28:31], a[204:207], v[120:123]
    v_exp_f32 v19, v167
    v_cvt_pk_bf16_f32 v164, v16, v17
    v_mfma_f32_16x16x32_bf16 v[124:127], v[28:31], a[228:231], v[124:127]
    ds_read_b128 v[44:47], v3 offset:18688
    v_mfma_f32_16x16x32_bf16 v[124:127], v[24:27], a[224:227], v[124:127]
    s_waitcnt lgkmcnt(2)
    v_exp_f32 v16, v100
    v_mfma_f32_16x16x32_bf16 v[184:187], v[32:35], a[208:211], v[184:187]
    ds_read_b128 v[24:27], v1 offset:0
    v_add_f32 v6, v6, v18
    v_mfma_f32_16x16x32_bf16 v[184:187], v[36:39], a[212:215], v[184:187]
    v_add_f32 v6, v6, v19
    v_mfma_f32_16x16x32_bf16 v[188:191], v[36:39], a[236:239], v[188:191]
    ds_read_b128 v[28:31], v1 offset:12288
    v_mfma_f32_16x16x32_bf16 v[188:191], v[32:35], a[232:235], v[188:191]
    s_waitcnt lgkmcnt(2)
    v_exp_f32 v17, v101
    v_cvt_pk_bf16_f32 v165, v18, v19
    v_mfma_f32_16x16x32_bf16 v[120:123], v[40:43], a[208:211], v[120:123]
    ds_read_b128 v[32:35], v1 offset:1024
    v_mfma_f32_16x16x32_bf16 v[120:123], v[44:47], a[212:215], v[120:123]
    v_exp_f32 v18, v102
    v_mfma_f32_16x16x32_bf16 v[124:127], v[44:47], a[236:239], v[124:127]
    ds_read_b128 v[36:39], v1 offset:13312
    v_add_f32 v6, v6, v16
    v_mfma_f32_16x16x32_bf16 v[124:127], v[40:43], a[232:235], v[124:127]
    s_waitcnt lgkmcnt(2)
    v_add_f32 v6, v6, v17
    v_exp_f32 v19, v103
    v_cvt_pk_bf16_f32 v166, v16, v17
    v_add_f32 v6, v6, v18
    v_add_f32 v6, v6, v19
    v_cvt_pk_bf16_f32 v167, v18, v19
    v_mfma_f32_16x16x32_bf16 a[0:3], v[64:67], v[24:27], a[0:3]
    s_mov_b32 m0, s56
    ds_read_b128 v[40:43], v1 offset:2048
    v_bfe_u32 v57, v4, 8, 2
    v_mfma_f32_16x16x32_bf16 a[0:3], v[80:83], v[28:31], a[0:3]
    buffer_load_dwordx4 v4, s[4:7], s27 offen offset:0 sc1 lds
    v_mfma_f32_16x16x32_bf16 a[48:51], v[84:87], v[28:31], a[48:51]
    v_exp_f32 v16, v168
    v_mfma_f32_16x16x32_bf16 a[48:51], v[68:71], v[24:27], a[48:51]
    v_exp_f32 v17, v169
    v_mfma_f32_16x16x32_bf16 a[96:99], v[72:75], v[24:27], a[96:99]
    ds_read_b128 v[44:47], v1 offset:14336
    v_mul_u32_u24 v56, 1536, v57
    v_mfma_f32_16x16x32_bf16 a[96:99], v[88:91], v[28:31], a[96:99]
    buffer_load_dwordx4 v4, s[4:7], s27 offen offset:1024 sc1 lds
    v_mfma_f32_16x16x32_bf16 a[144:147], v[92:95], v[28:31], a[144:147]
    v_exp_f32 v18, v170
    v_mfma_f32_16x16x32_bf16 a[144:147], v[76:79], v[24:27], a[144:147]
    s_waitcnt lgkmcnt(2)
    v_add_f32 v5, v5, v16
    v_add_f32 v5, v5, v17
    v_mfma_f32_16x16x32_bf16 a[4:7], v[64:67], v[32:35], a[4:7]
    ds_read_b128 v[24:27], v1 offset:3072
    v_lshlrev_b32 v58, 4, v57
    v_mfma_f32_16x16x32_bf16 a[4:7], v[80:83], v[36:39], a[4:7]
    buffer_load_dwordx4 v4, s[4:7], s27 offen offset:2048 sc1 lds
    v_mfma_f32_16x16x32_bf16 a[52:55], v[84:87], v[36:39], a[52:55]
    v_exp_f32 v19, v171
    v_mfma_f32_16x16x32_bf16 a[52:55], v[68:71], v[32:35], a[52:55]
    s_add_u32 s27, s27, 24576
    v_cvt_pk_bf16_f32 v168, v16, v17
    v_bfe_u32 v57, v4, 4, 4
    v_mfma_f32_16x16x32_bf16 a[100:103], v[72:75], v[32:35], a[100:103]
    ds_read_b128 v[28:31], v1 offset:15360
    v_mfma_f32_16x16x32_bf16 a[100:103], v[88:91], v[36:39], a[100:103]
    s_add_u32 s56, s56, 12288
    v_exp_f32 v16, v104
    v_mfma_f32_16x16x32_bf16 a[148:151], v[92:95], v[36:39], a[148:151]
    v_add_f32 v5, v5, v18
    v_add_f32 v5, v5, v19
    v_mfma_f32_16x16x32_bf16 a[148:151], v[76:79], v[32:35], a[148:151]
    s_waitcnt lgkmcnt(2)
    v_exp_f32 v17, v105
    v_mfma_f32_16x16x32_bf16 a[8:11], v[64:67], v[40:43], a[8:11]
    s_mov_b32 m0, s56
    ds_read_b128 v[32:35], v1 offset:4096
    v_cvt_pk_bf16_f32 v169, v18, v19
    v_mfma_f32_16x16x32_bf16 a[8:11], v[80:83], v[44:47], a[8:11]
    v_exp_f32 v18, v106
    v_mfma_f32_16x16x32_bf16 a[56:59], v[84:87], v[44:47], a[56:59]
    v_add_f32 v5, v5, v16
    v_add_f32 v5, v5, v17
    v_mfma_f32_16x16x32_bf16 a[56:59], v[68:71], v[40:43], a[56:59]
    buffer_load_dwordx4 v4, s[4:7], s27 offen offset:0 sc1 lds
    v_mfma_f32_16x16x32_bf16 a[104:107], v[72:75], v[40:43], a[104:107]
    ds_read_b128 v[36:39], v1 offset:16384
    v_mul_u32_u24 v57, 12, v57
    v_mfma_f32_16x16x32_bf16 a[104:107], v[88:91], v[44:47], a[104:107]
    v_exp_f32 v19, v107
    v_mfma_f32_16x16x32_bf16 a[152:155], v[92:95], v[44:47], a[152:155]
    v_cvt_pk_bf16_f32 v170, v16, v17
    v_add_u32 v56, v56, v57
    v_mfma_f32_16x16x32_bf16 a[152:155], v[76:79], v[40:43], a[152:155]
    s_waitcnt lgkmcnt(2)
    buffer_load_dwordx4 v4, s[4:7], s27 offen offset:1024 sc1 lds
    v_mfma_f32_16x16x32_bf16 a[12:15], v[64:67], v[24:27], a[12:15]
    ds_read_b128 v[40:43], v1 offset:5120
    v_mfma_f32_16x16x32_bf16 a[12:15], v[80:83], v[28:31], a[12:15]
    v_exp_f32 v16, v172
    v_mfma_f32_16x16x32_bf16 a[60:63], v[84:87], v[28:31], a[60:63]
    v_add_f32 v5, v5, v18
    v_add_f32 v5, v5, v19
    v_mfma_f32_16x16x32_bf16 a[60:63], v[68:71], v[24:27], a[60:63]
    buffer_load_dwordx4 v4, s[4:7], s27 offen offset:2048 sc1 lds
    v_mfma_f32_16x16x32_bf16 a[108:111], v[72:75], v[24:27], a[108:111]
    ds_read_b128 v[44:47], v1 offset:17408
    v_mov_b32 v57, 1.0
    v_mfma_f32_16x16x32_bf16 a[108:111], v[88:91], v[28:31], a[108:111]
    v_exp_f32 v17, v173
    v_mfma_f32_16x16x32_bf16 a[156:159], v[92:95], v[28:31], a[156:159]
    s_add_u32 s27, s27, 24576
    v_cvt_pk_bf16_f32 v171, v18, v19
    v_mfma_f32_16x16x32_bf16 a[156:159], v[76:79], v[24:27], a[156:159]
    s_waitcnt lgkmcnt(2)
    v_exp_f32 v18, v174
    v_mfma_f32_16x16x32_bf16 a[16:19], v[64:67], v[32:35], a[16:19]
    s_add_u32 s56, s56, 36864
    ds_read_b128 v[24:27], v1 offset:6144
    v_add_f32 v6, v6, v16
    v_mfma_f32_16x16x32_bf16 a[16:19], v[80:83], v[36:39], a[16:19]
    v_add_f32 v6, v6, v17
    v_mov_b32 v20, 0x3f803f80
    v_mfma_f32_16x16x32_bf16 a[64:67], v[84:87], v[36:39], a[64:67]
    s_sub_u32 s58, s56, 147456
    v_exp_f32 v19, v175
    v_mfma_f32_16x16x32_bf16 a[64:67], v[68:71], v[32:35], a[64:67]
    v_cvt_pk_bf16_f32 v172, v16, v17
    v_mfma_f32_16x16x32_bf16 a[112:115], v[72:75], v[32:35], a[112:115]
    s_min_u32 s56, s56, s58
    ds_read_b128 v[28:31], v1 offset:18432
    v_mov_b32 v21, 0x3f803f80
    v_mfma_f32_16x16x32_bf16 a[112:115], v[88:91], v[36:39], a[112:115]
    v_exp_f32 v16, v108
    v_mfma_f32_16x16x32_bf16 a[160:163], v[92:95], v[36:39], a[160:163]
    s_mov_b32 m0, s56
    v_add_f32 v6, v6, v18
    v_add_f32 v6, v6, v19
    v_mfma_f32_16x16x32_bf16 a[160:163], v[76:79], v[32:35], a[160:163]
    s_waitcnt lgkmcnt(2)
    v_exp_f32 v17, v109
    v_mfma_f32_16x16x32_bf16 a[20:23], v[64:67], v[40:43], a[20:23]
    ds_read_b128 v[32:35], v1 offset:7168
    v_cvt_pk_bf16_f32 v173, v18, v19
    v_mfma_f32_16x16x32_bf16 a[20:23], v[80:83], v[44:47], a[20:23]
    buffer_load_dwordx4 v4, s[4:7], s27 offen offset:0 sc1 lds
    v_mfma_f32_16x16x32_bf16 a[68:71], v[84:87], v[44:47], a[68:71]
    v_exp_f32 v18, v110
    v_mfma_f32_16x16x32_bf16 a[68:71], v[68:71], v[40:43], a[68:71]
    v_add_f32 v6, v6, v16
    v_add_f32 v6, v6, v17
    v_mfma_f32_16x16x32_bf16 a[116:119], v[72:75], v[40:43], a[116:119]
    ds_read_b128 v[36:39], v1 offset:19456
    v_mov_b32 v22, 0x3f803f80
    v_mfma_f32_16x16x32_bf16 a[116:119], v[88:91], v[44:47], a[116:119]
    buffer_load_dwordx4 v4, s[4:7], s27 offen offset:1024 sc1 lds
    v_mfma_f32_16x16x32_bf16 a[164:167], v[92:95], v[44:47], a[164:167]
    v_exp_f32 v19, v111
    v_mfma_f32_16x16x32_bf16 a[164:167], v[76:79], v[40:43], a[164:167]
    s_waitcnt lgkmcnt(2)
    v_cvt_pk_bf16_f32 v174, v16, v17
    v_add_f32 v6, v6, v18
    v_mfma_f32_16x16x32_bf16 a[24:27], v[64:67], v[24:27], a[24:27]
    ds_read_b128 v[40:43], v1 offset:8192
    v_add_f32 v6, v6, v19
    v_mfma_f32_16x16x32_bf16 a[24:27], v[80:83], v[28:31], a[24:27]
    buffer_load_dwordx4 v4, s[4:7], s27 offen offset:2048 sc1 lds
    v_mfma_f32_16x16x32_bf16 a[72:75], v[84:87], v[28:31], a[72:75]
    v_cvt_pk_bf16_f32 v175, v18, v19
    v_mov_b32 v23, 0x3f803f80
    v_mfma_f32_16x16x32_bf16 a[72:75], v[68:71], v[24:27], a[72:75]
    v_exp_f32 v16, v176
    v_mfma_f32_16x16x32_bf16 a[120:123], v[72:75], v[24:27], a[120:123]
    ds_read_b128 v[44:47], v1 offset:20480
    v_mfma_f32_16x16x32_bf16 a[120:123], v[88:91], v[28:31], a[120:123]
    s_lshl_b32 s24, s95, 2
    v_exp_f32 v17, v177
    v_mfma_f32_16x16x32_bf16 a[168:171], v[92:95], v[28:31], a[168:171]
    s_add_u32 s27, s27, 24576
    v_exp_f32 v18, v178
    v_mfma_f32_16x16x32_bf16 a[168:171], v[76:79], v[24:27], a[168:171]
    s_waitcnt lgkmcnt(2)
    v_add_f32 v5, v5, v16
    v_add_f32 v5, v5, v17
    v_mfma_f32_16x16x32_bf16 a[28:31], v[64:67], v[32:35], a[28:31]
    s_add_u32 s56, s56, 12288
    ds_read_b128 v[24:27], v1 offset:9216
    v_mfma_f32_16x16x32_bf16 a[28:31], v[80:83], v[36:39], a[28:31]
    s_mov_b32 m0, s56
    v_exp_f32 v19, v179
    v_mfma_f32_16x16x32_bf16 a[76:79], v[84:87], v[36:39], a[76:79]
    v_cvt_pk_bf16_f32 v176, v16, v17
    v_mfma_f32_16x16x32_bf16 a[76:79], v[68:71], v[32:35], a[76:79]
    s_add_u32 s24, s24, s25
    v_exp_f32 v16, v112
    v_mfma_f32_16x16x32_bf16 a[124:127], v[72:75], v[32:35], a[124:127]
    ds_read_b128 v[28:31], v1 offset:21504
    v_add_f32 v5, v5, v18
    v_mfma_f32_16x16x32_bf16 a[124:127], v[88:91], v[36:39], a[124:127]
    buffer_load_dwordx4 v4, s[4:7], s27 offen offset:0 sc1 lds
    v_mfma_f32_16x16x32_bf16 a[172:175], v[92:95], v[36:39], a[172:175]
    v_add_f32 v5, v5, v19
    v_mfma_f32_16x16x32_bf16 a[172:175], v[76:79], v[32:35], a[172:175]
    s_waitcnt lgkmcnt(2)
    v_exp_f32 v17, v113
    v_mfma_f32_16x16x32_bf16 a[32:35], v[64:67], v[40:43], a[32:35]
    s_mul_i32 s24, s24, 24576
    ds_read_b128 v[32:35], v1 offset:10240
    v_cvt_pk_bf16_f32 v177, v18, v19
    v_mfma_f32_16x16x32_bf16 a[32:35], v[80:83], v[44:47], a[32:35]
    buffer_load_dwordx4 v4, s[4:7], s27 offen offset:1024 sc1 lds
    v_mfma_f32_16x16x32_bf16 a[80:83], v[84:87], v[44:47], a[80:83]
    v_exp_f32 v18, v114
    v_mfma_f32_16x16x32_bf16 a[80:83], v[68:71], v[40:43], a[80:83]
    v_add_f32 v5, v5, v16
    v_add_f32 v5, v5, v17
    v_mfma_f32_16x16x32_bf16 a[128:131], v[72:75], v[40:43], a[128:131]
    ds_read_b128 v[36:39], v1 offset:22528
    v_mfma_f32_16x16x32_bf16 a[128:131], v[88:91], v[44:47], a[128:131]
    buffer_load_dwordx4 v4, s[4:7], s27 offen offset:2048 sc1 lds
    v_mfma_f32_16x16x32_bf16 a[176:179], v[92:95], v[44:47], a[176:179]
    s_add_u32 s40, s24, 6144
    v_exp_f32 v19, v115
    v_mfma_f32_16x16x32_bf16 a[176:179], v[76:79], v[40:43], a[176:179]
    s_waitcnt lgkmcnt(2)
    v_cvt_pk_bf16_f32 v178, v16, v17
    v_mfma_f32_16x16x32_bf16 a[36:39], v[64:67], v[24:27], a[36:39]
    ds_read_b128 v[40:43], v1 offset:11264
    v_mfma_f32_16x16x32_bf16 a[36:39], v[80:83], v[28:31], a[36:39]
    v_exp_f32 v16, v180
    v_mfma_f32_16x16x32_bf16 a[84:87], v[84:87], v[28:31], a[84:87]
    v_add_f32 v5, v5, v18
    v_add_f32 v5, v5, v19
    v_mfma_f32_16x16x32_bf16 a[84:87], v[68:71], v[24:27], a[84:87]
    s_add_u32 s27, s27, 24576
    v_exp_f32 v17, v181
    v_mfma_f32_16x16x32_bf16 a[132:135], v[72:75], v[24:27], a[132:135]
    s_add_u32 s56, s56, 36864
    ds_read_b128 v[44:47], v1 offset:23552
    v_cvt_pk_bf16_f32 v179, v18, v19
    v_mfma_f32_16x16x32_bf16 a[132:135], v[88:91], v[28:31], a[132:135]
    s_waitcnt lgkmcnt(2)
    v_exp_f32 v18, v182
    v_mfma_f32_16x16x32_bf16 a[180:183], v[92:95], v[28:31], a[180:183]
    s_waitcnt vmcnt(12)
    v_add_f32 v6, v6, v16
    v_add_f32 v6, v6, v17
    v_mfma_f32_16x16x32_bf16 a[180:183], v[76:79], v[24:27], a[180:183]
    s_barrier
    v_add_u32 v2, 49152, v2
    v_add_u32 v3, 49152, v3
    v_mfma_f32_16x16x32_bf16 a[40:43], v[64:67], v[32:35], a[40:43]
    s_sub_u32 s58, s56, 147456
    ds_read_b128 v[24:27], v2 offset:0
    s_add_u32 s41, s24, 12288
    v_mfma_f32_16x16x32_bf16 a[40:43], v[80:83], v[36:39], a[40:43]
    s_min_u32 s56, s56, s58
    v_exp_f32 v19, v183
    v_mfma_f32_16x16x32_bf16 a[88:91], v[84:87], v[36:39], a[88:91]
L_pg11:
    s_cbranch_execz L_iwret
    s_add_u32 s42, s24, 18432
    v_cvt_pk_bf16_f32 v180, v16, v17
    v_mfma_f32_16x16x32_bf16 a[88:91], v[68:71], v[32:35], a[88:91]
    v_exp_f32 v16, v116
    v_mfma_f32_16x16x32_bf16 a[136:139], v[72:75], v[32:35], a[136:139]
    ds_read_b128 v[28:31], v3 offset:0
    v_add_f32 v6, v6, v18
    v_mfma_f32_16x16x32_bf16 a[136:139], v[88:91], v[36:39], a[136:139]
    v_add_f32 v6, v6, v19
    v_mfma_f32_16x16x32_bf16 a[184:187], v[92:95], v[36:39], a[184:187]
    v_exp_f32 v17, v117
    v_mfma_f32_16x16x32_bf16 a[184:187], v[76:79], v[32:35], a[184:187]
    s_waitcnt lgkmcnt(2)
    v_cvt_pk_bf16_f32 v181, v18, v19
    v_mfma_f32_16x16x32_bf16 a[44:47], v[64:67], v[40:43], a[44:47]
    ds_read_b128 v[32:35], v2 offset:6144
    v_mfma_f32_16x16x32_bf16 a[44:47], v[80:83], v[44:47], a[44:47]
    v_exp_f32 v18, v118
    v_mfma_f32_16x16x32_bf16 a[92:95], v[84:87], v[44:47], a[92:95]
    v_add_f32 v6, v6, v16
    v_add_f32 v6, v6, v17
    v_mfma_f32_16x16x32_bf16 a[92:95], v[68:71], v[40:43], a[92:95]
    v_exp_f32 v19, v119
    v_mfma_f32_16x16x32_bf16 a[140:143], v[72:75], v[40:43], a[140:143]
    ds_read_b128 v[36:39], v3 offset:6144
    v_cvt_pk_bf16_f32 v182, v16, v17
    v_mfma_f32_16x16x32_bf16 a[140:143], v[88:91], v[44:47], a[140:143]
    v_add_f32 v6, v6, v18
    v_add_f32 v6, v6, v19
    v_mfma_f32_16x16x32_bf16 a[188:191], v[92:95], v[44:47], a[188:191]
    v_cvt_pk_bf16_f32 v183, v18, v19
    v_mfma_f32_16x16x32_bf16 a[188:191], v[76:79], v[40:43], a[188:191]
    s_waitcnt lgkmcnt(2)
    v_mfma_f32_16x16x32_bf16 v[64:67], v[24:27], a[192:195], v[128:131]
    ds_read_b128 v[40:43], v2 offset:128
    v_mfma_f32_16x16x32_bf16 v[64:67], v[28:31], a[196:199], v[64:67]
    v_exp_f32 v16, v184
    v_mfma_f32_16x16x32_bf16 v[68:71], v[28:31], a[220:223], v[132:135]
    ds_read_b128 v[44:47], v3 offset:128
    v_mfma_f32_16x16x32_bf16 v[68:71], v[24:27], a[216:219], v[68:71]
    s_waitcnt lgkmcnt(2)
    v_exp_f32 v17, v185
    v_mfma_f32_16x16x32_bf16 v[96:99], v[32:35], a[192:195], v[128:131]
    ds_read_b128 v[24:27], v2 offset:6272
    v_mfma_f32_16x16x32_bf16 v[96:99], v[36:39], a[196:199], v[96:99]
    v_exp_f32 v18, v186
    v_mfma_f32_16x16x32_bf16 v[100:103], v[36:39], a[220:223], v[132:135]
    ds_read_b128 v[28:31], v3 offset:6272
    v_add_f32 v5, v5, v16
    v_mfma_f32_16x16x32_bf16 v[100:103], v[32:35], a[216:219], v[100:103]
    s_waitcnt lgkmcnt(2)
    v_add_f32 v5, v5, v17
    v_mfma_f32_16x16x32_bf16 v[64:67], v[40:43], a[200:203], v[64:67]
    ds_read_b128 v[32:35], v2 offset:256
    v_mfma_f32_16x16x32_bf16 v[64:67], v[44:47], a[204:207], v[64:67]
    v_exp_f32 v19, v187
    v_mfma_f32_16x16x32_bf16 v[68:71], v[44:47], a[228:231], v[68:71]
    ds_read_b128 v[36:39], v3 offset:256
    v_cvt_pk_bf16_f32 v184, v16, v17
    v_mfma_f32_16x16x32_bf16 v[68:71], v[40:43], a[224:227], v[68:71]
    s_waitcnt lgkmcnt(2)
    v_exp_f32 v16, v120
    v_mfma_f32_16x16x32_bf16 v[96:99], v[24:27], a[200:203], v[96:99]
    ds_read_b128 v[40:43], v2 offset:6400
    v_add_f32 v5, v5, v18
    v_mfma_f32_16x16x32_bf16 v[96:99], v[28:31], a[204:207], v[96:99]
    s_waitcnt vmcnt(0)
    v_add_f32 v5, v5, v19
    v_mfma_f32_16x16x32_bf16 v[100:103], v[28:31], a[228:231], v[100:103]
    ds_read_b128 v[44:47], v3 offset:6400
    v_mfma_f32_16x16x32_bf16 v[100:103], v[24:27], a[224:227], v[100:103]
    s_waitcnt lgkmcnt(2)
    s_barrier
    v_mfma_f32_16x16x32_bf16 v[64:67], v[32:35], a[208:211], v[64:67]
    s_mov_b32 m0, s56
    ds_read_b128 v[24:27], v2 offset:12288
    v_mfma_f32_16x16x32_bf16 v[64:67], v[36:39], a[212:215], v[64:67]
    buffer_load_dwordx4 v4, s[4:7], s27 offen offset:0 sc1 lds
    v_mfma_f32_16x16x32_bf16 v[68:71], v[36:39], a[236:239], v[68:71]
    ds_read_b128 v[28:31], v3 offset:12288
    v_mfma_f32_16x16x32_bf16 v[68:71], v[32:35], a[232:235], v[68:71]
    s_waitcnt lgkmcnt(2)
    v_exp_f32 v17, v121
    v_cvt_pk_bf16_f32 v185, v18, v19
    v_mfma_f32_16x16x32_bf16 v[96:99], v[40:43], a[208:211], v[96:99]
    ds_read_b128 v[32:35], v2 offset:18432
    v_mfma_f32_16x16x32_bf16 v[96:99], v[44:47], a[212:215], v[96:99]
    buffer_load_dwordx4 v4, s[4:7], s27 offen offset:1024 sc1 lds
    v_mfma_f32_16x16x32_bf16 v[100:103], v[44:47], a[236:239], v[100:103]
    ds_read_b128 v[36:39], v3 offset:18432
    v_mfma_f32_16x16x32_bf16 v[100:103], v[40:43], a[232:235], v[100:103]
    s_waitcnt lgkmcnt(2)
    v_exp_f32 v18, v122
    v_add_f32 v5, v5, v16
    v_mfma_f32_16x16x32_bf16 v[72:75], v[24:27], a[192:195], v[128:131]
    ds_read_b128 v[40:43], v2 offset:12416
    v_add_f32 v5, v5, v17
    v_mfma_f32_16x16x32_bf16 v[72:75], v[28:31], a[196:199], v[72:75]
    v_exp_f32 v19, v123
    v_cvt_pk_bf16_f32 v186, v16, v17
    v_mfma_f32_16x16x32_bf16 v[76:79], v[28:31], a[220:223], v[132:135]
    ds_read_b128 v[44:47], v3 offset:12416
    v_mfma_f32_16x16x32_bf16 v[76:79], v[24:27], a[216:219], v[76:79]
    s_waitcnt lgkmcnt(2)
    buffer_load_dwordx4 v4, s[4:7], s27 offen offset:2048 sc1 lds
    v_mfma_f32_16x16x32_bf16 v[104:107], v[32:35], a[192:195], v[128:131]
    ds_read_b128 v[24:27], v2 offset:18560
    v_mfma_f32_16x16x32_bf16 v[104:107], v[36:39], a[196:199], v[104:107]
    v_exp_f32 v16, v188
    v_add_f32 v5, v5, v18
    v_mfma_f32_16x16x32_bf16 v[108:111], v[36:39], a[220:223], v[132:135]
    ds_read_b128 v[28:31], v3 offset:18560
    v_add_f32 v5, v5, v19
    v_mfma_f32_16x16x32_bf16 v[108:111], v[32:35], a[216:219], v[108:111]
    s_waitcnt lgkmcnt(2)
    v_exp_f32 v17, v189
    v_cvt_pk_bf16_f32 v187, v18, v19
    v_mfma_f32_16x16x32_bf16 v[72:75], v[40:43], a[200:203], v[72:75]
    s_add_u32 s27, s27, 24576
    ds_read_b128 v[32:35], v2 offset:12544
    v_mfma_f32_16x16x32_bf16 v[72:75], v[44:47], a[204:207], v[72:75]
    v_exp_f32 v18, v190
    v_mfma_f32_16x16x32_bf16 v[76:79], v[44:47], a[228:231], v[76:79]
    s_add_u32 s56, s56, 12288
    ds_read_b128 v[36:39], v3 offset:12544
    v_add_f32 v6, v6, v16
    v_mfma_f32_16x16x32_bf16 v[76:79], v[40:43], a[224:227], v[76:79]
    s_waitcnt lgkmcnt(2)
    v_add_f32 v6, v6, v17
    v_mfma_f32_16x16x32_bf16 v[104:107], v[24:27], a[200:203], v[104:107]
    ds_read_b128 v[40:43], v2 offset:18688
    v_mfma_f32_16x16x32_bf16 v[104:107], v[28:31], a[204:207], v[104:107]
    v_exp_f32 v19, v191
    v_cvt_pk_bf16_f32 v188, v16, v17
    v_mfma_f32_16x16x32_bf16 v[108:111], v[28:31], a[228:231], v[108:111]
    s_mov_b32 m0, s56
    ds_read_b128 v[44:47], v3 offset:18688
    v_mfma_f32_16x16x32_bf16 v[108:111], v[24:27], a[224:227], v[108:111]
    s_waitcnt lgkmcnt(2)
    v_add_u32 v2, 49152, v2
    v_add_u32 v3, 49152, v3
    v_mfma_f32_16x16x32_bf16 v[72:75], v[32:35], a[208:211], v[72:75]
    ds_read_b128 v[24:27], v2 offset:0
    v_mfma_f32_16x16x32_bf16 v[72:75], v[36:39], a[212:215], v[72:75]
    buffer_load_dwordx4 v4, s[4:7], s27 offen offset:0 sc1 lds
    v_mfma_f32_16x16x32_bf16 v[76:79], v[36:39], a[236:239], v[76:79]
    ds_read_b128 v[28:31], v3 offset:0
    v_mfma_f32_16x16x32_bf16 v[76:79], v[32:35], a[232:235], v[76:79]
    s_waitcnt lgkmcnt(2)
    v_exp_f32 v16, v124
    v_add_f32 v6, v6, v18
    v_mfma_f32_16x16x32_bf16 v[104:107], v[40:43], a[208:211], v[104:107]
    ds_read_b128 v[32:35], v2 offset:6144
    v_add_f32 v6, v6, v19
    v_mfma_f32_16x16x32_bf16 v[104:107], v[44:47], a[212:215], v[104:107]
    v_exp_f32 v17, v125
    v_cvt_pk_bf16_f32 v189, v18, v19
    v_mfma_f32_16x16x32_bf16 v[108:111], v[44:47], a[236:239], v[108:111]
    ds_read_b128 v[36:39], v3 offset:6144
    v_mfma_f32_16x16x32_bf16 v[108:111], v[40:43], a[232:235], v[108:111]
    s_waitcnt lgkmcnt(2)
    buffer_load_dwordx4 v4, s[4:7], s27 offen offset:1024 sc1 lds
    v_mfma_f32_16x16x32_bf16 v[80:83], v[24:27], a[240:243], v[136:139]
    ds_read_b128 v[40:43], v2 offset:128
    v_mfma_f32_16x16x32_bf16 v[80:83], v[28:31], a[244:247], v[80:83]
    v_exp_f32 v18, v126
    v_add_f32 v6, v6, v16
    v_mfma_f32_16x16x32_bf16 v[84:87], v[28:31], v[204:207], v[140:143]
    ds_read_b128 v[44:47], v3 offset:128
    v_add_f32 v6, v6, v17
    v_exp_f32 v19, v127
    v_cvt_pk_bf16_f32 v190, v16, v17
    v_add_f32 v6, v6, v18
    v_add_f32 v6, v6, v19
    v_cvt_pk_bf16_f32 v191, v18, v19
    v_mfma_f32_16x16x32_bf16 v[84:87], v[24:27], v[200:203], v[84:87]
    s_waitcnt lgkmcnt(2)
    v_exp_f32 v16, v64
    v_mfma_f32_16x16x32_bf16 v[112:115], v[32:35], a[240:243], v[136:139]
    ds_read_b128 v[24:27], v2 offset:6272
    v_mfma_f32_16x16x32_bf16 v[112:115], v[36:39], a[244:247], v[112:115]
    buffer_load_dwordx4 v4, s[4:7], s27 offen offset:2048 sc1 lds
    v_mfma_f32_16x16x32_bf16 v[116:119], v[36:39], v[204:207], v[140:143]
    ds_read_b128 v[28:31], v3 offset:6272
    v_mfma_f32_16x16x32_bf16 v[116:119], v[32:35], v[200:203], v[116:119]
    s_waitcnt lgkmcnt(2)
    v_exp_f32 v17, v65
    v_mfma_f32_16x16x32_bf16 v[80:83], v[40:43], a[248:251], v[80:83]
    ds_read_b128 v[32:35], v2 offset:256
    v_mfma_f32_16x16x32_bf16 v[80:83], v[44:47], a[252:255], v[80:83]
    v_exp_f32 v18, v66
    v_mfma_f32_16x16x32_bf16 v[84:87], v[44:47], v[212:215], v[84:87]
    ds_read_b128 v[36:39], v3 offset:256
    v_add_f32 v5, v5, v16
    v_mfma_f32_16x16x32_bf16 v[84:87], v[40:43], v[208:211], v[84:87]
    s_waitcnt lgkmcnt(2)
    v_add_f32 v5, v5, v17
    v_mfma_f32_16x16x32_bf16 v[112:115], v[24:27], a[248:251], v[112:115]
    ds_read_b128 v[40:43], v2 offset:6400
    v_mfma_f32_16x16x32_bf16 v[112:115], v[28:31], a[252:255], v[112:115]
    v_exp_f32 v19, v67
    v_cvt_pk_bf16_f32 v64, v16, v17
    v_mfma_f32_16x16x32_bf16 v[116:119], v[28:31], v[212:215], v[116:119]
    s_add_u32 s27, s27, 24576
    ds_read_b128 v[44:47], v3 offset:6400
    s_add_u32 s56, s56, 36864
    v_mfma_f32_16x16x32_bf16 v[116:119], v[24:27], v[208:211], v[116:119]
    s_waitcnt lgkmcnt(2)
    v_exp_f32 v16, v96
    v_mfma_f32_16x16x32_bf16 v[80:83], v[32:35], v[192:195], v[80:83]
    s_sub_u32 s58, s56, 147456
    ds_read_b128 v[24:27], v2 offset:12288
    v_add_f32 v5, v5, v18
    v_mfma_f32_16x16x32_bf16 v[80:83], v[36:39], v[196:199], v[80:83]
    s_min_u32 s56, s56, s58
    v_add_f32 v5, v5, v19
    v_mfma_f32_16x16x32_bf16 v[84:87], v[36:39], v[220:223], v[84:87]
    ds_read_b128 v[28:31], v3 offset:12288
    v_mfma_f32_16x16x32_bf16 v[84:87], v[32:35], v[216:219], v[84:87]
    s_waitcnt lgkmcnt(2)
    v_exp_f32 v17, v97
    v_cvt_pk_bf16_f32 v65, v18, v19
    v_mfma_f32_16x16x32_bf16 v[112:115], v[40:43], v[192:195], v[112:115]
    ds_read_b128 v[32:35], v2 offset:18432
    v_mfma_f32_16x16x32_bf16 v[112:115], v[44:47], v[196:199], v[112:115]
    v_exp_f32 v18, v98
    v_mfma_f32_16x16x32_bf16 v[116:119], v[44:47], v[220:223], v[116:119]
    ds_read_b128 v[36:39], v3 offset:18432
    v_add_f32 v5, v5, v16
    v_mfma_f32_16x16x32_bf16 v[116:119], v[40:43], v[216:219], v[116:119]
    s_waitcnt lgkmcnt(2)
    v_add_f32 v5, v5, v17
    v_mfma_f32_16x16x32_bf16 v[88:91], v[24:27], a[240:243], v[136:139]
    ds_read_b128 v[40:43], v2 offset:12416
    v_mfma_f32_16x16x32_bf16 v[88:91], v[28:31], a[244:247], v[88:91]
    v_exp_f32 v19, v99
    v_cvt_pk_bf16_f32 v66, v16, v17
    v_mfma_f32_16x16x32_bf16 v[92:95], v[28:31], v[204:207], v[140:143]
    ds_read_b128 v[44:47], v3 offset:12416
    v_mfma_f32_16x16x32_bf16 v[92:95], v[24:27], v[200:203], v[92:95]
    s_waitcnt lgkmcnt(2)
    v_exp_f32 v16, v68
    v_mfma_f32_16x16x32_bf16 v[120:123], v[32:35], a[240:243], v[136:139]
    ds_read_b128 v[24:27], v2 offset:18560
    v_add_f32 v5, v5, v18
    v_mfma_f32_16x16x32_bf16 v[120:123], v[36:39], a[244:247], v[120:123]
    v_add_f32 v5, v5, v19
    v_mfma_f32_16x16x32_bf16 v[124:127], v[36:39], v[204:207], v[140:143]
    ds_read_b128 v[28:31], v3 offset:18560
    v_mfma_f32_16x16x32_bf16 v[124:127], v[32:35], v[200:203], v[124:127]
    s_waitcnt lgkmcnt(2)
    v_exp_f32 v17, v69
    v_cvt_pk_bf16_f32 v67, v18, v19
    v_mfma_f32_16x16x32_bf16 v[88:91], v[40:43], a[248:251], v[88:91]
    ds_read_b128 v[32:35], v2 offset:12544
    v_mfma_f32_16x16x32_bf16 v[88:91], v[44:47], a[252:255], v[88:91]
    v_exp_f32 v18, v70
    v_mfma_f32_16x16x32_bf16 v[92:95], v[44:47], v[212:215], v[92:95]
    ds_read_b128 v[36:39], v3 offset:12544
    v_add_f32 v6, v6, v16
    v_mfma_f32_16x16x32_bf16 v[92:95], v[40:43], v[208:211], v[92:95]
    s_waitcnt lgkmcnt(2)
    v_add_f32 v6, v6, v17
    v_mfma_f32_16x16x32_bf16 v[120:123], v[24:27], a[248:251], v[120:123]
    ds_read_b128 v[40:43], v2 offset:18688
    v_mfma_f32_16x16x32_bf16 v[120:123], v[28:31], a[252:255], v[120:123]
    v_exp_f32 v19, v71
    v_cvt_pk_bf16_f32 v68, v16, v17
    v_mfma_f32_16x16x32_bf16 v[124:127], v[28:31], v[212:215], v[124:127]
    ds_read_b128 v[44:47], v3 offset:18688
    v_mfma_f32_16x16x32_bf16 v[124:127], v[24:27], v[208:211], v[124:127]
    s_waitcnt lgkmcnt(2)
    v_add_u32 v1, 49152, v1
    v_exp_f32 v16, v100
    v_mfma_f32_16x16x32_bf16 v[88:91], v[32:35], v[192:195], v[88:91]
    ds_read_b128 v[24:27], v1 offset:0
    v_add_f32 v6, v6, v18
    v_mfma_f32_16x16x32_bf16 v[88:91], v[36:39], v[196:199], v[88:91]
    v_add_f32 v6, v6, v19
    v_mfma_f32_16x16x32_bf16 v[92:95], v[36:39], v[220:223], v[92:95]
    ds_read_b128 v[28:31], v1 offset:12288
    v_mfma_f32_16x16x32_bf16 v[92:95], v[32:35], v[216:219], v[92:95]
    s_waitcnt lgkmcnt(2)
    v_exp_f32 v17, v101
    v_cvt_pk_bf16_f32 v69, v18, v19
    v_mfma_f32_16x16x32_bf16 v[120:123], v[40:43], v[192:195], v[120:123]
    ds_read_b128 v[32:35], v1 offset:1024
    v_mfma_f32_16x16x32_bf16 v[120:123], v[44:47], v[196:199], v[120:123]
    v_exp_f32 v18, v102
    v_mfma_f32_16x16x32_bf16 v[124:127], v[44:47], v[220:223], v[124:127]
    ds_read_b128 v[36:39], v1 offset:13312
    v_add_f32 v6, v6, v16
    v_mfma_f32_16x16x32_bf16 v[124:127], v[40:43], v[216:219], v[124:127]
    s_waitcnt lgkmcnt(2)
    v_add_f32 v6, v6, v17
    v_exp_f32 v19, v103
    v_cvt_pk_bf16_f32 v70, v16, v17
    v_add_f32 v6, v6, v18
    v_add_f32 v6, v6, v19
    v_cvt_pk_bf16_f32 v71, v18, v19
    v_mfma_f32_16x16x32_bf16 a[0:3], v[160:163], v[24:27], a[0:3]
    ds_read_b128 v[40:43], v1 offset:2048
    v_mfma_f32_16x16x32_bf16 a[0:3], v[168:171], v[28:31], a[0:3]
    v_exp_f32 v16, v72
    v_mfma_f32_16x16x32_bf16 a[48:51], v[172:175], v[28:31], a[48:51]
    ds_read_b128 v[44:47], v1 offset:14336
    v_mfma_f32_16x16x32_bf16 a[48:51], v[164:167], v[24:27], a[48:51]
    s_waitcnt lgkmcnt(2)
    v_exp_f32 v17, v73
    v_mfma_f32_16x16x32_bf16 a[4:7], v[160:163], v[32:35], a[4:7]
    ds_read_b128 v[24:27], v1 offset:3072
    v_mfma_f32_16x16x32_bf16 a[4:7], v[168:171], v[36:39], a[4:7]
    v_exp_f32 v18, v74
    v_mfma_f32_16x16x32_bf16 a[52:55], v[172:175], v[36:39], a[52:55]
    ds_read_b128 v[28:31], v1 offset:15360
    v_add_f32 v5, v5, v16
    v_mfma_f32_16x16x32_bf16 a[52:55], v[164:167], v[32:35], a[52:55]
    s_waitcnt lgkmcnt(2)
    v_add_f32 v5, v5, v17
    v_mfma_f32_16x16x32_bf16 a[8:11], v[160:163], v[40:43], a[8:11]
    ds_read_b128 v[32:35], v1 offset:4096
    v_mfma_f32_16x16x32_bf16 a[8:11], v[168:171], v[44:47], a[8:11]
    v_exp_f32 v19, v75
    v_mfma_f32_16x16x32_bf16 a[56:59], v[172:175], v[44:47], a[56:59]
    ds_read_b128 v[36:39], v1 offset:16384
    v_cvt_pk_bf16_f32 v72, v16, v17
    v_mfma_f32_16x16x32_bf16 a[56:59], v[164:167], v[40:43], a[56:59]
    s_waitcnt lgkmcnt(2)
    v_exp_f32 v16, v104
    v_mfma_f32_16x16x32_bf16 a[12:15], v[160:163], v[24:27], a[12:15]
    ds_read_b128 v[40:43], v1 offset:5120
    v_add_f32 v5, v5, v18
    v_mfma_f32_16x16x32_bf16 a[12:15], v[168:171], v[28:31], a[12:15]
    v_add_f32 v5, v5, v19
    v_mfma_f32_16x16x32_bf16 a[60:63], v[172:175], v[28:31], a[60:63]
    ds_read_b128 v[44:47], v1 offset:17408
    v_mfma_f32_16x16x32_bf16 a[60:63], v[164:167], v[24:27], a[60:63]
    s_waitcnt lgkmcnt(2)
    v_exp_f32 v17, v105
    v_mfma_f32_16x16x32_bf16 a[16:19], v[160:163], v[32:35], a[16:19]
    ds_read_b128 v[24:27], v1 offset:6144
    v_cvt_pk_bf16_f32 v73, v18, v19
    v_mfma_f32_16x16x32_bf16 a[16:19], v[168:171], v[36:39], a[16:19]
    v_exp_f32 v18, v106
    v_mfma_f32_16x16x32_bf16 a[64:67], v[172:175], v[36:39], a[64:67]
    ds_read_b128 v[28:31], v1 offset:18432
    v_add_f32 v5, v5, v16
    v_mfma_f32_16x16x32_bf16 a[64:67], v[164:167], v[32:35], a[64:67]
    s_waitcnt lgkmcnt(2)
    v_add_f32 v5, v5, v17
    v_mfma_f32_16x16x32_bf16 a[20:23], v[160:163], v[40:43], a[20:23]
    ds_read_b128 v[32:35], v1 offset:7168
    v_mfma_f32_16x16x32_bf16 a[20:23], v[168:171], v[44:47], a[20:23]
    v_exp_f32 v19, v107
    v_mfma_f32_16x16x32_bf16 a[68:71], v[172:175], v[44:47], a[68:71]
    ds_read_b128 v[36:39], v1 offset:19456
    v_cvt_pk_bf16_f32 v74, v16, v17
    v_mfma_f32_16x16x32_bf16 a[68:71], v[164:167], v[40:43], a[68:71]
    s_waitcnt lgkmcnt(2)
    v_exp_f32 v16, v76
    v_mfma_f32_16x16x32_bf16 a[24:27], v[160:163], v[24:27], a[24:27]
    ds_read_b128 v[40:43], v1 offset:8192
    v_add_f32 v5, v5, v18
    v_mfma_f32_16x16x32_bf16 a[24:27], v[168:171], v[28:31], a[24:27]
    v_add_f32 v5, v5, v19
    v_mfma_f32_16x16x32_bf16 a[72:75], v[172:175], v[28:31], a[72:75]
    ds_read_b128 v[44:47], v1 offset:20480
    v_mfma_f32_16x16x32_bf16 a[72:75], v[164:167], v[24:27], a[72:75]
    s_waitcnt lgkmcnt(2)
    v_exp_f32 v17, v77
    v_mfma_f32_16x16x32_bf16 a[28:31], v[160:163], v[32:35], a[28:31]
    ds_read_b128 v[24:27], v1 offset:9216
    v_cvt_pk_bf16_f32 v75, v18, v19
    v_mfma_f32_16x16x32_bf16 a[28:31], v[168:171], v[36:39], a[28:31]
    v_exp_f32 v18, v78
    v_mfma_f32_16x16x32_bf16 a[76:79], v[172:175], v[36:39], a[76:79]
    ds_read_b128 v[28:31], v1 offset:21504
    v_add_f32 v6, v6, v16
    v_mfma_f32_16x16x32_bf16 a[76:79], v[164:167], v[32:35], a[76:79]
    s_waitcnt lgkmcnt(2)
    v_add_f32 v6, v6, v17
    v_mfma_f32_16x16x32_bf16 a[32:35], v[160:163], v[40:43], a[32:35]
    ds_read_b128 v[32:35], v1 offset:10240
    v_mfma_f32_16x16x32_bf16 a[32:35], v[168:171], v[44:47], a[32:35]
    v_exp_f32 v19, v79
    v_mfma_f32_16x16x32_bf16 a[80:83], v[172:175], v[44:47], a[80:83]
    ds_read_b128 v[36:39], v1 offset:22528
    v_cvt_pk_bf16_f32 v76, v16, v17
    v_mfma_f32_16x16x32_bf16 a[80:83], v[164:167], v[40:43], a[80:83]
    s_waitcnt lgkmcnt(2)
    v_exp_f32 v16, v108
    v_mfma_f32_16x16x32_bf16 a[36:39], v[160:163], v[24:27], a[36:39]
    ds_read_b128 v[40:43], v1 offset:11264
    v_add_f32 v6, v6, v18
    v_mfma_f32_16x16x32_bf16 a[36:39], v[168:171], v[28:31], a[36:39]
    v_add_f32 v6, v6, v19
    v_mfma_f32_16x16x32_bf16 a[84:87], v[172:175], v[28:31], a[84:87]
    ds_read_b128 v[44:47], v1 offset:23552
    v_mfma_f32_16x16x32_bf16 a[84:87], v[164:167], v[24:27], a[84:87]
    s_waitcnt lgkmcnt(2)
    v_subrev_u32 v1, 98304, v1
    v_mfma_f32_16x16x32_bf16 a[40:43], v[160:163], v[32:35], a[40:43]
    ds_read_b128 v[24:27], v1 offset:0
    v_mfma_f32_16x16x32_bf16 a[40:43], v[168:171], v[36:39], a[40:43]
    v_exp_f32 v17, v109
    v_mfma_f32_16x16x32_bf16 a[88:91], v[172:175], v[36:39], a[88:91]
    ds_read_b128 v[28:31], v1 offset:12288
    v_cvt_pk_bf16_f32 v77, v18, v19
    v_mfma_f32_16x16x32_bf16 a[88:91], v[164:167], v[32:35], a[88:91]
    s_waitcnt lgkmcnt(2)
    v_exp_f32 v18, v110
    v_mfma_f32_16x16x32_bf16 a[44:47], v[160:163], v[40:43], a[44:47]
    ds_read_b128 v[32:35], v1 offset:1024
    v_add_f32 v6, v6, v16
    v_mfma_f32_16x16x32_bf16 a[44:47], v[168:171], v[44:47], a[44:47]
    v_add_f32 v6, v6, v17
    v_mfma_f32_16x16x32_bf16 a[92:95], v[172:175], v[44:47], a[92:95]
    ds_read_b128 v[36:39], v1 offset:13312
    v_mfma_f32_16x16x32_bf16 a[92:95], v[164:167], v[40:43], a[92:95]
    s_waitcnt lgkmcnt(2)
    v_exp_f32 v19, v111
    v_mfma_f32_16x16x32_bf16 a[0:3], v[176:179], v[24:27], a[0:3]
    ds_read_b128 v[40:43], v1 offset:2048
    v_cvt_pk_bf16_f32 v78, v16, v17
    v_mfma_f32_16x16x32_bf16 a[0:3], v[184:187], v[28:31], a[0:3]
    v_add_f32 v6, v6, v18
    v_add_f32 v6, v6, v19
    v_mfma_f32_16x16x32_bf16 a[48:51], v[188:191], v[28:31], a[48:51]
    ds_read_b128 v[44:47], v1 offset:14336
    v_cvt_pk_bf16_f32 v79, v18, v19
    v_mfma_f32_16x16x32_bf16 a[48:51], v[180:183], v[24:27], a[48:51]
    s_waitcnt lgkmcnt(2)
    v_exp_f32 v16, v80
    v_mfma_f32_16x16x32_bf16 a[4:7], v[176:179], v[32:35], a[4:7]
    ds_read_b128 v[24:27], v1 offset:3072
    v_mfma_f32_16x16x32_bf16 a[4:7], v[184:187], v[36:39], a[4:7]
    v_exp_f32 v17, v81
    v_mfma_f32_16x16x32_bf16 a[52:55], v[188:191], v[36:39], a[52:55]
    ds_read_b128 v[28:31], v1 offset:15360
    v_mfma_f32_16x16x32_bf16 a[52:55], v[180:183], v[32:35], a[52:55]
    s_waitcnt lgkmcnt(2)
    v_exp_f32 v18, v82
    v_mfma_f32_16x16x32_bf16 a[8:11], v[176:179], v[40:43], a[8:11]
    ds_read_b128 v[32:35], v1 offset:4096
    v_add_f32 v7, v7, v16
    v_mfma_f32_16x16x32_bf16 a[8:11], v[184:187], v[44:47], a[8:11]
    v_add_f32 v7, v7, v17
    v_mfma_f32_16x16x32_bf16 a[56:59], v[188:191], v[44:47], a[56:59]
    ds_read_b128 v[36:39], v1 offset:16384
    v_mfma_f32_16x16x32_bf16 a[56:59], v[180:183], v[40:43], a[56:59]
    s_waitcnt lgkmcnt(2)
    v_exp_f32 v19, v83
    v_mfma_f32_16x16x32_bf16 a[12:15], v[176:179], v[24:27], a[12:15]
    ds_read_b128 v[40:43], v1 offset:5120
    v_cvt_pk_bf16_f32 v80, v16, v17
    v_mfma_f32_16x16x32_bf16 a[12:15], v[184:187], v[28:31], a[12:15]
    v_exp_f32 v16, v112
    v_mfma_f32_16x16x32_bf16 a[60:63], v[188:191], v[28:31], a[60:63]
    ds_read_b128 v[44:47], v1 offset:17408
    v_add_f32 v7, v7, v18
    v_mfma_f32_16x16x32_bf16 a[60:63], v[180:183], v[24:27], a[60:63]
    s_waitcnt lgkmcnt(2)
    v_add_f32 v7, v7, v19
    v_mfma_f32_16x16x32_bf16 a[16:19], v[176:179], v[32:35], a[16:19]
    ds_read_b128 v[24:27], v1 offset:6144
    v_mfma_f32_16x16x32_bf16 a[16:19], v[184:187], v[36:39], a[16:19]
    v_exp_f32 v17, v113
    v_mfma_f32_16x16x32_bf16 a[64:67], v[188:191], v[36:39], a[64:67]
    ds_read_b128 v[28:31], v1 offset:18432
    v_cvt_pk_bf16_f32 v81, v18, v19
    v_mfma_f32_16x16x32_bf16 a[64:67], v[180:183], v[32:35], a[64:67]
    s_waitcnt lgkmcnt(2)
    v_exp_f32 v18, v114
    v_mfma_f32_16x16x32_bf16 a[20:23], v[176:179], v[40:43], a[20:23]
    ds_read_b128 v[32:35], v1 offset:7168
    v_add_f32 v7, v7, v16
    v_mfma_f32_16x16x32_bf16 a[20:23], v[184:187], v[44:47], a[20:23]
    v_add_f32 v7, v7, v17
    v_mfma_f32_16x16x32_bf16 a[68:71], v[188:191], v[44:47], a[68:71]
    ds_read_b128 v[36:39], v1 offset:19456
    v_mfma_f32_16x16x32_bf16 a[68:71], v[180:183], v[40:43], a[68:71]
    s_waitcnt lgkmcnt(2)
    v_exp_f32 v19, v115
    v_mfma_f32_16x16x32_bf16 a[24:27], v[176:179], v[24:27], a[24:27]
    ds_read_b128 v[40:43], v1 offset:8192
    v_cvt_pk_bf16_f32 v82, v16, v17
    v_mfma_f32_16x16x32_bf16 a[24:27], v[184:187], v[28:31], a[24:27]
    v_exp_f32 v16, v84
    v_mfma_f32_16x16x32_bf16 a[72:75], v[188:191], v[28:31], a[72:75]
    ds_read_b128 v[44:47], v1 offset:20480
    v_add_f32 v7, v7, v18
    v_mfma_f32_16x16x32_bf16 a[72:75], v[180:183], v[24:27], a[72:75]
    s_waitcnt lgkmcnt(2)
    v_add_f32 v7, v7, v19
    v_mfma_f32_16x16x32_bf16 a[28:31], v[176:179], v[32:35], a[28:31]
    ds_read_b128 v[24:27], v1 offset:9216
    v_mfma_f32_16x16x32_bf16 a[28:31], v[184:187], v[36:39], a[28:31]
    s_waitcnt vmcnt(0)
    v_exp_f32 v17, v85
    v_mfma_f32_16x16x32_bf16 a[76:79], v[188:191], v[36:39], a[76:79]
    ds_read_b128 v[28:31], v1 offset:21504
    v_cvt_pk_bf16_f32 v83, v18, v19
    v_mfma_f32_16x16x32_bf16 a[76:79], v[180:183], v[32:35], a[76:79]
    s_waitcnt lgkmcnt(2)
    s_barrier
    v_mfma_f32_16x16x32_bf16 a[32:35], v[176:179], v[40:43], a[32:35]
    ds_read_b128 v[32:35], v1 offset:10240
    v_mfma_f32_16x16x32_bf16 a[32:35], v[184:187], v[44:47], a[32:35]
    v_exp_f32 v18, v86
    v_mfma_f32_16x16x32_bf16 a[80:83], v[188:191], v[44:47], a[80:83]
    ds_read_b128 v[36:39], v1 offset:22528
    v_add_f32 v8, v8, v16
    v_mfma_f32_16x16x32_bf16 a[80:83], v[180:183], v[40:43], a[80:83]
    s_waitcnt lgkmcnt(2)
    v_add_f32 v8, v8, v17
    v_mfma_f32_16x16x32_bf16 a[36:39], v[176:179], v[24:27], a[36:39]
    ds_read_b128 v[40:43], v1 offset:11264
    v_mfma_f32_16x16x32_bf16 a[36:39], v[184:187], v[28:31], a[36:39]
    v_exp_f32 v19, v87
    v_cvt_pk_bf16_f32 v84, v16, v17
    v_mfma_f32_16x16x32_bf16 a[84:87], v[188:191], v[28:31], a[84:87]
    ds_read_b128 v[44:47], v1 offset:23552
    v_mfma_f32_16x16x32_bf16 a[84:87], v[180:183], v[24:27], a[84:87]
    s_waitcnt lgkmcnt(2)
    v_add_u32 v1, 49152, v1
    v_exp_f32 v16, v116
    v_mfma_f32_16x16x32_bf16 a[40:43], v[176:179], v[32:35], a[40:43]
    ds_read_b128 v[24:27], v1 offset:0
    v_add_f32 v8, v8, v18
    v_mfma_f32_16x16x32_bf16 a[40:43], v[184:187], v[36:39], a[40:43]
    v_add_f32 v8, v8, v19
    v_mfma_f32_16x16x32_bf16 a[88:91], v[188:191], v[36:39], a[88:91]
    ds_read_b128 v[28:31], v1 offset:12288
    v_mfma_f32_16x16x32_bf16 a[88:91], v[180:183], v[32:35], a[88:91]
    s_waitcnt lgkmcnt(2)
    v_exp_f32 v17, v117
    v_cvt_pk_bf16_f32 v85, v18, v19
    v_mfma_f32_16x16x32_bf16 a[44:47], v[176:179], v[40:43], a[44:47]
    ds_read_b128 v[32:35], v1 offset:1024
    v_mfma_f32_16x16x32_bf16 a[44:47], v[184:187], v[44:47], a[44:47]
    v_exp_f32 v18, v118
    v_mfma_f32_16x16x32_bf16 a[92:95], v[188:191], v[44:47], a[92:95]
    ds_read_b128 v[36:39], v1 offset:13312
    v_add_f32 v8, v8, v16
    v_mfma_f32_16x16x32_bf16 a[92:95], v[180:183], v[40:43], a[92:95]
    s_waitcnt lgkmcnt(2)
    v_add_f32 v8, v8, v17
    v_exp_f32 v19, v119
    v_cvt_pk_bf16_f32 v86, v16, v17
    v_add_f32 v8, v8, v18
    v_add_f32 v8, v8, v19
    v_cvt_pk_bf16_f32 v87, v18, v19
    v_mfma_f32_16x16x32_bf16 a[0:3], v[64:67], v[24:27], a[0:3]
    ds_read_b128 v[40:43], v1 offset:2048
    v_mfma_f32_16x16x32_bf16 a[0:3], v[72:75], v[28:31], a[0:3]
    v_exp_f32 v16, v88
    v_exp_f32 v17, v89
    v_exp_f32 v18, v90
    v_mfma_f32_16x16x4_f32 v[48:51], v5, v57, 0
    v_mfma_f32_16x16x32_bf16 a[48:51], v[76:79], v[28:31], a[48:51]
    ds_read_b128 v[44:47], v1 offset:14336
    v_mfma_f32_16x16x32_bf16 a[48:51], v[68:71], v[24:27], a[48:51]
    s_waitcnt lgkmcnt(2)
    v_exp_f32 v19, v91
    v_cvt_pk_bf16_f32 v88, v16, v17
    v_exp_f32 v16, v120
    v_mfma_f32_16x16x4_f32 v[52:55], v6, v57, 0
    v_mfma_f32_16x16x32_bf16 a[4:7], v[64:67], v[32:35], a[4:7]
    ds_read_b128 v[24:27], v1 offset:3072
    v_mfma_f32_16x16x32_bf16 a[4:7], v[72:75], v[36:39], a[4:7]
    v_exp_f32 v17, v121
    v_cvt_pk_bf16_f32 v89, v18, v19
    v_mfma_f32_16x16x32_bf16 a[52:55], v[76:79], v[36:39], a[52:55]
    ds_read_b128 v[28:31], v1 offset:15360
    v_mfma_f32_16x16x32_bf16 a[52:55], v[68:71], v[32:35], a[52:55]
    s_waitcnt lgkmcnt(2)
    v_exp_f32 v18, v122
    v_mfma_f32_16x16x32_bf16 a[8:11], v[64:67], v[40:43], a[8:11]
    ds_read_b128 v[32:35], v1 offset:4096
    v_mfma_f32_16x16x32_bf16 a[8:11], v[72:75], v[44:47], a[8:11]
    v_exp_f32 v19, v123
    v_mfma_f32_16x16x32_bf16 a[56:59], v[76:79], v[44:47], a[56:59]
    ds_read_b128 v[36:39], v1 offset:16384
    v_cvt_pk_bf16_f32 v90, v16, v17
    v_mfma_f32_16x16x32_bf16 a[56:59], v[68:71], v[40:43], a[56:59]
    s_waitcnt lgkmcnt(2)
    v_exp_f32 v16, v92
    v_mfma_f32_16x16x32_bf16 a[12:15], v[64:67], v[24:27], a[12:15]
    ds_read_b128 v[40:43], v1 offset:5120
    v_mfma_f32_16x16x32_bf16 a[12:15], v[72:75], v[28:31], a[12:15]
    v_exp_f32 v17, v93
    v_mfma_f32_16x16x32_bf16 a[60:63], v[76:79], v[28:31], a[60:63]
    ds_read_b128 v[44:47], v1 offset:17408
    v_cvt_pk_bf16_f32 v91, v18, v19
    v_mfma_f32_16x16x32_bf16 a[60:63], v[68:71], v[24:27], a[60:63]
    s_waitcnt lgkmcnt(2)
    v_exp_f32 v18, v94
    v_mfma_f32_16x16x32_bf16 a[16:19], v[64:67], v[32:35], a[16:19]
    ds_read_b128 v[24:27], v1 offset:6144
    v_mfma_f32_16x16x32_bf16 a[16:19], v[72:75], v[36:39], a[16:19]
    v_exp_f32 v19, v95
    v_mfma_f32_16x16x32_bf16 a[64:67], v[76:79], v[36:39], a[64:67]
    ds_read_b128 v[28:31], v1 offset:18432
    v_mfma_f32_16x16x32_bf16 a[64:67], v[68:71], v[32:35], a[64:67]
    s_waitcnt lgkmcnt(2)
    v_mfma_f32_16x16x32_bf16 v[128:131], v[88:91], v[20:23], 0
    v_mfma_f32_16x16x32_bf16 a[20:23], v[64:67], v[40:43], a[20:23]
    ds_read_b128 v[32:35], v1 offset:7168
    v_cvt_pk_bf16_f32 v92, v16, v17
    v_mfma_f32_16x16x32_bf16 a[20:23], v[72:75], v[44:47], a[20:23]
    v_exp_f32 v16, v124
    v_mfma_f32_16x16x32_bf16 a[68:71], v[76:79], v[44:47], a[68:71]
    ds_read_b128 v[36:39], v1 offset:19456
    v_mfma_f32_16x16x32_bf16 a[68:71], v[68:71], v[40:43], a[68:71]
    s_waitcnt lgkmcnt(2)
    v_exp_f32 v17, v125
    v_mfma_f32_16x16x32_bf16 a[24:27], v[64:67], v[24:27], a[24:27]
    ds_read_b128 v[40:43], v1 offset:8192
    v_cvt_pk_bf16_f32 v93, v18, v19
    v_mfma_f32_16x16x32_bf16 a[24:27], v[72:75], v[28:31], a[24:27]
L_pg12:
    s_cbranch_execz L_iwret
    v_exp_f32 v18, v126
    v_mfma_f32_16x16x32_bf16 a[72:75], v[76:79], v[28:31], a[72:75]
    ds_read_b128 v[44:47], v1 offset:20480
    v_mfma_f32_16x16x32_bf16 a[72:75], v[68:71], v[24:27], a[72:75]
    s_waitcnt lgkmcnt(2)
    v_exp_f32 v19, v127
    v_mfma_f32_16x16x32_bf16 a[28:31], v[64:67], v[32:35], a[28:31]
    ds_read_b128 v[24:27], v1 offset:9216
    v_cvt_pk_bf16_f32 v94, v16, v17
    v_mfma_f32_16x16x32_bf16 a[28:31], v[72:75], v[36:39], a[28:31]
    v_cvt_pk_bf16_f32 v95, v18, v19
    s_nop 1
    v_mfma_f32_16x16x32_bf16 a[76:79], v[76:79], v[36:39], a[76:79]
    ds_read_b128 v[28:31], v1 offset:21504
    v_mfma_f32_16x16x32_bf16 a[76:79], v[68:71], v[32:35], a[76:79]
    s_waitcnt lgkmcnt(2)
    v_mfma_f32_16x16x32_bf16 v[132:135], v[92:95], v[20:23], 0
    v_mfma_f32_16x16x32_bf16 a[32:35], v[64:67], v[40:43], a[32:35]
    ds_read_b128 v[32:35], v1 offset:10240
    v_mfma_f32_16x16x32_bf16 a[32:35], v[72:75], v[44:47], a[32:35]
    v_rcp_f32 v48, v48
    v_mfma_f32_16x16x32_bf16 a[80:83], v[76:79], v[44:47], a[80:83]
    ds_read_b128 v[36:39], v1 offset:22528
    v_mfma_f32_16x16x32_bf16 a[80:83], v[68:71], v[40:43], a[80:83]
    s_waitcnt lgkmcnt(2)
    v_rcp_f32 v49, v49
    v_mfma_f32_16x16x32_bf16 a[36:39], v[64:67], v[24:27], a[36:39]
    ds_read_b128 v[40:43], v1 offset:11264
    v_mfma_f32_16x16x32_bf16 a[36:39], v[72:75], v[28:31], a[36:39]
    v_rcp_f32 v50, v50
    v_mfma_f32_16x16x32_bf16 a[84:87], v[76:79], v[28:31], a[84:87]
    ds_read_b128 v[44:47], v1 offset:23552
    v_mfma_f32_16x16x32_bf16 a[84:87], v[68:71], v[24:27], a[84:87]
    s_waitcnt lgkmcnt(2)
    v_subrev_u32 v2, 98304, v2
    v_subrev_u32 v3, 98304, v3
    v_mfma_f32_16x16x32_bf16 a[40:43], v[64:67], v[32:35], a[40:43]
    ds_read_b128 v[24:27], v2 offset:0
    v_mfma_f32_16x16x32_bf16 a[40:43], v[72:75], v[36:39], a[40:43]
    v_rcp_f32 v51, v51
    v_mfma_f32_16x16x32_bf16 a[88:91], v[76:79], v[36:39], a[88:91]
    ds_read_b128 v[28:31], v3 offset:0
    v_mfma_f32_16x16x32_bf16 a[88:91], v[68:71], v[32:35], a[88:91]
    s_waitcnt lgkmcnt(2)
    v_rcp_f32 v52, v52
    v_mfma_f32_16x16x32_bf16 a[44:47], v[64:67], v[40:43], a[44:47]
    ds_read_b128 v[32:35], v2 offset:6144
    v_mfma_f32_16x16x32_bf16 a[44:47], v[72:75], v[44:47], a[44:47]
    v_rcp_f32 v53, v53
    v_mfma_f32_16x16x32_bf16 a[92:95], v[76:79], v[44:47], a[92:95]
    ds_read_b128 v[36:39], v3 offset:6144
    v_mfma_f32_16x16x32_bf16 a[92:95], v[68:71], v[40:43], a[92:95]
    s_waitcnt lgkmcnt(2)
    v_rcp_f32 v54, v54
    v_mfma_f32_16x16x32_bf16 v[160:163], v[24:27], a[240:243], v[136:139]
    ds_read_b128 v[40:43], v2 offset:128
    v_mfma_f32_16x16x32_bf16 v[160:163], v[28:31], a[244:247], v[160:163]
    v_rcp_f32 v55, v55
    v_mfma_f32_16x16x32_bf16 v[164:167], v[28:31], v[204:207], v[140:143]
    ds_read_b128 v[44:47], v3 offset:128
    v_mfma_f32_16x16x32_bf16 v[164:167], v[24:27], v[200:203], v[164:167]
    s_waitcnt lgkmcnt(2)
    v_mfma_f32_16x16x32_bf16 v[96:99], v[32:35], a[240:243], v[136:139]
    ds_read_b128 v[24:27], v2 offset:6272
    v_accvgpr_read_b32 v224, a0
    v_mfma_f32_16x16x32_bf16 v[96:99], v[36:39], a[244:247], v[96:99]
    v_accvgpr_read_b32 v225, a4
    v_accvgpr_read_b32 v226, a8
    v_accvgpr_read_b32 v227, a12
    v_accvgpr_read_b32 v228, a16
    v_accvgpr_read_b32 v229, a20
    v_mfma_f32_16x16x32_bf16 v[100:103], v[36:39], v[204:207], v[140:143]
    ds_read_b128 v[28:31], v3 offset:6272
    v_mul_f32 v224, v224, v48
    v_mfma_f32_16x16x32_bf16 v[100:103], v[32:35], v[200:203], v[100:103]
    s_waitcnt lgkmcnt(2)
    v_mul_f32 v225, v225, v48
    v_mul_f32 v226, v226, v48
    v_mul_f32 v227, v227, v48
    v_mul_f32 v228, v228, v48
    v_mul_f32 v229, v229, v48
    v_mfma_f32_16x16x32_bf16 v[160:163], v[40:43], a[248:251], v[160:163]
    ds_read_b128 v[32:35], v2 offset:256
    v_cvt_pk_bf16_f32 v224, v224, v225
    v_mfma_f32_16x16x32_bf16 v[160:163], v[44:47], a[252:255], v[160:163]
    v_cvt_pk_bf16_f32 v225, v226, v227
    v_cvt_pk_bf16_f32 v226, v228, v229
    v_accvgpr_read_b32 v230, a1
    v_accvgpr_read_b32 v231, a5
    v_accvgpr_read_b32 v232, a9
    v_mfma_f32_16x16x32_bf16 v[164:167], v[44:47], v[212:215], v[164:167]
    ds_read_b128 v[36:39], v3 offset:256
    v_accvgpr_read_b32 v233, a13
    v_mfma_f32_16x16x32_bf16 v[164:167], v[40:43], v[208:211], v[164:167]
    s_waitcnt lgkmcnt(2)
    buffer_store_dwordx3 v[224:226], v56, s[12:15], s24 offen offset:0 sc0 sc1
    v_accvgpr_read_b32 v234, a17
    v_accvgpr_read_b32 v235, a21
    v_mfma_f32_16x16x32_bf16 v[96:99], v[24:27], a[248:251], v[96:99]
    ds_read_b128 v[40:43], v2 offset:6400
    v_mul_f32 v230, v230, v49
    v_mfma_f32_16x16x32_bf16 v[96:99], v[28:31], a[252:255], v[96:99]
    v_mul_f32 v231, v231, v49
    v_mul_f32 v232, v232, v49
    v_mul_f32 v233, v233, v49
    v_mul_f32 v234, v234, v49
    v_mul_f32 v235, v235, v49
    v_mfma_f32_16x16x32_bf16 v[100:103], v[28:31], v[212:215], v[100:103]
    ds_read_b128 v[44:47], v3 offset:6400
    v_cvt_pk_bf16_f32 v230, v230, v231
    v_mfma_f32_16x16x32_bf16 v[100:103], v[24:27], v[208:211], v[100:103]
    s_waitcnt lgkmcnt(2)
    v_cvt_pk_bf16_f32 v231, v232, v233
    v_cvt_pk_bf16_f32 v232, v234, v235
    v_accvgpr_read_b32 v236, a2
    v_accvgpr_read_b32 v237, a6
    v_accvgpr_read_b32 v238, a10
    v_mfma_f32_16x16x32_bf16 v[160:163], v[32:35], v[192:195], v[160:163]
    ds_read_b128 v[24:27], v2 offset:12288
    v_accvgpr_read_b32 v239, a14
    v_mfma_f32_16x16x32_bf16 v[160:163], v[36:39], v[196:199], v[160:163]
    buffer_store_dwordx3 v[230:232], v56, s[12:15], s24 offen offset:384 sc0 sc1
    v_accvgpr_read_b32 v240, a18
    v_accvgpr_read_b32 v241, a22
    v_mfma_f32_16x16x32_bf16 v[164:167], v[36:39], v[220:223], v[164:167]
    ds_read_b128 v[28:31], v3 offset:12288
    v_mul_f32 v236, v236, v50
    v_mfma_f32_16x16x32_bf16 v[164:167], v[32:35], v[216:219], v[164:167]
    s_waitcnt lgkmcnt(2)
    v_mul_f32 v237, v237, v50
    v_mul_f32 v238, v238, v50
    v_mul_f32 v239, v239, v50
    v_mul_f32 v240, v240, v50
    v_mul_f32 v241, v241, v50
    v_mfma_f32_16x16x32_bf16 v[96:99], v[40:43], v[192:195], v[96:99]
    ds_read_b128 v[32:35], v2 offset:18432
    v_cvt_pk_bf16_f32 v236, v236, v237
    v_mfma_f32_16x16x32_bf16 v[96:99], v[44:47], v[196:199], v[96:99]
    v_cvt_pk_bf16_f32 v237, v238, v239
    v_cvt_pk_bf16_f32 v238, v240, v241
    v_accvgpr_read_b32 v242, a3
    v_accvgpr_read_b32 v243, a7
    v_accvgpr_read_b32 v244, a11
    v_mfma_f32_16x16x32_bf16 v[100:103], v[44:47], v[220:223], v[100:103]
    ds_read_b128 v[36:39], v3 offset:18432
    v_accvgpr_read_b32 v245, a15
    v_mfma_f32_16x16x32_bf16 v[100:103], v[40:43], v[216:219], v[100:103]
    s_waitcnt lgkmcnt(2)
    buffer_store_dwordx3 v[236:238], v56, s[12:15], s24 offen offset:768 sc0 sc1
    v_accvgpr_read_b32 v246, a19
    v_accvgpr_read_b32 v247, a23
    v_mfma_f32_16x16x32_bf16 v[168:171], v[24:27], a[240:243], v[136:139]
    ds_read_b128 v[40:43], v2 offset:12416
    v_mul_f32 v242, v242, v51
    v_mfma_f32_16x16x32_bf16 v[168:171], v[28:31], a[244:247], v[168:171]
    v_mul_f32 v243, v243, v51
    v_mul_f32 v244, v244, v51
    v_mul_f32 v245, v245, v51
    v_mul_f32 v246, v246, v51
    v_mul_f32 v247, v247, v51
    v_mfma_f32_16x16x32_bf16 v[172:175], v[28:31], v[204:207], v[140:143]
    ds_read_b128 v[44:47], v3 offset:12416
    v_cvt_pk_bf16_f32 v242, v242, v243
    v_mfma_f32_16x16x32_bf16 v[172:175], v[24:27], v[200:203], v[172:175]
    s_waitcnt lgkmcnt(2)
    v_cvt_pk_bf16_f32 v243, v244, v245
    v_cvt_pk_bf16_f32 v244, v246, v247
    v_accvgpr_read_b32 v248, a24
    v_accvgpr_read_b32 v249, a28
    v_accvgpr_read_b32 v250, a32
    v_mfma_f32_16x16x32_bf16 v[104:107], v[32:35], a[240:243], v[136:139]
    ds_read_b128 v[24:27], v2 offset:18560
    v_accvgpr_read_b32 v251, a36
    v_mfma_f32_16x16x32_bf16 v[104:107], v[36:39], a[244:247], v[104:107]
    buffer_store_dwordx3 v[242:244], v56, s[12:15], s24 offen offset:1152 sc0 sc1
    v_accvgpr_read_b32 v252, a40
    v_accvgpr_read_b32 v253, a44
    v_mfma_f32_16x16x32_bf16 v[108:111], v[36:39], v[204:207], v[140:143]
    ds_read_b128 v[28:31], v3 offset:18560
    v_mul_f32 v248, v248, v48
    v_mfma_f32_16x16x32_bf16 v[108:111], v[32:35], v[200:203], v[108:111]
    s_waitcnt lgkmcnt(2)
    v_mul_f32 v249, v249, v48
    v_mul_f32 v250, v250, v48
    v_mul_f32 v251, v251, v48
    v_mul_f32 v252, v252, v48
    v_mul_f32 v253, v253, v48
    v_mfma_f32_16x16x32_bf16 v[168:171], v[40:43], a[248:251], v[168:171]
    ds_read_b128 v[32:35], v2 offset:12544
    v_cvt_pk_bf16_f32 v248, v248, v249
    v_mfma_f32_16x16x32_bf16 v[168:171], v[44:47], a[252:255], v[168:171]
    v_cvt_pk_bf16_f32 v249, v250, v251
    v_cvt_pk_bf16_f32 v250, v252, v253
    v_accvgpr_read_b32 v224, a25
    v_accvgpr_read_b32 v225, a29
    v_accvgpr_read_b32 v226, a33
    v_mfma_f32_16x16x32_bf16 v[172:175], v[44:47], v[212:215], v[172:175]
    ds_read_b128 v[36:39], v3 offset:12544
    v_accvgpr_read_b32 v227, a37
    v_mfma_f32_16x16x32_bf16 v[172:175], v[40:43], v[208:211], v[172:175]
    s_waitcnt lgkmcnt(2)
    buffer_store_dwordx3 v[248:250], v56, s[12:15], s24 offen offset:192 sc0 sc1
    v_accvgpr_read_b32 v228, a41
    v_mfma_f32_16x16x32_bf16 v[104:107], v[24:27], a[248:251], v[104:107]
    ds_read_b128 v[40:43], v2 offset:18688
    v_accvgpr_read_b32 v229, a45
    v_mfma_f32_16x16x32_bf16 v[104:107], v[28:31], a[252:255], v[104:107]
    v_mul_f32 v224, v224, v49
    v_mul_f32 v225, v225, v49
    v_mul_f32 v226, v226, v49
    v_mul_f32 v227, v227, v49
    v_mul_f32 v228, v228, v49
    v_mul_f32 v229, v229, v49
    v_mfma_f32_16x16x32_bf16 v[108:111], v[28:31], v[212:215], v[108:111]
    ds_read_b128 v[44:47], v3 offset:18688
    v_cvt_pk_bf16_f32 v224, v224, v225
    v_mfma_f32_16x16x32_bf16 v[108:111], v[24:27], v[208:211], v[108:111]
    s_waitcnt lgkmcnt(2)
    v_add_u32 v2, 49152, v2
    v_add_u32 v3, 49152, v3
    v_exp_f32 v16, v160
    v_cvt_pk_bf16_f32 v225, v226, v227
    v_mfma_f32_16x16x32_bf16 v[168:171], v[32:35], v[192:195], v[168:171]
    ds_read_b128 v[24:27], v2 offset:0
    v_cvt_pk_bf16_f32 v226, v228, v229
    v_mfma_f32_16x16x32_bf16 v[168:171], v[36:39], v[196:199], v[168:171]
    buffer_store_dwordx3 v[224:226], v56, s[12:15], s24 offen offset:576 sc0 sc1
    v_accvgpr_read_b32 v230, a26
    v_mfma_f32_16x16x32_bf16 v[172:175], v[36:39], v[220:223], v[172:175]
    ds_read_b128 v[28:31], v3 offset:0
    v_accvgpr_read_b32 v231, a30
    v_mfma_f32_16x16x32_bf16 v[172:175], v[32:35], v[216:219], v[172:175]
    s_waitcnt lgkmcnt(2)
    v_exp_f32 v17, v161
    v_exp_f32 v18, v162
    v_exp_f32 v19, v163
    v_mfma_f32_16x16x32_bf16 v[104:107], v[40:43], v[192:195], v[104:107]
    ds_read_b128 v[32:35], v2 offset:6144
    v_accvgpr_read_b32 v232, a34
    v_mfma_f32_16x16x32_bf16 v[104:107], v[44:47], v[196:199], v[104:107]
    v_cvt_pk_bf16_f32 v160, v16, v17
    v_accvgpr_read_b32 v233, a38
    v_accvgpr_read_b32 v234, a42
    v_exp_f32 v16, v96
    v_mfma_f32_16x16x32_bf16 v[108:111], v[44:47], v[220:223], v[108:111]
    ds_read_b128 v[36:39], v3 offset:6144
    v_accvgpr_read_b32 v235, a46
    v_mfma_f32_16x16x32_bf16 v[108:111], v[40:43], v[216:219], v[108:111]
    s_waitcnt lgkmcnt(2)
    v_mul_f32 v230, v230, v50
    v_exp_f32 v17, v97
    v_mul_f32 v231, v231, v50
    v_mul_f32 v232, v232, v50
    v_mfma_f32_16x16x32_bf16 v[176:179], v[24:27], a[240:243], v[136:139]
    ds_read_b128 v[40:43], v2 offset:128
    v_cvt_pk_bf16_f32 v161, v18, v19
    v_mfma_f32_16x16x32_bf16 v[176:179], v[28:31], a[244:247], v[176:179]
    v_mul_f32 v233, v233, v50
    v_exp_f32 v18, v98
    v_mul_f32 v234, v234, v50
    v_mul_f32 v235, v235, v50
    v_cvt_pk_bf16_f32 v230, v230, v231
    v_mfma_f32_16x16x32_bf16 v[180:183], v[28:31], v[204:207], v[140:143]
    ds_read_b128 v[44:47], v3 offset:128
    v_cvt_pk_bf16_f32 v231, v232, v233
    v_mfma_f32_16x16x32_bf16 v[180:183], v[24:27], v[200:203], v[180:183]
    s_waitcnt lgkmcnt(2)
    v_exp_f32 v19, v99
    v_cvt_pk_bf16_f32 v232, v234, v235
    v_accvgpr_read_b32 v236, a27
    v_cvt_pk_bf16_f32 v162, v16, v17
    v_mfma_f32_16x16x32_bf16 v[112:115], v[32:35], a[240:243], v[136:139]
    ds_read_b128 v[24:27], v2 offset:6272
    v_accvgpr_read_b32 v237, a31
    v_mfma_f32_16x16x32_bf16 v[112:115], v[36:39], a[244:247], v[112:115]
    buffer_store_dwordx3 v[230:232], v56, s[12:15], s24 offen offset:960 sc0 sc1
    v_accvgpr_read_b32 v238, a35
    v_mfma_f32_16x16x32_bf16 v[116:119], v[36:39], v[204:207], v[140:143]
    ds_read_b128 v[28:31], v3 offset:6272
    v_accvgpr_read_b32 v239, a39
    v_mfma_f32_16x16x32_bf16 v[116:119], v[32:35], v[200:203], v[116:119]
    s_waitcnt lgkmcnt(2)
    v_exp_f32 v16, v164
    v_exp_f32 v17, v165
    v_accvgpr_read_b32 v240, a43
    v_accvgpr_read_b32 v241, a47
    v_mfma_f32_16x16x32_bf16 v[176:179], v[40:43], a[248:251], v[176:179]
    ds_read_b128 v[32:35], v2 offset:256
    v_cvt_pk_bf16_f32 v163, v18, v19
    v_mfma_f32_16x16x32_bf16 v[176:179], v[44:47], a[252:255], v[176:179]
    v_exp_f32 v18, v166
    v_mul_f32 v236, v236, v51
    v_mul_f32 v237, v237, v51
    v_mul_f32 v238, v238, v51
    v_mfma_f32_16x16x32_bf16 v[180:183], v[44:47], v[212:215], v[180:183]
    ds_read_b128 v[36:39], v3 offset:256
    v_mul_f32 v239, v239, v51
    v_mfma_f32_16x16x32_bf16 v[180:183], v[40:43], v[208:211], v[180:183]
    s_waitcnt lgkmcnt(2)
    v_exp_f32 v19, v167
    v_mul_f32 v240, v240, v51
    v_mul_f32 v241, v241, v51
    v_cvt_pk_bf16_f32 v236, v236, v237
    v_mfma_f32_16x16x32_bf16 v[112:115], v[24:27], a[248:251], v[112:115]
    ds_read_b128 v[40:43], v2 offset:6400
    v_cvt_pk_bf16_f32 v237, v238, v239
    v_mfma_f32_16x16x32_bf16 v[112:115], v[28:31], a[252:255], v[112:115]
    v_mfma_f32_16x16x32_bf16 v[128:131], v[160:163], v[20:23], v[128:131]
    v_cvt_pk_bf16_f32 v164, v16, v17
    v_cvt_pk_bf16_f32 v238, v240, v241
    v_accvgpr_read_b32 v242, a48
    v_mfma_f32_16x16x32_bf16 v[116:119], v[28:31], v[212:215], v[116:119]
    ds_read_b128 v[44:47], v3 offset:6400
    v_accvgpr_read_b32 v243, a52
    v_mfma_f32_16x16x32_bf16 v[116:119], v[24:27], v[208:211], v[116:119]
    s_waitcnt lgkmcnt(2)
    buffer_store_dwordx3 v[236:238], v56, s[12:15], s24 offen offset:1344 sc0 sc1
    v_exp_f32 v16, v100
    v_mfma_f32_16x16x32_bf16 v[176:179], v[32:35], v[192:195], v[176:179]
    ds_read_b128 v[24:27], v2 offset:12288
    v_accvgpr_read_b32 v244, a56
    v_mfma_f32_16x16x32_bf16 v[176:179], v[36:39], v[196:199], v[176:179]
    v_exp_f32 v17, v101
    v_accvgpr_read_b32 v245, a60
    v_cvt_pk_bf16_f32 v165, v18, v19
    v_accvgpr_read_b32 v246, a64
    v_mfma_f32_16x16x32_bf16 v[180:183], v[36:39], v[220:223], v[180:183]
    ds_read_b128 v[28:31], v3 offset:12288
    v_accvgpr_read_b32 v247, a68
    v_mfma_f32_16x16x32_bf16 v[180:183], v[32:35], v[216:219], v[180:183]
    s_waitcnt lgkmcnt(2)
    v_exp_f32 v18, v102
    v_mul_f32 v242, v242, v52
    v_mul_f32 v243, v243, v52
    v_mul_f32 v244, v244, v52
    v_mfma_f32_16x16x32_bf16 v[112:115], v[40:43], v[192:195], v[112:115]
    ds_read_b128 v[32:35], v2 offset:18432
    v_mul_f32 v245, v245, v52
    v_mfma_f32_16x16x32_bf16 v[112:115], v[44:47], v[196:199], v[112:115]
    v_exp_f32 v19, v103
    v_cvt_pk_bf16_f32 v166, v16, v17
    v_mul_f32 v246, v246, v52
    v_mul_f32 v247, v247, v52
    v_cvt_pk_bf16_f32 v167, v18, v19
    v_mfma_f32_16x16x32_bf16 v[116:119], v[44:47], v[220:223], v[116:119]
    ds_read_b128 v[36:39], v3 offset:18432
    v_cvt_pk_bf16_f32 v242, v242, v243
    v_mfma_f32_16x16x32_bf16 v[116:119], v[40:43], v[216:219], v[116:119]
    s_waitcnt lgkmcnt(2)
    s_nop 1
    v_cvt_pk_bf16_f32 v243, v244, v245
    v_cvt_pk_bf16_f32 v244, v246, v247
    v_accvgpr_read_b32 v248, a49
    v_mfma_f32_16x16x32_bf16 v[184:187], v[24:27], a[240:243], v[136:139]
    ds_read_b128 v[40:43], v2 offset:12416
    v_accvgpr_read_b32 v249, a53
    v_mfma_f32_16x16x32_bf16 v[184:187], v[28:31], a[244:247], v[184:187]
    buffer_store_dwordx3 v[242:244], v56, s[12:15], s40 offen offset:0 sc0 sc1
    v_accvgpr_read_b32 v250, a57
    v_mfma_f32_16x16x32_bf16 v[188:191], v[28:31], v[204:207], v[140:143]
    ds_read_b128 v[44:47], v3 offset:12416
    v_accvgpr_read_b32 v251, a61
    v_mfma_f32_16x16x32_bf16 v[188:191], v[24:27], v[200:203], v[188:191]
    s_waitcnt lgkmcnt(2)
    v_mfma_f32_16x16x32_bf16 v[132:135], v[164:167], v[20:23], v[132:135]
    v_exp_f32 v16, v168
    v_accvgpr_read_b32 v252, a65
    v_accvgpr_read_b32 v253, a69
    v_mfma_f32_16x16x32_bf16 v[120:123], v[32:35], a[240:243], v[136:139]
    ds_read_b128 v[24:27], v2 offset:18560
    v_mul_f32 v248, v248, v53
    v_mfma_f32_16x16x32_bf16 v[120:123], v[36:39], a[244:247], v[120:123]
    v_exp_f32 v17, v169
    v_exp_f32 v18, v170
    v_mul_f32 v249, v249, v53
    v_mfma_f32_16x16x32_bf16 v[124:127], v[36:39], v[204:207], v[140:143]
    ds_read_b128 v[28:31], v3 offset:18560
    v_mul_f32 v250, v250, v53
    v_mfma_f32_16x16x32_bf16 v[124:127], v[32:35], v[200:203], v[124:127]
    s_waitcnt lgkmcnt(2)
    v_exp_f32 v19, v171
    v_mul_f32 v251, v251, v53
    v_mul_f32 v252, v252, v53
    v_mul_f32 v253, v253, v53
    v_mfma_f32_16x16x32_bf16 v[184:187], v[40:43], a[248:251], v[184:187]
    ds_read_b128 v[32:35], v2 offset:12544
    v_cvt_pk_bf16_f32 v168, v16, v17
    v_mfma_f32_16x16x32_bf16 v[184:187], v[44:47], a[252:255], v[184:187]
    v_cvt_pk_bf16_f32 v248, v248, v249
    v_exp_f32 v16, v104
    v_cvt_pk_bf16_f32 v249, v250, v251
    v_cvt_pk_bf16_f32 v250, v252, v253
    v_accvgpr_read_b32 v224, a50
    v_mfma_f32_16x16x32_bf16 v[188:191], v[44:47], v[212:215], v[188:191]
    ds_read_b128 v[36:39], v3 offset:12544
    v_accvgpr_read_b32 v225, a54
    v_mfma_f32_16x16x32_bf16 v[188:191], v[40:43], v[208:211], v[188:191]
    s_waitcnt lgkmcnt(2)
    buffer_store_dwordx3 v[248:250], v56, s[12:15], s40 offen offset:384 sc0 sc1
    v_accvgpr_read_b32 v226, a58
    v_mfma_f32_16x16x32_bf16 v[120:123], v[24:27], a[248:251], v[120:123]
    ds_read_b128 v[40:43], v2 offset:18688
    v_accvgpr_read_b32 v227, a62
    v_mfma_f32_16x16x32_bf16 v[120:123], v[28:31], a[252:255], v[120:123]
    v_exp_f32 v17, v105
    v_cvt_pk_bf16_f32 v169, v18, v19
    v_accvgpr_read_b32 v228, a66
    v_accvgpr_read_b32 v229, a70
    v_mfma_f32_16x16x32_bf16 v[124:127], v[28:31], v[212:215], v[124:127]
    ds_read_b128 v[44:47], v3 offset:18688
    v_mul_f32 v224, v224, v54
    v_mfma_f32_16x16x32_bf16 v[124:127], v[24:27], v[208:211], v[124:127]
    s_waitcnt lgkmcnt(2)
    v_add_u32 v60, 49152, v1
    v_mov_b32 v59, v1
    v_subrev_u32 v1, 49152, v1
    v_exp_f32 v18, v106
    v_mfma_f32_16x16x32_bf16 v[184:187], v[32:35], v[192:195], v[184:187]
    ds_read_b128 v[24:27], v60 offset:0
    v_mul_f32 v225, v225, v54
    v_mfma_f32_16x16x32_bf16 v[184:187], v[36:39], v[196:199], v[184:187]
    v_exp_f32 v19, v107
    v_mul_f32 v226, v226, v54
    v_cvt_pk_bf16_f32 v170, v16, v17
    v_mul_f32 v227, v227, v54
    v_mul_f32 v228, v228, v54
    v_mfma_f32_16x16x32_bf16 v[188:191], v[36:39], v[220:223], v[188:191]
    ds_read_b128 v[28:31], v60 offset:12288
    v_mul_f32 v229, v229, v54
    v_mfma_f32_16x16x32_bf16 v[188:191], v[32:35], v[216:219], v[188:191]
    s_waitcnt lgkmcnt(2)
    v_exp_f32 v16, v172
    v_cvt_pk_bf16_f32 v224, v224, v225
    v_cvt_pk_bf16_f32 v225, v226, v227
    v_cvt_pk_bf16_f32 v226, v228, v229
    v_mfma_f32_16x16x32_bf16 v[120:123], v[40:43], v[192:195], v[120:123]
    ds_read_b128 v[32:35], v60 offset:1024
    v_accvgpr_read_b32 v230, a51
    v_mfma_f32_16x16x32_bf16 v[120:123], v[44:47], v[196:199], v[120:123]
    buffer_store_dwordx3 v[224:226], v56, s[12:15], s40 offen offset:768 sc0 sc1
    v_accvgpr_read_b32 v231, a55
    v_mfma_f32_16x16x32_bf16 v[124:127], v[44:47], v[220:223], v[124:127]
    ds_read_b128 v[36:39], v60 offset:13312
    v_accvgpr_read_b32 v232, a59
    v_mfma_f32_16x16x32_bf16 v[124:127], v[40:43], v[216:219], v[124:127]
    s_waitcnt lgkmcnt(2)
    v_exp_f32 v17, v173
    v_cvt_pk_bf16_f32 v171, v18, v19
    v_exp_f32 v18, v174
    v_accvgpr_read_b32 v233, a63
    v_mfma_f32_16x16x32_bf16 a[96:99], v[80:83], v[24:27], a[96:99]
    ds_read_b128 v[40:43], v60 offset:2048
    v_accvgpr_read_b32 v234, a67
    v_mfma_f32_16x16x32_bf16 a[96:99], v[88:91], v[28:31], a[96:99]
    v_exp_f32 v19, v175
    v_accvgpr_read_b32 v235, a71
    v_mul_f32 v230, v230, v55
    v_mul_f32 v231, v231, v55
    v_mfma_f32_16x16x32_bf16 a[144:147], v[92:95], v[28:31], a[144:147]
    ds_read_b128 v[44:47], v60 offset:14336
    v_mul_f32 v232, v232, v55
    v_mfma_f32_16x16x32_bf16 a[144:147], v[84:87], v[24:27], a[144:147]
    s_waitcnt lgkmcnt(2)
    v_mfma_f32_16x16x32_bf16 v[128:131], v[168:171], v[20:23], v[128:131]
    v_mul_f32 v233, v233, v55
    v_mul_f32 v234, v234, v55
    v_mul_f32 v235, v235, v55
    v_mfma_f32_16x16x32_bf16 a[100:103], v[80:83], v[32:35], a[100:103]
    ds_read_b128 v[24:27], v60 offset:3072
    v_cvt_pk_bf16_f32 v172, v16, v17
    v_mfma_f32_16x16x32_bf16 a[100:103], v[88:91], v[36:39], a[100:103]
    v_exp_f32 v16, v108
    v_cvt_pk_bf16_f32 v230, v230, v231
    v_cvt_pk_bf16_f32 v231, v232, v233
    v_cvt_pk_bf16_f32 v232, v234, v235
    v_accvgpr_read_b32 v236, a72
    v_mfma_f32_16x16x32_bf16 a[148:151], v[92:95], v[36:39], a[148:151]
    ds_read_b128 v[28:31], v60 offset:15360
    v_accvgpr_read_b32 v237, a76
    v_mfma_f32_16x16x32_bf16 a[148:151], v[84:87], v[32:35], a[148:151]
    s_waitcnt lgkmcnt(2)
    buffer_store_dwordx3 v[230:232], v56, s[12:15], s40 offen offset:1152 sc0 sc1
    v_accvgpr_read_b32 v238, a80
    v_mfma_f32_16x16x32_bf16 a[104:107], v[80:83], v[40:43], a[104:107]
    ds_read_b128 v[32:35], v60 offset:4096
    v_accvgpr_read_b32 v239, a84
    v_mfma_f32_16x16x32_bf16 a[104:107], v[88:91], v[44:47], a[104:107]
    v_exp_f32 v17, v109
    v_cvt_pk_bf16_f32 v173, v18, v19
    v_accvgpr_read_b32 v240, a88
    v_accvgpr_read_b32 v241, a92
    v_mfma_f32_16x16x32_bf16 a[152:155], v[92:95], v[44:47], a[152:155]
    ds_read_b128 v[36:39], v60 offset:16384
    v_mul_f32 v236, v236, v52
    v_mfma_f32_16x16x32_bf16 a[152:155], v[84:87], v[40:43], a[152:155]
    s_waitcnt lgkmcnt(2)
    v_exp_f32 v18, v110
    v_mul_f32 v237, v237, v52
    v_mul_f32 v238, v238, v52
    v_mul_f32 v239, v239, v52
    v_mul_f32 v240, v240, v52
    v_mfma_f32_16x16x32_bf16 a[108:111], v[80:83], v[24:27], a[108:111]
    ds_read_b128 v[40:43], v60 offset:5120
    v_mul_f32 v241, v241, v52
    v_mfma_f32_16x16x32_bf16 a[108:111], v[88:91], v[28:31], a[108:111]
    v_exp_f32 v19, v111
    v_cvt_pk_bf16_f32 v236, v236, v237
    v_cvt_pk_bf16_f32 v237, v238, v239
    v_cvt_pk_bf16_f32 v238, v240, v241
    v_mfma_f32_16x16x32_bf16 a[156:159], v[92:95], v[28:31], a[156:159]
    ds_read_b128 v[44:47], v60 offset:17408
    v_cvt_pk_bf16_f32 v174, v16, v17
    v_mfma_f32_16x16x32_bf16 a[156:159], v[84:87], v[24:27], a[156:159]
    s_waitcnt lgkmcnt(2)
    buffer_store_dwordx3 v[236:238], v56, s[12:15], s40 offen offset:192 sc0 sc1
    v_accvgpr_read_b32 v242, a73
    v_mfma_f32_16x16x32_bf16 a[112:115], v[80:83], v[32:35], a[112:115]
    ds_read_b128 v[24:27], v1 offset:0
    v_cvt_pk_bf16_f32 v175, v18, v19
    v_mfma_f32_16x16x32_bf16 a[112:115], v[88:91], v[36:39], a[112:115]
    s_nop 1
    v_accvgpr_read_b32 v243, a77
    v_accvgpr_read_b32 v244, a81
    v_accvgpr_read_b32 v245, a85
    v_accvgpr_read_b32 v246, a89
    v_mfma_f32_16x16x32_bf16 a[160:163], v[92:95], v[36:39], a[160:163]
    ds_read_b128 v[28:31], v1 offset:12288
    v_accvgpr_read_b32 v247, a93
    v_mfma_f32_16x16x32_bf16 a[160:163], v[84:87], v[32:35], a[160:163]
    s_waitcnt lgkmcnt(2)
    v_mul_f32 v242, v242, v53
    v_mfma_f32_16x16x32_bf16 v[132:135], v[172:175], v[20:23], v[132:135]
    v_exp_f32 v16, v176
    v_mul_f32 v243, v243, v53
    v_mfma_f32_16x16x32_bf16 a[116:119], v[80:83], v[40:43], a[116:119]
    ds_read_b128 v[32:35], v1 offset:1024
    v_mul_f32 v244, v244, v53
    v_mfma_f32_16x16x32_bf16 a[116:119], v[88:91], v[44:47], a[116:119]
    v_exp_f32 v17, v177
    v_exp_f32 v18, v178
    v_mul_f32 v245, v245, v53
    v_mfma_f32_16x16x32_bf16 a[164:167], v[92:95], v[44:47], a[164:167]
    ds_read_b128 v[36:39], v1 offset:13312
    v_mul_f32 v246, v246, v53
    v_mfma_f32_16x16x32_bf16 a[164:167], v[84:87], v[40:43], a[164:167]
    s_waitcnt lgkmcnt(2)
    v_exp_f32 v19, v179
    v_cvt_pk_bf16_f32 v176, v16, v17
    v_exp_f32 v16, v112
    v_mfma_f32_16x16x32_bf16 a[96:99], v[160:163], v[24:27], a[96:99]
    ds_read_b128 v[40:43], v1 offset:2048
    v_mul_f32 v247, v247, v53
    v_mfma_f32_16x16x32_bf16 a[96:99], v[168:171], v[28:31], a[96:99]
    v_exp_f32 v17, v113
    v_cvt_pk_bf16_f32 v177, v18, v19
    v_exp_f32 v18, v114
    v_cvt_pk_bf16_f32 v242, v242, v243
    v_mfma_f32_16x16x32_bf16 a[144:147], v[172:175], v[28:31], a[144:147]
    ds_read_b128 v[44:47], v1 offset:14336
    v_cvt_pk_bf16_f32 v243, v244, v245
    v_mfma_f32_16x16x32_bf16 a[144:147], v[164:167], v[24:27], a[144:147]
    s_waitcnt lgkmcnt(2)
    v_exp_f32 v19, v115
    v_cvt_pk_bf16_f32 v178, v16, v17
    v_exp_f32 v16, v180
    v_mfma_f32_16x16x32_bf16 a[100:103], v[160:163], v[32:35], a[100:103]
    ds_read_b128 v[24:27], v1 offset:3072
    v_cvt_pk_bf16_f32 v244, v246, v247
    v_mfma_f32_16x16x32_bf16 a[100:103], v[168:171], v[36:39], a[100:103]
    buffer_store_dwordx3 v[242:244], v56, s[12:15], s40 offen offset:576 sc0 sc1
    v_accvgpr_read_b32 v248, a74
    v_mfma_f32_16x16x32_bf16 a[148:151], v[172:175], v[36:39], a[148:151]
    ds_read_b128 v[28:31], v1 offset:15360
    v_accvgpr_read_b32 v249, a78
    v_mfma_f32_16x16x32_bf16 a[148:151], v[164:167], v[32:35], a[148:151]
    s_waitcnt lgkmcnt(2)
    v_exp_f32 v17, v181
    v_cvt_pk_bf16_f32 v179, v18, v19
    v_exp_f32 v18, v182
    v_accvgpr_read_b32 v250, a82
    v_mfma_f32_16x16x32_bf16 a[104:107], v[160:163], v[40:43], a[104:107]
    ds_read_b128 v[32:35], v1 offset:4096
    v_accvgpr_read_b32 v251, a86
    v_mfma_f32_16x16x32_bf16 a[104:107], v[168:171], v[44:47], a[104:107]
    v_exp_f32 v19, v183
    v_mfma_f32_16x16x32_bf16 v[128:131], v[176:179], v[20:23], v[128:131]
    v_cvt_pk_bf16_f32 v180, v16, v17
    v_mfma_f32_16x16x32_bf16 a[152:155], v[172:175], v[44:47], a[152:155]
    ds_read_b128 v[36:39], v1 offset:16384
    v_accvgpr_read_b32 v252, a90
    v_mfma_f32_16x16x32_bf16 a[152:155], v[164:167], v[40:43], a[152:155]
    s_waitcnt lgkmcnt(2)
    v_exp_f32 v16, v116
    v_exp_f32 v17, v117
    v_cvt_pk_bf16_f32 v181, v18, v19
    v_mfma_f32_16x16x32_bf16 a[108:111], v[160:163], v[24:27], a[108:111]
    ds_read_b128 v[40:43], v1 offset:5120
    v_accvgpr_read_b32 v253, a94
    v_mfma_f32_16x16x32_bf16 a[108:111], v[168:171], v[28:31], a[108:111]
    v_exp_f32 v18, v118
    v_exp_f32 v19, v119
    v_cvt_pk_bf16_f32 v182, v16, v17
    v_cvt_pk_bf16_f32 v183, v18, v19
    v_mfma_f32_16x16x32_bf16 a[156:159], v[172:175], v[28:31], a[156:159]
L_pg13:
    s_cbranch_execz L_iwret
    s_nop 1
    ds_read_b128 v[44:47], v1 offset:17408
    v_mfma_f32_16x16x32_bf16 a[156:159], v[164:167], v[24:27], a[156:159]
    s_waitcnt lgkmcnt(2)
    v_mfma_f32_16x16x32_bf16 v[132:135], v[180:183], v[20:23], v[132:135]
    v_exp_f32 v16, v184
    v_mul_f32 v248, v248, v54
    v_mfma_f32_16x16x32_bf16 a[112:115], v[160:163], v[32:35], a[112:115]
    ds_read_b128 v[24:27], v59 offset:0
    v_mul_f32 v249, v249, v54
    v_mfma_f32_16x16x32_bf16 a[112:115], v[168:171], v[36:39], a[112:115]
    v_exp_f32 v17, v185
    v_exp_f32 v18, v186
    v_mul_f32 v250, v250, v54
    v_mfma_f32_16x16x32_bf16 a[160:163], v[172:175], v[36:39], a[160:163]
    ds_read_b128 v[28:31], v59 offset:12288
    v_mul_f32 v251, v251, v54
    v_mfma_f32_16x16x32_bf16 a[160:163], v[164:167], v[32:35], a[160:163]
    s_waitcnt lgkmcnt(2)
    v_exp_f32 v19, v187
    v_cvt_pk_bf16_f32 v184, v16, v17
    v_exp_f32 v16, v120
    v_exp_f32 v17, v121
    v_cvt_pk_bf16_f32 v185, v18, v19
    v_exp_f32 v18, v122
    v_exp_f32 v19, v123
    v_cvt_pk_bf16_f32 v186, v16, v17
    v_exp_f32 v16, v188
    v_exp_f32 v17, v189
    v_cvt_pk_bf16_f32 v187, v18, v19
    v_exp_f32 v18, v190
    v_exp_f32 v19, v191
    v_mfma_f32_16x16x32_bf16 v[128:131], v[184:187], v[20:23], v[128:131]
    v_cvt_pk_bf16_f32 v188, v16, v17
    v_exp_f32 v16, v124
    v_exp_f32 v17, v125
    v_cvt_pk_bf16_f32 v189, v18, v19
    v_exp_f32 v18, v126
    v_exp_f32 v19, v127
    v_cvt_pk_bf16_f32 v190, v16, v17
    v_cvt_pk_bf16_f32 v191, v18, v19
    s_nop 1
    v_mfma_f32_16x16x32_bf16 v[132:135], v[188:191], v[20:23], v[132:135]
    v_mfma_f32_16x16x32_bf16 a[116:119], v[160:163], v[40:43], a[116:119]
    ds_read_b128 v[32:35], v59 offset:1024
    v_mul_f32 v252, v252, v54
    v_mfma_f32_16x16x32_bf16 a[116:119], v[168:171], v[44:47], a[116:119]
    v_mul_f32 v253, v253, v54
    v_cvt_pk_bf16_f32 v248, v248, v249
    v_cvt_pk_bf16_f32 v249, v250, v251
    v_cvt_pk_bf16_f32 v250, v252, v253
    v_accvgpr_read_b32 v224, a75
    v_mfma_f32_16x16x32_bf16 a[164:167], v[172:175], v[44:47], a[164:167]
    ds_read_b128 v[36:39], v59 offset:13312
    v_accvgpr_read_b32 v225, a79
    v_mfma_f32_16x16x32_bf16 a[164:167], v[164:167], v[40:43], a[164:167]
    s_waitcnt lgkmcnt(2)
    buffer_store_dwordx3 v[248:250], v56, s[12:15], s40 offen offset:960 sc0 sc1
    v_accvgpr_read_b32 v226, a83
    v_accvgpr_read_b32 v227, a87
    v_mfma_f32_16x16x4_f32 v[128:131], v7, v57, v[128:131]
    v_mfma_f32_16x16x32_bf16 a[96:99], v[176:179], v[24:27], a[96:99]
    ds_read_b128 v[40:43], v59 offset:2048
    v_accvgpr_read_b32 v228, a91
    v_mfma_f32_16x16x32_bf16 a[96:99], v[184:187], v[28:31], a[96:99]
    v_accvgpr_read_b32 v229, a95
    v_mul_f32 v224, v224, v55
    v_mul_f32 v225, v225, v55
    v_mul_f32 v226, v226, v55
    v_mul_f32 v227, v227, v55
    v_mul_f32 v228, v228, v55
    v_mfma_f32_16x16x4_f32 v[132:135], v8, v57, v[132:135]
    v_mfma_f32_16x16x32_bf16 a[144:147], v[188:191], v[28:31], a[144:147]
    ds_read_b128 v[44:47], v59 offset:14336
    v_mul_f32 v229, v229, v55
    v_mfma_f32_16x16x32_bf16 a[144:147], v[180:183], v[24:27], a[144:147]
    s_waitcnt lgkmcnt(2)
    v_cvt_pk_bf16_f32 v224, v224, v225
    v_cvt_pk_bf16_f32 v225, v226, v227
    v_cvt_pk_bf16_f32 v226, v228, v229
    v_mfma_f32_16x16x32_bf16 a[100:103], v[176:179], v[32:35], a[100:103]
    ds_read_b128 v[24:27], v59 offset:3072
    v_mfma_f32_16x16x32_bf16 a[100:103], v[184:187], v[36:39], a[100:103]
    buffer_store_dwordx3 v[224:226], v56, s[12:15], s40 offen offset:1344 sc0 sc1
    v_mfma_f32_16x16x32_bf16 a[148:151], v[188:191], v[36:39], a[148:151]
    ds_read_b128 v[28:31], v59 offset:15360
    v_max3_f32 v18, v5, v6, v128
    v_mfma_f32_16x16x32_bf16 a[148:151], v[180:183], v[32:35], a[148:151]
    s_waitcnt lgkmcnt(2)
    v_max3_f32 v18, v18, v129, v130
    v_max3_f32 v18, v18, v131, v132
    v_max3_f32 v18, v18, v133, v134
    v_max_f32 v18, v18, v135
    s_mov_b32 s29, 0x5f800000
    v_cmp_lt_f32 s[48:49], s29, v18
    v_rcp_f32 v128, v128
    v_mfma_f32_16x16x32_bf16 a[104:107], v[176:179], v[40:43], a[104:107]
    ds_read_b128 v[32:35], v59 offset:4096
    v_mfma_f32_16x16x32_bf16 a[104:107], v[184:187], v[44:47], a[104:107]
    v_rcp_f32 v129, v129
    v_rcp_f32 v130, v130
    v_rcp_f32 v131, v131
    v_mfma_f32_16x16x32_bf16 a[152:155], v[188:191], v[44:47], a[152:155]
    ds_read_b128 v[36:39], v59 offset:16384
    v_mfma_f32_16x16x32_bf16 a[152:155], v[180:183], v[40:43], a[152:155]
    s_waitcnt lgkmcnt(2)
    v_rcp_f32 v132, v132
    v_rcp_f32 v133, v133
    v_mfma_f32_16x16x32_bf16 a[108:111], v[176:179], v[24:27], a[108:111]
    ds_read_b128 v[40:43], v59 offset:5120
    v_mfma_f32_16x16x32_bf16 a[108:111], v[184:187], v[28:31], a[108:111]
    v_rcp_f32 v134, v134
    v_rcp_f32 v135, v135
    v_mfma_f32_16x16x32_bf16 a[156:159], v[188:191], v[28:31], a[156:159]
    ds_read_b128 v[44:47], v59 offset:17408
    v_mfma_f32_16x16x32_bf16 a[156:159], v[180:183], v[24:27], a[156:159]
    s_waitcnt lgkmcnt(2)
    v_mfma_f32_16x16x32_bf16 a[112:115], v[176:179], v[32:35], a[112:115]
    ds_read_b128 v[24:27], v60 offset:6144
    v_mfma_f32_16x16x32_bf16 a[112:115], v[184:187], v[36:39], a[112:115]
    v_mfma_f32_16x16x32_bf16 a[160:163], v[188:191], v[36:39], a[160:163]
    ds_read_b128 v[28:31], v60 offset:18432
    v_mfma_f32_16x16x32_bf16 a[160:163], v[180:183], v[32:35], a[160:163]
    s_waitcnt lgkmcnt(2)
    s_cmp_lg_u64 s[48:49], 0
    s_cbranch_scc1 L_slow
    v_mfma_f32_16x16x32_bf16 a[116:119], v[176:179], v[40:43], a[116:119]
    ds_read_b128 v[32:35], v60 offset:7168
    v_mfma_f32_16x16x32_bf16 a[116:119], v[184:187], v[44:47], a[116:119]
    v_mfma_f32_16x16x32_bf16 a[164:167], v[188:191], v[44:47], a[164:167]
    ds_read_b128 v[36:39], v60 offset:19456
    v_mfma_f32_16x16x32_bf16 a[164:167], v[180:183], v[40:43], a[164:167]
    s_waitcnt lgkmcnt(2)
    v_mfma_f32_16x16x32_bf16 a[120:123], v[80:83], v[24:27], a[120:123]
    ds_read_b128 v[40:43], v60 offset:8192
    v_mfma_f32_16x16x32_bf16 a[120:123], v[88:91], v[28:31], a[120:123]
    v_mfma_f32_16x16x32_bf16 a[168:171], v[92:95], v[28:31], a[168:171]
    ds_read_b128 v[44:47], v60 offset:20480
    v_mfma_f32_16x16x32_bf16 a[168:171], v[84:87], v[24:27], a[168:171]
    s_waitcnt lgkmcnt(2)
    v_mfma_f32_16x16x32_bf16 a[124:127], v[80:83], v[32:35], a[124:127]
    ds_read_b128 v[24:27], v1 offset:6144
    v_accvgpr_read_b32 v230, a96
    v_mfma_f32_16x16x32_bf16 a[124:127], v[88:91], v[36:39], a[124:127]
    v_accvgpr_read_b32 v231, a100
    v_accvgpr_read_b32 v232, a104
    v_accvgpr_read_b32 v233, a108
    v_accvgpr_read_b32 v234, a112
    v_accvgpr_read_b32 v235, a116
    v_mul_f32 v230, v230, v128
    v_mul_f32 v231, v231, v128
    v_mul_f32 v232, v232, v128
    v_mul_f32 v233, v233, v128
    v_mul_f32 v234, v234, v128
    v_mul_f32 v235, v235, v128
    v_cvt_pk_bf16_f32 v230, v230, v231
    v_cvt_pk_bf16_f32 v231, v232, v233
    v_cvt_pk_bf16_f32 v232, v234, v235
    v_accvgpr_read_b32 v236, a97
    v_accvgpr_read_b32 v237, a101
    v_accvgpr_read_b32 v238, a105
    v_accvgpr_read_b32 v239, a109
    v_accvgpr_read_b32 v240, a113
    v_accvgpr_read_b32 v241, a117
    v_mul_f32 v236, v236, v129
    v_mul_f32 v237, v237, v129
    v_mul_f32 v238, v238, v129
    v_mul_f32 v239, v239, v129
    v_mul_f32 v240, v240, v129
    v_mul_f32 v241, v241, v129
    v_cvt_pk_bf16_f32 v236, v236, v237
    v_cvt_pk_bf16_f32 v237, v238, v239
    v_cvt_pk_bf16_f32 v238, v240, v241
    v_accvgpr_read_b32 v242, a98
    v_mfma_f32_16x16x32_bf16 a[172:175], v[92:95], v[36:39], a[172:175]
    ds_read_b128 v[28:31], v1 offset:18432
    v_accvgpr_read_b32 v243, a102
    v_mfma_f32_16x16x32_bf16 a[172:175], v[84:87], v[32:35], a[172:175]
    s_waitcnt lgkmcnt(2)
    buffer_store_dwordx3 v[230:232], v56, s[12:15], s41 offen offset:0 sc0 sc1
    v_accvgpr_read_b32 v244, a106
    v_mfma_f32_16x16x32_bf16 a[128:131], v[80:83], v[40:43], a[128:131]
    ds_read_b128 v[32:35], v1 offset:7168
    v_accvgpr_read_b32 v245, a110
    v_mfma_f32_16x16x32_bf16 a[128:131], v[88:91], v[44:47], a[128:131]
    buffer_store_dwordx3 v[236:238], v56, s[12:15], s41 offen offset:384 sc0 sc1
    v_accvgpr_read_b32 v246, a114
    v_mfma_f32_16x16x32_bf16 a[176:179], v[92:95], v[44:47], a[176:179]
    ds_read_b128 v[36:39], v1 offset:19456
    v_accvgpr_read_b32 v247, a118
    v_mfma_f32_16x16x32_bf16 a[176:179], v[84:87], v[40:43], a[176:179]
    s_waitcnt lgkmcnt(2)
    v_mul_f32 v242, v242, v130
    v_mul_f32 v243, v243, v130
    v_mul_f32 v244, v244, v130
    v_mul_f32 v245, v245, v130
    v_mul_f32 v246, v246, v130
    v_mul_f32 v247, v247, v130
    v_mfma_f32_16x16x32_bf16 a[120:123], v[160:163], v[24:27], a[120:123]
    ds_read_b128 v[40:43], v1 offset:8192
    v_cvt_pk_bf16_f32 v242, v242, v243
    v_mfma_f32_16x16x32_bf16 a[120:123], v[168:171], v[28:31], a[120:123]
    v_cvt_pk_bf16_f32 v243, v244, v245
    v_cvt_pk_bf16_f32 v244, v246, v247
    v_accvgpr_read_b32 v248, a99
    v_accvgpr_read_b32 v249, a103
    v_accvgpr_read_b32 v250, a107
    v_mfma_f32_16x16x32_bf16 a[168:171], v[172:175], v[28:31], a[168:171]
    ds_read_b128 v[44:47], v1 offset:20480
    v_accvgpr_read_b32 v251, a111
    v_mfma_f32_16x16x32_bf16 a[168:171], v[164:167], v[24:27], a[168:171]
    s_waitcnt lgkmcnt(2)
    buffer_store_dwordx3 v[242:244], v56, s[12:15], s41 offen offset:768 sc0 sc1
    v_accvgpr_read_b32 v252, a115
    v_mfma_f32_16x16x32_bf16 a[124:127], v[160:163], v[32:35], a[124:127]
    ds_read_b128 v[24:27], v59 offset:6144
    v_accvgpr_read_b32 v253, a119
    v_mfma_f32_16x16x32_bf16 a[124:127], v[168:171], v[36:39], a[124:127]
    v_mul_f32 v248, v248, v131
    v_mul_f32 v249, v249, v131
    v_mul_f32 v250, v250, v131
    v_mul_f32 v251, v251, v131
    v_mul_f32 v252, v252, v131
    v_mul_f32 v253, v253, v131
    v_mfma_f32_16x16x32_bf16 a[172:175], v[172:175], v[36:39], a[172:175]
    ds_read_b128 v[28:31], v59 offset:18432
    v_cvt_pk_bf16_f32 v248, v248, v249
    v_mfma_f32_16x16x32_bf16 a[172:175], v[164:167], v[32:35], a[172:175]
    s_waitcnt lgkmcnt(2)
    v_cvt_pk_bf16_f32 v249, v250, v251
    v_cvt_pk_bf16_f32 v250, v252, v253
    v_accvgpr_read_b32 v224, a144
    v_accvgpr_read_b32 v225, a148
    v_accvgpr_read_b32 v226, a152
    v_mfma_f32_16x16x32_bf16 a[128:131], v[160:163], v[40:43], a[128:131]
    ds_read_b128 v[32:35], v59 offset:7168
    v_accvgpr_read_b32 v227, a156
    v_mfma_f32_16x16x32_bf16 a[128:131], v[168:171], v[44:47], a[128:131]
    buffer_store_dwordx3 v[248:250], v56, s[12:15], s41 offen offset:1152 sc0 sc1
    v_accvgpr_read_b32 v228, a160
    v_mfma_f32_16x16x32_bf16 a[176:179], v[172:175], v[44:47], a[176:179]
    ds_read_b128 v[36:39], v59 offset:19456
    v_accvgpr_read_b32 v229, a164
    v_mfma_f32_16x16x32_bf16 a[176:179], v[164:167], v[40:43], a[176:179]
    s_waitcnt lgkmcnt(2)
    v_mul_f32 v224, v224, v132
    v_mul_f32 v225, v225, v132
    v_mul_f32 v226, v226, v132
    v_mul_f32 v227, v227, v132
    v_mul_f32 v228, v228, v132
    v_mul_f32 v229, v229, v132
    v_mfma_f32_16x16x32_bf16 a[120:123], v[176:179], v[24:27], a[120:123]
    ds_read_b128 v[40:43], v59 offset:8192
    v_cvt_pk_bf16_f32 v224, v224, v225
    v_mfma_f32_16x16x32_bf16 a[120:123], v[184:187], v[28:31], a[120:123]
    v_cvt_pk_bf16_f32 v225, v226, v227
    v_cvt_pk_bf16_f32 v226, v228, v229
    v_accvgpr_read_b32 v230, a145
    v_accvgpr_read_b32 v231, a149
    v_accvgpr_read_b32 v232, a153
    v_mfma_f32_16x16x32_bf16 a[168:171], v[188:191], v[28:31], a[168:171]
    ds_read_b128 v[44:47], v59 offset:20480
    v_accvgpr_read_b32 v233, a157
    v_mfma_f32_16x16x32_bf16 a[168:171], v[180:183], v[24:27], a[168:171]
    s_waitcnt lgkmcnt(2)
    buffer_store_dwordx3 v[224:226], v56, s[12:15], s42 offen offset:0 sc0 sc1
    v_accvgpr_read_b32 v234, a161
    v_mfma_f32_16x16x32_bf16 a[124:127], v[176:179], v[32:35], a[124:127]
    ds_read_b128 v[24:27], v60 offset:9216
    v_accvgpr_read_b32 v235, a165
    v_mfma_f32_16x16x32_bf16 a[124:127], v[184:187], v[36:39], a[124:127]
    v_mul_f32 v230, v230, v133
    v_mul_f32 v231, v231, v133
    v_mul_f32 v232, v232, v133
    v_mul_f32 v233, v233, v133
    v_mul_f32 v234, v234, v133
    v_mul_f32 v235, v235, v133
    v_mfma_f32_16x16x32_bf16 a[172:175], v[188:191], v[36:39], a[172:175]
    ds_read_b128 v[28:31], v60 offset:21504
    v_cvt_pk_bf16_f32 v230, v230, v231
    v_mfma_f32_16x16x32_bf16 a[172:175], v[180:183], v[32:35], a[172:175]
    s_waitcnt lgkmcnt(2)
    v_cvt_pk_bf16_f32 v231, v232, v233
    v_cvt_pk_bf16_f32 v232, v234, v235
    v_accvgpr_read_b32 v236, a146
    v_accvgpr_read_b32 v237, a150
    v_accvgpr_read_b32 v238, a154
    v_mfma_f32_16x16x32_bf16 a[128:131], v[176:179], v[40:43], a[128:131]
    ds_read_b128 v[32:35], v60 offset:10240
    v_accvgpr_read_b32 v239, a158
    v_mfma_f32_16x16x32_bf16 a[128:131], v[184:187], v[44:47], a[128:131]
    buffer_store_dwordx3 v[230:232], v56, s[12:15], s42 offen offset:384 sc0 sc1
    v_accvgpr_read_b32 v240, a162
    v_mfma_f32_16x16x32_bf16 a[176:179], v[188:191], v[44:47], a[176:179]
    ds_read_b128 v[36:39], v60 offset:22528
    v_accvgpr_read_b32 v241, a166
    v_mfma_f32_16x16x32_bf16 a[176:179], v[180:183], v[40:43], a[176:179]
    s_waitcnt lgkmcnt(2)
    v_mul_f32 v236, v236, v134
    v_mul_f32 v237, v237, v134
    v_mul_f32 v238, v238, v134
    v_mul_f32 v239, v239, v134
    v_mul_f32 v240, v240, v134
    v_mfma_f32_16x16x32_bf16 a[132:135], v[80:83], v[24:27], a[132:135]
    ds_read_b128 v[40:43], v60 offset:11264
    v_mul_f32 v241, v241, v134
    v_mfma_f32_16x16x32_bf16 a[132:135], v[88:91], v[28:31], a[132:135]
    v_cvt_pk_bf16_f32 v236, v236, v237
    v_cvt_pk_bf16_f32 v237, v238, v239
    v_cvt_pk_bf16_f32 v238, v240, v241
    v_accvgpr_read_b32 v242, a147
    v_accvgpr_read_b32 v243, a151
    v_accvgpr_read_b32 v244, a155
    v_mfma_f32_16x16x32_bf16 a[180:183], v[92:95], v[28:31], a[180:183]
    ds_read_b128 v[44:47], v60 offset:23552
    v_accvgpr_read_b32 v245, a159
    v_mfma_f32_16x16x32_bf16 a[180:183], v[84:87], v[24:27], a[180:183]
    s_waitcnt lgkmcnt(2)
    buffer_store_dwordx3 v[236:238], v56, s[12:15], s42 offen offset:768 sc0 sc1
    v_accvgpr_read_b32 v246, a163
    v_mfma_f32_16x16x32_bf16 a[136:139], v[80:83], v[32:35], a[136:139]
    ds_read_b128 v[24:27], v1 offset:9216
    v_accvgpr_read_b32 v96, a120
    v_mfma_f32_16x16x32_bf16 a[136:139], v[88:91], v[36:39], a[136:139]
    v_accvgpr_read_b32 v97, a124
    v_accvgpr_read_b32 v98, a128
    v_mul_f32 v96, v96, v128
    v_mul_f32 v97, v97, v128
    v_mul_f32 v98, v98, v128
    v_mfma_f32_16x16x32_bf16 a[184:187], v[92:95], v[36:39], a[184:187]
    ds_read_b128 v[28:31], v1 offset:21504
    v_accvgpr_read_b32 v102, a121
    v_mfma_f32_16x16x32_bf16 a[184:187], v[84:87], v[32:35], a[184:187]
    s_waitcnt lgkmcnt(2)
    v_accvgpr_read_b32 v103, a125
    v_accvgpr_read_b32 v104, a129
    v_mul_f32 v102, v102, v129
    v_mul_f32 v103, v103, v129
    v_mul_f32 v104, v104, v129
    v_accvgpr_read_b32 v108, a122
    v_mfma_f32_16x16x32_bf16 a[140:143], v[80:83], v[40:43], a[140:143]
    ds_read_b128 v[32:35], v1 offset:10240
    v_accvgpr_read_b32 v109, a126
    v_mfma_f32_16x16x32_bf16 a[140:143], v[88:91], v[44:47], a[140:143]
    v_accvgpr_read_b32 v110, a130
    v_mul_f32 v108, v108, v130
    v_mul_f32 v109, v109, v130
    v_mul_f32 v110, v110, v130
    v_accvgpr_read_b32 v114, a123
    v_mfma_f32_16x16x32_bf16 a[188:191], v[92:95], v[44:47], a[188:191]
    ds_read_b128 v[36:39], v1 offset:22528
    v_accvgpr_read_b32 v115, a127
    v_mfma_f32_16x16x32_bf16 a[188:191], v[84:87], v[40:43], a[188:191]
    s_waitcnt lgkmcnt(2)
    v_accvgpr_read_b32 v116, a131
    v_mul_f32 v114, v114, v131
    v_mul_f32 v115, v115, v131
    v_mul_f32 v116, v116, v131
    v_accvgpr_read_b32 v120, a168
    v_mfma_f32_16x16x32_bf16 a[132:135], v[160:163], v[24:27], a[132:135]
    ds_read_b128 v[40:43], v1 offset:11264
    v_accvgpr_read_b32 v121, a172
    v_mfma_f32_16x16x32_bf16 a[132:135], v[168:171], v[28:31], a[132:135]
    v_accvgpr_read_b32 v122, a176
    v_mul_f32 v120, v120, v132
    v_mul_f32 v121, v121, v132
    v_mul_f32 v122, v122, v132
    v_accvgpr_read_b32 v64, a169
    v_accvgpr_read_b32 v65, a173
    v_mfma_f32_16x16x32_bf16 a[180:183], v[172:175], v[28:31], a[180:183]
    ds_read_b128 v[44:47], v1 offset:23552
    v_accvgpr_read_b32 v66, a177
    v_mfma_f32_16x16x32_bf16 a[180:183], v[164:167], v[24:27], a[180:183]
    s_waitcnt lgkmcnt(2)
    v_mul_f32 v64, v64, v133
    v_mul_f32 v65, v65, v133
    v_mul_f32 v66, v66, v133
    v_accvgpr_read_b32 v70, a170
    v_accvgpr_read_b32 v71, a174
    v_mfma_f32_16x16x32_bf16 a[136:139], v[160:163], v[32:35], a[136:139]
    ds_read_b128 v[24:27], v59 offset:9216
    v_accvgpr_read_b32 v247, a167
    v_mfma_f32_16x16x32_bf16 a[136:139], v[168:171], v[36:39], a[136:139]
    v_accvgpr_read_b32 v72, a178
    v_mul_f32 v242, v242, v135
    v_mul_f32 v70, v70, v134
    v_mul_f32 v243, v243, v135
    v_mul_f32 v71, v71, v134
    v_mfma_f32_16x16x32_bf16 a[184:187], v[172:175], v[36:39], a[184:187]
    ds_read_b128 v[28:31], v59 offset:21504
    v_mul_f32 v244, v244, v135
    v_mfma_f32_16x16x32_bf16 a[184:187], v[164:167], v[32:35], a[184:187]
    s_waitcnt lgkmcnt(2)
    v_mul_f32 v72, v72, v134
    v_mul_f32 v245, v245, v135
    v_accvgpr_read_b32 v144, a171
    v_mul_f32 v246, v246, v135
    v_accvgpr_read_b32 v145, a175
    v_mul_f32 v247, v247, v135
    v_mfma_f32_16x16x32_bf16 a[140:143], v[160:163], v[40:43], a[140:143]
    ds_read_b128 v[32:35], v59 offset:10240
    v_accvgpr_read_b32 v146, a179
    v_mfma_f32_16x16x32_bf16 a[140:143], v[168:171], v[44:47], a[140:143]
    v_cvt_pk_bf16_f32 v242, v242, v243
    v_mul_f32 v144, v144, v135
    v_cvt_pk_bf16_f32 v243, v244, v245
    v_mul_f32 v145, v145, v135
    v_cvt_pk_bf16_f32 v244, v246, v247
    v_mfma_f32_16x16x32_bf16 a[188:191], v[172:175], v[44:47], a[188:191]
    ds_read_b128 v[36:39], v59 offset:22528
    v_mul_f32 v146, v146, v135
    v_mfma_f32_16x16x32_bf16 a[188:191], v[164:167], v[40:43], a[188:191]
    s_waitcnt lgkmcnt(2)
    buffer_store_dwordx3 v[242:244], v56, s[12:15], s42 offen offset:1152 sc0 sc1
    v_mfma_f32_16x16x32_bf16 a[132:135], v[176:179], v[24:27], a[132:135]
    ds_read_b128 v[40:43], v59 offset:11264
    v_mfma_f32_16x16x32_bf16 a[132:135], v[184:187], v[28:31], a[132:135]
    v_mfma_f32_16x16x32_bf16 a[180:183], v[188:191], v[28:31], a[180:183]
    ds_read_b128 v[44:47], v59 offset:23552
    v_mfma_f32_16x16x32_bf16 a[180:183], v[180:183], v[24:27], a[180:183]
    s_waitcnt lgkmcnt(2)
    v_mfma_f32_16x16x32_bf16 a[136:139], v[176:179], v[32:35], a[136:139]
    v_mfma_f32_16x16x32_bf16 a[136:139], v[184:187], v[36:39], a[136:139]
    v_mfma_f32_16x16x32_bf16 a[184:187], v[188:191], v[36:39], a[184:187]
    v_mfma_f32_16x16x32_bf16 a[184:187], v[180:183], v[32:35], a[184:187]
    s_waitcnt lgkmcnt(0)
    v_mfma_f32_16x16x32_bf16 a[140:143], v[176:179], v[40:43], a[140:143]
    v_mfma_f32_16x16x32_bf16 a[140:143], v[184:187], v[44:47], a[140:143]
    v_mfma_f32_16x16x32_bf16 a[188:191], v[188:191], v[44:47], a[188:191]
    v_mfma_f32_16x16x32_bf16 a[188:191], v[180:183], v[40:43], a[188:191]
    s_nop 7
    v_accvgpr_read_b32 v99, a132
    v_accvgpr_read_b32 v100, a136
    v_accvgpr_read_b32 v101, a140
    v_cvt_pk_bf16_f32 v96, v96, v97
    v_mul_f32 v99, v99, v128
    v_mul_f32 v100, v100, v128
    v_mul_f32 v101, v101, v128
    v_cvt_pk_bf16_f32 v97, v98, v99
    v_cvt_pk_bf16_f32 v98, v100, v101
    buffer_store_dwordx3 v[96:98], v56, s[12:15], s41 offen offset:192 sc0 sc1
    v_accvgpr_read_b32 v105, a133
    v_accvgpr_read_b32 v106, a137
    v_accvgpr_read_b32 v107, a141
    v_cvt_pk_bf16_f32 v102, v102, v103
    v_mul_f32 v105, v105, v129
    v_mul_f32 v106, v106, v129
    v_mul_f32 v107, v107, v129
    v_cvt_pk_bf16_f32 v103, v104, v105
    v_cvt_pk_bf16_f32 v104, v106, v107
    buffer_store_dwordx3 v[102:104], v56, s[12:15], s41 offen offset:576 sc0 sc1
    v_accvgpr_read_b32 v111, a134
    v_accvgpr_read_b32 v112, a138
    v_accvgpr_read_b32 v113, a142
    v_cvt_pk_bf16_f32 v108, v108, v109
    v_mul_f32 v111, v111, v130
    v_mul_f32 v112, v112, v130
    v_mul_f32 v113, v113, v130
    v_cvt_pk_bf16_f32 v109, v110, v111
    v_cvt_pk_bf16_f32 v110, v112, v113
    buffer_store_dwordx3 v[108:110], v56, s[12:15], s41 offen offset:960 sc0 sc1
    v_accvgpr_read_b32 v117, a135
    v_accvgpr_read_b32 v118, a139
    v_accvgpr_read_b32 v119, a143
    v_cvt_pk_bf16_f32 v114, v114, v115
    v_mul_f32 v117, v117, v131
    v_mul_f32 v118, v118, v131
    v_mul_f32 v119, v119, v131
    v_cvt_pk_bf16_f32 v115, v116, v117
    v_cvt_pk_bf16_f32 v116, v118, v119
    buffer_store_dwordx3 v[114:116], v56, s[12:15], s41 offen offset:1344 sc0 sc1
    v_accvgpr_read_b32 v123, a180
    v_accvgpr_read_b32 v124, a184
    v_accvgpr_read_b32 v125, a188
    v_cvt_pk_bf16_f32 v120, v120, v121
    v_mul_f32 v123, v123, v132
    v_mul_f32 v124, v124, v132
    v_mul_f32 v125, v125, v132
    v_cvt_pk_bf16_f32 v121, v122, v123
    v_cvt_pk_bf16_f32 v122, v124, v125
    buffer_store_dwordx3 v[120:122], v56, s[12:15], s42 offen offset:192 sc0 sc1
    v_accvgpr_read_b32 v67, a181
    v_accvgpr_read_b32 v68, a185
    v_accvgpr_read_b32 v69, a189
    v_cvt_pk_bf16_f32 v64, v64, v65
    v_mul_f32 v67, v67, v133
    v_mul_f32 v68, v68, v133
    v_mul_f32 v69, v69, v133
    v_cvt_pk_bf16_f32 v65, v66, v67
    v_cvt_pk_bf16_f32 v66, v68, v69
    buffer_store_dwordx3 v[64:66], v56, s[12:15], s42 offen offset:576 sc0 sc1
    v_accvgpr_read_b32 v73, a182
    v_accvgpr_read_b32 v74, a186
    v_accvgpr_read_b32 v75, a190
    v_cvt_pk_bf16_f32 v70, v70, v71
    v_mul_f32 v73, v73, v134
    v_mul_f32 v74, v74, v134
    v_mul_f32 v75, v75, v134
    v_cvt_pk_bf16_f32 v71, v72, v73
    v_cvt_pk_bf16_f32 v72, v74, v75
    buffer_store_dwordx3 v[70:72], v56, s[12:15], s42 offen offset:960 sc0 sc1
    v_accvgpr_read_b32 v147, a183
    v_accvgpr_read_b32 v148, a187
    v_accvgpr_read_b32 v149, a191
    v_cvt_pk_bf16_f32 v144, v144, v145
    v_mul_f32 v147, v147, v135
    v_mul_f32 v148, v148, v135
    v_mul_f32 v149, v149, v135
    v_cvt_pk_bf16_f32 v145, v146, v147
    v_cvt_pk_bf16_f32 v146, v148, v149
    buffer_store_dwordx3 v[144:146], v56, s[12:15], s42 offen offset:1344 sc0 sc1
L_fin:
L_done:
    s_endpgm
L_pollslow0:
    s_mov_b32 s59, 60
L_pollsm0:
    s_buffer_load_dwordx8 s[48:55], s[20:23], s44 glc
    s_waitcnt lgkmcnt(0)
    s_sub_u32 s48, s48, s92
    s_sub_u32 s49, s49, s92
    s_sub_u32 s50, s50, s92
    s_sub_u32 s51, s51, s92
    s_sub_u32 s52, s52, s92
    s_sub_u32 s53, s53, s92
    s_sub_u32 s54, s54, s92
    s_sub_u32 s55, s55, s92
    s_max_u32 s48, s48, s49
    s_max_u32 s48, s48, s50
    s_max_u32 s48, s48, s51
    s_max_u32 s48, s48, s52
    s_max_u32 s48, s48, s53
    s_max_u32 s48, s48, s54
    s_max_u32 s48, s48, s55
    s_cmp_lt_u32 s48, 16
    s_cbranch_scc1 L_pollok0
    s_sub_u32 s59, s59, 1
    s_cbranch_scc1 L_pollvec0
    s_sleep 1
    s_branch L_pollsm0
L_pollvec0:
    v_bfe_u32 v53, v4, 4, 6
    v_lshlrev_b32 v53, 2, v53
    s_sub_u32 s96, s96, 1
    s_cbranch_scc1 L_pollgiveup0
    s_sleep 2
    buffer_load_dword v52, v53, s[20:23], s44 offen sc1
    s_waitcnt vmcnt(0)
    s_bitcmp1_b32 s92, 9
    s_cbranch_scc1 L_nomix
    v_xor_b32 v53, s92, v52
    v_lshrrev_b32 v53, 5, v53
    v_add_u32 v53, -1, v53
    v_cmp_gt_u32 vcc, 31, v53
    s_nop 1
    s_and_b32 s59, vcc_lo, 0xff
    s_cbranch_scc0 L_nomix
    buffer_store_dwordx4 v[224:227], v11, s[4:7], s33 offen offset:0 sc1
    v_xor_b32 v55, 16, v11
    buffer_store_dwordx4 v[228:231], v55, s[4:7], s33 offen offset:768 sc1
    v_xor_b32 v54, 32, v11
    buffer_store_dwordx4 v[232:235], v54, s[4:7], s33 offen offset:1536 sc1
    v_xor_b32 v55, 48, v11
    buffer_store_dwordx4 v[236:239], v55, s[4:7], s33 offen offset:2304 sc1
    buffer_store_dwordx4 v[112:115], v15, s[4:7], s35 offen offset:0 sc1
    buffer_store_dwordx4 v[116:119], v15, s[4:7], s35 offen offset:1024 sc1
    buffer_store_dwordx4 v[120:123], v15, s[4:7], s35 offen offset:2048 sc1
    s_waitcnt vmcnt(0)
    s_barrier
    s_and_b32 s92, s92, 0xfffffc00
    s_add_u32 s92, s92, 512
    v_mov_b32 v0, s92
    s_add_u32 s92, s92, 1
    s_mov_b32 s44, 32
    v_add_u32 v0, 1, v0
    buffer_store_dword v0, v13, s[20:23], 0 offen offset:32 sc1
    s_branch L_pollvec0
L_nomix:
    v_subrev_u32 v52, s92, v52
    v_cmp_lt_u32 vcc, 15, v52
    s_nop 0
    s_and_b32 s59, vcc_lo, 0xff
    s_cbranch_scc1 L_pollvec0
    s_branch L_pollok0
L_pollgiveup0:
    s_mov_b32 s96, 0
    s_branch L_pollok0
L_pollslow1:
    s_mov_b32 s59, 200
L_pollsm1:
    s_buffer_load_dwordx8 s[48:55], s[20:23], s44 glc
    s_waitcnt lgkmcnt(0)
    s_sub_u32 s48, s48, s92
    s_sub_u32 s49, s49, s92
    s_sub_u32 s50, s50, s92
    s_sub_u32 s51, s51, s92
    s_sub_u32 s52, s52, s92
    s_sub_u32 s53, s53, s92
    s_sub_u32 s54, s54, s92
    s_sub_u32 s55, s55, s92
    s_max_u32 s48, s48, s49
    s_max_u32 s48, s48, s50
    s_max_u32 s48, s48, s51
    s_max_u32 s48, s48, s52
    s_max_u32 s48, s48, s53
    s_max_u32 s48, s48, s54
    s_max_u32 s48, s48, s55
    s_cmp_lt_u32 s48, 16
    s_cbranch_scc1 L_pollok1
    s_sub_u32 s59, s59, 1
    s_cbranch_scc1 L_pollvec1
    s_sleep 1
    s_branch L_pollsm1
L_pollvec1:
    v_bfe_u32 v53, v4, 4, 6
    v_lshlrev_b32 v53, 2, v53
    s_sub_u32 s96, s96, 1
    s_cbranch_scc1 L_pollgiveup1
    s_sleep 2
    buffer_load_dword v52, v53, s[20:23], s44 offen sc1
    s_waitcnt vmcnt(0)
    v_subrev_u32 v52, s92, v52
    v_cmp_lt_u32 vcc, 15, v52
    s_nop 0
    s_and_b32 s59, vcc_lo, 0xff
    s_cbranch_scc1 L_pollvec1
    s_branch L_pollok1
L_pollgiveup1:
    s_mov_b32 s96, 0
    s_branch L_pollok1
L_pollslow2:
    s_mov_b32 s59, 200
L_pollsm2:
    s_buffer_load_dwordx8 s[48:55], s[20:23], s44 glc
    s_waitcnt lgkmcnt(0)
    s_sub_u32 s48, s48, s92
    s_sub_u32 s49, s49, s92
    s_sub_u32 s50, s50, s92
    s_sub_u32 s51, s51, s92
    s_sub_u32 s52, s52, s92
    s_sub_u32 s53, s53, s92
    s_sub_u32 s54, s54, s92
    s_sub_u32 s55, s55, s92
    s_max_u32 s48, s48, s49
    s_max_u32 s48, s48, s50
    s_max_u32 s48, s48, s51
    s_max_u32 s48, s48, s52
    s_max_u32 s48, s48, s53
    s_max_u32 s48, s48, s54
    s_max_u32 s48, s48, s55
    s_cmp_lt_u32 s48, 16
    s_cbranch_scc1 L_pollok2
    s_sub_u32 s59, s59, 1
    s_cbranch_scc1 L_pollvec2
    s_sleep 1
    s_branch L_pollsm2
L_pollvec2:
    v_bfe_u32 v53, v4, 4, 6
    v_lshlrev_b32 v53, 2, v53
    s_sub_u32 s96, s96, 1
    s_cbranch_scc1 L_pollgiveup2
    s_sleep 2
    buffer_load_dword v52, v53, s[20:23], s44 offen sc1
    s_waitcnt vmcnt(0)
    v_subrev_u32 v52, s92, v52
    v_cmp_lt_u32 vcc, 15, v52
    s_nop 0
    s_and_b32 s59, vcc_lo, 0xff
    s_cbranch_scc1 L_pollvec2
    s_branch L_pollok2
L_pollgiveup2:
    s_mov_b32 s96, 0
    s_branch L_pollok2
L_pollslow3:
    s_mov_b32 s59, 200
L_pollsm3:
    s_buffer_load_dwordx8 s[48:55], s[20:23], s44 glc
    s_waitcnt lgkmcnt(0)
    s_sub_u32 s48, s48, s92
    s_sub_u32 s49, s49, s92
    s_sub_u32 s50, s50, s92
    s_sub_u32 s51, s51, s92
    s_sub_u32 s52, s52, s92
    s_sub_u32 s53, s53, s92
    s_sub_u32 s54, s54, s92
    s_sub_u32 s55, s55, s92
    s_max_u32 s48, s48, s49
    s_max_u32 s48, s48, s50
    s_max_u32 s48, s48, s51
    s_max_u32 s48, s48, s52
    s_max_u32 s48, s48, s53
    s_max_u32 s48, s48, s54
    s_max_u32 s48, s48, s55
    s_cmp_lt_u32 s48, 16
    s_cbranch_scc1 L_pollok3
    s_sub_u32 s59, s59, 1
    s_cbranch_scc1 L_pollvec3
    s_sleep 1
    s_branch L_pollsm3
L_pollvec3:
    v_bfe_u32 v53, v4, 4, 6
    v_lshlrev_b32 v53, 2, v53
    s_sub_u32 s96, s96, 1
    s_cbranch_scc1 L_pollgiveup3
    s_sleep 2
    buffer_load_dword v52, v53, s[20:23], s44 offen sc1
    s_waitcnt vmcnt(0)
    v_subrev_u32 v52, s92, v52
    v_cmp_lt_u32 vcc, 15, v52
    s_nop 0
    s_and_b32 s59, vcc_lo, 0xff
    s_cbranch_scc1 L_pollvec3
    s_branch L_pollok3
L_pollgiveup3:
    s_mov_b32 s96, 0
    s_branch L_pollok3
L_pollslow4:
    s_mov_b32 s59, 200
L_pollsm4:
    s_buffer_load_dwordx8 s[48:55], s[20:23], s44 glc
    s_waitcnt lgkmcnt(0)
    s_sub_u32 s48, s48, s92
    s_sub_u32 s49, s49, s92
    s_sub_u32 s50, s50, s92
    s_sub_u32 s51, s51, s92
    s_sub_u32 s52, s52, s92
    s_sub_u32 s53, s53, s92
    s_sub_u32 s54, s54, s92
    s_sub_u32 s55, s55, s92
    s_max_u32 s48, s48, s49
    s_max_u32 s48, s48, s50
    s_max_u32 s48, s48, s51
    s_max_u32 s48, s48, s52
    s_max_u32 s48, s48, s53
    s_max_u32 s48, s48, s54
    s_max_u32 s48, s48, s55
    s_cmp_lt_u32 s48, 16
    s_cbranch_scc1 L_pollok4
    s_sub_u32 s59, s59, 1
    s_cbranch_scc1 L_pollvec4
    s_sleep 1
    s_branch L_pollsm4
L_pollvec4:
    v_bfe_u32 v53, v4, 4, 6
    v_lshlrev_b32 v53, 2, v53
    s_sub_u32 s96, s96, 1
    s_cbranch_scc1 L_pollgiveup4
    s_sleep 2
    buffer_load_dword v52, v53, s[20:23], s44 offen sc1
    s_waitcnt vmcnt(0)
    v_subrev_u32 v52, s92, v52
    v_cmp_lt_u32 vcc, 15, v52
    s_nop 0
    s_and_b32 s59, vcc_lo, 0xff
    s_cbranch_scc1 L_pollvec4
    s_branch L_pollok4
L_pollgiveup4:
    s_mov_b32 s96, 0
    s_branch L_pollok4
L_tagslow:
    s_sub_u32 s96, s96, 1
    s_cbranch_scc1 L_taggiveup
    s_sleep 2
    buffer_load_dword v0, off, s[88:91], s93 sc1
    s_waitcnt vmcnt(0)
    v_readfirstlane_b32 s42, v0
    s_nop 0
    s_cmp_eq_u32 s42, s46
    s_cbranch_scc1 L_tagslow
    s_cmp_eq_u32 s42, 0
    s_cbranch_scc1 L_tagslow
    s_branch L_tagok
L_taggiveup:
    s_mov_b32 s96, 0
    s_branch L_tagok
L_slow:
    s_waitcnt vmcnt(0) lgkmcnt(0)
    s_nop 15
    v_accvgpr_write_b32 a0, 0
    v_accvgpr_write_b32 a1, 0
    v_accvgpr_write_b32 a2, 0
    v_accvgpr_write_b32 a3, 0
    v_accvgpr_write_b32 a4, 0
    v_accvgpr_write_b32 a5, 0
    v_accvgpr_write_b32 a6, 0
    v_accvgpr_write_b32 a7, 0
    v_accvgpr_write_b32 a8, 0
    v_accvgpr_write_b32 a9, 0
    v_accvgpr_write_b32 a10, 0
    v_accvgpr_write_b32 a11, 0
    v_accvgpr_write_b32 a12, 0
    v_accvgpr_write_b32 a13, 0
    v_accvgpr_write_b32 a14, 0
    v_accvgpr_write_b32 a15, 0
    v_accvgpr_write_b32 a16, 0
    v_accvgpr_write_b32 a17, 0
    v_accvgpr_write_b32 a18, 0
    v_accvgpr_write_b32 a19, 0
    v_accvgpr_write_b32 a20, 0
    v_accvgpr_write_b32 a21, 0
    v_accvgpr_write_b32 a22, 0
    v_accvgpr_write_b32 a23, 0
    v_accvgpr_write_b32 a24, 0
    v_accvgpr_write_b32 a25, 0
    v_accvgpr_write_b32 a26, 0
    v_accvgpr_write_b32 a27, 0
    v_accvgpr_write_b32 a28, 0
    v_accvgpr_write_b32 a29, 0
    v_accvgpr_write_b32 a30, 0
    v_accvgpr_write_b32 a31, 0
    v_accvgpr_write_b32 a32, 0
    v_accvgpr_write_b32 a33, 0
    v_accvgpr_write_b32 a34, 0
    v_accvgpr_write_b32 a35, 0
    v_accvgpr_write_b32 a36, 0
    v_accvgpr_write_b32 a37, 0
    v_accvgpr_write_b32 a38, 0
    v_accvgpr_write_b32 a39, 0
    v_accvgpr_write_b32 a40, 0
    v_accvgpr_write_b32 a41, 0
    v_accvgpr_write_b32 a42, 0
    v_accvgpr_write_b32 a43, 0
    v_accvgpr_write_b32 a44, 0
    v_accvgpr_write_b32 a45, 0
    v_accvgpr_write_b32 a46, 0
    v_accvgpr_write_b32 a47, 0
    v_accvgpr_write_b32 a48, 0
    v_accvgpr_write_b32 a49, 0
    v_accvgpr_write_b32 a50, 0
    v_accvgpr_write_b32 a51, 0
    v_accvgpr_write_b32 a52, 0
    v_accvgpr_write_b32 a53, 0
    v_accvgpr_write_b32 a54, 0
    v_accvgpr_write_b32 a55, 0
    v_accvgpr_write_b32 a56, 0
    v_accvgpr_write_b32 a57, 0
    v_accvgpr_write_b32 a58, 0
    v_accvgpr_write_b32 a59, 0
    v_accvgpr_write_b32 a60, 0
    v_accvgpr_write_b32 a61, 0
    v_accvgpr_write_b32 a62, 0
    v_accvgpr_write_b32 a63, 0
    v_accvgpr_write_b32 a64, 0
    v_accvgpr_write_b32 a65, 0
    v_accvgpr_write_b32 a66, 0
    v_accvgpr_write_b32 a67, 0
    v_accvgpr_write_b32 a68, 0
    v_accvgpr_write_b32 a69, 0
    v_accvgpr_write_b32 a70, 0
    v_accvgpr_write_b32 a71, 0
    v_accvgpr_write_b32 a72, 0
    v_accvgpr_write_b32 a73, 0
    v_accvgpr_write_b32 a74, 0
    v_accvgpr_write_b32 a75, 0
    v_accvgpr_write_b32 a76, 0
    v_accvgpr_write_b32 a77, 0
    v_accvgpr_write_b32 a78, 0
    v_accvgpr_write_b32 a79, 0
    v_accvgpr_write_b32 a80, 0
    v_accvgpr_write_b32 a81, 0
    v_accvgpr_write_b32 a82, 0
    v_accvgpr_write_b32 a83, 0
    v_accvgpr_write_b32 a84, 0
    v_accvgpr_write_b32 a85, 0
    v_accvgpr_write_b32 a86, 0
    v_accvgpr_write_b32 a87, 0
    v_accvgpr_write_b32 a88, 0
    v_accvgpr_write_b32 a89, 0
    v_accvgpr_write_b32 a90, 0
    v_accvgpr_write_b32 a91, 0
    v_accvgpr_write_b32 a92, 0
    v_accvgpr_write_b32 a93, 0
    v_accvgpr_write_b32 a94, 0
    v_accvgpr_write_b32 a95, 0
    v_accvgpr_write_b32 a96, 0
    v_accvgpr_write_b32 a97, 0
    v_accvgpr_write_b32 a98, 0
    v_accvgpr_write_b32 a99, 0
    v_accvgpr_write_b32 a100, 0
    v_accvgpr_write_b32 a101, 0
    v_accvgpr_write_b32 a102, 0
    v_accvgpr_write_b32 a103, 0
    v_accvgpr_write_b32 a104, 0
    v_accvgpr_write_b32 a105, 0
    v_accvgpr_write_b32 a106, 0
    v_accvgpr_write_b32 a107, 0
    v_accvgpr_write_b32 a108, 0
    v_accvgpr_write_b32 a109, 0
    v_accvgpr_write_b32 a110, 0
    v_accvgpr_write_b32 a111, 0
    v_accvgpr_write_b32 a112, 0
    v_accvgpr_write_b32 a113, 0
    v_accvgpr_write_b32 a114, 0
    v_accvgpr_write_b32 a115, 0
    v_accvgpr_write_b32 a116, 0
    v_accvgpr_write_b32 a117, 0
    v_accvgpr_write_b32 a118, 0
    v_accvgpr_write_b32 a119, 0
    v_accvgpr_write_b32 a120, 0
    v_accvgpr_write_b32 a121, 0
    v_accvgpr_write_b32 a122, 0
    v_accvgpr_write_b32 a123, 0
    v_accvgpr_write_b32 a124, 0
    v_accvgpr_write_b32 a125, 0
    v_accvgpr_write_b32 a126, 0
    v_accvgpr_write_b32 a127, 0
    v_accvgpr_write_b32 a128, 0
    v_accvgpr_write_b32 a129, 0
    v_accvgpr_write_b32 a130, 0
    v_accvgpr_write_b32 a131, 0
    v_accvgpr_write_b32 a132, 0
    v_accvgpr_write_b32 a133, 0
    v_accvgpr_write_b32 a134, 0
    v_accvgpr_write_b32 a135, 0
    v_accvgpr_write_b32 a136, 0
    v_accvgpr_write_b32 a137, 0
    v_accvgpr_write_b32 a138, 0
    v_accvgpr_write_b32 a139, 0
    v_accvgpr_write_b32 a140, 0
    v_accvgpr_write_b32 a141, 0
    v_accvgpr_write_b32 a142, 0
    v_accvgpr_write_b32 a143, 0
    v_accvgpr_write_b32 a144, 0
    v_accvgpr_write_b32 a145, 0
    v_accvgpr_write_b32 a146, 0
    v_accvgpr_write_b32 a147, 0
    v_accvgpr_write_b32 a148, 0
    v_accvgpr_write_b32 a149, 0
    v_accvgpr_write_b32 a150, 0
    v_accvgpr_write_b32 a151, 0
    v_accvgpr_write_b32 a152, 0
    v_accvgpr_write_b32 a153, 0
    v_accvgpr_write_b32 a154, 0
    v_accvgpr_write_b32 a155, 0
    v_accvgpr_write_b32 a156, 0
    v_accvgpr_write_b32 a157, 0
    v_accvgpr_write_b32 a158, 0
    v_accvgpr_write_b32 a159, 0
    v_accvgpr_write_b32 a160, 0
    v_accvgpr_write_b32 a161, 0
    v_accvgpr_write_b32 a162, 0
    v_accvgpr_write_b32 a163, 0
    v_accvgpr_write_b32 a164, 0
    v_accvgpr_write_b32 a165, 0
    v_accvgpr_write_b32 a166, 0
    v_accvgpr_write_b32 a167, 0
    v_accvgpr_write_b32 a168, 0
    v_accvgpr_write_b32 a169, 0
    v_accvgpr_write_b32 a170, 0
    v_accvgpr_write_b32 a171, 0
    v_accvgpr_write_b32 a172, 0
    v_accvgpr_write_b32 a173, 0
    v_accvgpr_write_b32 a174, 0
    v_accvgpr_write_b32 a175, 0
    v_accvgpr_write_b32 a176, 0
    v_accvgpr_write_b32 a177, 0
    v_accvgpr_write_b32 a178, 0
    v_accvgpr_write_b32 a179, 0
    v_accvgpr_write_b32 a180, 0
    v_accvgpr_write_b32 a181, 0
    v_accvgpr_write_b32 a182, 0
    v_accvgpr_write_b32 a183, 0
    v_accvgpr_write_b32 a184, 0
    v_accvgpr_write_b32 a185, 0
    v_accvgpr_write_b32 a186, 0
    v_accvgpr_write_b32 a187, 0
    v_accvgpr_write_b32 a188, 0
    v_accvgpr_write_b32 a189, 0
    v_accvgpr_write_b32 a190, 0
    v_accvgpr_write_b32 a191, 0
    v_mov_b32 v5, 0
    v_mov_b32 v240, 0xff7fffff
    v_mov_b32 v6, 0
    v_mov_b32 v241, 0xff7fffff
    v_mov_b32 v7, 0
    v_mov_b32 v242, 0xff7fffff
    v_mov_b32 v8, 0
    v_mov_b32 v243, 0xff7fffff
    v_subrev_u32 v244, 49152, v2
    v_subrev_u32 v245, 49152, v3
    v_subrev_u32 v246, 24576, v1
    s_mov_b32 s48, 0
L_slowloop:
    s_add_u32 s49, s48, 6144
    s_add_u32 s50, s48, 12288
    s_add_u32 s51, s48, 16384
    s_add_u32 s52, s48, 20480
    buffer_load_dwordx4 v[64:67], v244, s[4:7], s48 offen offset:0 sc1
    buffer_load_dwordx4 v[68:71], v245, s[4:7], s48 offen offset:0 sc1
    buffer_load_dwordx4 v[72:75], v244, s[4:7], s49 offen offset:0 sc1
    buffer_load_dwordx4 v[76:79], v245, s[4:7], s49 offen offset:0 sc1
    buffer_load_dwordx4 v[80:83], v244, s[4:7], s48 offen offset:128 sc1
    buffer_load_dwordx4 v[84:87], v245, s[4:7], s48 offen offset:128 sc1
    buffer_load_dwordx4 v[88:91], v244, s[4:7], s49 offen offset:128 sc1
    buffer_load_dwordx4 v[92:95], v245, s[4:7], s49 offen offset:128 sc1
    buffer_load_dwordx4 v[96:99], v244, s[4:7], s48 offen offset:256 sc1
    buffer_load_dwordx4 v[100:103], v245, s[4:7], s48 offen offset:256 sc1
    buffer_load_dwordx4 v[104:107], v244, s[4:7], s49 offen offset:256 sc1
    buffer_load_dwordx4 v[108:111], v245, s[4:7], s49 offen offset:256 sc1
    buffer_load_dwordx4 v[112:115], v246, s[4:7], s50 offen offset:0 sc1
    buffer_load_dwordx4 v[116:119], v246, s[4:7], s50 offen offset:1024 sc1
    buffer_load_dwordx4 v[120:123], v246, s[4:7], s50 offen offset:2048 sc1
    buffer_load_dwordx4 v[124:127], v246, s[4:7], s50 offen offset:3072 sc1
    buffer_load_dwordx4 v[128:131], v246, s[4:7], s51 offen offset:0 sc1
    buffer_load_dwordx4 v[132:135], v246, s[4:7], s51 offen offset:1024 sc1
    buffer_load_dwordx4 v[136:139], v246, s[4:7], s51 offen offset:2048 sc1
    buffer_load_dwordx4 v[140:143], v246, s[4:7], s51 offen offset:3072 sc1
    buffer_load_dwordx4 v[144:147], v246, s[4:7], s52 offen offset:0 sc1
    buffer_load_dwordx4 v[148:151], v246, s[4:7], s52 offen offset:1024 sc1
    buffer_load_dwordx4 v[152:155], v246, s[4:7], s52 offen offset:2048 sc1
    buffer_load_dwordx4 v[156:159], v246, s[4:7], s52 offen offset:3072 sc1
    s_waitcnt vmcnt(12)
    v_mfma_f32_16x16x32_bf16 v[160:163], v[64:67], a[192:195], 0
    v_mfma_f32_16x16x32_bf16 v[168:171], v[64:67], a[216:219], 0
    v_mfma_f32_16x16x32_bf16 v[176:179], v[64:67], a[240:243], 0
    v_mfma_f32_16x16x32_bf16 v[184:187], v[64:67], v[200:203], 0
    v_mfma_f32_16x16x32_bf16 v[160:163], v[68:71], a[196:199], v[160:163]
    v_mfma_f32_16x16x32_bf16 v[168:171], v[68:71], a[220:223], v[168:171]
    v_mfma_f32_16x16x32_bf16 v[176:179], v[68:71], a[244:247], v[176:179]
    v_mfma_f32_16x16x32_bf16 v[184:187], v[68:71], v[204:207], v[184:187]
    v_mfma_f32_16x16x32_bf16 v[164:167], v[72:75], a[192:195], 0
    v_mfma_f32_16x16x32_bf16 v[172:175], v[72:75], a[216:219], 0
    v_mfma_f32_16x16x32_bf16 v[180:183], v[72:75], a[240:243], 0
    v_mfma_f32_16x16x32_bf16 v[188:191], v[72:75], v[200:203], 0
    v_mfma_f32_16x16x32_bf16 v[164:167], v[76:79], a[196:199], v[164:167]
    v_mfma_f32_16x16x32_bf16 v[172:175], v[76:79], a[220:223], v[172:175]
    v_mfma_f32_16x16x32_bf16 v[180:183], v[76:79], a[244:247], v[180:183]
    v_mfma_f32_16x16x32_bf16 v[188:191], v[76:79], v[204:207], v[188:191]
    v_mfma_f32_16x16x32_bf16 v[160:163], v[80:83], a[200:203], v[160:163]
    v_mfma_f32_16x16x32_bf16 v[168:171], v[80:83], a[224:227], v[168:171]
    v_mfma_f32_16x16x32_bf16 v[176:179], v[80:83], a[248:251], v[176:179]
    v_mfma_f32_16x16x32_bf16 v[184:187], v[80:83], v[208:211], v[184:187]
    v_mfma_f32_16x16x32_bf16 v[160:163], v[84:87], a[204:207], v[160:163]
    v_mfma_f32_16x16x32_bf16 v[168:171], v[84:87], a[228:231], v[168:171]
    v_mfma_f32_16x16x32_bf16 v[176:179], v[84:87], a[252:255], v[176:179]
    v_mfma_f32_16x16x32_bf16 v[184:187], v[84:87], v[212:215], v[184:187]
    v_mfma_f32_16x16x32_bf16 v[164:167], v[88:91], a[200:203], v[164:167]
    v_mfma_f32_16x16x32_bf16 v[172:175], v[88:91], a[224:227], v[172:175]
    v_mfma_f32_16x16x32_bf16 v[180:183], v[88:91], a[248:251], v[180:183]
    v_mfma_f32_16x16x32_bf16 v[188:191], v[88:91], v[208:211], v[188:191]
    v_mfma_f32_16x16x32_bf16 v[164:167], v[92:95], a[204:207], v[164:167]
    v_mfma_f32_16x16x32_bf16 v[172:175], v[92:95], a[228:231], v[172:175]
    v_mfma_f32_16x16x32_bf16 v[180:183], v[92:95], a[252:255], v[180:183]
    v_mfma_f32_16x16x32_bf16 v[188:191], v[92:95], v[212:215], v[188:191]
    v_mfma_f32_16x16x32_bf16 v[160:163], v[96:99], a[208:211], v[160:163]
    v_mfma_f32_16x16x32_bf16 v[168:171], v[96:99], a[232:235], v[168:171]
    v_mfma_f32_16x16x32_bf16 v[176:179], v[96:99], v[192:195], v[176:179]
    v_mfma_f32_16x16x32_bf16 v[184:187], v[96:99], v[216:219], v[184:187]
    v_mfma_f32_16x16x32_bf16 v[160:163], v[100:103], a[212:215], v[160:163]
    v_mfma_f32_16x16x32_bf16 v[168:171], v[100:103], a[236:239], v[168:171]
    v_mfma_f32_16x16x32_bf16 v[176:179], v[100:103], v[196:199], v[176:179]
    v_mfma_f32_16x16x32_bf16 v[184:187], v[100:103], v[220:223], v[184:187]
    v_mfma_f32_16x16x32_bf16 v[164:167], v[104:107], a[208:211], v[164:167]
    v_mfma_f32_16x16x32_bf16 v[172:175], v[104:107], a[232:235], v[172:175]
    v_mfma_f32_16x16x32_bf16 v[180:183], v[104:107], v[192:195], v[180:183]
    v_mfma_f32_16x16x32_bf16 v[188:191], v[104:107], v[216:219], v[188:191]
    v_mfma_f32_16x16x32_bf16 v[164:167], v[108:111], a[212:215], v[164:167]
    v_mfma_f32_16x16x32_bf16 v[172:175], v[108:111], a[236:239], v[172:175]
    v_mfma_f32_16x16x32_bf16 v[180:183], v[108:111], v[196:199], v[180:183]
    v_mfma_f32_16x16x32_bf16 v[188:191], v[108:111], v[220:223], v[188:191]
    s_nop 9
    v_max3_f32 v16, v160, v161, v162
    v_max3_f32 v16, v16, v163, v164
    v_max3_f32 v16, v16, v165, v166
    v_max3_f32 v16, v16, v167, v240
    v_mov_b32 v17, v16
    s_nop 1
    v_permlane16_swap_b32 v16, v17
    s_nop 1
    v_max_f32 v16, v16, v17
    v_mov_b32 v17, v16
    s_nop 1
    v_permlane32_swap_b32 v16, v17
    s_nop 1
    v_max_f32 v16, v16, v17
    v_sub_f32 v17, v240, v16
    v_exp_f32 v17, v17
    v_mov_b32 v240, v16
    v_sub_f32 v160, v160, v16
    v_sub_f32 v161, v161, v16
    v_sub_f32 v162, v162, v16
    v_sub_f32 v163, v163, v16
    v_sub_f32 v164, v164, v16
    v_sub_f32 v165, v165, v16
    v_sub_f32 v166, v166, v16
    v_sub_f32 v167, v167, v16
    v_exp_f32 v160, v160
    v_exp_f32 v161, v161
    v_exp_f32 v162, v162
    v_exp_f32 v163, v163
    v_exp_f32 v164, v164
    v_exp_f32 v165, v165
    v_exp_f32 v166, v166
    v_exp_f32 v167, v167
    v_mul_f32 v5, v5, v17
    v_add_f32 v5, v5, v160
    v_add_f32 v5, v5, v161
    v_add_f32 v5, v5, v162
    v_add_f32 v5, v5, v163
    v_add_f32 v5, v5, v164
    v_add_f32 v5, v5, v165
    v_add_f32 v5, v5, v166
    v_add_f32 v5, v5, v167
    v_cvt_pk_bf16_f32 v224, v160, v161
    v_cvt_pk_bf16_f32 v225, v162, v163
    v_cvt_pk_bf16_f32 v226, v164, v165
    v_cvt_pk_bf16_f32 v227, v166, v167
    ds_bpermute_b32 v248, v58, v17 offset:0
    ds_bpermute_b32 v249, v58, v17 offset:4
    ds_bpermute_b32 v250, v58, v17 offset:8
    ds_bpermute_b32 v251, v58, v17 offset:12
    s_waitcnt lgkmcnt(0)
    v_accvgpr_read_b32 v18, a0
    v_mul_f32 v18, v18, v248
    v_accvgpr_write_b32 a0, v18
    v_accvgpr_read_b32 v19, a1
    v_mul_f32 v19, v19, v249
    v_accvgpr_write_b32 a1, v19
    v_accvgpr_read_b32 v18, a2
    v_mul_f32 v18, v18, v250
    v_accvgpr_write_b32 a2, v18
    v_accvgpr_read_b32 v19, a3
    v_mul_f32 v19, v19, v251
    v_accvgpr_write_b32 a3, v19
    v_accvgpr_read_b32 v18, a4
    v_mul_f32 v18, v18, v248
    v_accvgpr_write_b32 a4, v18
    v_accvgpr_read_b32 v19, a5
    v_mul_f32 v19, v19, v249
    v_accvgpr_write_b32 a5, v19
    v_accvgpr_read_b32 v18, a6
    v_mul_f32 v18, v18, v250
    v_accvgpr_write_b32 a6, v18
    v_accvgpr_read_b32 v19, a7
    v_mul_f32 v19, v19, v251
    v_accvgpr_write_b32 a7, v19
    v_accvgpr_read_b32 v18, a8
    v_mul_f32 v18, v18, v248
    v_accvgpr_write_b32 a8, v18
    v_accvgpr_read_b32 v19, a9
    v_mul_f32 v19, v19, v249
    v_accvgpr_write_b32 a9, v19
    v_accvgpr_read_b32 v18, a10
    v_mul_f32 v18, v18, v250
    v_accvgpr_write_b32 a10, v18
    v_accvgpr_read_b32 v19, a11
    v_mul_f32 v19, v19, v251
    v_accvgpr_write_b32 a11, v19
    v_accvgpr_read_b32 v18, a12
    v_mul_f32 v18, v18, v248
    v_accvgpr_write_b32 a12, v18
    v_accvgpr_read_b32 v19, a13
    v_mul_f32 v19, v19, v249
    v_accvgpr_write_b32 a13, v19
    v_accvgpr_read_b32 v18, a14
    v_mul_f32 v18, v18, v250
    v_accvgpr_write_b32 a14, v18
    v_accvgpr_read_b32 v19, a15
    v_mul_f32 v19, v19, v251
    v_accvgpr_write_b32 a15, v19
    v_accvgpr_read_b32 v18, a16
    v_mul_f32 v18, v18, v248
    v_accvgpr_write_b32 a16, v18
    v_accvgpr_read_b32 v19, a17
    v_mul_f32 v19, v19, v249
    v_accvgpr_write_b32 a17, v19
    v_accvgpr_read_b32 v18, a18
    v_mul_f32 v18, v18, v250
    v_accvgpr_write_b32 a18, v18
    v_accvgpr_read_b32 v19, a19
    v_mul_f32 v19, v19, v251
    v_accvgpr_write_b32 a19, v19
    v_accvgpr_read_b32 v18, a20
    v_mul_f32 v18, v18, v248
    v_accvgpr_write_b32 a20, v18
    v_accvgpr_read_b32 v19, a21
    v_mul_f32 v19, v19, v249
    v_accvgpr_write_b32 a21, v19
    v_accvgpr_read_b32 v18, a22
    v_mul_f32 v18, v18, v250
    v_accvgpr_write_b32 a22, v18
    v_accvgpr_read_b32 v19, a23
    v_mul_f32 v19, v19, v251
    v_accvgpr_write_b32 a23, v19
    v_accvgpr_read_b32 v18, a24
    v_mul_f32 v18, v18, v248
    v_accvgpr_write_b32 a24, v18
    v_accvgpr_read_b32 v19, a25
    v_mul_f32 v19, v19, v249
    v_accvgpr_write_b32 a25, v19
    v_accvgpr_read_b32 v18, a26
    v_mul_f32 v18, v18, v250
    v_accvgpr_write_b32 a26, v18
    v_accvgpr_read_b32 v19, a27
    v_mul_f32 v19, v19, v251
    v_accvgpr_write_b32 a27, v19
    v_accvgpr_read_b32 v18, a28
    v_mul_f32 v18, v18, v248
    v_accvgpr_write_b32 a28, v18
    v_accvgpr_read_b32 v19, a29
    v_mul_f32 v19, v19, v249
    v_accvgpr_write_b32 a29, v19
    v_accvgpr_read_b32 v18, a30
    v_mul_f32 v18, v18, v250
    v_accvgpr_write_b32 a30, v18
    v_accvgpr_read_b32 v19, a31
    v_mul_f32 v19, v19, v251
    v_accvgpr_write_b32 a31, v19
    v_accvgpr_read_b32 v18, a32
    v_mul_f32 v18, v18, v248
    v_accvgpr_write_b32 a32, v18
    v_accvgpr_read_b32 v19, a33
    v_mul_f32 v19, v19, v249
    v_accvgpr_write_b32 a33, v19
    v_accvgpr_read_b32 v18, a34
    v_mul_f32 v18, v18, v250
    v_accvgpr_write_b32 a34, v18
    v_accvgpr_read_b32 v19, a35
    v_mul_f32 v19, v19, v251
    v_accvgpr_write_b32 a35, v19
    v_accvgpr_read_b32 v18, a36
    v_mul_f32 v18, v18, v248
    v_accvgpr_write_b32 a36, v18
    v_accvgpr_read_b32 v19, a37
    v_mul_f32 v19, v19, v249
    v_accvgpr_write_b32 a37, v19
    v_accvgpr_read_b32 v18, a38
    v_mul_f32 v18, v18, v250
    v_accvgpr_write_b32 a38, v18
    v_accvgpr_read_b32 v19, a39
    v_mul_f32 v19, v19, v251
    v_accvgpr_write_b32 a39, v19
    v_accvgpr_read_b32 v18, a40
    v_mul_f32 v18, v18, v248
    v_accvgpr_write_b32 a40, v18
    v_accvgpr_read_b32 v19, a41
    v_mul_f32 v19, v19, v249
    v_accvgpr_write_b32 a41, v19
    v_accvgpr_read_b32 v18, a42
    v_mul_f32 v18, v18, v250
    v_accvgpr_write_b32 a42, v18
    v_accvgpr_read_b32 v19, a43
    v_mul_f32 v19, v19, v251
    v_accvgpr_write_b32 a43, v19
    v_accvgpr_read_b32 v18, a44
    v_mul_f32 v18, v18, v248
    v_accvgpr_write_b32 a44, v18
    v_accvgpr_read_b32 v19, a45
    v_mul_f32 v19, v19, v249
    v_accvgpr_write_b32 a45, v19
    v_accvgpr_read_b32 v18, a46
    v_mul_f32 v18, v18, v250
    v_accvgpr_write_b32 a46, v18
    v_accvgpr_read_b32 v19, a47
    v_mul_f32 v19, v19, v251
    v_accvgpr_write_b32 a47, v19
    v_max3_f32 v16, v168, v169, v170
    v_max3_f32 v16, v16, v171, v172
    v_max3_f32 v16, v16, v173, v174
    v_max3_f32 v16, v16, v175, v241
    v_mov_b32 v17, v16
    s_nop 1
    v_permlane16_swap_b32 v16, v17
    s_nop 1
    v_max_f32 v16, v16, v17
    v_mov_b32 v17, v16
    s_nop 1
    v_permlane32_swap_b32 v16, v17
    s_nop 1
    v_max_f32 v16, v16, v17
    v_sub_f32 v17, v241, v16
    v_exp_f32 v17, v17
    v_mov_b32 v241, v16
    v_sub_f32 v168, v168, v16
    v_sub_f32 v169, v169, v16
    v_sub_f32 v170, v170, v16
    v_sub_f32 v171, v171, v16
    v_sub_f32 v172, v172, v16
    v_sub_f32 v173, v173, v16
    v_sub_f32 v174, v174, v16
    v_sub_f32 v175, v175, v16
    v_exp_f32 v168, v168
    v_exp_f32 v169, v169
    v_exp_f32 v170, v170
    v_exp_f32 v171, v171
    v_exp_f32 v172, v172
    v_exp_f32 v173, v173
    v_exp_f32 v174, v174
    v_exp_f32 v175, v175
    v_mul_f32 v6, v6, v17
    v_add_f32 v6, v6, v168
    v_add_f32 v6, v6, v169
    v_add_f32 v6, v6, v170
    v_add_f32 v6, v6, v171
    v_add_f32 v6, v6, v172
    v_add_f32 v6, v6, v173
    v_add_f32 v6, v6, v174
    v_add_f32 v6, v6, v175
    v_cvt_pk_bf16_f32 v228, v168, v169
    v_cvt_pk_bf16_f32 v229, v170, v171
    v_cvt_pk_bf16_f32 v230, v172, v173
    v_cvt_pk_bf16_f32 v231, v174, v175
    ds_bpermute_b32 v248, v58, v17 offset:0
    ds_bpermute_b32 v249, v58, v17 offset:4
    ds_bpermute_b32 v250, v58, v17 offset:8
    ds_bpermute_b32 v251, v58, v17 offset:12
    s_waitcnt lgkmcnt(0)
    v_accvgpr_read_b32 v18, a48
    v_mul_f32 v18, v18, v248
    v_accvgpr_write_b32 a48, v18
    v_accvgpr_read_b32 v19, a49
    v_mul_f32 v19, v19, v249
    v_accvgpr_write_b32 a49, v19
    v_accvgpr_read_b32 v18, a50
    v_mul_f32 v18, v18, v250
    v_accvgpr_write_b32 a50, v18
    v_accvgpr_read_b32 v19, a51
    v_mul_f32 v19, v19, v251
    v_accvgpr_write_b32 a51, v19
    v_accvgpr_read_b32 v18, a52
    v_mul_f32 v18, v18, v248
    v_accvgpr_write_b32 a52, v18
    v_accvgpr_read_b32 v19, a53
    v_mul_f32 v19, v19, v249
    v_accvgpr_write_b32 a53, v19
    v_accvgpr_read_b32 v18, a54
    v_mul_f32 v18, v18, v250
    v_accvgpr_write_b32 a54, v18
    v_accvgpr_read_b32 v19, a55
    v_mul_f32 v19, v19, v251
    v_accvgpr_write_b32 a55, v19
    v_accvgpr_read_b32 v18, a56
    v_mul_f32 v18, v18, v248
    v_accvgpr_write_b32 a56, v18
    v_accvgpr_read_b32 v19, a57
    v_mul_f32 v19, v19, v249
    v_accvgpr_write_b32 a57, v19
    v_accvgpr_read_b32 v18, a58
    v_mul_f32 v18, v18, v250
    v_accvgpr_write_b32 a58, v18
    v_accvgpr_read_b32 v19, a59
    v_mul_f32 v19, v19, v251
    v_accvgpr_write_b32 a59, v19
    v_accvgpr_read_b32 v18, a60
    v_mul_f32 v18, v18, v248
    v_accvgpr_write_b32 a60, v18
    v_accvgpr_read_b32 v19, a61
    v_mul_f32 v19, v19, v249
    v_accvgpr_write_b32 a61, v19
    v_accvgpr_read_b32 v18, a62
    v_mul_f32 v18, v18, v250
    v_accvgpr_write_b32 a62, v18
    v_accvgpr_read_b32 v19, a63
    v_mul_f32 v19, v19, v251
    v_accvgpr_write_b32 a63, v19
    v_accvgpr_read_b32 v18, a64
    v_mul_f32 v18, v18, v248
    v_accvgpr_write_b32 a64, v18
    v_accvgpr_read_b32 v19, a65
    v_mul_f32 v19, v19, v249
    v_accvgpr_write_b32 a65, v19
    v_accvgpr_read_b32 v18, a66
    v_mul_f32 v18, v18, v250
    v_accvgpr_write_b32 a66, v18
    v_accvgpr_read_b32 v19, a67
    v_mul_f32 v19, v19, v251
    v_accvgpr_write_b32 a67, v19
    v_accvgpr_read_b32 v18, a68
    v_mul_f32 v18, v18, v248
    v_accvgpr_write_b32 a68, v18
    v_accvgpr_read_b32 v19, a69
    v_mul_f32 v19, v19, v249
    v_accvgpr_write_b32 a69, v19
    v_accvgpr_read_b32 v18, a70
    v_mul_f32 v18, v18, v250
    v_accvgpr_write_b32 a70, v18
    v_accvgpr_read_b32 v19, a71
    v_mul_f32 v19, v19, v251
    v_accvgpr_write_b32 a71, v19
    v_accvgpr_read_b32 v18, a72
    v_mul_f32 v18, v18, v248
    v_accvgpr_write_b32 a72, v18
    v_accvgpr_read_b32 v19, a73
    v_mul_f32 v19, v19, v249
    v_accvgpr_write_b32 a73, v19
    v_accvgpr_read_b32 v18, a74
    v_mul_f32 v18, v18, v250
    v_accvgpr_write_b32 a74, v18
    v_accvgpr_read_b32 v19, a75
    v_mul_f32 v19, v19, v251
    v_accvgpr_write_b32 a75, v19
    v_accvgpr_read_b32 v18, a76
    v_mul_f32 v18, v18, v248
    v_accvgpr_write_b32 a76, v18
    v_accvgpr_read_b32 v19, a77
    v_mul_f32 v19, v19, v249
    v_accvgpr_write_b32 a77, v19
    v_accvgpr_read_b32 v18, a78
    v_mul_f32 v18, v18, v250
    v_accvgpr_write_b32 a78, v18
    v_accvgpr_read_b32 v19, a79
    v_mul_f32 v19, v19, v251
    v_accvgpr_write_b32 a79, v19
    v_accvgpr_read_b32 v18, a80
    v_mul_f32 v18, v18, v248
    v_accvgpr_write_b32 a80, v18
    v_accvgpr_read_b32 v19, a81
    v_mul_f32 v19, v19, v249
    v_accvgpr_write_b32 a81, v19
    v_accvgpr_read_b32 v18, a82
    v_mul_f32 v18, v18, v250
    v_accvgpr_write_b32 a82, v18
    v_accvgpr_read_b32 v19, a83
    v_mul_f32 v19, v19, v251
    v_accvgpr_write_b32 a83, v19
    v_accvgpr_read_b32 v18, a84
    v_mul_f32 v18, v18, v248
    v_accvgpr_write_b32 a84, v18
    v_accvgpr_read_b32 v19, a85
    v_mul_f32 v19, v19, v249
    v_accvgpr_write_b32 a85, v19
    v_accvgpr_read_b32 v18, a86
    v_mul_f32 v18, v18, v250
    v_accvgpr_write_b32 a86, v18
    v_accvgpr_read_b32 v19, a87
    v_mul_f32 v19, v19, v251
    v_accvgpr_write_b32 a87, v19
    v_accvgpr_read_b32 v18, a88
    v_mul_f32 v18, v18, v248
    v_accvgpr_write_b32 a88, v18
    v_accvgpr_read_b32 v19, a89
    v_mul_f32 v19, v19, v249
    v_accvgpr_write_b32 a89, v19
    v_accvgpr_read_b32 v18, a90
    v_mul_f32 v18, v18, v250
    v_accvgpr_write_b32 a90, v18
    v_accvgpr_read_b32 v19, a91
    v_mul_f32 v19, v19, v251
    v_accvgpr_write_b32 a91, v19
    v_accvgpr_read_b32 v18, a92
    v_mul_f32 v18, v18, v248
    v_accvgpr_write_b32 a92, v18
    v_accvgpr_read_b32 v19, a93
    v_mul_f32 v19, v19, v249
    v_accvgpr_write_b32 a93, v19
    v_accvgpr_read_b32 v18, a94
    v_mul_f32 v18, v18, v250
    v_accvgpr_write_b32 a94, v18
    v_accvgpr_read_b32 v19, a95
    v_mul_f32 v19, v19, v251
    v_accvgpr_write_b32 a95, v19
    v_max3_f32 v16, v176, v177, v178
    v_max3_f32 v16, v16, v179, v180
    v_max3_f32 v16, v16, v181, v182
    v_max3_f32 v16, v16, v183, v242
    v_mov_b32 v17, v16
    s_nop 1
    v_permlane16_swap_b32 v16, v17
    s_nop 1
    v_max_f32 v16, v16, v17
    v_mov_b32 v17, v16
    s_nop 1
    v_permlane32_swap_b32 v16, v17
    s_nop 1
    v_max_f32 v16, v16, v17
    v_sub_f32 v17, v242, v16
    v_exp_f32 v17, v17
    v_mov_b32 v242, v16
    v_sub_f32 v176, v176, v16
    v_sub_f32 v177, v177, v16
    v_sub_f32 v178, v178, v16
    v_sub_f32 v179, v179, v16
    v_sub_f32 v180, v180, v16
    v_sub_f32 v181, v181, v16
    v_sub_f32 v182, v182, v16
    v_sub_f32 v183, v183, v16
    v_exp_f32 v176, v176
    v_exp_f32 v177, v177
    v_exp_f32 v178, v178
    v_exp_f32 v179, v179
    v_exp_f32 v180, v180
    v_exp_f32 v181, v181
    v_exp_f32 v182, v182
    v_exp_f32 v183, v183
    v_mul_f32 v7, v7, v17
    v_add_f32 v7, v7, v176
    v_add_f32 v7, v7, v177
    v_add_f32 v7, v7, v178
    v_add_f32 v7, v7, v179
    v_add_f32 v7, v7, v180
    v_add_f32 v7, v7, v181
    v_add_f32 v7, v7, v182
    v_add_f32 v7, v7, v183
    v_cvt_pk_bf16_f32 v232, v176, v177
    v_cvt_pk_bf16_f32 v233, v178, v179
    v_cvt_pk_bf16_f32 v234, v180, v181
    v_cvt_pk_bf16_f32 v235, v182, v183
    ds_bpermute_b32 v248, v58, v17 offset:0
    ds_bpermute_b32 v249, v58, v17 offset:4
    ds_bpermute_b32 v250, v58, v17 offset:8
    ds_bpermute_b32 v251, v58, v17 offset:12
    s_waitcnt lgkmcnt(0)
    v_accvgpr_read_b32 v18, a96
    v_mul_f32 v18, v18, v248
    v_accvgpr_write_b32 a96, v18
    v_accvgpr_read_b32 v19, a97
    v_mul_f32 v19, v19, v249
    v_accvgpr_write_b32 a97, v19
    v_accvgpr_read_b32 v18, a98
    v_mul_f32 v18, v18, v250
    v_accvgpr_write_b32 a98, v18
    v_accvgpr_read_b32 v19, a99
    v_mul_f32 v19, v19, v251
    v_accvgpr_write_b32 a99, v19
    v_accvgpr_read_b32 v18, a100
    v_mul_f32 v18, v18, v248
    v_accvgpr_write_b32 a100, v18
    v_accvgpr_read_b32 v19, a101
    v_mul_f32 v19, v19, v249
    v_accvgpr_write_b32 a101, v19
    v_accvgpr_read_b32 v18, a102
    v_mul_f32 v18, v18, v250
    v_accvgpr_write_b32 a102, v18
    v_accvgpr_read_b32 v19, a103
    v_mul_f32 v19, v19, v251
    v_accvgpr_write_b32 a103, v19
    v_accvgpr_read_b32 v18, a104
    v_mul_f32 v18, v18, v248
    v_accvgpr_write_b32 a104, v18
    v_accvgpr_read_b32 v19, a105
    v_mul_f32 v19, v19, v249
    v_accvgpr_write_b32 a105, v19
    v_accvgpr_read_b32 v18, a106
    v_mul_f32 v18, v18, v250
    v_accvgpr_write_b32 a106, v18
    v_accvgpr_read_b32 v19, a107
    v_mul_f32 v19, v19, v251
    v_accvgpr_write_b32 a107, v19
    v_accvgpr_read_b32 v18, a108
    v_mul_f32 v18, v18, v248
    v_accvgpr_write_b32 a108, v18
    v_accvgpr_read_b32 v19, a109
    v_mul_f32 v19, v19, v249
    v_accvgpr_write_b32 a109, v19
    v_accvgpr_read_b32 v18, a110
    v_mul_f32 v18, v18, v250
    v_accvgpr_write_b32 a110, v18
    v_accvgpr_read_b32 v19, a111
    v_mul_f32 v19, v19, v251
    v_accvgpr_write_b32 a111, v19
    v_accvgpr_read_b32 v18, a112
    v_mul_f32 v18, v18, v248
    v_accvgpr_write_b32 a112, v18
    v_accvgpr_read_b32 v19, a113
    v_mul_f32 v19, v19, v249
    v_accvgpr_write_b32 a113, v19
    v_accvgpr_read_b32 v18, a114
    v_mul_f32 v18, v18, v250
    v_accvgpr_write_b32 a114, v18
    v_accvgpr_read_b32 v19, a115
    v_mul_f32 v19, v19, v251
    v_accvgpr_write_b32 a115, v19
    v_accvgpr_read_b32 v18, a116
    v_mul_f32 v18, v18, v248
    v_accvgpr_write_b32 a116, v18
    v_accvgpr_read_b32 v19, a117
    v_mul_f32 v19, v19, v249
    v_accvgpr_write_b32 a117, v19
    v_accvgpr_read_b32 v18, a118
    v_mul_f32 v18, v18, v250
    v_accvgpr_write_b32 a118, v18
    v_accvgpr_read_b32 v19, a119
    v_mul_f32 v19, v19, v251
    v_accvgpr_write_b32 a119, v19
    v_accvgpr_read_b32 v18, a120
    v_mul_f32 v18, v18, v248
    v_accvgpr_write_b32 a120, v18
    v_accvgpr_read_b32 v19, a121
    v_mul_f32 v19, v19, v249
    v_accvgpr_write_b32 a121, v19
    v_accvgpr_read_b32 v18, a122
    v_mul_f32 v18, v18, v250
    v_accvgpr_write_b32 a122, v18
    v_accvgpr_read_b32 v19, a123
    v_mul_f32 v19, v19, v251
    v_accvgpr_write_b32 a123, v19
    v_accvgpr_read_b32 v18, a124
    v_mul_f32 v18, v18, v248
    v_accvgpr_write_b32 a124, v18
    v_accvgpr_read_b32 v19, a125
    v_mul_f32 v19, v19, v249
    v_accvgpr_write_b32 a125, v19
    v_accvgpr_read_b32 v18, a126
    v_mul_f32 v18, v18, v250
    v_accvgpr_write_b32 a126, v18
    v_accvgpr_read_b32 v19, a127
    v_mul_f32 v19, v19, v251
    v_accvgpr_write_b32 a127, v19
    v_accvgpr_read_b32 v18, a128
    v_mul_f32 v18, v18, v248
    v_accvgpr_write_b32 a128, v18
    v_accvgpr_read_b32 v19, a129
    v_mul_f32 v19, v19, v249
    v_accvgpr_write_b32 a129, v19
    v_accvgpr_read_b32 v18, a130
    v_mul_f32 v18, v18, v250
    v_accvgpr_write_b32 a130, v18
    v_accvgpr_read_b32 v19, a131
    v_mul_f32 v19, v19, v251
    v_accvgpr_write_b32 a131, v19
    v_accvgpr_read_b32 v18, a132
    v_mul_f32 v18, v18, v248
    v_accvgpr_write_b32 a132, v18
    v_accvgpr_read_b32 v19, a133
    v_mul_f32 v19, v19, v249
    v_accvgpr_write_b32 a133, v19
    v_accvgpr_read_b32 v18, a134
    v_mul_f32 v18, v18, v250
    v_accvgpr_write_b32 a134, v18
    v_accvgpr_read_b32 v19, a135
    v_mul_f32 v19, v19, v251
    v_accvgpr_write_b32 a135, v19
    v_accvgpr_read_b32 v18, a136
    v_mul_f32 v18, v18, v248
    v_accvgpr_write_b32 a136, v18
    v_accvgpr_read_b32 v19, a137
    v_mul_f32 v19, v19, v249
    v_accvgpr_write_b32 a137, v19
    v_accvgpr_read_b32 v18, a138
    v_mul_f32 v18, v18, v250
    v_accvgpr_write_b32 a138, v18
    v_accvgpr_read_b32 v19, a139
    v_mul_f32 v19, v19, v251
    v_accvgpr_write_b32 a139, v19
    v_accvgpr_read_b32 v18, a140
    v_mul_f32 v18, v18, v248
    v_accvgpr_write_b32 a140, v18
    v_accvgpr_read_b32 v19, a141
    v_mul_f32 v19, v19, v249
    v_accvgpr_write_b32 a141, v19
    v_accvgpr_read_b32 v18, a142
    v_mul_f32 v18, v18, v250
    v_accvgpr_write_b32 a142, v18
    v_accvgpr_read_b32 v19, a143
    v_mul_f32 v19, v19, v251
    v_accvgpr_write_b32 a143, v19
    v_max3_f32 v16, v184, v185, v186
    v_max3_f32 v16, v16, v187, v188
    v_max3_f32 v16, v16, v189, v190
    v_max3_f32 v16, v16, v191, v243
    v_mov_b32 v17, v16
    s_nop 1
    v_permlane16_swap_b32 v16, v17
    s_nop 1
    v_max_f32 v16, v16, v17
    v_mov_b32 v17, v16
    s_nop 1
    v_permlane32_swap_b32 v16, v17
    s_nop 1
    v_max_f32 v16, v16, v17
    v_sub_f32 v17, v243, v16
    v_exp_f32 v17, v17
    v_mov_b32 v243, v16
    v_sub_f32 v184, v184, v16
    v_sub_f32 v185, v185, v16
    v_sub_f32 v186, v186, v16
    v_sub_f32 v187, v187, v16
    v_sub_f32 v188, v188, v16
    v_sub_f32 v189, v189, v16
    v_sub_f32 v190, v190, v16
    v_sub_f32 v191, v191, v16
    v_exp_f32 v184, v184
    v_exp_f32 v185, v185
    v_exp_f32 v186, v186
    v_exp_f32 v187, v187
    v_exp_f32 v188, v188
    v_exp_f32 v189, v189
    v_exp_f32 v190, v190
    v_exp_f32 v191, v191
    v_mul_f32 v8, v8, v17
    v_add_f32 v8, v8, v184
    v_add_f32 v8, v8, v185
    v_add_f32 v8, v8, v186
    v_add_f32 v8, v8, v187
    v_add_f32 v8, v8, v188
    v_add_f32 v8, v8, v189
    v_add_f32 v8, v8, v190
    v_add_f32 v8, v8, v191
    v_cvt_pk_bf16_f32 v236, v184, v185
    v_cvt_pk_bf16_f32 v237, v186, v187
    v_cvt_pk_bf16_f32 v238, v188, v189
    v_cvt_pk_bf16_f32 v239, v190, v191
    ds_bpermute_b32 v248, v58, v17 offset:0
    ds_bpermute_b32 v249, v58, v17 offset:4
    ds_bpermute_b32 v250, v58, v17 offset:8
    ds_bpermute_b32 v251, v58, v17 offset:12
    s_waitcnt lgkmcnt(0)
    v_accvgpr_read_b32 v18, a144
    v_mul_f32 v18, v18, v248
    v_accvgpr_write_b32 a144, v18
    v_accvgpr_read_b32 v19, a145
    v_mul_f32 v19, v19, v249
    v_accvgpr_write_b32 a145, v19
    v_accvgpr_read_b32 v18, a146
    v_mul_f32 v18, v18, v250
    v_accvgpr_write_b32 a146, v18
    v_accvgpr_read_b32 v19, a147
    v_mul_f32 v19, v19, v251
    v_accvgpr_write_b32 a147, v19
    v_accvgpr_read_b32 v18, a148
    v_mul_f32 v18, v18, v248
    v_accvgpr_write_b32 a148, v18
    v_accvgpr_read_b32 v19, a149
    v_mul_f32 v19, v19, v249
    v_accvgpr_write_b32 a149, v19
    v_accvgpr_read_b32 v18, a150
    v_mul_f32 v18, v18, v250
    v_accvgpr_write_b32 a150, v18
    v_accvgpr_read_b32 v19, a151
    v_mul_f32 v19, v19, v251
    v_accvgpr_write_b32 a151, v19
    v_accvgpr_read_b32 v18, a152
    v_mul_f32 v18, v18, v248
    v_accvgpr_write_b32 a152, v18
    v_accvgpr_read_b32 v19, a153
    v_mul_f32 v19, v19, v249
    v_accvgpr_write_b32 a153, v19
    v_accvgpr_read_b32 v18, a154
    v_mul_f32 v18, v18, v250
    v_accvgpr_write_b32 a154, v18
    v_accvgpr_read_b32 v19, a155
    v_mul_f32 v19, v19, v251
    v_accvgpr_write_b32 a155, v19
    v_accvgpr_read_b32 v18, a156
    v_mul_f32 v18, v18, v248
    v_accvgpr_write_b32 a156, v18
    v_accvgpr_read_b32 v19, a157
    v_mul_f32 v19, v19, v249
    v_accvgpr_write_b32 a157, v19
    v_accvgpr_read_b32 v18, a158
    v_mul_f32 v18, v18, v250
    v_accvgpr_write_b32 a158, v18
    v_accvgpr_read_b32 v19, a159
    v_mul_f32 v19, v19, v251
    v_accvgpr_write_b32 a159, v19
    v_accvgpr_read_b32 v18, a160
    v_mul_f32 v18, v18, v248
    v_accvgpr_write_b32 a160, v18
    v_accvgpr_read_b32 v19, a161
    v_mul_f32 v19, v19, v249
    v_accvgpr_write_b32 a161, v19
    v_accvgpr_read_b32 v18, a162
    v_mul_f32 v18, v18, v250
    v_accvgpr_write_b32 a162, v18
    v_accvgpr_read_b32 v19, a163
    v_mul_f32 v19, v19, v251
    v_accvgpr_write_b32 a163, v19
    v_accvgpr_read_b32 v18, a164
    v_mul_f32 v18, v18, v248
    v_accvgpr_write_b32 a164, v18
    v_accvgpr_read_b32 v19, a165
    v_mul_f32 v19, v19, v249
    v_accvgpr_write_b32 a165, v19
    v_accvgpr_read_b32 v18, a166
    v_mul_f32 v18, v18, v250
    v_accvgpr_write_b32 a166, v18
    v_accvgpr_read_b32 v19, a167
    v_mul_f32 v19, v19, v251
    v_accvgpr_write_b32 a167, v19
    v_accvgpr_read_b32 v18, a168
    v_mul_f32 v18, v18, v248
    v_accvgpr_write_b32 a168, v18
    v_accvgpr_read_b32 v19, a169
    v_mul_f32 v19, v19, v249
    v_accvgpr_write_b32 a169, v19
    v_accvgpr_read_b32 v18, a170
    v_mul_f32 v18, v18, v250
    v_accvgpr_write_b32 a170, v18
    v_accvgpr_read_b32 v19, a171
    v_mul_f32 v19, v19, v251
    v_accvgpr_write_b32 a171, v19
    v_accvgpr_read_b32 v18, a172
    v_mul_f32 v18, v18, v248
    v_accvgpr_write_b32 a172, v18
    v_accvgpr_read_b32 v19, a173
    v_mul_f32 v19, v19, v249
    v_accvgpr_write_b32 a173, v19
    v_accvgpr_read_b32 v18, a174
    v_mul_f32 v18, v18, v250
    v_accvgpr_write_b32 a174, v18
    v_accvgpr_read_b32 v19, a175
    v_mul_f32 v19, v19, v251
    v_accvgpr_write_b32 a175, v19
    v_accvgpr_read_b32 v18, a176
    v_mul_f32 v18, v18, v248
    v_accvgpr_write_b32 a176, v18
    v_accvgpr_read_b32 v19, a177
    v_mul_f32 v19, v19, v249
    v_accvgpr_write_b32 a177, v19
    v_accvgpr_read_b32 v18, a178
    v_mul_f32 v18, v18, v250
    v_accvgpr_write_b32 a178, v18
    v_accvgpr_read_b32 v19, a179
    v_mul_f32 v19, v19, v251
    v_accvgpr_write_b32 a179, v19
    v_accvgpr_read_b32 v18, a180
    v_mul_f32 v18, v18, v248
    v_accvgpr_write_b32 a180, v18
    v_accvgpr_read_b32 v19, a181
    v_mul_f32 v19, v19, v249
    v_accvgpr_write_b32 a181, v19
    v_accvgpr_read_b32 v18, a182
    v_mul_f32 v18, v18, v250
    v_accvgpr_write_b32 a182, v18
    v_accvgpr_read_b32 v19, a183
    v_mul_f32 v19, v19, v251
    v_accvgpr_write_b32 a183, v19
    v_accvgpr_read_b32 v18, a184
    v_mul_f32 v18, v18, v248
    v_accvgpr_write_b32 a184, v18
    v_accvgpr_read_b32 v19, a185
    v_mul_f32 v19, v19, v249
    v_accvgpr_write_b32 a185, v19
    v_accvgpr_read_b32 v18, a186
    v_mul_f32 v18, v18, v250
    v_accvgpr_write_b32 a186, v18
    v_accvgpr_read_b32 v19, a187
    v_mul_f32 v19, v19, v251
    v_accvgpr_write_b32 a187, v19
    v_accvgpr_read_b32 v18, a188
    v_mul_f32 v18, v18, v248
    v_accvgpr_write_b32 a188, v18
    v_accvgpr_read_b32 v19, a189
    v_mul_f32 v19, v19, v249
    v_accvgpr_write_b32 a189, v19
    v_accvgpr_read_b32 v18, a190
    v_mul_f32 v18, v18, v250
    v_accvgpr_write_b32 a190, v18
    v_accvgpr_read_b32 v19, a191
    v_mul_f32 v19, v19, v251
    v_accvgpr_write_b32 a191, v19
    s_waitcnt vmcnt(0)
    s_nop 1
    v_mfma_f32_16x16x32_bf16 a[0:3], v[224:227], v[112:115], a[0:3]
    v_mfma_f32_16x16x32_bf16 a[48:51], v[228:231], v[112:115], a[48:51]
    v_mfma_f32_16x16x32_bf16 a[96:99], v[232:235], v[112:115], a[96:99]
    v_mfma_f32_16x16x32_bf16 a[144:147], v[236:239], v[112:115], a[144:147]
    v_mfma_f32_16x16x32_bf16 a[4:7], v[224:227], v[116:119], a[4:7]
    v_mfma_f32_16x16x32_bf16 a[52:55], v[228:231], v[116:119], a[52:55]
    v_mfma_f32_16x16x32_bf16 a[100:103], v[232:235], v[116:119], a[100:103]
    v_mfma_f32_16x16x32_bf16 a[148:151], v[236:239], v[116:119], a[148:151]
    v_mfma_f32_16x16x32_bf16 a[8:11], v[224:227], v[120:123], a[8:11]
    v_mfma_f32_16x16x32_bf16 a[56:59], v[228:231], v[120:123], a[56:59]
    v_mfma_f32_16x16x32_bf16 a[104:107], v[232:235], v[120:123], a[104:107]
    v_mfma_f32_16x16x32_bf16 a[152:155], v[236:239], v[120:123], a[152:155]
    v_mfma_f32_16x16x32_bf16 a[12:15], v[224:227], v[124:127], a[12:15]
    v_mfma_f32_16x16x32_bf16 a[60:63], v[228:231], v[124:127], a[60:63]
    v_mfma_f32_16x16x32_bf16 a[108:111], v[232:235], v[124:127], a[108:111]
    v_mfma_f32_16x16x32_bf16 a[156:159], v[236:239], v[124:127], a[156:159]
    v_mfma_f32_16x16x32_bf16 a[16:19], v[224:227], v[128:131], a[16:19]
    v_mfma_f32_16x16x32_bf16 a[64:67], v[228:231], v[128:131], a[64:67]
    v_mfma_f32_16x16x32_bf16 a[112:115], v[232:235], v[128:131], a[112:115]
    v_mfma_f32_16x16x32_bf16 a[160:163], v[236:239], v[128:131], a[160:163]
    v_mfma_f32_16x16x32_bf16 a[20:23], v[224:227], v[132:135], a[20:23]
    v_mfma_f32_16x16x32_bf16 a[68:71], v[228:231], v[132:135], a[68:71]
    v_mfma_f32_16x16x32_bf16 a[116:119], v[232:235], v[132:135], a[116:119]
    v_mfma_f32_16x16x32_bf16 a[164:167], v[236:239], v[132:135], a[164:167]
    v_mfma_f32_16x16x32_bf16 a[24:27], v[224:227], v[136:139], a[24:27]
    v_mfma_f32_16x16x32_bf16 a[72:75], v[228:231], v[136:139], a[72:75]
    v_mfma_f32_16x16x32_bf16 a[120:123], v[232:235], v[136:139], a[120:123]
    v_mfma_f32_16x16x32_bf16 a[168:171], v[236:239], v[136:139], a[168:171]
    v_mfma_f32_16x16x32_bf16 a[28:31], v[224:227], v[140:143], a[28:31]
    v_mfma_f32_16x16x32_bf16 a[76:79], v[228:231], v[140:143], a[76:79]
    v_mfma_f32_16x16x32_bf16 a[124:127], v[232:235], v[140:143], a[124:127]
    v_mfma_f32_16x16x32_bf16 a[172:175], v[236:239], v[140:143], a[172:175]
    v_mfma_f32_16x16x32_bf16 a[32:35], v[224:227], v[144:147], a[32:35]
    v_mfma_f32_16x16x32_bf16 a[80:83], v[228:231], v[144:147], a[80:83]
    v_mfma_f32_16x16x32_bf16 a[128:131], v[232:235], v[144:147], a[128:131]
    v_mfma_f32_16x16x32_bf16 a[176:179], v[236:239], v[144:147], a[176:179]
    v_mfma_f32_16x16x32_bf16 a[36:39], v[224:227], v[148:151], a[36:39]
    v_mfma_f32_16x16x32_bf16 a[84:87], v[228:231], v[148:151], a[84:87]
    v_mfma_f32_16x16x32_bf16 a[132:135], v[232:235], v[148:151], a[132:135]
    v_mfma_f32_16x16x32_bf16 a[180:183], v[236:239], v[148:151], a[180:183]
    v_mfma_f32_16x16x32_bf16 a[40:43], v[224:227], v[152:155], a[40:43]
    v_mfma_f32_16x16x32_bf16 a[88:91], v[228:231], v[152:155], a[88:91]
    v_mfma_f32_16x16x32_bf16 a[136:139], v[232:235], v[152:155], a[136:139]
    v_mfma_f32_16x16x32_bf16 a[184:187], v[236:239], v[152:155], a[184:187]
    v_mfma_f32_16x16x32_bf16 a[44:47], v[224:227], v[156:159], a[44:47]
    v_mfma_f32_16x16x32_bf16 a[92:95], v[228:231], v[156:159], a[92:95]
    v_mfma_f32_16x16x32_bf16 a[140:143], v[232:235], v[156:159], a[140:143]
    v_mfma_f32_16x16x32_bf16 a[188:191], v[236:239], v[156:159], a[188:191]
    s_add_u32 s48, s48, 24576
    s_cmp_lt_u32 s48, 1572864
    s_nop 7
    s_cbranch_scc1 L_slowloop
    s_nop 1
    v_mfma_f32_16x16x4_f32 v[48:51], v5, v57, 0
    v_mfma_f32_16x16x4_f32 v[52:55], v6, v57, 0
    s_nop 7
    s_nop 1
    v_rcp_f32 v48, v48
    v_rcp_f32 v49, v49
    v_rcp_f32 v50, v50
    v_rcp_f32 v51, v51
    v_rcp_f32 v52, v52
    v_rcp_f32 v53, v53
    v_rcp_f32 v54, v54
    v_rcp_f32 v55, v55
    v_mfma_f32_16x16x4_f32 v[128:131], v7, v57, 0
    v_mfma_f32_16x16x4_f32 v[132:135], v8, v57, 0
    s_nop 7
    s_nop 1
    v_rcp_f32 v128, v128
    v_rcp_f32 v129, v129
    v_rcp_f32 v130, v130
    v_rcp_f32 v131, v131
    v_rcp_f32 v132, v132
    v_rcp_f32 v133, v133
    v_rcp_f32 v134, v134
    v_rcp_f32 v135, v135
    s_nop 0
    v_accvgpr_read_b32 v64, a0
    v_accvgpr_read_b32 v65, a4
    v_accvgpr_read_b32 v66, a8
    v_accvgpr_read_b32 v67, a12
    v_accvgpr_read_b32 v68, a16
    v_accvgpr_read_b32 v69, a20
    v_pk_mul_f32 v[64:65], v[64:65], v[48:49] op_sel_hi:[1,0]
    v_pk_mul_f32 v[66:67], v[66:67], v[48:49] op_sel_hi:[1,0]
    v_pk_mul_f32 v[68:69], v[68:69], v[48:49] op_sel_hi:[1,0]
    v_cvt_pk_bf16_f32 v64, v64, v65
    v_cvt_pk_bf16_f32 v65, v66, v67
    v_cvt_pk_bf16_f32 v66, v68, v69
    v_accvgpr_read_b32 v70, a1
    v_accvgpr_read_b32 v71, a5
    v_accvgpr_read_b32 v72, a9
    v_accvgpr_read_b32 v73, a13
    v_accvgpr_read_b32 v74, a17
    v_accvgpr_read_b32 v75, a21
    v_pk_mul_f32 v[70:71], v[70:71], v[48:49] op_sel:[0,1] op_sel_hi:[1,1]
    v_pk_mul_f32 v[72:73], v[72:73], v[48:49] op_sel:[0,1] op_sel_hi:[1,1]
    v_pk_mul_f32 v[74:75], v[74:75], v[48:49] op_sel:[0,1] op_sel_hi:[1,1]
    v_cvt_pk_bf16_f32 v70, v70, v71
    v_cvt_pk_bf16_f32 v71, v72, v73
    v_cvt_pk_bf16_f32 v72, v74, v75
    buffer_store_dwordx3 v[64:66], v56, s[12:15], s24 offen offset:0 sc0 sc1
    v_accvgpr_read_b32 v76, a2
    v_accvgpr_read_b32 v77, a6
    v_accvgpr_read_b32 v78, a10
    v_accvgpr_read_b32 v79, a14
    v_accvgpr_read_b32 v80, a18
    v_accvgpr_read_b32 v81, a22
    v_pk_mul_f32 v[76:77], v[76:77], v[50:51] op_sel_hi:[1,0]
    v_pk_mul_f32 v[78:79], v[78:79], v[50:51] op_sel_hi:[1,0]
    v_pk_mul_f32 v[80:81], v[80:81], v[50:51] op_sel_hi:[1,0]
    v_cvt_pk_bf16_f32 v76, v76, v77
    v_cvt_pk_bf16_f32 v77, v78, v79
    v_cvt_pk_bf16_f32 v78, v80, v81
    buffer_store_dwordx3 v[70:72], v56, s[12:15], s24 offen offset:384 sc0 sc1
    v_accvgpr_read_b32 v82, a3
    v_accvgpr_read_b32 v83, a7
    v_accvgpr_read_b32 v84, a11
    v_accvgpr_read_b32 v85, a15
    v_accvgpr_read_b32 v86, a19
    v_accvgpr_read_b32 v87, a23
    v_pk_mul_f32 v[82:83], v[82:83], v[50:51] op_sel:[0,1] op_sel_hi:[1,1]
    v_pk_mul_f32 v[84:85], v[84:85], v[50:51] op_sel:[0,1] op_sel_hi:[1,1]
    v_pk_mul_f32 v[86:87], v[86:87], v[50:51] op_sel:[0,1] op_sel_hi:[1,1]
    v_cvt_pk_bf16_f32 v82, v82, v83
    v_cvt_pk_bf16_f32 v83, v84, v85
    v_cvt_pk_bf16_f32 v84, v86, v87
    buffer_store_dwordx3 v[76:78], v56, s[12:15], s24 offen offset:768 sc0 sc1
    v_accvgpr_read_b32 v88, a24
    v_accvgpr_read_b32 v89, a28
    v_accvgpr_read_b32 v90, a32
    v_accvgpr_read_b32 v91, a36
    v_accvgpr_read_b32 v92, a40
    v_accvgpr_read_b32 v93, a44
    v_pk_mul_f32 v[88:89], v[88:89], v[48:49] op_sel_hi:[1,0]
    v_pk_mul_f32 v[90:91], v[90:91], v[48:49] op_sel_hi:[1,0]
    v_pk_mul_f32 v[92:93], v[92:93], v[48:49] op_sel_hi:[1,0]
    v_cvt_pk_bf16_f32 v88, v88, v89
    v_cvt_pk_bf16_f32 v89, v90, v91
    v_cvt_pk_bf16_f32 v90, v92, v93
    buffer_store_dwordx3 v[82:84], v56, s[12:15], s24 offen offset:1152 sc0 sc1
    v_accvgpr_read_b32 v94, a25
    v_accvgpr_read_b32 v95, a29
    v_accvgpr_read_b32 v96, a33
    v_accvgpr_read_b32 v97, a37
    v_accvgpr_read_b32 v98, a41
    v_accvgpr_read_b32 v99, a45
    v_pk_mul_f32 v[94:95], v[94:95], v[48:49] op_sel:[0,1] op_sel_hi:[1,1]
    v_pk_mul_f32 v[96:97], v[96:97], v[48:49] op_sel:[0,1] op_sel_hi:[1,1]
    v_pk_mul_f32 v[98:99], v[98:99], v[48:49] op_sel:[0,1] op_sel_hi:[1,1]
    v_cvt_pk_bf16_f32 v94, v94, v95
    v_cvt_pk_bf16_f32 v95, v96, v97
    v_cvt_pk_bf16_f32 v96, v98, v99
    buffer_store_dwordx3 v[88:90], v56, s[12:15], s24 offen offset:192 sc0 sc1
    v_accvgpr_read_b32 v100, a26
    v_accvgpr_read_b32 v101, a30
    v_accvgpr_read_b32 v102, a34
    v_accvgpr_read_b32 v103, a38
    v_accvgpr_read_b32 v104, a42
    v_accvgpr_read_b32 v105, a46
    v_pk_mul_f32 v[100:101], v[100:101], v[50:51] op_sel_hi:[1,0]
    v_pk_mul_f32 v[102:103], v[102:103], v[50:51] op_sel_hi:[1,0]
    v_pk_mul_f32 v[104:105], v[104:105], v[50:51] op_sel_hi:[1,0]
    v_cvt_pk_bf16_f32 v100, v100, v101
    v_cvt_pk_bf16_f32 v101, v102, v103
    v_cvt_pk_bf16_f32 v102, v104, v105
    buffer_store_dwordx3 v[94:96], v56, s[12:15], s24 offen offset:576 sc0 sc1
    v_accvgpr_read_b32 v106, a27
    v_accvgpr_read_b32 v107, a31
    v_accvgpr_read_b32 v108, a35
    v_accvgpr_read_b32 v109, a39
    v_accvgpr_read_b32 v110, a43
    v_accvgpr_read_b32 v111, a47
    v_pk_mul_f32 v[106:107], v[106:107], v[50:51] op_sel:[0,1] op_sel_hi:[1,1]
    v_pk_mul_f32 v[108:109], v[108:109], v[50:51] op_sel:[0,1] op_sel_hi:[1,1]
    v_pk_mul_f32 v[110:111], v[110:111], v[50:51] op_sel:[0,1] op_sel_hi:[1,1]
    v_cvt_pk_bf16_f32 v106, v106, v107
    v_cvt_pk_bf16_f32 v107, v108, v109
    v_cvt_pk_bf16_f32 v108, v110, v111
    buffer_store_dwordx3 v[100:102], v56, s[12:15], s24 offen offset:960 sc0 sc1
    v_accvgpr_read_b32 v64, a48
    v_accvgpr_read_b32 v65, a52
    v_accvgpr_read_b32 v66, a56
    v_accvgpr_read_b32 v67, a60
    v_accvgpr_read_b32 v68, a64
    v_accvgpr_read_b32 v69, a68
    v_pk_mul_f32 v[64:65], v[64:65], v[52:53] op_sel_hi:[1,0]
    v_pk_mul_f32 v[66:67], v[66:67], v[52:53] op_sel_hi:[1,0]
    v_pk_mul_f32 v[68:69], v[68:69], v[52:53] op_sel_hi:[1,0]
    v_cvt_pk_bf16_f32 v64, v64, v65
    v_cvt_pk_bf16_f32 v65, v66, v67
    v_cvt_pk_bf16_f32 v66, v68, v69
    buffer_store_dwordx3 v[106:108], v56, s[12:15], s24 offen offset:1344 sc0 sc1
    v_accvgpr_read_b32 v70, a49
    v_accvgpr_read_b32 v71, a53
    v_accvgpr_read_b32 v72, a57
    v_accvgpr_read_b32 v73, a61
    v_accvgpr_read_b32 v74, a65
    v_accvgpr_read_b32 v75, a69
    v_pk_mul_f32 v[70:71], v[70:71], v[52:53] op_sel:[0,1] op_sel_hi:[1,1]
    v_pk_mul_f32 v[72:73], v[72:73], v[52:53] op_sel:[0,1] op_sel_hi:[1,1]
    v_pk_mul_f32 v[74:75], v[74:75], v[52:53] op_sel:[0,1] op_sel_hi:[1,1]
    v_cvt_pk_bf16_f32 v70, v70, v71
    v_cvt_pk_bf16_f32 v71, v72, v73
    v_cvt_pk_bf16_f32 v72, v74, v75
    buffer_store_dwordx3 v[64:66], v56, s[12:15], s40 offen offset:0 sc0 sc1
    v_accvgpr_read_b32 v76, a50
    v_accvgpr_read_b32 v77, a54
    v_accvgpr_read_b32 v78, a58
    v_accvgpr_read_b32 v79, a62
    v_accvgpr_read_b32 v80, a66
    v_accvgpr_read_b32 v81, a70
    v_pk_mul_f32 v[76:77], v[76:77], v[54:55] op_sel_hi:[1,0]
    v_pk_mul_f32 v[78:79], v[78:79], v[54:55] op_sel_hi:[1,0]
    v_pk_mul_f32 v[80:81], v[80:81], v[54:55] op_sel_hi:[1,0]
    v_cvt_pk_bf16_f32 v76, v76, v77
    v_cvt_pk_bf16_f32 v77, v78, v79
    v_cvt_pk_bf16_f32 v78, v80, v81
    buffer_store_dwordx3 v[70:72], v56, s[12:15], s40 offen offset:384 sc0 sc1
    v_accvgpr_read_b32 v82, a51
    v_accvgpr_read_b32 v83, a55
    v_accvgpr_read_b32 v84, a59
    v_accvgpr_read_b32 v85, a63
    v_accvgpr_read_b32 v86, a67
    v_accvgpr_read_b32 v87, a71
    v_pk_mul_f32 v[82:83], v[82:83], v[54:55] op_sel:[0,1] op_sel_hi:[1,1]
    v_pk_mul_f32 v[84:85], v[84:85], v[54:55] op_sel:[0,1] op_sel_hi:[1,1]
    v_pk_mul_f32 v[86:87], v[86:87], v[54:55] op_sel:[0,1] op_sel_hi:[1,1]
    v_cvt_pk_bf16_f32 v82, v82, v83
    v_cvt_pk_bf16_f32 v83, v84, v85
    v_cvt_pk_bf16_f32 v84, v86, v87
    buffer_store_dwordx3 v[76:78], v56, s[12:15], s40 offen offset:768 sc0 sc1
    v_accvgpr_read_b32 v88, a72
    v_accvgpr_read_b32 v89, a76
    v_accvgpr_read_b32 v90, a80
    v_accvgpr_read_b32 v91, a84
    v_accvgpr_read_b32 v92, a88
    v_accvgpr_read_b32 v93, a92
    v_pk_mul_f32 v[88:89], v[88:89], v[52:53] op_sel_hi:[1,0]
    v_pk_mul_f32 v[90:91], v[90:91], v[52:53] op_sel_hi:[1,0]
    v_pk_mul_f32 v[92:93], v[92:93], v[52:53] op_sel_hi:[1,0]
    v_cvt_pk_bf16_f32 v88, v88, v89
    v_cvt_pk_bf16_f32 v89, v90, v91
    v_cvt_pk_bf16_f32 v90, v92, v93
    buffer_store_dwordx3 v[82:84], v56, s[12:15], s40 offen offset:1152 sc0 sc1
    v_accvgpr_read_b32 v94, a73
    v_accvgpr_read_b32 v95, a77
    v_accvgpr_read_b32 v96, a81
    v_accvgpr_read_b32 v97, a85
    v_accvgpr_read_b32 v98, a89
    v_accvgpr_read_b32 v99, a93
    v_pk_mul_f32 v[94:95], v[94:95], v[52:53] op_sel:[0,1] op_sel_hi:[1,1]
    v_pk_mul_f32 v[96:97], v[96:97], v[52:53] op_sel:[0,1] op_sel_hi:[1,1]
    v_pk_mul_f32 v[98:99], v[98:99], v[52:53] op_sel:[0,1] op_sel_hi:[1,1]
    v_cvt_pk_bf16_f32 v94, v94, v95
    v_cvt_pk_bf16_f32 v95, v96, v97
    v_cvt_pk_bf16_f32 v96, v98, v99
    buffer_store_dwordx3 v[88:90], v56, s[12:15], s40 offen offset:192 sc0 sc1
    v_accvgpr_read_b32 v100, a74
    v_accvgpr_read_b32 v101, a78
    v_accvgpr_read_b32 v102, a82
    v_accvgpr_read_b32 v103, a86
    v_accvgpr_read_b32 v104, a90
    v_accvgpr_read_b32 v105, a94
    v_pk_mul_f32 v[100:101], v[100:101], v[54:55] op_sel_hi:[1,0]
    v_pk_mul_f32 v[102:103], v[102:103], v[54:55] op_sel_hi:[1,0]
    v_pk_mul_f32 v[104:105], v[104:105], v[54:55] op_sel_hi:[1,0]
    v_cvt_pk_bf16_f32 v100, v100, v101
    v_cvt_pk_bf16_f32 v101, v102, v103
    v_cvt_pk_bf16_f32 v102, v104, v105
    buffer_store_dwordx3 v[94:96], v56, s[12:15], s40 offen offset:576 sc0 sc1
    v_accvgpr_read_b32 v106, a75
    v_accvgpr_read_b32 v107, a79
    v_accvgpr_read_b32 v108, a83
    v_accvgpr_read_b32 v109, a87
    v_accvgpr_read_b32 v110, a91
    v_accvgpr_read_b32 v111, a95
    v_pk_mul_f32 v[106:107], v[106:107], v[54:55] op_sel:[0,1] op_sel_hi:[1,1]
    v_pk_mul_f32 v[108:109], v[108:109], v[54:55] op_sel:[0,1] op_sel_hi:[1,1]
    v_pk_mul_f32 v[110:111], v[110:111], v[54:55] op_sel:[0,1] op_sel_hi:[1,1]
    v_cvt_pk_bf16_f32 v106, v106, v107
    v_cvt_pk_bf16_f32 v107, v108, v109
    v_cvt_pk_bf16_f32 v108, v110, v111
    buffer_store_dwordx3 v[100:102], v56, s[12:15], s40 offen offset:960 sc0 sc1
    v_accvgpr_read_b32 v64, a96
    v_accvgpr_read_b32 v65, a100
    v_accvgpr_read_b32 v66, a104
    v_accvgpr_read_b32 v67, a108
    v_accvgpr_read_b32 v68, a112
    v_accvgpr_read_b32 v69, a116
    v_pk_mul_f32 v[64:65], v[64:65], v[128:129] op_sel_hi:[1,0]
    v_pk_mul_f32 v[66:67], v[66:67], v[128:129] op_sel_hi:[1,0]
    v_pk_mul_f32 v[68:69], v[68:69], v[128:129] op_sel_hi:[1,0]
    v_cvt_pk_bf16_f32 v64, v64, v65
    v_cvt_pk_bf16_f32 v65, v66, v67
    v_cvt_pk_bf16_f32 v66, v68, v69
    buffer_store_dwordx3 v[106:108], v56, s[12:15], s40 offen offset:1344 sc0 sc1
    v_accvgpr_read_b32 v70, a97
    v_accvgpr_read_b32 v71, a101
    v_accvgpr_read_b32 v72, a105
    v_accvgpr_read_b32 v73, a109
    v_accvgpr_read_b32 v74, a113
    v_accvgpr_read_b32 v75, a117
    v_pk_mul_f32 v[70:71], v[70:71], v[128:129] op_sel:[0,1] op_sel_hi:[1,1]
    v_pk_mul_f32 v[72:73], v[72:73], v[128:129] op_sel:[0,1] op_sel_hi:[1,1]
    v_pk_mul_f32 v[74:75], v[74:75], v[128:129] op_sel:[0,1] op_sel_hi:[1,1]
    v_cvt_pk_bf16_f32 v70, v70, v71
    v_cvt_pk_bf16_f32 v71, v72, v73
    v_cvt_pk_bf16_f32 v72, v74, v75
    buffer_store_dwordx3 v[64:66], v56, s[12:15], s41 offen offset:0 sc0 sc1
    v_accvgpr_read_b32 v76, a98
    v_accvgpr_read_b32 v77, a102
    v_accvgpr_read_b32 v78, a106
    v_accvgpr_read_b32 v79, a110
    v_accvgpr_read_b32 v80, a114
    v_accvgpr_read_b32 v81, a118
    v_pk_mul_f32 v[76:77], v[76:77], v[130:131] op_sel_hi:[1,0]
    v_pk_mul_f32 v[78:79], v[78:79], v[130:131] op_sel_hi:[1,0]
    v_pk_mul_f32 v[80:81], v[80:81], v[130:131] op_sel_hi:[1,0]
    v_cvt_pk_bf16_f32 v76, v76, v77
    v_cvt_pk_bf16_f32 v77, v78, v79
    v_cvt_pk_bf16_f32 v78, v80, v81
    buffer_store_dwordx3 v[70:72], v56, s[12:15], s41 offen offset:384 sc0 sc1
    v_accvgpr_read_b32 v82, a99
    v_accvgpr_read_b32 v83, a103
    v_accvgpr_read_b32 v84, a107
    v_accvgpr_read_b32 v85, a111
    v_accvgpr_read_b32 v86, a115
    v_accvgpr_read_b32 v87, a119
    v_pk_mul_f32 v[82:83], v[82:83], v[130:131] op_sel:[0,1] op_sel_hi:[1,1]
    v_pk_mul_f32 v[84:85], v[84:85], v[130:131] op_sel:[0,1] op_sel_hi:[1,1]
    v_pk_mul_f32 v[86:87], v[86:87], v[130:131] op_sel:[0,1] op_sel_hi:[1,1]
    v_cvt_pk_bf16_f32 v82, v82, v83
    v_cvt_pk_bf16_f32 v83, v84, v85
    v_cvt_pk_bf16_f32 v84, v86, v87
    buffer_store_dwordx3 v[76:78], v56, s[12:15], s41 offen offset:768 sc0 sc1
    v_accvgpr_read_b32 v88, a120
    v_accvgpr_read_b32 v89, a124
    v_accvgpr_read_b32 v90, a128
    v_accvgpr_read_b32 v91, a132
    v_accvgpr_read_b32 v92, a136
    v_accvgpr_read_b32 v93, a140
    v_pk_mul_f32 v[88:89], v[88:89], v[128:129] op_sel_hi:[1,0]
    v_pk_mul_f32 v[90:91], v[90:91], v[128:129] op_sel_hi:[1,0]
    v_pk_mul_f32 v[92:93], v[92:93], v[128:129] op_sel_hi:[1,0]
    v_cvt_pk_bf16_f32 v88, v88, v89
    v_cvt_pk_bf16_f32 v89, v90, v91
    v_cvt_pk_bf16_f32 v90, v92, v93
    buffer_store_dwordx3 v[82:84], v56, s[12:15], s41 offen offset:1152 sc0 sc1
    v_accvgpr_read_b32 v94, a121
    v_accvgpr_read_b32 v95, a125
    v_accvgpr_read_b32 v96, a129
    v_accvgpr_read_b32 v97, a133
    v_accvgpr_read_b32 v98, a137
    v_accvgpr_read_b32 v99, a141
    v_pk_mul_f32 v[94:95], v[94:95], v[128:129] op_sel:[0,1] op_sel_hi:[1,1]
    v_pk_mul_f32 v[96:97], v[96:97], v[128:129] op_sel:[0,1] op_sel_hi:[1,1]
    v_pk_mul_f32 v[98:99], v[98:99], v[128:129] op_sel:[0,1] op_sel_hi:[1,1]
    v_cvt_pk_bf16_f32 v94, v94, v95
    v_cvt_pk_bf16_f32 v95, v96, v97
    v_cvt_pk_bf16_f32 v96, v98, v99
    buffer_store_dwordx3 v[88:90], v56, s[12:15], s41 offen offset:192 sc0 sc1
    v_accvgpr_read_b32 v100, a122
    v_accvgpr_read_b32 v101, a126
    v_accvgpr_read_b32 v102, a130
    v_accvgpr_read_b32 v103, a134
    v_accvgpr_read_b32 v104, a138
    v_accvgpr_read_b32 v105, a142
    v_pk_mul_f32 v[100:101], v[100:101], v[130:131] op_sel_hi:[1,0]
    v_pk_mul_f32 v[102:103], v[102:103], v[130:131] op_sel_hi:[1,0]
    v_pk_mul_f32 v[104:105], v[104:105], v[130:131] op_sel_hi:[1,0]
    v_cvt_pk_bf16_f32 v100, v100, v101
    v_cvt_pk_bf16_f32 v101, v102, v103
    v_cvt_pk_bf16_f32 v102, v104, v105
    buffer_store_dwordx3 v[94:96], v56, s[12:15], s41 offen offset:576 sc0 sc1
    v_accvgpr_read_b32 v106, a123
    v_accvgpr_read_b32 v107, a127
    v_accvgpr_read_b32 v108, a131
    v_accvgpr_read_b32 v109, a135
    v_accvgpr_read_b32 v110, a139
    v_accvgpr_read_b32 v111, a143
    v_pk_mul_f32 v[106:107], v[106:107], v[130:131] op_sel:[0,1] op_sel_hi:[1,1]
    v_pk_mul_f32 v[108:109], v[108:109], v[130:131] op_sel:[0,1] op_sel_hi:[1,1]
    v_pk_mul_f32 v[110:111], v[110:111], v[130:131] op_sel:[0,1] op_sel_hi:[1,1]
    v_cvt_pk_bf16_f32 v106, v106, v107
    v_cvt_pk_bf16_f32 v107, v108, v109
    v_cvt_pk_bf16_f32 v108, v110, v111
    buffer_store_dwordx3 v[100:102], v56, s[12:15], s41 offen offset:960 sc0 sc1
    v_accvgpr_read_b32 v64, a144
    v_accvgpr_read_b32 v65, a148
    v_accvgpr_read_b32 v66, a152
    v_accvgpr_read_b32 v67, a156
    v_accvgpr_read_b32 v68, a160
    v_accvgpr_read_b32 v69, a164
    v_pk_mul_f32 v[64:65], v[64:65], v[132:133] op_sel_hi:[1,0]
    v_pk_mul_f32 v[66:67], v[66:67], v[132:133] op_sel_hi:[1,0]
    v_pk_mul_f32 v[68:69], v[68:69], v[132:133] op_sel_hi:[1,0]
    v_cvt_pk_bf16_f32 v64, v64, v65
    v_cvt_pk_bf16_f32 v65, v66, v67
    v_cvt_pk_bf16_f32 v66, v68, v69
    buffer_store_dwordx3 v[106:108], v56, s[12:15], s41 offen offset:1344 sc0 sc1
    v_accvgpr_read_b32 v70, a145
    v_accvgpr_read_b32 v71, a149
    v_accvgpr_read_b32 v72, a153
    v_accvgpr_read_b32 v73, a157
    v_accvgpr_read_b32 v74, a161
    v_accvgpr_read_b32 v75, a165
    v_pk_mul_f32 v[70:71], v[70:71], v[132:133] op_sel:[0,1] op_sel_hi:[1,1]
    v_pk_mul_f32 v[72:73], v[72:73], v[132:133] op_sel:[0,1] op_sel_hi:[1,1]
    v_pk_mul_f32 v[74:75], v[74:75], v[132:133] op_sel:[0,1] op_sel_hi:[1,1]
    v_cvt_pk_bf16_f32 v70, v70, v71
    v_cvt_pk_bf16_f32 v71, v72, v73
    v_cvt_pk_bf16_f32 v72, v74, v75
    buffer_store_dwordx3 v[64:66], v56, s[12:15], s42 offen offset:0 sc0 sc1
    v_accvgpr_read_b32 v76, a146
    v_accvgpr_read_b32 v77, a150
    v_accvgpr_read_b32 v78, a154
    v_accvgpr_read_b32 v79, a158
    v_accvgpr_read_b32 v80, a162
    v_accvgpr_read_b32 v81, a166
    v_pk_mul_f32 v[76:77], v[76:77], v[134:135] op_sel_hi:[1,0]
    v_pk_mul_f32 v[78:79], v[78:79], v[134:135] op_sel_hi:[1,0]
    v_pk_mul_f32 v[80:81], v[80:81], v[134:135] op_sel_hi:[1,0]
    v_cvt_pk_bf16_f32 v76, v76, v77
    v_cvt_pk_bf16_f32 v77, v78, v79
    v_cvt_pk_bf16_f32 v78, v80, v81
    buffer_store_dwordx3 v[70:72], v56, s[12:15], s42 offen offset:384 sc0 sc1
    v_accvgpr_read_b32 v82, a147
    v_accvgpr_read_b32 v83, a151
    v_accvgpr_read_b32 v84, a155
    v_accvgpr_read_b32 v85, a159
    v_accvgpr_read_b32 v86, a163
    v_accvgpr_read_b32 v87, a167
    v_pk_mul_f32 v[82:83], v[82:83], v[134:135] op_sel:[0,1] op_sel_hi:[1,1]
    v_pk_mul_f32 v[84:85], v[84:85], v[134:135] op_sel:[0,1] op_sel_hi:[1,1]
    v_pk_mul_f32 v[86:87], v[86:87], v[134:135] op_sel:[0,1] op_sel_hi:[1,1]
    v_cvt_pk_bf16_f32 v82, v82, v83
    v_cvt_pk_bf16_f32 v83, v84, v85
    v_cvt_pk_bf16_f32 v84, v86, v87
    buffer_store_dwordx3 v[76:78], v56, s[12:15], s42 offen offset:768 sc0 sc1
    v_accvgpr_read_b32 v88, a168
    v_accvgpr_read_b32 v89, a172
    v_accvgpr_read_b32 v90, a176
    v_accvgpr_read_b32 v91, a180
    v_accvgpr_read_b32 v92, a184
    v_accvgpr_read_b32 v93, a188
    v_pk_mul_f32 v[88:89], v[88:89], v[132:133] op_sel_hi:[1,0]
    v_pk_mul_f32 v[90:91], v[90:91], v[132:133] op_sel_hi:[1,0]
    v_pk_mul_f32 v[92:93], v[92:93], v[132:133] op_sel_hi:[1,0]
    v_cvt_pk_bf16_f32 v88, v88, v89
    v_cvt_pk_bf16_f32 v89, v90, v91
    v_cvt_pk_bf16_f32 v90, v92, v93
    buffer_store_dwordx3 v[82:84], v56, s[12:15], s42 offen offset:1152 sc0 sc1
    v_accvgpr_read_b32 v94, a169
    v_accvgpr_read_b32 v95, a173
    v_accvgpr_read_b32 v96, a177
    v_accvgpr_read_b32 v97, a181
    v_accvgpr_read_b32 v98, a185
    v_accvgpr_read_b32 v99, a189
    v_pk_mul_f32 v[94:95], v[94:95], v[132:133] op_sel:[0,1] op_sel_hi:[1,1]
    v_pk_mul_f32 v[96:97], v[96:97], v[132:133] op_sel:[0,1] op_sel_hi:[1,1]
    v_pk_mul_f32 v[98:99], v[98:99], v[132:133] op_sel:[0,1] op_sel_hi:[1,1]
    v_cvt_pk_bf16_f32 v94, v94, v95
    v_cvt_pk_bf16_f32 v95, v96, v97
    v_cvt_pk_bf16_f32 v96, v98, v99
    buffer_store_dwordx3 v[88:90], v56, s[12:15], s42 offen offset:192 sc0 sc1
    v_accvgpr_read_b32 v100, a170
    v_accvgpr_read_b32 v101, a174
    v_accvgpr_read_b32 v102, a178
    v_accvgpr_read_b32 v103, a182
    v_accvgpr_read_b32 v104, a186
    v_accvgpr_read_b32 v105, a190
    v_pk_mul_f32 v[100:101], v[100:101], v[134:135] op_sel_hi:[1,0]
    v_pk_mul_f32 v[102:103], v[102:103], v[134:135] op_sel_hi:[1,0]
    v_pk_mul_f32 v[104:105], v[104:105], v[134:135] op_sel_hi:[1,0]
    v_cvt_pk_bf16_f32 v100, v100, v101
    v_cvt_pk_bf16_f32 v101, v102, v103
    v_cvt_pk_bf16_f32 v102, v104, v105
    buffer_store_dwordx3 v[94:96], v56, s[12:15], s42 offen offset:576 sc0 sc1
    v_accvgpr_read_b32 v106, a171
    v_accvgpr_read_b32 v107, a175
    v_accvgpr_read_b32 v108, a179
    v_accvgpr_read_b32 v109, a183
    v_accvgpr_read_b32 v110, a187
    v_accvgpr_read_b32 v111, a191
    v_pk_mul_f32 v[106:107], v[106:107], v[134:135] op_sel:[0,1] op_sel_hi:[1,1]
    v_pk_mul_f32 v[108:109], v[108:109], v[134:135] op_sel:[0,1] op_sel_hi:[1,1]
    v_pk_mul_f32 v[110:111], v[110:111], v[134:135] op_sel:[0,1] op_sel_hi:[1,1]
    v_cvt_pk_bf16_f32 v106, v106, v107
    v_cvt_pk_bf16_f32 v107, v108, v109
    v_cvt_pk_bf16_f32 v108, v110, v111
    buffer_store_dwordx3 v[100:102], v56, s[12:15], s42 offen offset:960 sc0 sc1
    buffer_store_dwordx3 v[106:108], v56, s[12:15], s42 offen offset:1344 sc0 sc1
    s_branch L_fin
.section .rodata,"a"
.p2align 6
.amdhsa_kernel standalone__kv_cache_quant_int4_int2_kv_with_per_channel_or_per_token_scales__prompt_kernel
  .amdhsa_next_free_vgpr 512
  .amdhsa_next_free_sgpr 102
  .amdhsa_accum_offset 256
  .amdhsa_group_segment_fixed_size 0
  .amdhsa_kernarg_size 80
  .amdhsa_user_sgpr_count 2
  .amdhsa_user_sgpr_kernarg_segment_ptr 1
  .amdhsa_system_sgpr_workgroup_id_x 1
.end_amdhsa_kernel
```

```asm
; @launch grid=(256,1,1) block=(256,1,1) lds=147584
.amdgcn_target "amdgcn-amd-amdhsa--gfx950"
.text
.globl standalone__kv_cache_quant_int4_int2_kv_with_per_channel_or_per_token_scales__prompt_kernel
.p2align 8
.type standalone__kv_cache_quant_int4_int2_kv_with_per_channel_or_per_token_scales__prompt_kernel,@function
standalone__kv_cache_quant_int4_int2_kv_with_per_channel_or_per_token_scales__prompt_kernel:
    s_cmp_ge_u32 s2, 256
    s_cbranch_scc1 L_done
    s_load_dwordx16 s[40:55], s[0:1], 0
    s_load_dwordx4 s[16:19], s[0:1], 64
    s_and_b32 s94, s2, 7
    s_lshr_b32 s95, s2, 3
    s_lshr_b32 s24, s95, 3
    s_lshl_b32 s94, s94, 2
    s_add_u32 s94, s94, s24
    s_and_b32 s95, s95, 7
    s_getpc_b64 s[60:61]
L_pc:
    s_sub_u32 s60, s60, L_pc-standalone__kv_cache_quant_int4_int2_kv_with_per_channel_or_per_token_scales__prompt_kernel
    s_subb_u32 s61, s61, 0
    s_mov_b32 s62, L_slow-standalone__kv_cache_quant_int4_int2_kv_with_per_channel_or_per_token_scales__prompt_kernel
    s_mov_b32 s63, 0x20000
    s_lshr_b32 s22, s2, 3
    s_lshl_b32 s22, s22, 12
    v_lshlrev_b32 v30, 4, v0
    buffer_load_dwordx4 v[128:131], v30, s[60:63], s22 offen
    v_lshrrev_b32 v24, 6, v0
    v_and_b32 v25, 63, v0
    v_readfirstlane_b32 s25, v24
    v_lshlrev_b32 v1, 4, v25
    v_mul_u32_u24 v26, 43, v25
    v_lshrrev_b32 v26, 10, v26
    v_mul_u32_u24 v27, 24, v26
    v_sub_u32 v27, v25, v27
    v_lshrrev_b32 v28, 1, v24
    v_and_b32 v29, 1, v24
    v_lshlrev_b32 v30, 4, v29
    v_lshl_add_u32 v30, v28, 2, v30
    v_add_u32 v30, v30, v26
    v_mul_u32_u24 v30, 768, v30
    v_lshrrev_b32 v48, 1, v26
    v_lshlrev_b32 v48, 30, v48
    v_lshl_add_u32 v30, v27, 4, v30
    v_or_b32 v9, v30, v48
    v_lshl_or_b32 v10, v27, 3, v48
    v_mul_u32_u24 v30, 6144, v24
    v_mul_u32_u24 v31, 12, v25
    v_add_u32 v12, v30, v31
    s_mov_b32 s66, 1572864
    s_mov_b32 s67, 0x20000
    s_mov_b32 s70, 1572864
    s_mov_b32 s71, 0x20000
    s_mov_b32 s74, 12288
    s_mov_b32 s75, 0x20000
    s_mov_b32 s78, 12288
    s_mov_b32 s79, 0x20000
    s_mov_b32 s82, 4096
    s_mov_b32 s83, 0x20000
    s_mov_b32 s86, 4096
    s_mov_b32 s87, 0x20000
    s_mov_b32 s22, 64
    s_mov_b32 s23, 0x20000
    s_mul_i32 s33, s95, 24576
    s_add_u32 s34, s33, 6144
    s_mov_b32 s35, s33
    s_lshr_b32 s36, s95, 1
    s_mul_i32 s36, s36, 384
    s_lshl_b32 s37, s95, 6
    s_lshl_b32 s24, s25, 4
    s_add_u32 s37, s37, s24
    s_mul_i32 s24, s94, 1572864
    s_mul_i32 s56, s94, 12288
    s_lshl_b32 s57, s94, 12
    s_lshl_b32 s58, s94, 10
    s_add_u32 s58, s58, 51380320
    s_or_b32 s39, s95, s25
    s_waitcnt lgkmcnt(0)
    s_add_u32 s64, s42, s24
    s_addc_u32 s65, s43, 0
    s_add_u32 s72, s46, s56
    s_addc_u32 s73, s47, 0
    s_add_u32 s76, s48, s56
    s_addc_u32 s77, s49, 0
    buffer_load_dwordx4 v[224:227], v9, s[64:67], s33 offen offset:0 nt
    buffer_load_dwordx4 v[228:231], v9, s[64:67], s33 offen offset:1536 nt
    buffer_load_dwordx4 v[232:235], v9, s[64:67], s34 offen offset:0 nt
    buffer_load_dwordx4 v[236:239], v9, s[64:67], s34 offen offset:1536 nt
    buffer_load_dwordx2 v[32:33], v10, s[72:75], s36 offen offset:0
    buffer_load_dwordx2 v[34:35], v10, s[76:79], s36 offen offset:0
    buffer_load_dwordx2 v[36:37], v10, s[72:75], s36 offen offset:192
    buffer_load_dwordx2 v[38:39], v10, s[76:79], s36 offen offset:192
    s_add_u32 s20, s18, s58
    s_addc_u32 s21, s19, 0
    s_add_u32 s80, s50, s57
    s_addc_u32 s81, s51, 0
    s_add_u32 s84, s52, s57
    s_addc_u32 s85, s53, 0
    s_add_u32 s68, s44, s24
    s_addc_u32 s69, s45, 0
    s_mul_i32 s59, s94, 786432
    s_add_u32 s12, s54, s59
    s_addc_u32 s13, s55, 0
    s_add_u32 s8, s40, s59
    s_addc_u32 s9, s41, 0
    s_cmp_lg_u32 s39, 0
    s_cbranch_scc1 L_notleader0
    s_buffer_load_dwordx16 s[40:55], s[20:23], 0 glc
L_notleader0:
    buffer_load_dwordx4 v[240:243], v9, s[64:67], s33 offen offset:384 nt
    buffer_load_dwordx4 v[244:247], v9, s[64:67], s33 offen offset:1920 nt
    buffer_load_dwordx4 v[248:251], v9, s[64:67], s34 offen offset:384 nt
    buffer_load_dwordx4 v[252:255], v9, s[64:67], s34 offen offset:1920 nt
    s_add_u32 s4, s18, s24
    s_addc_u32 s5, s19, 0
    s_mov_b32 s6, 1572864
    s_mov_b32 s7, 0x20000
    s_mov_b32 s10, 786432
    s_mov_b32 s11, 0x20000
    s_mov_b32 s88, s16
    s_mov_b32 s89, s17
    s_add_u32 s16, s33, 3072
    s_add_u32 s17, s33, 6144
    s_mov_b32 s90, 256
    s_mov_b32 s91, 0x20000
    s_lshl_b32 s93, s94, 3
    s_cmp_lg_u32 s39, 0
    s_cbranch_scc1 L_notleader
    s_waitcnt lgkmcnt(0)
    s_mov_b32 s59, 1
    s_lshr_b32 s40, s40, 10
    s_min_u32 s40, s40, 31
    s_bitset1_b32 s59, s40
    s_lshr_b32 s41, s41, 10
    s_min_u32 s41, s41, 31
    s_bitset1_b32 s59, s41
    s_lshr_b32 s42, s42, 10
    s_min_u32 s42, s42, 31
    s_bitset1_b32 s59, s42
    s_lshr_b32 s43, s43, 10
    s_min_u32 s43, s43, 31
    s_bitset1_b32 s59, s43
    s_lshr_b32 s44, s44, 10
    s_min_u32 s44, s44, 31
    s_bitset1_b32 s59, s44
    s_lshr_b32 s45, s45, 10
    s_min_u32 s45, s45, 31
    s_bitset1_b32 s59, s45
    s_lshr_b32 s46, s46, 10
    s_min_u32 s46, s46, 31
    s_bitset1_b32 s59, s46
    s_lshr_b32 s47, s47, 10
    s_min_u32 s47, s47, 31
    s_bitset1_b32 s59, s47
    s_lshr_b32 s48, s48, 10
    s_min_u32 s48, s48, 31
    s_bitset1_b32 s59, s48
    s_lshr_b32 s49, s49, 10
    s_min_u32 s49, s49, 31
    s_bitset1_b32 s59, s49
    s_lshr_b32 s50, s50, 10
    s_min_u32 s50, s50, 31
    s_bitset1_b32 s59, s50
    s_lshr_b32 s51, s51, 10
    s_min_u32 s51, s51, 31
    s_bitset1_b32 s59, s51
    s_lshr_b32 s52, s52, 10
    s_min_u32 s52, s52, 31
    s_bitset1_b32 s59, s52
    s_lshr_b32 s53, s53, 10
    s_min_u32 s53, s53, 31
    s_bitset1_b32 s59, s53
    s_lshr_b32 s54, s54, 10
    s_min_u32 s54, s54, 31
    s_bitset1_b32 s59, s54
    s_lshr_b32 s55, s55, 10
    s_min_u32 s55, s55, 31
    s_bitset1_b32 s59, s55
    s_ff0_i32_b32 s59, s59
    s_lshl_b32 s59, s59, 10
    v_mov_b32 v52, s59
    s_mov_b64 exec, 1
    buffer_store_dword v52, off, s[88:91], s93 sc1
    s_mov_b64 exec, -1
L_notleader:
    s_lshl_b32 s24, s95, 2
    s_add_u32 s24, s24, 32
    s_buffer_load_dword s46, s[20:23], s24 glc
    s_getreg_b32 s45, hwreg(HW_REG_XCC_ID, 0, 4)
    s_lshl_b32 s45, s45, 5
    s_mov_b32 s44, 32
    buffer_load_dwordx3 v[112:114], v12, s[68:71], s35 offen offset:0 nt
    buffer_load_dwordx3 v[116:118], v12, s[68:71], s35 offen offset:768 nt
    buffer_load_dwordx3 v[120:122], v12, s[68:71], s35 offen offset:1536 nt
    buffer_load_dwordx3 v[124:126], v12, s[68:71], s35 offen offset:2304 nt
    buffer_load_dwordx2 v[40:41], off, s[80:83], s37 offset:0
    buffer_load_dwordx2 v[42:43], off, s[84:87], s37 offset:0
    buffer_load_dwordx2 v[44:45], off, s[80:83], s37 offset:8
    buffer_load_dwordx2 v[46:47], off, s[84:87], s37 offset:8
    s_mov_b32 s14, 786432
    s_mov_b32 s15, 0x20000
    s_lshl_b32 s24, s25, 8
    s_add_u32 s93, s93, s24
    v_mul_u32_u24 v30, 3072, v24
    v_add_u32 v4, v30, v1
    v_lshl_add_u32 v30, v24, 3, v26
    v_mul_u32_u24 v30, 384, v30
    v_lshlrev_b32 v31, 2, v29
    v_xor_b32 v31, v27, v31
    v_lshl_add_u32 v30, v31, 4, v30
    v_or_b32 v11, v30, v48
    v_lshlrev_b32 v30, 8, v24
    v_add_u32 v30, 12288, v30
    v_lshrrev_b32 v31, 5, v25
    v_mul_u32_u24 v31, 6144, v31
    v_add_u32 v30, v30, v31
    v_and_b32 v31, 1, v25
    v_mul_u32_u24 v31, 3072, v31
    v_add_u32 v30, v30, v31
    v_bfe_u32 v31, v25, 1, 4
    v_lshl_add_u32 v15, v31, 4, v30
    s_lshl_b32 s24, s95, 2
    v_lshl_add_u32 v13, v0, 2, s24
    v_cmp_lt_u32 vcc, 0, v0
    v_mov_b32 v30, 0x40000000
    s_nop 0
    v_cndmask_b32 v13, v13, v30, vcc
    s_mul_i32 s26, s25, 3072
    s_add_u32 s26, s26, 12288
    s_add_u32 s56, s26, 24576
    s_add_u32 s24, s95, 1
    s_and_b32 s24, s24, 7
    s_mul_i32 s32, s24, 24576
    s_add_u32 s27, s32, 12288
    s_mov_b32 s28, 98304
    s_mov_b32 s30, 73728
    v_add_u32 v1, 24576, v1
    s_mov_b32 s38, 0x3dd53b95
    s_mov_b32 s97, 0xffff0000
    s_mov_b32 s96, 100000
    v_and_b32 v26, 15, v25
    v_lshrrev_b32 v27, 4, v25
    v_bfe_u32 v28, v25, 1, 3
    v_xor_b32 v29, v27, v28
    v_mul_u32_u24 v30, 384, v26
    v_lshl_add_u32 v2, v29, 4, v30
    v_xor_b32 v3, 64, v2
    s_mul_i32 s40, s25, 6144
    s_add_u32 s40, s40, 73728
    v_lshrrev_b32 v29, 1, v27
    v_xor_b32 v29, v29, v28
    v_lshl_add_u32 v31, v29, 4, v30
    v_and_b32 v29, 1, v27
    v_lshl_add_u32 v31, v29, 3, v31
    v_xor_b32 v22, 0, v31
    v_add_u32 v22, s40, v22
    v_xor_b32 v23, 32, v31
    v_add_u32 v23, s40, v23
    v_xor_b32 v142, 64, v31
    v_add_u32 v142, s40, v142
    v_xor_b32 v143, 96, v31
    v_add_u32 v143, s40, v143
    s_lshl_b32 s24, s95, 2
    s_add_u32 s24, s24, s25
    s_mul_i32 s24, s24, 24576
    v_add_u32 v26, 0, v25
    v_mul_u32_u24 v27, 2731, v26
    v_lshrrev_b32 v27, 17, v27
    v_and_b32 v27, 7, v27
    v_xor_b32 v26, v26, v27
    v_lshlrev_b32 v136, 4, v26
    v_add_u32 v136, s24, v136
    v_add_u32 v26, 64, v25
    v_mul_u32_u24 v27, 2731, v26
    v_lshrrev_b32 v27, 17, v27
    v_and_b32 v27, 7, v27
    v_xor_b32 v26, v26, v27
    v_lshlrev_b32 v137, 4, v26
    v_add_u32 v137, s24, v137
    v_add_u32 v26, 128, v25
    v_mul_u32_u24 v27, 2731, v26
    v_lshrrev_b32 v27, 17, v27
    v_and_b32 v27, 7, v27
    v_xor_b32 v26, v26, v27
    v_lshlrev_b32 v138, 4, v26
    v_add_u32 v138, s24, v138
    v_add_u32 v26, 192, v25
    v_mul_u32_u24 v27, 2731, v26
    v_lshrrev_b32 v27, 17, v27
    v_and_b32 v27, 7, v27
    v_xor_b32 v26, v26, v27
    v_lshlrev_b32 v139, 4, v26
    v_add_u32 v139, s24, v139
    v_add_u32 v26, 256, v25
    v_mul_u32_u24 v27, 2731, v26
    v_lshrrev_b32 v27, 17, v27
    v_and_b32 v27, 7, v27
    v_xor_b32 v26, v26, v27
    v_lshlrev_b32 v140, 4, v26
    v_add_u32 v140, s24, v140
    v_add_u32 v26, 320, v25
    v_mul_u32_u24 v27, 2731, v26
    v_lshrrev_b32 v27, 17, v27
    v_and_b32 v27, 7, v27
    v_xor_b32 v26, v26, v27
    v_lshlrev_b32 v141, 4, v26
    v_add_u32 v141, s24, v141
    v_mov_b32 v5, 0
    v_mov_b32 v6, 0
    v_mov_b32 v7, 0
    v_mov_b32 v8, 0
    s_mov_b32 s62, -1
    s_mov_b32 s63, 0xffff
    s_waitcnt vmcnt(12)
    s_bitcmp1_b32 s2, 0
    s_cbranch_scc1 L_thr1
    s_waitcnt vmcnt(7)
L_thr1:
    buffer_load_dwordx3 v[80:82], v12, s[68:71], s16 offen offset:0 nt
    s_bitcmp1_b32 s2, 0
    s_cbranch_scc1 L_thr2
    s_waitcnt vmcnt(7)
L_thr2:
    buffer_load_dwordx3 v[84:86], v12, s[68:71], s16 offen offset:768 nt
    s_bitcmp1_b32 s2, 0
    s_cbranch_scc1 L_thr3
    s_waitcnt vmcnt(7)
L_thr3:
    buffer_load_dwordx3 v[88:90], v12, s[68:71], s16 offen offset:1536 nt
    s_bitcmp1_b32 s2, 0
    s_cbranch_scc1 L_thr4
    s_waitcnt vmcnt(7)
L_thr4:
    buffer_load_dwordx3 v[92:94], v12, s[68:71], s16 offen offset:2304 nt
    v_lshlrev_b32 v48, 16, v32
    v_and_b32 v49, s97, v32
    v_lshlrev_b32 v50, 16, v34
    v_and_b32 v51, s97, v34
    v_mul_f32 v48, s38, v48
    v_mul_f32 v49, s38, v49
    v_mul_f32_e64 v50, -v50, v48
    v_mul_f32_e64 v51, -v51, v49
    v_cvt_f32_i32 v224, v224
    v_cvt_f32_i32 v225, v225
    v_fma_f32 v224, v224, v48, v50
    v_fma_f32 v225, v225, v49, v51
    v_cvt_pk_bf16_f32 v224, v224, v225
    v_cvt_f32_i32 v228, v228
    v_cvt_f32_i32 v229, v229
    v_fma_f32 v228, v228, v48, v50
    v_fma_f32 v229, v229, v49, v51
    v_cvt_pk_bf16_f32 v228, v228, v229
    v_cvt_f32_i32 v232, v232
    v_cvt_f32_i32 v233, v233
    v_fma_f32 v232, v232, v48, v50
    v_fma_f32 v233, v233, v49, v51
    v_cvt_pk_bf16_f32 v232, v232, v233
    v_cvt_f32_i32 v236, v236
    v_cvt_f32_i32 v237, v237
    v_fma_f32 v236, v236, v48, v50
    v_fma_f32 v237, v237, v49, v51
    v_cvt_pk_bf16_f32 v236, v236, v237
    v_lshlrev_b32 v48, 16, v33
    v_and_b32 v49, s97, v33
    v_lshlrev_b32 v50, 16, v35
    v_and_b32 v51, s97, v35
    v_mul_f32 v48, s38, v48
    v_mul_f32 v49, s38, v49
    v_mul_f32_e64 v50, -v50, v48
    v_mul_f32_e64 v51, -v51, v49
    v_cvt_f32_i32 v226, v226
    v_cvt_f32_i32 v227, v227
    v_fma_f32 v226, v226, v48, v50
    v_fma_f32 v227, v227, v49, v51
    v_cvt_pk_bf16_f32 v225, v226, v227
    v_cvt_f32_i32 v230, v230
    v_cvt_f32_i32 v231, v231
    v_fma_f32 v230, v230, v48, v50
    v_fma_f32 v231, v231, v49, v51
    v_cvt_pk_bf16_f32 v229, v230, v231
    v_cvt_f32_i32 v234, v234
    v_cvt_f32_i32 v235, v235
    v_fma_f32 v234, v234, v48, v50
    v_fma_f32 v235, v235, v49, v51
    v_cvt_pk_bf16_f32 v233, v234, v235
    v_cvt_f32_i32 v238, v238
    v_cvt_f32_i32 v239, v239
    v_fma_f32 v238, v238, v48, v50
    v_fma_f32 v239, v239, v49, v51
    v_cvt_pk_bf16_f32 v237, v238, v239
    s_waitcnt vmcnt(12)
    v_lshlrev_b32 v48, 16, v36
    v_and_b32 v49, s97, v36
    v_lshlrev_b32 v50, 16, v38
    v_and_b32 v51, s97, v38
    v_mul_f32 v48, s38, v48
    v_mul_f32 v49, s38, v49
    v_mul_f32_e64 v50, -v50, v48
    v_mul_f32_e64 v51, -v51, v49
    v_cvt_f32_i32 v240, v240
    v_cvt_f32_i32 v241, v241
    v_fma_f32 v240, v240, v48, v50
    v_fma_f32 v241, v241, v49, v51
    v_cvt_pk_bf16_f32 v226, v240, v241
    v_cvt_f32_i32 v244, v244
    v_cvt_f32_i32 v245, v245
    v_fma_f32 v244, v244, v48, v50
    v_fma_f32 v245, v245, v49, v51
    v_cvt_pk_bf16_f32 v230, v244, v245
    v_cvt_f32_i32 v248, v248
    v_cvt_f32_i32 v249, v249
    v_fma_f32 v248, v248, v48, v50
    v_fma_f32 v249, v249, v49, v51
    v_cvt_pk_bf16_f32 v234, v248, v249
    v_cvt_f32_i32 v252, v252
    v_cvt_f32_i32 v253, v253
    v_fma_f32 v252, v252, v48, v50
    v_fma_f32 v253, v253, v49, v51
    v_cvt_pk_bf16_f32 v238, v252, v253
    v_lshlrev_b32 v48, 16, v37
    v_and_b32 v49, s97, v37
    v_lshlrev_b32 v50, 16, v39
    v_and_b32 v51, s97, v39
    v_mul_f32 v48, s38, v48
    v_mul_f32 v49, s38, v49
    v_mul_f32_e64 v50, -v50, v48
    v_mul_f32_e64 v51, -v51, v49
    v_cvt_f32_i32 v242, v242
    v_cvt_f32_i32 v243, v243
    v_fma_f32 v242, v242, v48, v50
    v_fma_f32 v243, v243, v49, v51
    v_cvt_pk_bf16_f32 v227, v242, v243
    v_cvt_f32_i32 v246, v246
    v_cvt_f32_i32 v247, v247
    v_fma_f32 v246, v246, v48, v50
    v_fma_f32 v247, v247, v49, v51
    v_cvt_pk_bf16_f32 v231, v246, v247
    v_cvt_f32_i32 v250, v250
    v_cvt_f32_i32 v251, v251
    v_fma_f32 v250, v250, v48, v50
    v_fma_f32 v251, v251, v49, v51
    v_cvt_pk_bf16_f32 v235, v250, v251
    v_cvt_f32_i32 v254, v254
    v_cvt_f32_i32 v255, v255
    v_fma_f32 v254, v254, v48, v50
    v_fma_f32 v255, v255, v49, v51
    v_cvt_pk_bf16_f32 v239, v254, v255
    buffer_store_dwordx4 v[224:227], v11, s[4:7], s33 offen offset:0
    s_mov_b64 exec, s[62:63]
    ds_write_b128 v11, v[224:227] offset:0
    s_mov_b64 exec, -1
    v_xor_b32 v55, 16, v11
    buffer_store_dwordx4 v[228:231], v55, s[4:7], s33 offen offset:768
    s_mov_b64 exec, s[62:63]
    ds_write_b128 v55, v[228:231] offset:768
    s_mov_b64 exec, -1
    v_xor_b32 v54, 32, v11
    buffer_store_dwordx4 v[232:235], v54, s[4:7], s33 offen offset:1536
    s_mov_b64 exec, s[62:63]
    ds_write_b128 v54, v[232:235] offset:1536
    s_mov_b64 exec, -1
    v_xor_b32 v55, 48, v11
    buffer_store_dwordx4 v[236:239], v55, s[4:7], s33 offen offset:2304
    s_mov_b64 exec, s[62:63]
    ds_write_b128 v55, v[236:239] offset:2304
    s_mov_b64 exec, -1
    s_mov_b32 s41, 0
    s_add_u32 m0, s40, 24576
    s_nop 0
    s_bitcmp1_b32 s2, 0
    s_cbranch_scc1 L_thr5
    s_waitcnt vmcnt(8)
L_thr5:
    buffer_load_dwordx4 v136, s[8:11], s41 offen nt lds
    s_add_u32 m0, s40, 25600
    s_nop 0
    s_bitcmp1_b32 s2, 0
    s_cbranch_scc1 L_thr6
    s_waitcnt vmcnt(7)
L_thr6:
    buffer_load_dwordx4 v137, s[8:11], s41 offen nt lds
    s_add_u32 m0, s40, 26624
    s_nop 0
    s_bitcmp1_b32 s2, 0
    s_cbranch_scc1 L_thr7
    s_waitcnt vmcnt(7)
L_thr7:
    buffer_load_dwordx4 v138, s[8:11], s41 offen nt lds
    s_add_u32 m0, s40, 27648
    s_nop 0
    s_bitcmp1_b32 s2, 0
    s_cbranch_scc1 L_thr8
    s_waitcnt vmcnt(7)
L_thr8:
    buffer_load_dwordx4 v139, s[8:11], s41 offen nt lds
    s_add_u32 m0, s40, 28672
    s_nop 0
    s_bitcmp1_b32 s2, 0
    s_cbranch_scc1 L_thr9
    s_waitcnt vmcnt(3)
L_thr9:
    buffer_load_dwordx4 v140, s[8:11], s41 offen nt lds
    s_add_u32 m0, s40, 29696
    s_waitcnt vmcnt(20)
    s_bitcmp1_b32 s2, 0
    s_cbranch_scc1 L_thr10
    s_waitcnt vmcnt(3)
L_thr10:
    buffer_load_dwordx4 v141, s[8:11], s41 offen nt lds
    s_waitcnt vmcnt(14)
    v_lshlrev_b32 v48, 16, v40
    v_and_b32 v49, s97, v40
    v_lshlrev_b32 v50, 16, v42
    v_and_b32 v51, s97, v42
    v_mul_f32_e64 v50, -v50, v48
    v_mul_f32_e64 v51, -v51, v49
    v_cvt_f32_i32 v112, v112
    v_cvt_f32_i32 v116, v116
    v_fma_f32 v112, v112, v48, v50
    v_fma_f32 v116, v116, v49, v51
    v_cvt_f32_i32 v113, v113
    v_cvt_f32_i32 v117, v117
    v_fma_f32 v113, v113, v48, v50
    v_fma_f32 v117, v117, v49, v51
    v_cvt_f32_i32 v114, v114
    v_cvt_f32_i32 v118, v118
    v_fma_f32 v114, v114, v48, v50
    v_fma_f32 v118, v118, v49, v51
    v_lshlrev_b32 v48, 16, v41
    v_and_b32 v49, s97, v41
    v_lshlrev_b32 v50, 16, v43
    v_and_b32 v51, s97, v43
    v_mul_f32_e64 v50, -v50, v48
    v_mul_f32_e64 v51, -v51, v49
    v_cvt_f32_i32 v120, v120
    v_cvt_f32_i32 v124, v124
    v_fma_f32 v120, v120, v48, v50
    v_fma_f32 v124, v124, v49, v51
    v_cvt_f32_i32 v121, v121
    v_cvt_f32_i32 v125, v125
    v_fma_f32 v121, v121, v48, v50
    v_fma_f32 v125, v125, v49, v51
    v_cvt_f32_i32 v122, v122
    v_cvt_f32_i32 v126, v126
    v_fma_f32 v122, v122, v48, v50
    v_fma_f32 v126, v126, v49, v51
    v_cvt_pk_bf16_f32 v112, v112, v116
    v_cvt_pk_bf16_f32 v116, v113, v117
    v_cvt_pk_bf16_f32 v113, v120, v124
    v_cvt_pk_bf16_f32 v117, v121, v125
    v_cvt_pk_bf16_f32 v120, v114, v118
    v_cvt_pk_bf16_f32 v121, v122, v126
    s_waitcnt vmcnt(10)
    v_lshlrev_b32 v48, 16, v44
    v_and_b32 v49, s97, v44
    v_lshlrev_b32 v50, 16, v46
    v_and_b32 v51, s97, v46
    v_mul_f32_e64 v50, -v50, v48
    v_mul_f32_e64 v51, -v51, v49
    v_cvt_f32_i32 v80, v80
    v_cvt_f32_i32 v84, v84
    v_fma_f32 v80, v80, v48, v50
    v_fma_f32 v84, v84, v49, v51
    v_cvt_f32_i32 v81, v81
    v_cvt_f32_i32 v85, v85
    v_fma_f32 v81, v81, v48, v50
    v_fma_f32 v85, v85, v49, v51
    v_cvt_f32_i32 v82, v82
    v_cvt_f32_i32 v86, v86
    v_fma_f32 v82, v82, v48, v50
    v_fma_f32 v86, v86, v49, v51
    v_lshlrev_b32 v48, 16, v45
    v_and_b32 v49, s97, v45
    v_lshlrev_b32 v50, 16, v47
    v_and_b32 v51, s97, v47
    v_mul_f32_e64 v50, -v50, v48
    v_mul_f32_e64 v51, -v51, v49
    v_cvt_f32_i32 v88, v88
    v_cvt_f32_i32 v92, v92
    v_fma_f32 v88, v88, v48, v50
    v_fma_f32 v92, v92, v49, v51
    v_cvt_f32_i32 v89, v89
    v_cvt_f32_i32 v93, v93
    v_fma_f32 v89, v89, v48, v50
    v_fma_f32 v93, v93, v49, v51
    v_cvt_f32_i32 v90, v90
    v_cvt_f32_i32 v94, v94
    v_fma_f32 v90, v90, v48, v50
    v_fma_f32 v94, v94, v49, v51
    v_cvt_pk_bf16_f32 v114, v80, v84
    v_cvt_pk_bf16_f32 v118, v81, v85
    v_cvt_pk_bf16_f32 v115, v88, v92
    v_cvt_pk_bf16_f32 v119, v89, v93
    v_cvt_pk_bf16_f32 v122, v82, v86
    v_cvt_pk_bf16_f32 v123, v90, v94
    buffer_store_dwordx4 v[112:115], v15, s[4:7], s35 offen offset:0
    buffer_store_dwordx4 v[116:119], v15, s[4:7], s35 offen offset:1024
    buffer_store_dwordx4 v[120:123], v15, s[4:7], s35 offen offset:2048
    ds_write_b128 v15, v[112:115] offset:12288
    ds_write_b128 v15, v[116:119] offset:13312
    ds_write_b128 v15, v[120:123] offset:14336
    s_bitcmp1_b32 s2, 0
    s_cbranch_scc1 L_thr11
    s_waitcnt vmcnt(6)
L_thr11:
    buffer_load_dword v0, off, s[88:91], s93 sc1
    s_mov_b32 s41, 6144
    s_add_u32 m0, s40, 0
    s_nop 0
    s_bitcmp1_b32 s2, 0
    s_cbranch_scc1 L_thr12
    s_waitcnt vmcnt(6)
L_thr12:
    buffer_load_dwordx4 v136, s[8:11], s41 offen nt lds
    s_add_u32 m0, s40, 1024
    s_nop 0
    s_bitcmp1_b32 s2, 0
    s_cbranch_scc1 L_thr13
    s_waitcnt vmcnt(6)
L_thr13:
    buffer_load_dwordx4 v137, s[8:11], s41 offen nt lds
    s_add_u32 m0, s40, 2048
    s_nop 0
    s_bitcmp1_b32 s2, 0
    s_cbranch_scc1 L_thr14
    s_waitcnt vmcnt(6)
L_thr14:
    buffer_load_dwordx4 v138, s[8:11], s41 offen nt lds
    s_add_u32 m0, s40, 3072
    s_nop 0
    s_bitcmp1_b32 s2, 0
    s_cbranch_scc1 L_thr15
    s_waitcnt vmcnt(3)
L_thr15:
    buffer_load_dwordx4 v139, s[8:11], s41 offen nt lds
    s_add_u32 m0, s40, 4096
    s_nop 0
    s_bitcmp1_b32 s2, 0
    s_cbranch_scc1 L_thr16
    s_waitcnt vmcnt(3)
L_thr16:
    buffer_load_dwordx4 v140, s[8:11], s41 offen nt lds
    s_add_u32 m0, s40, 5120
    s_waitcnt vmcnt(14)
    s_bitcmp1_b32 s2, 0
    s_cbranch_scc1 L_thr17
    s_waitcnt vmcnt(3)
L_thr17:
    buffer_load_dwordx4 v141, s[8:11], s41 offen nt lds
    s_mov_b64 exec, 0
    s_cmp_eq_u32 s25, 0
    s_cbranch_scc1 L_iw0
    s_cmp_eq_u32 s25, 1
    s_cbranch_scc1 L_iw1
    s_cmp_eq_u32 s25, 2
    s_cbranch_scc1 L_iw2
    s_branch L_iw3
L_iwret:
    s_mov_b64 exec, -1
    s_waitcnt vmcnt(6)
    s_cmp_lg_u32 s25, 0
    s_cbranch_scc1 L_tagdone
    v_readfirstlane_b32 s42, v0
    s_mov_b32 s39, 100
    s_waitcnt lgkmcnt(0)
    s_and_b32 s46, s46, 0xfffffc00
L_tagretry:
    s_cmp_eq_u32 s42, s46
    s_cselect_b32 s42, 0, s42
    s_cmp_lg_u32 s42, 0
    s_cbranch_scc1 L_tagok
    s_sub_u32 s39, s39, 1
    s_cbranch_scc1 L_tagslow
    s_sleep 4
    s_buffer_load_dword s42, s[88:91], s93 glc
    s_waitcnt lgkmcnt(0)
    s_branch L_tagretry
L_tagok:
    s_add_u32 s42, s42, s45
    v_mov_b32 v0, s42
    v_mov_b32 v16, 147456
    ds_write_b32 v16, v0
L_tagdone:
    s_waitcnt lgkmcnt(0)
    s_barrier
    v_add_u32 v0, 1, v0
    buffer_store_dword v0, v13, s[20:23], 0 offen offset:32 sc1
    v_mov_b32 v16, 147456
    ds_read_b32 v17, v16
    ds_read_b128 v[144:147], v2 offset:0
    ds_read_b128 v[148:151], v3 offset:0
    ds_read_b128 v[152:155], v2 offset:6144
    ds_read_b128 v[156:159], v3 offset:6144
    ds_read_b128 v[160:163], v2 offset:128
    ds_read_b128 v[164:167], v3 offset:128
    ds_read_b128 v[168:171], v2 offset:6272
    ds_read_b128 v[172:175], v3 offset:6272
    ds_read_b128 v[176:179], v2 offset:256
    ds_read_b128 v[180:183], v3 offset:256
    ds_read_b128 v[184:187], v2 offset:6400
    ds_read_b128 v[188:191], v3 offset:6400
    s_mov_b32 s41, 12288
    s_add_u32 m0, s40, 49152
    s_nop 0
    s_bitcmp1_b32 s2, 0
    s_cbranch_scc1 L_thr18
    s_waitcnt vmcnt(4)
L_thr18:
    buffer_load_dwordx4 v136, s[8:11], s41 offen nt lds
    s_add_u32 m0, s40, 50176
    s_nop 0
    s_bitcmp1_b32 s2, 0
    s_cbranch_scc1 L_thr19
    s_waitcnt vmcnt(4)
L_thr19:
    buffer_load_dwordx4 v137, s[8:11], s41 offen nt lds
    s_add_u32 m0, s40, 51200
    s_nop 0
    s_bitcmp1_b32 s2, 0
    s_cbranch_scc1 L_thr20
    s_waitcnt vmcnt(4)
L_thr20:
    buffer_load_dwordx4 v138, s[8:11], s41 offen nt lds
    s_add_u32 m0, s40, 52224
    s_nop 0
    s_bitcmp1_b32 s2, 0
    s_cbranch_scc1 L_thr21
    s_waitcnt vmcnt(4)
L_thr21:
    buffer_load_dwordx4 v139, s[8:11], s41 offen nt lds
    s_add_u32 m0, s40, 53248
    s_nop 0
    s_bitcmp1_b32 s2, 0
    s_cbranch_scc1 L_thr22
    s_waitcnt vmcnt(3)
L_thr22:
    buffer_load_dwordx4 v140, s[8:11], s41 offen nt lds
    s_add_u32 m0, s40, 54272
    s_nop 0
    s_bitcmp1_b32 s2, 0
    s_cbranch_scc1 L_thr23
    s_waitcnt vmcnt(3)
L_thr23:
    buffer_load_dwordx4 v141, s[8:11], s41 offen nt lds
    s_waitcnt vmcnt(17)
    ds_read_b64 a[192:193], v22 offset:24576
    ds_read_b64 a[194:195], v142 offset:24704
    ds_read_b64 a[196:197], v23 offset:24576
    ds_read_b64 a[198:199], v143 offset:24704
    ds_read_b64 a[200:201], v142 offset:24576
    ds_read_b64 a[202:203], v22 offset:24832
    ds_read_b64 a[204:205], v143 offset:24576
    ds_read_b64 a[206:207], v23 offset:24832
    ds_read_b64 a[208:209], v22 offset:24704
    ds_read_b64 a[210:211], v142 offset:24832
    ds_read_b64 a[212:213], v23 offset:24704
    ds_read_b64 a[214:215], v143 offset:24832
    s_waitcnt lgkmcnt(15)
    v_readfirstlane_b32 s92, v17
    s_add_u32 s92, s92, 1
    s_waitcnt lgkmcnt(0)
    s_mov_b32 s41, 18432
    s_add_u32 m0, s40, 24576
    s_waitcnt vmcnt(12)
    s_bitcmp1_b32 s2, 0
    s_cbranch_scc1 L_thr24
    s_waitcnt vmcnt(3)
L_thr24:
    buffer_load_dwordx4 v136, s[8:11], s41 offen nt lds
    s_add_u32 m0, s40, 25600
    s_waitcnt vmcnt(12)
    s_bitcmp1_b32 s2, 0
    s_cbranch_scc1 L_thr25
    s_waitcnt vmcnt(3)
L_thr25:
    buffer_load_dwordx4 v137, s[8:11], s41 offen nt lds
    s_add_u32 m0, s40, 26624
    s_waitcnt vmcnt(12)
    s_bitcmp1_b32 s2, 0
    s_cbranch_scc1 L_thr26
    s_waitcnt vmcnt(3)
L_thr26:
    buffer_load_dwordx4 v138, s[8:11], s41 offen nt lds
    v_mfma_f32_16x16x32_bf16 v[64:67], v[144:147], a[192:195], 0
L_iw0:
L_pg0:
    s_cbranch_execz L_pg4
    v_mfma_f32_16x16x32_bf16 v[64:67], v[148:151], a[196:199], v[64:67]
    v_mfma_f32_16x16x32_bf16 v[64:67], v[160:163], a[200:203], v[64:67]
    v_mfma_f32_16x16x32_bf16 v[64:67], v[164:167], a[204:207], v[64:67]
    v_mfma_f32_16x16x32_bf16 v[64:67], v[176:179], a[208:211], v[64:67]
    v_mfma_f32_16x16x32_bf16 v[64:67], v[180:183], a[212:215], v[64:67]
    v_mfma_f32_16x16x32_bf16 v[96:99], v[152:155], a[192:195], 0
    v_mfma_f32_16x16x32_bf16 v[96:99], v[156:159], a[196:199], v[96:99]
    v_mfma_f32_16x16x32_bf16 v[96:99], v[168:171], a[200:203], v[96:99]
    v_mfma_f32_16x16x32_bf16 v[96:99], v[172:175], a[204:207], v[96:99]
    v_mfma_f32_16x16x32_bf16 v[96:99], v[184:187], a[208:211], v[96:99]
    v_mfma_f32_16x16x32_bf16 v[96:99], v[188:191], a[212:215], v[96:99]
    s_waitcnt vmcnt(10)
    ds_read_b64 a[216:217], v22 offset:0
    ds_read_b64 a[218:219], v142 offset:128
    ds_read_b64 a[220:221], v23 offset:0
    ds_read_b64 a[222:223], v143 offset:128
    ds_read_b64 a[224:225], v142 offset:0
    ds_read_b64 a[226:227], v22 offset:256
    ds_read_b64 a[228:229], v143 offset:0
    ds_read_b64 a[230:231], v23 offset:256
    ds_read_b64 a[232:233], v22 offset:128
    ds_read_b64 a[234:235], v142 offset:256
    ds_read_b64 a[236:237], v23 offset:128
    ds_read_b64 a[238:239], v143 offset:256
    s_mov_b32 s41, 18432
    s_add_u32 m0, s40, 27648
    s_nop 0
    s_bitcmp1_b32 s2, 0
    s_cbranch_scc1 L_thr27
    s_waitcnt vmcnt(3)
L_thr27:
    buffer_load_dwordx4 v139, s[8:11], s41 offen nt lds
    s_add_u32 m0, s40, 28672
    s_nop 0
    s_bitcmp1_b32 s2, 0
    s_cbranch_scc1 L_thr28
    s_waitcnt vmcnt(3)
L_thr28:
    buffer_load_dwordx4 v140, s[8:11], s41 offen nt lds
    s_add_u32 m0, s40, 29696
    s_nop 0
    s_bitcmp1_b32 s2, 0
    s_cbranch_scc1 L_thr29
    s_waitcnt vmcnt(3)
L_thr29:
    buffer_load_dwordx4 v141, s[8:11], s41 offen nt lds
    v_max3_f32 v48, v64, v65, v66
    v_max3_f32 v50, v67, v96, v97
    v_max3_f32 v48, v48, v98, v99
    v_max_f32 v48, v48, v50
    v_mov_b32 v49, v48
    s_nop 1
    v_permlane16_swap_b32 v48, v49
    s_nop 1
    v_max_f32 v48, v48, v49
    v_mov_b32 v49, v48
    s_nop 1
    v_permlane32_swap_b32 v48, v49
    s_nop 1
    v_max_f32 v48, v48, v49
    s_waitcnt lgkmcnt(0)
    v_mfma_f32_16x16x32_bf16 v[68:71], v[144:147], a[216:219], 0
    v_sub_f32 v64, v64, v48
    v_sub_f32 v65, v65, v48
    v_sub_f32 v66, v66, v48
    v_mfma_f32_16x16x32_bf16 v[68:71], v[148:151], a[220:223], v[68:71]
    v_sub_f32 v67, v67, v48
    v_sub_f32 v96, v96, v48
    v_sub_f32 v97, v97, v48
    v_mfma_f32_16x16x32_bf16 v[68:71], v[160:163], a[224:227], v[68:71]
    v_sub_f32 v98, v98, v48
    v_sub_f32 v99, v99, v48
    v_mfma_f32_16x16x32_bf16 v[68:71], v[164:167], a[228:231], v[68:71]
    v_exp_f32 v64, v64
    v_mfma_f32_16x16x32_bf16 v[68:71], v[176:179], a[232:235], v[68:71]
    v_exp_f32 v65, v65
    v_mfma_f32_16x16x32_bf16 v[68:71], v[180:183], a[236:239], v[68:71]
    v_exp_f32 v66, v66
    v_mfma_f32_16x16x32_bf16 v[100:103], v[152:155], a[216:219], 0
    v_exp_f32 v67, v67
    v_mfma_f32_16x16x32_bf16 v[100:103], v[156:159], a[220:223], v[100:103]
    v_exp_f32 v96, v96
    v_mfma_f32_16x16x32_bf16 v[100:103], v[168:171], a[224:227], v[100:103]
    v_exp_f32 v97, v97
    v_mfma_f32_16x16x32_bf16 v[100:103], v[172:175], a[228:231], v[100:103]
    v_exp_f32 v98, v98
    v_mfma_f32_16x16x32_bf16 v[100:103], v[184:187], a[232:235], v[100:103]
    v_exp_f32 v99, v99
    v_sub_f32 v128, 0, v48
    v_mfma_f32_16x16x32_bf16 v[100:103], v[188:191], a[236:239], v[100:103]
    v_sub_f32 v129, 0, v48
    v_sub_f32 v130, 0, v48
    v_sub_f32 v131, 0, v48
    v_add_f32 v5, v5, v64
    v_add_f32 v5, v5, v65
    v_add_f32 v5, v5, v66
    v_add_f32 v5, v5, v67
    v_add_f32 v5, v5, v96
    v_add_f32 v5, v5, v97
    v_add_f32 v5, v5, v98
    v_add_f32 v5, v5, v99
    v_cvt_pk_bf16_f32 v64, v64, v65
    v_cvt_pk_bf16_f32 v65, v66, v67
    v_cvt_pk_bf16_f32 v66, v96, v97
    v_cvt_pk_bf16_f32 v67, v98, v99
    s_waitcnt vmcnt(6)
    ds_read_b64 a[240:241], v22 offset:49152
    ds_read_b64 a[242:243], v142 offset:49280
    ds_read_b64 a[244:245], v23 offset:49152
    ds_read_b64 a[246:247], v143 offset:49280
    ds_read_b64 a[248:249], v142 offset:49152
    ds_read_b64 a[250:251], v22 offset:49408
    ds_read_b64 a[252:253], v143 offset:49152
    ds_read_b64 a[254:255], v23 offset:49408
    ds_read_b64 v[192:193], v22 offset:49280
    ds_read_b64 v[194:195], v142 offset:49408
    ds_read_b64 v[196:197], v23 offset:49280
    ds_read_b64 v[198:199], v143 offset:49408
    s_buffer_load_dwordx8 s[48:55], s[20:23], s44 glc
    v_max3_f32 v48, v68, v69, v70
    v_max3_f32 v50, v71, v100, v101
    v_max3_f32 v48, v48, v102, v103
    v_max_f32 v48, v48, v50
    v_mov_b32 v49, v48
    s_nop 1
    v_permlane16_swap_b32 v48, v49
    s_nop 1
    v_max_f32 v48, v48, v49
    v_mov_b32 v49, v48
    s_nop 1
    v_permlane32_swap_b32 v48, v49
    s_nop 1
    v_max_f32 v48, v48, v49
    s_waitcnt lgkmcnt(0)
    v_mfma_f32_16x16x32_bf16 v[72:75], v[144:147], a[240:243], 0
    v_sub_f32 v68, v68, v48
    v_sub_f32 v69, v69, v48
    v_sub_f32 v70, v70, v48
    v_mfma_f32_16x16x32_bf16 v[72:75], v[148:151], a[244:247], v[72:75]
    v_sub_f32 v71, v71, v48
    v_sub_f32 v100, v100, v48
    v_sub_f32 v101, v101, v48
    v_mfma_f32_16x16x32_bf16 v[72:75], v[160:163], a[248:251], v[72:75]
    v_sub_f32 v102, v102, v48
    v_sub_f32 v103, v103, v48
    v_mfma_f32_16x16x32_bf16 v[72:75], v[164:167], a[252:255], v[72:75]
    v_exp_f32 v68, v68
    v_mfma_f32_16x16x32_bf16 v[72:75], v[176:179], v[192:195], v[72:75]
    v_exp_f32 v69, v69
    v_mfma_f32_16x16x32_bf16 v[72:75], v[180:183], v[196:199], v[72:75]
    v_exp_f32 v70, v70
    v_mfma_f32_16x16x32_bf16 v[104:107], v[152:155], a[240:243], 0
    v_exp_f32 v71, v71
    v_mfma_f32_16x16x32_bf16 v[104:107], v[156:159], a[244:247], v[104:107]
    v_exp_f32 v100, v100
    v_mfma_f32_16x16x32_bf16 v[104:107], v[168:171], a[248:251], v[104:107]
    v_exp_f32 v101, v101
    v_mfma_f32_16x16x32_bf16 v[104:107], v[172:175], a[252:255], v[104:107]
    v_exp_f32 v102, v102
    v_mfma_f32_16x16x32_bf16 v[104:107], v[184:187], v[192:195], v[104:107]
    v_exp_f32 v103, v103
    v_sub_f32 v132, 0, v48
    v_mfma_f32_16x16x32_bf16 v[104:107], v[188:191], v[196:199], v[104:107]
    v_sub_f32 v133, 0, v48
    v_sub_f32 v134, 0, v48
    v_sub_f32 v135, 0, v48
    v_add_f32 v6, v6, v68
    v_add_f32 v6, v6, v69
    v_add_f32 v6, v6, v70
    v_add_f32 v6, v6, v71
    v_add_f32 v6, v6, v100
    v_add_f32 v6, v6, v101
    v_add_f32 v6, v6, v102
    v_add_f32 v6, v6, v103
    v_cvt_pk_bf16_f32 v68, v68, v69
    v_cvt_pk_bf16_f32 v69, v70, v71
    v_cvt_pk_bf16_f32 v70, v100, v101
    v_cvt_pk_bf16_f32 v71, v102, v103
    ds_read_b128 v[24:27], v1 offset:0
    ds_read_b128 v[28:31], v1 offset:1024
    ds_read_b128 v[32:35], v1 offset:2048
    ds_read_b128 v[36:39], v1 offset:3072
    s_waitcnt lgkmcnt(0)
    s_sub_u32 s48, s48, s92
    s_sub_u32 s49, s49, s92
    s_sub_u32 s50, s50, s92
    s_sub_u32 s51, s51, s92
    s_sub_u32 s52, s52, s92
    s_sub_u32 s53, s53, s92
    s_sub_u32 s54, s54, s92
    s_sub_u32 s55, s55, s92
    s_max_u32 s48, s48, s49
    s_max_u32 s48, s48, s50
    s_max_u32 s48, s48, s51
    s_max_u32 s48, s48, s52
    s_max_u32 s48, s48, s53
    s_max_u32 s48, s48, s54
    s_max_u32 s48, s48, s55
    s_cmp_ge_u32 s48, 16
    s_cbranch_scc1 L_pollslow0
L_pollok0:
    s_add_u32 s92, s92, 1
    s_mov_b32 m0, s26
    s_nop 0
    buffer_load_dwordx4 v4, s[4:7], s32 offen offset:0 sc1 lds
    buffer_load_dwordx4 v4, s[4:7], s32 offen offset:1024 sc1 lds
    buffer_load_dwordx4 v4, s[4:7], s32 offen offset:2048 sc1 lds
    s_add_u32 s32, s32, 24576
    s_sub_u32 s57, s32, 196608
    s_min_u32 s32, s32, s57
    s_add_u32 s26, s26, 36864
    s_sub_u32 s57, s26, 147456
    s_min_u32 s26, s26, s57
    s_mov_b32 m0, s26
    s_nop 0
    buffer_load_dwordx4 v4, s[4:7], s32 offen offset:0 sc1 lds
    buffer_load_dwordx4 v4, s[4:7], s32 offen offset:1024 sc1 lds
    buffer_load_dwordx4 v4, s[4:7], s32 offen offset:2048 sc1 lds
    s_add_u32 s32, s32, 24576
    s_sub_u32 s57, s32, 196608
    s_min_u32 s32, s32, s57
    s_add_u32 s26, s26, 12288
    s_mov_b32 m0, s26
    s_waitcnt vmcnt(11)
    buffer_load_dwordx4 v4, s[4:7], s32 offen offset:0 sc1 lds
    s_waitcnt vmcnt(11)
    buffer_load_dwordx4 v4, s[4:7], s32 offen offset:1024 sc1 lds
    s_waitcnt vmcnt(11)
    buffer_load_dwordx4 v4, s[4:7], s32 offen offset:2048 sc1 lds
    s_add_u32 s32, s32, 24576
    s_sub_u32 s57, s32, 196608
    s_min_u32 s32, s32, s57
    s_add_u32 s26, s26, 36864
    s_sub_u32 s57, s26, 147456
    s_min_u32 s26, s26, s57
    s_mov_b32 m0, s56
    s_waitcnt vmcnt(11)
    buffer_load_dwordx4 v4, s[4:7], s27 offen offset:0 sc1 lds
    s_waitcnt vmcnt(11)
    buffer_load_dwordx4 v4, s[4:7], s27 offen offset:1024 sc1 lds
    s_waitcnt vmcnt(11)
    buffer_load_dwordx4 v4, s[4:7], s27 offen offset:2048 sc1 lds
    s_add_u32 s27, s27, 24576
    s_sub_u32 s58, s27, 196608
    s_min_u32 s27, s27, s58
    s_add_u32 s56, s56, 36864
    s_sub_u32 s58, s56, 147456
    s_min_u32 s56, s56, s58
    s_add_u32 s33, s33, 196608
    s_add_u32 s34, s34, 196608
    s_add_u32 s36, s36, 1536
    s_add_u32 s35, s35, 196608
    s_add_u32 s16, s16, 196608
    s_add_u32 s17, s17, 196608
    s_add_u32 s37, s37, 512
    v_mfma_f32_16x16x32_bf16 a[0:3], v[64:67], v[24:27], 0
    ds_read_b128 v[40:43], v1 offset:4096
    v_max3_f32 v48, v72, v73, v74
    v_mfma_f32_16x16x32_bf16 a[4:7], v[64:67], v[28:31], 0
    v_max3_f32 v50, v75, v104, v105
    v_max3_f32 v48, v48, v106, v107
    v_mfma_f32_16x16x32_bf16 a[48:51], v[68:71], v[24:27], 0
    ds_read_b128 v[44:47], v1 offset:5120
    v_max_f32 v48, v48, v50
    v_mfma_f32_16x16x32_bf16 a[52:55], v[68:71], v[28:31], 0
    s_waitcnt lgkmcnt(2)
    v_mov_b32 v49, v48
    v_mfma_f32_16x16x32_bf16 a[8:11], v[64:67], v[32:35], 0
    s_nop 1
    ds_read_b128 v[24:27], v1 offset:6144
    v_mfma_f32_16x16x32_bf16 a[12:15], v[64:67], v[36:39], 0
    v_permlane16_swap_b32 v48, v49
    s_nop 1
    v_mfma_f32_16x16x32_bf16 a[56:59], v[68:71], v[32:35], 0
    ds_read_b128 v[28:31], v1 offset:7168
    v_max_f32 v48, v48, v49
    v_mfma_f32_16x16x32_bf16 a[60:63], v[68:71], v[36:39], 0
    s_waitcnt lgkmcnt(2)
    v_mov_b32 v49, v48
    s_nop 1
    v_mfma_f32_16x16x32_bf16 a[16:19], v[64:67], v[40:43], 0
    ds_read_b128 v[32:35], v1 offset:8192
    v_permlane32_swap_b32 v48, v49
    v_mfma_f32_16x16x32_bf16 a[20:23], v[64:67], v[44:47], 0
    s_nop 1
    v_max_f32 v48, v48, v49
    v_sub_f32 v72, v72, v48
    v_mfma_f32_16x16x32_bf16 a[64:67], v[68:71], v[40:43], 0
    ds_read_b128 v[36:39], v1 offset:9216
    v_sub_f32 v73, v73, v48
    v_mfma_f32_16x16x32_bf16 a[68:71], v[68:71], v[44:47], 0
    s_waitcnt lgkmcnt(2)
    v_sub_f32 v74, v74, v48
    v_sub_f32 v75, v75, v48
    v_sub_f32 v104, v104, v48
    v_mfma_f32_16x16x32_bf16 a[24:27], v[64:67], v[24:27], 0
    ds_read_b128 v[40:43], v1 offset:10240
    v_sub_f32 v105, v105, v48
    v_mfma_f32_16x16x32_bf16 a[28:31], v[64:67], v[28:31], 0
    v_sub_f32 v106, v106, v48
    v_sub_f32 v107, v107, v48
    v_mfma_f32_16x16x32_bf16 a[72:75], v[68:71], v[24:27], 0
    ds_read_b128 v[44:47], v1 offset:11264
    v_mfma_f32_16x16x32_bf16 a[76:79], v[68:71], v[28:31], 0
    s_waitcnt lgkmcnt(2)
    v_exp_f32 v72, v72
    v_mfma_f32_16x16x32_bf16 a[32:35], v[64:67], v[32:35], 0
    v_exp_f32 v73, v73
    v_mfma_f32_16x16x32_bf16 a[36:39], v[64:67], v[36:39], 0
    v_exp_f32 v74, v74
    v_mfma_f32_16x16x32_bf16 a[80:83], v[68:71], v[32:35], 0
    v_exp_f32 v75, v75
    v_mfma_f32_16x16x32_bf16 a[84:87], v[68:71], v[36:39], 0
    s_waitcnt lgkmcnt(0)
    v_exp_f32 v104, v104
    v_mfma_f32_16x16x32_bf16 a[40:43], v[64:67], v[40:43], 0
    v_exp_f32 v105, v105
    v_mfma_f32_16x16x32_bf16 a[44:47], v[64:67], v[44:47], 0
    v_exp_f32 v106, v106
    v_mfma_f32_16x16x32_bf16 a[88:91], v[68:71], v[40:43], 0
    v_exp_f32 v107, v107
    v_mfma_f32_16x16x32_bf16 a[92:95], v[68:71], v[44:47], 0
    v_sub_f32 v136, 0, v48
    v_sub_f32 v137, 0, v48
    v_sub_f32 v138, 0, v48
    v_sub_f32 v139, 0, v48
    v_add_f32 v7, v7, v72
    v_add_f32 v7, v7, v73
    v_add_f32 v7, v7, v74
    v_add_f32 v7, v7, v75
    v_add_f32 v7, v7, v104
    v_add_f32 v7, v7, v105
    v_add_f32 v7, v7, v106
    v_add_f32 v7, v7, v107
    v_cvt_pk_bf16_f32 v72, v72, v73
    v_cvt_pk_bf16_f32 v73, v74, v75
    v_cvt_pk_bf16_f32 v74, v104, v105
    v_cvt_pk_bf16_f32 v75, v106, v107
    s_waitcnt vmcnt(12)
    ds_read_b64 v[200:201], v22 offset:24576
    ds_read_b64 v[202:203], v142 offset:24704
    ds_read_b64 v[204:205], v23 offset:24576
    ds_read_b64 v[206:207], v143 offset:24704
    ds_read_b64 v[208:209], v142 offset:24576
    ds_read_b64 v[210:211], v22 offset:24832
    ds_read_b64 v[212:213], v143 offset:24576
    ds_read_b64 v[214:215], v23 offset:24832
    ds_read_b64 v[216:217], v22 offset:24704
    ds_read_b64 v[218:219], v142 offset:24832
    ds_read_b64 v[220:221], v23 offset:24704
    ds_read_b64 v[222:223], v143 offset:24832
    s_waitcnt lgkmcnt(0)
    v_mfma_f32_16x16x32_bf16 v[76:79], v[144:147], v[200:203], 0
    v_mfma_f32_16x16x32_bf16 v[76:79], v[148:151], v[204:207], v[76:79]
    v_mfma_f32_16x16x32_bf16 v[76:79], v[160:163], v[208:211], v[76:79]
    v_mfma_f32_16x16x32_bf16 v[76:79], v[164:167], v[212:215], v[76:79]
    v_mfma_f32_16x16x32_bf16 v[76:79], v[176:179], v[216:219], v[76:79]
    v_mfma_f32_16x16x32_bf16 v[76:79], v[180:183], v[220:223], v[76:79]
    v_mfma_f32_16x16x32_bf16 v[108:111], v[152:155], v[200:203], 0
    v_mfma_f32_16x16x32_bf16 v[108:111], v[156:159], v[204:207], v[108:111]
    v_mfma_f32_16x16x32_bf16 v[108:111], v[168:171], v[208:211], v[108:111]
    v_mfma_f32_16x16x32_bf16 v[108:111], v[172:175], v[212:215], v[108:111]
    v_mfma_f32_16x16x32_bf16 v[108:111], v[184:187], v[216:219], v[108:111]
    v_mfma_f32_16x16x32_bf16 v[108:111], v[188:191], v[220:223], v[108:111]
    s_nop 7
    v_max3_f32 v48, v76, v77, v78
    v_max3_f32 v50, v79, v108, v109
    v_max3_f32 v48, v48, v110, v111
    v_max_f32 v48, v48, v50
    v_mov_b32 v49, v48
    s_nop 1
    v_permlane16_swap_b32 v48, v49
    s_nop 1
    v_max_f32 v48, v48, v49
    v_mov_b32 v49, v48
    s_nop 1
    v_permlane32_swap_b32 v48, v49
    s_nop 1
    v_max_f32 v48, v48, v49
    v_sub_f32 v140, 0, v48
    v_sub_f32 v141, 0, v48
    v_sub_f32 v142, 0, v48
    v_sub_f32 v143, 0, v48
    s_waitcnt vmcnt(9)
    s_barrier
    ds_read_b128 v[24:27], v2 offset:12288
    ds_read_b128 v[28:31], v3 offset:12288
    ds_read_b128 v[32:35], v2 offset:18432
    ds_read_b128 v[36:39], v3 offset:18432
    s_waitcnt lgkmcnt(2)
    v_mfma_f32_16x16x32_bf16 v[80:83], v[24:27], a[192:195], v[128:131]
    ds_read_b128 v[40:43], v2 offset:12416
    v_sub_f32 v76, v76, v48
    v_mfma_f32_16x16x32_bf16 v[80:83], v[28:31], a[196:199], v[80:83]
    buffer_load_dwordx2 v[56:57], v10, s[72:75], s36 offen offset:0
    v_mfma_f32_16x16x32_bf16 v[84:87], v[28:31], a[220:223], v[132:135]
    v_sub_f32 v77, v77, v48
    v_sub_f32 v78, v78, v48
    v_mfma_f32_16x16x32_bf16 v[84:87], v[24:27], a[216:219], v[84:87]
    buffer_load_dwordx2 v[58:59], v10, s[76:79], s36 offen offset:0
    v_mfma_f32_16x16x32_bf16 v[88:91], v[24:27], a[240:243], v[136:139]
    ds_read_b128 v[44:47], v3 offset:12416
    v_sub_f32 v79, v79, v48
    v_mfma_f32_16x16x32_bf16 v[88:91], v[28:31], a[244:247], v[88:91]
    buffer_load_dwordx4 v[224:227], v9, s[64:67], s33 offen offset:0 nt
    v_mfma_f32_16x16x32_bf16 v[92:95], v[28:31], v[204:207], v[140:143]
    v_sub_f32 v108, v108, v48
    v_sub_f32 v109, v109, v48
    v_mfma_f32_16x16x32_bf16 v[92:95], v[24:27], v[200:203], v[92:95]
    s_waitcnt lgkmcnt(2)
    buffer_load_dwordx4 v[228:231], v9, s[64:67], s33 offen offset:1536 nt
    v_mfma_f32_16x16x32_bf16 v[112:115], v[32:35], a[192:195], v[128:131]
    ds_read_b128 v[24:27], v2 offset:18560
    v_sub_f32 v110, v110, v48
    v_mfma_f32_16x16x32_bf16 v[112:115], v[36:39], a[196:199], v[112:115]
    buffer_load_dwordx4 v[232:235], v9, s[64:67], s34 offen offset:0 nt
    v_mfma_f32_16x16x32_bf16 v[116:119], v[36:39], a[220:223], v[132:135]
    v_sub_f32 v111, v111, v48
    v_mfma_f32_16x16x32_bf16 v[116:119], v[32:35], a[216:219], v[116:119]
    s_waitcnt vmcnt(13)
    buffer_load_dwordx4 v[236:239], v9, s[64:67], s34 offen offset:1536 nt
    v_mfma_f32_16x16x32_bf16 v[120:123], v[32:35], a[240:243], v[136:139]
    ds_read_b128 v[28:31], v3 offset:18560
    v_mfma_f32_16x16x32_bf16 v[120:123], v[36:39], a[244:247], v[120:123]
    v_exp_f32 v76, v76
    v_mfma_f32_16x16x32_bf16 v[124:127], v[36:39], v[204:207], v[140:143]
    v_exp_f32 v77, v77
    v_mfma_f32_16x16x32_bf16 v[124:127], v[32:35], v[200:203], v[124:127]
    s_waitcnt lgkmcnt(2)
    s_waitcnt vmcnt(13)
    buffer_load_dwordx2 v[60:61], v10, s[72:75], s36 offen offset:192
    v_mfma_f32_16x16x32_bf16 v[80:83], v[40:43], a[200:203], v[80:83]
    ds_read_b128 v[32:35], v2 offset:12544
    v_mfma_f32_16x16x32_bf16 v[80:83], v[44:47], a[204:207], v[80:83]
    buffer_load_dwordx2 v[62:63], v10, s[76:79], s36 offen offset:192
    v_mfma_f32_16x16x32_bf16 v[84:87], v[44:47], a[228:231], v[84:87]
    v_exp_f32 v78, v78
    v_mfma_f32_16x16x32_bf16 v[84:87], v[40:43], a[224:227], v[84:87]
    s_waitcnt vmcnt(14)
    buffer_load_dwordx4 v[240:243], v9, s[64:67], s33 offen offset:384 nt
    v_mfma_f32_16x16x32_bf16 v[88:91], v[40:43], a[248:251], v[88:91]
    ds_read_b128 v[36:39], v3 offset:12544
    v_mfma_f32_16x16x32_bf16 v[88:91], v[44:47], a[252:255], v[88:91]
    buffer_load_dwordx4 v[244:247], v9, s[64:67], s33 offen offset:1920 nt
    v_mfma_f32_16x16x32_bf16 v[92:95], v[44:47], v[212:215], v[92:95]
    v_exp_f32 v79, v79
    v_mfma_f32_16x16x32_bf16 v[92:95], v[40:43], v[208:211], v[92:95]
    s_waitcnt lgkmcnt(2)
    v_exp_f32 v108, v108
    v_mfma_f32_16x16x32_bf16 v[112:115], v[24:27], a[200:203], v[112:115]
    ds_read_b128 v[40:43], v2 offset:18688
    v_mfma_f32_16x16x32_bf16 v[112:115], v[28:31], a[204:207], v[112:115]
    s_waitcnt vmcnt(15)
    buffer_load_dwordx4 v[248:251], v9, s[64:67], s34 offen offset:384 nt
    v_mfma_f32_16x16x32_bf16 v[116:119], v[28:31], a[228:231], v[116:119]
    v_exp_f32 v109, v109
    v_mfma_f32_16x16x32_bf16 v[116:119], v[24:27], a[224:227], v[116:119]
    s_waitcnt vmcnt(15)
    buffer_load_dwordx4 v[252:255], v9, s[64:67], s34 offen offset:1920 nt
    v_mfma_f32_16x16x32_bf16 v[120:123], v[24:27], a[248:251], v[120:123]
    ds_read_b128 v[44:47], v3 offset:18688
    v_mfma_f32_16x16x32_bf16 v[120:123], v[28:31], a[252:255], v[120:123]
    s_waitcnt lgkmcnt(2)
    v_exp_f32 v110, v110
    v_mfma_f32_16x16x32_bf16 v[124:127], v[28:31], v[212:215], v[124:127]
    s_waitcnt vmcnt(15)
    v_exp_f32 v111, v111
    v_mfma_f32_16x16x32_bf16 v[124:127], v[24:27], v[208:211], v[124:127]
    s_barrier
    v_add_u32 v2, 49152, v2
    v_add_u32 v3, 49152, v3
    v_mfma_f32_16x16x32_bf16 v[80:83], v[32:35], a[208:211], v[80:83]
    s_mov_b32 m0, s26
    ds_read_b128 v[24:27], v2 offset:0
    v_add_f32 v8, v8, v76
    v_mfma_f32_16x16x32_bf16 v[80:83], v[36:39], a[212:215], v[80:83]
    buffer_load_dwordx4 v4, s[4:7], s32 offen offset:0 sc1 lds
    v_add_f32 v8, v8, v77
    v_mfma_f32_16x16x32_bf16 v[84:87], v[36:39], a[236:239], v[84:87]
    v_add_f32 v8, v8, v78
    v_add_f32 v8, v8, v79
    v_mfma_f32_16x16x32_bf16 v[84:87], v[32:35], a[232:235], v[84:87]
    s_waitcnt vmcnt(15)
    buffer_load_dwordx4 v4, s[4:7], s32 offen offset:1024 sc1 lds
    v_add_f32 v8, v8, v108
    v_mfma_f32_16x16x32_bf16 v[88:91], v[32:35], v[192:195], v[88:91]
    ds_read_b128 v[28:31], v3 offset:0
    v_add_f32 v8, v8, v109
    v_mfma_f32_16x16x32_bf16 v[88:91], v[36:39], v[196:199], v[88:91]
    s_waitcnt vmcnt(15)
    buffer_load_dwordx4 v4, s[4:7], s32 offen offset:2048 sc1 lds
    v_add_f32 v8, v8, v110
    v_mfma_f32_16x16x32_bf16 v[92:95], v[36:39], v[220:223], v[92:95]
    s_add_u32 s32, s32, 24576
    v_add_f32 v8, v8, v111
    v_cvt_pk_bf16_f32 v76, v76, v77
    v_mfma_f32_16x16x32_bf16 v[92:95], v[32:35], v[216:219], v[92:95]
    s_waitcnt lgkmcnt(2)
    v_cvt_pk_bf16_f32 v77, v78, v79
    v_cvt_pk_bf16_f32 v78, v108, v109
    v_mfma_f32_16x16x32_bf16 v[112:115], v[40:43], a[208:211], v[112:115]
    ds_read_b128 v[32:35], v2 offset:6144
    v_cvt_pk_bf16_f32 v79, v110, v111
    v_bfe_u32 v20, v4, 4, 6
    v_lshlrev_b32 v20, 2, v20
    v_xor_b32 v21, 16, v11
    v_xor_b32 v22, 32, v11
    v_xor_b32 v23, 48, v11
    v_mfma_f32_16x16x32_bf16 v[112:115], v[44:47], a[212:215], v[112:115]
    s_sub_u32 s57, s32, 196608
    s_min_u32 s32, s32, s57
    v_mfma_f32_16x16x32_bf16 v[116:119], v[44:47], a[236:239], v[116:119]
    s_add_u32 s26, s26, 12288
    s_mov_b32 m0, s26
    v_mfma_f32_16x16x32_bf16 v[116:119], v[40:43], a[232:235], v[116:119]
    s_waitcnt vmcnt(15)
    buffer_load_dwordx4 v4, s[4:7], s32 offen offset:0 sc1 lds
    v_mfma_f32_16x16x32_bf16 v[120:123], v[40:43], v[192:195], v[120:123]
    ds_read_b128 v[36:39], v3 offset:6144
    v_mfma_f32_16x16x32_bf16 v[120:123], v[44:47], v[196:199], v[120:123]
    s_waitcnt vmcnt(14)
    buffer_load_dwordx4 v4, s[4:7], s32 offen offset:1024 sc1 lds
    v_mfma_f32_16x16x32_bf16 v[124:127], v[44:47], v[220:223], v[124:127]
    s_waitcnt vmcnt(14)
    buffer_load_dwordx4 v4, s[4:7], s32 offen offset:2048 sc1 lds
    v_mfma_f32_16x16x32_bf16 v[124:127], v[40:43], v[216:219], v[124:127]
    s_waitcnt lgkmcnt(2)
    s_add_u32 s32, s32, 24576
    s_sub_u32 s57, s32, 196608
    s_min_u32 s32, s32, s57
    s_add_u32 s26, s26, 36864
    s_sub_u32 s57, s26, 147456
    s_min_u32 s26, s26, s57
    v_mfma_f32_16x16x32_bf16 v[160:163], v[24:27], a[192:195], v[128:131]
    s_mov_b32 m0, s56
    ds_read_b128 v[40:43], v2 offset:128
    v_mfma_f32_16x16x32_bf16 v[160:163], v[28:31], a[196:199], v[160:163]
    s_waitcnt vmcnt(13)
    buffer_load_dwordx4 v4, s[4:7], s27 offen offset:0 sc1 lds
    v_mfma_f32_16x16x32_bf16 v[164:167], v[28:31], a[220:223], v[132:135]
    v_exp_f32 v16, v80
    v_mfma_f32_16x16x32_bf16 v[164:167], v[24:27], a[216:219], v[164:167]
    s_waitcnt vmcnt(13)
    buffer_load_dwordx4 v4, s[4:7], s27 offen offset:1024 sc1 lds
    v_exp_f32 v17, v81
    v_exp_f32 v18, v82
    v_add_f32 v5, v5, v16
    v_add_f32 v5, v5, v17
    v_mfma_f32_16x16x32_bf16 v[168:171], v[24:27], a[240:243], v[136:139]
    ds_read_b128 v[44:47], v3 offset:128
    v_mfma_f32_16x16x32_bf16 v[168:171], v[28:31], a[244:247], v[168:171]
    s_waitcnt vmcnt(12)
    buffer_load_dwordx4 v4, s[4:7], s27 offen offset:2048 sc1 lds
    v_exp_f32 v19, v83
    v_cvt_pk_bf16_f32 v80, v16, v17
    v_mfma_f32_16x16x32_bf16 v[172:175], v[28:31], v[204:207], v[140:143]
    s_add_u32 s27, s27, 24576
    v_exp_f32 v16, v112
    v_mfma_f32_16x16x32_bf16 v[172:175], v[24:27], v[200:203], v[172:175]
    s_waitcnt lgkmcnt(2)
    v_add_f32 v5, v5, v18
    v_add_f32 v5, v5, v19
    v_exp_f32 v17, v113
    v_cvt_pk_bf16_f32 v81, v18, v19
    s_sub_u32 s58, s27, 196608
    v_mfma_f32_16x16x32_bf16 v[96:99], v[32:35], a[192:195], v[128:131]
    s_min_u32 s27, s27, s58
    ds_read_b128 v[24:27], v2 offset:6272
    s_add_u32 s56, s56, 12288
    v_mfma_f32_16x16x32_bf16 v[96:99], v[36:39], a[196:199], v[96:99]
    s_mov_b32 m0, s56
    v_exp_f32 v18, v114
    v_add_f32 v5, v5, v16
    v_add_f32 v5, v5, v17
    v_mfma_f32_16x16x32_bf16 v[100:103], v[36:39], a[220:223], v[132:135]
    v_exp_f32 v19, v115
    v_mfma_f32_16x16x32_bf16 v[100:103], v[32:35], a[216:219], v[100:103]
    s_waitcnt vmcnt(11)
    buffer_load_dwordx4 v4, s[4:7], s27 offen offset:0 sc1 lds
    v_cvt_pk_bf16_f32 v82, v16, v17
    v_exp_f32 v16, v84
    v_add_f32 v5, v5, v18
    v_mfma_f32_16x16x32_bf16 v[104:107], v[32:35], a[240:243], v[136:139]
    ds_read_b128 v[28:31], v3 offset:6272
    v_add_f32 v5, v5, v19
    v_mfma_f32_16x16x32_bf16 v[104:107], v[36:39], a[244:247], v[104:107]
    s_waitcnt vmcnt(11)
    buffer_load_dwordx4 v4, s[4:7], s27 offen offset:1024 sc1 lds
    v_exp_f32 v17, v85
    v_cvt_pk_bf16_f32 v83, v18, v19
    v_mfma_f32_16x16x32_bf16 v[108:111], v[36:39], v[204:207], v[140:143]
    v_exp_f32 v18, v86
    v_mfma_f32_16x16x32_bf16 v[108:111], v[32:35], v[200:203], v[108:111]
    s_waitcnt lgkmcnt(2)
    s_waitcnt vmcnt(11)
    buffer_load_dwordx4 v4, s[4:7], s27 offen offset:2048 sc1 lds
    v_add_f32 v6, v6, v16
    v_add_f32 v6, v6, v17
    v_exp_f32 v19, v87
    v_mfma_f32_16x16x32_bf16 v[160:163], v[40:43], a[200:203], v[160:163]
    ds_read_b128 v[32:35], v2 offset:256
    v_cvt_pk_bf16_f32 v84, v16, v17
    v_mfma_f32_16x16x32_bf16 v[160:163], v[44:47], a[204:207], v[160:163]
    v_exp_f32 v16, v116
    v_add_f32 v6, v6, v18
    v_add_f32 v6, v6, v19
    v_mfma_f32_16x16x32_bf16 v[164:167], v[44:47], a[228:231], v[164:167]
    v_exp_f32 v17, v117
    v_mfma_f32_16x16x32_bf16 v[164:167], v[40:43], a[224:227], v[164:167]
    s_add_u32 s27, s27, 24576
    v_cvt_pk_bf16_f32 v85, v18, v19
    v_exp_f32 v18, v118
    v_add_f32 v6, v6, v16
    v_add_f32 v6, v6, v17
    s_sub_u32 s58, s27, 196608
    v_mfma_f32_16x16x32_bf16 v[168:171], v[40:43], a[248:251], v[168:171]
    s_waitcnt vmcnt(18)
    ds_read_b128 v[36:39], v3 offset:256
    v_lshlrev_b32 v48, 16, v56
    v_mfma_f32_16x16x32_bf16 v[168:171], v[44:47], a[252:255], v[168:171]
    s_waitcnt vmcnt(11)
    buffer_load_dwordx3 v[144:146], v12, s[68:71], s35 offen offset:0 nt
    v_exp_f32 v19, v119
    v_cvt_pk_bf16_f32 v86, v16, v17
    v_mfma_f32_16x16x32_bf16 v[172:175], v[44:47], v[212:215], v[172:175]
    s_min_u32 s27, s27, s58
    v_add_f32 v6, v6, v18
    v_add_f32 v6, v6, v19
    v_mfma_f32_16x16x32_bf16 v[172:175], v[40:43], v[208:211], v[172:175]
    s_waitcnt lgkmcnt(2)
    s_waitcnt vmcnt(11)
    buffer_load_dwordx3 v[148:150], v12, s[68:71], s35 offen offset:768 nt
    v_cvt_pk_bf16_f32 v87, v18, v19
    v_exp_f32 v16, v88
    v_and_b32 v49, s97, v56
    v_mfma_f32_16x16x32_bf16 v[96:99], v[24:27], a[200:203], v[96:99]
    s_add_u32 s56, s56, 36864
    ds_read_b128 v[40:43], v2 offset:6400
    v_lshlrev_b32 v50, 16, v58
    v_mfma_f32_16x16x32_bf16 v[96:99], v[28:31], a[204:207], v[96:99]
    s_waitcnt vmcnt(11)
    buffer_load_dwordx3 v[152:154], v12, s[68:71], s35 offen offset:1536 nt
    v_exp_f32 v17, v89
    v_and_b32 v51, s97, v58
    v_mfma_f32_16x16x32_bf16 v[100:103], v[28:31], a[228:231], v[100:103]
    s_sub_u32 s58, s56, 147456
    v_exp_f32 v18, v90
    v_mfma_f32_16x16x32_bf16 v[100:103], v[24:27], a[224:227], v[100:103]
    buffer_load_dwordx3 v[156:158], v12, s[68:71], s35 offen offset:2304 nt
    v_add_f32 v7, v7, v16
    v_add_f32 v7, v7, v17
    v_mul_f32 v48, s38, v48
    v_mfma_f32_16x16x32_bf16 v[104:107], v[24:27], a[248:251], v[104:107]
    s_min_u32 s56, s56, s58
    ds_read_b128 v[44:47], v3 offset:6400
    v_mul_f32 v49, s38, v49
    v_mfma_f32_16x16x32_bf16 v[104:107], v[28:31], a[252:255], v[104:107]
    v_exp_f32 v19, v91
    v_cvt_pk_bf16_f32 v88, v16, v17
    v_exp_f32 v16, v120
    v_mfma_f32_16x16x32_bf16 v[108:111], v[28:31], v[212:215], v[108:111]
L_iw1:
L_pg1:
    s_cbranch_execz L_pg5
    v_add_f32 v7, v7, v18
    v_add_f32 v7, v7, v19
    v_mfma_f32_16x16x32_bf16 v[108:111], v[24:27], v[208:211], v[108:111]
    s_waitcnt lgkmcnt(2)
    v_exp_f32 v17, v121
    v_mul_f32_e64 v50, -v50, v48
    v_mul_f32_e64 v51, -v51, v49
    v_cvt_pk_bf16_f32 v89, v18, v19
    v_cvt_f32_i32 v224, v224
    v_mfma_f32_16x16x32_bf16 v[160:163], v[32:35], a[208:211], v[160:163]
    ds_read_b128 v[24:27], v2 offset:12288
    v_cvt_f32_i32 v225, v225
    v_mfma_f32_16x16x32_bf16 v[160:163], v[36:39], a[212:215], v[160:163]
    v_exp_f32 v18, v122
    v_fma_f32 v224, v224, v48, v50
    v_add_f32 v7, v7, v16
    v_fma_f32 v225, v225, v49, v51
    v_mfma_f32_16x16x32_bf16 v[164:167], v[36:39], a[236:239], v[164:167]
    v_add_f32 v7, v7, v17
    v_cvt_pk_bf16_f32 v224, v224, v225
    v_mfma_f32_16x16x32_bf16 v[164:167], v[32:35], a[232:235], v[164:167]
    v_exp_f32 v19, v123
    v_cvt_f32_i32 v228, v228
    v_cvt_f32_i32 v229, v229
    v_cvt_pk_bf16_f32 v90, v16, v17
    v_mfma_f32_16x16x32_bf16 v[168:171], v[32:35], v[192:195], v[168:171]
    ds_read_b128 v[28:31], v3 offset:12288
    v_fma_f32 v228, v228, v48, v50
    v_mfma_f32_16x16x32_bf16 v[168:171], v[36:39], v[196:199], v[168:171]
    v_exp_f32 v16, v92
    v_fma_f32 v229, v229, v49, v51
    v_cvt_pk_bf16_f32 v228, v228, v229
    v_add_f32 v7, v7, v18
    v_mfma_f32_16x16x32_bf16 v[172:175], v[36:39], v[220:223], v[172:175]
    v_cvt_f32_i32 v232, v232
    v_add_f32 v7, v7, v19
    v_mfma_f32_16x16x32_bf16 v[172:175], v[32:35], v[216:219], v[172:175]
    s_waitcnt lgkmcnt(2)
    v_exp_f32 v17, v93
    v_cvt_f32_i32 v233, v233
    v_fma_f32 v232, v232, v48, v50
    v_fma_f32 v233, v233, v49, v51
    v_cvt_pk_bf16_f32 v91, v18, v19
    v_mfma_f32_16x16x32_bf16 v[96:99], v[40:43], a[208:211], v[96:99]
    ds_read_b128 v[32:35], v2 offset:18432
    v_cvt_pk_bf16_f32 v232, v232, v233
    v_mfma_f32_16x16x32_bf16 v[96:99], v[44:47], a[212:215], v[96:99]
    v_exp_f32 v18, v94
    v_cvt_f32_i32 v236, v236
    v_cvt_f32_i32 v237, v237
    v_add_f32 v8, v8, v16
    v_mfma_f32_16x16x32_bf16 v[100:103], v[44:47], a[236:239], v[100:103]
    v_fma_f32 v236, v236, v48, v50
    v_add_f32 v8, v8, v17
    v_mfma_f32_16x16x32_bf16 v[100:103], v[40:43], a[232:235], v[100:103]
    v_exp_f32 v19, v95
    v_fma_f32 v237, v237, v49, v51
    v_cvt_pk_bf16_f32 v236, v236, v237
    v_lshlrev_b32 v48, 16, v57
    v_mfma_f32_16x16x32_bf16 v[104:107], v[40:43], v[192:195], v[104:107]
    ds_read_b128 v[36:39], v3 offset:18432
    v_cvt_pk_bf16_f32 v92, v16, v17
    v_mfma_f32_16x16x32_bf16 v[104:107], v[44:47], v[196:199], v[104:107]
    v_exp_f32 v16, v124
    v_and_b32 v49, s97, v57
    v_lshlrev_b32 v50, 16, v59
    v_and_b32 v51, s97, v59
    v_mfma_f32_16x16x32_bf16 v[108:111], v[44:47], v[220:223], v[108:111]
    v_add_f32 v8, v8, v18
    v_mul_f32 v48, s38, v48
    v_mfma_f32_16x16x32_bf16 v[108:111], v[40:43], v[216:219], v[108:111]
    s_waitcnt lgkmcnt(2)
    v_add_f32 v8, v8, v19
    v_mul_f32 v49, s38, v49
    v_exp_f32 v17, v125
    v_mul_f32_e64 v50, -v50, v48
    v_mul_f32_e64 v51, -v51, v49
    v_mfma_f32_16x16x32_bf16 v[176:179], v[24:27], a[192:195], v[128:131]
    ds_read_b128 v[40:43], v2 offset:12416
    v_cvt_pk_bf16_f32 v93, v18, v19
    v_mfma_f32_16x16x32_bf16 v[176:179], v[28:31], a[196:199], v[176:179]
    v_exp_f32 v18, v126
    v_cvt_f32_i32 v226, v226
    v_cvt_f32_i32 v227, v227
    v_fma_f32 v226, v226, v48, v50
    v_mfma_f32_16x16x32_bf16 v[180:183], v[28:31], a[220:223], v[132:135]
    v_add_f32 v8, v8, v16
    v_fma_f32 v227, v227, v49, v51
    v_mfma_f32_16x16x32_bf16 v[180:183], v[24:27], a[216:219], v[180:183]
    v_add_f32 v8, v8, v17
    v_cvt_pk_bf16_f32 v225, v226, v227
    v_exp_f32 v19, v127
    v_cvt_f32_i32 v230, v230
    v_mfma_f32_16x16x32_bf16 v[184:187], v[24:27], a[240:243], v[136:139]
    ds_read_b128 v[44:47], v3 offset:12416
    v_cvt_f32_i32 v231, v231
    v_mfma_f32_16x16x32_bf16 v[184:187], v[28:31], a[244:247], v[184:187]
    v_cvt_pk_bf16_f32 v94, v16, v17
    v_fma_f32 v230, v230, v48, v50
    v_add_f32 v8, v8, v18
    v_fma_f32 v231, v231, v49, v51
    v_cvt_pk_bf16_f32 v229, v230, v231
    v_mfma_f32_16x16x32_bf16 v[188:191], v[28:31], v[204:207], v[140:143]
    v_add_f32 v8, v8, v19
    v_cvt_pk_bf16_f32 v95, v18, v19
    v_mfma_f32_16x16x32_bf16 v[188:191], v[24:27], v[200:203], v[188:191]
    s_waitcnt lgkmcnt(2)
    v_cvt_f32_i32 v234, v234
    v_cvt_f32_i32 v235, v235
    v_exp_f32 v16, v160
    v_fma_f32 v234, v234, v48, v50
    v_fma_f32 v235, v235, v49, v51
    v_mfma_f32_16x16x32_bf16 v[112:115], v[32:35], a[192:195], v[128:131]
    ds_read_b128 v[24:27], v2 offset:18560
    v_cvt_pk_bf16_f32 v233, v234, v235
    v_mfma_f32_16x16x32_bf16 v[112:115], v[36:39], a[196:199], v[112:115]
    v_exp_f32 v17, v161
    v_exp_f32 v18, v162
    v_add_f32 v5, v5, v16
    v_mfma_f32_16x16x32_bf16 v[116:119], v[36:39], a[220:223], v[132:135]
    v_cvt_f32_i32 v238, v238
    v_cvt_f32_i32 v239, v239
    v_mfma_f32_16x16x32_bf16 v[116:119], v[32:35], a[216:219], v[116:119]
    v_fma_f32 v238, v238, v48, v50
    v_add_f32 v5, v5, v17
    v_exp_f32 v19, v163
    v_cvt_pk_bf16_f32 v160, v16, v17
    v_mfma_f32_16x16x32_bf16 v[120:123], v[32:35], a[240:243], v[136:139]
    ds_read_b128 v[28:31], v3 offset:18560
    v_fma_f32 v239, v239, v49, v51
    v_cvt_pk_bf16_f32 v237, v238, v239
    v_mfma_f32_16x16x32_bf16 v[120:123], v[36:39], a[244:247], v[120:123]
    s_waitcnt vmcnt(16)
    v_lshlrev_b32 v48, 16, v60
    v_and_b32 v49, s97, v60
    v_lshlrev_b32 v50, 16, v62
    v_and_b32 v51, s97, v62
    v_mul_f32 v48, s38, v48
    v_mfma_f32_16x16x32_bf16 v[124:127], v[36:39], v[204:207], v[140:143]
    v_mul_f32 v49, s38, v49
    v_mul_f32_e64 v50, -v50, v48
    v_mfma_f32_16x16x32_bf16 v[124:127], v[32:35], v[200:203], v[124:127]
    s_waitcnt lgkmcnt(2)
    s_waitcnt vmcnt(12)
    buffer_load_dwordx2 v[56:57], off, s[80:83], s37 offset:0
    v_mul_f32_e64 v51, -v51, v49
    v_cvt_f32_i32 v240, v240
    v_cvt_f32_i32 v241, v241
    v_mfma_f32_16x16x32_bf16 v[176:179], v[40:43], a[200:203], v[176:179]
    ds_read_b128 v[32:35], v2 offset:12544
    v_fma_f32 v240, v240, v48, v50
    v_mfma_f32_16x16x32_bf16 v[176:179], v[44:47], a[204:207], v[176:179]
    buffer_load_dwordx2 v[58:59], off, s[84:87], s37 offset:0
    v_exp_f32 v16, v96
    v_fma_f32 v241, v241, v49, v51
    v_mfma_f32_16x16x32_bf16 v[180:183], v[44:47], a[228:231], v[180:183]
    v_cvt_pk_bf16_f32 v226, v240, v241
    v_add_f32 v5, v5, v18
    v_mfma_f32_16x16x32_bf16 v[180:183], v[40:43], a[224:227], v[180:183]
    v_cvt_f32_i32 v244, v244
    v_add_f32 v5, v5, v19
    v_cvt_f32_i32 v245, v245
    v_exp_f32 v17, v97
    v_fma_f32 v244, v244, v48, v50
    v_mfma_f32_16x16x32_bf16 v[184:187], v[40:43], a[248:251], v[184:187]
    ds_read_b128 v[36:39], v3 offset:12544
    v_fma_f32 v245, v245, v49, v51
    v_mfma_f32_16x16x32_bf16 v[184:187], v[44:47], a[252:255], v[184:187]
    v_cvt_pk_bf16_f32 v161, v18, v19
    v_cvt_pk_bf16_f32 v230, v244, v245
    v_exp_f32 v18, v98
    v_cvt_f32_i32 v248, v248
    v_mfma_f32_16x16x32_bf16 v[188:191], v[44:47], v[212:215], v[188:191]
    v_cvt_f32_i32 v249, v249
    v_add_f32 v5, v5, v16
    v_mfma_f32_16x16x32_bf16 v[188:191], v[40:43], v[208:211], v[188:191]
    s_waitcnt lgkmcnt(2)
    v_fma_f32 v248, v248, v48, v50
    v_add_f32 v5, v5, v17
    v_fma_f32 v249, v249, v49, v51
    v_exp_f32 v19, v99
    v_mfma_f32_16x16x32_bf16 v[112:115], v[24:27], a[200:203], v[112:115]
    ds_read_b128 v[40:43], v2 offset:18688
    v_cvt_pk_bf16_f32 v234, v248, v249
    v_mfma_f32_16x16x32_bf16 v[112:115], v[28:31], a[204:207], v[112:115]
    v_cvt_f32_i32 v252, v252
    v_cvt_pk_bf16_f32 v162, v16, v17
    v_cvt_f32_i32 v253, v253
    v_exp_f32 v16, v164
    v_mfma_f32_16x16x32_bf16 v[116:119], v[28:31], a[228:231], v[116:119]
    v_fma_f32 v252, v252, v48, v50
    v_fma_f32 v253, v253, v49, v51
    v_mfma_f32_16x16x32_bf16 v[116:119], v[24:27], a[224:227], v[116:119]
    v_add_f32 v5, v5, v18
    v_cvt_pk_bf16_f32 v238, v252, v253
    v_add_f32 v5, v5, v19
    v_lshlrev_b32 v48, 16, v61
    v_exp_f32 v17, v165
    v_mfma_f32_16x16x32_bf16 v[120:123], v[24:27], a[248:251], v[120:123]
    ds_read_b128 v[44:47], v3 offset:18688
    v_and_b32 v49, s97, v61
    v_mfma_f32_16x16x32_bf16 v[120:123], v[28:31], a[252:255], v[120:123]
    s_waitcnt lgkmcnt(2)
    v_lshlrev_b32 v50, 16, v63
    v_cvt_pk_bf16_f32 v163, v18, v19
    v_and_b32 v51, s97, v63
    v_exp_f32 v18, v166
    v_mfma_f32_16x16x32_bf16 v[124:127], v[28:31], v[212:215], v[124:127]
    s_waitcnt vmcnt(30)
    v_mul_f32 v48, s38, v48
    v_mul_f32 v49, s38, v49
    v_mfma_f32_16x16x32_bf16 v[124:127], v[24:27], v[208:211], v[124:127]
    s_barrier
    v_add_f32 v6, v6, v16
    v_mul_f32_e64 v50, -v50, v48
    v_add_f32 v6, v6, v17
    v_mul_f32_e64 v51, -v51, v49
    v_mfma_f32_16x16x32_bf16 v[176:179], v[32:35], a[208:211], v[176:179]
    ds_read_b128 v[24:27], v1 offset:0
    v_cvt_f32_i32 v242, v242
    v_mfma_f32_16x16x32_bf16 v[176:179], v[36:39], a[212:215], v[176:179]
    v_exp_f32 v19, v167
    v_cvt_f32_i32 v243, v243
    v_cvt_pk_bf16_f32 v164, v16, v17
    v_fma_f32 v242, v242, v48, v50
    v_mfma_f32_16x16x32_bf16 v[180:183], v[36:39], a[236:239], v[180:183]
    v_exp_f32 v16, v100
    v_mfma_f32_16x16x32_bf16 v[180:183], v[32:35], a[232:235], v[180:183]
    v_fma_f32 v243, v243, v49, v51
    v_cvt_pk_bf16_f32 v227, v242, v243
    v_add_f32 v6, v6, v18
    v_cvt_f32_i32 v246, v246
    v_add_f32 v6, v6, v19
    v_cvt_f32_i32 v247, v247
    v_mfma_f32_16x16x32_bf16 v[184:187], v[32:35], v[192:195], v[184:187]
    ds_read_b128 v[28:31], v1 offset:12288
    v_fma_f32 v246, v246, v48, v50
    v_mfma_f32_16x16x32_bf16 v[184:187], v[36:39], v[196:199], v[184:187]
    v_exp_f32 v17, v101
    v_fma_f32 v247, v247, v49, v51
    v_cvt_pk_bf16_f32 v165, v18, v19
    v_cvt_pk_bf16_f32 v231, v246, v247
    v_mfma_f32_16x16x32_bf16 v[188:191], v[36:39], v[220:223], v[188:191]
    v_exp_f32 v18, v102
    v_mfma_f32_16x16x32_bf16 v[188:191], v[32:35], v[216:219], v[188:191]
    s_waitcnt lgkmcnt(2)
    v_cvt_f32_i32 v250, v250
    v_cvt_f32_i32 v251, v251
    v_add_f32 v6, v6, v16
    v_fma_f32 v250, v250, v48, v50
    v_add_f32 v6, v6, v17
    v_mfma_f32_16x16x32_bf16 v[112:115], v[40:43], a[208:211], v[112:115]
    ds_read_b128 v[32:35], v1 offset:1024
    v_fma_f32 v251, v251, v49, v51
    v_mfma_f32_16x16x32_bf16 v[112:115], v[44:47], a[212:215], v[112:115]
    v_exp_f32 v19, v103
    v_cvt_pk_bf16_f32 v235, v250, v251
    v_cvt_f32_i32 v254, v254
    v_cvt_pk_bf16_f32 v166, v16, v17
    v_mfma_f32_16x16x32_bf16 v[116:119], v[44:47], a[236:239], v[116:119]
    v_cvt_f32_i32 v255, v255
    v_add_f32 v6, v6, v18
    v_mfma_f32_16x16x32_bf16 v[116:119], v[40:43], a[232:235], v[116:119]
    v_fma_f32 v254, v254, v48, v50
    v_add_f32 v6, v6, v19
    v_fma_f32 v255, v255, v49, v51
    v_cvt_pk_bf16_f32 v167, v18, v19
    v_cvt_pk_bf16_f32 v239, v254, v255
    v_mfma_f32_16x16x32_bf16 v[120:123], v[40:43], v[192:195], v[120:123]
    ds_read_b128 v[36:39], v1 offset:13312
    v_mfma_f32_16x16x32_bf16 v[120:123], v[44:47], v[196:199], v[120:123]
    v_mfma_f32_16x16x32_bf16 v[124:127], v[44:47], v[220:223], v[124:127]
    v_mfma_f32_16x16x32_bf16 v[124:127], v[40:43], v[216:219], v[124:127]
    s_waitcnt lgkmcnt(2)
    v_mfma_f32_16x16x32_bf16 a[144:147], v[76:79], v[24:27], 0
    ds_read_b128 v[40:43], v1 offset:2048
    v_mfma_f32_16x16x32_bf16 a[144:147], v[92:95], v[28:31], a[144:147]
    buffer_store_dwordx4 v[224:227], v11, s[4:7], s33 offen offset:0 sc1
    v_mfma_f32_16x16x32_bf16 a[96:99], v[72:75], v[24:27], 0
    v_exp_f32 v16, v168
    v_mfma_f32_16x16x32_bf16 a[96:99], v[88:91], v[28:31], a[96:99]
    ds_read_b128 v[44:47], v1 offset:14336
    v_mfma_f32_16x16x32_bf16 a[0:3], v[80:83], v[28:31], a[0:3]
    v_exp_f32 v17, v169
    v_mfma_f32_16x16x32_bf16 a[48:51], v[84:87], v[28:31], a[48:51]
    s_waitcnt lgkmcnt(2)
    v_exp_f32 v18, v170
    v_mfma_f32_16x16x32_bf16 a[148:151], v[76:79], v[32:35], 0
    ds_read_b128 v[24:27], v1 offset:3072
    v_add_f32 v7, v7, v16
    v_mfma_f32_16x16x32_bf16 a[148:151], v[92:95], v[36:39], a[148:151]
    v_add_f32 v7, v7, v17
    v_mfma_f32_16x16x32_bf16 a[100:103], v[72:75], v[32:35], 0
    v_exp_f32 v19, v171
    v_mfma_f32_16x16x32_bf16 a[100:103], v[88:91], v[36:39], a[100:103]
    ds_read_b128 v[28:31], v1 offset:15360
    v_cvt_pk_bf16_f32 v168, v16, v17
    v_mfma_f32_16x16x32_bf16 a[4:7], v[80:83], v[36:39], a[4:7]
    v_exp_f32 v16, v104
    v_mfma_f32_16x16x32_bf16 a[52:55], v[84:87], v[36:39], a[52:55]
    s_waitcnt lgkmcnt(2)
    v_add_f32 v7, v7, v18
    v_add_f32 v7, v7, v19
    v_mfma_f32_16x16x32_bf16 a[152:155], v[76:79], v[40:43], 0
    ds_read_b128 v[32:35], v1 offset:4096
    v_mfma_f32_16x16x32_bf16 a[152:155], v[92:95], v[44:47], a[152:155]
    buffer_store_dwordx4 v[228:231], v21, s[4:7], s33 offen offset:768 sc1
    v_mfma_f32_16x16x32_bf16 a[104:107], v[72:75], v[40:43], 0
    v_exp_f32 v17, v105
    v_mfma_f32_16x16x32_bf16 a[104:107], v[88:91], v[44:47], a[104:107]
    ds_read_b128 v[36:39], v1 offset:16384
    v_cvt_pk_bf16_f32 v169, v18, v19
    v_mfma_f32_16x16x32_bf16 a[8:11], v[80:83], v[44:47], a[8:11]
    v_exp_f32 v18, v106
    v_mfma_f32_16x16x32_bf16 a[56:59], v[84:87], v[44:47], a[56:59]
    s_waitcnt lgkmcnt(2)
    v_add_f32 v7, v7, v16
    v_add_f32 v7, v7, v17
    v_mfma_f32_16x16x32_bf16 a[156:159], v[76:79], v[24:27], 0
    ds_read_b128 v[40:43], v1 offset:5120
    v_mfma_f32_16x16x32_bf16 a[156:159], v[92:95], v[28:31], a[156:159]
    v_exp_f32 v19, v107
    v_cvt_pk_bf16_f32 v170, v16, v17
    v_mfma_f32_16x16x32_bf16 a[108:111], v[72:75], v[24:27], 0
    v_exp_f32 v16, v172
    v_mfma_f32_16x16x32_bf16 a[108:111], v[88:91], v[28:31], a[108:111]
    ds_read_b128 v[44:47], v1 offset:17408
    v_add_f32 v7, v7, v18
    v_add_f32 v7, v7, v19
    v_mfma_f32_16x16x32_bf16 a[12:15], v[80:83], v[28:31], a[12:15]
    v_exp_f32 v17, v173
    v_mfma_f32_16x16x32_bf16 a[60:63], v[84:87], v[28:31], a[60:63]
    s_waitcnt lgkmcnt(2)
    v_cvt_pk_bf16_f32 v171, v18, v19
    v_mfma_f32_16x16x32_bf16 a[160:163], v[76:79], v[32:35], 0
    ds_read_b128 v[24:27], v1 offset:6144
    v_mfma_f32_16x16x32_bf16 a[160:163], v[92:95], v[36:39], a[160:163]
    buffer_store_dwordx4 v[232:235], v22, s[4:7], s33 offen offset:1536 sc1
    v_mfma_f32_16x16x32_bf16 a[112:115], v[72:75], v[32:35], 0
    v_exp_f32 v18, v174
    v_mfma_f32_16x16x32_bf16 a[112:115], v[88:91], v[36:39], a[112:115]
    ds_read_b128 v[28:31], v1 offset:18432
    v_add_f32 v8, v8, v16
    v_add_f32 v8, v8, v17
    v_mfma_f32_16x16x32_bf16 a[16:19], v[80:83], v[36:39], a[16:19]
    v_exp_f32 v19, v175
    v_mfma_f32_16x16x32_bf16 a[64:67], v[84:87], v[36:39], a[64:67]
    s_waitcnt lgkmcnt(2)
    v_cvt_pk_bf16_f32 v172, v16, v17
    v_exp_f32 v16, v108
    v_mfma_f32_16x16x32_bf16 a[164:167], v[76:79], v[40:43], 0
    ds_read_b128 v[32:35], v1 offset:7168
    v_add_f32 v8, v8, v18
    v_mfma_f32_16x16x32_bf16 a[164:167], v[92:95], v[44:47], a[164:167]
    v_add_f32 v8, v8, v19
    v_exp_f32 v17, v109
    v_mfma_f32_16x16x32_bf16 a[116:119], v[72:75], v[40:43], 0
    v_cvt_pk_bf16_f32 v173, v18, v19
    v_mfma_f32_16x16x32_bf16 a[116:119], v[88:91], v[44:47], a[116:119]
    ds_read_b128 v[36:39], v1 offset:19456
    v_exp_f32 v18, v110
    v_mfma_f32_16x16x32_bf16 a[20:23], v[80:83], v[44:47], a[20:23]
    v_add_f32 v8, v8, v16
    v_add_f32 v8, v8, v17
    v_mfma_f32_16x16x32_bf16 a[68:71], v[84:87], v[44:47], a[68:71]
    s_waitcnt lgkmcnt(2)
    v_exp_f32 v19, v111
    v_mfma_f32_16x16x32_bf16 a[168:171], v[76:79], v[24:27], 0
    ds_read_b128 v[40:43], v1 offset:8192
    v_cvt_pk_bf16_f32 v174, v16, v17
    v_mfma_f32_16x16x32_bf16 a[168:171], v[92:95], v[28:31], a[168:171]
    buffer_store_dwordx4 v[236:239], v23, s[4:7], s33 offen offset:2304 sc1
    v_mfma_f32_16x16x32_bf16 a[120:123], v[72:75], v[24:27], 0
    v_add_f32 v8, v8, v18
    v_add_f32 v8, v8, v19
    v_mfma_f32_16x16x32_bf16 a[120:123], v[88:91], v[28:31], a[120:123]
    ds_read_b128 v[44:47], v1 offset:20480
    v_cvt_pk_bf16_f32 v175, v18, v19
    v_mfma_f32_16x16x32_bf16 a[24:27], v[80:83], v[28:31], a[24:27]
    v_exp_f32 v16, v176
    v_mfma_f32_16x16x32_bf16 a[72:75], v[84:87], v[28:31], a[72:75]
    s_waitcnt lgkmcnt(2)
    v_exp_f32 v17, v177
    v_mfma_f32_16x16x32_bf16 a[172:175], v[76:79], v[32:35], 0
    ds_read_b128 v[24:27], v1 offset:9216
    v_mfma_f32_16x16x32_bf16 a[172:175], v[92:95], v[36:39], a[172:175]
    v_exp_f32 v18, v178
    v_add_f32 v5, v5, v16
    v_mfma_f32_16x16x32_bf16 a[124:127], v[72:75], v[32:35], 0
    v_add_f32 v5, v5, v17
    v_mfma_f32_16x16x32_bf16 a[124:127], v[88:91], v[36:39], a[124:127]
    ds_read_b128 v[28:31], v1 offset:21504
    v_exp_f32 v19, v179
    v_mfma_f32_16x16x32_bf16 a[28:31], v[80:83], v[36:39], a[28:31]
    v_cvt_pk_bf16_f32 v176, v16, v17
    v_mfma_f32_16x16x32_bf16 a[76:79], v[84:87], v[36:39], a[76:79]
    s_waitcnt lgkmcnt(2)
    buffer_load_dwordx2 v[60:61], off, s[80:83], s37 offset:8
    v_mfma_f32_16x16x32_bf16 a[176:179], v[76:79], v[40:43], 0
    ds_read_b128 v[32:35], v1 offset:10240
    v_mfma_f32_16x16x32_bf16 a[176:179], v[92:95], v[44:47], a[176:179]
    buffer_load_dwordx2 v[62:63], off, s[84:87], s37 offset:8
    v_mfma_f32_16x16x32_bf16 a[128:131], v[72:75], v[40:43], 0
    v_exp_f32 v16, v112
    v_mfma_f32_16x16x32_bf16 a[128:131], v[88:91], v[44:47], a[128:131]
    ds_read_b128 v[36:39], v1 offset:22528
    v_add_f32 v5, v5, v18
    v_add_f32 v5, v5, v19
    v_mfma_f32_16x16x32_bf16 a[32:35], v[80:83], v[44:47], a[32:35]
    v_exp_f32 v17, v113
    v_mfma_f32_16x16x32_bf16 a[80:83], v[84:87], v[44:47], a[80:83]
    s_waitcnt lgkmcnt(2)
    s_waitcnt vmcnt(19)
    buffer_load_dwordx3 v[240:242], v12, s[68:71], s16 offen offset:0 nt
    v_cvt_pk_bf16_f32 v177, v18, v19
    v_mfma_f32_16x16x32_bf16 a[180:183], v[76:79], v[24:27], 0
    ds_read_b128 v[40:43], v1 offset:11264
    v_mfma_f32_16x16x32_bf16 a[180:183], v[92:95], v[28:31], a[180:183]
    buffer_load_dwordx3 v[244:246], v12, s[68:71], s16 offen offset:768 nt
    v_mfma_f32_16x16x32_bf16 a[132:135], v[72:75], v[24:27], 0
    v_exp_f32 v18, v114
    v_mfma_f32_16x16x32_bf16 a[132:135], v[88:91], v[28:31], a[132:135]
    s_waitcnt vmcnt(20)
    ds_read_b128 v[44:47], v1 offset:23552
    v_add_f32 v5, v5, v16
    v_add_f32 v5, v5, v17
    v_mfma_f32_16x16x32_bf16 a[36:39], v[80:83], v[28:31], a[36:39]
    v_exp_f32 v19, v115
    v_mfma_f32_16x16x32_bf16 a[84:87], v[84:87], v[28:31], a[84:87]
    s_waitcnt lgkmcnt(2)
    s_barrier
    v_add_u32 v2, 49152, v2
    v_add_u32 v3, 49152, v3
    v_mfma_f32_16x16x32_bf16 a[184:187], v[76:79], v[32:35], 0
    ds_read_b128 v[24:27], v2 offset:0
    v_cvt_pk_bf16_f32 v178, v16, v17
    v_mfma_f32_16x16x32_bf16 a[184:187], v[92:95], v[36:39], a[184:187]
    buffer_load_dwordx3 v[248:250], v12, s[68:71], s16 offen offset:1536 nt
    v_mfma_f32_16x16x32_bf16 a[136:139], v[72:75], v[32:35], 0
    v_exp_f32 v16, v180
    v_mfma_f32_16x16x32_bf16 a[136:139], v[88:91], v[36:39], a[136:139]
    ds_read_b128 v[28:31], v3 offset:0
    v_add_f32 v5, v5, v18
    v_add_f32 v5, v5, v19
    v_mfma_f32_16x16x32_bf16 a[40:43], v[80:83], v[36:39], a[40:43]
    v_exp_f32 v17, v181
    v_mfma_f32_16x16x32_bf16 a[88:91], v[84:87], v[36:39], a[88:91]
    s_waitcnt lgkmcnt(2)
    s_waitcnt vmcnt(20)
    buffer_load_dwordx3 v[252:254], v12, s[68:71], s16 offen offset:2304 nt
    v_cvt_pk_bf16_f32 v179, v18, v19
    v_mfma_f32_16x16x32_bf16 a[188:191], v[76:79], v[40:43], 0
    ds_read_b128 v[32:35], v2 offset:6144
    v_mfma_f32_16x16x32_bf16 a[188:191], v[92:95], v[44:47], a[188:191]
    v_exp_f32 v18, v182
    v_add_f32 v6, v6, v16
    v_mfma_f32_16x16x32_bf16 a[140:143], v[72:75], v[40:43], 0
    v_add_f32 v6, v6, v17
    v_mfma_f32_16x16x32_bf16 a[140:143], v[88:91], v[44:47], a[140:143]
    ds_read_b128 v[36:39], v3 offset:6144
    v_exp_f32 v19, v183
    v_mfma_f32_16x16x32_bf16 a[44:47], v[80:83], v[44:47], a[44:47]
    v_cvt_pk_bf16_f32 v180, v16, v17
    v_mfma_f32_16x16x32_bf16 a[92:95], v[84:87], v[44:47], a[92:95]
    s_waitcnt lgkmcnt(2)
    v_exp_f32 v16, v116
    v_add_f32 v6, v6, v18
    v_add_f32 v6, v6, v19
    v_exp_f32 v17, v117
    v_cvt_pk_bf16_f32 v181, v18, v19
    v_exp_f32 v18, v118
    v_add_f32 v6, v6, v16
    v_add_f32 v6, v6, v17
    v_exp_f32 v19, v119
    v_cvt_pk_bf16_f32 v182, v16, v17
    v_add_f32 v6, v6, v18
    v_add_f32 v6, v6, v19
    v_cvt_pk_bf16_f32 v183, v18, v19
    v_mfma_f32_16x16x32_bf16 v[64:67], v[24:27], a[192:195], v[128:131]
    s_waitcnt vmcnt(10)
    ds_read_b128 v[40:43], v2 offset:128
    v_lshlrev_b32 v48, 16, v56
    v_mfma_f32_16x16x32_bf16 v[64:67], v[28:31], a[196:199], v[64:67]
    v_exp_f32 v16, v184
    v_mfma_f32_16x16x32_bf16 v[68:71], v[28:31], a[220:223], v[132:135]
    v_exp_f32 v17, v185
    v_mfma_f32_16x16x32_bf16 v[68:71], v[24:27], a[216:219], v[68:71]
    v_exp_f32 v18, v186
    v_mfma_f32_16x16x32_bf16 v[72:75], v[24:27], a[240:243], v[136:139]
    ds_read_b128 v[44:47], v3 offset:128
    v_and_b32 v49, s97, v56
    v_mfma_f32_16x16x32_bf16 v[72:75], v[28:31], a[244:247], v[72:75]
    v_add_f32 v7, v7, v16
    v_add_f32 v7, v7, v17
    v_mfma_f32_16x16x32_bf16 v[76:79], v[28:31], v[204:207], v[140:143]
    v_exp_f32 v19, v187
    v_mfma_f32_16x16x32_bf16 v[76:79], v[24:27], v[200:203], v[76:79]
    s_waitcnt lgkmcnt(2)
    v_lshlrev_b32 v50, 16, v58
    v_and_b32 v51, s97, v58
    v_mfma_f32_16x16x32_bf16 v[96:99], v[32:35], a[192:195], v[128:131]
    ds_read_b128 v[24:27], v2 offset:6272
    v_cvt_pk_bf16_f32 v184, v16, v17
    v_mfma_f32_16x16x32_bf16 v[96:99], v[36:39], a[196:199], v[96:99]
    v_exp_f32 v16, v120
    v_mfma_f32_16x16x32_bf16 v[100:103], v[36:39], a[220:223], v[132:135]
    v_mul_f32_e64 v50, -v50, v48
    v_add_f32 v7, v7, v18
    v_mfma_f32_16x16x32_bf16 v[100:103], v[32:35], a[216:219], v[100:103]
    v_add_f32 v7, v7, v19
    v_mul_f32_e64 v51, -v51, v49
    v_mfma_f32_16x16x32_bf16 v[104:107], v[32:35], a[240:243], v[136:139]
    ds_read_b128 v[28:31], v3 offset:6272
    v_cvt_f32_i32 v144, v144
    v_mfma_f32_16x16x32_bf16 v[104:107], v[36:39], a[244:247], v[104:107]
    s_waitcnt lgkmcnt(2)
    v_exp_f32 v17, v121
    v_mfma_f32_16x16x32_bf16 v[108:111], v[36:39], v[204:207], v[140:143]
    s_waitcnt vmcnt(6)
    v_cvt_pk_bf16_f32 v185, v18, v19
    v_cvt_f32_i32 v148, v148
    v_mfma_f32_16x16x32_bf16 v[108:111], v[32:35], v[200:203], v[108:111]
    s_barrier
    v_mfma_f32_16x16x32_bf16 v[64:67], v[40:43], a[200:203], v[64:67]
    ds_read_b128 v[32:35], v2 offset:256
    v_add_u32 v0, 1, v0
    v_mfma_f32_16x16x32_bf16 v[64:67], v[44:47], a[204:207], v[64:67]
    buffer_store_dword v0, v13, s[20:23], 0 offen offset:32 sc1
    v_mfma_f32_16x16x32_bf16 v[68:71], v[44:47], a[228:231], v[68:71]
    s_mov_b32 m0, s26
    v_exp_f32 v18, v122
    v_mfma_f32_16x16x32_bf16 v[68:71], v[40:43], a[224:227], v[68:71]
    v_add_f32 v7, v7, v16
    v_add_f32 v7, v7, v17
    v_mfma_f32_16x16x32_bf16 v[72:75], v[40:43], a[248:251], v[72:75]
    ds_read_b128 v[36:39], v3 offset:256
    v_fma_f32 v144, v144, v48, v50
    v_mfma_f32_16x16x32_bf16 v[72:75], v[44:47], a[252:255], v[72:75]
    buffer_load_dwordx4 v4, s[4:7], s32 offen offset:0 sc1 lds
    v_mfma_f32_16x16x32_bf16 v[76:79], v[44:47], v[212:215], v[76:79]
    v_exp_f32 v19, v123
    v_mfma_f32_16x16x32_bf16 v[76:79], v[40:43], v[208:211], v[76:79]
    s_waitcnt lgkmcnt(2)
    v_cvt_pk_bf16_f32 v186, v16, v17
    v_fma_f32 v148, v148, v49, v51
    v_mfma_f32_16x16x32_bf16 v[96:99], v[24:27], a[200:203], v[96:99]
    ds_read_b128 v[40:43], v2 offset:6400
    v_cvt_f32_i32 v145, v145
    v_mfma_f32_16x16x32_bf16 v[96:99], v[28:31], a[204:207], v[96:99]
    buffer_load_dwordx4 v4, s[4:7], s32 offen offset:1024 sc1 lds
    v_mfma_f32_16x16x32_bf16 v[100:103], v[28:31], a[228:231], v[100:103]
    v_exp_f32 v16, v188
    v_mfma_f32_16x16x32_bf16 v[100:103], v[24:27], a[224:227], v[100:103]
    v_add_f32 v7, v7, v18
    v_add_f32 v7, v7, v19
    v_mfma_f32_16x16x32_bf16 v[104:107], v[24:27], a[248:251], v[104:107]
    ds_read_b128 v[44:47], v3 offset:6400
    v_cvt_f32_i32 v149, v149
    v_mfma_f32_16x16x32_bf16 v[104:107], v[28:31], a[252:255], v[104:107]
    buffer_load_dwordx4 v4, s[4:7], s32 offen offset:2048 sc1 lds
    v_mfma_f32_16x16x32_bf16 v[108:111], v[28:31], v[212:215], v[108:111]
    s_add_u32 s32, s32, 24576
    v_exp_f32 v17, v189
    v_mfma_f32_16x16x32_bf16 v[108:111], v[24:27], v[208:211], v[108:111]
    s_waitcnt lgkmcnt(2)
    v_cvt_pk_bf16_f32 v187, v18, v19
    v_fma_f32 v145, v145, v48, v50
    v_mfma_f32_16x16x32_bf16 v[64:67], v[32:35], a[208:211], v[64:67]
    s_sub_u32 s57, s32, 196608
    ds_read_b128 v[24:27], v2 offset:12288
    v_fma_f32 v149, v149, v49, v51
    v_mfma_f32_16x16x32_bf16 v[64:67], v[36:39], a[212:215], v[64:67]
    s_min_u32 s32, s32, s57
    v_exp_f32 v18, v190
    v_mfma_f32_16x16x32_bf16 v[68:71], v[36:39], a[236:239], v[68:71]
    s_add_u32 s26, s26, 12288
    v_add_f32 v8, v8, v16
    v_add_f32 v8, v8, v17
    v_mfma_f32_16x16x32_bf16 v[68:71], v[32:35], a[232:235], v[68:71]
    s_mov_b32 m0, s26
    v_exp_f32 v19, v191
    v_mfma_f32_16x16x32_bf16 v[72:75], v[32:35], v[192:195], v[72:75]
    ds_read_b128 v[28:31], v3 offset:12288
    v_cvt_pk_bf16_f32 v188, v16, v17
    v_mfma_f32_16x16x32_bf16 v[72:75], v[36:39], v[196:199], v[72:75]
    v_exp_f32 v16, v124
    v_mfma_f32_16x16x32_bf16 v[76:79], v[36:39], v[220:223], v[76:79]
    v_add_f32 v8, v8, v18
    v_add_f32 v8, v8, v19
    v_mfma_f32_16x16x32_bf16 v[76:79], v[32:35], v[216:219], v[76:79]
    s_waitcnt lgkmcnt(2)
    buffer_load_dwordx4 v4, s[4:7], s32 offen offset:0 sc1 lds
    v_mfma_f32_16x16x32_bf16 v[96:99], v[40:43], a[208:211], v[96:99]
    ds_read_b128 v[32:35], v2 offset:18432
    v_cvt_f32_i32 v146, v146
    v_mfma_f32_16x16x32_bf16 v[96:99], v[44:47], a[212:215], v[96:99]
    v_exp_f32 v17, v125
    v_mfma_f32_16x16x32_bf16 v[100:103], v[44:47], a[236:239], v[100:103]
    v_cvt_pk_bf16_f32 v189, v18, v19
    v_cvt_f32_i32 v150, v150
    v_mfma_f32_16x16x32_bf16 v[100:103], v[40:43], a[232:235], v[100:103]
    buffer_load_dwordx4 v4, s[4:7], s32 offen offset:1024 sc1 lds
    v_mfma_f32_16x16x32_bf16 v[104:107], v[40:43], v[192:195], v[104:107]
    ds_read_b128 v[36:39], v3 offset:18432
    v_fma_f32 v146, v146, v48, v50
    v_mfma_f32_16x16x32_bf16 v[104:107], v[44:47], v[196:199], v[104:107]
    v_exp_f32 v18, v126
    v_mfma_f32_16x16x32_bf16 v[108:111], v[44:47], v[220:223], v[108:111]
    v_add_f32 v8, v8, v16
    v_add_f32 v8, v8, v17
    v_mfma_f32_16x16x32_bf16 v[108:111], v[40:43], v[216:219], v[108:111]
    s_waitcnt lgkmcnt(2)
    buffer_load_dwordx4 v4, s[4:7], s32 offen offset:2048 sc1 lds
    v_mfma_f32_16x16x32_bf16 v[80:83], v[24:27], a[192:195], v[128:131]
    s_mov_b32 s32, 196608
    ds_read_b128 v[40:43], v2 offset:12416
    v_fma_f32 v150, v150, v49, v51
    v_mfma_f32_16x16x32_bf16 v[80:83], v[28:31], a[196:199], v[80:83]
    v_exp_f32 v19, v127
    v_cvt_pk_bf16_f32 v190, v16, v17
    v_mfma_f32_16x16x32_bf16 v[84:87], v[28:31], a[220:223], v[132:135]
    s_add_u32 s26, s26, 36864
    v_add_f32 v8, v8, v18
    v_add_f32 v8, v8, v19
    v_mfma_f32_16x16x32_bf16 v[84:87], v[24:27], a[216:219], v[84:87]
    s_sub_u32 s57, s26, 147456
    v_cvt_pk_bf16_f32 v191, v18, v19
    v_lshlrev_b32 v48, 16, v57
    v_mfma_f32_16x16x32_bf16 v[88:91], v[24:27], a[240:243], v[136:139]
    ds_read_b128 v[44:47], v3 offset:12416
    v_and_b32 v49, s97, v57
    v_mfma_f32_16x16x32_bf16 v[88:91], v[28:31], a[244:247], v[88:91]
    s_min_u32 s26, s26, s57
    v_exp_f32 v16, v64
    v_mfma_f32_16x16x32_bf16 v[92:95], v[28:31], v[204:207], v[140:143]
    v_exp_f32 v17, v65
    v_mfma_f32_16x16x32_bf16 v[92:95], v[24:27], v[200:203], v[92:95]
    s_waitcnt lgkmcnt(2)
    v_exp_f32 v18, v66
    v_mfma_f32_16x16x32_bf16 v[112:115], v[32:35], a[192:195], v[128:131]
    s_mov_b32 m0, s56
    ds_read_b128 v[24:27], v2 offset:18560
    v_lshlrev_b32 v50, 16, v59
    v_mfma_f32_16x16x32_bf16 v[112:115], v[36:39], a[196:199], v[112:115]
L_iw2:
L_pg2:
    s_cbranch_execz L_pg6
    v_add_f32 v5, v5, v16
    v_add_f32 v5, v5, v17
    v_mfma_f32_16x16x32_bf16 v[116:119], v[36:39], a[220:223], v[132:135]
    v_exp_f32 v19, v67
    v_mfma_f32_16x16x32_bf16 v[116:119], v[32:35], a[216:219], v[116:119]
    buffer_load_dwordx4 v4, s[4:7], s27 offen offset:0 sc1 lds
    v_mfma_f32_16x16x32_bf16 v[120:123], v[32:35], a[240:243], v[136:139]
    ds_read_b128 v[28:31], v3 offset:18560
    v_and_b32 v51, s97, v59
    v_mfma_f32_16x16x32_bf16 v[120:123], v[36:39], a[244:247], v[120:123]
    v_cvt_pk_bf16_f32 v64, v16, v17
    v_mul_f32_e64 v50, -v50, v48
    v_mfma_f32_16x16x32_bf16 v[124:127], v[36:39], v[204:207], v[140:143]
    v_exp_f32 v16, v96
    v_mfma_f32_16x16x32_bf16 v[124:127], v[32:35], v[200:203], v[124:127]
    s_waitcnt lgkmcnt(2)
    buffer_load_dwordx4 v4, s[4:7], s27 offen offset:1024 sc1 lds
    v_mfma_f32_16x16x32_bf16 v[80:83], v[40:43], a[200:203], v[80:83]
    ds_read_b128 v[32:35], v2 offset:12544
    v_add_f32 v5, v5, v18
    v_mfma_f32_16x16x32_bf16 v[80:83], v[44:47], a[204:207], v[80:83]
    v_add_f32 v5, v5, v19
    v_mul_f32_e64 v51, -v51, v49
    v_mfma_f32_16x16x32_bf16 v[84:87], v[44:47], a[228:231], v[84:87]
    v_exp_f32 v17, v97
    v_mfma_f32_16x16x32_bf16 v[84:87], v[40:43], a[224:227], v[84:87]
    s_waitcnt vmcnt(13)
    buffer_load_dwordx4 v4, s[4:7], s27 offen offset:2048 sc1 lds
    v_cvt_pk_bf16_f32 v65, v18, v19
    v_mfma_f32_16x16x32_bf16 v[88:91], v[40:43], a[248:251], v[88:91]
    s_add_u32 s27, s27, 24576
    ds_read_b128 v[36:39], v3 offset:12544
    v_cvt_f32_i32 v152, v152
    v_mfma_f32_16x16x32_bf16 v[88:91], v[44:47], a[252:255], v[88:91]
    v_exp_f32 v18, v98
    v_mfma_f32_16x16x32_bf16 v[92:95], v[44:47], v[212:215], v[92:95]
    s_sub_u32 s58, s27, 196608
    v_add_f32 v5, v5, v16
    v_add_f32 v5, v5, v17
    v_mfma_f32_16x16x32_bf16 v[92:95], v[40:43], v[208:211], v[92:95]
    s_waitcnt lgkmcnt(2)
    v_cvt_f32_i32 v156, v156
    v_fma_f32 v152, v152, v48, v50
    v_mfma_f32_16x16x32_bf16 v[112:115], v[24:27], a[200:203], v[112:115]
    s_min_u32 s27, s27, s58
    ds_read_b128 v[40:43], v2 offset:18688
    v_fma_f32 v156, v156, v49, v51
    v_mfma_f32_16x16x32_bf16 v[112:115], v[28:31], a[204:207], v[112:115]
    v_exp_f32 v19, v99
    v_cvt_pk_bf16_f32 v66, v16, v17
    v_mfma_f32_16x16x32_bf16 v[116:119], v[28:31], a[228:231], v[116:119]
    s_add_u32 s56, s56, 12288
    v_exp_f32 v16, v68
    v_mfma_f32_16x16x32_bf16 v[116:119], v[24:27], a[224:227], v[116:119]
    s_mov_b32 m0, s56
    v_add_f32 v5, v5, v18
    v_cvt_f32_i32 v153, v153
    v_mfma_f32_16x16x32_bf16 v[120:123], v[24:27], a[248:251], v[120:123]
    ds_read_b128 v[44:47], v3 offset:18688
    v_add_f32 v5, v5, v19
    v_mfma_f32_16x16x32_bf16 v[120:123], v[28:31], a[252:255], v[120:123]
    s_waitcnt lgkmcnt(2)
    v_exp_f32 v17, v69
    v_mfma_f32_16x16x32_bf16 v[124:127], v[28:31], v[212:215], v[124:127]
    s_waitcnt vmcnt(26)
    v_cvt_f32_i32 v157, v157
    v_cvt_pk_bf16_f32 v67, v18, v19
    v_mfma_f32_16x16x32_bf16 v[124:127], v[24:27], v[208:211], v[124:127]
    s_barrier
    v_add_u32 v1, 49152, v1
    v_mfma_f32_16x16x32_bf16 v[80:83], v[32:35], a[208:211], v[80:83]
    ds_read_b128 v[24:27], v1 offset:0
    v_fma_f32 v153, v153, v48, v50
    v_mfma_f32_16x16x32_bf16 v[80:83], v[36:39], a[212:215], v[80:83]
    s_waitcnt vmcnt(12)
    buffer_load_dwordx4 v4, s[4:7], s27 offen offset:0 sc1 lds
    v_mfma_f32_16x16x32_bf16 v[84:87], v[36:39], a[236:239], v[84:87]
    v_exp_f32 v18, v70
    v_mfma_f32_16x16x32_bf16 v[84:87], v[32:35], a[232:235], v[84:87]
    v_add_f32 v6, v6, v16
    v_add_f32 v6, v6, v17
    v_mfma_f32_16x16x32_bf16 v[88:91], v[32:35], v[192:195], v[88:91]
    ds_read_b128 v[28:31], v1 offset:12288
    v_fma_f32 v157, v157, v49, v51
    v_mfma_f32_16x16x32_bf16 v[88:91], v[36:39], v[196:199], v[88:91]
    s_waitcnt vmcnt(12)
    buffer_load_dwordx4 v4, s[4:7], s27 offen offset:1024 sc1 lds
    v_mfma_f32_16x16x32_bf16 v[92:95], v[36:39], v[220:223], v[92:95]
    v_exp_f32 v19, v71
    v_mfma_f32_16x16x32_bf16 v[92:95], v[32:35], v[216:219], v[92:95]
    s_waitcnt lgkmcnt(2)
    v_cvt_pk_bf16_f32 v68, v16, v17
    v_exp_f32 v16, v100
    v_mfma_f32_16x16x32_bf16 v[112:115], v[40:43], a[208:211], v[112:115]
    ds_read_b128 v[32:35], v1 offset:1024
    v_cvt_f32_i32 v154, v154
    v_mfma_f32_16x16x32_bf16 v[112:115], v[44:47], a[212:215], v[112:115]
    s_waitcnt vmcnt(12)
    buffer_load_dwordx4 v4, s[4:7], s27 offen offset:2048 sc1 lds
    v_add_f32 v6, v6, v18
    v_mfma_f32_16x16x32_bf16 v[116:119], v[44:47], a[236:239], v[116:119]
    v_add_f32 v6, v6, v19
    v_cvt_f32_i32 v158, v158
    v_mfma_f32_16x16x32_bf16 v[116:119], v[40:43], a[232:235], v[116:119]
    v_exp_f32 v17, v101
    v_cvt_pk_bf16_f32 v69, v18, v19
    v_mfma_f32_16x16x32_bf16 v[120:123], v[40:43], v[192:195], v[120:123]
    s_add_u32 s27, s27, 24576
    ds_read_b128 v[36:39], v1 offset:13312
    v_fma_f32 v154, v154, v48, v50
    v_mfma_f32_16x16x32_bf16 v[120:123], v[44:47], v[196:199], v[120:123]
    v_exp_f32 v18, v102
    v_fma_f32 v158, v158, v49, v51
    v_mfma_f32_16x16x32_bf16 v[124:127], v[44:47], v[220:223], v[124:127]
    s_sub_u32 s58, s27, 196608
    v_add_f32 v6, v6, v16
    v_add_f32 v6, v6, v17
    v_mfma_f32_16x16x32_bf16 v[124:127], v[40:43], v[216:219], v[124:127]
    s_waitcnt lgkmcnt(2)
    v_exp_f32 v19, v103
    v_cvt_pk_bf16_f32 v144, v144, v148
    v_cvt_pk_bf16_f32 v148, v145, v149
    v_cvt_pk_bf16_f32 v70, v16, v17
    s_min_u32 s27, s27, s58
    v_cvt_pk_bf16_f32 v145, v152, v156
    v_add_f32 v6, v6, v18
    s_add_u32 s56, s56, 36864
    v_cvt_pk_bf16_f32 v149, v153, v157
    v_add_f32 v6, v6, v19
    s_sub_u32 s58, s56, 147456
    v_cvt_pk_bf16_f32 v152, v146, v150
    v_cvt_pk_bf16_f32 v71, v18, v19
    s_min_u32 s56, s56, s58
    v_cvt_pk_bf16_f32 v153, v154, v158
    s_mov_b32 s31, 6
    v_mfma_f32_16x16x32_bf16 a[0:3], v[160:163], v[24:27], a[0:3]
    s_add_u32 s33, s33, 196608
    ds_read_b128 v[40:43], v1 offset:2048
    v_mfma_f32_16x16x32_bf16 a[0:3], v[176:179], v[28:31], a[0:3]
    s_add_u32 s34, s34, 196608
    v_exp_f32 v16, v72
    v_mfma_f32_16x16x32_bf16 a[48:51], v[180:183], v[28:31], a[48:51]
    s_add_u32 s36, s36, 1536
    v_exp_f32 v17, v73
    v_mfma_f32_16x16x32_bf16 a[48:51], v[164:167], v[24:27], a[48:51]
    v_exp_f32 v18, v74
    v_mfma_f32_16x16x32_bf16 a[96:99], v[168:171], v[24:27], a[96:99]
    ds_read_b128 v[44:47], v1 offset:14336
    v_add_f32 v7, v7, v16
    v_mfma_f32_16x16x32_bf16 a[96:99], v[184:187], v[28:31], a[96:99]
    s_waitcnt vmcnt(11)
    buffer_load_dwordx2 v[56:57], v10, s[72:75], s36 offen offset:0
    v_mfma_f32_16x16x32_bf16 a[144:147], v[188:191], v[28:31], a[144:147]
    v_add_f32 v7, v7, v17
    v_mfma_f32_16x16x32_bf16 a[144:147], v[172:175], v[24:27], a[144:147]
    s_waitcnt lgkmcnt(2)
    v_exp_f32 v19, v75
    v_mfma_f32_16x16x32_bf16 a[4:7], v[160:163], v[32:35], a[4:7]
    ds_read_b128 v[24:27], v1 offset:3072
    v_cvt_pk_bf16_f32 v72, v16, v17
    v_mfma_f32_16x16x32_bf16 a[4:7], v[176:179], v[36:39], a[4:7]
    buffer_load_dwordx2 v[58:59], v10, s[76:79], s36 offen offset:0
    v_mfma_f32_16x16x32_bf16 a[52:55], v[180:183], v[36:39], a[52:55]
    v_exp_f32 v16, v104
    v_mfma_f32_16x16x32_bf16 a[52:55], v[164:167], v[32:35], a[52:55]
    v_add_f32 v7, v7, v18
    v_add_f32 v7, v7, v19
    v_mfma_f32_16x16x32_bf16 a[100:103], v[168:171], v[32:35], a[100:103]
    ds_read_b128 v[28:31], v1 offset:15360
    v_mfma_f32_16x16x32_bf16 a[100:103], v[184:187], v[36:39], a[100:103]
    s_waitcnt vmcnt(12)
    buffer_load_dwordx4 v[224:227], v9, s[64:67], s33 offen offset:0 nt
    v_mfma_f32_16x16x32_bf16 a[148:151], v[188:191], v[36:39], a[148:151]
    v_exp_f32 v17, v105
    v_mfma_f32_16x16x32_bf16 a[148:151], v[172:175], v[32:35], a[148:151]
    s_waitcnt lgkmcnt(2)
    v_cvt_pk_bf16_f32 v73, v18, v19
    v_mfma_f32_16x16x32_bf16 a[8:11], v[160:163], v[40:43], a[8:11]
    ds_read_b128 v[32:35], v1 offset:4096
    v_mfma_f32_16x16x32_bf16 a[8:11], v[176:179], v[44:47], a[8:11]
    s_waitcnt vmcnt(12)
    buffer_load_dwordx4 v[228:231], v9, s[64:67], s33 offen offset:1536 nt
    v_mfma_f32_16x16x32_bf16 a[56:59], v[180:183], v[44:47], a[56:59]
    v_exp_f32 v18, v106
    v_mfma_f32_16x16x32_bf16 a[56:59], v[164:167], v[40:43], a[56:59]
    v_add_f32 v7, v7, v16
    v_add_f32 v7, v7, v17
    v_mfma_f32_16x16x32_bf16 a[104:107], v[168:171], v[40:43], a[104:107]
    s_waitcnt vmcnt(17)
    ds_read_b128 v[36:39], v1 offset:16384
    v_lshlrev_b32 v48, 16, v60
    v_mfma_f32_16x16x32_bf16 a[104:107], v[184:187], v[44:47], a[104:107]
    buffer_load_dwordx4 v[232:235], v9, s[64:67], s34 offen offset:0 nt
    v_mfma_f32_16x16x32_bf16 a[152:155], v[188:191], v[44:47], a[152:155]
    v_exp_f32 v19, v107
    v_mfma_f32_16x16x32_bf16 a[152:155], v[172:175], v[40:43], a[152:155]
    s_waitcnt lgkmcnt(2)
    v_cvt_pk_bf16_f32 v74, v16, v17
    v_and_b32 v49, s97, v60
    v_mfma_f32_16x16x32_bf16 a[12:15], v[160:163], v[24:27], a[12:15]
    ds_read_b128 v[40:43], v1 offset:5120
    v_lshlrev_b32 v50, 16, v62
    v_mfma_f32_16x16x32_bf16 a[12:15], v[176:179], v[28:31], a[12:15]
    s_waitcnt vmcnt(13)
    buffer_load_dwordx4 v[236:239], v9, s[64:67], s34 offen offset:1536 nt
    v_mfma_f32_16x16x32_bf16 a[60:63], v[180:183], v[28:31], a[60:63]
    v_exp_f32 v16, v76
    v_mfma_f32_16x16x32_bf16 a[60:63], v[164:167], v[24:27], a[60:63]
    v_add_f32 v7, v7, v18
    v_add_f32 v7, v7, v19
    v_mfma_f32_16x16x32_bf16 a[108:111], v[168:171], v[24:27], a[108:111]
    ds_read_b128 v[44:47], v1 offset:17408
    v_and_b32 v51, s97, v62
    v_mfma_f32_16x16x32_bf16 a[108:111], v[184:187], v[28:31], a[108:111]
    v_exp_f32 v17, v77
    v_mfma_f32_16x16x32_bf16 a[156:159], v[188:191], v[28:31], a[156:159]
    s_add_u32 s29, s28, 49152
    v_cvt_pk_bf16_f32 v75, v18, v19
    v_mul_f32_e64 v50, -v50, v48
    v_mfma_f32_16x16x32_bf16 a[156:159], v[172:175], v[24:27], a[156:159]
    s_waitcnt lgkmcnt(2)
    v_exp_f32 v18, v78
    v_mfma_f32_16x16x32_bf16 a[16:19], v[160:163], v[32:35], a[16:19]
    s_mov_b32 m0, s56
    ds_read_b128 v[24:27], v1 offset:6144
    v_add_f32 v8, v8, v16
    v_mfma_f32_16x16x32_bf16 a[16:19], v[176:179], v[36:39], a[16:19]
    s_sub_u32 s3, s29, 147456
    s_waitcnt vmcnt(13)
    buffer_load_dwordx4 v4, s[4:7], s27 offen offset:0 sc1 lds
    v_mfma_f32_16x16x32_bf16 a[64:67], v[180:183], v[36:39], a[64:67]
    s_min_u32 s29, s29, s3
    v_add_f32 v8, v8, v17
    v_mul_f32_e64 v51, -v51, v49
    v_mfma_f32_16x16x32_bf16 a[64:67], v[164:167], v[32:35], a[64:67]
    v_exp_f32 v19, v79
    v_mfma_f32_16x16x32_bf16 a[112:115], v[168:171], v[32:35], a[112:115]
    ds_read_b128 v[28:31], v1 offset:18432
    v_cvt_pk_bf16_f32 v76, v16, v17
    v_mfma_f32_16x16x32_bf16 a[112:115], v[184:187], v[36:39], a[112:115]
    s_waitcnt vmcnt(13)
    buffer_load_dwordx4 v4, s[4:7], s27 offen offset:1024 sc1 lds
    v_mfma_f32_16x16x32_bf16 a[160:163], v[188:191], v[36:39], a[160:163]
    s_sub_u32 s3, s29, s28
    v_exp_f32 v16, v108
    v_mfma_f32_16x16x32_bf16 a[160:163], v[172:175], v[32:35], a[160:163]
    s_waitcnt lgkmcnt(2)
    v_add_f32 v8, v8, v18
    v_add_f32 v8, v8, v19
    v_mfma_f32_16x16x32_bf16 a[20:23], v[160:163], v[40:43], a[20:23]
    ds_read_b128 v[32:35], v1 offset:7168
    v_cvt_f32_i32 v240, v240
    v_mfma_f32_16x16x32_bf16 a[20:23], v[176:179], v[44:47], a[20:23]
    buffer_load_dword v52, v20, s[20:23], s44 offen sc1
    v_mfma_f32_16x16x32_bf16 a[68:71], v[180:183], v[44:47], a[68:71]
    v_exp_f32 v17, v109
    v_mfma_f32_16x16x32_bf16 a[68:71], v[164:167], v[40:43], a[68:71]
    v_cvt_pk_bf16_f32 v77, v18, v19
    v_cvt_f32_i32 v244, v244
    v_mfma_f32_16x16x32_bf16 a[116:119], v[168:171], v[40:43], a[116:119]
    s_mov_b32 s28, s29
    ds_read_b128 v[36:39], v1 offset:19456
    v_fma_f32 v240, v240, v48, v50
    v_mfma_f32_16x16x32_bf16 a[116:119], v[184:187], v[44:47], a[116:119]
    s_waitcnt vmcnt(14)
    buffer_load_dwordx4 v4, s[4:7], s27 offen offset:2048 sc1 lds
    v_mfma_f32_16x16x32_bf16 a[164:167], v[188:191], v[44:47], a[164:167]
    s_add_u32 s27, s27, 24576
    v_exp_f32 v18, v110
    v_mfma_f32_16x16x32_bf16 a[164:167], v[172:175], v[40:43], a[164:167]
    s_waitcnt lgkmcnt(2)
    v_add_f32 v8, v8, v16
    v_add_f32 v8, v8, v17
    v_fma_f32 v244, v244, v49, v51
    v_mfma_f32_16x16x32_bf16 a[24:27], v[160:163], v[24:27], a[24:27]
    s_sub_u32 s58, s27, 196608
    ds_read_b128 v[40:43], v1 offset:8192
    v_cvt_f32_i32 v241, v241
    v_mfma_f32_16x16x32_bf16 a[24:27], v[176:179], v[28:31], a[24:27]
    v_exp_f32 v19, v111
    v_cvt_pk_bf16_f32 v78, v16, v17
    v_mfma_f32_16x16x32_bf16 a[72:75], v[180:183], v[28:31], a[72:75]
    s_min_u32 s27, s27, s58
    v_add_f32 v8, v8, v18
    v_add_f32 v8, v8, v19
    v_mfma_f32_16x16x32_bf16 a[72:75], v[164:167], v[24:27], a[72:75]
    v_cvt_f32_i32 v245, v245
    v_cvt_pk_bf16_f32 v79, v18, v19
    v_mfma_f32_16x16x32_bf16 a[120:123], v[168:171], v[24:27], a[120:123]
    s_add_u32 s56, s56, 12288
    ds_read_b128 v[44:47], v1 offset:20480
    v_fma_f32 v241, v241, v48, v50
    v_mfma_f32_16x16x32_bf16 a[120:123], v[184:187], v[28:31], a[120:123]
    v_exp_f32 v16, v80
    v_mfma_f32_16x16x32_bf16 a[168:171], v[188:191], v[28:31], a[168:171]
    s_mov_b32 m0, s56
    v_exp_f32 v17, v81
    v_mfma_f32_16x16x32_bf16 a[168:171], v[172:175], v[24:27], a[168:171]
    s_waitcnt lgkmcnt(2)
    v_fma_f32 v245, v245, v49, v51
    v_exp_f32 v18, v82
    v_mfma_f32_16x16x32_bf16 a[28:31], v[160:163], v[32:35], a[28:31]
    ds_read_b128 v[24:27], v1 offset:9216
    v_cvt_f32_i32 v242, v242
    v_mfma_f32_16x16x32_bf16 a[28:31], v[176:179], v[36:39], a[28:31]
    v_add_f32 v5, v5, v16
    v_cvt_f32_i32 v246, v246
    v_mfma_f32_16x16x32_bf16 a[76:79], v[180:183], v[36:39], a[76:79]
    v_add_f32 v5, v5, v17
    v_fma_f32 v242, v242, v48, v50
    v_mfma_f32_16x16x32_bf16 a[76:79], v[164:167], v[32:35], a[76:79]
    s_waitcnt vmcnt(14)
    buffer_load_dwordx4 v4, s[4:7], s27 offen offset:0 sc1 lds
    v_mfma_f32_16x16x32_bf16 a[124:127], v[168:171], v[32:35], a[124:127]
    ds_read_b128 v[28:31], v1 offset:21504
    v_fma_f32 v246, v246, v49, v51
    v_mfma_f32_16x16x32_bf16 a[124:127], v[184:187], v[36:39], a[124:127]
    v_exp_f32 v19, v83
    v_cvt_pk_bf16_f32 v80, v16, v17
    v_mfma_f32_16x16x32_bf16 a[172:175], v[188:191], v[36:39], a[172:175]
    v_exp_f32 v16, v112
    v_mfma_f32_16x16x32_bf16 a[172:175], v[172:175], v[32:35], a[172:175]
    s_waitcnt lgkmcnt(2)
    s_waitcnt vmcnt(14)
    buffer_load_dwordx4 v4, s[4:7], s27 offen offset:1024 sc1 lds
    v_add_f32 v5, v5, v18
    v_mfma_f32_16x16x32_bf16 a[32:35], v[160:163], v[40:43], a[32:35]
    ds_read_b128 v[32:35], v1 offset:10240
    v_lshlrev_b32 v48, 16, v61
    v_mfma_f32_16x16x32_bf16 a[32:35], v[176:179], v[44:47], a[32:35]
    v_add_f32 v5, v5, v19
    v_exp_f32 v17, v113
    v_mfma_f32_16x16x32_bf16 a[80:83], v[180:183], v[44:47], a[80:83]
    v_and_b32 v49, s97, v61
    v_cvt_pk_bf16_f32 v81, v18, v19
    v_mfma_f32_16x16x32_bf16 a[80:83], v[164:167], v[40:43], a[80:83]
    s_waitcnt vmcnt(14)
    buffer_load_dwordx4 v4, s[4:7], s27 offen offset:2048 sc1 lds
    v_lshlrev_b32 v50, 16, v63
    v_mfma_f32_16x16x32_bf16 a[128:131], v[168:171], v[40:43], a[128:131]
    ds_read_b128 v[36:39], v1 offset:22528
    v_and_b32 v51, s97, v63
    v_mfma_f32_16x16x32_bf16 a[128:131], v[184:187], v[44:47], a[128:131]
    v_exp_f32 v18, v114
    v_add_f32 v5, v5, v16
    v_mfma_f32_16x16x32_bf16 a[176:179], v[188:191], v[44:47], a[176:179]
    v_add_u32 v2, s3, v2
    v_add_u32 v3, s3, v3
    v_mfma_f32_16x16x32_bf16 a[176:179], v[172:175], v[40:43], a[176:179]
    s_waitcnt lgkmcnt(2)
    v_add_f32 v5, v5, v17
    v_exp_f32 v19, v115
    v_mfma_f32_16x16x32_bf16 a[36:39], v[160:163], v[24:27], a[36:39]
    ds_read_b128 v[40:43], v1 offset:11264
    v_mul_f32_e64 v50, -v50, v48
    v_mfma_f32_16x16x32_bf16 a[36:39], v[176:179], v[28:31], a[36:39]
    v_cvt_pk_bf16_f32 v82, v16, v17
    v_mul_f32_e64 v51, -v51, v49
    v_mfma_f32_16x16x32_bf16 a[84:87], v[180:183], v[28:31], a[84:87]
    v_exp_f32 v16, v84
    v_mfma_f32_16x16x32_bf16 a[84:87], v[164:167], v[24:27], a[84:87]
    v_cvt_f32_i32 v248, v248
    v_add_f32 v5, v5, v18
    v_cvt_f32_i32 v252, v252
    v_mfma_f32_16x16x32_bf16 a[132:135], v[168:171], v[24:27], a[132:135]
    s_mov_b32 s27, 208896
    ds_read_b128 v[44:47], v1 offset:23552
    v_add_f32 v5, v5, v19
    v_mfma_f32_16x16x32_bf16 a[132:135], v[184:187], v[28:31], a[132:135]
    s_waitcnt lgkmcnt(2)
    v_exp_f32 v17, v85
    v_fma_f32 v248, v248, v48, v50
    v_mfma_f32_16x16x32_bf16 a[180:183], v[188:191], v[28:31], a[180:183]
    s_waitcnt vmcnt(19)
    v_cvt_pk_bf16_f32 v83, v18, v19
    v_fma_f32 v252, v252, v49, v51
    v_mfma_f32_16x16x32_bf16 a[180:183], v[172:175], v[24:27], a[180:183]
    s_barrier
    v_mfma_f32_16x16x32_bf16 a[40:43], v[160:163], v[32:35], a[40:43]
    s_add_u32 s56, s56, 36864
    ds_read_b128 v[24:27], v2 offset:0
    v_cvt_f32_i32 v249, v249
    v_mfma_f32_16x16x32_bf16 a[40:43], v[176:179], v[36:39], a[40:43]
    v_exp_f32 v18, v86
    v_add_f32 v6, v6, v16
    v_mfma_f32_16x16x32_bf16 a[88:91], v[180:183], v[36:39], a[88:91]
    s_sub_u32 s58, s56, 147456
    v_add_f32 v6, v6, v17
    v_cvt_f32_i32 v253, v253
    v_mfma_f32_16x16x32_bf16 a[88:91], v[164:167], v[32:35], a[88:91]
    s_min_u32 s56, s56, s58
    v_exp_f32 v19, v87
    v_mfma_f32_16x16x32_bf16 a[136:139], v[168:171], v[32:35], a[136:139]
    ds_read_b128 v[28:31], v3 offset:0
    v_fma_f32 v249, v249, v48, v50
    v_mfma_f32_16x16x32_bf16 a[136:139], v[184:187], v[36:39], a[136:139]
    v_cvt_pk_bf16_f32 v84, v16, v17
    v_exp_f32 v16, v116
    v_mfma_f32_16x16x32_bf16 a[184:187], v[188:191], v[36:39], a[184:187]
    v_fma_f32 v253, v253, v49, v51
    v_add_f32 v6, v6, v18
    v_mfma_f32_16x16x32_bf16 a[184:187], v[172:175], v[32:35], a[184:187]
    s_waitcnt lgkmcnt(2)
    v_cvt_f32_i32 v250, v250
    v_add_f32 v6, v6, v19
    v_mfma_f32_16x16x32_bf16 a[44:47], v[160:163], v[40:43], a[44:47]
    ds_read_b128 v[32:35], v2 offset:6144
    v_cvt_f32_i32 v254, v254
    v_mfma_f32_16x16x32_bf16 a[44:47], v[176:179], v[44:47], a[44:47]
    v_exp_f32 v17, v117
    v_mfma_f32_16x16x32_bf16 a[92:95], v[180:183], v[44:47], a[92:95]
    v_cvt_pk_bf16_f32 v85, v18, v19
    v_fma_f32 v250, v250, v48, v50
    v_mfma_f32_16x16x32_bf16 a[92:95], v[164:167], v[40:43], a[92:95]
    v_exp_f32 v18, v118
    v_mfma_f32_16x16x32_bf16 a[140:143], v[168:171], v[40:43], a[140:143]
    s_nop 0
    ds_read_b128 v[36:39], v3 offset:6144
    v_fma_f32 v254, v254, v49, v51
    v_mfma_f32_16x16x32_bf16 a[140:143], v[184:187], v[44:47], a[140:143]
    v_add_f32 v6, v6, v16
    v_add_f32 v6, v6, v17
    v_mfma_f32_16x16x32_bf16 a[188:191], v[188:191], v[44:47], a[188:191]
    s_waitcnt lgkmcnt(2)
    v_exp_f32 v19, v119
    v_cvt_pk_bf16_f32 v146, v240, v244
    v_cvt_pk_bf16_f32 v150, v241, v245
    v_cvt_pk_bf16_f32 v86, v16, v17
    v_cvt_pk_bf16_f32 v147, v248, v252
    v_add_f32 v6, v6, v18
    v_cvt_pk_bf16_f32 v151, v249, v253
    v_add_f32 v6, v6, v19
    v_cvt_pk_bf16_f32 v154, v242, v246
    v_cvt_pk_bf16_f32 v87, v18, v19
    v_cvt_pk_bf16_f32 v155, v250, v254
    v_mfma_f32_16x16x32_bf16 a[188:191], v[172:175], v[40:43], a[188:191]
    s_branch L_join
.p2align 6
L_loop:
    v_mfma_f32_16x16x32_bf16 v[160:163], v[24:27], a[192:195], v[128:131]
    s_mov_b32 m0, s56
    ds_read_b128 v[40:43], v2 offset:128
    v_cvt_f32_i32 v247, v247
    v_mfma_f32_16x16x32_bf16 v[160:163], v[28:31], a[196:199], v[160:163]
    buffer_load_dwordx4 v4, s[4:7], s27 offen offset:0 sc1 lds
    v_mfma_f32_16x16x32_bf16 v[164:167], v[28:31], a[220:223], v[132:135]
    v_exp_f32 v16, v88
    v_mfma_f32_16x16x32_bf16 v[164:167], v[24:27], a[216:219], v[164:167]
    v_exp_f32 v17, v89
    v_mfma_f32_16x16x32_bf16 v[168:171], v[24:27], a[240:243], v[136:139]
    ds_read_b128 v[44:47], v3 offset:128
    v_fma_f32 v246, v246, v48, v50
    v_mfma_f32_16x16x32_bf16 v[168:171], v[28:31], a[244:247], v[168:171]
    v_exp_f32 v18, v90
    v_mfma_f32_16x16x32_bf16 v[172:175], v[28:31], v[204:207], v[140:143]
    v_fma_f32 v247, v247, v49, v51
    v_add_f32 v7, v7, v16
    v_mfma_f32_16x16x32_bf16 v[172:175], v[24:27], v[200:203], v[172:175]
    s_waitcnt lgkmcnt(2)
    v_add_f32 v7, v7, v17
    v_cvt_pk_bf16_f32 v231, v246, v247
    v_mfma_f32_16x16x32_bf16 v[96:99], v[32:35], a[192:195], v[128:131]
    ds_read_b128 v[24:27], v2 offset:6272
    v_cvt_f32_i32 v250, v250
    v_mfma_f32_16x16x32_bf16 v[96:99], v[36:39], a[196:199], v[96:99]
    buffer_load_dwordx4 v4, s[4:7], s27 offen offset:1024 sc1 lds
    v_mfma_f32_16x16x32_bf16 v[100:103], v[36:39], a[220:223], v[132:135]
    v_exp_f32 v19, v91
    v_mfma_f32_16x16x32_bf16 v[100:103], v[32:35], a[216:219], v[100:103]
    v_cvt_pk_bf16_f32 v88, v16, v17
    v_cvt_f32_i32 v251, v251
    v_mfma_f32_16x16x32_bf16 v[104:107], v[32:35], a[240:243], v[136:139]
    ds_read_b128 v[28:31], v3 offset:6272
    v_fma_f32 v250, v250, v48, v50
    v_mfma_f32_16x16x32_bf16 v[104:107], v[36:39], a[244:247], v[104:107]
    v_exp_f32 v16, v120
    v_mfma_f32_16x16x32_bf16 v[108:111], v[36:39], v[204:207], v[140:143]
    v_add_f32 v7, v7, v18
    v_add_f32 v7, v7, v19
    v_mfma_f32_16x16x32_bf16 v[108:111], v[32:35], v[200:203], v[108:111]
    s_waitcnt lgkmcnt(2)
    v_exp_f32 v17, v121
    v_mfma_f32_16x16x32_bf16 v[160:163], v[40:43], a[200:203], v[160:163]
    ds_read_b128 v[32:35], v2 offset:256
    v_cvt_pk_bf16_f32 v89, v18, v19
    v_mfma_f32_16x16x32_bf16 v[160:163], v[44:47], a[204:207], v[160:163]
    v_exp_f32 v18, v122
    v_mfma_f32_16x16x32_bf16 v[164:167], v[44:47], a[228:231], v[164:167]
    v_fma_f32 v251, v251, v49, v51
    v_add_f32 v7, v7, v16
    v_mfma_f32_16x16x32_bf16 v[164:167], v[40:43], a[224:227], v[164:167]
    buffer_load_dwordx4 v4, s[4:7], s27 offen offset:2048 sc1 lds
    v_mfma_f32_16x16x32_bf16 v[168:171], v[40:43], a[248:251], v[168:171]
    ds_read_b128 v[36:39], v3 offset:256
    v_cvt_pk_bf16_f32 v235, v250, v251
    v_mfma_f32_16x16x32_bf16 v[168:171], v[44:47], a[252:255], v[168:171]
    v_add_f32 v7, v7, v17
    v_cvt_f32_i32 v254, v254
    v_mfma_f32_16x16x32_bf16 v[172:175], v[44:47], v[212:215], v[172:175]
    v_exp_f32 v19, v123
    v_mfma_f32_16x16x32_bf16 v[172:175], v[40:43], v[208:211], v[172:175]
    s_waitcnt lgkmcnt(2)
    v_cvt_pk_bf16_f32 v90, v16, v17
    v_cvt_f32_i32 v255, v255
    v_mfma_f32_16x16x32_bf16 v[96:99], v[24:27], a[200:203], v[96:99]
    ds_read_b128 v[40:43], v2 offset:6400
    v_fma_f32 v254, v254, v48, v50
    v_mfma_f32_16x16x32_bf16 v[96:99], v[28:31], a[204:207], v[96:99]
    s_add_u32 s27, s27, 24576
    v_exp_f32 v16, v92
    v_mfma_f32_16x16x32_bf16 v[100:103], v[28:31], a[228:231], v[100:103]
    v_add_f32 v7, v7, v18
    v_add_f32 v7, v7, v19
    v_mfma_f32_16x16x32_bf16 v[100:103], v[24:27], a[224:227], v[100:103]
    v_exp_f32 v17, v93
    v_mfma_f32_16x16x32_bf16 v[104:107], v[24:27], a[248:251], v[104:107]
    ds_read_b128 v[44:47], v3 offset:6400
    v_fma_f32 v255, v255, v49, v51
    v_mfma_f32_16x16x32_bf16 v[104:107], v[28:31], a[252:255], v[104:107]
    v_cvt_pk_bf16_f32 v91, v18, v19
    v_cvt_pk_bf16_f32 v239, v254, v255
    v_mfma_f32_16x16x32_bf16 v[108:111], v[28:31], v[212:215], v[108:111]
    s_add_u32 s29, s30, 49152
    v_exp_f32 v18, v94
    v_mfma_f32_16x16x32_bf16 v[108:111], v[24:27], v[208:211], v[108:111]
    s_waitcnt lgkmcnt(2)
    v_add_f32 v8, v8, v16
    v_add_f32 v8, v8, v17
    v_mfma_f32_16x16x32_bf16 v[160:163], v[32:35], a[208:211], v[160:163]
    s_waitcnt vmcnt(11)
    ds_read_b128 v[24:27], v2 offset:12288
    v_lshlrev_b32 v48, 16, v56
    v_mfma_f32_16x16x32_bf16 v[160:163], v[36:39], a[212:215], v[160:163]
    s_sub_u32 s3, s29, 147456
    buffer_load_dwordx2 v[60:61], off, s[80:83], s37 offset:8
    v_mfma_f32_16x16x32_bf16 v[164:167], v[36:39], a[236:239], v[164:167]
    s_add_u32 s56, s56, 12288
    v_exp_f32 v19, v95
    v_mfma_f32_16x16x32_bf16 v[164:167], v[32:35], a[232:235], v[164:167]
    s_min_u32 s29, s29, s3
    v_cvt_pk_bf16_f32 v92, v16, v17
    v_and_b32 v49, s97, v56
    v_mfma_f32_16x16x32_bf16 v[168:171], v[32:35], v[192:195], v[168:171]
    s_mov_b32 m0, s56
    ds_read_b128 v[28:31], v3 offset:12288
    v_mfma_f32_16x16x32_bf16 v[168:171], v[36:39], v[196:199], v[168:171]
    buffer_load_dwordx2 v[62:63], off, s[84:87], s37 offset:8
    v_mfma_f32_16x16x32_bf16 v[172:175], v[36:39], v[220:223], v[172:175]
    v_exp_f32 v16, v124
    v_mfma_f32_16x16x32_bf16 v[172:175], v[32:35], v[216:219], v[172:175]
    s_waitcnt lgkmcnt(2)
    v_add_f32 v8, v8, v18
    v_add_f32 v8, v8, v19
    v_mfma_f32_16x16x32_bf16 v[96:99], v[40:43], a[208:211], v[96:99]
    ds_read_b128 v[32:35], v2 offset:18432
    v_lshlrev_b32 v50, 16, v58
    v_mfma_f32_16x16x32_bf16 v[96:99], v[44:47], a[212:215], v[96:99]
    s_sub_u32 s3, s29, s30
    v_exp_f32 v17, v125
    v_mfma_f32_16x16x32_bf16 v[100:103], v[44:47], a[236:239], v[100:103]
    v_cvt_pk_bf16_f32 v93, v18, v19
    v_mfma_f32_16x16x32_bf16 v[100:103], v[40:43], a[232:235], v[100:103]
    buffer_load_dwordx4 v4, s[4:7], s27 offen offset:0 sc1 lds
    v_mfma_f32_16x16x32_bf16 v[104:107], v[40:43], v[192:195], v[104:107]
    ds_read_b128 v[36:39], v3 offset:18432
    v_mfma_f32_16x16x32_bf16 v[104:107], v[44:47], v[196:199], v[104:107]
    v_exp_f32 v18, v126
    v_mfma_f32_16x16x32_bf16 v[108:111], v[44:47], v[220:223], v[108:111]
    v_add_f32 v8, v8, v16
    v_add_f32 v8, v8, v17
    v_mfma_f32_16x16x32_bf16 v[108:111], v[40:43], v[216:219], v[108:111]
    s_waitcnt lgkmcnt(2)
    buffer_load_dwordx3 v[240:242], v12, s[68:71], s16 offen offset:0 nt
    v_mfma_f32_16x16x32_bf16 v[176:179], v[24:27], a[192:195], v[128:131]
    ds_read_b128 v[40:43], v2 offset:12416
    v_and_b32 v51, s97, v58
    v_mfma_f32_16x16x32_bf16 v[176:179], v[28:31], a[196:199], v[176:179]
    v_exp_f32 v19, v127
    v_cvt_pk_bf16_f32 v94, v16, v17
    v_mfma_f32_16x16x32_bf16 v[180:183], v[28:31], a[220:223], v[132:135]
    s_mov_b32 s30, s29
    v_add_f32 v8, v8, v18
    v_add_f32 v8, v8, v19
    v_mfma_f32_16x16x32_bf16 v[180:183], v[24:27], a[216:219], v[180:183]
    buffer_load_dwordx4 v4, s[4:7], s27 offen offset:1024 sc1 lds
    v_mfma_f32_16x16x32_bf16 v[184:187], v[24:27], a[240:243], v[136:139]
    ds_read_b128 v[44:47], v3 offset:12416
    v_cvt_pk_bf16_f32 v95, v18, v19
    v_mfma_f32_16x16x32_bf16 v[184:187], v[28:31], a[244:247], v[184:187]
    v_exp_f32 v16, v160
    v_mfma_f32_16x16x32_bf16 v[188:191], v[28:31], v[204:207], v[140:143]
    v_exp_f32 v17, v161
    v_mfma_f32_16x16x32_bf16 v[188:191], v[24:27], v[200:203], v[188:191]
    s_waitcnt lgkmcnt(2)
    buffer_load_dwordx3 v[244:246], v12, s[68:71], s16 offen offset:768 nt
    v_mfma_f32_16x16x32_bf16 v[112:115], v[32:35], a[192:195], v[128:131]
    ds_read_b128 v[24:27], v2 offset:18560
    v_mul_f32_e64 v50, -v50, v48
    v_mfma_f32_16x16x32_bf16 v[112:115], v[36:39], a[196:199], v[112:115]
    v_exp_f32 v18, v162
    v_mfma_f32_16x16x32_bf16 v[116:119], v[36:39], a[220:223], v[132:135]
    v_add_f32 v5, v5, v16
    v_add_f32 v5, v5, v17
    v_mfma_f32_16x16x32_bf16 v[116:119], v[32:35], a[216:219], v[116:119]
    v_exp_f32 v19, v163
    v_mfma_f32_16x16x32_bf16 v[120:123], v[32:35], a[240:243], v[136:139]
    ds_read_b128 v[28:31], v3 offset:18560
    v_cvt_pk_bf16_f32 v160, v16, v17
    v_mfma_f32_16x16x32_bf16 v[120:123], v[36:39], a[244:247], v[120:123]
    buffer_load_dwordx3 v[248:250], v12, s[68:71], s16 offen offset:1536 nt
    v_mfma_f32_16x16x32_bf16 v[124:127], v[36:39], v[204:207], v[140:143]
    v_exp_f32 v16, v96
    v_mfma_f32_16x16x32_bf16 v[124:127], v[32:35], v[200:203], v[124:127]
    s_waitcnt lgkmcnt(2)
    v_add_f32 v5, v5, v18
    v_add_f32 v5, v5, v19
    v_mfma_f32_16x16x32_bf16 v[176:179], v[40:43], a[200:203], v[176:179]
    ds_read_b128 v[32:35], v2 offset:12544
    v_mul_f32_e64 v51, -v51, v49
    v_mfma_f32_16x16x32_bf16 v[176:179], v[44:47], a[204:207], v[176:179]
    buffer_load_dwordx4 v4, s[4:7], s27 offen offset:2048 sc1 lds
    v_mfma_f32_16x16x32_bf16 v[180:183], v[44:47], a[228:231], v[180:183]
    v_exp_f32 v17, v97
    v_mfma_f32_16x16x32_bf16 v[180:183], v[40:43], a[224:227], v[180:183]
L_iw3:
L_pg3:
    s_cbranch_execz L_pg7
    v_cvt_pk_bf16_f32 v161, v18, v19
    v_add_u32 v1, s3, v1
    v_mfma_f32_16x16x32_bf16 v[184:187], v[40:43], a[248:251], v[184:187]
    ds_read_b128 v[36:39], v3 offset:12544
    v_cvt_f32_i32 v144, v144
    v_mfma_f32_16x16x32_bf16 v[184:187], v[44:47], a[252:255], v[184:187]
    buffer_load_dwordx3 v[252:254], v12, s[68:71], s16 offen offset:2304 nt
    v_mfma_f32_16x16x32_bf16 v[188:191], v[44:47], v[212:215], v[188:191]
    v_exp_f32 v18, v98
    v_mfma_f32_16x16x32_bf16 v[188:191], v[40:43], v[208:211], v[188:191]
    s_waitcnt lgkmcnt(2)
    v_add_f32 v5, v5, v16
    v_add_f32 v5, v5, v17
    v_mfma_f32_16x16x32_bf16 v[112:115], v[24:27], a[200:203], v[112:115]
    ds_read_b128 v[40:43], v2 offset:18688
    v_cvt_f32_i32 v148, v148
    v_mfma_f32_16x16x32_bf16 v[112:115], v[28:31], a[204:207], v[112:115]
    v_exp_f32 v19, v99
    v_cvt_pk_bf16_f32 v162, v16, v17
    v_mfma_f32_16x16x32_bf16 v[116:119], v[28:31], a[228:231], v[116:119]
    v_exp_f32 v16, v164
    v_mfma_f32_16x16x32_bf16 v[116:119], v[24:27], a[224:227], v[116:119]
    s_add_u32 s27, s27, 24576
    v_add_f32 v5, v5, v18
    v_add_f32 v5, v5, v19
    v_mfma_f32_16x16x32_bf16 v[120:123], v[24:27], a[248:251], v[120:123]
    s_add_u32 s56, s56, 36864
    ds_read_b128 v[44:47], v3 offset:18688
    v_fma_f32 v144, v144, v48, v50
    v_mfma_f32_16x16x32_bf16 v[120:123], v[28:31], a[252:255], v[120:123]
    s_waitcnt lgkmcnt(2)
    v_exp_f32 v17, v165
    v_mfma_f32_16x16x32_bf16 v[124:127], v[28:31], v[212:215], v[124:127]
    s_waitcnt vmcnt(12)
    v_cvt_pk_bf16_f32 v163, v18, v19
    s_sub_u32 s58, s56, 147456
    v_mfma_f32_16x16x32_bf16 v[124:127], v[24:27], v[208:211], v[124:127]
    s_barrier
    v_mfma_f32_16x16x32_bf16 v[176:179], v[32:35], a[208:211], v[176:179]
    s_min_u32 s56, s56, s58
    ds_read_b128 v[24:27], v1 offset:0
    v_mfma_f32_16x16x32_bf16 v[176:179], v[36:39], a[212:215], v[176:179]
    v_exp_f32 v18, v166
    v_mfma_f32_16x16x32_bf16 v[180:183], v[36:39], a[236:239], v[180:183]
    v_add_f32 v6, v6, v16
    v_add_f32 v6, v6, v17
    v_mfma_f32_16x16x32_bf16 v[180:183], v[32:35], a[232:235], v[180:183]
    v_exp_f32 v19, v167
    v_mfma_f32_16x16x32_bf16 v[184:187], v[32:35], v[192:195], v[184:187]
    ds_read_b128 v[28:31], v1 offset:12288
    v_cvt_pk_bf16_f32 v164, v16, v17
    v_mfma_f32_16x16x32_bf16 v[184:187], v[36:39], v[196:199], v[184:187]
    v_exp_f32 v16, v100
    v_mfma_f32_16x16x32_bf16 v[188:191], v[36:39], v[220:223], v[188:191]
    v_add_f32 v6, v6, v18
    v_add_f32 v6, v6, v19
    v_mfma_f32_16x16x32_bf16 v[188:191], v[32:35], v[216:219], v[188:191]
    s_waitcnt lgkmcnt(2)
    v_exp_f32 v17, v101
    v_mfma_f32_16x16x32_bf16 v[112:115], v[40:43], a[208:211], v[112:115]
    ds_read_b128 v[32:35], v1 offset:1024
    v_cvt_pk_bf16_f32 v165, v18, v19
    v_mfma_f32_16x16x32_bf16 v[112:115], v[44:47], a[212:215], v[112:115]
    v_exp_f32 v18, v102
    v_mfma_f32_16x16x32_bf16 v[116:119], v[44:47], a[236:239], v[116:119]
    v_add_f32 v6, v6, v16
    v_add_f32 v6, v6, v17
    v_mfma_f32_16x16x32_bf16 v[116:119], v[40:43], a[232:235], v[116:119]
    v_exp_f32 v19, v103
    v_mfma_f32_16x16x32_bf16 v[120:123], v[40:43], v[192:195], v[120:123]
    ds_read_b128 v[36:39], v1 offset:13312
    v_cvt_pk_bf16_f32 v166, v16, v17
    v_mfma_f32_16x16x32_bf16 v[120:123], v[44:47], v[196:199], v[120:123]
    v_add_f32 v6, v6, v18
    v_fma_f32 v148, v148, v49, v51
    v_mfma_f32_16x16x32_bf16 v[124:127], v[44:47], v[220:223], v[124:127]
    v_add_f32 v6, v6, v19
    v_cvt_pk_bf16_f32 v167, v18, v19
    v_mfma_f32_16x16x32_bf16 v[124:127], v[40:43], v[216:219], v[124:127]
    s_waitcnt lgkmcnt(2)
    v_mfma_f32_16x16x32_bf16 a[0:3], v[64:67], v[24:27], a[0:3]
    ds_read_b128 v[40:43], v1 offset:2048
    v_cvt_f32_i32 v145, v145
    v_mfma_f32_16x16x32_bf16 a[0:3], v[80:83], v[28:31], a[0:3]
    buffer_store_dwordx4 v[224:227], v11, s[4:7], s33 offen offset:0 sc1
    v_mfma_f32_16x16x32_bf16 a[48:51], v[84:87], v[28:31], a[48:51]
    v_exp_f32 v16, v168
    v_mfma_f32_16x16x32_bf16 a[48:51], v[68:71], v[24:27], a[48:51]
    v_exp_f32 v17, v169
    v_mfma_f32_16x16x32_bf16 a[96:99], v[72:75], v[24:27], a[96:99]
    ds_read_b128 v[44:47], v1 offset:14336
    v_cvt_f32_i32 v149, v149
    v_mfma_f32_16x16x32_bf16 a[96:99], v[88:91], v[28:31], a[96:99]
    v_exp_f32 v18, v170
    v_mfma_f32_16x16x32_bf16 a[144:147], v[92:95], v[28:31], a[144:147]
    v_add_f32 v7, v7, v16
    v_add_f32 v7, v7, v17
    v_mfma_f32_16x16x32_bf16 a[144:147], v[76:79], v[24:27], a[144:147]
    s_waitcnt lgkmcnt(2)
    v_exp_f32 v19, v171
    v_mfma_f32_16x16x32_bf16 a[4:7], v[64:67], v[32:35], a[4:7]
    ds_read_b128 v[24:27], v1 offset:3072
    v_cvt_pk_bf16_f32 v168, v16, v17
    v_mfma_f32_16x16x32_bf16 a[4:7], v[80:83], v[36:39], a[4:7]
    buffer_store_dwordx4 v[228:231], v21, s[4:7], s33 offen offset:768 sc1
    v_mfma_f32_16x16x32_bf16 a[52:55], v[84:87], v[36:39], a[52:55]
    v_exp_f32 v16, v104
    v_mfma_f32_16x16x32_bf16 a[52:55], v[68:71], v[32:35], a[52:55]
    v_add_f32 v7, v7, v18
    v_fma_f32 v145, v145, v48, v50
    v_mfma_f32_16x16x32_bf16 a[100:103], v[72:75], v[32:35], a[100:103]
    ds_read_b128 v[28:31], v1 offset:15360
    v_add_f32 v7, v7, v19
    v_mfma_f32_16x16x32_bf16 a[100:103], v[88:91], v[36:39], a[100:103]
    v_exp_f32 v17, v105
    v_mfma_f32_16x16x32_bf16 a[148:151], v[92:95], v[36:39], a[148:151]
    v_cvt_pk_bf16_f32 v169, v18, v19
    v_fma_f32 v149, v149, v49, v51
    v_mfma_f32_16x16x32_bf16 a[148:151], v[76:79], v[32:35], a[148:151]
    s_waitcnt lgkmcnt(2)
    v_exp_f32 v18, v106
    v_mfma_f32_16x16x32_bf16 a[8:11], v[64:67], v[40:43], a[8:11]
    ds_read_b128 v[32:35], v1 offset:4096
    v_add_f32 v7, v7, v16
    v_mfma_f32_16x16x32_bf16 a[8:11], v[80:83], v[44:47], a[8:11]
    buffer_store_dwordx4 v[232:235], v22, s[4:7], s33 offen offset:1536 sc1
    v_mfma_f32_16x16x32_bf16 a[56:59], v[84:87], v[44:47], a[56:59]
    v_add_f32 v7, v7, v17
    v_cvt_f32_i32 v146, v146
    v_mfma_f32_16x16x32_bf16 a[56:59], v[68:71], v[40:43], a[56:59]
    v_exp_f32 v19, v107
    v_mfma_f32_16x16x32_bf16 a[104:107], v[72:75], v[40:43], a[104:107]
    ds_read_b128 v[36:39], v1 offset:16384
    v_cvt_pk_bf16_f32 v170, v16, v17
    v_mfma_f32_16x16x32_bf16 a[104:107], v[88:91], v[44:47], a[104:107]
    v_exp_f32 v16, v172
    v_mfma_f32_16x16x32_bf16 a[152:155], v[92:95], v[44:47], a[152:155]
    v_add_f32 v7, v7, v18
    v_cvt_f32_i32 v150, v150
    v_mfma_f32_16x16x32_bf16 a[152:155], v[76:79], v[40:43], a[152:155]
    s_waitcnt lgkmcnt(2)
    v_add_f32 v7, v7, v19
    v_fma_f32 v146, v146, v48, v50
    v_mfma_f32_16x16x32_bf16 a[12:15], v[64:67], v[24:27], a[12:15]
    ds_read_b128 v[40:43], v1 offset:5120
    v_mfma_f32_16x16x32_bf16 a[12:15], v[80:83], v[28:31], a[12:15]
    buffer_store_dwordx4 v[236:239], v23, s[4:7], s33 offen offset:2304 sc1
    v_mfma_f32_16x16x32_bf16 a[60:63], v[84:87], v[28:31], a[60:63]
    v_exp_f32 v17, v173
    v_mfma_f32_16x16x32_bf16 a[60:63], v[68:71], v[24:27], a[60:63]
    v_cvt_pk_bf16_f32 v171, v18, v19
    v_fma_f32 v150, v150, v49, v51
    v_mfma_f32_16x16x32_bf16 a[108:111], v[72:75], v[24:27], a[108:111]
    ds_read_b128 v[44:47], v1 offset:17408
    v_mfma_f32_16x16x32_bf16 a[108:111], v[88:91], v[28:31], a[108:111]
    v_exp_f32 v18, v174
    v_mfma_f32_16x16x32_bf16 a[156:159], v[92:95], v[28:31], a[156:159]
    s_add_u32 s29, s28, 49152
    v_add_f32 v8, v8, v16
    v_add_f32 v8, v8, v17
    v_mfma_f32_16x16x32_bf16 a[156:159], v[76:79], v[24:27], a[156:159]
    s_waitcnt lgkmcnt(2)
    v_exp_f32 v19, v175
    v_mfma_f32_16x16x32_bf16 a[16:19], v[64:67], v[32:35], a[16:19]
    s_sub_u32 s3, s29, 147456
    ds_read_b128 v[24:27], v1 offset:6144
    v_cvt_pk_bf16_f32 v172, v16, v17
    v_mfma_f32_16x16x32_bf16 a[16:19], v[80:83], v[36:39], a[16:19]
    s_mov_b32 m0, s26
    v_exp_f32 v16, v108
    v_mfma_f32_16x16x32_bf16 a[64:67], v[84:87], v[36:39], a[64:67]
    s_min_u32 s29, s29, s3
    v_add_f32 v8, v8, v18
    v_lshlrev_b32 v48, 16, v57
    v_mfma_f32_16x16x32_bf16 a[64:67], v[68:71], v[32:35], a[64:67]
    buffer_load_dwordx4 v4, s[4:7], s32 offen offset:0 sc1 lds
    v_mfma_f32_16x16x32_bf16 a[112:115], v[72:75], v[32:35], a[112:115]
    ds_read_b128 v[28:31], v1 offset:18432
    v_add_f32 v8, v8, v19
    v_mfma_f32_16x16x32_bf16 a[112:115], v[88:91], v[36:39], a[112:115]
    v_exp_f32 v17, v109
    v_mfma_f32_16x16x32_bf16 a[160:163], v[92:95], v[36:39], a[160:163]
    v_cvt_pk_bf16_f32 v173, v18, v19
    v_and_b32 v49, s97, v57
    v_mfma_f32_16x16x32_bf16 a[160:163], v[76:79], v[32:35], a[160:163]
    s_waitcnt lgkmcnt(2)
    buffer_load_dwordx4 v4, s[4:7], s32 offen offset:1024 sc1 lds
    v_mfma_f32_16x16x32_bf16 a[20:23], v[64:67], v[40:43], a[20:23]
    s_sub_u32 s3, s29, s28
    ds_read_b128 v[32:35], v1 offset:7168
    v_lshlrev_b32 v50, 16, v59
    v_mfma_f32_16x16x32_bf16 a[20:23], v[80:83], v[44:47], a[20:23]
    v_exp_f32 v18, v110
    v_mfma_f32_16x16x32_bf16 a[68:71], v[84:87], v[44:47], a[68:71]
    v_add_f32 v8, v8, v16
    v_add_f32 v8, v8, v17
    v_mfma_f32_16x16x32_bf16 a[68:71], v[68:71], v[40:43], a[68:71]
    buffer_load_dwordx4 v4, s[4:7], s32 offen offset:2048 sc1 lds
    v_mfma_f32_16x16x32_bf16 a[116:119], v[72:75], v[40:43], a[116:119]
    ds_read_b128 v[36:39], v1 offset:19456
    v_mfma_f32_16x16x32_bf16 a[116:119], v[88:91], v[44:47], a[116:119]
    v_exp_f32 v19, v111
    v_mfma_f32_16x16x32_bf16 a[164:167], v[92:95], v[44:47], a[164:167]
    s_mov_b32 s28, s29
    v_cvt_pk_bf16_f32 v174, v16, v17
    v_add_f32 v8, v8, v18
    v_mfma_f32_16x16x32_bf16 a[164:167], v[76:79], v[40:43], a[164:167]
    s_waitcnt lgkmcnt(2)
    v_add_f32 v8, v8, v19
    v_cvt_pk_bf16_f32 v175, v18, v19
    v_mfma_f32_16x16x32_bf16 a[24:27], v[64:67], v[24:27], a[24:27]
    s_add_u32 s32, s32, 24576
    ds_read_b128 v[40:43], v1 offset:8192
    v_and_b32 v51, s97, v59
    v_mfma_f32_16x16x32_bf16 a[24:27], v[80:83], v[28:31], a[24:27]
    v_exp_f32 v16, v176
    v_mfma_f32_16x16x32_bf16 a[72:75], v[84:87], v[28:31], a[72:75]
    s_add_u32 s26, s26, 12288
    v_exp_f32 v17, v177
    v_mfma_f32_16x16x32_bf16 a[72:75], v[68:71], v[24:27], a[72:75]
    v_exp_f32 v18, v178
    v_mfma_f32_16x16x32_bf16 a[120:123], v[72:75], v[24:27], a[120:123]
    s_mov_b32 m0, s26
    ds_read_b128 v[44:47], v1 offset:20480
    v_add_f32 v5, v5, v16
    v_mfma_f32_16x16x32_bf16 a[120:123], v[88:91], v[28:31], a[120:123]
    v_add_f32 v5, v5, v17
    v_mul_f32_e64 v50, -v50, v48
    v_mfma_f32_16x16x32_bf16 a[168:171], v[92:95], v[28:31], a[168:171]
    v_exp_f32 v19, v179
    v_mfma_f32_16x16x32_bf16 a[168:171], v[76:79], v[24:27], a[168:171]
    s_waitcnt lgkmcnt(2)
    v_cvt_pk_bf16_f32 v176, v16, v17
    v_mul_f32_e64 v51, -v51, v49
    v_mfma_f32_16x16x32_bf16 a[28:31], v[64:67], v[32:35], a[28:31]
    ds_read_b128 v[24:27], v1 offset:9216
    v_add_u32 v2, s3, v2
    v_mfma_f32_16x16x32_bf16 a[28:31], v[80:83], v[36:39], a[28:31]
    buffer_load_dwordx4 v4, s[4:7], s32 offen offset:0 sc1 lds
    v_mfma_f32_16x16x32_bf16 a[76:79], v[84:87], v[36:39], a[76:79]
    v_exp_f32 v16, v112
    v_mfma_f32_16x16x32_bf16 a[76:79], v[68:71], v[32:35], a[76:79]
    v_add_f32 v5, v5, v18
    v_add_f32 v5, v5, v19
    v_mfma_f32_16x16x32_bf16 a[124:127], v[72:75], v[32:35], a[124:127]
    ds_read_b128 v[28:31], v1 offset:21504
    v_cvt_f32_i32 v152, v152
    v_mfma_f32_16x16x32_bf16 a[124:127], v[88:91], v[36:39], a[124:127]
    buffer_load_dwordx4 v4, s[4:7], s32 offen offset:1024 sc1 lds
    v_mfma_f32_16x16x32_bf16 a[172:175], v[92:95], v[36:39], a[172:175]
    v_exp_f32 v17, v113
    v_mfma_f32_16x16x32_bf16 a[172:175], v[76:79], v[32:35], a[172:175]
    s_waitcnt lgkmcnt(2)
    v_cvt_pk_bf16_f32 v177, v18, v19
    v_add_u32 v3, s3, v3
    v_mfma_f32_16x16x32_bf16 a[32:35], v[64:67], v[40:43], a[32:35]
    ds_read_b128 v[32:35], v1 offset:10240
    v_cvt_f32_i32 v156, v156
    v_mfma_f32_16x16x32_bf16 a[32:35], v[80:83], v[44:47], a[32:35]
    v_exp_f32 v18, v114
    v_mfma_f32_16x16x32_bf16 a[80:83], v[84:87], v[44:47], a[80:83]
    v_add_f32 v5, v5, v16
    v_add_f32 v5, v5, v17
    v_mfma_f32_16x16x32_bf16 a[80:83], v[68:71], v[40:43], a[80:83]
    buffer_load_dwordx4 v4, s[4:7], s32 offen offset:2048 sc1 lds
    v_mfma_f32_16x16x32_bf16 a[128:131], v[72:75], v[40:43], a[128:131]
    ds_read_b128 v[36:39], v1 offset:22528
    v_mfma_f32_16x16x32_bf16 a[128:131], v[88:91], v[44:47], a[128:131]
    v_exp_f32 v19, v115
    v_mfma_f32_16x16x32_bf16 a[176:179], v[92:95], v[44:47], a[176:179]
    v_cvt_pk_bf16_f32 v178, v16, v17
    v_fma_f32 v152, v152, v48, v50
    v_mfma_f32_16x16x32_bf16 a[176:179], v[76:79], v[40:43], a[176:179]
    s_waitcnt lgkmcnt(2)
    v_exp_f32 v16, v180
    v_mfma_f32_16x16x32_bf16 a[36:39], v[64:67], v[24:27], a[36:39]
    ds_read_b128 v[40:43], v1 offset:11264
    v_add_f32 v5, v5, v18
    v_mfma_f32_16x16x32_bf16 a[36:39], v[80:83], v[28:31], a[36:39]
    v_add_f32 v5, v5, v19
    v_mfma_f32_16x16x32_bf16 a[84:87], v[84:87], v[28:31], a[84:87]
    v_exp_f32 v17, v181
    v_mfma_f32_16x16x32_bf16 a[84:87], v[68:71], v[24:27], a[84:87]
    s_add_u32 s32, s32, 24576
    v_cvt_pk_bf16_f32 v179, v18, v19
    s_add_u32 s26, s26, 36864
    v_mfma_f32_16x16x32_bf16 a[132:135], v[72:75], v[24:27], a[132:135]
    s_sub_u32 s57, s26, 147456
    ds_read_b128 v[44:47], v1 offset:23552
    v_fma_f32 v156, v156, v49, v51
    v_mfma_f32_16x16x32_bf16 a[132:135], v[88:91], v[28:31], a[132:135]
    s_waitcnt lgkmcnt(2)
    v_exp_f32 v18, v182
    v_mfma_f32_16x16x32_bf16 a[180:183], v[92:95], v[28:31], a[180:183]
    s_waitcnt vmcnt(6)
    v_add_f32 v6, v6, v16
    v_add_f32 v6, v6, v17
    v_mfma_f32_16x16x32_bf16 a[180:183], v[76:79], v[24:27], a[180:183]
    s_barrier
    v_mfma_f32_16x16x32_bf16 a[40:43], v[64:67], v[32:35], a[40:43]
    s_min_u32 s26, s26, s57
    ds_read_b128 v[24:27], v2 offset:0
    v_add_u32 v0, 1, v0
    v_mfma_f32_16x16x32_bf16 a[40:43], v[80:83], v[36:39], a[40:43]
    buffer_store_dword v0, v13, s[20:23], 0 offen offset:32 sc1
    v_mfma_f32_16x16x32_bf16 a[88:91], v[84:87], v[36:39], a[88:91]
    v_exp_f32 v19, v183
    v_mfma_f32_16x16x32_bf16 a[88:91], v[68:71], v[32:35], a[88:91]
    v_cvt_pk_bf16_f32 v180, v16, v17
    v_cvt_f32_i32 v153, v153
    v_mfma_f32_16x16x32_bf16 a[136:139], v[72:75], v[32:35], a[136:139]
    ds_read_b128 v[28:31], v3 offset:0
    v_cvt_f32_i32 v157, v157
    v_mfma_f32_16x16x32_bf16 a[136:139], v[88:91], v[36:39], a[136:139]
    v_exp_f32 v16, v116
    v_mfma_f32_16x16x32_bf16 a[184:187], v[92:95], v[36:39], a[184:187]
    v_add_f32 v6, v6, v18
    v_add_f32 v6, v6, v19
    v_mfma_f32_16x16x32_bf16 a[184:187], v[76:79], v[32:35], a[184:187]
    s_waitcnt lgkmcnt(2)
    v_exp_f32 v17, v117
    v_mfma_f32_16x16x32_bf16 a[44:47], v[64:67], v[40:43], a[44:47]
    ds_read_b128 v[32:35], v2 offset:6144
    v_cvt_pk_bf16_f32 v181, v18, v19
    v_mfma_f32_16x16x32_bf16 a[44:47], v[80:83], v[44:47], a[44:47]
    v_exp_f32 v18, v118
    v_mfma_f32_16x16x32_bf16 a[92:95], v[84:87], v[44:47], a[92:95]
    v_add_f32 v6, v6, v16
    v_add_f32 v6, v6, v17
    v_mfma_f32_16x16x32_bf16 a[92:95], v[68:71], v[40:43], a[92:95]
    v_exp_f32 v19, v119
    v_mfma_f32_16x16x32_bf16 a[140:143], v[72:75], v[40:43], a[140:143]
    ds_read_b128 v[36:39], v3 offset:6144
    v_cvt_pk_bf16_f32 v182, v16, v17
    v_mfma_f32_16x16x32_bf16 a[140:143], v[88:91], v[44:47], a[140:143]
    v_add_f32 v6, v6, v18
    v_add_f32 v6, v6, v19
    v_mfma_f32_16x16x32_bf16 a[188:191], v[92:95], v[44:47], a[188:191]
    v_cvt_pk_bf16_f32 v183, v18, v19
    v_mfma_f32_16x16x32_bf16 a[188:191], v[76:79], v[40:43], a[188:191]
    s_waitcnt lgkmcnt(2)
    v_mfma_f32_16x16x32_bf16 v[64:67], v[24:27], a[192:195], v[128:131]
    s_add_u32 s33, s33, 196608
    ds_read_b128 v[40:43], v2 offset:128
    v_fma_f32 v153, v153, v48, v50
    v_mfma_f32_16x16x32_bf16 v[64:67], v[28:31], a[196:199], v[64:67]
    s_mov_b32 m0, s56
    v_exp_f32 v16, v184
    v_mfma_f32_16x16x32_bf16 v[68:71], v[28:31], a[220:223], v[132:135]
    s_add_u32 s34, s34, 196608
    v_exp_f32 v17, v185
    v_mfma_f32_16x16x32_bf16 v[68:71], v[24:27], a[216:219], v[68:71]
    s_add_u32 s36, s36, 1536
    buffer_load_dwordx4 v4, s[4:7], s27 offen offset:0 sc1 lds
    v_mfma_f32_16x16x32_bf16 v[72:75], v[24:27], a[240:243], v[136:139]
    ds_read_b128 v[44:47], v3 offset:128
    v_fma_f32 v157, v157, v49, v51
    v_mfma_f32_16x16x32_bf16 v[72:75], v[28:31], a[244:247], v[72:75]
    v_exp_f32 v18, v186
    v_mfma_f32_16x16x32_bf16 v[76:79], v[28:31], v[204:207], v[140:143]
    v_add_f32 v7, v7, v16
    v_add_f32 v7, v7, v17
    v_mfma_f32_16x16x32_bf16 v[76:79], v[24:27], v[200:203], v[76:79]
    s_waitcnt lgkmcnt(2)
    buffer_load_dwordx2 v[56:57], v10, s[72:75], s36 offen offset:0
    v_mfma_f32_16x16x32_bf16 v[96:99], v[32:35], a[192:195], v[128:131]
    ds_read_b128 v[24:27], v2 offset:6272
    v_cvt_f32_i32 v154, v154
    v_mfma_f32_16x16x32_bf16 v[96:99], v[36:39], a[196:199], v[96:99]
    v_exp_f32 v19, v187
    v_mfma_f32_16x16x32_bf16 v[100:103], v[36:39], a[220:223], v[132:135]
    v_cvt_pk_bf16_f32 v184, v16, v17
    v_cvt_f32_i32 v158, v158
    v_mfma_f32_16x16x32_bf16 v[100:103], v[32:35], a[216:219], v[100:103]
    buffer_load_dwordx4 v4, s[4:7], s27 offen offset:1024 sc1 lds
    v_mfma_f32_16x16x32_bf16 v[104:107], v[32:35], a[240:243], v[136:139]
    ds_read_b128 v[28:31], v3 offset:6272
    v_fma_f32 v154, v154, v48, v50
    v_mfma_f32_16x16x32_bf16 v[104:107], v[36:39], a[244:247], v[104:107]
    v_exp_f32 v16, v120
    v_mfma_f32_16x16x32_bf16 v[108:111], v[36:39], v[204:207], v[140:143]
    v_add_f32 v7, v7, v18
    v_add_f32 v7, v7, v19
    v_mfma_f32_16x16x32_bf16 v[108:111], v[32:35], v[200:203], v[108:111]
    s_waitcnt lgkmcnt(2)
    buffer_load_dwordx2 v[58:59], v10, s[76:79], s36 offen offset:0
    v_mfma_f32_16x16x32_bf16 v[64:67], v[40:43], a[200:203], v[64:67]
    ds_read_b128 v[32:35], v2 offset:256
    v_fma_f32 v158, v158, v49, v51
    v_mfma_f32_16x16x32_bf16 v[64:67], v[44:47], a[204:207], v[64:67]
    v_exp_f32 v17, v121
    v_mfma_f32_16x16x32_bf16 v[68:71], v[44:47], a[228:231], v[68:71]
    v_cvt_pk_bf16_f32 v185, v18, v19
    v_mfma_f32_16x16x32_bf16 v[68:71], v[40:43], a[224:227], v[68:71]
    buffer_load_dwordx4 v[224:227], v9, s[64:67], s33 offen offset:0 nt
    v_mfma_f32_16x16x32_bf16 v[72:75], v[40:43], a[248:251], v[72:75]
    ds_read_b128 v[36:39], v3 offset:256
    v_cvt_pk_bf16_f32 v144, v144, v148
    v_mfma_f32_16x16x32_bf16 v[72:75], v[44:47], a[252:255], v[72:75]
    v_exp_f32 v18, v122
    v_mfma_f32_16x16x32_bf16 v[76:79], v[44:47], v[212:215], v[76:79]
    v_add_f32 v7, v7, v16
    v_add_f32 v7, v7, v17
    v_mfma_f32_16x16x32_bf16 v[76:79], v[40:43], v[208:211], v[76:79]
    s_waitcnt lgkmcnt(2)
    buffer_load_dwordx4 v4, s[4:7], s27 offen offset:2048 sc1 lds
    v_mfma_f32_16x16x32_bf16 v[96:99], v[24:27], a[200:203], v[96:99]
    ds_read_b128 v[40:43], v2 offset:6400
    v_cvt_pk_bf16_f32 v148, v145, v149
    v_mfma_f32_16x16x32_bf16 v[96:99], v[28:31], a[204:207], v[96:99]
    v_exp_f32 v19, v123
    v_cvt_pk_bf16_f32 v186, v16, v17
    v_mfma_f32_16x16x32_bf16 v[100:103], v[28:31], a[228:231], v[100:103]
    v_exp_f32 v16, v188
    v_mfma_f32_16x16x32_bf16 v[100:103], v[24:27], a[224:227], v[100:103]
    buffer_load_dwordx4 v[228:231], v9, s[64:67], s33 offen offset:1536 nt
    v_mfma_f32_16x16x32_bf16 v[104:107], v[24:27], a[248:251], v[104:107]
    ds_read_b128 v[44:47], v3 offset:6400
    v_add_f32 v7, v7, v18
    v_mfma_f32_16x16x32_bf16 v[104:107], v[28:31], a[252:255], v[104:107]
    v_add_f32 v7, v7, v19
    v_cvt_pk_bf16_f32 v145, v152, v156
    v_mfma_f32_16x16x32_bf16 v[108:111], v[28:31], v[212:215], v[108:111]
    s_add_u32 s29, s30, 49152
    v_exp_f32 v17, v189
    v_mfma_f32_16x16x32_bf16 v[108:111], v[24:27], v[208:211], v[108:111]
    s_waitcnt lgkmcnt(2)
    buffer_load_dwordx4 v[232:235], v9, s[64:67], s34 offen offset:0 nt
    v_cvt_pk_bf16_f32 v187, v18, v19
    v_mfma_f32_16x16x32_bf16 v[64:67], v[32:35], a[208:211], v[64:67]
    s_sub_u32 s3, s29, 147456
    ds_read_b128 v[24:27], v2 offset:12288
    s_add_u32 s27, s27, 24576
    v_mfma_f32_16x16x32_bf16 v[64:67], v[36:39], a[212:215], v[64:67]
    s_min_u32 s29, s29, s3
    v_exp_f32 v18, v190
    v_mfma_f32_16x16x32_bf16 v[68:71], v[36:39], a[236:239], v[68:71]
    v_add_f32 v8, v8, v16
    v_add_f32 v8, v8, v17
    v_mfma_f32_16x16x32_bf16 v[68:71], v[32:35], a[232:235], v[68:71]
    buffer_load_dwordx4 v[236:239], v9, s[64:67], s34 offen offset:1536 nt
    v_mfma_f32_16x16x32_bf16 v[72:75], v[32:35], v[192:195], v[72:75]
    s_add_u32 s56, s56, 12288
    ds_read_b128 v[28:31], v3 offset:12288
    v_cvt_pk_bf16_f32 v149, v153, v157
    v_mfma_f32_16x16x32_bf16 v[72:75], v[36:39], v[196:199], v[72:75]
    v_exp_f32 v19, v191
    v_cvt_pk_bf16_f32 v188, v16, v17
    v_mfma_f32_16x16x32_bf16 v[76:79], v[36:39], v[220:223], v[76:79]
    v_exp_f32 v16, v124
    v_mfma_f32_16x16x32_bf16 v[76:79], v[32:35], v[216:219], v[76:79]
    s_waitcnt lgkmcnt(2)
    v_add_f32 v8, v8, v18
    v_add_f32 v8, v8, v19
    v_mfma_f32_16x16x32_bf16 v[96:99], v[40:43], a[208:211], v[96:99]
    ds_read_b128 v[32:35], v2 offset:18432
    v_cvt_pk_bf16_f32 v152, v146, v150
    v_mfma_f32_16x16x32_bf16 v[96:99], v[44:47], a[212:215], v[96:99]
    s_sub_u32 s3, s29, s30
    v_exp_f32 v17, v125
    v_mfma_f32_16x16x32_bf16 v[100:103], v[44:47], a[236:239], v[100:103]
    s_mov_b32 m0, s56
    v_cvt_pk_bf16_f32 v189, v18, v19
    v_cvt_pk_bf16_f32 v153, v154, v158
    v_mfma_f32_16x16x32_bf16 v[100:103], v[40:43], a[232:235], v[100:103]
    v_exp_f32 v18, v126
    v_mfma_f32_16x16x32_bf16 v[104:107], v[40:43], v[192:195], v[104:107]
    ds_read_b128 v[36:39], v3 offset:18432
    v_add_f32 v8, v8, v16
    v_mfma_f32_16x16x32_bf16 v[104:107], v[44:47], v[196:199], v[104:107]
    v_add_f32 v8, v8, v17
    v_mfma_f32_16x16x32_bf16 v[108:111], v[44:47], v[220:223], v[108:111]
    v_exp_f32 v19, v127
    v_mfma_f32_16x16x32_bf16 v[108:111], v[40:43], v[216:219], v[108:111]
    s_waitcnt lgkmcnt(2)
    v_cvt_pk_bf16_f32 v190, v16, v17
    v_add_f32 v8, v8, v18
    v_mfma_f32_16x16x32_bf16 v[80:83], v[24:27], a[192:195], v[128:131]
    ds_read_b128 v[40:43], v2 offset:12416
    v_add_f32 v8, v8, v19
    v_mfma_f32_16x16x32_bf16 v[80:83], v[28:31], a[196:199], v[80:83]
    s_mov_b32 s30, s29
    v_cvt_pk_bf16_f32 v191, v18, v19
    v_mfma_f32_16x16x32_bf16 v[84:87], v[28:31], a[220:223], v[132:135]
    v_exp_f32 v16, v64
    v_mfma_f32_16x16x32_bf16 v[84:87], v[24:27], a[216:219], v[84:87]
    s_waitcnt vmcnt(20)
    buffer_load_dwordx4 v4, s[4:7], s27 offen offset:0 sc1 lds
    v_mfma_f32_16x16x32_bf16 v[88:91], v[24:27], a[240:243], v[136:139]
    ds_read_b128 v[44:47], v3 offset:12416
    v_lshlrev_b32 v48, 16, v60
    v_mfma_f32_16x16x32_bf16 v[88:91], v[28:31], a[244:247], v[88:91]
    v_exp_f32 v17, v65
    v_mfma_f32_16x16x32_bf16 v[92:95], v[28:31], v[204:207], v[140:143]
    v_exp_f32 v18, v66
    v_mfma_f32_16x16x32_bf16 v[92:95], v[24:27], v[200:203], v[92:95]
    s_waitcnt lgkmcnt(2)
    v_add_f32 v5, v5, v16
    v_add_f32 v5, v5, v17
    v_mfma_f32_16x16x32_bf16 v[112:115], v[32:35], a[192:195], v[128:131]
    ds_read_b128 v[24:27], v2 offset:18560
    v_and_b32 v49, s97, v60
    v_mfma_f32_16x16x32_bf16 v[112:115], v[36:39], a[196:199], v[112:115]
    v_exp_f32 v19, v67
    v_mfma_f32_16x16x32_bf16 v[116:119], v[36:39], a[220:223], v[132:135]
    v_cvt_pk_bf16_f32 v64, v16, v17
    v_lshlrev_b32 v50, 16, v62
    v_mfma_f32_16x16x32_bf16 v[116:119], v[32:35], a[216:219], v[116:119]
    v_exp_f32 v16, v96
    v_mfma_f32_16x16x32_bf16 v[120:123], v[32:35], a[240:243], v[136:139]
    ds_read_b128 v[28:31], v3 offset:18560
    v_add_f32 v5, v5, v18
    v_mfma_f32_16x16x32_bf16 v[120:123], v[36:39], a[244:247], v[120:123]
    v_add_f32 v5, v5, v19
    v_and_b32 v51, s97, v62
    v_mfma_f32_16x16x32_bf16 v[124:127], v[36:39], v[204:207], v[140:143]
    v_exp_f32 v17, v97
    v_mfma_f32_16x16x32_bf16 v[124:127], v[32:35], v[200:203], v[124:127]
    s_waitcnt lgkmcnt(2)
    buffer_load_dwordx4 v4, s[4:7], s27 offen offset:1024 sc1 lds
    v_mfma_f32_16x16x32_bf16 v[80:83], v[40:43], a[200:203], v[80:83]
    ds_read_b128 v[32:35], v2 offset:12544
    v_cvt_pk_bf16_f32 v65, v18, v19
    v_mfma_f32_16x16x32_bf16 v[80:83], v[44:47], a[204:207], v[80:83]
    v_exp_f32 v18, v98
    v_mfma_f32_16x16x32_bf16 v[84:87], v[44:47], a[228:231], v[84:87]
    v_add_f32 v5, v5, v16
    v_add_f32 v5, v5, v17
    v_mfma_f32_16x16x32_bf16 v[84:87], v[40:43], a[224:227], v[84:87]
    v_exp_f32 v19, v99
    v_mfma_f32_16x16x32_bf16 v[88:91], v[40:43], a[248:251], v[88:91]
    ds_read_b128 v[36:39], v3 offset:12544
    v_cvt_pk_bf16_f32 v66, v16, v17
    v_mfma_f32_16x16x32_bf16 v[88:91], v[44:47], a[252:255], v[88:91]
    v_exp_f32 v16, v68
    v_mfma_f32_16x16x32_bf16 v[92:95], v[44:47], v[212:215], v[92:95]
    v_add_u32 v1, s3, v1
    v_mul_f32_e64 v50, -v50, v48
    v_mfma_f32_16x16x32_bf16 v[92:95], v[40:43], v[208:211], v[92:95]
    s_waitcnt lgkmcnt(2)
    v_add_f32 v5, v5, v18
    v_add_f32 v5, v5, v19
    v_mfma_f32_16x16x32_bf16 v[112:115], v[24:27], a[200:203], v[112:115]
    ds_read_b128 v[40:43], v2 offset:18688
    v_mul_f32_e64 v51, -v51, v49
    v_mfma_f32_16x16x32_bf16 v[112:115], v[28:31], a[204:207], v[112:115]
    buffer_load_dwordx4 v4, s[4:7], s27 offen offset:2048 sc1 lds
    v_mfma_f32_16x16x32_bf16 v[116:119], v[28:31], a[228:231], v[116:119]
    v_exp_f32 v17, v69
    v_mfma_f32_16x16x32_bf16 v[116:119], v[24:27], a[224:227], v[116:119]
    v_cvt_pk_bf16_f32 v67, v18, v19
    v_cvt_f32_i32 v240, v240
    v_mfma_f32_16x16x32_bf16 v[120:123], v[24:27], a[248:251], v[120:123]
    ds_read_b128 v[44:47], v3 offset:18688
    v_mfma_f32_16x16x32_bf16 v[120:123], v[28:31], a[252:255], v[120:123]
    s_waitcnt lgkmcnt(2)
    v_exp_f32 v18, v70
    v_mfma_f32_16x16x32_bf16 v[124:127], v[28:31], v[212:215], v[124:127]
    s_waitcnt vmcnt(13)
    v_add_f32 v6, v6, v16
    v_add_f32 v6, v6, v17
    v_mfma_f32_16x16x32_bf16 v[124:127], v[24:27], v[208:211], v[124:127]
    s_barrier
    v_mfma_f32_16x16x32_bf16 v[80:83], v[32:35], a[208:211], v[80:83]
    ds_read_b128 v[24:27], v1 offset:0
    v_cvt_f32_i32 v244, v244
    v_mfma_f32_16x16x32_bf16 v[80:83], v[36:39], a[212:215], v[80:83]
    v_exp_f32 v19, v71
    v_mfma_f32_16x16x32_bf16 v[84:87], v[36:39], a[236:239], v[84:87]
    v_cvt_pk_bf16_f32 v68, v16, v17
    v_fma_f32 v240, v240, v48, v50
    v_mfma_f32_16x16x32_bf16 v[84:87], v[32:35], a[232:235], v[84:87]
    v_exp_f32 v16, v100
    v_mfma_f32_16x16x32_bf16 v[88:91], v[32:35], v[192:195], v[88:91]
    ds_read_b128 v[28:31], v1 offset:12288
    v_add_f32 v6, v6, v18
    v_mfma_f32_16x16x32_bf16 v[88:91], v[36:39], v[196:199], v[88:91]
    v_add_f32 v6, v6, v19
    v_fma_f32 v244, v244, v49, v51
    v_mfma_f32_16x16x32_bf16 v[92:95], v[36:39], v[220:223], v[92:95]
    v_exp_f32 v17, v101
    v_mfma_f32_16x16x32_bf16 v[92:95], v[32:35], v[216:219], v[92:95]
    s_waitcnt lgkmcnt(2)
    v_cvt_pk_bf16_f32 v69, v18, v19
    v_mfma_f32_16x16x32_bf16 v[112:115], v[40:43], a[208:211], v[112:115]
    ds_read_b128 v[32:35], v1 offset:1024
    v_mfma_f32_16x16x32_bf16 v[112:115], v[44:47], a[212:215], v[112:115]
    v_exp_f32 v18, v102
    v_mfma_f32_16x16x32_bf16 v[116:119], v[44:47], a[236:239], v[116:119]
    v_add_f32 v6, v6, v16
    v_add_f32 v6, v6, v17
    v_mfma_f32_16x16x32_bf16 v[116:119], v[40:43], a[232:235], v[116:119]
    s_add_u32 s27, s27, 24576
    v_exp_f32 v19, v103
    v_mfma_f32_16x16x32_bf16 v[120:123], v[40:43], v[192:195], v[120:123]
    s_add_u32 s56, s56, 36864
    ds_read_b128 v[36:39], v1 offset:13312
    v_cvt_pk_bf16_f32 v70, v16, v17
    v_mfma_f32_16x16x32_bf16 v[120:123], v[44:47], v[196:199], v[120:123]
    s_sub_u32 s58, s56, 147456
    v_add_f32 v6, v6, v18
    v_add_f32 v6, v6, v19
    v_mfma_f32_16x16x32_bf16 v[124:127], v[44:47], v[220:223], v[124:127]
    s_min_u32 s56, s56, s58
    v_cvt_pk_bf16_f32 v71, v18, v19
    v_mfma_f32_16x16x32_bf16 v[124:127], v[40:43], v[216:219], v[124:127]
    s_waitcnt lgkmcnt(2)
    v_mfma_f32_16x16x32_bf16 a[0:3], v[160:163], v[24:27], a[0:3]
    s_mov_b32 m0, s56
    ds_read_b128 v[40:43], v1 offset:2048
    v_cvt_f32_i32 v241, v241
    v_mfma_f32_16x16x32_bf16 a[0:3], v[176:179], v[28:31], a[0:3]
    buffer_load_dwordx4 v4, s[4:7], s27 offen offset:0 sc1 lds
    v_mfma_f32_16x16x32_bf16 a[48:51], v[180:183], v[28:31], a[48:51]
    v_exp_f32 v16, v72
    v_mfma_f32_16x16x32_bf16 a[48:51], v[164:167], v[24:27], a[48:51]
    v_exp_f32 v17, v73
    v_mfma_f32_16x16x32_bf16 a[96:99], v[168:171], v[24:27], a[96:99]
    ds_read_b128 v[44:47], v1 offset:14336
    v_cvt_f32_i32 v245, v245
    v_mfma_f32_16x16x32_bf16 a[96:99], v[184:187], v[28:31], a[96:99]
    v_exp_f32 v18, v74
    v_mfma_f32_16x16x32_bf16 a[144:147], v[188:191], v[28:31], a[144:147]
    v_add_f32 v7, v7, v16
    v_add_f32 v7, v7, v17
    v_mfma_f32_16x16x32_bf16 a[144:147], v[172:175], v[24:27], a[144:147]
    s_waitcnt lgkmcnt(2)
    v_exp_f32 v19, v75
    v_mfma_f32_16x16x32_bf16 a[4:7], v[160:163], v[32:35], a[4:7]
L_pg4:
    s_cbranch_execz L_pg8
    ds_read_b128 v[24:27], v1 offset:3072
    v_fma_f32 v241, v241, v48, v50
    v_mfma_f32_16x16x32_bf16 a[4:7], v[176:179], v[36:39], a[4:7]
    buffer_load_dwordx4 v4, s[4:7], s27 offen offset:1024 sc1 lds
    v_mfma_f32_16x16x32_bf16 a[52:55], v[180:183], v[36:39], a[52:55]
    v_cvt_pk_bf16_f32 v72, v16, v17
    v_fma_f32 v245, v245, v49, v51
    v_mfma_f32_16x16x32_bf16 a[52:55], v[164:167], v[32:35], a[52:55]
    v_exp_f32 v16, v104
    v_mfma_f32_16x16x32_bf16 a[100:103], v[168:171], v[32:35], a[100:103]
    ds_read_b128 v[28:31], v1 offset:15360
    v_add_f32 v7, v7, v18
    v_mfma_f32_16x16x32_bf16 a[100:103], v[184:187], v[36:39], a[100:103]
    buffer_load_dword v52, v20, s[20:23], s44 offen sc1
    v_mfma_f32_16x16x32_bf16 a[148:151], v[188:191], v[36:39], a[148:151]
    v_add_f32 v7, v7, v19
    v_cvt_f32_i32 v242, v242
    v_mfma_f32_16x16x32_bf16 a[148:151], v[172:175], v[32:35], a[148:151]
    s_waitcnt lgkmcnt(2)
    v_exp_f32 v17, v105
    v_mfma_f32_16x16x32_bf16 a[8:11], v[160:163], v[40:43], a[8:11]
    ds_read_b128 v[32:35], v1 offset:4096
    v_cvt_pk_bf16_f32 v73, v18, v19
    v_mfma_f32_16x16x32_bf16 a[8:11], v[176:179], v[44:47], a[8:11]
    v_exp_f32 v18, v106
    v_mfma_f32_16x16x32_bf16 a[56:59], v[180:183], v[44:47], a[56:59]
    v_add_f32 v7, v7, v16
    v_cvt_f32_i32 v246, v246
    v_mfma_f32_16x16x32_bf16 a[56:59], v[164:167], v[40:43], a[56:59]
    buffer_load_dwordx4 v4, s[4:7], s27 offen offset:2048 sc1 lds
    v_mfma_f32_16x16x32_bf16 a[104:107], v[168:171], v[40:43], a[104:107]
    ds_read_b128 v[36:39], v1 offset:16384
    v_add_f32 v7, v7, v17
    v_mfma_f32_16x16x32_bf16 a[104:107], v[184:187], v[44:47], a[104:107]
    v_exp_f32 v19, v107
    v_mfma_f32_16x16x32_bf16 a[152:155], v[188:191], v[44:47], a[152:155]
    v_cvt_pk_bf16_f32 v74, v16, v17
    v_fma_f32 v242, v242, v48, v50
    v_mfma_f32_16x16x32_bf16 a[152:155], v[172:175], v[40:43], a[152:155]
    s_waitcnt lgkmcnt(2)
    v_exp_f32 v16, v76
    v_mfma_f32_16x16x32_bf16 a[12:15], v[160:163], v[24:27], a[12:15]
    ds_read_b128 v[40:43], v1 offset:5120
    v_add_f32 v7, v7, v18
    v_mfma_f32_16x16x32_bf16 a[12:15], v[176:179], v[28:31], a[12:15]
    s_add_u32 s27, s27, 24576
    v_add_f32 v7, v7, v19
    v_fma_f32 v246, v246, v49, v51
    v_mfma_f32_16x16x32_bf16 a[60:63], v[180:183], v[28:31], a[60:63]
    v_exp_f32 v17, v77
    v_mfma_f32_16x16x32_bf16 a[60:63], v[164:167], v[24:27], a[60:63]
    v_cvt_pk_bf16_f32 v75, v18, v19
    v_lshlrev_b32 v48, 16, v61
    v_mfma_f32_16x16x32_bf16 a[108:111], v[168:171], v[24:27], a[108:111]
    ds_read_b128 v[44:47], v1 offset:17408
    v_and_b32 v49, s97, v61
    v_mfma_f32_16x16x32_bf16 a[108:111], v[184:187], v[28:31], a[108:111]
    v_exp_f32 v18, v78
    v_mfma_f32_16x16x32_bf16 a[156:159], v[188:191], v[28:31], a[156:159]
    s_add_u32 s29, s28, 49152
    v_add_f32 v8, v8, v16
    v_add_f32 v8, v8, v17
    v_mfma_f32_16x16x32_bf16 a[156:159], v[172:175], v[24:27], a[156:159]
    s_waitcnt lgkmcnt(2)
    v_exp_f32 v19, v79
    v_mfma_f32_16x16x32_bf16 a[16:19], v[160:163], v[32:35], a[16:19]
    s_sub_u32 s3, s29, 147456
    ds_read_b128 v[24:27], v1 offset:6144
    v_lshlrev_b32 v50, 16, v63
    v_mfma_f32_16x16x32_bf16 a[16:19], v[176:179], v[36:39], a[16:19]
    s_add_u32 s56, s56, 12288
    v_cvt_pk_bf16_f32 v76, v16, v17
    v_and_b32 v51, s97, v63
    v_mfma_f32_16x16x32_bf16 a[64:67], v[180:183], v[36:39], a[64:67]
    s_min_u32 s29, s29, s3
    v_exp_f32 v16, v108
    v_mfma_f32_16x16x32_bf16 a[64:67], v[164:167], v[32:35], a[64:67]
    s_mov_b32 m0, s56
    v_add_f32 v8, v8, v18
    v_add_f32 v8, v8, v19
    v_mfma_f32_16x16x32_bf16 a[112:115], v[168:171], v[32:35], a[112:115]
    ds_read_b128 v[28:31], v1 offset:18432
    v_mul_f32_e64 v50, -v50, v48
    v_mfma_f32_16x16x32_bf16 a[112:115], v[184:187], v[36:39], a[112:115]
    v_exp_f32 v17, v109
    v_mfma_f32_16x16x32_bf16 a[160:163], v[188:191], v[36:39], a[160:163]
    v_cvt_pk_bf16_f32 v77, v18, v19
    v_mul_f32_e64 v51, -v51, v49
    v_mfma_f32_16x16x32_bf16 a[160:163], v[172:175], v[32:35], a[160:163]
    s_waitcnt lgkmcnt(2)
    v_exp_f32 v18, v110
    v_mfma_f32_16x16x32_bf16 a[20:23], v[160:163], v[40:43], a[20:23]
    s_sub_u32 s3, s29, s28
    ds_read_b128 v[32:35], v1 offset:7168
    v_add_f32 v8, v8, v16
    v_mfma_f32_16x16x32_bf16 a[20:23], v[176:179], v[44:47], a[20:23]
    v_add_f32 v8, v8, v17
    v_cvt_f32_i32 v248, v248
    v_mfma_f32_16x16x32_bf16 a[68:71], v[180:183], v[44:47], a[68:71]
    v_exp_f32 v19, v111
    v_mfma_f32_16x16x32_bf16 a[68:71], v[164:167], v[40:43], a[68:71]
    buffer_load_dwordx4 v4, s[4:7], s27 offen offset:0 sc1 lds
    v_mfma_f32_16x16x32_bf16 a[116:119], v[168:171], v[40:43], a[116:119]
    ds_read_b128 v[36:39], v1 offset:19456
    v_cvt_pk_bf16_f32 v78, v16, v17
    v_mfma_f32_16x16x32_bf16 a[116:119], v[184:187], v[44:47], a[116:119]
    v_add_f32 v8, v8, v18
    v_cvt_f32_i32 v252, v252
    v_mfma_f32_16x16x32_bf16 a[164:167], v[188:191], v[44:47], a[164:167]
    s_mov_b32 s28, s29
    v_add_f32 v8, v8, v19
    v_cvt_pk_bf16_f32 v79, v18, v19
    v_mfma_f32_16x16x32_bf16 a[164:167], v[172:175], v[40:43], a[164:167]
    s_waitcnt lgkmcnt(2)
    v_exp_f32 v16, v80
    v_mfma_f32_16x16x32_bf16 a[24:27], v[160:163], v[24:27], a[24:27]
    ds_read_b128 v[40:43], v1 offset:8192
    v_fma_f32 v248, v248, v48, v50
    v_mfma_f32_16x16x32_bf16 a[24:27], v[176:179], v[28:31], a[24:27]
    v_exp_f32 v17, v81
    v_mfma_f32_16x16x32_bf16 a[72:75], v[180:183], v[28:31], a[72:75]
    v_fma_f32 v252, v252, v49, v51
    v_cvt_f32_i32 v249, v249
    v_mfma_f32_16x16x32_bf16 a[72:75], v[164:167], v[24:27], a[72:75]
    buffer_load_dwordx4 v4, s[4:7], s27 offen offset:1024 sc1 lds
    v_mfma_f32_16x16x32_bf16 a[120:123], v[168:171], v[24:27], a[120:123]
    ds_read_b128 v[44:47], v1 offset:20480
    v_cvt_f32_i32 v253, v253
    v_mfma_f32_16x16x32_bf16 a[120:123], v[184:187], v[28:31], a[120:123]
    v_exp_f32 v18, v82
    v_mfma_f32_16x16x32_bf16 a[168:171], v[188:191], v[28:31], a[168:171]
    v_add_f32 v5, v5, v16
    v_add_f32 v5, v5, v17
    v_mfma_f32_16x16x32_bf16 a[168:171], v[172:175], v[24:27], a[168:171]
    s_waitcnt lgkmcnt(2)
    v_exp_f32 v19, v83
    v_mfma_f32_16x16x32_bf16 a[28:31], v[160:163], v[32:35], a[28:31]
    ds_read_b128 v[24:27], v1 offset:9216
    v_cvt_pk_bf16_f32 v80, v16, v17
    v_mfma_f32_16x16x32_bf16 a[28:31], v[176:179], v[36:39], a[28:31]
    v_exp_f32 v16, v112
    v_mfma_f32_16x16x32_bf16 a[76:79], v[180:183], v[36:39], a[76:79]
    v_add_f32 v5, v5, v18
    v_fma_f32 v249, v249, v48, v50
    v_mfma_f32_16x16x32_bf16 a[76:79], v[164:167], v[32:35], a[76:79]
    v_add_f32 v5, v5, v19
    v_add_u32 v2, s3, v2
    v_mfma_f32_16x16x32_bf16 a[124:127], v[168:171], v[32:35], a[124:127]
    ds_read_b128 v[28:31], v1 offset:21504
    v_fma_f32 v253, v253, v49, v51
    v_mfma_f32_16x16x32_bf16 a[124:127], v[184:187], v[36:39], a[124:127]
    buffer_load_dwordx4 v4, s[4:7], s27 offen offset:2048 sc1 lds
    v_mfma_f32_16x16x32_bf16 a[172:175], v[188:191], v[36:39], a[172:175]
    v_exp_f32 v17, v113
    v_mfma_f32_16x16x32_bf16 a[172:175], v[172:175], v[32:35], a[172:175]
    s_waitcnt lgkmcnt(2)
    v_cvt_pk_bf16_f32 v81, v18, v19
    v_cvt_f32_i32 v250, v250
    v_mfma_f32_16x16x32_bf16 a[32:35], v[160:163], v[40:43], a[32:35]
    ds_read_b128 v[32:35], v1 offset:10240
    v_add_u32 v3, s3, v3
    v_mfma_f32_16x16x32_bf16 a[32:35], v[176:179], v[44:47], a[32:35]
    v_exp_f32 v18, v114
    v_mfma_f32_16x16x32_bf16 a[80:83], v[180:183], v[44:47], a[80:83]
    v_add_f32 v5, v5, v16
    v_add_f32 v5, v5, v17
    v_mfma_f32_16x16x32_bf16 a[80:83], v[164:167], v[40:43], a[80:83]
    v_exp_f32 v19, v115
    v_mfma_f32_16x16x32_bf16 a[128:131], v[168:171], v[40:43], a[128:131]
    ds_read_b128 v[36:39], v1 offset:22528
    v_cvt_pk_bf16_f32 v82, v16, v17
    v_mfma_f32_16x16x32_bf16 a[128:131], v[184:187], v[44:47], a[128:131]
    v_exp_f32 v16, v84
    v_mfma_f32_16x16x32_bf16 a[176:179], v[188:191], v[44:47], a[176:179]
    v_cvt_f32_i32 v254, v254
    v_add_f32 v5, v5, v18
    v_mfma_f32_16x16x32_bf16 a[176:179], v[172:175], v[40:43], a[176:179]
    s_waitcnt lgkmcnt(2)
    v_add_f32 v5, v5, v19
    v_fma_f32 v250, v250, v48, v50
    v_mfma_f32_16x16x32_bf16 a[36:39], v[160:163], v[24:27], a[36:39]
    ds_read_b128 v[40:43], v1 offset:11264
    v_fma_f32 v254, v254, v49, v51
    v_mfma_f32_16x16x32_bf16 a[36:39], v[176:179], v[28:31], a[36:39]
    v_exp_f32 v17, v85
    v_mfma_f32_16x16x32_bf16 a[84:87], v[180:183], v[28:31], a[84:87]
    v_cvt_pk_bf16_f32 v83, v18, v19
    v_cvt_pk_bf16_f32 v146, v240, v244
    v_mfma_f32_16x16x32_bf16 a[84:87], v[164:167], v[24:27], a[84:87]
    s_add_u32 s27, s27, 24576
    v_exp_f32 v18, v86
    v_mfma_f32_16x16x32_bf16 a[132:135], v[168:171], v[24:27], a[132:135]
    s_add_u32 s56, s56, 36864
    ds_read_b128 v[44:47], v1 offset:23552
    v_add_f32 v6, v6, v16
    v_mfma_f32_16x16x32_bf16 a[132:135], v[184:187], v[28:31], a[132:135]
    s_sub_u32 s58, s56, 147456
    v_add_f32 v6, v6, v17
    v_cvt_pk_bf16_f32 v150, v241, v245
    v_mfma_f32_16x16x32_bf16 a[180:183], v[188:191], v[28:31], a[180:183]
    v_exp_f32 v19, v87
    v_mfma_f32_16x16x32_bf16 a[180:183], v[172:175], v[24:27], a[180:183]
    s_waitcnt lgkmcnt(2)
    v_cvt_pk_bf16_f32 v84, v16, v17
    v_cvt_pk_bf16_f32 v147, v248, v252
    v_mfma_f32_16x16x32_bf16 a[40:43], v[160:163], v[32:35], a[40:43]
    s_min_u32 s56, s56, s58
    ds_read_b128 v[24:27], v2 offset:0
    v_mfma_f32_16x16x32_bf16 a[40:43], v[176:179], v[36:39], a[40:43]
    v_exp_f32 v16, v116
    v_mfma_f32_16x16x32_bf16 a[88:91], v[180:183], v[36:39], a[88:91]
    v_add_f32 v6, v6, v18
    v_add_f32 v6, v6, v19
    v_mfma_f32_16x16x32_bf16 a[88:91], v[164:167], v[32:35], a[88:91]
    v_exp_f32 v17, v117
    v_mfma_f32_16x16x32_bf16 a[136:139], v[168:171], v[32:35], a[136:139]
    ds_read_b128 v[28:31], v3 offset:0
    v_cvt_pk_bf16_f32 v151, v249, v253
    v_mfma_f32_16x16x32_bf16 a[136:139], v[184:187], v[36:39], a[136:139]
    v_cvt_pk_bf16_f32 v85, v18, v19
    v_cvt_pk_bf16_f32 v154, v242, v246
    v_mfma_f32_16x16x32_bf16 a[184:187], v[188:191], v[36:39], a[184:187]
    v_exp_f32 v18, v118
    v_mfma_f32_16x16x32_bf16 a[184:187], v[172:175], v[32:35], a[184:187]
    s_waitcnt lgkmcnt(2)
    v_add_f32 v6, v6, v16
    v_mfma_f32_16x16x32_bf16 a[44:47], v[160:163], v[40:43], a[44:47]
    ds_read_b128 v[32:35], v2 offset:6144
    v_add_f32 v6, v6, v17
    v_mfma_f32_16x16x32_bf16 a[44:47], v[176:179], v[44:47], a[44:47]
    v_exp_f32 v19, v119
    v_mfma_f32_16x16x32_bf16 a[92:95], v[180:183], v[44:47], a[92:95]
    v_cvt_pk_bf16_f32 v155, v250, v254
    v_mfma_f32_16x16x32_bf16 a[92:95], v[164:167], v[40:43], a[92:95]
    v_cvt_pk_bf16_f32 v86, v16, v17
    v_mfma_f32_16x16x32_bf16 a[140:143], v[168:171], v[40:43], a[140:143]
    ds_read_b128 v[36:39], v3 offset:6144
    v_add_f32 v6, v6, v18
    v_mfma_f32_16x16x32_bf16 a[140:143], v[184:187], v[44:47], a[140:143]
    v_add_f32 v6, v6, v19
    v_cvt_pk_bf16_f32 v87, v18, v19
    v_mfma_f32_16x16x32_bf16 a[188:191], v[188:191], v[44:47], a[188:191]
    v_mfma_f32_16x16x32_bf16 a[188:191], v[172:175], v[40:43], a[188:191]
    s_waitcnt lgkmcnt(2)
L_join:
    v_mfma_f32_16x16x32_bf16 v[160:163], v[24:27], a[192:195], v[128:131]
L_pg5:
    s_cbranch_execz L_pg9
    ds_read_b128 v[40:43], v2 offset:128
    v_mfma_f32_16x16x32_bf16 v[160:163], v[28:31], a[196:199], v[160:163]
    s_waitcnt vmcnt(4)
    v_subrev_u32 v52, s92, v52
    v_cmp_lt_u32 vcc, 15, v52
    v_mfma_f32_16x16x32_bf16 v[164:167], v[28:31], a[220:223], v[132:135]
    v_exp_f32 v16, v88
    v_mfma_f32_16x16x32_bf16 v[164:167], v[24:27], a[216:219], v[164:167]
    v_exp_f32 v17, v89
    v_mfma_f32_16x16x32_bf16 v[168:171], v[24:27], a[240:243], v[136:139]
    s_and_b32 s59, vcc_lo, 0xff
    ds_read_b128 v[44:47], v3 offset:128
    v_mfma_f32_16x16x32_bf16 v[168:171], v[28:31], a[244:247], v[168:171]
    s_cbranch_scc1 L_pollslow1
L_pollok1:
    v_mfma_f32_16x16x32_bf16 v[172:175], v[28:31], v[204:207], v[140:143]
    s_add_u32 s92, s92, 1
    v_exp_f32 v18, v90
    v_mfma_f32_16x16x32_bf16 v[172:175], v[24:27], v[200:203], v[172:175]
    s_waitcnt lgkmcnt(2)
    v_add_f32 v7, v7, v16
    v_add_f32 v7, v7, v17
    v_mfma_f32_16x16x32_bf16 v[96:99], v[32:35], a[192:195], v[128:131]
    ds_read_b128 v[24:27], v2 offset:6272
    v_mfma_f32_16x16x32_bf16 v[96:99], v[36:39], a[196:199], v[96:99]
    buffer_store_dwordx4 v[144:147], v15, s[4:7], s35 offen offset:0 sc1
    v_mfma_f32_16x16x32_bf16 v[100:103], v[36:39], a[220:223], v[132:135]
    v_exp_f32 v19, v91
    v_mfma_f32_16x16x32_bf16 v[100:103], v[32:35], a[216:219], v[100:103]
    v_cvt_pk_bf16_f32 v88, v16, v17
    v_mfma_f32_16x16x32_bf16 v[104:107], v[32:35], a[240:243], v[136:139]
    ds_read_b128 v[28:31], v3 offset:6272
    v_mfma_f32_16x16x32_bf16 v[104:107], v[36:39], a[244:247], v[104:107]
    v_exp_f32 v16, v120
    v_mfma_f32_16x16x32_bf16 v[108:111], v[36:39], v[204:207], v[140:143]
    v_add_f32 v7, v7, v18
    v_add_f32 v7, v7, v19
    v_mfma_f32_16x16x32_bf16 v[108:111], v[32:35], v[200:203], v[108:111]
    s_waitcnt lgkmcnt(2)
    v_exp_f32 v17, v121
    v_mfma_f32_16x16x32_bf16 v[160:163], v[40:43], a[200:203], v[160:163]
    ds_read_b128 v[32:35], v2 offset:256
    v_cvt_pk_bf16_f32 v89, v18, v19
    v_mfma_f32_16x16x32_bf16 v[160:163], v[44:47], a[204:207], v[160:163]
    buffer_store_dwordx4 v[148:151], v15, s[4:7], s35 offen offset:1024 sc1
    v_mfma_f32_16x16x32_bf16 v[164:167], v[44:47], a[228:231], v[164:167]
    v_exp_f32 v18, v122
    v_mfma_f32_16x16x32_bf16 v[164:167], v[40:43], a[224:227], v[164:167]
    v_add_f32 v7, v7, v16
    v_add_f32 v7, v7, v17
    v_mfma_f32_16x16x32_bf16 v[168:171], v[40:43], a[248:251], v[168:171]
    ds_read_b128 v[36:39], v3 offset:256
    v_mfma_f32_16x16x32_bf16 v[168:171], v[44:47], a[252:255], v[168:171]
    v_exp_f32 v19, v123
    v_mfma_f32_16x16x32_bf16 v[172:175], v[44:47], v[212:215], v[172:175]
    v_cvt_pk_bf16_f32 v90, v16, v17
    v_mfma_f32_16x16x32_bf16 v[172:175], v[40:43], v[208:211], v[172:175]
    s_waitcnt lgkmcnt(2)
    v_exp_f32 v16, v92
    v_mfma_f32_16x16x32_bf16 v[96:99], v[24:27], a[200:203], v[96:99]
    ds_read_b128 v[40:43], v2 offset:6400
    v_add_f32 v7, v7, v18
    v_mfma_f32_16x16x32_bf16 v[96:99], v[28:31], a[204:207], v[96:99]
    buffer_store_dwordx4 v[152:155], v15, s[4:7], s35 offen offset:2048 sc1
    v_mfma_f32_16x16x32_bf16 v[100:103], v[28:31], a[228:231], v[100:103]
    v_add_f32 v7, v7, v19
    v_mfma_f32_16x16x32_bf16 v[100:103], v[24:27], a[224:227], v[100:103]
    v_exp_f32 v17, v93
    v_mfma_f32_16x16x32_bf16 v[104:107], v[24:27], a[248:251], v[104:107]
    ds_read_b128 v[44:47], v3 offset:6400
    v_cvt_pk_bf16_f32 v91, v18, v19
    v_mfma_f32_16x16x32_bf16 v[104:107], v[28:31], a[252:255], v[104:107]
    v_exp_f32 v18, v94
    v_mfma_f32_16x16x32_bf16 v[108:111], v[28:31], v[212:215], v[108:111]
    s_add_u32 s29, s30, 49152
    v_add_f32 v8, v8, v16
    v_add_f32 v8, v8, v17
    v_mfma_f32_16x16x32_bf16 v[108:111], v[24:27], v[208:211], v[108:111]
    s_waitcnt lgkmcnt(2)
    v_exp_f32 v19, v95
    v_mfma_f32_16x16x32_bf16 v[160:163], v[32:35], a[208:211], v[160:163]
    s_sub_u32 s3, s29, 147456
    ds_read_b128 v[24:27], v2 offset:12288
    v_cvt_pk_bf16_f32 v92, v16, v17
    v_mfma_f32_16x16x32_bf16 v[160:163], v[36:39], a[212:215], v[160:163]
    s_min_u32 s29, s29, s3
    v_exp_f32 v16, v124
    v_mfma_f32_16x16x32_bf16 v[164:167], v[36:39], a[236:239], v[164:167]
    v_add_f32 v8, v8, v18
    v_add_f32 v8, v8, v19
    v_mfma_f32_16x16x32_bf16 v[164:167], v[32:35], a[232:235], v[164:167]
    v_exp_f32 v17, v125
    v_mfma_f32_16x16x32_bf16 v[168:171], v[32:35], v[192:195], v[168:171]
    ds_read_b128 v[28:31], v3 offset:12288
    v_mfma_f32_16x16x32_bf16 v[168:171], v[36:39], v[196:199], v[168:171]
    v_cvt_pk_bf16_f32 v93, v18, v19
    v_mfma_f32_16x16x32_bf16 v[172:175], v[36:39], v[220:223], v[172:175]
    v_exp_f32 v18, v126
    v_mfma_f32_16x16x32_bf16 v[172:175], v[32:35], v[216:219], v[172:175]
    s_waitcnt lgkmcnt(2)
    v_add_f32 v8, v8, v16
    v_mfma_f32_16x16x32_bf16 v[96:99], v[40:43], a[208:211], v[96:99]
    s_waitcnt vmcnt(10)
    ds_read_b128 v[32:35], v2 offset:18432
    v_lshlrev_b32 v48, 16, v56
    v_mfma_f32_16x16x32_bf16 v[96:99], v[44:47], a[212:215], v[96:99]
    s_mov_b32 m0, s26
    v_add_f32 v8, v8, v17
    v_and_b32 v49, s97, v56
    v_mfma_f32_16x16x32_bf16 v[100:103], v[44:47], a[236:239], v[100:103]
    s_sub_u32 s3, s29, s30
    v_exp_f32 v19, v127
    v_mfma_f32_16x16x32_bf16 v[100:103], v[40:43], a[232:235], v[100:103]
    buffer_load_dwordx4 v4, s[4:7], s32 offen offset:0 sc1 lds
    v_mfma_f32_16x16x32_bf16 v[104:107], v[40:43], v[192:195], v[104:107]
    ds_read_b128 v[36:39], v3 offset:18432
    v_cvt_pk_bf16_f32 v94, v16, v17
    v_mfma_f32_16x16x32_bf16 v[104:107], v[44:47], v[196:199], v[104:107]
    v_add_f32 v8, v8, v18
    v_add_f32 v8, v8, v19
    v_mfma_f32_16x16x32_bf16 v[108:111], v[44:47], v[220:223], v[108:111]
    v_lshlrev_b32 v50, 16, v58
    v_cvt_pk_bf16_f32 v95, v18, v19
    v_mfma_f32_16x16x32_bf16 v[108:111], v[40:43], v[216:219], v[108:111]
    s_waitcnt lgkmcnt(2)
    buffer_load_dwordx4 v4, s[4:7], s32 offen offset:1024 sc1 lds
    v_mfma_f32_16x16x32_bf16 v[176:179], v[24:27], a[192:195], v[128:131]
    ds_read_b128 v[40:43], v2 offset:12416
    v_and_b32 v51, s97, v58
    v_mfma_f32_16x16x32_bf16 v[176:179], v[28:31], a[196:199], v[176:179]
    s_mov_b32 s30, s29
    v_exp_f32 v16, v160
    v_mfma_f32_16x16x32_bf16 v[180:183], v[28:31], a[220:223], v[132:135]
    v_exp_f32 v17, v161
    v_mfma_f32_16x16x32_bf16 v[180:183], v[24:27], a[216:219], v[180:183]
    buffer_load_dwordx4 v4, s[4:7], s32 offen offset:2048 sc1 lds
    v_mfma_f32_16x16x32_bf16 v[184:187], v[24:27], a[240:243], v[136:139]
    s_add_u32 s32, s32, 24576
    ds_read_b128 v[44:47], v3 offset:12416
    v_mul_f32 v48, s38, v48
    v_mfma_f32_16x16x32_bf16 v[184:187], v[28:31], a[244:247], v[184:187]
    v_exp_f32 v18, v162
    v_mfma_f32_16x16x32_bf16 v[188:191], v[28:31], v[204:207], v[140:143]
    s_add_u32 s26, s26, 12288
    v_add_f32 v5, v5, v16
    v_add_f32 v5, v5, v17
    v_mfma_f32_16x16x32_bf16 v[188:191], v[24:27], v[200:203], v[188:191]
    s_waitcnt lgkmcnt(2)
    v_exp_f32 v19, v163
    v_mfma_f32_16x16x32_bf16 v[112:115], v[32:35], a[192:195], v[128:131]
    s_mov_b32 m0, s26
    ds_read_b128 v[24:27], v2 offset:18560
    v_mul_f32 v49, s38, v49
    v_mfma_f32_16x16x32_bf16 v[112:115], v[36:39], a[196:199], v[112:115]
    v_cvt_pk_bf16_f32 v160, v16, v17
    v_mul_f32_e64 v50, -v50, v48
    v_mfma_f32_16x16x32_bf16 v[116:119], v[36:39], a[220:223], v[132:135]
    v_exp_f32 v16, v96
    v_mfma_f32_16x16x32_bf16 v[116:119], v[32:35], a[216:219], v[116:119]
    v_add_f32 v5, v5, v18
    v_mul_f32_e64 v51, -v51, v49
    v_mfma_f32_16x16x32_bf16 v[120:123], v[32:35], a[240:243], v[136:139]
    ds_read_b128 v[28:31], v3 offset:18560
    v_add_f32 v5, v5, v19
    v_mfma_f32_16x16x32_bf16 v[120:123], v[36:39], a[244:247], v[120:123]
    buffer_load_dwordx4 v4, s[4:7], s32 offen offset:0 sc1 lds
    v_mfma_f32_16x16x32_bf16 v[124:127], v[36:39], v[204:207], v[140:143]
    v_exp_f32 v17, v97
    v_mfma_f32_16x16x32_bf16 v[124:127], v[32:35], v[200:203], v[124:127]
    s_waitcnt lgkmcnt(2)
    v_cvt_pk_bf16_f32 v161, v18, v19
    v_cvt_f32_i32 v224, v224
    v_mfma_f32_16x16x32_bf16 v[176:179], v[40:43], a[200:203], v[176:179]
    ds_read_b128 v[32:35], v2 offset:12544
    v_cvt_f32_i32 v225, v225
    v_mfma_f32_16x16x32_bf16 v[176:179], v[44:47], a[204:207], v[176:179]
    buffer_load_dwordx4 v4, s[4:7], s32 offen offset:1024 sc1 lds
    v_mfma_f32_16x16x32_bf16 v[180:183], v[44:47], a[228:231], v[180:183]
    v_exp_f32 v18, v98
    v_mfma_f32_16x16x32_bf16 v[180:183], v[40:43], a[224:227], v[180:183]
    v_add_f32 v5, v5, v16
    v_add_f32 v5, v5, v17
    v_mfma_f32_16x16x32_bf16 v[184:187], v[40:43], a[248:251], v[184:187]
    ds_read_b128 v[36:39], v3 offset:12544
    v_fma_f32 v224, v224, v48, v50
    v_mfma_f32_16x16x32_bf16 v[184:187], v[44:47], a[252:255], v[184:187]
    buffer_load_dwordx4 v4, s[4:7], s32 offen offset:2048 sc1 lds
    v_mfma_f32_16x16x32_bf16 v[188:191], v[44:47], v[212:215], v[188:191]
    v_exp_f32 v19, v99
    v_mfma_f32_16x16x32_bf16 v[188:191], v[40:43], v[208:211], v[188:191]
    s_waitcnt lgkmcnt(2)
    v_cvt_pk_bf16_f32 v162, v16, v17
    v_fma_f32 v225, v225, v49, v51
    v_mfma_f32_16x16x32_bf16 v[112:115], v[24:27], a[200:203], v[112:115]
    ds_read_b128 v[40:43], v2 offset:18688
    v_add_u32 v1, s3, v1
    v_mfma_f32_16x16x32_bf16 v[112:115], v[28:31], a[204:207], v[112:115]
    v_exp_f32 v16, v164
    v_mfma_f32_16x16x32_bf16 v[116:119], v[28:31], a[228:231], v[116:119]
    v_add_f32 v5, v5, v18
    v_add_f32 v5, v5, v19
    v_mfma_f32_16x16x32_bf16 v[116:119], v[24:27], a[224:227], v[116:119]
    s_add_u32 s32, s32, 24576
    v_exp_f32 v17, v165
    v_mfma_f32_16x16x32_bf16 v[120:123], v[24:27], a[248:251], v[120:123]
    s_add_u32 s26, s26, 36864
    ds_read_b128 v[44:47], v3 offset:18688
    v_cvt_pk_bf16_f32 v163, v18, v19
    v_mfma_f32_16x16x32_bf16 v[120:123], v[28:31], a[252:255], v[120:123]
    s_waitcnt lgkmcnt(2)
    v_exp_f32 v18, v166
    v_mfma_f32_16x16x32_bf16 v[124:127], v[28:31], v[212:215], v[124:127]
    s_waitcnt vmcnt(6)
    v_cvt_pk_bf16_f32 v224, v224, v225
    v_add_f32 v6, v6, v16
    v_mfma_f32_16x16x32_bf16 v[124:127], v[24:27], v[208:211], v[124:127]
    s_barrier
    v_mfma_f32_16x16x32_bf16 v[176:179], v[32:35], a[208:211], v[176:179]
    s_sub_u32 s57, s26, 147456
    ds_read_b128 v[24:27], v1 offset:0
    v_add_f32 v6, v6, v17
    v_mfma_f32_16x16x32_bf16 v[176:179], v[36:39], a[212:215], v[176:179]
    s_min_u32 s26, s26, s57
    v_exp_f32 v19, v167
    v_mfma_f32_16x16x32_bf16 v[180:183], v[36:39], a[236:239], v[180:183]
    v_cvt_f32_i32 v228, v228
    v_cvt_pk_bf16_f32 v164, v16, v17
    v_mfma_f32_16x16x32_bf16 v[180:183], v[32:35], a[232:235], v[180:183]
    v_cvt_f32_i32 v229, v229
    v_fma_f32 v228, v228, v48, v50
    v_mfma_f32_16x16x32_bf16 v[184:187], v[32:35], v[192:195], v[184:187]
    ds_read_b128 v[28:31], v1 offset:12288
    v_fma_f32 v229, v229, v49, v51
    v_mfma_f32_16x16x32_bf16 v[184:187], v[36:39], v[196:199], v[184:187]
    v_exp_f32 v16, v100
    v_mfma_f32_16x16x32_bf16 v[188:191], v[36:39], v[220:223], v[188:191]
    v_add_f32 v6, v6, v18
    v_add_f32 v6, v6, v19
    v_mfma_f32_16x16x32_bf16 v[188:191], v[32:35], v[216:219], v[188:191]
    s_waitcnt lgkmcnt(2)
    v_exp_f32 v17, v101
    v_mfma_f32_16x16x32_bf16 v[112:115], v[40:43], a[208:211], v[112:115]
    ds_read_b128 v[32:35], v1 offset:1024
    v_cvt_pk_bf16_f32 v165, v18, v19
    v_mfma_f32_16x16x32_bf16 v[112:115], v[44:47], a[212:215], v[112:115]
    v_exp_f32 v18, v102
    v_mfma_f32_16x16x32_bf16 v[116:119], v[44:47], a[236:239], v[116:119]
    v_cvt_pk_bf16_f32 v228, v228, v229
    v_add_u32 v0, 1, v0
    v_mfma_f32_16x16x32_bf16 v[116:119], v[40:43], a[232:235], v[116:119]
    buffer_store_dword v0, v13, s[20:23], 0 offen offset:32 sc1
    v_mfma_f32_16x16x32_bf16 v[120:123], v[40:43], v[192:195], v[120:123]
    ds_read_b128 v[36:39], v1 offset:13312
    v_add_f32 v6, v6, v16
    v_mfma_f32_16x16x32_bf16 v[120:123], v[44:47], v[196:199], v[120:123]
    v_add_f32 v6, v6, v17
    v_cvt_f32_i32 v232, v232
    v_mfma_f32_16x16x32_bf16 v[124:127], v[44:47], v[220:223], v[124:127]
    v_exp_f32 v19, v103
    v_mfma_f32_16x16x32_bf16 v[124:127], v[40:43], v[216:219], v[124:127]
    s_waitcnt lgkmcnt(2)
    v_cvt_pk_bf16_f32 v166, v16, v17
    v_add_f32 v6, v6, v18
    v_cvt_f32_i32 v233, v233
    v_add_f32 v6, v6, v19
    v_fma_f32 v232, v232, v48, v50
    v_cvt_pk_bf16_f32 v167, v18, v19
    v_fma_f32 v233, v233, v49, v51
    v_mfma_f32_16x16x32_bf16 a[0:3], v[64:67], v[24:27], a[0:3]
    s_mov_b32 m0, s26
    ds_read_b128 v[40:43], v1 offset:2048
    v_cvt_pk_bf16_f32 v232, v232, v233
    v_mfma_f32_16x16x32_bf16 a[0:3], v[80:83], v[28:31], a[0:3]
    buffer_load_dwordx2 v[60:61], v10, s[72:75], s36 offen offset:192
    v_mfma_f32_16x16x32_bf16 a[48:51], v[84:87], v[28:31], a[48:51]
    v_exp_f32 v16, v168
    v_mfma_f32_16x16x32_bf16 a[48:51], v[68:71], v[24:27], a[48:51]
    v_exp_f32 v17, v169
    v_mfma_f32_16x16x32_bf16 a[96:99], v[72:75], v[24:27], a[96:99]
    ds_read_b128 v[44:47], v1 offset:14336
    v_cvt_f32_i32 v236, v236
    v_mfma_f32_16x16x32_bf16 a[96:99], v[88:91], v[28:31], a[96:99]
    buffer_load_dwordx4 v4, s[4:7], s32 offen offset:0 sc1 lds
    v_mfma_f32_16x16x32_bf16 a[144:147], v[92:95], v[28:31], a[144:147]
    v_exp_f32 v18, v170
    v_mfma_f32_16x16x32_bf16 a[144:147], v[76:79], v[24:27], a[144:147]
    s_waitcnt lgkmcnt(2)
    v_add_f32 v7, v7, v16
    v_add_f32 v7, v7, v17
    v_mfma_f32_16x16x32_bf16 a[4:7], v[64:67], v[32:35], a[4:7]
    ds_read_b128 v[24:27], v1 offset:3072
    v_cvt_f32_i32 v237, v237
    v_mfma_f32_16x16x32_bf16 a[4:7], v[80:83], v[36:39], a[4:7]
    buffer_load_dwordx2 v[62:63], v10, s[76:79], s36 offen offset:192
    v_mfma_f32_16x16x32_bf16 a[52:55], v[84:87], v[36:39], a[52:55]
    v_exp_f32 v19, v171
    v_mfma_f32_16x16x32_bf16 a[52:55], v[68:71], v[32:35], a[52:55]
    v_cvt_pk_bf16_f32 v168, v16, v17
    v_fma_f32 v236, v236, v48, v50
    v_mfma_f32_16x16x32_bf16 a[100:103], v[72:75], v[32:35], a[100:103]
    ds_read_b128 v[28:31], v1 offset:15360
    v_fma_f32 v237, v237, v49, v51
    v_mfma_f32_16x16x32_bf16 a[100:103], v[88:91], v[36:39], a[100:103]
    buffer_load_dwordx4 v[240:243], v9, s[64:67], s33 offen offset:384 nt
    v_mfma_f32_16x16x32_bf16 a[148:151], v[92:95], v[36:39], a[148:151]
    v_exp_f32 v16, v104
    v_mfma_f32_16x16x32_bf16 a[148:151], v[76:79], v[32:35], a[148:151]
    s_waitcnt lgkmcnt(2)
    v_add_f32 v7, v7, v18
    v_add_f32 v7, v7, v19
    v_mfma_f32_16x16x32_bf16 a[8:11], v[64:67], v[40:43], a[8:11]
    ds_read_b128 v[32:35], v1 offset:4096
    v_cvt_pk_bf16_f32 v236, v236, v237
    v_mfma_f32_16x16x32_bf16 a[8:11], v[80:83], v[44:47], a[8:11]
    buffer_load_dwordx4 v4, s[4:7], s32 offen offset:1024 sc1 lds
    v_mfma_f32_16x16x32_bf16 a[56:59], v[84:87], v[44:47], a[56:59]
    v_exp_f32 v17, v105
    v_mfma_f32_16x16x32_bf16 a[56:59], v[68:71], v[40:43], a[56:59]
    v_cvt_pk_bf16_f32 v169, v18, v19
    v_lshlrev_b32 v48, 16, v57
    v_mfma_f32_16x16x32_bf16 a[104:107], v[72:75], v[40:43], a[104:107]
    ds_read_b128 v[36:39], v1 offset:16384
    v_mfma_f32_16x16x32_bf16 a[104:107], v[88:91], v[44:47], a[104:107]
    buffer_load_dwordx4 v[244:247], v9, s[64:67], s33 offen offset:1920 nt
    v_mfma_f32_16x16x32_bf16 a[152:155], v[92:95], v[44:47], a[152:155]
    v_exp_f32 v18, v106
    v_mfma_f32_16x16x32_bf16 a[152:155], v[76:79], v[40:43], a[152:155]
    s_waitcnt lgkmcnt(2)
    v_add_f32 v7, v7, v16
    v_add_f32 v7, v7, v17
    v_mfma_f32_16x16x32_bf16 a[12:15], v[64:67], v[24:27], a[12:15]
    ds_read_b128 v[40:43], v1 offset:5120
    v_and_b32 v49, s97, v57
    v_mfma_f32_16x16x32_bf16 a[12:15], v[80:83], v[28:31], a[12:15]
    buffer_load_dwordx4 v4, s[4:7], s32 offen offset:2048 sc1 lds
    v_mfma_f32_16x16x32_bf16 a[60:63], v[84:87], v[28:31], a[60:63]
    v_exp_f32 v19, v107
    v_mfma_f32_16x16x32_bf16 a[60:63], v[68:71], v[24:27], a[60:63]
    v_cvt_pk_bf16_f32 v170, v16, v17
    v_exp_f32 v16, v172
    v_mfma_f32_16x16x32_bf16 a[108:111], v[72:75], v[24:27], a[108:111]
    ds_read_b128 v[44:47], v1 offset:17408
    v_add_f32 v7, v7, v18
    v_mfma_f32_16x16x32_bf16 a[108:111], v[88:91], v[28:31], a[108:111]
    buffer_load_dwordx4 v[248:251], v9, s[64:67], s34 offen offset:384 nt
    v_add_f32 v7, v7, v19
    v_mfma_f32_16x16x32_bf16 a[156:159], v[92:95], v[28:31], a[156:159]
    s_add_u32 s29, s28, 49152
    v_exp_f32 v17, v173
    v_mfma_f32_16x16x32_bf16 a[156:159], v[76:79], v[24:27], a[156:159]
    s_waitcnt lgkmcnt(2)
    v_cvt_pk_bf16_f32 v171, v18, v19
    v_lshlrev_b32 v50, 16, v59
    v_mfma_f32_16x16x32_bf16 a[16:19], v[64:67], v[32:35], a[16:19]
    s_sub_u32 s3, s29, 147456
    ds_read_b128 v[24:27], v1 offset:6144
    v_and_b32 v51, s97, v59
    v_mfma_f32_16x16x32_bf16 a[16:19], v[80:83], v[36:39], a[16:19]
    s_add_u32 s32, s32, 24576
    buffer_load_dwordx4 v[252:255], v9, s[64:67], s34 offen offset:1920 nt
    v_mfma_f32_16x16x32_bf16 a[64:67], v[84:87], v[36:39], a[64:67]
    s_min_u32 s29, s29, s3
    v_exp_f32 v18, v174
    v_mfma_f32_16x16x32_bf16 a[64:67], v[68:71], v[32:35], a[64:67]
    v_add_f32 v8, v8, v16
    v_add_f32 v8, v8, v17
    v_mfma_f32_16x16x32_bf16 a[112:115], v[72:75], v[32:35], a[112:115]
    s_add_u32 s26, s26, 12288
    ds_read_b128 v[28:31], v1 offset:18432
    v_mul_f32 v48, s38, v48
    v_mfma_f32_16x16x32_bf16 a[112:115], v[88:91], v[36:39], a[112:115]
    v_exp_f32 v19, v175
    v_cvt_pk_bf16_f32 v172, v16, v17
    v_mfma_f32_16x16x32_bf16 a[160:163], v[92:95], v[36:39], a[160:163]
    v_exp_f32 v16, v108
    v_mfma_f32_16x16x32_bf16 a[160:163], v[76:79], v[32:35], a[160:163]
    s_waitcnt lgkmcnt(2)
    v_add_f32 v8, v8, v18
    v_add_f32 v8, v8, v19
    v_mfma_f32_16x16x32_bf16 a[20:23], v[64:67], v[40:43], a[20:23]
    s_sub_u32 s3, s29, s28
    ds_read_b128 v[32:35], v1 offset:7168
    v_mul_f32 v49, s38, v49
    v_mfma_f32_16x16x32_bf16 a[20:23], v[80:83], v[44:47], a[20:23]
L_pg6:
    s_cbranch_execz L_pg10
    v_exp_f32 v17, v109
    v_mfma_f32_16x16x32_bf16 a[68:71], v[84:87], v[44:47], a[68:71]
    s_mov_b32 m0, s26
    v_cvt_pk_bf16_f32 v173, v18, v19
    v_mul_f32_e64 v50, -v50, v48
    v_mfma_f32_16x16x32_bf16 a[68:71], v[68:71], v[40:43], a[68:71]
    v_exp_f32 v18, v110
    v_mfma_f32_16x16x32_bf16 a[116:119], v[72:75], v[40:43], a[116:119]
    ds_read_b128 v[36:39], v1 offset:19456
    v_add_f32 v8, v8, v16
    v_mfma_f32_16x16x32_bf16 a[116:119], v[88:91], v[44:47], a[116:119]
    v_add_f32 v8, v8, v17
    v_mul_f32_e64 v51, -v51, v49
    v_mfma_f32_16x16x32_bf16 a[164:167], v[92:95], v[44:47], a[164:167]
    s_mov_b32 s28, s29
    v_exp_f32 v19, v111
    v_mfma_f32_16x16x32_bf16 a[164:167], v[76:79], v[40:43], a[164:167]
    s_waitcnt lgkmcnt(2)
    v_cvt_pk_bf16_f32 v174, v16, v17
    v_add_f32 v8, v8, v18
    v_mfma_f32_16x16x32_bf16 a[24:27], v[64:67], v[24:27], a[24:27]
    ds_read_b128 v[40:43], v1 offset:8192
    v_add_f32 v8, v8, v19
    v_mfma_f32_16x16x32_bf16 a[24:27], v[80:83], v[28:31], a[24:27]
    v_cvt_pk_bf16_f32 v175, v18, v19
    v_cvt_f32_i32 v226, v226
    v_mfma_f32_16x16x32_bf16 a[72:75], v[84:87], v[28:31], a[72:75]
    v_exp_f32 v16, v176
    v_mfma_f32_16x16x32_bf16 a[72:75], v[68:71], v[24:27], a[72:75]
    buffer_load_dwordx4 v4, s[4:7], s32 offen offset:0 sc1 lds
    v_mfma_f32_16x16x32_bf16 a[120:123], v[72:75], v[24:27], a[120:123]
    ds_read_b128 v[44:47], v1 offset:20480
    v_mfma_f32_16x16x32_bf16 a[120:123], v[88:91], v[28:31], a[120:123]
    v_exp_f32 v17, v177
    v_mfma_f32_16x16x32_bf16 a[168:171], v[92:95], v[28:31], a[168:171]
    v_exp_f32 v18, v178
    v_mfma_f32_16x16x32_bf16 a[168:171], v[76:79], v[24:27], a[168:171]
    s_waitcnt lgkmcnt(2)
    v_add_f32 v5, v5, v16
    v_add_f32 v5, v5, v17
    v_mfma_f32_16x16x32_bf16 a[28:31], v[64:67], v[32:35], a[28:31]
    ds_read_b128 v[24:27], v1 offset:9216
    v_cvt_f32_i32 v227, v227
    v_mfma_f32_16x16x32_bf16 a[28:31], v[80:83], v[36:39], a[28:31]
    v_exp_f32 v19, v179
    v_mfma_f32_16x16x32_bf16 a[76:79], v[84:87], v[36:39], a[76:79]
    v_cvt_pk_bf16_f32 v176, v16, v17
    v_add_u32 v2, s3, v2
    v_mfma_f32_16x16x32_bf16 a[76:79], v[68:71], v[32:35], a[76:79]
    v_exp_f32 v16, v112
    v_mfma_f32_16x16x32_bf16 a[124:127], v[72:75], v[32:35], a[124:127]
    ds_read_b128 v[28:31], v1 offset:21504
    v_add_f32 v5, v5, v18
    v_mfma_f32_16x16x32_bf16 a[124:127], v[88:91], v[36:39], a[124:127]
    v_add_f32 v5, v5, v19
    v_fma_f32 v226, v226, v48, v50
    v_mfma_f32_16x16x32_bf16 a[172:175], v[92:95], v[36:39], a[172:175]
    v_exp_f32 v17, v113
    v_mfma_f32_16x16x32_bf16 a[172:175], v[76:79], v[32:35], a[172:175]
    s_waitcnt lgkmcnt(2)
    buffer_load_dwordx4 v4, s[4:7], s32 offen offset:1024 sc1 lds
    v_mfma_f32_16x16x32_bf16 a[32:35], v[64:67], v[40:43], a[32:35]
    ds_read_b128 v[32:35], v1 offset:10240
    v_cvt_pk_bf16_f32 v177, v18, v19
    v_mfma_f32_16x16x32_bf16 a[32:35], v[80:83], v[44:47], a[32:35]
    v_exp_f32 v18, v114
    v_mfma_f32_16x16x32_bf16 a[80:83], v[84:87], v[44:47], a[80:83]
    v_add_f32 v5, v5, v16
    v_add_f32 v5, v5, v17
    v_mfma_f32_16x16x32_bf16 a[80:83], v[68:71], v[40:43], a[80:83]
    v_exp_f32 v19, v115
    v_mfma_f32_16x16x32_bf16 a[128:131], v[72:75], v[40:43], a[128:131]
    ds_read_b128 v[36:39], v1 offset:22528
    v_cvt_pk_bf16_f32 v178, v16, v17
    v_mfma_f32_16x16x32_bf16 a[128:131], v[88:91], v[44:47], a[128:131]
    v_exp_f32 v16, v180
    v_mfma_f32_16x16x32_bf16 a[176:179], v[92:95], v[44:47], a[176:179]
    v_fma_f32 v227, v227, v49, v51
    v_add_u32 v3, s3, v3
    v_mfma_f32_16x16x32_bf16 a[176:179], v[76:79], v[40:43], a[176:179]
    s_waitcnt lgkmcnt(2)
    v_add_f32 v5, v5, v18
    v_add_f32 v5, v5, v19
    v_mfma_f32_16x16x32_bf16 a[36:39], v[64:67], v[24:27], a[36:39]
    ds_read_b128 v[40:43], v1 offset:11264
    v_cvt_pk_bf16_f32 v225, v226, v227
    v_mfma_f32_16x16x32_bf16 a[36:39], v[80:83], v[28:31], a[36:39]
    buffer_load_dwordx4 v4, s[4:7], s32 offen offset:2048 sc1 lds
    v_mfma_f32_16x16x32_bf16 a[84:87], v[84:87], v[28:31], a[84:87]
    v_exp_f32 v17, v181
    v_mfma_f32_16x16x32_bf16 a[84:87], v[68:71], v[24:27], a[84:87]
    v_cvt_pk_bf16_f32 v179, v18, v19
    v_cvt_f32_i32 v230, v230
    v_mfma_f32_16x16x32_bf16 a[132:135], v[72:75], v[24:27], a[132:135]
    ds_read_b128 v[44:47], v1 offset:23552
    v_cvt_f32_i32 v231, v231
    v_mfma_f32_16x16x32_bf16 a[132:135], v[88:91], v[28:31], a[132:135]
    s_waitcnt lgkmcnt(2)
    v_exp_f32 v18, v182
    v_mfma_f32_16x16x32_bf16 a[180:183], v[92:95], v[28:31], a[180:183]
    s_waitcnt vmcnt(13)
    v_add_f32 v6, v6, v16
    v_add_f32 v6, v6, v17
    v_mfma_f32_16x16x32_bf16 a[180:183], v[76:79], v[24:27], a[180:183]
    s_barrier
    v_mfma_f32_16x16x32_bf16 a[40:43], v[64:67], v[32:35], a[40:43]
    ds_read_b128 v[24:27], v2 offset:0
    v_fma_f32 v230, v230, v48, v50
    v_mfma_f32_16x16x32_bf16 a[40:43], v[80:83], v[36:39], a[40:43]
    v_exp_f32 v19, v183
    v_mfma_f32_16x16x32_bf16 a[88:91], v[84:87], v[36:39], a[88:91]
    v_cvt_pk_bf16_f32 v180, v16, v17
    v_fma_f32 v231, v231, v49, v51
    v_mfma_f32_16x16x32_bf16 a[88:91], v[68:71], v[32:35], a[88:91]
    v_exp_f32 v16, v116
    v_mfma_f32_16x16x32_bf16 a[136:139], v[72:75], v[32:35], a[136:139]
    ds_read_b128 v[28:31], v3 offset:0
    v_add_f32 v6, v6, v18
    v_mfma_f32_16x16x32_bf16 a[136:139], v[88:91], v[36:39], a[136:139]
    v_add_f32 v6, v6, v19
    v_cvt_pk_bf16_f32 v229, v230, v231
    v_mfma_f32_16x16x32_bf16 a[184:187], v[92:95], v[36:39], a[184:187]
    v_exp_f32 v17, v117
    v_mfma_f32_16x16x32_bf16 a[184:187], v[76:79], v[32:35], a[184:187]
    s_waitcnt lgkmcnt(2)
    v_cvt_pk_bf16_f32 v181, v18, v19
    v_mfma_f32_16x16x32_bf16 a[44:47], v[64:67], v[40:43], a[44:47]
    ds_read_b128 v[32:35], v2 offset:6144
    v_mfma_f32_16x16x32_bf16 a[44:47], v[80:83], v[44:47], a[44:47]
    v_exp_f32 v18, v118
    v_mfma_f32_16x16x32_bf16 a[92:95], v[84:87], v[44:47], a[92:95]
    v_add_f32 v6, v6, v16
    v_add_f32 v6, v6, v17
    v_mfma_f32_16x16x32_bf16 a[92:95], v[68:71], v[40:43], a[92:95]
    s_add_u32 s32, s32, 24576
    v_exp_f32 v19, v119
    v_mfma_f32_16x16x32_bf16 a[140:143], v[72:75], v[40:43], a[140:143]
    s_add_u32 s26, s26, 36864
    ds_read_b128 v[36:39], v3 offset:6144
    v_cvt_pk_bf16_f32 v182, v16, v17
    v_mfma_f32_16x16x32_bf16 a[140:143], v[88:91], v[44:47], a[140:143]
    s_sub_u32 s57, s26, 147456
    v_add_f32 v6, v6, v18
    v_add_f32 v6, v6, v19
    v_mfma_f32_16x16x32_bf16 a[188:191], v[92:95], v[44:47], a[188:191]
    s_min_u32 s26, s26, s57
    v_cvt_pk_bf16_f32 v183, v18, v19
    v_mfma_f32_16x16x32_bf16 a[188:191], v[76:79], v[40:43], a[188:191]
    s_waitcnt lgkmcnt(2)
    v_mfma_f32_16x16x32_bf16 v[64:67], v[24:27], a[192:195], v[128:131]
    ds_read_b128 v[40:43], v2 offset:128
    v_cvt_f32_i32 v234, v234
    v_mfma_f32_16x16x32_bf16 v[64:67], v[28:31], a[196:199], v[64:67]
    v_exp_f32 v16, v184
    v_mfma_f32_16x16x32_bf16 v[68:71], v[28:31], a[220:223], v[132:135]
    v_exp_f32 v17, v185
    v_mfma_f32_16x16x32_bf16 v[68:71], v[24:27], a[216:219], v[68:71]
    buffer_load_dword v52, v20, s[20:23], s44 offen sc1
    v_mfma_f32_16x16x32_bf16 v[72:75], v[24:27], a[240:243], v[136:139]
    ds_read_b128 v[44:47], v3 offset:128
    v_cvt_f32_i32 v235, v235
    v_mfma_f32_16x16x32_bf16 v[72:75], v[28:31], a[244:247], v[72:75]
    v_exp_f32 v18, v186
    v_mfma_f32_16x16x32_bf16 v[76:79], v[28:31], v[204:207], v[140:143]
    v_add_f32 v7, v7, v16
    v_add_f32 v7, v7, v17
    v_mfma_f32_16x16x32_bf16 v[76:79], v[24:27], v[200:203], v[76:79]
    s_waitcnt lgkmcnt(2)
    v_exp_f32 v19, v187
    v_mfma_f32_16x16x32_bf16 v[96:99], v[32:35], a[192:195], v[128:131]
    ds_read_b128 v[24:27], v2 offset:6272
    v_cvt_pk_bf16_f32 v184, v16, v17
    v_mfma_f32_16x16x32_bf16 v[96:99], v[36:39], a[196:199], v[96:99]
    v_exp_f32 v16, v120
    v_mfma_f32_16x16x32_bf16 v[100:103], v[36:39], a[220:223], v[132:135]
    v_add_f32 v7, v7, v18
    v_fma_f32 v234, v234, v48, v50
    v_mfma_f32_16x16x32_bf16 v[100:103], v[32:35], a[216:219], v[100:103]
    s_add_u32 s35, s35, 196608
    s_mov_b32 m0, s26
    v_add_f32 v7, v7, v19
    v_mfma_f32_16x16x32_bf16 v[104:107], v[32:35], a[240:243], v[136:139]
    s_add_u32 s16, s16, 196608
    ds_read_b128 v[28:31], v3 offset:6272
    v_fma_f32 v235, v235, v49, v51
    v_mfma_f32_16x16x32_bf16 v[104:107], v[36:39], a[244:247], v[104:107]
    s_add_u32 s17, s17, 196608
    buffer_load_dwordx4 v4, s[4:7], s32 offen offset:0 sc1 lds
    v_mfma_f32_16x16x32_bf16 v[108:111], v[36:39], v[204:207], v[140:143]
    v_exp_f32 v17, v121
    v_mfma_f32_16x16x32_bf16 v[108:111], v[32:35], v[200:203], v[108:111]
    s_waitcnt lgkmcnt(2)
    v_cvt_pk_bf16_f32 v185, v18, v19
    v_cvt_pk_bf16_f32 v233, v234, v235
    v_mfma_f32_16x16x32_bf16 v[64:67], v[40:43], a[200:203], v[64:67]
    s_add_u32 s37, s37, 512
    ds_read_b128 v[32:35], v2 offset:256
    v_mfma_f32_16x16x32_bf16 v[64:67], v[44:47], a[204:207], v[64:67]
    v_exp_f32 v18, v122
    v_mfma_f32_16x16x32_bf16 v[68:71], v[44:47], a[228:231], v[68:71]
    v_add_f32 v7, v7, v16
    v_add_f32 v7, v7, v17
    v_mfma_f32_16x16x32_bf16 v[68:71], v[40:43], a[224:227], v[68:71]
    v_exp_f32 v19, v123
    v_mfma_f32_16x16x32_bf16 v[72:75], v[40:43], a[248:251], v[72:75]
    ds_read_b128 v[36:39], v3 offset:256
    v_cvt_pk_bf16_f32 v186, v16, v17
    v_mfma_f32_16x16x32_bf16 v[72:75], v[44:47], a[252:255], v[72:75]
    buffer_load_dwordx4 v4, s[4:7], s32 offen offset:1024 sc1 lds
    v_mfma_f32_16x16x32_bf16 v[76:79], v[44:47], v[212:215], v[76:79]
    v_exp_f32 v16, v188
    v_mfma_f32_16x16x32_bf16 v[76:79], v[40:43], v[208:211], v[76:79]
    s_waitcnt lgkmcnt(2)
    v_add_f32 v7, v7, v18
    v_add_f32 v7, v7, v19
    v_mfma_f32_16x16x32_bf16 v[96:99], v[24:27], a[200:203], v[96:99]
    ds_read_b128 v[40:43], v2 offset:6400
    v_cvt_f32_i32 v238, v238
    v_mfma_f32_16x16x32_bf16 v[96:99], v[28:31], a[204:207], v[96:99]
    buffer_load_dwordx2 v[56:57], off, s[80:83], s37 offset:0
    v_mfma_f32_16x16x32_bf16 v[100:103], v[28:31], a[228:231], v[100:103]
    v_exp_f32 v17, v189
    v_mfma_f32_16x16x32_bf16 v[100:103], v[24:27], a[224:227], v[100:103]
    v_cvt_pk_bf16_f32 v187, v18, v19
    v_cvt_f32_i32 v239, v239
    v_mfma_f32_16x16x32_bf16 v[104:107], v[24:27], a[248:251], v[104:107]
    ds_read_b128 v[44:47], v3 offset:6400
    v_mfma_f32_16x16x32_bf16 v[104:107], v[28:31], a[252:255], v[104:107]
    buffer_load_dwordx2 v[58:59], off, s[84:87], s37 offset:0
    v_mfma_f32_16x16x32_bf16 v[108:111], v[28:31], v[212:215], v[108:111]
    s_add_u32 s29, s30, 49152
    v_exp_f32 v18, v190
    v_mfma_f32_16x16x32_bf16 v[108:111], v[24:27], v[208:211], v[108:111]
    s_waitcnt lgkmcnt(2)
    v_add_f32 v8, v8, v16
    v_add_f32 v8, v8, v17
    v_mfma_f32_16x16x32_bf16 v[64:67], v[32:35], a[208:211], v[64:67]
    s_sub_u32 s3, s29, 147456
    ds_read_b128 v[24:27], v2 offset:12288
    v_mfma_f32_16x16x32_bf16 v[64:67], v[36:39], a[212:215], v[64:67]
    s_min_u32 s29, s29, s3
    buffer_load_dwordx4 v4, s[4:7], s32 offen offset:2048 sc1 lds
    v_mfma_f32_16x16x32_bf16 v[68:71], v[36:39], a[236:239], v[68:71]
    v_exp_f32 v19, v191
    v_mfma_f32_16x16x32_bf16 v[68:71], v[32:35], a[232:235], v[68:71]
    v_cvt_pk_bf16_f32 v188, v16, v17
    v_fma_f32 v238, v238, v48, v50
    v_mfma_f32_16x16x32_bf16 v[72:75], v[32:35], v[192:195], v[72:75]
    ds_read_b128 v[28:31], v3 offset:12288
    v_mfma_f32_16x16x32_bf16 v[72:75], v[36:39], v[196:199], v[72:75]
    buffer_load_dwordx3 v[144:146], v12, s[68:71], s35 offen offset:0 nt
    v_mfma_f32_16x16x32_bf16 v[76:79], v[36:39], v[220:223], v[76:79]
    v_exp_f32 v16, v124
    v_mfma_f32_16x16x32_bf16 v[76:79], v[32:35], v[216:219], v[76:79]
    s_waitcnt lgkmcnt(2)
    v_add_f32 v8, v8, v18
    v_add_f32 v8, v8, v19
    v_mfma_f32_16x16x32_bf16 v[96:99], v[40:43], a[208:211], v[96:99]
    s_add_u32 s32, s32, 24576
    ds_read_b128 v[32:35], v2 offset:18432
    v_fma_f32 v239, v239, v49, v51
    v_mfma_f32_16x16x32_bf16 v[96:99], v[44:47], a[212:215], v[96:99]
    s_sub_u32 s3, s29, s30
    v_exp_f32 v17, v125
    v_mfma_f32_16x16x32_bf16 v[100:103], v[44:47], a[236:239], v[100:103]
    v_cvt_pk_bf16_f32 v189, v18, v19
    v_mfma_f32_16x16x32_bf16 v[100:103], v[40:43], a[232:235], v[100:103]
    v_exp_f32 v18, v126
    v_mfma_f32_16x16x32_bf16 v[104:107], v[40:43], v[192:195], v[104:107]
    s_add_u32 s26, s26, 12288
    ds_read_b128 v[36:39], v3 offset:18432
    v_add_f32 v8, v8, v16
    v_mfma_f32_16x16x32_bf16 v[104:107], v[44:47], v[196:199], v[104:107]
    buffer_load_dwordx3 v[148:150], v12, s[68:71], s35 offen offset:768 nt
    v_mfma_f32_16x16x32_bf16 v[108:111], v[44:47], v[220:223], v[108:111]
    v_add_f32 v8, v8, v17
    v_cvt_pk_bf16_f32 v237, v238, v239
    v_mfma_f32_16x16x32_bf16 v[108:111], v[40:43], v[216:219], v[108:111]
    s_waitcnt lgkmcnt(2)
    v_exp_f32 v19, v127
    v_mfma_f32_16x16x32_bf16 v[80:83], v[24:27], a[192:195], v[128:131]
    ds_read_b128 v[40:43], v2 offset:12416
    v_cvt_pk_bf16_f32 v190, v16, v17
    v_mfma_f32_16x16x32_bf16 v[80:83], v[28:31], a[196:199], v[80:83]
    s_mov_b32 m0, s26
    v_add_f32 v8, v8, v18
    v_add_f32 v8, v8, v19
    v_mfma_f32_16x16x32_bf16 v[84:87], v[28:31], a[220:223], v[132:135]
    s_mov_b32 s30, s29
    v_cvt_pk_bf16_f32 v191, v18, v19
    v_mfma_f32_16x16x32_bf16 v[84:87], v[24:27], a[216:219], v[84:87]
    v_exp_f32 v16, v64
    v_mfma_f32_16x16x32_bf16 v[88:91], v[24:27], a[240:243], v[136:139]
    ds_read_b128 v[44:47], v3 offset:12416
    v_mfma_f32_16x16x32_bf16 v[88:91], v[28:31], a[244:247], v[88:91]
    buffer_load_dwordx3 v[152:154], v12, s[68:71], s35 offen offset:1536 nt
    v_mfma_f32_16x16x32_bf16 v[92:95], v[28:31], v[204:207], v[140:143]
    v_exp_f32 v17, v65
    v_mfma_f32_16x16x32_bf16 v[92:95], v[24:27], v[200:203], v[92:95]
    s_waitcnt lgkmcnt(2)
    v_exp_f32 v18, v66
    v_mfma_f32_16x16x32_bf16 v[112:115], v[32:35], a[192:195], v[128:131]
    ds_read_b128 v[24:27], v2 offset:18560
    v_add_f32 v5, v5, v16
    v_mfma_f32_16x16x32_bf16 v[112:115], v[36:39], a[196:199], v[112:115]
    buffer_load_dwordx4 v4, s[4:7], s32 offen offset:0 sc1 lds
    v_mfma_f32_16x16x32_bf16 v[116:119], v[36:39], a[220:223], v[132:135]
    v_add_f32 v5, v5, v17
    v_add_u32 v1, s3, v1
    v_mfma_f32_16x16x32_bf16 v[116:119], v[32:35], a[216:219], v[116:119]
    v_exp_f32 v19, v67
    v_mfma_f32_16x16x32_bf16 v[120:123], v[32:35], a[240:243], v[136:139]
    ds_read_b128 v[28:31], v3 offset:18560
    v_cvt_pk_bf16_f32 v64, v16, v17
    v_mfma_f32_16x16x32_bf16 v[120:123], v[36:39], a[244:247], v[120:123]
    s_waitcnt vmcnt(13)
    buffer_load_dwordx3 v[156:158], v12, s[68:71], s35 offen offset:2304 nt
    v_mfma_f32_16x16x32_bf16 v[124:127], v[36:39], v[204:207], v[140:143]
    v_exp_f32 v16, v96
    v_mfma_f32_16x16x32_bf16 v[124:127], v[32:35], v[200:203], v[124:127]
    s_waitcnt lgkmcnt(2)
    v_add_f32 v5, v5, v18
    v_add_f32 v5, v5, v19
    v_mfma_f32_16x16x32_bf16 v[80:83], v[40:43], a[200:203], v[80:83]
    ds_read_b128 v[32:35], v2 offset:12544
    v_lshlrev_b32 v48, 16, v60
    v_mfma_f32_16x16x32_bf16 v[80:83], v[44:47], a[204:207], v[80:83]
    v_exp_f32 v17, v97
    v_mfma_f32_16x16x32_bf16 v[84:87], v[44:47], a[228:231], v[84:87]
    v_cvt_pk_bf16_f32 v65, v18, v19
    v_and_b32 v49, s97, v60
    v_mfma_f32_16x16x32_bf16 v[84:87], v[40:43], a[224:227], v[84:87]
    buffer_load_dwordx4 v4, s[4:7], s32 offen offset:1024 sc1 lds
    v_mfma_f32_16x16x32_bf16 v[88:91], v[40:43], a[248:251], v[88:91]
    ds_read_b128 v[36:39], v3 offset:12544
    v_lshlrev_b32 v50, 16, v62
    v_mfma_f32_16x16x32_bf16 v[88:91], v[44:47], a[252:255], v[88:91]
    v_exp_f32 v18, v98
    v_mfma_f32_16x16x32_bf16 v[92:95], v[44:47], v[212:215], v[92:95]
    v_add_f32 v5, v5, v16
    v_add_f32 v5, v5, v17
    v_mfma_f32_16x16x32_bf16 v[92:95], v[40:43], v[208:211], v[92:95]
    s_waitcnt lgkmcnt(2)
    v_exp_f32 v19, v99
    v_mfma_f32_16x16x32_bf16 v[112:115], v[24:27], a[200:203], v[112:115]
    ds_read_b128 v[40:43], v2 offset:18688
    v_cvt_pk_bf16_f32 v66, v16, v17
    v_mfma_f32_16x16x32_bf16 v[112:115], v[28:31], a[204:207], v[112:115]
    v_exp_f32 v16, v68
    v_mfma_f32_16x16x32_bf16 v[116:119], v[28:31], a[228:231], v[116:119]
    v_add_f32 v5, v5, v18
    v_add_f32 v5, v5, v19
    v_mfma_f32_16x16x32_bf16 v[116:119], v[24:27], a[224:227], v[116:119]
    v_exp_f32 v17, v69
    v_mfma_f32_16x16x32_bf16 v[120:123], v[24:27], a[248:251], v[120:123]
    ds_read_b128 v[44:47], v3 offset:18688
    v_cvt_pk_bf16_f32 v67, v18, v19
    v_mfma_f32_16x16x32_bf16 v[120:123], v[28:31], a[252:255], v[120:123]
    s_waitcnt lgkmcnt(2)
    buffer_load_dwordx4 v4, s[4:7], s32 offen offset:2048 sc1 lds
    v_mfma_f32_16x16x32_bf16 v[124:127], v[28:31], v[212:215], v[124:127]
    s_waitcnt vmcnt(13)
    v_exp_f32 v18, v70
    v_mfma_f32_16x16x32_bf16 v[124:127], v[24:27], v[208:211], v[124:127]
    s_barrier
    v_mfma_f32_16x16x32_bf16 v[80:83], v[32:35], a[208:211], v[80:83]
    ds_read_b128 v[24:27], v1 offset:0
    v_add_f32 v6, v6, v16
    v_mfma_f32_16x16x32_bf16 v[80:83], v[36:39], a[212:215], v[80:83]
    v_add_f32 v6, v6, v17
    v_and_b32 v51, s97, v62
    v_mfma_f32_16x16x32_bf16 v[84:87], v[36:39], a[236:239], v[84:87]
    v_exp_f32 v19, v71
    v_mfma_f32_16x16x32_bf16 v[84:87], v[32:35], a[232:235], v[84:87]
    v_cvt_pk_bf16_f32 v68, v16, v17
    v_mul_f32 v48, s38, v48
    v_mfma_f32_16x16x32_bf16 v[88:91], v[32:35], v[192:195], v[88:91]
    ds_read_b128 v[28:31], v1 offset:12288
    v_mul_f32 v49, s38, v49
    v_mfma_f32_16x16x32_bf16 v[88:91], v[36:39], v[196:199], v[88:91]
    v_exp_f32 v16, v100
    v_mfma_f32_16x16x32_bf16 v[92:95], v[36:39], v[220:223], v[92:95]
    v_add_f32 v6, v6, v18
    v_add_f32 v6, v6, v19
    v_mfma_f32_16x16x32_bf16 v[92:95], v[32:35], v[216:219], v[92:95]
    s_waitcnt lgkmcnt(2)
    v_exp_f32 v17, v101
    v_mfma_f32_16x16x32_bf16 v[112:115], v[40:43], a[208:211], v[112:115]
    ds_read_b128 v[32:35], v1 offset:1024
    v_cvt_pk_bf16_f32 v69, v18, v19
    v_mfma_f32_16x16x32_bf16 v[112:115], v[44:47], a[212:215], v[112:115]
    v_exp_f32 v18, v102
    v_mfma_f32_16x16x32_bf16 v[116:119], v[44:47], a[236:239], v[116:119]
    v_add_f32 v6, v6, v16
    v_add_f32 v6, v6, v17
    v_mfma_f32_16x16x32_bf16 v[116:119], v[40:43], a[232:235], v[116:119]
    v_exp_f32 v19, v103
    v_mfma_f32_16x16x32_bf16 v[120:123], v[40:43], v[192:195], v[120:123]
    ds_read_b128 v[36:39], v1 offset:13312
    v_cvt_pk_bf16_f32 v70, v16, v17
    v_mfma_f32_16x16x32_bf16 v[120:123], v[44:47], v[196:199], v[120:123]
    s_add_u32 s32, s32, 24576
    v_add_f32 v6, v6, v18
    s_add_u32 s26, s26, 36864
    v_mfma_f32_16x16x32_bf16 v[124:127], v[44:47], v[220:223], v[124:127]
    s_sub_u32 s57, s26, 147456
    v_add_f32 v6, v6, v19
    v_cvt_pk_bf16_f32 v71, v18, v19
    v_mfma_f32_16x16x32_bf16 v[124:127], v[40:43], v[216:219], v[124:127]
    s_waitcnt lgkmcnt(2)
    s_min_u32 s26, s26, s57
    v_mfma_f32_16x16x32_bf16 a[0:3], v[160:163], v[24:27], a[0:3]
    ds_read_b128 v[40:43], v1 offset:2048
    v_mul_f32_e64 v50, -v50, v48
    v_mfma_f32_16x16x32_bf16 a[0:3], v[176:179], v[28:31], a[0:3]
    s_waitcnt vmcnt(12)
    v_subrev_u32 v52, s92, v52
    v_cmp_lt_u32 vcc, 15, v52
    v_mfma_f32_16x16x32_bf16 a[48:51], v[180:183], v[28:31], a[48:51]
    v_exp_f32 v16, v72
    v_mfma_f32_16x16x32_bf16 a[48:51], v[164:167], v[24:27], a[48:51]
    v_exp_f32 v17, v73
    v_mfma_f32_16x16x32_bf16 a[96:99], v[168:171], v[24:27], a[96:99]
    s_and_b32 s59, vcc_lo, 0xff
    ds_read_b128 v[44:47], v1 offset:14336
    v_mul_f32_e64 v51, -v51, v49
    v_mfma_f32_16x16x32_bf16 a[96:99], v[184:187], v[28:31], a[96:99]
    s_cbranch_scc1 L_pollslow2
L_pollok2:
    v_mfma_f32_16x16x32_bf16 a[144:147], v[188:191], v[28:31], a[144:147]
    s_add_u32 s92, s92, 1
    v_exp_f32 v18, v74
    v_mfma_f32_16x16x32_bf16 a[144:147], v[172:175], v[24:27], a[144:147]
    s_waitcnt lgkmcnt(2)
    v_add_f32 v7, v7, v16
    v_add_f32 v7, v7, v17
    v_mfma_f32_16x16x32_bf16 a[4:7], v[160:163], v[32:35], a[4:7]
    s_mov_b32 m0, s56
    ds_read_b128 v[24:27], v1 offset:3072
    v_cvt_f32_i32 v240, v240
    v_mfma_f32_16x16x32_bf16 a[4:7], v[176:179], v[36:39], a[4:7]
    buffer_load_dwordx4 v4, s[4:7], s27 offen offset:0 sc1 lds
    v_mfma_f32_16x16x32_bf16 a[52:55], v[180:183], v[36:39], a[52:55]
    v_exp_f32 v19, v75
    v_mfma_f32_16x16x32_bf16 a[52:55], v[164:167], v[32:35], a[52:55]
    v_cvt_pk_bf16_f32 v72, v16, v17
    v_cvt_f32_i32 v241, v241
    v_mfma_f32_16x16x32_bf16 a[100:103], v[168:171], v[32:35], a[100:103]
    ds_read_b128 v[28:31], v1 offset:15360
    v_fma_f32 v240, v240, v48, v50
    v_mfma_f32_16x16x32_bf16 a[100:103], v[184:187], v[36:39], a[100:103]
    v_exp_f32 v16, v104
    v_mfma_f32_16x16x32_bf16 a[148:151], v[188:191], v[36:39], a[148:151]
    v_add_f32 v7, v7, v18
    v_add_f32 v7, v7, v19
    v_mfma_f32_16x16x32_bf16 a[148:151], v[172:175], v[32:35], a[148:151]
    s_waitcnt lgkmcnt(2)
    v_exp_f32 v17, v105
    v_mfma_f32_16x16x32_bf16 a[8:11], v[160:163], v[40:43], a[8:11]
    ds_read_b128 v[32:35], v1 offset:4096
    v_cvt_pk_bf16_f32 v73, v18, v19
    v_mfma_f32_16x16x32_bf16 a[8:11], v[176:179], v[44:47], a[8:11]
    buffer_load_dwordx4 v4, s[4:7], s27 offen offset:1024 sc1 lds
    v_mfma_f32_16x16x32_bf16 a[56:59], v[180:183], v[44:47], a[56:59]
    v_exp_f32 v18, v106
    v_mfma_f32_16x16x32_bf16 a[56:59], v[164:167], v[40:43], a[56:59]
    v_add_f32 v7, v7, v16
    v_fma_f32 v241, v241, v49, v51
    v_mfma_f32_16x16x32_bf16 a[104:107], v[168:171], v[40:43], a[104:107]
    ds_read_b128 v[36:39], v1 offset:16384
    v_add_f32 v7, v7, v17
    v_mfma_f32_16x16x32_bf16 a[104:107], v[184:187], v[44:47], a[104:107]
    v_exp_f32 v19, v107
    v_mfma_f32_16x16x32_bf16 a[152:155], v[188:191], v[44:47], a[152:155]
    v_cvt_pk_bf16_f32 v74, v16, v17
    v_cvt_pk_bf16_f32 v226, v240, v241
    v_mfma_f32_16x16x32_bf16 a[152:155], v[172:175], v[40:43], a[152:155]
    s_waitcnt lgkmcnt(2)
    v_exp_f32 v16, v76
    v_mfma_f32_16x16x32_bf16 a[12:15], v[160:163], v[24:27], a[12:15]
    ds_read_b128 v[40:43], v1 offset:5120
    v_add_f32 v7, v7, v18
    v_mfma_f32_16x16x32_bf16 a[12:15], v[176:179], v[28:31], a[12:15]
    buffer_load_dwordx4 v4, s[4:7], s27 offen offset:2048 sc1 lds
    v_mfma_f32_16x16x32_bf16 a[60:63], v[180:183], v[28:31], a[60:63]
    v_add_f32 v7, v7, v19
    v_cvt_f32_i32 v244, v244
    v_mfma_f32_16x16x32_bf16 a[60:63], v[164:167], v[24:27], a[60:63]
    v_exp_f32 v17, v77
    v_mfma_f32_16x16x32_bf16 a[108:111], v[168:171], v[24:27], a[108:111]
    ds_read_b128 v[44:47], v1 offset:17408
    v_cvt_pk_bf16_f32 v75, v18, v19
    v_mfma_f32_16x16x32_bf16 a[108:111], v[184:187], v[28:31], a[108:111]
    v_exp_f32 v18, v78
    v_mfma_f32_16x16x32_bf16 a[156:159], v[188:191], v[28:31], a[156:159]
    s_add_u32 s29, s28, 49152
    v_cvt_f32_i32 v245, v245
    v_fma_f32 v244, v244, v48, v50
    v_mfma_f32_16x16x32_bf16 a[156:159], v[172:175], v[24:27], a[156:159]
    s_waitcnt lgkmcnt(2)
    v_add_f32 v8, v8, v16
    v_add_f32 v8, v8, v17
    v_mfma_f32_16x16x32_bf16 a[16:19], v[160:163], v[32:35], a[16:19]
    s_sub_u32 s3, s29, 147456
    ds_read_b128 v[24:27], v1 offset:6144
    v_fma_f32 v245, v245, v49, v51
    v_mfma_f32_16x16x32_bf16 a[16:19], v[176:179], v[36:39], a[16:19]
    s_add_u32 s27, s27, 24576
    v_exp_f32 v19, v79
    v_mfma_f32_16x16x32_bf16 a[64:67], v[180:183], v[36:39], a[64:67]
    s_min_u32 s29, s29, s3
    v_cvt_pk_bf16_f32 v76, v16, v17
    v_cvt_pk_bf16_f32 v230, v244, v245
    v_mfma_f32_16x16x32_bf16 a[64:67], v[164:167], v[32:35], a[64:67]
    s_add_u32 s56, s56, 12288
    v_exp_f32 v16, v108
    v_mfma_f32_16x16x32_bf16 a[112:115], v[168:171], v[32:35], a[112:115]
    ds_read_b128 v[28:31], v1 offset:18432
    v_add_f32 v8, v8, v18
    v_mfma_f32_16x16x32_bf16 a[112:115], v[184:187], v[36:39], a[112:115]
    v_add_f32 v8, v8, v19
    v_cvt_f32_i32 v248, v248
    v_mfma_f32_16x16x32_bf16 a[160:163], v[188:191], v[36:39], a[160:163]
    v_exp_f32 v17, v109
    v_mfma_f32_16x16x32_bf16 a[160:163], v[172:175], v[32:35], a[160:163]
    s_waitcnt lgkmcnt(2)
    v_cvt_f32_i32 v249, v249
    v_cvt_pk_bf16_f32 v77, v18, v19
    v_mfma_f32_16x16x32_bf16 a[20:23], v[160:163], v[40:43], a[20:23]
    s_mov_b32 m0, s56
    ds_read_b128 v[32:35], v1 offset:7168
    v_fma_f32 v248, v248, v48, v50
    v_mfma_f32_16x16x32_bf16 a[20:23], v[176:179], v[44:47], a[20:23]
    s_sub_u32 s3, s29, s28
    v_exp_f32 v18, v110
    v_mfma_f32_16x16x32_bf16 a[68:71], v[180:183], v[44:47], a[68:71]
    v_add_f32 v8, v8, v16
    v_add_f32 v8, v8, v17
    v_mfma_f32_16x16x32_bf16 a[68:71], v[164:167], v[40:43], a[68:71]
    v_exp_f32 v19, v111
    v_mfma_f32_16x16x32_bf16 a[116:119], v[168:171], v[40:43], a[116:119]
    ds_read_b128 v[36:39], v1 offset:19456
    v_fma_f32 v249, v249, v49, v51
    v_mfma_f32_16x16x32_bf16 a[116:119], v[184:187], v[44:47], a[116:119]
    buffer_load_dwordx4 v4, s[4:7], s27 offen offset:0 sc1 lds
    v_mfma_f32_16x16x32_bf16 a[164:167], v[188:191], v[44:47], a[164:167]
    s_mov_b32 s28, s29
    v_cvt_pk_bf16_f32 v78, v16, v17
    v_add_f32 v8, v8, v18
    v_mfma_f32_16x16x32_bf16 a[164:167], v[172:175], v[40:43], a[164:167]
    s_waitcnt lgkmcnt(2)
    v_add_f32 v8, v8, v19
    v_cvt_pk_bf16_f32 v234, v248, v249
    v_mfma_f32_16x16x32_bf16 a[24:27], v[160:163], v[24:27], a[24:27]
    ds_read_b128 v[40:43], v1 offset:8192
    v_cvt_pk_bf16_f32 v79, v18, v19
    v_mfma_f32_16x16x32_bf16 a[24:27], v[176:179], v[28:31], a[24:27]
    v_exp_f32 v16, v80
    v_mfma_f32_16x16x32_bf16 a[72:75], v[180:183], v[28:31], a[72:75]
    v_cvt_f32_i32 v252, v252
    v_cvt_f32_i32 v253, v253
    v_mfma_f32_16x16x32_bf16 a[72:75], v[164:167], v[24:27], a[72:75]
    v_exp_f32 v17, v81
    v_mfma_f32_16x16x32_bf16 a[120:123], v[168:171], v[24:27], a[120:123]
    ds_read_b128 v[44:47], v1 offset:20480
    v_fma_f32 v252, v252, v48, v50
    v_mfma_f32_16x16x32_bf16 a[120:123], v[184:187], v[28:31], a[120:123]
    v_exp_f32 v18, v82
    v_mfma_f32_16x16x32_bf16 a[168:171], v[188:191], v[28:31], a[168:171]
    v_add_f32 v5, v5, v16
    v_add_f32 v5, v5, v17
    v_mfma_f32_16x16x32_bf16 a[168:171], v[172:175], v[24:27], a[168:171]
    s_waitcnt lgkmcnt(2)
    buffer_load_dwordx4 v4, s[4:7], s27 offen offset:1024 sc1 lds
    v_mfma_f32_16x16x32_bf16 a[28:31], v[160:163], v[32:35], a[28:31]
    ds_read_b128 v[24:27], v1 offset:9216
    v_fma_f32 v253, v253, v49, v51
    v_mfma_f32_16x16x32_bf16 a[28:31], v[176:179], v[36:39], a[28:31]
    v_exp_f32 v19, v83
    v_mfma_f32_16x16x32_bf16 a[76:79], v[180:183], v[36:39], a[76:79]
    v_cvt_pk_bf16_f32 v80, v16, v17
    v_cvt_pk_bf16_f32 v238, v252, v253
    v_mfma_f32_16x16x32_bf16 a[76:79], v[164:167], v[32:35], a[76:79]
    v_exp_f32 v16, v112
    v_mfma_f32_16x16x32_bf16 a[124:127], v[168:171], v[32:35], a[124:127]
    ds_read_b128 v[28:31], v1 offset:21504
    v_add_f32 v5, v5, v18
    v_mfma_f32_16x16x32_bf16 a[124:127], v[184:187], v[36:39], a[124:127]
    v_add_f32 v5, v5, v19
    v_lshlrev_b32 v48, 16, v61
    v_mfma_f32_16x16x32_bf16 a[172:175], v[188:191], v[36:39], a[172:175]
    v_exp_f32 v17, v113
    v_mfma_f32_16x16x32_bf16 a[172:175], v[172:175], v[32:35], a[172:175]
    s_waitcnt lgkmcnt(2)
    buffer_load_dwordx4 v4, s[4:7], s27 offen offset:2048 sc1 lds
    v_mfma_f32_16x16x32_bf16 a[32:35], v[160:163], v[40:43], a[32:35]
    ds_read_b128 v[32:35], v1 offset:10240
    v_cvt_pk_bf16_f32 v81, v18, v19
    v_mfma_f32_16x16x32_bf16 a[32:35], v[176:179], v[44:47], a[32:35]
    v_exp_f32 v18, v114
    v_mfma_f32_16x16x32_bf16 a[80:83], v[180:183], v[44:47], a[80:83]
    v_add_f32 v5, v5, v16
    v_and_b32 v49, s97, v61
    v_mfma_f32_16x16x32_bf16 a[80:83], v[164:167], v[40:43], a[80:83]
    v_add_f32 v5, v5, v17
    v_lshlrev_b32 v50, 16, v63
    v_mfma_f32_16x16x32_bf16 a[128:131], v[168:171], v[40:43], a[128:131]
    ds_read_b128 v[36:39], v1 offset:22528
    v_add_u32 v2, s3, v2
    v_mfma_f32_16x16x32_bf16 a[128:131], v[184:187], v[44:47], a[128:131]
    v_exp_f32 v19, v115
    v_mfma_f32_16x16x32_bf16 a[176:179], v[188:191], v[44:47], a[176:179]
    v_cvt_pk_bf16_f32 v82, v16, v17
    v_and_b32 v51, s97, v63
    v_mfma_f32_16x16x32_bf16 a[176:179], v[172:175], v[40:43], a[176:179]
    s_waitcnt lgkmcnt(2)
    v_exp_f32 v16, v84
    v_mfma_f32_16x16x32_bf16 a[36:39], v[160:163], v[24:27], a[36:39]
    ds_read_b128 v[40:43], v1 offset:11264
    v_add_f32 v5, v5, v18
    v_mfma_f32_16x16x32_bf16 a[36:39], v[176:179], v[28:31], a[36:39]
    v_add_f32 v5, v5, v19
    v_mul_f32 v48, s38, v48
    v_mfma_f32_16x16x32_bf16 a[84:87], v[180:183], v[28:31], a[84:87]
    v_exp_f32 v17, v85
    v_mfma_f32_16x16x32_bf16 a[84:87], v[164:167], v[24:27], a[84:87]
    s_add_u32 s27, s27, 24576
    v_add_u32 v3, s3, v3
    v_cvt_pk_bf16_f32 v83, v18, v19
    v_mfma_f32_16x16x32_bf16 a[132:135], v[168:171], v[24:27], a[132:135]
L_pg7:
    s_cbranch_execz L_pg11
    s_add_u32 s56, s56, 36864
    ds_read_b128 v[44:47], v1 offset:23552
    v_mul_f32 v49, s38, v49
    v_mfma_f32_16x16x32_bf16 a[132:135], v[184:187], v[28:31], a[132:135]
    s_sub_u32 s58, s56, 147456
    v_exp_f32 v18, v86
    v_mfma_f32_16x16x32_bf16 a[180:183], v[188:191], v[28:31], a[180:183]
    v_add_f32 v6, v6, v16
    v_add_f32 v6, v6, v17
    v_mfma_f32_16x16x32_bf16 a[180:183], v[172:175], v[24:27], a[180:183]
    s_waitcnt lgkmcnt(2)
    v_mul_f32_e64 v50, -v50, v48
    v_mul_f32_e64 v51, -v51, v49
    v_mfma_f32_16x16x32_bf16 a[40:43], v[160:163], v[32:35], a[40:43]
    s_min_u32 s56, s56, s58
    ds_read_b128 v[24:27], v2 offset:0
    v_cvt_f32_i32 v242, v242
    v_mfma_f32_16x16x32_bf16 a[40:43], v[176:179], v[36:39], a[40:43]
    v_exp_f32 v19, v87
    v_mfma_f32_16x16x32_bf16 a[88:91], v[180:183], v[36:39], a[88:91]
    v_cvt_pk_bf16_f32 v84, v16, v17
    v_cvt_f32_i32 v243, v243
    v_mfma_f32_16x16x32_bf16 a[88:91], v[164:167], v[32:35], a[88:91]
    v_exp_f32 v16, v116
    v_mfma_f32_16x16x32_bf16 a[136:139], v[168:171], v[32:35], a[136:139]
    ds_read_b128 v[28:31], v3 offset:0
    v_add_f32 v6, v6, v18
    v_mfma_f32_16x16x32_bf16 a[136:139], v[184:187], v[36:39], a[136:139]
    v_add_f32 v6, v6, v19
    v_fma_f32 v242, v242, v48, v50
    v_mfma_f32_16x16x32_bf16 a[184:187], v[188:191], v[36:39], a[184:187]
    v_exp_f32 v17, v117
    v_mfma_f32_16x16x32_bf16 a[184:187], v[172:175], v[32:35], a[184:187]
    s_waitcnt lgkmcnt(2)
    v_cvt_pk_bf16_f32 v85, v18, v19
    v_fma_f32 v243, v243, v49, v51
    v_mfma_f32_16x16x32_bf16 a[44:47], v[160:163], v[40:43], a[44:47]
    ds_read_b128 v[32:35], v2 offset:6144
    v_cvt_pk_bf16_f32 v227, v242, v243
    v_mfma_f32_16x16x32_bf16 a[44:47], v[176:179], v[44:47], a[44:47]
    v_exp_f32 v18, v118
    v_mfma_f32_16x16x32_bf16 a[92:95], v[180:183], v[44:47], a[92:95]
    v_add_f32 v6, v6, v16
    v_add_f32 v6, v6, v17
    v_mfma_f32_16x16x32_bf16 a[92:95], v[164:167], v[40:43], a[92:95]
    v_exp_f32 v19, v119
    v_mfma_f32_16x16x32_bf16 a[140:143], v[168:171], v[40:43], a[140:143]
    s_sub_u32 s31, s31, 1
    ds_read_b128 v[36:39], v3 offset:6144
    v_cvt_pk_bf16_f32 v86, v16, v17
    v_mfma_f32_16x16x32_bf16 a[140:143], v[184:187], v[44:47], a[140:143]
    v_add_f32 v6, v6, v18
    v_add_f32 v6, v6, v19
    v_mfma_f32_16x16x32_bf16 a[188:191], v[188:191], v[44:47], a[188:191]
    s_waitcnt lgkmcnt(2)
    s_cmp_lg_u32 s31, 0
    v_cvt_pk_bf16_f32 v87, v18, v19
    v_cvt_f32_i32 v246, v246
    v_mfma_f32_16x16x32_bf16 a[188:191], v[172:175], v[40:43], a[188:191]
    s_cbranch_scc1 L_loop
    v_mfma_f32_16x16x32_bf16 v[160:163], v[24:27], a[192:195], v[128:131]
    s_mov_b32 m0, s56
    ds_read_b128 v[40:43], v2 offset:128
    v_cvt_f32_i32 v247, v247
    v_mfma_f32_16x16x32_bf16 v[160:163], v[28:31], a[196:199], v[160:163]
    buffer_load_dwordx4 v4, s[4:7], s27 offen offset:0 sc1 lds
    v_mfma_f32_16x16x32_bf16 v[164:167], v[28:31], a[220:223], v[132:135]
    v_exp_f32 v16, v88
    v_mfma_f32_16x16x32_bf16 v[164:167], v[24:27], a[216:219], v[164:167]
    v_exp_f32 v17, v89
    v_mfma_f32_16x16x32_bf16 v[168:171], v[24:27], a[240:243], v[136:139]
    ds_read_b128 v[44:47], v3 offset:128
    v_fma_f32 v246, v246, v48, v50
    v_mfma_f32_16x16x32_bf16 v[168:171], v[28:31], a[244:247], v[168:171]
    v_exp_f32 v18, v90
    v_mfma_f32_16x16x32_bf16 v[172:175], v[28:31], v[204:207], v[140:143]
    v_fma_f32 v247, v247, v49, v51
    v_add_f32 v7, v7, v16
    v_mfma_f32_16x16x32_bf16 v[172:175], v[24:27], v[200:203], v[172:175]
    s_waitcnt lgkmcnt(2)
    v_add_f32 v7, v7, v17
    v_cvt_pk_bf16_f32 v231, v246, v247
    v_mfma_f32_16x16x32_bf16 v[96:99], v[32:35], a[192:195], v[128:131]
    ds_read_b128 v[24:27], v2 offset:6272
    v_cvt_f32_i32 v250, v250
    v_mfma_f32_16x16x32_bf16 v[96:99], v[36:39], a[196:199], v[96:99]
    buffer_load_dwordx4 v4, s[4:7], s27 offen offset:1024 sc1 lds
    v_mfma_f32_16x16x32_bf16 v[100:103], v[36:39], a[220:223], v[132:135]
    v_exp_f32 v19, v91
    v_mfma_f32_16x16x32_bf16 v[100:103], v[32:35], a[216:219], v[100:103]
    v_cvt_pk_bf16_f32 v88, v16, v17
    v_cvt_f32_i32 v251, v251
    v_mfma_f32_16x16x32_bf16 v[104:107], v[32:35], a[240:243], v[136:139]
    ds_read_b128 v[28:31], v3 offset:6272
    v_fma_f32 v250, v250, v48, v50
    v_mfma_f32_16x16x32_bf16 v[104:107], v[36:39], a[244:247], v[104:107]
    v_exp_f32 v16, v120
    v_mfma_f32_16x16x32_bf16 v[108:111], v[36:39], v[204:207], v[140:143]
    v_add_f32 v7, v7, v18
    v_add_f32 v7, v7, v19
    v_mfma_f32_16x16x32_bf16 v[108:111], v[32:35], v[200:203], v[108:111]
    s_waitcnt lgkmcnt(2)
    v_exp_f32 v17, v121
    v_mfma_f32_16x16x32_bf16 v[160:163], v[40:43], a[200:203], v[160:163]
    ds_read_b128 v[32:35], v2 offset:256
    v_cvt_pk_bf16_f32 v89, v18, v19
    v_mfma_f32_16x16x32_bf16 v[160:163], v[44:47], a[204:207], v[160:163]
    v_exp_f32 v18, v122
    v_mfma_f32_16x16x32_bf16 v[164:167], v[44:47], a[228:231], v[164:167]
    v_fma_f32 v251, v251, v49, v51
    v_add_f32 v7, v7, v16
    v_mfma_f32_16x16x32_bf16 v[164:167], v[40:43], a[224:227], v[164:167]
    buffer_load_dwordx4 v4, s[4:7], s27 offen offset:2048 sc1 lds
    v_mfma_f32_16x16x32_bf16 v[168:171], v[40:43], a[248:251], v[168:171]
    ds_read_b128 v[36:39], v3 offset:256
    v_cvt_pk_bf16_f32 v235, v250, v251
    v_mfma_f32_16x16x32_bf16 v[168:171], v[44:47], a[252:255], v[168:171]
    v_add_f32 v7, v7, v17
    v_cvt_f32_i32 v254, v254
    v_mfma_f32_16x16x32_bf16 v[172:175], v[44:47], v[212:215], v[172:175]
    v_exp_f32 v19, v123
    v_mfma_f32_16x16x32_bf16 v[172:175], v[40:43], v[208:211], v[172:175]
    s_waitcnt lgkmcnt(2)
    v_cvt_pk_bf16_f32 v90, v16, v17
    v_cvt_f32_i32 v255, v255
    v_mfma_f32_16x16x32_bf16 v[96:99], v[24:27], a[200:203], v[96:99]
    ds_read_b128 v[40:43], v2 offset:6400
    v_fma_f32 v254, v254, v48, v50
    v_mfma_f32_16x16x32_bf16 v[96:99], v[28:31], a[204:207], v[96:99]
    s_add_u32 s27, s27, 24576
    v_exp_f32 v16, v92
    v_mfma_f32_16x16x32_bf16 v[100:103], v[28:31], a[228:231], v[100:103]
    v_add_f32 v7, v7, v18
    v_add_f32 v7, v7, v19
    v_mfma_f32_16x16x32_bf16 v[100:103], v[24:27], a[224:227], v[100:103]
    v_exp_f32 v17, v93
    v_mfma_f32_16x16x32_bf16 v[104:107], v[24:27], a[248:251], v[104:107]
    ds_read_b128 v[44:47], v3 offset:6400
    v_fma_f32 v255, v255, v49, v51
    v_mfma_f32_16x16x32_bf16 v[104:107], v[28:31], a[252:255], v[104:107]
    v_cvt_pk_bf16_f32 v91, v18, v19
    v_cvt_pk_bf16_f32 v239, v254, v255
    v_mfma_f32_16x16x32_bf16 v[108:111], v[28:31], v[212:215], v[108:111]
    s_add_u32 s29, s30, 49152
    v_exp_f32 v18, v94
    v_mfma_f32_16x16x32_bf16 v[108:111], v[24:27], v[208:211], v[108:111]
    s_waitcnt lgkmcnt(2)
    v_add_f32 v8, v8, v16
    v_add_f32 v8, v8, v17
    v_mfma_f32_16x16x32_bf16 v[160:163], v[32:35], a[208:211], v[160:163]
    s_waitcnt vmcnt(11)
    ds_read_b128 v[24:27], v2 offset:12288
    v_lshlrev_b32 v48, 16, v56
    v_mfma_f32_16x16x32_bf16 v[160:163], v[36:39], a[212:215], v[160:163]
    s_sub_u32 s3, s29, 147456
    buffer_load_dwordx2 v[60:61], off, s[80:83], s37 offset:8
    v_mfma_f32_16x16x32_bf16 v[164:167], v[36:39], a[236:239], v[164:167]
    s_add_u32 s56, s56, 12288
    v_exp_f32 v19, v95
    v_mfma_f32_16x16x32_bf16 v[164:167], v[32:35], a[232:235], v[164:167]
    s_min_u32 s29, s29, s3
    v_cvt_pk_bf16_f32 v92, v16, v17
    v_and_b32 v49, s97, v56
    v_mfma_f32_16x16x32_bf16 v[168:171], v[32:35], v[192:195], v[168:171]
    s_mov_b32 m0, s56
    ds_read_b128 v[28:31], v3 offset:12288
    v_mfma_f32_16x16x32_bf16 v[168:171], v[36:39], v[196:199], v[168:171]
    buffer_load_dwordx2 v[62:63], off, s[84:87], s37 offset:8
    v_mfma_f32_16x16x32_bf16 v[172:175], v[36:39], v[220:223], v[172:175]
    v_exp_f32 v16, v124
    v_mfma_f32_16x16x32_bf16 v[172:175], v[32:35], v[216:219], v[172:175]
    s_waitcnt lgkmcnt(2)
    v_add_f32 v8, v8, v18
    v_add_f32 v8, v8, v19
    v_mfma_f32_16x16x32_bf16 v[96:99], v[40:43], a[208:211], v[96:99]
    ds_read_b128 v[32:35], v2 offset:18432
    v_lshlrev_b32 v50, 16, v58
    v_mfma_f32_16x16x32_bf16 v[96:99], v[44:47], a[212:215], v[96:99]
    s_sub_u32 s3, s29, s30
    v_exp_f32 v17, v125
    v_mfma_f32_16x16x32_bf16 v[100:103], v[44:47], a[236:239], v[100:103]
    v_cvt_pk_bf16_f32 v93, v18, v19
    v_mfma_f32_16x16x32_bf16 v[100:103], v[40:43], a[232:235], v[100:103]
    buffer_load_dwordx4 v4, s[4:7], s27 offen offset:0 sc1 lds
    v_mfma_f32_16x16x32_bf16 v[104:107], v[40:43], v[192:195], v[104:107]
    ds_read_b128 v[36:39], v3 offset:18432
    v_mfma_f32_16x16x32_bf16 v[104:107], v[44:47], v[196:199], v[104:107]
    v_exp_f32 v18, v126
    v_mfma_f32_16x16x32_bf16 v[108:111], v[44:47], v[220:223], v[108:111]
    v_add_f32 v8, v8, v16
    v_add_f32 v8, v8, v17
    v_mfma_f32_16x16x32_bf16 v[108:111], v[40:43], v[216:219], v[108:111]
    s_waitcnt lgkmcnt(2)
    buffer_load_dwordx3 v[240:242], v12, s[68:71], s16 offen offset:0 nt
    v_mfma_f32_16x16x32_bf16 v[176:179], v[24:27], a[192:195], v[128:131]
    ds_read_b128 v[40:43], v2 offset:12416
    v_and_b32 v51, s97, v58
    v_mfma_f32_16x16x32_bf16 v[176:179], v[28:31], a[196:199], v[176:179]
    v_exp_f32 v19, v127
    v_cvt_pk_bf16_f32 v94, v16, v17
    v_mfma_f32_16x16x32_bf16 v[180:183], v[28:31], a[220:223], v[132:135]
    s_mov_b32 s30, s29
    v_add_f32 v8, v8, v18
    v_add_f32 v8, v8, v19
    v_mfma_f32_16x16x32_bf16 v[180:183], v[24:27], a[216:219], v[180:183]
    buffer_load_dwordx4 v4, s[4:7], s27 offen offset:1024 sc1 lds
    v_mfma_f32_16x16x32_bf16 v[184:187], v[24:27], a[240:243], v[136:139]
    ds_read_b128 v[44:47], v3 offset:12416
    v_cvt_pk_bf16_f32 v95, v18, v19
    v_mfma_f32_16x16x32_bf16 v[184:187], v[28:31], a[244:247], v[184:187]
    v_exp_f32 v16, v160
    v_mfma_f32_16x16x32_bf16 v[188:191], v[28:31], v[204:207], v[140:143]
    v_exp_f32 v17, v161
    v_mfma_f32_16x16x32_bf16 v[188:191], v[24:27], v[200:203], v[188:191]
    s_waitcnt lgkmcnt(2)
    buffer_load_dwordx3 v[244:246], v12, s[68:71], s16 offen offset:768 nt
    v_mfma_f32_16x16x32_bf16 v[112:115], v[32:35], a[192:195], v[128:131]
    ds_read_b128 v[24:27], v2 offset:18560
    v_mul_f32_e64 v50, -v50, v48
    v_mfma_f32_16x16x32_bf16 v[112:115], v[36:39], a[196:199], v[112:115]
    v_exp_f32 v18, v162
    v_mfma_f32_16x16x32_bf16 v[116:119], v[36:39], a[220:223], v[132:135]
    v_add_f32 v5, v5, v16
    v_add_f32 v5, v5, v17
    v_mfma_f32_16x16x32_bf16 v[116:119], v[32:35], a[216:219], v[116:119]
    v_exp_f32 v19, v163
    v_mfma_f32_16x16x32_bf16 v[120:123], v[32:35], a[240:243], v[136:139]
    ds_read_b128 v[28:31], v3 offset:18560
    v_cvt_pk_bf16_f32 v160, v16, v17
    v_mfma_f32_16x16x32_bf16 v[120:123], v[36:39], a[244:247], v[120:123]
    buffer_load_dwordx3 v[248:250], v12, s[68:71], s16 offen offset:1536 nt
    v_mfma_f32_16x16x32_bf16 v[124:127], v[36:39], v[204:207], v[140:143]
    v_exp_f32 v16, v96
    v_mfma_f32_16x16x32_bf16 v[124:127], v[32:35], v[200:203], v[124:127]
    s_waitcnt lgkmcnt(2)
    v_add_f32 v5, v5, v18
    v_add_f32 v5, v5, v19
    v_mfma_f32_16x16x32_bf16 v[176:179], v[40:43], a[200:203], v[176:179]
    ds_read_b128 v[32:35], v2 offset:12544
    v_mul_f32_e64 v51, -v51, v49
    v_mfma_f32_16x16x32_bf16 v[176:179], v[44:47], a[204:207], v[176:179]
    buffer_load_dwordx4 v4, s[4:7], s27 offen offset:2048 sc1 lds
    v_mfma_f32_16x16x32_bf16 v[180:183], v[44:47], a[228:231], v[180:183]
    v_exp_f32 v17, v97
    v_mfma_f32_16x16x32_bf16 v[180:183], v[40:43], a[224:227], v[180:183]
    v_cvt_pk_bf16_f32 v161, v18, v19
    v_add_u32 v1, s3, v1
    v_mfma_f32_16x16x32_bf16 v[184:187], v[40:43], a[248:251], v[184:187]
    ds_read_b128 v[36:39], v3 offset:12544
    v_cvt_f32_i32 v144, v144
    v_mfma_f32_16x16x32_bf16 v[184:187], v[44:47], a[252:255], v[184:187]
    buffer_load_dwordx3 v[252:254], v12, s[68:71], s16 offen offset:2304 nt
    v_mfma_f32_16x16x32_bf16 v[188:191], v[44:47], v[212:215], v[188:191]
    v_exp_f32 v18, v98
    v_mfma_f32_16x16x32_bf16 v[188:191], v[40:43], v[208:211], v[188:191]
    s_waitcnt lgkmcnt(2)
    v_add_f32 v5, v5, v16
    v_add_f32 v5, v5, v17
    v_mfma_f32_16x16x32_bf16 v[112:115], v[24:27], a[200:203], v[112:115]
    ds_read_b128 v[40:43], v2 offset:18688
    v_cvt_f32_i32 v148, v148
    v_mfma_f32_16x16x32_bf16 v[112:115], v[28:31], a[204:207], v[112:115]
    v_exp_f32 v19, v99
    v_cvt_pk_bf16_f32 v162, v16, v17
    v_mfma_f32_16x16x32_bf16 v[116:119], v[28:31], a[228:231], v[116:119]
    v_exp_f32 v16, v164
    v_mfma_f32_16x16x32_bf16 v[116:119], v[24:27], a[224:227], v[116:119]
    s_add_u32 s27, s27, 24576
    v_add_f32 v5, v5, v18
    v_add_f32 v5, v5, v19
    v_mfma_f32_16x16x32_bf16 v[120:123], v[24:27], a[248:251], v[120:123]
    s_add_u32 s56, s56, 36864
    ds_read_b128 v[44:47], v3 offset:18688
    v_fma_f32 v144, v144, v48, v50
    v_mfma_f32_16x16x32_bf16 v[120:123], v[28:31], a[252:255], v[120:123]
    s_waitcnt lgkmcnt(2)
    v_exp_f32 v17, v165
    v_mfma_f32_16x16x32_bf16 v[124:127], v[28:31], v[212:215], v[124:127]
    s_waitcnt vmcnt(12)
    v_cvt_pk_bf16_f32 v163, v18, v19
    s_sub_u32 s58, s56, 147456
    v_mfma_f32_16x16x32_bf16 v[124:127], v[24:27], v[208:211], v[124:127]
    s_barrier
    v_mfma_f32_16x16x32_bf16 v[176:179], v[32:35], a[208:211], v[176:179]
    s_min_u32 s56, s56, s58
    ds_read_b128 v[24:27], v1 offset:0
    v_mfma_f32_16x16x32_bf16 v[176:179], v[36:39], a[212:215], v[176:179]
    v_exp_f32 v18, v166
    v_mfma_f32_16x16x32_bf16 v[180:183], v[36:39], a[236:239], v[180:183]
    v_add_f32 v6, v6, v16
    v_add_f32 v6, v6, v17
    v_mfma_f32_16x16x32_bf16 v[180:183], v[32:35], a[232:235], v[180:183]
    v_exp_f32 v19, v167
    v_mfma_f32_16x16x32_bf16 v[184:187], v[32:35], v[192:195], v[184:187]
    ds_read_b128 v[28:31], v1 offset:12288
    v_cvt_pk_bf16_f32 v164, v16, v17
    v_mfma_f32_16x16x32_bf16 v[184:187], v[36:39], v[196:199], v[184:187]
    v_exp_f32 v16, v100
    v_mfma_f32_16x16x32_bf16 v[188:191], v[36:39], v[220:223], v[188:191]
    v_add_f32 v6, v6, v18
    v_add_f32 v6, v6, v19
    v_mfma_f32_16x16x32_bf16 v[188:191], v[32:35], v[216:219], v[188:191]
    s_waitcnt lgkmcnt(2)
    v_exp_f32 v17, v101
    v_mfma_f32_16x16x32_bf16 v[112:115], v[40:43], a[208:211], v[112:115]
    ds_read_b128 v[32:35], v1 offset:1024
    v_cvt_pk_bf16_f32 v165, v18, v19
    v_mfma_f32_16x16x32_bf16 v[112:115], v[44:47], a[212:215], v[112:115]
    v_exp_f32 v18, v102
    v_mfma_f32_16x16x32_bf16 v[116:119], v[44:47], a[236:239], v[116:119]
    v_add_f32 v6, v6, v16
    v_add_f32 v6, v6, v17
    v_mfma_f32_16x16x32_bf16 v[116:119], v[40:43], a[232:235], v[116:119]
    v_exp_f32 v19, v103
    v_mfma_f32_16x16x32_bf16 v[120:123], v[40:43], v[192:195], v[120:123]
    ds_read_b128 v[36:39], v1 offset:13312
    v_cvt_pk_bf16_f32 v166, v16, v17
    v_mfma_f32_16x16x32_bf16 v[120:123], v[44:47], v[196:199], v[120:123]
    v_add_f32 v6, v6, v18
    v_fma_f32 v148, v148, v49, v51
    v_mfma_f32_16x16x32_bf16 v[124:127], v[44:47], v[220:223], v[124:127]
    v_add_f32 v6, v6, v19
    v_cvt_pk_bf16_f32 v167, v18, v19
    v_mfma_f32_16x16x32_bf16 v[124:127], v[40:43], v[216:219], v[124:127]
    s_waitcnt lgkmcnt(2)
    v_mfma_f32_16x16x32_bf16 a[0:3], v[64:67], v[24:27], a[0:3]
    ds_read_b128 v[40:43], v1 offset:2048
    v_cvt_f32_i32 v145, v145
    v_mfma_f32_16x16x32_bf16 a[0:3], v[80:83], v[28:31], a[0:3]
    buffer_store_dwordx4 v[224:227], v11, s[4:7], s33 offen offset:0 sc1
    v_mfma_f32_16x16x32_bf16 a[48:51], v[84:87], v[28:31], a[48:51]
    v_exp_f32 v16, v168
    v_mfma_f32_16x16x32_bf16 a[48:51], v[68:71], v[24:27], a[48:51]
    v_exp_f32 v17, v169
    v_mfma_f32_16x16x32_bf16 a[96:99], v[72:75], v[24:27], a[96:99]
    ds_read_b128 v[44:47], v1 offset:14336
    v_cvt_f32_i32 v149, v149
    v_mfma_f32_16x16x32_bf16 a[96:99], v[88:91], v[28:31], a[96:99]
    v_exp_f32 v18, v170
    v_mfma_f32_16x16x32_bf16 a[144:147], v[92:95], v[28:31], a[144:147]
    v_add_f32 v7, v7, v16
    v_add_f32 v7, v7, v17
    v_mfma_f32_16x16x32_bf16 a[144:147], v[76:79], v[24:27], a[144:147]
    s_waitcnt lgkmcnt(2)
    v_exp_f32 v19, v171
    v_mfma_f32_16x16x32_bf16 a[4:7], v[64:67], v[32:35], a[4:7]
    ds_read_b128 v[24:27], v1 offset:3072
    v_cvt_pk_bf16_f32 v168, v16, v17
    v_mfma_f32_16x16x32_bf16 a[4:7], v[80:83], v[36:39], a[4:7]
    buffer_store_dwordx4 v[228:231], v21, s[4:7], s33 offen offset:768 sc1
    v_mfma_f32_16x16x32_bf16 a[52:55], v[84:87], v[36:39], a[52:55]
    v_exp_f32 v16, v104
    v_mfma_f32_16x16x32_bf16 a[52:55], v[68:71], v[32:35], a[52:55]
    v_add_f32 v7, v7, v18
    v_fma_f32 v145, v145, v48, v50
    v_mfma_f32_16x16x32_bf16 a[100:103], v[72:75], v[32:35], a[100:103]
    ds_read_b128 v[28:31], v1 offset:15360
    v_add_f32 v7, v7, v19
    v_mfma_f32_16x16x32_bf16 a[100:103], v[88:91], v[36:39], a[100:103]
    v_exp_f32 v17, v105
    v_mfma_f32_16x16x32_bf16 a[148:151], v[92:95], v[36:39], a[148:151]
    v_cvt_pk_bf16_f32 v169, v18, v19
    v_fma_f32 v149, v149, v49, v51
    v_mfma_f32_16x16x32_bf16 a[148:151], v[76:79], v[32:35], a[148:151]
    s_waitcnt lgkmcnt(2)
    v_exp_f32 v18, v106
    v_mfma_f32_16x16x32_bf16 a[8:11], v[64:67], v[40:43], a[8:11]
    ds_read_b128 v[32:35], v1 offset:4096
    v_add_f32 v7, v7, v16
    v_mfma_f32_16x16x32_bf16 a[8:11], v[80:83], v[44:47], a[8:11]
    buffer_store_dwordx4 v[232:235], v22, s[4:7], s33 offen offset:1536 sc1
    v_mfma_f32_16x16x32_bf16 a[56:59], v[84:87], v[44:47], a[56:59]
    v_add_f32 v7, v7, v17
    v_cvt_f32_i32 v146, v146
    v_mfma_f32_16x16x32_bf16 a[56:59], v[68:71], v[40:43], a[56:59]
    v_exp_f32 v19, v107
    v_mfma_f32_16x16x32_bf16 a[104:107], v[72:75], v[40:43], a[104:107]
    ds_read_b128 v[36:39], v1 offset:16384
    v_cvt_pk_bf16_f32 v170, v16, v17
    v_mfma_f32_16x16x32_bf16 a[104:107], v[88:91], v[44:47], a[104:107]
    v_exp_f32 v16, v172
    v_mfma_f32_16x16x32_bf16 a[152:155], v[92:95], v[44:47], a[152:155]
    v_add_f32 v7, v7, v18
    v_cvt_f32_i32 v150, v150
    v_mfma_f32_16x16x32_bf16 a[152:155], v[76:79], v[40:43], a[152:155]
    s_waitcnt lgkmcnt(2)
    v_add_f32 v7, v7, v19
    v_fma_f32 v146, v146, v48, v50
    v_mfma_f32_16x16x32_bf16 a[12:15], v[64:67], v[24:27], a[12:15]
    ds_read_b128 v[40:43], v1 offset:5120
    v_mfma_f32_16x16x32_bf16 a[12:15], v[80:83], v[28:31], a[12:15]
    buffer_store_dwordx4 v[236:239], v23, s[4:7], s33 offen offset:2304 sc1
    v_mfma_f32_16x16x32_bf16 a[60:63], v[84:87], v[28:31], a[60:63]
    v_exp_f32 v17, v173
    v_mfma_f32_16x16x32_bf16 a[60:63], v[68:71], v[24:27], a[60:63]
    v_cvt_pk_bf16_f32 v171, v18, v19
    v_fma_f32 v150, v150, v49, v51
    v_mfma_f32_16x16x32_bf16 a[108:111], v[72:75], v[24:27], a[108:111]
    ds_read_b128 v[44:47], v1 offset:17408
    v_mfma_f32_16x16x32_bf16 a[108:111], v[88:91], v[28:31], a[108:111]
    v_exp_f32 v18, v174
    v_mfma_f32_16x16x32_bf16 a[156:159], v[92:95], v[28:31], a[156:159]
    s_add_u32 s29, s28, 49152
    v_add_f32 v8, v8, v16
    v_add_f32 v8, v8, v17
    v_mfma_f32_16x16x32_bf16 a[156:159], v[76:79], v[24:27], a[156:159]
    s_waitcnt lgkmcnt(2)
    v_exp_f32 v19, v175
    v_mfma_f32_16x16x32_bf16 a[16:19], v[64:67], v[32:35], a[16:19]
    s_sub_u32 s3, s29, 147456
    ds_read_b128 v[24:27], v1 offset:6144
    v_cvt_pk_bf16_f32 v172, v16, v17
    v_mfma_f32_16x16x32_bf16 a[16:19], v[80:83], v[36:39], a[16:19]
    s_mov_b32 m0, s26
    v_exp_f32 v16, v108
    v_mfma_f32_16x16x32_bf16 a[64:67], v[84:87], v[36:39], a[64:67]
    s_min_u32 s29, s29, s3
    v_add_f32 v8, v8, v18
    v_lshlrev_b32 v48, 16, v57
    v_mfma_f32_16x16x32_bf16 a[64:67], v[68:71], v[32:35], a[64:67]
    buffer_load_dwordx4 v4, s[4:7], s32 offen offset:0 sc1 lds
    v_mfma_f32_16x16x32_bf16 a[112:115], v[72:75], v[32:35], a[112:115]
    ds_read_b128 v[28:31], v1 offset:18432
    v_add_f32 v8, v8, v19
    v_mfma_f32_16x16x32_bf16 a[112:115], v[88:91], v[36:39], a[112:115]
    v_exp_f32 v17, v109
    v_mfma_f32_16x16x32_bf16 a[160:163], v[92:95], v[36:39], a[160:163]
    v_cvt_pk_bf16_f32 v173, v18, v19
    v_and_b32 v49, s97, v57
    v_mfma_f32_16x16x32_bf16 a[160:163], v[76:79], v[32:35], a[160:163]
    s_waitcnt lgkmcnt(2)
    buffer_load_dwordx4 v4, s[4:7], s32 offen offset:1024 sc1 lds
    v_mfma_f32_16x16x32_bf16 a[20:23], v[64:67], v[40:43], a[20:23]
    s_sub_u32 s3, s29, s28
    ds_read_b128 v[32:35], v1 offset:7168
    v_lshlrev_b32 v50, 16, v59
    v_mfma_f32_16x16x32_bf16 a[20:23], v[80:83], v[44:47], a[20:23]
    v_exp_f32 v18, v110
    v_mfma_f32_16x16x32_bf16 a[68:71], v[84:87], v[44:47], a[68:71]
    v_add_f32 v8, v8, v16
    v_add_f32 v8, v8, v17
    v_mfma_f32_16x16x32_bf16 a[68:71], v[68:71], v[40:43], a[68:71]
    buffer_load_dwordx4 v4, s[4:7], s32 offen offset:2048 sc1 lds
    v_mfma_f32_16x16x32_bf16 a[116:119], v[72:75], v[40:43], a[116:119]
    ds_read_b128 v[36:39], v1 offset:19456
    v_mfma_f32_16x16x32_bf16 a[116:119], v[88:91], v[44:47], a[116:119]
    v_exp_f32 v19, v111
    v_mfma_f32_16x16x32_bf16 a[164:167], v[92:95], v[44:47], a[164:167]
    s_mov_b32 s28, s29
    v_cvt_pk_bf16_f32 v174, v16, v17
    v_add_f32 v8, v8, v18
    v_mfma_f32_16x16x32_bf16 a[164:167], v[76:79], v[40:43], a[164:167]
    s_waitcnt lgkmcnt(2)
    v_add_f32 v8, v8, v19
    v_cvt_pk_bf16_f32 v175, v18, v19
    v_mfma_f32_16x16x32_bf16 a[24:27], v[64:67], v[24:27], a[24:27]
    s_add_u32 s32, s32, 24576
    ds_read_b128 v[40:43], v1 offset:8192
    v_and_b32 v51, s97, v59
    v_mfma_f32_16x16x32_bf16 a[24:27], v[80:83], v[28:31], a[24:27]
    v_exp_f32 v16, v176
    v_mfma_f32_16x16x32_bf16 a[72:75], v[84:87], v[28:31], a[72:75]
    s_add_u32 s26, s26, 12288
    v_exp_f32 v17, v177
    v_mfma_f32_16x16x32_bf16 a[72:75], v[68:71], v[24:27], a[72:75]
    v_exp_f32 v18, v178
    v_mfma_f32_16x16x32_bf16 a[120:123], v[72:75], v[24:27], a[120:123]
    s_mov_b32 m0, s26
    ds_read_b128 v[44:47], v1 offset:20480
    v_add_f32 v5, v5, v16
    v_mfma_f32_16x16x32_bf16 a[120:123], v[88:91], v[28:31], a[120:123]
    v_add_f32 v5, v5, v17
    v_mul_f32_e64 v50, -v50, v48
    v_mfma_f32_16x16x32_bf16 a[168:171], v[92:95], v[28:31], a[168:171]
    v_exp_f32 v19, v179
    v_mfma_f32_16x16x32_bf16 a[168:171], v[76:79], v[24:27], a[168:171]
    s_waitcnt lgkmcnt(2)
    v_cvt_pk_bf16_f32 v176, v16, v17
    v_mul_f32_e64 v51, -v51, v49
    v_mfma_f32_16x16x32_bf16 a[28:31], v[64:67], v[32:35], a[28:31]
    ds_read_b128 v[24:27], v1 offset:9216
    v_add_u32 v2, s3, v2
    v_mfma_f32_16x16x32_bf16 a[28:31], v[80:83], v[36:39], a[28:31]
    buffer_load_dwordx4 v4, s[4:7], s32 offen offset:0 sc1 lds
    v_mfma_f32_16x16x32_bf16 a[76:79], v[84:87], v[36:39], a[76:79]
    v_exp_f32 v16, v112
    v_mfma_f32_16x16x32_bf16 a[76:79], v[68:71], v[32:35], a[76:79]
    v_add_f32 v5, v5, v18
    v_add_f32 v5, v5, v19
    v_mfma_f32_16x16x32_bf16 a[124:127], v[72:75], v[32:35], a[124:127]
    ds_read_b128 v[28:31], v1 offset:21504
    v_cvt_f32_i32 v152, v152
    v_mfma_f32_16x16x32_bf16 a[124:127], v[88:91], v[36:39], a[124:127]
    buffer_load_dwordx4 v4, s[4:7], s32 offen offset:1024 sc1 lds
    v_mfma_f32_16x16x32_bf16 a[172:175], v[92:95], v[36:39], a[172:175]
    v_exp_f32 v17, v113
    v_mfma_f32_16x16x32_bf16 a[172:175], v[76:79], v[32:35], a[172:175]
    s_waitcnt lgkmcnt(2)
    v_cvt_pk_bf16_f32 v177, v18, v19
    v_add_u32 v3, s3, v3
    v_mfma_f32_16x16x32_bf16 a[32:35], v[64:67], v[40:43], a[32:35]
    ds_read_b128 v[32:35], v1 offset:10240
    v_cvt_f32_i32 v156, v156
    v_mfma_f32_16x16x32_bf16 a[32:35], v[80:83], v[44:47], a[32:35]
    v_exp_f32 v18, v114
    v_mfma_f32_16x16x32_bf16 a[80:83], v[84:87], v[44:47], a[80:83]
    v_add_f32 v5, v5, v16
    v_add_f32 v5, v5, v17
    v_mfma_f32_16x16x32_bf16 a[80:83], v[68:71], v[40:43], a[80:83]
    buffer_load_dwordx4 v4, s[4:7], s32 offen offset:2048 sc1 lds
    v_mfma_f32_16x16x32_bf16 a[128:131], v[72:75], v[40:43], a[128:131]
    ds_read_b128 v[36:39], v1 offset:22528
    v_mfma_f32_16x16x32_bf16 a[128:131], v[88:91], v[44:47], a[128:131]
    v_exp_f32 v19, v115
    v_mfma_f32_16x16x32_bf16 a[176:179], v[92:95], v[44:47], a[176:179]
    v_cvt_pk_bf16_f32 v178, v16, v17
    v_fma_f32 v152, v152, v48, v50
    v_mfma_f32_16x16x32_bf16 a[176:179], v[76:79], v[40:43], a[176:179]
    s_waitcnt lgkmcnt(2)
    v_exp_f32 v16, v180
    v_mfma_f32_16x16x32_bf16 a[36:39], v[64:67], v[24:27], a[36:39]
    ds_read_b128 v[40:43], v1 offset:11264
    v_add_f32 v5, v5, v18
    v_mfma_f32_16x16x32_bf16 a[36:39], v[80:83], v[28:31], a[36:39]
    v_add_f32 v5, v5, v19
    v_mfma_f32_16x16x32_bf16 a[84:87], v[84:87], v[28:31], a[84:87]
    v_exp_f32 v17, v181
    v_mfma_f32_16x16x32_bf16 a[84:87], v[68:71], v[24:27], a[84:87]
    s_add_u32 s32, s32, 24576
    v_cvt_pk_bf16_f32 v179, v18, v19
    s_add_u32 s26, s26, 36864
    v_mfma_f32_16x16x32_bf16 a[132:135], v[72:75], v[24:27], a[132:135]
    s_sub_u32 s57, s26, 147456
    ds_read_b128 v[44:47], v1 offset:23552
    v_fma_f32 v156, v156, v49, v51
    v_mfma_f32_16x16x32_bf16 a[132:135], v[88:91], v[28:31], a[132:135]
    s_waitcnt lgkmcnt(2)
    v_exp_f32 v18, v182
    v_mfma_f32_16x16x32_bf16 a[180:183], v[92:95], v[28:31], a[180:183]
    s_waitcnt vmcnt(6)
    v_add_f32 v6, v6, v16
    v_add_f32 v6, v6, v17
    v_mfma_f32_16x16x32_bf16 a[180:183], v[76:79], v[24:27], a[180:183]
    s_barrier
    v_mfma_f32_16x16x32_bf16 a[40:43], v[64:67], v[32:35], a[40:43]
    s_min_u32 s26, s26, s57
    ds_read_b128 v[24:27], v2 offset:0
    v_add_u32 v0, 1, v0
    v_mfma_f32_16x16x32_bf16 a[40:43], v[80:83], v[36:39], a[40:43]
    buffer_store_dword v0, v13, s[20:23], 0 offen offset:32 sc1
    v_mfma_f32_16x16x32_bf16 a[88:91], v[84:87], v[36:39], a[88:91]
    v_exp_f32 v19, v183
    v_mfma_f32_16x16x32_bf16 a[88:91], v[68:71], v[32:35], a[88:91]
    v_cvt_pk_bf16_f32 v180, v16, v17
    v_cvt_f32_i32 v153, v153
    v_mfma_f32_16x16x32_bf16 a[136:139], v[72:75], v[32:35], a[136:139]
    ds_read_b128 v[28:31], v3 offset:0
    v_cvt_f32_i32 v157, v157
    v_mfma_f32_16x16x32_bf16 a[136:139], v[88:91], v[36:39], a[136:139]
    v_exp_f32 v16, v116
    v_mfma_f32_16x16x32_bf16 a[184:187], v[92:95], v[36:39], a[184:187]
    v_add_f32 v6, v6, v18
    v_add_f32 v6, v6, v19
    v_mfma_f32_16x16x32_bf16 a[184:187], v[76:79], v[32:35], a[184:187]
    s_waitcnt lgkmcnt(2)
    v_exp_f32 v17, v117
    v_mfma_f32_16x16x32_bf16 a[44:47], v[64:67], v[40:43], a[44:47]
    ds_read_b128 v[32:35], v2 offset:6144
    v_cvt_pk_bf16_f32 v181, v18, v19
    v_mfma_f32_16x16x32_bf16 a[44:47], v[80:83], v[44:47], a[44:47]
    v_exp_f32 v18, v118
    v_mfma_f32_16x16x32_bf16 a[92:95], v[84:87], v[44:47], a[92:95]
    v_add_f32 v6, v6, v16
    v_add_f32 v6, v6, v17
    v_mfma_f32_16x16x32_bf16 a[92:95], v[68:71], v[40:43], a[92:95]
    v_exp_f32 v19, v119
    v_mfma_f32_16x16x32_bf16 a[140:143], v[72:75], v[40:43], a[140:143]
    ds_read_b128 v[36:39], v3 offset:6144
    v_cvt_pk_bf16_f32 v182, v16, v17
    v_mfma_f32_16x16x32_bf16 a[140:143], v[88:91], v[44:47], a[140:143]
    v_add_f32 v6, v6, v18
    v_add_f32 v6, v6, v19
    v_mfma_f32_16x16x32_bf16 a[188:191], v[92:95], v[44:47], a[188:191]
    v_cvt_pk_bf16_f32 v183, v18, v19
    v_mfma_f32_16x16x32_bf16 a[188:191], v[76:79], v[40:43], a[188:191]
    s_waitcnt lgkmcnt(2)
    v_mfma_f32_16x16x32_bf16 v[64:67], v[24:27], a[192:195], v[128:131]
    s_mov_b32 m0, s56
    ds_read_b128 v[40:43], v2 offset:128
    v_fma_f32 v153, v153, v48, v50
    v_mfma_f32_16x16x32_bf16 v[64:67], v[28:31], a[196:199], v[64:67]
    buffer_load_dwordx4 v4, s[4:7], s27 offen offset:0 sc1 lds
    v_mfma_f32_16x16x32_bf16 v[68:71], v[28:31], a[220:223], v[132:135]
    v_exp_f32 v16, v184
    v_mfma_f32_16x16x32_bf16 v[68:71], v[24:27], a[216:219], v[68:71]
    v_exp_f32 v17, v185
    v_mfma_f32_16x16x32_bf16 v[72:75], v[24:27], a[240:243], v[136:139]
    ds_read_b128 v[44:47], v3 offset:128
    v_fma_f32 v157, v157, v49, v51
    v_mfma_f32_16x16x32_bf16 v[72:75], v[28:31], a[244:247], v[72:75]
    v_exp_f32 v18, v186
    v_mfma_f32_16x16x32_bf16 v[76:79], v[28:31], v[204:207], v[140:143]
    v_add_f32 v7, v7, v16
    v_add_f32 v7, v7, v17
    v_mfma_f32_16x16x32_bf16 v[76:79], v[24:27], v[200:203], v[76:79]
    s_waitcnt lgkmcnt(2)
    v_exp_f32 v19, v187
    v_mfma_f32_16x16x32_bf16 v[96:99], v[32:35], a[192:195], v[128:131]
    ds_read_b128 v[24:27], v2 offset:6272
    v_cvt_pk_bf16_f32 v184, v16, v17
    v_mfma_f32_16x16x32_bf16 v[96:99], v[36:39], a[196:199], v[96:99]
    v_exp_f32 v16, v120
    v_mfma_f32_16x16x32_bf16 v[100:103], v[36:39], a[220:223], v[132:135]
    v_cvt_f32_i32 v154, v154
    v_add_f32 v7, v7, v18
    v_mfma_f32_16x16x32_bf16 v[100:103], v[32:35], a[216:219], v[100:103]
    buffer_load_dwordx4 v4, s[4:7], s27 offen offset:1024 sc1 lds
    v_mfma_f32_16x16x32_bf16 v[104:107], v[32:35], a[240:243], v[136:139]
    ds_read_b128 v[28:31], v3 offset:6272
    v_add_f32 v7, v7, v19
    v_mfma_f32_16x16x32_bf16 v[104:107], v[36:39], a[244:247], v[104:107]
    v_exp_f32 v17, v121
    v_mfma_f32_16x16x32_bf16 v[108:111], v[36:39], v[204:207], v[140:143]
    v_cvt_f32_i32 v158, v158
    v_cvt_pk_bf16_f32 v185, v18, v19
    v_mfma_f32_16x16x32_bf16 v[108:111], v[32:35], v[200:203], v[108:111]
    s_waitcnt lgkmcnt(2)
    v_exp_f32 v18, v122
    v_mfma_f32_16x16x32_bf16 v[64:67], v[40:43], a[200:203], v[64:67]
    ds_read_b128 v[32:35], v2 offset:256
    v_fma_f32 v154, v154, v48, v50
    v_mfma_f32_16x16x32_bf16 v[64:67], v[44:47], a[204:207], v[64:67]
L_pg8:
    s_cbranch_execz L_pg12
    v_add_f32 v7, v7, v16
    v_add_f32 v7, v7, v17
    v_mfma_f32_16x16x32_bf16 v[68:71], v[44:47], a[228:231], v[68:71]
    v_exp_f32 v19, v123
    v_mfma_f32_16x16x32_bf16 v[68:71], v[40:43], a[224:227], v[68:71]
    v_fma_f32 v158, v158, v49, v51
    v_cvt_pk_bf16_f32 v186, v16, v17
    v_mfma_f32_16x16x32_bf16 v[72:75], v[40:43], a[248:251], v[72:75]
    ds_read_b128 v[36:39], v3 offset:256
    v_cvt_pk_bf16_f32 v144, v144, v148
    v_mfma_f32_16x16x32_bf16 v[72:75], v[44:47], a[252:255], v[72:75]
    v_exp_f32 v16, v188
    v_mfma_f32_16x16x32_bf16 v[76:79], v[44:47], v[212:215], v[76:79]
    v_add_f32 v7, v7, v18
    v_add_f32 v7, v7, v19
    v_mfma_f32_16x16x32_bf16 v[76:79], v[40:43], v[208:211], v[76:79]
    s_waitcnt lgkmcnt(2)
    buffer_load_dwordx4 v4, s[4:7], s27 offen offset:2048 sc1 lds
    v_mfma_f32_16x16x32_bf16 v[96:99], v[24:27], a[200:203], v[96:99]
    ds_read_b128 v[40:43], v2 offset:6400
    v_cvt_pk_bf16_f32 v148, v145, v149
    v_mfma_f32_16x16x32_bf16 v[96:99], v[28:31], a[204:207], v[96:99]
    v_exp_f32 v17, v189
    v_mfma_f32_16x16x32_bf16 v[100:103], v[28:31], a[228:231], v[100:103]
    v_cvt_pk_bf16_f32 v187, v18, v19
    v_mfma_f32_16x16x32_bf16 v[100:103], v[24:27], a[224:227], v[100:103]
    v_exp_f32 v18, v190
    v_mfma_f32_16x16x32_bf16 v[104:107], v[24:27], a[248:251], v[104:107]
    ds_read_b128 v[44:47], v3 offset:6400
    v_add_f32 v8, v8, v16
    v_mfma_f32_16x16x32_bf16 v[104:107], v[28:31], a[252:255], v[104:107]
    v_add_f32 v8, v8, v17
    v_cvt_pk_bf16_f32 v145, v152, v156
    v_mfma_f32_16x16x32_bf16 v[108:111], v[28:31], v[212:215], v[108:111]
    s_add_u32 s29, s30, 49152
    v_exp_f32 v19, v191
    v_mfma_f32_16x16x32_bf16 v[108:111], v[24:27], v[208:211], v[108:111]
    s_waitcnt lgkmcnt(2)
    v_cvt_pk_bf16_f32 v188, v16, v17
    s_sub_u32 s3, s29, 147456
    v_mfma_f32_16x16x32_bf16 v[64:67], v[32:35], a[208:211], v[64:67]
    s_add_u32 s27, s27, 24576
    ds_read_b128 v[24:27], v2 offset:12288
    v_cvt_pk_bf16_f32 v149, v153, v157
    v_mfma_f32_16x16x32_bf16 v[64:67], v[36:39], a[212:215], v[64:67]
    s_min_u32 s29, s29, s3
    v_exp_f32 v16, v124
    v_mfma_f32_16x16x32_bf16 v[68:71], v[36:39], a[236:239], v[68:71]
    v_add_f32 v8, v8, v18
    v_add_f32 v8, v8, v19
    v_mfma_f32_16x16x32_bf16 v[68:71], v[32:35], a[232:235], v[68:71]
    v_exp_f32 v17, v125
    v_mfma_f32_16x16x32_bf16 v[72:75], v[32:35], v[192:195], v[72:75]
    s_add_u32 s56, s56, 12288
    ds_read_b128 v[28:31], v3 offset:12288
    v_cvt_pk_bf16_f32 v152, v146, v150
    v_mfma_f32_16x16x32_bf16 v[72:75], v[36:39], v[196:199], v[72:75]
    v_cvt_pk_bf16_f32 v189, v18, v19
    v_mfma_f32_16x16x32_bf16 v[76:79], v[36:39], v[220:223], v[76:79]
    v_exp_f32 v18, v126
    v_mfma_f32_16x16x32_bf16 v[76:79], v[32:35], v[216:219], v[76:79]
    s_waitcnt lgkmcnt(2)
    v_add_f32 v8, v8, v16
    v_mfma_f32_16x16x32_bf16 v[96:99], v[40:43], a[208:211], v[96:99]
    ds_read_b128 v[32:35], v2 offset:18432
    v_add_f32 v8, v8, v17
    v_mfma_f32_16x16x32_bf16 v[96:99], v[44:47], a[212:215], v[96:99]
    s_sub_u32 s3, s29, s30
    v_exp_f32 v19, v127
    v_mfma_f32_16x16x32_bf16 v[100:103], v[44:47], a[236:239], v[100:103]
    s_mov_b32 m0, s56
    v_cvt_pk_bf16_f32 v153, v154, v158
    v_mfma_f32_16x16x32_bf16 v[100:103], v[40:43], a[232:235], v[100:103]
    v_cvt_pk_bf16_f32 v190, v16, v17
    v_mfma_f32_16x16x32_bf16 v[104:107], v[40:43], v[192:195], v[104:107]
    ds_read_b128 v[36:39], v3 offset:18432
    v_add_f32 v8, v8, v18
    v_mfma_f32_16x16x32_bf16 v[104:107], v[44:47], v[196:199], v[104:107]
    v_add_f32 v8, v8, v19
    v_cvt_pk_bf16_f32 v191, v18, v19
    v_mfma_f32_16x16x32_bf16 v[108:111], v[44:47], v[220:223], v[108:111]
    v_mfma_f32_16x16x32_bf16 v[108:111], v[40:43], v[216:219], v[108:111]
    s_waitcnt lgkmcnt(2)
    v_exp_f32 v16, v64
    v_mfma_f32_16x16x32_bf16 v[80:83], v[24:27], a[192:195], v[128:131]
    ds_read_b128 v[40:43], v2 offset:12416
    v_mfma_f32_16x16x32_bf16 v[80:83], v[28:31], a[196:199], v[80:83]
    s_mov_b32 s30, s29
    v_exp_f32 v17, v65
    v_mfma_f32_16x16x32_bf16 v[84:87], v[28:31], a[220:223], v[132:135]
    v_exp_f32 v18, v66
    v_mfma_f32_16x16x32_bf16 v[84:87], v[24:27], a[216:219], v[84:87]
    s_waitcnt vmcnt(14)
    buffer_load_dwordx4 v4, s[4:7], s27 offen offset:0 sc1 lds
    v_mfma_f32_16x16x32_bf16 v[88:91], v[24:27], a[240:243], v[136:139]
    ds_read_b128 v[44:47], v3 offset:12416
    v_add_f32 v5, v5, v16
    v_mfma_f32_16x16x32_bf16 v[88:91], v[28:31], a[244:247], v[88:91]
    v_add_f32 v5, v5, v17
    v_lshlrev_b32 v48, 16, v60
    v_mfma_f32_16x16x32_bf16 v[92:95], v[28:31], v[204:207], v[140:143]
    v_exp_f32 v19, v67
    v_mfma_f32_16x16x32_bf16 v[92:95], v[24:27], v[200:203], v[92:95]
    s_waitcnt lgkmcnt(2)
    v_cvt_pk_bf16_f32 v64, v16, v17
    v_and_b32 v49, s97, v60
    v_mfma_f32_16x16x32_bf16 v[112:115], v[32:35], a[192:195], v[128:131]
    ds_read_b128 v[24:27], v2 offset:18560
    v_mfma_f32_16x16x32_bf16 v[112:115], v[36:39], a[196:199], v[112:115]
    v_exp_f32 v16, v96
    v_mfma_f32_16x16x32_bf16 v[116:119], v[36:39], a[220:223], v[132:135]
    v_add_f32 v5, v5, v18
    v_lshlrev_b32 v50, 16, v62
    v_mfma_f32_16x16x32_bf16 v[116:119], v[32:35], a[216:219], v[116:119]
    v_add_f32 v5, v5, v19
    v_add_u32 v1, s3, v1
    v_mfma_f32_16x16x32_bf16 v[120:123], v[32:35], a[240:243], v[136:139]
    ds_read_b128 v[28:31], v3 offset:18560
    v_mfma_f32_16x16x32_bf16 v[120:123], v[36:39], a[244:247], v[120:123]
    v_exp_f32 v17, v97
    v_mfma_f32_16x16x32_bf16 v[124:127], v[36:39], v[204:207], v[140:143]
    v_cvt_pk_bf16_f32 v65, v18, v19
    v_and_b32 v51, s97, v62
    v_mfma_f32_16x16x32_bf16 v[124:127], v[32:35], v[200:203], v[124:127]
    s_waitcnt lgkmcnt(2)
    buffer_load_dwordx4 v4, s[4:7], s27 offen offset:1024 sc1 lds
    v_mfma_f32_16x16x32_bf16 v[80:83], v[40:43], a[200:203], v[80:83]
    ds_read_b128 v[32:35], v2 offset:12544
    v_mfma_f32_16x16x32_bf16 v[80:83], v[44:47], a[204:207], v[80:83]
    v_exp_f32 v18, v98
    v_mfma_f32_16x16x32_bf16 v[84:87], v[44:47], a[228:231], v[84:87]
    v_add_f32 v5, v5, v16
    v_add_f32 v5, v5, v17
    v_mfma_f32_16x16x32_bf16 v[84:87], v[40:43], a[224:227], v[84:87]
    v_exp_f32 v19, v99
    v_mfma_f32_16x16x32_bf16 v[88:91], v[40:43], a[248:251], v[88:91]
    ds_read_b128 v[36:39], v3 offset:12544
    v_cvt_pk_bf16_f32 v66, v16, v17
    v_mfma_f32_16x16x32_bf16 v[88:91], v[44:47], a[252:255], v[88:91]
    v_exp_f32 v16, v68
    v_mfma_f32_16x16x32_bf16 v[92:95], v[44:47], v[212:215], v[92:95]
    v_mul_f32_e64 v50, -v50, v48
    v_add_f32 v5, v5, v18
    v_mfma_f32_16x16x32_bf16 v[92:95], v[40:43], v[208:211], v[92:95]
    s_waitcnt lgkmcnt(2)
    v_add_f32 v5, v5, v19
    v_mul_f32_e64 v51, -v51, v49
    v_mfma_f32_16x16x32_bf16 v[112:115], v[24:27], a[200:203], v[112:115]
    ds_read_b128 v[40:43], v2 offset:18688
    v_mfma_f32_16x16x32_bf16 v[112:115], v[28:31], a[204:207], v[112:115]
    buffer_load_dwordx4 v4, s[4:7], s27 offen offset:2048 sc1 lds
    v_mfma_f32_16x16x32_bf16 v[116:119], v[28:31], a[228:231], v[116:119]
    v_exp_f32 v17, v69
    v_mfma_f32_16x16x32_bf16 v[116:119], v[24:27], a[224:227], v[116:119]
    v_cvt_pk_bf16_f32 v67, v18, v19
    v_cvt_f32_i32 v240, v240
    v_mfma_f32_16x16x32_bf16 v[120:123], v[24:27], a[248:251], v[120:123]
    ds_read_b128 v[44:47], v3 offset:18688
    v_mfma_f32_16x16x32_bf16 v[120:123], v[28:31], a[252:255], v[120:123]
    s_waitcnt lgkmcnt(2)
    v_exp_f32 v18, v70
    v_mfma_f32_16x16x32_bf16 v[124:127], v[28:31], v[212:215], v[124:127]
    s_waitcnt vmcnt(7)
    v_add_f32 v6, v6, v16
    v_add_f32 v6, v6, v17
    v_mfma_f32_16x16x32_bf16 v[124:127], v[24:27], v[208:211], v[124:127]
    s_barrier
    v_mfma_f32_16x16x32_bf16 v[80:83], v[32:35], a[208:211], v[80:83]
    ds_read_b128 v[24:27], v1 offset:0
    v_cvt_f32_i32 v244, v244
    v_mfma_f32_16x16x32_bf16 v[80:83], v[36:39], a[212:215], v[80:83]
    v_exp_f32 v19, v71
    v_mfma_f32_16x16x32_bf16 v[84:87], v[36:39], a[236:239], v[84:87]
    v_cvt_pk_bf16_f32 v68, v16, v17
    v_fma_f32 v240, v240, v48, v50
    v_mfma_f32_16x16x32_bf16 v[84:87], v[32:35], a[232:235], v[84:87]
    v_exp_f32 v16, v100
    v_mfma_f32_16x16x32_bf16 v[88:91], v[32:35], v[192:195], v[88:91]
    ds_read_b128 v[28:31], v1 offset:12288
    v_add_f32 v6, v6, v18
    v_mfma_f32_16x16x32_bf16 v[88:91], v[36:39], v[196:199], v[88:91]
    v_add_f32 v6, v6, v19
    v_fma_f32 v244, v244, v49, v51
    v_mfma_f32_16x16x32_bf16 v[92:95], v[36:39], v[220:223], v[92:95]
    v_exp_f32 v17, v101
    v_mfma_f32_16x16x32_bf16 v[92:95], v[32:35], v[216:219], v[92:95]
    s_waitcnt lgkmcnt(2)
    v_cvt_pk_bf16_f32 v69, v18, v19
    v_mfma_f32_16x16x32_bf16 v[112:115], v[40:43], a[208:211], v[112:115]
    ds_read_b128 v[32:35], v1 offset:1024
    v_mfma_f32_16x16x32_bf16 v[112:115], v[44:47], a[212:215], v[112:115]
    v_exp_f32 v18, v102
    v_mfma_f32_16x16x32_bf16 v[116:119], v[44:47], a[236:239], v[116:119]
    v_add_f32 v6, v6, v16
    v_add_f32 v6, v6, v17
    v_mfma_f32_16x16x32_bf16 v[116:119], v[40:43], a[232:235], v[116:119]
    s_add_u32 s27, s27, 24576
    v_exp_f32 v19, v103
    v_mfma_f32_16x16x32_bf16 v[120:123], v[40:43], v[192:195], v[120:123]
    s_add_u32 s56, s56, 36864
    ds_read_b128 v[36:39], v1 offset:13312
    v_cvt_pk_bf16_f32 v70, v16, v17
    v_mfma_f32_16x16x32_bf16 v[120:123], v[44:47], v[196:199], v[120:123]
    s_sub_u32 s58, s56, 147456
    v_add_f32 v6, v6, v18
    v_add_f32 v6, v6, v19
    v_mfma_f32_16x16x32_bf16 v[124:127], v[44:47], v[220:223], v[124:127]
    s_min_u32 s56, s56, s58
    v_cvt_pk_bf16_f32 v71, v18, v19
    v_mfma_f32_16x16x32_bf16 v[124:127], v[40:43], v[216:219], v[124:127]
    s_waitcnt lgkmcnt(2)
    v_mfma_f32_16x16x32_bf16 a[0:3], v[160:163], v[24:27], a[0:3]
    s_mov_b32 m0, s56
    ds_read_b128 v[40:43], v1 offset:2048
    v_cvt_f32_i32 v241, v241
    v_mfma_f32_16x16x32_bf16 a[0:3], v[176:179], v[28:31], a[0:3]
    buffer_load_dwordx4 v4, s[4:7], s27 offen offset:0 sc1 lds
    v_mfma_f32_16x16x32_bf16 a[48:51], v[180:183], v[28:31], a[48:51]
    v_exp_f32 v16, v72
    v_mfma_f32_16x16x32_bf16 a[48:51], v[164:167], v[24:27], a[48:51]
    v_exp_f32 v17, v73
    v_mfma_f32_16x16x32_bf16 a[96:99], v[168:171], v[24:27], a[96:99]
    ds_read_b128 v[44:47], v1 offset:14336
    v_cvt_f32_i32 v245, v245
    v_mfma_f32_16x16x32_bf16 a[96:99], v[184:187], v[28:31], a[96:99]
    v_exp_f32 v18, v74
    v_mfma_f32_16x16x32_bf16 a[144:147], v[188:191], v[28:31], a[144:147]
    v_add_f32 v7, v7, v16
    v_add_f32 v7, v7, v17
    v_mfma_f32_16x16x32_bf16 a[144:147], v[172:175], v[24:27], a[144:147]
    s_waitcnt lgkmcnt(2)
    v_exp_f32 v19, v75
    v_mfma_f32_16x16x32_bf16 a[4:7], v[160:163], v[32:35], a[4:7]
    ds_read_b128 v[24:27], v1 offset:3072
    v_fma_f32 v241, v241, v48, v50
    v_mfma_f32_16x16x32_bf16 a[4:7], v[176:179], v[36:39], a[4:7]
    buffer_load_dwordx4 v4, s[4:7], s27 offen offset:1024 sc1 lds
    v_mfma_f32_16x16x32_bf16 a[52:55], v[180:183], v[36:39], a[52:55]
    v_cvt_pk_bf16_f32 v72, v16, v17
    v_fma_f32 v245, v245, v49, v51
    v_mfma_f32_16x16x32_bf16 a[52:55], v[164:167], v[32:35], a[52:55]
    v_exp_f32 v16, v104
    v_mfma_f32_16x16x32_bf16 a[100:103], v[168:171], v[32:35], a[100:103]
    ds_read_b128 v[28:31], v1 offset:15360
    v_add_f32 v7, v7, v18
    v_mfma_f32_16x16x32_bf16 a[100:103], v[184:187], v[36:39], a[100:103]
    buffer_load_dword v52, v20, s[20:23], s44 offen sc1
    v_mfma_f32_16x16x32_bf16 a[148:151], v[188:191], v[36:39], a[148:151]
    v_add_f32 v7, v7, v19
    v_cvt_f32_i32 v242, v242
    v_mfma_f32_16x16x32_bf16 a[148:151], v[172:175], v[32:35], a[148:151]
    s_waitcnt lgkmcnt(2)
    v_exp_f32 v17, v105
    v_mfma_f32_16x16x32_bf16 a[8:11], v[160:163], v[40:43], a[8:11]
    ds_read_b128 v[32:35], v1 offset:4096
    v_cvt_pk_bf16_f32 v73, v18, v19
    v_mfma_f32_16x16x32_bf16 a[8:11], v[176:179], v[44:47], a[8:11]
    v_exp_f32 v18, v106
    v_mfma_f32_16x16x32_bf16 a[56:59], v[180:183], v[44:47], a[56:59]
    v_add_f32 v7, v7, v16
    v_cvt_f32_i32 v246, v246
    v_mfma_f32_16x16x32_bf16 a[56:59], v[164:167], v[40:43], a[56:59]
    buffer_load_dwordx4 v4, s[4:7], s27 offen offset:2048 sc1 lds
    v_mfma_f32_16x16x32_bf16 a[104:107], v[168:171], v[40:43], a[104:107]
    ds_read_b128 v[36:39], v1 offset:16384
    v_add_f32 v7, v7, v17
    v_mfma_f32_16x16x32_bf16 a[104:107], v[184:187], v[44:47], a[104:107]
    v_exp_f32 v19, v107
    v_mfma_f32_16x16x32_bf16 a[152:155], v[188:191], v[44:47], a[152:155]
    v_cvt_pk_bf16_f32 v74, v16, v17
    v_fma_f32 v242, v242, v48, v50
    v_mfma_f32_16x16x32_bf16 a[152:155], v[172:175], v[40:43], a[152:155]
    s_waitcnt lgkmcnt(2)
    v_exp_f32 v16, v76
    v_mfma_f32_16x16x32_bf16 a[12:15], v[160:163], v[24:27], a[12:15]
    ds_read_b128 v[40:43], v1 offset:5120
    v_add_f32 v7, v7, v18
    v_mfma_f32_16x16x32_bf16 a[12:15], v[176:179], v[28:31], a[12:15]
    s_add_u32 s27, s27, 24576
    v_add_f32 v7, v7, v19
    v_fma_f32 v246, v246, v49, v51
    v_mfma_f32_16x16x32_bf16 a[60:63], v[180:183], v[28:31], a[60:63]
    v_exp_f32 v17, v77
    v_mfma_f32_16x16x32_bf16 a[60:63], v[164:167], v[24:27], a[60:63]
    v_cvt_pk_bf16_f32 v75, v18, v19
    v_lshlrev_b32 v48, 16, v61
    v_mfma_f32_16x16x32_bf16 a[108:111], v[168:171], v[24:27], a[108:111]
    ds_read_b128 v[44:47], v1 offset:17408
    v_and_b32 v49, s97, v61
    v_mfma_f32_16x16x32_bf16 a[108:111], v[184:187], v[28:31], a[108:111]
    v_exp_f32 v18, v78
    v_mfma_f32_16x16x32_bf16 a[156:159], v[188:191], v[28:31], a[156:159]
    s_add_u32 s29, s28, 49152
    v_add_f32 v8, v8, v16
    v_add_f32 v8, v8, v17
    v_mfma_f32_16x16x32_bf16 a[156:159], v[172:175], v[24:27], a[156:159]
    s_waitcnt lgkmcnt(2)
    v_exp_f32 v19, v79
    v_mfma_f32_16x16x32_bf16 a[16:19], v[160:163], v[32:35], a[16:19]
    s_sub_u32 s3, s29, 147456
    ds_read_b128 v[24:27], v1 offset:6144
    v_lshlrev_b32 v50, 16, v63
    v_mfma_f32_16x16x32_bf16 a[16:19], v[176:179], v[36:39], a[16:19]
    s_add_u32 s56, s56, 12288
    v_cvt_pk_bf16_f32 v76, v16, v17
    v_and_b32 v51, s97, v63
    v_mfma_f32_16x16x32_bf16 a[64:67], v[180:183], v[36:39], a[64:67]
    s_min_u32 s29, s29, s3
    v_exp_f32 v16, v108
    v_mfma_f32_16x16x32_bf16 a[64:67], v[164:167], v[32:35], a[64:67]
    s_mov_b32 m0, s56
    v_add_f32 v8, v8, v18
    v_add_f32 v8, v8, v19
    v_mfma_f32_16x16x32_bf16 a[112:115], v[168:171], v[32:35], a[112:115]
    ds_read_b128 v[28:31], v1 offset:18432
    v_mul_f32_e64 v50, -v50, v48
    v_mfma_f32_16x16x32_bf16 a[112:115], v[184:187], v[36:39], a[112:115]
    v_exp_f32 v17, v109
    v_mfma_f32_16x16x32_bf16 a[160:163], v[188:191], v[36:39], a[160:163]
    v_cvt_pk_bf16_f32 v77, v18, v19
    v_mul_f32_e64 v51, -v51, v49
    v_mfma_f32_16x16x32_bf16 a[160:163], v[172:175], v[32:35], a[160:163]
    s_waitcnt lgkmcnt(2)
    v_exp_f32 v18, v110
    v_mfma_f32_16x16x32_bf16 a[20:23], v[160:163], v[40:43], a[20:23]
    s_sub_u32 s3, s29, s28
    ds_read_b128 v[32:35], v1 offset:7168
    v_add_f32 v8, v8, v16
    v_mfma_f32_16x16x32_bf16 a[20:23], v[176:179], v[44:47], a[20:23]
    v_add_f32 v8, v8, v17
    v_cvt_f32_i32 v248, v248
    v_mfma_f32_16x16x32_bf16 a[68:71], v[180:183], v[44:47], a[68:71]
    v_exp_f32 v19, v111
    v_mfma_f32_16x16x32_bf16 a[68:71], v[164:167], v[40:43], a[68:71]
    buffer_load_dwordx4 v4, s[4:7], s27 offen offset:0 sc1 lds
    v_mfma_f32_16x16x32_bf16 a[116:119], v[168:171], v[40:43], a[116:119]
    ds_read_b128 v[36:39], v1 offset:19456
    v_cvt_pk_bf16_f32 v78, v16, v17
    v_mfma_f32_16x16x32_bf16 a[116:119], v[184:187], v[44:47], a[116:119]
    v_add_f32 v8, v8, v18
    v_cvt_f32_i32 v252, v252
    v_mfma_f32_16x16x32_bf16 a[164:167], v[188:191], v[44:47], a[164:167]
    s_mov_b32 s28, s29
    v_add_f32 v8, v8, v19
    v_cvt_pk_bf16_f32 v79, v18, v19
    v_mfma_f32_16x16x32_bf16 a[164:167], v[172:175], v[40:43], a[164:167]
    s_waitcnt lgkmcnt(2)
    v_exp_f32 v16, v80
    v_mfma_f32_16x16x32_bf16 a[24:27], v[160:163], v[24:27], a[24:27]
    ds_read_b128 v[40:43], v1 offset:8192
    v_fma_f32 v248, v248, v48, v50
    v_mfma_f32_16x16x32_bf16 a[24:27], v[176:179], v[28:31], a[24:27]
    v_exp_f32 v17, v81
    v_mfma_f32_16x16x32_bf16 a[72:75], v[180:183], v[28:31], a[72:75]
    v_fma_f32 v252, v252, v49, v51
    v_cvt_f32_i32 v249, v249
    v_mfma_f32_16x16x32_bf16 a[72:75], v[164:167], v[24:27], a[72:75]
    buffer_load_dwordx4 v4, s[4:7], s27 offen offset:1024 sc1 lds
    v_mfma_f32_16x16x32_bf16 a[120:123], v[168:171], v[24:27], a[120:123]
    ds_read_b128 v[44:47], v1 offset:20480
    v_cvt_f32_i32 v253, v253
    v_mfma_f32_16x16x32_bf16 a[120:123], v[184:187], v[28:31], a[120:123]
    v_exp_f32 v18, v82
    v_mfma_f32_16x16x32_bf16 a[168:171], v[188:191], v[28:31], a[168:171]
    v_add_f32 v5, v5, v16
    v_add_f32 v5, v5, v17
    v_mfma_f32_16x16x32_bf16 a[168:171], v[172:175], v[24:27], a[168:171]
    s_waitcnt lgkmcnt(2)
    v_exp_f32 v19, v83
    v_mfma_f32_16x16x32_bf16 a[28:31], v[160:163], v[32:35], a[28:31]
    ds_read_b128 v[24:27], v1 offset:9216
    v_cvt_pk_bf16_f32 v80, v16, v17
    v_mfma_f32_16x16x32_bf16 a[28:31], v[176:179], v[36:39], a[28:31]
    v_exp_f32 v16, v112
    v_mfma_f32_16x16x32_bf16 a[76:79], v[180:183], v[36:39], a[76:79]
    v_add_f32 v5, v5, v18
    v_fma_f32 v249, v249, v48, v50
    v_mfma_f32_16x16x32_bf16 a[76:79], v[164:167], v[32:35], a[76:79]
    v_add_f32 v5, v5, v19
    v_add_u32 v2, s3, v2
    v_mfma_f32_16x16x32_bf16 a[124:127], v[168:171], v[32:35], a[124:127]
    ds_read_b128 v[28:31], v1 offset:21504
    v_fma_f32 v253, v253, v49, v51
    v_mfma_f32_16x16x32_bf16 a[124:127], v[184:187], v[36:39], a[124:127]
    buffer_load_dwordx4 v4, s[4:7], s27 offen offset:2048 sc1 lds
    v_mfma_f32_16x16x32_bf16 a[172:175], v[188:191], v[36:39], a[172:175]
    v_exp_f32 v17, v113
    v_mfma_f32_16x16x32_bf16 a[172:175], v[172:175], v[32:35], a[172:175]
    s_waitcnt lgkmcnt(2)
    v_cvt_pk_bf16_f32 v81, v18, v19
    v_cvt_f32_i32 v250, v250
    v_mfma_f32_16x16x32_bf16 a[32:35], v[160:163], v[40:43], a[32:35]
    ds_read_b128 v[32:35], v1 offset:10240
    v_add_u32 v3, s3, v3
    v_mfma_f32_16x16x32_bf16 a[32:35], v[176:179], v[44:47], a[32:35]
    v_exp_f32 v18, v114
    v_mfma_f32_16x16x32_bf16 a[80:83], v[180:183], v[44:47], a[80:83]
    v_add_f32 v5, v5, v16
    v_add_f32 v5, v5, v17
    v_mfma_f32_16x16x32_bf16 a[80:83], v[164:167], v[40:43], a[80:83]
    v_exp_f32 v19, v115
    v_mfma_f32_16x16x32_bf16 a[128:131], v[168:171], v[40:43], a[128:131]
    ds_read_b128 v[36:39], v1 offset:22528
    v_cvt_pk_bf16_f32 v82, v16, v17
    v_mfma_f32_16x16x32_bf16 a[128:131], v[184:187], v[44:47], a[128:131]
    v_exp_f32 v16, v84
    v_mfma_f32_16x16x32_bf16 a[176:179], v[188:191], v[44:47], a[176:179]
    v_cvt_f32_i32 v254, v254
    v_add_f32 v5, v5, v18
    v_mfma_f32_16x16x32_bf16 a[176:179], v[172:175], v[40:43], a[176:179]
    s_waitcnt lgkmcnt(2)
    v_add_f32 v5, v5, v19
    v_fma_f32 v250, v250, v48, v50
    v_mfma_f32_16x16x32_bf16 a[36:39], v[160:163], v[24:27], a[36:39]
    ds_read_b128 v[40:43], v1 offset:11264
    v_fma_f32 v254, v254, v49, v51
    v_mfma_f32_16x16x32_bf16 a[36:39], v[176:179], v[28:31], a[36:39]
    v_exp_f32 v17, v85
    v_mfma_f32_16x16x32_bf16 a[84:87], v[180:183], v[28:31], a[84:87]
    v_cvt_pk_bf16_f32 v83, v18, v19
    v_cvt_pk_bf16_f32 v146, v240, v244
    v_mfma_f32_16x16x32_bf16 a[84:87], v[164:167], v[24:27], a[84:87]
    s_add_u32 s27, s27, 24576
    v_exp_f32 v18, v86
    v_mfma_f32_16x16x32_bf16 a[132:135], v[168:171], v[24:27], a[132:135]
    s_add_u32 s56, s56, 36864
    ds_read_b128 v[44:47], v1 offset:23552
    v_add_f32 v6, v6, v16
    v_mfma_f32_16x16x32_bf16 a[132:135], v[184:187], v[28:31], a[132:135]
    s_sub_u32 s58, s56, 147456
    v_add_f32 v6, v6, v17
    v_cvt_pk_bf16_f32 v150, v241, v245
    v_mfma_f32_16x16x32_bf16 a[180:183], v[188:191], v[28:31], a[180:183]
    v_exp_f32 v19, v87
    v_mfma_f32_16x16x32_bf16 a[180:183], v[172:175], v[24:27], a[180:183]
    s_waitcnt lgkmcnt(2)
    v_cvt_pk_bf16_f32 v84, v16, v17
    v_cvt_pk_bf16_f32 v147, v248, v252
    v_mfma_f32_16x16x32_bf16 a[40:43], v[160:163], v[32:35], a[40:43]
    s_min_u32 s56, s56, s58
    ds_read_b128 v[24:27], v2 offset:0
    v_mfma_f32_16x16x32_bf16 a[40:43], v[176:179], v[36:39], a[40:43]
    v_exp_f32 v16, v116
    v_mfma_f32_16x16x32_bf16 a[88:91], v[180:183], v[36:39], a[88:91]
    v_add_f32 v6, v6, v18
    v_add_f32 v6, v6, v19
    v_mfma_f32_16x16x32_bf16 a[88:91], v[164:167], v[32:35], a[88:91]
    v_exp_f32 v17, v117
    v_mfma_f32_16x16x32_bf16 a[136:139], v[168:171], v[32:35], a[136:139]
    ds_read_b128 v[28:31], v3 offset:0
    v_cvt_pk_bf16_f32 v151, v249, v253
    v_mfma_f32_16x16x32_bf16 a[136:139], v[184:187], v[36:39], a[136:139]
    v_cvt_pk_bf16_f32 v85, v18, v19
    v_cvt_pk_bf16_f32 v154, v242, v246
    v_mfma_f32_16x16x32_bf16 a[184:187], v[188:191], v[36:39], a[184:187]
    v_exp_f32 v18, v118
    v_mfma_f32_16x16x32_bf16 a[184:187], v[172:175], v[32:35], a[184:187]
    s_waitcnt lgkmcnt(2)
    v_add_f32 v6, v6, v16
    v_mfma_f32_16x16x32_bf16 a[44:47], v[160:163], v[40:43], a[44:47]
    ds_read_b128 v[32:35], v2 offset:6144
    v_add_f32 v6, v6, v17
    v_mfma_f32_16x16x32_bf16 a[44:47], v[176:179], v[44:47], a[44:47]
    v_exp_f32 v19, v119
    v_mfma_f32_16x16x32_bf16 a[92:95], v[180:183], v[44:47], a[92:95]
    v_cvt_pk_bf16_f32 v155, v250, v254
    v_mfma_f32_16x16x32_bf16 a[92:95], v[164:167], v[40:43], a[92:95]
    v_cvt_pk_bf16_f32 v86, v16, v17
    v_mfma_f32_16x16x32_bf16 a[140:143], v[168:171], v[40:43], a[140:143]
    ds_read_b128 v[36:39], v3 offset:6144
    v_add_f32 v6, v6, v18
    v_mfma_f32_16x16x32_bf16 a[140:143], v[184:187], v[44:47], a[140:143]
    v_add_f32 v6, v6, v19
    v_cvt_pk_bf16_f32 v87, v18, v19
    v_mfma_f32_16x16x32_bf16 a[188:191], v[188:191], v[44:47], a[188:191]
    v_mfma_f32_16x16x32_bf16 a[188:191], v[172:175], v[40:43], a[188:191]
    s_waitcnt lgkmcnt(2)
    v_mfma_f32_16x16x32_bf16 v[160:163], v[24:27], a[192:195], v[128:131]
    ds_read_b128 v[40:43], v2 offset:128
    v_mfma_f32_16x16x32_bf16 v[160:163], v[28:31], a[196:199], v[160:163]
    s_waitcnt vmcnt(4)
    v_subrev_u32 v52, s92, v52
    v_cmp_lt_u32 vcc, 15, v52
    v_mfma_f32_16x16x32_bf16 v[164:167], v[28:31], a[220:223], v[132:135]
    v_exp_f32 v16, v88
    v_mfma_f32_16x16x32_bf16 v[164:167], v[24:27], a[216:219], v[164:167]
    v_exp_f32 v17, v89
    v_mfma_f32_16x16x32_bf16 v[168:171], v[24:27], a[240:243], v[136:139]
    s_and_b32 s59, vcc_lo, 0xff
    ds_read_b128 v[44:47], v3 offset:128
    v_mfma_f32_16x16x32_bf16 v[168:171], v[28:31], a[244:247], v[168:171]
    s_cbranch_scc1 L_pollslow3
L_pollok3:
    v_mfma_f32_16x16x32_bf16 v[172:175], v[28:31], v[204:207], v[140:143]
    s_add_u32 s92, s92, 1
    v_exp_f32 v18, v90
    v_mfma_f32_16x16x32_bf16 v[172:175], v[24:27], v[200:203], v[172:175]
    s_waitcnt lgkmcnt(2)
    v_add_f32 v7, v7, v16
    v_add_f32 v7, v7, v17
    v_mfma_f32_16x16x32_bf16 v[96:99], v[32:35], a[192:195], v[128:131]
    ds_read_b128 v[24:27], v2 offset:6272
    v_mfma_f32_16x16x32_bf16 v[96:99], v[36:39], a[196:199], v[96:99]
    buffer_store_dwordx4 v[144:147], v15, s[4:7], s35 offen offset:0 sc1
    v_mfma_f32_16x16x32_bf16 v[100:103], v[36:39], a[220:223], v[132:135]
    v_exp_f32 v19, v91
    v_mfma_f32_16x16x32_bf16 v[100:103], v[32:35], a[216:219], v[100:103]
    v_cvt_pk_bf16_f32 v88, v16, v17
    v_mfma_f32_16x16x32_bf16 v[104:107], v[32:35], a[240:243], v[136:139]
    ds_read_b128 v[28:31], v3 offset:6272
    v_mfma_f32_16x16x32_bf16 v[104:107], v[36:39], a[244:247], v[104:107]
    v_exp_f32 v16, v120
    v_mfma_f32_16x16x32_bf16 v[108:111], v[36:39], v[204:207], v[140:143]
    v_add_f32 v7, v7, v18
    v_add_f32 v7, v7, v19
    v_mfma_f32_16x16x32_bf16 v[108:111], v[32:35], v[200:203], v[108:111]
    s_waitcnt lgkmcnt(2)
    v_exp_f32 v17, v121
    v_mfma_f32_16x16x32_bf16 v[160:163], v[40:43], a[200:203], v[160:163]
    ds_read_b128 v[32:35], v2 offset:256
    v_cvt_pk_bf16_f32 v89, v18, v19
    v_mfma_f32_16x16x32_bf16 v[160:163], v[44:47], a[204:207], v[160:163]
    buffer_store_dwordx4 v[148:151], v15, s[4:7], s35 offen offset:1024 sc1
    v_mfma_f32_16x16x32_bf16 v[164:167], v[44:47], a[228:231], v[164:167]
    v_exp_f32 v18, v122
    v_mfma_f32_16x16x32_bf16 v[164:167], v[40:43], a[224:227], v[164:167]
    v_add_f32 v7, v7, v16
    v_add_f32 v7, v7, v17
    v_mfma_f32_16x16x32_bf16 v[168:171], v[40:43], a[248:251], v[168:171]
    ds_read_b128 v[36:39], v3 offset:256
    v_mfma_f32_16x16x32_bf16 v[168:171], v[44:47], a[252:255], v[168:171]
    v_exp_f32 v19, v123
    v_mfma_f32_16x16x32_bf16 v[172:175], v[44:47], v[212:215], v[172:175]
    v_cvt_pk_bf16_f32 v90, v16, v17
    v_mfma_f32_16x16x32_bf16 v[172:175], v[40:43], v[208:211], v[172:175]
    s_waitcnt lgkmcnt(2)
    v_exp_f32 v16, v92
    v_mfma_f32_16x16x32_bf16 v[96:99], v[24:27], a[200:203], v[96:99]
    ds_read_b128 v[40:43], v2 offset:6400
    v_add_f32 v7, v7, v18
    v_mfma_f32_16x16x32_bf16 v[96:99], v[28:31], a[204:207], v[96:99]
    buffer_store_dwordx4 v[152:155], v15, s[4:7], s35 offen offset:2048 sc1
    v_mfma_f32_16x16x32_bf16 v[100:103], v[28:31], a[228:231], v[100:103]
    v_add_f32 v7, v7, v19
    v_mfma_f32_16x16x32_bf16 v[100:103], v[24:27], a[224:227], v[100:103]
    v_exp_f32 v17, v93
    v_mfma_f32_16x16x32_bf16 v[104:107], v[24:27], a[248:251], v[104:107]
    ds_read_b128 v[44:47], v3 offset:6400
    v_cvt_pk_bf16_f32 v91, v18, v19
    v_mfma_f32_16x16x32_bf16 v[104:107], v[28:31], a[252:255], v[104:107]
    v_exp_f32 v18, v94
    v_mfma_f32_16x16x32_bf16 v[108:111], v[28:31], v[212:215], v[108:111]
    s_add_u32 s29, s30, 49152
    v_add_f32 v8, v8, v16
    v_add_f32 v8, v8, v17
    v_mfma_f32_16x16x32_bf16 v[108:111], v[24:27], v[208:211], v[108:111]
    s_waitcnt lgkmcnt(2)
    v_exp_f32 v19, v95
    v_mfma_f32_16x16x32_bf16 v[160:163], v[32:35], a[208:211], v[160:163]
    s_sub_u32 s3, s29, 147456
    ds_read_b128 v[24:27], v2 offset:12288
    v_cvt_pk_bf16_f32 v92, v16, v17
    v_mfma_f32_16x16x32_bf16 v[160:163], v[36:39], a[212:215], v[160:163]
    s_min_u32 s29, s29, s3
    v_exp_f32 v16, v124
    v_mfma_f32_16x16x32_bf16 v[164:167], v[36:39], a[236:239], v[164:167]
    v_add_f32 v8, v8, v18
    v_add_f32 v8, v8, v19
    v_mfma_f32_16x16x32_bf16 v[164:167], v[32:35], a[232:235], v[164:167]
    v_exp_f32 v17, v125
    v_mfma_f32_16x16x32_bf16 v[168:171], v[32:35], v[192:195], v[168:171]
    ds_read_b128 v[28:31], v3 offset:12288
    v_mfma_f32_16x16x32_bf16 v[168:171], v[36:39], v[196:199], v[168:171]
    v_cvt_pk_bf16_f32 v93, v18, v19
    v_mfma_f32_16x16x32_bf16 v[172:175], v[36:39], v[220:223], v[172:175]
    v_exp_f32 v18, v126
    v_mfma_f32_16x16x32_bf16 v[172:175], v[32:35], v[216:219], v[172:175]
    s_waitcnt lgkmcnt(2)
    v_add_f32 v8, v8, v16
    v_mfma_f32_16x16x32_bf16 v[96:99], v[40:43], a[208:211], v[96:99]
    ds_read_b128 v[32:35], v2 offset:18432
    v_add_f32 v8, v8, v17
    v_mfma_f32_16x16x32_bf16 v[96:99], v[44:47], a[212:215], v[96:99]
    s_mov_b32 m0, s26
    v_exp_f32 v19, v127
    v_mfma_f32_16x16x32_bf16 v[100:103], v[44:47], a[236:239], v[100:103]
    s_sub_u32 s3, s29, s30
    v_mfma_f32_16x16x32_bf16 v[100:103], v[40:43], a[232:235], v[100:103]
    buffer_load_dwordx4 v4, s[4:7], s32 offen offset:0 sc1 lds
    v_mfma_f32_16x16x32_bf16 v[104:107], v[40:43], v[192:195], v[104:107]
    ds_read_b128 v[36:39], v3 offset:18432
    v_cvt_pk_bf16_f32 v94, v16, v17
    v_mfma_f32_16x16x32_bf16 v[104:107], v[44:47], v[196:199], v[104:107]
    v_add_f32 v8, v8, v18
    v_add_f32 v8, v8, v19
    v_mfma_f32_16x16x32_bf16 v[108:111], v[44:47], v[220:223], v[108:111]
    v_cvt_pk_bf16_f32 v95, v18, v19
    v_mfma_f32_16x16x32_bf16 v[108:111], v[40:43], v[216:219], v[108:111]
    s_waitcnt lgkmcnt(2)
    buffer_load_dwordx4 v4, s[4:7], s32 offen offset:1024 sc1 lds
    v_mfma_f32_16x16x32_bf16 v[176:179], v[24:27], a[192:195], v[128:131]
    ds_read_b128 v[40:43], v2 offset:12416
    v_mfma_f32_16x16x32_bf16 v[176:179], v[28:31], a[196:199], v[176:179]
    s_mov_b32 s30, s29
    v_exp_f32 v16, v160
    v_mfma_f32_16x16x32_bf16 v[180:183], v[28:31], a[220:223], v[132:135]
    v_exp_f32 v17, v161
    v_mfma_f32_16x16x32_bf16 v[180:183], v[24:27], a[216:219], v[180:183]
    buffer_load_dwordx4 v4, s[4:7], s32 offen offset:2048 sc1 lds
    v_mfma_f32_16x16x32_bf16 v[184:187], v[24:27], a[240:243], v[136:139]
    s_add_u32 s32, s32, 24576
    ds_read_b128 v[44:47], v3 offset:12416
    v_mfma_f32_16x16x32_bf16 v[184:187], v[28:31], a[244:247], v[184:187]
    v_exp_f32 v18, v162
    v_mfma_f32_16x16x32_bf16 v[188:191], v[28:31], v[204:207], v[140:143]
    s_add_u32 s26, s26, 12288
    v_add_f32 v5, v5, v16
    v_add_f32 v5, v5, v17
    v_mfma_f32_16x16x32_bf16 v[188:191], v[24:27], v[200:203], v[188:191]
    s_waitcnt lgkmcnt(2)
    v_exp_f32 v19, v163
    v_mfma_f32_16x16x32_bf16 v[112:115], v[32:35], a[192:195], v[128:131]
    s_mov_b32 m0, s26
    ds_read_b128 v[24:27], v2 offset:18560
    v_cvt_pk_bf16_f32 v160, v16, v17
    v_mfma_f32_16x16x32_bf16 v[112:115], v[36:39], a[196:199], v[112:115]
L_pg9:
    s_cbranch_execz L_pg13
    v_exp_f32 v16, v96
    v_mfma_f32_16x16x32_bf16 v[116:119], v[36:39], a[220:223], v[132:135]
    v_add_f32 v5, v5, v18
    v_add_f32 v5, v5, v19
    v_mfma_f32_16x16x32_bf16 v[116:119], v[32:35], a[216:219], v[116:119]
    v_exp_f32 v17, v97
    v_mfma_f32_16x16x32_bf16 v[120:123], v[32:35], a[240:243], v[136:139]
    ds_read_b128 v[28:31], v3 offset:18560
    v_add_u32 v1, s3, v1
    v_mfma_f32_16x16x32_bf16 v[120:123], v[36:39], a[244:247], v[120:123]
    buffer_load_dwordx4 v4, s[4:7], s32 offen offset:0 sc1 lds
    v_mfma_f32_16x16x32_bf16 v[124:127], v[36:39], v[204:207], v[140:143]
    v_cvt_pk_bf16_f32 v161, v18, v19
    v_mfma_f32_16x16x32_bf16 v[124:127], v[32:35], v[200:203], v[124:127]
    s_waitcnt lgkmcnt(2)
    v_exp_f32 v18, v98
    v_mfma_f32_16x16x32_bf16 v[176:179], v[40:43], a[200:203], v[176:179]
    ds_read_b128 v[32:35], v2 offset:12544
    v_add_f32 v5, v5, v16
    v_mfma_f32_16x16x32_bf16 v[176:179], v[44:47], a[204:207], v[176:179]
    buffer_load_dwordx4 v4, s[4:7], s32 offen offset:1024 sc1 lds
    v_mfma_f32_16x16x32_bf16 v[180:183], v[44:47], a[228:231], v[180:183]
    v_add_f32 v5, v5, v17
    v_mfma_f32_16x16x32_bf16 v[180:183], v[40:43], a[224:227], v[180:183]
    v_exp_f32 v19, v99
    v_mfma_f32_16x16x32_bf16 v[184:187], v[40:43], a[248:251], v[184:187]
    ds_read_b128 v[36:39], v3 offset:12544
    v_cvt_pk_bf16_f32 v162, v16, v17
    v_mfma_f32_16x16x32_bf16 v[184:187], v[44:47], a[252:255], v[184:187]
    buffer_load_dwordx4 v4, s[4:7], s32 offen offset:2048 sc1 lds
    v_mfma_f32_16x16x32_bf16 v[188:191], v[44:47], v[212:215], v[188:191]
    v_exp_f32 v16, v164
    v_mfma_f32_16x16x32_bf16 v[188:191], v[40:43], v[208:211], v[188:191]
    s_waitcnt lgkmcnt(2)
    v_add_f32 v5, v5, v18
    v_add_f32 v5, v5, v19
    v_mfma_f32_16x16x32_bf16 v[112:115], v[24:27], a[200:203], v[112:115]
    ds_read_b128 v[40:43], v2 offset:18688
    v_mfma_f32_16x16x32_bf16 v[112:115], v[28:31], a[204:207], v[112:115]
    v_exp_f32 v17, v165
    v_mfma_f32_16x16x32_bf16 v[116:119], v[28:31], a[228:231], v[116:119]
    v_cvt_pk_bf16_f32 v163, v18, v19
    v_mfma_f32_16x16x32_bf16 v[116:119], v[24:27], a[224:227], v[116:119]
    s_add_u32 s32, s32, 24576
    v_exp_f32 v18, v166
    v_mfma_f32_16x16x32_bf16 v[120:123], v[24:27], a[248:251], v[120:123]
    s_add_u32 s26, s26, 36864
    ds_read_b128 v[44:47], v3 offset:18688
    v_add_f32 v6, v6, v16
    v_mfma_f32_16x16x32_bf16 v[120:123], v[28:31], a[252:255], v[120:123]
    s_waitcnt lgkmcnt(2)
    v_add_f32 v6, v6, v17
    s_sub_u32 s57, s26, 147456
    v_mfma_f32_16x16x32_bf16 v[124:127], v[28:31], v[212:215], v[124:127]
    s_waitcnt vmcnt(6)
    v_exp_f32 v19, v167
    v_mfma_f32_16x16x32_bf16 v[124:127], v[24:27], v[208:211], v[124:127]
    s_barrier
    v_mfma_f32_16x16x32_bf16 v[176:179], v[32:35], a[208:211], v[176:179]
    s_min_u32 s26, s26, s57
    ds_read_b128 v[24:27], v1 offset:0
    v_cvt_pk_bf16_f32 v164, v16, v17
    v_mfma_f32_16x16x32_bf16 v[176:179], v[36:39], a[212:215], v[176:179]
    v_exp_f32 v16, v100
    v_mfma_f32_16x16x32_bf16 v[180:183], v[36:39], a[236:239], v[180:183]
    v_add_u32 v0, 1, v0
    v_add_f32 v6, v6, v18
    v_mfma_f32_16x16x32_bf16 v[180:183], v[32:35], a[232:235], v[180:183]
    buffer_store_dword v0, v13, s[20:23], 0 offen offset:32 sc1
    v_mfma_f32_16x16x32_bf16 v[184:187], v[32:35], v[192:195], v[184:187]
    ds_read_b128 v[28:31], v1 offset:12288
    v_add_f32 v6, v6, v19
    v_mfma_f32_16x16x32_bf16 v[184:187], v[36:39], v[196:199], v[184:187]
    v_exp_f32 v17, v101
    v_mfma_f32_16x16x32_bf16 v[188:191], v[36:39], v[220:223], v[188:191]
    v_cvt_pk_bf16_f32 v165, v18, v19
    v_mfma_f32_16x16x32_bf16 v[188:191], v[32:35], v[216:219], v[188:191]
    s_waitcnt lgkmcnt(2)
    v_exp_f32 v18, v102
    v_mfma_f32_16x16x32_bf16 v[112:115], v[40:43], a[208:211], v[112:115]
    ds_read_b128 v[32:35], v1 offset:1024
    v_add_f32 v6, v6, v16
    v_mfma_f32_16x16x32_bf16 v[112:115], v[44:47], a[212:215], v[112:115]
    v_add_f32 v6, v6, v17
    v_mfma_f32_16x16x32_bf16 v[116:119], v[44:47], a[236:239], v[116:119]
    v_exp_f32 v19, v103
    v_mfma_f32_16x16x32_bf16 v[116:119], v[40:43], a[232:235], v[116:119]
    v_cvt_pk_bf16_f32 v166, v16, v17
    v_mfma_f32_16x16x32_bf16 v[120:123], v[40:43], v[192:195], v[120:123]
    ds_read_b128 v[36:39], v1 offset:13312
    v_add_f32 v6, v6, v18
    v_mfma_f32_16x16x32_bf16 v[120:123], v[44:47], v[196:199], v[120:123]
    v_add_f32 v6, v6, v19
    v_cvt_pk_bf16_f32 v167, v18, v19
    v_mfma_f32_16x16x32_bf16 v[124:127], v[44:47], v[220:223], v[124:127]
    v_mfma_f32_16x16x32_bf16 v[124:127], v[40:43], v[216:219], v[124:127]
    s_waitcnt lgkmcnt(2)
    v_mfma_f32_16x16x32_bf16 a[0:3], v[64:67], v[24:27], a[0:3]
    s_mov_b32 m0, s26
    ds_read_b128 v[40:43], v1 offset:2048
    v_mfma_f32_16x16x32_bf16 a[0:3], v[80:83], v[28:31], a[0:3]
    buffer_load_dwordx4 v4, s[4:7], s32 offen offset:0 sc1 lds
    v_mfma_f32_16x16x32_bf16 a[48:51], v[84:87], v[28:31], a[48:51]
    v_exp_f32 v16, v168
    v_mfma_f32_16x16x32_bf16 a[48:51], v[68:71], v[24:27], a[48:51]
    v_exp_f32 v17, v169
    v_mfma_f32_16x16x32_bf16 a[96:99], v[72:75], v[24:27], a[96:99]
    ds_read_b128 v[44:47], v1 offset:14336
    v_mfma_f32_16x16x32_bf16 a[96:99], v[88:91], v[28:31], a[96:99]
    v_exp_f32 v18, v170
    v_mfma_f32_16x16x32_bf16 a[144:147], v[92:95], v[28:31], a[144:147]
    v_add_f32 v7, v7, v16
    v_add_f32 v7, v7, v17
    v_mfma_f32_16x16x32_bf16 a[144:147], v[76:79], v[24:27], a[144:147]
    s_waitcnt lgkmcnt(2)
    v_exp_f32 v19, v171
    v_mfma_f32_16x16x32_bf16 a[4:7], v[64:67], v[32:35], a[4:7]
    ds_read_b128 v[24:27], v1 offset:3072
    v_cvt_pk_bf16_f32 v168, v16, v17
    v_mfma_f32_16x16x32_bf16 a[4:7], v[80:83], v[36:39], a[4:7]
    v_exp_f32 v16, v104
    v_mfma_f32_16x16x32_bf16 a[52:55], v[84:87], v[36:39], a[52:55]
    v_add_f32 v7, v7, v18
    v_add_f32 v7, v7, v19
    v_mfma_f32_16x16x32_bf16 a[52:55], v[68:71], v[32:35], a[52:55]
    buffer_load_dwordx4 v4, s[4:7], s32 offen offset:1024 sc1 lds
    v_mfma_f32_16x16x32_bf16 a[100:103], v[72:75], v[32:35], a[100:103]
    ds_read_b128 v[28:31], v1 offset:15360
    v_mfma_f32_16x16x32_bf16 a[100:103], v[88:91], v[36:39], a[100:103]
    v_exp_f32 v17, v105
    v_mfma_f32_16x16x32_bf16 a[148:151], v[92:95], v[36:39], a[148:151]
    v_cvt_pk_bf16_f32 v169, v18, v19
    v_mfma_f32_16x16x32_bf16 a[148:151], v[76:79], v[32:35], a[148:151]
    s_waitcnt lgkmcnt(2)
    v_exp_f32 v18, v106
    v_mfma_f32_16x16x32_bf16 a[8:11], v[64:67], v[40:43], a[8:11]
    ds_read_b128 v[32:35], v1 offset:4096
    v_add_f32 v7, v7, v16
    v_mfma_f32_16x16x32_bf16 a[8:11], v[80:83], v[44:47], a[8:11]
    v_add_f32 v7, v7, v17
    v_mfma_f32_16x16x32_bf16 a[56:59], v[84:87], v[44:47], a[56:59]
    v_exp_f32 v19, v107
    v_mfma_f32_16x16x32_bf16 a[56:59], v[68:71], v[40:43], a[56:59]
    v_cvt_pk_bf16_f32 v170, v16, v17
    v_mfma_f32_16x16x32_bf16 a[104:107], v[72:75], v[40:43], a[104:107]
    ds_read_b128 v[36:39], v1 offset:16384
    v_mfma_f32_16x16x32_bf16 a[104:107], v[88:91], v[44:47], a[104:107]
    v_exp_f32 v16, v172
    v_mfma_f32_16x16x32_bf16 a[152:155], v[92:95], v[44:47], a[152:155]
    v_add_f32 v7, v7, v18
    v_add_f32 v7, v7, v19
    v_mfma_f32_16x16x32_bf16 a[152:155], v[76:79], v[40:43], a[152:155]
    s_waitcnt lgkmcnt(2)
    buffer_load_dwordx4 v4, s[4:7], s32 offen offset:2048 sc1 lds
    v_mfma_f32_16x16x32_bf16 a[12:15], v[64:67], v[24:27], a[12:15]
    ds_read_b128 v[40:43], v1 offset:5120
    v_mfma_f32_16x16x32_bf16 a[12:15], v[80:83], v[28:31], a[12:15]
    v_exp_f32 v17, v173
    v_mfma_f32_16x16x32_bf16 a[60:63], v[84:87], v[28:31], a[60:63]
    v_cvt_pk_bf16_f32 v171, v18, v19
    v_mfma_f32_16x16x32_bf16 a[60:63], v[68:71], v[24:27], a[60:63]
    v_exp_f32 v18, v174
    v_mfma_f32_16x16x32_bf16 a[108:111], v[72:75], v[24:27], a[108:111]
    ds_read_b128 v[44:47], v1 offset:17408
    v_add_f32 v8, v8, v16
    v_mfma_f32_16x16x32_bf16 a[108:111], v[88:91], v[28:31], a[108:111]
    v_add_f32 v8, v8, v17
    v_mfma_f32_16x16x32_bf16 a[156:159], v[92:95], v[28:31], a[156:159]
    s_add_u32 s29, s28, 49152
    v_exp_f32 v19, v175
    v_mfma_f32_16x16x32_bf16 a[156:159], v[76:79], v[24:27], a[156:159]
    s_waitcnt lgkmcnt(2)
    v_cvt_pk_bf16_f32 v172, v16, v17
    s_sub_u32 s3, s29, 147456
    v_mfma_f32_16x16x32_bf16 a[16:19], v[64:67], v[32:35], a[16:19]
    s_add_u32 s32, s32, 24576
    ds_read_b128 v[24:27], v1 offset:6144
    v_mfma_f32_16x16x32_bf16 a[16:19], v[80:83], v[36:39], a[16:19]
    s_min_u32 s29, s29, s3
    v_exp_f32 v16, v108
    v_mfma_f32_16x16x32_bf16 a[64:67], v[84:87], v[36:39], a[64:67]
    v_add_f32 v8, v8, v18
    v_add_f32 v8, v8, v19
    v_mfma_f32_16x16x32_bf16 a[64:67], v[68:71], v[32:35], a[64:67]
    v_exp_f32 v17, v109
    v_mfma_f32_16x16x32_bf16 a[112:115], v[72:75], v[32:35], a[112:115]
    s_add_u32 s26, s26, 12288
    ds_read_b128 v[28:31], v1 offset:18432
    v_mfma_f32_16x16x32_bf16 a[112:115], v[88:91], v[36:39], a[112:115]
    v_cvt_pk_bf16_f32 v173, v18, v19
    v_mfma_f32_16x16x32_bf16 a[160:163], v[92:95], v[36:39], a[160:163]
    v_exp_f32 v18, v110
    v_mfma_f32_16x16x32_bf16 a[160:163], v[76:79], v[32:35], a[160:163]
    s_waitcnt lgkmcnt(2)
    v_add_f32 v8, v8, v16
    v_mfma_f32_16x16x32_bf16 a[20:23], v[64:67], v[40:43], a[20:23]
    s_sub_u32 s3, s29, s28
    ds_read_b128 v[32:35], v1 offset:7168
    v_add_f32 v8, v8, v17
    v_mfma_f32_16x16x32_bf16 a[20:23], v[80:83], v[44:47], a[20:23]
    v_exp_f32 v19, v111
    v_mfma_f32_16x16x32_bf16 a[68:71], v[84:87], v[44:47], a[68:71]
    s_mov_b32 m0, s26
    v_mfma_f32_16x16x32_bf16 a[68:71], v[68:71], v[40:43], a[68:71]
    v_cvt_pk_bf16_f32 v174, v16, v17
    v_mfma_f32_16x16x32_bf16 a[116:119], v[72:75], v[40:43], a[116:119]
    ds_read_b128 v[36:39], v1 offset:19456
    v_add_f32 v8, v8, v18
    v_mfma_f32_16x16x32_bf16 a[116:119], v[88:91], v[44:47], a[116:119]
    v_add_f32 v8, v8, v19
    v_cvt_pk_bf16_f32 v175, v18, v19
    v_mfma_f32_16x16x32_bf16 a[164:167], v[92:95], v[44:47], a[164:167]
    s_mov_b32 s28, s29
    v_mfma_f32_16x16x32_bf16 a[164:167], v[76:79], v[40:43], a[164:167]
    s_waitcnt lgkmcnt(2)
    v_exp_f32 v16, v176
    v_mfma_f32_16x16x32_bf16 a[24:27], v[64:67], v[24:27], a[24:27]
    ds_read_b128 v[40:43], v1 offset:8192
    v_mfma_f32_16x16x32_bf16 a[24:27], v[80:83], v[28:31], a[24:27]
    v_exp_f32 v17, v177
    v_mfma_f32_16x16x32_bf16 a[72:75], v[84:87], v[28:31], a[72:75]
    v_exp_f32 v18, v178
    v_mfma_f32_16x16x32_bf16 a[72:75], v[68:71], v[24:27], a[72:75]
    buffer_load_dwordx4 v4, s[4:7], s32 offen offset:0 sc1 lds
    v_mfma_f32_16x16x32_bf16 a[120:123], v[72:75], v[24:27], a[120:123]
    ds_read_b128 v[44:47], v1 offset:20480
    v_add_f32 v5, v5, v16
    v_mfma_f32_16x16x32_bf16 a[120:123], v[88:91], v[28:31], a[120:123]
    v_add_f32 v5, v5, v17
    v_add_u32 v2, s3, v2
    v_mfma_f32_16x16x32_bf16 a[168:171], v[92:95], v[28:31], a[168:171]
    v_exp_f32 v19, v179
    v_mfma_f32_16x16x32_bf16 a[168:171], v[76:79], v[24:27], a[168:171]
    s_waitcnt lgkmcnt(2)
    v_cvt_pk_bf16_f32 v176, v16, v17
    v_mfma_f32_16x16x32_bf16 a[28:31], v[64:67], v[32:35], a[28:31]
    ds_read_b128 v[24:27], v1 offset:9216
    v_mfma_f32_16x16x32_bf16 a[28:31], v[80:83], v[36:39], a[28:31]
    v_exp_f32 v16, v112
    v_mfma_f32_16x16x32_bf16 a[76:79], v[84:87], v[36:39], a[76:79]
    v_add_f32 v5, v5, v18
    v_add_f32 v5, v5, v19
    v_mfma_f32_16x16x32_bf16 a[76:79], v[68:71], v[32:35], a[76:79]
    v_exp_f32 v17, v113
    v_mfma_f32_16x16x32_bf16 a[124:127], v[72:75], v[32:35], a[124:127]
    ds_read_b128 v[28:31], v1 offset:21504
    v_add_u32 v3, s3, v3
    v_mfma_f32_16x16x32_bf16 a[124:127], v[88:91], v[36:39], a[124:127]
    v_cvt_pk_bf16_f32 v177, v18, v19
    v_mfma_f32_16x16x32_bf16 a[172:175], v[92:95], v[36:39], a[172:175]
    v_exp_f32 v18, v114
    v_mfma_f32_16x16x32_bf16 a[172:175], v[76:79], v[32:35], a[172:175]
    s_waitcnt lgkmcnt(2)
    buffer_load_dwordx4 v4, s[4:7], s32 offen offset:1024 sc1 lds
    v_mfma_f32_16x16x32_bf16 a[32:35], v[64:67], v[40:43], a[32:35]
    ds_read_b128 v[32:35], v1 offset:10240
    v_add_f32 v5, v5, v16
    v_mfma_f32_16x16x32_bf16 a[32:35], v[80:83], v[44:47], a[32:35]
    v_add_f32 v5, v5, v17
    v_mfma_f32_16x16x32_bf16 a[80:83], v[84:87], v[44:47], a[80:83]
    v_exp_f32 v19, v115
    v_mfma_f32_16x16x32_bf16 a[80:83], v[68:71], v[40:43], a[80:83]
    v_cvt_pk_bf16_f32 v178, v16, v17
    v_mfma_f32_16x16x32_bf16 a[128:131], v[72:75], v[40:43], a[128:131]
    ds_read_b128 v[36:39], v1 offset:22528
    v_mfma_f32_16x16x32_bf16 a[128:131], v[88:91], v[44:47], a[128:131]
    v_exp_f32 v16, v180
    v_mfma_f32_16x16x32_bf16 a[176:179], v[92:95], v[44:47], a[176:179]
    v_add_f32 v5, v5, v18
    v_add_f32 v5, v5, v19
    v_mfma_f32_16x16x32_bf16 a[176:179], v[76:79], v[40:43], a[176:179]
    s_waitcnt lgkmcnt(2)
    v_exp_f32 v17, v181
    v_mfma_f32_16x16x32_bf16 a[36:39], v[64:67], v[24:27], a[36:39]
    ds_read_b128 v[40:43], v1 offset:11264
    v_mfma_f32_16x16x32_bf16 a[36:39], v[80:83], v[28:31], a[36:39]
    buffer_load_dwordx4 v4, s[4:7], s32 offen offset:2048 sc1 lds
    v_mfma_f32_16x16x32_bf16 a[84:87], v[84:87], v[28:31], a[84:87]
    v_cvt_pk_bf16_f32 v179, v18, v19
    v_mfma_f32_16x16x32_bf16 a[84:87], v[68:71], v[24:27], a[84:87]
    v_exp_f32 v18, v182
    v_mfma_f32_16x16x32_bf16 a[132:135], v[72:75], v[24:27], a[132:135]
    ds_read_b128 v[44:47], v1 offset:23552
    v_add_f32 v6, v6, v16
    v_mfma_f32_16x16x32_bf16 a[132:135], v[88:91], v[28:31], a[132:135]
    s_waitcnt lgkmcnt(2)
    v_add_f32 v6, v6, v17
    v_mfma_f32_16x16x32_bf16 a[180:183], v[92:95], v[28:31], a[180:183]
    s_waitcnt vmcnt(7)
    v_exp_f32 v19, v183
    v_mfma_f32_16x16x32_bf16 a[180:183], v[76:79], v[24:27], a[180:183]
    s_barrier
    v_mfma_f32_16x16x32_bf16 a[40:43], v[64:67], v[32:35], a[40:43]
    ds_read_b128 v[24:27], v2 offset:0
    v_cvt_pk_bf16_f32 v180, v16, v17
    v_mfma_f32_16x16x32_bf16 a[40:43], v[80:83], v[36:39], a[40:43]
    v_exp_f32 v16, v116
    v_mfma_f32_16x16x32_bf16 a[88:91], v[84:87], v[36:39], a[88:91]
    v_add_f32 v6, v6, v18
    v_add_f32 v6, v6, v19
    v_mfma_f32_16x16x32_bf16 a[88:91], v[68:71], v[32:35], a[88:91]
    v_exp_f32 v17, v117
    v_mfma_f32_16x16x32_bf16 a[136:139], v[72:75], v[32:35], a[136:139]
    ds_read_b128 v[28:31], v3 offset:0
    v_mfma_f32_16x16x32_bf16 a[136:139], v[88:91], v[36:39], a[136:139]
    v_cvt_pk_bf16_f32 v181, v18, v19
    v_mfma_f32_16x16x32_bf16 a[184:187], v[92:95], v[36:39], a[184:187]
    v_exp_f32 v18, v118
    v_mfma_f32_16x16x32_bf16 a[184:187], v[76:79], v[32:35], a[184:187]
    s_waitcnt lgkmcnt(2)
    v_add_f32 v6, v6, v16
    v_mfma_f32_16x16x32_bf16 a[44:47], v[64:67], v[40:43], a[44:47]
    ds_read_b128 v[32:35], v2 offset:6144
    v_add_f32 v6, v6, v17
    v_mfma_f32_16x16x32_bf16 a[44:47], v[80:83], v[44:47], a[44:47]
    v_exp_f32 v19, v119
    v_mfma_f32_16x16x32_bf16 a[92:95], v[84:87], v[44:47], a[92:95]
    v_mfma_f32_16x16x32_bf16 a[92:95], v[68:71], v[40:43], a[92:95]
    s_add_u32 s32, s32, 24576
    s_add_u32 s26, s26, 36864
    v_cvt_pk_bf16_f32 v182, v16, v17
    v_mfma_f32_16x16x32_bf16 a[140:143], v[72:75], v[40:43], a[140:143]
    s_sub_u32 s57, s26, 147456
    ds_read_b128 v[36:39], v3 offset:6144
    v_add_f32 v6, v6, v18
    v_mfma_f32_16x16x32_bf16 a[140:143], v[88:91], v[44:47], a[140:143]
    s_min_u32 s26, s26, s57
    v_add_f32 v6, v6, v19
    v_cvt_pk_bf16_f32 v183, v18, v19
    v_mfma_f32_16x16x32_bf16 a[188:191], v[92:95], v[44:47], a[188:191]
    v_mfma_f32_16x16x32_bf16 a[188:191], v[76:79], v[40:43], a[188:191]
    s_waitcnt lgkmcnt(2)
    v_mfma_f32_16x16x32_bf16 v[64:67], v[24:27], a[192:195], v[128:131]
    ds_read_b128 v[40:43], v2 offset:128
    v_mfma_f32_16x16x32_bf16 v[64:67], v[28:31], a[196:199], v[64:67]
    v_exp_f32 v16, v184
    v_mfma_f32_16x16x32_bf16 v[68:71], v[28:31], a[220:223], v[132:135]
    v_exp_f32 v17, v185
    v_mfma_f32_16x16x32_bf16 v[68:71], v[24:27], a[216:219], v[68:71]
    buffer_load_dword v52, v20, s[20:23], s44 offen sc1
    v_mfma_f32_16x16x32_bf16 v[72:75], v[24:27], a[240:243], v[136:139]
    ds_read_b128 v[44:47], v3 offset:128
    v_mfma_f32_16x16x32_bf16 v[72:75], v[28:31], a[244:247], v[72:75]
    v_exp_f32 v18, v186
    v_mfma_f32_16x16x32_bf16 v[76:79], v[28:31], v[204:207], v[140:143]
    v_add_f32 v7, v7, v16
    v_add_f32 v7, v7, v17
    v_mfma_f32_16x16x32_bf16 v[76:79], v[24:27], v[200:203], v[76:79]
    s_waitcnt lgkmcnt(2)
    v_exp_f32 v19, v187
    v_mfma_f32_16x16x32_bf16 v[96:99], v[32:35], a[192:195], v[128:131]
    ds_read_b128 v[24:27], v2 offset:6272
    v_cvt_pk_bf16_f32 v184, v16, v17
    v_mfma_f32_16x16x32_bf16 v[96:99], v[36:39], a[196:199], v[96:99]
    v_exp_f32 v16, v120
    v_mfma_f32_16x16x32_bf16 v[100:103], v[36:39], a[220:223], v[132:135]
    v_add_f32 v7, v7, v18
    v_add_f32 v7, v7, v19
    v_mfma_f32_16x16x32_bf16 v[100:103], v[32:35], a[216:219], v[100:103]
    s_mov_b32 m0, s26
    v_exp_f32 v17, v121
    v_mfma_f32_16x16x32_bf16 v[104:107], v[32:35], a[240:243], v[136:139]
    ds_read_b128 v[28:31], v3 offset:6272
    v_mfma_f32_16x16x32_bf16 v[104:107], v[36:39], a[244:247], v[104:107]
    buffer_load_dwordx4 v4, s[4:7], s32 offen offset:0 sc1 lds
    v_mfma_f32_16x16x32_bf16 v[108:111], v[36:39], v[204:207], v[140:143]
    v_cvt_pk_bf16_f32 v185, v18, v19
    v_mfma_f32_16x16x32_bf16 v[108:111], v[32:35], v[200:203], v[108:111]
    s_waitcnt lgkmcnt(2)
    v_exp_f32 v18, v122
    v_mfma_f32_16x16x32_bf16 v[64:67], v[40:43], a[200:203], v[64:67]
    ds_read_b128 v[32:35], v2 offset:256
    v_add_f32 v7, v7, v16
    v_mfma_f32_16x16x32_bf16 v[64:67], v[44:47], a[204:207], v[64:67]
    v_add_f32 v7, v7, v17
    v_mfma_f32_16x16x32_bf16 v[68:71], v[44:47], a[228:231], v[68:71]
    v_exp_f32 v19, v123
    v_mfma_f32_16x16x32_bf16 v[68:71], v[40:43], a[224:227], v[68:71]
    v_cvt_pk_bf16_f32 v186, v16, v17
    v_mfma_f32_16x16x32_bf16 v[72:75], v[40:43], a[248:251], v[72:75]
    ds_read_b128 v[36:39], v3 offset:256
    v_mfma_f32_16x16x32_bf16 v[72:75], v[44:47], a[252:255], v[72:75]
    buffer_load_dwordx4 v4, s[4:7], s32 offen offset:1024 sc1 lds
    v_mfma_f32_16x16x32_bf16 v[76:79], v[44:47], v[212:215], v[76:79]
    v_exp_f32 v16, v188
    v_mfma_f32_16x16x32_bf16 v[76:79], v[40:43], v[208:211], v[76:79]
    s_waitcnt lgkmcnt(2)
    v_add_f32 v7, v7, v18
    v_add_f32 v7, v7, v19
    v_mfma_f32_16x16x32_bf16 v[96:99], v[24:27], a[200:203], v[96:99]
    ds_read_b128 v[40:43], v2 offset:6400
    v_mfma_f32_16x16x32_bf16 v[96:99], v[28:31], a[204:207], v[96:99]
    v_exp_f32 v17, v189
    v_mfma_f32_16x16x32_bf16 v[100:103], v[28:31], a[228:231], v[100:103]
    v_cvt_pk_bf16_f32 v187, v18, v19
    v_mfma_f32_16x16x32_bf16 v[100:103], v[24:27], a[224:227], v[100:103]
    v_exp_f32 v18, v190
    v_mfma_f32_16x16x32_bf16 v[104:107], v[24:27], a[248:251], v[104:107]
    ds_read_b128 v[44:47], v3 offset:6400
    v_add_f32 v8, v8, v16
    v_mfma_f32_16x16x32_bf16 v[104:107], v[28:31], a[252:255], v[104:107]
    v_add_f32 v8, v8, v17
    v_mfma_f32_16x16x32_bf16 v[108:111], v[28:31], v[212:215], v[108:111]
    s_add_u32 s29, s30, 49152
    v_exp_f32 v19, v191
    v_mfma_f32_16x16x32_bf16 v[108:111], v[24:27], v[208:211], v[108:111]
    s_waitcnt lgkmcnt(2)
    buffer_load_dwordx4 v4, s[4:7], s32 offen offset:2048 sc1 lds
    v_mfma_f32_16x16x32_bf16 v[64:67], v[32:35], a[208:211], v[64:67]
    s_sub_u32 s3, s29, 147456
    ds_read_b128 v[24:27], v2 offset:12288
    v_cvt_pk_bf16_f32 v188, v16, v17
    v_mfma_f32_16x16x32_bf16 v[64:67], v[36:39], a[212:215], v[64:67]
    s_min_u32 s29, s29, s3
    v_exp_f32 v16, v124
    v_mfma_f32_16x16x32_bf16 v[68:71], v[36:39], a[236:239], v[68:71]
    v_add_f32 v8, v8, v18
    v_add_f32 v8, v8, v19
    v_mfma_f32_16x16x32_bf16 v[68:71], v[32:35], a[232:235], v[68:71]
    v_exp_f32 v17, v125
    v_mfma_f32_16x16x32_bf16 v[72:75], v[32:35], v[192:195], v[72:75]
    ds_read_b128 v[28:31], v3 offset:12288
    v_mfma_f32_16x16x32_bf16 v[72:75], v[36:39], v[196:199], v[72:75]
    v_cvt_pk_bf16_f32 v189, v18, v19
    v_mfma_f32_16x16x32_bf16 v[76:79], v[36:39], v[220:223], v[76:79]
    v_exp_f32 v18, v126
    v_mfma_f32_16x16x32_bf16 v[76:79], v[32:35], v[216:219], v[76:79]
    s_waitcnt lgkmcnt(2)
    v_add_f32 v8, v8, v16
    s_add_u32 s32, s32, 24576
    v_mfma_f32_16x16x32_bf16 v[96:99], v[40:43], a[208:211], v[96:99]
    ds_read_b128 v[32:35], v2 offset:18432
    v_add_f32 v8, v8, v17
    v_mfma_f32_16x16x32_bf16 v[96:99], v[44:47], a[212:215], v[96:99]
    s_sub_u32 s3, s29, s30
    v_exp_f32 v19, v127
    v_mfma_f32_16x16x32_bf16 v[100:103], v[44:47], a[236:239], v[100:103]
    v_mfma_f32_16x16x32_bf16 v[100:103], v[40:43], a[232:235], v[100:103]
    v_cvt_pk_bf16_f32 v190, v16, v17
    v_mfma_f32_16x16x32_bf16 v[104:107], v[40:43], v[192:195], v[104:107]
    s_add_u32 s26, s26, 12288
    ds_read_b128 v[36:39], v3 offset:18432
    v_add_f32 v8, v8, v18
    v_mfma_f32_16x16x32_bf16 v[104:107], v[44:47], v[196:199], v[104:107]
    v_add_f32 v8, v8, v19
    v_cvt_pk_bf16_f32 v191, v18, v19
    v_mfma_f32_16x16x32_bf16 v[108:111], v[44:47], v[220:223], v[108:111]
    v_mfma_f32_16x16x32_bf16 v[108:111], v[40:43], v[216:219], v[108:111]
    s_waitcnt lgkmcnt(2)
    v_exp_f32 v16, v64
    v_mfma_f32_16x16x32_bf16 v[80:83], v[24:27], a[192:195], v[128:131]
    ds_read_b128 v[40:43], v2 offset:12416
    v_mfma_f32_16x16x32_bf16 v[80:83], v[28:31], a[196:199], v[80:83]
    s_mov_b32 m0, s26
    v_exp_f32 v17, v65
    v_mfma_f32_16x16x32_bf16 v[84:87], v[28:31], a[220:223], v[132:135]
    s_mov_b32 s30, s29
    v_exp_f32 v18, v66
    v_mfma_f32_16x16x32_bf16 v[84:87], v[24:27], a[216:219], v[84:87]
    v_add_f32 v5, v5, v16
    v_mfma_f32_16x16x32_bf16 v[88:91], v[24:27], a[240:243], v[136:139]
    ds_read_b128 v[44:47], v3 offset:12416
    v_add_f32 v5, v5, v17
    v_mfma_f32_16x16x32_bf16 v[88:91], v[28:31], a[244:247], v[88:91]
    v_exp_f32 v19, v67
    v_mfma_f32_16x16x32_bf16 v[92:95], v[28:31], v[204:207], v[140:143]
    v_mfma_f32_16x16x32_bf16 v[92:95], v[24:27], v[200:203], v[92:95]
    s_waitcnt lgkmcnt(2)
    v_cvt_pk_bf16_f32 v64, v16, v17
    v_mfma_f32_16x16x32_bf16 v[112:115], v[32:35], a[192:195], v[128:131]
    ds_read_b128 v[24:27], v2 offset:18560
    v_mfma_f32_16x16x32_bf16 v[112:115], v[36:39], a[196:199], v[112:115]
    buffer_load_dwordx4 v4, s[4:7], s32 offen offset:0 sc1 lds
    v_mfma_f32_16x16x32_bf16 v[116:119], v[36:39], a[220:223], v[132:135]
    v_exp_f32 v16, v96
    v_mfma_f32_16x16x32_bf16 v[116:119], v[32:35], a[216:219], v[116:119]
    v_add_f32 v5, v5, v18
    v_add_f32 v5, v5, v19
    v_mfma_f32_16x16x32_bf16 v[120:123], v[32:35], a[240:243], v[136:139]
    ds_read_b128 v[28:31], v3 offset:18560
    v_add_u32 v1, s3, v1
    v_mfma_f32_16x16x32_bf16 v[120:123], v[36:39], a[244:247], v[120:123]
    v_exp_f32 v17, v97
    v_mfma_f32_16x16x32_bf16 v[124:127], v[36:39], v[204:207], v[140:143]
    v_cvt_pk_bf16_f32 v65, v18, v19
    v_mfma_f32_16x16x32_bf16 v[124:127], v[32:35], v[200:203], v[124:127]
    s_waitcnt lgkmcnt(2)
    v_exp_f32 v18, v98
    v_mfma_f32_16x16x32_bf16 v[80:83], v[40:43], a[200:203], v[80:83]
    ds_read_b128 v[32:35], v2 offset:12544
    v_add_f32 v5, v5, v16
    v_mfma_f32_16x16x32_bf16 v[80:83], v[44:47], a[204:207], v[80:83]
    v_add_f32 v5, v5, v17
    v_mfma_f32_16x16x32_bf16 v[84:87], v[44:47], a[228:231], v[84:87]
    v_exp_f32 v19, v99
    v_mfma_f32_16x16x32_bf16 v[84:87], v[40:43], a[224:227], v[84:87]
    buffer_load_dwordx4 v4, s[4:7], s32 offen offset:1024 sc1 lds
    v_mfma_f32_16x16x32_bf16 v[88:91], v[40:43], a[248:251], v[88:91]
    ds_read_b128 v[36:39], v3 offset:12544
    v_cvt_pk_bf16_f32 v66, v16, v17
    v_mfma_f32_16x16x32_bf16 v[88:91], v[44:47], a[252:255], v[88:91]
    v_exp_f32 v16, v68
    v_mfma_f32_16x16x32_bf16 v[92:95], v[44:47], v[212:215], v[92:95]
    v_add_f32 v5, v5, v18
    v_add_f32 v5, v5, v19
    v_mfma_f32_16x16x32_bf16 v[92:95], v[40:43], v[208:211], v[92:95]
    s_waitcnt lgkmcnt(2)
    v_exp_f32 v17, v69
    v_mfma_f32_16x16x32_bf16 v[112:115], v[24:27], a[200:203], v[112:115]
    ds_read_b128 v[40:43], v2 offset:18688
    v_mfma_f32_16x16x32_bf16 v[112:115], v[28:31], a[204:207], v[112:115]
    v_cvt_pk_bf16_f32 v67, v18, v19
    v_mfma_f32_16x16x32_bf16 v[116:119], v[28:31], a[228:231], v[116:119]
    v_exp_f32 v18, v70
    v_mfma_f32_16x16x32_bf16 v[116:119], v[24:27], a[224:227], v[116:119]
    v_add_f32 v6, v6, v16
    v_mfma_f32_16x16x32_bf16 v[120:123], v[24:27], a[248:251], v[120:123]
    ds_read_b128 v[44:47], v3 offset:18688
    v_add_f32 v6, v6, v17
    v_mfma_f32_16x16x32_bf16 v[120:123], v[28:31], a[252:255], v[120:123]
    s_waitcnt lgkmcnt(2)
    buffer_load_dwordx4 v4, s[4:7], s32 offen offset:2048 sc1 lds
    v_mfma_f32_16x16x32_bf16 v[124:127], v[28:31], v[212:215], v[124:127]
    s_waitcnt vmcnt(7)
    v_exp_f32 v19, v71
    v_mfma_f32_16x16x32_bf16 v[124:127], v[24:27], v[208:211], v[124:127]
    s_barrier
    v_mfma_f32_16x16x32_bf16 v[80:83], v[32:35], a[208:211], v[80:83]
    ds_read_b128 v[24:27], v1 offset:0
    v_cvt_pk_bf16_f32 v68, v16, v17
    v_mfma_f32_16x16x32_bf16 v[80:83], v[36:39], a[212:215], v[80:83]
    v_exp_f32 v16, v100
    v_mfma_f32_16x16x32_bf16 v[84:87], v[36:39], a[236:239], v[84:87]
    v_add_f32 v6, v6, v18
    v_add_f32 v6, v6, v19
    v_mfma_f32_16x16x32_bf16 v[84:87], v[32:35], a[232:235], v[84:87]
    v_exp_f32 v17, v101
    v_mfma_f32_16x16x32_bf16 v[88:91], v[32:35], v[192:195], v[88:91]
    ds_read_b128 v[28:31], v1 offset:12288
    v_mfma_f32_16x16x32_bf16 v[88:91], v[36:39], v[196:199], v[88:91]
    v_cvt_pk_bf16_f32 v69, v18, v19
    v_mfma_f32_16x16x32_bf16 v[92:95], v[36:39], v[220:223], v[92:95]
    v_exp_f32 v18, v102
    v_mfma_f32_16x16x32_bf16 v[92:95], v[32:35], v[216:219], v[92:95]
    s_waitcnt lgkmcnt(2)
    v_add_f32 v6, v6, v16
    v_mfma_f32_16x16x32_bf16 v[112:115], v[40:43], a[208:211], v[112:115]
    ds_read_b128 v[32:35], v1 offset:1024
    v_add_f32 v6, v6, v17
    v_mfma_f32_16x16x32_bf16 v[112:115], v[44:47], a[212:215], v[112:115]
    v_exp_f32 v19, v103
    v_mfma_f32_16x16x32_bf16 v[116:119], v[44:47], a[236:239], v[116:119]
    v_mfma_f32_16x16x32_bf16 v[116:119], v[40:43], a[232:235], v[116:119]
    v_cvt_pk_bf16_f32 v70, v16, v17
    v_mfma_f32_16x16x32_bf16 v[120:123], v[40:43], v[192:195], v[120:123]
    ds_read_b128 v[36:39], v1 offset:13312
    v_add_f32 v6, v6, v18
    v_mfma_f32_16x16x32_bf16 v[120:123], v[44:47], v[196:199], v[120:123]
    s_add_u32 s32, s32, 24576
    s_add_u32 s26, s26, 36864
    v_add_f32 v6, v6, v19
    v_mfma_f32_16x16x32_bf16 v[124:127], v[44:47], v[220:223], v[124:127]
    s_sub_u32 s57, s26, 147456
    v_cvt_pk_bf16_f32 v71, v18, v19
    s_min_u32 s26, s26, s57
    v_mfma_f32_16x16x32_bf16 v[124:127], v[40:43], v[216:219], v[124:127]
    s_waitcnt lgkmcnt(2)
    v_mfma_f32_16x16x32_bf16 a[0:3], v[160:163], v[24:27], a[0:3]
    ds_read_b128 v[40:43], v1 offset:2048
    v_mfma_f32_16x16x32_bf16 a[0:3], v[176:179], v[28:31], a[0:3]
    s_waitcnt vmcnt(6)
    v_subrev_u32 v52, s92, v52
    v_cmp_lt_u32 vcc, 15, v52
    v_mfma_f32_16x16x32_bf16 a[48:51], v[180:183], v[28:31], a[48:51]
    v_exp_f32 v16, v72
    v_mfma_f32_16x16x32_bf16 a[48:51], v[164:167], v[24:27], a[48:51]
    v_exp_f32 v17, v73
    v_mfma_f32_16x16x32_bf16 a[96:99], v[168:171], v[24:27], a[96:99]
    s_and_b32 s59, vcc_lo, 0xff
    ds_read_b128 v[44:47], v1 offset:14336
    v_mfma_f32_16x16x32_bf16 a[96:99], v[184:187], v[28:31], a[96:99]
    s_cbranch_scc1 L_pollslow4
L_pollok4:
    v_mfma_f32_16x16x32_bf16 a[144:147], v[188:191], v[28:31], a[144:147]
    s_add_u32 s92, s92, 1
    v_exp_f32 v18, v74
    v_mfma_f32_16x16x32_bf16 a[144:147], v[172:175], v[24:27], a[144:147]
    s_waitcnt lgkmcnt(2)
    v_add_f32 v7, v7, v16
    v_add_f32 v7, v7, v17
    v_mfma_f32_16x16x32_bf16 a[4:7], v[160:163], v[32:35], a[4:7]
    ds_read_b128 v[24:27], v1 offset:3072
    v_mfma_f32_16x16x32_bf16 a[4:7], v[176:179], v[36:39], a[4:7]
    v_exp_f32 v19, v75
    v_mfma_f32_16x16x32_bf16 a[52:55], v[180:183], v[36:39], a[52:55]
    v_cvt_pk_bf16_f32 v72, v16, v17
    v_mfma_f32_16x16x32_bf16 a[52:55], v[164:167], v[32:35], a[52:55]
    v_exp_f32 v16, v104
    v_mfma_f32_16x16x32_bf16 a[100:103], v[168:171], v[32:35], a[100:103]
    ds_read_b128 v[28:31], v1 offset:15360
    v_add_f32 v7, v7, v18
    v_mfma_f32_16x16x32_bf16 a[100:103], v[184:187], v[36:39], a[100:103]
    s_waitcnt lgkmcnt(2)
    v_add_f32 v7, v7, v19
    v_mfma_f32_16x16x32_bf16 a[148:151], v[188:191], v[36:39], a[148:151]
    s_waitcnt vmcnt(0)
    v_exp_f32 v17, v105
    v_mfma_f32_16x16x32_bf16 a[148:151], v[172:175], v[32:35], a[148:151]
    s_barrier
    v_mfma_f32_16x16x32_bf16 a[8:11], v[160:163], v[40:43], a[8:11]
    s_mov_b32 m0, s56
    ds_read_b128 v[32:35], v1 offset:4096
    v_cvt_pk_bf16_f32 v73, v18, v19
    v_mfma_f32_16x16x32_bf16 a[8:11], v[176:179], v[44:47], a[8:11]
    buffer_load_dwordx4 v4, s[4:7], s27 offen offset:0 sc1 lds
    v_mfma_f32_16x16x32_bf16 a[56:59], v[180:183], v[44:47], a[56:59]
    v_exp_f32 v18, v106
    v_mfma_f32_16x16x32_bf16 a[56:59], v[164:167], v[40:43], a[56:59]
    v_add_f32 v7, v7, v16
    v_add_f32 v7, v7, v17
    v_mfma_f32_16x16x32_bf16 a[104:107], v[168:171], v[40:43], a[104:107]
    ds_read_b128 v[36:39], v1 offset:16384
    v_mfma_f32_16x16x32_bf16 a[104:107], v[184:187], v[44:47], a[104:107]
    buffer_load_dwordx4 v4, s[4:7], s27 offen offset:1024 sc1 lds
    v_mfma_f32_16x16x32_bf16 a[152:155], v[188:191], v[44:47], a[152:155]
    v_exp_f32 v19, v107
    v_mfma_f32_16x16x32_bf16 a[152:155], v[172:175], v[40:43], a[152:155]
    s_waitcnt lgkmcnt(2)
    v_cvt_pk_bf16_f32 v74, v16, v17
    v_mfma_f32_16x16x32_bf16 a[12:15], v[160:163], v[24:27], a[12:15]
L_pg10:
    s_cbranch_execz L_iwret
    ds_read_b128 v[40:43], v1 offset:5120
    v_mfma_f32_16x16x32_bf16 a[12:15], v[176:179], v[28:31], a[12:15]
    buffer_load_dwordx4 v4, s[4:7], s27 offen offset:2048 sc1 lds
    v_mfma_f32_16x16x32_bf16 a[60:63], v[180:183], v[28:31], a[60:63]
    v_exp_f32 v16, v76
    v_mfma_f32_16x16x32_bf16 a[60:63], v[164:167], v[24:27], a[60:63]
    s_add_u32 s27, s27, 24576
    v_add_f32 v7, v7, v18
    v_add_f32 v7, v7, v19
    v_mfma_f32_16x16x32_bf16 a[108:111], v[168:171], v[24:27], a[108:111]
    ds_read_b128 v[44:47], v1 offset:17408
    v_mfma_f32_16x16x32_bf16 a[108:111], v[184:187], v[28:31], a[108:111]
    s_add_u32 s56, s56, 12288
    v_exp_f32 v17, v77
    v_mfma_f32_16x16x32_bf16 a[156:159], v[188:191], v[28:31], a[156:159]
    s_add_u32 s29, s28, 49152
    v_cvt_pk_bf16_f32 v75, v18, v19
    v_mfma_f32_16x16x32_bf16 a[156:159], v[172:175], v[24:27], a[156:159]
    s_waitcnt lgkmcnt(2)
    v_exp_f32 v18, v78
    v_mfma_f32_16x16x32_bf16 a[16:19], v[160:163], v[32:35], a[16:19]
    s_sub_u32 s3, s29, 147456
    ds_read_b128 v[24:27], v1 offset:6144
    v_add_f32 v8, v8, v16
    v_mfma_f32_16x16x32_bf16 a[16:19], v[176:179], v[36:39], a[16:19]
    s_mov_b32 m0, s56
    v_add_f32 v8, v8, v17
    s_min_u32 s29, s29, s3
    v_mfma_f32_16x16x32_bf16 a[64:67], v[180:183], v[36:39], a[64:67]
    v_exp_f32 v19, v79
    v_mfma_f32_16x16x32_bf16 a[64:67], v[164:167], v[32:35], a[64:67]
    buffer_load_dwordx4 v4, s[4:7], s27 offen offset:0 sc1 lds
    v_mfma_f32_16x16x32_bf16 a[112:115], v[168:171], v[32:35], a[112:115]
    ds_read_b128 v[28:31], v1 offset:18432
    v_cvt_pk_bf16_f32 v76, v16, v17
    v_mfma_f32_16x16x32_bf16 a[112:115], v[184:187], v[36:39], a[112:115]
    v_exp_f32 v16, v108
    v_mfma_f32_16x16x32_bf16 a[160:163], v[188:191], v[36:39], a[160:163]
    v_add_f32 v8, v8, v18
    v_add_f32 v8, v8, v19
    v_mfma_f32_16x16x32_bf16 a[160:163], v[172:175], v[32:35], a[160:163]
    s_waitcnt lgkmcnt(2)
    buffer_load_dwordx4 v4, s[4:7], s27 offen offset:1024 sc1 lds
    v_mfma_f32_16x16x32_bf16 a[20:23], v[160:163], v[40:43], a[20:23]
    s_sub_u32 s3, s29, s28
    ds_read_b128 v[32:35], v1 offset:7168
    v_mfma_f32_16x16x32_bf16 a[20:23], v[176:179], v[44:47], a[20:23]
    v_exp_f32 v17, v109
    v_mfma_f32_16x16x32_bf16 a[68:71], v[180:183], v[44:47], a[68:71]
    v_cvt_pk_bf16_f32 v77, v18, v19
    v_mfma_f32_16x16x32_bf16 a[68:71], v[164:167], v[40:43], a[68:71]
    buffer_load_dwordx4 v4, s[4:7], s27 offen offset:2048 sc1 lds
    v_mfma_f32_16x16x32_bf16 a[116:119], v[168:171], v[40:43], a[116:119]
    ds_read_b128 v[36:39], v1 offset:19456
    v_mfma_f32_16x16x32_bf16 a[116:119], v[184:187], v[44:47], a[116:119]
    v_exp_f32 v18, v110
    v_mfma_f32_16x16x32_bf16 a[164:167], v[188:191], v[44:47], a[164:167]
    s_add_u32 s27, s27, 24576
    v_add_f32 v8, v8, v16
    v_add_f32 v8, v8, v17
    v_mfma_f32_16x16x32_bf16 a[164:167], v[172:175], v[40:43], a[164:167]
    s_waitcnt lgkmcnt(2)
    v_exp_f32 v19, v111
    v_mfma_f32_16x16x32_bf16 a[24:27], v[160:163], v[24:27], a[24:27]
    s_add_u32 s56, s56, 36864
    ds_read_b128 v[40:43], v1 offset:8192
    v_cvt_pk_bf16_f32 v78, v16, v17
    v_mfma_f32_16x16x32_bf16 a[24:27], v[176:179], v[28:31], a[24:27]
    s_mov_b32 s28, s29
    v_add_f32 v8, v8, v18
    v_add_f32 v8, v8, v19
    v_mfma_f32_16x16x32_bf16 a[72:75], v[180:183], v[28:31], a[72:75]
    s_sub_u32 s58, s56, 147456
    v_cvt_pk_bf16_f32 v79, v18, v19
    v_mfma_f32_16x16x32_bf16 a[72:75], v[164:167], v[24:27], a[72:75]
    v_exp_f32 v16, v80
    v_mfma_f32_16x16x32_bf16 a[120:123], v[168:171], v[24:27], a[120:123]
    s_min_u32 s56, s56, s58
    ds_read_b128 v[44:47], v1 offset:20480
    v_mfma_f32_16x16x32_bf16 a[120:123], v[184:187], v[28:31], a[120:123]
    v_exp_f32 v17, v81
    v_mfma_f32_16x16x32_bf16 a[168:171], v[188:191], v[28:31], a[168:171]
    s_mov_b32 m0, s26
    v_exp_f32 v18, v82
    v_mfma_f32_16x16x32_bf16 a[168:171], v[172:175], v[24:27], a[168:171]
    s_waitcnt lgkmcnt(2)
    v_add_f32 v5, v5, v16
    v_add_f32 v5, v5, v17
    v_mfma_f32_16x16x32_bf16 a[28:31], v[160:163], v[32:35], a[28:31]
    ds_read_b128 v[24:27], v1 offset:9216
    v_add_u32 v2, s3, v2
    v_mfma_f32_16x16x32_bf16 a[28:31], v[176:179], v[36:39], a[28:31]
    buffer_load_dwordx4 v4, s[4:7], s32 offen offset:0 sc1 lds
    v_mfma_f32_16x16x32_bf16 a[76:79], v[180:183], v[36:39], a[76:79]
    v_exp_f32 v19, v83
    v_mfma_f32_16x16x32_bf16 a[76:79], v[164:167], v[32:35], a[76:79]
    v_cvt_pk_bf16_f32 v80, v16, v17
    v_mfma_f32_16x16x32_bf16 a[124:127], v[168:171], v[32:35], a[124:127]
    ds_read_b128 v[28:31], v1 offset:21504
    v_add_u32 v3, s3, v3
    v_mfma_f32_16x16x32_bf16 a[124:127], v[184:187], v[36:39], a[124:127]
    buffer_load_dwordx4 v4, s[4:7], s32 offen offset:1024 sc1 lds
    v_mfma_f32_16x16x32_bf16 a[172:175], v[188:191], v[36:39], a[172:175]
    v_exp_f32 v16, v112
    v_mfma_f32_16x16x32_bf16 a[172:175], v[172:175], v[32:35], a[172:175]
    s_waitcnt lgkmcnt(2)
    v_add_f32 v5, v5, v18
    v_add_f32 v5, v5, v19
    v_mfma_f32_16x16x32_bf16 a[32:35], v[160:163], v[40:43], a[32:35]
    ds_read_b128 v[32:35], v1 offset:10240
    v_mfma_f32_16x16x32_bf16 a[32:35], v[176:179], v[44:47], a[32:35]
    buffer_load_dwordx4 v4, s[4:7], s32 offen offset:2048 sc1 lds
    v_mfma_f32_16x16x32_bf16 a[80:83], v[180:183], v[44:47], a[80:83]
    v_exp_f32 v17, v113
    v_mfma_f32_16x16x32_bf16 a[80:83], v[164:167], v[40:43], a[80:83]
    v_cvt_pk_bf16_f32 v81, v18, v19
    v_mfma_f32_16x16x32_bf16 a[128:131], v[168:171], v[40:43], a[128:131]
    ds_read_b128 v[36:39], v1 offset:22528
    v_mfma_f32_16x16x32_bf16 a[128:131], v[184:187], v[44:47], a[128:131]
    s_add_u32 s32, s32, 24576
    v_exp_f32 v18, v114
    v_mfma_f32_16x16x32_bf16 a[176:179], v[188:191], v[44:47], a[176:179]
    v_add_f32 v5, v5, v16
    v_add_f32 v5, v5, v17
    v_mfma_f32_16x16x32_bf16 a[176:179], v[172:175], v[40:43], a[176:179]
    s_waitcnt lgkmcnt(2)
    v_exp_f32 v19, v115
    v_mfma_f32_16x16x32_bf16 a[36:39], v[160:163], v[24:27], a[36:39]
    s_add_u32 s26, s26, 12288
    ds_read_b128 v[40:43], v1 offset:11264
    v_cvt_pk_bf16_f32 v82, v16, v17
    v_mfma_f32_16x16x32_bf16 a[36:39], v[176:179], v[28:31], a[36:39]
    s_mov_b32 m0, s26
    v_exp_f32 v16, v84
    v_mfma_f32_16x16x32_bf16 a[84:87], v[180:183], v[28:31], a[84:87]
    v_add_f32 v5, v5, v18
    v_add_f32 v5, v5, v19
    v_mfma_f32_16x16x32_bf16 a[84:87], v[164:167], v[24:27], a[84:87]
    v_exp_f32 v17, v85
    v_mfma_f32_16x16x32_bf16 a[132:135], v[168:171], v[24:27], a[132:135]
    ds_read_b128 v[44:47], v1 offset:23552
    v_cvt_pk_bf16_f32 v83, v18, v19
    v_mfma_f32_16x16x32_bf16 a[132:135], v[184:187], v[28:31], a[132:135]
    buffer_load_dwordx4 v4, s[4:7], s32 offen offset:0 sc1 lds
    v_mfma_f32_16x16x32_bf16 a[180:183], v[188:191], v[28:31], a[180:183]
    v_exp_f32 v18, v86
    v_mfma_f32_16x16x32_bf16 a[180:183], v[172:175], v[24:27], a[180:183]
    s_waitcnt lgkmcnt(2)
    v_add_f32 v6, v6, v16
    v_add_f32 v6, v6, v17
    v_mfma_f32_16x16x32_bf16 a[40:43], v[160:163], v[32:35], a[40:43]
    ds_read_b128 v[24:27], v2 offset:0
    v_mfma_f32_16x16x32_bf16 a[40:43], v[176:179], v[36:39], a[40:43]
    buffer_load_dwordx4 v4, s[4:7], s32 offen offset:1024 sc1 lds
    v_mfma_f32_16x16x32_bf16 a[88:91], v[180:183], v[36:39], a[88:91]
    v_exp_f32 v19, v87
    v_mfma_f32_16x16x32_bf16 a[88:91], v[164:167], v[32:35], a[88:91]
    v_cvt_pk_bf16_f32 v84, v16, v17
    v_mfma_f32_16x16x32_bf16 a[136:139], v[168:171], v[32:35], a[136:139]
    ds_read_b128 v[28:31], v3 offset:0
    v_mfma_f32_16x16x32_bf16 a[136:139], v[184:187], v[36:39], a[136:139]
    buffer_load_dwordx4 v4, s[4:7], s32 offen offset:2048 sc1 lds
    v_mfma_f32_16x16x32_bf16 a[184:187], v[188:191], v[36:39], a[184:187]
    v_exp_f32 v16, v116
    v_mfma_f32_16x16x32_bf16 a[184:187], v[172:175], v[32:35], a[184:187]
    s_waitcnt lgkmcnt(2)
    v_add_f32 v6, v6, v18
    v_add_f32 v6, v6, v19
    v_mfma_f32_16x16x32_bf16 a[44:47], v[160:163], v[40:43], a[44:47]
    ds_read_b128 v[32:35], v2 offset:6144
    v_mfma_f32_16x16x32_bf16 a[44:47], v[176:179], v[44:47], a[44:47]
    v_exp_f32 v17, v117
    v_mfma_f32_16x16x32_bf16 a[92:95], v[180:183], v[44:47], a[92:95]
    v_cvt_pk_bf16_f32 v85, v18, v19
    v_mfma_f32_16x16x32_bf16 a[92:95], v[164:167], v[40:43], a[92:95]
    s_add_u32 s32, s32, 24576
    v_exp_f32 v18, v118
    v_mfma_f32_16x16x32_bf16 a[140:143], v[168:171], v[40:43], a[140:143]
    s_add_u32 s26, s26, 36864
    ds_read_b128 v[36:39], v3 offset:6144
    v_add_f32 v6, v6, v16
    v_mfma_f32_16x16x32_bf16 a[140:143], v[184:187], v[44:47], a[140:143]
    s_sub_u32 s57, s26, 147456
    v_add_f32 v6, v6, v17
    s_min_u32 s26, s26, s57
    v_mfma_f32_16x16x32_bf16 a[188:191], v[188:191], v[44:47], a[188:191]
    v_exp_f32 v19, v119
    v_mfma_f32_16x16x32_bf16 a[188:191], v[172:175], v[40:43], a[188:191]
    s_waitcnt lgkmcnt(2)
    v_cvt_pk_bf16_f32 v86, v16, v17
    v_add_f32 v6, v6, v18
    v_add_f32 v6, v6, v19
    v_cvt_pk_bf16_f32 v87, v18, v19
    v_mfma_f32_16x16x32_bf16 v[160:163], v[24:27], a[192:195], v[128:131]
    ds_read_b128 v[40:43], v2 offset:128
    v_mfma_f32_16x16x32_bf16 v[160:163], v[28:31], a[196:199], v[160:163]
    v_exp_f32 v16, v88
    v_mfma_f32_16x16x32_bf16 v[164:167], v[28:31], a[220:223], v[132:135]
    ds_read_b128 v[44:47], v3 offset:128
    v_mfma_f32_16x16x32_bf16 v[164:167], v[24:27], a[216:219], v[164:167]
    s_waitcnt lgkmcnt(2)
    v_exp_f32 v17, v89
    v_mfma_f32_16x16x32_bf16 v[96:99], v[32:35], a[192:195], v[128:131]
    ds_read_b128 v[24:27], v2 offset:6272
    v_mfma_f32_16x16x32_bf16 v[96:99], v[36:39], a[196:199], v[96:99]
    v_exp_f32 v18, v90
    v_mfma_f32_16x16x32_bf16 v[100:103], v[36:39], a[220:223], v[132:135]
    ds_read_b128 v[28:31], v3 offset:6272
    v_add_f32 v7, v7, v16
    v_mfma_f32_16x16x32_bf16 v[100:103], v[32:35], a[216:219], v[100:103]
    s_waitcnt lgkmcnt(2)
    v_add_f32 v7, v7, v17
    v_mfma_f32_16x16x32_bf16 v[160:163], v[40:43], a[200:203], v[160:163]
    ds_read_b128 v[32:35], v2 offset:256
    v_mfma_f32_16x16x32_bf16 v[160:163], v[44:47], a[204:207], v[160:163]
    v_exp_f32 v19, v91
    v_mfma_f32_16x16x32_bf16 v[164:167], v[44:47], a[228:231], v[164:167]
    ds_read_b128 v[36:39], v3 offset:256
    v_cvt_pk_bf16_f32 v88, v16, v17
    v_mfma_f32_16x16x32_bf16 v[164:167], v[40:43], a[224:227], v[164:167]
    s_waitcnt lgkmcnt(2)
    v_exp_f32 v16, v120
    v_mfma_f32_16x16x32_bf16 v[96:99], v[24:27], a[200:203], v[96:99]
    ds_read_b128 v[40:43], v2 offset:6400
    v_add_f32 v7, v7, v18
    v_mfma_f32_16x16x32_bf16 v[96:99], v[28:31], a[204:207], v[96:99]
    v_add_f32 v7, v7, v19
    v_mfma_f32_16x16x32_bf16 v[100:103], v[28:31], a[228:231], v[100:103]
    ds_read_b128 v[44:47], v3 offset:6400
    v_mfma_f32_16x16x32_bf16 v[100:103], v[24:27], a[224:227], v[100:103]
    s_waitcnt lgkmcnt(2)
    v_exp_f32 v17, v121
    v_mfma_f32_16x16x32_bf16 v[160:163], v[32:35], a[208:211], v[160:163]
    ds_read_b128 v[24:27], v2 offset:12288
    v_cvt_pk_bf16_f32 v89, v18, v19
    v_mfma_f32_16x16x32_bf16 v[160:163], v[36:39], a[212:215], v[160:163]
    v_exp_f32 v18, v122
    v_mfma_f32_16x16x32_bf16 v[164:167], v[36:39], a[236:239], v[164:167]
    ds_read_b128 v[28:31], v3 offset:12288
    v_add_f32 v7, v7, v16
    v_mfma_f32_16x16x32_bf16 v[164:167], v[32:35], a[232:235], v[164:167]
    s_waitcnt lgkmcnt(2)
    v_add_f32 v7, v7, v17
    v_mfma_f32_16x16x32_bf16 v[96:99], v[40:43], a[208:211], v[96:99]
    ds_read_b128 v[32:35], v2 offset:18432
    v_mfma_f32_16x16x32_bf16 v[96:99], v[44:47], a[212:215], v[96:99]
    v_exp_f32 v19, v123
    v_mfma_f32_16x16x32_bf16 v[100:103], v[44:47], a[236:239], v[100:103]
    ds_read_b128 v[36:39], v3 offset:18432
    v_cvt_pk_bf16_f32 v90, v16, v17
    v_mfma_f32_16x16x32_bf16 v[100:103], v[40:43], a[232:235], v[100:103]
    s_waitcnt lgkmcnt(2)
    v_exp_f32 v16, v92
    v_mfma_f32_16x16x32_bf16 v[168:171], v[24:27], a[192:195], v[128:131]
    ds_read_b128 v[40:43], v2 offset:12416
    v_add_f32 v7, v7, v18
    v_mfma_f32_16x16x32_bf16 v[168:171], v[28:31], a[196:199], v[168:171]
    v_add_f32 v7, v7, v19
    v_mfma_f32_16x16x32_bf16 v[172:175], v[28:31], a[220:223], v[132:135]
    ds_read_b128 v[44:47], v3 offset:12416
    v_mfma_f32_16x16x32_bf16 v[172:175], v[24:27], a[216:219], v[172:175]
    s_waitcnt lgkmcnt(2)
    v_exp_f32 v17, v93
    v_mfma_f32_16x16x32_bf16 v[104:107], v[32:35], a[192:195], v[128:131]
    ds_read_b128 v[24:27], v2 offset:18560
    v_cvt_pk_bf16_f32 v91, v18, v19
    v_mfma_f32_16x16x32_bf16 v[104:107], v[36:39], a[196:199], v[104:107]
    v_exp_f32 v18, v94
    v_mfma_f32_16x16x32_bf16 v[108:111], v[36:39], a[220:223], v[132:135]
    s_add_u32 s29, s30, 49152
    ds_read_b128 v[28:31], v3 offset:18560
    v_add_f32 v8, v8, v16
    v_mfma_f32_16x16x32_bf16 v[108:111], v[32:35], a[216:219], v[108:111]
    s_waitcnt lgkmcnt(2)
    v_add_f32 v8, v8, v17
    s_sub_u32 s3, s29, 147456
    v_mfma_f32_16x16x32_bf16 v[168:171], v[40:43], a[200:203], v[168:171]
    ds_read_b128 v[32:35], v2 offset:12544
    v_mfma_f32_16x16x32_bf16 v[168:171], v[44:47], a[204:207], v[168:171]
    s_min_u32 s29, s29, s3
    v_exp_f32 v19, v95
    v_mfma_f32_16x16x32_bf16 v[172:175], v[44:47], a[228:231], v[172:175]
    ds_read_b128 v[36:39], v3 offset:12544
    v_cvt_pk_bf16_f32 v92, v16, v17
    v_mfma_f32_16x16x32_bf16 v[172:175], v[40:43], a[224:227], v[172:175]
    s_waitcnt lgkmcnt(2)
    v_exp_f32 v16, v124
    v_mfma_f32_16x16x32_bf16 v[104:107], v[24:27], a[200:203], v[104:107]
    ds_read_b128 v[40:43], v2 offset:18688
    v_add_f32 v8, v8, v18
    v_mfma_f32_16x16x32_bf16 v[104:107], v[28:31], a[204:207], v[104:107]
    v_add_f32 v8, v8, v19
    v_mfma_f32_16x16x32_bf16 v[108:111], v[28:31], a[228:231], v[108:111]
    ds_read_b128 v[44:47], v3 offset:18688
    v_mfma_f32_16x16x32_bf16 v[108:111], v[24:27], a[224:227], v[108:111]
    s_waitcnt lgkmcnt(2)
    v_subrev_u32 v2, 98304, v2
    v_subrev_u32 v3, 98304, v3
    v_mfma_f32_16x16x32_bf16 v[168:171], v[32:35], a[208:211], v[168:171]
    ds_read_b128 v[24:27], v2 offset:0
    v_mfma_f32_16x16x32_bf16 v[168:171], v[36:39], a[212:215], v[168:171]
    s_sub_u32 s3, s29, s30
    v_exp_f32 v17, v125
    v_mfma_f32_16x16x32_bf16 v[172:175], v[36:39], a[236:239], v[172:175]
    ds_read_b128 v[28:31], v3 offset:0
    v_cvt_pk_bf16_f32 v93, v18, v19
    v_mfma_f32_16x16x32_bf16 v[172:175], v[32:35], a[232:235], v[172:175]
    s_waitcnt lgkmcnt(2)
    v_exp_f32 v18, v126
    v_mfma_f32_16x16x32_bf16 v[104:107], v[40:43], a[208:211], v[104:107]
    ds_read_b128 v[32:35], v2 offset:6144
    v_add_f32 v8, v8, v16
    v_mfma_f32_16x16x32_bf16 v[104:107], v[44:47], a[212:215], v[104:107]
    v_add_f32 v8, v8, v17
    v_mfma_f32_16x16x32_bf16 v[108:111], v[44:47], a[236:239], v[108:111]
    ds_read_b128 v[36:39], v3 offset:6144
    v_mfma_f32_16x16x32_bf16 v[108:111], v[40:43], a[232:235], v[108:111]
    s_waitcnt lgkmcnt(2)
    v_exp_f32 v19, v127
    v_mfma_f32_16x16x32_bf16 v[176:179], v[24:27], a[192:195], v[128:131]
    ds_read_b128 v[40:43], v2 offset:128
    v_cvt_pk_bf16_f32 v94, v16, v17
    v_mfma_f32_16x16x32_bf16 v[176:179], v[28:31], a[196:199], v[176:179]
    s_mov_b32 s30, s29
    v_add_f32 v8, v8, v18
    v_add_f32 v8, v8, v19
    v_mfma_f32_16x16x32_bf16 v[180:183], v[28:31], a[220:223], v[132:135]
    ds_read_b128 v[44:47], v3 offset:128
    v_cvt_pk_bf16_f32 v95, v18, v19
    v_mfma_f32_16x16x32_bf16 v[180:183], v[24:27], a[216:219], v[180:183]
    s_waitcnt lgkmcnt(2)
    v_exp_f32 v16, v160
    v_mfma_f32_16x16x32_bf16 v[112:115], v[32:35], a[192:195], v[128:131]
    ds_read_b128 v[24:27], v2 offset:6272
    v_mfma_f32_16x16x32_bf16 v[112:115], v[36:39], a[196:199], v[112:115]
    v_exp_f32 v17, v161
    v_mfma_f32_16x16x32_bf16 v[116:119], v[36:39], a[220:223], v[132:135]
    ds_read_b128 v[28:31], v3 offset:6272
    v_mfma_f32_16x16x32_bf16 v[116:119], v[32:35], a[216:219], v[116:119]
    s_waitcnt lgkmcnt(2)
    v_exp_f32 v18, v162
    v_mfma_f32_16x16x32_bf16 v[176:179], v[40:43], a[200:203], v[176:179]
    ds_read_b128 v[32:35], v2 offset:256
    v_add_f32 v5, v5, v16
    v_mfma_f32_16x16x32_bf16 v[176:179], v[44:47], a[204:207], v[176:179]
    v_add_f32 v5, v5, v17
    v_add_u32 v1, s3, v1
    v_mfma_f32_16x16x32_bf16 v[180:183], v[44:47], a[228:231], v[180:183]
    ds_read_b128 v[36:39], v3 offset:256
    v_mfma_f32_16x16x32_bf16 v[180:183], v[40:43], a[224:227], v[180:183]
    s_waitcnt lgkmcnt(2)
    v_exp_f32 v19, v163
    v_mfma_f32_16x16x32_bf16 v[112:115], v[24:27], a[200:203], v[112:115]
    ds_read_b128 v[40:43], v2 offset:6400
    v_cvt_pk_bf16_f32 v160, v16, v17
    v_mfma_f32_16x16x32_bf16 v[112:115], v[28:31], a[204:207], v[112:115]
    v_exp_f32 v16, v96
    v_mfma_f32_16x16x32_bf16 v[116:119], v[28:31], a[228:231], v[116:119]
    ds_read_b128 v[44:47], v3 offset:6400
    v_add_f32 v5, v5, v18
    v_mfma_f32_16x16x32_bf16 v[116:119], v[24:27], a[224:227], v[116:119]
    s_waitcnt lgkmcnt(2)
    v_add_f32 v5, v5, v19
    v_mfma_f32_16x16x32_bf16 v[176:179], v[32:35], a[208:211], v[176:179]
    ds_read_b128 v[24:27], v2 offset:12288
    v_mfma_f32_16x16x32_bf16 v[176:179], v[36:39], a[212:215], v[176:179]
    v_exp_f32 v17, v97
    v_mfma_f32_16x16x32_bf16 v[180:183], v[36:39], a[236:239], v[180:183]
    ds_read_b128 v[28:31], v3 offset:12288
    v_cvt_pk_bf16_f32 v161, v18, v19
    v_mfma_f32_16x16x32_bf16 v[180:183], v[32:35], a[232:235], v[180:183]
    s_waitcnt lgkmcnt(2)
    v_exp_f32 v18, v98
    v_mfma_f32_16x16x32_bf16 v[112:115], v[40:43], a[208:211], v[112:115]
    ds_read_b128 v[32:35], v2 offset:18432
    v_add_f32 v5, v5, v16
    v_mfma_f32_16x16x32_bf16 v[112:115], v[44:47], a[212:215], v[112:115]
    v_add_f32 v5, v5, v17
    v_mfma_f32_16x16x32_bf16 v[116:119], v[44:47], a[236:239], v[116:119]
    ds_read_b128 v[36:39], v3 offset:18432
    v_mfma_f32_16x16x32_bf16 v[116:119], v[40:43], a[232:235], v[116:119]
    s_waitcnt lgkmcnt(2)
    v_exp_f32 v19, v99
    v_mfma_f32_16x16x32_bf16 v[184:187], v[24:27], a[192:195], v[128:131]
    ds_read_b128 v[40:43], v2 offset:12416
    v_cvt_pk_bf16_f32 v162, v16, v17
    v_mfma_f32_16x16x32_bf16 v[184:187], v[28:31], a[196:199], v[184:187]
    v_exp_f32 v16, v164
    v_mfma_f32_16x16x32_bf16 v[188:191], v[28:31], a[220:223], v[132:135]
    ds_read_b128 v[44:47], v3 offset:12416
    v_add_f32 v5, v5, v18
    v_mfma_f32_16x16x32_bf16 v[188:191], v[24:27], a[216:219], v[188:191]
    s_waitcnt lgkmcnt(2)
    v_add_f32 v5, v5, v19
    v_mfma_f32_16x16x32_bf16 v[120:123], v[32:35], a[192:195], v[128:131]
    ds_read_b128 v[24:27], v2 offset:18560
    v_mfma_f32_16x16x32_bf16 v[120:123], v[36:39], a[196:199], v[120:123]
    s_waitcnt vmcnt(6)
    v_exp_f32 v17, v165
    v_mfma_f32_16x16x32_bf16 v[124:127], v[36:39], a[220:223], v[132:135]
    ds_read_b128 v[28:31], v3 offset:18560
    v_cvt_pk_bf16_f32 v163, v18, v19
    v_mfma_f32_16x16x32_bf16 v[124:127], v[32:35], a[216:219], v[124:127]
    s_waitcnt lgkmcnt(2)
    s_barrier
    v_mfma_f32_16x16x32_bf16 v[184:187], v[40:43], a[200:203], v[184:187]
    ds_read_b128 v[32:35], v2 offset:12544
    v_mfma_f32_16x16x32_bf16 v[184:187], v[44:47], a[204:207], v[184:187]
    v_exp_f32 v18, v166
    v_mfma_f32_16x16x32_bf16 v[188:191], v[44:47], a[228:231], v[188:191]
    ds_read_b128 v[36:39], v3 offset:12544
    v_add_f32 v6, v6, v16
    v_mfma_f32_16x16x32_bf16 v[188:191], v[40:43], a[224:227], v[188:191]
    s_waitcnt lgkmcnt(2)
    v_add_f32 v6, v6, v17
    v_mfma_f32_16x16x32_bf16 v[120:123], v[24:27], a[200:203], v[120:123]
    ds_read_b128 v[40:43], v2 offset:18688
    v_mfma_f32_16x16x32_bf16 v[120:123], v[28:31], a[204:207], v[120:123]
    v_exp_f32 v19, v167
    v_cvt_pk_bf16_f32 v164, v16, v17
    v_mfma_f32_16x16x32_bf16 v[124:127], v[28:31], a[228:231], v[124:127]
    ds_read_b128 v[44:47], v3 offset:18688
    v_mfma_f32_16x16x32_bf16 v[124:127], v[24:27], a[224:227], v[124:127]
    s_waitcnt lgkmcnt(2)
    v_exp_f32 v16, v100
    v_mfma_f32_16x16x32_bf16 v[184:187], v[32:35], a[208:211], v[184:187]
    ds_read_b128 v[24:27], v1 offset:0
    v_add_f32 v6, v6, v18
    v_mfma_f32_16x16x32_bf16 v[184:187], v[36:39], a[212:215], v[184:187]
    v_add_f32 v6, v6, v19
    v_mfma_f32_16x16x32_bf16 v[188:191], v[36:39], a[236:239], v[188:191]
    ds_read_b128 v[28:31], v1 offset:12288
    v_mfma_f32_16x16x32_bf16 v[188:191], v[32:35], a[232:235], v[188:191]
    s_waitcnt lgkmcnt(2)
    v_exp_f32 v17, v101
    v_cvt_pk_bf16_f32 v165, v18, v19
    v_mfma_f32_16x16x32_bf16 v[120:123], v[40:43], a[208:211], v[120:123]
    ds_read_b128 v[32:35], v1 offset:1024
    v_mfma_f32_16x16x32_bf16 v[120:123], v[44:47], a[212:215], v[120:123]
    v_exp_f32 v18, v102
    v_mfma_f32_16x16x32_bf16 v[124:127], v[44:47], a[236:239], v[124:127]
    ds_read_b128 v[36:39], v1 offset:13312
    v_add_f32 v6, v6, v16
    v_mfma_f32_16x16x32_bf16 v[124:127], v[40:43], a[232:235], v[124:127]
    s_waitcnt lgkmcnt(2)
    v_add_f32 v6, v6, v17
    v_exp_f32 v19, v103
    v_cvt_pk_bf16_f32 v166, v16, v17
    v_add_f32 v6, v6, v18
    v_add_f32 v6, v6, v19
    v_cvt_pk_bf16_f32 v167, v18, v19
    v_mfma_f32_16x16x32_bf16 a[0:3], v[64:67], v[24:27], a[0:3]
    s_mov_b32 m0, s56
    ds_read_b128 v[40:43], v1 offset:2048
    v_bfe_u32 v57, v4, 8, 2
    v_mfma_f32_16x16x32_bf16 a[0:3], v[80:83], v[28:31], a[0:3]
    buffer_load_dwordx4 v4, s[4:7], s27 offen offset:0 sc1 lds
    v_mfma_f32_16x16x32_bf16 a[48:51], v[84:87], v[28:31], a[48:51]
    v_exp_f32 v16, v168
    v_mfma_f32_16x16x32_bf16 a[48:51], v[68:71], v[24:27], a[48:51]
    v_exp_f32 v17, v169
    v_mfma_f32_16x16x32_bf16 a[96:99], v[72:75], v[24:27], a[96:99]
    ds_read_b128 v[44:47], v1 offset:14336
    v_mul_u32_u24 v56, 1536, v57
    v_mfma_f32_16x16x32_bf16 a[96:99], v[88:91], v[28:31], a[96:99]
    buffer_load_dwordx4 v4, s[4:7], s27 offen offset:1024 sc1 lds
    v_mfma_f32_16x16x32_bf16 a[144:147], v[92:95], v[28:31], a[144:147]
    v_exp_f32 v18, v170
    v_mfma_f32_16x16x32_bf16 a[144:147], v[76:79], v[24:27], a[144:147]
    s_waitcnt lgkmcnt(2)
    v_add_f32 v5, v5, v16
    v_add_f32 v5, v5, v17
    v_mfma_f32_16x16x32_bf16 a[4:7], v[64:67], v[32:35], a[4:7]
    ds_read_b128 v[24:27], v1 offset:3072
    v_lshlrev_b32 v58, 4, v57
    v_mfma_f32_16x16x32_bf16 a[4:7], v[80:83], v[36:39], a[4:7]
    buffer_load_dwordx4 v4, s[4:7], s27 offen offset:2048 sc1 lds
    v_mfma_f32_16x16x32_bf16 a[52:55], v[84:87], v[36:39], a[52:55]
    v_exp_f32 v19, v171
    v_mfma_f32_16x16x32_bf16 a[52:55], v[68:71], v[32:35], a[52:55]
    s_add_u32 s27, s27, 24576
    v_cvt_pk_bf16_f32 v168, v16, v17
    v_bfe_u32 v57, v4, 4, 4
    v_mfma_f32_16x16x32_bf16 a[100:103], v[72:75], v[32:35], a[100:103]
    ds_read_b128 v[28:31], v1 offset:15360
    v_mfma_f32_16x16x32_bf16 a[100:103], v[88:91], v[36:39], a[100:103]
    s_add_u32 s56, s56, 12288
    v_exp_f32 v16, v104
    v_mfma_f32_16x16x32_bf16 a[148:151], v[92:95], v[36:39], a[148:151]
    v_add_f32 v5, v5, v18
    v_add_f32 v5, v5, v19
    v_mfma_f32_16x16x32_bf16 a[148:151], v[76:79], v[32:35], a[148:151]
    s_waitcnt lgkmcnt(2)
    v_exp_f32 v17, v105
    v_mfma_f32_16x16x32_bf16 a[8:11], v[64:67], v[40:43], a[8:11]
    s_mov_b32 m0, s56
    ds_read_b128 v[32:35], v1 offset:4096
    v_cvt_pk_bf16_f32 v169, v18, v19
    v_mfma_f32_16x16x32_bf16 a[8:11], v[80:83], v[44:47], a[8:11]
    v_exp_f32 v18, v106
    v_mfma_f32_16x16x32_bf16 a[56:59], v[84:87], v[44:47], a[56:59]
    v_add_f32 v5, v5, v16
    v_add_f32 v5, v5, v17
    v_mfma_f32_16x16x32_bf16 a[56:59], v[68:71], v[40:43], a[56:59]
    buffer_load_dwordx4 v4, s[4:7], s27 offen offset:0 sc1 lds
    v_mfma_f32_16x16x32_bf16 a[104:107], v[72:75], v[40:43], a[104:107]
    ds_read_b128 v[36:39], v1 offset:16384
    v_mul_u32_u24 v57, 12, v57
    v_mfma_f32_16x16x32_bf16 a[104:107], v[88:91], v[44:47], a[104:107]
    v_exp_f32 v19, v107
    v_mfma_f32_16x16x32_bf16 a[152:155], v[92:95], v[44:47], a[152:155]
    v_cvt_pk_bf16_f32 v170, v16, v17
    v_add_u32 v56, v56, v57
    v_mfma_f32_16x16x32_bf16 a[152:155], v[76:79], v[40:43], a[152:155]
    s_waitcnt lgkmcnt(2)
    buffer_load_dwordx4 v4, s[4:7], s27 offen offset:1024 sc1 lds
    v_mfma_f32_16x16x32_bf16 a[12:15], v[64:67], v[24:27], a[12:15]
    ds_read_b128 v[40:43], v1 offset:5120
    v_mfma_f32_16x16x32_bf16 a[12:15], v[80:83], v[28:31], a[12:15]
    v_exp_f32 v16, v172
    v_mfma_f32_16x16x32_bf16 a[60:63], v[84:87], v[28:31], a[60:63]
    v_add_f32 v5, v5, v18
    v_add_f32 v5, v5, v19
    v_mfma_f32_16x16x32_bf16 a[60:63], v[68:71], v[24:27], a[60:63]
    buffer_load_dwordx4 v4, s[4:7], s27 offen offset:2048 sc1 lds
    v_mfma_f32_16x16x32_bf16 a[108:111], v[72:75], v[24:27], a[108:111]
    ds_read_b128 v[44:47], v1 offset:17408
    v_mov_b32 v57, 1.0
    v_mfma_f32_16x16x32_bf16 a[108:111], v[88:91], v[28:31], a[108:111]
    v_exp_f32 v17, v173
    v_mfma_f32_16x16x32_bf16 a[156:159], v[92:95], v[28:31], a[156:159]
    s_add_u32 s27, s27, 24576
    v_cvt_pk_bf16_f32 v171, v18, v19
    v_mfma_f32_16x16x32_bf16 a[156:159], v[76:79], v[24:27], a[156:159]
    s_waitcnt lgkmcnt(2)
    v_exp_f32 v18, v174
    v_mfma_f32_16x16x32_bf16 a[16:19], v[64:67], v[32:35], a[16:19]
    s_add_u32 s56, s56, 36864
    ds_read_b128 v[24:27], v1 offset:6144
    v_add_f32 v6, v6, v16
    v_mfma_f32_16x16x32_bf16 a[16:19], v[80:83], v[36:39], a[16:19]
    v_add_f32 v6, v6, v17
    v_mov_b32 v20, 0x3f803f80
    v_mfma_f32_16x16x32_bf16 a[64:67], v[84:87], v[36:39], a[64:67]
    s_sub_u32 s58, s56, 147456
    v_exp_f32 v19, v175
    v_mfma_f32_16x16x32_bf16 a[64:67], v[68:71], v[32:35], a[64:67]
    v_cvt_pk_bf16_f32 v172, v16, v17
    v_mfma_f32_16x16x32_bf16 a[112:115], v[72:75], v[32:35], a[112:115]
    s_min_u32 s56, s56, s58
    ds_read_b128 v[28:31], v1 offset:18432
    v_mov_b32 v21, 0x3f803f80
    v_mfma_f32_16x16x32_bf16 a[112:115], v[88:91], v[36:39], a[112:115]
    v_exp_f32 v16, v108
    v_mfma_f32_16x16x32_bf16 a[160:163], v[92:95], v[36:39], a[160:163]
    s_mov_b32 m0, s56
    v_add_f32 v6, v6, v18
    v_add_f32 v6, v6, v19
    v_mfma_f32_16x16x32_bf16 a[160:163], v[76:79], v[32:35], a[160:163]
    s_waitcnt lgkmcnt(2)
    v_exp_f32 v17, v109
    v_mfma_f32_16x16x32_bf16 a[20:23], v[64:67], v[40:43], a[20:23]
    ds_read_b128 v[32:35], v1 offset:7168
    v_cvt_pk_bf16_f32 v173, v18, v19
    v_mfma_f32_16x16x32_bf16 a[20:23], v[80:83], v[44:47], a[20:23]
    buffer_load_dwordx4 v4, s[4:7], s27 offen offset:0 sc1 lds
    v_mfma_f32_16x16x32_bf16 a[68:71], v[84:87], v[44:47], a[68:71]
    v_exp_f32 v18, v110
    v_mfma_f32_16x16x32_bf16 a[68:71], v[68:71], v[40:43], a[68:71]
    v_add_f32 v6, v6, v16
    v_add_f32 v6, v6, v17
    v_mfma_f32_16x16x32_bf16 a[116:119], v[72:75], v[40:43], a[116:119]
    ds_read_b128 v[36:39], v1 offset:19456
    v_mov_b32 v22, 0x3f803f80
    v_mfma_f32_16x16x32_bf16 a[116:119], v[88:91], v[44:47], a[116:119]
    buffer_load_dwordx4 v4, s[4:7], s27 offen offset:1024 sc1 lds
    v_mfma_f32_16x16x32_bf16 a[164:167], v[92:95], v[44:47], a[164:167]
    v_exp_f32 v19, v111
    v_mfma_f32_16x16x32_bf16 a[164:167], v[76:79], v[40:43], a[164:167]
    s_waitcnt lgkmcnt(2)
    v_cvt_pk_bf16_f32 v174, v16, v17
    v_add_f32 v6, v6, v18
    v_mfma_f32_16x16x32_bf16 a[24:27], v[64:67], v[24:27], a[24:27]
    ds_read_b128 v[40:43], v1 offset:8192
    v_add_f32 v6, v6, v19
    v_mfma_f32_16x16x32_bf16 a[24:27], v[80:83], v[28:31], a[24:27]
    buffer_load_dwordx4 v4, s[4:7], s27 offen offset:2048 sc1 lds
    v_mfma_f32_16x16x32_bf16 a[72:75], v[84:87], v[28:31], a[72:75]
    v_cvt_pk_bf16_f32 v175, v18, v19
    v_mov_b32 v23, 0x3f803f80
    v_mfma_f32_16x16x32_bf16 a[72:75], v[68:71], v[24:27], a[72:75]
    v_exp_f32 v16, v176
    v_mfma_f32_16x16x32_bf16 a[120:123], v[72:75], v[24:27], a[120:123]
    ds_read_b128 v[44:47], v1 offset:20480
    v_mfma_f32_16x16x32_bf16 a[120:123], v[88:91], v[28:31], a[120:123]
    s_lshl_b32 s24, s95, 2
    v_exp_f32 v17, v177
    v_mfma_f32_16x16x32_bf16 a[168:171], v[92:95], v[28:31], a[168:171]
    s_add_u32 s27, s27, 24576
    v_exp_f32 v18, v178
    v_mfma_f32_16x16x32_bf16 a[168:171], v[76:79], v[24:27], a[168:171]
    s_waitcnt lgkmcnt(2)
    v_add_f32 v5, v5, v16
    v_add_f32 v5, v5, v17
    v_mfma_f32_16x16x32_bf16 a[28:31], v[64:67], v[32:35], a[28:31]
    s_add_u32 s56, s56, 12288
    ds_read_b128 v[24:27], v1 offset:9216
    v_mfma_f32_16x16x32_bf16 a[28:31], v[80:83], v[36:39], a[28:31]
    s_mov_b32 m0, s56
    v_exp_f32 v19, v179
    v_mfma_f32_16x16x32_bf16 a[76:79], v[84:87], v[36:39], a[76:79]
    v_cvt_pk_bf16_f32 v176, v16, v17
    v_mfma_f32_16x16x32_bf16 a[76:79], v[68:71], v[32:35], a[76:79]
    s_add_u32 s24, s24, s25
    v_exp_f32 v16, v112
    v_mfma_f32_16x16x32_bf16 a[124:127], v[72:75], v[32:35], a[124:127]
    ds_read_b128 v[28:31], v1 offset:21504
    v_add_f32 v5, v5, v18
    v_mfma_f32_16x16x32_bf16 a[124:127], v[88:91], v[36:39], a[124:127]
    buffer_load_dwordx4 v4, s[4:7], s27 offen offset:0 sc1 lds
    v_mfma_f32_16x16x32_bf16 a[172:175], v[92:95], v[36:39], a[172:175]
L_pg11:
    s_cbranch_execz L_iwret
    v_add_f32 v5, v5, v19
    v_mfma_f32_16x16x32_bf16 a[172:175], v[76:79], v[32:35], a[172:175]
    s_waitcnt lgkmcnt(2)
    v_exp_f32 v17, v113
    v_mfma_f32_16x16x32_bf16 a[32:35], v[64:67], v[40:43], a[32:35]
    s_mul_i32 s24, s24, 24576
    ds_read_b128 v[32:35], v1 offset:10240
    v_cvt_pk_bf16_f32 v177, v18, v19
    v_mfma_f32_16x16x32_bf16 a[32:35], v[80:83], v[44:47], a[32:35]
    buffer_load_dwordx4 v4, s[4:7], s27 offen offset:1024 sc1 lds
    v_mfma_f32_16x16x32_bf16 a[80:83], v[84:87], v[44:47], a[80:83]
    v_exp_f32 v18, v114
    v_mfma_f32_16x16x32_bf16 a[80:83], v[68:71], v[40:43], a[80:83]
    v_add_f32 v5, v5, v16
    v_add_f32 v5, v5, v17
    v_mfma_f32_16x16x32_bf16 a[128:131], v[72:75], v[40:43], a[128:131]
    ds_read_b128 v[36:39], v1 offset:22528
    v_mfma_f32_16x16x32_bf16 a[128:131], v[88:91], v[44:47], a[128:131]
    buffer_load_dwordx4 v4, s[4:7], s27 offen offset:2048 sc1 lds
    v_mfma_f32_16x16x32_bf16 a[176:179], v[92:95], v[44:47], a[176:179]
    s_add_u32 s40, s24, 6144
    v_exp_f32 v19, v115
    v_mfma_f32_16x16x32_bf16 a[176:179], v[76:79], v[40:43], a[176:179]
    s_waitcnt lgkmcnt(2)
    v_cvt_pk_bf16_f32 v178, v16, v17
    v_mfma_f32_16x16x32_bf16 a[36:39], v[64:67], v[24:27], a[36:39]
    ds_read_b128 v[40:43], v1 offset:11264
    v_mfma_f32_16x16x32_bf16 a[36:39], v[80:83], v[28:31], a[36:39]
    v_exp_f32 v16, v180
    v_mfma_f32_16x16x32_bf16 a[84:87], v[84:87], v[28:31], a[84:87]
    v_add_f32 v5, v5, v18
    v_add_f32 v5, v5, v19
    v_mfma_f32_16x16x32_bf16 a[84:87], v[68:71], v[24:27], a[84:87]
    s_add_u32 s27, s27, 24576
    v_exp_f32 v17, v181
    v_mfma_f32_16x16x32_bf16 a[132:135], v[72:75], v[24:27], a[132:135]
    s_add_u32 s56, s56, 36864
    ds_read_b128 v[44:47], v1 offset:23552
    v_cvt_pk_bf16_f32 v179, v18, v19
    v_mfma_f32_16x16x32_bf16 a[132:135], v[88:91], v[28:31], a[132:135]
    s_waitcnt lgkmcnt(2)
    v_exp_f32 v18, v182
    v_mfma_f32_16x16x32_bf16 a[180:183], v[92:95], v[28:31], a[180:183]
    s_waitcnt vmcnt(12)
    v_add_f32 v6, v6, v16
    v_add_f32 v6, v6, v17
    v_mfma_f32_16x16x32_bf16 a[180:183], v[76:79], v[24:27], a[180:183]
    s_barrier
    v_add_u32 v2, 49152, v2
    v_add_u32 v3, 49152, v3
    v_mfma_f32_16x16x32_bf16 a[40:43], v[64:67], v[32:35], a[40:43]
    s_sub_u32 s58, s56, 147456
    ds_read_b128 v[24:27], v2 offset:0
    s_add_u32 s41, s24, 12288
    v_mfma_f32_16x16x32_bf16 a[40:43], v[80:83], v[36:39], a[40:43]
    s_min_u32 s56, s56, s58
    v_exp_f32 v19, v183
    v_mfma_f32_16x16x32_bf16 a[88:91], v[84:87], v[36:39], a[88:91]
    s_add_u32 s42, s24, 18432
    v_cvt_pk_bf16_f32 v180, v16, v17
    v_mfma_f32_16x16x32_bf16 a[88:91], v[68:71], v[32:35], a[88:91]
    v_exp_f32 v16, v116
    v_mfma_f32_16x16x32_bf16 a[136:139], v[72:75], v[32:35], a[136:139]
    ds_read_b128 v[28:31], v3 offset:0
    v_add_f32 v6, v6, v18
    v_mfma_f32_16x16x32_bf16 a[136:139], v[88:91], v[36:39], a[136:139]
    v_add_f32 v6, v6, v19
    v_mfma_f32_16x16x32_bf16 a[184:187], v[92:95], v[36:39], a[184:187]
    v_exp_f32 v17, v117
    v_mfma_f32_16x16x32_bf16 a[184:187], v[76:79], v[32:35], a[184:187]
    s_waitcnt lgkmcnt(2)
    v_cvt_pk_bf16_f32 v181, v18, v19
    v_mfma_f32_16x16x32_bf16 a[44:47], v[64:67], v[40:43], a[44:47]
    ds_read_b128 v[32:35], v2 offset:6144
    v_mfma_f32_16x16x32_bf16 a[44:47], v[80:83], v[44:47], a[44:47]
    v_exp_f32 v18, v118
    v_mfma_f32_16x16x32_bf16 a[92:95], v[84:87], v[44:47], a[92:95]
    v_add_f32 v6, v6, v16
    v_add_f32 v6, v6, v17
    v_mfma_f32_16x16x32_bf16 a[92:95], v[68:71], v[40:43], a[92:95]
    v_exp_f32 v19, v119
    v_mfma_f32_16x16x32_bf16 a[140:143], v[72:75], v[40:43], a[140:143]
    ds_read_b128 v[36:39], v3 offset:6144
    v_cvt_pk_bf16_f32 v182, v16, v17
    v_mfma_f32_16x16x32_bf16 a[140:143], v[88:91], v[44:47], a[140:143]
    v_add_f32 v6, v6, v18
    v_add_f32 v6, v6, v19
    v_mfma_f32_16x16x32_bf16 a[188:191], v[92:95], v[44:47], a[188:191]
    v_cvt_pk_bf16_f32 v183, v18, v19
    v_mfma_f32_16x16x32_bf16 a[188:191], v[76:79], v[40:43], a[188:191]
    s_waitcnt lgkmcnt(2)
    v_mfma_f32_16x16x32_bf16 v[64:67], v[24:27], a[192:195], v[128:131]
    ds_read_b128 v[40:43], v2 offset:128
    v_mfma_f32_16x16x32_bf16 v[64:67], v[28:31], a[196:199], v[64:67]
    v_exp_f32 v16, v184
    v_mfma_f32_16x16x32_bf16 v[68:71], v[28:31], a[220:223], v[132:135]
    ds_read_b128 v[44:47], v3 offset:128
    v_mfma_f32_16x16x32_bf16 v[68:71], v[24:27], a[216:219], v[68:71]
    s_waitcnt lgkmcnt(2)
    v_exp_f32 v17, v185
    v_mfma_f32_16x16x32_bf16 v[96:99], v[32:35], a[192:195], v[128:131]
    ds_read_b128 v[24:27], v2 offset:6272
    v_mfma_f32_16x16x32_bf16 v[96:99], v[36:39], a[196:199], v[96:99]
    v_exp_f32 v18, v186
    v_mfma_f32_16x16x32_bf16 v[100:103], v[36:39], a[220:223], v[132:135]
    ds_read_b128 v[28:31], v3 offset:6272
    v_add_f32 v5, v5, v16
    v_mfma_f32_16x16x32_bf16 v[100:103], v[32:35], a[216:219], v[100:103]
    s_waitcnt lgkmcnt(2)
    v_add_f32 v5, v5, v17
    v_mfma_f32_16x16x32_bf16 v[64:67], v[40:43], a[200:203], v[64:67]
    ds_read_b128 v[32:35], v2 offset:256
    v_mfma_f32_16x16x32_bf16 v[64:67], v[44:47], a[204:207], v[64:67]
    v_exp_f32 v19, v187
    v_mfma_f32_16x16x32_bf16 v[68:71], v[44:47], a[228:231], v[68:71]
    ds_read_b128 v[36:39], v3 offset:256
    v_cvt_pk_bf16_f32 v184, v16, v17
    v_mfma_f32_16x16x32_bf16 v[68:71], v[40:43], a[224:227], v[68:71]
    s_waitcnt lgkmcnt(2)
    v_exp_f32 v16, v120
    v_mfma_f32_16x16x32_bf16 v[96:99], v[24:27], a[200:203], v[96:99]
    ds_read_b128 v[40:43], v2 offset:6400
    v_add_f32 v5, v5, v18
    v_mfma_f32_16x16x32_bf16 v[96:99], v[28:31], a[204:207], v[96:99]
    s_waitcnt vmcnt(0)
    v_add_f32 v5, v5, v19
    v_mfma_f32_16x16x32_bf16 v[100:103], v[28:31], a[228:231], v[100:103]
    ds_read_b128 v[44:47], v3 offset:6400
    v_mfma_f32_16x16x32_bf16 v[100:103], v[24:27], a[224:227], v[100:103]
    s_waitcnt lgkmcnt(2)
    s_barrier
    v_mfma_f32_16x16x32_bf16 v[64:67], v[32:35], a[208:211], v[64:67]
    s_mov_b32 m0, s56
    ds_read_b128 v[24:27], v2 offset:12288
    v_mfma_f32_16x16x32_bf16 v[64:67], v[36:39], a[212:215], v[64:67]
    buffer_load_dwordx4 v4, s[4:7], s27 offen offset:0 sc1 lds
    v_mfma_f32_16x16x32_bf16 v[68:71], v[36:39], a[236:239], v[68:71]
    ds_read_b128 v[28:31], v3 offset:12288
    v_mfma_f32_16x16x32_bf16 v[68:71], v[32:35], a[232:235], v[68:71]
    s_waitcnt lgkmcnt(2)
    v_exp_f32 v17, v121
    v_cvt_pk_bf16_f32 v185, v18, v19
    v_mfma_f32_16x16x32_bf16 v[96:99], v[40:43], a[208:211], v[96:99]
    ds_read_b128 v[32:35], v2 offset:18432
    v_mfma_f32_16x16x32_bf16 v[96:99], v[44:47], a[212:215], v[96:99]
    buffer_load_dwordx4 v4, s[4:7], s27 offen offset:1024 sc1 lds
    v_mfma_f32_16x16x32_bf16 v[100:103], v[44:47], a[236:239], v[100:103]
    ds_read_b128 v[36:39], v3 offset:18432
    v_mfma_f32_16x16x32_bf16 v[100:103], v[40:43], a[232:235], v[100:103]
    s_waitcnt lgkmcnt(2)
    v_exp_f32 v18, v122
    v_add_f32 v5, v5, v16
    v_mfma_f32_16x16x32_bf16 v[72:75], v[24:27], a[192:195], v[128:131]
    ds_read_b128 v[40:43], v2 offset:12416
    v_add_f32 v5, v5, v17
    v_mfma_f32_16x16x32_bf16 v[72:75], v[28:31], a[196:199], v[72:75]
    v_exp_f32 v19, v123
    v_cvt_pk_bf16_f32 v186, v16, v17
    v_mfma_f32_16x16x32_bf16 v[76:79], v[28:31], a[220:223], v[132:135]
    ds_read_b128 v[44:47], v3 offset:12416
    v_mfma_f32_16x16x32_bf16 v[76:79], v[24:27], a[216:219], v[76:79]
    s_waitcnt lgkmcnt(2)
    buffer_load_dwordx4 v4, s[4:7], s27 offen offset:2048 sc1 lds
    v_mfma_f32_16x16x32_bf16 v[104:107], v[32:35], a[192:195], v[128:131]
    ds_read_b128 v[24:27], v2 offset:18560
    v_mfma_f32_16x16x32_bf16 v[104:107], v[36:39], a[196:199], v[104:107]
    v_exp_f32 v16, v188
    v_add_f32 v5, v5, v18
    v_mfma_f32_16x16x32_bf16 v[108:111], v[36:39], a[220:223], v[132:135]
    ds_read_b128 v[28:31], v3 offset:18560
    v_add_f32 v5, v5, v19
    v_mfma_f32_16x16x32_bf16 v[108:111], v[32:35], a[216:219], v[108:111]
    s_waitcnt lgkmcnt(2)
    v_exp_f32 v17, v189
    v_cvt_pk_bf16_f32 v187, v18, v19
    v_mfma_f32_16x16x32_bf16 v[72:75], v[40:43], a[200:203], v[72:75]
    s_add_u32 s27, s27, 24576
    ds_read_b128 v[32:35], v2 offset:12544
    v_mfma_f32_16x16x32_bf16 v[72:75], v[44:47], a[204:207], v[72:75]
    v_exp_f32 v18, v190
    v_mfma_f32_16x16x32_bf16 v[76:79], v[44:47], a[228:231], v[76:79]
    s_add_u32 s56, s56, 12288
    ds_read_b128 v[36:39], v3 offset:12544
    v_add_f32 v6, v6, v16
    v_mfma_f32_16x16x32_bf16 v[76:79], v[40:43], a[224:227], v[76:79]
    s_waitcnt lgkmcnt(2)
    v_add_f32 v6, v6, v17
    v_mfma_f32_16x16x32_bf16 v[104:107], v[24:27], a[200:203], v[104:107]
    ds_read_b128 v[40:43], v2 offset:18688
    v_mfma_f32_16x16x32_bf16 v[104:107], v[28:31], a[204:207], v[104:107]
    v_exp_f32 v19, v191
    v_cvt_pk_bf16_f32 v188, v16, v17
    v_mfma_f32_16x16x32_bf16 v[108:111], v[28:31], a[228:231], v[108:111]
    s_mov_b32 m0, s56
    ds_read_b128 v[44:47], v3 offset:18688
    v_mfma_f32_16x16x32_bf16 v[108:111], v[24:27], a[224:227], v[108:111]
    s_waitcnt lgkmcnt(2)
    v_add_u32 v2, 49152, v2
    v_add_u32 v3, 49152, v3
    v_mfma_f32_16x16x32_bf16 v[72:75], v[32:35], a[208:211], v[72:75]
    ds_read_b128 v[24:27], v2 offset:0
    v_mfma_f32_16x16x32_bf16 v[72:75], v[36:39], a[212:215], v[72:75]
    buffer_load_dwordx4 v4, s[4:7], s27 offen offset:0 sc1 lds
    v_mfma_f32_16x16x32_bf16 v[76:79], v[36:39], a[236:239], v[76:79]
    ds_read_b128 v[28:31], v3 offset:0
    v_mfma_f32_16x16x32_bf16 v[76:79], v[32:35], a[232:235], v[76:79]
    s_waitcnt lgkmcnt(2)
    v_exp_f32 v16, v124
    v_add_f32 v6, v6, v18
    v_mfma_f32_16x16x32_bf16 v[104:107], v[40:43], a[208:211], v[104:107]
    ds_read_b128 v[32:35], v2 offset:6144
    v_add_f32 v6, v6, v19
    v_mfma_f32_16x16x32_bf16 v[104:107], v[44:47], a[212:215], v[104:107]
    v_exp_f32 v17, v125
    v_cvt_pk_bf16_f32 v189, v18, v19
    v_mfma_f32_16x16x32_bf16 v[108:111], v[44:47], a[236:239], v[108:111]
    ds_read_b128 v[36:39], v3 offset:6144
    v_mfma_f32_16x16x32_bf16 v[108:111], v[40:43], a[232:235], v[108:111]
    s_waitcnt lgkmcnt(2)
    buffer_load_dwordx4 v4, s[4:7], s27 offen offset:1024 sc1 lds
    v_mfma_f32_16x16x32_bf16 v[80:83], v[24:27], a[240:243], v[136:139]
    ds_read_b128 v[40:43], v2 offset:128
    v_mfma_f32_16x16x32_bf16 v[80:83], v[28:31], a[244:247], v[80:83]
    v_exp_f32 v18, v126
    v_add_f32 v6, v6, v16
    v_mfma_f32_16x16x32_bf16 v[84:87], v[28:31], v[204:207], v[140:143]
    ds_read_b128 v[44:47], v3 offset:128
    v_add_f32 v6, v6, v17
    v_exp_f32 v19, v127
    v_cvt_pk_bf16_f32 v190, v16, v17
    v_add_f32 v6, v6, v18
    v_add_f32 v6, v6, v19
    v_cvt_pk_bf16_f32 v191, v18, v19
    v_mfma_f32_16x16x32_bf16 v[84:87], v[24:27], v[200:203], v[84:87]
    s_waitcnt lgkmcnt(2)
    v_exp_f32 v16, v64
    v_mfma_f32_16x16x32_bf16 v[112:115], v[32:35], a[240:243], v[136:139]
    ds_read_b128 v[24:27], v2 offset:6272
    v_mfma_f32_16x16x32_bf16 v[112:115], v[36:39], a[244:247], v[112:115]
    buffer_load_dwordx4 v4, s[4:7], s27 offen offset:2048 sc1 lds
    v_mfma_f32_16x16x32_bf16 v[116:119], v[36:39], v[204:207], v[140:143]
    ds_read_b128 v[28:31], v3 offset:6272
    v_mfma_f32_16x16x32_bf16 v[116:119], v[32:35], v[200:203], v[116:119]
    s_waitcnt lgkmcnt(2)
    v_exp_f32 v17, v65
    v_mfma_f32_16x16x32_bf16 v[80:83], v[40:43], a[248:251], v[80:83]
    ds_read_b128 v[32:35], v2 offset:256
    v_mfma_f32_16x16x32_bf16 v[80:83], v[44:47], a[252:255], v[80:83]
    v_exp_f32 v18, v66
    v_mfma_f32_16x16x32_bf16 v[84:87], v[44:47], v[212:215], v[84:87]
    ds_read_b128 v[36:39], v3 offset:256
    v_add_f32 v5, v5, v16
    v_mfma_f32_16x16x32_bf16 v[84:87], v[40:43], v[208:211], v[84:87]
    s_waitcnt lgkmcnt(2)
    v_add_f32 v5, v5, v17
    v_mfma_f32_16x16x32_bf16 v[112:115], v[24:27], a[248:251], v[112:115]
    ds_read_b128 v[40:43], v2 offset:6400
    v_mfma_f32_16x16x32_bf16 v[112:115], v[28:31], a[252:255], v[112:115]
    v_exp_f32 v19, v67
    v_cvt_pk_bf16_f32 v64, v16, v17
    v_mfma_f32_16x16x32_bf16 v[116:119], v[28:31], v[212:215], v[116:119]
    s_add_u32 s27, s27, 24576
    ds_read_b128 v[44:47], v3 offset:6400
    s_add_u32 s56, s56, 36864
    v_mfma_f32_16x16x32_bf16 v[116:119], v[24:27], v[208:211], v[116:119]
    s_waitcnt lgkmcnt(2)
    v_exp_f32 v16, v96
    v_mfma_f32_16x16x32_bf16 v[80:83], v[32:35], v[192:195], v[80:83]
    s_sub_u32 s58, s56, 147456
    ds_read_b128 v[24:27], v2 offset:12288
    v_add_f32 v5, v5, v18
    v_mfma_f32_16x16x32_bf16 v[80:83], v[36:39], v[196:199], v[80:83]
    s_min_u32 s56, s56, s58
    v_add_f32 v5, v5, v19
    v_mfma_f32_16x16x32_bf16 v[84:87], v[36:39], v[220:223], v[84:87]
    ds_read_b128 v[28:31], v3 offset:12288
    v_mfma_f32_16x16x32_bf16 v[84:87], v[32:35], v[216:219], v[84:87]
    s_waitcnt lgkmcnt(2)
    v_exp_f32 v17, v97
    v_cvt_pk_bf16_f32 v65, v18, v19
    v_mfma_f32_16x16x32_bf16 v[112:115], v[40:43], v[192:195], v[112:115]
    ds_read_b128 v[32:35], v2 offset:18432
    v_mfma_f32_16x16x32_bf16 v[112:115], v[44:47], v[196:199], v[112:115]
    v_exp_f32 v18, v98
    v_mfma_f32_16x16x32_bf16 v[116:119], v[44:47], v[220:223], v[116:119]
    ds_read_b128 v[36:39], v3 offset:18432
    v_add_f32 v5, v5, v16
    v_mfma_f32_16x16x32_bf16 v[116:119], v[40:43], v[216:219], v[116:119]
    s_waitcnt lgkmcnt(2)
    v_add_f32 v5, v5, v17
    v_mfma_f32_16x16x32_bf16 v[88:91], v[24:27], a[240:243], v[136:139]
    ds_read_b128 v[40:43], v2 offset:12416
    v_mfma_f32_16x16x32_bf16 v[88:91], v[28:31], a[244:247], v[88:91]
    v_exp_f32 v19, v99
    v_cvt_pk_bf16_f32 v66, v16, v17
    v_mfma_f32_16x16x32_bf16 v[92:95], v[28:31], v[204:207], v[140:143]
    ds_read_b128 v[44:47], v3 offset:12416
    v_mfma_f32_16x16x32_bf16 v[92:95], v[24:27], v[200:203], v[92:95]
    s_waitcnt lgkmcnt(2)
    v_exp_f32 v16, v68
    v_mfma_f32_16x16x32_bf16 v[120:123], v[32:35], a[240:243], v[136:139]
    ds_read_b128 v[24:27], v2 offset:18560
    v_add_f32 v5, v5, v18
    v_mfma_f32_16x16x32_bf16 v[120:123], v[36:39], a[244:247], v[120:123]
    v_add_f32 v5, v5, v19
    v_mfma_f32_16x16x32_bf16 v[124:127], v[36:39], v[204:207], v[140:143]
    ds_read_b128 v[28:31], v3 offset:18560
    v_mfma_f32_16x16x32_bf16 v[124:127], v[32:35], v[200:203], v[124:127]
    s_waitcnt lgkmcnt(2)
    v_exp_f32 v17, v69
    v_cvt_pk_bf16_f32 v67, v18, v19
    v_mfma_f32_16x16x32_bf16 v[88:91], v[40:43], a[248:251], v[88:91]
    ds_read_b128 v[32:35], v2 offset:12544
    v_mfma_f32_16x16x32_bf16 v[88:91], v[44:47], a[252:255], v[88:91]
    v_exp_f32 v18, v70
    v_mfma_f32_16x16x32_bf16 v[92:95], v[44:47], v[212:215], v[92:95]
    ds_read_b128 v[36:39], v3 offset:12544
    v_add_f32 v6, v6, v16
    v_mfma_f32_16x16x32_bf16 v[92:95], v[40:43], v[208:211], v[92:95]
    s_waitcnt lgkmcnt(2)
    v_add_f32 v6, v6, v17
    v_mfma_f32_16x16x32_bf16 v[120:123], v[24:27], a[248:251], v[120:123]
    ds_read_b128 v[40:43], v2 offset:18688
    v_mfma_f32_16x16x32_bf16 v[120:123], v[28:31], a[252:255], v[120:123]
    v_exp_f32 v19, v71
    v_cvt_pk_bf16_f32 v68, v16, v17
    v_mfma_f32_16x16x32_bf16 v[124:127], v[28:31], v[212:215], v[124:127]
    ds_read_b128 v[44:47], v3 offset:18688
    v_mfma_f32_16x16x32_bf16 v[124:127], v[24:27], v[208:211], v[124:127]
    s_waitcnt lgkmcnt(2)
    v_add_u32 v1, 49152, v1
    v_exp_f32 v16, v100
    v_mfma_f32_16x16x32_bf16 v[88:91], v[32:35], v[192:195], v[88:91]
    ds_read_b128 v[24:27], v1 offset:0
    v_add_f32 v6, v6, v18
    v_mfma_f32_16x16x32_bf16 v[88:91], v[36:39], v[196:199], v[88:91]
    v_add_f32 v6, v6, v19
    v_mfma_f32_16x16x32_bf16 v[92:95], v[36:39], v[220:223], v[92:95]
    ds_read_b128 v[28:31], v1 offset:12288
    v_mfma_f32_16x16x32_bf16 v[92:95], v[32:35], v[216:219], v[92:95]
    s_waitcnt lgkmcnt(2)
    v_exp_f32 v17, v101
    v_cvt_pk_bf16_f32 v69, v18, v19
    v_mfma_f32_16x16x32_bf16 v[120:123], v[40:43], v[192:195], v[120:123]
    ds_read_b128 v[32:35], v1 offset:1024
    v_mfma_f32_16x16x32_bf16 v[120:123], v[44:47], v[196:199], v[120:123]
    v_exp_f32 v18, v102
    v_mfma_f32_16x16x32_bf16 v[124:127], v[44:47], v[220:223], v[124:127]
    ds_read_b128 v[36:39], v1 offset:13312
    v_add_f32 v6, v6, v16
    v_mfma_f32_16x16x32_bf16 v[124:127], v[40:43], v[216:219], v[124:127]
    s_waitcnt lgkmcnt(2)
    v_add_f32 v6, v6, v17
    v_exp_f32 v19, v103
    v_cvt_pk_bf16_f32 v70, v16, v17
    v_add_f32 v6, v6, v18
    v_add_f32 v6, v6, v19
    v_cvt_pk_bf16_f32 v71, v18, v19
    v_mfma_f32_16x16x32_bf16 a[0:3], v[160:163], v[24:27], a[0:3]
    ds_read_b128 v[40:43], v1 offset:2048
    v_mfma_f32_16x16x32_bf16 a[0:3], v[168:171], v[28:31], a[0:3]
    v_exp_f32 v16, v72
    v_mfma_f32_16x16x32_bf16 a[48:51], v[172:175], v[28:31], a[48:51]
    ds_read_b128 v[44:47], v1 offset:14336
    v_mfma_f32_16x16x32_bf16 a[48:51], v[164:167], v[24:27], a[48:51]
    s_waitcnt lgkmcnt(2)
    v_exp_f32 v17, v73
    v_mfma_f32_16x16x32_bf16 a[4:7], v[160:163], v[32:35], a[4:7]
    ds_read_b128 v[24:27], v1 offset:3072
    v_mfma_f32_16x16x32_bf16 a[4:7], v[168:171], v[36:39], a[4:7]
    v_exp_f32 v18, v74
    v_mfma_f32_16x16x32_bf16 a[52:55], v[172:175], v[36:39], a[52:55]
    ds_read_b128 v[28:31], v1 offset:15360
    v_add_f32 v5, v5, v16
    v_mfma_f32_16x16x32_bf16 a[52:55], v[164:167], v[32:35], a[52:55]
    s_waitcnt lgkmcnt(2)
    v_add_f32 v5, v5, v17
    v_mfma_f32_16x16x32_bf16 a[8:11], v[160:163], v[40:43], a[8:11]
    ds_read_b128 v[32:35], v1 offset:4096
    v_mfma_f32_16x16x32_bf16 a[8:11], v[168:171], v[44:47], a[8:11]
    v_exp_f32 v19, v75
    v_mfma_f32_16x16x32_bf16 a[56:59], v[172:175], v[44:47], a[56:59]
    ds_read_b128 v[36:39], v1 offset:16384
    v_cvt_pk_bf16_f32 v72, v16, v17
    v_mfma_f32_16x16x32_bf16 a[56:59], v[164:167], v[40:43], a[56:59]
    s_waitcnt lgkmcnt(2)
    v_exp_f32 v16, v104
    v_mfma_f32_16x16x32_bf16 a[12:15], v[160:163], v[24:27], a[12:15]
    ds_read_b128 v[40:43], v1 offset:5120
    v_add_f32 v5, v5, v18
    v_mfma_f32_16x16x32_bf16 a[12:15], v[168:171], v[28:31], a[12:15]
    v_add_f32 v5, v5, v19
    v_mfma_f32_16x16x32_bf16 a[60:63], v[172:175], v[28:31], a[60:63]
    ds_read_b128 v[44:47], v1 offset:17408
    v_mfma_f32_16x16x32_bf16 a[60:63], v[164:167], v[24:27], a[60:63]
    s_waitcnt lgkmcnt(2)
    v_exp_f32 v17, v105
    v_mfma_f32_16x16x32_bf16 a[16:19], v[160:163], v[32:35], a[16:19]
    ds_read_b128 v[24:27], v1 offset:6144
    v_cvt_pk_bf16_f32 v73, v18, v19
    v_mfma_f32_16x16x32_bf16 a[16:19], v[168:171], v[36:39], a[16:19]
    v_exp_f32 v18, v106
    v_mfma_f32_16x16x32_bf16 a[64:67], v[172:175], v[36:39], a[64:67]
    ds_read_b128 v[28:31], v1 offset:18432
    v_add_f32 v5, v5, v16
    v_mfma_f32_16x16x32_bf16 a[64:67], v[164:167], v[32:35], a[64:67]
    s_waitcnt lgkmcnt(2)
    v_add_f32 v5, v5, v17
    v_mfma_f32_16x16x32_bf16 a[20:23], v[160:163], v[40:43], a[20:23]
    ds_read_b128 v[32:35], v1 offset:7168
    v_mfma_f32_16x16x32_bf16 a[20:23], v[168:171], v[44:47], a[20:23]
    v_exp_f32 v19, v107
    v_mfma_f32_16x16x32_bf16 a[68:71], v[172:175], v[44:47], a[68:71]
    ds_read_b128 v[36:39], v1 offset:19456
    v_cvt_pk_bf16_f32 v74, v16, v17
    v_mfma_f32_16x16x32_bf16 a[68:71], v[164:167], v[40:43], a[68:71]
    s_waitcnt lgkmcnt(2)
    v_exp_f32 v16, v76
    v_mfma_f32_16x16x32_bf16 a[24:27], v[160:163], v[24:27], a[24:27]
    ds_read_b128 v[40:43], v1 offset:8192
    v_add_f32 v5, v5, v18
    v_mfma_f32_16x16x32_bf16 a[24:27], v[168:171], v[28:31], a[24:27]
    v_add_f32 v5, v5, v19
    v_mfma_f32_16x16x32_bf16 a[72:75], v[172:175], v[28:31], a[72:75]
    ds_read_b128 v[44:47], v1 offset:20480
    v_mfma_f32_16x16x32_bf16 a[72:75], v[164:167], v[24:27], a[72:75]
    s_waitcnt lgkmcnt(2)
    v_exp_f32 v17, v77
    v_mfma_f32_16x16x32_bf16 a[28:31], v[160:163], v[32:35], a[28:31]
    ds_read_b128 v[24:27], v1 offset:9216
    v_cvt_pk_bf16_f32 v75, v18, v19
    v_mfma_f32_16x16x32_bf16 a[28:31], v[168:171], v[36:39], a[28:31]
    v_exp_f32 v18, v78
    v_mfma_f32_16x16x32_bf16 a[76:79], v[172:175], v[36:39], a[76:79]
    ds_read_b128 v[28:31], v1 offset:21504
    v_add_f32 v6, v6, v16
    v_mfma_f32_16x16x32_bf16 a[76:79], v[164:167], v[32:35], a[76:79]
    s_waitcnt lgkmcnt(2)
    v_add_f32 v6, v6, v17
    v_mfma_f32_16x16x32_bf16 a[32:35], v[160:163], v[40:43], a[32:35]
    ds_read_b128 v[32:35], v1 offset:10240
    v_mfma_f32_16x16x32_bf16 a[32:35], v[168:171], v[44:47], a[32:35]
    v_exp_f32 v19, v79
    v_mfma_f32_16x16x32_bf16 a[80:83], v[172:175], v[44:47], a[80:83]
    ds_read_b128 v[36:39], v1 offset:22528
    v_cvt_pk_bf16_f32 v76, v16, v17
    v_mfma_f32_16x16x32_bf16 a[80:83], v[164:167], v[40:43], a[80:83]
    s_waitcnt lgkmcnt(2)
    v_exp_f32 v16, v108
    v_mfma_f32_16x16x32_bf16 a[36:39], v[160:163], v[24:27], a[36:39]
    ds_read_b128 v[40:43], v1 offset:11264
    v_add_f32 v6, v6, v18
    v_mfma_f32_16x16x32_bf16 a[36:39], v[168:171], v[28:31], a[36:39]
    v_add_f32 v6, v6, v19
    v_mfma_f32_16x16x32_bf16 a[84:87], v[172:175], v[28:31], a[84:87]
    ds_read_b128 v[44:47], v1 offset:23552
    v_mfma_f32_16x16x32_bf16 a[84:87], v[164:167], v[24:27], a[84:87]
    s_waitcnt lgkmcnt(2)
    v_subrev_u32 v1, 98304, v1
    v_mfma_f32_16x16x32_bf16 a[40:43], v[160:163], v[32:35], a[40:43]
    ds_read_b128 v[24:27], v1 offset:0
    v_mfma_f32_16x16x32_bf16 a[40:43], v[168:171], v[36:39], a[40:43]
    v_exp_f32 v17, v109
    v_mfma_f32_16x16x32_bf16 a[88:91], v[172:175], v[36:39], a[88:91]
    ds_read_b128 v[28:31], v1 offset:12288
    v_cvt_pk_bf16_f32 v77, v18, v19
    v_mfma_f32_16x16x32_bf16 a[88:91], v[164:167], v[32:35], a[88:91]
    s_waitcnt lgkmcnt(2)
    v_exp_f32 v18, v110
    v_mfma_f32_16x16x32_bf16 a[44:47], v[160:163], v[40:43], a[44:47]
    ds_read_b128 v[32:35], v1 offset:1024
    v_add_f32 v6, v6, v16
    v_mfma_f32_16x16x32_bf16 a[44:47], v[168:171], v[44:47], a[44:47]
    v_add_f32 v6, v6, v17
    v_mfma_f32_16x16x32_bf16 a[92:95], v[172:175], v[44:47], a[92:95]
    ds_read_b128 v[36:39], v1 offset:13312
    v_mfma_f32_16x16x32_bf16 a[92:95], v[164:167], v[40:43], a[92:95]
    s_waitcnt lgkmcnt(2)
    v_exp_f32 v19, v111
    v_mfma_f32_16x16x32_bf16 a[0:3], v[176:179], v[24:27], a[0:3]
    ds_read_b128 v[40:43], v1 offset:2048
    v_cvt_pk_bf16_f32 v78, v16, v17
    v_mfma_f32_16x16x32_bf16 a[0:3], v[184:187], v[28:31], a[0:3]
    v_add_f32 v6, v6, v18
    v_add_f32 v6, v6, v19
    v_mfma_f32_16x16x32_bf16 a[48:51], v[188:191], v[28:31], a[48:51]
    ds_read_b128 v[44:47], v1 offset:14336
    v_cvt_pk_bf16_f32 v79, v18, v19
    v_mfma_f32_16x16x32_bf16 a[48:51], v[180:183], v[24:27], a[48:51]
    s_waitcnt lgkmcnt(2)
    v_exp_f32 v16, v80
    v_mfma_f32_16x16x32_bf16 a[4:7], v[176:179], v[32:35], a[4:7]
    ds_read_b128 v[24:27], v1 offset:3072
    v_mfma_f32_16x16x32_bf16 a[4:7], v[184:187], v[36:39], a[4:7]
    v_exp_f32 v17, v81
    v_mfma_f32_16x16x32_bf16 a[52:55], v[188:191], v[36:39], a[52:55]
    ds_read_b128 v[28:31], v1 offset:15360
    v_mfma_f32_16x16x32_bf16 a[52:55], v[180:183], v[32:35], a[52:55]
    s_waitcnt lgkmcnt(2)
    v_exp_f32 v18, v82
    v_mfma_f32_16x16x32_bf16 a[8:11], v[176:179], v[40:43], a[8:11]
    ds_read_b128 v[32:35], v1 offset:4096
    v_add_f32 v7, v7, v16
    v_mfma_f32_16x16x32_bf16 a[8:11], v[184:187], v[44:47], a[8:11]
    v_add_f32 v7, v7, v17
    v_mfma_f32_16x16x32_bf16 a[56:59], v[188:191], v[44:47], a[56:59]
    ds_read_b128 v[36:39], v1 offset:16384
    v_mfma_f32_16x16x32_bf16 a[56:59], v[180:183], v[40:43], a[56:59]
    s_waitcnt lgkmcnt(2)
    v_exp_f32 v19, v83
    v_mfma_f32_16x16x32_bf16 a[12:15], v[176:179], v[24:27], a[12:15]
    ds_read_b128 v[40:43], v1 offset:5120
    v_cvt_pk_bf16_f32 v80, v16, v17
    v_mfma_f32_16x16x32_bf16 a[12:15], v[184:187], v[28:31], a[12:15]
    v_exp_f32 v16, v112
    v_mfma_f32_16x16x32_bf16 a[60:63], v[188:191], v[28:31], a[60:63]
    ds_read_b128 v[44:47], v1 offset:17408
    v_add_f32 v7, v7, v18
    v_mfma_f32_16x16x32_bf16 a[60:63], v[180:183], v[24:27], a[60:63]
    s_waitcnt lgkmcnt(2)
    v_add_f32 v7, v7, v19
    v_mfma_f32_16x16x32_bf16 a[16:19], v[176:179], v[32:35], a[16:19]
    ds_read_b128 v[24:27], v1 offset:6144
    v_mfma_f32_16x16x32_bf16 a[16:19], v[184:187], v[36:39], a[16:19]
    v_exp_f32 v17, v113
    v_mfma_f32_16x16x32_bf16 a[64:67], v[188:191], v[36:39], a[64:67]
    ds_read_b128 v[28:31], v1 offset:18432
    v_cvt_pk_bf16_f32 v81, v18, v19
    v_mfma_f32_16x16x32_bf16 a[64:67], v[180:183], v[32:35], a[64:67]
    s_waitcnt lgkmcnt(2)
    v_exp_f32 v18, v114
    v_mfma_f32_16x16x32_bf16 a[20:23], v[176:179], v[40:43], a[20:23]
    ds_read_b128 v[32:35], v1 offset:7168
    v_add_f32 v7, v7, v16
    v_mfma_f32_16x16x32_bf16 a[20:23], v[184:187], v[44:47], a[20:23]
    v_add_f32 v7, v7, v17
    v_mfma_f32_16x16x32_bf16 a[68:71], v[188:191], v[44:47], a[68:71]
    ds_read_b128 v[36:39], v1 offset:19456
    v_mfma_f32_16x16x32_bf16 a[68:71], v[180:183], v[40:43], a[68:71]
    s_waitcnt lgkmcnt(2)
    v_exp_f32 v19, v115
    v_mfma_f32_16x16x32_bf16 a[24:27], v[176:179], v[24:27], a[24:27]
    ds_read_b128 v[40:43], v1 offset:8192
    v_cvt_pk_bf16_f32 v82, v16, v17
    v_mfma_f32_16x16x32_bf16 a[24:27], v[184:187], v[28:31], a[24:27]
    v_exp_f32 v16, v84
    v_mfma_f32_16x16x32_bf16 a[72:75], v[188:191], v[28:31], a[72:75]
    ds_read_b128 v[44:47], v1 offset:20480
    v_add_f32 v7, v7, v18
    v_mfma_f32_16x16x32_bf16 a[72:75], v[180:183], v[24:27], a[72:75]
    s_waitcnt lgkmcnt(2)
    v_add_f32 v7, v7, v19
    v_mfma_f32_16x16x32_bf16 a[28:31], v[176:179], v[32:35], a[28:31]
    ds_read_b128 v[24:27], v1 offset:9216
    v_mfma_f32_16x16x32_bf16 a[28:31], v[184:187], v[36:39], a[28:31]
    s_waitcnt vmcnt(0)
    v_exp_f32 v17, v85
    v_mfma_f32_16x16x32_bf16 a[76:79], v[188:191], v[36:39], a[76:79]
    ds_read_b128 v[28:31], v1 offset:21504
    v_cvt_pk_bf16_f32 v83, v18, v19
    v_mfma_f32_16x16x32_bf16 a[76:79], v[180:183], v[32:35], a[76:79]
    s_waitcnt lgkmcnt(2)
    s_barrier
    v_mfma_f32_16x16x32_bf16 a[32:35], v[176:179], v[40:43], a[32:35]
    ds_read_b128 v[32:35], v1 offset:10240
    v_mfma_f32_16x16x32_bf16 a[32:35], v[184:187], v[44:47], a[32:35]
    v_exp_f32 v18, v86
    v_mfma_f32_16x16x32_bf16 a[80:83], v[188:191], v[44:47], a[80:83]
    ds_read_b128 v[36:39], v1 offset:22528
    v_add_f32 v8, v8, v16
    v_mfma_f32_16x16x32_bf16 a[80:83], v[180:183], v[40:43], a[80:83]
    s_waitcnt lgkmcnt(2)
    v_add_f32 v8, v8, v17
    v_mfma_f32_16x16x32_bf16 a[36:39], v[176:179], v[24:27], a[36:39]
    ds_read_b128 v[40:43], v1 offset:11264
    v_mfma_f32_16x16x32_bf16 a[36:39], v[184:187], v[28:31], a[36:39]
    v_exp_f32 v19, v87
    v_cvt_pk_bf16_f32 v84, v16, v17
    v_mfma_f32_16x16x32_bf16 a[84:87], v[188:191], v[28:31], a[84:87]
    ds_read_b128 v[44:47], v1 offset:23552
    v_mfma_f32_16x16x32_bf16 a[84:87], v[180:183], v[24:27], a[84:87]
    s_waitcnt lgkmcnt(2)
    v_add_u32 v1, 49152, v1
    v_exp_f32 v16, v116
    v_mfma_f32_16x16x32_bf16 a[40:43], v[176:179], v[32:35], a[40:43]
    ds_read_b128 v[24:27], v1 offset:0
    v_add_f32 v8, v8, v18
    v_mfma_f32_16x16x32_bf16 a[40:43], v[184:187], v[36:39], a[40:43]
    v_add_f32 v8, v8, v19
    v_mfma_f32_16x16x32_bf16 a[88:91], v[188:191], v[36:39], a[88:91]
    ds_read_b128 v[28:31], v1 offset:12288
    v_mfma_f32_16x16x32_bf16 a[88:91], v[180:183], v[32:35], a[88:91]
    s_waitcnt lgkmcnt(2)
    v_exp_f32 v17, v117
    v_cvt_pk_bf16_f32 v85, v18, v19
    v_mfma_f32_16x16x32_bf16 a[44:47], v[176:179], v[40:43], a[44:47]
    ds_read_b128 v[32:35], v1 offset:1024
    v_mfma_f32_16x16x32_bf16 a[44:47], v[184:187], v[44:47], a[44:47]
    v_exp_f32 v18, v118
    v_mfma_f32_16x16x32_bf16 a[92:95], v[188:191], v[44:47], a[92:95]
    ds_read_b128 v[36:39], v1 offset:13312
    v_add_f32 v8, v8, v16
    v_mfma_f32_16x16x32_bf16 a[92:95], v[180:183], v[40:43], a[92:95]
    s_waitcnt lgkmcnt(2)
    v_add_f32 v8, v8, v17
    v_exp_f32 v19, v119
    v_cvt_pk_bf16_f32 v86, v16, v17
    v_add_f32 v8, v8, v18
    v_add_f32 v8, v8, v19
    v_cvt_pk_bf16_f32 v87, v18, v19
    v_mfma_f32_16x16x32_bf16 a[0:3], v[64:67], v[24:27], a[0:3]
    ds_read_b128 v[40:43], v1 offset:2048
    v_mfma_f32_16x16x32_bf16 a[0:3], v[72:75], v[28:31], a[0:3]
    v_exp_f32 v16, v88
    v_exp_f32 v17, v89
    v_exp_f32 v18, v90
    v_mfma_f32_16x16x4_f32 v[48:51], v5, v57, 0
    v_mfma_f32_16x16x32_bf16 a[48:51], v[76:79], v[28:31], a[48:51]
    ds_read_b128 v[44:47], v1 offset:14336
    v_mfma_f32_16x16x32_bf16 a[48:51], v[68:71], v[24:27], a[48:51]
L_pg12:
    s_cbranch_execz L_iwret
    s_waitcnt lgkmcnt(2)
    v_exp_f32 v19, v91
    v_cvt_pk_bf16_f32 v88, v16, v17
    v_exp_f32 v16, v120
    v_mfma_f32_16x16x4_f32 v[52:55], v6, v57, 0
    v_mfma_f32_16x16x32_bf16 a[4:7], v[64:67], v[32:35], a[4:7]
    ds_read_b128 v[24:27], v1 offset:3072
    v_mfma_f32_16x16x32_bf16 a[4:7], v[72:75], v[36:39], a[4:7]
    v_exp_f32 v17, v121
    v_cvt_pk_bf16_f32 v89, v18, v19
    v_mfma_f32_16x16x32_bf16 a[52:55], v[76:79], v[36:39], a[52:55]
    ds_read_b128 v[28:31], v1 offset:15360
    v_mfma_f32_16x16x32_bf16 a[52:55], v[68:71], v[32:35], a[52:55]
    s_waitcnt lgkmcnt(2)
    v_exp_f32 v18, v122
    v_mfma_f32_16x16x32_bf16 a[8:11], v[64:67], v[40:43], a[8:11]
    ds_read_b128 v[32:35], v1 offset:4096
    v_mfma_f32_16x16x32_bf16 a[8:11], v[72:75], v[44:47], a[8:11]
    v_exp_f32 v19, v123
    v_mfma_f32_16x16x32_bf16 a[56:59], v[76:79], v[44:47], a[56:59]
    ds_read_b128 v[36:39], v1 offset:16384
    v_cvt_pk_bf16_f32 v90, v16, v17
    v_mfma_f32_16x16x32_bf16 a[56:59], v[68:71], v[40:43], a[56:59]
    s_waitcnt lgkmcnt(2)
    v_exp_f32 v16, v92
    v_mfma_f32_16x16x32_bf16 a[12:15], v[64:67], v[24:27], a[12:15]
    ds_read_b128 v[40:43], v1 offset:5120
    v_mfma_f32_16x16x32_bf16 a[12:15], v[72:75], v[28:31], a[12:15]
    v_exp_f32 v17, v93
    v_mfma_f32_16x16x32_bf16 a[60:63], v[76:79], v[28:31], a[60:63]
    ds_read_b128 v[44:47], v1 offset:17408
    v_cvt_pk_bf16_f32 v91, v18, v19
    v_mfma_f32_16x16x32_bf16 a[60:63], v[68:71], v[24:27], a[60:63]
    s_waitcnt lgkmcnt(2)
    v_exp_f32 v18, v94
    v_mfma_f32_16x16x32_bf16 a[16:19], v[64:67], v[32:35], a[16:19]
    ds_read_b128 v[24:27], v1 offset:6144
    v_mfma_f32_16x16x32_bf16 a[16:19], v[72:75], v[36:39], a[16:19]
    v_exp_f32 v19, v95
    v_mfma_f32_16x16x32_bf16 a[64:67], v[76:79], v[36:39], a[64:67]
    ds_read_b128 v[28:31], v1 offset:18432
    v_mfma_f32_16x16x32_bf16 a[64:67], v[68:71], v[32:35], a[64:67]
    s_waitcnt lgkmcnt(2)
    v_mfma_f32_16x16x32_bf16 v[128:131], v[88:91], v[20:23], 0
    v_mfma_f32_16x16x32_bf16 a[20:23], v[64:67], v[40:43], a[20:23]
    ds_read_b128 v[32:35], v1 offset:7168
    v_cvt_pk_bf16_f32 v92, v16, v17
    v_mfma_f32_16x16x32_bf16 a[20:23], v[72:75], v[44:47], a[20:23]
    v_exp_f32 v16, v124
    v_mfma_f32_16x16x32_bf16 a[68:71], v[76:79], v[44:47], a[68:71]
    ds_read_b128 v[36:39], v1 offset:19456
    v_mfma_f32_16x16x32_bf16 a[68:71], v[68:71], v[40:43], a[68:71]
    s_waitcnt lgkmcnt(2)
    v_exp_f32 v17, v125
    v_mfma_f32_16x16x32_bf16 a[24:27], v[64:67], v[24:27], a[24:27]
    ds_read_b128 v[40:43], v1 offset:8192
    v_cvt_pk_bf16_f32 v93, v18, v19
    v_mfma_f32_16x16x32_bf16 a[24:27], v[72:75], v[28:31], a[24:27]
    v_exp_f32 v18, v126
    v_mfma_f32_16x16x32_bf16 a[72:75], v[76:79], v[28:31], a[72:75]
    ds_read_b128 v[44:47], v1 offset:20480
    v_mfma_f32_16x16x32_bf16 a[72:75], v[68:71], v[24:27], a[72:75]
    s_waitcnt lgkmcnt(2)
    v_exp_f32 v19, v127
    v_mfma_f32_16x16x32_bf16 a[28:31], v[64:67], v[32:35], a[28:31]
    ds_read_b128 v[24:27], v1 offset:9216
    v_cvt_pk_bf16_f32 v94, v16, v17
    v_mfma_f32_16x16x32_bf16 a[28:31], v[72:75], v[36:39], a[28:31]
    v_cvt_pk_bf16_f32 v95, v18, v19
    s_nop 1
    v_mfma_f32_16x16x32_bf16 a[76:79], v[76:79], v[36:39], a[76:79]
    ds_read_b128 v[28:31], v1 offset:21504
    v_mfma_f32_16x16x32_bf16 a[76:79], v[68:71], v[32:35], a[76:79]
    s_waitcnt lgkmcnt(2)
    v_mfma_f32_16x16x32_bf16 v[132:135], v[92:95], v[20:23], 0
    v_mfma_f32_16x16x32_bf16 a[32:35], v[64:67], v[40:43], a[32:35]
    ds_read_b128 v[32:35], v1 offset:10240
    v_mfma_f32_16x16x32_bf16 a[32:35], v[72:75], v[44:47], a[32:35]
    v_rcp_f32 v48, v48
    v_mfma_f32_16x16x32_bf16 a[80:83], v[76:79], v[44:47], a[80:83]
    ds_read_b128 v[36:39], v1 offset:22528
    v_mfma_f32_16x16x32_bf16 a[80:83], v[68:71], v[40:43], a[80:83]
    s_waitcnt lgkmcnt(2)
    v_rcp_f32 v49, v49
    v_mfma_f32_16x16x32_bf16 a[36:39], v[64:67], v[24:27], a[36:39]
    ds_read_b128 v[40:43], v1 offset:11264
    v_mfma_f32_16x16x32_bf16 a[36:39], v[72:75], v[28:31], a[36:39]
    v_rcp_f32 v50, v50
    v_mfma_f32_16x16x32_bf16 a[84:87], v[76:79], v[28:31], a[84:87]
    ds_read_b128 v[44:47], v1 offset:23552
    v_mfma_f32_16x16x32_bf16 a[84:87], v[68:71], v[24:27], a[84:87]
    s_waitcnt lgkmcnt(2)
    v_subrev_u32 v2, 98304, v2
    v_subrev_u32 v3, 98304, v3
    v_mfma_f32_16x16x32_bf16 a[40:43], v[64:67], v[32:35], a[40:43]
    ds_read_b128 v[24:27], v2 offset:0
    v_mfma_f32_16x16x32_bf16 a[40:43], v[72:75], v[36:39], a[40:43]
    v_rcp_f32 v51, v51
    v_mfma_f32_16x16x32_bf16 a[88:91], v[76:79], v[36:39], a[88:91]
    ds_read_b128 v[28:31], v3 offset:0
    v_mfma_f32_16x16x32_bf16 a[88:91], v[68:71], v[32:35], a[88:91]
    s_waitcnt lgkmcnt(2)
    v_rcp_f32 v52, v52
    v_mfma_f32_16x16x32_bf16 a[44:47], v[64:67], v[40:43], a[44:47]
    ds_read_b128 v[32:35], v2 offset:6144
    v_mfma_f32_16x16x32_bf16 a[44:47], v[72:75], v[44:47], a[44:47]
    v_rcp_f32 v53, v53
    v_mfma_f32_16x16x32_bf16 a[92:95], v[76:79], v[44:47], a[92:95]
    ds_read_b128 v[36:39], v3 offset:6144
    v_mfma_f32_16x16x32_bf16 a[92:95], v[68:71], v[40:43], a[92:95]
    s_waitcnt lgkmcnt(2)
    v_rcp_f32 v54, v54
    v_mfma_f32_16x16x32_bf16 v[160:163], v[24:27], a[240:243], v[136:139]
    ds_read_b128 v[40:43], v2 offset:128
    v_mfma_f32_16x16x32_bf16 v[160:163], v[28:31], a[244:247], v[160:163]
    v_rcp_f32 v55, v55
    v_mfma_f32_16x16x32_bf16 v[164:167], v[28:31], v[204:207], v[140:143]
    ds_read_b128 v[44:47], v3 offset:128
    v_mfma_f32_16x16x32_bf16 v[164:167], v[24:27], v[200:203], v[164:167]
    s_waitcnt lgkmcnt(2)
    v_mfma_f32_16x16x32_bf16 v[96:99], v[32:35], a[240:243], v[136:139]
    ds_read_b128 v[24:27], v2 offset:6272
    v_accvgpr_read_b32 v224, a0
    v_mfma_f32_16x16x32_bf16 v[96:99], v[36:39], a[244:247], v[96:99]
    v_accvgpr_read_b32 v225, a4
    v_accvgpr_read_b32 v226, a8
    v_accvgpr_read_b32 v227, a12
    v_accvgpr_read_b32 v228, a16
    v_accvgpr_read_b32 v229, a20
    v_mfma_f32_16x16x32_bf16 v[100:103], v[36:39], v[204:207], v[140:143]
    ds_read_b128 v[28:31], v3 offset:6272
    v_mul_f32 v224, v224, v48
    v_mfma_f32_16x16x32_bf16 v[100:103], v[32:35], v[200:203], v[100:103]
    s_waitcnt lgkmcnt(2)
    v_mul_f32 v225, v225, v48
    v_mul_f32 v226, v226, v48
    v_mul_f32 v227, v227, v48
    v_mul_f32 v228, v228, v48
    v_mul_f32 v229, v229, v48
    v_mfma_f32_16x16x32_bf16 v[160:163], v[40:43], a[248:251], v[160:163]
    ds_read_b128 v[32:35], v2 offset:256
    v_cvt_pk_bf16_f32 v224, v224, v225
    v_mfma_f32_16x16x32_bf16 v[160:163], v[44:47], a[252:255], v[160:163]
    v_cvt_pk_bf16_f32 v225, v226, v227
    v_cvt_pk_bf16_f32 v226, v228, v229
    v_accvgpr_read_b32 v230, a1
    v_accvgpr_read_b32 v231, a5
    v_accvgpr_read_b32 v232, a9
    v_mfma_f32_16x16x32_bf16 v[164:167], v[44:47], v[212:215], v[164:167]
    ds_read_b128 v[36:39], v3 offset:256
    v_accvgpr_read_b32 v233, a13
    v_mfma_f32_16x16x32_bf16 v[164:167], v[40:43], v[208:211], v[164:167]
    s_waitcnt lgkmcnt(2)
    buffer_store_dwordx3 v[224:226], v56, s[12:15], s24 offen offset:0 sc0 sc1
    v_accvgpr_read_b32 v234, a17
    v_accvgpr_read_b32 v235, a21
    v_mfma_f32_16x16x32_bf16 v[96:99], v[24:27], a[248:251], v[96:99]
    ds_read_b128 v[40:43], v2 offset:6400
    v_mul_f32 v230, v230, v49
    v_mfma_f32_16x16x32_bf16 v[96:99], v[28:31], a[252:255], v[96:99]
    v_mul_f32 v231, v231, v49
    v_mul_f32 v232, v232, v49
    v_mul_f32 v233, v233, v49
    v_mul_f32 v234, v234, v49
    v_mul_f32 v235, v235, v49
    v_mfma_f32_16x16x32_bf16 v[100:103], v[28:31], v[212:215], v[100:103]
    ds_read_b128 v[44:47], v3 offset:6400
    v_cvt_pk_bf16_f32 v230, v230, v231
    v_mfma_f32_16x16x32_bf16 v[100:103], v[24:27], v[208:211], v[100:103]
    s_waitcnt lgkmcnt(2)
    v_cvt_pk_bf16_f32 v231, v232, v233
    v_cvt_pk_bf16_f32 v232, v234, v235
    v_accvgpr_read_b32 v236, a2
    v_accvgpr_read_b32 v237, a6
    v_accvgpr_read_b32 v238, a10
    v_mfma_f32_16x16x32_bf16 v[160:163], v[32:35], v[192:195], v[160:163]
    ds_read_b128 v[24:27], v2 offset:12288
    v_accvgpr_read_b32 v239, a14
    v_mfma_f32_16x16x32_bf16 v[160:163], v[36:39], v[196:199], v[160:163]
    buffer_store_dwordx3 v[230:232], v56, s[12:15], s24 offen offset:384 sc0 sc1
    v_accvgpr_read_b32 v240, a18
    v_accvgpr_read_b32 v241, a22
    v_mfma_f32_16x16x32_bf16 v[164:167], v[36:39], v[220:223], v[164:167]
    ds_read_b128 v[28:31], v3 offset:12288
    v_mul_f32 v236, v236, v50
    v_mfma_f32_16x16x32_bf16 v[164:167], v[32:35], v[216:219], v[164:167]
    s_waitcnt lgkmcnt(2)
    v_mul_f32 v237, v237, v50
    v_mul_f32 v238, v238, v50
    v_mul_f32 v239, v239, v50
    v_mul_f32 v240, v240, v50
    v_mul_f32 v241, v241, v50
    v_mfma_f32_16x16x32_bf16 v[96:99], v[40:43], v[192:195], v[96:99]
    ds_read_b128 v[32:35], v2 offset:18432
    v_cvt_pk_bf16_f32 v236, v236, v237
    v_mfma_f32_16x16x32_bf16 v[96:99], v[44:47], v[196:199], v[96:99]
    v_cvt_pk_bf16_f32 v237, v238, v239
    v_cvt_pk_bf16_f32 v238, v240, v241
    v_accvgpr_read_b32 v242, a3
    v_accvgpr_read_b32 v243, a7
    v_accvgpr_read_b32 v244, a11
    v_mfma_f32_16x16x32_bf16 v[100:103], v[44:47], v[220:223], v[100:103]
    ds_read_b128 v[36:39], v3 offset:18432
    v_accvgpr_read_b32 v245, a15
    v_mfma_f32_16x16x32_bf16 v[100:103], v[40:43], v[216:219], v[100:103]
    s_waitcnt lgkmcnt(2)
    buffer_store_dwordx3 v[236:238], v56, s[12:15], s24 offen offset:768 sc0 sc1
    v_accvgpr_read_b32 v246, a19
    v_accvgpr_read_b32 v247, a23
    v_mfma_f32_16x16x32_bf16 v[168:171], v[24:27], a[240:243], v[136:139]
    ds_read_b128 v[40:43], v2 offset:12416
    v_mul_f32 v242, v242, v51
    v_mfma_f32_16x16x32_bf16 v[168:171], v[28:31], a[244:247], v[168:171]
    v_mul_f32 v243, v243, v51
    v_mul_f32 v244, v244, v51
    v_mul_f32 v245, v245, v51
    v_mul_f32 v246, v246, v51
    v_mul_f32 v247, v247, v51
    v_mfma_f32_16x16x32_bf16 v[172:175], v[28:31], v[204:207], v[140:143]
    ds_read_b128 v[44:47], v3 offset:12416
    v_cvt_pk_bf16_f32 v242, v242, v243
    v_mfma_f32_16x16x32_bf16 v[172:175], v[24:27], v[200:203], v[172:175]
    s_waitcnt lgkmcnt(2)
    v_cvt_pk_bf16_f32 v243, v244, v245
    v_cvt_pk_bf16_f32 v244, v246, v247
    v_accvgpr_read_b32 v248, a24
    v_accvgpr_read_b32 v249, a28
    v_accvgpr_read_b32 v250, a32
    v_mfma_f32_16x16x32_bf16 v[104:107], v[32:35], a[240:243], v[136:139]
    ds_read_b128 v[24:27], v2 offset:18560
    v_accvgpr_read_b32 v251, a36
    v_mfma_f32_16x16x32_bf16 v[104:107], v[36:39], a[244:247], v[104:107]
    buffer_store_dwordx3 v[242:244], v56, s[12:15], s24 offen offset:1152 sc0 sc1
    v_accvgpr_read_b32 v252, a40
    v_accvgpr_read_b32 v253, a44
    v_mfma_f32_16x16x32_bf16 v[108:111], v[36:39], v[204:207], v[140:143]
    ds_read_b128 v[28:31], v3 offset:18560
    v_mul_f32 v248, v248, v48
    v_mfma_f32_16x16x32_bf16 v[108:111], v[32:35], v[200:203], v[108:111]
    s_waitcnt lgkmcnt(2)
    v_mul_f32 v249, v249, v48
    v_mul_f32 v250, v250, v48
    v_mul_f32 v251, v251, v48
    v_mul_f32 v252, v252, v48
    v_mul_f32 v253, v253, v48
    v_mfma_f32_16x16x32_bf16 v[168:171], v[40:43], a[248:251], v[168:171]
    ds_read_b128 v[32:35], v2 offset:12544
    v_cvt_pk_bf16_f32 v248, v248, v249
    v_mfma_f32_16x16x32_bf16 v[168:171], v[44:47], a[252:255], v[168:171]
    v_cvt_pk_bf16_f32 v249, v250, v251
    v_cvt_pk_bf16_f32 v250, v252, v253
    v_accvgpr_read_b32 v224, a25
    v_accvgpr_read_b32 v225, a29
    v_accvgpr_read_b32 v226, a33
    v_mfma_f32_16x16x32_bf16 v[172:175], v[44:47], v[212:215], v[172:175]
    ds_read_b128 v[36:39], v3 offset:12544
    v_accvgpr_read_b32 v227, a37
    v_mfma_f32_16x16x32_bf16 v[172:175], v[40:43], v[208:211], v[172:175]
    s_waitcnt lgkmcnt(2)
    buffer_store_dwordx3 v[248:250], v56, s[12:15], s24 offen offset:192 sc0 sc1
    v_accvgpr_read_b32 v228, a41
    v_mfma_f32_16x16x32_bf16 v[104:107], v[24:27], a[248:251], v[104:107]
    ds_read_b128 v[40:43], v2 offset:18688
    v_accvgpr_read_b32 v229, a45
    v_mfma_f32_16x16x32_bf16 v[104:107], v[28:31], a[252:255], v[104:107]
    v_mul_f32 v224, v224, v49
    v_mul_f32 v225, v225, v49
    v_mul_f32 v226, v226, v49
    v_mul_f32 v227, v227, v49
    v_mul_f32 v228, v228, v49
    v_mul_f32 v229, v229, v49
    v_mfma_f32_16x16x32_bf16 v[108:111], v[28:31], v[212:215], v[108:111]
    ds_read_b128 v[44:47], v3 offset:18688
    v_cvt_pk_bf16_f32 v224, v224, v225
    v_mfma_f32_16x16x32_bf16 v[108:111], v[24:27], v[208:211], v[108:111]
    s_waitcnt lgkmcnt(2)
    v_add_u32 v2, 49152, v2
    v_add_u32 v3, 49152, v3
    v_exp_f32 v16, v160
    v_cvt_pk_bf16_f32 v225, v226, v227
    v_mfma_f32_16x16x32_bf16 v[168:171], v[32:35], v[192:195], v[168:171]
    ds_read_b128 v[24:27], v2 offset:0
    v_cvt_pk_bf16_f32 v226, v228, v229
    v_mfma_f32_16x16x32_bf16 v[168:171], v[36:39], v[196:199], v[168:171]
    buffer_store_dwordx3 v[224:226], v56, s[12:15], s24 offen offset:576 sc0 sc1
    v_accvgpr_read_b32 v230, a26
    v_mfma_f32_16x16x32_bf16 v[172:175], v[36:39], v[220:223], v[172:175]
    ds_read_b128 v[28:31], v3 offset:0
    v_accvgpr_read_b32 v231, a30
    v_mfma_f32_16x16x32_bf16 v[172:175], v[32:35], v[216:219], v[172:175]
    s_waitcnt lgkmcnt(2)
    v_exp_f32 v17, v161
    v_exp_f32 v18, v162
    v_exp_f32 v19, v163
    v_mfma_f32_16x16x32_bf16 v[104:107], v[40:43], v[192:195], v[104:107]
    ds_read_b128 v[32:35], v2 offset:6144
    v_accvgpr_read_b32 v232, a34
    v_mfma_f32_16x16x32_bf16 v[104:107], v[44:47], v[196:199], v[104:107]
    v_cvt_pk_bf16_f32 v160, v16, v17
    v_accvgpr_read_b32 v233, a38
    v_accvgpr_read_b32 v234, a42
    v_exp_f32 v16, v96
    v_mfma_f32_16x16x32_bf16 v[108:111], v[44:47], v[220:223], v[108:111]
    ds_read_b128 v[36:39], v3 offset:6144
    v_accvgpr_read_b32 v235, a46
    v_mfma_f32_16x16x32_bf16 v[108:111], v[40:43], v[216:219], v[108:111]
    s_waitcnt lgkmcnt(2)
    v_mul_f32 v230, v230, v50
    v_exp_f32 v17, v97
    v_mul_f32 v231, v231, v50
    v_mul_f32 v232, v232, v50
    v_mfma_f32_16x16x32_bf16 v[176:179], v[24:27], a[240:243], v[136:139]
    ds_read_b128 v[40:43], v2 offset:128
    v_cvt_pk_bf16_f32 v161, v18, v19
    v_mfma_f32_16x16x32_bf16 v[176:179], v[28:31], a[244:247], v[176:179]
    v_mul_f32 v233, v233, v50
    v_exp_f32 v18, v98
    v_mul_f32 v234, v234, v50
    v_mul_f32 v235, v235, v50
    v_cvt_pk_bf16_f32 v230, v230, v231
    v_mfma_f32_16x16x32_bf16 v[180:183], v[28:31], v[204:207], v[140:143]
    ds_read_b128 v[44:47], v3 offset:128
    v_cvt_pk_bf16_f32 v231, v232, v233
    v_mfma_f32_16x16x32_bf16 v[180:183], v[24:27], v[200:203], v[180:183]
    s_waitcnt lgkmcnt(2)
    v_exp_f32 v19, v99
    v_cvt_pk_bf16_f32 v232, v234, v235
    v_accvgpr_read_b32 v236, a27
    v_cvt_pk_bf16_f32 v162, v16, v17
    v_mfma_f32_16x16x32_bf16 v[112:115], v[32:35], a[240:243], v[136:139]
    ds_read_b128 v[24:27], v2 offset:6272
    v_accvgpr_read_b32 v237, a31
    v_mfma_f32_16x16x32_bf16 v[112:115], v[36:39], a[244:247], v[112:115]
    buffer_store_dwordx3 v[230:232], v56, s[12:15], s24 offen offset:960 sc0 sc1
    v_accvgpr_read_b32 v238, a35
    v_mfma_f32_16x16x32_bf16 v[116:119], v[36:39], v[204:207], v[140:143]
    ds_read_b128 v[28:31], v3 offset:6272
    v_accvgpr_read_b32 v239, a39
    v_mfma_f32_16x16x32_bf16 v[116:119], v[32:35], v[200:203], v[116:119]
    s_waitcnt lgkmcnt(2)
    v_exp_f32 v16, v164
    v_exp_f32 v17, v165
    v_accvgpr_read_b32 v240, a43
    v_accvgpr_read_b32 v241, a47
    v_mfma_f32_16x16x32_bf16 v[176:179], v[40:43], a[248:251], v[176:179]
    ds_read_b128 v[32:35], v2 offset:256
    v_cvt_pk_bf16_f32 v163, v18, v19
    v_mfma_f32_16x16x32_bf16 v[176:179], v[44:47], a[252:255], v[176:179]
    v_exp_f32 v18, v166
    v_mul_f32 v236, v236, v51
    v_mul_f32 v237, v237, v51
    v_mul_f32 v238, v238, v51
    v_mfma_f32_16x16x32_bf16 v[180:183], v[44:47], v[212:215], v[180:183]
    ds_read_b128 v[36:39], v3 offset:256
    v_mul_f32 v239, v239, v51
    v_mfma_f32_16x16x32_bf16 v[180:183], v[40:43], v[208:211], v[180:183]
    s_waitcnt lgkmcnt(2)
    v_exp_f32 v19, v167
    v_mul_f32 v240, v240, v51
    v_mul_f32 v241, v241, v51
    v_cvt_pk_bf16_f32 v236, v236, v237
    v_mfma_f32_16x16x32_bf16 v[112:115], v[24:27], a[248:251], v[112:115]
    ds_read_b128 v[40:43], v2 offset:6400
    v_cvt_pk_bf16_f32 v237, v238, v239
    v_mfma_f32_16x16x32_bf16 v[112:115], v[28:31], a[252:255], v[112:115]
    v_mfma_f32_16x16x32_bf16 v[128:131], v[160:163], v[20:23], v[128:131]
    v_cvt_pk_bf16_f32 v164, v16, v17
    v_cvt_pk_bf16_f32 v238, v240, v241
    v_accvgpr_read_b32 v242, a48
    v_mfma_f32_16x16x32_bf16 v[116:119], v[28:31], v[212:215], v[116:119]
    ds_read_b128 v[44:47], v3 offset:6400
    v_accvgpr_read_b32 v243, a52
    v_mfma_f32_16x16x32_bf16 v[116:119], v[24:27], v[208:211], v[116:119]
    s_waitcnt lgkmcnt(2)
    buffer_store_dwordx3 v[236:238], v56, s[12:15], s24 offen offset:1344 sc0 sc1
    v_exp_f32 v16, v100
    v_mfma_f32_16x16x32_bf16 v[176:179], v[32:35], v[192:195], v[176:179]
    ds_read_b128 v[24:27], v2 offset:12288
    v_accvgpr_read_b32 v244, a56
    v_mfma_f32_16x16x32_bf16 v[176:179], v[36:39], v[196:199], v[176:179]
    v_exp_f32 v17, v101
    v_accvgpr_read_b32 v245, a60
    v_cvt_pk_bf16_f32 v165, v18, v19
    v_accvgpr_read_b32 v246, a64
    v_mfma_f32_16x16x32_bf16 v[180:183], v[36:39], v[220:223], v[180:183]
    ds_read_b128 v[28:31], v3 offset:12288
    v_accvgpr_read_b32 v247, a68
    v_mfma_f32_16x16x32_bf16 v[180:183], v[32:35], v[216:219], v[180:183]
    s_waitcnt lgkmcnt(2)
    v_exp_f32 v18, v102
    v_mul_f32 v242, v242, v52
    v_mul_f32 v243, v243, v52
    v_mul_f32 v244, v244, v52
    v_mfma_f32_16x16x32_bf16 v[112:115], v[40:43], v[192:195], v[112:115]
    ds_read_b128 v[32:35], v2 offset:18432
    v_mul_f32 v245, v245, v52
    v_mfma_f32_16x16x32_bf16 v[112:115], v[44:47], v[196:199], v[112:115]
    v_exp_f32 v19, v103
    v_cvt_pk_bf16_f32 v166, v16, v17
    v_mul_f32 v246, v246, v52
    v_mul_f32 v247, v247, v52
    v_cvt_pk_bf16_f32 v167, v18, v19
    v_mfma_f32_16x16x32_bf16 v[116:119], v[44:47], v[220:223], v[116:119]
    ds_read_b128 v[36:39], v3 offset:18432
    v_cvt_pk_bf16_f32 v242, v242, v243
    v_mfma_f32_16x16x32_bf16 v[116:119], v[40:43], v[216:219], v[116:119]
    s_waitcnt lgkmcnt(2)
    s_nop 1
    v_cvt_pk_bf16_f32 v243, v244, v245
    v_cvt_pk_bf16_f32 v244, v246, v247
    v_accvgpr_read_b32 v248, a49
    v_mfma_f32_16x16x32_bf16 v[184:187], v[24:27], a[240:243], v[136:139]
    ds_read_b128 v[40:43], v2 offset:12416
    v_accvgpr_read_b32 v249, a53
    v_mfma_f32_16x16x32_bf16 v[184:187], v[28:31], a[244:247], v[184:187]
    buffer_store_dwordx3 v[242:244], v56, s[12:15], s40 offen offset:0 sc0 sc1
    v_accvgpr_read_b32 v250, a57
    v_mfma_f32_16x16x32_bf16 v[188:191], v[28:31], v[204:207], v[140:143]
    ds_read_b128 v[44:47], v3 offset:12416
    v_accvgpr_read_b32 v251, a61
    v_mfma_f32_16x16x32_bf16 v[188:191], v[24:27], v[200:203], v[188:191]
    s_waitcnt lgkmcnt(2)
    v_mfma_f32_16x16x32_bf16 v[132:135], v[164:167], v[20:23], v[132:135]
    v_exp_f32 v16, v168
    v_accvgpr_read_b32 v252, a65
    v_accvgpr_read_b32 v253, a69
    v_mfma_f32_16x16x32_bf16 v[120:123], v[32:35], a[240:243], v[136:139]
    ds_read_b128 v[24:27], v2 offset:18560
    v_mul_f32 v248, v248, v53
    v_mfma_f32_16x16x32_bf16 v[120:123], v[36:39], a[244:247], v[120:123]
    v_exp_f32 v17, v169
    v_exp_f32 v18, v170
    v_mul_f32 v249, v249, v53
    v_mfma_f32_16x16x32_bf16 v[124:127], v[36:39], v[204:207], v[140:143]
    ds_read_b128 v[28:31], v3 offset:18560
    v_mul_f32 v250, v250, v53
    v_mfma_f32_16x16x32_bf16 v[124:127], v[32:35], v[200:203], v[124:127]
    s_waitcnt lgkmcnt(2)
    v_exp_f32 v19, v171
    v_mul_f32 v251, v251, v53
    v_mul_f32 v252, v252, v53
    v_mul_f32 v253, v253, v53
    v_mfma_f32_16x16x32_bf16 v[184:187], v[40:43], a[248:251], v[184:187]
    ds_read_b128 v[32:35], v2 offset:12544
    v_cvt_pk_bf16_f32 v168, v16, v17
    v_mfma_f32_16x16x32_bf16 v[184:187], v[44:47], a[252:255], v[184:187]
    v_cvt_pk_bf16_f32 v248, v248, v249
    v_exp_f32 v16, v104
    v_cvt_pk_bf16_f32 v249, v250, v251
    v_cvt_pk_bf16_f32 v250, v252, v253
    v_accvgpr_read_b32 v224, a50
    v_mfma_f32_16x16x32_bf16 v[188:191], v[44:47], v[212:215], v[188:191]
    ds_read_b128 v[36:39], v3 offset:12544
    v_accvgpr_read_b32 v225, a54
    v_mfma_f32_16x16x32_bf16 v[188:191], v[40:43], v[208:211], v[188:191]
    s_waitcnt lgkmcnt(2)
    buffer_store_dwordx3 v[248:250], v56, s[12:15], s40 offen offset:384 sc0 sc1
    v_accvgpr_read_b32 v226, a58
    v_mfma_f32_16x16x32_bf16 v[120:123], v[24:27], a[248:251], v[120:123]
    ds_read_b128 v[40:43], v2 offset:18688
    v_accvgpr_read_b32 v227, a62
    v_mfma_f32_16x16x32_bf16 v[120:123], v[28:31], a[252:255], v[120:123]
    v_exp_f32 v17, v105
    v_cvt_pk_bf16_f32 v169, v18, v19
    v_accvgpr_read_b32 v228, a66
    v_accvgpr_read_b32 v229, a70
    v_mfma_f32_16x16x32_bf16 v[124:127], v[28:31], v[212:215], v[124:127]
    ds_read_b128 v[44:47], v3 offset:18688
    v_mul_f32 v224, v224, v54
    v_mfma_f32_16x16x32_bf16 v[124:127], v[24:27], v[208:211], v[124:127]
    s_waitcnt lgkmcnt(2)
    v_add_u32 v60, 49152, v1
    v_mov_b32 v59, v1
    v_subrev_u32 v1, 49152, v1
    v_exp_f32 v18, v106
    v_mfma_f32_16x16x32_bf16 v[184:187], v[32:35], v[192:195], v[184:187]
    ds_read_b128 v[24:27], v60 offset:0
    v_mul_f32 v225, v225, v54
    v_mfma_f32_16x16x32_bf16 v[184:187], v[36:39], v[196:199], v[184:187]
    v_exp_f32 v19, v107
    v_mul_f32 v226, v226, v54
    v_cvt_pk_bf16_f32 v170, v16, v17
    v_mul_f32 v227, v227, v54
    v_mul_f32 v228, v228, v54
    v_mfma_f32_16x16x32_bf16 v[188:191], v[36:39], v[220:223], v[188:191]
    ds_read_b128 v[28:31], v60 offset:12288
    v_mul_f32 v229, v229, v54
    v_mfma_f32_16x16x32_bf16 v[188:191], v[32:35], v[216:219], v[188:191]
    s_waitcnt lgkmcnt(2)
    v_exp_f32 v16, v172
    v_cvt_pk_bf16_f32 v224, v224, v225
    v_cvt_pk_bf16_f32 v225, v226, v227
    v_cvt_pk_bf16_f32 v226, v228, v229
    v_mfma_f32_16x16x32_bf16 v[120:123], v[40:43], v[192:195], v[120:123]
    ds_read_b128 v[32:35], v60 offset:1024
    v_accvgpr_read_b32 v230, a51
    v_mfma_f32_16x16x32_bf16 v[120:123], v[44:47], v[196:199], v[120:123]
    buffer_store_dwordx3 v[224:226], v56, s[12:15], s40 offen offset:768 sc0 sc1
    v_accvgpr_read_b32 v231, a55
    v_mfma_f32_16x16x32_bf16 v[124:127], v[44:47], v[220:223], v[124:127]
    ds_read_b128 v[36:39], v60 offset:13312
    v_accvgpr_read_b32 v232, a59
    v_mfma_f32_16x16x32_bf16 v[124:127], v[40:43], v[216:219], v[124:127]
    s_waitcnt lgkmcnt(2)
    v_exp_f32 v17, v173
    v_cvt_pk_bf16_f32 v171, v18, v19
    v_exp_f32 v18, v174
    v_accvgpr_read_b32 v233, a63
    v_mfma_f32_16x16x32_bf16 a[96:99], v[80:83], v[24:27], a[96:99]
    ds_read_b128 v[40:43], v60 offset:2048
    v_accvgpr_read_b32 v234, a67
    v_mfma_f32_16x16x32_bf16 a[96:99], v[88:91], v[28:31], a[96:99]
    v_exp_f32 v19, v175
    v_accvgpr_read_b32 v235, a71
    v_mul_f32 v230, v230, v55
    v_mul_f32 v231, v231, v55
    v_mfma_f32_16x16x32_bf16 a[144:147], v[92:95], v[28:31], a[144:147]
    ds_read_b128 v[44:47], v60 offset:14336
    v_mul_f32 v232, v232, v55
    v_mfma_f32_16x16x32_bf16 a[144:147], v[84:87], v[24:27], a[144:147]
    s_waitcnt lgkmcnt(2)
    v_mfma_f32_16x16x32_bf16 v[128:131], v[168:171], v[20:23], v[128:131]
    v_mul_f32 v233, v233, v55
    v_mul_f32 v234, v234, v55
    v_mul_f32 v235, v235, v55
    v_mfma_f32_16x16x32_bf16 a[100:103], v[80:83], v[32:35], a[100:103]
    ds_read_b128 v[24:27], v60 offset:3072
    v_cvt_pk_bf16_f32 v172, v16, v17
    v_mfma_f32_16x16x32_bf16 a[100:103], v[88:91], v[36:39], a[100:103]
    v_exp_f32 v16, v108
    v_cvt_pk_bf16_f32 v230, v230, v231
    v_cvt_pk_bf16_f32 v231, v232, v233
    v_cvt_pk_bf16_f32 v232, v234, v235
    v_accvgpr_read_b32 v236, a72
    v_mfma_f32_16x16x32_bf16 a[148:151], v[92:95], v[36:39], a[148:151]
    ds_read_b128 v[28:31], v60 offset:15360
    v_accvgpr_read_b32 v237, a76
    v_mfma_f32_16x16x32_bf16 a[148:151], v[84:87], v[32:35], a[148:151]
    s_waitcnt lgkmcnt(2)
    buffer_store_dwordx3 v[230:232], v56, s[12:15], s40 offen offset:1152 sc0 sc1
    v_accvgpr_read_b32 v238, a80
    v_mfma_f32_16x16x32_bf16 a[104:107], v[80:83], v[40:43], a[104:107]
    ds_read_b128 v[32:35], v60 offset:4096
    v_accvgpr_read_b32 v239, a84
    v_mfma_f32_16x16x32_bf16 a[104:107], v[88:91], v[44:47], a[104:107]
    v_exp_f32 v17, v109
    v_cvt_pk_bf16_f32 v173, v18, v19
    v_accvgpr_read_b32 v240, a88
    v_accvgpr_read_b32 v241, a92
    v_mfma_f32_16x16x32_bf16 a[152:155], v[92:95], v[44:47], a[152:155]
    ds_read_b128 v[36:39], v60 offset:16384
    v_mul_f32 v236, v236, v52
    v_mfma_f32_16x16x32_bf16 a[152:155], v[84:87], v[40:43], a[152:155]
    s_waitcnt lgkmcnt(2)
    v_exp_f32 v18, v110
    v_mul_f32 v237, v237, v52
    v_mul_f32 v238, v238, v52
    v_mul_f32 v239, v239, v52
    v_mul_f32 v240, v240, v52
    v_mfma_f32_16x16x32_bf16 a[108:111], v[80:83], v[24:27], a[108:111]
    ds_read_b128 v[40:43], v60 offset:5120
    v_mul_f32 v241, v241, v52
    v_mfma_f32_16x16x32_bf16 a[108:111], v[88:91], v[28:31], a[108:111]
    v_exp_f32 v19, v111
    v_cvt_pk_bf16_f32 v236, v236, v237
    v_cvt_pk_bf16_f32 v237, v238, v239
    v_cvt_pk_bf16_f32 v238, v240, v241
    v_mfma_f32_16x16x32_bf16 a[156:159], v[92:95], v[28:31], a[156:159]
    ds_read_b128 v[44:47], v60 offset:17408
    v_cvt_pk_bf16_f32 v174, v16, v17
    v_mfma_f32_16x16x32_bf16 a[156:159], v[84:87], v[24:27], a[156:159]
    s_waitcnt lgkmcnt(2)
    buffer_store_dwordx3 v[236:238], v56, s[12:15], s40 offen offset:192 sc0 sc1
    v_accvgpr_read_b32 v242, a73
    v_mfma_f32_16x16x32_bf16 a[112:115], v[80:83], v[32:35], a[112:115]
    ds_read_b128 v[24:27], v1 offset:0
    v_cvt_pk_bf16_f32 v175, v18, v19
    v_mfma_f32_16x16x32_bf16 a[112:115], v[88:91], v[36:39], a[112:115]
    s_nop 1
    v_accvgpr_read_b32 v243, a77
    v_accvgpr_read_b32 v244, a81
    v_accvgpr_read_b32 v245, a85
    v_accvgpr_read_b32 v246, a89
    v_mfma_f32_16x16x32_bf16 a[160:163], v[92:95], v[36:39], a[160:163]
    ds_read_b128 v[28:31], v1 offset:12288
    v_accvgpr_read_b32 v247, a93
    v_mfma_f32_16x16x32_bf16 a[160:163], v[84:87], v[32:35], a[160:163]
    s_waitcnt lgkmcnt(2)
    v_mul_f32 v242, v242, v53
    v_mfma_f32_16x16x32_bf16 v[132:135], v[172:175], v[20:23], v[132:135]
    v_exp_f32 v16, v176
    v_mul_f32 v243, v243, v53
    v_mfma_f32_16x16x32_bf16 a[116:119], v[80:83], v[40:43], a[116:119]
    ds_read_b128 v[32:35], v1 offset:1024
    v_mul_f32 v244, v244, v53
    v_mfma_f32_16x16x32_bf16 a[116:119], v[88:91], v[44:47], a[116:119]
    v_exp_f32 v17, v177
    v_exp_f32 v18, v178
    v_mul_f32 v245, v245, v53
    v_mfma_f32_16x16x32_bf16 a[164:167], v[92:95], v[44:47], a[164:167]
    ds_read_b128 v[36:39], v1 offset:13312
    v_mul_f32 v246, v246, v53
    v_mfma_f32_16x16x32_bf16 a[164:167], v[84:87], v[40:43], a[164:167]
    s_waitcnt lgkmcnt(2)
    v_exp_f32 v19, v179
    v_cvt_pk_bf16_f32 v176, v16, v17
    v_exp_f32 v16, v112
    v_mfma_f32_16x16x32_bf16 a[96:99], v[160:163], v[24:27], a[96:99]
L_pg13:
    s_cbranch_execz L_iwret
    ds_read_b128 v[40:43], v1 offset:2048
    v_mul_f32 v247, v247, v53
    v_mfma_f32_16x16x32_bf16 a[96:99], v[168:171], v[28:31], a[96:99]
    v_exp_f32 v17, v113
    v_cvt_pk_bf16_f32 v177, v18, v19
    v_exp_f32 v18, v114
    v_cvt_pk_bf16_f32 v242, v242, v243
    v_mfma_f32_16x16x32_bf16 a[144:147], v[172:175], v[28:31], a[144:147]
    ds_read_b128 v[44:47], v1 offset:14336
    v_cvt_pk_bf16_f32 v243, v244, v245
    v_mfma_f32_16x16x32_bf16 a[144:147], v[164:167], v[24:27], a[144:147]
    s_waitcnt lgkmcnt(2)
    v_exp_f32 v19, v115
    v_cvt_pk_bf16_f32 v178, v16, v17
    v_exp_f32 v16, v180
    v_mfma_f32_16x16x32_bf16 a[100:103], v[160:163], v[32:35], a[100:103]
    ds_read_b128 v[24:27], v1 offset:3072
    v_cvt_pk_bf16_f32 v244, v246, v247
    v_mfma_f32_16x16x32_bf16 a[100:103], v[168:171], v[36:39], a[100:103]
    buffer_store_dwordx3 v[242:244], v56, s[12:15], s40 offen offset:576 sc0 sc1
    v_accvgpr_read_b32 v248, a74
    v_mfma_f32_16x16x32_bf16 a[148:151], v[172:175], v[36:39], a[148:151]
    ds_read_b128 v[28:31], v1 offset:15360
    v_accvgpr_read_b32 v249, a78
    v_mfma_f32_16x16x32_bf16 a[148:151], v[164:167], v[32:35], a[148:151]
    s_waitcnt lgkmcnt(2)
    v_exp_f32 v17, v181
    v_cvt_pk_bf16_f32 v179, v18, v19
    v_exp_f32 v18, v182
    v_accvgpr_read_b32 v250, a82
    v_mfma_f32_16x16x32_bf16 a[104:107], v[160:163], v[40:43], a[104:107]
    ds_read_b128 v[32:35], v1 offset:4096
    v_accvgpr_read_b32 v251, a86
    v_mfma_f32_16x16x32_bf16 a[104:107], v[168:171], v[44:47], a[104:107]
    v_exp_f32 v19, v183
    v_mfma_f32_16x16x32_bf16 v[128:131], v[176:179], v[20:23], v[128:131]
    v_cvt_pk_bf16_f32 v180, v16, v17
    v_mfma_f32_16x16x32_bf16 a[152:155], v[172:175], v[44:47], a[152:155]
    ds_read_b128 v[36:39], v1 offset:16384
    v_accvgpr_read_b32 v252, a90
    v_mfma_f32_16x16x32_bf16 a[152:155], v[164:167], v[40:43], a[152:155]
    s_waitcnt lgkmcnt(2)
    v_exp_f32 v16, v116
    v_exp_f32 v17, v117
    v_cvt_pk_bf16_f32 v181, v18, v19
    v_mfma_f32_16x16x32_bf16 a[108:111], v[160:163], v[24:27], a[108:111]
    ds_read_b128 v[40:43], v1 offset:5120
    v_accvgpr_read_b32 v253, a94
    v_mfma_f32_16x16x32_bf16 a[108:111], v[168:171], v[28:31], a[108:111]
    v_exp_f32 v18, v118
    v_exp_f32 v19, v119
    v_cvt_pk_bf16_f32 v182, v16, v17
    v_cvt_pk_bf16_f32 v183, v18, v19
    v_mfma_f32_16x16x32_bf16 a[156:159], v[172:175], v[28:31], a[156:159]
    s_nop 1
    ds_read_b128 v[44:47], v1 offset:17408
    v_mfma_f32_16x16x32_bf16 a[156:159], v[164:167], v[24:27], a[156:159]
    s_waitcnt lgkmcnt(2)
    v_mfma_f32_16x16x32_bf16 v[132:135], v[180:183], v[20:23], v[132:135]
    v_exp_f32 v16, v184
    v_mul_f32 v248, v248, v54
    v_mfma_f32_16x16x32_bf16 a[112:115], v[160:163], v[32:35], a[112:115]
    ds_read_b128 v[24:27], v59 offset:0
    v_mul_f32 v249, v249, v54
    v_mfma_f32_16x16x32_bf16 a[112:115], v[168:171], v[36:39], a[112:115]
    v_exp_f32 v17, v185
    v_exp_f32 v18, v186
    v_mul_f32 v250, v250, v54
    v_mfma_f32_16x16x32_bf16 a[160:163], v[172:175], v[36:39], a[160:163]
    ds_read_b128 v[28:31], v59 offset:12288
    v_mul_f32 v251, v251, v54
    v_mfma_f32_16x16x32_bf16 a[160:163], v[164:167], v[32:35], a[160:163]
    s_waitcnt lgkmcnt(2)
    v_exp_f32 v19, v187
    v_cvt_pk_bf16_f32 v184, v16, v17
    v_exp_f32 v16, v120
    v_exp_f32 v17, v121
    v_cvt_pk_bf16_f32 v185, v18, v19
    v_exp_f32 v18, v122
    v_exp_f32 v19, v123
    v_cvt_pk_bf16_f32 v186, v16, v17
    v_exp_f32 v16, v188
    v_exp_f32 v17, v189
    v_cvt_pk_bf16_f32 v187, v18, v19
    v_exp_f32 v18, v190
    v_exp_f32 v19, v191
    v_mfma_f32_16x16x32_bf16 v[128:131], v[184:187], v[20:23], v[128:131]
    v_cvt_pk_bf16_f32 v188, v16, v17
    v_exp_f32 v16, v124
    v_exp_f32 v17, v125
    v_cvt_pk_bf16_f32 v189, v18, v19
    v_exp_f32 v18, v126
    v_exp_f32 v19, v127
    v_cvt_pk_bf16_f32 v190, v16, v17
    v_cvt_pk_bf16_f32 v191, v18, v19
    s_nop 1
    v_mfma_f32_16x16x32_bf16 v[132:135], v[188:191], v[20:23], v[132:135]
    v_mfma_f32_16x16x32_bf16 a[116:119], v[160:163], v[40:43], a[116:119]
    ds_read_b128 v[32:35], v59 offset:1024
    v_mul_f32 v252, v252, v54
    v_mfma_f32_16x16x32_bf16 a[116:119], v[168:171], v[44:47], a[116:119]
    v_mul_f32 v253, v253, v54
    v_cvt_pk_bf16_f32 v248, v248, v249
    v_cvt_pk_bf16_f32 v249, v250, v251
    v_cvt_pk_bf16_f32 v250, v252, v253
    v_accvgpr_read_b32 v224, a75
    v_mfma_f32_16x16x32_bf16 a[164:167], v[172:175], v[44:47], a[164:167]
    ds_read_b128 v[36:39], v59 offset:13312
    v_accvgpr_read_b32 v225, a79
    v_mfma_f32_16x16x32_bf16 a[164:167], v[164:167], v[40:43], a[164:167]
    s_waitcnt lgkmcnt(2)
    buffer_store_dwordx3 v[248:250], v56, s[12:15], s40 offen offset:960 sc0 sc1
    v_accvgpr_read_b32 v226, a83
    v_accvgpr_read_b32 v227, a87
    v_mfma_f32_16x16x4_f32 v[128:131], v7, v57, v[128:131]
    v_mfma_f32_16x16x32_bf16 a[96:99], v[176:179], v[24:27], a[96:99]
    ds_read_b128 v[40:43], v59 offset:2048
    v_accvgpr_read_b32 v228, a91
    v_mfma_f32_16x16x32_bf16 a[96:99], v[184:187], v[28:31], a[96:99]
    v_accvgpr_read_b32 v229, a95
    v_mul_f32 v224, v224, v55
    v_mul_f32 v225, v225, v55
    v_mul_f32 v226, v226, v55
    v_mul_f32 v227, v227, v55
    v_mul_f32 v228, v228, v55
    v_mfma_f32_16x16x4_f32 v[132:135], v8, v57, v[132:135]
    v_mfma_f32_16x16x32_bf16 a[144:147], v[188:191], v[28:31], a[144:147]
    ds_read_b128 v[44:47], v59 offset:14336
    v_mul_f32 v229, v229, v55
    v_mfma_f32_16x16x32_bf16 a[144:147], v[180:183], v[24:27], a[144:147]
    s_waitcnt lgkmcnt(2)
    v_cvt_pk_bf16_f32 v224, v224, v225
    v_cvt_pk_bf16_f32 v225, v226, v227
    v_cvt_pk_bf16_f32 v226, v228, v229
    v_mfma_f32_16x16x32_bf16 a[100:103], v[176:179], v[32:35], a[100:103]
    ds_read_b128 v[24:27], v59 offset:3072
    v_mfma_f32_16x16x32_bf16 a[100:103], v[184:187], v[36:39], a[100:103]
    buffer_store_dwordx3 v[224:226], v56, s[12:15], s40 offen offset:1344 sc0 sc1
    v_mfma_f32_16x16x32_bf16 a[148:151], v[188:191], v[36:39], a[148:151]
    ds_read_b128 v[28:31], v59 offset:15360
    v_max3_f32 v18, v5, v6, v128
    v_mfma_f32_16x16x32_bf16 a[148:151], v[180:183], v[32:35], a[148:151]
    s_waitcnt lgkmcnt(2)
    v_max3_f32 v18, v18, v129, v130
    v_max3_f32 v18, v18, v131, v132
    v_max3_f32 v18, v18, v133, v134
    v_max_f32 v18, v18, v135
    s_mov_b32 s29, 0x5f800000
    v_cmp_lt_f32 s[48:49], s29, v18
    v_rcp_f32 v128, v128
    v_mfma_f32_16x16x32_bf16 a[104:107], v[176:179], v[40:43], a[104:107]
    ds_read_b128 v[32:35], v59 offset:4096
    v_mfma_f32_16x16x32_bf16 a[104:107], v[184:187], v[44:47], a[104:107]
    v_rcp_f32 v129, v129
    v_rcp_f32 v130, v130
    v_rcp_f32 v131, v131
    v_mfma_f32_16x16x32_bf16 a[152:155], v[188:191], v[44:47], a[152:155]
    ds_read_b128 v[36:39], v59 offset:16384
    v_mfma_f32_16x16x32_bf16 a[152:155], v[180:183], v[40:43], a[152:155]
    s_waitcnt lgkmcnt(2)
    v_rcp_f32 v132, v132
    v_rcp_f32 v133, v133
    v_mfma_f32_16x16x32_bf16 a[108:111], v[176:179], v[24:27], a[108:111]
    ds_read_b128 v[40:43], v59 offset:5120
    v_mfma_f32_16x16x32_bf16 a[108:111], v[184:187], v[28:31], a[108:111]
    v_rcp_f32 v134, v134
    v_rcp_f32 v135, v135
    v_mfma_f32_16x16x32_bf16 a[156:159], v[188:191], v[28:31], a[156:159]
    ds_read_b128 v[44:47], v59 offset:17408
    v_mfma_f32_16x16x32_bf16 a[156:159], v[180:183], v[24:27], a[156:159]
    s_waitcnt lgkmcnt(2)
    v_mfma_f32_16x16x32_bf16 a[112:115], v[176:179], v[32:35], a[112:115]
    ds_read_b128 v[24:27], v60 offset:6144
    v_mfma_f32_16x16x32_bf16 a[112:115], v[184:187], v[36:39], a[112:115]
    v_mfma_f32_16x16x32_bf16 a[160:163], v[188:191], v[36:39], a[160:163]
    ds_read_b128 v[28:31], v60 offset:18432
    v_mfma_f32_16x16x32_bf16 a[160:163], v[180:183], v[32:35], a[160:163]
    s_waitcnt lgkmcnt(2)
    s_cmp_lg_u64 s[48:49], 0
    s_cbranch_scc1 L_slow
    v_mfma_f32_16x16x32_bf16 a[116:119], v[176:179], v[40:43], a[116:119]
    ds_read_b128 v[32:35], v60 offset:7168
    v_mfma_f32_16x16x32_bf16 a[116:119], v[184:187], v[44:47], a[116:119]
    v_mfma_f32_16x16x32_bf16 a[164:167], v[188:191], v[44:47], a[164:167]
    ds_read_b128 v[36:39], v60 offset:19456
    v_mfma_f32_16x16x32_bf16 a[164:167], v[180:183], v[40:43], a[164:167]
    s_waitcnt lgkmcnt(2)
    v_mfma_f32_16x16x32_bf16 a[120:123], v[80:83], v[24:27], a[120:123]
    ds_read_b128 v[40:43], v60 offset:8192
    v_mfma_f32_16x16x32_bf16 a[120:123], v[88:91], v[28:31], a[120:123]
    v_mfma_f32_16x16x32_bf16 a[168:171], v[92:95], v[28:31], a[168:171]
    ds_read_b128 v[44:47], v60 offset:20480
    v_mfma_f32_16x16x32_bf16 a[168:171], v[84:87], v[24:27], a[168:171]
    s_waitcnt lgkmcnt(2)
    v_mfma_f32_16x16x32_bf16 a[124:127], v[80:83], v[32:35], a[124:127]
    ds_read_b128 v[24:27], v1 offset:6144
    v_accvgpr_read_b32 v230, a96
    v_mfma_f32_16x16x32_bf16 a[124:127], v[88:91], v[36:39], a[124:127]
    v_accvgpr_read_b32 v231, a100
    v_accvgpr_read_b32 v232, a104
    v_accvgpr_read_b32 v233, a108
    v_accvgpr_read_b32 v234, a112
    v_accvgpr_read_b32 v235, a116
    v_mul_f32 v230, v230, v128
    v_mul_f32 v231, v231, v128
    v_mul_f32 v232, v232, v128
    v_mul_f32 v233, v233, v128
    v_mul_f32 v234, v234, v128
    v_mul_f32 v235, v235, v128
    v_cvt_pk_bf16_f32 v230, v230, v231
    v_cvt_pk_bf16_f32 v231, v232, v233
    v_cvt_pk_bf16_f32 v232, v234, v235
    v_accvgpr_read_b32 v236, a97
    v_accvgpr_read_b32 v237, a101
    v_accvgpr_read_b32 v238, a105
    v_accvgpr_read_b32 v239, a109
    v_accvgpr_read_b32 v240, a113
    v_accvgpr_read_b32 v241, a117
    v_mul_f32 v236, v236, v129
    v_mul_f32 v237, v237, v129
    v_mul_f32 v238, v238, v129
    v_mul_f32 v239, v239, v129
    v_mul_f32 v240, v240, v129
    v_mul_f32 v241, v241, v129
    v_cvt_pk_bf16_f32 v236, v236, v237
    v_cvt_pk_bf16_f32 v237, v238, v239
    v_cvt_pk_bf16_f32 v238, v240, v241
    v_accvgpr_read_b32 v242, a98
    v_mfma_f32_16x16x32_bf16 a[172:175], v[92:95], v[36:39], a[172:175]
    ds_read_b128 v[28:31], v1 offset:18432
    v_accvgpr_read_b32 v243, a102
    v_mfma_f32_16x16x32_bf16 a[172:175], v[84:87], v[32:35], a[172:175]
    s_waitcnt lgkmcnt(2)
    buffer_store_dwordx3 v[230:232], v56, s[12:15], s41 offen offset:0 sc0 sc1
    v_accvgpr_read_b32 v244, a106
    v_mfma_f32_16x16x32_bf16 a[128:131], v[80:83], v[40:43], a[128:131]
    ds_read_b128 v[32:35], v1 offset:7168
    v_accvgpr_read_b32 v245, a110
    v_mfma_f32_16x16x32_bf16 a[128:131], v[88:91], v[44:47], a[128:131]
    buffer_store_dwordx3 v[236:238], v56, s[12:15], s41 offen offset:384 sc0 sc1
    v_accvgpr_read_b32 v246, a114
    v_mfma_f32_16x16x32_bf16 a[176:179], v[92:95], v[44:47], a[176:179]
    ds_read_b128 v[36:39], v1 offset:19456
    v_accvgpr_read_b32 v247, a118
    v_mfma_f32_16x16x32_bf16 a[176:179], v[84:87], v[40:43], a[176:179]
    s_waitcnt lgkmcnt(2)
    v_mul_f32 v242, v242, v130
    v_mul_f32 v243, v243, v130
    v_mul_f32 v244, v244, v130
    v_mul_f32 v245, v245, v130
    v_mul_f32 v246, v246, v130
    v_mul_f32 v247, v247, v130
    v_mfma_f32_16x16x32_bf16 a[120:123], v[160:163], v[24:27], a[120:123]
    ds_read_b128 v[40:43], v1 offset:8192
    v_cvt_pk_bf16_f32 v242, v242, v243
    v_mfma_f32_16x16x32_bf16 a[120:123], v[168:171], v[28:31], a[120:123]
    v_cvt_pk_bf16_f32 v243, v244, v245
    v_cvt_pk_bf16_f32 v244, v246, v247
    v_accvgpr_read_b32 v248, a99
    v_accvgpr_read_b32 v249, a103
    v_accvgpr_read_b32 v250, a107
    v_mfma_f32_16x16x32_bf16 a[168:171], v[172:175], v[28:31], a[168:171]
    ds_read_b128 v[44:47], v1 offset:20480
    v_accvgpr_read_b32 v251, a111
    v_mfma_f32_16x16x32_bf16 a[168:171], v[164:167], v[24:27], a[168:171]
    s_waitcnt lgkmcnt(2)
    buffer_store_dwordx3 v[242:244], v56, s[12:15], s41 offen offset:768 sc0 sc1
    v_accvgpr_read_b32 v252, a115
    v_mfma_f32_16x16x32_bf16 a[124:127], v[160:163], v[32:35], a[124:127]
    ds_read_b128 v[24:27], v59 offset:6144
    v_accvgpr_read_b32 v253, a119
    v_mfma_f32_16x16x32_bf16 a[124:127], v[168:171], v[36:39], a[124:127]
    v_mul_f32 v248, v248, v131
    v_mul_f32 v249, v249, v131
    v_mul_f32 v250, v250, v131
    v_mul_f32 v251, v251, v131
    v_mul_f32 v252, v252, v131
    v_mul_f32 v253, v253, v131
    v_mfma_f32_16x16x32_bf16 a[172:175], v[172:175], v[36:39], a[172:175]
    ds_read_b128 v[28:31], v59 offset:18432
    v_cvt_pk_bf16_f32 v248, v248, v249
    v_mfma_f32_16x16x32_bf16 a[172:175], v[164:167], v[32:35], a[172:175]
    s_waitcnt lgkmcnt(2)
    v_cvt_pk_bf16_f32 v249, v250, v251
    v_cvt_pk_bf16_f32 v250, v252, v253
    v_accvgpr_read_b32 v224, a144
    v_accvgpr_read_b32 v225, a148
    v_accvgpr_read_b32 v226, a152
    v_mfma_f32_16x16x32_bf16 a[128:131], v[160:163], v[40:43], a[128:131]
    ds_read_b128 v[32:35], v59 offset:7168
    v_accvgpr_read_b32 v227, a156
    v_mfma_f32_16x16x32_bf16 a[128:131], v[168:171], v[44:47], a[128:131]
    buffer_store_dwordx3 v[248:250], v56, s[12:15], s41 offen offset:1152 sc0 sc1
    v_accvgpr_read_b32 v228, a160
    v_mfma_f32_16x16x32_bf16 a[176:179], v[172:175], v[44:47], a[176:179]
    ds_read_b128 v[36:39], v59 offset:19456
    v_accvgpr_read_b32 v229, a164
    v_mfma_f32_16x16x32_bf16 a[176:179], v[164:167], v[40:43], a[176:179]
    s_waitcnt lgkmcnt(2)
    v_mul_f32 v224, v224, v132
    v_mul_f32 v225, v225, v132
    v_mul_f32 v226, v226, v132
    v_mul_f32 v227, v227, v132
    v_mul_f32 v228, v228, v132
    v_mul_f32 v229, v229, v132
    v_mfma_f32_16x16x32_bf16 a[120:123], v[176:179], v[24:27], a[120:123]
    ds_read_b128 v[40:43], v59 offset:8192
    v_cvt_pk_bf16_f32 v224, v224, v225
    v_mfma_f32_16x16x32_bf16 a[120:123], v[184:187], v[28:31], a[120:123]
    v_cvt_pk_bf16_f32 v225, v226, v227
    v_cvt_pk_bf16_f32 v226, v228, v229
    v_accvgpr_read_b32 v230, a145
    v_accvgpr_read_b32 v231, a149
    v_accvgpr_read_b32 v232, a153
    v_mfma_f32_16x16x32_bf16 a[168:171], v[188:191], v[28:31], a[168:171]
    ds_read_b128 v[44:47], v59 offset:20480
    v_accvgpr_read_b32 v233, a157
    v_mfma_f32_16x16x32_bf16 a[168:171], v[180:183], v[24:27], a[168:171]
    s_waitcnt lgkmcnt(2)
    buffer_store_dwordx3 v[224:226], v56, s[12:15], s42 offen offset:0 sc0 sc1
    v_accvgpr_read_b32 v234, a161
    v_mfma_f32_16x16x32_bf16 a[124:127], v[176:179], v[32:35], a[124:127]
    ds_read_b128 v[24:27], v60 offset:9216
    v_accvgpr_read_b32 v235, a165
    v_mfma_f32_16x16x32_bf16 a[124:127], v[184:187], v[36:39], a[124:127]
    v_mul_f32 v230, v230, v133
    v_mul_f32 v231, v231, v133
    v_mul_f32 v232, v232, v133
    v_mul_f32 v233, v233, v133
    v_mul_f32 v234, v234, v133
    v_mul_f32 v235, v235, v133
    v_mfma_f32_16x16x32_bf16 a[172:175], v[188:191], v[36:39], a[172:175]
    ds_read_b128 v[28:31], v60 offset:21504
    v_cvt_pk_bf16_f32 v230, v230, v231
    v_mfma_f32_16x16x32_bf16 a[172:175], v[180:183], v[32:35], a[172:175]
    s_waitcnt lgkmcnt(2)
    v_cvt_pk_bf16_f32 v231, v232, v233
    v_cvt_pk_bf16_f32 v232, v234, v235
    v_accvgpr_read_b32 v236, a146
    v_accvgpr_read_b32 v237, a150
    v_accvgpr_read_b32 v238, a154
    v_mfma_f32_16x16x32_bf16 a[128:131], v[176:179], v[40:43], a[128:131]
    ds_read_b128 v[32:35], v60 offset:10240
    v_accvgpr_read_b32 v239, a158
    v_mfma_f32_16x16x32_bf16 a[128:131], v[184:187], v[44:47], a[128:131]
    buffer_store_dwordx3 v[230:232], v56, s[12:15], s42 offen offset:384 sc0 sc1
    v_accvgpr_read_b32 v240, a162
    v_mfma_f32_16x16x32_bf16 a[176:179], v[188:191], v[44:47], a[176:179]
    ds_read_b128 v[36:39], v60 offset:22528
    v_accvgpr_read_b32 v241, a166
    v_mfma_f32_16x16x32_bf16 a[176:179], v[180:183], v[40:43], a[176:179]
    s_waitcnt lgkmcnt(2)
    v_mul_f32 v236, v236, v134
    v_mul_f32 v237, v237, v134
    v_mul_f32 v238, v238, v134
    v_mul_f32 v239, v239, v134
    v_mul_f32 v240, v240, v134
    v_mfma_f32_16x16x32_bf16 a[132:135], v[80:83], v[24:27], a[132:135]
    ds_read_b128 v[40:43], v60 offset:11264
    v_mul_f32 v241, v241, v134
    v_mfma_f32_16x16x32_bf16 a[132:135], v[88:91], v[28:31], a[132:135]
    v_cvt_pk_bf16_f32 v236, v236, v237
    v_cvt_pk_bf16_f32 v237, v238, v239
    v_cvt_pk_bf16_f32 v238, v240, v241
    v_accvgpr_read_b32 v242, a147
    v_accvgpr_read_b32 v243, a151
    v_accvgpr_read_b32 v244, a155
    v_mfma_f32_16x16x32_bf16 a[180:183], v[92:95], v[28:31], a[180:183]
    ds_read_b128 v[44:47], v60 offset:23552
    v_accvgpr_read_b32 v245, a159
    v_mfma_f32_16x16x32_bf16 a[180:183], v[84:87], v[24:27], a[180:183]
    s_waitcnt lgkmcnt(2)
    buffer_store_dwordx3 v[236:238], v56, s[12:15], s42 offen offset:768 sc0 sc1
    v_accvgpr_read_b32 v246, a163
    v_mfma_f32_16x16x32_bf16 a[136:139], v[80:83], v[32:35], a[136:139]
    ds_read_b128 v[24:27], v1 offset:9216
    v_accvgpr_read_b32 v96, a120
    v_mfma_f32_16x16x32_bf16 a[136:139], v[88:91], v[36:39], a[136:139]
    v_accvgpr_read_b32 v97, a124
    v_accvgpr_read_b32 v98, a128
    v_mul_f32 v96, v96, v128
    v_mul_f32 v97, v97, v128
    v_mul_f32 v98, v98, v128
    v_mfma_f32_16x16x32_bf16 a[184:187], v[92:95], v[36:39], a[184:187]
    ds_read_b128 v[28:31], v1 offset:21504
    v_accvgpr_read_b32 v102, a121
    v_mfma_f32_16x16x32_bf16 a[184:187], v[84:87], v[32:35], a[184:187]
    s_waitcnt lgkmcnt(2)
    v_accvgpr_read_b32 v103, a125
    v_accvgpr_read_b32 v104, a129
    v_mul_f32 v102, v102, v129
    v_mul_f32 v103, v103, v129
    v_mul_f32 v104, v104, v129
    v_accvgpr_read_b32 v108, a122
    v_mfma_f32_16x16x32_bf16 a[140:143], v[80:83], v[40:43], a[140:143]
    ds_read_b128 v[32:35], v1 offset:10240
    v_accvgpr_read_b32 v109, a126
    v_mfma_f32_16x16x32_bf16 a[140:143], v[88:91], v[44:47], a[140:143]
    v_accvgpr_read_b32 v110, a130
    v_mul_f32 v108, v108, v130
    v_mul_f32 v109, v109, v130
    v_mul_f32 v110, v110, v130
    v_accvgpr_read_b32 v114, a123
    v_mfma_f32_16x16x32_bf16 a[188:191], v[92:95], v[44:47], a[188:191]
    ds_read_b128 v[36:39], v1 offset:22528
    v_accvgpr_read_b32 v115, a127
    v_mfma_f32_16x16x32_bf16 a[188:191], v[84:87], v[40:43], a[188:191]
    s_waitcnt lgkmcnt(2)
    v_accvgpr_read_b32 v116, a131
    v_mul_f32 v114, v114, v131
    v_mul_f32 v115, v115, v131
    v_mul_f32 v116, v116, v131
    v_accvgpr_read_b32 v120, a168
    v_mfma_f32_16x16x32_bf16 a[132:135], v[160:163], v[24:27], a[132:135]
    ds_read_b128 v[40:43], v1 offset:11264
    v_accvgpr_read_b32 v121, a172
    v_mfma_f32_16x16x32_bf16 a[132:135], v[168:171], v[28:31], a[132:135]
    v_accvgpr_read_b32 v122, a176
    v_mul_f32 v120, v120, v132
    v_mul_f32 v121, v121, v132
    v_mul_f32 v122, v122, v132
    v_accvgpr_read_b32 v64, a169
    v_accvgpr_read_b32 v65, a173
    v_mfma_f32_16x16x32_bf16 a[180:183], v[172:175], v[28:31], a[180:183]
    ds_read_b128 v[44:47], v1 offset:23552
    v_accvgpr_read_b32 v66, a177
    v_mfma_f32_16x16x32_bf16 a[180:183], v[164:167], v[24:27], a[180:183]
    s_waitcnt lgkmcnt(2)
    v_mul_f32 v64, v64, v133
    v_mul_f32 v65, v65, v133
    v_mul_f32 v66, v66, v133
    v_accvgpr_read_b32 v70, a170
    v_accvgpr_read_b32 v71, a174
    v_mfma_f32_16x16x32_bf16 a[136:139], v[160:163], v[32:35], a[136:139]
    ds_read_b128 v[24:27], v59 offset:9216
    v_accvgpr_read_b32 v247, a167
    v_mfma_f32_16x16x32_bf16 a[136:139], v[168:171], v[36:39], a[136:139]
    v_accvgpr_read_b32 v72, a178
    v_mul_f32 v242, v242, v135
    v_mul_f32 v70, v70, v134
    v_mul_f32 v243, v243, v135
    v_mul_f32 v71, v71, v134
    v_mfma_f32_16x16x32_bf16 a[184:187], v[172:175], v[36:39], a[184:187]
    ds_read_b128 v[28:31], v59 offset:21504
    v_mul_f32 v244, v244, v135
    v_mfma_f32_16x16x32_bf16 a[184:187], v[164:167], v[32:35], a[184:187]
    s_waitcnt lgkmcnt(2)
    v_mul_f32 v72, v72, v134
    v_mul_f32 v245, v245, v135
    v_accvgpr_read_b32 v144, a171
    v_mul_f32 v246, v246, v135
    v_accvgpr_read_b32 v145, a175
    v_mul_f32 v247, v247, v135
    v_mfma_f32_16x16x32_bf16 a[140:143], v[160:163], v[40:43], a[140:143]
    ds_read_b128 v[32:35], v59 offset:10240
    v_accvgpr_read_b32 v146, a179
    v_mfma_f32_16x16x32_bf16 a[140:143], v[168:171], v[44:47], a[140:143]
    v_cvt_pk_bf16_f32 v242, v242, v243
    v_mul_f32 v144, v144, v135
    v_cvt_pk_bf16_f32 v243, v244, v245
    v_mul_f32 v145, v145, v135
    v_cvt_pk_bf16_f32 v244, v246, v247
    v_mfma_f32_16x16x32_bf16 a[188:191], v[172:175], v[44:47], a[188:191]
    ds_read_b128 v[36:39], v59 offset:22528
    v_mul_f32 v146, v146, v135
    v_mfma_f32_16x16x32_bf16 a[188:191], v[164:167], v[40:43], a[188:191]
    s_waitcnt lgkmcnt(2)
    buffer_store_dwordx3 v[242:244], v56, s[12:15], s42 offen offset:1152 sc0 sc1
    v_mfma_f32_16x16x32_bf16 a[132:135], v[176:179], v[24:27], a[132:135]
    ds_read_b128 v[40:43], v59 offset:11264
    v_mfma_f32_16x16x32_bf16 a[132:135], v[184:187], v[28:31], a[132:135]
    v_mfma_f32_16x16x32_bf16 a[180:183], v[188:191], v[28:31], a[180:183]
    ds_read_b128 v[44:47], v59 offset:23552
    v_mfma_f32_16x16x32_bf16 a[180:183], v[180:183], v[24:27], a[180:183]
    s_waitcnt lgkmcnt(2)
    v_mfma_f32_16x16x32_bf16 a[136:139], v[176:179], v[32:35], a[136:139]
    v_mfma_f32_16x16x32_bf16 a[136:139], v[184:187], v[36:39], a[136:139]
    v_mfma_f32_16x16x32_bf16 a[184:187], v[188:191], v[36:39], a[184:187]
    v_mfma_f32_16x16x32_bf16 a[184:187], v[180:183], v[32:35], a[184:187]
    s_waitcnt lgkmcnt(0)
    v_mfma_f32_16x16x32_bf16 a[140:143], v[176:179], v[40:43], a[140:143]
    v_mfma_f32_16x16x32_bf16 a[140:143], v[184:187], v[44:47], a[140:143]
    v_mfma_f32_16x16x32_bf16 a[188:191], v[188:191], v[44:47], a[188:191]
    v_mfma_f32_16x16x32_bf16 a[188:191], v[180:183], v[40:43], a[188:191]
    s_nop 7
    v_accvgpr_read_b32 v99, a132
    v_accvgpr_read_b32 v100, a136
    v_accvgpr_read_b32 v101, a140
    v_cvt_pk_bf16_f32 v96, v96, v97
    v_mul_f32 v99, v99, v128
    v_mul_f32 v100, v100, v128
    v_mul_f32 v101, v101, v128
    v_cvt_pk_bf16_f32 v97, v98, v99
    v_cvt_pk_bf16_f32 v98, v100, v101
    buffer_store_dwordx3 v[96:98], v56, s[12:15], s41 offen offset:192 sc0 sc1
    v_accvgpr_read_b32 v105, a133
    v_accvgpr_read_b32 v106, a137
    v_accvgpr_read_b32 v107, a141
    v_cvt_pk_bf16_f32 v102, v102, v103
    v_mul_f32 v105, v105, v129
    v_mul_f32 v106, v106, v129
    v_mul_f32 v107, v107, v129
    v_cvt_pk_bf16_f32 v103, v104, v105
    v_cvt_pk_bf16_f32 v104, v106, v107
    buffer_store_dwordx3 v[102:104], v56, s[12:15], s41 offen offset:576 sc0 sc1
    v_accvgpr_read_b32 v111, a134
    v_accvgpr_read_b32 v112, a138
    v_accvgpr_read_b32 v113, a142
    v_cvt_pk_bf16_f32 v108, v108, v109
    v_mul_f32 v111, v111, v130
    v_mul_f32 v112, v112, v130
    v_mul_f32 v113, v113, v130
    v_cvt_pk_bf16_f32 v109, v110, v111
    v_cvt_pk_bf16_f32 v110, v112, v113
    buffer_store_dwordx3 v[108:110], v56, s[12:15], s41 offen offset:960 sc0 sc1
    v_accvgpr_read_b32 v117, a135
    v_accvgpr_read_b32 v118, a139
    v_accvgpr_read_b32 v119, a143
    v_cvt_pk_bf16_f32 v114, v114, v115
    v_mul_f32 v117, v117, v131
    v_mul_f32 v118, v118, v131
    v_mul_f32 v119, v119, v131
    v_cvt_pk_bf16_f32 v115, v116, v117
    v_cvt_pk_bf16_f32 v116, v118, v119
    buffer_store_dwordx3 v[114:116], v56, s[12:15], s41 offen offset:1344 sc0 sc1
    v_accvgpr_read_b32 v123, a180
    v_accvgpr_read_b32 v124, a184
    v_accvgpr_read_b32 v125, a188
    v_cvt_pk_bf16_f32 v120, v120, v121
    v_mul_f32 v123, v123, v132
    v_mul_f32 v124, v124, v132
    v_mul_f32 v125, v125, v132
    v_cvt_pk_bf16_f32 v121, v122, v123
    v_cvt_pk_bf16_f32 v122, v124, v125
    buffer_store_dwordx3 v[120:122], v56, s[12:15], s42 offen offset:192 sc0 sc1
    v_accvgpr_read_b32 v67, a181
    v_accvgpr_read_b32 v68, a185
    v_accvgpr_read_b32 v69, a189
    v_cvt_pk_bf16_f32 v64, v64, v65
    v_mul_f32 v67, v67, v133
    v_mul_f32 v68, v68, v133
    v_mul_f32 v69, v69, v133
    v_cvt_pk_bf16_f32 v65, v66, v67
    v_cvt_pk_bf16_f32 v66, v68, v69
    buffer_store_dwordx3 v[64:66], v56, s[12:15], s42 offen offset:576 sc0 sc1
    v_accvgpr_read_b32 v73, a182
    v_accvgpr_read_b32 v74, a186
    v_accvgpr_read_b32 v75, a190
    v_cvt_pk_bf16_f32 v70, v70, v71
    v_mul_f32 v73, v73, v134
    v_mul_f32 v74, v74, v134
    v_mul_f32 v75, v75, v134
    v_cvt_pk_bf16_f32 v71, v72, v73
    v_cvt_pk_bf16_f32 v72, v74, v75
    buffer_store_dwordx3 v[70:72], v56, s[12:15], s42 offen offset:960 sc0 sc1
    v_accvgpr_read_b32 v147, a183
    v_accvgpr_read_b32 v148, a187
    v_accvgpr_read_b32 v149, a191
    v_cvt_pk_bf16_f32 v144, v144, v145
    v_mul_f32 v147, v147, v135
    v_mul_f32 v148, v148, v135
    v_mul_f32 v149, v149, v135
    v_cvt_pk_bf16_f32 v145, v146, v147
    v_cvt_pk_bf16_f32 v146, v148, v149
    buffer_store_dwordx3 v[144:146], v56, s[12:15], s42 offen offset:1344 sc0 sc1
L_fin:
L_done:
    s_endpgm
L_pollslow0:
    s_mov_b32 s59, 60
L_pollsm0:
    s_buffer_load_dwordx8 s[48:55], s[20:23], s44 glc
    s_waitcnt lgkmcnt(0)
    s_sub_u32 s48, s48, s92
    s_sub_u32 s49, s49, s92
    s_sub_u32 s50, s50, s92
    s_sub_u32 s51, s51, s92
    s_sub_u32 s52, s52, s92
    s_sub_u32 s53, s53, s92
    s_sub_u32 s54, s54, s92
    s_sub_u32 s55, s55, s92
    s_max_u32 s48, s48, s49
    s_max_u32 s48, s48, s50
    s_max_u32 s48, s48, s51
    s_max_u32 s48, s48, s52
    s_max_u32 s48, s48, s53
    s_max_u32 s48, s48, s54
    s_max_u32 s48, s48, s55
    s_cmp_lt_u32 s48, 16
    s_cbranch_scc1 L_pollok0
    s_sub_u32 s59, s59, 1
    s_cbranch_scc1 L_pollvec0
    s_sleep 1
    s_branch L_pollsm0
L_pollvec0:
    v_bfe_u32 v53, v4, 4, 6
    v_lshlrev_b32 v53, 2, v53
    s_sub_u32 s96, s96, 1
    s_cbranch_scc1 L_pollgiveup0
    s_sleep 2
    buffer_load_dword v52, v53, s[20:23], s44 offen sc1
    s_waitcnt vmcnt(0)
    s_bitcmp1_b32 s92, 9
    s_cbranch_scc1 L_nomix
    v_xor_b32 v53, s92, v52
    v_lshrrev_b32 v53, 5, v53
    v_add_u32 v53, -1, v53
    v_cmp_gt_u32 vcc, 31, v53
    s_nop 1
    s_and_b32 s59, vcc_lo, 0xff
    s_cbranch_scc0 L_nomix
    buffer_store_dwordx4 v[224:227], v11, s[4:7], s33 offen offset:0 sc1
    v_xor_b32 v55, 16, v11
    buffer_store_dwordx4 v[228:231], v55, s[4:7], s33 offen offset:768 sc1
    v_xor_b32 v54, 32, v11
    buffer_store_dwordx4 v[232:235], v54, s[4:7], s33 offen offset:1536 sc1
    v_xor_b32 v55, 48, v11
    buffer_store_dwordx4 v[236:239], v55, s[4:7], s33 offen offset:2304 sc1
    buffer_store_dwordx4 v[112:115], v15, s[4:7], s35 offen offset:0 sc1
    buffer_store_dwordx4 v[116:119], v15, s[4:7], s35 offen offset:1024 sc1
    buffer_store_dwordx4 v[120:123], v15, s[4:7], s35 offen offset:2048 sc1
    s_waitcnt vmcnt(0)
    s_barrier
    s_and_b32 s92, s92, 0xfffffc00
    s_add_u32 s92, s92, 512
    v_mov_b32 v0, s92
    s_add_u32 s92, s92, 1
    s_mov_b32 s44, 32
    v_add_u32 v0, 1, v0
    buffer_store_dword v0, v13, s[20:23], 0 offen offset:32 sc1
    s_branch L_pollvec0
L_nomix:
    v_subrev_u32 v52, s92, v52
    v_cmp_lt_u32 vcc, 15, v52
    s_nop 0
    s_and_b32 s59, vcc_lo, 0xff
    s_cbranch_scc1 L_pollvec0
    s_branch L_pollok0
L_pollgiveup0:
    s_mov_b32 s96, 0
    s_branch L_pollok0
L_pollslow1:
    s_mov_b32 s59, 200
L_pollsm1:
    s_buffer_load_dwordx8 s[48:55], s[20:23], s44 glc
    s_waitcnt lgkmcnt(0)
    s_sub_u32 s48, s48, s92
    s_sub_u32 s49, s49, s92
    s_sub_u32 s50, s50, s92
    s_sub_u32 s51, s51, s92
    s_sub_u32 s52, s52, s92
    s_sub_u32 s53, s53, s92
    s_sub_u32 s54, s54, s92
    s_sub_u32 s55, s55, s92
    s_max_u32 s48, s48, s49
    s_max_u32 s48, s48, s50
    s_max_u32 s48, s48, s51
    s_max_u32 s48, s48, s52
    s_max_u32 s48, s48, s53
    s_max_u32 s48, s48, s54
    s_max_u32 s48, s48, s55
    s_cmp_lt_u32 s48, 16
    s_cbranch_scc1 L_pollok1
    s_sub_u32 s59, s59, 1
    s_cbranch_scc1 L_pollvec1
    s_sleep 1
    s_branch L_pollsm1
L_pollvec1:
    v_bfe_u32 v53, v4, 4, 6
    v_lshlrev_b32 v53, 2, v53
    s_sub_u32 s96, s96, 1
    s_cbranch_scc1 L_pollgiveup1
    s_sleep 2
    buffer_load_dword v52, v53, s[20:23], s44 offen sc1
    s_waitcnt vmcnt(0)
    v_subrev_u32 v52, s92, v52
    v_cmp_lt_u32 vcc, 15, v52
    s_nop 0
    s_and_b32 s59, vcc_lo, 0xff
    s_cbranch_scc1 L_pollvec1
    s_branch L_pollok1
L_pollgiveup1:
    s_mov_b32 s96, 0
    s_branch L_pollok1
L_pollslow2:
    s_mov_b32 s59, 200
L_pollsm2:
    s_buffer_load_dwordx8 s[48:55], s[20:23], s44 glc
    s_waitcnt lgkmcnt(0)
    s_sub_u32 s48, s48, s92
    s_sub_u32 s49, s49, s92
    s_sub_u32 s50, s50, s92
    s_sub_u32 s51, s51, s92
    s_sub_u32 s52, s52, s92
    s_sub_u32 s53, s53, s92
    s_sub_u32 s54, s54, s92
    s_sub_u32 s55, s55, s92
    s_max_u32 s48, s48, s49
    s_max_u32 s48, s48, s50
    s_max_u32 s48, s48, s51
    s_max_u32 s48, s48, s52
    s_max_u32 s48, s48, s53
    s_max_u32 s48, s48, s54
    s_max_u32 s48, s48, s55
    s_cmp_lt_u32 s48, 16
    s_cbranch_scc1 L_pollok2
    s_sub_u32 s59, s59, 1
    s_cbranch_scc1 L_pollvec2
    s_sleep 1
    s_branch L_pollsm2
L_pollvec2:
    v_bfe_u32 v53, v4, 4, 6
    v_lshlrev_b32 v53, 2, v53
    s_sub_u32 s96, s96, 1
    s_cbranch_scc1 L_pollgiveup2
    s_sleep 2
    buffer_load_dword v52, v53, s[20:23], s44 offen sc1
    s_waitcnt vmcnt(0)
    v_subrev_u32 v52, s92, v52
    v_cmp_lt_u32 vcc, 15, v52
    s_nop 0
    s_and_b32 s59, vcc_lo, 0xff
    s_cbranch_scc1 L_pollvec2
    s_branch L_pollok2
L_pollgiveup2:
    s_mov_b32 s96, 0
    s_branch L_pollok2
L_pollslow3:
    s_mov_b32 s59, 200
L_pollsm3:
    s_buffer_load_dwordx8 s[48:55], s[20:23], s44 glc
    s_waitcnt lgkmcnt(0)
    s_sub_u32 s48, s48, s92
    s_sub_u32 s49, s49, s92
    s_sub_u32 s50, s50, s92
    s_sub_u32 s51, s51, s92
    s_sub_u32 s52, s52, s92
    s_sub_u32 s53, s53, s92
    s_sub_u32 s54, s54, s92
    s_sub_u32 s55, s55, s92
    s_max_u32 s48, s48, s49
    s_max_u32 s48, s48, s50
    s_max_u32 s48, s48, s51
    s_max_u32 s48, s48, s52
    s_max_u32 s48, s48, s53
    s_max_u32 s48, s48, s54
    s_max_u32 s48, s48, s55
    s_cmp_lt_u32 s48, 16
    s_cbranch_scc1 L_pollok3
    s_sub_u32 s59, s59, 1
    s_cbranch_scc1 L_pollvec3
    s_sleep 1
    s_branch L_pollsm3
L_pollvec3:
    v_bfe_u32 v53, v4, 4, 6
    v_lshlrev_b32 v53, 2, v53
    s_sub_u32 s96, s96, 1
    s_cbranch_scc1 L_pollgiveup3
    s_sleep 2
    buffer_load_dword v52, v53, s[20:23], s44 offen sc1
    s_waitcnt vmcnt(0)
    v_subrev_u32 v52, s92, v52
    v_cmp_lt_u32 vcc, 15, v52
    s_nop 0
    s_and_b32 s59, vcc_lo, 0xff
    s_cbranch_scc1 L_pollvec3
    s_branch L_pollok3
L_pollgiveup3:
    s_mov_b32 s96, 0
    s_branch L_pollok3
L_pollslow4:
    s_mov_b32 s59, 200
L_pollsm4:
    s_buffer_load_dwordx8 s[48:55], s[20:23], s44 glc
    s_waitcnt lgkmcnt(0)
    s_sub_u32 s48, s48, s92
    s_sub_u32 s49, s49, s92
    s_sub_u32 s50, s50, s92
    s_sub_u32 s51, s51, s92
    s_sub_u32 s52, s52, s92
    s_sub_u32 s53, s53, s92
    s_sub_u32 s54, s54, s92
    s_sub_u32 s55, s55, s92
    s_max_u32 s48, s48, s49
    s_max_u32 s48, s48, s50
    s_max_u32 s48, s48, s51
    s_max_u32 s48, s48, s52
    s_max_u32 s48, s48, s53
    s_max_u32 s48, s48, s54
    s_max_u32 s48, s48, s55
    s_cmp_lt_u32 s48, 16
    s_cbranch_scc1 L_pollok4
    s_sub_u32 s59, s59, 1
    s_cbranch_scc1 L_pollvec4
    s_sleep 1
    s_branch L_pollsm4
L_pollvec4:
    v_bfe_u32 v53, v4, 4, 6
    v_lshlrev_b32 v53, 2, v53
    s_sub_u32 s96, s96, 1
    s_cbranch_scc1 L_pollgiveup4
    s_sleep 2
    buffer_load_dword v52, v53, s[20:23], s44 offen sc1
    s_waitcnt vmcnt(0)
    v_subrev_u32 v52, s92, v52
    v_cmp_lt_u32 vcc, 15, v52
    s_nop 0
    s_and_b32 s59, vcc_lo, 0xff
    s_cbranch_scc1 L_pollvec4
    s_branch L_pollok4
L_pollgiveup4:
    s_mov_b32 s96, 0
    s_branch L_pollok4
L_tagslow:
    s_sub_u32 s96, s96, 1
    s_cbranch_scc1 L_taggiveup
    s_sleep 2
    buffer_load_dword v0, off, s[88:91], s93 sc1
    s_waitcnt vmcnt(0)
    v_readfirstlane_b32 s42, v0
    s_nop 0
    s_cmp_eq_u32 s42, s46
    s_cbranch_scc1 L_tagslow
    s_cmp_eq_u32 s42, 0
    s_cbranch_scc1 L_tagslow
    s_branch L_tagok
L_taggiveup:
    s_mov_b32 s96, 0
    s_branch L_tagok
L_slow:
    s_waitcnt vmcnt(0) lgkmcnt(0)
    s_nop 15
    v_accvgpr_write_b32 a0, 0
    v_accvgpr_write_b32 a1, 0
    v_accvgpr_write_b32 a2, 0
    v_accvgpr_write_b32 a3, 0
    v_accvgpr_write_b32 a4, 0
    v_accvgpr_write_b32 a5, 0
    v_accvgpr_write_b32 a6, 0
    v_accvgpr_write_b32 a7, 0
    v_accvgpr_write_b32 a8, 0
    v_accvgpr_write_b32 a9, 0
    v_accvgpr_write_b32 a10, 0
    v_accvgpr_write_b32 a11, 0
    v_accvgpr_write_b32 a12, 0
    v_accvgpr_write_b32 a13, 0
    v_accvgpr_write_b32 a14, 0
    v_accvgpr_write_b32 a15, 0
    v_accvgpr_write_b32 a16, 0
    v_accvgpr_write_b32 a17, 0
    v_accvgpr_write_b32 a18, 0
    v_accvgpr_write_b32 a19, 0
    v_accvgpr_write_b32 a20, 0
    v_accvgpr_write_b32 a21, 0
    v_accvgpr_write_b32 a22, 0
    v_accvgpr_write_b32 a23, 0
    v_accvgpr_write_b32 a24, 0
    v_accvgpr_write_b32 a25, 0
    v_accvgpr_write_b32 a26, 0
    v_accvgpr_write_b32 a27, 0
    v_accvgpr_write_b32 a28, 0
    v_accvgpr_write_b32 a29, 0
    v_accvgpr_write_b32 a30, 0
    v_accvgpr_write_b32 a31, 0
    v_accvgpr_write_b32 a32, 0
    v_accvgpr_write_b32 a33, 0
    v_accvgpr_write_b32 a34, 0
    v_accvgpr_write_b32 a35, 0
    v_accvgpr_write_b32 a36, 0
    v_accvgpr_write_b32 a37, 0
    v_accvgpr_write_b32 a38, 0
    v_accvgpr_write_b32 a39, 0
    v_accvgpr_write_b32 a40, 0
    v_accvgpr_write_b32 a41, 0
    v_accvgpr_write_b32 a42, 0
    v_accvgpr_write_b32 a43, 0
    v_accvgpr_write_b32 a44, 0
    v_accvgpr_write_b32 a45, 0
    v_accvgpr_write_b32 a46, 0
    v_accvgpr_write_b32 a47, 0
    v_accvgpr_write_b32 a48, 0
    v_accvgpr_write_b32 a49, 0
    v_accvgpr_write_b32 a50, 0
    v_accvgpr_write_b32 a51, 0
    v_accvgpr_write_b32 a52, 0
    v_accvgpr_write_b32 a53, 0
    v_accvgpr_write_b32 a54, 0
    v_accvgpr_write_b32 a55, 0
    v_accvgpr_write_b32 a56, 0
    v_accvgpr_write_b32 a57, 0
    v_accvgpr_write_b32 a58, 0
    v_accvgpr_write_b32 a59, 0
    v_accvgpr_write_b32 a60, 0
    v_accvgpr_write_b32 a61, 0
    v_accvgpr_write_b32 a62, 0
    v_accvgpr_write_b32 a63, 0
    v_accvgpr_write_b32 a64, 0
    v_accvgpr_write_b32 a65, 0
    v_accvgpr_write_b32 a66, 0
    v_accvgpr_write_b32 a67, 0
    v_accvgpr_write_b32 a68, 0
    v_accvgpr_write_b32 a69, 0
    v_accvgpr_write_b32 a70, 0
    v_accvgpr_write_b32 a71, 0
    v_accvgpr_write_b32 a72, 0
    v_accvgpr_write_b32 a73, 0
    v_accvgpr_write_b32 a74, 0
    v_accvgpr_write_b32 a75, 0
    v_accvgpr_write_b32 a76, 0
    v_accvgpr_write_b32 a77, 0
    v_accvgpr_write_b32 a78, 0
    v_accvgpr_write_b32 a79, 0
    v_accvgpr_write_b32 a80, 0
    v_accvgpr_write_b32 a81, 0
    v_accvgpr_write_b32 a82, 0
    v_accvgpr_write_b32 a83, 0
    v_accvgpr_write_b32 a84, 0
    v_accvgpr_write_b32 a85, 0
    v_accvgpr_write_b32 a86, 0
    v_accvgpr_write_b32 a87, 0
    v_accvgpr_write_b32 a88, 0
    v_accvgpr_write_b32 a89, 0
    v_accvgpr_write_b32 a90, 0
    v_accvgpr_write_b32 a91, 0
    v_accvgpr_write_b32 a92, 0
    v_accvgpr_write_b32 a93, 0
    v_accvgpr_write_b32 a94, 0
    v_accvgpr_write_b32 a95, 0
    v_accvgpr_write_b32 a96, 0
    v_accvgpr_write_b32 a97, 0
    v_accvgpr_write_b32 a98, 0
    v_accvgpr_write_b32 a99, 0
    v_accvgpr_write_b32 a100, 0
    v_accvgpr_write_b32 a101, 0
    v_accvgpr_write_b32 a102, 0
    v_accvgpr_write_b32 a103, 0
    v_accvgpr_write_b32 a104, 0
    v_accvgpr_write_b32 a105, 0
    v_accvgpr_write_b32 a106, 0
    v_accvgpr_write_b32 a107, 0
    v_accvgpr_write_b32 a108, 0
    v_accvgpr_write_b32 a109, 0
    v_accvgpr_write_b32 a110, 0
    v_accvgpr_write_b32 a111, 0
    v_accvgpr_write_b32 a112, 0
    v_accvgpr_write_b32 a113, 0
    v_accvgpr_write_b32 a114, 0
    v_accvgpr_write_b32 a115, 0
    v_accvgpr_write_b32 a116, 0
    v_accvgpr_write_b32 a117, 0
    v_accvgpr_write_b32 a118, 0
    v_accvgpr_write_b32 a119, 0
    v_accvgpr_write_b32 a120, 0
    v_accvgpr_write_b32 a121, 0
    v_accvgpr_write_b32 a122, 0
    v_accvgpr_write_b32 a123, 0
    v_accvgpr_write_b32 a124, 0
    v_accvgpr_write_b32 a125, 0
    v_accvgpr_write_b32 a126, 0
    v_accvgpr_write_b32 a127, 0
    v_accvgpr_write_b32 a128, 0
    v_accvgpr_write_b32 a129, 0
    v_accvgpr_write_b32 a130, 0
    v_accvgpr_write_b32 a131, 0
    v_accvgpr_write_b32 a132, 0
    v_accvgpr_write_b32 a133, 0
    v_accvgpr_write_b32 a134, 0
    v_accvgpr_write_b32 a135, 0
    v_accvgpr_write_b32 a136, 0
    v_accvgpr_write_b32 a137, 0
    v_accvgpr_write_b32 a138, 0
    v_accvgpr_write_b32 a139, 0
    v_accvgpr_write_b32 a140, 0
    v_accvgpr_write_b32 a141, 0
    v_accvgpr_write_b32 a142, 0
    v_accvgpr_write_b32 a143, 0
    v_accvgpr_write_b32 a144, 0
    v_accvgpr_write_b32 a145, 0
    v_accvgpr_write_b32 a146, 0
    v_accvgpr_write_b32 a147, 0
    v_accvgpr_write_b32 a148, 0
    v_accvgpr_write_b32 a149, 0
    v_accvgpr_write_b32 a150, 0
    v_accvgpr_write_b32 a151, 0
    v_accvgpr_write_b32 a152, 0
    v_accvgpr_write_b32 a153, 0
    v_accvgpr_write_b32 a154, 0
    v_accvgpr_write_b32 a155, 0
    v_accvgpr_write_b32 a156, 0
    v_accvgpr_write_b32 a157, 0
    v_accvgpr_write_b32 a158, 0
    v_accvgpr_write_b32 a159, 0
    v_accvgpr_write_b32 a160, 0
    v_accvgpr_write_b32 a161, 0
    v_accvgpr_write_b32 a162, 0
    v_accvgpr_write_b32 a163, 0
    v_accvgpr_write_b32 a164, 0
    v_accvgpr_write_b32 a165, 0
    v_accvgpr_write_b32 a166, 0
    v_accvgpr_write_b32 a167, 0
    v_accvgpr_write_b32 a168, 0
    v_accvgpr_write_b32 a169, 0
    v_accvgpr_write_b32 a170, 0
    v_accvgpr_write_b32 a171, 0
    v_accvgpr_write_b32 a172, 0
    v_accvgpr_write_b32 a173, 0
    v_accvgpr_write_b32 a174, 0
    v_accvgpr_write_b32 a175, 0
    v_accvgpr_write_b32 a176, 0
    v_accvgpr_write_b32 a177, 0
    v_accvgpr_write_b32 a178, 0
    v_accvgpr_write_b32 a179, 0
    v_accvgpr_write_b32 a180, 0
    v_accvgpr_write_b32 a181, 0
    v_accvgpr_write_b32 a182, 0
    v_accvgpr_write_b32 a183, 0
    v_accvgpr_write_b32 a184, 0
    v_accvgpr_write_b32 a185, 0
    v_accvgpr_write_b32 a186, 0
    v_accvgpr_write_b32 a187, 0
    v_accvgpr_write_b32 a188, 0
    v_accvgpr_write_b32 a189, 0
    v_accvgpr_write_b32 a190, 0
    v_accvgpr_write_b32 a191, 0
    v_mov_b32 v5, 0
    v_mov_b32 v240, 0xff7fffff
    v_mov_b32 v6, 0
    v_mov_b32 v241, 0xff7fffff
    v_mov_b32 v7, 0
    v_mov_b32 v242, 0xff7fffff
    v_mov_b32 v8, 0
    v_mov_b32 v243, 0xff7fffff
    v_subrev_u32 v244, 49152, v2
    v_subrev_u32 v245, 49152, v3
    v_subrev_u32 v246, 24576, v1
    s_mov_b32 s48, 0
L_slowloop:
    s_add_u32 s49, s48, 6144
    s_add_u32 s50, s48, 12288
    s_add_u32 s51, s48, 16384
    s_add_u32 s52, s48, 20480
    buffer_load_dwordx4 v[64:67], v244, s[4:7], s48 offen offset:0 sc1
    buffer_load_dwordx4 v[68:71], v245, s[4:7], s48 offen offset:0 sc1
    buffer_load_dwordx4 v[72:75], v244, s[4:7], s49 offen offset:0 sc1
    buffer_load_dwordx4 v[76:79], v245, s[4:7], s49 offen offset:0 sc1
    buffer_load_dwordx4 v[80:83], v244, s[4:7], s48 offen offset:128 sc1
    buffer_load_dwordx4 v[84:87], v245, s[4:7], s48 offen offset:128 sc1
    buffer_load_dwordx4 v[88:91], v244, s[4:7], s49 offen offset:128 sc1
    buffer_load_dwordx4 v[92:95], v245, s[4:7], s49 offen offset:128 sc1
    buffer_load_dwordx4 v[96:99], v244, s[4:7], s48 offen offset:256 sc1
    buffer_load_dwordx4 v[100:103], v245, s[4:7], s48 offen offset:256 sc1
    buffer_load_dwordx4 v[104:107], v244, s[4:7], s49 offen offset:256 sc1
    buffer_load_dwordx4 v[108:111], v245, s[4:7], s49 offen offset:256 sc1
    buffer_load_dwordx4 v[112:115], v246, s[4:7], s50 offen offset:0 sc1
    buffer_load_dwordx4 v[116:119], v246, s[4:7], s50 offen offset:1024 sc1
    buffer_load_dwordx4 v[120:123], v246, s[4:7], s50 offen offset:2048 sc1
    buffer_load_dwordx4 v[124:127], v246, s[4:7], s50 offen offset:3072 sc1
    buffer_load_dwordx4 v[128:131], v246, s[4:7], s51 offen offset:0 sc1
    buffer_load_dwordx4 v[132:135], v246, s[4:7], s51 offen offset:1024 sc1
    buffer_load_dwordx4 v[136:139], v246, s[4:7], s51 offen offset:2048 sc1
    buffer_load_dwordx4 v[140:143], v246, s[4:7], s51 offen offset:3072 sc1
    buffer_load_dwordx4 v[144:147], v246, s[4:7], s52 offen offset:0 sc1
    buffer_load_dwordx4 v[148:151], v246, s[4:7], s52 offen offset:1024 sc1
    buffer_load_dwordx4 v[152:155], v246, s[4:7], s52 offen offset:2048 sc1
    buffer_load_dwordx4 v[156:159], v246, s[4:7], s52 offen offset:3072 sc1
    s_waitcnt vmcnt(12)
    v_mfma_f32_16x16x32_bf16 v[160:163], v[64:67], a[192:195], 0
    v_mfma_f32_16x16x32_bf16 v[168:171], v[64:67], a[216:219], 0
    v_mfma_f32_16x16x32_bf16 v[176:179], v[64:67], a[240:243], 0
    v_mfma_f32_16x16x32_bf16 v[184:187], v[64:67], v[200:203], 0
    v_mfma_f32_16x16x32_bf16 v[160:163], v[68:71], a[196:199], v[160:163]
    v_mfma_f32_16x16x32_bf16 v[168:171], v[68:71], a[220:223], v[168:171]
    v_mfma_f32_16x16x32_bf16 v[176:179], v[68:71], a[244:247], v[176:179]
    v_mfma_f32_16x16x32_bf16 v[184:187], v[68:71], v[204:207], v[184:187]
    v_mfma_f32_16x16x32_bf16 v[164:167], v[72:75], a[192:195], 0
    v_mfma_f32_16x16x32_bf16 v[172:175], v[72:75], a[216:219], 0
    v_mfma_f32_16x16x32_bf16 v[180:183], v[72:75], a[240:243], 0
    v_mfma_f32_16x16x32_bf16 v[188:191], v[72:75], v[200:203], 0
    v_mfma_f32_16x16x32_bf16 v[164:167], v[76:79], a[196:199], v[164:167]
    v_mfma_f32_16x16x32_bf16 v[172:175], v[76:79], a[220:223], v[172:175]
    v_mfma_f32_16x16x32_bf16 v[180:183], v[76:79], a[244:247], v[180:183]
    v_mfma_f32_16x16x32_bf16 v[188:191], v[76:79], v[204:207], v[188:191]
    v_mfma_f32_16x16x32_bf16 v[160:163], v[80:83], a[200:203], v[160:163]
    v_mfma_f32_16x16x32_bf16 v[168:171], v[80:83], a[224:227], v[168:171]
    v_mfma_f32_16x16x32_bf16 v[176:179], v[80:83], a[248:251], v[176:179]
    v_mfma_f32_16x16x32_bf16 v[184:187], v[80:83], v[208:211], v[184:187]
    v_mfma_f32_16x16x32_bf16 v[160:163], v[84:87], a[204:207], v[160:163]
    v_mfma_f32_16x16x32_bf16 v[168:171], v[84:87], a[228:231], v[168:171]
    v_mfma_f32_16x16x32_bf16 v[176:179], v[84:87], a[252:255], v[176:179]
    v_mfma_f32_16x16x32_bf16 v[184:187], v[84:87], v[212:215], v[184:187]
    v_mfma_f32_16x16x32_bf16 v[164:167], v[88:91], a[200:203], v[164:167]
    v_mfma_f32_16x16x32_bf16 v[172:175], v[88:91], a[224:227], v[172:175]
    v_mfma_f32_16x16x32_bf16 v[180:183], v[88:91], a[248:251], v[180:183]
    v_mfma_f32_16x16x32_bf16 v[188:191], v[88:91], v[208:211], v[188:191]
    v_mfma_f32_16x16x32_bf16 v[164:167], v[92:95], a[204:207], v[164:167]
    v_mfma_f32_16x16x32_bf16 v[172:175], v[92:95], a[228:231], v[172:175]
    v_mfma_f32_16x16x32_bf16 v[180:183], v[92:95], a[252:255], v[180:183]
    v_mfma_f32_16x16x32_bf16 v[188:191], v[92:95], v[212:215], v[188:191]
    v_mfma_f32_16x16x32_bf16 v[160:163], v[96:99], a[208:211], v[160:163]
    v_mfma_f32_16x16x32_bf16 v[168:171], v[96:99], a[232:235], v[168:171]
    v_mfma_f32_16x16x32_bf16 v[176:179], v[96:99], v[192:195], v[176:179]
    v_mfma_f32_16x16x32_bf16 v[184:187], v[96:99], v[216:219], v[184:187]
    v_mfma_f32_16x16x32_bf16 v[160:163], v[100:103], a[212:215], v[160:163]
    v_mfma_f32_16x16x32_bf16 v[168:171], v[100:103], a[236:239], v[168:171]
    v_mfma_f32_16x16x32_bf16 v[176:179], v[100:103], v[196:199], v[176:179]
    v_mfma_f32_16x16x32_bf16 v[184:187], v[100:103], v[220:223], v[184:187]
    v_mfma_f32_16x16x32_bf16 v[164:167], v[104:107], a[208:211], v[164:167]
    v_mfma_f32_16x16x32_bf16 v[172:175], v[104:107], a[232:235], v[172:175]
    v_mfma_f32_16x16x32_bf16 v[180:183], v[104:107], v[192:195], v[180:183]
    v_mfma_f32_16x16x32_bf16 v[188:191], v[104:107], v[216:219], v[188:191]
    v_mfma_f32_16x16x32_bf16 v[164:167], v[108:111], a[212:215], v[164:167]
    v_mfma_f32_16x16x32_bf16 v[172:175], v[108:111], a[236:239], v[172:175]
    v_mfma_f32_16x16x32_bf16 v[180:183], v[108:111], v[196:199], v[180:183]
    v_mfma_f32_16x16x32_bf16 v[188:191], v[108:111], v[220:223], v[188:191]
    s_nop 9
    v_max3_f32 v16, v160, v161, v162
    v_max3_f32 v16, v16, v163, v164
    v_max3_f32 v16, v16, v165, v166
    v_max3_f32 v16, v16, v167, v240
    v_mov_b32 v17, v16
    s_nop 1
    v_permlane16_swap_b32 v16, v17
    s_nop 1
    v_max_f32 v16, v16, v17
    v_mov_b32 v17, v16
    s_nop 1
    v_permlane32_swap_b32 v16, v17
    s_nop 1
    v_max_f32 v16, v16, v17
    v_sub_f32 v17, v240, v16
    v_exp_f32 v17, v17
    v_mov_b32 v240, v16
    v_sub_f32 v160, v160, v16
    v_sub_f32 v161, v161, v16
    v_sub_f32 v162, v162, v16
    v_sub_f32 v163, v163, v16
    v_sub_f32 v164, v164, v16
    v_sub_f32 v165, v165, v16
    v_sub_f32 v166, v166, v16
    v_sub_f32 v167, v167, v16
    v_exp_f32 v160, v160
    v_exp_f32 v161, v161
    v_exp_f32 v162, v162
    v_exp_f32 v163, v163
    v_exp_f32 v164, v164
    v_exp_f32 v165, v165
    v_exp_f32 v166, v166
    v_exp_f32 v167, v167
    v_mul_f32 v5, v5, v17
    v_add_f32 v5, v5, v160
    v_add_f32 v5, v5, v161
    v_add_f32 v5, v5, v162
    v_add_f32 v5, v5, v163
    v_add_f32 v5, v5, v164
    v_add_f32 v5, v5, v165
    v_add_f32 v5, v5, v166
    v_add_f32 v5, v5, v167
    v_cvt_pk_bf16_f32 v224, v160, v161
    v_cvt_pk_bf16_f32 v225, v162, v163
    v_cvt_pk_bf16_f32 v226, v164, v165
    v_cvt_pk_bf16_f32 v227, v166, v167
    ds_bpermute_b32 v248, v58, v17 offset:0
    ds_bpermute_b32 v249, v58, v17 offset:4
    ds_bpermute_b32 v250, v58, v17 offset:8
    ds_bpermute_b32 v251, v58, v17 offset:12
    s_waitcnt lgkmcnt(0)
    v_accvgpr_read_b32 v18, a0
    v_mul_f32 v18, v18, v248
    v_accvgpr_write_b32 a0, v18
    v_accvgpr_read_b32 v19, a1
    v_mul_f32 v19, v19, v249
    v_accvgpr_write_b32 a1, v19
    v_accvgpr_read_b32 v18, a2
    v_mul_f32 v18, v18, v250
    v_accvgpr_write_b32 a2, v18
    v_accvgpr_read_b32 v19, a3
    v_mul_f32 v19, v19, v251
    v_accvgpr_write_b32 a3, v19
    v_accvgpr_read_b32 v18, a4
    v_mul_f32 v18, v18, v248
    v_accvgpr_write_b32 a4, v18
    v_accvgpr_read_b32 v19, a5
    v_mul_f32 v19, v19, v249
    v_accvgpr_write_b32 a5, v19
    v_accvgpr_read_b32 v18, a6
    v_mul_f32 v18, v18, v250
    v_accvgpr_write_b32 a6, v18
    v_accvgpr_read_b32 v19, a7
    v_mul_f32 v19, v19, v251
    v_accvgpr_write_b32 a7, v19
    v_accvgpr_read_b32 v18, a8
    v_mul_f32 v18, v18, v248
    v_accvgpr_write_b32 a8, v18
    v_accvgpr_read_b32 v19, a9
    v_mul_f32 v19, v19, v249
    v_accvgpr_write_b32 a9, v19
    v_accvgpr_read_b32 v18, a10
    v_mul_f32 v18, v18, v250
    v_accvgpr_write_b32 a10, v18
    v_accvgpr_read_b32 v19, a11
    v_mul_f32 v19, v19, v251
    v_accvgpr_write_b32 a11, v19
    v_accvgpr_read_b32 v18, a12
    v_mul_f32 v18, v18, v248
    v_accvgpr_write_b32 a12, v18
    v_accvgpr_read_b32 v19, a13
    v_mul_f32 v19, v19, v249
    v_accvgpr_write_b32 a13, v19
    v_accvgpr_read_b32 v18, a14
    v_mul_f32 v18, v18, v250
    v_accvgpr_write_b32 a14, v18
    v_accvgpr_read_b32 v19, a15
    v_mul_f32 v19, v19, v251
    v_accvgpr_write_b32 a15, v19
    v_accvgpr_read_b32 v18, a16
    v_mul_f32 v18, v18, v248
    v_accvgpr_write_b32 a16, v18
    v_accvgpr_read_b32 v19, a17
    v_mul_f32 v19, v19, v249
    v_accvgpr_write_b32 a17, v19
    v_accvgpr_read_b32 v18, a18
    v_mul_f32 v18, v18, v250
    v_accvgpr_write_b32 a18, v18
    v_accvgpr_read_b32 v19, a19
    v_mul_f32 v19, v19, v251
    v_accvgpr_write_b32 a19, v19
    v_accvgpr_read_b32 v18, a20
    v_mul_f32 v18, v18, v248
    v_accvgpr_write_b32 a20, v18
    v_accvgpr_read_b32 v19, a21
    v_mul_f32 v19, v19, v249
    v_accvgpr_write_b32 a21, v19
    v_accvgpr_read_b32 v18, a22
    v_mul_f32 v18, v18, v250
    v_accvgpr_write_b32 a22, v18
    v_accvgpr_read_b32 v19, a23
    v_mul_f32 v19, v19, v251
    v_accvgpr_write_b32 a23, v19
    v_accvgpr_read_b32 v18, a24
    v_mul_f32 v18, v18, v248
    v_accvgpr_write_b32 a24, v18
    v_accvgpr_read_b32 v19, a25
    v_mul_f32 v19, v19, v249
    v_accvgpr_write_b32 a25, v19
    v_accvgpr_read_b32 v18, a26
    v_mul_f32 v18, v18, v250
    v_accvgpr_write_b32 a26, v18
    v_accvgpr_read_b32 v19, a27
    v_mul_f32 v19, v19, v251
    v_accvgpr_write_b32 a27, v19
    v_accvgpr_read_b32 v18, a28
    v_mul_f32 v18, v18, v248
    v_accvgpr_write_b32 a28, v18
    v_accvgpr_read_b32 v19, a29
    v_mul_f32 v19, v19, v249
    v_accvgpr_write_b32 a29, v19
    v_accvgpr_read_b32 v18, a30
    v_mul_f32 v18, v18, v250
    v_accvgpr_write_b32 a30, v18
    v_accvgpr_read_b32 v19, a31
    v_mul_f32 v19, v19, v251
    v_accvgpr_write_b32 a31, v19
    v_accvgpr_read_b32 v18, a32
    v_mul_f32 v18, v18, v248
    v_accvgpr_write_b32 a32, v18
    v_accvgpr_read_b32 v19, a33
    v_mul_f32 v19, v19, v249
    v_accvgpr_write_b32 a33, v19
    v_accvgpr_read_b32 v18, a34
    v_mul_f32 v18, v18, v250
    v_accvgpr_write_b32 a34, v18
    v_accvgpr_read_b32 v19, a35
    v_mul_f32 v19, v19, v251
    v_accvgpr_write_b32 a35, v19
    v_accvgpr_read_b32 v18, a36
    v_mul_f32 v18, v18, v248
    v_accvgpr_write_b32 a36, v18
    v_accvgpr_read_b32 v19, a37
    v_mul_f32 v19, v19, v249
    v_accvgpr_write_b32 a37, v19
    v_accvgpr_read_b32 v18, a38
    v_mul_f32 v18, v18, v250
    v_accvgpr_write_b32 a38, v18
    v_accvgpr_read_b32 v19, a39
    v_mul_f32 v19, v19, v251
    v_accvgpr_write_b32 a39, v19
    v_accvgpr_read_b32 v18, a40
    v_mul_f32 v18, v18, v248
    v_accvgpr_write_b32 a40, v18
    v_accvgpr_read_b32 v19, a41
    v_mul_f32 v19, v19, v249
    v_accvgpr_write_b32 a41, v19
    v_accvgpr_read_b32 v18, a42
    v_mul_f32 v18, v18, v250
    v_accvgpr_write_b32 a42, v18
    v_accvgpr_read_b32 v19, a43
    v_mul_f32 v19, v19, v251
    v_accvgpr_write_b32 a43, v19
    v_accvgpr_read_b32 v18, a44
    v_mul_f32 v18, v18, v248
    v_accvgpr_write_b32 a44, v18
    v_accvgpr_read_b32 v19, a45
    v_mul_f32 v19, v19, v249
    v_accvgpr_write_b32 a45, v19
    v_accvgpr_read_b32 v18, a46
    v_mul_f32 v18, v18, v250
    v_accvgpr_write_b32 a46, v18
    v_accvgpr_read_b32 v19, a47
    v_mul_f32 v19, v19, v251
    v_accvgpr_write_b32 a47, v19
    v_max3_f32 v16, v168, v169, v170
    v_max3_f32 v16, v16, v171, v172
    v_max3_f32 v16, v16, v173, v174
    v_max3_f32 v16, v16, v175, v241
    v_mov_b32 v17, v16
    s_nop 1
    v_permlane16_swap_b32 v16, v17
    s_nop 1
    v_max_f32 v16, v16, v17
    v_mov_b32 v17, v16
    s_nop 1
    v_permlane32_swap_b32 v16, v17
    s_nop 1
    v_max_f32 v16, v16, v17
    v_sub_f32 v17, v241, v16
    v_exp_f32 v17, v17
    v_mov_b32 v241, v16
    v_sub_f32 v168, v168, v16
    v_sub_f32 v169, v169, v16
    v_sub_f32 v170, v170, v16
    v_sub_f32 v171, v171, v16
    v_sub_f32 v172, v172, v16
    v_sub_f32 v173, v173, v16
    v_sub_f32 v174, v174, v16
    v_sub_f32 v175, v175, v16
    v_exp_f32 v168, v168
    v_exp_f32 v169, v169
    v_exp_f32 v170, v170
    v_exp_f32 v171, v171
    v_exp_f32 v172, v172
    v_exp_f32 v173, v173
    v_exp_f32 v174, v174
    v_exp_f32 v175, v175
    v_mul_f32 v6, v6, v17
    v_add_f32 v6, v6, v168
    v_add_f32 v6, v6, v169
    v_add_f32 v6, v6, v170
    v_add_f32 v6, v6, v171
    v_add_f32 v6, v6, v172
    v_add_f32 v6, v6, v173
    v_add_f32 v6, v6, v174
    v_add_f32 v6, v6, v175
    v_cvt_pk_bf16_f32 v228, v168, v169
    v_cvt_pk_bf16_f32 v229, v170, v171
    v_cvt_pk_bf16_f32 v230, v172, v173
    v_cvt_pk_bf16_f32 v231, v174, v175
    ds_bpermute_b32 v248, v58, v17 offset:0
    ds_bpermute_b32 v249, v58, v17 offset:4
    ds_bpermute_b32 v250, v58, v17 offset:8
    ds_bpermute_b32 v251, v58, v17 offset:12
    s_waitcnt lgkmcnt(0)
    v_accvgpr_read_b32 v18, a48
    v_mul_f32 v18, v18, v248
    v_accvgpr_write_b32 a48, v18
    v_accvgpr_read_b32 v19, a49
    v_mul_f32 v19, v19, v249
    v_accvgpr_write_b32 a49, v19
    v_accvgpr_read_b32 v18, a50
    v_mul_f32 v18, v18, v250
    v_accvgpr_write_b32 a50, v18
    v_accvgpr_read_b32 v19, a51
    v_mul_f32 v19, v19, v251
    v_accvgpr_write_b32 a51, v19
    v_accvgpr_read_b32 v18, a52
    v_mul_f32 v18, v18, v248
    v_accvgpr_write_b32 a52, v18
    v_accvgpr_read_b32 v19, a53
    v_mul_f32 v19, v19, v249
    v_accvgpr_write_b32 a53, v19
    v_accvgpr_read_b32 v18, a54
    v_mul_f32 v18, v18, v250
    v_accvgpr_write_b32 a54, v18
    v_accvgpr_read_b32 v19, a55
    v_mul_f32 v19, v19, v251
    v_accvgpr_write_b32 a55, v19
    v_accvgpr_read_b32 v18, a56
    v_mul_f32 v18, v18, v248
    v_accvgpr_write_b32 a56, v18
    v_accvgpr_read_b32 v19, a57
    v_mul_f32 v19, v19, v249
    v_accvgpr_write_b32 a57, v19
    v_accvgpr_read_b32 v18, a58
    v_mul_f32 v18, v18, v250
    v_accvgpr_write_b32 a58, v18
    v_accvgpr_read_b32 v19, a59
    v_mul_f32 v19, v19, v251
    v_accvgpr_write_b32 a59, v19
    v_accvgpr_read_b32 v18, a60
    v_mul_f32 v18, v18, v248
    v_accvgpr_write_b32 a60, v18
    v_accvgpr_read_b32 v19, a61
    v_mul_f32 v19, v19, v249
    v_accvgpr_write_b32 a61, v19
    v_accvgpr_read_b32 v18, a62
    v_mul_f32 v18, v18, v250
    v_accvgpr_write_b32 a62, v18
    v_accvgpr_read_b32 v19, a63
    v_mul_f32 v19, v19, v251
    v_accvgpr_write_b32 a63, v19
    v_accvgpr_read_b32 v18, a64
    v_mul_f32 v18, v18, v248
    v_accvgpr_write_b32 a64, v18
    v_accvgpr_read_b32 v19, a65
    v_mul_f32 v19, v19, v249
    v_accvgpr_write_b32 a65, v19
    v_accvgpr_read_b32 v18, a66
    v_mul_f32 v18, v18, v250
    v_accvgpr_write_b32 a66, v18
    v_accvgpr_read_b32 v19, a67
    v_mul_f32 v19, v19, v251
    v_accvgpr_write_b32 a67, v19
    v_accvgpr_read_b32 v18, a68
    v_mul_f32 v18, v18, v248
    v_accvgpr_write_b32 a68, v18
    v_accvgpr_read_b32 v19, a69
    v_mul_f32 v19, v19, v249
    v_accvgpr_write_b32 a69, v19
    v_accvgpr_read_b32 v18, a70
    v_mul_f32 v18, v18, v250
    v_accvgpr_write_b32 a70, v18
    v_accvgpr_read_b32 v19, a71
    v_mul_f32 v19, v19, v251
    v_accvgpr_write_b32 a71, v19
    v_accvgpr_read_b32 v18, a72
    v_mul_f32 v18, v18, v248
    v_accvgpr_write_b32 a72, v18
    v_accvgpr_read_b32 v19, a73
    v_mul_f32 v19, v19, v249
    v_accvgpr_write_b32 a73, v19
    v_accvgpr_read_b32 v18, a74
    v_mul_f32 v18, v18, v250
    v_accvgpr_write_b32 a74, v18
    v_accvgpr_read_b32 v19, a75
    v_mul_f32 v19, v19, v251
    v_accvgpr_write_b32 a75, v19
    v_accvgpr_read_b32 v18, a76
    v_mul_f32 v18, v18, v248
    v_accvgpr_write_b32 a76, v18
    v_accvgpr_read_b32 v19, a77
    v_mul_f32 v19, v19, v249
    v_accvgpr_write_b32 a77, v19
    v_accvgpr_read_b32 v18, a78
    v_mul_f32 v18, v18, v250
    v_accvgpr_write_b32 a78, v18
    v_accvgpr_read_b32 v19, a79
    v_mul_f32 v19, v19, v251
    v_accvgpr_write_b32 a79, v19
    v_accvgpr_read_b32 v18, a80
    v_mul_f32 v18, v18, v248
    v_accvgpr_write_b32 a80, v18
    v_accvgpr_read_b32 v19, a81
    v_mul_f32 v19, v19, v249
    v_accvgpr_write_b32 a81, v19
    v_accvgpr_read_b32 v18, a82
    v_mul_f32 v18, v18, v250
    v_accvgpr_write_b32 a82, v18
    v_accvgpr_read_b32 v19, a83
    v_mul_f32 v19, v19, v251
    v_accvgpr_write_b32 a83, v19
    v_accvgpr_read_b32 v18, a84
    v_mul_f32 v18, v18, v248
    v_accvgpr_write_b32 a84, v18
    v_accvgpr_read_b32 v19, a85
    v_mul_f32 v19, v19, v249
    v_accvgpr_write_b32 a85, v19
    v_accvgpr_read_b32 v18, a86
    v_mul_f32 v18, v18, v250
    v_accvgpr_write_b32 a86, v18
    v_accvgpr_read_b32 v19, a87
    v_mul_f32 v19, v19, v251
    v_accvgpr_write_b32 a87, v19
    v_accvgpr_read_b32 v18, a88
    v_mul_f32 v18, v18, v248
    v_accvgpr_write_b32 a88, v18
    v_accvgpr_read_b32 v19, a89
    v_mul_f32 v19, v19, v249
    v_accvgpr_write_b32 a89, v19
    v_accvgpr_read_b32 v18, a90
    v_mul_f32 v18, v18, v250
    v_accvgpr_write_b32 a90, v18
    v_accvgpr_read_b32 v19, a91
    v_mul_f32 v19, v19, v251
    v_accvgpr_write_b32 a91, v19
    v_accvgpr_read_b32 v18, a92
    v_mul_f32 v18, v18, v248
    v_accvgpr_write_b32 a92, v18
    v_accvgpr_read_b32 v19, a93
    v_mul_f32 v19, v19, v249
    v_accvgpr_write_b32 a93, v19
    v_accvgpr_read_b32 v18, a94
    v_mul_f32 v18, v18, v250
    v_accvgpr_write_b32 a94, v18
    v_accvgpr_read_b32 v19, a95
    v_mul_f32 v19, v19, v251
    v_accvgpr_write_b32 a95, v19
    v_max3_f32 v16, v176, v177, v178
    v_max3_f32 v16, v16, v179, v180
    v_max3_f32 v16, v16, v181, v182
    v_max3_f32 v16, v16, v183, v242
    v_mov_b32 v17, v16
    s_nop 1
    v_permlane16_swap_b32 v16, v17
    s_nop 1
    v_max_f32 v16, v16, v17
    v_mov_b32 v17, v16
    s_nop 1
    v_permlane32_swap_b32 v16, v17
    s_nop 1
    v_max_f32 v16, v16, v17
    v_sub_f32 v17, v242, v16
    v_exp_f32 v17, v17
    v_mov_b32 v242, v16
    v_sub_f32 v176, v176, v16
    v_sub_f32 v177, v177, v16
    v_sub_f32 v178, v178, v16
    v_sub_f32 v179, v179, v16
    v_sub_f32 v180, v180, v16
    v_sub_f32 v181, v181, v16
    v_sub_f32 v182, v182, v16
    v_sub_f32 v183, v183, v16
    v_exp_f32 v176, v176
    v_exp_f32 v177, v177
    v_exp_f32 v178, v178
    v_exp_f32 v179, v179
    v_exp_f32 v180, v180
    v_exp_f32 v181, v181
    v_exp_f32 v182, v182
    v_exp_f32 v183, v183
    v_mul_f32 v7, v7, v17
    v_add_f32 v7, v7, v176
    v_add_f32 v7, v7, v177
    v_add_f32 v7, v7, v178
    v_add_f32 v7, v7, v179
    v_add_f32 v7, v7, v180
    v_add_f32 v7, v7, v181
    v_add_f32 v7, v7, v182
    v_add_f32 v7, v7, v183
    v_cvt_pk_bf16_f32 v232, v176, v177
    v_cvt_pk_bf16_f32 v233, v178, v179
    v_cvt_pk_bf16_f32 v234, v180, v181
    v_cvt_pk_bf16_f32 v235, v182, v183
    ds_bpermute_b32 v248, v58, v17 offset:0
    ds_bpermute_b32 v249, v58, v17 offset:4
    ds_bpermute_b32 v250, v58, v17 offset:8
    ds_bpermute_b32 v251, v58, v17 offset:12
    s_waitcnt lgkmcnt(0)
    v_accvgpr_read_b32 v18, a96
    v_mul_f32 v18, v18, v248
    v_accvgpr_write_b32 a96, v18
    v_accvgpr_read_b32 v19, a97
    v_mul_f32 v19, v19, v249
    v_accvgpr_write_b32 a97, v19
    v_accvgpr_read_b32 v18, a98
    v_mul_f32 v18, v18, v250
    v_accvgpr_write_b32 a98, v18
    v_accvgpr_read_b32 v19, a99
    v_mul_f32 v19, v19, v251
    v_accvgpr_write_b32 a99, v19
    v_accvgpr_read_b32 v18, a100
    v_mul_f32 v18, v18, v248
    v_accvgpr_write_b32 a100, v18
    v_accvgpr_read_b32 v19, a101
    v_mul_f32 v19, v19, v249
    v_accvgpr_write_b32 a101, v19
    v_accvgpr_read_b32 v18, a102
    v_mul_f32 v18, v18, v250
    v_accvgpr_write_b32 a102, v18
    v_accvgpr_read_b32 v19, a103
    v_mul_f32 v19, v19, v251
    v_accvgpr_write_b32 a103, v19
    v_accvgpr_read_b32 v18, a104
    v_mul_f32 v18, v18, v248
    v_accvgpr_write_b32 a104, v18
    v_accvgpr_read_b32 v19, a105
    v_mul_f32 v19, v19, v249
    v_accvgpr_write_b32 a105, v19
    v_accvgpr_read_b32 v18, a106
    v_mul_f32 v18, v18, v250
    v_accvgpr_write_b32 a106, v18
    v_accvgpr_read_b32 v19, a107
    v_mul_f32 v19, v19, v251
    v_accvgpr_write_b32 a107, v19
    v_accvgpr_read_b32 v18, a108
    v_mul_f32 v18, v18, v248
    v_accvgpr_write_b32 a108, v18
    v_accvgpr_read_b32 v19, a109
    v_mul_f32 v19, v19, v249
    v_accvgpr_write_b32 a109, v19
    v_accvgpr_read_b32 v18, a110
    v_mul_f32 v18, v18, v250
    v_accvgpr_write_b32 a110, v18
    v_accvgpr_read_b32 v19, a111
    v_mul_f32 v19, v19, v251
    v_accvgpr_write_b32 a111, v19
    v_accvgpr_read_b32 v18, a112
    v_mul_f32 v18, v18, v248
    v_accvgpr_write_b32 a112, v18
    v_accvgpr_read_b32 v19, a113
    v_mul_f32 v19, v19, v249
    v_accvgpr_write_b32 a113, v19
    v_accvgpr_read_b32 v18, a114
    v_mul_f32 v18, v18, v250
    v_accvgpr_write_b32 a114, v18
    v_accvgpr_read_b32 v19, a115
    v_mul_f32 v19, v19, v251
    v_accvgpr_write_b32 a115, v19
    v_accvgpr_read_b32 v18, a116
    v_mul_f32 v18, v18, v248
    v_accvgpr_write_b32 a116, v18
    v_accvgpr_read_b32 v19, a117
    v_mul_f32 v19, v19, v249
    v_accvgpr_write_b32 a117, v19
    v_accvgpr_read_b32 v18, a118
    v_mul_f32 v18, v18, v250
    v_accvgpr_write_b32 a118, v18
    v_accvgpr_read_b32 v19, a119
    v_mul_f32 v19, v19, v251
    v_accvgpr_write_b32 a119, v19
    v_accvgpr_read_b32 v18, a120
    v_mul_f32 v18, v18, v248
    v_accvgpr_write_b32 a120, v18
    v_accvgpr_read_b32 v19, a121
    v_mul_f32 v19, v19, v249
    v_accvgpr_write_b32 a121, v19
    v_accvgpr_read_b32 v18, a122
    v_mul_f32 v18, v18, v250
    v_accvgpr_write_b32 a122, v18
    v_accvgpr_read_b32 v19, a123
    v_mul_f32 v19, v19, v251
    v_accvgpr_write_b32 a123, v19
    v_accvgpr_read_b32 v18, a124
    v_mul_f32 v18, v18, v248
    v_accvgpr_write_b32 a124, v18
    v_accvgpr_read_b32 v19, a125
    v_mul_f32 v19, v19, v249
    v_accvgpr_write_b32 a125, v19
    v_accvgpr_read_b32 v18, a126
    v_mul_f32 v18, v18, v250
    v_accvgpr_write_b32 a126, v18
    v_accvgpr_read_b32 v19, a127
    v_mul_f32 v19, v19, v251
    v_accvgpr_write_b32 a127, v19
    v_accvgpr_read_b32 v18, a128
    v_mul_f32 v18, v18, v248
    v_accvgpr_write_b32 a128, v18
    v_accvgpr_read_b32 v19, a129
    v_mul_f32 v19, v19, v249
    v_accvgpr_write_b32 a129, v19
    v_accvgpr_read_b32 v18, a130
    v_mul_f32 v18, v18, v250
    v_accvgpr_write_b32 a130, v18
    v_accvgpr_read_b32 v19, a131
    v_mul_f32 v19, v19, v251
    v_accvgpr_write_b32 a131, v19
    v_accvgpr_read_b32 v18, a132
    v_mul_f32 v18, v18, v248
    v_accvgpr_write_b32 a132, v18
    v_accvgpr_read_b32 v19, a133
    v_mul_f32 v19, v19, v249
    v_accvgpr_write_b32 a133, v19
    v_accvgpr_read_b32 v18, a134
    v_mul_f32 v18, v18, v250
    v_accvgpr_write_b32 a134, v18
    v_accvgpr_read_b32 v19, a135
    v_mul_f32 v19, v19, v251
    v_accvgpr_write_b32 a135, v19
    v_accvgpr_read_b32 v18, a136
    v_mul_f32 v18, v18, v248
    v_accvgpr_write_b32 a136, v18
    v_accvgpr_read_b32 v19, a137
    v_mul_f32 v19, v19, v249
    v_accvgpr_write_b32 a137, v19
    v_accvgpr_read_b32 v18, a138
    v_mul_f32 v18, v18, v250
    v_accvgpr_write_b32 a138, v18
    v_accvgpr_read_b32 v19, a139
    v_mul_f32 v19, v19, v251
    v_accvgpr_write_b32 a139, v19
    v_accvgpr_read_b32 v18, a140
    v_mul_f32 v18, v18, v248
    v_accvgpr_write_b32 a140, v18
    v_accvgpr_read_b32 v19, a141
    v_mul_f32 v19, v19, v249
    v_accvgpr_write_b32 a141, v19
    v_accvgpr_read_b32 v18, a142
    v_mul_f32 v18, v18, v250
    v_accvgpr_write_b32 a142, v18
    v_accvgpr_read_b32 v19, a143
    v_mul_f32 v19, v19, v251
    v_accvgpr_write_b32 a143, v19
    v_max3_f32 v16, v184, v185, v186
    v_max3_f32 v16, v16, v187, v188
    v_max3_f32 v16, v16, v189, v190
    v_max3_f32 v16, v16, v191, v243
    v_mov_b32 v17, v16
    s_nop 1
    v_permlane16_swap_b32 v16, v17
    s_nop 1
    v_max_f32 v16, v16, v17
    v_mov_b32 v17, v16
    s_nop 1
    v_permlane32_swap_b32 v16, v17
    s_nop 1
    v_max_f32 v16, v16, v17
    v_sub_f32 v17, v243, v16
    v_exp_f32 v17, v17
    v_mov_b32 v243, v16
    v_sub_f32 v184, v184, v16
    v_sub_f32 v185, v185, v16
    v_sub_f32 v186, v186, v16
    v_sub_f32 v187, v187, v16
    v_sub_f32 v188, v188, v16
    v_sub_f32 v189, v189, v16
    v_sub_f32 v190, v190, v16
    v_sub_f32 v191, v191, v16
    v_exp_f32 v184, v184
    v_exp_f32 v185, v185
    v_exp_f32 v186, v186
    v_exp_f32 v187, v187
    v_exp_f32 v188, v188
    v_exp_f32 v189, v189
    v_exp_f32 v190, v190
    v_exp_f32 v191, v191
    v_mul_f32 v8, v8, v17
    v_add_f32 v8, v8, v184
    v_add_f32 v8, v8, v185
    v_add_f32 v8, v8, v186
    v_add_f32 v8, v8, v187
    v_add_f32 v8, v8, v188
    v_add_f32 v8, v8, v189
    v_add_f32 v8, v8, v190
    v_add_f32 v8, v8, v191
    v_cvt_pk_bf16_f32 v236, v184, v185
    v_cvt_pk_bf16_f32 v237, v186, v187
    v_cvt_pk_bf16_f32 v238, v188, v189
    v_cvt_pk_bf16_f32 v239, v190, v191
    ds_bpermute_b32 v248, v58, v17 offset:0
    ds_bpermute_b32 v249, v58, v17 offset:4
    ds_bpermute_b32 v250, v58, v17 offset:8
    ds_bpermute_b32 v251, v58, v17 offset:12
    s_waitcnt lgkmcnt(0)
    v_accvgpr_read_b32 v18, a144
    v_mul_f32 v18, v18, v248
    v_accvgpr_write_b32 a144, v18
    v_accvgpr_read_b32 v19, a145
    v_mul_f32 v19, v19, v249
    v_accvgpr_write_b32 a145, v19
    v_accvgpr_read_b32 v18, a146
    v_mul_f32 v18, v18, v250
    v_accvgpr_write_b32 a146, v18
    v_accvgpr_read_b32 v19, a147
    v_mul_f32 v19, v19, v251
    v_accvgpr_write_b32 a147, v19
    v_accvgpr_read_b32 v18, a148
    v_mul_f32 v18, v18, v248
    v_accvgpr_write_b32 a148, v18
    v_accvgpr_read_b32 v19, a149
    v_mul_f32 v19, v19, v249
    v_accvgpr_write_b32 a149, v19
    v_accvgpr_read_b32 v18, a150
    v_mul_f32 v18, v18, v250
    v_accvgpr_write_b32 a150, v18
    v_accvgpr_read_b32 v19, a151
    v_mul_f32 v19, v19, v251
    v_accvgpr_write_b32 a151, v19
    v_accvgpr_read_b32 v18, a152
    v_mul_f32 v18, v18, v248
    v_accvgpr_write_b32 a152, v18
    v_accvgpr_read_b32 v19, a153
    v_mul_f32 v19, v19, v249
    v_accvgpr_write_b32 a153, v19
    v_accvgpr_read_b32 v18, a154
    v_mul_f32 v18, v18, v250
    v_accvgpr_write_b32 a154, v18
    v_accvgpr_read_b32 v19, a155
    v_mul_f32 v19, v19, v251
    v_accvgpr_write_b32 a155, v19
    v_accvgpr_read_b32 v18, a156
    v_mul_f32 v18, v18, v248
    v_accvgpr_write_b32 a156, v18
    v_accvgpr_read_b32 v19, a157
    v_mul_f32 v19, v19, v249
    v_accvgpr_write_b32 a157, v19
    v_accvgpr_read_b32 v18, a158
    v_mul_f32 v18, v18, v250
    v_accvgpr_write_b32 a158, v18
    v_accvgpr_read_b32 v19, a159
    v_mul_f32 v19, v19, v251
    v_accvgpr_write_b32 a159, v19
    v_accvgpr_read_b32 v18, a160
    v_mul_f32 v18, v18, v248
    v_accvgpr_write_b32 a160, v18
    v_accvgpr_read_b32 v19, a161
    v_mul_f32 v19, v19, v249
    v_accvgpr_write_b32 a161, v19
    v_accvgpr_read_b32 v18, a162
    v_mul_f32 v18, v18, v250
    v_accvgpr_write_b32 a162, v18
    v_accvgpr_read_b32 v19, a163
    v_mul_f32 v19, v19, v251
    v_accvgpr_write_b32 a163, v19
    v_accvgpr_read_b32 v18, a164
    v_mul_f32 v18, v18, v248
    v_accvgpr_write_b32 a164, v18
    v_accvgpr_read_b32 v19, a165
    v_mul_f32 v19, v19, v249
    v_accvgpr_write_b32 a165, v19
    v_accvgpr_read_b32 v18, a166
    v_mul_f32 v18, v18, v250
    v_accvgpr_write_b32 a166, v18
    v_accvgpr_read_b32 v19, a167
    v_mul_f32 v19, v19, v251
    v_accvgpr_write_b32 a167, v19
    v_accvgpr_read_b32 v18, a168
    v_mul_f32 v18, v18, v248
    v_accvgpr_write_b32 a168, v18
    v_accvgpr_read_b32 v19, a169
    v_mul_f32 v19, v19, v249
    v_accvgpr_write_b32 a169, v19
    v_accvgpr_read_b32 v18, a170
    v_mul_f32 v18, v18, v250
    v_accvgpr_write_b32 a170, v18
    v_accvgpr_read_b32 v19, a171
    v_mul_f32 v19, v19, v251
    v_accvgpr_write_b32 a171, v19
    v_accvgpr_read_b32 v18, a172
    v_mul_f32 v18, v18, v248
    v_accvgpr_write_b32 a172, v18
    v_accvgpr_read_b32 v19, a173
    v_mul_f32 v19, v19, v249
    v_accvgpr_write_b32 a173, v19
    v_accvgpr_read_b32 v18, a174
    v_mul_f32 v18, v18, v250
    v_accvgpr_write_b32 a174, v18
    v_accvgpr_read_b32 v19, a175
    v_mul_f32 v19, v19, v251
    v_accvgpr_write_b32 a175, v19
    v_accvgpr_read_b32 v18, a176
    v_mul_f32 v18, v18, v248
    v_accvgpr_write_b32 a176, v18
    v_accvgpr_read_b32 v19, a177
    v_mul_f32 v19, v19, v249
    v_accvgpr_write_b32 a177, v19
    v_accvgpr_read_b32 v18, a178
    v_mul_f32 v18, v18, v250
    v_accvgpr_write_b32 a178, v18
    v_accvgpr_read_b32 v19, a179
    v_mul_f32 v19, v19, v251
    v_accvgpr_write_b32 a179, v19
    v_accvgpr_read_b32 v18, a180
    v_mul_f32 v18, v18, v248
    v_accvgpr_write_b32 a180, v18
    v_accvgpr_read_b32 v19, a181
    v_mul_f32 v19, v19, v249
    v_accvgpr_write_b32 a181, v19
    v_accvgpr_read_b32 v18, a182
    v_mul_f32 v18, v18, v250
    v_accvgpr_write_b32 a182, v18
    v_accvgpr_read_b32 v19, a183
    v_mul_f32 v19, v19, v251
    v_accvgpr_write_b32 a183, v19
    v_accvgpr_read_b32 v18, a184
    v_mul_f32 v18, v18, v248
    v_accvgpr_write_b32 a184, v18
    v_accvgpr_read_b32 v19, a185
    v_mul_f32 v19, v19, v249
    v_accvgpr_write_b32 a185, v19
    v_accvgpr_read_b32 v18, a186
    v_mul_f32 v18, v18, v250
    v_accvgpr_write_b32 a186, v18
    v_accvgpr_read_b32 v19, a187
    v_mul_f32 v19, v19, v251
    v_accvgpr_write_b32 a187, v19
    v_accvgpr_read_b32 v18, a188
    v_mul_f32 v18, v18, v248
    v_accvgpr_write_b32 a188, v18
    v_accvgpr_read_b32 v19, a189
    v_mul_f32 v19, v19, v249
    v_accvgpr_write_b32 a189, v19
    v_accvgpr_read_b32 v18, a190
    v_mul_f32 v18, v18, v250
    v_accvgpr_write_b32 a190, v18
    v_accvgpr_read_b32 v19, a191
    v_mul_f32 v19, v19, v251
    v_accvgpr_write_b32 a191, v19
    s_waitcnt vmcnt(0)
    s_nop 1
    v_mfma_f32_16x16x32_bf16 a[0:3], v[224:227], v[112:115], a[0:3]
    v_mfma_f32_16x16x32_bf16 a[48:51], v[228:231], v[112:115], a[48:51]
    v_mfma_f32_16x16x32_bf16 a[96:99], v[232:235], v[112:115], a[96:99]
    v_mfma_f32_16x16x32_bf16 a[144:147], v[236:239], v[112:115], a[144:147]
    v_mfma_f32_16x16x32_bf16 a[4:7], v[224:227], v[116:119], a[4:7]
    v_mfma_f32_16x16x32_bf16 a[52:55], v[228:231], v[116:119], a[52:55]
    v_mfma_f32_16x16x32_bf16 a[100:103], v[232:235], v[116:119], a[100:103]
    v_mfma_f32_16x16x32_bf16 a[148:151], v[236:239], v[116:119], a[148:151]
    v_mfma_f32_16x16x32_bf16 a[8:11], v[224:227], v[120:123], a[8:11]
    v_mfma_f32_16x16x32_bf16 a[56:59], v[228:231], v[120:123], a[56:59]
    v_mfma_f32_16x16x32_bf16 a[104:107], v[232:235], v[120:123], a[104:107]
    v_mfma_f32_16x16x32_bf16 a[152:155], v[236:239], v[120:123], a[152:155]
    v_mfma_f32_16x16x32_bf16 a[12:15], v[224:227], v[124:127], a[12:15]
    v_mfma_f32_16x16x32_bf16 a[60:63], v[228:231], v[124:127], a[60:63]
    v_mfma_f32_16x16x32_bf16 a[108:111], v[232:235], v[124:127], a[108:111]
    v_mfma_f32_16x16x32_bf16 a[156:159], v[236:239], v[124:127], a[156:159]
    v_mfma_f32_16x16x32_bf16 a[16:19], v[224:227], v[128:131], a[16:19]
    v_mfma_f32_16x16x32_bf16 a[64:67], v[228:231], v[128:131], a[64:67]
    v_mfma_f32_16x16x32_bf16 a[112:115], v[232:235], v[128:131], a[112:115]
    v_mfma_f32_16x16x32_bf16 a[160:163], v[236:239], v[128:131], a[160:163]
    v_mfma_f32_16x16x32_bf16 a[20:23], v[224:227], v[132:135], a[20:23]
    v_mfma_f32_16x16x32_bf16 a[68:71], v[228:231], v[132:135], a[68:71]
    v_mfma_f32_16x16x32_bf16 a[116:119], v[232:235], v[132:135], a[116:119]
    v_mfma_f32_16x16x32_bf16 a[164:167], v[236:239], v[132:135], a[164:167]
    v_mfma_f32_16x16x32_bf16 a[24:27], v[224:227], v[136:139], a[24:27]
    v_mfma_f32_16x16x32_bf16 a[72:75], v[228:231], v[136:139], a[72:75]
    v_mfma_f32_16x16x32_bf16 a[120:123], v[232:235], v[136:139], a[120:123]
    v_mfma_f32_16x16x32_bf16 a[168:171], v[236:239], v[136:139], a[168:171]
    v_mfma_f32_16x16x32_bf16 a[28:31], v[224:227], v[140:143], a[28:31]
    v_mfma_f32_16x16x32_bf16 a[76:79], v[228:231], v[140:143], a[76:79]
    v_mfma_f32_16x16x32_bf16 a[124:127], v[232:235], v[140:143], a[124:127]
    v_mfma_f32_16x16x32_bf16 a[172:175], v[236:239], v[140:143], a[172:175]
    v_mfma_f32_16x16x32_bf16 a[32:35], v[224:227], v[144:147], a[32:35]
    v_mfma_f32_16x16x32_bf16 a[80:83], v[228:231], v[144:147], a[80:83]
    v_mfma_f32_16x16x32_bf16 a[128:131], v[232:235], v[144:147], a[128:131]
    v_mfma_f32_16x16x32_bf16 a[176:179], v[236:239], v[144:147], a[176:179]
    v_mfma_f32_16x16x32_bf16 a[36:39], v[224:227], v[148:151], a[36:39]
    v_mfma_f32_16x16x32_bf16 a[84:87], v[228:231], v[148:151], a[84:87]
    v_mfma_f32_16x16x32_bf16 a[132:135], v[232:235], v[148:151], a[132:135]
    v_mfma_f32_16x16x32_bf16 a[180:183], v[236:239], v[148:151], a[180:183]
    v_mfma_f32_16x16x32_bf16 a[40:43], v[224:227], v[152:155], a[40:43]
    v_mfma_f32_16x16x32_bf16 a[88:91], v[228:231], v[152:155], a[88:91]
    v_mfma_f32_16x16x32_bf16 a[136:139], v[232:235], v[152:155], a[136:139]
    v_mfma_f32_16x16x32_bf16 a[184:187], v[236:239], v[152:155], a[184:187]
    v_mfma_f32_16x16x32_bf16 a[44:47], v[224:227], v[156:159], a[44:47]
    v_mfma_f32_16x16x32_bf16 a[92:95], v[228:231], v[156:159], a[92:95]
    v_mfma_f32_16x16x32_bf16 a[140:143], v[232:235], v[156:159], a[140:143]
    v_mfma_f32_16x16x32_bf16 a[188:191], v[236:239], v[156:159], a[188:191]
    s_add_u32 s48, s48, 24576
    s_cmp_lt_u32 s48, 1572864
    s_nop 7
    s_cbranch_scc1 L_slowloop
    s_nop 1
    v_mfma_f32_16x16x4_f32 v[48:51], v5, v57, 0
    v_mfma_f32_16x16x4_f32 v[52:55], v6, v57, 0
    s_nop 7
    s_nop 1
    v_rcp_f32 v48, v48
    v_rcp_f32 v49, v49
    v_rcp_f32 v50, v50
    v_rcp_f32 v51, v51
    v_rcp_f32 v52, v52
    v_rcp_f32 v53, v53
    v_rcp_f32 v54, v54
    v_rcp_f32 v55, v55
    v_mfma_f32_16x16x4_f32 v[128:131], v7, v57, 0
    v_mfma_f32_16x16x4_f32 v[132:135], v8, v57, 0
    s_nop 7
    s_nop 1
    v_rcp_f32 v128, v128
    v_rcp_f32 v129, v129
    v_rcp_f32 v130, v130
    v_rcp_f32 v131, v131
    v_rcp_f32 v132, v132
    v_rcp_f32 v133, v133
    v_rcp_f32 v134, v134
    v_rcp_f32 v135, v135
    s_nop 0
    v_accvgpr_read_b32 v64, a0
    v_accvgpr_read_b32 v65, a4
    v_accvgpr_read_b32 v66, a8
    v_accvgpr_read_b32 v67, a12
    v_accvgpr_read_b32 v68, a16
    v_accvgpr_read_b32 v69, a20
    v_pk_mul_f32 v[64:65], v[64:65], v[48:49] op_sel_hi:[1,0]
    v_pk_mul_f32 v[66:67], v[66:67], v[48:49] op_sel_hi:[1,0]
    v_pk_mul_f32 v[68:69], v[68:69], v[48:49] op_sel_hi:[1,0]
    v_cvt_pk_bf16_f32 v64, v64, v65
    v_cvt_pk_bf16_f32 v65, v66, v67
    v_cvt_pk_bf16_f32 v66, v68, v69
    v_accvgpr_read_b32 v70, a1
    v_accvgpr_read_b32 v71, a5
    v_accvgpr_read_b32 v72, a9
    v_accvgpr_read_b32 v73, a13
    v_accvgpr_read_b32 v74, a17
    v_accvgpr_read_b32 v75, a21
    v_pk_mul_f32 v[70:71], v[70:71], v[48:49] op_sel:[0,1] op_sel_hi:[1,1]
    v_pk_mul_f32 v[72:73], v[72:73], v[48:49] op_sel:[0,1] op_sel_hi:[1,1]
    v_pk_mul_f32 v[74:75], v[74:75], v[48:49] op_sel:[0,1] op_sel_hi:[1,1]
    v_cvt_pk_bf16_f32 v70, v70, v71
    v_cvt_pk_bf16_f32 v71, v72, v73
    v_cvt_pk_bf16_f32 v72, v74, v75
    buffer_store_dwordx3 v[64:66], v56, s[12:15], s24 offen offset:0 sc0 sc1
    v_accvgpr_read_b32 v76, a2
    v_accvgpr_read_b32 v77, a6
    v_accvgpr_read_b32 v78, a10
    v_accvgpr_read_b32 v79, a14
    v_accvgpr_read_b32 v80, a18
    v_accvgpr_read_b32 v81, a22
    v_pk_mul_f32 v[76:77], v[76:77], v[50:51] op_sel_hi:[1,0]
    v_pk_mul_f32 v[78:79], v[78:79], v[50:51] op_sel_hi:[1,0]
    v_pk_mul_f32 v[80:81], v[80:81], v[50:51] op_sel_hi:[1,0]
    v_cvt_pk_bf16_f32 v76, v76, v77
    v_cvt_pk_bf16_f32 v77, v78, v79
    v_cvt_pk_bf16_f32 v78, v80, v81
    buffer_store_dwordx3 v[70:72], v56, s[12:15], s24 offen offset:384 sc0 sc1
    v_accvgpr_read_b32 v82, a3
    v_accvgpr_read_b32 v83, a7
    v_accvgpr_read_b32 v84, a11
    v_accvgpr_read_b32 v85, a15
    v_accvgpr_read_b32 v86, a19
    v_accvgpr_read_b32 v87, a23
    v_pk_mul_f32 v[82:83], v[82:83], v[50:51] op_sel:[0,1] op_sel_hi:[1,1]
    v_pk_mul_f32 v[84:85], v[84:85], v[50:51] op_sel:[0,1] op_sel_hi:[1,1]
    v_pk_mul_f32 v[86:87], v[86:87], v[50:51] op_sel:[0,1] op_sel_hi:[1,1]
    v_cvt_pk_bf16_f32 v82, v82, v83
    v_cvt_pk_bf16_f32 v83, v84, v85
    v_cvt_pk_bf16_f32 v84, v86, v87
    buffer_store_dwordx3 v[76:78], v56, s[12:15], s24 offen offset:768 sc0 sc1
    v_accvgpr_read_b32 v88, a24
    v_accvgpr_read_b32 v89, a28
    v_accvgpr_read_b32 v90, a32
    v_accvgpr_read_b32 v91, a36
    v_accvgpr_read_b32 v92, a40
    v_accvgpr_read_b32 v93, a44
    v_pk_mul_f32 v[88:89], v[88:89], v[48:49] op_sel_hi:[1,0]
    v_pk_mul_f32 v[90:91], v[90:91], v[48:49] op_sel_hi:[1,0]
    v_pk_mul_f32 v[92:93], v[92:93], v[48:49] op_sel_hi:[1,0]
    v_cvt_pk_bf16_f32 v88, v88, v89
    v_cvt_pk_bf16_f32 v89, v90, v91
    v_cvt_pk_bf16_f32 v90, v92, v93
    buffer_store_dwordx3 v[82:84], v56, s[12:15], s24 offen offset:1152 sc0 sc1
    v_accvgpr_read_b32 v94, a25
    v_accvgpr_read_b32 v95, a29
    v_accvgpr_read_b32 v96, a33
    v_accvgpr_read_b32 v97, a37
    v_accvgpr_read_b32 v98, a41
    v_accvgpr_read_b32 v99, a45
    v_pk_mul_f32 v[94:95], v[94:95], v[48:49] op_sel:[0,1] op_sel_hi:[1,1]
    v_pk_mul_f32 v[96:97], v[96:97], v[48:49] op_sel:[0,1] op_sel_hi:[1,1]
    v_pk_mul_f32 v[98:99], v[98:99], v[48:49] op_sel:[0,1] op_sel_hi:[1,1]
    v_cvt_pk_bf16_f32 v94, v94, v95
    v_cvt_pk_bf16_f32 v95, v96, v97
    v_cvt_pk_bf16_f32 v96, v98, v99
    buffer_store_dwordx3 v[88:90], v56, s[12:15], s24 offen offset:192 sc0 sc1
    v_accvgpr_read_b32 v100, a26
    v_accvgpr_read_b32 v101, a30
    v_accvgpr_read_b32 v102, a34
    v_accvgpr_read_b32 v103, a38
    v_accvgpr_read_b32 v104, a42
    v_accvgpr_read_b32 v105, a46
    v_pk_mul_f32 v[100:101], v[100:101], v[50:51] op_sel_hi:[1,0]
    v_pk_mul_f32 v[102:103], v[102:103], v[50:51] op_sel_hi:[1,0]
    v_pk_mul_f32 v[104:105], v[104:105], v[50:51] op_sel_hi:[1,0]
    v_cvt_pk_bf16_f32 v100, v100, v101
    v_cvt_pk_bf16_f32 v101, v102, v103
    v_cvt_pk_bf16_f32 v102, v104, v105
    buffer_store_dwordx3 v[94:96], v56, s[12:15], s24 offen offset:576 sc0 sc1
    v_accvgpr_read_b32 v106, a27
    v_accvgpr_read_b32 v107, a31
    v_accvgpr_read_b32 v108, a35
    v_accvgpr_read_b32 v109, a39
    v_accvgpr_read_b32 v110, a43
    v_accvgpr_read_b32 v111, a47
    v_pk_mul_f32 v[106:107], v[106:107], v[50:51] op_sel:[0,1] op_sel_hi:[1,1]
    v_pk_mul_f32 v[108:109], v[108:109], v[50:51] op_sel:[0,1] op_sel_hi:[1,1]
    v_pk_mul_f32 v[110:111], v[110:111], v[50:51] op_sel:[0,1] op_sel_hi:[1,1]
    v_cvt_pk_bf16_f32 v106, v106, v107
    v_cvt_pk_bf16_f32 v107, v108, v109
    v_cvt_pk_bf16_f32 v108, v110, v111
    buffer_store_dwordx3 v[100:102], v56, s[12:15], s24 offen offset:960 sc0 sc1
    v_accvgpr_read_b32 v64, a48
    v_accvgpr_read_b32 v65, a52
    v_accvgpr_read_b32 v66, a56
    v_accvgpr_read_b32 v67, a60
    v_accvgpr_read_b32 v68, a64
    v_accvgpr_read_b32 v69, a68
    v_pk_mul_f32 v[64:65], v[64:65], v[52:53] op_sel_hi:[1,0]
    v_pk_mul_f32 v[66:67], v[66:67], v[52:53] op_sel_hi:[1,0]
    v_pk_mul_f32 v[68:69], v[68:69], v[52:53] op_sel_hi:[1,0]
    v_cvt_pk_bf16_f32 v64, v64, v65
    v_cvt_pk_bf16_f32 v65, v66, v67
    v_cvt_pk_bf16_f32 v66, v68, v69
    buffer_store_dwordx3 v[106:108], v56, s[12:15], s24 offen offset:1344 sc0 sc1
    v_accvgpr_read_b32 v70, a49
    v_accvgpr_read_b32 v71, a53
    v_accvgpr_read_b32 v72, a57
    v_accvgpr_read_b32 v73, a61
    v_accvgpr_read_b32 v74, a65
    v_accvgpr_read_b32 v75, a69
    v_pk_mul_f32 v[70:71], v[70:71], v[52:53] op_sel:[0,1] op_sel_hi:[1,1]
    v_pk_mul_f32 v[72:73], v[72:73], v[52:53] op_sel:[0,1] op_sel_hi:[1,1]
    v_pk_mul_f32 v[74:75], v[74:75], v[52:53] op_sel:[0,1] op_sel_hi:[1,1]
    v_cvt_pk_bf16_f32 v70, v70, v71
    v_cvt_pk_bf16_f32 v71, v72, v73
    v_cvt_pk_bf16_f32 v72, v74, v75
    buffer_store_dwordx3 v[64:66], v56, s[12:15], s40 offen offset:0 sc0 sc1
    v_accvgpr_read_b32 v76, a50
    v_accvgpr_read_b32 v77, a54
    v_accvgpr_read_b32 v78, a58
    v_accvgpr_read_b32 v79, a62
    v_accvgpr_read_b32 v80, a66
    v_accvgpr_read_b32 v81, a70
    v_pk_mul_f32 v[76:77], v[76:77], v[54:55] op_sel_hi:[1,0]
    v_pk_mul_f32 v[78:79], v[78:79], v[54:55] op_sel_hi:[1,0]
    v_pk_mul_f32 v[80:81], v[80:81], v[54:55] op_sel_hi:[1,0]
    v_cvt_pk_bf16_f32 v76, v76, v77
    v_cvt_pk_bf16_f32 v77, v78, v79
    v_cvt_pk_bf16_f32 v78, v80, v81
    buffer_store_dwordx3 v[70:72], v56, s[12:15], s40 offen offset:384 sc0 sc1
    v_accvgpr_read_b32 v82, a51
    v_accvgpr_read_b32 v83, a55
    v_accvgpr_read_b32 v84, a59
    v_accvgpr_read_b32 v85, a63
    v_accvgpr_read_b32 v86, a67
    v_accvgpr_read_b32 v87, a71
    v_pk_mul_f32 v[82:83], v[82:83], v[54:55] op_sel:[0,1] op_sel_hi:[1,1]
    v_pk_mul_f32 v[84:85], v[84:85], v[54:55] op_sel:[0,1] op_sel_hi:[1,1]
    v_pk_mul_f32 v[86:87], v[86:87], v[54:55] op_sel:[0,1] op_sel_hi:[1,1]
    v_cvt_pk_bf16_f32 v82, v82, v83
    v_cvt_pk_bf16_f32 v83, v84, v85
    v_cvt_pk_bf16_f32 v84, v86, v87
    buffer_store_dwordx3 v[76:78], v56, s[12:15], s40 offen offset:768 sc0 sc1
    v_accvgpr_read_b32 v88, a72
    v_accvgpr_read_b32 v89, a76
    v_accvgpr_read_b32 v90, a80
    v_accvgpr_read_b32 v91, a84
    v_accvgpr_read_b32 v92, a88
    v_accvgpr_read_b32 v93, a92
    v_pk_mul_f32 v[88:89], v[88:89], v[52:53] op_sel_hi:[1,0]
    v_pk_mul_f32 v[90:91], v[90:91], v[52:53] op_sel_hi:[1,0]
    v_pk_mul_f32 v[92:93], v[92:93], v[52:53] op_sel_hi:[1,0]
    v_cvt_pk_bf16_f32 v88, v88, v89
    v_cvt_pk_bf16_f32 v89, v90, v91
    v_cvt_pk_bf16_f32 v90, v92, v93
    buffer_store_dwordx3 v[82:84], v56, s[12:15], s40 offen offset:1152 sc0 sc1
    v_accvgpr_read_b32 v94, a73
    v_accvgpr_read_b32 v95, a77
    v_accvgpr_read_b32 v96, a81
    v_accvgpr_read_b32 v97, a85
    v_accvgpr_read_b32 v98, a89
    v_accvgpr_read_b32 v99, a93
    v_pk_mul_f32 v[94:95], v[94:95], v[52:53] op_sel:[0,1] op_sel_hi:[1,1]
    v_pk_mul_f32 v[96:97], v[96:97], v[52:53] op_sel:[0,1] op_sel_hi:[1,1]
    v_pk_mul_f32 v[98:99], v[98:99], v[52:53] op_sel:[0,1] op_sel_hi:[1,1]
    v_cvt_pk_bf16_f32 v94, v94, v95
    v_cvt_pk_bf16_f32 v95, v96, v97
    v_cvt_pk_bf16_f32 v96, v98, v99
    buffer_store_dwordx3 v[88:90], v56, s[12:15], s40 offen offset:192 sc0 sc1
    v_accvgpr_read_b32 v100, a74
    v_accvgpr_read_b32 v101, a78
    v_accvgpr_read_b32 v102, a82
    v_accvgpr_read_b32 v103, a86
    v_accvgpr_read_b32 v104, a90
    v_accvgpr_read_b32 v105, a94
    v_pk_mul_f32 v[100:101], v[100:101], v[54:55] op_sel_hi:[1,0]
    v_pk_mul_f32 v[102:103], v[102:103], v[54:55] op_sel_hi:[1,0]
    v_pk_mul_f32 v[104:105], v[104:105], v[54:55] op_sel_hi:[1,0]
    v_cvt_pk_bf16_f32 v100, v100, v101
    v_cvt_pk_bf16_f32 v101, v102, v103
    v_cvt_pk_bf16_f32 v102, v104, v105
    buffer_store_dwordx3 v[94:96], v56, s[12:15], s40 offen offset:576 sc0 sc1
    v_accvgpr_read_b32 v106, a75
    v_accvgpr_read_b32 v107, a79
    v_accvgpr_read_b32 v108, a83
    v_accvgpr_read_b32 v109, a87
    v_accvgpr_read_b32 v110, a91
    v_accvgpr_read_b32 v111, a95
    v_pk_mul_f32 v[106:107], v[106:107], v[54:55] op_sel:[0,1] op_sel_hi:[1,1]
    v_pk_mul_f32 v[108:109], v[108:109], v[54:55] op_sel:[0,1] op_sel_hi:[1,1]
    v_pk_mul_f32 v[110:111], v[110:111], v[54:55] op_sel:[0,1] op_sel_hi:[1,1]
    v_cvt_pk_bf16_f32 v106, v106, v107
    v_cvt_pk_bf16_f32 v107, v108, v109
    v_cvt_pk_bf16_f32 v108, v110, v111
    buffer_store_dwordx3 v[100:102], v56, s[12:15], s40 offen offset:960 sc0 sc1
    v_accvgpr_read_b32 v64, a96
    v_accvgpr_read_b32 v65, a100
    v_accvgpr_read_b32 v66, a104
    v_accvgpr_read_b32 v67, a108
    v_accvgpr_read_b32 v68, a112
    v_accvgpr_read_b32 v69, a116
    v_pk_mul_f32 v[64:65], v[64:65], v[128:129] op_sel_hi:[1,0]
    v_pk_mul_f32 v[66:67], v[66:67], v[128:129] op_sel_hi:[1,0]
    v_pk_mul_f32 v[68:69], v[68:69], v[128:129] op_sel_hi:[1,0]
    v_cvt_pk_bf16_f32 v64, v64, v65
    v_cvt_pk_bf16_f32 v65, v66, v67
    v_cvt_pk_bf16_f32 v66, v68, v69
    buffer_store_dwordx3 v[106:108], v56, s[12:15], s40 offen offset:1344 sc0 sc1
    v_accvgpr_read_b32 v70, a97
    v_accvgpr_read_b32 v71, a101
    v_accvgpr_read_b32 v72, a105
    v_accvgpr_read_b32 v73, a109
    v_accvgpr_read_b32 v74, a113
    v_accvgpr_read_b32 v75, a117
    v_pk_mul_f32 v[70:71], v[70:71], v[128:129] op_sel:[0,1] op_sel_hi:[1,1]
    v_pk_mul_f32 v[72:73], v[72:73], v[128:129] op_sel:[0,1] op_sel_hi:[1,1]
    v_pk_mul_f32 v[74:75], v[74:75], v[128:129] op_sel:[0,1] op_sel_hi:[1,1]
    v_cvt_pk_bf16_f32 v70, v70, v71
    v_cvt_pk_bf16_f32 v71, v72, v73
    v_cvt_pk_bf16_f32 v72, v74, v75
    buffer_store_dwordx3 v[64:66], v56, s[12:15], s41 offen offset:0 sc0 sc1
    v_accvgpr_read_b32 v76, a98
    v_accvgpr_read_b32 v77, a102
    v_accvgpr_read_b32 v78, a106
    v_accvgpr_read_b32 v79, a110
    v_accvgpr_read_b32 v80, a114
    v_accvgpr_read_b32 v81, a118
    v_pk_mul_f32 v[76:77], v[76:77], v[130:131] op_sel_hi:[1,0]
    v_pk_mul_f32 v[78:79], v[78:79], v[130:131] op_sel_hi:[1,0]
    v_pk_mul_f32 v[80:81], v[80:81], v[130:131] op_sel_hi:[1,0]
    v_cvt_pk_bf16_f32 v76, v76, v77
    v_cvt_pk_bf16_f32 v77, v78, v79
    v_cvt_pk_bf16_f32 v78, v80, v81
    buffer_store_dwordx3 v[70:72], v56, s[12:15], s41 offen offset:384 sc0 sc1
    v_accvgpr_read_b32 v82, a99
    v_accvgpr_read_b32 v83, a103
    v_accvgpr_read_b32 v84, a107
    v_accvgpr_read_b32 v85, a111
    v_accvgpr_read_b32 v86, a115
    v_accvgpr_read_b32 v87, a119
    v_pk_mul_f32 v[82:83], v[82:83], v[130:131] op_sel:[0,1] op_sel_hi:[1,1]
    v_pk_mul_f32 v[84:85], v[84:85], v[130:131] op_sel:[0,1] op_sel_hi:[1,1]
    v_pk_mul_f32 v[86:87], v[86:87], v[130:131] op_sel:[0,1] op_sel_hi:[1,1]
    v_cvt_pk_bf16_f32 v82, v82, v83
    v_cvt_pk_bf16_f32 v83, v84, v85
    v_cvt_pk_bf16_f32 v84, v86, v87
    buffer_store_dwordx3 v[76:78], v56, s[12:15], s41 offen offset:768 sc0 sc1
    v_accvgpr_read_b32 v88, a120
    v_accvgpr_read_b32 v89, a124
    v_accvgpr_read_b32 v90, a128
    v_accvgpr_read_b32 v91, a132
    v_accvgpr_read_b32 v92, a136
    v_accvgpr_read_b32 v93, a140
    v_pk_mul_f32 v[88:89], v[88:89], v[128:129] op_sel_hi:[1,0]
    v_pk_mul_f32 v[90:91], v[90:91], v[128:129] op_sel_hi:[1,0]
    v_pk_mul_f32 v[92:93], v[92:93], v[128:129] op_sel_hi:[1,0]
    v_cvt_pk_bf16_f32 v88, v88, v89
    v_cvt_pk_bf16_f32 v89, v90, v91
    v_cvt_pk_bf16_f32 v90, v92, v93
    buffer_store_dwordx3 v[82:84], v56, s[12:15], s41 offen offset:1152 sc0 sc1
    v_accvgpr_read_b32 v94, a121
    v_accvgpr_read_b32 v95, a125
    v_accvgpr_read_b32 v96, a129
    v_accvgpr_read_b32 v97, a133
    v_accvgpr_read_b32 v98, a137
    v_accvgpr_read_b32 v99, a141
    v_pk_mul_f32 v[94:95], v[94:95], v[128:129] op_sel:[0,1] op_sel_hi:[1,1]
    v_pk_mul_f32 v[96:97], v[96:97], v[128:129] op_sel:[0,1] op_sel_hi:[1,1]
    v_pk_mul_f32 v[98:99], v[98:99], v[128:129] op_sel:[0,1] op_sel_hi:[1,1]
    v_cvt_pk_bf16_f32 v94, v94, v95
    v_cvt_pk_bf16_f32 v95, v96, v97
    v_cvt_pk_bf16_f32 v96, v98, v99
    buffer_store_dwordx3 v[88:90], v56, s[12:15], s41 offen offset:192 sc0 sc1
    v_accvgpr_read_b32 v100, a122
    v_accvgpr_read_b32 v101, a126
    v_accvgpr_read_b32 v102, a130
    v_accvgpr_read_b32 v103, a134
    v_accvgpr_read_b32 v104, a138
    v_accvgpr_read_b32 v105, a142
    v_pk_mul_f32 v[100:101], v[100:101], v[130:131] op_sel_hi:[1,0]
    v_pk_mul_f32 v[102:103], v[102:103], v[130:131] op_sel_hi:[1,0]
    v_pk_mul_f32 v[104:105], v[104:105], v[130:131] op_sel_hi:[1,0]
    v_cvt_pk_bf16_f32 v100, v100, v101
    v_cvt_pk_bf16_f32 v101, v102, v103
    v_cvt_pk_bf16_f32 v102, v104, v105
    buffer_store_dwordx3 v[94:96], v56, s[12:15], s41 offen offset:576 sc0 sc1
    v_accvgpr_read_b32 v106, a123
    v_accvgpr_read_b32 v107, a127
    v_accvgpr_read_b32 v108, a131
    v_accvgpr_read_b32 v109, a135
    v_accvgpr_read_b32 v110, a139
    v_accvgpr_read_b32 v111, a143
    v_pk_mul_f32 v[106:107], v[106:107], v[130:131] op_sel:[0,1] op_sel_hi:[1,1]
    v_pk_mul_f32 v[108:109], v[108:109], v[130:131] op_sel:[0,1] op_sel_hi:[1,1]
    v_pk_mul_f32 v[110:111], v[110:111], v[130:131] op_sel:[0,1] op_sel_hi:[1,1]
    v_cvt_pk_bf16_f32 v106, v106, v107
    v_cvt_pk_bf16_f32 v107, v108, v109
    v_cvt_pk_bf16_f32 v108, v110, v111
    buffer_store_dwordx3 v[100:102], v56, s[12:15], s41 offen offset:960 sc0 sc1
    v_accvgpr_read_b32 v64, a144
    v_accvgpr_read_b32 v65, a148
    v_accvgpr_read_b32 v66, a152
    v_accvgpr_read_b32 v67, a156
    v_accvgpr_read_b32 v68, a160
    v_accvgpr_read_b32 v69, a164
    v_pk_mul_f32 v[64:65], v[64:65], v[132:133] op_sel_hi:[1,0]
    v_pk_mul_f32 v[66:67], v[66:67], v[132:133] op_sel_hi:[1,0]
    v_pk_mul_f32 v[68:69], v[68:69], v[132:133] op_sel_hi:[1,0]
    v_cvt_pk_bf16_f32 v64, v64, v65
    v_cvt_pk_bf16_f32 v65, v66, v67
    v_cvt_pk_bf16_f32 v66, v68, v69
    buffer_store_dwordx3 v[106:108], v56, s[12:15], s41 offen offset:1344 sc0 sc1
    v_accvgpr_read_b32 v70, a145
    v_accvgpr_read_b32 v71, a149
    v_accvgpr_read_b32 v72, a153
    v_accvgpr_read_b32 v73, a157
    v_accvgpr_read_b32 v74, a161
    v_accvgpr_read_b32 v75, a165
    v_pk_mul_f32 v[70:71], v[70:71], v[132:133] op_sel:[0,1] op_sel_hi:[1,1]
    v_pk_mul_f32 v[72:73], v[72:73], v[132:133] op_sel:[0,1] op_sel_hi:[1,1]
    v_pk_mul_f32 v[74:75], v[74:75], v[132:133] op_sel:[0,1] op_sel_hi:[1,1]
    v_cvt_pk_bf16_f32 v70, v70, v71
    v_cvt_pk_bf16_f32 v71, v72, v73
    v_cvt_pk_bf16_f32 v72, v74, v75
    buffer_store_dwordx3 v[64:66], v56, s[12:15], s42 offen offset:0 sc0 sc1
    v_accvgpr_read_b32 v76, a146
    v_accvgpr_read_b32 v77, a150
    v_accvgpr_read_b32 v78, a154
    v_accvgpr_read_b32 v79, a158
    v_accvgpr_read_b32 v80, a162
    v_accvgpr_read_b32 v81, a166
    v_pk_mul_f32 v[76:77], v[76:77], v[134:135] op_sel_hi:[1,0]
    v_pk_mul_f32 v[78:79], v[78:79], v[134:135] op_sel_hi:[1,0]
    v_pk_mul_f32 v[80:81], v[80:81], v[134:135] op_sel_hi:[1,0]
    v_cvt_pk_bf16_f32 v76, v76, v77
    v_cvt_pk_bf16_f32 v77, v78, v79
    v_cvt_pk_bf16_f32 v78, v80, v81
    buffer_store_dwordx3 v[70:72], v56, s[12:15], s42 offen offset:384 sc0 sc1
    v_accvgpr_read_b32 v82, a147
    v_accvgpr_read_b32 v83, a151
    v_accvgpr_read_b32 v84, a155
    v_accvgpr_read_b32 v85, a159
    v_accvgpr_read_b32 v86, a163
    v_accvgpr_read_b32 v87, a167
    v_pk_mul_f32 v[82:83], v[82:83], v[134:135] op_sel:[0,1] op_sel_hi:[1,1]
    v_pk_mul_f32 v[84:85], v[84:85], v[134:135] op_sel:[0,1] op_sel_hi:[1,1]
    v_pk_mul_f32 v[86:87], v[86:87], v[134:135] op_sel:[0,1] op_sel_hi:[1,1]
    v_cvt_pk_bf16_f32 v82, v82, v83
    v_cvt_pk_bf16_f32 v83, v84, v85
    v_cvt_pk_bf16_f32 v84, v86, v87
    buffer_store_dwordx3 v[76:78], v56, s[12:15], s42 offen offset:768 sc0 sc1
    v_accvgpr_read_b32 v88, a168
    v_accvgpr_read_b32 v89, a172
    v_accvgpr_read_b32 v90, a176
    v_accvgpr_read_b32 v91, a180
    v_accvgpr_read_b32 v92, a184
    v_accvgpr_read_b32 v93, a188
    v_pk_mul_f32 v[88:89], v[88:89], v[132:133] op_sel_hi:[1,0]
    v_pk_mul_f32 v[90:91], v[90:91], v[132:133] op_sel_hi:[1,0]
    v_pk_mul_f32 v[92:93], v[92:93], v[132:133] op_sel_hi:[1,0]
    v_cvt_pk_bf16_f32 v88, v88, v89
    v_cvt_pk_bf16_f32 v89, v90, v91
    v_cvt_pk_bf16_f32 v90, v92, v93
    buffer_store_dwordx3 v[82:84], v56, s[12:15], s42 offen offset:1152 sc0 sc1
    v_accvgpr_read_b32 v94, a169
    v_accvgpr_read_b32 v95, a173
    v_accvgpr_read_b32 v96, a177
    v_accvgpr_read_b32 v97, a181
    v_accvgpr_read_b32 v98, a185
    v_accvgpr_read_b32 v99, a189
    v_pk_mul_f32 v[94:95], v[94:95], v[132:133] op_sel:[0,1] op_sel_hi:[1,1]
    v_pk_mul_f32 v[96:97], v[96:97], v[132:133] op_sel:[0,1] op_sel_hi:[1,1]
    v_pk_mul_f32 v[98:99], v[98:99], v[132:133] op_sel:[0,1] op_sel_hi:[1,1]
    v_cvt_pk_bf16_f32 v94, v94, v95
    v_cvt_pk_bf16_f32 v95, v96, v97
    v_cvt_pk_bf16_f32 v96, v98, v99
    buffer_store_dwordx3 v[88:90], v56, s[12:15], s42 offen offset:192 sc0 sc1
    v_accvgpr_read_b32 v100, a170
    v_accvgpr_read_b32 v101, a174
    v_accvgpr_read_b32 v102, a178
    v_accvgpr_read_b32 v103, a182
    v_accvgpr_read_b32 v104, a186
    v_accvgpr_read_b32 v105, a190
    v_pk_mul_f32 v[100:101], v[100:101], v[134:135] op_sel_hi:[1,0]
    v_pk_mul_f32 v[102:103], v[102:103], v[134:135] op_sel_hi:[1,0]
    v_pk_mul_f32 v[104:105], v[104:105], v[134:135] op_sel_hi:[1,0]
    v_cvt_pk_bf16_f32 v100, v100, v101
    v_cvt_pk_bf16_f32 v101, v102, v103
    v_cvt_pk_bf16_f32 v102, v104, v105
    buffer_store_dwordx3 v[94:96], v56, s[12:15], s42 offen offset:576 sc0 sc1
    v_accvgpr_read_b32 v106, a171
    v_accvgpr_read_b32 v107, a175
    v_accvgpr_read_b32 v108, a179
    v_accvgpr_read_b32 v109, a183
    v_accvgpr_read_b32 v110, a187
    v_accvgpr_read_b32 v111, a191
    v_pk_mul_f32 v[106:107], v[106:107], v[134:135] op_sel:[0,1] op_sel_hi:[1,1]
    v_pk_mul_f32 v[108:109], v[108:109], v[134:135] op_sel:[0,1] op_sel_hi:[1,1]
    v_pk_mul_f32 v[110:111], v[110:111], v[134:135] op_sel:[0,1] op_sel_hi:[1,1]
    v_cvt_pk_bf16_f32 v106, v106, v107
    v_cvt_pk_bf16_f32 v107, v108, v109
    v_cvt_pk_bf16_f32 v108, v110, v111
    buffer_store_dwordx3 v[100:102], v56, s[12:15], s42 offen offset:960 sc0 sc1
    buffer_store_dwordx3 v[106:108], v56, s[12:15], s42 offen offset:1344 sc0 sc1
    s_branch L_fin
.section .rodata,"a"
.p2align 6
.amdhsa_kernel standalone__kv_cache_quant_int4_int2_kv_with_per_channel_or_per_token_scales__prompt_kernel
  .amdhsa_next_free_vgpr 512
  .amdhsa_next_free_sgpr 102
  .amdhsa_accum_offset 256
  .amdhsa_group_segment_fixed_size 0
  .amdhsa_kernarg_size 80
  .amdhsa_user_sgpr_count 2
  .amdhsa_user_sgpr_kernarg_segment_ptr 1
  .amdhsa_system_sgpr_workgroup_id_x 1
.end_amdhsa_kernel
```

```asm
; @launch grid=(256,1,1) block=(256,1,1) lds=147584
.amdgcn_target "amdgcn-amd-amdhsa--gfx950"
.text
.globl standalone__kv_cache_quant_int4_int2_kv_with_per_channel_or_per_token_scales__prompt_kernel
.p2align 8
.type standalone__kv_cache_quant_int4_int2_kv_with_per_channel_or_per_token_scales__prompt_kernel,@function
standalone__kv_cache_quant_int4_int2_kv_with_per_channel_or_per_token_scales__prompt_kernel:
    s_cmp_ge_u32 s2, 256
    s_cbranch_scc1 L_done
    s_load_dwordx16 s[40:55], s[0:1], 0
    s_load_dwordx4 s[16:19], s[0:1], 64
    s_and_b32 s94, s2, 7
    s_lshr_b32 s95, s2, 3
    s_lshr_b32 s24, s95, 3
    s_lshl_b32 s94, s94, 2
    s_add_u32 s94, s94, s24
    s_and_b32 s95, s95, 7
    s_getpc_b64 s[60:61]
L_pc:
    s_sub_u32 s60, s60, L_pc-standalone__kv_cache_quant_int4_int2_kv_with_per_channel_or_per_token_scales__prompt_kernel
    s_subb_u32 s61, s61, 0
    s_mov_b32 s62, L_slow-standalone__kv_cache_quant_int4_int2_kv_with_per_channel_or_per_token_scales__prompt_kernel
    s_mov_b32 s63, 0x20000
    s_lshr_b32 s22, s2, 3
    s_lshl_b32 s22, s22, 12
    v_lshlrev_b32 v30, 4, v0
    buffer_load_dwordx4 v[128:131], v30, s[60:63], s22 offen
    v_lshrrev_b32 v24, 6, v0
    v_and_b32 v25, 63, v0
    v_readfirstlane_b32 s25, v24
    v_lshlrev_b32 v1, 4, v25
    v_mul_u32_u24 v26, 43, v25
    v_lshrrev_b32 v26, 10, v26
    v_mul_u32_u24 v27, 24, v26
    v_sub_u32 v27, v25, v27
    v_lshrrev_b32 v28, 1, v24
    v_and_b32 v29, 1, v24
    v_lshlrev_b32 v30, 4, v29
    v_lshl_add_u32 v30, v28, 2, v30
    v_add_u32 v30, v30, v26
    v_mul_u32_u24 v30, 768, v30
    v_lshrrev_b32 v48, 1, v26
    v_lshlrev_b32 v48, 30, v48
    v_lshl_add_u32 v30, v27, 4, v30
    v_or_b32 v9, v30, v48
    v_lshl_or_b32 v10, v27, 3, v48
    v_mul_u32_u24 v30, 6144, v24
    v_mul_u32_u24 v31, 12, v25
    v_add_u32 v12, v30, v31
    s_mov_b32 s66, 1572864
    s_mov_b32 s67, 0x20000
    s_mov_b32 s70, 1572864
    s_mov_b32 s71, 0x20000
    s_mov_b32 s74, 12288
    s_mov_b32 s75, 0x20000
    s_mov_b32 s78, 12288
    s_mov_b32 s79, 0x20000
    s_mov_b32 s82, 4096
    s_mov_b32 s83, 0x20000
    s_mov_b32 s86, 4096
    s_mov_b32 s87, 0x20000
    s_mov_b32 s22, 64
    s_mov_b32 s23, 0x20000
    s_mul_i32 s33, s95, 24576
    s_add_u32 s34, s33, 6144
    s_mov_b32 s35, s33
    s_lshr_b32 s36, s95, 1
    s_mul_i32 s36, s36, 384
    s_lshl_b32 s37, s95, 6
    s_lshl_b32 s24, s25, 4
    s_add_u32 s37, s37, s24
    s_mul_i32 s24, s94, 1572864
    s_mul_i32 s56, s94, 12288
    s_lshl_b32 s57, s94, 12
    s_lshl_b32 s58, s94, 10
    s_add_u32 s58, s58, 51380320
    s_or_b32 s39, s95, s25
    s_waitcnt lgkmcnt(0)
    s_add_u32 s64, s42, s24
    s_addc_u32 s65, s43, 0
    s_add_u32 s72, s46, s56
    s_addc_u32 s73, s47, 0
    s_add_u32 s76, s48, s56
    s_addc_u32 s77, s49, 0
    buffer_load_dwordx4 v[224:227], v9, s[64:67], s33 offen offset:0 nt
    buffer_load_dwordx4 v[228:231], v9, s[64:67], s33 offen offset:1536 nt
    buffer_load_dwordx4 v[232:235], v9, s[64:67], s34 offen offset:0 nt
    buffer_load_dwordx4 v[236:239], v9, s[64:67], s34 offen offset:1536 nt
    buffer_load_dwordx2 v[32:33], v10, s[72:75], s36 offen offset:0
    buffer_load_dwordx2 v[34:35], v10, s[76:79], s36 offen offset:0
    buffer_load_dwordx2 v[36:37], v10, s[72:75], s36 offen offset:192
    buffer_load_dwordx2 v[38:39], v10, s[76:79], s36 offen offset:192
    s_add_u32 s20, s18, s58
    s_addc_u32 s21, s19, 0
    s_add_u32 s80, s50, s57
    s_addc_u32 s81, s51, 0
    s_add_u32 s84, s52, s57
    s_addc_u32 s85, s53, 0
    s_add_u32 s68, s44, s24
    s_addc_u32 s69, s45, 0
    s_mul_i32 s59, s94, 786432
    s_add_u32 s12, s54, s59
    s_addc_u32 s13, s55, 0
    s_add_u32 s8, s40, s59
    s_addc_u32 s9, s41, 0
    s_cmp_lg_u32 s39, 0
    s_cbranch_scc1 L_notleader0
    s_buffer_load_dwordx16 s[40:55], s[20:23], 0 glc
L_notleader0:
    buffer_load_dwordx4 v[240:243], v9, s[64:67], s33 offen offset:384 nt
    buffer_load_dwordx4 v[244:247], v9, s[64:67], s33 offen offset:1920 nt
    buffer_load_dwordx4 v[248:251], v9, s[64:67], s34 offen offset:384 nt
    buffer_load_dwordx4 v[252:255], v9, s[64:67], s34 offen offset:1920 nt
    s_add_u32 s4, s18, s24
    s_addc_u32 s5, s19, 0
    s_mov_b32 s6, 1572864
    s_mov_b32 s7, 0x20000
    s_mov_b32 s10, 786432
    s_mov_b32 s11, 0x20000
    s_mov_b32 s88, s16
    s_mov_b32 s89, s17
    s_add_u32 s16, s33, 3072
    s_add_u32 s17, s33, 6144
    s_mov_b32 s90, 256
    s_mov_b32 s91, 0x20000
    s_lshl_b32 s93, s94, 3
    s_cmp_lg_u32 s39, 0
    s_cbranch_scc1 L_notleader
    s_waitcnt lgkmcnt(0)
    s_mov_b32 s59, 1
    s_lshr_b32 s40, s40, 10
    s_min_u32 s40, s40, 31
    s_bitset1_b32 s59, s40
    s_lshr_b32 s41, s41, 10
    s_min_u32 s41, s41, 31
    s_bitset1_b32 s59, s41
    s_lshr_b32 s42, s42, 10
    s_min_u32 s42, s42, 31
    s_bitset1_b32 s59, s42
    s_lshr_b32 s43, s43, 10
    s_min_u32 s43, s43, 31
    s_bitset1_b32 s59, s43
    s_lshr_b32 s44, s44, 10
    s_min_u32 s44, s44, 31
    s_bitset1_b32 s59, s44
    s_lshr_b32 s45, s45, 10
    s_min_u32 s45, s45, 31
    s_bitset1_b32 s59, s45
    s_lshr_b32 s46, s46, 10
    s_min_u32 s46, s46, 31
    s_bitset1_b32 s59, s46
    s_lshr_b32 s47, s47, 10
    s_min_u32 s47, s47, 31
    s_bitset1_b32 s59, s47
    s_lshr_b32 s48, s48, 10
    s_min_u32 s48, s48, 31
    s_bitset1_b32 s59, s48
    s_lshr_b32 s49, s49, 10
    s_min_u32 s49, s49, 31
    s_bitset1_b32 s59, s49
    s_lshr_b32 s50, s50, 10
    s_min_u32 s50, s50, 31
    s_bitset1_b32 s59, s50
    s_lshr_b32 s51, s51, 10
    s_min_u32 s51, s51, 31
    s_bitset1_b32 s59, s51
    s_lshr_b32 s52, s52, 10
    s_min_u32 s52, s52, 31
    s_bitset1_b32 s59, s52
    s_lshr_b32 s53, s53, 10
    s_min_u32 s53, s53, 31
    s_bitset1_b32 s59, s53
    s_lshr_b32 s54, s54, 10
    s_min_u32 s54, s54, 31
    s_bitset1_b32 s59, s54
    s_lshr_b32 s55, s55, 10
    s_min_u32 s55, s55, 31
    s_bitset1_b32 s59, s55
    s_ff0_i32_b32 s59, s59
    s_lshl_b32 s59, s59, 10
    v_mov_b32 v52, s59
    s_mov_b64 exec, 1
    buffer_store_dword v52, off, s[88:91], s93 sc1
    s_mov_b64 exec, -1
L_notleader:
    s_lshl_b32 s24, s95, 2
    s_add_u32 s24, s24, 32
    s_buffer_load_dword s46, s[20:23], s24 glc
    s_getreg_b32 s45, hwreg(HW_REG_XCC_ID, 0, 4)
    s_lshl_b32 s45, s45, 5
    s_mov_b32 s44, 32
    buffer_load_dwordx3 v[112:114], v12, s[68:71], s35 offen offset:0 nt
    buffer_load_dwordx3 v[116:118], v12, s[68:71], s35 offen offset:768 nt
    buffer_load_dwordx3 v[120:122], v12, s[68:71], s35 offen offset:1536 nt
    buffer_load_dwordx3 v[124:126], v12, s[68:71], s35 offen offset:2304 nt
    buffer_load_dwordx2 v[40:41], off, s[80:83], s37 offset:0
    buffer_load_dwordx2 v[42:43], off, s[84:87], s37 offset:0
    buffer_load_dwordx2 v[44:45], off, s[80:83], s37 offset:8
    buffer_load_dwordx2 v[46:47], off, s[84:87], s37 offset:8
    s_mov_b32 s14, 786432
    s_mov_b32 s15, 0x20000
    s_lshl_b32 s24, s25, 8
    s_add_u32 s93, s93, s24
    v_mul_u32_u24 v30, 3072, v24
    v_add_u32 v4, v30, v1
    v_lshl_add_u32 v30, v24, 3, v26
    v_mul_u32_u24 v30, 384, v30
    v_lshlrev_b32 v31, 2, v29
    v_xor_b32 v31, v27, v31
    v_lshl_add_u32 v30, v31, 4, v30
    v_or_b32 v11, v30, v48
    v_lshlrev_b32 v30, 8, v24
    v_add_u32 v30, 12288, v30
    v_lshrrev_b32 v31, 5, v25
    v_mul_u32_u24 v31, 6144, v31
    v_add_u32 v30, v30, v31
    v_and_b32 v31, 1, v25
    v_mul_u32_u24 v31, 3072, v31
    v_add_u32 v30, v30, v31
    v_bfe_u32 v31, v25, 1, 4
    v_lshl_add_u32 v15, v31, 4, v30
    s_lshl_b32 s24, s95, 2
    v_lshl_add_u32 v13, v0, 2, s24
    v_cmp_lt_u32 vcc, 0, v0
    v_mov_b32 v30, 0x40000000
    s_nop 0
    v_cndmask_b32 v13, v13, v30, vcc
    s_mul_i32 s26, s25, 3072
    s_add_u32 s26, s26, 12288
    s_add_u32 s56, s26, 24576
    s_add_u32 s24, s95, 1
    s_and_b32 s24, s24, 7
    s_mul_i32 s32, s24, 24576
    s_add_u32 s27, s32, 12288
    s_mov_b32 s28, 98304
    s_mov_b32 s30, 73728
    v_add_u32 v1, 24576, v1
    s_mov_b32 s38, 0x3dd53b95
    s_mov_b32 s97, 0xffff0000
    s_mov_b32 s96, 100000
    v_and_b32 v26, 15, v25
    v_lshrrev_b32 v27, 4, v25
    v_bfe_u32 v28, v25, 1, 3
    v_xor_b32 v29, v27, v28
    v_mul_u32_u24 v30, 384, v26
    v_lshl_add_u32 v2, v29, 4, v30
    v_xor_b32 v3, 64, v2
    s_mul_i32 s40, s25, 6144
    s_add_u32 s40, s40, 73728
    v_lshrrev_b32 v29, 1, v27
    v_xor_b32 v29, v29, v28
    v_lshl_add_u32 v31, v29, 4, v30
    v_and_b32 v29, 1, v27
    v_lshl_add_u32 v31, v29, 3, v31
    v_xor_b32 v22, 0, v31
    v_add_u32 v22, s40, v22
    v_xor_b32 v23, 32, v31
    v_add_u32 v23, s40, v23
    v_xor_b32 v142, 64, v31
    v_add_u32 v142, s40, v142
    v_xor_b32 v143, 96, v31
    v_add_u32 v143, s40, v143
    s_lshl_b32 s24, s95, 2
    s_add_u32 s24, s24, s25
    s_mul_i32 s24, s24, 24576
    v_add_u32 v26, 0, v25
    v_mul_u32_u24 v27, 2731, v26
    v_lshrrev_b32 v27, 17, v27
    v_and_b32 v27, 7, v27
    v_xor_b32 v26, v26, v27
    v_lshlrev_b32 v136, 4, v26
    v_add_u32 v136, s24, v136
    v_add_u32 v26, 64, v25
    v_mul_u32_u24 v27, 2731, v26
    v_lshrrev_b32 v27, 17, v27
    v_and_b32 v27, 7, v27
    v_xor_b32 v26, v26, v27
    v_lshlrev_b32 v137, 4, v26
    v_add_u32 v137, s24, v137
    v_add_u32 v26, 128, v25
    v_mul_u32_u24 v27, 2731, v26
    v_lshrrev_b32 v27, 17, v27
    v_and_b32 v27, 7, v27
    v_xor_b32 v26, v26, v27
    v_lshlrev_b32 v138, 4, v26
    v_add_u32 v138, s24, v138
    v_add_u32 v26, 192, v25
    v_mul_u32_u24 v27, 2731, v26
    v_lshrrev_b32 v27, 17, v27
    v_and_b32 v27, 7, v27
    v_xor_b32 v26, v26, v27
    v_lshlrev_b32 v139, 4, v26
    v_add_u32 v139, s24, v139
    v_add_u32 v26, 256, v25
    v_mul_u32_u24 v27, 2731, v26
    v_lshrrev_b32 v27, 17, v27
    v_and_b32 v27, 7, v27
    v_xor_b32 v26, v26, v27
    v_lshlrev_b32 v140, 4, v26
    v_add_u32 v140, s24, v140
    v_add_u32 v26, 320, v25
    v_mul_u32_u24 v27, 2731, v26
    v_lshrrev_b32 v27, 17, v27
    v_and_b32 v27, 7, v27
    v_xor_b32 v26, v26, v27
    v_lshlrev_b32 v141, 4, v26
    v_add_u32 v141, s24, v141
    v_mov_b32 v5, 0
    v_mov_b32 v6, 0
    v_mov_b32 v7, 0
    v_mov_b32 v8, 0
    s_mov_b32 s62, -1
    s_mov_b32 s63, 0xffff
    s_waitcnt vmcnt(12)
    s_bitcmp1_b32 s2, 0
    s_cbranch_scc1 L_thr1
    s_waitcnt vmcnt(9)
L_thr1:
    buffer_load_dwordx3 v[80:82], v12, s[68:71], s16 offen offset:0 nt
    s_bitcmp1_b32 s2, 0
    s_cbranch_scc1 L_thr2
    s_waitcnt vmcnt(9)
L_thr2:
    buffer_load_dwordx3 v[84:86], v12, s[68:71], s16 offen offset:768 nt
    s_bitcmp1_b32 s2, 0
    s_cbranch_scc1 L_thr3
    s_waitcnt vmcnt(9)
L_thr3:
    buffer_load_dwordx3 v[88:90], v12, s[68:71], s16 offen offset:1536 nt
    s_bitcmp1_b32 s2, 0
    s_cbranch_scc1 L_thr4
    s_waitcnt vmcnt(9)
L_thr4:
    buffer_load_dwordx3 v[92:94], v12, s[68:71], s16 offen offset:2304 nt
    v_lshlrev_b32 v48, 16, v32
    v_and_b32 v49, s97, v32
    v_lshlrev_b32 v50, 16, v34
    v_and_b32 v51, s97, v34
    v_mul_f32 v48, s38, v48
    v_mul_f32 v49, s38, v49
    v_mul_f32_e64 v50, -v50, v48
    v_mul_f32_e64 v51, -v51, v49
    v_cvt_f32_i32 v224, v224
    v_cvt_f32_i32 v225, v225
    v_fma_f32 v224, v224, v48, v50
    v_fma_f32 v225, v225, v49, v51
    v_cvt_pk_bf16_f32 v224, v224, v225
    v_cvt_f32_i32 v228, v228
    v_cvt_f32_i32 v229, v229
    v_fma_f32 v228, v228, v48, v50
    v_fma_f32 v229, v229, v49, v51
    v_cvt_pk_bf16_f32 v228, v228, v229
    v_cvt_f32_i32 v232, v232
    v_cvt_f32_i32 v233, v233
    v_fma_f32 v232, v232, v48, v50
    v_fma_f32 v233, v233, v49, v51
    v_cvt_pk_bf16_f32 v232, v232, v233
    v_cvt_f32_i32 v236, v236
    v_cvt_f32_i32 v237, v237
    v_fma_f32 v236, v236, v48, v50
    v_fma_f32 v237, v237, v49, v51
    v_cvt_pk_bf16_f32 v236, v236, v237
    v_lshlrev_b32 v48, 16, v33
    v_and_b32 v49, s97, v33
    v_lshlrev_b32 v50, 16, v35
    v_and_b32 v51, s97, v35
    v_mul_f32 v48, s38, v48
    v_mul_f32 v49, s38, v49
    v_mul_f32_e64 v50, -v50, v48
    v_mul_f32_e64 v51, -v51, v49
    v_cvt_f32_i32 v226, v226
    v_cvt_f32_i32 v227, v227
    v_fma_f32 v226, v226, v48, v50
    v_fma_f32 v227, v227, v49, v51
    v_cvt_pk_bf16_f32 v225, v226, v227
    v_cvt_f32_i32 v230, v230
    v_cvt_f32_i32 v231, v231
    v_fma_f32 v230, v230, v48, v50
    v_fma_f32 v231, v231, v49, v51
    v_cvt_pk_bf16_f32 v229, v230, v231
    v_cvt_f32_i32 v234, v234
    v_cvt_f32_i32 v235, v235
    v_fma_f32 v234, v234, v48, v50
    v_fma_f32 v235, v235, v49, v51
    v_cvt_pk_bf16_f32 v233, v234, v235
    v_cvt_f32_i32 v238, v238
    v_cvt_f32_i32 v239, v239
    v_fma_f32 v238, v238, v48, v50
    v_fma_f32 v239, v239, v49, v51
    v_cvt_pk_bf16_f32 v237, v238, v239
    s_waitcnt vmcnt(12)
    v_lshlrev_b32 v48, 16, v36
    v_and_b32 v49, s97, v36
    v_lshlrev_b32 v50, 16, v38
    v_and_b32 v51, s97, v38
    v_mul_f32 v48, s38, v48
    v_mul_f32 v49, s38, v49
    v_mul_f32_e64 v50, -v50, v48
    v_mul_f32_e64 v51, -v51, v49
    v_cvt_f32_i32 v240, v240
    v_cvt_f32_i32 v241, v241
    v_fma_f32 v240, v240, v48, v50
    v_fma_f32 v241, v241, v49, v51
    v_cvt_pk_bf16_f32 v226, v240, v241
    v_cvt_f32_i32 v244, v244
    v_cvt_f32_i32 v245, v245
    v_fma_f32 v244, v244, v48, v50
    v_fma_f32 v245, v245, v49, v51
    v_cvt_pk_bf16_f32 v230, v244, v245
    v_cvt_f32_i32 v248, v248
    v_cvt_f32_i32 v249, v249
    v_fma_f32 v248, v248, v48, v50
    v_fma_f32 v249, v249, v49, v51
    v_cvt_pk_bf16_f32 v234, v248, v249
    v_cvt_f32_i32 v252, v252
    v_cvt_f32_i32 v253, v253
    v_fma_f32 v252, v252, v48, v50
    v_fma_f32 v253, v253, v49, v51
    v_cvt_pk_bf16_f32 v238, v252, v253
    v_lshlrev_b32 v48, 16, v37
    v_and_b32 v49, s97, v37
    v_lshlrev_b32 v50, 16, v39
    v_and_b32 v51, s97, v39
    v_mul_f32 v48, s38, v48
    v_mul_f32 v49, s38, v49
    v_mul_f32_e64 v50, -v50, v48
    v_mul_f32_e64 v51, -v51, v49
    v_cvt_f32_i32 v242, v242
    v_cvt_f32_i32 v243, v243
    v_fma_f32 v242, v242, v48, v50
    v_fma_f32 v243, v243, v49, v51
    v_cvt_pk_bf16_f32 v227, v242, v243
    v_cvt_f32_i32 v246, v246
    v_cvt_f32_i32 v247, v247
    v_fma_f32 v246, v246, v48, v50
    v_fma_f32 v247, v247, v49, v51
    v_cvt_pk_bf16_f32 v231, v246, v247
    v_cvt_f32_i32 v250, v250
    v_cvt_f32_i32 v251, v251
    v_fma_f32 v250, v250, v48, v50
    v_fma_f32 v251, v251, v49, v51
    v_cvt_pk_bf16_f32 v235, v250, v251
    v_cvt_f32_i32 v254, v254
    v_cvt_f32_i32 v255, v255
    v_fma_f32 v254, v254, v48, v50
    v_fma_f32 v255, v255, v49, v51
    v_cvt_pk_bf16_f32 v239, v254, v255
    buffer_store_dwordx4 v[224:227], v11, s[4:7], s33 offen offset:0
    s_mov_b64 exec, s[62:63]
    ds_write_b128 v11, v[224:227] offset:0
    s_mov_b64 exec, -1
    v_xor_b32 v55, 16, v11
    buffer_store_dwordx4 v[228:231], v55, s[4:7], s33 offen offset:768
    s_mov_b64 exec, s[62:63]
    ds_write_b128 v55, v[228:231] offset:768
    s_mov_b64 exec, -1
    v_xor_b32 v54, 32, v11
    buffer_store_dwordx4 v[232:235], v54, s[4:7], s33 offen offset:1536
    s_mov_b64 exec, s[62:63]
    ds_write_b128 v54, v[232:235] offset:1536
    s_mov_b64 exec, -1
    v_xor_b32 v55, 48, v11
    buffer_store_dwordx4 v[236:239], v55, s[4:7], s33 offen offset:2304
    s_mov_b64 exec, s[62:63]
    ds_write_b128 v55, v[236:239] offset:2304
    s_mov_b64 exec, -1
    s_mov_b32 s41, 0
    s_add_u32 m0, s40, 24576
    s_nop 0
    s_bitcmp1_b32 s2, 0
    s_cbranch_scc1 L_thr5
    s_waitcnt vmcnt(12)
L_thr5:
    buffer_load_dwordx4 v136, s[8:11], s41 offen nt lds
    s_add_u32 m0, s40, 25600
    s_nop 0
    s_bitcmp1_b32 s2, 0
    s_cbranch_scc1 L_thr6
    s_waitcnt vmcnt(9)
L_thr6:
    buffer_load_dwordx4 v137, s[8:11], s41 offen nt lds
    s_add_u32 m0, s40, 26624
    s_nop 0
    s_bitcmp1_b32 s2, 0
    s_cbranch_scc1 L_thr7
    s_waitcnt vmcnt(8)
L_thr7:
    buffer_load_dwordx4 v138, s[8:11], s41 offen nt lds
    s_add_u32 m0, s40, 27648
    s_nop 0
    s_bitcmp1_b32 s2, 0
    s_cbranch_scc1 L_thr8
    s_waitcnt vmcnt(8)
L_thr8:
    buffer_load_dwordx4 v139, s[8:11], s41 offen nt lds
    s_add_u32 m0, s40, 28672
    s_nop 0
    s_bitcmp1_b32 s2, 0
    s_cbranch_scc1 L_thr9
    s_waitcnt vmcnt(8)
L_thr9:
    buffer_load_dwordx4 v140, s[8:11], s41 offen nt lds
    s_add_u32 m0, s40, 29696
    s_waitcnt vmcnt(20)
    s_bitcmp1_b32 s2, 0
    s_cbranch_scc1 L_thr10
    s_waitcnt vmcnt(4)
L_thr10:
    buffer_load_dwordx4 v141, s[8:11], s41 offen nt lds
    s_waitcnt vmcnt(14)
    v_lshlrev_b32 v48, 16, v40
    v_and_b32 v49, s97, v40
    v_lshlrev_b32 v50, 16, v42
    v_and_b32 v51, s97, v42
    v_mul_f32_e64 v50, -v50, v48
    v_mul_f32_e64 v51, -v51, v49
    v_cvt_f32_i32 v112, v112
    v_cvt_f32_i32 v116, v116
    v_fma_f32 v112, v112, v48, v50
    v_fma_f32 v116, v116, v49, v51
    v_cvt_f32_i32 v113, v113
    v_cvt_f32_i32 v117, v117
    v_fma_f32 v113, v113, v48, v50
    v_fma_f32 v117, v117, v49, v51
    v_cvt_f32_i32 v114, v114
    v_cvt_f32_i32 v118, v118
    v_fma_f32 v114, v114, v48, v50
    v_fma_f32 v118, v118, v49, v51
    v_lshlrev_b32 v48, 16, v41
    v_and_b32 v49, s97, v41
    v_lshlrev_b32 v50, 16, v43
    v_and_b32 v51, s97, v43
    v_mul_f32_e64 v50, -v50, v48
    v_mul_f32_e64 v51, -v51, v49
    v_cvt_f32_i32 v120, v120
    v_cvt_f32_i32 v124, v124
    v_fma_f32 v120, v120, v48, v50
    v_fma_f32 v124, v124, v49, v51
    v_cvt_f32_i32 v121, v121
    v_cvt_f32_i32 v125, v125
    v_fma_f32 v121, v121, v48, v50
    v_fma_f32 v125, v125, v49, v51
    v_cvt_f32_i32 v122, v122
    v_cvt_f32_i32 v126, v126
    v_fma_f32 v122, v122, v48, v50
    v_fma_f32 v126, v126, v49, v51
    v_cvt_pk_bf16_f32 v112, v112, v116
    v_cvt_pk_bf16_f32 v116, v113, v117
    v_cvt_pk_bf16_f32 v113, v120, v124
    v_cvt_pk_bf16_f32 v117, v121, v125
    v_cvt_pk_bf16_f32 v120, v114, v118
    v_cvt_pk_bf16_f32 v121, v122, v126
    s_waitcnt vmcnt(10)
    v_lshlrev_b32 v48, 16, v44
    v_and_b32 v49, s97, v44
    v_lshlrev_b32 v50, 16, v46
    v_and_b32 v51, s97, v46
    v_mul_f32_e64 v50, -v50, v48
    v_mul_f32_e64 v51, -v51, v49
    v_cvt_f32_i32 v80, v80
    v_cvt_f32_i32 v84, v84
    v_fma_f32 v80, v80, v48, v50
    v_fma_f32 v84, v84, v49, v51
    v_cvt_f32_i32 v81, v81
    v_cvt_f32_i32 v85, v85
    v_fma_f32 v81, v81, v48, v50
    v_fma_f32 v85, v85, v49, v51
    v_cvt_f32_i32 v82, v82
    v_cvt_f32_i32 v86, v86
    v_fma_f32 v82, v82, v48, v50
    v_fma_f32 v86, v86, v49, v51
    v_lshlrev_b32 v48, 16, v45
    v_and_b32 v49, s97, v45
    v_lshlrev_b32 v50, 16, v47
    v_and_b32 v51, s97, v47
    v_mul_f32_e64 v50, -v50, v48
    v_mul_f32_e64 v51, -v51, v49
    v_cvt_f32_i32 v88, v88
    v_cvt_f32_i32 v92, v92
    v_fma_f32 v88, v88, v48, v50
    v_fma_f32 v92, v92, v49, v51
    v_cvt_f32_i32 v89, v89
    v_cvt_f32_i32 v93, v93
    v_fma_f32 v89, v89, v48, v50
    v_fma_f32 v93, v93, v49, v51
    v_cvt_f32_i32 v90, v90
    v_cvt_f32_i32 v94, v94
    v_fma_f32 v90, v90, v48, v50
    v_fma_f32 v94, v94, v49, v51
    v_cvt_pk_bf16_f32 v114, v80, v84
    v_cvt_pk_bf16_f32 v118, v81, v85
    v_cvt_pk_bf16_f32 v115, v88, v92
    v_cvt_pk_bf16_f32 v119, v89, v93
    v_cvt_pk_bf16_f32 v122, v82, v86
    v_cvt_pk_bf16_f32 v123, v90, v94
    buffer_store_dwordx4 v[112:115], v15, s[4:7], s35 offen offset:0
    buffer_store_dwordx4 v[116:119], v15, s[4:7], s35 offen offset:1024
    buffer_store_dwordx4 v[120:123], v15, s[4:7], s35 offen offset:2048
    ds_write_b128 v15, v[112:115] offset:12288
    ds_write_b128 v15, v[116:119] offset:13312
    ds_write_b128 v15, v[120:123] offset:14336
    s_bitcmp1_b32 s2, 0
    s_cbranch_scc1 L_thr11
    s_waitcnt vmcnt(7)
L_thr11:
    buffer_load_dword v0, off, s[88:91], s93 sc1
    s_mov_b32 s41, 6144
    s_add_u32 m0, s40, 0
    s_nop 0
    s_bitcmp1_b32 s2, 0
    s_cbranch_scc1 L_thr12
    s_waitcnt vmcnt(7)
L_thr12:
    buffer_load_dwordx4 v136, s[8:11], s41 offen nt lds
    s_add_u32 m0, s40, 1024
    s_nop 0
    s_bitcmp1_b32 s2, 0
    s_cbranch_scc1 L_thr13
    s_waitcnt vmcnt(7)
L_thr13:
    buffer_load_dwordx4 v137, s[8:11], s41 offen nt lds
    s_add_u32 m0, s40, 2048
    s_nop 0
    s_bitcmp1_b32 s2, 0
    s_cbranch_scc1 L_thr14
    s_waitcnt vmcnt(7)
L_thr14:
    buffer_load_dwordx4 v138, s[8:11], s41 offen nt lds
    s_add_u32 m0, s40, 3072
    s_nop 0
    s_bitcmp1_b32 s2, 0
    s_cbranch_scc1 L_thr15
    s_waitcnt vmcnt(7)
L_thr15:
    buffer_load_dwordx4 v139, s[8:11], s41 offen nt lds
    s_add_u32 m0, s40, 4096
    s_nop 0
    s_bitcmp1_b32 s2, 0
    s_cbranch_scc1 L_thr16
    s_waitcnt vmcnt(4)
L_thr16:
    buffer_load_dwordx4 v140, s[8:11], s41 offen nt lds
    s_add_u32 m0, s40, 5120
    s_waitcnt vmcnt(14)
    s_bitcmp1_b32 s2, 0
    s_cbranch_scc1 L_thr17
    s_waitcnt vmcnt(4)
L_thr17:
    buffer_load_dwordx4 v141, s[8:11], s41 offen nt lds
    s_mov_b32 s41, 12288
    s_add_u32 m0, s40, 49152
    s_waitcnt vmcnt(14)
    s_bitcmp1_b32 s2, 0
    s_cbranch_scc1 L_thr18
    s_waitcnt vmcnt(4)
L_thr18:
    buffer_load_dwordx4 v136, s[8:11], s41 offen nt lds
    s_add_u32 m0, s40, 50176
    s_waitcnt vmcnt(14)
    s_bitcmp1_b32 s2, 0
    s_cbranch_scc1 L_thr19
    s_waitcnt vmcnt(4)
L_thr19:
    buffer_load_dwordx4 v137, s[8:11], s41 offen nt lds
    s_add_u32 m0, s40, 51200
    s_waitcnt vmcnt(14)
    s_bitcmp1_b32 s2, 0
    s_cbranch_scc1 L_thr20
    s_waitcnt vmcnt(4)
L_thr20:
    buffer_load_dwordx4 v138, s[8:11], s41 offen nt lds
    s_mov_b64 exec, 0
    s_cmp_eq_u32 s25, 0
    s_cbranch_scc1 L_iw0
    s_cmp_eq_u32 s25, 1
    s_cbranch_scc1 L_iw1
    s_cmp_eq_u32 s25, 2
    s_cbranch_scc1 L_iw2
    s_branch L_iw3
L_iwret:
    s_mov_b64 exec, -1
    s_waitcnt vmcnt(9)
    s_cmp_lg_u32 s25, 0
    s_cbranch_scc1 L_tagdone
    v_readfirstlane_b32 s42, v0
    s_mov_b32 s39, 100
    s_waitcnt lgkmcnt(0)
    s_and_b32 s46, s46, 0xfffffc00
L_tagretry:
    s_cmp_eq_u32 s42, s46
    s_cselect_b32 s42, 0, s42
    s_cmp_lg_u32 s42, 0
    s_cbranch_scc1 L_tagok
    s_sub_u32 s39, s39, 1
    s_cbranch_scc1 L_tagslow
    s_sleep 4
    s_buffer_load_dword s42, s[88:91], s93 glc
    s_waitcnt lgkmcnt(0)
    s_branch L_tagretry
L_tagok:
    s_add_u32 s42, s42, s45
    v_mov_b32 v0, s42
    v_mov_b32 v16, 147456
    ds_write_b32 v16, v0
L_tagdone:
    s_waitcnt lgkmcnt(0)
    s_barrier
    v_add_u32 v0, 1, v0
    buffer_store_dword v0, v13, s[20:23], 0 offen offset:32 sc1
    v_mov_b32 v16, 147456
    ds_read_b32 v17, v16
    ds_read_b128 v[144:147], v2 offset:0
    ds_read_b128 v[148:151], v3 offset:0
    ds_read_b128 v[152:155], v2 offset:6144
    ds_read_b128 v[156:159], v3 offset:6144
    ds_read_b128 v[160:163], v2 offset:128
    ds_read_b128 v[164:167], v3 offset:128
    ds_read_b128 v[168:171], v2 offset:6272
    ds_read_b128 v[172:175], v3 offset:6272
    ds_read_b128 v[176:179], v2 offset:256
    ds_read_b128 v[180:183], v3 offset:256
    ds_read_b128 v[184:187], v2 offset:6400
    ds_read_b128 v[188:191], v3 offset:6400
    s_mov_b32 s41, 12288
    s_add_u32 m0, s40, 52224
    s_nop 0
    s_bitcmp1_b32 s2, 0
    s_cbranch_scc1 L_thr21
    s_waitcnt vmcnt(5)
L_thr21:
    buffer_load_dwordx4 v139, s[8:11], s41 offen nt lds
    s_add_u32 m0, s40, 53248
    s_nop 0
    s_bitcmp1_b32 s2, 0
    s_cbranch_scc1 L_thr22
    s_waitcnt vmcnt(5)
L_thr22:
    buffer_load_dwordx4 v140, s[8:11], s41 offen nt lds
    s_add_u32 m0, s40, 54272
    s_nop 0
    s_bitcmp1_b32 s2, 0
    s_cbranch_scc1 L_thr23
    s_waitcnt vmcnt(5)
L_thr23:
    buffer_load_dwordx4 v141, s[8:11], s41 offen nt lds
    s_waitcnt vmcnt(17)
    ds_read_b64 a[192:193], v22 offset:24576
    ds_read_b64 a[194:195], v142 offset:24704
    ds_read_b64 a[196:197], v23 offset:24576
    ds_read_b64 a[198:199], v143 offset:24704
    ds_read_b64 a[200:201], v142 offset:24576
    ds_read_b64 a[202:203], v22 offset:24832
    ds_read_b64 a[204:205], v143 offset:24576
    ds_read_b64 a[206:207], v23 offset:24832
    ds_read_b64 a[208:209], v22 offset:24704
    ds_read_b64 a[210:211], v142 offset:24832
    ds_read_b64 a[212:213], v23 offset:24704
    ds_read_b64 a[214:215], v143 offset:24832
    s_waitcnt lgkmcnt(15)
    v_readfirstlane_b32 s92, v17
    s_add_u32 s92, s92, 1
    s_waitcnt lgkmcnt(0)
    s_mov_b32 s41, 18432
    s_add_u32 m0, s40, 24576
    s_waitcnt vmcnt(12)
    s_bitcmp1_b32 s2, 0
    s_cbranch_scc1 L_thr24
    s_waitcnt vmcnt(5)
L_thr24:
    buffer_load_dwordx4 v136, s[8:11], s41 offen nt lds
    s_add_u32 m0, s40, 25600
    s_waitcnt vmcnt(12)
    s_bitcmp1_b32 s2, 0
    s_cbranch_scc1 L_thr25
    s_waitcnt vmcnt(5)
L_thr25:
    buffer_load_dwordx4 v137, s[8:11], s41 offen nt lds
    s_add_u32 m0, s40, 26624
    s_waitcnt vmcnt(12)
    s_bitcmp1_b32 s2, 0
    s_cbranch_scc1 L_thr26
    s_waitcnt vmcnt(4)
L_thr26:
    buffer_load_dwordx4 v138, s[8:11], s41 offen nt lds
    v_mfma_f32_16x16x32_bf16 v[64:67], v[144:147], a[192:195], 0
L_iw0:
L_pg0:
    s_cbranch_execz L_pg4
    v_mfma_f32_16x16x32_bf16 v[64:67], v[148:151], a[196:199], v[64:67]
    v_mfma_f32_16x16x32_bf16 v[64:67], v[160:163], a[200:203], v[64:67]
    v_mfma_f32_16x16x32_bf16 v[64:67], v[164:167], a[204:207], v[64:67]
    v_mfma_f32_16x16x32_bf16 v[64:67], v[176:179], a[208:211], v[64:67]
    v_mfma_f32_16x16x32_bf16 v[64:67], v[180:183], a[212:215], v[64:67]
    v_mfma_f32_16x16x32_bf16 v[96:99], v[152:155], a[192:195], 0
    v_mfma_f32_16x16x32_bf16 v[96:99], v[156:159], a[196:199], v[96:99]
    v_mfma_f32_16x16x32_bf16 v[96:99], v[168:171], a[200:203], v[96:99]
    v_mfma_f32_16x16x32_bf16 v[96:99], v[172:175], a[204:207], v[96:99]
    v_mfma_f32_16x16x32_bf16 v[96:99], v[184:187], a[208:211], v[96:99]
    v_mfma_f32_16x16x32_bf16 v[96:99], v[188:191], a[212:215], v[96:99]
    s_waitcnt vmcnt(10)
    ds_read_b64 a[216:217], v22 offset:0
    ds_read_b64 a[218:219], v142 offset:128
    ds_read_b64 a[220:221], v23 offset:0
    ds_read_b64 a[222:223], v143 offset:128
    ds_read_b64 a[224:225], v142 offset:0
    ds_read_b64 a[226:227], v22 offset:256
    ds_read_b64 a[228:229], v143 offset:0
    ds_read_b64 a[230:231], v23 offset:256
    ds_read_b64 a[232:233], v22 offset:128
    ds_read_b64 a[234:235], v142 offset:256
    ds_read_b64 a[236:237], v23 offset:128
    ds_read_b64 a[238:239], v143 offset:256
    s_mov_b32 s41, 18432
    s_add_u32 m0, s40, 27648
    s_nop 0
    s_bitcmp1_b32 s2, 0
    s_cbranch_scc1 L_thr27
    s_waitcnt vmcnt(4)
L_thr27:
    buffer_load_dwordx4 v139, s[8:11], s41 offen nt lds
    s_add_u32 m0, s40, 28672
    s_nop 0
    s_bitcmp1_b32 s2, 0
    s_cbranch_scc1 L_thr28
    s_waitcnt vmcnt(4)
L_thr28:
    buffer_load_dwordx4 v140, s[8:11], s41 offen nt lds
    s_add_u32 m0, s40, 29696
    s_nop 0
    s_bitcmp1_b32 s2, 0
    s_cbranch_scc1 L_thr29
    s_waitcnt vmcnt(4)
L_thr29:
    buffer_load_dwordx4 v141, s[8:11], s41 offen nt lds
    v_max3_f32 v48, v64, v65, v66
    v_max3_f32 v50, v67, v96, v97
    v_max3_f32 v48, v48, v98, v99
    v_max_f32 v48, v48, v50
    v_mov_b32 v49, v48
    s_nop 1
    v_permlane16_swap_b32 v48, v49
    s_nop 1
    v_max_f32 v48, v48, v49
    v_mov_b32 v49, v48
    s_nop 1
    v_permlane32_swap_b32 v48, v49
    s_nop 1
    v_max_f32 v48, v48, v49
    s_waitcnt lgkmcnt(0)
    v_mfma_f32_16x16x32_bf16 v[68:71], v[144:147], a[216:219], 0
    v_sub_f32 v64, v64, v48
    v_sub_f32 v65, v65, v48
    v_sub_f32 v66, v66, v48
    v_mfma_f32_16x16x32_bf16 v[68:71], v[148:151], a[220:223], v[68:71]
    v_sub_f32 v67, v67, v48
    v_sub_f32 v96, v96, v48
    v_sub_f32 v97, v97, v48
    v_mfma_f32_16x16x32_bf16 v[68:71], v[160:163], a[224:227], v[68:71]
    v_sub_f32 v98, v98, v48
    v_sub_f32 v99, v99, v48
    v_mfma_f32_16x16x32_bf16 v[68:71], v[164:167], a[228:231], v[68:71]
    v_exp_f32 v64, v64
    v_mfma_f32_16x16x32_bf16 v[68:71], v[176:179], a[232:235], v[68:71]
    v_exp_f32 v65, v65
    v_mfma_f32_16x16x32_bf16 v[68:71], v[180:183], a[236:239], v[68:71]
    v_exp_f32 v66, v66
    v_mfma_f32_16x16x32_bf16 v[100:103], v[152:155], a[216:219], 0
    v_exp_f32 v67, v67
    v_mfma_f32_16x16x32_bf16 v[100:103], v[156:159], a[220:223], v[100:103]
    v_exp_f32 v96, v96
    v_mfma_f32_16x16x32_bf16 v[100:103], v[168:171], a[224:227], v[100:103]
    v_exp_f32 v97, v97
    v_mfma_f32_16x16x32_bf16 v[100:103], v[172:175], a[228:231], v[100:103]
    v_exp_f32 v98, v98
    v_mfma_f32_16x16x32_bf16 v[100:103], v[184:187], a[232:235], v[100:103]
    v_exp_f32 v99, v99
    v_sub_f32 v128, 0, v48
    v_mfma_f32_16x16x32_bf16 v[100:103], v[188:191], a[236:239], v[100:103]
    v_sub_f32 v129, 0, v48
    v_sub_f32 v130, 0, v48
    v_sub_f32 v131, 0, v48
    v_add_f32 v5, v5, v64
    v_add_f32 v5, v5, v65
    v_add_f32 v5, v5, v66
    v_add_f32 v5, v5, v67
    v_add_f32 v5, v5, v96
    v_add_f32 v5, v5, v97
    v_add_f32 v5, v5, v98
    v_add_f32 v5, v5, v99
    v_cvt_pk_bf16_f32 v64, v64, v65
    v_cvt_pk_bf16_f32 v65, v66, v67
    v_cvt_pk_bf16_f32 v66, v96, v97
    v_cvt_pk_bf16_f32 v67, v98, v99
    s_waitcnt vmcnt(6)
    ds_read_b64 a[240:241], v22 offset:49152
    ds_read_b64 a[242:243], v142 offset:49280
    ds_read_b64 a[244:245], v23 offset:49152
    ds_read_b64 a[246:247], v143 offset:49280
    ds_read_b64 a[248:249], v142 offset:49152
    ds_read_b64 a[250:251], v22 offset:49408
    ds_read_b64 a[252:253], v143 offset:49152
    ds_read_b64 a[254:255], v23 offset:49408
    ds_read_b64 v[192:193], v22 offset:49280
    ds_read_b64 v[194:195], v142 offset:49408
    ds_read_b64 v[196:197], v23 offset:49280
    ds_read_b64 v[198:199], v143 offset:49408
    s_buffer_load_dwordx8 s[48:55], s[20:23], s44 glc
    v_max3_f32 v48, v68, v69, v70
    v_max3_f32 v50, v71, v100, v101
    v_max3_f32 v48, v48, v102, v103
    v_max_f32 v48, v48, v50
    v_mov_b32 v49, v48
    s_nop 1
    v_permlane16_swap_b32 v48, v49
    s_nop 1
    v_max_f32 v48, v48, v49
    v_mov_b32 v49, v48
    s_nop 1
    v_permlane32_swap_b32 v48, v49
    s_nop 1
    v_max_f32 v48, v48, v49
    s_waitcnt lgkmcnt(0)
    v_mfma_f32_16x16x32_bf16 v[72:75], v[144:147], a[240:243], 0
    v_sub_f32 v68, v68, v48
    v_sub_f32 v69, v69, v48
    v_sub_f32 v70, v70, v48
    v_mfma_f32_16x16x32_bf16 v[72:75], v[148:151], a[244:247], v[72:75]
    v_sub_f32 v71, v71, v48
    v_sub_f32 v100, v100, v48
    v_sub_f32 v101, v101, v48
    v_mfma_f32_16x16x32_bf16 v[72:75], v[160:163], a[248:251], v[72:75]
    v_sub_f32 v102, v102, v48
    v_sub_f32 v103, v103, v48
    v_mfma_f32_16x16x32_bf16 v[72:75], v[164:167], a[252:255], v[72:75]
    v_exp_f32 v68, v68
    v_mfma_f32_16x16x32_bf16 v[72:75], v[176:179], v[192:195], v[72:75]
    v_exp_f32 v69, v69
    v_mfma_f32_16x16x32_bf16 v[72:75], v[180:183], v[196:199], v[72:75]
    v_exp_f32 v70, v70
    v_mfma_f32_16x16x32_bf16 v[104:107], v[152:155], a[240:243], 0
    v_exp_f32 v71, v71
    v_mfma_f32_16x16x32_bf16 v[104:107], v[156:159], a[244:247], v[104:107]
    v_exp_f32 v100, v100
    v_mfma_f32_16x16x32_bf16 v[104:107], v[168:171], a[248:251], v[104:107]
    v_exp_f32 v101, v101
    v_mfma_f32_16x16x32_bf16 v[104:107], v[172:175], a[252:255], v[104:107]
    v_exp_f32 v102, v102
    v_mfma_f32_16x16x32_bf16 v[104:107], v[184:187], v[192:195], v[104:107]
    v_exp_f32 v103, v103
    v_sub_f32 v132, 0, v48
    v_mfma_f32_16x16x32_bf16 v[104:107], v[188:191], v[196:199], v[104:107]
    v_sub_f32 v133, 0, v48
    v_sub_f32 v134, 0, v48
    v_sub_f32 v135, 0, v48
    v_add_f32 v6, v6, v68
    v_add_f32 v6, v6, v69
    v_add_f32 v6, v6, v70
    v_add_f32 v6, v6, v71
    v_add_f32 v6, v6, v100
    v_add_f32 v6, v6, v101
    v_add_f32 v6, v6, v102
    v_add_f32 v6, v6, v103
    v_cvt_pk_bf16_f32 v68, v68, v69
    v_cvt_pk_bf16_f32 v69, v70, v71
    v_cvt_pk_bf16_f32 v70, v100, v101
    v_cvt_pk_bf16_f32 v71, v102, v103
    ds_read_b128 v[24:27], v1 offset:0
    ds_read_b128 v[28:31], v1 offset:1024
    ds_read_b128 v[32:35], v1 offset:2048
    ds_read_b128 v[36:39], v1 offset:3072
    s_waitcnt lgkmcnt(0)
    s_sub_u32 s48, s48, s92
    s_sub_u32 s49, s49, s92
    s_sub_u32 s50, s50, s92
    s_sub_u32 s51, s51, s92
    s_sub_u32 s52, s52, s92
    s_sub_u32 s53, s53, s92
    s_sub_u32 s54, s54, s92
    s_sub_u32 s55, s55, s92
    s_max_u32 s48, s48, s49
    s_max_u32 s48, s48, s50
    s_max_u32 s48, s48, s51
    s_max_u32 s48, s48, s52
    s_max_u32 s48, s48, s53
    s_max_u32 s48, s48, s54
    s_max_u32 s48, s48, s55
    s_cmp_ge_u32 s48, 16
    s_cbranch_scc1 L_pollslow0
L_pollok0:
    s_add_u32 s92, s92, 1
    s_mov_b32 m0, s26
    s_nop 0
    buffer_load_dwordx4 v4, s[4:7], s32 offen offset:0 sc1 lds
    buffer_load_dwordx4 v4, s[4:7], s32 offen offset:1024 sc1 lds
    buffer_load_dwordx4 v4, s[4:7], s32 offen offset:2048 sc1 lds
    s_add_u32 s32, s32, 24576
    s_sub_u32 s57, s32, 196608
    s_min_u32 s32, s32, s57
    s_add_u32 s26, s26, 36864
    s_sub_u32 s57, s26, 147456
    s_min_u32 s26, s26, s57
    s_mov_b32 m0, s26
    s_nop 0
    buffer_load_dwordx4 v4, s[4:7], s32 offen offset:0 sc1 lds
    buffer_load_dwordx4 v4, s[4:7], s32 offen offset:1024 sc1 lds
    buffer_load_dwordx4 v4, s[4:7], s32 offen offset:2048 sc1 lds
    s_add_u32 s32, s32, 24576
    s_sub_u32 s57, s32, 196608
    s_min_u32 s32, s32, s57
    s_add_u32 s26, s26, 12288
    s_mov_b32 m0, s26
    s_waitcnt vmcnt(11)
    buffer_load_dwordx4 v4, s[4:7], s32 offen offset:0 sc1 lds
    s_waitcnt vmcnt(11)
    buffer_load_dwordx4 v4, s[4:7], s32 offen offset:1024 sc1 lds
    s_waitcnt vmcnt(11)
    buffer_load_dwordx4 v4, s[4:7], s32 offen offset:2048 sc1 lds
    s_add_u32 s32, s32, 24576
    s_sub_u32 s57, s32, 196608
    s_min_u32 s32, s32, s57
    s_add_u32 s26, s26, 36864
    s_sub_u32 s57, s26, 147456
    s_min_u32 s26, s26, s57
    s_mov_b32 m0, s56
    s_waitcnt vmcnt(11)
    buffer_load_dwordx4 v4, s[4:7], s27 offen offset:0 sc1 lds
    s_waitcnt vmcnt(11)
    buffer_load_dwordx4 v4, s[4:7], s27 offen offset:1024 sc1 lds
    s_waitcnt vmcnt(11)
    buffer_load_dwordx4 v4, s[4:7], s27 offen offset:2048 sc1 lds
    s_add_u32 s27, s27, 24576
    s_sub_u32 s58, s27, 196608
    s_min_u32 s27, s27, s58
    s_add_u32 s56, s56, 36864
    s_sub_u32 s58, s56, 147456
    s_min_u32 s56, s56, s58
    s_add_u32 s33, s33, 196608
    s_add_u32 s34, s34, 196608
    s_add_u32 s36, s36, 1536
    s_add_u32 s35, s35, 196608
    s_add_u32 s16, s16, 196608
    s_add_u32 s17, s17, 196608
    s_add_u32 s37, s37, 512
    v_mfma_f32_16x16x32_bf16 a[0:3], v[64:67], v[24:27], 0
    ds_read_b128 v[40:43], v1 offset:4096
    v_max3_f32 v48, v72, v73, v74
    v_mfma_f32_16x16x32_bf16 a[4:7], v[64:67], v[28:31], 0
    v_max3_f32 v50, v75, v104, v105
    v_max3_f32 v48, v48, v106, v107
    v_mfma_f32_16x16x32_bf16 a[48:51], v[68:71], v[24:27], 0
    ds_read_b128 v[44:47], v1 offset:5120
    v_max_f32 v48, v48, v50
    v_mfma_f32_16x16x32_bf16 a[52:55], v[68:71], v[28:31], 0
    s_waitcnt lgkmcnt(2)
    v_mov_b32 v49, v48
    v_mfma_f32_16x16x32_bf16 a[8:11], v[64:67], v[32:35], 0
    s_nop 1
    ds_read_b128 v[24:27], v1 offset:6144
    v_mfma_f32_16x16x32_bf16 a[12:15], v[64:67], v[36:39], 0
    v_permlane16_swap_b32 v48, v49
    s_nop 1
    v_mfma_f32_16x16x32_bf16 a[56:59], v[68:71], v[32:35], 0
    ds_read_b128 v[28:31], v1 offset:7168
    v_max_f32 v48, v48, v49
    v_mfma_f32_16x16x32_bf16 a[60:63], v[68:71], v[36:39], 0
    s_waitcnt lgkmcnt(2)
    v_mov_b32 v49, v48
    s_nop 1
    v_mfma_f32_16x16x32_bf16 a[16:19], v[64:67], v[40:43], 0
    ds_read_b128 v[32:35], v1 offset:8192
    v_permlane32_swap_b32 v48, v49
    v_mfma_f32_16x16x32_bf16 a[20:23], v[64:67], v[44:47], 0
    s_nop 1
    v_max_f32 v48, v48, v49
    v_sub_f32 v72, v72, v48
    v_mfma_f32_16x16x32_bf16 a[64:67], v[68:71], v[40:43], 0
    ds_read_b128 v[36:39], v1 offset:9216
    v_sub_f32 v73, v73, v48
    v_mfma_f32_16x16x32_bf16 a[68:71], v[68:71], v[44:47], 0
    s_waitcnt lgkmcnt(2)
    v_sub_f32 v74, v74, v48
    v_sub_f32 v75, v75, v48
    v_sub_f32 v104, v104, v48
    v_mfma_f32_16x16x32_bf16 a[24:27], v[64:67], v[24:27], 0
    ds_read_b128 v[40:43], v1 offset:10240
    v_sub_f32 v105, v105, v48
    v_mfma_f32_16x16x32_bf16 a[28:31], v[64:67], v[28:31], 0
    v_sub_f32 v106, v106, v48
    v_sub_f32 v107, v107, v48
    v_mfma_f32_16x16x32_bf16 a[72:75], v[68:71], v[24:27], 0
    ds_read_b128 v[44:47], v1 offset:11264
    v_mfma_f32_16x16x32_bf16 a[76:79], v[68:71], v[28:31], 0
    s_waitcnt lgkmcnt(2)
    v_exp_f32 v72, v72
    v_mfma_f32_16x16x32_bf16 a[32:35], v[64:67], v[32:35], 0
    v_exp_f32 v73, v73
    v_mfma_f32_16x16x32_bf16 a[36:39], v[64:67], v[36:39], 0
    v_exp_f32 v74, v74
    v_mfma_f32_16x16x32_bf16 a[80:83], v[68:71], v[32:35], 0
    v_exp_f32 v75, v75
    v_mfma_f32_16x16x32_bf16 a[84:87], v[68:71], v[36:39], 0
    s_waitcnt lgkmcnt(0)
    v_exp_f32 v104, v104
    v_mfma_f32_16x16x32_bf16 a[40:43], v[64:67], v[40:43], 0
    v_exp_f32 v105, v105
    v_mfma_f32_16x16x32_bf16 a[44:47], v[64:67], v[44:47], 0
    v_exp_f32 v106, v106
    v_mfma_f32_16x16x32_bf16 a[88:91], v[68:71], v[40:43], 0
    v_exp_f32 v107, v107
    v_mfma_f32_16x16x32_bf16 a[92:95], v[68:71], v[44:47], 0
    v_sub_f32 v136, 0, v48
    v_sub_f32 v137, 0, v48
    v_sub_f32 v138, 0, v48
    v_sub_f32 v139, 0, v48
    v_add_f32 v7, v7, v72
    v_add_f32 v7, v7, v73
    v_add_f32 v7, v7, v74
    v_add_f32 v7, v7, v75
    v_add_f32 v7, v7, v104
    v_add_f32 v7, v7, v105
    v_add_f32 v7, v7, v106
    v_add_f32 v7, v7, v107
    v_cvt_pk_bf16_f32 v72, v72, v73
    v_cvt_pk_bf16_f32 v73, v74, v75
    v_cvt_pk_bf16_f32 v74, v104, v105
    v_cvt_pk_bf16_f32 v75, v106, v107
    s_waitcnt vmcnt(12)
    ds_read_b64 v[200:201], v22 offset:24576
    ds_read_b64 v[202:203], v142 offset:24704
    ds_read_b64 v[204:205], v23 offset:24576
    ds_read_b64 v[206:207], v143 offset:24704
    ds_read_b64 v[208:209], v142 offset:24576
    ds_read_b64 v[210:211], v22 offset:24832
    ds_read_b64 v[212:213], v143 offset:24576
    ds_read_b64 v[214:215], v23 offset:24832
    ds_read_b64 v[216:217], v22 offset:24704
    ds_read_b64 v[218:219], v142 offset:24832
    ds_read_b64 v[220:221], v23 offset:24704
    ds_read_b64 v[222:223], v143 offset:24832
    s_waitcnt lgkmcnt(0)
    v_mfma_f32_16x16x32_bf16 v[76:79], v[144:147], v[200:203], 0
    v_mfma_f32_16x16x32_bf16 v[76:79], v[148:151], v[204:207], v[76:79]
    v_mfma_f32_16x16x32_bf16 v[76:79], v[160:163], v[208:211], v[76:79]
    v_mfma_f32_16x16x32_bf16 v[76:79], v[164:167], v[212:215], v[76:79]
    v_mfma_f32_16x16x32_bf16 v[76:79], v[176:179], v[216:219], v[76:79]
    v_mfma_f32_16x16x32_bf16 v[76:79], v[180:183], v[220:223], v[76:79]
    v_mfma_f32_16x16x32_bf16 v[108:111], v[152:155], v[200:203], 0
    v_mfma_f32_16x16x32_bf16 v[108:111], v[156:159], v[204:207], v[108:111]
    v_mfma_f32_16x16x32_bf16 v[108:111], v[168:171], v[208:211], v[108:111]
    v_mfma_f32_16x16x32_bf16 v[108:111], v[172:175], v[212:215], v[108:111]
    v_mfma_f32_16x16x32_bf16 v[108:111], v[184:187], v[216:219], v[108:111]
    v_mfma_f32_16x16x32_bf16 v[108:111], v[188:191], v[220:223], v[108:111]
    s_nop 7
    v_max3_f32 v48, v76, v77, v78
    v_max3_f32 v50, v79, v108, v109
    v_max3_f32 v48, v48, v110, v111
    v_max_f32 v48, v48, v50
    v_mov_b32 v49, v48
    s_nop 1
    v_permlane16_swap_b32 v48, v49
    s_nop 1
    v_max_f32 v48, v48, v49
    v_mov_b32 v49, v48
    s_nop 1
    v_permlane32_swap_b32 v48, v49
    s_nop 1
    v_max_f32 v48, v48, v49
    v_sub_f32 v140, 0, v48
    v_sub_f32 v141, 0, v48
    v_sub_f32 v142, 0, v48
    v_sub_f32 v143, 0, v48
    s_waitcnt vmcnt(9)
    s_barrier
    ds_read_b128 v[24:27], v2 offset:12288
    ds_read_b128 v[28:31], v3 offset:12288
    ds_read_b128 v[32:35], v2 offset:18432
    ds_read_b128 v[36:39], v3 offset:18432
    s_waitcnt lgkmcnt(2)
    v_mfma_f32_16x16x32_bf16 v[80:83], v[24:27], a[192:195], v[128:131]
    ds_read_b128 v[40:43], v2 offset:12416
    v_sub_f32 v76, v76, v48
    v_mfma_f32_16x16x32_bf16 v[80:83], v[28:31], a[196:199], v[80:83]
    buffer_load_dwordx2 v[56:57], v10, s[72:75], s36 offen offset:0
    v_mfma_f32_16x16x32_bf16 v[84:87], v[28:31], a[220:223], v[132:135]
    v_sub_f32 v77, v77, v48
    v_sub_f32 v78, v78, v48
    v_mfma_f32_16x16x32_bf16 v[84:87], v[24:27], a[216:219], v[84:87]
    buffer_load_dwordx2 v[58:59], v10, s[76:79], s36 offen offset:0
    v_mfma_f32_16x16x32_bf16 v[88:91], v[24:27], a[240:243], v[136:139]
    ds_read_b128 v[44:47], v3 offset:12416
    v_sub_f32 v79, v79, v48
    v_mfma_f32_16x16x32_bf16 v[88:91], v[28:31], a[244:247], v[88:91]
    buffer_load_dwordx4 v[224:227], v9, s[64:67], s33 offen offset:0 nt
    v_mfma_f32_16x16x32_bf16 v[92:95], v[28:31], v[204:207], v[140:143]
    v_sub_f32 v108, v108, v48
    v_sub_f32 v109, v109, v48
    v_mfma_f32_16x16x32_bf16 v[92:95], v[24:27], v[200:203], v[92:95]
    s_waitcnt lgkmcnt(2)
    buffer_load_dwordx4 v[228:231], v9, s[64:67], s33 offen offset:1536 nt
    v_mfma_f32_16x16x32_bf16 v[112:115], v[32:35], a[192:195], v[128:131]
    ds_read_b128 v[24:27], v2 offset:18560
    v_sub_f32 v110, v110, v48
    v_mfma_f32_16x16x32_bf16 v[112:115], v[36:39], a[196:199], v[112:115]
    buffer_load_dwordx4 v[232:235], v9, s[64:67], s34 offen offset:0 nt
    v_mfma_f32_16x16x32_bf16 v[116:119], v[36:39], a[220:223], v[132:135]
    v_sub_f32 v111, v111, v48
    v_mfma_f32_16x16x32_bf16 v[116:119], v[32:35], a[216:219], v[116:119]
    s_waitcnt vmcnt(13)
    buffer_load_dwordx4 v[236:239], v9, s[64:67], s34 offen offset:1536 nt
    v_mfma_f32_16x16x32_bf16 v[120:123], v[32:35], a[240:243], v[136:139]
    ds_read_b128 v[28:31], v3 offset:18560
    v_mfma_f32_16x16x32_bf16 v[120:123], v[36:39], a[244:247], v[120:123]
    v_exp_f32 v76, v76
    v_mfma_f32_16x16x32_bf16 v[124:127], v[36:39], v[204:207], v[140:143]
    v_exp_f32 v77, v77
    v_mfma_f32_16x16x32_bf16 v[124:127], v[32:35], v[200:203], v[124:127]
    s_waitcnt lgkmcnt(2)
    s_waitcnt vmcnt(13)
    buffer_load_dwordx2 v[60:61], v10, s[72:75], s36 offen offset:192
    v_mfma_f32_16x16x32_bf16 v[80:83], v[40:43], a[200:203], v[80:83]
    ds_read_b128 v[32:35], v2 offset:12544
    v_mfma_f32_16x16x32_bf16 v[80:83], v[44:47], a[204:207], v[80:83]
    buffer_load_dwordx2 v[62:63], v10, s[76:79], s36 offen offset:192
    v_mfma_f32_16x16x32_bf16 v[84:87], v[44:47], a[228:231], v[84:87]
    v_exp_f32 v78, v78
    v_mfma_f32_16x16x32_bf16 v[84:87], v[40:43], a[224:227], v[84:87]
    s_waitcnt vmcnt(14)
    buffer_load_dwordx4 v[240:243], v9, s[64:67], s33 offen offset:384 nt
    v_mfma_f32_16x16x32_bf16 v[88:91], v[40:43], a[248:251], v[88:91]
    ds_read_b128 v[36:39], v3 offset:12544
    v_mfma_f32_16x16x32_bf16 v[88:91], v[44:47], a[252:255], v[88:91]
    buffer_load_dwordx4 v[244:247], v9, s[64:67], s33 offen offset:1920 nt
    v_mfma_f32_16x16x32_bf16 v[92:95], v[44:47], v[212:215], v[92:95]
    v_exp_f32 v79, v79
    v_mfma_f32_16x16x32_bf16 v[92:95], v[40:43], v[208:211], v[92:95]
    s_waitcnt lgkmcnt(2)
    v_exp_f32 v108, v108
    v_mfma_f32_16x16x32_bf16 v[112:115], v[24:27], a[200:203], v[112:115]
    ds_read_b128 v[40:43], v2 offset:18688
    v_mfma_f32_16x16x32_bf16 v[112:115], v[28:31], a[204:207], v[112:115]
    s_waitcnt vmcnt(15)
    buffer_load_dwordx4 v[248:251], v9, s[64:67], s34 offen offset:384 nt
    v_mfma_f32_16x16x32_bf16 v[116:119], v[28:31], a[228:231], v[116:119]
    v_exp_f32 v109, v109
    v_mfma_f32_16x16x32_bf16 v[116:119], v[24:27], a[224:227], v[116:119]
    s_waitcnt vmcnt(15)
    buffer_load_dwordx4 v[252:255], v9, s[64:67], s34 offen offset:1920 nt
    v_mfma_f32_16x16x32_bf16 v[120:123], v[24:27], a[248:251], v[120:123]
    ds_read_b128 v[44:47], v3 offset:18688
    v_mfma_f32_16x16x32_bf16 v[120:123], v[28:31], a[252:255], v[120:123]
    s_waitcnt lgkmcnt(2)
    v_exp_f32 v110, v110
    v_mfma_f32_16x16x32_bf16 v[124:127], v[28:31], v[212:215], v[124:127]
    s_waitcnt vmcnt(15)
    v_exp_f32 v111, v111
    v_mfma_f32_16x16x32_bf16 v[124:127], v[24:27], v[208:211], v[124:127]
    s_barrier
    v_add_u32 v2, 49152, v2
    v_add_u32 v3, 49152, v3
    v_mfma_f32_16x16x32_bf16 v[80:83], v[32:35], a[208:211], v[80:83]
    s_mov_b32 m0, s26
    ds_read_b128 v[24:27], v2 offset:0
    v_add_f32 v8, v8, v76
    v_mfma_f32_16x16x32_bf16 v[80:83], v[36:39], a[212:215], v[80:83]
    buffer_load_dwordx4 v4, s[4:7], s32 offen offset:0 sc1 lds
    v_add_f32 v8, v8, v77
    v_mfma_f32_16x16x32_bf16 v[84:87], v[36:39], a[236:239], v[84:87]
    v_add_f32 v8, v8, v78
    v_add_f32 v8, v8, v79
    v_mfma_f32_16x16x32_bf16 v[84:87], v[32:35], a[232:235], v[84:87]
    s_waitcnt vmcnt(15)
    buffer_load_dwordx4 v4, s[4:7], s32 offen offset:1024 sc1 lds
    v_add_f32 v8, v8, v108
    v_mfma_f32_16x16x32_bf16 v[88:91], v[32:35], v[192:195], v[88:91]
    ds_read_b128 v[28:31], v3 offset:0
    v_add_f32 v8, v8, v109
    v_mfma_f32_16x16x32_bf16 v[88:91], v[36:39], v[196:199], v[88:91]
    s_waitcnt vmcnt(15)
    buffer_load_dwordx4 v4, s[4:7], s32 offen offset:2048 sc1 lds
    v_add_f32 v8, v8, v110
    v_mfma_f32_16x16x32_bf16 v[92:95], v[36:39], v[220:223], v[92:95]
    s_add_u32 s32, s32, 24576
    v_add_f32 v8, v8, v111
    v_cvt_pk_bf16_f32 v76, v76, v77
    v_mfma_f32_16x16x32_bf16 v[92:95], v[32:35], v[216:219], v[92:95]
    s_waitcnt lgkmcnt(2)
    v_cvt_pk_bf16_f32 v77, v78, v79
    v_cvt_pk_bf16_f32 v78, v108, v109
    v_mfma_f32_16x16x32_bf16 v[112:115], v[40:43], a[208:211], v[112:115]
    ds_read_b128 v[32:35], v2 offset:6144
    v_cvt_pk_bf16_f32 v79, v110, v111
    v_bfe_u32 v20, v4, 4, 6
    v_lshlrev_b32 v20, 2, v20
    v_xor_b32 v21, 16, v11
    v_xor_b32 v22, 32, v11
    v_xor_b32 v23, 48, v11
    v_mfma_f32_16x16x32_bf16 v[112:115], v[44:47], a[212:215], v[112:115]
    s_sub_u32 s57, s32, 196608
    s_min_u32 s32, s32, s57
    v_mfma_f32_16x16x32_bf16 v[116:119], v[44:47], a[236:239], v[116:119]
    s_add_u32 s26, s26, 12288
    s_mov_b32 m0, s26
    v_mfma_f32_16x16x32_bf16 v[116:119], v[40:43], a[232:235], v[116:119]
    s_waitcnt vmcnt(15)
    buffer_load_dwordx4 v4, s[4:7], s32 offen offset:0 sc1 lds
    v_mfma_f32_16x16x32_bf16 v[120:123], v[40:43], v[192:195], v[120:123]
    ds_read_b128 v[36:39], v3 offset:6144
    v_mfma_f32_16x16x32_bf16 v[120:123], v[44:47], v[196:199], v[120:123]
    s_waitcnt vmcnt(14)
    buffer_load_dwordx4 v4, s[4:7], s32 offen offset:1024 sc1 lds
    v_mfma_f32_16x16x32_bf16 v[124:127], v[44:47], v[220:223], v[124:127]
    s_waitcnt vmcnt(14)
    buffer_load_dwordx4 v4, s[4:7], s32 offen offset:2048 sc1 lds
    v_mfma_f32_16x16x32_bf16 v[124:127], v[40:43], v[216:219], v[124:127]
    s_waitcnt lgkmcnt(2)
    s_add_u32 s32, s32, 24576
    s_sub_u32 s57, s32, 196608
    s_min_u32 s32, s32, s57
    s_add_u32 s26, s26, 36864
    s_sub_u32 s57, s26, 147456
    s_min_u32 s26, s26, s57
    v_mfma_f32_16x16x32_bf16 v[160:163], v[24:27], a[192:195], v[128:131]
    s_mov_b32 m0, s56
    ds_read_b128 v[40:43], v2 offset:128
    v_mfma_f32_16x16x32_bf16 v[160:163], v[28:31], a[196:199], v[160:163]
    s_waitcnt vmcnt(13)
    buffer_load_dwordx4 v4, s[4:7], s27 offen offset:0 sc1 lds
    v_mfma_f32_16x16x32_bf16 v[164:167], v[28:31], a[220:223], v[132:135]
    v_exp_f32 v16, v80
    v_mfma_f32_16x16x32_bf16 v[164:167], v[24:27], a[216:219], v[164:167]
    s_waitcnt vmcnt(13)
    buffer_load_dwordx4 v4, s[4:7], s27 offen offset:1024 sc1 lds
    v_exp_f32 v17, v81
    v_exp_f32 v18, v82
    v_add_f32 v5, v5, v16
    v_add_f32 v5, v5, v17
    v_mfma_f32_16x16x32_bf16 v[168:171], v[24:27], a[240:243], v[136:139]
    ds_read_b128 v[44:47], v3 offset:128
    v_mfma_f32_16x16x32_bf16 v[168:171], v[28:31], a[244:247], v[168:171]
    s_waitcnt vmcnt(12)
    buffer_load_dwordx4 v4, s[4:7], s27 offen offset:2048 sc1 lds
    v_exp_f32 v19, v83
    v_cvt_pk_bf16_f32 v80, v16, v17
    v_mfma_f32_16x16x32_bf16 v[172:175], v[28:31], v[204:207], v[140:143]
    s_add_u32 s27, s27, 24576
    v_exp_f32 v16, v112
    v_mfma_f32_16x16x32_bf16 v[172:175], v[24:27], v[200:203], v[172:175]
    s_waitcnt lgkmcnt(2)
    v_add_f32 v5, v5, v18
    v_add_f32 v5, v5, v19
    v_exp_f32 v17, v113
    v_cvt_pk_bf16_f32 v81, v18, v19
    s_sub_u32 s58, s27, 196608
    v_mfma_f32_16x16x32_bf16 v[96:99], v[32:35], a[192:195], v[128:131]
    s_min_u32 s27, s27, s58
    ds_read_b128 v[24:27], v2 offset:6272
    s_add_u32 s56, s56, 12288
    v_mfma_f32_16x16x32_bf16 v[96:99], v[36:39], a[196:199], v[96:99]
    s_mov_b32 m0, s56
    v_exp_f32 v18, v114
    v_add_f32 v5, v5, v16
    v_add_f32 v5, v5, v17
    v_mfma_f32_16x16x32_bf16 v[100:103], v[36:39], a[220:223], v[132:135]
    v_exp_f32 v19, v115
    v_mfma_f32_16x16x32_bf16 v[100:103], v[32:35], a[216:219], v[100:103]
    s_waitcnt vmcnt(11)
    buffer_load_dwordx4 v4, s[4:7], s27 offen offset:0 sc1 lds
    v_cvt_pk_bf16_f32 v82, v16, v17
    v_exp_f32 v16, v84
    v_add_f32 v5, v5, v18
    v_mfma_f32_16x16x32_bf16 v[104:107], v[32:35], a[240:243], v[136:139]
    ds_read_b128 v[28:31], v3 offset:6272
    v_add_f32 v5, v5, v19
    v_mfma_f32_16x16x32_bf16 v[104:107], v[36:39], a[244:247], v[104:107]
    s_waitcnt vmcnt(11)
    buffer_load_dwordx4 v4, s[4:7], s27 offen offset:1024 sc1 lds
    v_exp_f32 v17, v85
    v_cvt_pk_bf16_f32 v83, v18, v19
    v_mfma_f32_16x16x32_bf16 v[108:111], v[36:39], v[204:207], v[140:143]
    v_exp_f32 v18, v86
    v_mfma_f32_16x16x32_bf16 v[108:111], v[32:35], v[200:203], v[108:111]
    s_waitcnt lgkmcnt(2)
    s_waitcnt vmcnt(11)
    buffer_load_dwordx4 v4, s[4:7], s27 offen offset:2048 sc1 lds
    v_add_f32 v6, v6, v16
    v_add_f32 v6, v6, v17
    v_exp_f32 v19, v87
    v_mfma_f32_16x16x32_bf16 v[160:163], v[40:43], a[200:203], v[160:163]
    ds_read_b128 v[32:35], v2 offset:256
    v_cvt_pk_bf16_f32 v84, v16, v17
    v_mfma_f32_16x16x32_bf16 v[160:163], v[44:47], a[204:207], v[160:163]
    v_exp_f32 v16, v116
    v_add_f32 v6, v6, v18
    v_add_f32 v6, v6, v19
    v_mfma_f32_16x16x32_bf16 v[164:167], v[44:47], a[228:231], v[164:167]
    v_exp_f32 v17, v117
    v_mfma_f32_16x16x32_bf16 v[164:167], v[40:43], a[224:227], v[164:167]
    s_add_u32 s27, s27, 24576
    v_cvt_pk_bf16_f32 v85, v18, v19
    v_exp_f32 v18, v118
    v_add_f32 v6, v6, v16
    v_add_f32 v6, v6, v17
    s_sub_u32 s58, s27, 196608
    v_mfma_f32_16x16x32_bf16 v[168:171], v[40:43], a[248:251], v[168:171]
    s_waitcnt vmcnt(18)
    ds_read_b128 v[36:39], v3 offset:256
    v_lshlrev_b32 v48, 16, v56
    v_mfma_f32_16x16x32_bf16 v[168:171], v[44:47], a[252:255], v[168:171]
    s_waitcnt vmcnt(11)
    buffer_load_dwordx3 v[144:146], v12, s[68:71], s35 offen offset:0 nt
    v_exp_f32 v19, v119
    v_cvt_pk_bf16_f32 v86, v16, v17
    v_mfma_f32_16x16x32_bf16 v[172:175], v[44:47], v[212:215], v[172:175]
    s_min_u32 s27, s27, s58
    v_add_f32 v6, v6, v18
    v_add_f32 v6, v6, v19
    v_mfma_f32_16x16x32_bf16 v[172:175], v[40:43], v[208:211], v[172:175]
    s_waitcnt lgkmcnt(2)
    s_waitcnt vmcnt(11)
    buffer_load_dwordx3 v[148:150], v12, s[68:71], s35 offen offset:768 nt
    v_cvt_pk_bf16_f32 v87, v18, v19
    v_exp_f32 v16, v88
    v_and_b32 v49, s97, v56
    v_mfma_f32_16x16x32_bf16 v[96:99], v[24:27], a[200:203], v[96:99]
    s_add_u32 s56, s56, 36864
    ds_read_b128 v[40:43], v2 offset:6400
    v_lshlrev_b32 v50, 16, v58
    v_mfma_f32_16x16x32_bf16 v[96:99], v[28:31], a[204:207], v[96:99]
    s_waitcnt vmcnt(11)
    buffer_load_dwordx3 v[152:154], v12, s[68:71], s35 offen offset:1536 nt
    v_exp_f32 v17, v89
    v_and_b32 v51, s97, v58
    v_mfma_f32_16x16x32_bf16 v[100:103], v[28:31], a[228:231], v[100:103]
    s_sub_u32 s58, s56, 147456
    v_exp_f32 v18, v90
    v_mfma_f32_16x16x32_bf16 v[100:103], v[24:27], a[224:227], v[100:103]
    buffer_load_dwordx3 v[156:158], v12, s[68:71], s35 offen offset:2304 nt
    v_add_f32 v7, v7, v16
    v_add_f32 v7, v7, v17
    v_mul_f32 v48, s38, v48
    v_mfma_f32_16x16x32_bf16 v[104:107], v[24:27], a[248:251], v[104:107]
    s_min_u32 s56, s56, s58
    ds_read_b128 v[44:47], v3 offset:6400
    v_mul_f32 v49, s38, v49
    v_mfma_f32_16x16x32_bf16 v[104:107], v[28:31], a[252:255], v[104:107]
    v_exp_f32 v19, v91
    v_cvt_pk_bf16_f32 v88, v16, v17
    v_exp_f32 v16, v120
    v_mfma_f32_16x16x32_bf16 v[108:111], v[28:31], v[212:215], v[108:111]
L_iw1:
L_pg1:
    s_cbranch_execz L_pg5
    v_add_f32 v7, v7, v18
    v_add_f32 v7, v7, v19
    v_mfma_f32_16x16x32_bf16 v[108:111], v[24:27], v[208:211], v[108:111]
    s_waitcnt lgkmcnt(2)
    v_exp_f32 v17, v121
    v_mul_f32_e64 v50, -v50, v48
    v_mul_f32_e64 v51, -v51, v49
    v_cvt_pk_bf16_f32 v89, v18, v19
    v_cvt_f32_i32 v224, v224
    v_mfma_f32_16x16x32_bf16 v[160:163], v[32:35], a[208:211], v[160:163]
    ds_read_b128 v[24:27], v2 offset:12288
    v_cvt_f32_i32 v225, v225
    v_mfma_f32_16x16x32_bf16 v[160:163], v[36:39], a[212:215], v[160:163]
    v_exp_f32 v18, v122
    v_fma_f32 v224, v224, v48, v50
    v_add_f32 v7, v7, v16
    v_fma_f32 v225, v225, v49, v51
    v_mfma_f32_16x16x32_bf16 v[164:167], v[36:39], a[236:239], v[164:167]
    v_add_f32 v7, v7, v17
    v_cvt_pk_bf16_f32 v224, v224, v225
    v_mfma_f32_16x16x32_bf16 v[164:167], v[32:35], a[232:235], v[164:167]
    v_exp_f32 v19, v123
    v_cvt_f32_i32 v228, v228
    v_cvt_f32_i32 v229, v229
    v_cvt_pk_bf16_f32 v90, v16, v17
    v_mfma_f32_16x16x32_bf16 v[168:171], v[32:35], v[192:195], v[168:171]
    ds_read_b128 v[28:31], v3 offset:12288
    v_fma_f32 v228, v228, v48, v50
    v_mfma_f32_16x16x32_bf16 v[168:171], v[36:39], v[196:199], v[168:171]
    v_exp_f32 v16, v92
    v_fma_f32 v229, v229, v49, v51
    v_cvt_pk_bf16_f32 v228, v228, v229
    v_add_f32 v7, v7, v18
    v_mfma_f32_16x16x32_bf16 v[172:175], v[36:39], v[220:223], v[172:175]
    v_cvt_f32_i32 v232, v232
    v_add_f32 v7, v7, v19
    v_mfma_f32_16x16x32_bf16 v[172:175], v[32:35], v[216:219], v[172:175]
    s_waitcnt lgkmcnt(2)
    v_exp_f32 v17, v93
    v_cvt_f32_i32 v233, v233
    v_fma_f32 v232, v232, v48, v50
    v_fma_f32 v233, v233, v49, v51
    v_cvt_pk_bf16_f32 v91, v18, v19
    v_mfma_f32_16x16x32_bf16 v[96:99], v[40:43], a[208:211], v[96:99]
    ds_read_b128 v[32:35], v2 offset:18432
    v_cvt_pk_bf16_f32 v232, v232, v233
    v_mfma_f32_16x16x32_bf16 v[96:99], v[44:47], a[212:215], v[96:99]
    v_exp_f32 v18, v94
    v_cvt_f32_i32 v236, v236
    v_cvt_f32_i32 v237, v237
    v_add_f32 v8, v8, v16
    v_mfma_f32_16x16x32_bf16 v[100:103], v[44:47], a[236:239], v[100:103]
    v_fma_f32 v236, v236, v48, v50
    v_add_f32 v8, v8, v17
    v_mfma_f32_16x16x32_bf16 v[100:103], v[40:43], a[232:235], v[100:103]
    v_exp_f32 v19, v95
    v_fma_f32 v237, v237, v49, v51
    v_cvt_pk_bf16_f32 v236, v236, v237
    v_lshlrev_b32 v48, 16, v57
    v_mfma_f32_16x16x32_bf16 v[104:107], v[40:43], v[192:195], v[104:107]
    ds_read_b128 v[36:39], v3 offset:18432
    v_cvt_pk_bf16_f32 v92, v16, v17
    v_mfma_f32_16x16x32_bf16 v[104:107], v[44:47], v[196:199], v[104:107]
    v_exp_f32 v16, v124
    v_and_b32 v49, s97, v57
    v_lshlrev_b32 v50, 16, v59
    v_and_b32 v51, s97, v59
    v_mfma_f32_16x16x32_bf16 v[108:111], v[44:47], v[220:223], v[108:111]
    v_add_f32 v8, v8, v18
    v_mul_f32 v48, s38, v48
    v_mfma_f32_16x16x32_bf16 v[108:111], v[40:43], v[216:219], v[108:111]
    s_waitcnt lgkmcnt(2)
    v_add_f32 v8, v8, v19
    v_mul_f32 v49, s38, v49
    v_exp_f32 v17, v125
    v_mul_f32_e64 v50, -v50, v48
    v_mul_f32_e64 v51, -v51, v49
    v_mfma_f32_16x16x32_bf16 v[176:179], v[24:27], a[192:195], v[128:131]
    ds_read_b128 v[40:43], v2 offset:12416
    v_cvt_pk_bf16_f32 v93, v18, v19
    v_mfma_f32_16x16x32_bf16 v[176:179], v[28:31], a[196:199], v[176:179]
    v_exp_f32 v18, v126
    v_cvt_f32_i32 v226, v226
    v_cvt_f32_i32 v227, v227
    v_fma_f32 v226, v226, v48, v50
    v_mfma_f32_16x16x32_bf16 v[180:183], v[28:31], a[220:223], v[132:135]
    v_add_f32 v8, v8, v16
    v_fma_f32 v227, v227, v49, v51
    v_mfma_f32_16x16x32_bf16 v[180:183], v[24:27], a[216:219], v[180:183]
    v_add_f32 v8, v8, v17
    v_cvt_pk_bf16_f32 v225, v226, v227
    v_exp_f32 v19, v127
    v_cvt_f32_i32 v230, v230
    v_mfma_f32_16x16x32_bf16 v[184:187], v[24:27], a[240:243], v[136:139]
    ds_read_b128 v[44:47], v3 offset:12416
    v_cvt_f32_i32 v231, v231
    v_mfma_f32_16x16x32_bf16 v[184:187], v[28:31], a[244:247], v[184:187]
    v_cvt_pk_bf16_f32 v94, v16, v17
    v_fma_f32 v230, v230, v48, v50
    v_add_f32 v8, v8, v18
    v_fma_f32 v231, v231, v49, v51
    v_cvt_pk_bf16_f32 v229, v230, v231
    v_mfma_f32_16x16x32_bf16 v[188:191], v[28:31], v[204:207], v[140:143]
    v_add_f32 v8, v8, v19
    v_cvt_pk_bf16_f32 v95, v18, v19
    v_mfma_f32_16x16x32_bf16 v[188:191], v[24:27], v[200:203], v[188:191]
    s_waitcnt lgkmcnt(2)
    v_cvt_f32_i32 v234, v234
    v_cvt_f32_i32 v235, v235
    v_exp_f32 v16, v160
    v_fma_f32 v234, v234, v48, v50
    v_fma_f32 v235, v235, v49, v51
    v_mfma_f32_16x16x32_bf16 v[112:115], v[32:35], a[192:195], v[128:131]
    ds_read_b128 v[24:27], v2 offset:18560
    v_cvt_pk_bf16_f32 v233, v234, v235
    v_mfma_f32_16x16x32_bf16 v[112:115], v[36:39], a[196:199], v[112:115]
    v_exp_f32 v17, v161
    v_exp_f32 v18, v162
    v_add_f32 v5, v5, v16
    v_mfma_f32_16x16x32_bf16 v[116:119], v[36:39], a[220:223], v[132:135]
    v_cvt_f32_i32 v238, v238
    v_cvt_f32_i32 v239, v239
    v_mfma_f32_16x16x32_bf16 v[116:119], v[32:35], a[216:219], v[116:119]
    v_fma_f32 v238, v238, v48, v50
    v_add_f32 v5, v5, v17
    v_exp_f32 v19, v163
    v_cvt_pk_bf16_f32 v160, v16, v17
    v_mfma_f32_16x16x32_bf16 v[120:123], v[32:35], a[240:243], v[136:139]
    ds_read_b128 v[28:31], v3 offset:18560
    v_fma_f32 v239, v239, v49, v51
    v_cvt_pk_bf16_f32 v237, v238, v239
    v_mfma_f32_16x16x32_bf16 v[120:123], v[36:39], a[244:247], v[120:123]
    s_waitcnt vmcnt(16)
    v_lshlrev_b32 v48, 16, v60
    v_and_b32 v49, s97, v60
    v_lshlrev_b32 v50, 16, v62
    v_and_b32 v51, s97, v62
    v_mul_f32 v48, s38, v48
    v_mfma_f32_16x16x32_bf16 v[124:127], v[36:39], v[204:207], v[140:143]
    v_mul_f32 v49, s38, v49
    v_mul_f32_e64 v50, -v50, v48
    v_mfma_f32_16x16x32_bf16 v[124:127], v[32:35], v[200:203], v[124:127]
    s_waitcnt lgkmcnt(2)
    s_waitcnt vmcnt(12)
    buffer_load_dwordx2 v[56:57], off, s[80:83], s37 offset:0
    v_mul_f32_e64 v51, -v51, v49
    v_cvt_f32_i32 v240, v240
    v_cvt_f32_i32 v241, v241
    v_mfma_f32_16x16x32_bf16 v[176:179], v[40:43], a[200:203], v[176:179]
    ds_read_b128 v[32:35], v2 offset:12544
    v_fma_f32 v240, v240, v48, v50
    v_mfma_f32_16x16x32_bf16 v[176:179], v[44:47], a[204:207], v[176:179]
    buffer_load_dwordx2 v[58:59], off, s[84:87], s37 offset:0
    v_exp_f32 v16, v96
    v_fma_f32 v241, v241, v49, v51
    v_mfma_f32_16x16x32_bf16 v[180:183], v[44:47], a[228:231], v[180:183]
    v_cvt_pk_bf16_f32 v226, v240, v241
    v_add_f32 v5, v5, v18
    v_mfma_f32_16x16x32_bf16 v[180:183], v[40:43], a[224:227], v[180:183]
    v_cvt_f32_i32 v244, v244
    v_add_f32 v5, v5, v19
    v_cvt_f32_i32 v245, v245
    v_exp_f32 v17, v97
    v_fma_f32 v244, v244, v48, v50
    v_mfma_f32_16x16x32_bf16 v[184:187], v[40:43], a[248:251], v[184:187]
    ds_read_b128 v[36:39], v3 offset:12544
    v_fma_f32 v245, v245, v49, v51
    v_mfma_f32_16x16x32_bf16 v[184:187], v[44:47], a[252:255], v[184:187]
    v_cvt_pk_bf16_f32 v161, v18, v19
    v_cvt_pk_bf16_f32 v230, v244, v245
    v_exp_f32 v18, v98
    v_cvt_f32_i32 v248, v248
    v_mfma_f32_16x16x32_bf16 v[188:191], v[44:47], v[212:215], v[188:191]
    v_cvt_f32_i32 v249, v249
    v_add_f32 v5, v5, v16
    v_mfma_f32_16x16x32_bf16 v[188:191], v[40:43], v[208:211], v[188:191]
    s_waitcnt lgkmcnt(2)
    v_fma_f32 v248, v248, v48, v50
    v_add_f32 v5, v5, v17
    v_fma_f32 v249, v249, v49, v51
    v_exp_f32 v19, v99
    v_mfma_f32_16x16x32_bf16 v[112:115], v[24:27], a[200:203], v[112:115]
    ds_read_b128 v[40:43], v2 offset:18688
    v_cvt_pk_bf16_f32 v234, v248, v249
    v_mfma_f32_16x16x32_bf16 v[112:115], v[28:31], a[204:207], v[112:115]
    v_cvt_f32_i32 v252, v252
    v_cvt_pk_bf16_f32 v162, v16, v17
    v_cvt_f32_i32 v253, v253
    v_exp_f32 v16, v164
    v_mfma_f32_16x16x32_bf16 v[116:119], v[28:31], a[228:231], v[116:119]
    v_fma_f32 v252, v252, v48, v50
    v_fma_f32 v253, v253, v49, v51
    v_mfma_f32_16x16x32_bf16 v[116:119], v[24:27], a[224:227], v[116:119]
    v_add_f32 v5, v5, v18
    v_cvt_pk_bf16_f32 v238, v252, v253
    v_add_f32 v5, v5, v19
    v_lshlrev_b32 v48, 16, v61
    v_exp_f32 v17, v165
    v_mfma_f32_16x16x32_bf16 v[120:123], v[24:27], a[248:251], v[120:123]
    ds_read_b128 v[44:47], v3 offset:18688
    v_and_b32 v49, s97, v61
    v_mfma_f32_16x16x32_bf16 v[120:123], v[28:31], a[252:255], v[120:123]
    s_waitcnt lgkmcnt(2)
    v_lshlrev_b32 v50, 16, v63
    v_cvt_pk_bf16_f32 v163, v18, v19
    v_and_b32 v51, s97, v63
    v_exp_f32 v18, v166
    v_mfma_f32_16x16x32_bf16 v[124:127], v[28:31], v[212:215], v[124:127]
    s_waitcnt vmcnt(30)
    v_mul_f32 v48, s38, v48
    v_mul_f32 v49, s38, v49
    v_mfma_f32_16x16x32_bf16 v[124:127], v[24:27], v[208:211], v[124:127]
    s_barrier
    v_add_f32 v6, v6, v16
    v_mul_f32_e64 v50, -v50, v48
    v_add_f32 v6, v6, v17
    v_mul_f32_e64 v51, -v51, v49
    v_mfma_f32_16x16x32_bf16 v[176:179], v[32:35], a[208:211], v[176:179]
    ds_read_b128 v[24:27], v1 offset:0
    v_cvt_f32_i32 v242, v242
    v_mfma_f32_16x16x32_bf16 v[176:179], v[36:39], a[212:215], v[176:179]
    v_exp_f32 v19, v167
    v_cvt_f32_i32 v243, v243
    v_cvt_pk_bf16_f32 v164, v16, v17
    v_fma_f32 v242, v242, v48, v50
    v_mfma_f32_16x16x32_bf16 v[180:183], v[36:39], a[236:239], v[180:183]
    v_exp_f32 v16, v100
    v_mfma_f32_16x16x32_bf16 v[180:183], v[32:35], a[232:235], v[180:183]
    v_fma_f32 v243, v243, v49, v51
    v_cvt_pk_bf16_f32 v227, v242, v243
    v_add_f32 v6, v6, v18
    v_cvt_f32_i32 v246, v246
    v_add_f32 v6, v6, v19
    v_cvt_f32_i32 v247, v247
    v_mfma_f32_16x16x32_bf16 v[184:187], v[32:35], v[192:195], v[184:187]
    ds_read_b128 v[28:31], v1 offset:12288
    v_fma_f32 v246, v246, v48, v50
    v_mfma_f32_16x16x32_bf16 v[184:187], v[36:39], v[196:199], v[184:187]
    v_exp_f32 v17, v101
    v_fma_f32 v247, v247, v49, v51
    v_cvt_pk_bf16_f32 v165, v18, v19
    v_cvt_pk_bf16_f32 v231, v246, v247
    v_mfma_f32_16x16x32_bf16 v[188:191], v[36:39], v[220:223], v[188:191]
    v_exp_f32 v18, v102
    v_mfma_f32_16x16x32_bf16 v[188:191], v[32:35], v[216:219], v[188:191]
    s_waitcnt lgkmcnt(2)
    v_cvt_f32_i32 v250, v250
    v_cvt_f32_i32 v251, v251
    v_add_f32 v6, v6, v16
    v_fma_f32 v250, v250, v48, v50
    v_add_f32 v6, v6, v17
    v_mfma_f32_16x16x32_bf16 v[112:115], v[40:43], a[208:211], v[112:115]
    ds_read_b128 v[32:35], v1 offset:1024
    v_fma_f32 v251, v251, v49, v51
    v_mfma_f32_16x16x32_bf16 v[112:115], v[44:47], a[212:215], v[112:115]
    v_exp_f32 v19, v103
    v_cvt_pk_bf16_f32 v235, v250, v251
    v_cvt_f32_i32 v254, v254
    v_cvt_pk_bf16_f32 v166, v16, v17
    v_mfma_f32_16x16x32_bf16 v[116:119], v[44:47], a[236:239], v[116:119]
    v_cvt_f32_i32 v255, v255
    v_add_f32 v6, v6, v18
    v_mfma_f32_16x16x32_bf16 v[116:119], v[40:43], a[232:235], v[116:119]
    v_fma_f32 v254, v254, v48, v50
    v_add_f32 v6, v6, v19
    v_fma_f32 v255, v255, v49, v51
    v_cvt_pk_bf16_f32 v167, v18, v19
    v_cvt_pk_bf16_f32 v239, v254, v255
    v_mfma_f32_16x16x32_bf16 v[120:123], v[40:43], v[192:195], v[120:123]
    ds_read_b128 v[36:39], v1 offset:13312
    v_mfma_f32_16x16x32_bf16 v[120:123], v[44:47], v[196:199], v[120:123]
    v_mfma_f32_16x16x32_bf16 v[124:127], v[44:47], v[220:223], v[124:127]
    v_mfma_f32_16x16x32_bf16 v[124:127], v[40:43], v[216:219], v[124:127]
    s_waitcnt lgkmcnt(2)
    v_mfma_f32_16x16x32_bf16 a[144:147], v[76:79], v[24:27], 0
    ds_read_b128 v[40:43], v1 offset:2048
    v_mfma_f32_16x16x32_bf16 a[144:147], v[92:95], v[28:31], a[144:147]
    buffer_store_dwordx4 v[224:227], v11, s[4:7], s33 offen offset:0 sc1
    v_mfma_f32_16x16x32_bf16 a[96:99], v[72:75], v[24:27], 0
    v_exp_f32 v16, v168
    v_mfma_f32_16x16x32_bf16 a[96:99], v[88:91], v[28:31], a[96:99]
    ds_read_b128 v[44:47], v1 offset:14336
    v_mfma_f32_16x16x32_bf16 a[0:3], v[80:83], v[28:31], a[0:3]
    v_exp_f32 v17, v169
    v_mfma_f32_16x16x32_bf16 a[48:51], v[84:87], v[28:31], a[48:51]
    s_waitcnt lgkmcnt(2)
    v_exp_f32 v18, v170
    v_mfma_f32_16x16x32_bf16 a[148:151], v[76:79], v[32:35], 0
    ds_read_b128 v[24:27], v1 offset:3072
    v_add_f32 v7, v7, v16
    v_mfma_f32_16x16x32_bf16 a[148:151], v[92:95], v[36:39], a[148:151]
    v_add_f32 v7, v7, v17
    v_mfma_f32_16x16x32_bf16 a[100:103], v[72:75], v[32:35], 0
    v_exp_f32 v19, v171
    v_mfma_f32_16x16x32_bf16 a[100:103], v[88:91], v[36:39], a[100:103]
    ds_read_b128 v[28:31], v1 offset:15360
    v_cvt_pk_bf16_f32 v168, v16, v17
    v_mfma_f32_16x16x32_bf16 a[4:7], v[80:83], v[36:39], a[4:7]
    v_exp_f32 v16, v104
    v_mfma_f32_16x16x32_bf16 a[52:55], v[84:87], v[36:39], a[52:55]
    s_waitcnt lgkmcnt(2)
    v_add_f32 v7, v7, v18
    v_add_f32 v7, v7, v19
    v_mfma_f32_16x16x32_bf16 a[152:155], v[76:79], v[40:43], 0
    ds_read_b128 v[32:35], v1 offset:4096
    v_mfma_f32_16x16x32_bf16 a[152:155], v[92:95], v[44:47], a[152:155]
    buffer_store_dwordx4 v[228:231], v21, s[4:7], s33 offen offset:768 sc1
    v_mfma_f32_16x16x32_bf16 a[104:107], v[72:75], v[40:43], 0
    v_exp_f32 v17, v105
    v_mfma_f32_16x16x32_bf16 a[104:107], v[88:91], v[44:47], a[104:107]
    ds_read_b128 v[36:39], v1 offset:16384
    v_cvt_pk_bf16_f32 v169, v18, v19
    v_mfma_f32_16x16x32_bf16 a[8:11], v[80:83], v[44:47], a[8:11]
    v_exp_f32 v18, v106
    v_mfma_f32_16x16x32_bf16 a[56:59], v[84:87], v[44:47], a[56:59]
    s_waitcnt lgkmcnt(2)
    v_add_f32 v7, v7, v16
    v_add_f32 v7, v7, v17
    v_mfma_f32_16x16x32_bf16 a[156:159], v[76:79], v[24:27], 0
    ds_read_b128 v[40:43], v1 offset:5120
    v_mfma_f32_16x16x32_bf16 a[156:159], v[92:95], v[28:31], a[156:159]
    v_exp_f32 v19, v107
    v_cvt_pk_bf16_f32 v170, v16, v17
    v_mfma_f32_16x16x32_bf16 a[108:111], v[72:75], v[24:27], 0
    v_exp_f32 v16, v172
    v_mfma_f32_16x16x32_bf16 a[108:111], v[88:91], v[28:31], a[108:111]
    ds_read_b128 v[44:47], v1 offset:17408
    v_add_f32 v7, v7, v18
    v_add_f32 v7, v7, v19
    v_mfma_f32_16x16x32_bf16 a[12:15], v[80:83], v[28:31], a[12:15]
    v_exp_f32 v17, v173
    v_mfma_f32_16x16x32_bf16 a[60:63], v[84:87], v[28:31], a[60:63]
    s_waitcnt lgkmcnt(2)
    v_cvt_pk_bf16_f32 v171, v18, v19
    v_mfma_f32_16x16x32_bf16 a[160:163], v[76:79], v[32:35], 0
    ds_read_b128 v[24:27], v1 offset:6144
    v_mfma_f32_16x16x32_bf16 a[160:163], v[92:95], v[36:39], a[160:163]
    buffer_store_dwordx4 v[232:235], v22, s[4:7], s33 offen offset:1536 sc1
    v_mfma_f32_16x16x32_bf16 a[112:115], v[72:75], v[32:35], 0
    v_exp_f32 v18, v174
    v_mfma_f32_16x16x32_bf16 a[112:115], v[88:91], v[36:39], a[112:115]
    ds_read_b128 v[28:31], v1 offset:18432
    v_add_f32 v8, v8, v16
    v_add_f32 v8, v8, v17
    v_mfma_f32_16x16x32_bf16 a[16:19], v[80:83], v[36:39], a[16:19]
    v_exp_f32 v19, v175
    v_mfma_f32_16x16x32_bf16 a[64:67], v[84:87], v[36:39], a[64:67]
    s_waitcnt lgkmcnt(2)
    v_cvt_pk_bf16_f32 v172, v16, v17
    v_exp_f32 v16, v108
    v_mfma_f32_16x16x32_bf16 a[164:167], v[76:79], v[40:43], 0
    ds_read_b128 v[32:35], v1 offset:7168
    v_add_f32 v8, v8, v18
    v_mfma_f32_16x16x32_bf16 a[164:167], v[92:95], v[44:47], a[164:167]
    v_add_f32 v8, v8, v19
    v_exp_f32 v17, v109
    v_mfma_f32_16x16x32_bf16 a[116:119], v[72:75], v[40:43], 0
    v_cvt_pk_bf16_f32 v173, v18, v19
    v_mfma_f32_16x16x32_bf16 a[116:119], v[88:91], v[44:47], a[116:119]
    ds_read_b128 v[36:39], v1 offset:19456
    v_exp_f32 v18, v110
    v_mfma_f32_16x16x32_bf16 a[20:23], v[80:83], v[44:47], a[20:23]
    v_add_f32 v8, v8, v16
    v_add_f32 v8, v8, v17
    v_mfma_f32_16x16x32_bf16 a[68:71], v[84:87], v[44:47], a[68:71]
    s_waitcnt lgkmcnt(2)
    v_exp_f32 v19, v111
    v_mfma_f32_16x16x32_bf16 a[168:171], v[76:79], v[24:27], 0
    ds_read_b128 v[40:43], v1 offset:8192
    v_cvt_pk_bf16_f32 v174, v16, v17
    v_mfma_f32_16x16x32_bf16 a[168:171], v[92:95], v[28:31], a[168:171]
    buffer_store_dwordx4 v[236:239], v23, s[4:7], s33 offen offset:2304 sc1
    v_mfma_f32_16x16x32_bf16 a[120:123], v[72:75], v[24:27], 0
    v_add_f32 v8, v8, v18
    v_add_f32 v8, v8, v19
    v_mfma_f32_16x16x32_bf16 a[120:123], v[88:91], v[28:31], a[120:123]
    ds_read_b128 v[44:47], v1 offset:20480
    v_cvt_pk_bf16_f32 v175, v18, v19
    v_mfma_f32_16x16x32_bf16 a[24:27], v[80:83], v[28:31], a[24:27]
    v_exp_f32 v16, v176
    v_mfma_f32_16x16x32_bf16 a[72:75], v[84:87], v[28:31], a[72:75]
    s_waitcnt lgkmcnt(2)
    v_exp_f32 v17, v177
    v_mfma_f32_16x16x32_bf16 a[172:175], v[76:79], v[32:35], 0
    ds_read_b128 v[24:27], v1 offset:9216
    v_mfma_f32_16x16x32_bf16 a[172:175], v[92:95], v[36:39], a[172:175]
    v_exp_f32 v18, v178
    v_add_f32 v5, v5, v16
    v_mfma_f32_16x16x32_bf16 a[124:127], v[72:75], v[32:35], 0
    v_add_f32 v5, v5, v17
    v_mfma_f32_16x16x32_bf16 a[124:127], v[88:91], v[36:39], a[124:127]
    ds_read_b128 v[28:31], v1 offset:21504
    v_exp_f32 v19, v179
    v_mfma_f32_16x16x32_bf16 a[28:31], v[80:83], v[36:39], a[28:31]
    v_cvt_pk_bf16_f32 v176, v16, v17
    v_mfma_f32_16x16x32_bf16 a[76:79], v[84:87], v[36:39], a[76:79]
    s_waitcnt lgkmcnt(2)
    buffer_load_dwordx2 v[60:61], off, s[80:83], s37 offset:8
    v_mfma_f32_16x16x32_bf16 a[176:179], v[76:79], v[40:43], 0
    ds_read_b128 v[32:35], v1 offset:10240
    v_mfma_f32_16x16x32_bf16 a[176:179], v[92:95], v[44:47], a[176:179]
    buffer_load_dwordx2 v[62:63], off, s[84:87], s37 offset:8
    v_mfma_f32_16x16x32_bf16 a[128:131], v[72:75], v[40:43], 0
    v_exp_f32 v16, v112
    v_mfma_f32_16x16x32_bf16 a[128:131], v[88:91], v[44:47], a[128:131]
    ds_read_b128 v[36:39], v1 offset:22528
    v_add_f32 v5, v5, v18
    v_add_f32 v5, v5, v19
    v_mfma_f32_16x16x32_bf16 a[32:35], v[80:83], v[44:47], a[32:35]
    v_exp_f32 v17, v113
    v_mfma_f32_16x16x32_bf16 a[80:83], v[84:87], v[44:47], a[80:83]
    s_waitcnt lgkmcnt(2)
    s_waitcnt vmcnt(19)
    buffer_load_dwordx3 v[240:242], v12, s[68:71], s16 offen offset:0 nt
    v_cvt_pk_bf16_f32 v177, v18, v19
    v_mfma_f32_16x16x32_bf16 a[180:183], v[76:79], v[24:27], 0
    ds_read_b128 v[40:43], v1 offset:11264
    v_mfma_f32_16x16x32_bf16 a[180:183], v[92:95], v[28:31], a[180:183]
    buffer_load_dwordx3 v[244:246], v12, s[68:71], s16 offen offset:768 nt
    v_mfma_f32_16x16x32_bf16 a[132:135], v[72:75], v[24:27], 0
    v_exp_f32 v18, v114
    v_mfma_f32_16x16x32_bf16 a[132:135], v[88:91], v[28:31], a[132:135]
    s_waitcnt vmcnt(20)
    ds_read_b128 v[44:47], v1 offset:23552
    v_add_f32 v5, v5, v16
    v_add_f32 v5, v5, v17
    v_mfma_f32_16x16x32_bf16 a[36:39], v[80:83], v[28:31], a[36:39]
    v_exp_f32 v19, v115
    v_mfma_f32_16x16x32_bf16 a[84:87], v[84:87], v[28:31], a[84:87]
    s_waitcnt lgkmcnt(2)
    s_barrier
    v_add_u32 v2, 49152, v2
    v_add_u32 v3, 49152, v3
    v_mfma_f32_16x16x32_bf16 a[184:187], v[76:79], v[32:35], 0
    ds_read_b128 v[24:27], v2 offset:0
    v_cvt_pk_bf16_f32 v178, v16, v17
    v_mfma_f32_16x16x32_bf16 a[184:187], v[92:95], v[36:39], a[184:187]
    buffer_load_dwordx3 v[248:250], v12, s[68:71], s16 offen offset:1536 nt
    v_mfma_f32_16x16x32_bf16 a[136:139], v[72:75], v[32:35], 0
    v_exp_f32 v16, v180
    v_mfma_f32_16x16x32_bf16 a[136:139], v[88:91], v[36:39], a[136:139]
    ds_read_b128 v[28:31], v3 offset:0
    v_add_f32 v5, v5, v18
    v_add_f32 v5, v5, v19
    v_mfma_f32_16x16x32_bf16 a[40:43], v[80:83], v[36:39], a[40:43]
    v_exp_f32 v17, v181
    v_mfma_f32_16x16x32_bf16 a[88:91], v[84:87], v[36:39], a[88:91]
    s_waitcnt lgkmcnt(2)
    s_waitcnt vmcnt(20)
    buffer_load_dwordx3 v[252:254], v12, s[68:71], s16 offen offset:2304 nt
    v_cvt_pk_bf16_f32 v179, v18, v19
    v_mfma_f32_16x16x32_bf16 a[188:191], v[76:79], v[40:43], 0
    ds_read_b128 v[32:35], v2 offset:6144
    v_mfma_f32_16x16x32_bf16 a[188:191], v[92:95], v[44:47], a[188:191]
    v_exp_f32 v18, v182
    v_add_f32 v6, v6, v16
    v_mfma_f32_16x16x32_bf16 a[140:143], v[72:75], v[40:43], 0
    v_add_f32 v6, v6, v17
    v_mfma_f32_16x16x32_bf16 a[140:143], v[88:91], v[44:47], a[140:143]
    ds_read_b128 v[36:39], v3 offset:6144
    v_exp_f32 v19, v183
    v_mfma_f32_16x16x32_bf16 a[44:47], v[80:83], v[44:47], a[44:47]
    v_cvt_pk_bf16_f32 v180, v16, v17
    v_mfma_f32_16x16x32_bf16 a[92:95], v[84:87], v[44:47], a[92:95]
    s_waitcnt lgkmcnt(2)
    v_exp_f32 v16, v116
    v_add_f32 v6, v6, v18
    v_add_f32 v6, v6, v19
    v_exp_f32 v17, v117
    v_cvt_pk_bf16_f32 v181, v18, v19
    v_exp_f32 v18, v118
    v_add_f32 v6, v6, v16
    v_add_f32 v6, v6, v17
    v_exp_f32 v19, v119
    v_cvt_pk_bf16_f32 v182, v16, v17
    v_add_f32 v6, v6, v18
    v_add_f32 v6, v6, v19
    v_cvt_pk_bf16_f32 v183, v18, v19
    v_mfma_f32_16x16x32_bf16 v[64:67], v[24:27], a[192:195], v[128:131]
    s_waitcnt vmcnt(10)
    ds_read_b128 v[40:43], v2 offset:128
    v_lshlrev_b32 v48, 16, v56
    v_mfma_f32_16x16x32_bf16 v[64:67], v[28:31], a[196:199], v[64:67]
    v_exp_f32 v16, v184
    v_mfma_f32_16x16x32_bf16 v[68:71], v[28:31], a[220:223], v[132:135]
    v_exp_f32 v17, v185
    v_mfma_f32_16x16x32_bf16 v[68:71], v[24:27], a[216:219], v[68:71]
    v_exp_f32 v18, v186
    v_mfma_f32_16x16x32_bf16 v[72:75], v[24:27], a[240:243], v[136:139]
    ds_read_b128 v[44:47], v3 offset:128
    v_and_b32 v49, s97, v56
    v_mfma_f32_16x16x32_bf16 v[72:75], v[28:31], a[244:247], v[72:75]
    v_add_f32 v7, v7, v16
    v_add_f32 v7, v7, v17
    v_mfma_f32_16x16x32_bf16 v[76:79], v[28:31], v[204:207], v[140:143]
    v_exp_f32 v19, v187
    v_mfma_f32_16x16x32_bf16 v[76:79], v[24:27], v[200:203], v[76:79]
    s_waitcnt lgkmcnt(2)
    v_lshlrev_b32 v50, 16, v58
    v_and_b32 v51, s97, v58
    v_mfma_f32_16x16x32_bf16 v[96:99], v[32:35], a[192:195], v[128:131]
    ds_read_b128 v[24:27], v2 offset:6272
    v_cvt_pk_bf16_f32 v184, v16, v17
    v_mfma_f32_16x16x32_bf16 v[96:99], v[36:39], a[196:199], v[96:99]
    v_exp_f32 v16, v120
    v_mfma_f32_16x16x32_bf16 v[100:103], v[36:39], a[220:223], v[132:135]
    v_mul_f32_e64 v50, -v50, v48
    v_add_f32 v7, v7, v18
    v_mfma_f32_16x16x32_bf16 v[100:103], v[32:35], a[216:219], v[100:103]
    v_add_f32 v7, v7, v19
    v_mul_f32_e64 v51, -v51, v49
    v_mfma_f32_16x16x32_bf16 v[104:107], v[32:35], a[240:243], v[136:139]
    ds_read_b128 v[28:31], v3 offset:6272
    v_cvt_f32_i32 v144, v144
    v_mfma_f32_16x16x32_bf16 v[104:107], v[36:39], a[244:247], v[104:107]
    s_waitcnt lgkmcnt(2)
    v_exp_f32 v17, v121
    v_mfma_f32_16x16x32_bf16 v[108:111], v[36:39], v[204:207], v[140:143]
    s_waitcnt vmcnt(6)
    v_cvt_pk_bf16_f32 v185, v18, v19
    v_cvt_f32_i32 v148, v148
    v_mfma_f32_16x16x32_bf16 v[108:111], v[32:35], v[200:203], v[108:111]
    s_barrier
    v_mfma_f32_16x16x32_bf16 v[64:67], v[40:43], a[200:203], v[64:67]
    ds_read_b128 v[32:35], v2 offset:256
    v_add_u32 v0, 1, v0
    v_mfma_f32_16x16x32_bf16 v[64:67], v[44:47], a[204:207], v[64:67]
    buffer_store_dword v0, v13, s[20:23], 0 offen offset:32 sc1
    v_mfma_f32_16x16x32_bf16 v[68:71], v[44:47], a[228:231], v[68:71]
    s_mov_b32 m0, s26
    v_exp_f32 v18, v122
    v_mfma_f32_16x16x32_bf16 v[68:71], v[40:43], a[224:227], v[68:71]
    v_add_f32 v7, v7, v16
    v_add_f32 v7, v7, v17
    v_mfma_f32_16x16x32_bf16 v[72:75], v[40:43], a[248:251], v[72:75]
    ds_read_b128 v[36:39], v3 offset:256
    v_fma_f32 v144, v144, v48, v50
    v_mfma_f32_16x16x32_bf16 v[72:75], v[44:47], a[252:255], v[72:75]
    buffer_load_dwordx4 v4, s[4:7], s32 offen offset:0 sc1 lds
    v_mfma_f32_16x16x32_bf16 v[76:79], v[44:47], v[212:215], v[76:79]
    v_exp_f32 v19, v123
    v_mfma_f32_16x16x32_bf16 v[76:79], v[40:43], v[208:211], v[76:79]
    s_waitcnt lgkmcnt(2)
    v_cvt_pk_bf16_f32 v186, v16, v17
    v_fma_f32 v148, v148, v49, v51
    v_mfma_f32_16x16x32_bf16 v[96:99], v[24:27], a[200:203], v[96:99]
    ds_read_b128 v[40:43], v2 offset:6400
    v_cvt_f32_i32 v145, v145
    v_mfma_f32_16x16x32_bf16 v[96:99], v[28:31], a[204:207], v[96:99]
    buffer_load_dwordx4 v4, s[4:7], s32 offen offset:1024 sc1 lds
    v_mfma_f32_16x16x32_bf16 v[100:103], v[28:31], a[228:231], v[100:103]
    v_exp_f32 v16, v188
    v_mfma_f32_16x16x32_bf16 v[100:103], v[24:27], a[224:227], v[100:103]
    v_add_f32 v7, v7, v18
    v_add_f32 v7, v7, v19
    v_mfma_f32_16x16x32_bf16 v[104:107], v[24:27], a[248:251], v[104:107]
    ds_read_b128 v[44:47], v3 offset:6400
    v_cvt_f32_i32 v149, v149
    v_mfma_f32_16x16x32_bf16 v[104:107], v[28:31], a[252:255], v[104:107]
    buffer_load_dwordx4 v4, s[4:7], s32 offen offset:2048 sc1 lds
    v_mfma_f32_16x16x32_bf16 v[108:111], v[28:31], v[212:215], v[108:111]
    s_add_u32 s32, s32, 24576
    v_exp_f32 v17, v189
    v_mfma_f32_16x16x32_bf16 v[108:111], v[24:27], v[208:211], v[108:111]
    s_waitcnt lgkmcnt(2)
    v_cvt_pk_bf16_f32 v187, v18, v19
    v_fma_f32 v145, v145, v48, v50
    v_mfma_f32_16x16x32_bf16 v[64:67], v[32:35], a[208:211], v[64:67]
    s_sub_u32 s57, s32, 196608
    ds_read_b128 v[24:27], v2 offset:12288
    v_fma_f32 v149, v149, v49, v51
    v_mfma_f32_16x16x32_bf16 v[64:67], v[36:39], a[212:215], v[64:67]
    s_min_u32 s32, s32, s57
    v_exp_f32 v18, v190
    v_mfma_f32_16x16x32_bf16 v[68:71], v[36:39], a[236:239], v[68:71]
    s_add_u32 s26, s26, 12288
    v_add_f32 v8, v8, v16
    v_add_f32 v8, v8, v17
    v_mfma_f32_16x16x32_bf16 v[68:71], v[32:35], a[232:235], v[68:71]
    s_mov_b32 m0, s26
    v_exp_f32 v19, v191
    v_mfma_f32_16x16x32_bf16 v[72:75], v[32:35], v[192:195], v[72:75]
    ds_read_b128 v[28:31], v3 offset:12288
    v_cvt_pk_bf16_f32 v188, v16, v17
    v_mfma_f32_16x16x32_bf16 v[72:75], v[36:39], v[196:199], v[72:75]
    v_exp_f32 v16, v124
    v_mfma_f32_16x16x32_bf16 v[76:79], v[36:39], v[220:223], v[76:79]
    v_add_f32 v8, v8, v18
    v_add_f32 v8, v8, v19
    v_mfma_f32_16x16x32_bf16 v[76:79], v[32:35], v[216:219], v[76:79]
    s_waitcnt lgkmcnt(2)
    buffer_load_dwordx4 v4, s[4:7], s32 offen offset:0 sc1 lds
    v_mfma_f32_16x16x32_bf16 v[96:99], v[40:43], a[208:211], v[96:99]
    ds_read_b128 v[32:35], v2 offset:18432
    v_cvt_f32_i32 v146, v146
    v_mfma_f32_16x16x32_bf16 v[96:99], v[44:47], a[212:215], v[96:99]
    v_exp_f32 v17, v125
    v_mfma_f32_16x16x32_bf16 v[100:103], v[44:47], a[236:239], v[100:103]
    v_cvt_pk_bf16_f32 v189, v18, v19
    v_cvt_f32_i32 v150, v150
    v_mfma_f32_16x16x32_bf16 v[100:103], v[40:43], a[232:235], v[100:103]
    buffer_load_dwordx4 v4, s[4:7], s32 offen offset:1024 sc1 lds
    v_mfma_f32_16x16x32_bf16 v[104:107], v[40:43], v[192:195], v[104:107]
    ds_read_b128 v[36:39], v3 offset:18432
    v_fma_f32 v146, v146, v48, v50
    v_mfma_f32_16x16x32_bf16 v[104:107], v[44:47], v[196:199], v[104:107]
    v_exp_f32 v18, v126
    v_mfma_f32_16x16x32_bf16 v[108:111], v[44:47], v[220:223], v[108:111]
    v_add_f32 v8, v8, v16
    v_add_f32 v8, v8, v17
    v_mfma_f32_16x16x32_bf16 v[108:111], v[40:43], v[216:219], v[108:111]
    s_waitcnt lgkmcnt(2)
    buffer_load_dwordx4 v4, s[4:7], s32 offen offset:2048 sc1 lds
    v_mfma_f32_16x16x32_bf16 v[80:83], v[24:27], a[192:195], v[128:131]
    s_mov_b32 s32, 196608
    ds_read_b128 v[40:43], v2 offset:12416
    v_fma_f32 v150, v150, v49, v51
    v_mfma_f32_16x16x32_bf16 v[80:83], v[28:31], a[196:199], v[80:83]
    v_exp_f32 v19, v127
    v_cvt_pk_bf16_f32 v190, v16, v17
    v_mfma_f32_16x16x32_bf16 v[84:87], v[28:31], a[220:223], v[132:135]
    s_add_u32 s26, s26, 36864
    v_add_f32 v8, v8, v18
    v_add_f32 v8, v8, v19
    v_mfma_f32_16x16x32_bf16 v[84:87], v[24:27], a[216:219], v[84:87]
    s_sub_u32 s57, s26, 147456
    v_cvt_pk_bf16_f32 v191, v18, v19
    v_lshlrev_b32 v48, 16, v57
    v_mfma_f32_16x16x32_bf16 v[88:91], v[24:27], a[240:243], v[136:139]
    ds_read_b128 v[44:47], v3 offset:12416
    v_and_b32 v49, s97, v57
    v_mfma_f32_16x16x32_bf16 v[88:91], v[28:31], a[244:247], v[88:91]
    s_min_u32 s26, s26, s57
    v_exp_f32 v16, v64
    v_mfma_f32_16x16x32_bf16 v[92:95], v[28:31], v[204:207], v[140:143]
    v_exp_f32 v17, v65
    v_mfma_f32_16x16x32_bf16 v[92:95], v[24:27], v[200:203], v[92:95]
    s_waitcnt lgkmcnt(2)
    v_exp_f32 v18, v66
    v_mfma_f32_16x16x32_bf16 v[112:115], v[32:35], a[192:195], v[128:131]
    s_mov_b32 m0, s56
    ds_read_b128 v[24:27], v2 offset:18560
    v_lshlrev_b32 v50, 16, v59
    v_mfma_f32_16x16x32_bf16 v[112:115], v[36:39], a[196:199], v[112:115]
L_iw2:
L_pg2:
    s_cbranch_execz L_pg6
    v_add_f32 v5, v5, v16
    v_add_f32 v5, v5, v17
    v_mfma_f32_16x16x32_bf16 v[116:119], v[36:39], a[220:223], v[132:135]
    v_exp_f32 v19, v67
    v_mfma_f32_16x16x32_bf16 v[116:119], v[32:35], a[216:219], v[116:119]
    buffer_load_dwordx4 v4, s[4:7], s27 offen offset:0 sc1 lds
    v_mfma_f32_16x16x32_bf16 v[120:123], v[32:35], a[240:243], v[136:139]
    ds_read_b128 v[28:31], v3 offset:18560
    v_and_b32 v51, s97, v59
    v_mfma_f32_16x16x32_bf16 v[120:123], v[36:39], a[244:247], v[120:123]
    v_cvt_pk_bf16_f32 v64, v16, v17
    v_mul_f32_e64 v50, -v50, v48
    v_mfma_f32_16x16x32_bf16 v[124:127], v[36:39], v[204:207], v[140:143]
    v_exp_f32 v16, v96
    v_mfma_f32_16x16x32_bf16 v[124:127], v[32:35], v[200:203], v[124:127]
    s_waitcnt lgkmcnt(2)
    buffer_load_dwordx4 v4, s[4:7], s27 offen offset:1024 sc1 lds
    v_mfma_f32_16x16x32_bf16 v[80:83], v[40:43], a[200:203], v[80:83]
    ds_read_b128 v[32:35], v2 offset:12544
    v_add_f32 v5, v5, v18
    v_mfma_f32_16x16x32_bf16 v[80:83], v[44:47], a[204:207], v[80:83]
    v_add_f32 v5, v5, v19
    v_mul_f32_e64 v51, -v51, v49
    v_mfma_f32_16x16x32_bf16 v[84:87], v[44:47], a[228:231], v[84:87]
    v_exp_f32 v17, v97
    v_mfma_f32_16x16x32_bf16 v[84:87], v[40:43], a[224:227], v[84:87]
    s_waitcnt vmcnt(13)
    buffer_load_dwordx4 v4, s[4:7], s27 offen offset:2048 sc1 lds
    v_cvt_pk_bf16_f32 v65, v18, v19
    v_mfma_f32_16x16x32_bf16 v[88:91], v[40:43], a[248:251], v[88:91]
    s_add_u32 s27, s27, 24576
    ds_read_b128 v[36:39], v3 offset:12544
    v_cvt_f32_i32 v152, v152
    v_mfma_f32_16x16x32_bf16 v[88:91], v[44:47], a[252:255], v[88:91]
    v_exp_f32 v18, v98
    v_mfma_f32_16x16x32_bf16 v[92:95], v[44:47], v[212:215], v[92:95]
    s_sub_u32 s58, s27, 196608
    v_add_f32 v5, v5, v16
    v_add_f32 v5, v5, v17
    v_mfma_f32_16x16x32_bf16 v[92:95], v[40:43], v[208:211], v[92:95]
    s_waitcnt lgkmcnt(2)
    v_cvt_f32_i32 v156, v156
    v_fma_f32 v152, v152, v48, v50
    v_mfma_f32_16x16x32_bf16 v[112:115], v[24:27], a[200:203], v[112:115]
    s_min_u32 s27, s27, s58
    ds_read_b128 v[40:43], v2 offset:18688
    v_fma_f32 v156, v156, v49, v51
    v_mfma_f32_16x16x32_bf16 v[112:115], v[28:31], a[204:207], v[112:115]
    v_exp_f32 v19, v99
    v_cvt_pk_bf16_f32 v66, v16, v17
    v_mfma_f32_16x16x32_bf16 v[116:119], v[28:31], a[228:231], v[116:119]
    s_add_u32 s56, s56, 12288
    v_exp_f32 v16, v68
    v_mfma_f32_16x16x32_bf16 v[116:119], v[24:27], a[224:227], v[116:119]
    s_mov_b32 m0, s56
    v_add_f32 v5, v5, v18
    v_cvt_f32_i32 v153, v153
    v_mfma_f32_16x16x32_bf16 v[120:123], v[24:27], a[248:251], v[120:123]
    ds_read_b128 v[44:47], v3 offset:18688
    v_add_f32 v5, v5, v19
    v_mfma_f32_16x16x32_bf16 v[120:123], v[28:31], a[252:255], v[120:123]
    s_waitcnt lgkmcnt(2)
    v_exp_f32 v17, v69
    v_mfma_f32_16x16x32_bf16 v[124:127], v[28:31], v[212:215], v[124:127]
    s_waitcnt vmcnt(26)
    v_cvt_f32_i32 v157, v157
    v_cvt_pk_bf16_f32 v67, v18, v19
    v_mfma_f32_16x16x32_bf16 v[124:127], v[24:27], v[208:211], v[124:127]
    s_barrier
    v_add_u32 v1, 49152, v1
    v_mfma_f32_16x16x32_bf16 v[80:83], v[32:35], a[208:211], v[80:83]
    ds_read_b128 v[24:27], v1 offset:0
    v_fma_f32 v153, v153, v48, v50
    v_mfma_f32_16x16x32_bf16 v[80:83], v[36:39], a[212:215], v[80:83]
    s_waitcnt vmcnt(12)
    buffer_load_dwordx4 v4, s[4:7], s27 offen offset:0 sc1 lds
    v_mfma_f32_16x16x32_bf16 v[84:87], v[36:39], a[236:239], v[84:87]
    v_exp_f32 v18, v70
    v_mfma_f32_16x16x32_bf16 v[84:87], v[32:35], a[232:235], v[84:87]
    v_add_f32 v6, v6, v16
    v_add_f32 v6, v6, v17
    v_mfma_f32_16x16x32_bf16 v[88:91], v[32:35], v[192:195], v[88:91]
    ds_read_b128 v[28:31], v1 offset:12288
    v_fma_f32 v157, v157, v49, v51
    v_mfma_f32_16x16x32_bf16 v[88:91], v[36:39], v[196:199], v[88:91]
    s_waitcnt vmcnt(12)
    buffer_load_dwordx4 v4, s[4:7], s27 offen offset:1024 sc1 lds
    v_mfma_f32_16x16x32_bf16 v[92:95], v[36:39], v[220:223], v[92:95]
    v_exp_f32 v19, v71
    v_mfma_f32_16x16x32_bf16 v[92:95], v[32:35], v[216:219], v[92:95]
    s_waitcnt lgkmcnt(2)
    v_cvt_pk_bf16_f32 v68, v16, v17
    v_exp_f32 v16, v100
    v_mfma_f32_16x16x32_bf16 v[112:115], v[40:43], a[208:211], v[112:115]
    ds_read_b128 v[32:35], v1 offset:1024
    v_cvt_f32_i32 v154, v154
    v_mfma_f32_16x16x32_bf16 v[112:115], v[44:47], a[212:215], v[112:115]
    s_waitcnt vmcnt(12)
    buffer_load_dwordx4 v4, s[4:7], s27 offen offset:2048 sc1 lds
    v_add_f32 v6, v6, v18
    v_mfma_f32_16x16x32_bf16 v[116:119], v[44:47], a[236:239], v[116:119]
    v_add_f32 v6, v6, v19
    v_cvt_f32_i32 v158, v158
    v_mfma_f32_16x16x32_bf16 v[116:119], v[40:43], a[232:235], v[116:119]
    v_exp_f32 v17, v101
    v_cvt_pk_bf16_f32 v69, v18, v19
    v_mfma_f32_16x16x32_bf16 v[120:123], v[40:43], v[192:195], v[120:123]
    s_add_u32 s27, s27, 24576
    ds_read_b128 v[36:39], v1 offset:13312
    v_fma_f32 v154, v154, v48, v50
    v_mfma_f32_16x16x32_bf16 v[120:123], v[44:47], v[196:199], v[120:123]
    v_exp_f32 v18, v102
    v_fma_f32 v158, v158, v49, v51
    v_mfma_f32_16x16x32_bf16 v[124:127], v[44:47], v[220:223], v[124:127]
    s_sub_u32 s58, s27, 196608
    v_add_f32 v6, v6, v16
    v_add_f32 v6, v6, v17
    v_mfma_f32_16x16x32_bf16 v[124:127], v[40:43], v[216:219], v[124:127]
    s_waitcnt lgkmcnt(2)
    v_exp_f32 v19, v103
    v_cvt_pk_bf16_f32 v144, v144, v148
    v_cvt_pk_bf16_f32 v148, v145, v149
    v_cvt_pk_bf16_f32 v70, v16, v17
    s_min_u32 s27, s27, s58
    v_cvt_pk_bf16_f32 v145, v152, v156
    v_add_f32 v6, v6, v18
    s_add_u32 s56, s56, 36864
    v_cvt_pk_bf16_f32 v149, v153, v157
    v_add_f32 v6, v6, v19
    s_sub_u32 s58, s56, 147456
    v_cvt_pk_bf16_f32 v152, v146, v150
    v_cvt_pk_bf16_f32 v71, v18, v19
    s_min_u32 s56, s56, s58
    v_cvt_pk_bf16_f32 v153, v154, v158
    s_mov_b32 s31, 6
    v_mfma_f32_16x16x32_bf16 a[0:3], v[160:163], v[24:27], a[0:3]
    s_add_u32 s33, s33, 196608
    ds_read_b128 v[40:43], v1 offset:2048
    v_mfma_f32_16x16x32_bf16 a[0:3], v[176:179], v[28:31], a[0:3]
    s_add_u32 s34, s34, 196608
    v_exp_f32 v16, v72
    v_mfma_f32_16x16x32_bf16 a[48:51], v[180:183], v[28:31], a[48:51]
    s_add_u32 s36, s36, 1536
    v_exp_f32 v17, v73
    v_mfma_f32_16x16x32_bf16 a[48:51], v[164:167], v[24:27], a[48:51]
    v_exp_f32 v18, v74
    v_mfma_f32_16x16x32_bf16 a[96:99], v[168:171], v[24:27], a[96:99]
    ds_read_b128 v[44:47], v1 offset:14336
    v_add_f32 v7, v7, v16
    v_mfma_f32_16x16x32_bf16 a[96:99], v[184:187], v[28:31], a[96:99]
    s_waitcnt vmcnt(11)
    buffer_load_dwordx2 v[56:57], v10, s[72:75], s36 offen offset:0
    v_mfma_f32_16x16x32_bf16 a[144:147], v[188:191], v[28:31], a[144:147]
    v_add_f32 v7, v7, v17
    v_mfma_f32_16x16x32_bf16 a[144:147], v[172:175], v[24:27], a[144:147]
    s_waitcnt lgkmcnt(2)
    v_exp_f32 v19, v75
    v_mfma_f32_16x16x32_bf16 a[4:7], v[160:163], v[32:35], a[4:7]
    ds_read_b128 v[24:27], v1 offset:3072
    v_cvt_pk_bf16_f32 v72, v16, v17
    v_mfma_f32_16x16x32_bf16 a[4:7], v[176:179], v[36:39], a[4:7]
    buffer_load_dwordx2 v[58:59], v10, s[76:79], s36 offen offset:0
    v_mfma_f32_16x16x32_bf16 a[52:55], v[180:183], v[36:39], a[52:55]
    v_exp_f32 v16, v104
    v_mfma_f32_16x16x32_bf16 a[52:55], v[164:167], v[32:35], a[52:55]
    v_add_f32 v7, v7, v18
    v_add_f32 v7, v7, v19
    v_mfma_f32_16x16x32_bf16 a[100:103], v[168:171], v[32:35], a[100:103]
    ds_read_b128 v[28:31], v1 offset:15360
    v_mfma_f32_16x16x32_bf16 a[100:103], v[184:187], v[36:39], a[100:103]
    s_waitcnt vmcnt(12)
    buffer_load_dwordx4 v[224:227], v9, s[64:67], s33 offen offset:0 nt
    v_mfma_f32_16x16x32_bf16 a[148:151], v[188:191], v[36:39], a[148:151]
    v_exp_f32 v17, v105
    v_mfma_f32_16x16x32_bf16 a[148:151], v[172:175], v[32:35], a[148:151]
    s_waitcnt lgkmcnt(2)
    v_cvt_pk_bf16_f32 v73, v18, v19
    v_mfma_f32_16x16x32_bf16 a[8:11], v[160:163], v[40:43], a[8:11]
    ds_read_b128 v[32:35], v1 offset:4096
    v_mfma_f32_16x16x32_bf16 a[8:11], v[176:179], v[44:47], a[8:11]
    s_waitcnt vmcnt(12)
    buffer_load_dwordx4 v[228:231], v9, s[64:67], s33 offen offset:1536 nt
    v_mfma_f32_16x16x32_bf16 a[56:59], v[180:183], v[44:47], a[56:59]
    v_exp_f32 v18, v106
    v_mfma_f32_16x16x32_bf16 a[56:59], v[164:167], v[40:43], a[56:59]
    v_add_f32 v7, v7, v16
    v_add_f32 v7, v7, v17
    v_mfma_f32_16x16x32_bf16 a[104:107], v[168:171], v[40:43], a[104:107]
    s_waitcnt vmcnt(17)
    ds_read_b128 v[36:39], v1 offset:16384
    v_lshlrev_b32 v48, 16, v60
    v_mfma_f32_16x16x32_bf16 a[104:107], v[184:187], v[44:47], a[104:107]
    buffer_load_dwordx4 v[232:235], v9, s[64:67], s34 offen offset:0 nt
    v_mfma_f32_16x16x32_bf16 a[152:155], v[188:191], v[44:47], a[152:155]
    v_exp_f32 v19, v107
    v_mfma_f32_16x16x32_bf16 a[152:155], v[172:175], v[40:43], a[152:155]
    s_waitcnt lgkmcnt(2)
    v_cvt_pk_bf16_f32 v74, v16, v17
    v_and_b32 v49, s97, v60
    v_mfma_f32_16x16x32_bf16 a[12:15], v[160:163], v[24:27], a[12:15]
    ds_read_b128 v[40:43], v1 offset:5120
    v_lshlrev_b32 v50, 16, v62
    v_mfma_f32_16x16x32_bf16 a[12:15], v[176:179], v[28:31], a[12:15]
    s_waitcnt vmcnt(13)
    buffer_load_dwordx4 v[236:239], v9, s[64:67], s34 offen offset:1536 nt
    v_mfma_f32_16x16x32_bf16 a[60:63], v[180:183], v[28:31], a[60:63]
    v_exp_f32 v16, v76
    v_mfma_f32_16x16x32_bf16 a[60:63], v[164:167], v[24:27], a[60:63]
    v_add_f32 v7, v7, v18
    v_add_f32 v7, v7, v19
    v_mfma_f32_16x16x32_bf16 a[108:111], v[168:171], v[24:27], a[108:111]
    ds_read_b128 v[44:47], v1 offset:17408
    v_and_b32 v51, s97, v62
    v_mfma_f32_16x16x32_bf16 a[108:111], v[184:187], v[28:31], a[108:111]
    v_exp_f32 v17, v77
    v_mfma_f32_16x16x32_bf16 a[156:159], v[188:191], v[28:31], a[156:159]
    s_add_u32 s29, s28, 49152
    v_cvt_pk_bf16_f32 v75, v18, v19
    v_mul_f32_e64 v50, -v50, v48
    v_mfma_f32_16x16x32_bf16 a[156:159], v[172:175], v[24:27], a[156:159]
    s_waitcnt lgkmcnt(2)
    v_exp_f32 v18, v78
    v_mfma_f32_16x16x32_bf16 a[16:19], v[160:163], v[32:35], a[16:19]
    s_mov_b32 m0, s56
    ds_read_b128 v[24:27], v1 offset:6144
    v_add_f32 v8, v8, v16
    v_mfma_f32_16x16x32_bf16 a[16:19], v[176:179], v[36:39], a[16:19]
    s_sub_u32 s3, s29, 147456
    s_waitcnt vmcnt(13)
    buffer_load_dwordx4 v4, s[4:7], s27 offen offset:0 sc1 lds
    v_mfma_f32_16x16x32_bf16 a[64:67], v[180:183], v[36:39], a[64:67]
    s_min_u32 s29, s29, s3
    v_add_f32 v8, v8, v17
    v_mul_f32_e64 v51, -v51, v49
    v_mfma_f32_16x16x32_bf16 a[64:67], v[164:167], v[32:35], a[64:67]
    v_exp_f32 v19, v79
    v_mfma_f32_16x16x32_bf16 a[112:115], v[168:171], v[32:35], a[112:115]
    ds_read_b128 v[28:31], v1 offset:18432
    v_cvt_pk_bf16_f32 v76, v16, v17
    v_mfma_f32_16x16x32_bf16 a[112:115], v[184:187], v[36:39], a[112:115]
    s_waitcnt vmcnt(13)
    buffer_load_dwordx4 v4, s[4:7], s27 offen offset:1024 sc1 lds
    v_mfma_f32_16x16x32_bf16 a[160:163], v[188:191], v[36:39], a[160:163]
    s_sub_u32 s3, s29, s28
    v_exp_f32 v16, v108
    v_mfma_f32_16x16x32_bf16 a[160:163], v[172:175], v[32:35], a[160:163]
    s_waitcnt lgkmcnt(2)
    v_add_f32 v8, v8, v18
    v_add_f32 v8, v8, v19
    v_mfma_f32_16x16x32_bf16 a[20:23], v[160:163], v[40:43], a[20:23]
    ds_read_b128 v[32:35], v1 offset:7168
    v_cvt_f32_i32 v240, v240
    v_mfma_f32_16x16x32_bf16 a[20:23], v[176:179], v[44:47], a[20:23]
    buffer_load_dword v52, v20, s[20:23], s44 offen sc1
    v_mfma_f32_16x16x32_bf16 a[68:71], v[180:183], v[44:47], a[68:71]
    v_exp_f32 v17, v109
    v_mfma_f32_16x16x32_bf16 a[68:71], v[164:167], v[40:43], a[68:71]
    v_cvt_pk_bf16_f32 v77, v18, v19
    v_cvt_f32_i32 v244, v244
    v_mfma_f32_16x16x32_bf16 a[116:119], v[168:171], v[40:43], a[116:119]
    s_mov_b32 s28, s29
    ds_read_b128 v[36:39], v1 offset:19456
    v_fma_f32 v240, v240, v48, v50
    v_mfma_f32_16x16x32_bf16 a[116:119], v[184:187], v[44:47], a[116:119]
    s_waitcnt vmcnt(14)
    buffer_load_dwordx4 v4, s[4:7], s27 offen offset:2048 sc1 lds
    v_mfma_f32_16x16x32_bf16 a[164:167], v[188:191], v[44:47], a[164:167]
    s_add_u32 s27, s27, 24576
    v_exp_f32 v18, v110
    v_mfma_f32_16x16x32_bf16 a[164:167], v[172:175], v[40:43], a[164:167]
    s_waitcnt lgkmcnt(2)
    v_add_f32 v8, v8, v16
    v_add_f32 v8, v8, v17
    v_fma_f32 v244, v244, v49, v51
    v_mfma_f32_16x16x32_bf16 a[24:27], v[160:163], v[24:27], a[24:27]
    s_sub_u32 s58, s27, 196608
    ds_read_b128 v[40:43], v1 offset:8192
    v_cvt_f32_i32 v241, v241
    v_mfma_f32_16x16x32_bf16 a[24:27], v[176:179], v[28:31], a[24:27]
    v_exp_f32 v19, v111
    v_cvt_pk_bf16_f32 v78, v16, v17
    v_mfma_f32_16x16x32_bf16 a[72:75], v[180:183], v[28:31], a[72:75]
    s_min_u32 s27, s27, s58
    v_add_f32 v8, v8, v18
    v_add_f32 v8, v8, v19
    v_mfma_f32_16x16x32_bf16 a[72:75], v[164:167], v[24:27], a[72:75]
    v_cvt_f32_i32 v245, v245
    v_cvt_pk_bf16_f32 v79, v18, v19
    v_mfma_f32_16x16x32_bf16 a[120:123], v[168:171], v[24:27], a[120:123]
    s_add_u32 s56, s56, 12288
    ds_read_b128 v[44:47], v1 offset:20480
    v_fma_f32 v241, v241, v48, v50
    v_mfma_f32_16x16x32_bf16 a[120:123], v[184:187], v[28:31], a[120:123]
    v_exp_f32 v16, v80
    v_mfma_f32_16x16x32_bf16 a[168:171], v[188:191], v[28:31], a[168:171]
    s_mov_b32 m0, s56
    v_exp_f32 v17, v81
    v_mfma_f32_16x16x32_bf16 a[168:171], v[172:175], v[24:27], a[168:171]
    s_waitcnt lgkmcnt(2)
    v_fma_f32 v245, v245, v49, v51
    v_exp_f32 v18, v82
    v_mfma_f32_16x16x32_bf16 a[28:31], v[160:163], v[32:35], a[28:31]
    ds_read_b128 v[24:27], v1 offset:9216
    v_cvt_f32_i32 v242, v242
    v_mfma_f32_16x16x32_bf16 a[28:31], v[176:179], v[36:39], a[28:31]
    v_add_f32 v5, v5, v16
    v_cvt_f32_i32 v246, v246
    v_mfma_f32_16x16x32_bf16 a[76:79], v[180:183], v[36:39], a[76:79]
    v_add_f32 v5, v5, v17
    v_fma_f32 v242, v242, v48, v50
    v_mfma_f32_16x16x32_bf16 a[76:79], v[164:167], v[32:35], a[76:79]
    s_waitcnt vmcnt(14)
    buffer_load_dwordx4 v4, s[4:7], s27 offen offset:0 sc1 lds
    v_mfma_f32_16x16x32_bf16 a[124:127], v[168:171], v[32:35], a[124:127]
    ds_read_b128 v[28:31], v1 offset:21504
    v_fma_f32 v246, v246, v49, v51
    v_mfma_f32_16x16x32_bf16 a[124:127], v[184:187], v[36:39], a[124:127]
    v_exp_f32 v19, v83
    v_cvt_pk_bf16_f32 v80, v16, v17
    v_mfma_f32_16x16x32_bf16 a[172:175], v[188:191], v[36:39], a[172:175]
    v_exp_f32 v16, v112
    v_mfma_f32_16x16x32_bf16 a[172:175], v[172:175], v[32:35], a[172:175]
    s_waitcnt lgkmcnt(2)
    s_waitcnt vmcnt(14)
    buffer_load_dwordx4 v4, s[4:7], s27 offen offset:1024 sc1 lds
    v_add_f32 v5, v5, v18
    v_mfma_f32_16x16x32_bf16 a[32:35], v[160:163], v[40:43], a[32:35]
    ds_read_b128 v[32:35], v1 offset:10240
    v_lshlrev_b32 v48, 16, v61
    v_mfma_f32_16x16x32_bf16 a[32:35], v[176:179], v[44:47], a[32:35]
    v_add_f32 v5, v5, v19
    v_exp_f32 v17, v113
    v_mfma_f32_16x16x32_bf16 a[80:83], v[180:183], v[44:47], a[80:83]
    v_and_b32 v49, s97, v61
    v_cvt_pk_bf16_f32 v81, v18, v19
    v_mfma_f32_16x16x32_bf16 a[80:83], v[164:167], v[40:43], a[80:83]
    s_waitcnt vmcnt(14)
    buffer_load_dwordx4 v4, s[4:7], s27 offen offset:2048 sc1 lds
    v_lshlrev_b32 v50, 16, v63
    v_mfma_f32_16x16x32_bf16 a[128:131], v[168:171], v[40:43], a[128:131]
    ds_read_b128 v[36:39], v1 offset:22528
    v_and_b32 v51, s97, v63
    v_mfma_f32_16x16x32_bf16 a[128:131], v[184:187], v[44:47], a[128:131]
    v_exp_f32 v18, v114
    v_add_f32 v5, v5, v16
    v_mfma_f32_16x16x32_bf16 a[176:179], v[188:191], v[44:47], a[176:179]
    v_add_u32 v2, s3, v2
    v_add_u32 v3, s3, v3
    v_mfma_f32_16x16x32_bf16 a[176:179], v[172:175], v[40:43], a[176:179]
    s_waitcnt lgkmcnt(2)
    v_add_f32 v5, v5, v17
    v_exp_f32 v19, v115
    v_mfma_f32_16x16x32_bf16 a[36:39], v[160:163], v[24:27], a[36:39]
    ds_read_b128 v[40:43], v1 offset:11264
    v_mul_f32_e64 v50, -v50, v48
    v_mfma_f32_16x16x32_bf16 a[36:39], v[176:179], v[28:31], a[36:39]
    v_cvt_pk_bf16_f32 v82, v16, v17
    v_mul_f32_e64 v51, -v51, v49
    v_mfma_f32_16x16x32_bf16 a[84:87], v[180:183], v[28:31], a[84:87]
    v_exp_f32 v16, v84
    v_mfma_f32_16x16x32_bf16 a[84:87], v[164:167], v[24:27], a[84:87]
    v_cvt_f32_i32 v248, v248
    v_add_f32 v5, v5, v18
    v_cvt_f32_i32 v252, v252
    v_mfma_f32_16x16x32_bf16 a[132:135], v[168:171], v[24:27], a[132:135]
    s_mov_b32 s27, 208896
    ds_read_b128 v[44:47], v1 offset:23552
    v_add_f32 v5, v5, v19
    v_mfma_f32_16x16x32_bf16 a[132:135], v[184:187], v[28:31], a[132:135]
    s_waitcnt lgkmcnt(2)
    v_exp_f32 v17, v85
    v_fma_f32 v248, v248, v48, v50
    v_mfma_f32_16x16x32_bf16 a[180:183], v[188:191], v[28:31], a[180:183]
    s_waitcnt vmcnt(19)
    v_cvt_pk_bf16_f32 v83, v18, v19
    v_fma_f32 v252, v252, v49, v51
    v_mfma_f32_16x16x32_bf16 a[180:183], v[172:175], v[24:27], a[180:183]
    s_barrier
    v_mfma_f32_16x16x32_bf16 a[40:43], v[160:163], v[32:35], a[40:43]
    s_add_u32 s56, s56, 36864
    ds_read_b128 v[24:27], v2 offset:0
    v_cvt_f32_i32 v249, v249
    v_mfma_f32_16x16x32_bf16 a[40:43], v[176:179], v[36:39], a[40:43]
    v_exp_f32 v18, v86
    v_add_f32 v6, v6, v16
    v_mfma_f32_16x16x32_bf16 a[88:91], v[180:183], v[36:39], a[88:91]
    s_sub_u32 s58, s56, 147456
    v_add_f32 v6, v6, v17
    v_cvt_f32_i32 v253, v253
    v_mfma_f32_16x16x32_bf16 a[88:91], v[164:167], v[32:35], a[88:91]
    s_min_u32 s56, s56, s58
    v_exp_f32 v19, v87
    v_mfma_f32_16x16x32_bf16 a[136:139], v[168:171], v[32:35], a[136:139]
    ds_read_b128 v[28:31], v3 offset:0
    v_fma_f32 v249, v249, v48, v50
    v_mfma_f32_16x16x32_bf16 a[136:139], v[184:187], v[36:39], a[136:139]
    v_cvt_pk_bf16_f32 v84, v16, v17
    v_exp_f32 v16, v116
    v_mfma_f32_16x16x32_bf16 a[184:187], v[188:191], v[36:39], a[184:187]
    v_fma_f32 v253, v253, v49, v51
    v_add_f32 v6, v6, v18
    v_mfma_f32_16x16x32_bf16 a[184:187], v[172:175], v[32:35], a[184:187]
    s_waitcnt lgkmcnt(2)
    v_cvt_f32_i32 v250, v250
    v_add_f32 v6, v6, v19
    v_mfma_f32_16x16x32_bf16 a[44:47], v[160:163], v[40:43], a[44:47]
    ds_read_b128 v[32:35], v2 offset:6144
    v_cvt_f32_i32 v254, v254
    v_mfma_f32_16x16x32_bf16 a[44:47], v[176:179], v[44:47], a[44:47]
    v_exp_f32 v17, v117
    v_mfma_f32_16x16x32_bf16 a[92:95], v[180:183], v[44:47], a[92:95]
    v_cvt_pk_bf16_f32 v85, v18, v19
    v_fma_f32 v250, v250, v48, v50
    v_mfma_f32_16x16x32_bf16 a[92:95], v[164:167], v[40:43], a[92:95]
    v_exp_f32 v18, v118
    v_mfma_f32_16x16x32_bf16 a[140:143], v[168:171], v[40:43], a[140:143]
    s_nop 0
    ds_read_b128 v[36:39], v3 offset:6144
    v_fma_f32 v254, v254, v49, v51
    v_mfma_f32_16x16x32_bf16 a[140:143], v[184:187], v[44:47], a[140:143]
    v_add_f32 v6, v6, v16
    v_add_f32 v6, v6, v17
    v_mfma_f32_16x16x32_bf16 a[188:191], v[188:191], v[44:47], a[188:191]
    s_waitcnt lgkmcnt(2)
    v_exp_f32 v19, v119
    v_cvt_pk_bf16_f32 v146, v240, v244
    v_cvt_pk_bf16_f32 v150, v241, v245
    v_cvt_pk_bf16_f32 v86, v16, v17
    v_cvt_pk_bf16_f32 v147, v248, v252
    v_add_f32 v6, v6, v18
    v_cvt_pk_bf16_f32 v151, v249, v253
    v_add_f32 v6, v6, v19
    v_cvt_pk_bf16_f32 v154, v242, v246
    v_cvt_pk_bf16_f32 v87, v18, v19
    v_cvt_pk_bf16_f32 v155, v250, v254
    v_mfma_f32_16x16x32_bf16 a[188:191], v[172:175], v[40:43], a[188:191]
    s_branch L_join
.p2align 6
L_loop:
    v_mfma_f32_16x16x32_bf16 v[160:163], v[24:27], a[192:195], v[128:131]
    s_mov_b32 m0, s56
    ds_read_b128 v[40:43], v2 offset:128
    v_cvt_f32_i32 v247, v247
    v_mfma_f32_16x16x32_bf16 v[160:163], v[28:31], a[196:199], v[160:163]
    buffer_load_dwordx4 v4, s[4:7], s27 offen offset:0 sc1 lds
    v_mfma_f32_16x16x32_bf16 v[164:167], v[28:31], a[220:223], v[132:135]
    v_exp_f32 v16, v88
    v_mfma_f32_16x16x32_bf16 v[164:167], v[24:27], a[216:219], v[164:167]
    v_exp_f32 v17, v89
    v_mfma_f32_16x16x32_bf16 v[168:171], v[24:27], a[240:243], v[136:139]
    ds_read_b128 v[44:47], v3 offset:128
    v_fma_f32 v246, v246, v48, v50
    v_mfma_f32_16x16x32_bf16 v[168:171], v[28:31], a[244:247], v[168:171]
    v_exp_f32 v18, v90
    v_mfma_f32_16x16x32_bf16 v[172:175], v[28:31], v[204:207], v[140:143]
    v_fma_f32 v247, v247, v49, v51
    v_add_f32 v7, v7, v16
    v_mfma_f32_16x16x32_bf16 v[172:175], v[24:27], v[200:203], v[172:175]
    s_waitcnt lgkmcnt(2)
    v_add_f32 v7, v7, v17
    v_cvt_pk_bf16_f32 v231, v246, v247
    v_mfma_f32_16x16x32_bf16 v[96:99], v[32:35], a[192:195], v[128:131]
    ds_read_b128 v[24:27], v2 offset:6272
    v_cvt_f32_i32 v250, v250
    v_mfma_f32_16x16x32_bf16 v[96:99], v[36:39], a[196:199], v[96:99]
    buffer_load_dwordx4 v4, s[4:7], s27 offen offset:1024 sc1 lds
    v_mfma_f32_16x16x32_bf16 v[100:103], v[36:39], a[220:223], v[132:135]
    v_exp_f32 v19, v91
    v_mfma_f32_16x16x32_bf16 v[100:103], v[32:35], a[216:219], v[100:103]
    v_cvt_pk_bf16_f32 v88, v16, v17
    v_cvt_f32_i32 v251, v251
    v_mfma_f32_16x16x32_bf16 v[104:107], v[32:35], a[240:243], v[136:139]
    ds_read_b128 v[28:31], v3 offset:6272
    v_fma_f32 v250, v250, v48, v50
    v_mfma_f32_16x16x32_bf16 v[104:107], v[36:39], a[244:247], v[104:107]
    v_exp_f32 v16, v120
    v_mfma_f32_16x16x32_bf16 v[108:111], v[36:39], v[204:207], v[140:143]
    v_add_f32 v7, v7, v18
    v_add_f32 v7, v7, v19
    v_mfma_f32_16x16x32_bf16 v[108:111], v[32:35], v[200:203], v[108:111]
    s_waitcnt lgkmcnt(2)
    v_exp_f32 v17, v121
    v_mfma_f32_16x16x32_bf16 v[160:163], v[40:43], a[200:203], v[160:163]
    ds_read_b128 v[32:35], v2 offset:256
    v_cvt_pk_bf16_f32 v89, v18, v19
    v_mfma_f32_16x16x32_bf16 v[160:163], v[44:47], a[204:207], v[160:163]
    v_exp_f32 v18, v122
    v_mfma_f32_16x16x32_bf16 v[164:167], v[44:47], a[228:231], v[164:167]
    v_fma_f32 v251, v251, v49, v51
    v_add_f32 v7, v7, v16
    v_mfma_f32_16x16x32_bf16 v[164:167], v[40:43], a[224:227], v[164:167]
    buffer_load_dwordx4 v4, s[4:7], s27 offen offset:2048 sc1 lds
    v_mfma_f32_16x16x32_bf16 v[168:171], v[40:43], a[248:251], v[168:171]
    ds_read_b128 v[36:39], v3 offset:256
    v_cvt_pk_bf16_f32 v235, v250, v251
    v_mfma_f32_16x16x32_bf16 v[168:171], v[44:47], a[252:255], v[168:171]
    v_add_f32 v7, v7, v17
    v_cvt_f32_i32 v254, v254
    v_mfma_f32_16x16x32_bf16 v[172:175], v[44:47], v[212:215], v[172:175]
    v_exp_f32 v19, v123
    v_mfma_f32_16x16x32_bf16 v[172:175], v[40:43], v[208:211], v[172:175]
    s_waitcnt lgkmcnt(2)
    v_cvt_pk_bf16_f32 v90, v16, v17
    v_cvt_f32_i32 v255, v255
    v_mfma_f32_16x16x32_bf16 v[96:99], v[24:27], a[200:203], v[96:99]
    ds_read_b128 v[40:43], v2 offset:6400
    v_fma_f32 v254, v254, v48, v50
    v_mfma_f32_16x16x32_bf16 v[96:99], v[28:31], a[204:207], v[96:99]
    s_add_u32 s27, s27, 24576
    v_exp_f32 v16, v92
    v_mfma_f32_16x16x32_bf16 v[100:103], v[28:31], a[228:231], v[100:103]
    v_add_f32 v7, v7, v18
    v_add_f32 v7, v7, v19
    v_mfma_f32_16x16x32_bf16 v[100:103], v[24:27], a[224:227], v[100:103]
    v_exp_f32 v17, v93
    v_mfma_f32_16x16x32_bf16 v[104:107], v[24:27], a[248:251], v[104:107]
    ds_read_b128 v[44:47], v3 offset:6400
    v_fma_f32 v255, v255, v49, v51
    v_mfma_f32_16x16x32_bf16 v[104:107], v[28:31], a[252:255], v[104:107]
    v_cvt_pk_bf16_f32 v91, v18, v19
    v_cvt_pk_bf16_f32 v239, v254, v255
    v_mfma_f32_16x16x32_bf16 v[108:111], v[28:31], v[212:215], v[108:111]
    s_add_u32 s29, s30, 49152
    v_exp_f32 v18, v94
    v_mfma_f32_16x16x32_bf16 v[108:111], v[24:27], v[208:211], v[108:111]
    s_waitcnt lgkmcnt(2)
    v_add_f32 v8, v8, v16
    v_add_f32 v8, v8, v17
    v_mfma_f32_16x16x32_bf16 v[160:163], v[32:35], a[208:211], v[160:163]
    s_waitcnt vmcnt(11)
    ds_read_b128 v[24:27], v2 offset:12288
    v_lshlrev_b32 v48, 16, v56
    v_mfma_f32_16x16x32_bf16 v[160:163], v[36:39], a[212:215], v[160:163]
    s_sub_u32 s3, s29, 147456
    buffer_load_dwordx2 v[60:61], off, s[80:83], s37 offset:8
    v_mfma_f32_16x16x32_bf16 v[164:167], v[36:39], a[236:239], v[164:167]
    s_add_u32 s56, s56, 12288
    v_exp_f32 v19, v95
    v_mfma_f32_16x16x32_bf16 v[164:167], v[32:35], a[232:235], v[164:167]
    s_min_u32 s29, s29, s3
    v_cvt_pk_bf16_f32 v92, v16, v17
    v_and_b32 v49, s97, v56
    v_mfma_f32_16x16x32_bf16 v[168:171], v[32:35], v[192:195], v[168:171]
    s_mov_b32 m0, s56
    ds_read_b128 v[28:31], v3 offset:12288
    v_mfma_f32_16x16x32_bf16 v[168:171], v[36:39], v[196:199], v[168:171]
    buffer_load_dwordx2 v[62:63], off, s[84:87], s37 offset:8
    v_mfma_f32_16x16x32_bf16 v[172:175], v[36:39], v[220:223], v[172:175]
    v_exp_f32 v16, v124
    v_mfma_f32_16x16x32_bf16 v[172:175], v[32:35], v[216:219], v[172:175]
    s_waitcnt lgkmcnt(2)
    v_add_f32 v8, v8, v18
    v_add_f32 v8, v8, v19
    v_mfma_f32_16x16x32_bf16 v[96:99], v[40:43], a[208:211], v[96:99]
    ds_read_b128 v[32:35], v2 offset:18432
    v_lshlrev_b32 v50, 16, v58
    v_mfma_f32_16x16x32_bf16 v[96:99], v[44:47], a[212:215], v[96:99]
    s_sub_u32 s3, s29, s30
    v_exp_f32 v17, v125
    v_mfma_f32_16x16x32_bf16 v[100:103], v[44:47], a[236:239], v[100:103]
    v_cvt_pk_bf16_f32 v93, v18, v19
    v_mfma_f32_16x16x32_bf16 v[100:103], v[40:43], a[232:235], v[100:103]
    buffer_load_dwordx4 v4, s[4:7], s27 offen offset:0 sc1 lds
    v_mfma_f32_16x16x32_bf16 v[104:107], v[40:43], v[192:195], v[104:107]
    ds_read_b128 v[36:39], v3 offset:18432
    v_mfma_f32_16x16x32_bf16 v[104:107], v[44:47], v[196:199], v[104:107]
    v_exp_f32 v18, v126
    v_mfma_f32_16x16x32_bf16 v[108:111], v[44:47], v[220:223], v[108:111]
    v_add_f32 v8, v8, v16
    v_add_f32 v8, v8, v17
    v_mfma_f32_16x16x32_bf16 v[108:111], v[40:43], v[216:219], v[108:111]
    s_waitcnt lgkmcnt(2)
    buffer_load_dwordx3 v[240:242], v12, s[68:71], s16 offen offset:0 nt
    v_mfma_f32_16x16x32_bf16 v[176:179], v[24:27], a[192:195], v[128:131]
    ds_read_b128 v[40:43], v2 offset:12416
    v_and_b32 v51, s97, v58
    v_mfma_f32_16x16x32_bf16 v[176:179], v[28:31], a[196:199], v[176:179]
    v_exp_f32 v19, v127
    v_cvt_pk_bf16_f32 v94, v16, v17
    v_mfma_f32_16x16x32_bf16 v[180:183], v[28:31], a[220:223], v[132:135]
    s_mov_b32 s30, s29
    v_add_f32 v8, v8, v18
    v_add_f32 v8, v8, v19
    v_mfma_f32_16x16x32_bf16 v[180:183], v[24:27], a[216:219], v[180:183]
    buffer_load_dwordx4 v4, s[4:7], s27 offen offset:1024 sc1 lds
    v_mfma_f32_16x16x32_bf16 v[184:187], v[24:27], a[240:243], v[136:139]
    ds_read_b128 v[44:47], v3 offset:12416
    v_cvt_pk_bf16_f32 v95, v18, v19
    v_mfma_f32_16x16x32_bf16 v[184:187], v[28:31], a[244:247], v[184:187]
    v_exp_f32 v16, v160
    v_mfma_f32_16x16x32_bf16 v[188:191], v[28:31], v[204:207], v[140:143]
    v_exp_f32 v17, v161
    v_mfma_f32_16x16x32_bf16 v[188:191], v[24:27], v[200:203], v[188:191]
    s_waitcnt lgkmcnt(2)
    buffer_load_dwordx3 v[244:246], v12, s[68:71], s16 offen offset:768 nt
    v_mfma_f32_16x16x32_bf16 v[112:115], v[32:35], a[192:195], v[128:131]
    ds_read_b128 v[24:27], v2 offset:18560
    v_mul_f32_e64 v50, -v50, v48
    v_mfma_f32_16x16x32_bf16 v[112:115], v[36:39], a[196:199], v[112:115]
    v_exp_f32 v18, v162
    v_mfma_f32_16x16x32_bf16 v[116:119], v[36:39], a[220:223], v[132:135]
    v_add_f32 v5, v5, v16
    v_add_f32 v5, v5, v17
    v_mfma_f32_16x16x32_bf16 v[116:119], v[32:35], a[216:219], v[116:119]
    v_exp_f32 v19, v163
    v_mfma_f32_16x16x32_bf16 v[120:123], v[32:35], a[240:243], v[136:139]
    ds_read_b128 v[28:31], v3 offset:18560
    v_cvt_pk_bf16_f32 v160, v16, v17
    v_mfma_f32_16x16x32_bf16 v[120:123], v[36:39], a[244:247], v[120:123]
    buffer_load_dwordx3 v[248:250], v12, s[68:71], s16 offen offset:1536 nt
    v_mfma_f32_16x16x32_bf16 v[124:127], v[36:39], v[204:207], v[140:143]
    v_exp_f32 v16, v96
    v_mfma_f32_16x16x32_bf16 v[124:127], v[32:35], v[200:203], v[124:127]
    s_waitcnt lgkmcnt(2)
    v_add_f32 v5, v5, v18
    v_add_f32 v5, v5, v19
    v_mfma_f32_16x16x32_bf16 v[176:179], v[40:43], a[200:203], v[176:179]
    ds_read_b128 v[32:35], v2 offset:12544
    v_mul_f32_e64 v51, -v51, v49
    v_mfma_f32_16x16x32_bf16 v[176:179], v[44:47], a[204:207], v[176:179]
    buffer_load_dwordx4 v4, s[4:7], s27 offen offset:2048 sc1 lds
    v_mfma_f32_16x16x32_bf16 v[180:183], v[44:47], a[228:231], v[180:183]
    v_exp_f32 v17, v97
    v_mfma_f32_16x16x32_bf16 v[180:183], v[40:43], a[224:227], v[180:183]
L_iw3:
L_pg3:
    s_cbranch_execz L_pg7
    v_cvt_pk_bf16_f32 v161, v18, v19
    v_add_u32 v1, s3, v1
    v_mfma_f32_16x16x32_bf16 v[184:187], v[40:43], a[248:251], v[184:187]
    ds_read_b128 v[36:39], v3 offset:12544
    v_cvt_f32_i32 v144, v144
    v_mfma_f32_16x16x32_bf16 v[184:187], v[44:47], a[252:255], v[184:187]
    buffer_load_dwordx3 v[252:254], v12, s[68:71], s16 offen offset:2304 nt
    v_mfma_f32_16x16x32_bf16 v[188:191], v[44:47], v[212:215], v[188:191]
    v_exp_f32 v18, v98
    v_mfma_f32_16x16x32_bf16 v[188:191], v[40:43], v[208:211], v[188:191]
    s_waitcnt lgkmcnt(2)
    v_add_f32 v5, v5, v16
    v_add_f32 v5, v5, v17
    v_mfma_f32_16x16x32_bf16 v[112:115], v[24:27], a[200:203], v[112:115]
    ds_read_b128 v[40:43], v2 offset:18688
    v_cvt_f32_i32 v148, v148
    v_mfma_f32_16x16x32_bf16 v[112:115], v[28:31], a[204:207], v[112:115]
    v_exp_f32 v19, v99
    v_cvt_pk_bf16_f32 v162, v16, v17
    v_mfma_f32_16x16x32_bf16 v[116:119], v[28:31], a[228:231], v[116:119]
    v_exp_f32 v16, v164
    v_mfma_f32_16x16x32_bf16 v[116:119], v[24:27], a[224:227], v[116:119]
    s_add_u32 s27, s27, 24576
    v_add_f32 v5, v5, v18
    v_add_f32 v5, v5, v19
    v_mfma_f32_16x16x32_bf16 v[120:123], v[24:27], a[248:251], v[120:123]
    s_add_u32 s56, s56, 36864
    ds_read_b128 v[44:47], v3 offset:18688
    v_fma_f32 v144, v144, v48, v50
    v_mfma_f32_16x16x32_bf16 v[120:123], v[28:31], a[252:255], v[120:123]
    s_waitcnt lgkmcnt(2)
    v_exp_f32 v17, v165
    v_mfma_f32_16x16x32_bf16 v[124:127], v[28:31], v[212:215], v[124:127]
    s_waitcnt vmcnt(12)
    v_cvt_pk_bf16_f32 v163, v18, v19
    s_sub_u32 s58, s56, 147456
    v_mfma_f32_16x16x32_bf16 v[124:127], v[24:27], v[208:211], v[124:127]
    s_barrier
    v_mfma_f32_16x16x32_bf16 v[176:179], v[32:35], a[208:211], v[176:179]
    s_min_u32 s56, s56, s58
    ds_read_b128 v[24:27], v1 offset:0
    v_mfma_f32_16x16x32_bf16 v[176:179], v[36:39], a[212:215], v[176:179]
    v_exp_f32 v18, v166
    v_mfma_f32_16x16x32_bf16 v[180:183], v[36:39], a[236:239], v[180:183]
    v_add_f32 v6, v6, v16
    v_add_f32 v6, v6, v17
    v_mfma_f32_16x16x32_bf16 v[180:183], v[32:35], a[232:235], v[180:183]
    v_exp_f32 v19, v167
    v_mfma_f32_16x16x32_bf16 v[184:187], v[32:35], v[192:195], v[184:187]
    ds_read_b128 v[28:31], v1 offset:12288
    v_cvt_pk_bf16_f32 v164, v16, v17
    v_mfma_f32_16x16x32_bf16 v[184:187], v[36:39], v[196:199], v[184:187]
    v_exp_f32 v16, v100
    v_mfma_f32_16x16x32_bf16 v[188:191], v[36:39], v[220:223], v[188:191]
    v_add_f32 v6, v6, v18
    v_add_f32 v6, v6, v19
    v_mfma_f32_16x16x32_bf16 v[188:191], v[32:35], v[216:219], v[188:191]
    s_waitcnt lgkmcnt(2)
    v_exp_f32 v17, v101
    v_mfma_f32_16x16x32_bf16 v[112:115], v[40:43], a[208:211], v[112:115]
    ds_read_b128 v[32:35], v1 offset:1024
    v_cvt_pk_bf16_f32 v165, v18, v19
    v_mfma_f32_16x16x32_bf16 v[112:115], v[44:47], a[212:215], v[112:115]
    v_exp_f32 v18, v102
    v_mfma_f32_16x16x32_bf16 v[116:119], v[44:47], a[236:239], v[116:119]
    v_add_f32 v6, v6, v16
    v_add_f32 v6, v6, v17
    v_mfma_f32_16x16x32_bf16 v[116:119], v[40:43], a[232:235], v[116:119]
    v_exp_f32 v19, v103
    v_mfma_f32_16x16x32_bf16 v[120:123], v[40:43], v[192:195], v[120:123]
    ds_read_b128 v[36:39], v1 offset:13312
    v_cvt_pk_bf16_f32 v166, v16, v17
    v_mfma_f32_16x16x32_bf16 v[120:123], v[44:47], v[196:199], v[120:123]
    v_add_f32 v6, v6, v18
    v_fma_f32 v148, v148, v49, v51
    v_mfma_f32_16x16x32_bf16 v[124:127], v[44:47], v[220:223], v[124:127]
    v_add_f32 v6, v6, v19
    v_cvt_pk_bf16_f32 v167, v18, v19
    v_mfma_f32_16x16x32_bf16 v[124:127], v[40:43], v[216:219], v[124:127]
    s_waitcnt lgkmcnt(2)
    v_mfma_f32_16x16x32_bf16 a[0:3], v[64:67], v[24:27], a[0:3]
    ds_read_b128 v[40:43], v1 offset:2048
    v_cvt_f32_i32 v145, v145
    v_mfma_f32_16x16x32_bf16 a[0:3], v[80:83], v[28:31], a[0:3]
    buffer_store_dwordx4 v[224:227], v11, s[4:7], s33 offen offset:0 sc1
    v_mfma_f32_16x16x32_bf16 a[48:51], v[84:87], v[28:31], a[48:51]
    v_exp_f32 v16, v168
    v_mfma_f32_16x16x32_bf16 a[48:51], v[68:71], v[24:27], a[48:51]
    v_exp_f32 v17, v169
    v_mfma_f32_16x16x32_bf16 a[96:99], v[72:75], v[24:27], a[96:99]
    ds_read_b128 v[44:47], v1 offset:14336
    v_cvt_f32_i32 v149, v149
    v_mfma_f32_16x16x32_bf16 a[96:99], v[88:91], v[28:31], a[96:99]
    v_exp_f32 v18, v170
    v_mfma_f32_16x16x32_bf16 a[144:147], v[92:95], v[28:31], a[144:147]
    v_add_f32 v7, v7, v16
    v_add_f32 v7, v7, v17
    v_mfma_f32_16x16x32_bf16 a[144:147], v[76:79], v[24:27], a[144:147]
    s_waitcnt lgkmcnt(2)
    v_exp_f32 v19, v171
    v_mfma_f32_16x16x32_bf16 a[4:7], v[64:67], v[32:35], a[4:7]
    ds_read_b128 v[24:27], v1 offset:3072
    v_cvt_pk_bf16_f32 v168, v16, v17
    v_mfma_f32_16x16x32_bf16 a[4:7], v[80:83], v[36:39], a[4:7]
    buffer_store_dwordx4 v[228:231], v21, s[4:7], s33 offen offset:768 sc1
    v_mfma_f32_16x16x32_bf16 a[52:55], v[84:87], v[36:39], a[52:55]
    v_exp_f32 v16, v104
    v_mfma_f32_16x16x32_bf16 a[52:55], v[68:71], v[32:35], a[52:55]
    v_add_f32 v7, v7, v18
    v_fma_f32 v145, v145, v48, v50
    v_mfma_f32_16x16x32_bf16 a[100:103], v[72:75], v[32:35], a[100:103]
    ds_read_b128 v[28:31], v1 offset:15360
    v_add_f32 v7, v7, v19
    v_mfma_f32_16x16x32_bf16 a[100:103], v[88:91], v[36:39], a[100:103]
    v_exp_f32 v17, v105
    v_mfma_f32_16x16x32_bf16 a[148:151], v[92:95], v[36:39], a[148:151]
    v_cvt_pk_bf16_f32 v169, v18, v19
    v_fma_f32 v149, v149, v49, v51
    v_mfma_f32_16x16x32_bf16 a[148:151], v[76:79], v[32:35], a[148:151]
    s_waitcnt lgkmcnt(2)
    v_exp_f32 v18, v106
    v_mfma_f32_16x16x32_bf16 a[8:11], v[64:67], v[40:43], a[8:11]
    ds_read_b128 v[32:35], v1 offset:4096
    v_add_f32 v7, v7, v16
    v_mfma_f32_16x16x32_bf16 a[8:11], v[80:83], v[44:47], a[8:11]
    buffer_store_dwordx4 v[232:235], v22, s[4:7], s33 offen offset:1536 sc1
    v_mfma_f32_16x16x32_bf16 a[56:59], v[84:87], v[44:47], a[56:59]
    v_add_f32 v7, v7, v17
    v_cvt_f32_i32 v146, v146
    v_mfma_f32_16x16x32_bf16 a[56:59], v[68:71], v[40:43], a[56:59]
    v_exp_f32 v19, v107
    v_mfma_f32_16x16x32_bf16 a[104:107], v[72:75], v[40:43], a[104:107]
    ds_read_b128 v[36:39], v1 offset:16384
    v_cvt_pk_bf16_f32 v170, v16, v17
    v_mfma_f32_16x16x32_bf16 a[104:107], v[88:91], v[44:47], a[104:107]
    v_exp_f32 v16, v172
    v_mfma_f32_16x16x32_bf16 a[152:155], v[92:95], v[44:47], a[152:155]
    v_add_f32 v7, v7, v18
    v_cvt_f32_i32 v150, v150
    v_mfma_f32_16x16x32_bf16 a[152:155], v[76:79], v[40:43], a[152:155]
    s_waitcnt lgkmcnt(2)
    v_add_f32 v7, v7, v19
    v_fma_f32 v146, v146, v48, v50
    v_mfma_f32_16x16x32_bf16 a[12:15], v[64:67], v[24:27], a[12:15]
    ds_read_b128 v[40:43], v1 offset:5120
    v_mfma_f32_16x16x32_bf16 a[12:15], v[80:83], v[28:31], a[12:15]
    buffer_store_dwordx4 v[236:239], v23, s[4:7], s33 offen offset:2304 sc1
    v_mfma_f32_16x16x32_bf16 a[60:63], v[84:87], v[28:31], a[60:63]
    v_exp_f32 v17, v173
    v_mfma_f32_16x16x32_bf16 a[60:63], v[68:71], v[24:27], a[60:63]
    v_cvt_pk_bf16_f32 v171, v18, v19
    v_fma_f32 v150, v150, v49, v51
    v_mfma_f32_16x16x32_bf16 a[108:111], v[72:75], v[24:27], a[108:111]
    ds_read_b128 v[44:47], v1 offset:17408
    v_mfma_f32_16x16x32_bf16 a[108:111], v[88:91], v[28:31], a[108:111]
    v_exp_f32 v18, v174
    v_mfma_f32_16x16x32_bf16 a[156:159], v[92:95], v[28:31], a[156:159]
    s_add_u32 s29, s28, 49152
    v_add_f32 v8, v8, v16
    v_add_f32 v8, v8, v17
    v_mfma_f32_16x16x32_bf16 a[156:159], v[76:79], v[24:27], a[156:159]
    s_waitcnt lgkmcnt(2)
    v_exp_f32 v19, v175
    v_mfma_f32_16x16x32_bf16 a[16:19], v[64:67], v[32:35], a[16:19]
    s_sub_u32 s3, s29, 147456
    ds_read_b128 v[24:27], v1 offset:6144
    v_cvt_pk_bf16_f32 v172, v16, v17
    v_mfma_f32_16x16x32_bf16 a[16:19], v[80:83], v[36:39], a[16:19]
    s_mov_b32 m0, s26
    v_exp_f32 v16, v108
    v_mfma_f32_16x16x32_bf16 a[64:67], v[84:87], v[36:39], a[64:67]
    s_min_u32 s29, s29, s3
    v_add_f32 v8, v8, v18
    v_lshlrev_b32 v48, 16, v57
    v_mfma_f32_16x16x32_bf16 a[64:67], v[68:71], v[32:35], a[64:67]
    buffer_load_dwordx4 v4, s[4:7], s32 offen offset:0 sc1 lds
    v_mfma_f32_16x16x32_bf16 a[112:115], v[72:75], v[32:35], a[112:115]
    ds_read_b128 v[28:31], v1 offset:18432
    v_add_f32 v8, v8, v19
    v_mfma_f32_16x16x32_bf16 a[112:115], v[88:91], v[36:39], a[112:115]
    v_exp_f32 v17, v109
    v_mfma_f32_16x16x32_bf16 a[160:163], v[92:95], v[36:39], a[160:163]
    v_cvt_pk_bf16_f32 v173, v18, v19
    v_and_b32 v49, s97, v57
    v_mfma_f32_16x16x32_bf16 a[160:163], v[76:79], v[32:35], a[160:163]
    s_waitcnt lgkmcnt(2)
    buffer_load_dwordx4 v4, s[4:7], s32 offen offset:1024 sc1 lds
    v_mfma_f32_16x16x32_bf16 a[20:23], v[64:67], v[40:43], a[20:23]
    s_sub_u32 s3, s29, s28
    ds_read_b128 v[32:35], v1 offset:7168
    v_lshlrev_b32 v50, 16, v59
    v_mfma_f32_16x16x32_bf16 a[20:23], v[80:83], v[44:47], a[20:23]
    v_exp_f32 v18, v110
    v_mfma_f32_16x16x32_bf16 a[68:71], v[84:87], v[44:47], a[68:71]
    v_add_f32 v8, v8, v16
    v_add_f32 v8, v8, v17
    v_mfma_f32_16x16x32_bf16 a[68:71], v[68:71], v[40:43], a[68:71]
    buffer_load_dwordx4 v4, s[4:7], s32 offen offset:2048 sc1 lds
    v_mfma_f32_16x16x32_bf16 a[116:119], v[72:75], v[40:43], a[116:119]
    ds_read_b128 v[36:39], v1 offset:19456
    v_mfma_f32_16x16x32_bf16 a[116:119], v[88:91], v[44:47], a[116:119]
    v_exp_f32 v19, v111
    v_mfma_f32_16x16x32_bf16 a[164:167], v[92:95], v[44:47], a[164:167]
    s_mov_b32 s28, s29
    v_cvt_pk_bf16_f32 v174, v16, v17
    v_add_f32 v8, v8, v18
    v_mfma_f32_16x16x32_bf16 a[164:167], v[76:79], v[40:43], a[164:167]
    s_waitcnt lgkmcnt(2)
    v_add_f32 v8, v8, v19
    v_cvt_pk_bf16_f32 v175, v18, v19
    v_mfma_f32_16x16x32_bf16 a[24:27], v[64:67], v[24:27], a[24:27]
    s_add_u32 s32, s32, 24576
    ds_read_b128 v[40:43], v1 offset:8192
    v_and_b32 v51, s97, v59
    v_mfma_f32_16x16x32_bf16 a[24:27], v[80:83], v[28:31], a[24:27]
    v_exp_f32 v16, v176
    v_mfma_f32_16x16x32_bf16 a[72:75], v[84:87], v[28:31], a[72:75]
    s_add_u32 s26, s26, 12288
    v_exp_f32 v17, v177
    v_mfma_f32_16x16x32_bf16 a[72:75], v[68:71], v[24:27], a[72:75]
    v_exp_f32 v18, v178
    v_mfma_f32_16x16x32_bf16 a[120:123], v[72:75], v[24:27], a[120:123]
    s_mov_b32 m0, s26
    ds_read_b128 v[44:47], v1 offset:20480
    v_add_f32 v5, v5, v16
    v_mfma_f32_16x16x32_bf16 a[120:123], v[88:91], v[28:31], a[120:123]
    v_add_f32 v5, v5, v17
    v_mul_f32_e64 v50, -v50, v48
    v_mfma_f32_16x16x32_bf16 a[168:171], v[92:95], v[28:31], a[168:171]
    v_exp_f32 v19, v179
    v_mfma_f32_16x16x32_bf16 a[168:171], v[76:79], v[24:27], a[168:171]
    s_waitcnt lgkmcnt(2)
    v_cvt_pk_bf16_f32 v176, v16, v17
    v_mul_f32_e64 v51, -v51, v49
    v_mfma_f32_16x16x32_bf16 a[28:31], v[64:67], v[32:35], a[28:31]
    ds_read_b128 v[24:27], v1 offset:9216
    v_add_u32 v2, s3, v2
    v_mfma_f32_16x16x32_bf16 a[28:31], v[80:83], v[36:39], a[28:31]
    buffer_load_dwordx4 v4, s[4:7], s32 offen offset:0 sc1 lds
    v_mfma_f32_16x16x32_bf16 a[76:79], v[84:87], v[36:39], a[76:79]
    v_exp_f32 v16, v112
    v_mfma_f32_16x16x32_bf16 a[76:79], v[68:71], v[32:35], a[76:79]
    v_add_f32 v5, v5, v18
    v_add_f32 v5, v5, v19
    v_mfma_f32_16x16x32_bf16 a[124:127], v[72:75], v[32:35], a[124:127]
    ds_read_b128 v[28:31], v1 offset:21504
    v_cvt_f32_i32 v152, v152
    v_mfma_f32_16x16x32_bf16 a[124:127], v[88:91], v[36:39], a[124:127]
    buffer_load_dwordx4 v4, s[4:7], s32 offen offset:1024 sc1 lds
    v_mfma_f32_16x16x32_bf16 a[172:175], v[92:95], v[36:39], a[172:175]
    v_exp_f32 v17, v113
    v_mfma_f32_16x16x32_bf16 a[172:175], v[76:79], v[32:35], a[172:175]
    s_waitcnt lgkmcnt(2)
    v_cvt_pk_bf16_f32 v177, v18, v19
    v_add_u32 v3, s3, v3
    v_mfma_f32_16x16x32_bf16 a[32:35], v[64:67], v[40:43], a[32:35]
    ds_read_b128 v[32:35], v1 offset:10240
    v_cvt_f32_i32 v156, v156
    v_mfma_f32_16x16x32_bf16 a[32:35], v[80:83], v[44:47], a[32:35]
    v_exp_f32 v18, v114
    v_mfma_f32_16x16x32_bf16 a[80:83], v[84:87], v[44:47], a[80:83]
    v_add_f32 v5, v5, v16
    v_add_f32 v5, v5, v17
    v_mfma_f32_16x16x32_bf16 a[80:83], v[68:71], v[40:43], a[80:83]
    buffer_load_dwordx4 v4, s[4:7], s32 offen offset:2048 sc1 lds
    v_mfma_f32_16x16x32_bf16 a[128:131], v[72:75], v[40:43], a[128:131]
    ds_read_b128 v[36:39], v1 offset:22528
    v_mfma_f32_16x16x32_bf16 a[128:131], v[88:91], v[44:47], a[128:131]
    v_exp_f32 v19, v115
    v_mfma_f32_16x16x32_bf16 a[176:179], v[92:95], v[44:47], a[176:179]
    v_cvt_pk_bf16_f32 v178, v16, v17
    v_fma_f32 v152, v152, v48, v50
    v_mfma_f32_16x16x32_bf16 a[176:179], v[76:79], v[40:43], a[176:179]
    s_waitcnt lgkmcnt(2)
    v_exp_f32 v16, v180
    v_mfma_f32_16x16x32_bf16 a[36:39], v[64:67], v[24:27], a[36:39]
    ds_read_b128 v[40:43], v1 offset:11264
    v_add_f32 v5, v5, v18
    v_mfma_f32_16x16x32_bf16 a[36:39], v[80:83], v[28:31], a[36:39]
    v_add_f32 v5, v5, v19
    v_mfma_f32_16x16x32_bf16 a[84:87], v[84:87], v[28:31], a[84:87]
    v_exp_f32 v17, v181
    v_mfma_f32_16x16x32_bf16 a[84:87], v[68:71], v[24:27], a[84:87]
    s_add_u32 s32, s32, 24576
    v_cvt_pk_bf16_f32 v179, v18, v19
    s_add_u32 s26, s26, 36864
    v_mfma_f32_16x16x32_bf16 a[132:135], v[72:75], v[24:27], a[132:135]
    s_sub_u32 s57, s26, 147456
    ds_read_b128 v[44:47], v1 offset:23552
    v_fma_f32 v156, v156, v49, v51
    v_mfma_f32_16x16x32_bf16 a[132:135], v[88:91], v[28:31], a[132:135]
    s_waitcnt lgkmcnt(2)
    v_exp_f32 v18, v182
    v_mfma_f32_16x16x32_bf16 a[180:183], v[92:95], v[28:31], a[180:183]
    s_waitcnt vmcnt(6)
    v_add_f32 v6, v6, v16
    v_add_f32 v6, v6, v17
    v_mfma_f32_16x16x32_bf16 a[180:183], v[76:79], v[24:27], a[180:183]
    s_barrier
    v_mfma_f32_16x16x32_bf16 a[40:43], v[64:67], v[32:35], a[40:43]
    s_min_u32 s26, s26, s57
    ds_read_b128 v[24:27], v2 offset:0
    v_add_u32 v0, 1, v0
    v_mfma_f32_16x16x32_bf16 a[40:43], v[80:83], v[36:39], a[40:43]
    buffer_store_dword v0, v13, s[20:23], 0 offen offset:32 sc1
    v_mfma_f32_16x16x32_bf16 a[88:91], v[84:87], v[36:39], a[88:91]
    v_exp_f32 v19, v183
    v_mfma_f32_16x16x32_bf16 a[88:91], v[68:71], v[32:35], a[88:91]
    v_cvt_pk_bf16_f32 v180, v16, v17
    v_cvt_f32_i32 v153, v153
    v_mfma_f32_16x16x32_bf16 a[136:139], v[72:75], v[32:35], a[136:139]
    ds_read_b128 v[28:31], v3 offset:0
    v_cvt_f32_i32 v157, v157
    v_mfma_f32_16x16x32_bf16 a[136:139], v[88:91], v[36:39], a[136:139]
    v_exp_f32 v16, v116
    v_mfma_f32_16x16x32_bf16 a[184:187], v[92:95], v[36:39], a[184:187]
    v_add_f32 v6, v6, v18
    v_add_f32 v6, v6, v19
    v_mfma_f32_16x16x32_bf16 a[184:187], v[76:79], v[32:35], a[184:187]
    s_waitcnt lgkmcnt(2)
    v_exp_f32 v17, v117
    v_mfma_f32_16x16x32_bf16 a[44:47], v[64:67], v[40:43], a[44:47]
    ds_read_b128 v[32:35], v2 offset:6144
    v_cvt_pk_bf16_f32 v181, v18, v19
    v_mfma_f32_16x16x32_bf16 a[44:47], v[80:83], v[44:47], a[44:47]
    v_exp_f32 v18, v118
    v_mfma_f32_16x16x32_bf16 a[92:95], v[84:87], v[44:47], a[92:95]
    v_add_f32 v6, v6, v16
    v_add_f32 v6, v6, v17
    v_mfma_f32_16x16x32_bf16 a[92:95], v[68:71], v[40:43], a[92:95]
    v_exp_f32 v19, v119
    v_mfma_f32_16x16x32_bf16 a[140:143], v[72:75], v[40:43], a[140:143]
    ds_read_b128 v[36:39], v3 offset:6144
    v_cvt_pk_bf16_f32 v182, v16, v17
    v_mfma_f32_16x16x32_bf16 a[140:143], v[88:91], v[44:47], a[140:143]
    v_add_f32 v6, v6, v18
    v_add_f32 v6, v6, v19
    v_mfma_f32_16x16x32_bf16 a[188:191], v[92:95], v[44:47], a[188:191]
    v_cvt_pk_bf16_f32 v183, v18, v19
    v_mfma_f32_16x16x32_bf16 a[188:191], v[76:79], v[40:43], a[188:191]
    s_waitcnt lgkmcnt(2)
    v_mfma_f32_16x16x32_bf16 v[64:67], v[24:27], a[192:195], v[128:131]
    s_add_u32 s33, s33, 196608
    ds_read_b128 v[40:43], v2 offset:128
    v_fma_f32 v153, v153, v48, v50
    v_mfma_f32_16x16x32_bf16 v[64:67], v[28:31], a[196:199], v[64:67]
    s_mov_b32 m0, s56
    v_exp_f32 v16, v184
    v_mfma_f32_16x16x32_bf16 v[68:71], v[28:31], a[220:223], v[132:135]
    s_add_u32 s34, s34, 196608
    v_exp_f32 v17, v185
    v_mfma_f32_16x16x32_bf16 v[68:71], v[24:27], a[216:219], v[68:71]
    s_add_u32 s36, s36, 1536
    buffer_load_dwordx4 v4, s[4:7], s27 offen offset:0 sc1 lds
    v_mfma_f32_16x16x32_bf16 v[72:75], v[24:27], a[240:243], v[136:139]
    ds_read_b128 v[44:47], v3 offset:128
    v_fma_f32 v157, v157, v49, v51
    v_mfma_f32_16x16x32_bf16 v[72:75], v[28:31], a[244:247], v[72:75]
    v_exp_f32 v18, v186
    v_mfma_f32_16x16x32_bf16 v[76:79], v[28:31], v[204:207], v[140:143]
    v_add_f32 v7, v7, v16
    v_add_f32 v7, v7, v17
    v_mfma_f32_16x16x32_bf16 v[76:79], v[24:27], v[200:203], v[76:79]
    s_waitcnt lgkmcnt(2)
    buffer_load_dwordx2 v[56:57], v10, s[72:75], s36 offen offset:0
    v_mfma_f32_16x16x32_bf16 v[96:99], v[32:35], a[192:195], v[128:131]
    ds_read_b128 v[24:27], v2 offset:6272
    v_cvt_f32_i32 v154, v154
    v_mfma_f32_16x16x32_bf16 v[96:99], v[36:39], a[196:199], v[96:99]
    v_exp_f32 v19, v187
    v_mfma_f32_16x16x32_bf16 v[100:103], v[36:39], a[220:223], v[132:135]
    v_cvt_pk_bf16_f32 v184, v16, v17
    v_cvt_f32_i32 v158, v158
    v_mfma_f32_16x16x32_bf16 v[100:103], v[32:35], a[216:219], v[100:103]
    buffer_load_dwordx4 v4, s[4:7], s27 offen offset:1024 sc1 lds
    v_mfma_f32_16x16x32_bf16 v[104:107], v[32:35], a[240:243], v[136:139]
    ds_read_b128 v[28:31], v3 offset:6272
    v_fma_f32 v154, v154, v48, v50
    v_mfma_f32_16x16x32_bf16 v[104:107], v[36:39], a[244:247], v[104:107]
    v_exp_f32 v16, v120
    v_mfma_f32_16x16x32_bf16 v[108:111], v[36:39], v[204:207], v[140:143]
    v_add_f32 v7, v7, v18
    v_add_f32 v7, v7, v19
    v_mfma_f32_16x16x32_bf16 v[108:111], v[32:35], v[200:203], v[108:111]
    s_waitcnt lgkmcnt(2)
    buffer_load_dwordx2 v[58:59], v10, s[76:79], s36 offen offset:0
    v_mfma_f32_16x16x32_bf16 v[64:67], v[40:43], a[200:203], v[64:67]
    ds_read_b128 v[32:35], v2 offset:256
    v_fma_f32 v158, v158, v49, v51
    v_mfma_f32_16x16x32_bf16 v[64:67], v[44:47], a[204:207], v[64:67]
    v_exp_f32 v17, v121
    v_mfma_f32_16x16x32_bf16 v[68:71], v[44:47], a[228:231], v[68:71]
    v_cvt_pk_bf16_f32 v185, v18, v19
    v_mfma_f32_16x16x32_bf16 v[68:71], v[40:43], a[224:227], v[68:71]
    buffer_load_dwordx4 v[224:227], v9, s[64:67], s33 offen offset:0 nt
    v_mfma_f32_16x16x32_bf16 v[72:75], v[40:43], a[248:251], v[72:75]
    ds_read_b128 v[36:39], v3 offset:256
    v_cvt_pk_bf16_f32 v144, v144, v148
    v_mfma_f32_16x16x32_bf16 v[72:75], v[44:47], a[252:255], v[72:75]
    v_exp_f32 v18, v122
    v_mfma_f32_16x16x32_bf16 v[76:79], v[44:47], v[212:215], v[76:79]
    v_add_f32 v7, v7, v16
    v_add_f32 v7, v7, v17
    v_mfma_f32_16x16x32_bf16 v[76:79], v[40:43], v[208:211], v[76:79]
    s_waitcnt lgkmcnt(2)
    buffer_load_dwordx4 v4, s[4:7], s27 offen offset:2048 sc1 lds
    v_mfma_f32_16x16x32_bf16 v[96:99], v[24:27], a[200:203], v[96:99]
    ds_read_b128 v[40:43], v2 offset:6400
    v_cvt_pk_bf16_f32 v148, v145, v149
    v_mfma_f32_16x16x32_bf16 v[96:99], v[28:31], a[204:207], v[96:99]
    v_exp_f32 v19, v123
    v_cvt_pk_bf16_f32 v186, v16, v17
    v_mfma_f32_16x16x32_bf16 v[100:103], v[28:31], a[228:231], v[100:103]
    v_exp_f32 v16, v188
    v_mfma_f32_16x16x32_bf16 v[100:103], v[24:27], a[224:227], v[100:103]
    buffer_load_dwordx4 v[228:231], v9, s[64:67], s33 offen offset:1536 nt
    v_mfma_f32_16x16x32_bf16 v[104:107], v[24:27], a[248:251], v[104:107]
    ds_read_b128 v[44:47], v3 offset:6400
    v_add_f32 v7, v7, v18
    v_mfma_f32_16x16x32_bf16 v[104:107], v[28:31], a[252:255], v[104:107]
    v_add_f32 v7, v7, v19
    v_cvt_pk_bf16_f32 v145, v152, v156
    v_mfma_f32_16x16x32_bf16 v[108:111], v[28:31], v[212:215], v[108:111]
    s_add_u32 s29, s30, 49152
    v_exp_f32 v17, v189
    v_mfma_f32_16x16x32_bf16 v[108:111], v[24:27], v[208:211], v[108:111]
    s_waitcnt lgkmcnt(2)
    buffer_load_dwordx4 v[232:235], v9, s[64:67], s34 offen offset:0 nt
    v_cvt_pk_bf16_f32 v187, v18, v19
    v_mfma_f32_16x16x32_bf16 v[64:67], v[32:35], a[208:211], v[64:67]
    s_sub_u32 s3, s29, 147456
    ds_read_b128 v[24:27], v2 offset:12288
    s_add_u32 s27, s27, 24576
    v_mfma_f32_16x16x32_bf16 v[64:67], v[36:39], a[212:215], v[64:67]
    s_min_u32 s29, s29, s3
    v_exp_f32 v18, v190
    v_mfma_f32_16x16x32_bf16 v[68:71], v[36:39], a[236:239], v[68:71]
    v_add_f32 v8, v8, v16
    v_add_f32 v8, v8, v17
    v_mfma_f32_16x16x32_bf16 v[68:71], v[32:35], a[232:235], v[68:71]
    buffer_load_dwordx4 v[236:239], v9, s[64:67], s34 offen offset:1536 nt
    v_mfma_f32_16x16x32_bf16 v[72:75], v[32:35], v[192:195], v[72:75]
    s_add_u32 s56, s56, 12288
    ds_read_b128 v[28:31], v3 offset:12288
    v_cvt_pk_bf16_f32 v149, v153, v157
    v_mfma_f32_16x16x32_bf16 v[72:75], v[36:39], v[196:199], v[72:75]
    v_exp_f32 v19, v191
    v_cvt_pk_bf16_f32 v188, v16, v17
    v_mfma_f32_16x16x32_bf16 v[76:79], v[36:39], v[220:223], v[76:79]
    v_exp_f32 v16, v124
    v_mfma_f32_16x16x32_bf16 v[76:79], v[32:35], v[216:219], v[76:79]
    s_waitcnt lgkmcnt(2)
    v_add_f32 v8, v8, v18
    v_add_f32 v8, v8, v19
    v_mfma_f32_16x16x32_bf16 v[96:99], v[40:43], a[208:211], v[96:99]
    ds_read_b128 v[32:35], v2 offset:18432
    v_cvt_pk_bf16_f32 v152, v146, v150
    v_mfma_f32_16x16x32_bf16 v[96:99], v[44:47], a[212:215], v[96:99]
    s_sub_u32 s3, s29, s30
    v_exp_f32 v17, v125
    v_mfma_f32_16x16x32_bf16 v[100:103], v[44:47], a[236:239], v[100:103]
    s_mov_b32 m0, s56
    v_cvt_pk_bf16_f32 v189, v18, v19
    v_cvt_pk_bf16_f32 v153, v154, v158
    v_mfma_f32_16x16x32_bf16 v[100:103], v[40:43], a[232:235], v[100:103]
    v_exp_f32 v18, v126
    v_mfma_f32_16x16x32_bf16 v[104:107], v[40:43], v[192:195], v[104:107]
    ds_read_b128 v[36:39], v3 offset:18432
    v_add_f32 v8, v8, v16
    v_mfma_f32_16x16x32_bf16 v[104:107], v[44:47], v[196:199], v[104:107]
    v_add_f32 v8, v8, v17
    v_mfma_f32_16x16x32_bf16 v[108:111], v[44:47], v[220:223], v[108:111]
    v_exp_f32 v19, v127
    v_mfma_f32_16x16x32_bf16 v[108:111], v[40:43], v[216:219], v[108:111]
    s_waitcnt lgkmcnt(2)
    v_cvt_pk_bf16_f32 v190, v16, v17
    v_add_f32 v8, v8, v18
    v_mfma_f32_16x16x32_bf16 v[80:83], v[24:27], a[192:195], v[128:131]
    ds_read_b128 v[40:43], v2 offset:12416
    v_add_f32 v8, v8, v19
    v_mfma_f32_16x16x32_bf16 v[80:83], v[28:31], a[196:199], v[80:83]
    s_mov_b32 s30, s29
    v_cvt_pk_bf16_f32 v191, v18, v19
    v_mfma_f32_16x16x32_bf16 v[84:87], v[28:31], a[220:223], v[132:135]
    v_exp_f32 v16, v64
    v_mfma_f32_16x16x32_bf16 v[84:87], v[24:27], a[216:219], v[84:87]
    s_waitcnt vmcnt(20)
    buffer_load_dwordx4 v4, s[4:7], s27 offen offset:0 sc1 lds
    v_mfma_f32_16x16x32_bf16 v[88:91], v[24:27], a[240:243], v[136:139]
    ds_read_b128 v[44:47], v3 offset:12416
    v_lshlrev_b32 v48, 16, v60
    v_mfma_f32_16x16x32_bf16 v[88:91], v[28:31], a[244:247], v[88:91]
    v_exp_f32 v17, v65
    v_mfma_f32_16x16x32_bf16 v[92:95], v[28:31], v[204:207], v[140:143]
    v_exp_f32 v18, v66
    v_mfma_f32_16x16x32_bf16 v[92:95], v[24:27], v[200:203], v[92:95]
    s_waitcnt lgkmcnt(2)
    v_add_f32 v5, v5, v16
    v_add_f32 v5, v5, v17
    v_mfma_f32_16x16x32_bf16 v[112:115], v[32:35], a[192:195], v[128:131]
    ds_read_b128 v[24:27], v2 offset:18560
    v_and_b32 v49, s97, v60
    v_mfma_f32_16x16x32_bf16 v[112:115], v[36:39], a[196:199], v[112:115]
    v_exp_f32 v19, v67
    v_mfma_f32_16x16x32_bf16 v[116:119], v[36:39], a[220:223], v[132:135]
    v_cvt_pk_bf16_f32 v64, v16, v17
    v_lshlrev_b32 v50, 16, v62
    v_mfma_f32_16x16x32_bf16 v[116:119], v[32:35], a[216:219], v[116:119]
    v_exp_f32 v16, v96
    v_mfma_f32_16x16x32_bf16 v[120:123], v[32:35], a[240:243], v[136:139]
    ds_read_b128 v[28:31], v3 offset:18560
    v_add_f32 v5, v5, v18
    v_mfma_f32_16x16x32_bf16 v[120:123], v[36:39], a[244:247], v[120:123]
    v_add_f32 v5, v5, v19
    v_and_b32 v51, s97, v62
    v_mfma_f32_16x16x32_bf16 v[124:127], v[36:39], v[204:207], v[140:143]
    v_exp_f32 v17, v97
    v_mfma_f32_16x16x32_bf16 v[124:127], v[32:35], v[200:203], v[124:127]
    s_waitcnt lgkmcnt(2)
    buffer_load_dwordx4 v4, s[4:7], s27 offen offset:1024 sc1 lds
    v_mfma_f32_16x16x32_bf16 v[80:83], v[40:43], a[200:203], v[80:83]
    ds_read_b128 v[32:35], v2 offset:12544
    v_cvt_pk_bf16_f32 v65, v18, v19
    v_mfma_f32_16x16x32_bf16 v[80:83], v[44:47], a[204:207], v[80:83]
    v_exp_f32 v18, v98
    v_mfma_f32_16x16x32_bf16 v[84:87], v[44:47], a[228:231], v[84:87]
    v_add_f32 v5, v5, v16
    v_add_f32 v5, v5, v17
    v_mfma_f32_16x16x32_bf16 v[84:87], v[40:43], a[224:227], v[84:87]
    v_exp_f32 v19, v99
    v_mfma_f32_16x16x32_bf16 v[88:91], v[40:43], a[248:251], v[88:91]
    ds_read_b128 v[36:39], v3 offset:12544
    v_cvt_pk_bf16_f32 v66, v16, v17
    v_mfma_f32_16x16x32_bf16 v[88:91], v[44:47], a[252:255], v[88:91]
    v_exp_f32 v16, v68
    v_mfma_f32_16x16x32_bf16 v[92:95], v[44:47], v[212:215], v[92:95]
    v_add_u32 v1, s3, v1
    v_mul_f32_e64 v50, -v50, v48
    v_mfma_f32_16x16x32_bf16 v[92:95], v[40:43], v[208:211], v[92:95]
    s_waitcnt lgkmcnt(2)
    v_add_f32 v5, v5, v18
    v_add_f32 v5, v5, v19
    v_mfma_f32_16x16x32_bf16 v[112:115], v[24:27], a[200:203], v[112:115]
    ds_read_b128 v[40:43], v2 offset:18688
    v_mul_f32_e64 v51, -v51, v49
    v_mfma_f32_16x16x32_bf16 v[112:115], v[28:31], a[204:207], v[112:115]
    buffer_load_dwordx4 v4, s[4:7], s27 offen offset:2048 sc1 lds
    v_mfma_f32_16x16x32_bf16 v[116:119], v[28:31], a[228:231], v[116:119]
    v_exp_f32 v17, v69
    v_mfma_f32_16x16x32_bf16 v[116:119], v[24:27], a[224:227], v[116:119]
    v_cvt_pk_bf16_f32 v67, v18, v19
    v_cvt_f32_i32 v240, v240
    v_mfma_f32_16x16x32_bf16 v[120:123], v[24:27], a[248:251], v[120:123]
    ds_read_b128 v[44:47], v3 offset:18688
    v_mfma_f32_16x16x32_bf16 v[120:123], v[28:31], a[252:255], v[120:123]
    s_waitcnt lgkmcnt(2)
    v_exp_f32 v18, v70
    v_mfma_f32_16x16x32_bf16 v[124:127], v[28:31], v[212:215], v[124:127]
    s_waitcnt vmcnt(13)
    v_add_f32 v6, v6, v16
    v_add_f32 v6, v6, v17
    v_mfma_f32_16x16x32_bf16 v[124:127], v[24:27], v[208:211], v[124:127]
    s_barrier
    v_mfma_f32_16x16x32_bf16 v[80:83], v[32:35], a[208:211], v[80:83]
    ds_read_b128 v[24:27], v1 offset:0
    v_cvt_f32_i32 v244, v244
    v_mfma_f32_16x16x32_bf16 v[80:83], v[36:39], a[212:215], v[80:83]
    v_exp_f32 v19, v71
    v_mfma_f32_16x16x32_bf16 v[84:87], v[36:39], a[236:239], v[84:87]
    v_cvt_pk_bf16_f32 v68, v16, v17
    v_fma_f32 v240, v240, v48, v50
    v_mfma_f32_16x16x32_bf16 v[84:87], v[32:35], a[232:235], v[84:87]
    v_exp_f32 v16, v100
    v_mfma_f32_16x16x32_bf16 v[88:91], v[32:35], v[192:195], v[88:91]
    ds_read_b128 v[28:31], v1 offset:12288
    v_add_f32 v6, v6, v18
    v_mfma_f32_16x16x32_bf16 v[88:91], v[36:39], v[196:199], v[88:91]
    v_add_f32 v6, v6, v19
    v_fma_f32 v244, v244, v49, v51
    v_mfma_f32_16x16x32_bf16 v[92:95], v[36:39], v[220:223], v[92:95]
    v_exp_f32 v17, v101
    v_mfma_f32_16x16x32_bf16 v[92:95], v[32:35], v[216:219], v[92:95]
    s_waitcnt lgkmcnt(2)
    v_cvt_pk_bf16_f32 v69, v18, v19
    v_mfma_f32_16x16x32_bf16 v[112:115], v[40:43], a[208:211], v[112:115]
    ds_read_b128 v[32:35], v1 offset:1024
    v_mfma_f32_16x16x32_bf16 v[112:115], v[44:47], a[212:215], v[112:115]
    v_exp_f32 v18, v102
    v_mfma_f32_16x16x32_bf16 v[116:119], v[44:47], a[236:239], v[116:119]
    v_add_f32 v6, v6, v16
    v_add_f32 v6, v6, v17
    v_mfma_f32_16x16x32_bf16 v[116:119], v[40:43], a[232:235], v[116:119]
    s_add_u32 s27, s27, 24576
    v_exp_f32 v19, v103
    v_mfma_f32_16x16x32_bf16 v[120:123], v[40:43], v[192:195], v[120:123]
    s_add_u32 s56, s56, 36864
    ds_read_b128 v[36:39], v1 offset:13312
    v_cvt_pk_bf16_f32 v70, v16, v17
    v_mfma_f32_16x16x32_bf16 v[120:123], v[44:47], v[196:199], v[120:123]
    s_sub_u32 s58, s56, 147456
    v_add_f32 v6, v6, v18
    v_add_f32 v6, v6, v19
    v_mfma_f32_16x16x32_bf16 v[124:127], v[44:47], v[220:223], v[124:127]
    s_min_u32 s56, s56, s58
    v_cvt_pk_bf16_f32 v71, v18, v19
    v_mfma_f32_16x16x32_bf16 v[124:127], v[40:43], v[216:219], v[124:127]
    s_waitcnt lgkmcnt(2)
    v_mfma_f32_16x16x32_bf16 a[0:3], v[160:163], v[24:27], a[0:3]
    s_mov_b32 m0, s56
    ds_read_b128 v[40:43], v1 offset:2048
    v_cvt_f32_i32 v241, v241
    v_mfma_f32_16x16x32_bf16 a[0:3], v[176:179], v[28:31], a[0:3]
    buffer_load_dwordx4 v4, s[4:7], s27 offen offset:0 sc1 lds
    v_mfma_f32_16x16x32_bf16 a[48:51], v[180:183], v[28:31], a[48:51]
    v_exp_f32 v16, v72
    v_mfma_f32_16x16x32_bf16 a[48:51], v[164:167], v[24:27], a[48:51]
    v_exp_f32 v17, v73
    v_mfma_f32_16x16x32_bf16 a[96:99], v[168:171], v[24:27], a[96:99]
    ds_read_b128 v[44:47], v1 offset:14336
    v_cvt_f32_i32 v245, v245
    v_mfma_f32_16x16x32_bf16 a[96:99], v[184:187], v[28:31], a[96:99]
    v_exp_f32 v18, v74
    v_mfma_f32_16x16x32_bf16 a[144:147], v[188:191], v[28:31], a[144:147]
    v_add_f32 v7, v7, v16
    v_add_f32 v7, v7, v17
    v_mfma_f32_16x16x32_bf16 a[144:147], v[172:175], v[24:27], a[144:147]
    s_waitcnt lgkmcnt(2)
    v_exp_f32 v19, v75
    v_mfma_f32_16x16x32_bf16 a[4:7], v[160:163], v[32:35], a[4:7]
L_pg4:
    s_cbranch_execz L_pg8
    ds_read_b128 v[24:27], v1 offset:3072
    v_fma_f32 v241, v241, v48, v50
    v_mfma_f32_16x16x32_bf16 a[4:7], v[176:179], v[36:39], a[4:7]
    buffer_load_dwordx4 v4, s[4:7], s27 offen offset:1024 sc1 lds
    v_mfma_f32_16x16x32_bf16 a[52:55], v[180:183], v[36:39], a[52:55]
    v_cvt_pk_bf16_f32 v72, v16, v17
    v_fma_f32 v245, v245, v49, v51
    v_mfma_f32_16x16x32_bf16 a[52:55], v[164:167], v[32:35], a[52:55]
    v_exp_f32 v16, v104
    v_mfma_f32_16x16x32_bf16 a[100:103], v[168:171], v[32:35], a[100:103]
    ds_read_b128 v[28:31], v1 offset:15360
    v_add_f32 v7, v7, v18
    v_mfma_f32_16x16x32_bf16 a[100:103], v[184:187], v[36:39], a[100:103]
    buffer_load_dword v52, v20, s[20:23], s44 offen sc1
    v_mfma_f32_16x16x32_bf16 a[148:151], v[188:191], v[36:39], a[148:151]
    v_add_f32 v7, v7, v19
    v_cvt_f32_i32 v242, v242
    v_mfma_f32_16x16x32_bf16 a[148:151], v[172:175], v[32:35], a[148:151]
    s_waitcnt lgkmcnt(2)
    v_exp_f32 v17, v105
    v_mfma_f32_16x16x32_bf16 a[8:11], v[160:163], v[40:43], a[8:11]
    ds_read_b128 v[32:35], v1 offset:4096
    v_cvt_pk_bf16_f32 v73, v18, v19
    v_mfma_f32_16x16x32_bf16 a[8:11], v[176:179], v[44:47], a[8:11]
    v_exp_f32 v18, v106
    v_mfma_f32_16x16x32_bf16 a[56:59], v[180:183], v[44:47], a[56:59]
    v_add_f32 v7, v7, v16
    v_cvt_f32_i32 v246, v246
    v_mfma_f32_16x16x32_bf16 a[56:59], v[164:167], v[40:43], a[56:59]
    buffer_load_dwordx4 v4, s[4:7], s27 offen offset:2048 sc1 lds
    v_mfma_f32_16x16x32_bf16 a[104:107], v[168:171], v[40:43], a[104:107]
    ds_read_b128 v[36:39], v1 offset:16384
    v_add_f32 v7, v7, v17
    v_mfma_f32_16x16x32_bf16 a[104:107], v[184:187], v[44:47], a[104:107]
    v_exp_f32 v19, v107
    v_mfma_f32_16x16x32_bf16 a[152:155], v[188:191], v[44:47], a[152:155]
    v_cvt_pk_bf16_f32 v74, v16, v17
    v_fma_f32 v242, v242, v48, v50
    v_mfma_f32_16x16x32_bf16 a[152:155], v[172:175], v[40:43], a[152:155]
    s_waitcnt lgkmcnt(2)
    v_exp_f32 v16, v76
    v_mfma_f32_16x16x32_bf16 a[12:15], v[160:163], v[24:27], a[12:15]
    ds_read_b128 v[40:43], v1 offset:5120
    v_add_f32 v7, v7, v18
    v_mfma_f32_16x16x32_bf16 a[12:15], v[176:179], v[28:31], a[12:15]
    s_add_u32 s27, s27, 24576
    v_add_f32 v7, v7, v19
    v_fma_f32 v246, v246, v49, v51
    v_mfma_f32_16x16x32_bf16 a[60:63], v[180:183], v[28:31], a[60:63]
    v_exp_f32 v17, v77
    v_mfma_f32_16x16x32_bf16 a[60:63], v[164:167], v[24:27], a[60:63]
    v_cvt_pk_bf16_f32 v75, v18, v19
    v_lshlrev_b32 v48, 16, v61
    v_mfma_f32_16x16x32_bf16 a[108:111], v[168:171], v[24:27], a[108:111]
    ds_read_b128 v[44:47], v1 offset:17408
    v_and_b32 v49, s97, v61
    v_mfma_f32_16x16x32_bf16 a[108:111], v[184:187], v[28:31], a[108:111]
    v_exp_f32 v18, v78
    v_mfma_f32_16x16x32_bf16 a[156:159], v[188:191], v[28:31], a[156:159]
    s_add_u32 s29, s28, 49152
    v_add_f32 v8, v8, v16
    v_add_f32 v8, v8, v17
    v_mfma_f32_16x16x32_bf16 a[156:159], v[172:175], v[24:27], a[156:159]
    s_waitcnt lgkmcnt(2)
    v_exp_f32 v19, v79
    v_mfma_f32_16x16x32_bf16 a[16:19], v[160:163], v[32:35], a[16:19]
    s_sub_u32 s3, s29, 147456
    ds_read_b128 v[24:27], v1 offset:6144
    v_lshlrev_b32 v50, 16, v63
    v_mfma_f32_16x16x32_bf16 a[16:19], v[176:179], v[36:39], a[16:19]
    s_add_u32 s56, s56, 12288
    v_cvt_pk_bf16_f32 v76, v16, v17
    v_and_b32 v51, s97, v63
    v_mfma_f32_16x16x32_bf16 a[64:67], v[180:183], v[36:39], a[64:67]
    s_min_u32 s29, s29, s3
    v_exp_f32 v16, v108
    v_mfma_f32_16x16x32_bf16 a[64:67], v[164:167], v[32:35], a[64:67]
    s_mov_b32 m0, s56
    v_add_f32 v8, v8, v18
    v_add_f32 v8, v8, v19
    v_mfma_f32_16x16x32_bf16 a[112:115], v[168:171], v[32:35], a[112:115]
    ds_read_b128 v[28:31], v1 offset:18432
    v_mul_f32_e64 v50, -v50, v48
    v_mfma_f32_16x16x32_bf16 a[112:115], v[184:187], v[36:39], a[112:115]
    v_exp_f32 v17, v109
    v_mfma_f32_16x16x32_bf16 a[160:163], v[188:191], v[36:39], a[160:163]
    v_cvt_pk_bf16_f32 v77, v18, v19
    v_mul_f32_e64 v51, -v51, v49
    v_mfma_f32_16x16x32_bf16 a[160:163], v[172:175], v[32:35], a[160:163]
    s_waitcnt lgkmcnt(2)
    v_exp_f32 v18, v110
    v_mfma_f32_16x16x32_bf16 a[20:23], v[160:163], v[40:43], a[20:23]
    s_sub_u32 s3, s29, s28
    ds_read_b128 v[32:35], v1 offset:7168
    v_add_f32 v8, v8, v16
    v_mfma_f32_16x16x32_bf16 a[20:23], v[176:179], v[44:47], a[20:23]
    v_add_f32 v8, v8, v17
    v_cvt_f32_i32 v248, v248
    v_mfma_f32_16x16x32_bf16 a[68:71], v[180:183], v[44:47], a[68:71]
    v_exp_f32 v19, v111
    v_mfma_f32_16x16x32_bf16 a[68:71], v[164:167], v[40:43], a[68:71]
    buffer_load_dwordx4 v4, s[4:7], s27 offen offset:0 sc1 lds
    v_mfma_f32_16x16x32_bf16 a[116:119], v[168:171], v[40:43], a[116:119]
    ds_read_b128 v[36:39], v1 offset:19456
    v_cvt_pk_bf16_f32 v78, v16, v17
    v_mfma_f32_16x16x32_bf16 a[116:119], v[184:187], v[44:47], a[116:119]
    v_add_f32 v8, v8, v18
    v_cvt_f32_i32 v252, v252
    v_mfma_f32_16x16x32_bf16 a[164:167], v[188:191], v[44:47], a[164:167]
    s_mov_b32 s28, s29
    v_add_f32 v8, v8, v19
    v_cvt_pk_bf16_f32 v79, v18, v19
    v_mfma_f32_16x16x32_bf16 a[164:167], v[172:175], v[40:43], a[164:167]
    s_waitcnt lgkmcnt(2)
    v_exp_f32 v16, v80
    v_mfma_f32_16x16x32_bf16 a[24:27], v[160:163], v[24:27], a[24:27]
    ds_read_b128 v[40:43], v1 offset:8192
    v_fma_f32 v248, v248, v48, v50
    v_mfma_f32_16x16x32_bf16 a[24:27], v[176:179], v[28:31], a[24:27]
    v_exp_f32 v17, v81
    v_mfma_f32_16x16x32_bf16 a[72:75], v[180:183], v[28:31], a[72:75]
    v_fma_f32 v252, v252, v49, v51
    v_cvt_f32_i32 v249, v249
    v_mfma_f32_16x16x32_bf16 a[72:75], v[164:167], v[24:27], a[72:75]
    buffer_load_dwordx4 v4, s[4:7], s27 offen offset:1024 sc1 lds
    v_mfma_f32_16x16x32_bf16 a[120:123], v[168:171], v[24:27], a[120:123]
    ds_read_b128 v[44:47], v1 offset:20480
    v_cvt_f32_i32 v253, v253
    v_mfma_f32_16x16x32_bf16 a[120:123], v[184:187], v[28:31], a[120:123]
    v_exp_f32 v18, v82
    v_mfma_f32_16x16x32_bf16 a[168:171], v[188:191], v[28:31], a[168:171]
    v_add_f32 v5, v5, v16
    v_add_f32 v5, v5, v17
    v_mfma_f32_16x16x32_bf16 a[168:171], v[172:175], v[24:27], a[168:171]
    s_waitcnt lgkmcnt(2)
    v_exp_f32 v19, v83
    v_mfma_f32_16x16x32_bf16 a[28:31], v[160:163], v[32:35], a[28:31]
    ds_read_b128 v[24:27], v1 offset:9216
    v_cvt_pk_bf16_f32 v80, v16, v17
    v_mfma_f32_16x16x32_bf16 a[28:31], v[176:179], v[36:39], a[28:31]
    v_exp_f32 v16, v112
    v_mfma_f32_16x16x32_bf16 a[76:79], v[180:183], v[36:39], a[76:79]
    v_add_f32 v5, v5, v18
    v_fma_f32 v249, v249, v48, v50
    v_mfma_f32_16x16x32_bf16 a[76:79], v[164:167], v[32:35], a[76:79]
    v_add_f32 v5, v5, v19
    v_add_u32 v2, s3, v2
    v_mfma_f32_16x16x32_bf16 a[124:127], v[168:171], v[32:35], a[124:127]
    ds_read_b128 v[28:31], v1 offset:21504
    v_fma_f32 v253, v253, v49, v51
    v_mfma_f32_16x16x32_bf16 a[124:127], v[184:187], v[36:39], a[124:127]
    buffer_load_dwordx4 v4, s[4:7], s27 offen offset:2048 sc1 lds
    v_mfma_f32_16x16x32_bf16 a[172:175], v[188:191], v[36:39], a[172:175]
    v_exp_f32 v17, v113
    v_mfma_f32_16x16x32_bf16 a[172:175], v[172:175], v[32:35], a[172:175]
    s_waitcnt lgkmcnt(2)
    v_cvt_pk_bf16_f32 v81, v18, v19
    v_cvt_f32_i32 v250, v250
    v_mfma_f32_16x16x32_bf16 a[32:35], v[160:163], v[40:43], a[32:35]
    ds_read_b128 v[32:35], v1 offset:10240
    v_add_u32 v3, s3, v3
    v_mfma_f32_16x16x32_bf16 a[32:35], v[176:179], v[44:47], a[32:35]
    v_exp_f32 v18, v114
    v_mfma_f32_16x16x32_bf16 a[80:83], v[180:183], v[44:47], a[80:83]
    v_add_f32 v5, v5, v16
    v_add_f32 v5, v5, v17
    v_mfma_f32_16x16x32_bf16 a[80:83], v[164:167], v[40:43], a[80:83]
    v_exp_f32 v19, v115
    v_mfma_f32_16x16x32_bf16 a[128:131], v[168:171], v[40:43], a[128:131]
    ds_read_b128 v[36:39], v1 offset:22528
    v_cvt_pk_bf16_f32 v82, v16, v17
    v_mfma_f32_16x16x32_bf16 a[128:131], v[184:187], v[44:47], a[128:131]
    v_exp_f32 v16, v84
    v_mfma_f32_16x16x32_bf16 a[176:179], v[188:191], v[44:47], a[176:179]
    v_cvt_f32_i32 v254, v254
    v_add_f32 v5, v5, v18
    v_mfma_f32_16x16x32_bf16 a[176:179], v[172:175], v[40:43], a[176:179]
    s_waitcnt lgkmcnt(2)
    v_add_f32 v5, v5, v19
    v_fma_f32 v250, v250, v48, v50
    v_mfma_f32_16x16x32_bf16 a[36:39], v[160:163], v[24:27], a[36:39]
    ds_read_b128 v[40:43], v1 offset:11264
    v_fma_f32 v254, v254, v49, v51
    v_mfma_f32_16x16x32_bf16 a[36:39], v[176:179], v[28:31], a[36:39]
    v_exp_f32 v17, v85
    v_mfma_f32_16x16x32_bf16 a[84:87], v[180:183], v[28:31], a[84:87]
    v_cvt_pk_bf16_f32 v83, v18, v19
    v_cvt_pk_bf16_f32 v146, v240, v244
    v_mfma_f32_16x16x32_bf16 a[84:87], v[164:167], v[24:27], a[84:87]
    s_add_u32 s27, s27, 24576
    v_exp_f32 v18, v86
    v_mfma_f32_16x16x32_bf16 a[132:135], v[168:171], v[24:27], a[132:135]
    s_add_u32 s56, s56, 36864
    ds_read_b128 v[44:47], v1 offset:23552
    v_add_f32 v6, v6, v16
    v_mfma_f32_16x16x32_bf16 a[132:135], v[184:187], v[28:31], a[132:135]
    s_sub_u32 s58, s56, 147456
    v_add_f32 v6, v6, v17
    v_cvt_pk_bf16_f32 v150, v241, v245
    v_mfma_f32_16x16x32_bf16 a[180:183], v[188:191], v[28:31], a[180:183]
    v_exp_f32 v19, v87
    v_mfma_f32_16x16x32_bf16 a[180:183], v[172:175], v[24:27], a[180:183]
    s_waitcnt lgkmcnt(2)
    v_cvt_pk_bf16_f32 v84, v16, v17
    v_cvt_pk_bf16_f32 v147, v248, v252
    v_mfma_f32_16x16x32_bf16 a[40:43], v[160:163], v[32:35], a[40:43]
    s_min_u32 s56, s56, s58
    ds_read_b128 v[24:27], v2 offset:0
    v_mfma_f32_16x16x32_bf16 a[40:43], v[176:179], v[36:39], a[40:43]
    v_exp_f32 v16, v116
    v_mfma_f32_16x16x32_bf16 a[88:91], v[180:183], v[36:39], a[88:91]
    v_add_f32 v6, v6, v18
    v_add_f32 v6, v6, v19
    v_mfma_f32_16x16x32_bf16 a[88:91], v[164:167], v[32:35], a[88:91]
    v_exp_f32 v17, v117
    v_mfma_f32_16x16x32_bf16 a[136:139], v[168:171], v[32:35], a[136:139]
    ds_read_b128 v[28:31], v3 offset:0
    v_cvt_pk_bf16_f32 v151, v249, v253
    v_mfma_f32_16x16x32_bf16 a[136:139], v[184:187], v[36:39], a[136:139]
    v_cvt_pk_bf16_f32 v85, v18, v19
    v_cvt_pk_bf16_f32 v154, v242, v246
    v_mfma_f32_16x16x32_bf16 a[184:187], v[188:191], v[36:39], a[184:187]
    v_exp_f32 v18, v118
    v_mfma_f32_16x16x32_bf16 a[184:187], v[172:175], v[32:35], a[184:187]
    s_waitcnt lgkmcnt(2)
    v_add_f32 v6, v6, v16
    v_mfma_f32_16x16x32_bf16 a[44:47], v[160:163], v[40:43], a[44:47]
    ds_read_b128 v[32:35], v2 offset:6144
    v_add_f32 v6, v6, v17
    v_mfma_f32_16x16x32_bf16 a[44:47], v[176:179], v[44:47], a[44:47]
    v_exp_f32 v19, v119
    v_mfma_f32_16x16x32_bf16 a[92:95], v[180:183], v[44:47], a[92:95]
    v_cvt_pk_bf16_f32 v155, v250, v254
    v_mfma_f32_16x16x32_bf16 a[92:95], v[164:167], v[40:43], a[92:95]
    v_cvt_pk_bf16_f32 v86, v16, v17
    v_mfma_f32_16x16x32_bf16 a[140:143], v[168:171], v[40:43], a[140:143]
    ds_read_b128 v[36:39], v3 offset:6144
    v_add_f32 v6, v6, v18
    v_mfma_f32_16x16x32_bf16 a[140:143], v[184:187], v[44:47], a[140:143]
    v_add_f32 v6, v6, v19
    v_cvt_pk_bf16_f32 v87, v18, v19
    v_mfma_f32_16x16x32_bf16 a[188:191], v[188:191], v[44:47], a[188:191]
    v_mfma_f32_16x16x32_bf16 a[188:191], v[172:175], v[40:43], a[188:191]
    s_waitcnt lgkmcnt(2)
L_join:
    v_mfma_f32_16x16x32_bf16 v[160:163], v[24:27], a[192:195], v[128:131]
L_pg5:
    s_cbranch_execz L_pg9
    ds_read_b128 v[40:43], v2 offset:128
    v_mfma_f32_16x16x32_bf16 v[160:163], v[28:31], a[196:199], v[160:163]
    s_waitcnt vmcnt(4)
    v_subrev_u32 v52, s92, v52
    v_cmp_lt_u32 vcc, 15, v52
    v_mfma_f32_16x16x32_bf16 v[164:167], v[28:31], a[220:223], v[132:135]
    v_exp_f32 v16, v88
    v_mfma_f32_16x16x32_bf16 v[164:167], v[24:27], a[216:219], v[164:167]
    v_exp_f32 v17, v89
    v_mfma_f32_16x16x32_bf16 v[168:171], v[24:27], a[240:243], v[136:139]
    s_and_b32 s59, vcc_lo, 0xff
    ds_read_b128 v[44:47], v3 offset:128
    v_mfma_f32_16x16x32_bf16 v[168:171], v[28:31], a[244:247], v[168:171]
    s_cbranch_scc1 L_pollslow1
L_pollok1:
    v_mfma_f32_16x16x32_bf16 v[172:175], v[28:31], v[204:207], v[140:143]
    s_add_u32 s92, s92, 1
    v_exp_f32 v18, v90
    v_mfma_f32_16x16x32_bf16 v[172:175], v[24:27], v[200:203], v[172:175]
    s_waitcnt lgkmcnt(2)
    v_add_f32 v7, v7, v16
    v_add_f32 v7, v7, v17
    v_mfma_f32_16x16x32_bf16 v[96:99], v[32:35], a[192:195], v[128:131]
    ds_read_b128 v[24:27], v2 offset:6272
    v_mfma_f32_16x16x32_bf16 v[96:99], v[36:39], a[196:199], v[96:99]
    buffer_store_dwordx4 v[144:147], v15, s[4:7], s35 offen offset:0 sc1
    v_mfma_f32_16x16x32_bf16 v[100:103], v[36:39], a[220:223], v[132:135]
    v_exp_f32 v19, v91
    v_mfma_f32_16x16x32_bf16 v[100:103], v[32:35], a[216:219], v[100:103]
    v_cvt_pk_bf16_f32 v88, v16, v17
    v_mfma_f32_16x16x32_bf16 v[104:107], v[32:35], a[240:243], v[136:139]
    ds_read_b128 v[28:31], v3 offset:6272
    v_mfma_f32_16x16x32_bf16 v[104:107], v[36:39], a[244:247], v[104:107]
    v_exp_f32 v16, v120
    v_mfma_f32_16x16x32_bf16 v[108:111], v[36:39], v[204:207], v[140:143]
    v_add_f32 v7, v7, v18
    v_add_f32 v7, v7, v19
    v_mfma_f32_16x16x32_bf16 v[108:111], v[32:35], v[200:203], v[108:111]
    s_waitcnt lgkmcnt(2)
    v_exp_f32 v17, v121
    v_mfma_f32_16x16x32_bf16 v[160:163], v[40:43], a[200:203], v[160:163]
    ds_read_b128 v[32:35], v2 offset:256
    v_cvt_pk_bf16_f32 v89, v18, v19
    v_mfma_f32_16x16x32_bf16 v[160:163], v[44:47], a[204:207], v[160:163]
    buffer_store_dwordx4 v[148:151], v15, s[4:7], s35 offen offset:1024 sc1
    v_mfma_f32_16x16x32_bf16 v[164:167], v[44:47], a[228:231], v[164:167]
    v_exp_f32 v18, v122
    v_mfma_f32_16x16x32_bf16 v[164:167], v[40:43], a[224:227], v[164:167]
    v_add_f32 v7, v7, v16
    v_add_f32 v7, v7, v17
    v_mfma_f32_16x16x32_bf16 v[168:171], v[40:43], a[248:251], v[168:171]
    ds_read_b128 v[36:39], v3 offset:256
    v_mfma_f32_16x16x32_bf16 v[168:171], v[44:47], a[252:255], v[168:171]
    v_exp_f32 v19, v123
    v_mfma_f32_16x16x32_bf16 v[172:175], v[44:47], v[212:215], v[172:175]
    v_cvt_pk_bf16_f32 v90, v16, v17
    v_mfma_f32_16x16x32_bf16 v[172:175], v[40:43], v[208:211], v[172:175]
    s_waitcnt lgkmcnt(2)
    v_exp_f32 v16, v92
    v_mfma_f32_16x16x32_bf16 v[96:99], v[24:27], a[200:203], v[96:99]
    ds_read_b128 v[40:43], v2 offset:6400
    v_add_f32 v7, v7, v18
    v_mfma_f32_16x16x32_bf16 v[96:99], v[28:31], a[204:207], v[96:99]
    buffer_store_dwordx4 v[152:155], v15, s[4:7], s35 offen offset:2048 sc1
    v_mfma_f32_16x16x32_bf16 v[100:103], v[28:31], a[228:231], v[100:103]
    v_add_f32 v7, v7, v19
    v_mfma_f32_16x16x32_bf16 v[100:103], v[24:27], a[224:227], v[100:103]
    v_exp_f32 v17, v93
    v_mfma_f32_16x16x32_bf16 v[104:107], v[24:27], a[248:251], v[104:107]
    ds_read_b128 v[44:47], v3 offset:6400
    v_cvt_pk_bf16_f32 v91, v18, v19
    v_mfma_f32_16x16x32_bf16 v[104:107], v[28:31], a[252:255], v[104:107]
    v_exp_f32 v18, v94
    v_mfma_f32_16x16x32_bf16 v[108:111], v[28:31], v[212:215], v[108:111]
    s_add_u32 s29, s30, 49152
    v_add_f32 v8, v8, v16
    v_add_f32 v8, v8, v17
    v_mfma_f32_16x16x32_bf16 v[108:111], v[24:27], v[208:211], v[108:111]
    s_waitcnt lgkmcnt(2)
    v_exp_f32 v19, v95
    v_mfma_f32_16x16x32_bf16 v[160:163], v[32:35], a[208:211], v[160:163]
    s_sub_u32 s3, s29, 147456
    ds_read_b128 v[24:27], v2 offset:12288
    v_cvt_pk_bf16_f32 v92, v16, v17
    v_mfma_f32_16x16x32_bf16 v[160:163], v[36:39], a[212:215], v[160:163]
    s_min_u32 s29, s29, s3
    v_exp_f32 v16, v124
    v_mfma_f32_16x16x32_bf16 v[164:167], v[36:39], a[236:239], v[164:167]
    v_add_f32 v8, v8, v18
    v_add_f32 v8, v8, v19
    v_mfma_f32_16x16x32_bf16 v[164:167], v[32:35], a[232:235], v[164:167]
    v_exp_f32 v17, v125
    v_mfma_f32_16x16x32_bf16 v[168:171], v[32:35], v[192:195], v[168:171]
    ds_read_b128 v[28:31], v3 offset:12288
    v_mfma_f32_16x16x32_bf16 v[168:171], v[36:39], v[196:199], v[168:171]
    v_cvt_pk_bf16_f32 v93, v18, v19
    v_mfma_f32_16x16x32_bf16 v[172:175], v[36:39], v[220:223], v[172:175]
    v_exp_f32 v18, v126
    v_mfma_f32_16x16x32_bf16 v[172:175], v[32:35], v[216:219], v[172:175]
    s_waitcnt lgkmcnt(2)
    v_add_f32 v8, v8, v16
    v_mfma_f32_16x16x32_bf16 v[96:99], v[40:43], a[208:211], v[96:99]
    s_waitcnt vmcnt(10)
    ds_read_b128 v[32:35], v2 offset:18432
    v_lshlrev_b32 v48, 16, v56
    v_mfma_f32_16x16x32_bf16 v[96:99], v[44:47], a[212:215], v[96:99]
    s_mov_b32 m0, s26
    v_add_f32 v8, v8, v17
    v_and_b32 v49, s97, v56
    v_mfma_f32_16x16x32_bf16 v[100:103], v[44:47], a[236:239], v[100:103]
    s_sub_u32 s3, s29, s30
    v_exp_f32 v19, v127
    v_mfma_f32_16x16x32_bf16 v[100:103], v[40:43], a[232:235], v[100:103]
    buffer_load_dwordx4 v4, s[4:7], s32 offen offset:0 sc1 lds
    v_mfma_f32_16x16x32_bf16 v[104:107], v[40:43], v[192:195], v[104:107]
    ds_read_b128 v[36:39], v3 offset:18432
    v_cvt_pk_bf16_f32 v94, v16, v17
    v_mfma_f32_16x16x32_bf16 v[104:107], v[44:47], v[196:199], v[104:107]
    v_add_f32 v8, v8, v18
    v_add_f32 v8, v8, v19
    v_mfma_f32_16x16x32_bf16 v[108:111], v[44:47], v[220:223], v[108:111]
    v_lshlrev_b32 v50, 16, v58
    v_cvt_pk_bf16_f32 v95, v18, v19
    v_mfma_f32_16x16x32_bf16 v[108:111], v[40:43], v[216:219], v[108:111]
    s_waitcnt lgkmcnt(2)
    buffer_load_dwordx4 v4, s[4:7], s32 offen offset:1024 sc1 lds
    v_mfma_f32_16x16x32_bf16 v[176:179], v[24:27], a[192:195], v[128:131]
    ds_read_b128 v[40:43], v2 offset:12416
    v_and_b32 v51, s97, v58
    v_mfma_f32_16x16x32_bf16 v[176:179], v[28:31], a[196:199], v[176:179]
    s_mov_b32 s30, s29
    v_exp_f32 v16, v160
    v_mfma_f32_16x16x32_bf16 v[180:183], v[28:31], a[220:223], v[132:135]
    v_exp_f32 v17, v161
    v_mfma_f32_16x16x32_bf16 v[180:183], v[24:27], a[216:219], v[180:183]
    buffer_load_dwordx4 v4, s[4:7], s32 offen offset:2048 sc1 lds
    v_mfma_f32_16x16x32_bf16 v[184:187], v[24:27], a[240:243], v[136:139]
    s_add_u32 s32, s32, 24576
    ds_read_b128 v[44:47], v3 offset:12416
    v_mul_f32 v48, s38, v48
    v_mfma_f32_16x16x32_bf16 v[184:187], v[28:31], a[244:247], v[184:187]
    v_exp_f32 v18, v162
    v_mfma_f32_16x16x32_bf16 v[188:191], v[28:31], v[204:207], v[140:143]
    s_add_u32 s26, s26, 12288
    v_add_f32 v5, v5, v16
    v_add_f32 v5, v5, v17
    v_mfma_f32_16x16x32_bf16 v[188:191], v[24:27], v[200:203], v[188:191]
    s_waitcnt lgkmcnt(2)
    v_exp_f32 v19, v163
    v_mfma_f32_16x16x32_bf16 v[112:115], v[32:35], a[192:195], v[128:131]
    s_mov_b32 m0, s26
    ds_read_b128 v[24:27], v2 offset:18560
    v_mul_f32 v49, s38, v49
    v_mfma_f32_16x16x32_bf16 v[112:115], v[36:39], a[196:199], v[112:115]
    v_cvt_pk_bf16_f32 v160, v16, v17
    v_mul_f32_e64 v50, -v50, v48
    v_mfma_f32_16x16x32_bf16 v[116:119], v[36:39], a[220:223], v[132:135]
    v_exp_f32 v16, v96
    v_mfma_f32_16x16x32_bf16 v[116:119], v[32:35], a[216:219], v[116:119]
    v_add_f32 v5, v5, v18
    v_mul_f32_e64 v51, -v51, v49
    v_mfma_f32_16x16x32_bf16 v[120:123], v[32:35], a[240:243], v[136:139]
    ds_read_b128 v[28:31], v3 offset:18560
    v_add_f32 v5, v5, v19
    v_mfma_f32_16x16x32_bf16 v[120:123], v[36:39], a[244:247], v[120:123]
    buffer_load_dwordx4 v4, s[4:7], s32 offen offset:0 sc1 lds
    v_mfma_f32_16x16x32_bf16 v[124:127], v[36:39], v[204:207], v[140:143]
    v_exp_f32 v17, v97
    v_mfma_f32_16x16x32_bf16 v[124:127], v[32:35], v[200:203], v[124:127]
    s_waitcnt lgkmcnt(2)
    v_cvt_pk_bf16_f32 v161, v18, v19
    v_cvt_f32_i32 v224, v224
    v_mfma_f32_16x16x32_bf16 v[176:179], v[40:43], a[200:203], v[176:179]
    ds_read_b128 v[32:35], v2 offset:12544
    v_cvt_f32_i32 v225, v225
    v_mfma_f32_16x16x32_bf16 v[176:179], v[44:47], a[204:207], v[176:179]
    buffer_load_dwordx4 v4, s[4:7], s32 offen offset:1024 sc1 lds
    v_mfma_f32_16x16x32_bf16 v[180:183], v[44:47], a[228:231], v[180:183]
    v_exp_f32 v18, v98
    v_mfma_f32_16x16x32_bf16 v[180:183], v[40:43], a[224:227], v[180:183]
    v_add_f32 v5, v5, v16
    v_add_f32 v5, v5, v17
    v_mfma_f32_16x16x32_bf16 v[184:187], v[40:43], a[248:251], v[184:187]
    ds_read_b128 v[36:39], v3 offset:12544
    v_fma_f32 v224, v224, v48, v50
    v_mfma_f32_16x16x32_bf16 v[184:187], v[44:47], a[252:255], v[184:187]
    buffer_load_dwordx4 v4, s[4:7], s32 offen offset:2048 sc1 lds
    v_mfma_f32_16x16x32_bf16 v[188:191], v[44:47], v[212:215], v[188:191]
    v_exp_f32 v19, v99
    v_mfma_f32_16x16x32_bf16 v[188:191], v[40:43], v[208:211], v[188:191]
    s_waitcnt lgkmcnt(2)
    v_cvt_pk_bf16_f32 v162, v16, v17
    v_fma_f32 v225, v225, v49, v51
    v_mfma_f32_16x16x32_bf16 v[112:115], v[24:27], a[200:203], v[112:115]
    ds_read_b128 v[40:43], v2 offset:18688
    v_add_u32 v1, s3, v1
    v_mfma_f32_16x16x32_bf16 v[112:115], v[28:31], a[204:207], v[112:115]
    v_exp_f32 v16, v164
    v_mfma_f32_16x16x32_bf16 v[116:119], v[28:31], a[228:231], v[116:119]
    v_add_f32 v5, v5, v18
    v_add_f32 v5, v5, v19
    v_mfma_f32_16x16x32_bf16 v[116:119], v[24:27], a[224:227], v[116:119]
    s_add_u32 s32, s32, 24576
    v_exp_f32 v17, v165
    v_mfma_f32_16x16x32_bf16 v[120:123], v[24:27], a[248:251], v[120:123]
    s_add_u32 s26, s26, 36864
    ds_read_b128 v[44:47], v3 offset:18688
    v_cvt_pk_bf16_f32 v163, v18, v19
    v_mfma_f32_16x16x32_bf16 v[120:123], v[28:31], a[252:255], v[120:123]
    s_waitcnt lgkmcnt(2)
    v_exp_f32 v18, v166
    v_mfma_f32_16x16x32_bf16 v[124:127], v[28:31], v[212:215], v[124:127]
    s_waitcnt vmcnt(6)
    v_cvt_pk_bf16_f32 v224, v224, v225
    v_add_f32 v6, v6, v16
    v_mfma_f32_16x16x32_bf16 v[124:127], v[24:27], v[208:211], v[124:127]
    s_barrier
    v_mfma_f32_16x16x32_bf16 v[176:179], v[32:35], a[208:211], v[176:179]
    s_sub_u32 s57, s26, 147456
    ds_read_b128 v[24:27], v1 offset:0
    v_add_f32 v6, v6, v17
    v_mfma_f32_16x16x32_bf16 v[176:179], v[36:39], a[212:215], v[176:179]
    s_min_u32 s26, s26, s57
    v_exp_f32 v19, v167
    v_mfma_f32_16x16x32_bf16 v[180:183], v[36:39], a[236:239], v[180:183]
    v_cvt_f32_i32 v228, v228
    v_cvt_pk_bf16_f32 v164, v16, v17
    v_mfma_f32_16x16x32_bf16 v[180:183], v[32:35], a[232:235], v[180:183]
    v_cvt_f32_i32 v229, v229
    v_fma_f32 v228, v228, v48, v50
    v_mfma_f32_16x16x32_bf16 v[184:187], v[32:35], v[192:195], v[184:187]
    ds_read_b128 v[28:31], v1 offset:12288
    v_fma_f32 v229, v229, v49, v51
    v_mfma_f32_16x16x32_bf16 v[184:187], v[36:39], v[196:199], v[184:187]
    v_exp_f32 v16, v100
    v_mfma_f32_16x16x32_bf16 v[188:191], v[36:39], v[220:223], v[188:191]
    v_add_f32 v6, v6, v18
    v_add_f32 v6, v6, v19
    v_mfma_f32_16x16x32_bf16 v[188:191], v[32:35], v[216:219], v[188:191]
    s_waitcnt lgkmcnt(2)
    v_exp_f32 v17, v101
    v_mfma_f32_16x16x32_bf16 v[112:115], v[40:43], a[208:211], v[112:115]
    ds_read_b128 v[32:35], v1 offset:1024
    v_cvt_pk_bf16_f32 v165, v18, v19
    v_mfma_f32_16x16x32_bf16 v[112:115], v[44:47], a[212:215], v[112:115]
    v_exp_f32 v18, v102
    v_mfma_f32_16x16x32_bf16 v[116:119], v[44:47], a[236:239], v[116:119]
    v_cvt_pk_bf16_f32 v228, v228, v229
    v_add_u32 v0, 1, v0
    v_mfma_f32_16x16x32_bf16 v[116:119], v[40:43], a[232:235], v[116:119]
    buffer_store_dword v0, v13, s[20:23], 0 offen offset:32 sc1
    v_mfma_f32_16x16x32_bf16 v[120:123], v[40:43], v[192:195], v[120:123]
    ds_read_b128 v[36:39], v1 offset:13312
    v_add_f32 v6, v6, v16
    v_mfma_f32_16x16x32_bf16 v[120:123], v[44:47], v[196:199], v[120:123]
    v_add_f32 v6, v6, v17
    v_cvt_f32_i32 v232, v232
    v_mfma_f32_16x16x32_bf16 v[124:127], v[44:47], v[220:223], v[124:127]
    v_exp_f32 v19, v103
    v_mfma_f32_16x16x32_bf16 v[124:127], v[40:43], v[216:219], v[124:127]
    s_waitcnt lgkmcnt(2)
    v_cvt_pk_bf16_f32 v166, v16, v17
    v_add_f32 v6, v6, v18
    v_cvt_f32_i32 v233, v233
    v_add_f32 v6, v6, v19
    v_fma_f32 v232, v232, v48, v50
    v_cvt_pk_bf16_f32 v167, v18, v19
    v_fma_f32 v233, v233, v49, v51
    v_mfma_f32_16x16x32_bf16 a[0:3], v[64:67], v[24:27], a[0:3]
    s_mov_b32 m0, s26
    ds_read_b128 v[40:43], v1 offset:2048
    v_cvt_pk_bf16_f32 v232, v232, v233
    v_mfma_f32_16x16x32_bf16 a[0:3], v[80:83], v[28:31], a[0:3]
    buffer_load_dwordx2 v[60:61], v10, s[72:75], s36 offen offset:192
    v_mfma_f32_16x16x32_bf16 a[48:51], v[84:87], v[28:31], a[48:51]
    v_exp_f32 v16, v168
    v_mfma_f32_16x16x32_bf16 a[48:51], v[68:71], v[24:27], a[48:51]
    v_exp_f32 v17, v169
    v_mfma_f32_16x16x32_bf16 a[96:99], v[72:75], v[24:27], a[96:99]
    ds_read_b128 v[44:47], v1 offset:14336
    v_cvt_f32_i32 v236, v236
    v_mfma_f32_16x16x32_bf16 a[96:99], v[88:91], v[28:31], a[96:99]
    buffer_load_dwordx4 v4, s[4:7], s32 offen offset:0 sc1 lds
    v_mfma_f32_16x16x32_bf16 a[144:147], v[92:95], v[28:31], a[144:147]
    v_exp_f32 v18, v170
    v_mfma_f32_16x16x32_bf16 a[144:147], v[76:79], v[24:27], a[144:147]
    s_waitcnt lgkmcnt(2)
    v_add_f32 v7, v7, v16
    v_add_f32 v7, v7, v17
    v_mfma_f32_16x16x32_bf16 a[4:7], v[64:67], v[32:35], a[4:7]
    ds_read_b128 v[24:27], v1 offset:3072
    v_cvt_f32_i32 v237, v237
    v_mfma_f32_16x16x32_bf16 a[4:7], v[80:83], v[36:39], a[4:7]
    buffer_load_dwordx2 v[62:63], v10, s[76:79], s36 offen offset:192
    v_mfma_f32_16x16x32_bf16 a[52:55], v[84:87], v[36:39], a[52:55]
    v_exp_f32 v19, v171
    v_mfma_f32_16x16x32_bf16 a[52:55], v[68:71], v[32:35], a[52:55]
    v_cvt_pk_bf16_f32 v168, v16, v17
    v_fma_f32 v236, v236, v48, v50
    v_mfma_f32_16x16x32_bf16 a[100:103], v[72:75], v[32:35], a[100:103]
    ds_read_b128 v[28:31], v1 offset:15360
    v_fma_f32 v237, v237, v49, v51
    v_mfma_f32_16x16x32_bf16 a[100:103], v[88:91], v[36:39], a[100:103]
    buffer_load_dwordx4 v[240:243], v9, s[64:67], s33 offen offset:384 nt
    v_mfma_f32_16x16x32_bf16 a[148:151], v[92:95], v[36:39], a[148:151]
    v_exp_f32 v16, v104
    v_mfma_f32_16x16x32_bf16 a[148:151], v[76:79], v[32:35], a[148:151]
    s_waitcnt lgkmcnt(2)
    v_add_f32 v7, v7, v18
    v_add_f32 v7, v7, v19
    v_mfma_f32_16x16x32_bf16 a[8:11], v[64:67], v[40:43], a[8:11]
    ds_read_b128 v[32:35], v1 offset:4096
    v_cvt_pk_bf16_f32 v236, v236, v237
    v_mfma_f32_16x16x32_bf16 a[8:11], v[80:83], v[44:47], a[8:11]
    buffer_load_dwordx4 v4, s[4:7], s32 offen offset:1024 sc1 lds
    v_mfma_f32_16x16x32_bf16 a[56:59], v[84:87], v[44:47], a[56:59]
    v_exp_f32 v17, v105
    v_mfma_f32_16x16x32_bf16 a[56:59], v[68:71], v[40:43], a[56:59]
    v_cvt_pk_bf16_f32 v169, v18, v19
    v_lshlrev_b32 v48, 16, v57
    v_mfma_f32_16x16x32_bf16 a[104:107], v[72:75], v[40:43], a[104:107]
    ds_read_b128 v[36:39], v1 offset:16384
    v_mfma_f32_16x16x32_bf16 a[104:107], v[88:91], v[44:47], a[104:107]
    buffer_load_dwordx4 v[244:247], v9, s[64:67], s33 offen offset:1920 nt
    v_mfma_f32_16x16x32_bf16 a[152:155], v[92:95], v[44:47], a[152:155]
    v_exp_f32 v18, v106
    v_mfma_f32_16x16x32_bf16 a[152:155], v[76:79], v[40:43], a[152:155]
    s_waitcnt lgkmcnt(2)
    v_add_f32 v7, v7, v16
    v_add_f32 v7, v7, v17
    v_mfma_f32_16x16x32_bf16 a[12:15], v[64:67], v[24:27], a[12:15]
    ds_read_b128 v[40:43], v1 offset:5120
    v_and_b32 v49, s97, v57
    v_mfma_f32_16x16x32_bf16 a[12:15], v[80:83], v[28:31], a[12:15]
    buffer_load_dwordx4 v4, s[4:7], s32 offen offset:2048 sc1 lds
    v_mfma_f32_16x16x32_bf16 a[60:63], v[84:87], v[28:31], a[60:63]
    v_exp_f32 v19, v107
    v_mfma_f32_16x16x32_bf16 a[60:63], v[68:71], v[24:27], a[60:63]
    v_cvt_pk_bf16_f32 v170, v16, v17
    v_exp_f32 v16, v172
    v_mfma_f32_16x16x32_bf16 a[108:111], v[72:75], v[24:27], a[108:111]
    ds_read_b128 v[44:47], v1 offset:17408
    v_add_f32 v7, v7, v18
    v_mfma_f32_16x16x32_bf16 a[108:111], v[88:91], v[28:31], a[108:111]
    buffer_load_dwordx4 v[248:251], v9, s[64:67], s34 offen offset:384 nt
    v_add_f32 v7, v7, v19
    v_mfma_f32_16x16x32_bf16 a[156:159], v[92:95], v[28:31], a[156:159]
    s_add_u32 s29, s28, 49152
    v_exp_f32 v17, v173
    v_mfma_f32_16x16x32_bf16 a[156:159], v[76:79], v[24:27], a[156:159]
    s_waitcnt lgkmcnt(2)
    v_cvt_pk_bf16_f32 v171, v18, v19
    v_lshlrev_b32 v50, 16, v59
    v_mfma_f32_16x16x32_bf16 a[16:19], v[64:67], v[32:35], a[16:19]
    s_sub_u32 s3, s29, 147456
    ds_read_b128 v[24:27], v1 offset:6144
    v_and_b32 v51, s97, v59
    v_mfma_f32_16x16x32_bf16 a[16:19], v[80:83], v[36:39], a[16:19]
    s_add_u32 s32, s32, 24576
    buffer_load_dwordx4 v[252:255], v9, s[64:67], s34 offen offset:1920 nt
    v_mfma_f32_16x16x32_bf16 a[64:67], v[84:87], v[36:39], a[64:67]
    s_min_u32 s29, s29, s3
    v_exp_f32 v18, v174
    v_mfma_f32_16x16x32_bf16 a[64:67], v[68:71], v[32:35], a[64:67]
    v_add_f32 v8, v8, v16
    v_add_f32 v8, v8, v17
    v_mfma_f32_16x16x32_bf16 a[112:115], v[72:75], v[32:35], a[112:115]
    s_add_u32 s26, s26, 12288
    ds_read_b128 v[28:31], v1 offset:18432
    v_mul_f32 v48, s38, v48
    v_mfma_f32_16x16x32_bf16 a[112:115], v[88:91], v[36:39], a[112:115]
    v_exp_f32 v19, v175
    v_cvt_pk_bf16_f32 v172, v16, v17
    v_mfma_f32_16x16x32_bf16 a[160:163], v[92:95], v[36:39], a[160:163]
    v_exp_f32 v16, v108
    v_mfma_f32_16x16x32_bf16 a[160:163], v[76:79], v[32:35], a[160:163]
    s_waitcnt lgkmcnt(2)
    v_add_f32 v8, v8, v18
    v_add_f32 v8, v8, v19
    v_mfma_f32_16x16x32_bf16 a[20:23], v[64:67], v[40:43], a[20:23]
    s_sub_u32 s3, s29, s28
    ds_read_b128 v[32:35], v1 offset:7168
    v_mul_f32 v49, s38, v49
    v_mfma_f32_16x16x32_bf16 a[20:23], v[80:83], v[44:47], a[20:23]
L_pg6:
    s_cbranch_execz L_pg10
    v_exp_f32 v17, v109
    v_mfma_f32_16x16x32_bf16 a[68:71], v[84:87], v[44:47], a[68:71]
    s_mov_b32 m0, s26
    v_cvt_pk_bf16_f32 v173, v18, v19
    v_mul_f32_e64 v50, -v50, v48
    v_mfma_f32_16x16x32_bf16 a[68:71], v[68:71], v[40:43], a[68:71]
    v_exp_f32 v18, v110
    v_mfma_f32_16x16x32_bf16 a[116:119], v[72:75], v[40:43], a[116:119]
    ds_read_b128 v[36:39], v1 offset:19456
    v_add_f32 v8, v8, v16
    v_mfma_f32_16x16x32_bf16 a[116:119], v[88:91], v[44:47], a[116:119]
    v_add_f32 v8, v8, v17
    v_mul_f32_e64 v51, -v51, v49
    v_mfma_f32_16x16x32_bf16 a[164:167], v[92:95], v[44:47], a[164:167]
    s_mov_b32 s28, s29
    v_exp_f32 v19, v111
    v_mfma_f32_16x16x32_bf16 a[164:167], v[76:79], v[40:43], a[164:167]
    s_waitcnt lgkmcnt(2)
    v_cvt_pk_bf16_f32 v174, v16, v17
    v_add_f32 v8, v8, v18
    v_mfma_f32_16x16x32_bf16 a[24:27], v[64:67], v[24:27], a[24:27]
    ds_read_b128 v[40:43], v1 offset:8192
    v_add_f32 v8, v8, v19
    v_mfma_f32_16x16x32_bf16 a[24:27], v[80:83], v[28:31], a[24:27]
    v_cvt_pk_bf16_f32 v175, v18, v19
    v_cvt_f32_i32 v226, v226
    v_mfma_f32_16x16x32_bf16 a[72:75], v[84:87], v[28:31], a[72:75]
    v_exp_f32 v16, v176
    v_mfma_f32_16x16x32_bf16 a[72:75], v[68:71], v[24:27], a[72:75]
    buffer_load_dwordx4 v4, s[4:7], s32 offen offset:0 sc1 lds
    v_mfma_f32_16x16x32_bf16 a[120:123], v[72:75], v[24:27], a[120:123]
    ds_read_b128 v[44:47], v1 offset:20480
    v_mfma_f32_16x16x32_bf16 a[120:123], v[88:91], v[28:31], a[120:123]
    v_exp_f32 v17, v177
    v_mfma_f32_16x16x32_bf16 a[168:171], v[92:95], v[28:31], a[168:171]
    v_exp_f32 v18, v178
    v_mfma_f32_16x16x32_bf16 a[168:171], v[76:79], v[24:27], a[168:171]
    s_waitcnt lgkmcnt(2)
    v_add_f32 v5, v5, v16
    v_add_f32 v5, v5, v17
    v_mfma_f32_16x16x32_bf16 a[28:31], v[64:67], v[32:35], a[28:31]
    ds_read_b128 v[24:27], v1 offset:9216
    v_cvt_f32_i32 v227, v227
    v_mfma_f32_16x16x32_bf16 a[28:31], v[80:83], v[36:39], a[28:31]
    v_exp_f32 v19, v179
    v_mfma_f32_16x16x32_bf16 a[76:79], v[84:87], v[36:39], a[76:79]
    v_cvt_pk_bf16_f32 v176, v16, v17
    v_add_u32 v2, s3, v2
    v_mfma_f32_16x16x32_bf16 a[76:79], v[68:71], v[32:35], a[76:79]
    v_exp_f32 v16, v112
    v_mfma_f32_16x16x32_bf16 a[124:127], v[72:75], v[32:35], a[124:127]
    ds_read_b128 v[28:31], v1 offset:21504
    v_add_f32 v5, v5, v18
    v_mfma_f32_16x16x32_bf16 a[124:127], v[88:91], v[36:39], a[124:127]
    v_add_f32 v5, v5, v19
    v_fma_f32 v226, v226, v48, v50
    v_mfma_f32_16x16x32_bf16 a[172:175], v[92:95], v[36:39], a[172:175]
    v_exp_f32 v17, v113
    v_mfma_f32_16x16x32_bf16 a[172:175], v[76:79], v[32:35], a[172:175]
    s_waitcnt lgkmcnt(2)
    buffer_load_dwordx4 v4, s[4:7], s32 offen offset:1024 sc1 lds
    v_mfma_f32_16x16x32_bf16 a[32:35], v[64:67], v[40:43], a[32:35]
    ds_read_b128 v[32:35], v1 offset:10240
    v_cvt_pk_bf16_f32 v177, v18, v19
    v_mfma_f32_16x16x32_bf16 a[32:35], v[80:83], v[44:47], a[32:35]
    v_exp_f32 v18, v114
    v_mfma_f32_16x16x32_bf16 a[80:83], v[84:87], v[44:47], a[80:83]
    v_add_f32 v5, v5, v16
    v_add_f32 v5, v5, v17
    v_mfma_f32_16x16x32_bf16 a[80:83], v[68:71], v[40:43], a[80:83]
    v_exp_f32 v19, v115
    v_mfma_f32_16x16x32_bf16 a[128:131], v[72:75], v[40:43], a[128:131]
    ds_read_b128 v[36:39], v1 offset:22528
    v_cvt_pk_bf16_f32 v178, v16, v17
    v_mfma_f32_16x16x32_bf16 a[128:131], v[88:91], v[44:47], a[128:131]
    v_exp_f32 v16, v180
    v_mfma_f32_16x16x32_bf16 a[176:179], v[92:95], v[44:47], a[176:179]
    v_fma_f32 v227, v227, v49, v51
    v_add_u32 v3, s3, v3
    v_mfma_f32_16x16x32_bf16 a[176:179], v[76:79], v[40:43], a[176:179]
    s_waitcnt lgkmcnt(2)
    v_add_f32 v5, v5, v18
    v_add_f32 v5, v5, v19
    v_mfma_f32_16x16x32_bf16 a[36:39], v[64:67], v[24:27], a[36:39]
    ds_read_b128 v[40:43], v1 offset:11264
    v_cvt_pk_bf16_f32 v225, v226, v227
    v_mfma_f32_16x16x32_bf16 a[36:39], v[80:83], v[28:31], a[36:39]
    buffer_load_dwordx4 v4, s[4:7], s32 offen offset:2048 sc1 lds
    v_mfma_f32_16x16x32_bf16 a[84:87], v[84:87], v[28:31], a[84:87]
    v_exp_f32 v17, v181
    v_mfma_f32_16x16x32_bf16 a[84:87], v[68:71], v[24:27], a[84:87]
    v_cvt_pk_bf16_f32 v179, v18, v19
    v_cvt_f32_i32 v230, v230
    v_mfma_f32_16x16x32_bf16 a[132:135], v[72:75], v[24:27], a[132:135]
    ds_read_b128 v[44:47], v1 offset:23552
    v_cvt_f32_i32 v231, v231
    v_mfma_f32_16x16x32_bf16 a[132:135], v[88:91], v[28:31], a[132:135]
    s_waitcnt lgkmcnt(2)
    v_exp_f32 v18, v182
    v_mfma_f32_16x16x32_bf16 a[180:183], v[92:95], v[28:31], a[180:183]
    s_waitcnt vmcnt(13)
    v_add_f32 v6, v6, v16
    v_add_f32 v6, v6, v17
    v_mfma_f32_16x16x32_bf16 a[180:183], v[76:79], v[24:27], a[180:183]
    s_barrier
    v_mfma_f32_16x16x32_bf16 a[40:43], v[64:67], v[32:35], a[40:43]
    ds_read_b128 v[24:27], v2 offset:0
    v_fma_f32 v230, v230, v48, v50
    v_mfma_f32_16x16x32_bf16 a[40:43], v[80:83], v[36:39], a[40:43]
    v_exp_f32 v19, v183
    v_mfma_f32_16x16x32_bf16 a[88:91], v[84:87], v[36:39], a[88:91]
    v_cvt_pk_bf16_f32 v180, v16, v17
    v_fma_f32 v231, v231, v49, v51
    v_mfma_f32_16x16x32_bf16 a[88:91], v[68:71], v[32:35], a[88:91]
    v_exp_f32 v16, v116
    v_mfma_f32_16x16x32_bf16 a[136:139], v[72:75], v[32:35], a[136:139]
    ds_read_b128 v[28:31], v3 offset:0
    v_add_f32 v6, v6, v18
    v_mfma_f32_16x16x32_bf16 a[136:139], v[88:91], v[36:39], a[136:139]
    v_add_f32 v6, v6, v19
    v_cvt_pk_bf16_f32 v229, v230, v231
    v_mfma_f32_16x16x32_bf16 a[184:187], v[92:95], v[36:39], a[184:187]
    v_exp_f32 v17, v117
    v_mfma_f32_16x16x32_bf16 a[184:187], v[76:79], v[32:35], a[184:187]
    s_waitcnt lgkmcnt(2)
    v_cvt_pk_bf16_f32 v181, v18, v19
    v_mfma_f32_16x16x32_bf16 a[44:47], v[64:67], v[40:43], a[44:47]
    ds_read_b128 v[32:35], v2 offset:6144
    v_mfma_f32_16x16x32_bf16 a[44:47], v[80:83], v[44:47], a[44:47]
    v_exp_f32 v18, v118
    v_mfma_f32_16x16x32_bf16 a[92:95], v[84:87], v[44:47], a[92:95]
    v_add_f32 v6, v6, v16
    v_add_f32 v6, v6, v17
    v_mfma_f32_16x16x32_bf16 a[92:95], v[68:71], v[40:43], a[92:95]
    s_add_u32 s32, s32, 24576
    v_exp_f32 v19, v119
    v_mfma_f32_16x16x32_bf16 a[140:143], v[72:75], v[40:43], a[140:143]
    s_add_u32 s26, s26, 36864
    ds_read_b128 v[36:39], v3 offset:6144
    v_cvt_pk_bf16_f32 v182, v16, v17
    v_mfma_f32_16x16x32_bf16 a[140:143], v[88:91], v[44:47], a[140:143]
    s_sub_u32 s57, s26, 147456
    v_add_f32 v6, v6, v18
    v_add_f32 v6, v6, v19
    v_mfma_f32_16x16x32_bf16 a[188:191], v[92:95], v[44:47], a[188:191]
    s_min_u32 s26, s26, s57
    v_cvt_pk_bf16_f32 v183, v18, v19
    v_mfma_f32_16x16x32_bf16 a[188:191], v[76:79], v[40:43], a[188:191]
    s_waitcnt lgkmcnt(2)
    v_mfma_f32_16x16x32_bf16 v[64:67], v[24:27], a[192:195], v[128:131]
    ds_read_b128 v[40:43], v2 offset:128
    v_cvt_f32_i32 v234, v234
    v_mfma_f32_16x16x32_bf16 v[64:67], v[28:31], a[196:199], v[64:67]
    v_exp_f32 v16, v184
    v_mfma_f32_16x16x32_bf16 v[68:71], v[28:31], a[220:223], v[132:135]
    v_exp_f32 v17, v185
    v_mfma_f32_16x16x32_bf16 v[68:71], v[24:27], a[216:219], v[68:71]
    buffer_load_dword v52, v20, s[20:23], s44 offen sc1
    v_mfma_f32_16x16x32_bf16 v[72:75], v[24:27], a[240:243], v[136:139]
    ds_read_b128 v[44:47], v3 offset:128
    v_cvt_f32_i32 v235, v235
    v_mfma_f32_16x16x32_bf16 v[72:75], v[28:31], a[244:247], v[72:75]
    v_exp_f32 v18, v186
    v_mfma_f32_16x16x32_bf16 v[76:79], v[28:31], v[204:207], v[140:143]
    v_add_f32 v7, v7, v16
    v_add_f32 v7, v7, v17
    v_mfma_f32_16x16x32_bf16 v[76:79], v[24:27], v[200:203], v[76:79]
    s_waitcnt lgkmcnt(2)
    v_exp_f32 v19, v187
    v_mfma_f32_16x16x32_bf16 v[96:99], v[32:35], a[192:195], v[128:131]
    ds_read_b128 v[24:27], v2 offset:6272
    v_cvt_pk_bf16_f32 v184, v16, v17
    v_mfma_f32_16x16x32_bf16 v[96:99], v[36:39], a[196:199], v[96:99]
    v_exp_f32 v16, v120
    v_mfma_f32_16x16x32_bf16 v[100:103], v[36:39], a[220:223], v[132:135]
    v_add_f32 v7, v7, v18
    v_fma_f32 v234, v234, v48, v50
    v_mfma_f32_16x16x32_bf16 v[100:103], v[32:35], a[216:219], v[100:103]
    s_add_u32 s35, s35, 196608
    s_mov_b32 m0, s26
    v_add_f32 v7, v7, v19
    v_mfma_f32_16x16x32_bf16 v[104:107], v[32:35], a[240:243], v[136:139]
    s_add_u32 s16, s16, 196608
    ds_read_b128 v[28:31], v3 offset:6272
    v_fma_f32 v235, v235, v49, v51
    v_mfma_f32_16x16x32_bf16 v[104:107], v[36:39], a[244:247], v[104:107]
    s_add_u32 s17, s17, 196608
    buffer_load_dwordx4 v4, s[4:7], s32 offen offset:0 sc1 lds
    v_mfma_f32_16x16x32_bf16 v[108:111], v[36:39], v[204:207], v[140:143]
    v_exp_f32 v17, v121
    v_mfma_f32_16x16x32_bf16 v[108:111], v[32:35], v[200:203], v[108:111]
    s_waitcnt lgkmcnt(2)
    v_cvt_pk_bf16_f32 v185, v18, v19
    v_cvt_pk_bf16_f32 v233, v234, v235
    v_mfma_f32_16x16x32_bf16 v[64:67], v[40:43], a[200:203], v[64:67]
    s_add_u32 s37, s37, 512
    ds_read_b128 v[32:35], v2 offset:256
    v_mfma_f32_16x16x32_bf16 v[64:67], v[44:47], a[204:207], v[64:67]
    v_exp_f32 v18, v122
    v_mfma_f32_16x16x32_bf16 v[68:71], v[44:47], a[228:231], v[68:71]
    v_add_f32 v7, v7, v16
    v_add_f32 v7, v7, v17
    v_mfma_f32_16x16x32_bf16 v[68:71], v[40:43], a[224:227], v[68:71]
    v_exp_f32 v19, v123
    v_mfma_f32_16x16x32_bf16 v[72:75], v[40:43], a[248:251], v[72:75]
    ds_read_b128 v[36:39], v3 offset:256
    v_cvt_pk_bf16_f32 v186, v16, v17
    v_mfma_f32_16x16x32_bf16 v[72:75], v[44:47], a[252:255], v[72:75]
    buffer_load_dwordx4 v4, s[4:7], s32 offen offset:1024 sc1 lds
    v_mfma_f32_16x16x32_bf16 v[76:79], v[44:47], v[212:215], v[76:79]
    v_exp_f32 v16, v188
    v_mfma_f32_16x16x32_bf16 v[76:79], v[40:43], v[208:211], v[76:79]
    s_waitcnt lgkmcnt(2)
    v_add_f32 v7, v7, v18
    v_add_f32 v7, v7, v19
    v_mfma_f32_16x16x32_bf16 v[96:99], v[24:27], a[200:203], v[96:99]
    ds_read_b128 v[40:43], v2 offset:6400
    v_cvt_f32_i32 v238, v238
    v_mfma_f32_16x16x32_bf16 v[96:99], v[28:31], a[204:207], v[96:99]
    buffer_load_dwordx2 v[56:57], off, s[80:83], s37 offset:0
    v_mfma_f32_16x16x32_bf16 v[100:103], v[28:31], a[228:231], v[100:103]
    v_exp_f32 v17, v189
    v_mfma_f32_16x16x32_bf16 v[100:103], v[24:27], a[224:227], v[100:103]
    v_cvt_pk_bf16_f32 v187, v18, v19
    v_cvt_f32_i32 v239, v239
    v_mfma_f32_16x16x32_bf16 v[104:107], v[24:27], a[248:251], v[104:107]
    ds_read_b128 v[44:47], v3 offset:6400
    v_mfma_f32_16x16x32_bf16 v[104:107], v[28:31], a[252:255], v[104:107]
    buffer_load_dwordx2 v[58:59], off, s[84:87], s37 offset:0
    v_mfma_f32_16x16x32_bf16 v[108:111], v[28:31], v[212:215], v[108:111]
    s_add_u32 s29, s30, 49152
    v_exp_f32 v18, v190
    v_mfma_f32_16x16x32_bf16 v[108:111], v[24:27], v[208:211], v[108:111]
    s_waitcnt lgkmcnt(2)
    v_add_f32 v8, v8, v16
    v_add_f32 v8, v8, v17
    v_mfma_f32_16x16x32_bf16 v[64:67], v[32:35], a[208:211], v[64:67]
    s_sub_u32 s3, s29, 147456
    ds_read_b128 v[24:27], v2 offset:12288
    v_mfma_f32_16x16x32_bf16 v[64:67], v[36:39], a[212:215], v[64:67]
    s_min_u32 s29, s29, s3
    buffer_load_dwordx4 v4, s[4:7], s32 offen offset:2048 sc1 lds
    v_mfma_f32_16x16x32_bf16 v[68:71], v[36:39], a[236:239], v[68:71]
    v_exp_f32 v19, v191
    v_mfma_f32_16x16x32_bf16 v[68:71], v[32:35], a[232:235], v[68:71]
    v_cvt_pk_bf16_f32 v188, v16, v17
    v_fma_f32 v238, v238, v48, v50
    v_mfma_f32_16x16x32_bf16 v[72:75], v[32:35], v[192:195], v[72:75]
    ds_read_b128 v[28:31], v3 offset:12288
    v_mfma_f32_16x16x32_bf16 v[72:75], v[36:39], v[196:199], v[72:75]
    buffer_load_dwordx3 v[144:146], v12, s[68:71], s35 offen offset:0 nt
    v_mfma_f32_16x16x32_bf16 v[76:79], v[36:39], v[220:223], v[76:79]
    v_exp_f32 v16, v124
    v_mfma_f32_16x16x32_bf16 v[76:79], v[32:35], v[216:219], v[76:79]
    s_waitcnt lgkmcnt(2)
    v_add_f32 v8, v8, v18
    v_add_f32 v8, v8, v19
    v_mfma_f32_16x16x32_bf16 v[96:99], v[40:43], a[208:211], v[96:99]
    s_add_u32 s32, s32, 24576
    ds_read_b128 v[32:35], v2 offset:18432
    v_fma_f32 v239, v239, v49, v51
    v_mfma_f32_16x16x32_bf16 v[96:99], v[44:47], a[212:215], v[96:99]
    s_sub_u32 s3, s29, s30
    v_exp_f32 v17, v125
    v_mfma_f32_16x16x32_bf16 v[100:103], v[44:47], a[236:239], v[100:103]
    v_cvt_pk_bf16_f32 v189, v18, v19
    v_mfma_f32_16x16x32_bf16 v[100:103], v[40:43], a[232:235], v[100:103]
    v_exp_f32 v18, v126
    v_mfma_f32_16x16x32_bf16 v[104:107], v[40:43], v[192:195], v[104:107]
    s_add_u32 s26, s26, 12288
    ds_read_b128 v[36:39], v3 offset:18432
    v_add_f32 v8, v8, v16
    v_mfma_f32_16x16x32_bf16 v[104:107], v[44:47], v[196:199], v[104:107]
    buffer_load_dwordx3 v[148:150], v12, s[68:71], s35 offen offset:768 nt
    v_mfma_f32_16x16x32_bf16 v[108:111], v[44:47], v[220:223], v[108:111]
    v_add_f32 v8, v8, v17
    v_cvt_pk_bf16_f32 v237, v238, v239
    v_mfma_f32_16x16x32_bf16 v[108:111], v[40:43], v[216:219], v[108:111]
    s_waitcnt lgkmcnt(2)
    v_exp_f32 v19, v127
    v_mfma_f32_16x16x32_bf16 v[80:83], v[24:27], a[192:195], v[128:131]
    ds_read_b128 v[40:43], v2 offset:12416
    v_cvt_pk_bf16_f32 v190, v16, v17
    v_mfma_f32_16x16x32_bf16 v[80:83], v[28:31], a[196:199], v[80:83]
    s_mov_b32 m0, s26
    v_add_f32 v8, v8, v18
    v_add_f32 v8, v8, v19
    v_mfma_f32_16x16x32_bf16 v[84:87], v[28:31], a[220:223], v[132:135]
    s_mov_b32 s30, s29
    v_cvt_pk_bf16_f32 v191, v18, v19
    v_mfma_f32_16x16x32_bf16 v[84:87], v[24:27], a[216:219], v[84:87]
    v_exp_f32 v16, v64
    v_mfma_f32_16x16x32_bf16 v[88:91], v[24:27], a[240:243], v[136:139]
    ds_read_b128 v[44:47], v3 offset:12416
    v_mfma_f32_16x16x32_bf16 v[88:91], v[28:31], a[244:247], v[88:91]
    buffer_load_dwordx3 v[152:154], v12, s[68:71], s35 offen offset:1536 nt
    v_mfma_f32_16x16x32_bf16 v[92:95], v[28:31], v[204:207], v[140:143]
    v_exp_f32 v17, v65
    v_mfma_f32_16x16x32_bf16 v[92:95], v[24:27], v[200:203], v[92:95]
    s_waitcnt lgkmcnt(2)
    v_exp_f32 v18, v66
    v_mfma_f32_16x16x32_bf16 v[112:115], v[32:35], a[192:195], v[128:131]
    ds_read_b128 v[24:27], v2 offset:18560
    v_add_f32 v5, v5, v16
    v_mfma_f32_16x16x32_bf16 v[112:115], v[36:39], a[196:199], v[112:115]
    buffer_load_dwordx4 v4, s[4:7], s32 offen offset:0 sc1 lds
    v_mfma_f32_16x16x32_bf16 v[116:119], v[36:39], a[220:223], v[132:135]
    v_add_f32 v5, v5, v17
    v_add_u32 v1, s3, v1
    v_mfma_f32_16x16x32_bf16 v[116:119], v[32:35], a[216:219], v[116:119]
    v_exp_f32 v19, v67
    v_mfma_f32_16x16x32_bf16 v[120:123], v[32:35], a[240:243], v[136:139]
    ds_read_b128 v[28:31], v3 offset:18560
    v_cvt_pk_bf16_f32 v64, v16, v17
    v_mfma_f32_16x16x32_bf16 v[120:123], v[36:39], a[244:247], v[120:123]
    s_waitcnt vmcnt(13)
    buffer_load_dwordx3 v[156:158], v12, s[68:71], s35 offen offset:2304 nt
    v_mfma_f32_16x16x32_bf16 v[124:127], v[36:39], v[204:207], v[140:143]
    v_exp_f32 v16, v96
    v_mfma_f32_16x16x32_bf16 v[124:127], v[32:35], v[200:203], v[124:127]
    s_waitcnt lgkmcnt(2)
    v_add_f32 v5, v5, v18
    v_add_f32 v5, v5, v19
    v_mfma_f32_16x16x32_bf16 v[80:83], v[40:43], a[200:203], v[80:83]
    ds_read_b128 v[32:35], v2 offset:12544
    v_lshlrev_b32 v48, 16, v60
    v_mfma_f32_16x16x32_bf16 v[80:83], v[44:47], a[204:207], v[80:83]
    v_exp_f32 v17, v97
    v_mfma_f32_16x16x32_bf16 v[84:87], v[44:47], a[228:231], v[84:87]
    v_cvt_pk_bf16_f32 v65, v18, v19
    v_and_b32 v49, s97, v60
    v_mfma_f32_16x16x32_bf16 v[84:87], v[40:43], a[224:227], v[84:87]
    buffer_load_dwordx4 v4, s[4:7], s32 offen offset:1024 sc1 lds
    v_mfma_f32_16x16x32_bf16 v[88:91], v[40:43], a[248:251], v[88:91]
    ds_read_b128 v[36:39], v3 offset:12544
    v_lshlrev_b32 v50, 16, v62
    v_mfma_f32_16x16x32_bf16 v[88:91], v[44:47], a[252:255], v[88:91]
    v_exp_f32 v18, v98
    v_mfma_f32_16x16x32_bf16 v[92:95], v[44:47], v[212:215], v[92:95]
    v_add_f32 v5, v5, v16
    v_add_f32 v5, v5, v17
    v_mfma_f32_16x16x32_bf16 v[92:95], v[40:43], v[208:211], v[92:95]
    s_waitcnt lgkmcnt(2)
    v_exp_f32 v19, v99
    v_mfma_f32_16x16x32_bf16 v[112:115], v[24:27], a[200:203], v[112:115]
    ds_read_b128 v[40:43], v2 offset:18688
    v_cvt_pk_bf16_f32 v66, v16, v17
    v_mfma_f32_16x16x32_bf16 v[112:115], v[28:31], a[204:207], v[112:115]
    v_exp_f32 v16, v68
    v_mfma_f32_16x16x32_bf16 v[116:119], v[28:31], a[228:231], v[116:119]
    v_add_f32 v5, v5, v18
    v_add_f32 v5, v5, v19
    v_mfma_f32_16x16x32_bf16 v[116:119], v[24:27], a[224:227], v[116:119]
    v_exp_f32 v17, v69
    v_mfma_f32_16x16x32_bf16 v[120:123], v[24:27], a[248:251], v[120:123]
    ds_read_b128 v[44:47], v3 offset:18688
    v_cvt_pk_bf16_f32 v67, v18, v19
    v_mfma_f32_16x16x32_bf16 v[120:123], v[28:31], a[252:255], v[120:123]
    s_waitcnt lgkmcnt(2)
    buffer_load_dwordx4 v4, s[4:7], s32 offen offset:2048 sc1 lds
    v_mfma_f32_16x16x32_bf16 v[124:127], v[28:31], v[212:215], v[124:127]
    s_waitcnt vmcnt(13)
    v_exp_f32 v18, v70
    v_mfma_f32_16x16x32_bf16 v[124:127], v[24:27], v[208:211], v[124:127]
    s_barrier
    v_mfma_f32_16x16x32_bf16 v[80:83], v[32:35], a[208:211], v[80:83]
    ds_read_b128 v[24:27], v1 offset:0
    v_add_f32 v6, v6, v16
    v_mfma_f32_16x16x32_bf16 v[80:83], v[36:39], a[212:215], v[80:83]
    v_add_f32 v6, v6, v17
    v_and_b32 v51, s97, v62
    v_mfma_f32_16x16x32_bf16 v[84:87], v[36:39], a[236:239], v[84:87]
    v_exp_f32 v19, v71
    v_mfma_f32_16x16x32_bf16 v[84:87], v[32:35], a[232:235], v[84:87]
    v_cvt_pk_bf16_f32 v68, v16, v17
    v_mul_f32 v48, s38, v48
    v_mfma_f32_16x16x32_bf16 v[88:91], v[32:35], v[192:195], v[88:91]
    ds_read_b128 v[28:31], v1 offset:12288
    v_mul_f32 v49, s38, v49
    v_mfma_f32_16x16x32_bf16 v[88:91], v[36:39], v[196:199], v[88:91]
    v_exp_f32 v16, v100
    v_mfma_f32_16x16x32_bf16 v[92:95], v[36:39], v[220:223], v[92:95]
    v_add_f32 v6, v6, v18
    v_add_f32 v6, v6, v19
    v_mfma_f32_16x16x32_bf16 v[92:95], v[32:35], v[216:219], v[92:95]
    s_waitcnt lgkmcnt(2)
    v_exp_f32 v17, v101
    v_mfma_f32_16x16x32_bf16 v[112:115], v[40:43], a[208:211], v[112:115]
    ds_read_b128 v[32:35], v1 offset:1024
    v_cvt_pk_bf16_f32 v69, v18, v19
    v_mfma_f32_16x16x32_bf16 v[112:115], v[44:47], a[212:215], v[112:115]
    v_exp_f32 v18, v102
    v_mfma_f32_16x16x32_bf16 v[116:119], v[44:47], a[236:239], v[116:119]
    v_add_f32 v6, v6, v16
    v_add_f32 v6, v6, v17
    v_mfma_f32_16x16x32_bf16 v[116:119], v[40:43], a[232:235], v[116:119]
    v_exp_f32 v19, v103
    v_mfma_f32_16x16x32_bf16 v[120:123], v[40:43], v[192:195], v[120:123]
    ds_read_b128 v[36:39], v1 offset:13312
    v_cvt_pk_bf16_f32 v70, v16, v17
    v_mfma_f32_16x16x32_bf16 v[120:123], v[44:47], v[196:199], v[120:123]
    s_add_u32 s32, s32, 24576
    v_add_f32 v6, v6, v18
    s_add_u32 s26, s26, 36864
    v_mfma_f32_16x16x32_bf16 v[124:127], v[44:47], v[220:223], v[124:127]
    s_sub_u32 s57, s26, 147456
    v_add_f32 v6, v6, v19
    v_cvt_pk_bf16_f32 v71, v18, v19
    v_mfma_f32_16x16x32_bf16 v[124:127], v[40:43], v[216:219], v[124:127]
    s_waitcnt lgkmcnt(2)
    s_min_u32 s26, s26, s57
    v_mfma_f32_16x16x32_bf16 a[0:3], v[160:163], v[24:27], a[0:3]
    ds_read_b128 v[40:43], v1 offset:2048
    v_mul_f32_e64 v50, -v50, v48
    v_mfma_f32_16x16x32_bf16 a[0:3], v[176:179], v[28:31], a[0:3]
    s_waitcnt vmcnt(12)
    v_subrev_u32 v52, s92, v52
    v_cmp_lt_u32 vcc, 15, v52
    v_mfma_f32_16x16x32_bf16 a[48:51], v[180:183], v[28:31], a[48:51]
    v_exp_f32 v16, v72
    v_mfma_f32_16x16x32_bf16 a[48:51], v[164:167], v[24:27], a[48:51]
    v_exp_f32 v17, v73
    v_mfma_f32_16x16x32_bf16 a[96:99], v[168:171], v[24:27], a[96:99]
    s_and_b32 s59, vcc_lo, 0xff
    ds_read_b128 v[44:47], v1 offset:14336
    v_mul_f32_e64 v51, -v51, v49
    v_mfma_f32_16x16x32_bf16 a[96:99], v[184:187], v[28:31], a[96:99]
    s_cbranch_scc1 L_pollslow2
L_pollok2:
    v_mfma_f32_16x16x32_bf16 a[144:147], v[188:191], v[28:31], a[144:147]
    s_add_u32 s92, s92, 1
    v_exp_f32 v18, v74
    v_mfma_f32_16x16x32_bf16 a[144:147], v[172:175], v[24:27], a[144:147]
    s_waitcnt lgkmcnt(2)
    v_add_f32 v7, v7, v16
    v_add_f32 v7, v7, v17
    v_mfma_f32_16x16x32_bf16 a[4:7], v[160:163], v[32:35], a[4:7]
    s_mov_b32 m0, s56
    ds_read_b128 v[24:27], v1 offset:3072
    v_cvt_f32_i32 v240, v240
    v_mfma_f32_16x16x32_bf16 a[4:7], v[176:179], v[36:39], a[4:7]
    buffer_load_dwordx4 v4, s[4:7], s27 offen offset:0 sc1 lds
    v_mfma_f32_16x16x32_bf16 a[52:55], v[180:183], v[36:39], a[52:55]
    v_exp_f32 v19, v75
    v_mfma_f32_16x16x32_bf16 a[52:55], v[164:167], v[32:35], a[52:55]
    v_cvt_pk_bf16_f32 v72, v16, v17
    v_cvt_f32_i32 v241, v241
    v_mfma_f32_16x16x32_bf16 a[100:103], v[168:171], v[32:35], a[100:103]
    ds_read_b128 v[28:31], v1 offset:15360
    v_fma_f32 v240, v240, v48, v50
    v_mfma_f32_16x16x32_bf16 a[100:103], v[184:187], v[36:39], a[100:103]
    v_exp_f32 v16, v104
    v_mfma_f32_16x16x32_bf16 a[148:151], v[188:191], v[36:39], a[148:151]
    v_add_f32 v7, v7, v18
    v_add_f32 v7, v7, v19
    v_mfma_f32_16x16x32_bf16 a[148:151], v[172:175], v[32:35], a[148:151]
    s_waitcnt lgkmcnt(2)
    v_exp_f32 v17, v105
    v_mfma_f32_16x16x32_bf16 a[8:11], v[160:163], v[40:43], a[8:11]
    ds_read_b128 v[32:35], v1 offset:4096
    v_cvt_pk_bf16_f32 v73, v18, v19
    v_mfma_f32_16x16x32_bf16 a[8:11], v[176:179], v[44:47], a[8:11]
    buffer_load_dwordx4 v4, s[4:7], s27 offen offset:1024 sc1 lds
    v_mfma_f32_16x16x32_bf16 a[56:59], v[180:183], v[44:47], a[56:59]
    v_exp_f32 v18, v106
    v_mfma_f32_16x16x32_bf16 a[56:59], v[164:167], v[40:43], a[56:59]
    v_add_f32 v7, v7, v16
    v_fma_f32 v241, v241, v49, v51
    v_mfma_f32_16x16x32_bf16 a[104:107], v[168:171], v[40:43], a[104:107]
    ds_read_b128 v[36:39], v1 offset:16384
    v_add_f32 v7, v7, v17
    v_mfma_f32_16x16x32_bf16 a[104:107], v[184:187], v[44:47], a[104:107]
    v_exp_f32 v19, v107
    v_mfma_f32_16x16x32_bf16 a[152:155], v[188:191], v[44:47], a[152:155]
    v_cvt_pk_bf16_f32 v74, v16, v17
    v_cvt_pk_bf16_f32 v226, v240, v241
    v_mfma_f32_16x16x32_bf16 a[152:155], v[172:175], v[40:43], a[152:155]
    s_waitcnt lgkmcnt(2)
    v_exp_f32 v16, v76
    v_mfma_f32_16x16x32_bf16 a[12:15], v[160:163], v[24:27], a[12:15]
    ds_read_b128 v[40:43], v1 offset:5120
    v_add_f32 v7, v7, v18
    v_mfma_f32_16x16x32_bf16 a[12:15], v[176:179], v[28:31], a[12:15]
    buffer_load_dwordx4 v4, s[4:7], s27 offen offset:2048 sc1 lds
    v_mfma_f32_16x16x32_bf16 a[60:63], v[180:183], v[28:31], a[60:63]
    v_add_f32 v7, v7, v19
    v_cvt_f32_i32 v244, v244
    v_mfma_f32_16x16x32_bf16 a[60:63], v[164:167], v[24:27], a[60:63]
    v_exp_f32 v17, v77
    v_mfma_f32_16x16x32_bf16 a[108:111], v[168:171], v[24:27], a[108:111]
    ds_read_b128 v[44:47], v1 offset:17408
    v_cvt_pk_bf16_f32 v75, v18, v19
    v_mfma_f32_16x16x32_bf16 a[108:111], v[184:187], v[28:31], a[108:111]
    v_exp_f32 v18, v78
    v_mfma_f32_16x16x32_bf16 a[156:159], v[188:191], v[28:31], a[156:159]
    s_add_u32 s29, s28, 49152
    v_cvt_f32_i32 v245, v245
    v_fma_f32 v244, v244, v48, v50
    v_mfma_f32_16x16x32_bf16 a[156:159], v[172:175], v[24:27], a[156:159]
    s_waitcnt lgkmcnt(2)
    v_add_f32 v8, v8, v16
    v_add_f32 v8, v8, v17
    v_mfma_f32_16x16x32_bf16 a[16:19], v[160:163], v[32:35], a[16:19]
    s_sub_u32 s3, s29, 147456
    ds_read_b128 v[24:27], v1 offset:6144
    v_fma_f32 v245, v245, v49, v51
    v_mfma_f32_16x16x32_bf16 a[16:19], v[176:179], v[36:39], a[16:19]
    s_add_u32 s27, s27, 24576
    v_exp_f32 v19, v79
    v_mfma_f32_16x16x32_bf16 a[64:67], v[180:183], v[36:39], a[64:67]
    s_min_u32 s29, s29, s3
    v_cvt_pk_bf16_f32 v76, v16, v17
    v_cvt_pk_bf16_f32 v230, v244, v245
    v_mfma_f32_16x16x32_bf16 a[64:67], v[164:167], v[32:35], a[64:67]
    s_add_u32 s56, s56, 12288
    v_exp_f32 v16, v108
    v_mfma_f32_16x16x32_bf16 a[112:115], v[168:171], v[32:35], a[112:115]
    ds_read_b128 v[28:31], v1 offset:18432
    v_add_f32 v8, v8, v18
    v_mfma_f32_16x16x32_bf16 a[112:115], v[184:187], v[36:39], a[112:115]
    v_add_f32 v8, v8, v19
    v_cvt_f32_i32 v248, v248
    v_mfma_f32_16x16x32_bf16 a[160:163], v[188:191], v[36:39], a[160:163]
    v_exp_f32 v17, v109
    v_mfma_f32_16x16x32_bf16 a[160:163], v[172:175], v[32:35], a[160:163]
    s_waitcnt lgkmcnt(2)
    v_cvt_f32_i32 v249, v249
    v_cvt_pk_bf16_f32 v77, v18, v19
    v_mfma_f32_16x16x32_bf16 a[20:23], v[160:163], v[40:43], a[20:23]
    s_mov_b32 m0, s56
    ds_read_b128 v[32:35], v1 offset:7168
    v_fma_f32 v248, v248, v48, v50
    v_mfma_f32_16x16x32_bf16 a[20:23], v[176:179], v[44:47], a[20:23]
    s_sub_u32 s3, s29, s28
    v_exp_f32 v18, v110
    v_mfma_f32_16x16x32_bf16 a[68:71], v[180:183], v[44:47], a[68:71]
    v_add_f32 v8, v8, v16
    v_add_f32 v8, v8, v17
    v_mfma_f32_16x16x32_bf16 a[68:71], v[164:167], v[40:43], a[68:71]
    v_exp_f32 v19, v111
    v_mfma_f32_16x16x32_bf16 a[116:119], v[168:171], v[40:43], a[116:119]
    ds_read_b128 v[36:39], v1 offset:19456
    v_fma_f32 v249, v249, v49, v51
    v_mfma_f32_16x16x32_bf16 a[116:119], v[184:187], v[44:47], a[116:119]
    buffer_load_dwordx4 v4, s[4:7], s27 offen offset:0 sc1 lds
    v_mfma_f32_16x16x32_bf16 a[164:167], v[188:191], v[44:47], a[164:167]
    s_mov_b32 s28, s29
    v_cvt_pk_bf16_f32 v78, v16, v17
    v_add_f32 v8, v8, v18
    v_mfma_f32_16x16x32_bf16 a[164:167], v[172:175], v[40:43], a[164:167]
    s_waitcnt lgkmcnt(2)
    v_add_f32 v8, v8, v19
    v_cvt_pk_bf16_f32 v234, v248, v249
    v_mfma_f32_16x16x32_bf16 a[24:27], v[160:163], v[24:27], a[24:27]
    ds_read_b128 v[40:43], v1 offset:8192
    v_cvt_pk_bf16_f32 v79, v18, v19
    v_mfma_f32_16x16x32_bf16 a[24:27], v[176:179], v[28:31], a[24:27]
    v_exp_f32 v16, v80
    v_mfma_f32_16x16x32_bf16 a[72:75], v[180:183], v[28:31], a[72:75]
    v_cvt_f32_i32 v252, v252
    v_cvt_f32_i32 v253, v253
    v_mfma_f32_16x16x32_bf16 a[72:75], v[164:167], v[24:27], a[72:75]
    v_exp_f32 v17, v81
    v_mfma_f32_16x16x32_bf16 a[120:123], v[168:171], v[24:27], a[120:123]
    ds_read_b128 v[44:47], v1 offset:20480
    v_fma_f32 v252, v252, v48, v50
    v_mfma_f32_16x16x32_bf16 a[120:123], v[184:187], v[28:31], a[120:123]
    v_exp_f32 v18, v82
    v_mfma_f32_16x16x32_bf16 a[168:171], v[188:191], v[28:31], a[168:171]
    v_add_f32 v5, v5, v16
    v_add_f32 v5, v5, v17
    v_mfma_f32_16x16x32_bf16 a[168:171], v[172:175], v[24:27], a[168:171]
    s_waitcnt lgkmcnt(2)
    buffer_load_dwordx4 v4, s[4:7], s27 offen offset:1024 sc1 lds
    v_mfma_f32_16x16x32_bf16 a[28:31], v[160:163], v[32:35], a[28:31]
    ds_read_b128 v[24:27], v1 offset:9216
    v_fma_f32 v253, v253, v49, v51
    v_mfma_f32_16x16x32_bf16 a[28:31], v[176:179], v[36:39], a[28:31]
    v_exp_f32 v19, v83
    v_mfma_f32_16x16x32_bf16 a[76:79], v[180:183], v[36:39], a[76:79]
    v_cvt_pk_bf16_f32 v80, v16, v17
    v_cvt_pk_bf16_f32 v238, v252, v253
    v_mfma_f32_16x16x32_bf16 a[76:79], v[164:167], v[32:35], a[76:79]
    v_exp_f32 v16, v112
    v_mfma_f32_16x16x32_bf16 a[124:127], v[168:171], v[32:35], a[124:127]
    ds_read_b128 v[28:31], v1 offset:21504
    v_add_f32 v5, v5, v18
    v_mfma_f32_16x16x32_bf16 a[124:127], v[184:187], v[36:39], a[124:127]
    v_add_f32 v5, v5, v19
    v_lshlrev_b32 v48, 16, v61
    v_mfma_f32_16x16x32_bf16 a[172:175], v[188:191], v[36:39], a[172:175]
    v_exp_f32 v17, v113
    v_mfma_f32_16x16x32_bf16 a[172:175], v[172:175], v[32:35], a[172:175]
    s_waitcnt lgkmcnt(2)
    buffer_load_dwordx4 v4, s[4:7], s27 offen offset:2048 sc1 lds
    v_mfma_f32_16x16x32_bf16 a[32:35], v[160:163], v[40:43], a[32:35]
    ds_read_b128 v[32:35], v1 offset:10240
    v_cvt_pk_bf16_f32 v81, v18, v19
    v_mfma_f32_16x16x32_bf16 a[32:35], v[176:179], v[44:47], a[32:35]
    v_exp_f32 v18, v114
    v_mfma_f32_16x16x32_bf16 a[80:83], v[180:183], v[44:47], a[80:83]
    v_add_f32 v5, v5, v16
    v_and_b32 v49, s97, v61
    v_mfma_f32_16x16x32_bf16 a[80:83], v[164:167], v[40:43], a[80:83]
    v_add_f32 v5, v5, v17
    v_lshlrev_b32 v50, 16, v63
    v_mfma_f32_16x16x32_bf16 a[128:131], v[168:171], v[40:43], a[128:131]
    ds_read_b128 v[36:39], v1 offset:22528
    v_add_u32 v2, s3, v2
    v_mfma_f32_16x16x32_bf16 a[128:131], v[184:187], v[44:47], a[128:131]
    v_exp_f32 v19, v115
    v_mfma_f32_16x16x32_bf16 a[176:179], v[188:191], v[44:47], a[176:179]
    v_cvt_pk_bf16_f32 v82, v16, v17
    v_and_b32 v51, s97, v63
    v_mfma_f32_16x16x32_bf16 a[176:179], v[172:175], v[40:43], a[176:179]
    s_waitcnt lgkmcnt(2)
    v_exp_f32 v16, v84
    v_mfma_f32_16x16x32_bf16 a[36:39], v[160:163], v[24:27], a[36:39]
    ds_read_b128 v[40:43], v1 offset:11264
    v_add_f32 v5, v5, v18
    v_mfma_f32_16x16x32_bf16 a[36:39], v[176:179], v[28:31], a[36:39]
    v_add_f32 v5, v5, v19
    v_mul_f32 v48, s38, v48
    v_mfma_f32_16x16x32_bf16 a[84:87], v[180:183], v[28:31], a[84:87]
    v_exp_f32 v17, v85
    v_mfma_f32_16x16x32_bf16 a[84:87], v[164:167], v[24:27], a[84:87]
    s_add_u32 s27, s27, 24576
    v_add_u32 v3, s3, v3
    v_cvt_pk_bf16_f32 v83, v18, v19
    v_mfma_f32_16x16x32_bf16 a[132:135], v[168:171], v[24:27], a[132:135]
L_pg7:
    s_cbranch_execz L_pg11
    s_add_u32 s56, s56, 36864
    ds_read_b128 v[44:47], v1 offset:23552
    v_mul_f32 v49, s38, v49
    v_mfma_f32_16x16x32_bf16 a[132:135], v[184:187], v[28:31], a[132:135]
    s_sub_u32 s58, s56, 147456
    v_exp_f32 v18, v86
    v_mfma_f32_16x16x32_bf16 a[180:183], v[188:191], v[28:31], a[180:183]
    v_add_f32 v6, v6, v16
    v_add_f32 v6, v6, v17
    v_mfma_f32_16x16x32_bf16 a[180:183], v[172:175], v[24:27], a[180:183]
    s_waitcnt lgkmcnt(2)
    v_mul_f32_e64 v50, -v50, v48
    v_mul_f32_e64 v51, -v51, v49
    v_mfma_f32_16x16x32_bf16 a[40:43], v[160:163], v[32:35], a[40:43]
    s_min_u32 s56, s56, s58
    ds_read_b128 v[24:27], v2 offset:0
    v_cvt_f32_i32 v242, v242
    v_mfma_f32_16x16x32_bf16 a[40:43], v[176:179], v[36:39], a[40:43]
    v_exp_f32 v19, v87
    v_mfma_f32_16x16x32_bf16 a[88:91], v[180:183], v[36:39], a[88:91]
    v_cvt_pk_bf16_f32 v84, v16, v17
    v_cvt_f32_i32 v243, v243
    v_mfma_f32_16x16x32_bf16 a[88:91], v[164:167], v[32:35], a[88:91]
    v_exp_f32 v16, v116
    v_mfma_f32_16x16x32_bf16 a[136:139], v[168:171], v[32:35], a[136:139]
    ds_read_b128 v[28:31], v3 offset:0
    v_add_f32 v6, v6, v18
    v_mfma_f32_16x16x32_bf16 a[136:139], v[184:187], v[36:39], a[136:139]
    v_add_f32 v6, v6, v19
    v_fma_f32 v242, v242, v48, v50
    v_mfma_f32_16x16x32_bf16 a[184:187], v[188:191], v[36:39], a[184:187]
    v_exp_f32 v17, v117
    v_mfma_f32_16x16x32_bf16 a[184:187], v[172:175], v[32:35], a[184:187]
    s_waitcnt lgkmcnt(2)
    v_cvt_pk_bf16_f32 v85, v18, v19
    v_fma_f32 v243, v243, v49, v51
    v_mfma_f32_16x16x32_bf16 a[44:47], v[160:163], v[40:43], a[44:47]
    ds_read_b128 v[32:35], v2 offset:6144
    v_cvt_pk_bf16_f32 v227, v242, v243
    v_mfma_f32_16x16x32_bf16 a[44:47], v[176:179], v[44:47], a[44:47]
    v_exp_f32 v18, v118
    v_mfma_f32_16x16x32_bf16 a[92:95], v[180:183], v[44:47], a[92:95]
    v_add_f32 v6, v6, v16
    v_add_f32 v6, v6, v17
    v_mfma_f32_16x16x32_bf16 a[92:95], v[164:167], v[40:43], a[92:95]
    v_exp_f32 v19, v119
    v_mfma_f32_16x16x32_bf16 a[140:143], v[168:171], v[40:43], a[140:143]
    s_sub_u32 s31, s31, 1
    ds_read_b128 v[36:39], v3 offset:6144
    v_cvt_pk_bf16_f32 v86, v16, v17
    v_mfma_f32_16x16x32_bf16 a[140:143], v[184:187], v[44:47], a[140:143]
    v_add_f32 v6, v6, v18
    v_add_f32 v6, v6, v19
    v_mfma_f32_16x16x32_bf16 a[188:191], v[188:191], v[44:47], a[188:191]
    s_waitcnt lgkmcnt(2)
    s_cmp_lg_u32 s31, 0
    v_cvt_pk_bf16_f32 v87, v18, v19
    v_cvt_f32_i32 v246, v246
    v_mfma_f32_16x16x32_bf16 a[188:191], v[172:175], v[40:43], a[188:191]
    s_cbranch_scc1 L_loop
    v_mfma_f32_16x16x32_bf16 v[160:163], v[24:27], a[192:195], v[128:131]
    s_mov_b32 m0, s56
    ds_read_b128 v[40:43], v2 offset:128
    v_cvt_f32_i32 v247, v247
    v_mfma_f32_16x16x32_bf16 v[160:163], v[28:31], a[196:199], v[160:163]
    buffer_load_dwordx4 v4, s[4:7], s27 offen offset:0 sc1 lds
    v_mfma_f32_16x16x32_bf16 v[164:167], v[28:31], a[220:223], v[132:135]
    v_exp_f32 v16, v88
    v_mfma_f32_16x16x32_bf16 v[164:167], v[24:27], a[216:219], v[164:167]
    v_exp_f32 v17, v89
    v_mfma_f32_16x16x32_bf16 v[168:171], v[24:27], a[240:243], v[136:139]
    ds_read_b128 v[44:47], v3 offset:128
    v_fma_f32 v246, v246, v48, v50
    v_mfma_f32_16x16x32_bf16 v[168:171], v[28:31], a[244:247], v[168:171]
    v_exp_f32 v18, v90
    v_mfma_f32_16x16x32_bf16 v[172:175], v[28:31], v[204:207], v[140:143]
    v_fma_f32 v247, v247, v49, v51
    v_add_f32 v7, v7, v16
    v_mfma_f32_16x16x32_bf16 v[172:175], v[24:27], v[200:203], v[172:175]
    s_waitcnt lgkmcnt(2)
    v_add_f32 v7, v7, v17
    v_cvt_pk_bf16_f32 v231, v246, v247
    v_mfma_f32_16x16x32_bf16 v[96:99], v[32:35], a[192:195], v[128:131]
    ds_read_b128 v[24:27], v2 offset:6272
    v_cvt_f32_i32 v250, v250
    v_mfma_f32_16x16x32_bf16 v[96:99], v[36:39], a[196:199], v[96:99]
    buffer_load_dwordx4 v4, s[4:7], s27 offen offset:1024 sc1 lds
    v_mfma_f32_16x16x32_bf16 v[100:103], v[36:39], a[220:223], v[132:135]
    v_exp_f32 v19, v91
    v_mfma_f32_16x16x32_bf16 v[100:103], v[32:35], a[216:219], v[100:103]
    v_cvt_pk_bf16_f32 v88, v16, v17
    v_cvt_f32_i32 v251, v251
    v_mfma_f32_16x16x32_bf16 v[104:107], v[32:35], a[240:243], v[136:139]
    ds_read_b128 v[28:31], v3 offset:6272
    v_fma_f32 v250, v250, v48, v50
    v_mfma_f32_16x16x32_bf16 v[104:107], v[36:39], a[244:247], v[104:107]
    v_exp_f32 v16, v120
    v_mfma_f32_16x16x32_bf16 v[108:111], v[36:39], v[204:207], v[140:143]
    v_add_f32 v7, v7, v18
    v_add_f32 v7, v7, v19
    v_mfma_f32_16x16x32_bf16 v[108:111], v[32:35], v[200:203], v[108:111]
    s_waitcnt lgkmcnt(2)
    v_exp_f32 v17, v121
    v_mfma_f32_16x16x32_bf16 v[160:163], v[40:43], a[200:203], v[160:163]
    ds_read_b128 v[32:35], v2 offset:256
    v_cvt_pk_bf16_f32 v89, v18, v19
    v_mfma_f32_16x16x32_bf16 v[160:163], v[44:47], a[204:207], v[160:163]
    v_exp_f32 v18, v122
    v_mfma_f32_16x16x32_bf16 v[164:167], v[44:47], a[228:231], v[164:167]
    v_fma_f32 v251, v251, v49, v51
    v_add_f32 v7, v7, v16
    v_mfma_f32_16x16x32_bf16 v[164:167], v[40:43], a[224:227], v[164:167]
    buffer_load_dwordx4 v4, s[4:7], s27 offen offset:2048 sc1 lds
    v_mfma_f32_16x16x32_bf16 v[168:171], v[40:43], a[248:251], v[168:171]
    ds_read_b128 v[36:39], v3 offset:256
    v_cvt_pk_bf16_f32 v235, v250, v251
    v_mfma_f32_16x16x32_bf16 v[168:171], v[44:47], a[252:255], v[168:171]
    v_add_f32 v7, v7, v17
    v_cvt_f32_i32 v254, v254
    v_mfma_f32_16x16x32_bf16 v[172:175], v[44:47], v[212:215], v[172:175]
    v_exp_f32 v19, v123
    v_mfma_f32_16x16x32_bf16 v[172:175], v[40:43], v[208:211], v[172:175]
    s_waitcnt lgkmcnt(2)
    v_cvt_pk_bf16_f32 v90, v16, v17
    v_cvt_f32_i32 v255, v255
    v_mfma_f32_16x16x32_bf16 v[96:99], v[24:27], a[200:203], v[96:99]
    ds_read_b128 v[40:43], v2 offset:6400
    v_fma_f32 v254, v254, v48, v50
    v_mfma_f32_16x16x32_bf16 v[96:99], v[28:31], a[204:207], v[96:99]
    s_add_u32 s27, s27, 24576
    v_exp_f32 v16, v92
    v_mfma_f32_16x16x32_bf16 v[100:103], v[28:31], a[228:231], v[100:103]
    v_add_f32 v7, v7, v18
    v_add_f32 v7, v7, v19
    v_mfma_f32_16x16x32_bf16 v[100:103], v[24:27], a[224:227], v[100:103]
    v_exp_f32 v17, v93
    v_mfma_f32_16x16x32_bf16 v[104:107], v[24:27], a[248:251], v[104:107]
    ds_read_b128 v[44:47], v3 offset:6400
    v_fma_f32 v255, v255, v49, v51
    v_mfma_f32_16x16x32_bf16 v[104:107], v[28:31], a[252:255], v[104:107]
    v_cvt_pk_bf16_f32 v91, v18, v19
    v_cvt_pk_bf16_f32 v239, v254, v255
    v_mfma_f32_16x16x32_bf16 v[108:111], v[28:31], v[212:215], v[108:111]
    s_add_u32 s29, s30, 49152
    v_exp_f32 v18, v94
    v_mfma_f32_16x16x32_bf16 v[108:111], v[24:27], v[208:211], v[108:111]
    s_waitcnt lgkmcnt(2)
    v_add_f32 v8, v8, v16
    v_add_f32 v8, v8, v17
    v_mfma_f32_16x16x32_bf16 v[160:163], v[32:35], a[208:211], v[160:163]
    s_waitcnt vmcnt(11)
    ds_read_b128 v[24:27], v2 offset:12288
    v_lshlrev_b32 v48, 16, v56
    v_mfma_f32_16x16x32_bf16 v[160:163], v[36:39], a[212:215], v[160:163]
    s_sub_u32 s3, s29, 147456
    buffer_load_dwordx2 v[60:61], off, s[80:83], s37 offset:8
    v_mfma_f32_16x16x32_bf16 v[164:167], v[36:39], a[236:239], v[164:167]
    s_add_u32 s56, s56, 12288
    v_exp_f32 v19, v95
    v_mfma_f32_16x16x32_bf16 v[164:167], v[32:35], a[232:235], v[164:167]
    s_min_u32 s29, s29, s3
    v_cvt_pk_bf16_f32 v92, v16, v17
    v_and_b32 v49, s97, v56
    v_mfma_f32_16x16x32_bf16 v[168:171], v[32:35], v[192:195], v[168:171]
    s_mov_b32 m0, s56
    ds_read_b128 v[28:31], v3 offset:12288
    v_mfma_f32_16x16x32_bf16 v[168:171], v[36:39], v[196:199], v[168:171]
    buffer_load_dwordx2 v[62:63], off, s[84:87], s37 offset:8
    v_mfma_f32_16x16x32_bf16 v[172:175], v[36:39], v[220:223], v[172:175]
    v_exp_f32 v16, v124
    v_mfma_f32_16x16x32_bf16 v[172:175], v[32:35], v[216:219], v[172:175]
    s_waitcnt lgkmcnt(2)
    v_add_f32 v8, v8, v18
    v_add_f32 v8, v8, v19
    v_mfma_f32_16x16x32_bf16 v[96:99], v[40:43], a[208:211], v[96:99]
    ds_read_b128 v[32:35], v2 offset:18432
    v_lshlrev_b32 v50, 16, v58
    v_mfma_f32_16x16x32_bf16 v[96:99], v[44:47], a[212:215], v[96:99]
    s_sub_u32 s3, s29, s30
    v_exp_f32 v17, v125
    v_mfma_f32_16x16x32_bf16 v[100:103], v[44:47], a[236:239], v[100:103]
    v_cvt_pk_bf16_f32 v93, v18, v19
    v_mfma_f32_16x16x32_bf16 v[100:103], v[40:43], a[232:235], v[100:103]
    buffer_load_dwordx4 v4, s[4:7], s27 offen offset:0 sc1 lds
    v_mfma_f32_16x16x32_bf16 v[104:107], v[40:43], v[192:195], v[104:107]
    ds_read_b128 v[36:39], v3 offset:18432
    v_mfma_f32_16x16x32_bf16 v[104:107], v[44:47], v[196:199], v[104:107]
    v_exp_f32 v18, v126
    v_mfma_f32_16x16x32_bf16 v[108:111], v[44:47], v[220:223], v[108:111]
    v_add_f32 v8, v8, v16
    v_add_f32 v8, v8, v17
    v_mfma_f32_16x16x32_bf16 v[108:111], v[40:43], v[216:219], v[108:111]
    s_waitcnt lgkmcnt(2)
    buffer_load_dwordx3 v[240:242], v12, s[68:71], s16 offen offset:0 nt
    v_mfma_f32_16x16x32_bf16 v[176:179], v[24:27], a[192:195], v[128:131]
    ds_read_b128 v[40:43], v2 offset:12416
    v_and_b32 v51, s97, v58
    v_mfma_f32_16x16x32_bf16 v[176:179], v[28:31], a[196:199], v[176:179]
    v_exp_f32 v19, v127
    v_cvt_pk_bf16_f32 v94, v16, v17
    v_mfma_f32_16x16x32_bf16 v[180:183], v[28:31], a[220:223], v[132:135]
    s_mov_b32 s30, s29
    v_add_f32 v8, v8, v18
    v_add_f32 v8, v8, v19
    v_mfma_f32_16x16x32_bf16 v[180:183], v[24:27], a[216:219], v[180:183]
    buffer_load_dwordx4 v4, s[4:7], s27 offen offset:1024 sc1 lds
    v_mfma_f32_16x16x32_bf16 v[184:187], v[24:27], a[240:243], v[136:139]
    ds_read_b128 v[44:47], v3 offset:12416
    v_cvt_pk_bf16_f32 v95, v18, v19
    v_mfma_f32_16x16x32_bf16 v[184:187], v[28:31], a[244:247], v[184:187]
    v_exp_f32 v16, v160
    v_mfma_f32_16x16x32_bf16 v[188:191], v[28:31], v[204:207], v[140:143]
    v_exp_f32 v17, v161
    v_mfma_f32_16x16x32_bf16 v[188:191], v[24:27], v[200:203], v[188:191]
    s_waitcnt lgkmcnt(2)
    buffer_load_dwordx3 v[244:246], v12, s[68:71], s16 offen offset:768 nt
    v_mfma_f32_16x16x32_bf16 v[112:115], v[32:35], a[192:195], v[128:131]
    ds_read_b128 v[24:27], v2 offset:18560
    v_mul_f32_e64 v50, -v50, v48
    v_mfma_f32_16x16x32_bf16 v[112:115], v[36:39], a[196:199], v[112:115]
    v_exp_f32 v18, v162
    v_mfma_f32_16x16x32_bf16 v[116:119], v[36:39], a[220:223], v[132:135]
    v_add_f32 v5, v5, v16
    v_add_f32 v5, v5, v17
    v_mfma_f32_16x16x32_bf16 v[116:119], v[32:35], a[216:219], v[116:119]
    v_exp_f32 v19, v163
    v_mfma_f32_16x16x32_bf16 v[120:123], v[32:35], a[240:243], v[136:139]
    ds_read_b128 v[28:31], v3 offset:18560
    v_cvt_pk_bf16_f32 v160, v16, v17
    v_mfma_f32_16x16x32_bf16 v[120:123], v[36:39], a[244:247], v[120:123]
    buffer_load_dwordx3 v[248:250], v12, s[68:71], s16 offen offset:1536 nt
    v_mfma_f32_16x16x32_bf16 v[124:127], v[36:39], v[204:207], v[140:143]
    v_exp_f32 v16, v96
    v_mfma_f32_16x16x32_bf16 v[124:127], v[32:35], v[200:203], v[124:127]
    s_waitcnt lgkmcnt(2)
    v_add_f32 v5, v5, v18
    v_add_f32 v5, v5, v19
    v_mfma_f32_16x16x32_bf16 v[176:179], v[40:43], a[200:203], v[176:179]
    ds_read_b128 v[32:35], v2 offset:12544
    v_mul_f32_e64 v51, -v51, v49
    v_mfma_f32_16x16x32_bf16 v[176:179], v[44:47], a[204:207], v[176:179]
    buffer_load_dwordx4 v4, s[4:7], s27 offen offset:2048 sc1 lds
    v_mfma_f32_16x16x32_bf16 v[180:183], v[44:47], a[228:231], v[180:183]
    v_exp_f32 v17, v97
    v_mfma_f32_16x16x32_bf16 v[180:183], v[40:43], a[224:227], v[180:183]
    v_cvt_pk_bf16_f32 v161, v18, v19
    v_add_u32 v1, s3, v1
    v_mfma_f32_16x16x32_bf16 v[184:187], v[40:43], a[248:251], v[184:187]
    ds_read_b128 v[36:39], v3 offset:12544
    v_cvt_f32_i32 v144, v144
    v_mfma_f32_16x16x32_bf16 v[184:187], v[44:47], a[252:255], v[184:187]
    buffer_load_dwordx3 v[252:254], v12, s[68:71], s16 offen offset:2304 nt
    v_mfma_f32_16x16x32_bf16 v[188:191], v[44:47], v[212:215], v[188:191]
    v_exp_f32 v18, v98
    v_mfma_f32_16x16x32_bf16 v[188:191], v[40:43], v[208:211], v[188:191]
    s_waitcnt lgkmcnt(2)
    v_add_f32 v5, v5, v16
    v_add_f32 v5, v5, v17
    v_mfma_f32_16x16x32_bf16 v[112:115], v[24:27], a[200:203], v[112:115]
    ds_read_b128 v[40:43], v2 offset:18688
    v_cvt_f32_i32 v148, v148
    v_mfma_f32_16x16x32_bf16 v[112:115], v[28:31], a[204:207], v[112:115]
    v_exp_f32 v19, v99
    v_cvt_pk_bf16_f32 v162, v16, v17
    v_mfma_f32_16x16x32_bf16 v[116:119], v[28:31], a[228:231], v[116:119]
    v_exp_f32 v16, v164
    v_mfma_f32_16x16x32_bf16 v[116:119], v[24:27], a[224:227], v[116:119]
    s_add_u32 s27, s27, 24576
    v_add_f32 v5, v5, v18
    v_add_f32 v5, v5, v19
    v_mfma_f32_16x16x32_bf16 v[120:123], v[24:27], a[248:251], v[120:123]
    s_add_u32 s56, s56, 36864
    ds_read_b128 v[44:47], v3 offset:18688
    v_fma_f32 v144, v144, v48, v50
    v_mfma_f32_16x16x32_bf16 v[120:123], v[28:31], a[252:255], v[120:123]
    s_waitcnt lgkmcnt(2)
    v_exp_f32 v17, v165
    v_mfma_f32_16x16x32_bf16 v[124:127], v[28:31], v[212:215], v[124:127]
    s_waitcnt vmcnt(12)
    v_cvt_pk_bf16_f32 v163, v18, v19
    s_sub_u32 s58, s56, 147456
    v_mfma_f32_16x16x32_bf16 v[124:127], v[24:27], v[208:211], v[124:127]
    s_barrier
    v_mfma_f32_16x16x32_bf16 v[176:179], v[32:35], a[208:211], v[176:179]
    s_min_u32 s56, s56, s58
    ds_read_b128 v[24:27], v1 offset:0
    v_mfma_f32_16x16x32_bf16 v[176:179], v[36:39], a[212:215], v[176:179]
    v_exp_f32 v18, v166
    v_mfma_f32_16x16x32_bf16 v[180:183], v[36:39], a[236:239], v[180:183]
    v_add_f32 v6, v6, v16
    v_add_f32 v6, v6, v17
    v_mfma_f32_16x16x32_bf16 v[180:183], v[32:35], a[232:235], v[180:183]
    v_exp_f32 v19, v167
    v_mfma_f32_16x16x32_bf16 v[184:187], v[32:35], v[192:195], v[184:187]
    ds_read_b128 v[28:31], v1 offset:12288
    v_cvt_pk_bf16_f32 v164, v16, v17
    v_mfma_f32_16x16x32_bf16 v[184:187], v[36:39], v[196:199], v[184:187]
    v_exp_f32 v16, v100
    v_mfma_f32_16x16x32_bf16 v[188:191], v[36:39], v[220:223], v[188:191]
    v_add_f32 v6, v6, v18
    v_add_f32 v6, v6, v19
    v_mfma_f32_16x16x32_bf16 v[188:191], v[32:35], v[216:219], v[188:191]
    s_waitcnt lgkmcnt(2)
    v_exp_f32 v17, v101
    v_mfma_f32_16x16x32_bf16 v[112:115], v[40:43], a[208:211], v[112:115]
    ds_read_b128 v[32:35], v1 offset:1024
    v_cvt_pk_bf16_f32 v165, v18, v19
    v_mfma_f32_16x16x32_bf16 v[112:115], v[44:47], a[212:215], v[112:115]
    v_exp_f32 v18, v102
    v_mfma_f32_16x16x32_bf16 v[116:119], v[44:47], a[236:239], v[116:119]
    v_add_f32 v6, v6, v16
    v_add_f32 v6, v6, v17
    v_mfma_f32_16x16x32_bf16 v[116:119], v[40:43], a[232:235], v[116:119]
    v_exp_f32 v19, v103
    v_mfma_f32_16x16x32_bf16 v[120:123], v[40:43], v[192:195], v[120:123]
    ds_read_b128 v[36:39], v1 offset:13312
    v_cvt_pk_bf16_f32 v166, v16, v17
    v_mfma_f32_16x16x32_bf16 v[120:123], v[44:47], v[196:199], v[120:123]
    v_add_f32 v6, v6, v18
    v_fma_f32 v148, v148, v49, v51
    v_mfma_f32_16x16x32_bf16 v[124:127], v[44:47], v[220:223], v[124:127]
    v_add_f32 v6, v6, v19
    v_cvt_pk_bf16_f32 v167, v18, v19
    v_mfma_f32_16x16x32_bf16 v[124:127], v[40:43], v[216:219], v[124:127]
    s_waitcnt lgkmcnt(2)
    v_mfma_f32_16x16x32_bf16 a[0:3], v[64:67], v[24:27], a[0:3]
    ds_read_b128 v[40:43], v1 offset:2048
    v_cvt_f32_i32 v145, v145
    v_mfma_f32_16x16x32_bf16 a[0:3], v[80:83], v[28:31], a[0:3]
    buffer_store_dwordx4 v[224:227], v11, s[4:7], s33 offen offset:0 sc1
    v_mfma_f32_16x16x32_bf16 a[48:51], v[84:87], v[28:31], a[48:51]
    v_exp_f32 v16, v168
    v_mfma_f32_16x16x32_bf16 a[48:51], v[68:71], v[24:27], a[48:51]
    v_exp_f32 v17, v169
    v_mfma_f32_16x16x32_bf16 a[96:99], v[72:75], v[24:27], a[96:99]
    ds_read_b128 v[44:47], v1 offset:14336
    v_cvt_f32_i32 v149, v149
    v_mfma_f32_16x16x32_bf16 a[96:99], v[88:91], v[28:31], a[96:99]
    v_exp_f32 v18, v170
    v_mfma_f32_16x16x32_bf16 a[144:147], v[92:95], v[28:31], a[144:147]
    v_add_f32 v7, v7, v16
    v_add_f32 v7, v7, v17
    v_mfma_f32_16x16x32_bf16 a[144:147], v[76:79], v[24:27], a[144:147]
    s_waitcnt lgkmcnt(2)
    v_exp_f32 v19, v171
    v_mfma_f32_16x16x32_bf16 a[4:7], v[64:67], v[32:35], a[4:7]
    ds_read_b128 v[24:27], v1 offset:3072
    v_cvt_pk_bf16_f32 v168, v16, v17
    v_mfma_f32_16x16x32_bf16 a[4:7], v[80:83], v[36:39], a[4:7]
    buffer_store_dwordx4 v[228:231], v21, s[4:7], s33 offen offset:768 sc1
    v_mfma_f32_16x16x32_bf16 a[52:55], v[84:87], v[36:39], a[52:55]
    v_exp_f32 v16, v104
    v_mfma_f32_16x16x32_bf16 a[52:55], v[68:71], v[32:35], a[52:55]
    v_add_f32 v7, v7, v18
    v_fma_f32 v145, v145, v48, v50
    v_mfma_f32_16x16x32_bf16 a[100:103], v[72:75], v[32:35], a[100:103]
    ds_read_b128 v[28:31], v1 offset:15360
    v_add_f32 v7, v7, v19
    v_mfma_f32_16x16x32_bf16 a[100:103], v[88:91], v[36:39], a[100:103]
    v_exp_f32 v17, v105
    v_mfma_f32_16x16x32_bf16 a[148:151], v[92:95], v[36:39], a[148:151]
    v_cvt_pk_bf16_f32 v169, v18, v19
    v_fma_f32 v149, v149, v49, v51
    v_mfma_f32_16x16x32_bf16 a[148:151], v[76:79], v[32:35], a[148:151]
    s_waitcnt lgkmcnt(2)
    v_exp_f32 v18, v106
    v_mfma_f32_16x16x32_bf16 a[8:11], v[64:67], v[40:43], a[8:11]
    ds_read_b128 v[32:35], v1 offset:4096
    v_add_f32 v7, v7, v16
    v_mfma_f32_16x16x32_bf16 a[8:11], v[80:83], v[44:47], a[8:11]
    buffer_store_dwordx4 v[232:235], v22, s[4:7], s33 offen offset:1536 sc1
    v_mfma_f32_16x16x32_bf16 a[56:59], v[84:87], v[44:47], a[56:59]
    v_add_f32 v7, v7, v17
    v_cvt_f32_i32 v146, v146
    v_mfma_f32_16x16x32_bf16 a[56:59], v[68:71], v[40:43], a[56:59]
    v_exp_f32 v19, v107
    v_mfma_f32_16x16x32_bf16 a[104:107], v[72:75], v[40:43], a[104:107]
    ds_read_b128 v[36:39], v1 offset:16384
    v_cvt_pk_bf16_f32 v170, v16, v17
    v_mfma_f32_16x16x32_bf16 a[104:107], v[88:91], v[44:47], a[104:107]
    v_exp_f32 v16, v172
    v_mfma_f32_16x16x32_bf16 a[152:155], v[92:95], v[44:47], a[152:155]
    v_add_f32 v7, v7, v18
    v_cvt_f32_i32 v150, v150
    v_mfma_f32_16x16x32_bf16 a[152:155], v[76:79], v[40:43], a[152:155]
    s_waitcnt lgkmcnt(2)
    v_add_f32 v7, v7, v19
    v_fma_f32 v146, v146, v48, v50
    v_mfma_f32_16x16x32_bf16 a[12:15], v[64:67], v[24:27], a[12:15]
    ds_read_b128 v[40:43], v1 offset:5120
    v_mfma_f32_16x16x32_bf16 a[12:15], v[80:83], v[28:31], a[12:15]
    buffer_store_dwordx4 v[236:239], v23, s[4:7], s33 offen offset:2304 sc1
    v_mfma_f32_16x16x32_bf16 a[60:63], v[84:87], v[28:31], a[60:63]
    v_exp_f32 v17, v173
    v_mfma_f32_16x16x32_bf16 a[60:63], v[68:71], v[24:27], a[60:63]
    v_cvt_pk_bf16_f32 v171, v18, v19
    v_fma_f32 v150, v150, v49, v51
    v_mfma_f32_16x16x32_bf16 a[108:111], v[72:75], v[24:27], a[108:111]
    ds_read_b128 v[44:47], v1 offset:17408
    v_mfma_f32_16x16x32_bf16 a[108:111], v[88:91], v[28:31], a[108:111]
    v_exp_f32 v18, v174
    v_mfma_f32_16x16x32_bf16 a[156:159], v[92:95], v[28:31], a[156:159]
    s_add_u32 s29, s28, 49152
    v_add_f32 v8, v8, v16
    v_add_f32 v8, v8, v17
    v_mfma_f32_16x16x32_bf16 a[156:159], v[76:79], v[24:27], a[156:159]
    s_waitcnt lgkmcnt(2)
    v_exp_f32 v19, v175
    v_mfma_f32_16x16x32_bf16 a[16:19], v[64:67], v[32:35], a[16:19]
    s_sub_u32 s3, s29, 147456
    ds_read_b128 v[24:27], v1 offset:6144
    v_cvt_pk_bf16_f32 v172, v16, v17
    v_mfma_f32_16x16x32_bf16 a[16:19], v[80:83], v[36:39], a[16:19]
    s_mov_b32 m0, s26
    v_exp_f32 v16, v108
    v_mfma_f32_16x16x32_bf16 a[64:67], v[84:87], v[36:39], a[64:67]
    s_min_u32 s29, s29, s3
    v_add_f32 v8, v8, v18
    v_lshlrev_b32 v48, 16, v57
    v_mfma_f32_16x16x32_bf16 a[64:67], v[68:71], v[32:35], a[64:67]
    buffer_load_dwordx4 v4, s[4:7], s32 offen offset:0 sc1 lds
    v_mfma_f32_16x16x32_bf16 a[112:115], v[72:75], v[32:35], a[112:115]
    ds_read_b128 v[28:31], v1 offset:18432
    v_add_f32 v8, v8, v19
    v_mfma_f32_16x16x32_bf16 a[112:115], v[88:91], v[36:39], a[112:115]
    v_exp_f32 v17, v109
    v_mfma_f32_16x16x32_bf16 a[160:163], v[92:95], v[36:39], a[160:163]
    v_cvt_pk_bf16_f32 v173, v18, v19
    v_and_b32 v49, s97, v57
    v_mfma_f32_16x16x32_bf16 a[160:163], v[76:79], v[32:35], a[160:163]
    s_waitcnt lgkmcnt(2)
    buffer_load_dwordx4 v4, s[4:7], s32 offen offset:1024 sc1 lds
    v_mfma_f32_16x16x32_bf16 a[20:23], v[64:67], v[40:43], a[20:23]
    s_sub_u32 s3, s29, s28
    ds_read_b128 v[32:35], v1 offset:7168
    v_lshlrev_b32 v50, 16, v59
    v_mfma_f32_16x16x32_bf16 a[20:23], v[80:83], v[44:47], a[20:23]
    v_exp_f32 v18, v110
    v_mfma_f32_16x16x32_bf16 a[68:71], v[84:87], v[44:47], a[68:71]
    v_add_f32 v8, v8, v16
    v_add_f32 v8, v8, v17
    v_mfma_f32_16x16x32_bf16 a[68:71], v[68:71], v[40:43], a[68:71]
    buffer_load_dwordx4 v4, s[4:7], s32 offen offset:2048 sc1 lds
    v_mfma_f32_16x16x32_bf16 a[116:119], v[72:75], v[40:43], a[116:119]
    ds_read_b128 v[36:39], v1 offset:19456
    v_mfma_f32_16x16x32_bf16 a[116:119], v[88:91], v[44:47], a[116:119]
    v_exp_f32 v19, v111
    v_mfma_f32_16x16x32_bf16 a[164:167], v[92:95], v[44:47], a[164:167]
    s_mov_b32 s28, s29
    v_cvt_pk_bf16_f32 v174, v16, v17
    v_add_f32 v8, v8, v18
    v_mfma_f32_16x16x32_bf16 a[164:167], v[76:79], v[40:43], a[164:167]
    s_waitcnt lgkmcnt(2)
    v_add_f32 v8, v8, v19
    v_cvt_pk_bf16_f32 v175, v18, v19
    v_mfma_f32_16x16x32_bf16 a[24:27], v[64:67], v[24:27], a[24:27]
    s_add_u32 s32, s32, 24576
    ds_read_b128 v[40:43], v1 offset:8192
    v_and_b32 v51, s97, v59
    v_mfma_f32_16x16x32_bf16 a[24:27], v[80:83], v[28:31], a[24:27]
    v_exp_f32 v16, v176
    v_mfma_f32_16x16x32_bf16 a[72:75], v[84:87], v[28:31], a[72:75]
    s_add_u32 s26, s26, 12288
    v_exp_f32 v17, v177
    v_mfma_f32_16x16x32_bf16 a[72:75], v[68:71], v[24:27], a[72:75]
    v_exp_f32 v18, v178
    v_mfma_f32_16x16x32_bf16 a[120:123], v[72:75], v[24:27], a[120:123]
    s_mov_b32 m0, s26
    ds_read_b128 v[44:47], v1 offset:20480
    v_add_f32 v5, v5, v16
    v_mfma_f32_16x16x32_bf16 a[120:123], v[88:91], v[28:31], a[120:123]
    v_add_f32 v5, v5, v17
    v_mul_f32_e64 v50, -v50, v48
    v_mfma_f32_16x16x32_bf16 a[168:171], v[92:95], v[28:31], a[168:171]
    v_exp_f32 v19, v179
    v_mfma_f32_16x16x32_bf16 a[168:171], v[76:79], v[24:27], a[168:171]
    s_waitcnt lgkmcnt(2)
    v_cvt_pk_bf16_f32 v176, v16, v17
    v_mul_f32_e64 v51, -v51, v49
    v_mfma_f32_16x16x32_bf16 a[28:31], v[64:67], v[32:35], a[28:31]
    ds_read_b128 v[24:27], v1 offset:9216
    v_add_u32 v2, s3, v2
    v_mfma_f32_16x16x32_bf16 a[28:31], v[80:83], v[36:39], a[28:31]
    buffer_load_dwordx4 v4, s[4:7], s32 offen offset:0 sc1 lds
    v_mfma_f32_16x16x32_bf16 a[76:79], v[84:87], v[36:39], a[76:79]
    v_exp_f32 v16, v112
    v_mfma_f32_16x16x32_bf16 a[76:79], v[68:71], v[32:35], a[76:79]
    v_add_f32 v5, v5, v18
    v_add_f32 v5, v5, v19
    v_mfma_f32_16x16x32_bf16 a[124:127], v[72:75], v[32:35], a[124:127]
    ds_read_b128 v[28:31], v1 offset:21504
    v_cvt_f32_i32 v152, v152
    v_mfma_f32_16x16x32_bf16 a[124:127], v[88:91], v[36:39], a[124:127]
    buffer_load_dwordx4 v4, s[4:7], s32 offen offset:1024 sc1 lds
    v_mfma_f32_16x16x32_bf16 a[172:175], v[92:95], v[36:39], a[172:175]
    v_exp_f32 v17, v113
    v_mfma_f32_16x16x32_bf16 a[172:175], v[76:79], v[32:35], a[172:175]
    s_waitcnt lgkmcnt(2)
    v_cvt_pk_bf16_f32 v177, v18, v19
    v_add_u32 v3, s3, v3
    v_mfma_f32_16x16x32_bf16 a[32:35], v[64:67], v[40:43], a[32:35]
    ds_read_b128 v[32:35], v1 offset:10240
    v_cvt_f32_i32 v156, v156
    v_mfma_f32_16x16x32_bf16 a[32:35], v[80:83], v[44:47], a[32:35]
    v_exp_f32 v18, v114
    v_mfma_f32_16x16x32_bf16 a[80:83], v[84:87], v[44:47], a[80:83]
    v_add_f32 v5, v5, v16
    v_add_f32 v5, v5, v17
    v_mfma_f32_16x16x32_bf16 a[80:83], v[68:71], v[40:43], a[80:83]
    buffer_load_dwordx4 v4, s[4:7], s32 offen offset:2048 sc1 lds
    v_mfma_f32_16x16x32_bf16 a[128:131], v[72:75], v[40:43], a[128:131]
    ds_read_b128 v[36:39], v1 offset:22528
    v_mfma_f32_16x16x32_bf16 a[128:131], v[88:91], v[44:47], a[128:131]
    v_exp_f32 v19, v115
    v_mfma_f32_16x16x32_bf16 a[176:179], v[92:95], v[44:47], a[176:179]
    v_cvt_pk_bf16_f32 v178, v16, v17
    v_fma_f32 v152, v152, v48, v50
    v_mfma_f32_16x16x32_bf16 a[176:179], v[76:79], v[40:43], a[176:179]
    s_waitcnt lgkmcnt(2)
    v_exp_f32 v16, v180
    v_mfma_f32_16x16x32_bf16 a[36:39], v[64:67], v[24:27], a[36:39]
    ds_read_b128 v[40:43], v1 offset:11264
    v_add_f32 v5, v5, v18
    v_mfma_f32_16x16x32_bf16 a[36:39], v[80:83], v[28:31], a[36:39]
    v_add_f32 v5, v5, v19
    v_mfma_f32_16x16x32_bf16 a[84:87], v[84:87], v[28:31], a[84:87]
    v_exp_f32 v17, v181
    v_mfma_f32_16x16x32_bf16 a[84:87], v[68:71], v[24:27], a[84:87]
    s_add_u32 s32, s32, 24576
    v_cvt_pk_bf16_f32 v179, v18, v19
    s_add_u32 s26, s26, 36864
    v_mfma_f32_16x16x32_bf16 a[132:135], v[72:75], v[24:27], a[132:135]
    s_sub_u32 s57, s26, 147456
    ds_read_b128 v[44:47], v1 offset:23552
    v_fma_f32 v156, v156, v49, v51
    v_mfma_f32_16x16x32_bf16 a[132:135], v[88:91], v[28:31], a[132:135]
    s_waitcnt lgkmcnt(2)
    v_exp_f32 v18, v182
    v_mfma_f32_16x16x32_bf16 a[180:183], v[92:95], v[28:31], a[180:183]
    s_waitcnt vmcnt(6)
    v_add_f32 v6, v6, v16
    v_add_f32 v6, v6, v17
    v_mfma_f32_16x16x32_bf16 a[180:183], v[76:79], v[24:27], a[180:183]
    s_barrier
    v_mfma_f32_16x16x32_bf16 a[40:43], v[64:67], v[32:35], a[40:43]
    s_min_u32 s26, s26, s57
    ds_read_b128 v[24:27], v2 offset:0
    v_add_u32 v0, 1, v0
    v_mfma_f32_16x16x32_bf16 a[40:43], v[80:83], v[36:39], a[40:43]
    buffer_store_dword v0, v13, s[20:23], 0 offen offset:32 sc1
    v_mfma_f32_16x16x32_bf16 a[88:91], v[84:87], v[36:39], a[88:91]
    v_exp_f32 v19, v183
    v_mfma_f32_16x16x32_bf16 a[88:91], v[68:71], v[32:35], a[88:91]
    v_cvt_pk_bf16_f32 v180, v16, v17
    v_cvt_f32_i32 v153, v153
    v_mfma_f32_16x16x32_bf16 a[136:139], v[72:75], v[32:35], a[136:139]
    ds_read_b128 v[28:31], v3 offset:0
    v_cvt_f32_i32 v157, v157
    v_mfma_f32_16x16x32_bf16 a[136:139], v[88:91], v[36:39], a[136:139]
    v_exp_f32 v16, v116
    v_mfma_f32_16x16x32_bf16 a[184:187], v[92:95], v[36:39], a[184:187]
    v_add_f32 v6, v6, v18
    v_add_f32 v6, v6, v19
    v_mfma_f32_16x16x32_bf16 a[184:187], v[76:79], v[32:35], a[184:187]
    s_waitcnt lgkmcnt(2)
    v_exp_f32 v17, v117
    v_mfma_f32_16x16x32_bf16 a[44:47], v[64:67], v[40:43], a[44:47]
    ds_read_b128 v[32:35], v2 offset:6144
    v_cvt_pk_bf16_f32 v181, v18, v19
    v_mfma_f32_16x16x32_bf16 a[44:47], v[80:83], v[44:47], a[44:47]
    v_exp_f32 v18, v118
    v_mfma_f32_16x16x32_bf16 a[92:95], v[84:87], v[44:47], a[92:95]
    v_add_f32 v6, v6, v16
    v_add_f32 v6, v6, v17
    v_mfma_f32_16x16x32_bf16 a[92:95], v[68:71], v[40:43], a[92:95]
    v_exp_f32 v19, v119
    v_mfma_f32_16x16x32_bf16 a[140:143], v[72:75], v[40:43], a[140:143]
    ds_read_b128 v[36:39], v3 offset:6144
    v_cvt_pk_bf16_f32 v182, v16, v17
    v_mfma_f32_16x16x32_bf16 a[140:143], v[88:91], v[44:47], a[140:143]
    v_add_f32 v6, v6, v18
    v_add_f32 v6, v6, v19
    v_mfma_f32_16x16x32_bf16 a[188:191], v[92:95], v[44:47], a[188:191]
    v_cvt_pk_bf16_f32 v183, v18, v19
    v_mfma_f32_16x16x32_bf16 a[188:191], v[76:79], v[40:43], a[188:191]
    s_waitcnt lgkmcnt(2)
    v_mfma_f32_16x16x32_bf16 v[64:67], v[24:27], a[192:195], v[128:131]
    s_mov_b32 m0, s56
    ds_read_b128 v[40:43], v2 offset:128
    v_fma_f32 v153, v153, v48, v50
    v_mfma_f32_16x16x32_bf16 v[64:67], v[28:31], a[196:199], v[64:67]
    buffer_load_dwordx4 v4, s[4:7], s27 offen offset:0 sc1 lds
    v_mfma_f32_16x16x32_bf16 v[68:71], v[28:31], a[220:223], v[132:135]
    v_exp_f32 v16, v184
    v_mfma_f32_16x16x32_bf16 v[68:71], v[24:27], a[216:219], v[68:71]
    v_exp_f32 v17, v185
    v_mfma_f32_16x16x32_bf16 v[72:75], v[24:27], a[240:243], v[136:139]
    ds_read_b128 v[44:47], v3 offset:128
    v_fma_f32 v157, v157, v49, v51
    v_mfma_f32_16x16x32_bf16 v[72:75], v[28:31], a[244:247], v[72:75]
    v_exp_f32 v18, v186
    v_mfma_f32_16x16x32_bf16 v[76:79], v[28:31], v[204:207], v[140:143]
    v_add_f32 v7, v7, v16
    v_add_f32 v7, v7, v17
    v_mfma_f32_16x16x32_bf16 v[76:79], v[24:27], v[200:203], v[76:79]
    s_waitcnt lgkmcnt(2)
    v_exp_f32 v19, v187
    v_mfma_f32_16x16x32_bf16 v[96:99], v[32:35], a[192:195], v[128:131]
    ds_read_b128 v[24:27], v2 offset:6272
    v_cvt_pk_bf16_f32 v184, v16, v17
    v_mfma_f32_16x16x32_bf16 v[96:99], v[36:39], a[196:199], v[96:99]
    v_exp_f32 v16, v120
    v_mfma_f32_16x16x32_bf16 v[100:103], v[36:39], a[220:223], v[132:135]
    v_cvt_f32_i32 v154, v154
    v_add_f32 v7, v7, v18
    v_mfma_f32_16x16x32_bf16 v[100:103], v[32:35], a[216:219], v[100:103]
    buffer_load_dwordx4 v4, s[4:7], s27 offen offset:1024 sc1 lds
    v_mfma_f32_16x16x32_bf16 v[104:107], v[32:35], a[240:243], v[136:139]
    ds_read_b128 v[28:31], v3 offset:6272
    v_add_f32 v7, v7, v19
    v_mfma_f32_16x16x32_bf16 v[104:107], v[36:39], a[244:247], v[104:107]
    v_exp_f32 v17, v121
    v_mfma_f32_16x16x32_bf16 v[108:111], v[36:39], v[204:207], v[140:143]
    v_cvt_f32_i32 v158, v158
    v_cvt_pk_bf16_f32 v185, v18, v19
    v_mfma_f32_16x16x32_bf16 v[108:111], v[32:35], v[200:203], v[108:111]
    s_waitcnt lgkmcnt(2)
    v_exp_f32 v18, v122
    v_mfma_f32_16x16x32_bf16 v[64:67], v[40:43], a[200:203], v[64:67]
    ds_read_b128 v[32:35], v2 offset:256
    v_fma_f32 v154, v154, v48, v50
    v_mfma_f32_16x16x32_bf16 v[64:67], v[44:47], a[204:207], v[64:67]
L_pg8:
    s_cbranch_execz L_pg12
    v_add_f32 v7, v7, v16
    v_add_f32 v7, v7, v17
    v_mfma_f32_16x16x32_bf16 v[68:71], v[44:47], a[228:231], v[68:71]
    v_exp_f32 v19, v123
    v_mfma_f32_16x16x32_bf16 v[68:71], v[40:43], a[224:227], v[68:71]
    v_fma_f32 v158, v158, v49, v51
    v_cvt_pk_bf16_f32 v186, v16, v17
    v_mfma_f32_16x16x32_bf16 v[72:75], v[40:43], a[248:251], v[72:75]
    ds_read_b128 v[36:39], v3 offset:256
    v_cvt_pk_bf16_f32 v144, v144, v148
    v_mfma_f32_16x16x32_bf16 v[72:75], v[44:47], a[252:255], v[72:75]
    v_exp_f32 v16, v188
    v_mfma_f32_16x16x32_bf16 v[76:79], v[44:47], v[212:215], v[76:79]
    v_add_f32 v7, v7, v18
    v_add_f32 v7, v7, v19
    v_mfma_f32_16x16x32_bf16 v[76:79], v[40:43], v[208:211], v[76:79]
    s_waitcnt lgkmcnt(2)
    buffer_load_dwordx4 v4, s[4:7], s27 offen offset:2048 sc1 lds
    v_mfma_f32_16x16x32_bf16 v[96:99], v[24:27], a[200:203], v[96:99]
    ds_read_b128 v[40:43], v2 offset:6400
    v_cvt_pk_bf16_f32 v148, v145, v149
    v_mfma_f32_16x16x32_bf16 v[96:99], v[28:31], a[204:207], v[96:99]
    v_exp_f32 v17, v189
    v_mfma_f32_16x16x32_bf16 v[100:103], v[28:31], a[228:231], v[100:103]
    v_cvt_pk_bf16_f32 v187, v18, v19
    v_mfma_f32_16x16x32_bf16 v[100:103], v[24:27], a[224:227], v[100:103]
    v_exp_f32 v18, v190
    v_mfma_f32_16x16x32_bf16 v[104:107], v[24:27], a[248:251], v[104:107]
    ds_read_b128 v[44:47], v3 offset:6400
    v_add_f32 v8, v8, v16
    v_mfma_f32_16x16x32_bf16 v[104:107], v[28:31], a[252:255], v[104:107]
    v_add_f32 v8, v8, v17
    v_cvt_pk_bf16_f32 v145, v152, v156
    v_mfma_f32_16x16x32_bf16 v[108:111], v[28:31], v[212:215], v[108:111]
    s_add_u32 s29, s30, 49152
    v_exp_f32 v19, v191
    v_mfma_f32_16x16x32_bf16 v[108:111], v[24:27], v[208:211], v[108:111]
    s_waitcnt lgkmcnt(2)
    v_cvt_pk_bf16_f32 v188, v16, v17
    s_sub_u32 s3, s29, 147456
    v_mfma_f32_16x16x32_bf16 v[64:67], v[32:35], a[208:211], v[64:67]
    s_add_u32 s27, s27, 24576
    ds_read_b128 v[24:27], v2 offset:12288
    v_cvt_pk_bf16_f32 v149, v153, v157
    v_mfma_f32_16x16x32_bf16 v[64:67], v[36:39], a[212:215], v[64:67]
    s_min_u32 s29, s29, s3
    v_exp_f32 v16, v124
    v_mfma_f32_16x16x32_bf16 v[68:71], v[36:39], a[236:239], v[68:71]
    v_add_f32 v8, v8, v18
    v_add_f32 v8, v8, v19
    v_mfma_f32_16x16x32_bf16 v[68:71], v[32:35], a[232:235], v[68:71]
    v_exp_f32 v17, v125
    v_mfma_f32_16x16x32_bf16 v[72:75], v[32:35], v[192:195], v[72:75]
    s_add_u32 s56, s56, 12288
    ds_read_b128 v[28:31], v3 offset:12288
    v_cvt_pk_bf16_f32 v152, v146, v150
    v_mfma_f32_16x16x32_bf16 v[72:75], v[36:39], v[196:199], v[72:75]
    v_cvt_pk_bf16_f32 v189, v18, v19
    v_mfma_f32_16x16x32_bf16 v[76:79], v[36:39], v[220:223], v[76:79]
    v_exp_f32 v18, v126
    v_mfma_f32_16x16x32_bf16 v[76:79], v[32:35], v[216:219], v[76:79]
    s_waitcnt lgkmcnt(2)
    v_add_f32 v8, v8, v16
    v_mfma_f32_16x16x32_bf16 v[96:99], v[40:43], a[208:211], v[96:99]
    ds_read_b128 v[32:35], v2 offset:18432
    v_add_f32 v8, v8, v17
    v_mfma_f32_16x16x32_bf16 v[96:99], v[44:47], a[212:215], v[96:99]
    s_sub_u32 s3, s29, s30
    v_exp_f32 v19, v127
    v_mfma_f32_16x16x32_bf16 v[100:103], v[44:47], a[236:239], v[100:103]
    s_mov_b32 m0, s56
    v_cvt_pk_bf16_f32 v153, v154, v158
    v_mfma_f32_16x16x32_bf16 v[100:103], v[40:43], a[232:235], v[100:103]
    v_cvt_pk_bf16_f32 v190, v16, v17
    v_mfma_f32_16x16x32_bf16 v[104:107], v[40:43], v[192:195], v[104:107]
    ds_read_b128 v[36:39], v3 offset:18432
    v_add_f32 v8, v8, v18
    v_mfma_f32_16x16x32_bf16 v[104:107], v[44:47], v[196:199], v[104:107]
    v_add_f32 v8, v8, v19
    v_cvt_pk_bf16_f32 v191, v18, v19
    v_mfma_f32_16x16x32_bf16 v[108:111], v[44:47], v[220:223], v[108:111]
    v_mfma_f32_16x16x32_bf16 v[108:111], v[40:43], v[216:219], v[108:111]
    s_waitcnt lgkmcnt(2)
    v_exp_f32 v16, v64
    v_mfma_f32_16x16x32_bf16 v[80:83], v[24:27], a[192:195], v[128:131]
    ds_read_b128 v[40:43], v2 offset:12416
    v_mfma_f32_16x16x32_bf16 v[80:83], v[28:31], a[196:199], v[80:83]
    s_mov_b32 s30, s29
    v_exp_f32 v17, v65
    v_mfma_f32_16x16x32_bf16 v[84:87], v[28:31], a[220:223], v[132:135]
    v_exp_f32 v18, v66
    v_mfma_f32_16x16x32_bf16 v[84:87], v[24:27], a[216:219], v[84:87]
    s_waitcnt vmcnt(14)
    buffer_load_dwordx4 v4, s[4:7], s27 offen offset:0 sc1 lds
    v_mfma_f32_16x16x32_bf16 v[88:91], v[24:27], a[240:243], v[136:139]
    ds_read_b128 v[44:47], v3 offset:12416
    v_add_f32 v5, v5, v16
    v_mfma_f32_16x16x32_bf16 v[88:91], v[28:31], a[244:247], v[88:91]
    v_add_f32 v5, v5, v17
    v_lshlrev_b32 v48, 16, v60
    v_mfma_f32_16x16x32_bf16 v[92:95], v[28:31], v[204:207], v[140:143]
    v_exp_f32 v19, v67
    v_mfma_f32_16x16x32_bf16 v[92:95], v[24:27], v[200:203], v[92:95]
    s_waitcnt lgkmcnt(2)
    v_cvt_pk_bf16_f32 v64, v16, v17
    v_and_b32 v49, s97, v60
    v_mfma_f32_16x16x32_bf16 v[112:115], v[32:35], a[192:195], v[128:131]
    ds_read_b128 v[24:27], v2 offset:18560
    v_mfma_f32_16x16x32_bf16 v[112:115], v[36:39], a[196:199], v[112:115]
    v_exp_f32 v16, v96
    v_mfma_f32_16x16x32_bf16 v[116:119], v[36:39], a[220:223], v[132:135]
    v_add_f32 v5, v5, v18
    v_lshlrev_b32 v50, 16, v62
    v_mfma_f32_16x16x32_bf16 v[116:119], v[32:35], a[216:219], v[116:119]
    v_add_f32 v5, v5, v19
    v_add_u32 v1, s3, v1
    v_mfma_f32_16x16x32_bf16 v[120:123], v[32:35], a[240:243], v[136:139]
    ds_read_b128 v[28:31], v3 offset:18560
    v_mfma_f32_16x16x32_bf16 v[120:123], v[36:39], a[244:247], v[120:123]
    v_exp_f32 v17, v97
    v_mfma_f32_16x16x32_bf16 v[124:127], v[36:39], v[204:207], v[140:143]
    v_cvt_pk_bf16_f32 v65, v18, v19
    v_and_b32 v51, s97, v62
    v_mfma_f32_16x16x32_bf16 v[124:127], v[32:35], v[200:203], v[124:127]
    s_waitcnt lgkmcnt(2)
    buffer_load_dwordx4 v4, s[4:7], s27 offen offset:1024 sc1 lds
    v_mfma_f32_16x16x32_bf16 v[80:83], v[40:43], a[200:203], v[80:83]
    ds_read_b128 v[32:35], v2 offset:12544
    v_mfma_f32_16x16x32_bf16 v[80:83], v[44:47], a[204:207], v[80:83]
    v_exp_f32 v18, v98
    v_mfma_f32_16x16x32_bf16 v[84:87], v[44:47], a[228:231], v[84:87]
    v_add_f32 v5, v5, v16
    v_add_f32 v5, v5, v17
    v_mfma_f32_16x16x32_bf16 v[84:87], v[40:43], a[224:227], v[84:87]
    v_exp_f32 v19, v99
    v_mfma_f32_16x16x32_bf16 v[88:91], v[40:43], a[248:251], v[88:91]
    ds_read_b128 v[36:39], v3 offset:12544
    v_cvt_pk_bf16_f32 v66, v16, v17
    v_mfma_f32_16x16x32_bf16 v[88:91], v[44:47], a[252:255], v[88:91]
    v_exp_f32 v16, v68
    v_mfma_f32_16x16x32_bf16 v[92:95], v[44:47], v[212:215], v[92:95]
    v_mul_f32_e64 v50, -v50, v48
    v_add_f32 v5, v5, v18
    v_mfma_f32_16x16x32_bf16 v[92:95], v[40:43], v[208:211], v[92:95]
    s_waitcnt lgkmcnt(2)
    v_add_f32 v5, v5, v19
    v_mul_f32_e64 v51, -v51, v49
    v_mfma_f32_16x16x32_bf16 v[112:115], v[24:27], a[200:203], v[112:115]
    ds_read_b128 v[40:43], v2 offset:18688
    v_mfma_f32_16x16x32_bf16 v[112:115], v[28:31], a[204:207], v[112:115]
    buffer_load_dwordx4 v4, s[4:7], s27 offen offset:2048 sc1 lds
    v_mfma_f32_16x16x32_bf16 v[116:119], v[28:31], a[228:231], v[116:119]
    v_exp_f32 v17, v69
    v_mfma_f32_16x16x32_bf16 v[116:119], v[24:27], a[224:227], v[116:119]
    v_cvt_pk_bf16_f32 v67, v18, v19
    v_cvt_f32_i32 v240, v240
    v_mfma_f32_16x16x32_bf16 v[120:123], v[24:27], a[248:251], v[120:123]
    ds_read_b128 v[44:47], v3 offset:18688
    v_mfma_f32_16x16x32_bf16 v[120:123], v[28:31], a[252:255], v[120:123]
    s_waitcnt lgkmcnt(2)
    v_exp_f32 v18, v70
    v_mfma_f32_16x16x32_bf16 v[124:127], v[28:31], v[212:215], v[124:127]
    s_waitcnt vmcnt(7)
    v_add_f32 v6, v6, v16
    v_add_f32 v6, v6, v17
    v_mfma_f32_16x16x32_bf16 v[124:127], v[24:27], v[208:211], v[124:127]
    s_barrier
    v_mfma_f32_16x16x32_bf16 v[80:83], v[32:35], a[208:211], v[80:83]
    ds_read_b128 v[24:27], v1 offset:0
    v_cvt_f32_i32 v244, v244
    v_mfma_f32_16x16x32_bf16 v[80:83], v[36:39], a[212:215], v[80:83]
    v_exp_f32 v19, v71
    v_mfma_f32_16x16x32_bf16 v[84:87], v[36:39], a[236:239], v[84:87]
    v_cvt_pk_bf16_f32 v68, v16, v17
    v_fma_f32 v240, v240, v48, v50
    v_mfma_f32_16x16x32_bf16 v[84:87], v[32:35], a[232:235], v[84:87]
    v_exp_f32 v16, v100
    v_mfma_f32_16x16x32_bf16 v[88:91], v[32:35], v[192:195], v[88:91]
    ds_read_b128 v[28:31], v1 offset:12288
    v_add_f32 v6, v6, v18
    v_mfma_f32_16x16x32_bf16 v[88:91], v[36:39], v[196:199], v[88:91]
    v_add_f32 v6, v6, v19
    v_fma_f32 v244, v244, v49, v51
    v_mfma_f32_16x16x32_bf16 v[92:95], v[36:39], v[220:223], v[92:95]
    v_exp_f32 v17, v101
    v_mfma_f32_16x16x32_bf16 v[92:95], v[32:35], v[216:219], v[92:95]
    s_waitcnt lgkmcnt(2)
    v_cvt_pk_bf16_f32 v69, v18, v19
    v_mfma_f32_16x16x32_bf16 v[112:115], v[40:43], a[208:211], v[112:115]
    ds_read_b128 v[32:35], v1 offset:1024
    v_mfma_f32_16x16x32_bf16 v[112:115], v[44:47], a[212:215], v[112:115]
    v_exp_f32 v18, v102
    v_mfma_f32_16x16x32_bf16 v[116:119], v[44:47], a[236:239], v[116:119]
    v_add_f32 v6, v6, v16
    v_add_f32 v6, v6, v17
    v_mfma_f32_16x16x32_bf16 v[116:119], v[40:43], a[232:235], v[116:119]
    s_add_u32 s27, s27, 24576
    v_exp_f32 v19, v103
    v_mfma_f32_16x16x32_bf16 v[120:123], v[40:43], v[192:195], v[120:123]
    s_add_u32 s56, s56, 36864
    ds_read_b128 v[36:39], v1 offset:13312
    v_cvt_pk_bf16_f32 v70, v16, v17
    v_mfma_f32_16x16x32_bf16 v[120:123], v[44:47], v[196:199], v[120:123]
    s_sub_u32 s58, s56, 147456
    v_add_f32 v6, v6, v18
    v_add_f32 v6, v6, v19
    v_mfma_f32_16x16x32_bf16 v[124:127], v[44:47], v[220:223], v[124:127]
    s_min_u32 s56, s56, s58
    v_cvt_pk_bf16_f32 v71, v18, v19
    v_mfma_f32_16x16x32_bf16 v[124:127], v[40:43], v[216:219], v[124:127]
    s_waitcnt lgkmcnt(2)
    v_mfma_f32_16x16x32_bf16 a[0:3], v[160:163], v[24:27], a[0:3]
    s_mov_b32 m0, s56
    ds_read_b128 v[40:43], v1 offset:2048
    v_cvt_f32_i32 v241, v241
    v_mfma_f32_16x16x32_bf16 a[0:3], v[176:179], v[28:31], a[0:3]
    buffer_load_dwordx4 v4, s[4:7], s27 offen offset:0 sc1 lds
    v_mfma_f32_16x16x32_bf16 a[48:51], v[180:183], v[28:31], a[48:51]
    v_exp_f32 v16, v72
    v_mfma_f32_16x16x32_bf16 a[48:51], v[164:167], v[24:27], a[48:51]
    v_exp_f32 v17, v73
    v_mfma_f32_16x16x32_bf16 a[96:99], v[168:171], v[24:27], a[96:99]
    ds_read_b128 v[44:47], v1 offset:14336
    v_cvt_f32_i32 v245, v245
    v_mfma_f32_16x16x32_bf16 a[96:99], v[184:187], v[28:31], a[96:99]
    v_exp_f32 v18, v74
    v_mfma_f32_16x16x32_bf16 a[144:147], v[188:191], v[28:31], a[144:147]
    v_add_f32 v7, v7, v16
    v_add_f32 v7, v7, v17
    v_mfma_f32_16x16x32_bf16 a[144:147], v[172:175], v[24:27], a[144:147]
    s_waitcnt lgkmcnt(2)
    v_exp_f32 v19, v75
    v_mfma_f32_16x16x32_bf16 a[4:7], v[160:163], v[32:35], a[4:7]
    ds_read_b128 v[24:27], v1 offset:3072
    v_fma_f32 v241, v241, v48, v50
    v_mfma_f32_16x16x32_bf16 a[4:7], v[176:179], v[36:39], a[4:7]
    buffer_load_dwordx4 v4, s[4:7], s27 offen offset:1024 sc1 lds
    v_mfma_f32_16x16x32_bf16 a[52:55], v[180:183], v[36:39], a[52:55]
    v_cvt_pk_bf16_f32 v72, v16, v17
    v_fma_f32 v245, v245, v49, v51
    v_mfma_f32_16x16x32_bf16 a[52:55], v[164:167], v[32:35], a[52:55]
    v_exp_f32 v16, v104
    v_mfma_f32_16x16x32_bf16 a[100:103], v[168:171], v[32:35], a[100:103]
    ds_read_b128 v[28:31], v1 offset:15360
    v_add_f32 v7, v7, v18
    v_mfma_f32_16x16x32_bf16 a[100:103], v[184:187], v[36:39], a[100:103]
    buffer_load_dword v52, v20, s[20:23], s44 offen sc1
    v_mfma_f32_16x16x32_bf16 a[148:151], v[188:191], v[36:39], a[148:151]
    v_add_f32 v7, v7, v19
    v_cvt_f32_i32 v242, v242
    v_mfma_f32_16x16x32_bf16 a[148:151], v[172:175], v[32:35], a[148:151]
    s_waitcnt lgkmcnt(2)
    v_exp_f32 v17, v105
    v_mfma_f32_16x16x32_bf16 a[8:11], v[160:163], v[40:43], a[8:11]
    ds_read_b128 v[32:35], v1 offset:4096
    v_cvt_pk_bf16_f32 v73, v18, v19
    v_mfma_f32_16x16x32_bf16 a[8:11], v[176:179], v[44:47], a[8:11]
    v_exp_f32 v18, v106
    v_mfma_f32_16x16x32_bf16 a[56:59], v[180:183], v[44:47], a[56:59]
    v_add_f32 v7, v7, v16
    v_cvt_f32_i32 v246, v246
    v_mfma_f32_16x16x32_bf16 a[56:59], v[164:167], v[40:43], a[56:59]
    buffer_load_dwordx4 v4, s[4:7], s27 offen offset:2048 sc1 lds
    v_mfma_f32_16x16x32_bf16 a[104:107], v[168:171], v[40:43], a[104:107]
    ds_read_b128 v[36:39], v1 offset:16384
    v_add_f32 v7, v7, v17
    v_mfma_f32_16x16x32_bf16 a[104:107], v[184:187], v[44:47], a[104:107]
    v_exp_f32 v19, v107
    v_mfma_f32_16x16x32_bf16 a[152:155], v[188:191], v[44:47], a[152:155]
    v_cvt_pk_bf16_f32 v74, v16, v17
    v_fma_f32 v242, v242, v48, v50
    v_mfma_f32_16x16x32_bf16 a[152:155], v[172:175], v[40:43], a[152:155]
    s_waitcnt lgkmcnt(2)
    v_exp_f32 v16, v76
    v_mfma_f32_16x16x32_bf16 a[12:15], v[160:163], v[24:27], a[12:15]
    ds_read_b128 v[40:43], v1 offset:5120
    v_add_f32 v7, v7, v18
    v_mfma_f32_16x16x32_bf16 a[12:15], v[176:179], v[28:31], a[12:15]
    s_add_u32 s27, s27, 24576
    v_add_f32 v7, v7, v19
    v_fma_f32 v246, v246, v49, v51
    v_mfma_f32_16x16x32_bf16 a[60:63], v[180:183], v[28:31], a[60:63]
    v_exp_f32 v17, v77
    v_mfma_f32_16x16x32_bf16 a[60:63], v[164:167], v[24:27], a[60:63]
    v_cvt_pk_bf16_f32 v75, v18, v19
    v_lshlrev_b32 v48, 16, v61
    v_mfma_f32_16x16x32_bf16 a[108:111], v[168:171], v[24:27], a[108:111]
    ds_read_b128 v[44:47], v1 offset:17408
    v_and_b32 v49, s97, v61
    v_mfma_f32_16x16x32_bf16 a[108:111], v[184:187], v[28:31], a[108:111]
    v_exp_f32 v18, v78
    v_mfma_f32_16x16x32_bf16 a[156:159], v[188:191], v[28:31], a[156:159]
    s_add_u32 s29, s28, 49152
    v_add_f32 v8, v8, v16
    v_add_f32 v8, v8, v17
    v_mfma_f32_16x16x32_bf16 a[156:159], v[172:175], v[24:27], a[156:159]
    s_waitcnt lgkmcnt(2)
    v_exp_f32 v19, v79
    v_mfma_f32_16x16x32_bf16 a[16:19], v[160:163], v[32:35], a[16:19]
    s_sub_u32 s3, s29, 147456
    ds_read_b128 v[24:27], v1 offset:6144
    v_lshlrev_b32 v50, 16, v63
    v_mfma_f32_16x16x32_bf16 a[16:19], v[176:179], v[36:39], a[16:19]
    s_add_u32 s56, s56, 12288
    v_cvt_pk_bf16_f32 v76, v16, v17
    v_and_b32 v51, s97, v63
    v_mfma_f32_16x16x32_bf16 a[64:67], v[180:183], v[36:39], a[64:67]
    s_min_u32 s29, s29, s3
    v_exp_f32 v16, v108
    v_mfma_f32_16x16x32_bf16 a[64:67], v[164:167], v[32:35], a[64:67]
    s_mov_b32 m0, s56
    v_add_f32 v8, v8, v18
    v_add_f32 v8, v8, v19
    v_mfma_f32_16x16x32_bf16 a[112:115], v[168:171], v[32:35], a[112:115]
    ds_read_b128 v[28:31], v1 offset:18432
    v_mul_f32_e64 v50, -v50, v48
    v_mfma_f32_16x16x32_bf16 a[112:115], v[184:187], v[36:39], a[112:115]
    v_exp_f32 v17, v109
    v_mfma_f32_16x16x32_bf16 a[160:163], v[188:191], v[36:39], a[160:163]
    v_cvt_pk_bf16_f32 v77, v18, v19
    v_mul_f32_e64 v51, -v51, v49
    v_mfma_f32_16x16x32_bf16 a[160:163], v[172:175], v[32:35], a[160:163]
    s_waitcnt lgkmcnt(2)
    v_exp_f32 v18, v110
    v_mfma_f32_16x16x32_bf16 a[20:23], v[160:163], v[40:43], a[20:23]
    s_sub_u32 s3, s29, s28
    ds_read_b128 v[32:35], v1 offset:7168
    v_add_f32 v8, v8, v16
    v_mfma_f32_16x16x32_bf16 a[20:23], v[176:179], v[44:47], a[20:23]
    v_add_f32 v8, v8, v17
    v_cvt_f32_i32 v248, v248
    v_mfma_f32_16x16x32_bf16 a[68:71], v[180:183], v[44:47], a[68:71]
    v_exp_f32 v19, v111
    v_mfma_f32_16x16x32_bf16 a[68:71], v[164:167], v[40:43], a[68:71]
    buffer_load_dwordx4 v4, s[4:7], s27 offen offset:0 sc1 lds
    v_mfma_f32_16x16x32_bf16 a[116:119], v[168:171], v[40:43], a[116:119]
    ds_read_b128 v[36:39], v1 offset:19456
    v_cvt_pk_bf16_f32 v78, v16, v17
    v_mfma_f32_16x16x32_bf16 a[116:119], v[184:187], v[44:47], a[116:119]
    v_add_f32 v8, v8, v18
    v_cvt_f32_i32 v252, v252
    v_mfma_f32_16x16x32_bf16 a[164:167], v[188:191], v[44:47], a[164:167]
    s_mov_b32 s28, s29
    v_add_f32 v8, v8, v19
    v_cvt_pk_bf16_f32 v79, v18, v19
    v_mfma_f32_16x16x32_bf16 a[164:167], v[172:175], v[40:43], a[164:167]
    s_waitcnt lgkmcnt(2)
    v_exp_f32 v16, v80
    v_mfma_f32_16x16x32_bf16 a[24:27], v[160:163], v[24:27], a[24:27]
    ds_read_b128 v[40:43], v1 offset:8192
    v_fma_f32 v248, v248, v48, v50
    v_mfma_f32_16x16x32_bf16 a[24:27], v[176:179], v[28:31], a[24:27]
    v_exp_f32 v17, v81
    v_mfma_f32_16x16x32_bf16 a[72:75], v[180:183], v[28:31], a[72:75]
    v_fma_f32 v252, v252, v49, v51
    v_cvt_f32_i32 v249, v249
    v_mfma_f32_16x16x32_bf16 a[72:75], v[164:167], v[24:27], a[72:75]
    buffer_load_dwordx4 v4, s[4:7], s27 offen offset:1024 sc1 lds
    v_mfma_f32_16x16x32_bf16 a[120:123], v[168:171], v[24:27], a[120:123]
    ds_read_b128 v[44:47], v1 offset:20480
    v_cvt_f32_i32 v253, v253
    v_mfma_f32_16x16x32_bf16 a[120:123], v[184:187], v[28:31], a[120:123]
    v_exp_f32 v18, v82
    v_mfma_f32_16x16x32_bf16 a[168:171], v[188:191], v[28:31], a[168:171]
    v_add_f32 v5, v5, v16
    v_add_f32 v5, v5, v17
    v_mfma_f32_16x16x32_bf16 a[168:171], v[172:175], v[24:27], a[168:171]
    s_waitcnt lgkmcnt(2)
    v_exp_f32 v19, v83
    v_mfma_f32_16x16x32_bf16 a[28:31], v[160:163], v[32:35], a[28:31]
    ds_read_b128 v[24:27], v1 offset:9216
    v_cvt_pk_bf16_f32 v80, v16, v17
    v_mfma_f32_16x16x32_bf16 a[28:31], v[176:179], v[36:39], a[28:31]
    v_exp_f32 v16, v112
    v_mfma_f32_16x16x32_bf16 a[76:79], v[180:183], v[36:39], a[76:79]
    v_add_f32 v5, v5, v18
    v_fma_f32 v249, v249, v48, v50
    v_mfma_f32_16x16x32_bf16 a[76:79], v[164:167], v[32:35], a[76:79]
    v_add_f32 v5, v5, v19
    v_add_u32 v2, s3, v2
    v_mfma_f32_16x16x32_bf16 a[124:127], v[168:171], v[32:35], a[124:127]
    ds_read_b128 v[28:31], v1 offset:21504
    v_fma_f32 v253, v253, v49, v51
    v_mfma_f32_16x16x32_bf16 a[124:127], v[184:187], v[36:39], a[124:127]
    buffer_load_dwordx4 v4, s[4:7], s27 offen offset:2048 sc1 lds
    v_mfma_f32_16x16x32_bf16 a[172:175], v[188:191], v[36:39], a[172:175]
    v_exp_f32 v17, v113
    v_mfma_f32_16x16x32_bf16 a[172:175], v[172:175], v[32:35], a[172:175]
    s_waitcnt lgkmcnt(2)
    v_cvt_pk_bf16_f32 v81, v18, v19
    v_cvt_f32_i32 v250, v250
    v_mfma_f32_16x16x32_bf16 a[32:35], v[160:163], v[40:43], a[32:35]
    ds_read_b128 v[32:35], v1 offset:10240
    v_add_u32 v3, s3, v3
    v_mfma_f32_16x16x32_bf16 a[32:35], v[176:179], v[44:47], a[32:35]
    v_exp_f32 v18, v114
    v_mfma_f32_16x16x32_bf16 a[80:83], v[180:183], v[44:47], a[80:83]
    v_add_f32 v5, v5, v16
    v_add_f32 v5, v5, v17
    v_mfma_f32_16x16x32_bf16 a[80:83], v[164:167], v[40:43], a[80:83]
    v_exp_f32 v19, v115
    v_mfma_f32_16x16x32_bf16 a[128:131], v[168:171], v[40:43], a[128:131]
    ds_read_b128 v[36:39], v1 offset:22528
    v_cvt_pk_bf16_f32 v82, v16, v17
    v_mfma_f32_16x16x32_bf16 a[128:131], v[184:187], v[44:47], a[128:131]
    v_exp_f32 v16, v84
    v_mfma_f32_16x16x32_bf16 a[176:179], v[188:191], v[44:47], a[176:179]
    v_cvt_f32_i32 v254, v254
    v_add_f32 v5, v5, v18
    v_mfma_f32_16x16x32_bf16 a[176:179], v[172:175], v[40:43], a[176:179]
    s_waitcnt lgkmcnt(2)
    v_add_f32 v5, v5, v19
    v_fma_f32 v250, v250, v48, v50
    v_mfma_f32_16x16x32_bf16 a[36:39], v[160:163], v[24:27], a[36:39]
    ds_read_b128 v[40:43], v1 offset:11264
    v_fma_f32 v254, v254, v49, v51
    v_mfma_f32_16x16x32_bf16 a[36:39], v[176:179], v[28:31], a[36:39]
    v_exp_f32 v17, v85
    v_mfma_f32_16x16x32_bf16 a[84:87], v[180:183], v[28:31], a[84:87]
    v_cvt_pk_bf16_f32 v83, v18, v19
    v_cvt_pk_bf16_f32 v146, v240, v244
    v_mfma_f32_16x16x32_bf16 a[84:87], v[164:167], v[24:27], a[84:87]
    s_add_u32 s27, s27, 24576
    v_exp_f32 v18, v86
    v_mfma_f32_16x16x32_bf16 a[132:135], v[168:171], v[24:27], a[132:135]
    s_add_u32 s56, s56, 36864
    ds_read_b128 v[44:47], v1 offset:23552
    v_add_f32 v6, v6, v16
    v_mfma_f32_16x16x32_bf16 a[132:135], v[184:187], v[28:31], a[132:135]
    s_sub_u32 s58, s56, 147456
    v_add_f32 v6, v6, v17
    v_cvt_pk_bf16_f32 v150, v241, v245
    v_mfma_f32_16x16x32_bf16 a[180:183], v[188:191], v[28:31], a[180:183]
    v_exp_f32 v19, v87
    v_mfma_f32_16x16x32_bf16 a[180:183], v[172:175], v[24:27], a[180:183]
    s_waitcnt lgkmcnt(2)
    v_cvt_pk_bf16_f32 v84, v16, v17
    v_cvt_pk_bf16_f32 v147, v248, v252
    v_mfma_f32_16x16x32_bf16 a[40:43], v[160:163], v[32:35], a[40:43]
    s_min_u32 s56, s56, s58
    ds_read_b128 v[24:27], v2 offset:0
    v_mfma_f32_16x16x32_bf16 a[40:43], v[176:179], v[36:39], a[40:43]
    v_exp_f32 v16, v116
    v_mfma_f32_16x16x32_bf16 a[88:91], v[180:183], v[36:39], a[88:91]
    v_add_f32 v6, v6, v18
    v_add_f32 v6, v6, v19
    v_mfma_f32_16x16x32_bf16 a[88:91], v[164:167], v[32:35], a[88:91]
    v_exp_f32 v17, v117
    v_mfma_f32_16x16x32_bf16 a[136:139], v[168:171], v[32:35], a[136:139]
    ds_read_b128 v[28:31], v3 offset:0
    v_cvt_pk_bf16_f32 v151, v249, v253
    v_mfma_f32_16x16x32_bf16 a[136:139], v[184:187], v[36:39], a[136:139]
    v_cvt_pk_bf16_f32 v85, v18, v19
    v_cvt_pk_bf16_f32 v154, v242, v246
    v_mfma_f32_16x16x32_bf16 a[184:187], v[188:191], v[36:39], a[184:187]
    v_exp_f32 v18, v118
    v_mfma_f32_16x16x32_bf16 a[184:187], v[172:175], v[32:35], a[184:187]
    s_waitcnt lgkmcnt(2)
    v_add_f32 v6, v6, v16
    v_mfma_f32_16x16x32_bf16 a[44:47], v[160:163], v[40:43], a[44:47]
    ds_read_b128 v[32:35], v2 offset:6144
    v_add_f32 v6, v6, v17
    v_mfma_f32_16x16x32_bf16 a[44:47], v[176:179], v[44:47], a[44:47]
    v_exp_f32 v19, v119
    v_mfma_f32_16x16x32_bf16 a[92:95], v[180:183], v[44:47], a[92:95]
    v_cvt_pk_bf16_f32 v155, v250, v254
    v_mfma_f32_16x16x32_bf16 a[92:95], v[164:167], v[40:43], a[92:95]
    v_cvt_pk_bf16_f32 v86, v16, v17
    v_mfma_f32_16x16x32_bf16 a[140:143], v[168:171], v[40:43], a[140:143]
    ds_read_b128 v[36:39], v3 offset:6144
    v_add_f32 v6, v6, v18
    v_mfma_f32_16x16x32_bf16 a[140:143], v[184:187], v[44:47], a[140:143]
    v_add_f32 v6, v6, v19
    v_cvt_pk_bf16_f32 v87, v18, v19
    v_mfma_f32_16x16x32_bf16 a[188:191], v[188:191], v[44:47], a[188:191]
    v_mfma_f32_16x16x32_bf16 a[188:191], v[172:175], v[40:43], a[188:191]
    s_waitcnt lgkmcnt(2)
    v_mfma_f32_16x16x32_bf16 v[160:163], v[24:27], a[192:195], v[128:131]
    ds_read_b128 v[40:43], v2 offset:128
    v_mfma_f32_16x16x32_bf16 v[160:163], v[28:31], a[196:199], v[160:163]
    s_waitcnt vmcnt(4)
    v_subrev_u32 v52, s92, v52
    v_cmp_lt_u32 vcc, 15, v52
    v_mfma_f32_16x16x32_bf16 v[164:167], v[28:31], a[220:223], v[132:135]
    v_exp_f32 v16, v88
    v_mfma_f32_16x16x32_bf16 v[164:167], v[24:27], a[216:219], v[164:167]
    v_exp_f32 v17, v89
    v_mfma_f32_16x16x32_bf16 v[168:171], v[24:27], a[240:243], v[136:139]
    s_and_b32 s59, vcc_lo, 0xff
    ds_read_b128 v[44:47], v3 offset:128
    v_mfma_f32_16x16x32_bf16 v[168:171], v[28:31], a[244:247], v[168:171]
    s_cbranch_scc1 L_pollslow3
L_pollok3:
    v_mfma_f32_16x16x32_bf16 v[172:175], v[28:31], v[204:207], v[140:143]
    s_add_u32 s92, s92, 1
    v_exp_f32 v18, v90
    v_mfma_f32_16x16x32_bf16 v[172:175], v[24:27], v[200:203], v[172:175]
    s_waitcnt lgkmcnt(2)
    v_add_f32 v7, v7, v16
    v_add_f32 v7, v7, v17
    v_mfma_f32_16x16x32_bf16 v[96:99], v[32:35], a[192:195], v[128:131]
    ds_read_b128 v[24:27], v2 offset:6272
    v_mfma_f32_16x16x32_bf16 v[96:99], v[36:39], a[196:199], v[96:99]
    buffer_store_dwordx4 v[144:147], v15, s[4:7], s35 offen offset:0 sc1
    v_mfma_f32_16x16x32_bf16 v[100:103], v[36:39], a[220:223], v[132:135]
    v_exp_f32 v19, v91
    v_mfma_f32_16x16x32_bf16 v[100:103], v[32:35], a[216:219], v[100:103]
    v_cvt_pk_bf16_f32 v88, v16, v17
    v_mfma_f32_16x16x32_bf16 v[104:107], v[32:35], a[240:243], v[136:139]
    ds_read_b128 v[28:31], v3 offset:6272
    v_mfma_f32_16x16x32_bf16 v[104:107], v[36:39], a[244:247], v[104:107]
    v_exp_f32 v16, v120
    v_mfma_f32_16x16x32_bf16 v[108:111], v[36:39], v[204:207], v[140:143]
    v_add_f32 v7, v7, v18
    v_add_f32 v7, v7, v19
    v_mfma_f32_16x16x32_bf16 v[108:111], v[32:35], v[200:203], v[108:111]
    s_waitcnt lgkmcnt(2)
    v_exp_f32 v17, v121
    v_mfma_f32_16x16x32_bf16 v[160:163], v[40:43], a[200:203], v[160:163]
    ds_read_b128 v[32:35], v2 offset:256
    v_cvt_pk_bf16_f32 v89, v18, v19
    v_mfma_f32_16x16x32_bf16 v[160:163], v[44:47], a[204:207], v[160:163]
    buffer_store_dwordx4 v[148:151], v15, s[4:7], s35 offen offset:1024 sc1
    v_mfma_f32_16x16x32_bf16 v[164:167], v[44:47], a[228:231], v[164:167]
    v_exp_f32 v18, v122
    v_mfma_f32_16x16x32_bf16 v[164:167], v[40:43], a[224:227], v[164:167]
    v_add_f32 v7, v7, v16
    v_add_f32 v7, v7, v17
    v_mfma_f32_16x16x32_bf16 v[168:171], v[40:43], a[248:251], v[168:171]
    ds_read_b128 v[36:39], v3 offset:256
    v_mfma_f32_16x16x32_bf16 v[168:171], v[44:47], a[252:255], v[168:171]
    v_exp_f32 v19, v123
    v_mfma_f32_16x16x32_bf16 v[172:175], v[44:47], v[212:215], v[172:175]
    v_cvt_pk_bf16_f32 v90, v16, v17
    v_mfma_f32_16x16x32_bf16 v[172:175], v[40:43], v[208:211], v[172:175]
    s_waitcnt lgkmcnt(2)
    v_exp_f32 v16, v92
    v_mfma_f32_16x16x32_bf16 v[96:99], v[24:27], a[200:203], v[96:99]
    ds_read_b128 v[40:43], v2 offset:6400
    v_add_f32 v7, v7, v18
    v_mfma_f32_16x16x32_bf16 v[96:99], v[28:31], a[204:207], v[96:99]
    buffer_store_dwordx4 v[152:155], v15, s[4:7], s35 offen offset:2048 sc1
    v_mfma_f32_16x16x32_bf16 v[100:103], v[28:31], a[228:231], v[100:103]
    v_add_f32 v7, v7, v19
    v_mfma_f32_16x16x32_bf16 v[100:103], v[24:27], a[224:227], v[100:103]
    v_exp_f32 v17, v93
    v_mfma_f32_16x16x32_bf16 v[104:107], v[24:27], a[248:251], v[104:107]
    ds_read_b128 v[44:47], v3 offset:6400
    v_cvt_pk_bf16_f32 v91, v18, v19
    v_mfma_f32_16x16x32_bf16 v[104:107], v[28:31], a[252:255], v[104:107]
    v_exp_f32 v18, v94
    v_mfma_f32_16x16x32_bf16 v[108:111], v[28:31], v[212:215], v[108:111]
    s_add_u32 s29, s30, 49152
    v_add_f32 v8, v8, v16
    v_add_f32 v8, v8, v17
    v_mfma_f32_16x16x32_bf16 v[108:111], v[24:27], v[208:211], v[108:111]
    s_waitcnt lgkmcnt(2)
    v_exp_f32 v19, v95
    v_mfma_f32_16x16x32_bf16 v[160:163], v[32:35], a[208:211], v[160:163]
    s_sub_u32 s3, s29, 147456
    ds_read_b128 v[24:27], v2 offset:12288
    v_cvt_pk_bf16_f32 v92, v16, v17
    v_mfma_f32_16x16x32_bf16 v[160:163], v[36:39], a[212:215], v[160:163]
    s_min_u32 s29, s29, s3
    v_exp_f32 v16, v124
    v_mfma_f32_16x16x32_bf16 v[164:167], v[36:39], a[236:239], v[164:167]
    v_add_f32 v8, v8, v18
    v_add_f32 v8, v8, v19
    v_mfma_f32_16x16x32_bf16 v[164:167], v[32:35], a[232:235], v[164:167]
    v_exp_f32 v17, v125
    v_mfma_f32_16x16x32_bf16 v[168:171], v[32:35], v[192:195], v[168:171]
    ds_read_b128 v[28:31], v3 offset:12288
    v_mfma_f32_16x16x32_bf16 v[168:171], v[36:39], v[196:199], v[168:171]
    v_cvt_pk_bf16_f32 v93, v18, v19
    v_mfma_f32_16x16x32_bf16 v[172:175], v[36:39], v[220:223], v[172:175]
    v_exp_f32 v18, v126
    v_mfma_f32_16x16x32_bf16 v[172:175], v[32:35], v[216:219], v[172:175]
    s_waitcnt lgkmcnt(2)
    v_add_f32 v8, v8, v16
    v_mfma_f32_16x16x32_bf16 v[96:99], v[40:43], a[208:211], v[96:99]
    ds_read_b128 v[32:35], v2 offset:18432
    v_add_f32 v8, v8, v17
    v_mfma_f32_16x16x32_bf16 v[96:99], v[44:47], a[212:215], v[96:99]
    s_mov_b32 m0, s26
    v_exp_f32 v19, v127
    v_mfma_f32_16x16x32_bf16 v[100:103], v[44:47], a[236:239], v[100:103]
    s_sub_u32 s3, s29, s30
    v_mfma_f32_16x16x32_bf16 v[100:103], v[40:43], a[232:235], v[100:103]
    buffer_load_dwordx4 v4, s[4:7], s32 offen offset:0 sc1 lds
    v_mfma_f32_16x16x32_bf16 v[104:107], v[40:43], v[192:195], v[104:107]
    ds_read_b128 v[36:39], v3 offset:18432
    v_cvt_pk_bf16_f32 v94, v16, v17
    v_mfma_f32_16x16x32_bf16 v[104:107], v[44:47], v[196:199], v[104:107]
    v_add_f32 v8, v8, v18
    v_add_f32 v8, v8, v19
    v_mfma_f32_16x16x32_bf16 v[108:111], v[44:47], v[220:223], v[108:111]
    v_cvt_pk_bf16_f32 v95, v18, v19
    v_mfma_f32_16x16x32_bf16 v[108:111], v[40:43], v[216:219], v[108:111]
    s_waitcnt lgkmcnt(2)
    buffer_load_dwordx4 v4, s[4:7], s32 offen offset:1024 sc1 lds
    v_mfma_f32_16x16x32_bf16 v[176:179], v[24:27], a[192:195], v[128:131]
    ds_read_b128 v[40:43], v2 offset:12416
    v_mfma_f32_16x16x32_bf16 v[176:179], v[28:31], a[196:199], v[176:179]
    s_mov_b32 s30, s29
    v_exp_f32 v16, v160
    v_mfma_f32_16x16x32_bf16 v[180:183], v[28:31], a[220:223], v[132:135]
    v_exp_f32 v17, v161
    v_mfma_f32_16x16x32_bf16 v[180:183], v[24:27], a[216:219], v[180:183]
    buffer_load_dwordx4 v4, s[4:7], s32 offen offset:2048 sc1 lds
    v_mfma_f32_16x16x32_bf16 v[184:187], v[24:27], a[240:243], v[136:139]
    s_add_u32 s32, s32, 24576
    ds_read_b128 v[44:47], v3 offset:12416
    v_mfma_f32_16x16x32_bf16 v[184:187], v[28:31], a[244:247], v[184:187]
    v_exp_f32 v18, v162
    v_mfma_f32_16x16x32_bf16 v[188:191], v[28:31], v[204:207], v[140:143]
    s_add_u32 s26, s26, 12288
    v_add_f32 v5, v5, v16
    v_add_f32 v5, v5, v17
    v_mfma_f32_16x16x32_bf16 v[188:191], v[24:27], v[200:203], v[188:191]
    s_waitcnt lgkmcnt(2)
    v_exp_f32 v19, v163
    v_mfma_f32_16x16x32_bf16 v[112:115], v[32:35], a[192:195], v[128:131]
    s_mov_b32 m0, s26
    ds_read_b128 v[24:27], v2 offset:18560
    v_cvt_pk_bf16_f32 v160, v16, v17
    v_mfma_f32_16x16x32_bf16 v[112:115], v[36:39], a[196:199], v[112:115]
L_pg9:
    s_cbranch_execz L_pg13
    v_exp_f32 v16, v96
    v_mfma_f32_16x16x32_bf16 v[116:119], v[36:39], a[220:223], v[132:135]
    v_add_f32 v5, v5, v18
    v_add_f32 v5, v5, v19
    v_mfma_f32_16x16x32_bf16 v[116:119], v[32:35], a[216:219], v[116:119]
    v_exp_f32 v17, v97
    v_mfma_f32_16x16x32_bf16 v[120:123], v[32:35], a[240:243], v[136:139]
    ds_read_b128 v[28:31], v3 offset:18560
    v_add_u32 v1, s3, v1
    v_mfma_f32_16x16x32_bf16 v[120:123], v[36:39], a[244:247], v[120:123]
    buffer_load_dwordx4 v4, s[4:7], s32 offen offset:0 sc1 lds
    v_mfma_f32_16x16x32_bf16 v[124:127], v[36:39], v[204:207], v[140:143]
    v_cvt_pk_bf16_f32 v161, v18, v19
    v_mfma_f32_16x16x32_bf16 v[124:127], v[32:35], v[200:203], v[124:127]
    s_waitcnt lgkmcnt(2)
    v_exp_f32 v18, v98
    v_mfma_f32_16x16x32_bf16 v[176:179], v[40:43], a[200:203], v[176:179]
    ds_read_b128 v[32:35], v2 offset:12544
    v_add_f32 v5, v5, v16
    v_mfma_f32_16x16x32_bf16 v[176:179], v[44:47], a[204:207], v[176:179]
    buffer_load_dwordx4 v4, s[4:7], s32 offen offset:1024 sc1 lds
    v_mfma_f32_16x16x32_bf16 v[180:183], v[44:47], a[228:231], v[180:183]
    v_add_f32 v5, v5, v17
    v_mfma_f32_16x16x32_bf16 v[180:183], v[40:43], a[224:227], v[180:183]
    v_exp_f32 v19, v99
    v_mfma_f32_16x16x32_bf16 v[184:187], v[40:43], a[248:251], v[184:187]
    ds_read_b128 v[36:39], v3 offset:12544
    v_cvt_pk_bf16_f32 v162, v16, v17
    v_mfma_f32_16x16x32_bf16 v[184:187], v[44:47], a[252:255], v[184:187]
    buffer_load_dwordx4 v4, s[4:7], s32 offen offset:2048 sc1 lds
    v_mfma_f32_16x16x32_bf16 v[188:191], v[44:47], v[212:215], v[188:191]
    v_exp_f32 v16, v164
    v_mfma_f32_16x16x32_bf16 v[188:191], v[40:43], v[208:211], v[188:191]
    s_waitcnt lgkmcnt(2)
    v_add_f32 v5, v5, v18
    v_add_f32 v5, v5, v19
    v_mfma_f32_16x16x32_bf16 v[112:115], v[24:27], a[200:203], v[112:115]
    ds_read_b128 v[40:43], v2 offset:18688
    v_mfma_f32_16x16x32_bf16 v[112:115], v[28:31], a[204:207], v[112:115]
    v_exp_f32 v17, v165
    v_mfma_f32_16x16x32_bf16 v[116:119], v[28:31], a[228:231], v[116:119]
    v_cvt_pk_bf16_f32 v163, v18, v19
    v_mfma_f32_16x16x32_bf16 v[116:119], v[24:27], a[224:227], v[116:119]
    s_add_u32 s32, s32, 24576
    v_exp_f32 v18, v166
    v_mfma_f32_16x16x32_bf16 v[120:123], v[24:27], a[248:251], v[120:123]
    s_add_u32 s26, s26, 36864
    ds_read_b128 v[44:47], v3 offset:18688
    v_add_f32 v6, v6, v16
    v_mfma_f32_16x16x32_bf16 v[120:123], v[28:31], a[252:255], v[120:123]
    s_waitcnt lgkmcnt(2)
    v_add_f32 v6, v6, v17
    s_sub_u32 s57, s26, 147456
    v_mfma_f32_16x16x32_bf16 v[124:127], v[28:31], v[212:215], v[124:127]
    s_waitcnt vmcnt(6)
    v_exp_f32 v19, v167
    v_mfma_f32_16x16x32_bf16 v[124:127], v[24:27], v[208:211], v[124:127]
    s_barrier
    v_mfma_f32_16x16x32_bf16 v[176:179], v[32:35], a[208:211], v[176:179]
    s_min_u32 s26, s26, s57
    ds_read_b128 v[24:27], v1 offset:0
    v_cvt_pk_bf16_f32 v164, v16, v17
    v_mfma_f32_16x16x32_bf16 v[176:179], v[36:39], a[212:215], v[176:179]
    v_exp_f32 v16, v100
    v_mfma_f32_16x16x32_bf16 v[180:183], v[36:39], a[236:239], v[180:183]
    v_add_u32 v0, 1, v0
    v_add_f32 v6, v6, v18
    v_mfma_f32_16x16x32_bf16 v[180:183], v[32:35], a[232:235], v[180:183]
    buffer_store_dword v0, v13, s[20:23], 0 offen offset:32 sc1
    v_mfma_f32_16x16x32_bf16 v[184:187], v[32:35], v[192:195], v[184:187]
    ds_read_b128 v[28:31], v1 offset:12288
    v_add_f32 v6, v6, v19
    v_mfma_f32_16x16x32_bf16 v[184:187], v[36:39], v[196:199], v[184:187]
    v_exp_f32 v17, v101
    v_mfma_f32_16x16x32_bf16 v[188:191], v[36:39], v[220:223], v[188:191]
    v_cvt_pk_bf16_f32 v165, v18, v19
    v_mfma_f32_16x16x32_bf16 v[188:191], v[32:35], v[216:219], v[188:191]
    s_waitcnt lgkmcnt(2)
    v_exp_f32 v18, v102
    v_mfma_f32_16x16x32_bf16 v[112:115], v[40:43], a[208:211], v[112:115]
    ds_read_b128 v[32:35], v1 offset:1024
    v_add_f32 v6, v6, v16
    v_mfma_f32_16x16x32_bf16 v[112:115], v[44:47], a[212:215], v[112:115]
    v_add_f32 v6, v6, v17
    v_mfma_f32_16x16x32_bf16 v[116:119], v[44:47], a[236:239], v[116:119]
    v_exp_f32 v19, v103
    v_mfma_f32_16x16x32_bf16 v[116:119], v[40:43], a[232:235], v[116:119]
    v_cvt_pk_bf16_f32 v166, v16, v17
    v_mfma_f32_16x16x32_bf16 v[120:123], v[40:43], v[192:195], v[120:123]
    ds_read_b128 v[36:39], v1 offset:13312
    v_add_f32 v6, v6, v18
    v_mfma_f32_16x16x32_bf16 v[120:123], v[44:47], v[196:199], v[120:123]
    v_add_f32 v6, v6, v19
    v_cvt_pk_bf16_f32 v167, v18, v19
    v_mfma_f32_16x16x32_bf16 v[124:127], v[44:47], v[220:223], v[124:127]
    v_mfma_f32_16x16x32_bf16 v[124:127], v[40:43], v[216:219], v[124:127]
    s_waitcnt lgkmcnt(2)
    v_mfma_f32_16x16x32_bf16 a[0:3], v[64:67], v[24:27], a[0:3]
    s_mov_b32 m0, s26
    ds_read_b128 v[40:43], v1 offset:2048
    v_mfma_f32_16x16x32_bf16 a[0:3], v[80:83], v[28:31], a[0:3]
    buffer_load_dwordx4 v4, s[4:7], s32 offen offset:0 sc1 lds
    v_mfma_f32_16x16x32_bf16 a[48:51], v[84:87], v[28:31], a[48:51]
    v_exp_f32 v16, v168
    v_mfma_f32_16x16x32_bf16 a[48:51], v[68:71], v[24:27], a[48:51]
    v_exp_f32 v17, v169
    v_mfma_f32_16x16x32_bf16 a[96:99], v[72:75], v[24:27], a[96:99]
    ds_read_b128 v[44:47], v1 offset:14336
    v_mfma_f32_16x16x32_bf16 a[96:99], v[88:91], v[28:31], a[96:99]
    v_exp_f32 v18, v170
    v_mfma_f32_16x16x32_bf16 a[144:147], v[92:95], v[28:31], a[144:147]
    v_add_f32 v7, v7, v16
    v_add_f32 v7, v7, v17
    v_mfma_f32_16x16x32_bf16 a[144:147], v[76:79], v[24:27], a[144:147]
    s_waitcnt lgkmcnt(2)
    v_exp_f32 v19, v171
    v_mfma_f32_16x16x32_bf16 a[4:7], v[64:67], v[32:35], a[4:7]
    ds_read_b128 v[24:27], v1 offset:3072
    v_cvt_pk_bf16_f32 v168, v16, v17
    v_mfma_f32_16x16x32_bf16 a[4:7], v[80:83], v[36:39], a[4:7]
    v_exp_f32 v16, v104
    v_mfma_f32_16x16x32_bf16 a[52:55], v[84:87], v[36:39], a[52:55]
    v_add_f32 v7, v7, v18
    v_add_f32 v7, v7, v19
    v_mfma_f32_16x16x32_bf16 a[52:55], v[68:71], v[32:35], a[52:55]
    buffer_load_dwordx4 v4, s[4:7], s32 offen offset:1024 sc1 lds
    v_mfma_f32_16x16x32_bf16 a[100:103], v[72:75], v[32:35], a[100:103]
    ds_read_b128 v[28:31], v1 offset:15360
    v_mfma_f32_16x16x32_bf16 a[100:103], v[88:91], v[36:39], a[100:103]
    v_exp_f32 v17, v105
    v_mfma_f32_16x16x32_bf16 a[148:151], v[92:95], v[36:39], a[148:151]
    v_cvt_pk_bf16_f32 v169, v18, v19
    v_mfma_f32_16x16x32_bf16 a[148:151], v[76:79], v[32:35], a[148:151]
    s_waitcnt lgkmcnt(2)
    v_exp_f32 v18, v106
    v_mfma_f32_16x16x32_bf16 a[8:11], v[64:67], v[40:43], a[8:11]
    ds_read_b128 v[32:35], v1 offset:4096
    v_add_f32 v7, v7, v16
    v_mfma_f32_16x16x32_bf16 a[8:11], v[80:83], v[44:47], a[8:11]
    v_add_f32 v7, v7, v17
    v_mfma_f32_16x16x32_bf16 a[56:59], v[84:87], v[44:47], a[56:59]
    v_exp_f32 v19, v107
    v_mfma_f32_16x16x32_bf16 a[56:59], v[68:71], v[40:43], a[56:59]
    v_cvt_pk_bf16_f32 v170, v16, v17
    v_mfma_f32_16x16x32_bf16 a[104:107], v[72:75], v[40:43], a[104:107]
    ds_read_b128 v[36:39], v1 offset:16384
    v_mfma_f32_16x16x32_bf16 a[104:107], v[88:91], v[44:47], a[104:107]
    v_exp_f32 v16, v172
    v_mfma_f32_16x16x32_bf16 a[152:155], v[92:95], v[44:47], a[152:155]
    v_add_f32 v7, v7, v18
    v_add_f32 v7, v7, v19
    v_mfma_f32_16x16x32_bf16 a[152:155], v[76:79], v[40:43], a[152:155]
    s_waitcnt lgkmcnt(2)
    buffer_load_dwordx4 v4, s[4:7], s32 offen offset:2048 sc1 lds
    v_mfma_f32_16x16x32_bf16 a[12:15], v[64:67], v[24:27], a[12:15]
    ds_read_b128 v[40:43], v1 offset:5120
    v_mfma_f32_16x16x32_bf16 a[12:15], v[80:83], v[28:31], a[12:15]
    v_exp_f32 v17, v173
    v_mfma_f32_16x16x32_bf16 a[60:63], v[84:87], v[28:31], a[60:63]
    v_cvt_pk_bf16_f32 v171, v18, v19
    v_mfma_f32_16x16x32_bf16 a[60:63], v[68:71], v[24:27], a[60:63]
    v_exp_f32 v18, v174
    v_mfma_f32_16x16x32_bf16 a[108:111], v[72:75], v[24:27], a[108:111]
    ds_read_b128 v[44:47], v1 offset:17408
    v_add_f32 v8, v8, v16
    v_mfma_f32_16x16x32_bf16 a[108:111], v[88:91], v[28:31], a[108:111]
    v_add_f32 v8, v8, v17
    v_mfma_f32_16x16x32_bf16 a[156:159], v[92:95], v[28:31], a[156:159]
    s_add_u32 s29, s28, 49152
    v_exp_f32 v19, v175
    v_mfma_f32_16x16x32_bf16 a[156:159], v[76:79], v[24:27], a[156:159]
    s_waitcnt lgkmcnt(2)
    v_cvt_pk_bf16_f32 v172, v16, v17
    s_sub_u32 s3, s29, 147456
    v_mfma_f32_16x16x32_bf16 a[16:19], v[64:67], v[32:35], a[16:19]
    s_add_u32 s32, s32, 24576
    ds_read_b128 v[24:27], v1 offset:6144
    v_mfma_f32_16x16x32_bf16 a[16:19], v[80:83], v[36:39], a[16:19]
    s_min_u32 s29, s29, s3
    v_exp_f32 v16, v108
    v_mfma_f32_16x16x32_bf16 a[64:67], v[84:87], v[36:39], a[64:67]
    v_add_f32 v8, v8, v18
    v_add_f32 v8, v8, v19
    v_mfma_f32_16x16x32_bf16 a[64:67], v[68:71], v[32:35], a[64:67]
    v_exp_f32 v17, v109
    v_mfma_f32_16x16x32_bf16 a[112:115], v[72:75], v[32:35], a[112:115]
    s_add_u32 s26, s26, 12288
    ds_read_b128 v[28:31], v1 offset:18432
    v_mfma_f32_16x16x32_bf16 a[112:115], v[88:91], v[36:39], a[112:115]
    v_cvt_pk_bf16_f32 v173, v18, v19
    v_mfma_f32_16x16x32_bf16 a[160:163], v[92:95], v[36:39], a[160:163]
    v_exp_f32 v18, v110
    v_mfma_f32_16x16x32_bf16 a[160:163], v[76:79], v[32:35], a[160:163]
    s_waitcnt lgkmcnt(2)
    v_add_f32 v8, v8, v16
    v_mfma_f32_16x16x32_bf16 a[20:23], v[64:67], v[40:43], a[20:23]
    s_sub_u32 s3, s29, s28
    ds_read_b128 v[32:35], v1 offset:7168
    v_add_f32 v8, v8, v17
    v_mfma_f32_16x16x32_bf16 a[20:23], v[80:83], v[44:47], a[20:23]
    v_exp_f32 v19, v111
    v_mfma_f32_16x16x32_bf16 a[68:71], v[84:87], v[44:47], a[68:71]
    s_mov_b32 m0, s26
    v_mfma_f32_16x16x32_bf16 a[68:71], v[68:71], v[40:43], a[68:71]
    v_cvt_pk_bf16_f32 v174, v16, v17
    v_mfma_f32_16x16x32_bf16 a[116:119], v[72:75], v[40:43], a[116:119]
    ds_read_b128 v[36:39], v1 offset:19456
    v_add_f32 v8, v8, v18
    v_mfma_f32_16x16x32_bf16 a[116:119], v[88:91], v[44:47], a[116:119]
    v_add_f32 v8, v8, v19
    v_cvt_pk_bf16_f32 v175, v18, v19
    v_mfma_f32_16x16x32_bf16 a[164:167], v[92:95], v[44:47], a[164:167]
    s_mov_b32 s28, s29
    v_mfma_f32_16x16x32_bf16 a[164:167], v[76:79], v[40:43], a[164:167]
    s_waitcnt lgkmcnt(2)
    v_exp_f32 v16, v176
    v_mfma_f32_16x16x32_bf16 a[24:27], v[64:67], v[24:27], a[24:27]
    ds_read_b128 v[40:43], v1 offset:8192
    v_mfma_f32_16x16x32_bf16 a[24:27], v[80:83], v[28:31], a[24:27]
    v_exp_f32 v17, v177
    v_mfma_f32_16x16x32_bf16 a[72:75], v[84:87], v[28:31], a[72:75]
    v_exp_f32 v18, v178
    v_mfma_f32_16x16x32_bf16 a[72:75], v[68:71], v[24:27], a[72:75]
    buffer_load_dwordx4 v4, s[4:7], s32 offen offset:0 sc1 lds
    v_mfma_f32_16x16x32_bf16 a[120:123], v[72:75], v[24:27], a[120:123]
    ds_read_b128 v[44:47], v1 offset:20480
    v_add_f32 v5, v5, v16
    v_mfma_f32_16x16x32_bf16 a[120:123], v[88:91], v[28:31], a[120:123]
    v_add_f32 v5, v5, v17
    v_add_u32 v2, s3, v2
    v_mfma_f32_16x16x32_bf16 a[168:171], v[92:95], v[28:31], a[168:171]
    v_exp_f32 v19, v179
    v_mfma_f32_16x16x32_bf16 a[168:171], v[76:79], v[24:27], a[168:171]
    s_waitcnt lgkmcnt(2)
    v_cvt_pk_bf16_f32 v176, v16, v17
    v_mfma_f32_16x16x32_bf16 a[28:31], v[64:67], v[32:35], a[28:31]
    ds_read_b128 v[24:27], v1 offset:9216
    v_mfma_f32_16x16x32_bf16 a[28:31], v[80:83], v[36:39], a[28:31]
    v_exp_f32 v16, v112
    v_mfma_f32_16x16x32_bf16 a[76:79], v[84:87], v[36:39], a[76:79]
    v_add_f32 v5, v5, v18
    v_add_f32 v5, v5, v19
    v_mfma_f32_16x16x32_bf16 a[76:79], v[68:71], v[32:35], a[76:79]
    v_exp_f32 v17, v113
    v_mfma_f32_16x16x32_bf16 a[124:127], v[72:75], v[32:35], a[124:127]
    ds_read_b128 v[28:31], v1 offset:21504
    v_add_u32 v3, s3, v3
    v_mfma_f32_16x16x32_bf16 a[124:127], v[88:91], v[36:39], a[124:127]
    v_cvt_pk_bf16_f32 v177, v18, v19
    v_mfma_f32_16x16x32_bf16 a[172:175], v[92:95], v[36:39], a[172:175]
    v_exp_f32 v18, v114
    v_mfma_f32_16x16x32_bf16 a[172:175], v[76:79], v[32:35], a[172:175]
    s_waitcnt lgkmcnt(2)
    buffer_load_dwordx4 v4, s[4:7], s32 offen offset:1024 sc1 lds
    v_mfma_f32_16x16x32_bf16 a[32:35], v[64:67], v[40:43], a[32:35]
    ds_read_b128 v[32:35], v1 offset:10240
    v_add_f32 v5, v5, v16
    v_mfma_f32_16x16x32_bf16 a[32:35], v[80:83], v[44:47], a[32:35]
    v_add_f32 v5, v5, v17
    v_mfma_f32_16x16x32_bf16 a[80:83], v[84:87], v[44:47], a[80:83]
    v_exp_f32 v19, v115
    v_mfma_f32_16x16x32_bf16 a[80:83], v[68:71], v[40:43], a[80:83]
    v_cvt_pk_bf16_f32 v178, v16, v17
    v_mfma_f32_16x16x32_bf16 a[128:131], v[72:75], v[40:43], a[128:131]
    ds_read_b128 v[36:39], v1 offset:22528
    v_mfma_f32_16x16x32_bf16 a[128:131], v[88:91], v[44:47], a[128:131]
    v_exp_f32 v16, v180
    v_mfma_f32_16x16x32_bf16 a[176:179], v[92:95], v[44:47], a[176:179]
    v_add_f32 v5, v5, v18
    v_add_f32 v5, v5, v19
    v_mfma_f32_16x16x32_bf16 a[176:179], v[76:79], v[40:43], a[176:179]
    s_waitcnt lgkmcnt(2)
    v_exp_f32 v17, v181
    v_mfma_f32_16x16x32_bf16 a[36:39], v[64:67], v[24:27], a[36:39]
    ds_read_b128 v[40:43], v1 offset:11264
    v_mfma_f32_16x16x32_bf16 a[36:39], v[80:83], v[28:31], a[36:39]
    buffer_load_dwordx4 v4, s[4:7], s32 offen offset:2048 sc1 lds
    v_mfma_f32_16x16x32_bf16 a[84:87], v[84:87], v[28:31], a[84:87]
    v_cvt_pk_bf16_f32 v179, v18, v19
    v_mfma_f32_16x16x32_bf16 a[84:87], v[68:71], v[24:27], a[84:87]
    v_exp_f32 v18, v182
    v_mfma_f32_16x16x32_bf16 a[132:135], v[72:75], v[24:27], a[132:135]
    ds_read_b128 v[44:47], v1 offset:23552
    v_add_f32 v6, v6, v16
    v_mfma_f32_16x16x32_bf16 a[132:135], v[88:91], v[28:31], a[132:135]
    s_waitcnt lgkmcnt(2)
    v_add_f32 v6, v6, v17
    v_mfma_f32_16x16x32_bf16 a[180:183], v[92:95], v[28:31], a[180:183]
    s_waitcnt vmcnt(7)
    v_exp_f32 v19, v183
    v_mfma_f32_16x16x32_bf16 a[180:183], v[76:79], v[24:27], a[180:183]
    s_barrier
    v_mfma_f32_16x16x32_bf16 a[40:43], v[64:67], v[32:35], a[40:43]
    ds_read_b128 v[24:27], v2 offset:0
    v_cvt_pk_bf16_f32 v180, v16, v17
    v_mfma_f32_16x16x32_bf16 a[40:43], v[80:83], v[36:39], a[40:43]
    v_exp_f32 v16, v116
    v_mfma_f32_16x16x32_bf16 a[88:91], v[84:87], v[36:39], a[88:91]
    v_add_f32 v6, v6, v18
    v_add_f32 v6, v6, v19
    v_mfma_f32_16x16x32_bf16 a[88:91], v[68:71], v[32:35], a[88:91]
    v_exp_f32 v17, v117
    v_mfma_f32_16x16x32_bf16 a[136:139], v[72:75], v[32:35], a[136:139]
    ds_read_b128 v[28:31], v3 offset:0
    v_mfma_f32_16x16x32_bf16 a[136:139], v[88:91], v[36:39], a[136:139]
    v_cvt_pk_bf16_f32 v181, v18, v19
    v_mfma_f32_16x16x32_bf16 a[184:187], v[92:95], v[36:39], a[184:187]
    v_exp_f32 v18, v118
    v_mfma_f32_16x16x32_bf16 a[184:187], v[76:79], v[32:35], a[184:187]
    s_waitcnt lgkmcnt(2)
    v_add_f32 v6, v6, v16
    v_mfma_f32_16x16x32_bf16 a[44:47], v[64:67], v[40:43], a[44:47]
    ds_read_b128 v[32:35], v2 offset:6144
    v_add_f32 v6, v6, v17
    v_mfma_f32_16x16x32_bf16 a[44:47], v[80:83], v[44:47], a[44:47]
    v_exp_f32 v19, v119
    v_mfma_f32_16x16x32_bf16 a[92:95], v[84:87], v[44:47], a[92:95]
    v_mfma_f32_16x16x32_bf16 a[92:95], v[68:71], v[40:43], a[92:95]
    s_add_u32 s32, s32, 24576
    s_add_u32 s26, s26, 36864
    v_cvt_pk_bf16_f32 v182, v16, v17
    v_mfma_f32_16x16x32_bf16 a[140:143], v[72:75], v[40:43], a[140:143]
    s_sub_u32 s57, s26, 147456
    ds_read_b128 v[36:39], v3 offset:6144
    v_add_f32 v6, v6, v18
    v_mfma_f32_16x16x32_bf16 a[140:143], v[88:91], v[44:47], a[140:143]
    s_min_u32 s26, s26, s57
    v_add_f32 v6, v6, v19
    v_cvt_pk_bf16_f32 v183, v18, v19
    v_mfma_f32_16x16x32_bf16 a[188:191], v[92:95], v[44:47], a[188:191]
    v_mfma_f32_16x16x32_bf16 a[188:191], v[76:79], v[40:43], a[188:191]
    s_waitcnt lgkmcnt(2)
    v_mfma_f32_16x16x32_bf16 v[64:67], v[24:27], a[192:195], v[128:131]
    ds_read_b128 v[40:43], v2 offset:128
    v_mfma_f32_16x16x32_bf16 v[64:67], v[28:31], a[196:199], v[64:67]
    v_exp_f32 v16, v184
    v_mfma_f32_16x16x32_bf16 v[68:71], v[28:31], a[220:223], v[132:135]
    v_exp_f32 v17, v185
    v_mfma_f32_16x16x32_bf16 v[68:71], v[24:27], a[216:219], v[68:71]
    buffer_load_dword v52, v20, s[20:23], s44 offen sc1
    v_mfma_f32_16x16x32_bf16 v[72:75], v[24:27], a[240:243], v[136:139]
    ds_read_b128 v[44:47], v3 offset:128
    v_mfma_f32_16x16x32_bf16 v[72:75], v[28:31], a[244:247], v[72:75]
    v_exp_f32 v18, v186
    v_mfma_f32_16x16x32_bf16 v[76:79], v[28:31], v[204:207], v[140:143]
    v_add_f32 v7, v7, v16
    v_add_f32 v7, v7, v17
    v_mfma_f32_16x16x32_bf16 v[76:79], v[24:27], v[200:203], v[76:79]
    s_waitcnt lgkmcnt(2)
    v_exp_f32 v19, v187
    v_mfma_f32_16x16x32_bf16 v[96:99], v[32:35], a[192:195], v[128:131]
    ds_read_b128 v[24:27], v2 offset:6272
    v_cvt_pk_bf16_f32 v184, v16, v17
    v_mfma_f32_16x16x32_bf16 v[96:99], v[36:39], a[196:199], v[96:99]
    v_exp_f32 v16, v120
    v_mfma_f32_16x16x32_bf16 v[100:103], v[36:39], a[220:223], v[132:135]
    v_add_f32 v7, v7, v18
    v_add_f32 v7, v7, v19
    v_mfma_f32_16x16x32_bf16 v[100:103], v[32:35], a[216:219], v[100:103]
    s_mov_b32 m0, s26
    v_exp_f32 v17, v121
    v_mfma_f32_16x16x32_bf16 v[104:107], v[32:35], a[240:243], v[136:139]
    ds_read_b128 v[28:31], v3 offset:6272
    v_mfma_f32_16x16x32_bf16 v[104:107], v[36:39], a[244:247], v[104:107]
    buffer_load_dwordx4 v4, s[4:7], s32 offen offset:0 sc1 lds
    v_mfma_f32_16x16x32_bf16 v[108:111], v[36:39], v[204:207], v[140:143]
    v_cvt_pk_bf16_f32 v185, v18, v19
    v_mfma_f32_16x16x32_bf16 v[108:111], v[32:35], v[200:203], v[108:111]
    s_waitcnt lgkmcnt(2)
    v_exp_f32 v18, v122
    v_mfma_f32_16x16x32_bf16 v[64:67], v[40:43], a[200:203], v[64:67]
    ds_read_b128 v[32:35], v2 offset:256
    v_add_f32 v7, v7, v16
    v_mfma_f32_16x16x32_bf16 v[64:67], v[44:47], a[204:207], v[64:67]
    v_add_f32 v7, v7, v17
    v_mfma_f32_16x16x32_bf16 v[68:71], v[44:47], a[228:231], v[68:71]
    v_exp_f32 v19, v123
    v_mfma_f32_16x16x32_bf16 v[68:71], v[40:43], a[224:227], v[68:71]
    v_cvt_pk_bf16_f32 v186, v16, v17
    v_mfma_f32_16x16x32_bf16 v[72:75], v[40:43], a[248:251], v[72:75]
    ds_read_b128 v[36:39], v3 offset:256
    v_mfma_f32_16x16x32_bf16 v[72:75], v[44:47], a[252:255], v[72:75]
    buffer_load_dwordx4 v4, s[4:7], s32 offen offset:1024 sc1 lds
    v_mfma_f32_16x16x32_bf16 v[76:79], v[44:47], v[212:215], v[76:79]
    v_exp_f32 v16, v188
    v_mfma_f32_16x16x32_bf16 v[76:79], v[40:43], v[208:211], v[76:79]
    s_waitcnt lgkmcnt(2)
    v_add_f32 v7, v7, v18
    v_add_f32 v7, v7, v19
    v_mfma_f32_16x16x32_bf16 v[96:99], v[24:27], a[200:203], v[96:99]
    ds_read_b128 v[40:43], v2 offset:6400
    v_mfma_f32_16x16x32_bf16 v[96:99], v[28:31], a[204:207], v[96:99]
    v_exp_f32 v17, v189
    v_mfma_f32_16x16x32_bf16 v[100:103], v[28:31], a[228:231], v[100:103]
    v_cvt_pk_bf16_f32 v187, v18, v19
    v_mfma_f32_16x16x32_bf16 v[100:103], v[24:27], a[224:227], v[100:103]
    v_exp_f32 v18, v190
    v_mfma_f32_16x16x32_bf16 v[104:107], v[24:27], a[248:251], v[104:107]
    ds_read_b128 v[44:47], v3 offset:6400
    v_add_f32 v8, v8, v16
    v_mfma_f32_16x16x32_bf16 v[104:107], v[28:31], a[252:255], v[104:107]
    v_add_f32 v8, v8, v17
    v_mfma_f32_16x16x32_bf16 v[108:111], v[28:31], v[212:215], v[108:111]
    s_add_u32 s29, s30, 49152
    v_exp_f32 v19, v191
    v_mfma_f32_16x16x32_bf16 v[108:111], v[24:27], v[208:211], v[108:111]
    s_waitcnt lgkmcnt(2)
    buffer_load_dwordx4 v4, s[4:7], s32 offen offset:2048 sc1 lds
    v_mfma_f32_16x16x32_bf16 v[64:67], v[32:35], a[208:211], v[64:67]
    s_sub_u32 s3, s29, 147456
    ds_read_b128 v[24:27], v2 offset:12288
    v_cvt_pk_bf16_f32 v188, v16, v17
    v_mfma_f32_16x16x32_bf16 v[64:67], v[36:39], a[212:215], v[64:67]
    s_min_u32 s29, s29, s3
    v_exp_f32 v16, v124
    v_mfma_f32_16x16x32_bf16 v[68:71], v[36:39], a[236:239], v[68:71]
    v_add_f32 v8, v8, v18
    v_add_f32 v8, v8, v19
    v_mfma_f32_16x16x32_bf16 v[68:71], v[32:35], a[232:235], v[68:71]
    v_exp_f32 v17, v125
    v_mfma_f32_16x16x32_bf16 v[72:75], v[32:35], v[192:195], v[72:75]
    ds_read_b128 v[28:31], v3 offset:12288
    v_mfma_f32_16x16x32_bf16 v[72:75], v[36:39], v[196:199], v[72:75]
    v_cvt_pk_bf16_f32 v189, v18, v19
    v_mfma_f32_16x16x32_bf16 v[76:79], v[36:39], v[220:223], v[76:79]
    v_exp_f32 v18, v126
    v_mfma_f32_16x16x32_bf16 v[76:79], v[32:35], v[216:219], v[76:79]
    s_waitcnt lgkmcnt(2)
    v_add_f32 v8, v8, v16
    s_add_u32 s32, s32, 24576
    v_mfma_f32_16x16x32_bf16 v[96:99], v[40:43], a[208:211], v[96:99]
    ds_read_b128 v[32:35], v2 offset:18432
    v_add_f32 v8, v8, v17
    v_mfma_f32_16x16x32_bf16 v[96:99], v[44:47], a[212:215], v[96:99]
    s_sub_u32 s3, s29, s30
    v_exp_f32 v19, v127
    v_mfma_f32_16x16x32_bf16 v[100:103], v[44:47], a[236:239], v[100:103]
    v_mfma_f32_16x16x32_bf16 v[100:103], v[40:43], a[232:235], v[100:103]
    v_cvt_pk_bf16_f32 v190, v16, v17
    v_mfma_f32_16x16x32_bf16 v[104:107], v[40:43], v[192:195], v[104:107]
    s_add_u32 s26, s26, 12288
    ds_read_b128 v[36:39], v3 offset:18432
    v_add_f32 v8, v8, v18
    v_mfma_f32_16x16x32_bf16 v[104:107], v[44:47], v[196:199], v[104:107]
    v_add_f32 v8, v8, v19
    v_cvt_pk_bf16_f32 v191, v18, v19
    v_mfma_f32_16x16x32_bf16 v[108:111], v[44:47], v[220:223], v[108:111]
    v_mfma_f32_16x16x32_bf16 v[108:111], v[40:43], v[216:219], v[108:111]
    s_waitcnt lgkmcnt(2)
    v_exp_f32 v16, v64
    v_mfma_f32_16x16x32_bf16 v[80:83], v[24:27], a[192:195], v[128:131]
    ds_read_b128 v[40:43], v2 offset:12416
    v_mfma_f32_16x16x32_bf16 v[80:83], v[28:31], a[196:199], v[80:83]
    s_mov_b32 m0, s26
    v_exp_f32 v17, v65
    v_mfma_f32_16x16x32_bf16 v[84:87], v[28:31], a[220:223], v[132:135]
    s_mov_b32 s30, s29
    v_exp_f32 v18, v66
    v_mfma_f32_16x16x32_bf16 v[84:87], v[24:27], a[216:219], v[84:87]
    v_add_f32 v5, v5, v16
    v_mfma_f32_16x16x32_bf16 v[88:91], v[24:27], a[240:243], v[136:139]
    ds_read_b128 v[44:47], v3 offset:12416
    v_add_f32 v5, v5, v17
    v_mfma_f32_16x16x32_bf16 v[88:91], v[28:31], a[244:247], v[88:91]
    v_exp_f32 v19, v67
    v_mfma_f32_16x16x32_bf16 v[92:95], v[28:31], v[204:207], v[140:143]
    v_mfma_f32_16x16x32_bf16 v[92:95], v[24:27], v[200:203], v[92:95]
    s_waitcnt lgkmcnt(2)
    v_cvt_pk_bf16_f32 v64, v16, v17
    v_mfma_f32_16x16x32_bf16 v[112:115], v[32:35], a[192:195], v[128:131]
    ds_read_b128 v[24:27], v2 offset:18560
    v_mfma_f32_16x16x32_bf16 v[112:115], v[36:39], a[196:199], v[112:115]
    buffer_load_dwordx4 v4, s[4:7], s32 offen offset:0 sc1 lds
    v_mfma_f32_16x16x32_bf16 v[116:119], v[36:39], a[220:223], v[132:135]
    v_exp_f32 v16, v96
    v_mfma_f32_16x16x32_bf16 v[116:119], v[32:35], a[216:219], v[116:119]
    v_add_f32 v5, v5, v18
    v_add_f32 v5, v5, v19
    v_mfma_f32_16x16x32_bf16 v[120:123], v[32:35], a[240:243], v[136:139]
    ds_read_b128 v[28:31], v3 offset:18560
    v_add_u32 v1, s3, v1
    v_mfma_f32_16x16x32_bf16 v[120:123], v[36:39], a[244:247], v[120:123]
    v_exp_f32 v17, v97
    v_mfma_f32_16x16x32_bf16 v[124:127], v[36:39], v[204:207], v[140:143]
    v_cvt_pk_bf16_f32 v65, v18, v19
    v_mfma_f32_16x16x32_bf16 v[124:127], v[32:35], v[200:203], v[124:127]
    s_waitcnt lgkmcnt(2)
    v_exp_f32 v18, v98
    v_mfma_f32_16x16x32_bf16 v[80:83], v[40:43], a[200:203], v[80:83]
    ds_read_b128 v[32:35], v2 offset:12544
    v_add_f32 v5, v5, v16
    v_mfma_f32_16x16x32_bf16 v[80:83], v[44:47], a[204:207], v[80:83]
    v_add_f32 v5, v5, v17
    v_mfma_f32_16x16x32_bf16 v[84:87], v[44:47], a[228:231], v[84:87]
    v_exp_f32 v19, v99
    v_mfma_f32_16x16x32_bf16 v[84:87], v[40:43], a[224:227], v[84:87]
    buffer_load_dwordx4 v4, s[4:7], s32 offen offset:1024 sc1 lds
    v_mfma_f32_16x16x32_bf16 v[88:91], v[40:43], a[248:251], v[88:91]
    ds_read_b128 v[36:39], v3 offset:12544
    v_cvt_pk_bf16_f32 v66, v16, v17
    v_mfma_f32_16x16x32_bf16 v[88:91], v[44:47], a[252:255], v[88:91]
    v_exp_f32 v16, v68
    v_mfma_f32_16x16x32_bf16 v[92:95], v[44:47], v[212:215], v[92:95]
    v_add_f32 v5, v5, v18
    v_add_f32 v5, v5, v19
    v_mfma_f32_16x16x32_bf16 v[92:95], v[40:43], v[208:211], v[92:95]
    s_waitcnt lgkmcnt(2)
    v_exp_f32 v17, v69
    v_mfma_f32_16x16x32_bf16 v[112:115], v[24:27], a[200:203], v[112:115]
    ds_read_b128 v[40:43], v2 offset:18688
    v_mfma_f32_16x16x32_bf16 v[112:115], v[28:31], a[204:207], v[112:115]
    v_cvt_pk_bf16_f32 v67, v18, v19
    v_mfma_f32_16x16x32_bf16 v[116:119], v[28:31], a[228:231], v[116:119]
    v_exp_f32 v18, v70
    v_mfma_f32_16x16x32_bf16 v[116:119], v[24:27], a[224:227], v[116:119]
    v_add_f32 v6, v6, v16
    v_mfma_f32_16x16x32_bf16 v[120:123], v[24:27], a[248:251], v[120:123]
    ds_read_b128 v[44:47], v3 offset:18688
    v_add_f32 v6, v6, v17
    v_mfma_f32_16x16x32_bf16 v[120:123], v[28:31], a[252:255], v[120:123]
    s_waitcnt lgkmcnt(2)
    buffer_load_dwordx4 v4, s[4:7], s32 offen offset:2048 sc1 lds
    v_mfma_f32_16x16x32_bf16 v[124:127], v[28:31], v[212:215], v[124:127]
    s_waitcnt vmcnt(7)
    v_exp_f32 v19, v71
    v_mfma_f32_16x16x32_bf16 v[124:127], v[24:27], v[208:211], v[124:127]
    s_barrier
    v_mfma_f32_16x16x32_bf16 v[80:83], v[32:35], a[208:211], v[80:83]
    ds_read_b128 v[24:27], v1 offset:0
    v_cvt_pk_bf16_f32 v68, v16, v17
    v_mfma_f32_16x16x32_bf16 v[80:83], v[36:39], a[212:215], v[80:83]
    v_exp_f32 v16, v100
    v_mfma_f32_16x16x32_bf16 v[84:87], v[36:39], a[236:239], v[84:87]
    v_add_f32 v6, v6, v18
    v_add_f32 v6, v6, v19
    v_mfma_f32_16x16x32_bf16 v[84:87], v[32:35], a[232:235], v[84:87]
    v_exp_f32 v17, v101
    v_mfma_f32_16x16x32_bf16 v[88:91], v[32:35], v[192:195], v[88:91]
    ds_read_b128 v[28:31], v1 offset:12288
    v_mfma_f32_16x16x32_bf16 v[88:91], v[36:39], v[196:199], v[88:91]
    v_cvt_pk_bf16_f32 v69, v18, v19
    v_mfma_f32_16x16x32_bf16 v[92:95], v[36:39], v[220:223], v[92:95]
    v_exp_f32 v18, v102
    v_mfma_f32_16x16x32_bf16 v[92:95], v[32:35], v[216:219], v[92:95]
    s_waitcnt lgkmcnt(2)
    v_add_f32 v6, v6, v16
    v_mfma_f32_16x16x32_bf16 v[112:115], v[40:43], a[208:211], v[112:115]
    ds_read_b128 v[32:35], v1 offset:1024
    v_add_f32 v6, v6, v17
    v_mfma_f32_16x16x32_bf16 v[112:115], v[44:47], a[212:215], v[112:115]
    v_exp_f32 v19, v103
    v_mfma_f32_16x16x32_bf16 v[116:119], v[44:47], a[236:239], v[116:119]
    v_mfma_f32_16x16x32_bf16 v[116:119], v[40:43], a[232:235], v[116:119]
    v_cvt_pk_bf16_f32 v70, v16, v17
    v_mfma_f32_16x16x32_bf16 v[120:123], v[40:43], v[192:195], v[120:123]
    ds_read_b128 v[36:39], v1 offset:13312
    v_add_f32 v6, v6, v18
    v_mfma_f32_16x16x32_bf16 v[120:123], v[44:47], v[196:199], v[120:123]
    s_add_u32 s32, s32, 24576
    s_add_u32 s26, s26, 36864
    v_add_f32 v6, v6, v19
    v_mfma_f32_16x16x32_bf16 v[124:127], v[44:47], v[220:223], v[124:127]
    s_sub_u32 s57, s26, 147456
    v_cvt_pk_bf16_f32 v71, v18, v19
    s_min_u32 s26, s26, s57
    v_mfma_f32_16x16x32_bf16 v[124:127], v[40:43], v[216:219], v[124:127]
    s_waitcnt lgkmcnt(2)
    v_mfma_f32_16x16x32_bf16 a[0:3], v[160:163], v[24:27], a[0:3]
    ds_read_b128 v[40:43], v1 offset:2048
    v_mfma_f32_16x16x32_bf16 a[0:3], v[176:179], v[28:31], a[0:3]
    s_waitcnt vmcnt(6)
    v_subrev_u32 v52, s92, v52
    v_cmp_lt_u32 vcc, 15, v52
    v_mfma_f32_16x16x32_bf16 a[48:51], v[180:183], v[28:31], a[48:51]
    v_exp_f32 v16, v72
    v_mfma_f32_16x16x32_bf16 a[48:51], v[164:167], v[24:27], a[48:51]
    v_exp_f32 v17, v73
    v_mfma_f32_16x16x32_bf16 a[96:99], v[168:171], v[24:27], a[96:99]
    s_and_b32 s59, vcc_lo, 0xff
    ds_read_b128 v[44:47], v1 offset:14336
    v_mfma_f32_16x16x32_bf16 a[96:99], v[184:187], v[28:31], a[96:99]
    s_cbranch_scc1 L_pollslow4
L_pollok4:
    v_mfma_f32_16x16x32_bf16 a[144:147], v[188:191], v[28:31], a[144:147]
    s_add_u32 s92, s92, 1
    v_exp_f32 v18, v74
    v_mfma_f32_16x16x32_bf16 a[144:147], v[172:175], v[24:27], a[144:147]
    s_waitcnt lgkmcnt(2)
    v_add_f32 v7, v7, v16
    v_add_f32 v7, v7, v17
    v_mfma_f32_16x16x32_bf16 a[4:7], v[160:163], v[32:35], a[4:7]
    ds_read_b128 v[24:27], v1 offset:3072
    v_mfma_f32_16x16x32_bf16 a[4:7], v[176:179], v[36:39], a[4:7]
    v_exp_f32 v19, v75
    v_mfma_f32_16x16x32_bf16 a[52:55], v[180:183], v[36:39], a[52:55]
    v_cvt_pk_bf16_f32 v72, v16, v17
    v_mfma_f32_16x16x32_bf16 a[52:55], v[164:167], v[32:35], a[52:55]
    v_exp_f32 v16, v104
    v_mfma_f32_16x16x32_bf16 a[100:103], v[168:171], v[32:35], a[100:103]
    ds_read_b128 v[28:31], v1 offset:15360
    v_add_f32 v7, v7, v18
    v_mfma_f32_16x16x32_bf16 a[100:103], v[184:187], v[36:39], a[100:103]
    s_waitcnt lgkmcnt(2)
    v_add_f32 v7, v7, v19
    v_mfma_f32_16x16x32_bf16 a[148:151], v[188:191], v[36:39], a[148:151]
    s_waitcnt vmcnt(0)
    v_exp_f32 v17, v105
    v_mfma_f32_16x16x32_bf16 a[148:151], v[172:175], v[32:35], a[148:151]
    s_barrier
    v_mfma_f32_16x16x32_bf16 a[8:11], v[160:163], v[40:43], a[8:11]
    s_mov_b32 m0, s56
    ds_read_b128 v[32:35], v1 offset:4096
    v_cvt_pk_bf16_f32 v73, v18, v19
    v_mfma_f32_16x16x32_bf16 a[8:11], v[176:179], v[44:47], a[8:11]
    buffer_load_dwordx4 v4, s[4:7], s27 offen offset:0 sc1 lds
    v_mfma_f32_16x16x32_bf16 a[56:59], v[180:183], v[44:47], a[56:59]
    v_exp_f32 v18, v106
    v_mfma_f32_16x16x32_bf16 a[56:59], v[164:167], v[40:43], a[56:59]
    v_add_f32 v7, v7, v16
    v_add_f32 v7, v7, v17
    v_mfma_f32_16x16x32_bf16 a[104:107], v[168:171], v[40:43], a[104:107]
    ds_read_b128 v[36:39], v1 offset:16384
    v_mfma_f32_16x16x32_bf16 a[104:107], v[184:187], v[44:47], a[104:107]
    buffer_load_dwordx4 v4, s[4:7], s27 offen offset:1024 sc1 lds
    v_mfma_f32_16x16x32_bf16 a[152:155], v[188:191], v[44:47], a[152:155]
    v_exp_f32 v19, v107
    v_mfma_f32_16x16x32_bf16 a[152:155], v[172:175], v[40:43], a[152:155]
    s_waitcnt lgkmcnt(2)
    v_cvt_pk_bf16_f32 v74, v16, v17
    v_mfma_f32_16x16x32_bf16 a[12:15], v[160:163], v[24:27], a[12:15]
L_pg10:
    s_cbranch_execz L_iwret
    ds_read_b128 v[40:43], v1 offset:5120
    v_mfma_f32_16x16x32_bf16 a[12:15], v[176:179], v[28:31], a[12:15]
    buffer_load_dwordx4 v4, s[4:7], s27 offen offset:2048 sc1 lds
    v_mfma_f32_16x16x32_bf16 a[60:63], v[180:183], v[28:31], a[60:63]
    v_exp_f32 v16, v76
    v_mfma_f32_16x16x32_bf16 a[60:63], v[164:167], v[24:27], a[60:63]
    s_add_u32 s27, s27, 24576
    v_add_f32 v7, v7, v18
    v_add_f32 v7, v7, v19
    v_mfma_f32_16x16x32_bf16 a[108:111], v[168:171], v[24:27], a[108:111]
    ds_read_b128 v[44:47], v1 offset:17408
    v_mfma_f32_16x16x32_bf16 a[108:111], v[184:187], v[28:31], a[108:111]
    s_add_u32 s56, s56, 12288
    v_exp_f32 v17, v77
    v_mfma_f32_16x16x32_bf16 a[156:159], v[188:191], v[28:31], a[156:159]
    s_add_u32 s29, s28, 49152
    v_cvt_pk_bf16_f32 v75, v18, v19
    v_mfma_f32_16x16x32_bf16 a[156:159], v[172:175], v[24:27], a[156:159]
    s_waitcnt lgkmcnt(2)
    v_exp_f32 v18, v78
    v_mfma_f32_16x16x32_bf16 a[16:19], v[160:163], v[32:35], a[16:19]
    s_sub_u32 s3, s29, 147456
    ds_read_b128 v[24:27], v1 offset:6144
    v_add_f32 v8, v8, v16
    v_mfma_f32_16x16x32_bf16 a[16:19], v[176:179], v[36:39], a[16:19]
    s_mov_b32 m0, s56
    v_add_f32 v8, v8, v17
    s_min_u32 s29, s29, s3
    v_mfma_f32_16x16x32_bf16 a[64:67], v[180:183], v[36:39], a[64:67]
    v_exp_f32 v19, v79
    v_mfma_f32_16x16x32_bf16 a[64:67], v[164:167], v[32:35], a[64:67]
    buffer_load_dwordx4 v4, s[4:7], s27 offen offset:0 sc1 lds
    v_mfma_f32_16x16x32_bf16 a[112:115], v[168:171], v[32:35], a[112:115]
    ds_read_b128 v[28:31], v1 offset:18432
    v_cvt_pk_bf16_f32 v76, v16, v17
    v_mfma_f32_16x16x32_bf16 a[112:115], v[184:187], v[36:39], a[112:115]
    v_exp_f32 v16, v108
    v_mfma_f32_16x16x32_bf16 a[160:163], v[188:191], v[36:39], a[160:163]
    v_add_f32 v8, v8, v18
    v_add_f32 v8, v8, v19
    v_mfma_f32_16x16x32_bf16 a[160:163], v[172:175], v[32:35], a[160:163]
    s_waitcnt lgkmcnt(2)
    buffer_load_dwordx4 v4, s[4:7], s27 offen offset:1024 sc1 lds
    v_mfma_f32_16x16x32_bf16 a[20:23], v[160:163], v[40:43], a[20:23]
    s_sub_u32 s3, s29, s28
    ds_read_b128 v[32:35], v1 offset:7168
    v_mfma_f32_16x16x32_bf16 a[20:23], v[176:179], v[44:47], a[20:23]
    v_exp_f32 v17, v109
    v_mfma_f32_16x16x32_bf16 a[68:71], v[180:183], v[44:47], a[68:71]
    v_cvt_pk_bf16_f32 v77, v18, v19
    v_mfma_f32_16x16x32_bf16 a[68:71], v[164:167], v[40:43], a[68:71]
    buffer_load_dwordx4 v4, s[4:7], s27 offen offset:2048 sc1 lds
    v_mfma_f32_16x16x32_bf16 a[116:119], v[168:171], v[40:43], a[116:119]
    ds_read_b128 v[36:39], v1 offset:19456
    v_mfma_f32_16x16x32_bf16 a[116:119], v[184:187], v[44:47], a[116:119]
    v_exp_f32 v18, v110
    v_mfma_f32_16x16x32_bf16 a[164:167], v[188:191], v[44:47], a[164:167]
    s_add_u32 s27, s27, 24576
    v_add_f32 v8, v8, v16
    v_add_f32 v8, v8, v17
    v_mfma_f32_16x16x32_bf16 a[164:167], v[172:175], v[40:43], a[164:167]
    s_waitcnt lgkmcnt(2)
    v_exp_f32 v19, v111
    v_mfma_f32_16x16x32_bf16 a[24:27], v[160:163], v[24:27], a[24:27]
    s_add_u32 s56, s56, 36864
    ds_read_b128 v[40:43], v1 offset:8192
    v_cvt_pk_bf16_f32 v78, v16, v17
    v_mfma_f32_16x16x32_bf16 a[24:27], v[176:179], v[28:31], a[24:27]
    s_mov_b32 s28, s29
    v_add_f32 v8, v8, v18
    v_add_f32 v8, v8, v19
    v_mfma_f32_16x16x32_bf16 a[72:75], v[180:183], v[28:31], a[72:75]
    s_sub_u32 s58, s56, 147456
    v_cvt_pk_bf16_f32 v79, v18, v19
    v_mfma_f32_16x16x32_bf16 a[72:75], v[164:167], v[24:27], a[72:75]
    v_exp_f32 v16, v80
    v_mfma_f32_16x16x32_bf16 a[120:123], v[168:171], v[24:27], a[120:123]
    s_min_u32 s56, s56, s58
    ds_read_b128 v[44:47], v1 offset:20480
    v_mfma_f32_16x16x32_bf16 a[120:123], v[184:187], v[28:31], a[120:123]
    v_exp_f32 v17, v81
    v_mfma_f32_16x16x32_bf16 a[168:171], v[188:191], v[28:31], a[168:171]
    s_mov_b32 m0, s26
    v_exp_f32 v18, v82
    v_mfma_f32_16x16x32_bf16 a[168:171], v[172:175], v[24:27], a[168:171]
    s_waitcnt lgkmcnt(2)
    v_add_f32 v5, v5, v16
    v_add_f32 v5, v5, v17
    v_mfma_f32_16x16x32_bf16 a[28:31], v[160:163], v[32:35], a[28:31]
    ds_read_b128 v[24:27], v1 offset:9216
    v_add_u32 v2, s3, v2
    v_mfma_f32_16x16x32_bf16 a[28:31], v[176:179], v[36:39], a[28:31]
    buffer_load_dwordx4 v4, s[4:7], s32 offen offset:0 sc1 lds
    v_mfma_f32_16x16x32_bf16 a[76:79], v[180:183], v[36:39], a[76:79]
    v_exp_f32 v19, v83
    v_mfma_f32_16x16x32_bf16 a[76:79], v[164:167], v[32:35], a[76:79]
    v_cvt_pk_bf16_f32 v80, v16, v17
    v_mfma_f32_16x16x32_bf16 a[124:127], v[168:171], v[32:35], a[124:127]
    ds_read_b128 v[28:31], v1 offset:21504
    v_add_u32 v3, s3, v3
    v_mfma_f32_16x16x32_bf16 a[124:127], v[184:187], v[36:39], a[124:127]
    buffer_load_dwordx4 v4, s[4:7], s32 offen offset:1024 sc1 lds
    v_mfma_f32_16x16x32_bf16 a[172:175], v[188:191], v[36:39], a[172:175]
    v_exp_f32 v16, v112
    v_mfma_f32_16x16x32_bf16 a[172:175], v[172:175], v[32:35], a[172:175]
    s_waitcnt lgkmcnt(2)
    v_add_f32 v5, v5, v18
    v_add_f32 v5, v5, v19
    v_mfma_f32_16x16x32_bf16 a[32:35], v[160:163], v[40:43], a[32:35]
    ds_read_b128 v[32:35], v1 offset:10240
    v_mfma_f32_16x16x32_bf16 a[32:35], v[176:179], v[44:47], a[32:35]
    buffer_load_dwordx4 v4, s[4:7], s32 offen offset:2048 sc1 lds
    v_mfma_f32_16x16x32_bf16 a[80:83], v[180:183], v[44:47], a[80:83]
    v_exp_f32 v17, v113
    v_mfma_f32_16x16x32_bf16 a[80:83], v[164:167], v[40:43], a[80:83]
    v_cvt_pk_bf16_f32 v81, v18, v19
    v_mfma_f32_16x16x32_bf16 a[128:131], v[168:171], v[40:43], a[128:131]
    ds_read_b128 v[36:39], v1 offset:22528
    v_mfma_f32_16x16x32_bf16 a[128:131], v[184:187], v[44:47], a[128:131]
    s_add_u32 s32, s32, 24576
    v_exp_f32 v18, v114
    v_mfma_f32_16x16x32_bf16 a[176:179], v[188:191], v[44:47], a[176:179]
    v_add_f32 v5, v5, v16
    v_add_f32 v5, v5, v17
    v_mfma_f32_16x16x32_bf16 a[176:179], v[172:175], v[40:43], a[176:179]
    s_waitcnt lgkmcnt(2)
    v_exp_f32 v19, v115
    v_mfma_f32_16x16x32_bf16 a[36:39], v[160:163], v[24:27], a[36:39]
    s_add_u32 s26, s26, 12288
    ds_read_b128 v[40:43], v1 offset:11264
    v_cvt_pk_bf16_f32 v82, v16, v17
    v_mfma_f32_16x16x32_bf16 a[36:39], v[176:179], v[28:31], a[36:39]
    s_mov_b32 m0, s26
    v_exp_f32 v16, v84
    v_mfma_f32_16x16x32_bf16 a[84:87], v[180:183], v[28:31], a[84:87]
    v_add_f32 v5, v5, v18
    v_add_f32 v5, v5, v19
    v_mfma_f32_16x16x32_bf16 a[84:87], v[164:167], v[24:27], a[84:87]
    v_exp_f32 v17, v85
    v_mfma_f32_16x16x32_bf16 a[132:135], v[168:171], v[24:27], a[132:135]
    ds_read_b128 v[44:47], v1 offset:23552
    v_cvt_pk_bf16_f32 v83, v18, v19
    v_mfma_f32_16x16x32_bf16 a[132:135], v[184:187], v[28:31], a[132:135]
    buffer_load_dwordx4 v4, s[4:7], s32 offen offset:0 sc1 lds
    v_mfma_f32_16x16x32_bf16 a[180:183], v[188:191], v[28:31], a[180:183]
    v_exp_f32 v18, v86
    v_mfma_f32_16x16x32_bf16 a[180:183], v[172:175], v[24:27], a[180:183]
    s_waitcnt lgkmcnt(2)
    v_add_f32 v6, v6, v16
    v_add_f32 v6, v6, v17
    v_mfma_f32_16x16x32_bf16 a[40:43], v[160:163], v[32:35], a[40:43]
    ds_read_b128 v[24:27], v2 offset:0
    v_mfma_f32_16x16x32_bf16 a[40:43], v[176:179], v[36:39], a[40:43]
    buffer_load_dwordx4 v4, s[4:7], s32 offen offset:1024 sc1 lds
    v_mfma_f32_16x16x32_bf16 a[88:91], v[180:183], v[36:39], a[88:91]
    v_exp_f32 v19, v87
    v_mfma_f32_16x16x32_bf16 a[88:91], v[164:167], v[32:35], a[88:91]
    v_cvt_pk_bf16_f32 v84, v16, v17
    v_mfma_f32_16x16x32_bf16 a[136:139], v[168:171], v[32:35], a[136:139]
    ds_read_b128 v[28:31], v3 offset:0
    v_mfma_f32_16x16x32_bf16 a[136:139], v[184:187], v[36:39], a[136:139]
    buffer_load_dwordx4 v4, s[4:7], s32 offen offset:2048 sc1 lds
    v_mfma_f32_16x16x32_bf16 a[184:187], v[188:191], v[36:39], a[184:187]
    v_exp_f32 v16, v116
    v_mfma_f32_16x16x32_bf16 a[184:187], v[172:175], v[32:35], a[184:187]
    s_waitcnt lgkmcnt(2)
    v_add_f32 v6, v6, v18
    v_add_f32 v6, v6, v19
    v_mfma_f32_16x16x32_bf16 a[44:47], v[160:163], v[40:43], a[44:47]
    ds_read_b128 v[32:35], v2 offset:6144
    v_mfma_f32_16x16x32_bf16 a[44:47], v[176:179], v[44:47], a[44:47]
    v_exp_f32 v17, v117
    v_mfma_f32_16x16x32_bf16 a[92:95], v[180:183], v[44:47], a[92:95]
    v_cvt_pk_bf16_f32 v85, v18, v19
    v_mfma_f32_16x16x32_bf16 a[92:95], v[164:167], v[40:43], a[92:95]
    s_add_u32 s32, s32, 24576
    v_exp_f32 v18, v118
    v_mfma_f32_16x16x32_bf16 a[140:143], v[168:171], v[40:43], a[140:143]
    s_add_u32 s26, s26, 36864
    ds_read_b128 v[36:39], v3 offset:6144
    v_add_f32 v6, v6, v16
    v_mfma_f32_16x16x32_bf16 a[140:143], v[184:187], v[44:47], a[140:143]
    s_sub_u32 s57, s26, 147456
    v_add_f32 v6, v6, v17
    s_min_u32 s26, s26, s57
    v_mfma_f32_16x16x32_bf16 a[188:191], v[188:191], v[44:47], a[188:191]
    v_exp_f32 v19, v119
    v_mfma_f32_16x16x32_bf16 a[188:191], v[172:175], v[40:43], a[188:191]
    s_waitcnt lgkmcnt(2)
    v_cvt_pk_bf16_f32 v86, v16, v17
    v_add_f32 v6, v6, v18
    v_add_f32 v6, v6, v19
    v_cvt_pk_bf16_f32 v87, v18, v19
    v_mfma_f32_16x16x32_bf16 v[160:163], v[24:27], a[192:195], v[128:131]
    ds_read_b128 v[40:43], v2 offset:128
    v_mfma_f32_16x16x32_bf16 v[160:163], v[28:31], a[196:199], v[160:163]
    v_exp_f32 v16, v88
    v_mfma_f32_16x16x32_bf16 v[164:167], v[28:31], a[220:223], v[132:135]
    ds_read_b128 v[44:47], v3 offset:128
    v_mfma_f32_16x16x32_bf16 v[164:167], v[24:27], a[216:219], v[164:167]
    s_waitcnt lgkmcnt(2)
    v_exp_f32 v17, v89
    v_mfma_f32_16x16x32_bf16 v[96:99], v[32:35], a[192:195], v[128:131]
    ds_read_b128 v[24:27], v2 offset:6272
    v_mfma_f32_16x16x32_bf16 v[96:99], v[36:39], a[196:199], v[96:99]
    v_exp_f32 v18, v90
    v_mfma_f32_16x16x32_bf16 v[100:103], v[36:39], a[220:223], v[132:135]
    ds_read_b128 v[28:31], v3 offset:6272
    v_add_f32 v7, v7, v16
    v_mfma_f32_16x16x32_bf16 v[100:103], v[32:35], a[216:219], v[100:103]
    s_waitcnt lgkmcnt(2)
    v_add_f32 v7, v7, v17
    v_mfma_f32_16x16x32_bf16 v[160:163], v[40:43], a[200:203], v[160:163]
    ds_read_b128 v[32:35], v2 offset:256
    v_mfma_f32_16x16x32_bf16 v[160:163], v[44:47], a[204:207], v[160:163]
    v_exp_f32 v19, v91
    v_mfma_f32_16x16x32_bf16 v[164:167], v[44:47], a[228:231], v[164:167]
    ds_read_b128 v[36:39], v3 offset:256
    v_cvt_pk_bf16_f32 v88, v16, v17
    v_mfma_f32_16x16x32_bf16 v[164:167], v[40:43], a[224:227], v[164:167]
    s_waitcnt lgkmcnt(2)
    v_exp_f32 v16, v120
    v_mfma_f32_16x16x32_bf16 v[96:99], v[24:27], a[200:203], v[96:99]
    ds_read_b128 v[40:43], v2 offset:6400
    v_add_f32 v7, v7, v18
    v_mfma_f32_16x16x32_bf16 v[96:99], v[28:31], a[204:207], v[96:99]
    v_add_f32 v7, v7, v19
    v_mfma_f32_16x16x32_bf16 v[100:103], v[28:31], a[228:231], v[100:103]
    ds_read_b128 v[44:47], v3 offset:6400
    v_mfma_f32_16x16x32_bf16 v[100:103], v[24:27], a[224:227], v[100:103]
    s_waitcnt lgkmcnt(2)
    v_exp_f32 v17, v121
    v_mfma_f32_16x16x32_bf16 v[160:163], v[32:35], a[208:211], v[160:163]
    ds_read_b128 v[24:27], v2 offset:12288
    v_cvt_pk_bf16_f32 v89, v18, v19
    v_mfma_f32_16x16x32_bf16 v[160:163], v[36:39], a[212:215], v[160:163]
    v_exp_f32 v18, v122
    v_mfma_f32_16x16x32_bf16 v[164:167], v[36:39], a[236:239], v[164:167]
    ds_read_b128 v[28:31], v3 offset:12288
    v_add_f32 v7, v7, v16
    v_mfma_f32_16x16x32_bf16 v[164:167], v[32:35], a[232:235], v[164:167]
    s_waitcnt lgkmcnt(2)
    v_add_f32 v7, v7, v17
    v_mfma_f32_16x16x32_bf16 v[96:99], v[40:43], a[208:211], v[96:99]
    ds_read_b128 v[32:35], v2 offset:18432
    v_mfma_f32_16x16x32_bf16 v[96:99], v[44:47], a[212:215], v[96:99]
    v_exp_f32 v19, v123
    v_mfma_f32_16x16x32_bf16 v[100:103], v[44:47], a[236:239], v[100:103]
    ds_read_b128 v[36:39], v3 offset:18432
    v_cvt_pk_bf16_f32 v90, v16, v17
    v_mfma_f32_16x16x32_bf16 v[100:103], v[40:43], a[232:235], v[100:103]
    s_waitcnt lgkmcnt(2)
    v_exp_f32 v16, v92
    v_mfma_f32_16x16x32_bf16 v[168:171], v[24:27], a[192:195], v[128:131]
    ds_read_b128 v[40:43], v2 offset:12416
    v_add_f32 v7, v7, v18
    v_mfma_f32_16x16x32_bf16 v[168:171], v[28:31], a[196:199], v[168:171]
    v_add_f32 v7, v7, v19
    v_mfma_f32_16x16x32_bf16 v[172:175], v[28:31], a[220:223], v[132:135]
    ds_read_b128 v[44:47], v3 offset:12416
    v_mfma_f32_16x16x32_bf16 v[172:175], v[24:27], a[216:219], v[172:175]
    s_waitcnt lgkmcnt(2)
    v_exp_f32 v17, v93
    v_mfma_f32_16x16x32_bf16 v[104:107], v[32:35], a[192:195], v[128:131]
    ds_read_b128 v[24:27], v2 offset:18560
    v_cvt_pk_bf16_f32 v91, v18, v19
    v_mfma_f32_16x16x32_bf16 v[104:107], v[36:39], a[196:199], v[104:107]
    v_exp_f32 v18, v94
    v_mfma_f32_16x16x32_bf16 v[108:111], v[36:39], a[220:223], v[132:135]
    s_add_u32 s29, s30, 49152
    ds_read_b128 v[28:31], v3 offset:18560
    v_add_f32 v8, v8, v16
    v_mfma_f32_16x16x32_bf16 v[108:111], v[32:35], a[216:219], v[108:111]
    s_waitcnt lgkmcnt(2)
    v_add_f32 v8, v8, v17
    s_sub_u32 s3, s29, 147456
    v_mfma_f32_16x16x32_bf16 v[168:171], v[40:43], a[200:203], v[168:171]
    ds_read_b128 v[32:35], v2 offset:12544
    v_mfma_f32_16x16x32_bf16 v[168:171], v[44:47], a[204:207], v[168:171]
    s_min_u32 s29, s29, s3
    v_exp_f32 v19, v95
    v_mfma_f32_16x16x32_bf16 v[172:175], v[44:47], a[228:231], v[172:175]
    ds_read_b128 v[36:39], v3 offset:12544
    v_cvt_pk_bf16_f32 v92, v16, v17
    v_mfma_f32_16x16x32_bf16 v[172:175], v[40:43], a[224:227], v[172:175]
    s_waitcnt lgkmcnt(2)
    v_exp_f32 v16, v124
    v_mfma_f32_16x16x32_bf16 v[104:107], v[24:27], a[200:203], v[104:107]
    ds_read_b128 v[40:43], v2 offset:18688
    v_add_f32 v8, v8, v18
    v_mfma_f32_16x16x32_bf16 v[104:107], v[28:31], a[204:207], v[104:107]
    v_add_f32 v8, v8, v19
    v_mfma_f32_16x16x32_bf16 v[108:111], v[28:31], a[228:231], v[108:111]
    ds_read_b128 v[44:47], v3 offset:18688
    v_mfma_f32_16x16x32_bf16 v[108:111], v[24:27], a[224:227], v[108:111]
    s_waitcnt lgkmcnt(2)
    v_subrev_u32 v2, 98304, v2
    v_subrev_u32 v3, 98304, v3
    v_mfma_f32_16x16x32_bf16 v[168:171], v[32:35], a[208:211], v[168:171]
    ds_read_b128 v[24:27], v2 offset:0
    v_mfma_f32_16x16x32_bf16 v[168:171], v[36:39], a[212:215], v[168:171]
    s_sub_u32 s3, s29, s30
    v_exp_f32 v17, v125
    v_mfma_f32_16x16x32_bf16 v[172:175], v[36:39], a[236:239], v[172:175]
    ds_read_b128 v[28:31], v3 offset:0
    v_cvt_pk_bf16_f32 v93, v18, v19
    v_mfma_f32_16x16x32_bf16 v[172:175], v[32:35], a[232:235], v[172:175]
    s_waitcnt lgkmcnt(2)
    v_exp_f32 v18, v126
    v_mfma_f32_16x16x32_bf16 v[104:107], v[40:43], a[208:211], v[104:107]
    ds_read_b128 v[32:35], v2 offset:6144
    v_add_f32 v8, v8, v16
    v_mfma_f32_16x16x32_bf16 v[104:107], v[44:47], a[212:215], v[104:107]
    v_add_f32 v8, v8, v17
    v_mfma_f32_16x16x32_bf16 v[108:111], v[44:47], a[236:239], v[108:111]
    ds_read_b128 v[36:39], v3 offset:6144
    v_mfma_f32_16x16x32_bf16 v[108:111], v[40:43], a[232:235], v[108:111]
    s_waitcnt lgkmcnt(2)
    v_exp_f32 v19, v127
    v_mfma_f32_16x16x32_bf16 v[176:179], v[24:27], a[192:195], v[128:131]
    ds_read_b128 v[40:43], v2 offset:128
    v_cvt_pk_bf16_f32 v94, v16, v17
    v_mfma_f32_16x16x32_bf16 v[176:179], v[28:31], a[196:199], v[176:179]
    s_mov_b32 s30, s29
    v_add_f32 v8, v8, v18
    v_add_f32 v8, v8, v19
    v_mfma_f32_16x16x32_bf16 v[180:183], v[28:31], a[220:223], v[132:135]
    ds_read_b128 v[44:47], v3 offset:128
    v_cvt_pk_bf16_f32 v95, v18, v19
    v_mfma_f32_16x16x32_bf16 v[180:183], v[24:27], a[216:219], v[180:183]
    s_waitcnt lgkmcnt(2)
    v_exp_f32 v16, v160
    v_mfma_f32_16x16x32_bf16 v[112:115], v[32:35], a[192:195], v[128:131]
    ds_read_b128 v[24:27], v2 offset:6272
    v_mfma_f32_16x16x32_bf16 v[112:115], v[36:39], a[196:199], v[112:115]
    v_exp_f32 v17, v161
    v_mfma_f32_16x16x32_bf16 v[116:119], v[36:39], a[220:223], v[132:135]
    ds_read_b128 v[28:31], v3 offset:6272
    v_mfma_f32_16x16x32_bf16 v[116:119], v[32:35], a[216:219], v[116:119]
    s_waitcnt lgkmcnt(2)
    v_exp_f32 v18, v162
    v_mfma_f32_16x16x32_bf16 v[176:179], v[40:43], a[200:203], v[176:179]
    ds_read_b128 v[32:35], v2 offset:256
    v_add_f32 v5, v5, v16
    v_mfma_f32_16x16x32_bf16 v[176:179], v[44:47], a[204:207], v[176:179]
    v_add_f32 v5, v5, v17
    v_add_u32 v1, s3, v1
    v_mfma_f32_16x16x32_bf16 v[180:183], v[44:47], a[228:231], v[180:183]
    ds_read_b128 v[36:39], v3 offset:256
    v_mfma_f32_16x16x32_bf16 v[180:183], v[40:43], a[224:227], v[180:183]
    s_waitcnt lgkmcnt(2)
    v_exp_f32 v19, v163
    v_mfma_f32_16x16x32_bf16 v[112:115], v[24:27], a[200:203], v[112:115]
    ds_read_b128 v[40:43], v2 offset:6400
    v_cvt_pk_bf16_f32 v160, v16, v17
    v_mfma_f32_16x16x32_bf16 v[112:115], v[28:31], a[204:207], v[112:115]
    v_exp_f32 v16, v96
    v_mfma_f32_16x16x32_bf16 v[116:119], v[28:31], a[228:231], v[116:119]
    ds_read_b128 v[44:47], v3 offset:6400
    v_add_f32 v5, v5, v18
    v_mfma_f32_16x16x32_bf16 v[116:119], v[24:27], a[224:227], v[116:119]
    s_waitcnt lgkmcnt(2)
    v_add_f32 v5, v5, v19
    v_mfma_f32_16x16x32_bf16 v[176:179], v[32:35], a[208:211], v[176:179]
    ds_read_b128 v[24:27], v2 offset:12288
    v_mfma_f32_16x16x32_bf16 v[176:179], v[36:39], a[212:215], v[176:179]
    v_exp_f32 v17, v97
    v_mfma_f32_16x16x32_bf16 v[180:183], v[36:39], a[236:239], v[180:183]
    ds_read_b128 v[28:31], v3 offset:12288
    v_cvt_pk_bf16_f32 v161, v18, v19
    v_mfma_f32_16x16x32_bf16 v[180:183], v[32:35], a[232:235], v[180:183]
    s_waitcnt lgkmcnt(2)
    v_exp_f32 v18, v98
    v_mfma_f32_16x16x32_bf16 v[112:115], v[40:43], a[208:211], v[112:115]
    ds_read_b128 v[32:35], v2 offset:18432
    v_add_f32 v5, v5, v16
    v_mfma_f32_16x16x32_bf16 v[112:115], v[44:47], a[212:215], v[112:115]
    v_add_f32 v5, v5, v17
    v_mfma_f32_16x16x32_bf16 v[116:119], v[44:47], a[236:239], v[116:119]
    ds_read_b128 v[36:39], v3 offset:18432
    v_mfma_f32_16x16x32_bf16 v[116:119], v[40:43], a[232:235], v[116:119]
    s_waitcnt lgkmcnt(2)
    v_exp_f32 v19, v99
    v_mfma_f32_16x16x32_bf16 v[184:187], v[24:27], a[192:195], v[128:131]
    ds_read_b128 v[40:43], v2 offset:12416
    v_cvt_pk_bf16_f32 v162, v16, v17
    v_mfma_f32_16x16x32_bf16 v[184:187], v[28:31], a[196:199], v[184:187]
    v_exp_f32 v16, v164
    v_mfma_f32_16x16x32_bf16 v[188:191], v[28:31], a[220:223], v[132:135]
    ds_read_b128 v[44:47], v3 offset:12416
    v_add_f32 v5, v5, v18
    v_mfma_f32_16x16x32_bf16 v[188:191], v[24:27], a[216:219], v[188:191]
    s_waitcnt lgkmcnt(2)
    v_add_f32 v5, v5, v19
    v_mfma_f32_16x16x32_bf16 v[120:123], v[32:35], a[192:195], v[128:131]
    ds_read_b128 v[24:27], v2 offset:18560
    v_mfma_f32_16x16x32_bf16 v[120:123], v[36:39], a[196:199], v[120:123]
    s_waitcnt vmcnt(6)
    v_exp_f32 v17, v165
    v_mfma_f32_16x16x32_bf16 v[124:127], v[36:39], a[220:223], v[132:135]
    ds_read_b128 v[28:31], v3 offset:18560
    v_cvt_pk_bf16_f32 v163, v18, v19
    v_mfma_f32_16x16x32_bf16 v[124:127], v[32:35], a[216:219], v[124:127]
    s_waitcnt lgkmcnt(2)
    s_barrier
    v_mfma_f32_16x16x32_bf16 v[184:187], v[40:43], a[200:203], v[184:187]
    ds_read_b128 v[32:35], v2 offset:12544
    v_mfma_f32_16x16x32_bf16 v[184:187], v[44:47], a[204:207], v[184:187]
    v_exp_f32 v18, v166
    v_mfma_f32_16x16x32_bf16 v[188:191], v[44:47], a[228:231], v[188:191]
    ds_read_b128 v[36:39], v3 offset:12544
    v_add_f32 v6, v6, v16
    v_mfma_f32_16x16x32_bf16 v[188:191], v[40:43], a[224:227], v[188:191]
    s_waitcnt lgkmcnt(2)
    v_add_f32 v6, v6, v17
    v_mfma_f32_16x16x32_bf16 v[120:123], v[24:27], a[200:203], v[120:123]
    ds_read_b128 v[40:43], v2 offset:18688
    v_mfma_f32_16x16x32_bf16 v[120:123], v[28:31], a[204:207], v[120:123]
    v_exp_f32 v19, v167
    v_cvt_pk_bf16_f32 v164, v16, v17
    v_mfma_f32_16x16x32_bf16 v[124:127], v[28:31], a[228:231], v[124:127]
    ds_read_b128 v[44:47], v3 offset:18688
    v_mfma_f32_16x16x32_bf16 v[124:127], v[24:27], a[224:227], v[124:127]
    s_waitcnt lgkmcnt(2)
    v_exp_f32 v16, v100
    v_mfma_f32_16x16x32_bf16 v[184:187], v[32:35], a[208:211], v[184:187]
    ds_read_b128 v[24:27], v1 offset:0
    v_add_f32 v6, v6, v18
    v_mfma_f32_16x16x32_bf16 v[184:187], v[36:39], a[212:215], v[184:187]
    v_add_f32 v6, v6, v19
    v_mfma_f32_16x16x32_bf16 v[188:191], v[36:39], a[236:239], v[188:191]
    ds_read_b128 v[28:31], v1 offset:12288
    v_mfma_f32_16x16x32_bf16 v[188:191], v[32:35], a[232:235], v[188:191]
    s_waitcnt lgkmcnt(2)
    v_exp_f32 v17, v101
    v_cvt_pk_bf16_f32 v165, v18, v19
    v_mfma_f32_16x16x32_bf16 v[120:123], v[40:43], a[208:211], v[120:123]
    ds_read_b128 v[32:35], v1 offset:1024
    v_mfma_f32_16x16x32_bf16 v[120:123], v[44:47], a[212:215], v[120:123]
    v_exp_f32 v18, v102
    v_mfma_f32_16x16x32_bf16 v[124:127], v[44:47], a[236:239], v[124:127]
    ds_read_b128 v[36:39], v1 offset:13312
    v_add_f32 v6, v6, v16
    v_mfma_f32_16x16x32_bf16 v[124:127], v[40:43], a[232:235], v[124:127]
    s_waitcnt lgkmcnt(2)
    v_add_f32 v6, v6, v17
    v_exp_f32 v19, v103
    v_cvt_pk_bf16_f32 v166, v16, v17
    v_add_f32 v6, v6, v18
    v_add_f32 v6, v6, v19
    v_cvt_pk_bf16_f32 v167, v18, v19
    v_mfma_f32_16x16x32_bf16 a[0:3], v[64:67], v[24:27], a[0:3]
    s_mov_b32 m0, s56
    ds_read_b128 v[40:43], v1 offset:2048
    v_bfe_u32 v57, v4, 8, 2
    v_mfma_f32_16x16x32_bf16 a[0:3], v[80:83], v[28:31], a[0:3]
    buffer_load_dwordx4 v4, s[4:7], s27 offen offset:0 sc1 lds
    v_mfma_f32_16x16x32_bf16 a[48:51], v[84:87], v[28:31], a[48:51]
    v_exp_f32 v16, v168
    v_mfma_f32_16x16x32_bf16 a[48:51], v[68:71], v[24:27], a[48:51]
    v_exp_f32 v17, v169
    v_mfma_f32_16x16x32_bf16 a[96:99], v[72:75], v[24:27], a[96:99]
    ds_read_b128 v[44:47], v1 offset:14336
    v_mul_u32_u24 v56, 1536, v57
    v_mfma_f32_16x16x32_bf16 a[96:99], v[88:91], v[28:31], a[96:99]
    buffer_load_dwordx4 v4, s[4:7], s27 offen offset:1024 sc1 lds
    v_mfma_f32_16x16x32_bf16 a[144:147], v[92:95], v[28:31], a[144:147]
    v_exp_f32 v18, v170
    v_mfma_f32_16x16x32_bf16 a[144:147], v[76:79], v[24:27], a[144:147]
    s_waitcnt lgkmcnt(2)
    v_add_f32 v5, v5, v16
    v_add_f32 v5, v5, v17
    v_mfma_f32_16x16x32_bf16 a[4:7], v[64:67], v[32:35], a[4:7]
    ds_read_b128 v[24:27], v1 offset:3072
    v_lshlrev_b32 v58, 4, v57
    v_mfma_f32_16x16x32_bf16 a[4:7], v[80:83], v[36:39], a[4:7]
    buffer_load_dwordx4 v4, s[4:7], s27 offen offset:2048 sc1 lds
    v_mfma_f32_16x16x32_bf16 a[52:55], v[84:87], v[36:39], a[52:55]
    v_exp_f32 v19, v171
    v_mfma_f32_16x16x32_bf16 a[52:55], v[68:71], v[32:35], a[52:55]
    s_add_u32 s27, s27, 24576
    v_cvt_pk_bf16_f32 v168, v16, v17
    v_bfe_u32 v57, v4, 4, 4
    v_mfma_f32_16x16x32_bf16 a[100:103], v[72:75], v[32:35], a[100:103]
    ds_read_b128 v[28:31], v1 offset:15360
    v_mfma_f32_16x16x32_bf16 a[100:103], v[88:91], v[36:39], a[100:103]
    s_add_u32 s56, s56, 12288
    v_exp_f32 v16, v104
    v_mfma_f32_16x16x32_bf16 a[148:151], v[92:95], v[36:39], a[148:151]
    v_add_f32 v5, v5, v18
    v_add_f32 v5, v5, v19
    v_mfma_f32_16x16x32_bf16 a[148:151], v[76:79], v[32:35], a[148:151]
    s_waitcnt lgkmcnt(2)
    v_exp_f32 v17, v105
    v_mfma_f32_16x16x32_bf16 a[8:11], v[64:67], v[40:43], a[8:11]
    s_mov_b32 m0, s56
    ds_read_b128 v[32:35], v1 offset:4096
    v_cvt_pk_bf16_f32 v169, v18, v19
    v_mfma_f32_16x16x32_bf16 a[8:11], v[80:83], v[44:47], a[8:11]
    v_exp_f32 v18, v106
    v_mfma_f32_16x16x32_bf16 a[56:59], v[84:87], v[44:47], a[56:59]
    v_add_f32 v5, v5, v16
    v_add_f32 v5, v5, v17
    v_mfma_f32_16x16x32_bf16 a[56:59], v[68:71], v[40:43], a[56:59]
    buffer_load_dwordx4 v4, s[4:7], s27 offen offset:0 sc1 lds
    v_mfma_f32_16x16x32_bf16 a[104:107], v[72:75], v[40:43], a[104:107]
    ds_read_b128 v[36:39], v1 offset:16384
    v_mul_u32_u24 v57, 12, v57
    v_mfma_f32_16x16x32_bf16 a[104:107], v[88:91], v[44:47], a[104:107]
    v_exp_f32 v19, v107
    v_mfma_f32_16x16x32_bf16 a[152:155], v[92:95], v[44:47], a[152:155]
    v_cvt_pk_bf16_f32 v170, v16, v17
    v_add_u32 v56, v56, v57
    v_mfma_f32_16x16x32_bf16 a[152:155], v[76:79], v[40:43], a[152:155]
    s_waitcnt lgkmcnt(2)
    buffer_load_dwordx4 v4, s[4:7], s27 offen offset:1024 sc1 lds
    v_mfma_f32_16x16x32_bf16 a[12:15], v[64:67], v[24:27], a[12:15]
    ds_read_b128 v[40:43], v1 offset:5120
    v_mfma_f32_16x16x32_bf16 a[12:15], v[80:83], v[28:31], a[12:15]
    v_exp_f32 v16, v172
    v_mfma_f32_16x16x32_bf16 a[60:63], v[84:87], v[28:31], a[60:63]
    v_add_f32 v5, v5, v18
    v_add_f32 v5, v5, v19
    v_mfma_f32_16x16x32_bf16 a[60:63], v[68:71], v[24:27], a[60:63]
    buffer_load_dwordx4 v4, s[4:7], s27 offen offset:2048 sc1 lds
    v_mfma_f32_16x16x32_bf16 a[108:111], v[72:75], v[24:27], a[108:111]
    ds_read_b128 v[44:47], v1 offset:17408
    v_mov_b32 v57, 1.0
    v_mfma_f32_16x16x32_bf16 a[108:111], v[88:91], v[28:31], a[108:111]
    v_exp_f32 v17, v173
    v_mfma_f32_16x16x32_bf16 a[156:159], v[92:95], v[28:31], a[156:159]
    s_add_u32 s27, s27, 24576
    v_cvt_pk_bf16_f32 v171, v18, v19
    v_mfma_f32_16x16x32_bf16 a[156:159], v[76:79], v[24:27], a[156:159]
    s_waitcnt lgkmcnt(2)
    v_exp_f32 v18, v174
    v_mfma_f32_16x16x32_bf16 a[16:19], v[64:67], v[32:35], a[16:19]
    s_add_u32 s56, s56, 36864
    ds_read_b128 v[24:27], v1 offset:6144
    v_add_f32 v6, v6, v16
    v_mfma_f32_16x16x32_bf16 a[16:19], v[80:83], v[36:39], a[16:19]
    v_add_f32 v6, v6, v17
    v_mov_b32 v20, 0x3f803f80
    v_mfma_f32_16x16x32_bf16 a[64:67], v[84:87], v[36:39], a[64:67]
    s_sub_u32 s58, s56, 147456
    v_exp_f32 v19, v175
    v_mfma_f32_16x16x32_bf16 a[64:67], v[68:71], v[32:35], a[64:67]
    v_cvt_pk_bf16_f32 v172, v16, v17
    v_mfma_f32_16x16x32_bf16 a[112:115], v[72:75], v[32:35], a[112:115]
    s_min_u32 s56, s56, s58
    ds_read_b128 v[28:31], v1 offset:18432
    v_mov_b32 v21, 0x3f803f80
    v_mfma_f32_16x16x32_bf16 a[112:115], v[88:91], v[36:39], a[112:115]
    v_exp_f32 v16, v108
    v_mfma_f32_16x16x32_bf16 a[160:163], v[92:95], v[36:39], a[160:163]
    s_mov_b32 m0, s56
    v_add_f32 v6, v6, v18
    v_add_f32 v6, v6, v19
    v_mfma_f32_16x16x32_bf16 a[160:163], v[76:79], v[32:35], a[160:163]
    s_waitcnt lgkmcnt(2)
    v_exp_f32 v17, v109
    v_mfma_f32_16x16x32_bf16 a[20:23], v[64:67], v[40:43], a[20:23]
    ds_read_b128 v[32:35], v1 offset:7168
    v_cvt_pk_bf16_f32 v173, v18, v19
    v_mfma_f32_16x16x32_bf16 a[20:23], v[80:83], v[44:47], a[20:23]
    buffer_load_dwordx4 v4, s[4:7], s27 offen offset:0 sc1 lds
    v_mfma_f32_16x16x32_bf16 a[68:71], v[84:87], v[44:47], a[68:71]
    v_exp_f32 v18, v110
    v_mfma_f32_16x16x32_bf16 a[68:71], v[68:71], v[40:43], a[68:71]
    v_add_f32 v6, v6, v16
    v_add_f32 v6, v6, v17
    v_mfma_f32_16x16x32_bf16 a[116:119], v[72:75], v[40:43], a[116:119]
    ds_read_b128 v[36:39], v1 offset:19456
    v_mov_b32 v22, 0x3f803f80
    v_mfma_f32_16x16x32_bf16 a[116:119], v[88:91], v[44:47], a[116:119]
    buffer_load_dwordx4 v4, s[4:7], s27 offen offset:1024 sc1 lds
    v_mfma_f32_16x16x32_bf16 a[164:167], v[92:95], v[44:47], a[164:167]
    v_exp_f32 v19, v111
    v_mfma_f32_16x16x32_bf16 a[164:167], v[76:79], v[40:43], a[164:167]
    s_waitcnt lgkmcnt(2)
    v_cvt_pk_bf16_f32 v174, v16, v17
    v_add_f32 v6, v6, v18
    v_mfma_f32_16x16x32_bf16 a[24:27], v[64:67], v[24:27], a[24:27]
    ds_read_b128 v[40:43], v1 offset:8192
    v_add_f32 v6, v6, v19
    v_mfma_f32_16x16x32_bf16 a[24:27], v[80:83], v[28:31], a[24:27]
    buffer_load_dwordx4 v4, s[4:7], s27 offen offset:2048 sc1 lds
    v_mfma_f32_16x16x32_bf16 a[72:75], v[84:87], v[28:31], a[72:75]
    v_cvt_pk_bf16_f32 v175, v18, v19
    v_mov_b32 v23, 0x3f803f80
    v_mfma_f32_16x16x32_bf16 a[72:75], v[68:71], v[24:27], a[72:75]
    v_exp_f32 v16, v176
    v_mfma_f32_16x16x32_bf16 a[120:123], v[72:75], v[24:27], a[120:123]
    ds_read_b128 v[44:47], v1 offset:20480
    v_mfma_f32_16x16x32_bf16 a[120:123], v[88:91], v[28:31], a[120:123]
    s_lshl_b32 s24, s95, 2
    v_exp_f32 v17, v177
    v_mfma_f32_16x16x32_bf16 a[168:171], v[92:95], v[28:31], a[168:171]
    s_add_u32 s27, s27, 24576
    v_exp_f32 v18, v178
    v_mfma_f32_16x16x32_bf16 a[168:171], v[76:79], v[24:27], a[168:171]
    s_waitcnt lgkmcnt(2)
    v_add_f32 v5, v5, v16
    v_add_f32 v5, v5, v17
    v_mfma_f32_16x16x32_bf16 a[28:31], v[64:67], v[32:35], a[28:31]
    s_add_u32 s56, s56, 12288
    ds_read_b128 v[24:27], v1 offset:9216
    v_mfma_f32_16x16x32_bf16 a[28:31], v[80:83], v[36:39], a[28:31]
    s_mov_b32 m0, s56
    v_exp_f32 v19, v179
    v_mfma_f32_16x16x32_bf16 a[76:79], v[84:87], v[36:39], a[76:79]
    v_cvt_pk_bf16_f32 v176, v16, v17
    v_mfma_f32_16x16x32_bf16 a[76:79], v[68:71], v[32:35], a[76:79]
    s_add_u32 s24, s24, s25
    v_exp_f32 v16, v112
    v_mfma_f32_16x16x32_bf16 a[124:127], v[72:75], v[32:35], a[124:127]
    ds_read_b128 v[28:31], v1 offset:21504
    v_add_f32 v5, v5, v18
    v_mfma_f32_16x16x32_bf16 a[124:127], v[88:91], v[36:39], a[124:127]
    buffer_load_dwordx4 v4, s[4:7], s27 offen offset:0 sc1 lds
    v_mfma_f32_16x16x32_bf16 a[172:175], v[92:95], v[36:39], a[172:175]
L_pg11:
    s_cbranch_execz L_iwret
    v_add_f32 v5, v5, v19
    v_mfma_f32_16x16x32_bf16 a[172:175], v[76:79], v[32:35], a[172:175]
    s_waitcnt lgkmcnt(2)
    v_exp_f32 v17, v113
    v_mfma_f32_16x16x32_bf16 a[32:35], v[64:67], v[40:43], a[32:35]
    s_mul_i32 s24, s24, 24576
    ds_read_b128 v[32:35], v1 offset:10240
    v_cvt_pk_bf16_f32 v177, v18, v19
    v_mfma_f32_16x16x32_bf16 a[32:35], v[80:83], v[44:47], a[32:35]
    buffer_load_dwordx4 v4, s[4:7], s27 offen offset:1024 sc1 lds
    v_mfma_f32_16x16x32_bf16 a[80:83], v[84:87], v[44:47], a[80:83]
    v_exp_f32 v18, v114
    v_mfma_f32_16x16x32_bf16 a[80:83], v[68:71], v[40:43], a[80:83]
    v_add_f32 v5, v5, v16
    v_add_f32 v5, v5, v17
    v_mfma_f32_16x16x32_bf16 a[128:131], v[72:75], v[40:43], a[128:131]
    ds_read_b128 v[36:39], v1 offset:22528
    v_mfma_f32_16x16x32_bf16 a[128:131], v[88:91], v[44:47], a[128:131]
    buffer_load_dwordx4 v4, s[4:7], s27 offen offset:2048 sc1 lds
    v_mfma_f32_16x16x32_bf16 a[176:179], v[92:95], v[44:47], a[176:179]
    s_add_u32 s40, s24, 6144
    v_exp_f32 v19, v115
    v_mfma_f32_16x16x32_bf16 a[176:179], v[76:79], v[40:43], a[176:179]
    s_waitcnt lgkmcnt(2)
    v_cvt_pk_bf16_f32 v178, v16, v17
    v_mfma_f32_16x16x32_bf16 a[36:39], v[64:67], v[24:27], a[36:39]
    ds_read_b128 v[40:43], v1 offset:11264
    v_mfma_f32_16x16x32_bf16 a[36:39], v[80:83], v[28:31], a[36:39]
    v_exp_f32 v16, v180
    v_mfma_f32_16x16x32_bf16 a[84:87], v[84:87], v[28:31], a[84:87]
    v_add_f32 v5, v5, v18
    v_add_f32 v5, v5, v19
    v_mfma_f32_16x16x32_bf16 a[84:87], v[68:71], v[24:27], a[84:87]
    s_add_u32 s27, s27, 24576
    v_exp_f32 v17, v181
    v_mfma_f32_16x16x32_bf16 a[132:135], v[72:75], v[24:27], a[132:135]
    s_add_u32 s56, s56, 36864
    ds_read_b128 v[44:47], v1 offset:23552
    v_cvt_pk_bf16_f32 v179, v18, v19
    v_mfma_f32_16x16x32_bf16 a[132:135], v[88:91], v[28:31], a[132:135]
    s_waitcnt lgkmcnt(2)
    v_exp_f32 v18, v182
    v_mfma_f32_16x16x32_bf16 a[180:183], v[92:95], v[28:31], a[180:183]
    s_waitcnt vmcnt(12)
    v_add_f32 v6, v6, v16
    v_add_f32 v6, v6, v17
    v_mfma_f32_16x16x32_bf16 a[180:183], v[76:79], v[24:27], a[180:183]
    s_barrier
    v_add_u32 v2, 49152, v2
    v_add_u32 v3, 49152, v3
    v_mfma_f32_16x16x32_bf16 a[40:43], v[64:67], v[32:35], a[40:43]
    s_sub_u32 s58, s56, 147456
    ds_read_b128 v[24:27], v2 offset:0
    s_add_u32 s41, s24, 12288
    v_mfma_f32_16x16x32_bf16 a[40:43], v[80:83], v[36:39], a[40:43]
    s_min_u32 s56, s56, s58
    v_exp_f32 v19, v183
    v_mfma_f32_16x16x32_bf16 a[88:91], v[84:87], v[36:39], a[88:91]
    s_add_u32 s42, s24, 18432
    v_cvt_pk_bf16_f32 v180, v16, v17
    v_mfma_f32_16x16x32_bf16 a[88:91], v[68:71], v[32:35], a[88:91]
    v_exp_f32 v16, v116
    v_mfma_f32_16x16x32_bf16 a[136:139], v[72:75], v[32:35], a[136:139]
    ds_read_b128 v[28:31], v3 offset:0
    v_add_f32 v6, v6, v18
    v_mfma_f32_16x16x32_bf16 a[136:139], v[88:91], v[36:39], a[136:139]
    v_add_f32 v6, v6, v19
    v_mfma_f32_16x16x32_bf16 a[184:187], v[92:95], v[36:39], a[184:187]
    v_exp_f32 v17, v117
    v_mfma_f32_16x16x32_bf16 a[184:187], v[76:79], v[32:35], a[184:187]
    s_waitcnt lgkmcnt(2)
    v_cvt_pk_bf16_f32 v181, v18, v19
    v_mfma_f32_16x16x32_bf16 a[44:47], v[64:67], v[40:43], a[44:47]
    ds_read_b128 v[32:35], v2 offset:6144
    v_mfma_f32_16x16x32_bf16 a[44:47], v[80:83], v[44:47], a[44:47]
    v_exp_f32 v18, v118
    v_mfma_f32_16x16x32_bf16 a[92:95], v[84:87], v[44:47], a[92:95]
    v_add_f32 v6, v6, v16
    v_add_f32 v6, v6, v17
    v_mfma_f32_16x16x32_bf16 a[92:95], v[68:71], v[40:43], a[92:95]
    v_exp_f32 v19, v119
    v_mfma_f32_16x16x32_bf16 a[140:143], v[72:75], v[40:43], a[140:143]
    ds_read_b128 v[36:39], v3 offset:6144
    v_cvt_pk_bf16_f32 v182, v16, v17
    v_mfma_f32_16x16x32_bf16 a[140:143], v[88:91], v[44:47], a[140:143]
    v_add_f32 v6, v6, v18
    v_add_f32 v6, v6, v19
    v_mfma_f32_16x16x32_bf16 a[188:191], v[92:95], v[44:47], a[188:191]
    v_cvt_pk_bf16_f32 v183, v18, v19
    v_mfma_f32_16x16x32_bf16 a[188:191], v[76:79], v[40:43], a[188:191]
    s_waitcnt lgkmcnt(2)
    v_mfma_f32_16x16x32_bf16 v[64:67], v[24:27], a[192:195], v[128:131]
    ds_read_b128 v[40:43], v2 offset:128
    v_mfma_f32_16x16x32_bf16 v[64:67], v[28:31], a[196:199], v[64:67]
    v_exp_f32 v16, v184
    v_mfma_f32_16x16x32_bf16 v[68:71], v[28:31], a[220:223], v[132:135]
    ds_read_b128 v[44:47], v3 offset:128
    v_mfma_f32_16x16x32_bf16 v[68:71], v[24:27], a[216:219], v[68:71]
    s_waitcnt lgkmcnt(2)
    v_exp_f32 v17, v185
    v_mfma_f32_16x16x32_bf16 v[96:99], v[32:35], a[192:195], v[128:131]
    ds_read_b128 v[24:27], v2 offset:6272
    v_mfma_f32_16x16x32_bf16 v[96:99], v[36:39], a[196:199], v[96:99]
    v_exp_f32 v18, v186
    v_mfma_f32_16x16x32_bf16 v[100:103], v[36:39], a[220:223], v[132:135]
    ds_read_b128 v[28:31], v3 offset:6272
    v_add_f32 v5, v5, v16
    v_mfma_f32_16x16x32_bf16 v[100:103], v[32:35], a[216:219], v[100:103]
    s_waitcnt lgkmcnt(2)
    v_add_f32 v5, v5, v17
    v_mfma_f32_16x16x32_bf16 v[64:67], v[40:43], a[200:203], v[64:67]
    ds_read_b128 v[32:35], v2 offset:256
    v_mfma_f32_16x16x32_bf16 v[64:67], v[44:47], a[204:207], v[64:67]
    v_exp_f32 v19, v187
    v_mfma_f32_16x16x32_bf16 v[68:71], v[44:47], a[228:231], v[68:71]
    ds_read_b128 v[36:39], v3 offset:256
    v_cvt_pk_bf16_f32 v184, v16, v17
    v_mfma_f32_16x16x32_bf16 v[68:71], v[40:43], a[224:227], v[68:71]
    s_waitcnt lgkmcnt(2)
    v_exp_f32 v16, v120
    v_mfma_f32_16x16x32_bf16 v[96:99], v[24:27], a[200:203], v[96:99]
    ds_read_b128 v[40:43], v2 offset:6400
    v_add_f32 v5, v5, v18
    v_mfma_f32_16x16x32_bf16 v[96:99], v[28:31], a[204:207], v[96:99]
    s_waitcnt vmcnt(0)
    v_add_f32 v5, v5, v19
    v_mfma_f32_16x16x32_bf16 v[100:103], v[28:31], a[228:231], v[100:103]
    ds_read_b128 v[44:47], v3 offset:6400
    v_mfma_f32_16x16x32_bf16 v[100:103], v[24:27], a[224:227], v[100:103]
    s_waitcnt lgkmcnt(2)
    s_barrier
    v_mfma_f32_16x16x32_bf16 v[64:67], v[32:35], a[208:211], v[64:67]
    s_mov_b32 m0, s56
    ds_read_b128 v[24:27], v2 offset:12288
    v_mfma_f32_16x16x32_bf16 v[64:67], v[36:39], a[212:215], v[64:67]
    buffer_load_dwordx4 v4, s[4:7], s27 offen offset:0 sc1 lds
    v_mfma_f32_16x16x32_bf16 v[68:71], v[36:39], a[236:239], v[68:71]
    ds_read_b128 v[28:31], v3 offset:12288
    v_mfma_f32_16x16x32_bf16 v[68:71], v[32:35], a[232:235], v[68:71]
    s_waitcnt lgkmcnt(2)
    v_exp_f32 v17, v121
    v_cvt_pk_bf16_f32 v185, v18, v19
    v_mfma_f32_16x16x32_bf16 v[96:99], v[40:43], a[208:211], v[96:99]
    ds_read_b128 v[32:35], v2 offset:18432
    v_mfma_f32_16x16x32_bf16 v[96:99], v[44:47], a[212:215], v[96:99]
    buffer_load_dwordx4 v4, s[4:7], s27 offen offset:1024 sc1 lds
    v_mfma_f32_16x16x32_bf16 v[100:103], v[44:47], a[236:239], v[100:103]
    ds_read_b128 v[36:39], v3 offset:18432
    v_mfma_f32_16x16x32_bf16 v[100:103], v[40:43], a[232:235], v[100:103]
    s_waitcnt lgkmcnt(2)
    v_exp_f32 v18, v122
    v_add_f32 v5, v5, v16
    v_mfma_f32_16x16x32_bf16 v[72:75], v[24:27], a[192:195], v[128:131]
    ds_read_b128 v[40:43], v2 offset:12416
    v_add_f32 v5, v5, v17
    v_mfma_f32_16x16x32_bf16 v[72:75], v[28:31], a[196:199], v[72:75]
    v_exp_f32 v19, v123
    v_cvt_pk_bf16_f32 v186, v16, v17
    v_mfma_f32_16x16x32_bf16 v[76:79], v[28:31], a[220:223], v[132:135]
    ds_read_b128 v[44:47], v3 offset:12416
    v_mfma_f32_16x16x32_bf16 v[76:79], v[24:27], a[216:219], v[76:79]
    s_waitcnt lgkmcnt(2)
    buffer_load_dwordx4 v4, s[4:7], s27 offen offset:2048 sc1 lds
    v_mfma_f32_16x16x32_bf16 v[104:107], v[32:35], a[192:195], v[128:131]
    ds_read_b128 v[24:27], v2 offset:18560
    v_mfma_f32_16x16x32_bf16 v[104:107], v[36:39], a[196:199], v[104:107]
    v_exp_f32 v16, v188
    v_add_f32 v5, v5, v18
    v_mfma_f32_16x16x32_bf16 v[108:111], v[36:39], a[220:223], v[132:135]
    ds_read_b128 v[28:31], v3 offset:18560
    v_add_f32 v5, v5, v19
    v_mfma_f32_16x16x32_bf16 v[108:111], v[32:35], a[216:219], v[108:111]
    s_waitcnt lgkmcnt(2)
    v_exp_f32 v17, v189
    v_cvt_pk_bf16_f32 v187, v18, v19
    v_mfma_f32_16x16x32_bf16 v[72:75], v[40:43], a[200:203], v[72:75]
    s_add_u32 s27, s27, 24576
    ds_read_b128 v[32:35], v2 offset:12544
    v_mfma_f32_16x16x32_bf16 v[72:75], v[44:47], a[204:207], v[72:75]
    v_exp_f32 v18, v190
    v_mfma_f32_16x16x32_bf16 v[76:79], v[44:47], a[228:231], v[76:79]
    s_add_u32 s56, s56, 12288
    ds_read_b128 v[36:39], v3 offset:12544
    v_add_f32 v6, v6, v16
    v_mfma_f32_16x16x32_bf16 v[76:79], v[40:43], a[224:227], v[76:79]
    s_waitcnt lgkmcnt(2)
    v_add_f32 v6, v6, v17
    v_mfma_f32_16x16x32_bf16 v[104:107], v[24:27], a[200:203], v[104:107]
    ds_read_b128 v[40:43], v2 offset:18688
    v_mfma_f32_16x16x32_bf16 v[104:107], v[28:31], a[204:207], v[104:107]
    v_exp_f32 v19, v191
    v_cvt_pk_bf16_f32 v188, v16, v17
    v_mfma_f32_16x16x32_bf16 v[108:111], v[28:31], a[228:231], v[108:111]
    s_mov_b32 m0, s56
    ds_read_b128 v[44:47], v3 offset:18688
    v_mfma_f32_16x16x32_bf16 v[108:111], v[24:27], a[224:227], v[108:111]
    s_waitcnt lgkmcnt(2)
    v_add_u32 v2, 49152, v2
    v_add_u32 v3, 49152, v3
    v_mfma_f32_16x16x32_bf16 v[72:75], v[32:35], a[208:211], v[72:75]
    ds_read_b128 v[24:27], v2 offset:0
    v_mfma_f32_16x16x32_bf16 v[72:75], v[36:39], a[212:215], v[72:75]
    buffer_load_dwordx4 v4, s[4:7], s27 offen offset:0 sc1 lds
    v_mfma_f32_16x16x32_bf16 v[76:79], v[36:39], a[236:239], v[76:79]
    ds_read_b128 v[28:31], v3 offset:0
    v_mfma_f32_16x16x32_bf16 v[76:79], v[32:35], a[232:235], v[76:79]
    s_waitcnt lgkmcnt(2)
    v_exp_f32 v16, v124
    v_add_f32 v6, v6, v18
    v_mfma_f32_16x16x32_bf16 v[104:107], v[40:43], a[208:211], v[104:107]
    ds_read_b128 v[32:35], v2 offset:6144
    v_add_f32 v6, v6, v19
    v_mfma_f32_16x16x32_bf16 v[104:107], v[44:47], a[212:215], v[104:107]
    v_exp_f32 v17, v125
    v_cvt_pk_bf16_f32 v189, v18, v19
    v_mfma_f32_16x16x32_bf16 v[108:111], v[44:47], a[236:239], v[108:111]
    ds_read_b128 v[36:39], v3 offset:6144
    v_mfma_f32_16x16x32_bf16 v[108:111], v[40:43], a[232:235], v[108:111]
    s_waitcnt lgkmcnt(2)
    buffer_load_dwordx4 v4, s[4:7], s27 offen offset:1024 sc1 lds
    v_mfma_f32_16x16x32_bf16 v[80:83], v[24:27], a[240:243], v[136:139]
    ds_read_b128 v[40:43], v2 offset:128
    v_mfma_f32_16x16x32_bf16 v[80:83], v[28:31], a[244:247], v[80:83]
    v_exp_f32 v18, v126
    v_add_f32 v6, v6, v16
    v_mfma_f32_16x16x32_bf16 v[84:87], v[28:31], v[204:207], v[140:143]
    ds_read_b128 v[44:47], v3 offset:128
    v_add_f32 v6, v6, v17
    v_exp_f32 v19, v127
    v_cvt_pk_bf16_f32 v190, v16, v17
    v_add_f32 v6, v6, v18
    v_add_f32 v6, v6, v19
    v_cvt_pk_bf16_f32 v191, v18, v19
    v_mfma_f32_16x16x32_bf16 v[84:87], v[24:27], v[200:203], v[84:87]
    s_waitcnt lgkmcnt(2)
    v_exp_f32 v16, v64
    v_mfma_f32_16x16x32_bf16 v[112:115], v[32:35], a[240:243], v[136:139]
    ds_read_b128 v[24:27], v2 offset:6272
    v_mfma_f32_16x16x32_bf16 v[112:115], v[36:39], a[244:247], v[112:115]
    buffer_load_dwordx4 v4, s[4:7], s27 offen offset:2048 sc1 lds
    v_mfma_f32_16x16x32_bf16 v[116:119], v[36:39], v[204:207], v[140:143]
    ds_read_b128 v[28:31], v3 offset:6272
    v_mfma_f32_16x16x32_bf16 v[116:119], v[32:35], v[200:203], v[116:119]
    s_waitcnt lgkmcnt(2)
    v_exp_f32 v17, v65
    v_mfma_f32_16x16x32_bf16 v[80:83], v[40:43], a[248:251], v[80:83]
    ds_read_b128 v[32:35], v2 offset:256
    v_mfma_f32_16x16x32_bf16 v[80:83], v[44:47], a[252:255], v[80:83]
    v_exp_f32 v18, v66
    v_mfma_f32_16x16x32_bf16 v[84:87], v[44:47], v[212:215], v[84:87]
    ds_read_b128 v[36:39], v3 offset:256
    v_add_f32 v5, v5, v16
    v_mfma_f32_16x16x32_bf16 v[84:87], v[40:43], v[208:211], v[84:87]
    s_waitcnt lgkmcnt(2)
    v_add_f32 v5, v5, v17
    v_mfma_f32_16x16x32_bf16 v[112:115], v[24:27], a[248:251], v[112:115]
    ds_read_b128 v[40:43], v2 offset:6400
    v_mfma_f32_16x16x32_bf16 v[112:115], v[28:31], a[252:255], v[112:115]
    v_exp_f32 v19, v67
    v_cvt_pk_bf16_f32 v64, v16, v17
    v_mfma_f32_16x16x32_bf16 v[116:119], v[28:31], v[212:215], v[116:119]
    s_add_u32 s27, s27, 24576
    ds_read_b128 v[44:47], v3 offset:6400
    s_add_u32 s56, s56, 36864
    v_mfma_f32_16x16x32_bf16 v[116:119], v[24:27], v[208:211], v[116:119]
    s_waitcnt lgkmcnt(2)
    v_exp_f32 v16, v96
    v_mfma_f32_16x16x32_bf16 v[80:83], v[32:35], v[192:195], v[80:83]
    s_sub_u32 s58, s56, 147456
    ds_read_b128 v[24:27], v2 offset:12288
    v_add_f32 v5, v5, v18
    v_mfma_f32_16x16x32_bf16 v[80:83], v[36:39], v[196:199], v[80:83]
    s_min_u32 s56, s56, s58
    v_add_f32 v5, v5, v19
    v_mfma_f32_16x16x32_bf16 v[84:87], v[36:39], v[220:223], v[84:87]
    ds_read_b128 v[28:31], v3 offset:12288
    v_mfma_f32_16x16x32_bf16 v[84:87], v[32:35], v[216:219], v[84:87]
    s_waitcnt lgkmcnt(2)
    v_exp_f32 v17, v97
    v_cvt_pk_bf16_f32 v65, v18, v19
    v_mfma_f32_16x16x32_bf16 v[112:115], v[40:43], v[192:195], v[112:115]
    ds_read_b128 v[32:35], v2 offset:18432
    v_mfma_f32_16x16x32_bf16 v[112:115], v[44:47], v[196:199], v[112:115]
    v_exp_f32 v18, v98
    v_mfma_f32_16x16x32_bf16 v[116:119], v[44:47], v[220:223], v[116:119]
    ds_read_b128 v[36:39], v3 offset:18432
    v_add_f32 v5, v5, v16
    v_mfma_f32_16x16x32_bf16 v[116:119], v[40:43], v[216:219], v[116:119]
    s_waitcnt lgkmcnt(2)
    v_add_f32 v5, v5, v17
    v_mfma_f32_16x16x32_bf16 v[88:91], v[24:27], a[240:243], v[136:139]
    ds_read_b128 v[40:43], v2 offset:12416
    v_mfma_f32_16x16x32_bf16 v[88:91], v[28:31], a[244:247], v[88:91]
    v_exp_f32 v19, v99
    v_cvt_pk_bf16_f32 v66, v16, v17
    v_mfma_f32_16x16x32_bf16 v[92:95], v[28:31], v[204:207], v[140:143]
    ds_read_b128 v[44:47], v3 offset:12416
    v_mfma_f32_16x16x32_bf16 v[92:95], v[24:27], v[200:203], v[92:95]
    s_waitcnt lgkmcnt(2)
    v_exp_f32 v16, v68
    v_mfma_f32_16x16x32_bf16 v[120:123], v[32:35], a[240:243], v[136:139]
    ds_read_b128 v[24:27], v2 offset:18560
    v_add_f32 v5, v5, v18
    v_mfma_f32_16x16x32_bf16 v[120:123], v[36:39], a[244:247], v[120:123]
    v_add_f32 v5, v5, v19
    v_mfma_f32_16x16x32_bf16 v[124:127], v[36:39], v[204:207], v[140:143]
    ds_read_b128 v[28:31], v3 offset:18560
    v_mfma_f32_16x16x32_bf16 v[124:127], v[32:35], v[200:203], v[124:127]
    s_waitcnt lgkmcnt(2)
    v_exp_f32 v17, v69
    v_cvt_pk_bf16_f32 v67, v18, v19
    v_mfma_f32_16x16x32_bf16 v[88:91], v[40:43], a[248:251], v[88:91]
    ds_read_b128 v[32:35], v2 offset:12544
    v_mfma_f32_16x16x32_bf16 v[88:91], v[44:47], a[252:255], v[88:91]
    v_exp_f32 v18, v70
    v_mfma_f32_16x16x32_bf16 v[92:95], v[44:47], v[212:215], v[92:95]
    ds_read_b128 v[36:39], v3 offset:12544
    v_add_f32 v6, v6, v16
    v_mfma_f32_16x16x32_bf16 v[92:95], v[40:43], v[208:211], v[92:95]
    s_waitcnt lgkmcnt(2)
    v_add_f32 v6, v6, v17
    v_mfma_f32_16x16x32_bf16 v[120:123], v[24:27], a[248:251], v[120:123]
    ds_read_b128 v[40:43], v2 offset:18688
    v_mfma_f32_16x16x32_bf16 v[120:123], v[28:31], a[252:255], v[120:123]
    v_exp_f32 v19, v71
    v_cvt_pk_bf16_f32 v68, v16, v17
    v_mfma_f32_16x16x32_bf16 v[124:127], v[28:31], v[212:215], v[124:127]
    ds_read_b128 v[44:47], v3 offset:18688
    v_mfma_f32_16x16x32_bf16 v[124:127], v[24:27], v[208:211], v[124:127]
    s_waitcnt lgkmcnt(2)
    v_add_u32 v1, 49152, v1
    v_exp_f32 v16, v100
    v_mfma_f32_16x16x32_bf16 v[88:91], v[32:35], v[192:195], v[88:91]
    ds_read_b128 v[24:27], v1 offset:0
    v_add_f32 v6, v6, v18
    v_mfma_f32_16x16x32_bf16 v[88:91], v[36:39], v[196:199], v[88:91]
    v_add_f32 v6, v6, v19
    v_mfma_f32_16x16x32_bf16 v[92:95], v[36:39], v[220:223], v[92:95]
    ds_read_b128 v[28:31], v1 offset:12288
    v_mfma_f32_16x16x32_bf16 v[92:95], v[32:35], v[216:219], v[92:95]
    s_waitcnt lgkmcnt(2)
    v_exp_f32 v17, v101
    v_cvt_pk_bf16_f32 v69, v18, v19
    v_mfma_f32_16x16x32_bf16 v[120:123], v[40:43], v[192:195], v[120:123]
    ds_read_b128 v[32:35], v1 offset:1024
    v_mfma_f32_16x16x32_bf16 v[120:123], v[44:47], v[196:199], v[120:123]
    v_exp_f32 v18, v102
    v_mfma_f32_16x16x32_bf16 v[124:127], v[44:47], v[220:223], v[124:127]
    ds_read_b128 v[36:39], v1 offset:13312
    v_add_f32 v6, v6, v16
    v_mfma_f32_16x16x32_bf16 v[124:127], v[40:43], v[216:219], v[124:127]
    s_waitcnt lgkmcnt(2)
    v_add_f32 v6, v6, v17
    v_exp_f32 v19, v103
    v_cvt_pk_bf16_f32 v70, v16, v17
    v_add_f32 v6, v6, v18
    v_add_f32 v6, v6, v19
    v_cvt_pk_bf16_f32 v71, v18, v19
    v_mfma_f32_16x16x32_bf16 a[0:3], v[160:163], v[24:27], a[0:3]
    ds_read_b128 v[40:43], v1 offset:2048
    v_mfma_f32_16x16x32_bf16 a[0:3], v[168:171], v[28:31], a[0:3]
    v_exp_f32 v16, v72
    v_mfma_f32_16x16x32_bf16 a[48:51], v[172:175], v[28:31], a[48:51]
    ds_read_b128 v[44:47], v1 offset:14336
    v_mfma_f32_16x16x32_bf16 a[48:51], v[164:167], v[24:27], a[48:51]
    s_waitcnt lgkmcnt(2)
    v_exp_f32 v17, v73
    v_mfma_f32_16x16x32_bf16 a[4:7], v[160:163], v[32:35], a[4:7]
    ds_read_b128 v[24:27], v1 offset:3072
    v_mfma_f32_16x16x32_bf16 a[4:7], v[168:171], v[36:39], a[4:7]
    v_exp_f32 v18, v74
    v_mfma_f32_16x16x32_bf16 a[52:55], v[172:175], v[36:39], a[52:55]
    ds_read_b128 v[28:31], v1 offset:15360
    v_add_f32 v5, v5, v16
    v_mfma_f32_16x16x32_bf16 a[52:55], v[164:167], v[32:35], a[52:55]
    s_waitcnt lgkmcnt(2)
    v_add_f32 v5, v5, v17
    v_mfma_f32_16x16x32_bf16 a[8:11], v[160:163], v[40:43], a[8:11]
    ds_read_b128 v[32:35], v1 offset:4096
    v_mfma_f32_16x16x32_bf16 a[8:11], v[168:171], v[44:47], a[8:11]
    v_exp_f32 v19, v75
    v_mfma_f32_16x16x32_bf16 a[56:59], v[172:175], v[44:47], a[56:59]
    ds_read_b128 v[36:39], v1 offset:16384
    v_cvt_pk_bf16_f32 v72, v16, v17
    v_mfma_f32_16x16x32_bf16 a[56:59], v[164:167], v[40:43], a[56:59]
    s_waitcnt lgkmcnt(2)
    v_exp_f32 v16, v104
    v_mfma_f32_16x16x32_bf16 a[12:15], v[160:163], v[24:27], a[12:15]
    ds_read_b128 v[40:43], v1 offset:5120
    v_add_f32 v5, v5, v18
    v_mfma_f32_16x16x32_bf16 a[12:15], v[168:171], v[28:31], a[12:15]
    v_add_f32 v5, v5, v19
    v_mfma_f32_16x16x32_bf16 a[60:63], v[172:175], v[28:31], a[60:63]
    ds_read_b128 v[44:47], v1 offset:17408
    v_mfma_f32_16x16x32_bf16 a[60:63], v[164:167], v[24:27], a[60:63]
    s_waitcnt lgkmcnt(2)
    v_exp_f32 v17, v105
    v_mfma_f32_16x16x32_bf16 a[16:19], v[160:163], v[32:35], a[16:19]
    ds_read_b128 v[24:27], v1 offset:6144
    v_cvt_pk_bf16_f32 v73, v18, v19
    v_mfma_f32_16x16x32_bf16 a[16:19], v[168:171], v[36:39], a[16:19]
    v_exp_f32 v18, v106
    v_mfma_f32_16x16x32_bf16 a[64:67], v[172:175], v[36:39], a[64:67]
    ds_read_b128 v[28:31], v1 offset:18432
    v_add_f32 v5, v5, v16
    v_mfma_f32_16x16x32_bf16 a[64:67], v[164:167], v[32:35], a[64:67]
    s_waitcnt lgkmcnt(2)
    v_add_f32 v5, v5, v17
    v_mfma_f32_16x16x32_bf16 a[20:23], v[160:163], v[40:43], a[20:23]
    ds_read_b128 v[32:35], v1 offset:7168
    v_mfma_f32_16x16x32_bf16 a[20:23], v[168:171], v[44:47], a[20:23]
    v_exp_f32 v19, v107
    v_mfma_f32_16x16x32_bf16 a[68:71], v[172:175], v[44:47], a[68:71]
    ds_read_b128 v[36:39], v1 offset:19456
    v_cvt_pk_bf16_f32 v74, v16, v17
    v_mfma_f32_16x16x32_bf16 a[68:71], v[164:167], v[40:43], a[68:71]
    s_waitcnt lgkmcnt(2)
    v_exp_f32 v16, v76
    v_mfma_f32_16x16x32_bf16 a[24:27], v[160:163], v[24:27], a[24:27]
    ds_read_b128 v[40:43], v1 offset:8192
    v_add_f32 v5, v5, v18
    v_mfma_f32_16x16x32_bf16 a[24:27], v[168:171], v[28:31], a[24:27]
    v_add_f32 v5, v5, v19
    v_mfma_f32_16x16x32_bf16 a[72:75], v[172:175], v[28:31], a[72:75]
    ds_read_b128 v[44:47], v1 offset:20480
    v_mfma_f32_16x16x32_bf16 a[72:75], v[164:167], v[24:27], a[72:75]
    s_waitcnt lgkmcnt(2)
    v_exp_f32 v17, v77
    v_mfma_f32_16x16x32_bf16 a[28:31], v[160:163], v[32:35], a[28:31]
    ds_read_b128 v[24:27], v1 offset:9216
    v_cvt_pk_bf16_f32 v75, v18, v19
    v_mfma_f32_16x16x32_bf16 a[28:31], v[168:171], v[36:39], a[28:31]
    v_exp_f32 v18, v78
    v_mfma_f32_16x16x32_bf16 a[76:79], v[172:175], v[36:39], a[76:79]
    ds_read_b128 v[28:31], v1 offset:21504
    v_add_f32 v6, v6, v16
    v_mfma_f32_16x16x32_bf16 a[76:79], v[164:167], v[32:35], a[76:79]
    s_waitcnt lgkmcnt(2)
    v_add_f32 v6, v6, v17
    v_mfma_f32_16x16x32_bf16 a[32:35], v[160:163], v[40:43], a[32:35]
    ds_read_b128 v[32:35], v1 offset:10240
    v_mfma_f32_16x16x32_bf16 a[32:35], v[168:171], v[44:47], a[32:35]
    v_exp_f32 v19, v79
    v_mfma_f32_16x16x32_bf16 a[80:83], v[172:175], v[44:47], a[80:83]
    ds_read_b128 v[36:39], v1 offset:22528
    v_cvt_pk_bf16_f32 v76, v16, v17
    v_mfma_f32_16x16x32_bf16 a[80:83], v[164:167], v[40:43], a[80:83]
    s_waitcnt lgkmcnt(2)
    v_exp_f32 v16, v108
    v_mfma_f32_16x16x32_bf16 a[36:39], v[160:163], v[24:27], a[36:39]
    ds_read_b128 v[40:43], v1 offset:11264
    v_add_f32 v6, v6, v18
    v_mfma_f32_16x16x32_bf16 a[36:39], v[168:171], v[28:31], a[36:39]
    v_add_f32 v6, v6, v19
    v_mfma_f32_16x16x32_bf16 a[84:87], v[172:175], v[28:31], a[84:87]
    ds_read_b128 v[44:47], v1 offset:23552
    v_mfma_f32_16x16x32_bf16 a[84:87], v[164:167], v[24:27], a[84:87]
    s_waitcnt lgkmcnt(2)
    v_subrev_u32 v1, 98304, v1
    v_mfma_f32_16x16x32_bf16 a[40:43], v[160:163], v[32:35], a[40:43]
    ds_read_b128 v[24:27], v1 offset:0
    v_mfma_f32_16x16x32_bf16 a[40:43], v[168:171], v[36:39], a[40:43]
    v_exp_f32 v17, v109
    v_mfma_f32_16x16x32_bf16 a[88:91], v[172:175], v[36:39], a[88:91]
    ds_read_b128 v[28:31], v1 offset:12288
    v_cvt_pk_bf16_f32 v77, v18, v19
    v_mfma_f32_16x16x32_bf16 a[88:91], v[164:167], v[32:35], a[88:91]
    s_waitcnt lgkmcnt(2)
    v_exp_f32 v18, v110
    v_mfma_f32_16x16x32_bf16 a[44:47], v[160:163], v[40:43], a[44:47]
    ds_read_b128 v[32:35], v1 offset:1024
    v_add_f32 v6, v6, v16
    v_mfma_f32_16x16x32_bf16 a[44:47], v[168:171], v[44:47], a[44:47]
    v_add_f32 v6, v6, v17
    v_mfma_f32_16x16x32_bf16 a[92:95], v[172:175], v[44:47], a[92:95]
    ds_read_b128 v[36:39], v1 offset:13312
    v_mfma_f32_16x16x32_bf16 a[92:95], v[164:167], v[40:43], a[92:95]
    s_waitcnt lgkmcnt(2)
    v_exp_f32 v19, v111
    v_mfma_f32_16x16x32_bf16 a[0:3], v[176:179], v[24:27], a[0:3]
    ds_read_b128 v[40:43], v1 offset:2048
    v_cvt_pk_bf16_f32 v78, v16, v17
    v_mfma_f32_16x16x32_bf16 a[0:3], v[184:187], v[28:31], a[0:3]
    v_add_f32 v6, v6, v18
    v_add_f32 v6, v6, v19
    v_mfma_f32_16x16x32_bf16 a[48:51], v[188:191], v[28:31], a[48:51]
    ds_read_b128 v[44:47], v1 offset:14336
    v_cvt_pk_bf16_f32 v79, v18, v19
    v_mfma_f32_16x16x32_bf16 a[48:51], v[180:183], v[24:27], a[48:51]
    s_waitcnt lgkmcnt(2)
    v_exp_f32 v16, v80
    v_mfma_f32_16x16x32_bf16 a[4:7], v[176:179], v[32:35], a[4:7]
    ds_read_b128 v[24:27], v1 offset:3072
    v_mfma_f32_16x16x32_bf16 a[4:7], v[184:187], v[36:39], a[4:7]
    v_exp_f32 v17, v81
    v_mfma_f32_16x16x32_bf16 a[52:55], v[188:191], v[36:39], a[52:55]
    ds_read_b128 v[28:31], v1 offset:15360
    v_mfma_f32_16x16x32_bf16 a[52:55], v[180:183], v[32:35], a[52:55]
    s_waitcnt lgkmcnt(2)
    v_exp_f32 v18, v82
    v_mfma_f32_16x16x32_bf16 a[8:11], v[176:179], v[40:43], a[8:11]
    ds_read_b128 v[32:35], v1 offset:4096
    v_add_f32 v7, v7, v16
    v_mfma_f32_16x16x32_bf16 a[8:11], v[184:187], v[44:47], a[8:11]
    v_add_f32 v7, v7, v17
    v_mfma_f32_16x16x32_bf16 a[56:59], v[188:191], v[44:47], a[56:59]
    ds_read_b128 v[36:39], v1 offset:16384
    v_mfma_f32_16x16x32_bf16 a[56:59], v[180:183], v[40:43], a[56:59]
    s_waitcnt lgkmcnt(2)
    v_exp_f32 v19, v83
    v_mfma_f32_16x16x32_bf16 a[12:15], v[176:179], v[24:27], a[12:15]
    ds_read_b128 v[40:43], v1 offset:5120
    v_cvt_pk_bf16_f32 v80, v16, v17
    v_mfma_f32_16x16x32_bf16 a[12:15], v[184:187], v[28:31], a[12:15]
    v_exp_f32 v16, v112
    v_mfma_f32_16x16x32_bf16 a[60:63], v[188:191], v[28:31], a[60:63]
    ds_read_b128 v[44:47], v1 offset:17408
    v_add_f32 v7, v7, v18
    v_mfma_f32_16x16x32_bf16 a[60:63], v[180:183], v[24:27], a[60:63]
    s_waitcnt lgkmcnt(2)
    v_add_f32 v7, v7, v19
    v_mfma_f32_16x16x32_bf16 a[16:19], v[176:179], v[32:35], a[16:19]
    ds_read_b128 v[24:27], v1 offset:6144
    v_mfma_f32_16x16x32_bf16 a[16:19], v[184:187], v[36:39], a[16:19]
    v_exp_f32 v17, v113
    v_mfma_f32_16x16x32_bf16 a[64:67], v[188:191], v[36:39], a[64:67]
    ds_read_b128 v[28:31], v1 offset:18432
    v_cvt_pk_bf16_f32 v81, v18, v19
    v_mfma_f32_16x16x32_bf16 a[64:67], v[180:183], v[32:35], a[64:67]
    s_waitcnt lgkmcnt(2)
    v_exp_f32 v18, v114
    v_mfma_f32_16x16x32_bf16 a[20:23], v[176:179], v[40:43], a[20:23]
    ds_read_b128 v[32:35], v1 offset:7168
    v_add_f32 v7, v7, v16
    v_mfma_f32_16x16x32_bf16 a[20:23], v[184:187], v[44:47], a[20:23]
    v_add_f32 v7, v7, v17
    v_mfma_f32_16x16x32_bf16 a[68:71], v[188:191], v[44:47], a[68:71]
    ds_read_b128 v[36:39], v1 offset:19456
    v_mfma_f32_16x16x32_bf16 a[68:71], v[180:183], v[40:43], a[68:71]
    s_waitcnt lgkmcnt(2)
    v_exp_f32 v19, v115
    v_mfma_f32_16x16x32_bf16 a[24:27], v[176:179], v[24:27], a[24:27]
    ds_read_b128 v[40:43], v1 offset:8192
    v_cvt_pk_bf16_f32 v82, v16, v17
    v_mfma_f32_16x16x32_bf16 a[24:27], v[184:187], v[28:31], a[24:27]
    v_exp_f32 v16, v84
    v_mfma_f32_16x16x32_bf16 a[72:75], v[188:191], v[28:31], a[72:75]
    ds_read_b128 v[44:47], v1 offset:20480
    v_add_f32 v7, v7, v18
    v_mfma_f32_16x16x32_bf16 a[72:75], v[180:183], v[24:27], a[72:75]
    s_waitcnt lgkmcnt(2)
    v_add_f32 v7, v7, v19
    v_mfma_f32_16x16x32_bf16 a[28:31], v[176:179], v[32:35], a[28:31]
    ds_read_b128 v[24:27], v1 offset:9216
    v_mfma_f32_16x16x32_bf16 a[28:31], v[184:187], v[36:39], a[28:31]
    s_waitcnt vmcnt(0)
    v_exp_f32 v17, v85
    v_mfma_f32_16x16x32_bf16 a[76:79], v[188:191], v[36:39], a[76:79]
    ds_read_b128 v[28:31], v1 offset:21504
    v_cvt_pk_bf16_f32 v83, v18, v19
    v_mfma_f32_16x16x32_bf16 a[76:79], v[180:183], v[32:35], a[76:79]
    s_waitcnt lgkmcnt(2)
    s_barrier
    v_mfma_f32_16x16x32_bf16 a[32:35], v[176:179], v[40:43], a[32:35]
    ds_read_b128 v[32:35], v1 offset:10240
    v_mfma_f32_16x16x32_bf16 a[32:35], v[184:187], v[44:47], a[32:35]
    v_exp_f32 v18, v86
    v_mfma_f32_16x16x32_bf16 a[80:83], v[188:191], v[44:47], a[80:83]
    ds_read_b128 v[36:39], v1 offset:22528
    v_add_f32 v8, v8, v16
    v_mfma_f32_16x16x32_bf16 a[80:83], v[180:183], v[40:43], a[80:83]
    s_waitcnt lgkmcnt(2)
    v_add_f32 v8, v8, v17
    v_mfma_f32_16x16x32_bf16 a[36:39], v[176:179], v[24:27], a[36:39]
    ds_read_b128 v[40:43], v1 offset:11264
    v_mfma_f32_16x16x32_bf16 a[36:39], v[184:187], v[28:31], a[36:39]
    v_exp_f32 v19, v87
    v_cvt_pk_bf16_f32 v84, v16, v17
    v_mfma_f32_16x16x32_bf16 a[84:87], v[188:191], v[28:31], a[84:87]
    ds_read_b128 v[44:47], v1 offset:23552
    v_mfma_f32_16x16x32_bf16 a[84:87], v[180:183], v[24:27], a[84:87]
    s_waitcnt lgkmcnt(2)
    v_add_u32 v1, 49152, v1
    v_exp_f32 v16, v116
    v_mfma_f32_16x16x32_bf16 a[40:43], v[176:179], v[32:35], a[40:43]
    ds_read_b128 v[24:27], v1 offset:0
    v_add_f32 v8, v8, v18
    v_mfma_f32_16x16x32_bf16 a[40:43], v[184:187], v[36:39], a[40:43]
    v_add_f32 v8, v8, v19
    v_mfma_f32_16x16x32_bf16 a[88:91], v[188:191], v[36:39], a[88:91]
    ds_read_b128 v[28:31], v1 offset:12288
    v_mfma_f32_16x16x32_bf16 a[88:91], v[180:183], v[32:35], a[88:91]
    s_waitcnt lgkmcnt(2)
    v_exp_f32 v17, v117
    v_cvt_pk_bf16_f32 v85, v18, v19
    v_mfma_f32_16x16x32_bf16 a[44:47], v[176:179], v[40:43], a[44:47]
    ds_read_b128 v[32:35], v1 offset:1024
    v_mfma_f32_16x16x32_bf16 a[44:47], v[184:187], v[44:47], a[44:47]
    v_exp_f32 v18, v118
    v_mfma_f32_16x16x32_bf16 a[92:95], v[188:191], v[44:47], a[92:95]
    ds_read_b128 v[36:39], v1 offset:13312
    v_add_f32 v8, v8, v16
    v_mfma_f32_16x16x32_bf16 a[92:95], v[180:183], v[40:43], a[92:95]
    s_waitcnt lgkmcnt(2)
    v_add_f32 v8, v8, v17
    v_exp_f32 v19, v119
    v_cvt_pk_bf16_f32 v86, v16, v17
    v_add_f32 v8, v8, v18
    v_add_f32 v8, v8, v19
    v_cvt_pk_bf16_f32 v87, v18, v19
    v_mfma_f32_16x16x32_bf16 a[0:3], v[64:67], v[24:27], a[0:3]
    ds_read_b128 v[40:43], v1 offset:2048
    v_mfma_f32_16x16x32_bf16 a[0:3], v[72:75], v[28:31], a[0:3]
    v_exp_f32 v16, v88
    v_exp_f32 v17, v89
    v_exp_f32 v18, v90
    v_mfma_f32_16x16x4_f32 v[48:51], v5, v57, 0
    v_mfma_f32_16x16x32_bf16 a[48:51], v[76:79], v[28:31], a[48:51]
    ds_read_b128 v[44:47], v1 offset:14336
    v_mfma_f32_16x16x32_bf16 a[48:51], v[68:71], v[24:27], a[48:51]
L_pg12:
    s_cbranch_execz L_iwret
    s_waitcnt lgkmcnt(2)
    v_exp_f32 v19, v91
    v_cvt_pk_bf16_f32 v88, v16, v17
    v_exp_f32 v16, v120
    v_mfma_f32_16x16x4_f32 v[52:55], v6, v57, 0
    v_mfma_f32_16x16x32_bf16 a[4:7], v[64:67], v[32:35], a[4:7]
    ds_read_b128 v[24:27], v1 offset:3072
    v_mfma_f32_16x16x32_bf16 a[4:7], v[72:75], v[36:39], a[4:7]
    v_exp_f32 v17, v121
    v_cvt_pk_bf16_f32 v89, v18, v19
    v_mfma_f32_16x16x32_bf16 a[52:55], v[76:79], v[36:39], a[52:55]
    ds_read_b128 v[28:31], v1 offset:15360
    v_mfma_f32_16x16x32_bf16 a[52:55], v[68:71], v[32:35], a[52:55]
    s_waitcnt lgkmcnt(2)
    v_exp_f32 v18, v122
    v_mfma_f32_16x16x32_bf16 a[8:11], v[64:67], v[40:43], a[8:11]
    ds_read_b128 v[32:35], v1 offset:4096
    v_mfma_f32_16x16x32_bf16 a[8:11], v[72:75], v[44:47], a[8:11]
    v_exp_f32 v19, v123
    v_mfma_f32_16x16x32_bf16 a[56:59], v[76:79], v[44:47], a[56:59]
    ds_read_b128 v[36:39], v1 offset:16384
    v_cvt_pk_bf16_f32 v90, v16, v17
    v_mfma_f32_16x16x32_bf16 a[56:59], v[68:71], v[40:43], a[56:59]
    s_waitcnt lgkmcnt(2)
    v_exp_f32 v16, v92
    v_mfma_f32_16x16x32_bf16 a[12:15], v[64:67], v[24:27], a[12:15]
    ds_read_b128 v[40:43], v1 offset:5120
    v_mfma_f32_16x16x32_bf16 a[12:15], v[72:75], v[28:31], a[12:15]
    v_exp_f32 v17, v93
    v_mfma_f32_16x16x32_bf16 a[60:63], v[76:79], v[28:31], a[60:63]
    ds_read_b128 v[44:47], v1 offset:17408
    v_cvt_pk_bf16_f32 v91, v18, v19
    v_mfma_f32_16x16x32_bf16 a[60:63], v[68:71], v[24:27], a[60:63]
    s_waitcnt lgkmcnt(2)
    v_exp_f32 v18, v94
    v_mfma_f32_16x16x32_bf16 a[16:19], v[64:67], v[32:35], a[16:19]
    ds_read_b128 v[24:27], v1 offset:6144
    v_mfma_f32_16x16x32_bf16 a[16:19], v[72:75], v[36:39], a[16:19]
    v_exp_f32 v19, v95
    v_mfma_f32_16x16x32_bf16 a[64:67], v[76:79], v[36:39], a[64:67]
    ds_read_b128 v[28:31], v1 offset:18432
    v_mfma_f32_16x16x32_bf16 a[64:67], v[68:71], v[32:35], a[64:67]
    s_waitcnt lgkmcnt(2)
    v_mfma_f32_16x16x32_bf16 v[128:131], v[88:91], v[20:23], 0
    v_mfma_f32_16x16x32_bf16 a[20:23], v[64:67], v[40:43], a[20:23]
    ds_read_b128 v[32:35], v1 offset:7168
    v_cvt_pk_bf16_f32 v92, v16, v17
    v_mfma_f32_16x16x32_bf16 a[20:23], v[72:75], v[44:47], a[20:23]
    v_exp_f32 v16, v124
    v_mfma_f32_16x16x32_bf16 a[68:71], v[76:79], v[44:47], a[68:71]
    ds_read_b128 v[36:39], v1 offset:19456
    v_mfma_f32_16x16x32_bf16 a[68:71], v[68:71], v[40:43], a[68:71]
    s_waitcnt lgkmcnt(2)
    v_exp_f32 v17, v125
    v_mfma_f32_16x16x32_bf16 a[24:27], v[64:67], v[24:27], a[24:27]
    ds_read_b128 v[40:43], v1 offset:8192
    v_cvt_pk_bf16_f32 v93, v18, v19
    v_mfma_f32_16x16x32_bf16 a[24:27], v[72:75], v[28:31], a[24:27]
    v_exp_f32 v18, v126
    v_mfma_f32_16x16x32_bf16 a[72:75], v[76:79], v[28:31], a[72:75]
    ds_read_b128 v[44:47], v1 offset:20480
    v_mfma_f32_16x16x32_bf16 a[72:75], v[68:71], v[24:27], a[72:75]
    s_waitcnt lgkmcnt(2)
    v_exp_f32 v19, v127
    v_mfma_f32_16x16x32_bf16 a[28:31], v[64:67], v[32:35], a[28:31]
    ds_read_b128 v[24:27], v1 offset:9216
    v_cvt_pk_bf16_f32 v94, v16, v17
    v_mfma_f32_16x16x32_bf16 a[28:31], v[72:75], v[36:39], a[28:31]
    v_cvt_pk_bf16_f32 v95, v18, v19
    s_nop 1
    v_mfma_f32_16x16x32_bf16 a[76:79], v[76:79], v[36:39], a[76:79]
    ds_read_b128 v[28:31], v1 offset:21504
    v_mfma_f32_16x16x32_bf16 a[76:79], v[68:71], v[32:35], a[76:79]
    s_waitcnt lgkmcnt(2)
    v_mfma_f32_16x16x32_bf16 v[132:135], v[92:95], v[20:23], 0
    v_mfma_f32_16x16x32_bf16 a[32:35], v[64:67], v[40:43], a[32:35]
    ds_read_b128 v[32:35], v1 offset:10240
    v_mfma_f32_16x16x32_bf16 a[32:35], v[72:75], v[44:47], a[32:35]
    v_rcp_f32 v48, v48
    v_mfma_f32_16x16x32_bf16 a[80:83], v[76:79], v[44:47], a[80:83]
    ds_read_b128 v[36:39], v1 offset:22528
    v_mfma_f32_16x16x32_bf16 a[80:83], v[68:71], v[40:43], a[80:83]
    s_waitcnt lgkmcnt(2)
    v_rcp_f32 v49, v49
    v_mfma_f32_16x16x32_bf16 a[36:39], v[64:67], v[24:27], a[36:39]
    ds_read_b128 v[40:43], v1 offset:11264
    v_mfma_f32_16x16x32_bf16 a[36:39], v[72:75], v[28:31], a[36:39]
    v_rcp_f32 v50, v50
    v_mfma_f32_16x16x32_bf16 a[84:87], v[76:79], v[28:31], a[84:87]
    ds_read_b128 v[44:47], v1 offset:23552
    v_mfma_f32_16x16x32_bf16 a[84:87], v[68:71], v[24:27], a[84:87]
    s_waitcnt lgkmcnt(2)
    v_subrev_u32 v2, 98304, v2
    v_subrev_u32 v3, 98304, v3
    v_mfma_f32_16x16x32_bf16 a[40:43], v[64:67], v[32:35], a[40:43]
    ds_read_b128 v[24:27], v2 offset:0
    v_mfma_f32_16x16x32_bf16 a[40:43], v[72:75], v[36:39], a[40:43]
    v_rcp_f32 v51, v51
    v_mfma_f32_16x16x32_bf16 a[88:91], v[76:79], v[36:39], a[88:91]
    ds_read_b128 v[28:31], v3 offset:0
    v_mfma_f32_16x16x32_bf16 a[88:91], v[68:71], v[32:35], a[88:91]
    s_waitcnt lgkmcnt(2)
    v_rcp_f32 v52, v52
    v_mfma_f32_16x16x32_bf16 a[44:47], v[64:67], v[40:43], a[44:47]
    ds_read_b128 v[32:35], v2 offset:6144
    v_mfma_f32_16x16x32_bf16 a[44:47], v[72:75], v[44:47], a[44:47]
    v_rcp_f32 v53, v53
    v_mfma_f32_16x16x32_bf16 a[92:95], v[76:79], v[44:47], a[92:95]
    ds_read_b128 v[36:39], v3 offset:6144
    v_mfma_f32_16x16x32_bf16 a[92:95], v[68:71], v[40:43], a[92:95]
    s_waitcnt lgkmcnt(2)
    v_rcp_f32 v54, v54
    v_mfma_f32_16x16x32_bf16 v[160:163], v[24:27], a[240:243], v[136:139]
    ds_read_b128 v[40:43], v2 offset:128
    v_mfma_f32_16x16x32_bf16 v[160:163], v[28:31], a[244:247], v[160:163]
    v_rcp_f32 v55, v55
    v_mfma_f32_16x16x32_bf16 v[164:167], v[28:31], v[204:207], v[140:143]
    ds_read_b128 v[44:47], v3 offset:128
    v_mfma_f32_16x16x32_bf16 v[164:167], v[24:27], v[200:203], v[164:167]
    s_waitcnt lgkmcnt(2)
    v_mfma_f32_16x16x32_bf16 v[96:99], v[32:35], a[240:243], v[136:139]
    ds_read_b128 v[24:27], v2 offset:6272
    v_accvgpr_read_b32 v224, a0
    v_mfma_f32_16x16x32_bf16 v[96:99], v[36:39], a[244:247], v[96:99]
    v_accvgpr_read_b32 v225, a4
    v_accvgpr_read_b32 v226, a8
    v_accvgpr_read_b32 v227, a12
    v_accvgpr_read_b32 v228, a16
    v_accvgpr_read_b32 v229, a20
    v_mfma_f32_16x16x32_bf16 v[100:103], v[36:39], v[204:207], v[140:143]
    ds_read_b128 v[28:31], v3 offset:6272
    v_mul_f32 v224, v224, v48
    v_mfma_f32_16x16x32_bf16 v[100:103], v[32:35], v[200:203], v[100:103]
    s_waitcnt lgkmcnt(2)
    v_mul_f32 v225, v225, v48
    v_mul_f32 v226, v226, v48
    v_mul_f32 v227, v227, v48
    v_mul_f32 v228, v228, v48
    v_mul_f32 v229, v229, v48
    v_mfma_f32_16x16x32_bf16 v[160:163], v[40:43], a[248:251], v[160:163]
    ds_read_b128 v[32:35], v2 offset:256
    v_cvt_pk_bf16_f32 v224, v224, v225
    v_mfma_f32_16x16x32_bf16 v[160:163], v[44:47], a[252:255], v[160:163]
    v_cvt_pk_bf16_f32 v225, v226, v227
    v_cvt_pk_bf16_f32 v226, v228, v229
    v_accvgpr_read_b32 v230, a1
    v_accvgpr_read_b32 v231, a5
    v_accvgpr_read_b32 v232, a9
    v_mfma_f32_16x16x32_bf16 v[164:167], v[44:47], v[212:215], v[164:167]
    ds_read_b128 v[36:39], v3 offset:256
    v_accvgpr_read_b32 v233, a13
    v_mfma_f32_16x16x32_bf16 v[164:167], v[40:43], v[208:211], v[164:167]
    s_waitcnt lgkmcnt(2)
    buffer_store_dwordx3 v[224:226], v56, s[12:15], s24 offen offset:0 sc0 sc1
    v_accvgpr_read_b32 v234, a17
    v_accvgpr_read_b32 v235, a21
    v_mfma_f32_16x16x32_bf16 v[96:99], v[24:27], a[248:251], v[96:99]
    ds_read_b128 v[40:43], v2 offset:6400
    v_mul_f32 v230, v230, v49
    v_mfma_f32_16x16x32_bf16 v[96:99], v[28:31], a[252:255], v[96:99]
    v_mul_f32 v231, v231, v49
    v_mul_f32 v232, v232, v49
    v_mul_f32 v233, v233, v49
    v_mul_f32 v234, v234, v49
    v_mul_f32 v235, v235, v49
    v_mfma_f32_16x16x32_bf16 v[100:103], v[28:31], v[212:215], v[100:103]
    ds_read_b128 v[44:47], v3 offset:6400
    v_cvt_pk_bf16_f32 v230, v230, v231
    v_mfma_f32_16x16x32_bf16 v[100:103], v[24:27], v[208:211], v[100:103]
    s_waitcnt lgkmcnt(2)
    v_cvt_pk_bf16_f32 v231, v232, v233
    v_cvt_pk_bf16_f32 v232, v234, v235
    v_accvgpr_read_b32 v236, a2
    v_accvgpr_read_b32 v237, a6
    v_accvgpr_read_b32 v238, a10
    v_mfma_f32_16x16x32_bf16 v[160:163], v[32:35], v[192:195], v[160:163]
    ds_read_b128 v[24:27], v2 offset:12288
    v_accvgpr_read_b32 v239, a14
    v_mfma_f32_16x16x32_bf16 v[160:163], v[36:39], v[196:199], v[160:163]
    buffer_store_dwordx3 v[230:232], v56, s[12:15], s24 offen offset:384 sc0 sc1
    v_accvgpr_read_b32 v240, a18
    v_accvgpr_read_b32 v241, a22
    v_mfma_f32_16x16x32_bf16 v[164:167], v[36:39], v[220:223], v[164:167]
    ds_read_b128 v[28:31], v3 offset:12288
    v_mul_f32 v236, v236, v50
    v_mfma_f32_16x16x32_bf16 v[164:167], v[32:35], v[216:219], v[164:167]
    s_waitcnt lgkmcnt(2)
    v_mul_f32 v237, v237, v50
    v_mul_f32 v238, v238, v50
    v_mul_f32 v239, v239, v50
    v_mul_f32 v240, v240, v50
    v_mul_f32 v241, v241, v50
    v_mfma_f32_16x16x32_bf16 v[96:99], v[40:43], v[192:195], v[96:99]
    ds_read_b128 v[32:35], v2 offset:18432
    v_cvt_pk_bf16_f32 v236, v236, v237
    v_mfma_f32_16x16x32_bf16 v[96:99], v[44:47], v[196:199], v[96:99]
    v_cvt_pk_bf16_f32 v237, v238, v239
    v_cvt_pk_bf16_f32 v238, v240, v241
    v_accvgpr_read_b32 v242, a3
    v_accvgpr_read_b32 v243, a7
    v_accvgpr_read_b32 v244, a11
    v_mfma_f32_16x16x32_bf16 v[100:103], v[44:47], v[220:223], v[100:103]
    ds_read_b128 v[36:39], v3 offset:18432
    v_accvgpr_read_b32 v245, a15
    v_mfma_f32_16x16x32_bf16 v[100:103], v[40:43], v[216:219], v[100:103]
    s_waitcnt lgkmcnt(2)
    buffer_store_dwordx3 v[236:238], v56, s[12:15], s24 offen offset:768 sc0 sc1
    v_accvgpr_read_b32 v246, a19
    v_accvgpr_read_b32 v247, a23
    v_mfma_f32_16x16x32_bf16 v[168:171], v[24:27], a[240:243], v[136:139]
    ds_read_b128 v[40:43], v2 offset:12416
    v_mul_f32 v242, v242, v51
    v_mfma_f32_16x16x32_bf16 v[168:171], v[28:31], a[244:247], v[168:171]
    v_mul_f32 v243, v243, v51
    v_mul_f32 v244, v244, v51
    v_mul_f32 v245, v245, v51
    v_mul_f32 v246, v246, v51
    v_mul_f32 v247, v247, v51
    v_mfma_f32_16x16x32_bf16 v[172:175], v[28:31], v[204:207], v[140:143]
    ds_read_b128 v[44:47], v3 offset:12416
    v_cvt_pk_bf16_f32 v242, v242, v243
    v_mfma_f32_16x16x32_bf16 v[172:175], v[24:27], v[200:203], v[172:175]
    s_waitcnt lgkmcnt(2)
    v_cvt_pk_bf16_f32 v243, v244, v245
    v_cvt_pk_bf16_f32 v244, v246, v247
    v_accvgpr_read_b32 v248, a24
    v_accvgpr_read_b32 v249, a28
    v_accvgpr_read_b32 v250, a32
    v_mfma_f32_16x16x32_bf16 v[104:107], v[32:35], a[240:243], v[136:139]
    ds_read_b128 v[24:27], v2 offset:18560
    v_accvgpr_read_b32 v251, a36
    v_mfma_f32_16x16x32_bf16 v[104:107], v[36:39], a[244:247], v[104:107]
    buffer_store_dwordx3 v[242:244], v56, s[12:15], s24 offen offset:1152 sc0 sc1
    v_accvgpr_read_b32 v252, a40
    v_accvgpr_read_b32 v253, a44
    v_mfma_f32_16x16x32_bf16 v[108:111], v[36:39], v[204:207], v[140:143]
    ds_read_b128 v[28:31], v3 offset:18560
    v_mul_f32 v248, v248, v48
    v_mfma_f32_16x16x32_bf16 v[108:111], v[32:35], v[200:203], v[108:111]
    s_waitcnt lgkmcnt(2)
    v_mul_f32 v249, v249, v48
    v_mul_f32 v250, v250, v48
    v_mul_f32 v251, v251, v48
    v_mul_f32 v252, v252, v48
    v_mul_f32 v253, v253, v48
    v_mfma_f32_16x16x32_bf16 v[168:171], v[40:43], a[248:251], v[168:171]
    ds_read_b128 v[32:35], v2 offset:12544
    v_cvt_pk_bf16_f32 v248, v248, v249
    v_mfma_f32_16x16x32_bf16 v[168:171], v[44:47], a[252:255], v[168:171]
    v_cvt_pk_bf16_f32 v249, v250, v251
    v_cvt_pk_bf16_f32 v250, v252, v253
    v_accvgpr_read_b32 v224, a25
    v_accvgpr_read_b32 v225, a29
    v_accvgpr_read_b32 v226, a33
    v_mfma_f32_16x16x32_bf16 v[172:175], v[44:47], v[212:215], v[172:175]
    ds_read_b128 v[36:39], v3 offset:12544
    v_accvgpr_read_b32 v227, a37
    v_mfma_f32_16x16x32_bf16 v[172:175], v[40:43], v[208:211], v[172:175]
    s_waitcnt lgkmcnt(2)
    buffer_store_dwordx3 v[248:250], v56, s[12:15], s24 offen offset:192 sc0 sc1
    v_accvgpr_read_b32 v228, a41
    v_mfma_f32_16x16x32_bf16 v[104:107], v[24:27], a[248:251], v[104:107]
    ds_read_b128 v[40:43], v2 offset:18688
    v_accvgpr_read_b32 v229, a45
    v_mfma_f32_16x16x32_bf16 v[104:107], v[28:31], a[252:255], v[104:107]
    v_mul_f32 v224, v224, v49
    v_mul_f32 v225, v225, v49
    v_mul_f32 v226, v226, v49
    v_mul_f32 v227, v227, v49
    v_mul_f32 v228, v228, v49
    v_mul_f32 v229, v229, v49
    v_mfma_f32_16x16x32_bf16 v[108:111], v[28:31], v[212:215], v[108:111]
    ds_read_b128 v[44:47], v3 offset:18688
    v_cvt_pk_bf16_f32 v224, v224, v225
    v_mfma_f32_16x16x32_bf16 v[108:111], v[24:27], v[208:211], v[108:111]
    s_waitcnt lgkmcnt(2)
    v_add_u32 v2, 49152, v2
    v_add_u32 v3, 49152, v3
    v_exp_f32 v16, v160
    v_cvt_pk_bf16_f32 v225, v226, v227
    v_mfma_f32_16x16x32_bf16 v[168:171], v[32:35], v[192:195], v[168:171]
    ds_read_b128 v[24:27], v2 offset:0
    v_cvt_pk_bf16_f32 v226, v228, v229
    v_mfma_f32_16x16x32_bf16 v[168:171], v[36:39], v[196:199], v[168:171]
    buffer_store_dwordx3 v[224:226], v56, s[12:15], s24 offen offset:576 sc0 sc1
    v_accvgpr_read_b32 v230, a26
    v_mfma_f32_16x16x32_bf16 v[172:175], v[36:39], v[220:223], v[172:175]
    ds_read_b128 v[28:31], v3 offset:0
    v_accvgpr_read_b32 v231, a30
    v_mfma_f32_16x16x32_bf16 v[172:175], v[32:35], v[216:219], v[172:175]
    s_waitcnt lgkmcnt(2)
    v_exp_f32 v17, v161
    v_exp_f32 v18, v162
    v_exp_f32 v19, v163
    v_mfma_f32_16x16x32_bf16 v[104:107], v[40:43], v[192:195], v[104:107]
    ds_read_b128 v[32:35], v2 offset:6144
    v_accvgpr_read_b32 v232, a34
    v_mfma_f32_16x16x32_bf16 v[104:107], v[44:47], v[196:199], v[104:107]
    v_cvt_pk_bf16_f32 v160, v16, v17
    v_accvgpr_read_b32 v233, a38
    v_accvgpr_read_b32 v234, a42
    v_exp_f32 v16, v96
    v_mfma_f32_16x16x32_bf16 v[108:111], v[44:47], v[220:223], v[108:111]
    ds_read_b128 v[36:39], v3 offset:6144
    v_accvgpr_read_b32 v235, a46
    v_mfma_f32_16x16x32_bf16 v[108:111], v[40:43], v[216:219], v[108:111]
    s_waitcnt lgkmcnt(2)
    v_mul_f32 v230, v230, v50
    v_exp_f32 v17, v97
    v_mul_f32 v231, v231, v50
    v_mul_f32 v232, v232, v50
    v_mfma_f32_16x16x32_bf16 v[176:179], v[24:27], a[240:243], v[136:139]
    ds_read_b128 v[40:43], v2 offset:128
    v_cvt_pk_bf16_f32 v161, v18, v19
    v_mfma_f32_16x16x32_bf16 v[176:179], v[28:31], a[244:247], v[176:179]
    v_mul_f32 v233, v233, v50
    v_exp_f32 v18, v98
    v_mul_f32 v234, v234, v50
    v_mul_f32 v235, v235, v50
    v_cvt_pk_bf16_f32 v230, v230, v231
    v_mfma_f32_16x16x32_bf16 v[180:183], v[28:31], v[204:207], v[140:143]
    ds_read_b128 v[44:47], v3 offset:128
    v_cvt_pk_bf16_f32 v231, v232, v233
    v_mfma_f32_16x16x32_bf16 v[180:183], v[24:27], v[200:203], v[180:183]
    s_waitcnt lgkmcnt(2)
    v_exp_f32 v19, v99
    v_cvt_pk_bf16_f32 v232, v234, v235
    v_accvgpr_read_b32 v236, a27
    v_cvt_pk_bf16_f32 v162, v16, v17
    v_mfma_f32_16x16x32_bf16 v[112:115], v[32:35], a[240:243], v[136:139]
    ds_read_b128 v[24:27], v2 offset:6272
    v_accvgpr_read_b32 v237, a31
    v_mfma_f32_16x16x32_bf16 v[112:115], v[36:39], a[244:247], v[112:115]
    buffer_store_dwordx3 v[230:232], v56, s[12:15], s24 offen offset:960 sc0 sc1
    v_accvgpr_read_b32 v238, a35
    v_mfma_f32_16x16x32_bf16 v[116:119], v[36:39], v[204:207], v[140:143]
    ds_read_b128 v[28:31], v3 offset:6272
    v_accvgpr_read_b32 v239, a39
    v_mfma_f32_16x16x32_bf16 v[116:119], v[32:35], v[200:203], v[116:119]
    s_waitcnt lgkmcnt(2)
    v_exp_f32 v16, v164
    v_exp_f32 v17, v165
    v_accvgpr_read_b32 v240, a43
    v_accvgpr_read_b32 v241, a47
    v_mfma_f32_16x16x32_bf16 v[176:179], v[40:43], a[248:251], v[176:179]
    ds_read_b128 v[32:35], v2 offset:256
    v_cvt_pk_bf16_f32 v163, v18, v19
    v_mfma_f32_16x16x32_bf16 v[176:179], v[44:47], a[252:255], v[176:179]
    v_exp_f32 v18, v166
    v_mul_f32 v236, v236, v51
    v_mul_f32 v237, v237, v51
    v_mul_f32 v238, v238, v51
    v_mfma_f32_16x16x32_bf16 v[180:183], v[44:47], v[212:215], v[180:183]
    ds_read_b128 v[36:39], v3 offset:256
    v_mul_f32 v239, v239, v51
    v_mfma_f32_16x16x32_bf16 v[180:183], v[40:43], v[208:211], v[180:183]
    s_waitcnt lgkmcnt(2)
    v_exp_f32 v19, v167
    v_mul_f32 v240, v240, v51
    v_mul_f32 v241, v241, v51
    v_cvt_pk_bf16_f32 v236, v236, v237
    v_mfma_f32_16x16x32_bf16 v[112:115], v[24:27], a[248:251], v[112:115]
    ds_read_b128 v[40:43], v2 offset:6400
    v_cvt_pk_bf16_f32 v237, v238, v239
    v_mfma_f32_16x16x32_bf16 v[112:115], v[28:31], a[252:255], v[112:115]
    v_mfma_f32_16x16x32_bf16 v[128:131], v[160:163], v[20:23], v[128:131]
    v_cvt_pk_bf16_f32 v164, v16, v17
    v_cvt_pk_bf16_f32 v238, v240, v241
    v_accvgpr_read_b32 v242, a48
    v_mfma_f32_16x16x32_bf16 v[116:119], v[28:31], v[212:215], v[116:119]
    ds_read_b128 v[44:47], v3 offset:6400
    v_accvgpr_read_b32 v243, a52
    v_mfma_f32_16x16x32_bf16 v[116:119], v[24:27], v[208:211], v[116:119]
    s_waitcnt lgkmcnt(2)
    buffer_store_dwordx3 v[236:238], v56, s[12:15], s24 offen offset:1344 sc0 sc1
    v_exp_f32 v16, v100
    v_mfma_f32_16x16x32_bf16 v[176:179], v[32:35], v[192:195], v[176:179]
    ds_read_b128 v[24:27], v2 offset:12288
    v_accvgpr_read_b32 v244, a56
    v_mfma_f32_16x16x32_bf16 v[176:179], v[36:39], v[196:199], v[176:179]
    v_exp_f32 v17, v101
    v_accvgpr_read_b32 v245, a60
    v_cvt_pk_bf16_f32 v165, v18, v19
    v_accvgpr_read_b32 v246, a64
    v_mfma_f32_16x16x32_bf16 v[180:183], v[36:39], v[220:223], v[180:183]
    ds_read_b128 v[28:31], v3 offset:12288
    v_accvgpr_read_b32 v247, a68
    v_mfma_f32_16x16x32_bf16 v[180:183], v[32:35], v[216:219], v[180:183]
    s_waitcnt lgkmcnt(2)
    v_exp_f32 v18, v102
    v_mul_f32 v242, v242, v52
    v_mul_f32 v243, v243, v52
    v_mul_f32 v244, v244, v52
    v_mfma_f32_16x16x32_bf16 v[112:115], v[40:43], v[192:195], v[112:115]
    ds_read_b128 v[32:35], v2 offset:18432
    v_mul_f32 v245, v245, v52
    v_mfma_f32_16x16x32_bf16 v[112:115], v[44:47], v[196:199], v[112:115]
    v_exp_f32 v19, v103
    v_cvt_pk_bf16_f32 v166, v16, v17
    v_mul_f32 v246, v246, v52
    v_mul_f32 v247, v247, v52
    v_cvt_pk_bf16_f32 v167, v18, v19
    v_mfma_f32_16x16x32_bf16 v[116:119], v[44:47], v[220:223], v[116:119]
    ds_read_b128 v[36:39], v3 offset:18432
    v_cvt_pk_bf16_f32 v242, v242, v243
    v_mfma_f32_16x16x32_bf16 v[116:119], v[40:43], v[216:219], v[116:119]
    s_waitcnt lgkmcnt(2)
    s_nop 1
    v_cvt_pk_bf16_f32 v243, v244, v245
    v_cvt_pk_bf16_f32 v244, v246, v247
    v_accvgpr_read_b32 v248, a49
    v_mfma_f32_16x16x32_bf16 v[184:187], v[24:27], a[240:243], v[136:139]
    ds_read_b128 v[40:43], v2 offset:12416
    v_accvgpr_read_b32 v249, a53
    v_mfma_f32_16x16x32_bf16 v[184:187], v[28:31], a[244:247], v[184:187]
    buffer_store_dwordx3 v[242:244], v56, s[12:15], s40 offen offset:0 sc0 sc1
    v_accvgpr_read_b32 v250, a57
    v_mfma_f32_16x16x32_bf16 v[188:191], v[28:31], v[204:207], v[140:143]
    ds_read_b128 v[44:47], v3 offset:12416
    v_accvgpr_read_b32 v251, a61
    v_mfma_f32_16x16x32_bf16 v[188:191], v[24:27], v[200:203], v[188:191]
    s_waitcnt lgkmcnt(2)
    v_mfma_f32_16x16x32_bf16 v[132:135], v[164:167], v[20:23], v[132:135]
    v_exp_f32 v16, v168
    v_accvgpr_read_b32 v252, a65
    v_accvgpr_read_b32 v253, a69
    v_mfma_f32_16x16x32_bf16 v[120:123], v[32:35], a[240:243], v[136:139]
    ds_read_b128 v[24:27], v2 offset:18560
    v_mul_f32 v248, v248, v53
    v_mfma_f32_16x16x32_bf16 v[120:123], v[36:39], a[244:247], v[120:123]
    v_exp_f32 v17, v169
    v_exp_f32 v18, v170
    v_mul_f32 v249, v249, v53
    v_mfma_f32_16x16x32_bf16 v[124:127], v[36:39], v[204:207], v[140:143]
    ds_read_b128 v[28:31], v3 offset:18560
    v_mul_f32 v250, v250, v53
    v_mfma_f32_16x16x32_bf16 v[124:127], v[32:35], v[200:203], v[124:127]
    s_waitcnt lgkmcnt(2)
    v_exp_f32 v19, v171
    v_mul_f32 v251, v251, v53
    v_mul_f32 v252, v252, v53
    v_mul_f32 v253, v253, v53
    v_mfma_f32_16x16x32_bf16 v[184:187], v[40:43], a[248:251], v[184:187]
    ds_read_b128 v[32:35], v2 offset:12544
    v_cvt_pk_bf16_f32 v168, v16, v17
    v_mfma_f32_16x16x32_bf16 v[184:187], v[44:47], a[252:255], v[184:187]
    v_cvt_pk_bf16_f32 v248, v248, v249
    v_exp_f32 v16, v104
    v_cvt_pk_bf16_f32 v249, v250, v251
    v_cvt_pk_bf16_f32 v250, v252, v253
    v_accvgpr_read_b32 v224, a50
    v_mfma_f32_16x16x32_bf16 v[188:191], v[44:47], v[212:215], v[188:191]
    ds_read_b128 v[36:39], v3 offset:12544
    v_accvgpr_read_b32 v225, a54
    v_mfma_f32_16x16x32_bf16 v[188:191], v[40:43], v[208:211], v[188:191]
    s_waitcnt lgkmcnt(2)
    buffer_store_dwordx3 v[248:250], v56, s[12:15], s40 offen offset:384 sc0 sc1
    v_accvgpr_read_b32 v226, a58
    v_mfma_f32_16x16x32_bf16 v[120:123], v[24:27], a[248:251], v[120:123]
    ds_read_b128 v[40:43], v2 offset:18688
    v_accvgpr_read_b32 v227, a62
    v_mfma_f32_16x16x32_bf16 v[120:123], v[28:31], a[252:255], v[120:123]
    v_exp_f32 v17, v105
    v_cvt_pk_bf16_f32 v169, v18, v19
    v_accvgpr_read_b32 v228, a66
    v_accvgpr_read_b32 v229, a70
    v_mfma_f32_16x16x32_bf16 v[124:127], v[28:31], v[212:215], v[124:127]
    ds_read_b128 v[44:47], v3 offset:18688
    v_mul_f32 v224, v224, v54
    v_mfma_f32_16x16x32_bf16 v[124:127], v[24:27], v[208:211], v[124:127]
    s_waitcnt lgkmcnt(2)
    v_add_u32 v60, 49152, v1
    v_mov_b32 v59, v1
    v_subrev_u32 v1, 49152, v1
    v_exp_f32 v18, v106
    v_mfma_f32_16x16x32_bf16 v[184:187], v[32:35], v[192:195], v[184:187]
    ds_read_b128 v[24:27], v60 offset:0
    v_mul_f32 v225, v225, v54
    v_mfma_f32_16x16x32_bf16 v[184:187], v[36:39], v[196:199], v[184:187]
    v_exp_f32 v19, v107
    v_mul_f32 v226, v226, v54
    v_cvt_pk_bf16_f32 v170, v16, v17
    v_mul_f32 v227, v227, v54
    v_mul_f32 v228, v228, v54
    v_mfma_f32_16x16x32_bf16 v[188:191], v[36:39], v[220:223], v[188:191]
    ds_read_b128 v[28:31], v60 offset:12288
    v_mul_f32 v229, v229, v54
    v_mfma_f32_16x16x32_bf16 v[188:191], v[32:35], v[216:219], v[188:191]
    s_waitcnt lgkmcnt(2)
    v_exp_f32 v16, v172
    v_cvt_pk_bf16_f32 v224, v224, v225
    v_cvt_pk_bf16_f32 v225, v226, v227
    v_cvt_pk_bf16_f32 v226, v228, v229
    v_mfma_f32_16x16x32_bf16 v[120:123], v[40:43], v[192:195], v[120:123]
    ds_read_b128 v[32:35], v60 offset:1024
    v_accvgpr_read_b32 v230, a51
    v_mfma_f32_16x16x32_bf16 v[120:123], v[44:47], v[196:199], v[120:123]
    buffer_store_dwordx3 v[224:226], v56, s[12:15], s40 offen offset:768 sc0 sc1
    v_accvgpr_read_b32 v231, a55
    v_mfma_f32_16x16x32_bf16 v[124:127], v[44:47], v[220:223], v[124:127]
    ds_read_b128 v[36:39], v60 offset:13312
    v_accvgpr_read_b32 v232, a59
    v_mfma_f32_16x16x32_bf16 v[124:127], v[40:43], v[216:219], v[124:127]
    s_waitcnt lgkmcnt(2)
    v_exp_f32 v17, v173
    v_cvt_pk_bf16_f32 v171, v18, v19
    v_exp_f32 v18, v174
    v_accvgpr_read_b32 v233, a63
    v_mfma_f32_16x16x32_bf16 a[96:99], v[80:83], v[24:27], a[96:99]
    ds_read_b128 v[40:43], v60 offset:2048
    v_accvgpr_read_b32 v234, a67
    v_mfma_f32_16x16x32_bf16 a[96:99], v[88:91], v[28:31], a[96:99]
    v_exp_f32 v19, v175
    v_accvgpr_read_b32 v235, a71
    v_mul_f32 v230, v230, v55
    v_mul_f32 v231, v231, v55
    v_mfma_f32_16x16x32_bf16 a[144:147], v[92:95], v[28:31], a[144:147]
    ds_read_b128 v[44:47], v60 offset:14336
    v_mul_f32 v232, v232, v55
    v_mfma_f32_16x16x32_bf16 a[144:147], v[84:87], v[24:27], a[144:147]
    s_waitcnt lgkmcnt(2)
    v_mfma_f32_16x16x32_bf16 v[128:131], v[168:171], v[20:23], v[128:131]
    v_mul_f32 v233, v233, v55
    v_mul_f32 v234, v234, v55
    v_mul_f32 v235, v235, v55
    v_mfma_f32_16x16x32_bf16 a[100:103], v[80:83], v[32:35], a[100:103]
    ds_read_b128 v[24:27], v60 offset:3072
    v_cvt_pk_bf16_f32 v172, v16, v17
    v_mfma_f32_16x16x32_bf16 a[100:103], v[88:91], v[36:39], a[100:103]
    v_exp_f32 v16, v108
    v_cvt_pk_bf16_f32 v230, v230, v231
    v_cvt_pk_bf16_f32 v231, v232, v233
    v_cvt_pk_bf16_f32 v232, v234, v235
    v_accvgpr_read_b32 v236, a72
    v_mfma_f32_16x16x32_bf16 a[148:151], v[92:95], v[36:39], a[148:151]
    ds_read_b128 v[28:31], v60 offset:15360
    v_accvgpr_read_b32 v237, a76
    v_mfma_f32_16x16x32_bf16 a[148:151], v[84:87], v[32:35], a[148:151]
    s_waitcnt lgkmcnt(2)
    buffer_store_dwordx3 v[230:232], v56, s[12:15], s40 offen offset:1152 sc0 sc1
    v_accvgpr_read_b32 v238, a80
    v_mfma_f32_16x16x32_bf16 a[104:107], v[80:83], v[40:43], a[104:107]
    ds_read_b128 v[32:35], v60 offset:4096
    v_accvgpr_read_b32 v239, a84
    v_mfma_f32_16x16x32_bf16 a[104:107], v[88:91], v[44:47], a[104:107]
    v_exp_f32 v17, v109
    v_cvt_pk_bf16_f32 v173, v18, v19
    v_accvgpr_read_b32 v240, a88
    v_accvgpr_read_b32 v241, a92
    v_mfma_f32_16x16x32_bf16 a[152:155], v[92:95], v[44:47], a[152:155]
    ds_read_b128 v[36:39], v60 offset:16384
    v_mul_f32 v236, v236, v52
    v_mfma_f32_16x16x32_bf16 a[152:155], v[84:87], v[40:43], a[152:155]
    s_waitcnt lgkmcnt(2)
    v_exp_f32 v18, v110
    v_mul_f32 v237, v237, v52
    v_mul_f32 v238, v238, v52
    v_mul_f32 v239, v239, v52
    v_mul_f32 v240, v240, v52
    v_mfma_f32_16x16x32_bf16 a[108:111], v[80:83], v[24:27], a[108:111]
    ds_read_b128 v[40:43], v60 offset:5120
    v_mul_f32 v241, v241, v52
    v_mfma_f32_16x16x32_bf16 a[108:111], v[88:91], v[28:31], a[108:111]
    v_exp_f32 v19, v111
    v_cvt_pk_bf16_f32 v236, v236, v237
    v_cvt_pk_bf16_f32 v237, v238, v239
    v_cvt_pk_bf16_f32 v238, v240, v241
    v_mfma_f32_16x16x32_bf16 a[156:159], v[92:95], v[28:31], a[156:159]
    ds_read_b128 v[44:47], v60 offset:17408
    v_cvt_pk_bf16_f32 v174, v16, v17
    v_mfma_f32_16x16x32_bf16 a[156:159], v[84:87], v[24:27], a[156:159]
    s_waitcnt lgkmcnt(2)
    buffer_store_dwordx3 v[236:238], v56, s[12:15], s40 offen offset:192 sc0 sc1
    v_accvgpr_read_b32 v242, a73
    v_mfma_f32_16x16x32_bf16 a[112:115], v[80:83], v[32:35], a[112:115]
    ds_read_b128 v[24:27], v1 offset:0
    v_cvt_pk_bf16_f32 v175, v18, v19
    v_mfma_f32_16x16x32_bf16 a[112:115], v[88:91], v[36:39], a[112:115]
    s_nop 1
    v_accvgpr_read_b32 v243, a77
    v_accvgpr_read_b32 v244, a81
    v_accvgpr_read_b32 v245, a85
    v_accvgpr_read_b32 v246, a89
    v_mfma_f32_16x16x32_bf16 a[160:163], v[92:95], v[36:39], a[160:163]
    ds_read_b128 v[28:31], v1 offset:12288
    v_accvgpr_read_b32 v247, a93
    v_mfma_f32_16x16x32_bf16 a[160:163], v[84:87], v[32:35], a[160:163]
    s_waitcnt lgkmcnt(2)
    v_mul_f32 v242, v242, v53
    v_mfma_f32_16x16x32_bf16 v[132:135], v[172:175], v[20:23], v[132:135]
    v_exp_f32 v16, v176
    v_mul_f32 v243, v243, v53
    v_mfma_f32_16x16x32_bf16 a[116:119], v[80:83], v[40:43], a[116:119]
    ds_read_b128 v[32:35], v1 offset:1024
    v_mul_f32 v244, v244, v53
    v_mfma_f32_16x16x32_bf16 a[116:119], v[88:91], v[44:47], a[116:119]
    v_exp_f32 v17, v177
    v_exp_f32 v18, v178
    v_mul_f32 v245, v245, v53
    v_mfma_f32_16x16x32_bf16 a[164:167], v[92:95], v[44:47], a[164:167]
    ds_read_b128 v[36:39], v1 offset:13312
    v_mul_f32 v246, v246, v53
    v_mfma_f32_16x16x32_bf16 a[164:167], v[84:87], v[40:43], a[164:167]
    s_waitcnt lgkmcnt(2)
    v_exp_f32 v19, v179
    v_cvt_pk_bf16_f32 v176, v16, v17
    v_exp_f32 v16, v112
    v_mfma_f32_16x16x32_bf16 a[96:99], v[160:163], v[24:27], a[96:99]
L_pg13:
    s_cbranch_execz L_iwret
    ds_read_b128 v[40:43], v1 offset:2048
    v_mul_f32 v247, v247, v53
    v_mfma_f32_16x16x32_bf16 a[96:99], v[168:171], v[28:31], a[96:99]
    v_exp_f32 v17, v113
    v_cvt_pk_bf16_f32 v177, v18, v19
    v_exp_f32 v18, v114
    v_cvt_pk_bf16_f32 v242, v242, v243
    v_mfma_f32_16x16x32_bf16 a[144:147], v[172:175], v[28:31], a[144:147]
    ds_read_b128 v[44:47], v1 offset:14336
    v_cvt_pk_bf16_f32 v243, v244, v245
    v_mfma_f32_16x16x32_bf16 a[144:147], v[164:167], v[24:27], a[144:147]
    s_waitcnt lgkmcnt(2)
    v_exp_f32 v19, v115
    v_cvt_pk_bf16_f32 v178, v16, v17
    v_exp_f32 v16, v180
    v_mfma_f32_16x16x32_bf16 a[100:103], v[160:163], v[32:35], a[100:103]
    ds_read_b128 v[24:27], v1 offset:3072
    v_cvt_pk_bf16_f32 v244, v246, v247
    v_mfma_f32_16x16x32_bf16 a[100:103], v[168:171], v[36:39], a[100:103]
    buffer_store_dwordx3 v[242:244], v56, s[12:15], s40 offen offset:576 sc0 sc1
    v_accvgpr_read_b32 v248, a74
    v_mfma_f32_16x16x32_bf16 a[148:151], v[172:175], v[36:39], a[148:151]
    ds_read_b128 v[28:31], v1 offset:15360
    v_accvgpr_read_b32 v249, a78
    v_mfma_f32_16x16x32_bf16 a[148:151], v[164:167], v[32:35], a[148:151]
    s_waitcnt lgkmcnt(2)
    v_exp_f32 v17, v181
    v_cvt_pk_bf16_f32 v179, v18, v19
    v_exp_f32 v18, v182
    v_accvgpr_read_b32 v250, a82
    v_mfma_f32_16x16x32_bf16 a[104:107], v[160:163], v[40:43], a[104:107]
    ds_read_b128 v[32:35], v1 offset:4096
    v_accvgpr_read_b32 v251, a86
    v_mfma_f32_16x16x32_bf16 a[104:107], v[168:171], v[44:47], a[104:107]
    v_exp_f32 v19, v183
    v_mfma_f32_16x16x32_bf16 v[128:131], v[176:179], v[20:23], v[128:131]
    v_cvt_pk_bf16_f32 v180, v16, v17
    v_mfma_f32_16x16x32_bf16 a[152:155], v[172:175], v[44:47], a[152:155]
    ds_read_b128 v[36:39], v1 offset:16384
    v_accvgpr_read_b32 v252, a90
    v_mfma_f32_16x16x32_bf16 a[152:155], v[164:167], v[40:43], a[152:155]
    s_waitcnt lgkmcnt(2)
    v_exp_f32 v16, v116
    v_exp_f32 v17, v117
    v_cvt_pk_bf16_f32 v181, v18, v19
    v_mfma_f32_16x16x32_bf16 a[108:111], v[160:163], v[24:27], a[108:111]
    ds_read_b128 v[40:43], v1 offset:5120
    v_accvgpr_read_b32 v253, a94
    v_mfma_f32_16x16x32_bf16 a[108:111], v[168:171], v[28:31], a[108:111]
    v_exp_f32 v18, v118
    v_exp_f32 v19, v119
    v_cvt_pk_bf16_f32 v182, v16, v17
    v_cvt_pk_bf16_f32 v183, v18, v19
    v_mfma_f32_16x16x32_bf16 a[156:159], v[172:175], v[28:31], a[156:159]
    s_nop 1
    ds_read_b128 v[44:47], v1 offset:17408
    v_mfma_f32_16x16x32_bf16 a[156:159], v[164:167], v[24:27], a[156:159]
    s_waitcnt lgkmcnt(2)
    v_mfma_f32_16x16x32_bf16 v[132:135], v[180:183], v[20:23], v[132:135]
    v_exp_f32 v16, v184
    v_mul_f32 v248, v248, v54
    v_mfma_f32_16x16x32_bf16 a[112:115], v[160:163], v[32:35], a[112:115]
    ds_read_b128 v[24:27], v59 offset:0
    v_mul_f32 v249, v249, v54
    v_mfma_f32_16x16x32_bf16 a[112:115], v[168:171], v[36:39], a[112:115]
    v_exp_f32 v17, v185
    v_exp_f32 v18, v186
    v_mul_f32 v250, v250, v54
    v_mfma_f32_16x16x32_bf16 a[160:163], v[172:175], v[36:39], a[160:163]
    ds_read_b128 v[28:31], v59 offset:12288
    v_mul_f32 v251, v251, v54
    v_mfma_f32_16x16x32_bf16 a[160:163], v[164:167], v[32:35], a[160:163]
    s_waitcnt lgkmcnt(2)
    v_exp_f32 v19, v187
    v_cvt_pk_bf16_f32 v184, v16, v17
    v_exp_f32 v16, v120
    v_exp_f32 v17, v121
    v_cvt_pk_bf16_f32 v185, v18, v19
    v_exp_f32 v18, v122
    v_exp_f32 v19, v123
    v_cvt_pk_bf16_f32 v186, v16, v17
    v_exp_f32 v16, v188
    v_exp_f32 v17, v189
    v_cvt_pk_bf16_f32 v187, v18, v19
    v_exp_f32 v18, v190
    v_exp_f32 v19, v191
    v_mfma_f32_16x16x32_bf16 v[128:131], v[184:187], v[20:23], v[128:131]
    v_cvt_pk_bf16_f32 v188, v16, v17
    v_exp_f32 v16, v124
    v_exp_f32 v17, v125
    v_cvt_pk_bf16_f32 v189, v18, v19
    v_exp_f32 v18, v126
    v_exp_f32 v19, v127
    v_cvt_pk_bf16_f32 v190, v16, v17
    v_cvt_pk_bf16_f32 v191, v18, v19
    s_nop 1
    v_mfma_f32_16x16x32_bf16 v[132:135], v[188:191], v[20:23], v[132:135]
    v_mfma_f32_16x16x32_bf16 a[116:119], v[160:163], v[40:43], a[116:119]
    ds_read_b128 v[32:35], v59 offset:1024
    v_mul_f32 v252, v252, v54
    v_mfma_f32_16x16x32_bf16 a[116:119], v[168:171], v[44:47], a[116:119]
    v_mul_f32 v253, v253, v54
    v_cvt_pk_bf16_f32 v248, v248, v249
    v_cvt_pk_bf16_f32 v249, v250, v251
    v_cvt_pk_bf16_f32 v250, v252, v253
    v_accvgpr_read_b32 v224, a75
    v_mfma_f32_16x16x32_bf16 a[164:167], v[172:175], v[44:47], a[164:167]
    ds_read_b128 v[36:39], v59 offset:13312
    v_accvgpr_read_b32 v225, a79
    v_mfma_f32_16x16x32_bf16 a[164:167], v[164:167], v[40:43], a[164:167]
    s_waitcnt lgkmcnt(2)
    buffer_store_dwordx3 v[248:250], v56, s[12:15], s40 offen offset:960 sc0 sc1
    v_accvgpr_read_b32 v226, a83
    v_accvgpr_read_b32 v227, a87
    v_mfma_f32_16x16x4_f32 v[128:131], v7, v57, v[128:131]
    v_mfma_f32_16x16x32_bf16 a[96:99], v[176:179], v[24:27], a[96:99]
    ds_read_b128 v[40:43], v59 offset:2048
    v_accvgpr_read_b32 v228, a91
    v_mfma_f32_16x16x32_bf16 a[96:99], v[184:187], v[28:31], a[96:99]
    v_accvgpr_read_b32 v229, a95
    v_mul_f32 v224, v224, v55
    v_mul_f32 v225, v225, v55
    v_mul_f32 v226, v226, v55
    v_mul_f32 v227, v227, v55
    v_mul_f32 v228, v228, v55
    v_mfma_f32_16x16x4_f32 v[132:135], v8, v57, v[132:135]
    v_mfma_f32_16x16x32_bf16 a[144:147], v[188:191], v[28:31], a[144:147]
    ds_read_b128 v[44:47], v59 offset:14336
    v_mul_f32 v229, v229, v55
    v_mfma_f32_16x16x32_bf16 a[144:147], v[180:183], v[24:27], a[144:147]
    s_waitcnt lgkmcnt(2)
    v_cvt_pk_bf16_f32 v224, v224, v225
    v_cvt_pk_bf16_f32 v225, v226, v227
    v_cvt_pk_bf16_f32 v226, v228, v229
    v_mfma_f32_16x16x32_bf16 a[100:103], v[176:179], v[32:35], a[100:103]
    ds_read_b128 v[24:27], v59 offset:3072
    v_mfma_f32_16x16x32_bf16 a[100:103], v[184:187], v[36:39], a[100:103]
    buffer_store_dwordx3 v[224:226], v56, s[12:15], s40 offen offset:1344 sc0 sc1
    v_mfma_f32_16x16x32_bf16 a[148:151], v[188:191], v[36:39], a[148:151]
    ds_read_b128 v[28:31], v59 offset:15360
    v_max3_f32 v18, v5, v6, v128
    v_mfma_f32_16x16x32_bf16 a[148:151], v[180:183], v[32:35], a[148:151]
    s_waitcnt lgkmcnt(2)
    v_max3_f32 v18, v18, v129, v130
    v_max3_f32 v18, v18, v131, v132
    v_max3_f32 v18, v18, v133, v134
    v_max_f32 v18, v18, v135
    s_mov_b32 s29, 0x5f800000
    v_cmp_lt_f32 s[48:49], s29, v18
    v_rcp_f32 v128, v128
    v_mfma_f32_16x16x32_bf16 a[104:107], v[176:179], v[40:43], a[104:107]
    ds_read_b128 v[32:35], v59 offset:4096
    v_mfma_f32_16x16x32_bf16 a[104:107], v[184:187], v[44:47], a[104:107]
    v_rcp_f32 v129, v129
    v_rcp_f32 v130, v130
    v_rcp_f32 v131, v131
    v_mfma_f32_16x16x32_bf16 a[152:155], v[188:191], v[44:47], a[152:155]
    ds_read_b128 v[36:39], v59 offset:16384
    v_mfma_f32_16x16x32_bf16 a[152:155], v[180:183], v[40:43], a[152:155]
    s_waitcnt lgkmcnt(2)
    v_rcp_f32 v132, v132
    v_rcp_f32 v133, v133
    v_mfma_f32_16x16x32_bf16 a[108:111], v[176:179], v[24:27], a[108:111]
    ds_read_b128 v[40:43], v59 offset:5120
    v_mfma_f32_16x16x32_bf16 a[108:111], v[184:187], v[28:31], a[108:111]
    v_rcp_f32 v134, v134
    v_rcp_f32 v135, v135
    v_mfma_f32_16x16x32_bf16 a[156:159], v[188:191], v[28:31], a[156:159]
    ds_read_b128 v[44:47], v59 offset:17408
    v_mfma_f32_16x16x32_bf16 a[156:159], v[180:183], v[24:27], a[156:159]
    s_waitcnt lgkmcnt(2)
    v_mfma_f32_16x16x32_bf16 a[112:115], v[176:179], v[32:35], a[112:115]
    ds_read_b128 v[24:27], v60 offset:6144
    v_mfma_f32_16x16x32_bf16 a[112:115], v[184:187], v[36:39], a[112:115]
    v_mfma_f32_16x16x32_bf16 a[160:163], v[188:191], v[36:39], a[160:163]
    ds_read_b128 v[28:31], v60 offset:18432
    v_mfma_f32_16x16x32_bf16 a[160:163], v[180:183], v[32:35], a[160:163]
    s_waitcnt lgkmcnt(2)
    s_cmp_lg_u64 s[48:49], 0
    s_cbranch_scc1 L_slow
    v_mfma_f32_16x16x32_bf16 a[116:119], v[176:179], v[40:43], a[116:119]
    ds_read_b128 v[32:35], v60 offset:7168
    v_mfma_f32_16x16x32_bf16 a[116:119], v[184:187], v[44:47], a[116:119]
    v_mfma_f32_16x16x32_bf16 a[164:167], v[188:191], v[44:47], a[164:167]
    ds_read_b128 v[36:39], v60 offset:19456
    v_mfma_f32_16x16x32_bf16 a[164:167], v[180:183], v[40:43], a[164:167]
    s_waitcnt lgkmcnt(2)
    v_mfma_f32_16x16x32_bf16 a[120:123], v[80:83], v[24:27], a[120:123]
    ds_read_b128 v[40:43], v60 offset:8192
    v_mfma_f32_16x16x32_bf16 a[120:123], v[88:91], v[28:31], a[120:123]
    v_mfma_f32_16x16x32_bf16 a[168:171], v[92:95], v[28:31], a[168:171]
    ds_read_b128 v[44:47], v60 offset:20480
    v_mfma_f32_16x16x32_bf16 a[168:171], v[84:87], v[24:27], a[168:171]
    s_waitcnt lgkmcnt(2)
    v_mfma_f32_16x16x32_bf16 a[124:127], v[80:83], v[32:35], a[124:127]
    ds_read_b128 v[24:27], v1 offset:6144
    v_accvgpr_read_b32 v230, a96
    v_mfma_f32_16x16x32_bf16 a[124:127], v[88:91], v[36:39], a[124:127]
    v_accvgpr_read_b32 v231, a100
    v_accvgpr_read_b32 v232, a104
    v_accvgpr_read_b32 v233, a108
    v_accvgpr_read_b32 v234, a112
    v_accvgpr_read_b32 v235, a116
    v_mul_f32 v230, v230, v128
    v_mul_f32 v231, v231, v128
    v_mul_f32 v232, v232, v128
    v_mul_f32 v233, v233, v128
    v_mul_f32 v234, v234, v128
    v_mul_f32 v235, v235, v128
    v_cvt_pk_bf16_f32 v230, v230, v231
    v_cvt_pk_bf16_f32 v231, v232, v233
    v_cvt_pk_bf16_f32 v232, v234, v235
    v_accvgpr_read_b32 v236, a97
    v_accvgpr_read_b32 v237, a101
    v_accvgpr_read_b32 v238, a105
    v_accvgpr_read_b32 v239, a109
    v_accvgpr_read_b32 v240, a113
    v_accvgpr_read_b32 v241, a117
    v_mul_f32 v236, v236, v129
    v_mul_f32 v237, v237, v129
    v_mul_f32 v238, v238, v129
    v_mul_f32 v239, v239, v129
    v_mul_f32 v240, v240, v129
    v_mul_f32 v241, v241, v129
    v_cvt_pk_bf16_f32 v236, v236, v237
    v_cvt_pk_bf16_f32 v237, v238, v239
    v_cvt_pk_bf16_f32 v238, v240, v241
    v_accvgpr_read_b32 v242, a98
    v_mfma_f32_16x16x32_bf16 a[172:175], v[92:95], v[36:39], a[172:175]
    ds_read_b128 v[28:31], v1 offset:18432
    v_accvgpr_read_b32 v243, a102
    v_mfma_f32_16x16x32_bf16 a[172:175], v[84:87], v[32:35], a[172:175]
    s_waitcnt lgkmcnt(2)
    buffer_store_dwordx3 v[230:232], v56, s[12:15], s41 offen offset:0 sc0 sc1
    v_accvgpr_read_b32 v244, a106
    v_mfma_f32_16x16x32_bf16 a[128:131], v[80:83], v[40:43], a[128:131]
    ds_read_b128 v[32:35], v1 offset:7168
    v_accvgpr_read_b32 v245, a110
    v_mfma_f32_16x16x32_bf16 a[128:131], v[88:91], v[44:47], a[128:131]
    buffer_store_dwordx3 v[236:238], v56, s[12:15], s41 offen offset:384 sc0 sc1
    v_accvgpr_read_b32 v246, a114
    v_mfma_f32_16x16x32_bf16 a[176:179], v[92:95], v[44:47], a[176:179]
    ds_read_b128 v[36:39], v1 offset:19456
    v_accvgpr_read_b32 v247, a118
    v_mfma_f32_16x16x32_bf16 a[176:179], v[84:87], v[40:43], a[176:179]
    s_waitcnt lgkmcnt(2)
    v_mul_f32 v242, v242, v130
    v_mul_f32 v243, v243, v130
    v_mul_f32 v244, v244, v130
    v_mul_f32 v245, v245, v130
    v_mul_f32 v246, v246, v130
    v_mul_f32 v247, v247, v130
    v_mfma_f32_16x16x32_bf16 a[120:123], v[160:163], v[24:27], a[120:123]
    ds_read_b128 v[40:43], v1 offset:8192
    v_cvt_pk_bf16_f32 v242, v242, v243
    v_mfma_f32_16x16x32_bf16 a[120:123], v[168:171], v[28:31], a[120:123]
    v_cvt_pk_bf16_f32 v243, v244, v245
    v_cvt_pk_bf16_f32 v244, v246, v247
    v_accvgpr_read_b32 v248, a99
    v_accvgpr_read_b32 v249, a103
    v_accvgpr_read_b32 v250, a107
    v_mfma_f32_16x16x32_bf16 a[168:171], v[172:175], v[28:31], a[168:171]
    ds_read_b128 v[44:47], v1 offset:20480
    v_accvgpr_read_b32 v251, a111
    v_mfma_f32_16x16x32_bf16 a[168:171], v[164:167], v[24:27], a[168:171]
    s_waitcnt lgkmcnt(2)
    buffer_store_dwordx3 v[242:244], v56, s[12:15], s41 offen offset:768 sc0 sc1
    v_accvgpr_read_b32 v252, a115
    v_mfma_f32_16x16x32_bf16 a[124:127], v[160:163], v[32:35], a[124:127]
    ds_read_b128 v[24:27], v59 offset:6144
    v_accvgpr_read_b32 v253, a119
    v_mfma_f32_16x16x32_bf16 a[124:127], v[168:171], v[36:39], a[124:127]
    v_mul_f32 v248, v248, v131
    v_mul_f32 v249, v249, v131
    v_mul_f32 v250, v250, v131
    v_mul_f32 v251, v251, v131
    v_mul_f32 v252, v252, v131
    v_mul_f32 v253, v253, v131
    v_mfma_f32_16x16x32_bf16 a[172:175], v[172:175], v[36:39], a[172:175]
    ds_read_b128 v[28:31], v59 offset:18432
    v_cvt_pk_bf16_f32 v248, v248, v249
    v_mfma_f32_16x16x32_bf16 a[172:175], v[164:167], v[32:35], a[172:175]
    s_waitcnt lgkmcnt(2)
    v_cvt_pk_bf16_f32 v249, v250, v251
    v_cvt_pk_bf16_f32 v250, v252, v253
    v_accvgpr_read_b32 v224, a144
    v_accvgpr_read_b32 v225, a148
    v_accvgpr_read_b32 v226, a152
    v_mfma_f32_16x16x32_bf16 a[128:131], v[160:163], v[40:43], a[128:131]
    ds_read_b128 v[32:35], v59 offset:7168
    v_accvgpr_read_b32 v227, a156
    v_mfma_f32_16x16x32_bf16 a[128:131], v[168:171], v[44:47], a[128:131]
    buffer_store_dwordx3 v[248:250], v56, s[12:15], s41 offen offset:1152 sc0 sc1
    v_accvgpr_read_b32 v228, a160
    v_mfma_f32_16x16x32_bf16 a[176:179], v[172:175], v[44:47], a[176:179]
    ds_read_b128 v[36:39], v59 offset:19456
    v_accvgpr_read_b32 v229, a164
    v_mfma_f32_16x16x32_bf16 a[176:179], v[164:167], v[40:43], a[176:179]
    s_waitcnt lgkmcnt(2)
    v_mul_f32 v224, v224, v132
    v_mul_f32 v225, v225, v132
    v_mul_f32 v226, v226, v132
    v_mul_f32 v227, v227, v132
    v_mul_f32 v228, v228, v132
    v_mul_f32 v229, v229, v132
    v_mfma_f32_16x16x32_bf16 a[120:123], v[176:179], v[24:27], a[120:123]
    ds_read_b128 v[40:43], v59 offset:8192
    v_cvt_pk_bf16_f32 v224, v224, v225
    v_mfma_f32_16x16x32_bf16 a[120:123], v[184:187], v[28:31], a[120:123]
    v_cvt_pk_bf16_f32 v225, v226, v227
    v_cvt_pk_bf16_f32 v226, v228, v229
    v_accvgpr_read_b32 v230, a145
    v_accvgpr_read_b32 v231, a149
    v_accvgpr_read_b32 v232, a153
    v_mfma_f32_16x16x32_bf16 a[168:171], v[188:191], v[28:31], a[168:171]
    ds_read_b128 v[44:47], v59 offset:20480
    v_accvgpr_read_b32 v233, a157
    v_mfma_f32_16x16x32_bf16 a[168:171], v[180:183], v[24:27], a[168:171]
    s_waitcnt lgkmcnt(2)
    buffer_store_dwordx3 v[224:226], v56, s[12:15], s42 offen offset:0 sc0 sc1
    v_accvgpr_read_b32 v234, a161
    v_mfma_f32_16x16x32_bf16 a[124:127], v[176:179], v[32:35], a[124:127]
    ds_read_b128 v[24:27], v60 offset:9216
    v_accvgpr_read_b32 v235, a165
    v_mfma_f32_16x16x32_bf16 a[124:127], v[184:187], v[36:39], a[124:127]
    v_mul_f32 v230, v230, v133
    v_mul_f32 v231, v231, v133
    v_mul_f32 v232, v232, v133
    v_mul_f32 v233, v233, v133
    v_mul_f32 v234, v234, v133
    v_mul_f32 v235, v235, v133
    v_mfma_f32_16x16x32_bf16 a[172:175], v[188:191], v[36:39], a[172:175]
    ds_read_b128 v[28:31], v60 offset:21504
    v_cvt_pk_bf16_f32 v230, v230, v231
    v_mfma_f32_16x16x32_bf16 a[172:175], v[180:183], v[32:35], a[172:175]
    s_waitcnt lgkmcnt(2)
    v_cvt_pk_bf16_f32 v231, v232, v233
    v_cvt_pk_bf16_f32 v232, v234, v235
    v_accvgpr_read_b32 v236, a146
    v_accvgpr_read_b32 v237, a150
    v_accvgpr_read_b32 v238, a154
    v_mfma_f32_16x16x32_bf16 a[128:131], v[176:179], v[40:43], a[128:131]
    ds_read_b128 v[32:35], v60 offset:10240
    v_accvgpr_read_b32 v239, a158
    v_mfma_f32_16x16x32_bf16 a[128:131], v[184:187], v[44:47], a[128:131]
    buffer_store_dwordx3 v[230:232], v56, s[12:15], s42 offen offset:384 sc0 sc1
    v_accvgpr_read_b32 v240, a162
    v_mfma_f32_16x16x32_bf16 a[176:179], v[188:191], v[44:47], a[176:179]
    ds_read_b128 v[36:39], v60 offset:22528
    v_accvgpr_read_b32 v241, a166
    v_mfma_f32_16x16x32_bf16 a[176:179], v[180:183], v[40:43], a[176:179]
    s_waitcnt lgkmcnt(2)
    v_mul_f32 v236, v236, v134
    v_mul_f32 v237, v237, v134
    v_mul_f32 v238, v238, v134
    v_mul_f32 v239, v239, v134
    v_mul_f32 v240, v240, v134
    v_mfma_f32_16x16x32_bf16 a[132:135], v[80:83], v[24:27], a[132:135]
    ds_read_b128 v[40:43], v60 offset:11264
    v_mul_f32 v241, v241, v134
    v_mfma_f32_16x16x32_bf16 a[132:135], v[88:91], v[28:31], a[132:135]
    v_cvt_pk_bf16_f32 v236, v236, v237
    v_cvt_pk_bf16_f32 v237, v238, v239
    v_cvt_pk_bf16_f32 v238, v240, v241
    v_accvgpr_read_b32 v242, a147
    v_accvgpr_read_b32 v243, a151
    v_accvgpr_read_b32 v244, a155
    v_mfma_f32_16x16x32_bf16 a[180:183], v[92:95], v[28:31], a[180:183]
    ds_read_b128 v[44:47], v60 offset:23552
    v_accvgpr_read_b32 v245, a159
    v_mfma_f32_16x16x32_bf16 a[180:183], v[84:87], v[24:27], a[180:183]
    s_waitcnt lgkmcnt(2)
    buffer_store_dwordx3 v[236:238], v56, s[12:15], s42 offen offset:768 sc0 sc1
    v_accvgpr_read_b32 v246, a163
    v_mfma_f32_16x16x32_bf16 a[136:139], v[80:83], v[32:35], a[136:139]
    ds_read_b128 v[24:27], v1 offset:9216
    v_accvgpr_read_b32 v96, a120
    v_mfma_f32_16x16x32_bf16 a[136:139], v[88:91], v[36:39], a[136:139]
    v_accvgpr_read_b32 v97, a124
    v_accvgpr_read_b32 v98, a128
    v_mul_f32 v96, v96, v128
    v_mul_f32 v97, v97, v128
    v_mul_f32 v98, v98, v128
    v_mfma_f32_16x16x32_bf16 a[184:187], v[92:95], v[36:39], a[184:187]
    ds_read_b128 v[28:31], v1 offset:21504
    v_accvgpr_read_b32 v102, a121
    v_mfma_f32_16x16x32_bf16 a[184:187], v[84:87], v[32:35], a[184:187]
    s_waitcnt lgkmcnt(2)
    v_accvgpr_read_b32 v103, a125
    v_accvgpr_read_b32 v104, a129
    v_mul_f32 v102, v102, v129
    v_mul_f32 v103, v103, v129
    v_mul_f32 v104, v104, v129
    v_accvgpr_read_b32 v108, a122
    v_mfma_f32_16x16x32_bf16 a[140:143], v[80:83], v[40:43], a[140:143]
    ds_read_b128 v[32:35], v1 offset:10240
    v_accvgpr_read_b32 v109, a126
    v_mfma_f32_16x16x32_bf16 a[140:143], v[88:91], v[44:47], a[140:143]
    v_accvgpr_read_b32 v110, a130
    v_mul_f32 v108, v108, v130
    v_mul_f32 v109, v109, v130
    v_mul_f32 v110, v110, v130
    v_accvgpr_read_b32 v114, a123
    v_mfma_f32_16x16x32_bf16 a[188:191], v[92:95], v[44:47], a[188:191]
    ds_read_b128 v[36:39], v1 offset:22528
    v_accvgpr_read_b32 v115, a127
    v_mfma_f32_16x16x32_bf16 a[188:191], v[84:87], v[40:43], a[188:191]
    s_waitcnt lgkmcnt(2)
    v_accvgpr_read_b32 v116, a131
    v_mul_f32 v114, v114, v131
    v_mul_f32 v115, v115, v131
    v_mul_f32 v116, v116, v131
    v_accvgpr_read_b32 v120, a168
    v_mfma_f32_16x16x32_bf16 a[132:135], v[160:163], v[24:27], a[132:135]
    ds_read_b128 v[40:43], v1 offset:11264
    v_accvgpr_read_b32 v121, a172
    v_mfma_f32_16x16x32_bf16 a[132:135], v[168:171], v[28:31], a[132:135]
    v_accvgpr_read_b32 v122, a176
    v_mul_f32 v120, v120, v132
    v_mul_f32 v121, v121, v132
    v_mul_f32 v122, v122, v132
    v_accvgpr_read_b32 v64, a169
    v_accvgpr_read_b32 v65, a173
    v_mfma_f32_16x16x32_bf16 a[180:183], v[172:175], v[28:31], a[180:183]
    ds_read_b128 v[44:47], v1 offset:23552
    v_accvgpr_read_b32 v66, a177
    v_mfma_f32_16x16x32_bf16 a[180:183], v[164:167], v[24:27], a[180:183]
    s_waitcnt lgkmcnt(2)
    v_mul_f32 v64, v64, v133
    v_mul_f32 v65, v65, v133
    v_mul_f32 v66, v66, v133
    v_accvgpr_read_b32 v70, a170
    v_accvgpr_read_b32 v71, a174
    v_mfma_f32_16x16x32_bf16 a[136:139], v[160:163], v[32:35], a[136:139]
    ds_read_b128 v[24:27], v59 offset:9216
    v_accvgpr_read_b32 v247, a167
    v_mfma_f32_16x16x32_bf16 a[136:139], v[168:171], v[36:39], a[136:139]
    v_accvgpr_read_b32 v72, a178
    v_mul_f32 v242, v242, v135
    v_mul_f32 v70, v70, v134
    v_mul_f32 v243, v243, v135
    v_mul_f32 v71, v71, v134
    v_mfma_f32_16x16x32_bf16 a[184:187], v[172:175], v[36:39], a[184:187]
    ds_read_b128 v[28:31], v59 offset:21504
    v_mul_f32 v244, v244, v135
    v_mfma_f32_16x16x32_bf16 a[184:187], v[164:167], v[32:35], a[184:187]
    s_waitcnt lgkmcnt(2)
    v_mul_f32 v72, v72, v134
    v_mul_f32 v245, v245, v135
    v_accvgpr_read_b32 v144, a171
    v_mul_f32 v246, v246, v135
    v_accvgpr_read_b32 v145, a175
    v_mul_f32 v247, v247, v135
    v_mfma_f32_16x16x32_bf16 a[140:143], v[160:163], v[40:43], a[140:143]
    ds_read_b128 v[32:35], v59 offset:10240
    v_accvgpr_read_b32 v146, a179
    v_mfma_f32_16x16x32_bf16 a[140:143], v[168:171], v[44:47], a[140:143]
    v_cvt_pk_bf16_f32 v242, v242, v243
    v_mul_f32 v144, v144, v135
    v_cvt_pk_bf16_f32 v243, v244, v245
    v_mul_f32 v145, v145, v135
    v_cvt_pk_bf16_f32 v244, v246, v247
    v_mfma_f32_16x16x32_bf16 a[188:191], v[172:175], v[44:47], a[188:191]
    ds_read_b128 v[36:39], v59 offset:22528
    v_mul_f32 v146, v146, v135
    v_mfma_f32_16x16x32_bf16 a[188:191], v[164:167], v[40:43], a[188:191]
    s_waitcnt lgkmcnt(2)
    buffer_store_dwordx3 v[242:244], v56, s[12:15], s42 offen offset:1152 sc0 sc1
    v_mfma_f32_16x16x32_bf16 a[132:135], v[176:179], v[24:27], a[132:135]
    ds_read_b128 v[40:43], v59 offset:11264
    v_mfma_f32_16x16x32_bf16 a[132:135], v[184:187], v[28:31], a[132:135]
    v_mfma_f32_16x16x32_bf16 a[180:183], v[188:191], v[28:31], a[180:183]
    ds_read_b128 v[44:47], v59 offset:23552
    v_mfma_f32_16x16x32_bf16 a[180:183], v[180:183], v[24:27], a[180:183]
    s_waitcnt lgkmcnt(2)
    v_mfma_f32_16x16x32_bf16 a[136:139], v[176:179], v[32:35], a[136:139]
    v_mfma_f32_16x16x32_bf16 a[136:139], v[184:187], v[36:39], a[136:139]
    v_mfma_f32_16x16x32_bf16 a[184:187], v[188:191], v[36:39], a[184:187]
    v_mfma_f32_16x16x32_bf16 a[184:187], v[180:183], v[32:35], a[184:187]
    s_waitcnt lgkmcnt(0)
    v_mfma_f32_16x16x32_bf16 a[140:143], v[176:179], v[40:43], a[140:143]
    v_mfma_f32_16x16x32_bf16 a[140:143], v[184:187], v[44:47], a[140:143]
    v_mfma_f32_16x16x32_bf16 a[188:191], v[188:191], v[44:47], a[188:191]
    v_mfma_f32_16x16x32_bf16 a[188:191], v[180:183], v[40:43], a[188:191]
    s_nop 7
    v_accvgpr_read_b32 v99, a132
    v_accvgpr_read_b32 v100, a136
    v_accvgpr_read_b32 v101, a140
    v_cvt_pk_bf16_f32 v96, v96, v97
    v_mul_f32 v99, v99, v128
    v_mul_f32 v100, v100, v128
    v_mul_f32 v101, v101, v128
    v_cvt_pk_bf16_f32 v97, v98, v99
    v_cvt_pk_bf16_f32 v98, v100, v101
    buffer_store_dwordx3 v[96:98], v56, s[12:15], s41 offen offset:192 sc0 sc1
    v_accvgpr_read_b32 v105, a133
    v_accvgpr_read_b32 v106, a137
    v_accvgpr_read_b32 v107, a141
    v_cvt_pk_bf16_f32 v102, v102, v103
    v_mul_f32 v105, v105, v129
    v_mul_f32 v106, v106, v129
    v_mul_f32 v107, v107, v129
    v_cvt_pk_bf16_f32 v103, v104, v105
    v_cvt_pk_bf16_f32 v104, v106, v107
    buffer_store_dwordx3 v[102:104], v56, s[12:15], s41 offen offset:576 sc0 sc1
    v_accvgpr_read_b32 v111, a134
    v_accvgpr_read_b32 v112, a138
    v_accvgpr_read_b32 v113, a142
    v_cvt_pk_bf16_f32 v108, v108, v109
    v_mul_f32 v111, v111, v130
    v_mul_f32 v112, v112, v130
    v_mul_f32 v113, v113, v130
    v_cvt_pk_bf16_f32 v109, v110, v111
    v_cvt_pk_bf16_f32 v110, v112, v113
    buffer_store_dwordx3 v[108:110], v56, s[12:15], s41 offen offset:960 sc0 sc1
    v_accvgpr_read_b32 v117, a135
    v_accvgpr_read_b32 v118, a139
    v_accvgpr_read_b32 v119, a143
    v_cvt_pk_bf16_f32 v114, v114, v115
    v_mul_f32 v117, v117, v131
    v_mul_f32 v118, v118, v131
    v_mul_f32 v119, v119, v131
    v_cvt_pk_bf16_f32 v115, v116, v117
    v_cvt_pk_bf16_f32 v116, v118, v119
    buffer_store_dwordx3 v[114:116], v56, s[12:15], s41 offen offset:1344 sc0 sc1
    v_accvgpr_read_b32 v123, a180
    v_accvgpr_read_b32 v124, a184
    v_accvgpr_read_b32 v125, a188
    v_cvt_pk_bf16_f32 v120, v120, v121
    v_mul_f32 v123, v123, v132
    v_mul_f32 v124, v124, v132
    v_mul_f32 v125, v125, v132
    v_cvt_pk_bf16_f32 v121, v122, v123
    v_cvt_pk_bf16_f32 v122, v124, v125
    buffer_store_dwordx3 v[120:122], v56, s[12:15], s42 offen offset:192 sc0 sc1
    v_accvgpr_read_b32 v67, a181
    v_accvgpr_read_b32 v68, a185
    v_accvgpr_read_b32 v69, a189
    v_cvt_pk_bf16_f32 v64, v64, v65
    v_mul_f32 v67, v67, v133
    v_mul_f32 v68, v68, v133
    v_mul_f32 v69, v69, v133
    v_cvt_pk_bf16_f32 v65, v66, v67
    v_cvt_pk_bf16_f32 v66, v68, v69
    buffer_store_dwordx3 v[64:66], v56, s[12:15], s42 offen offset:576 sc0 sc1
    v_accvgpr_read_b32 v73, a182
    v_accvgpr_read_b32 v74, a186
    v_accvgpr_read_b32 v75, a190
    v_cvt_pk_bf16_f32 v70, v70, v71
    v_mul_f32 v73, v73, v134
    v_mul_f32 v74, v74, v134
    v_mul_f32 v75, v75, v134
    v_cvt_pk_bf16_f32 v71, v72, v73
    v_cvt_pk_bf16_f32 v72, v74, v75
    buffer_store_dwordx3 v[70:72], v56, s[12:15], s42 offen offset:960 sc0 sc1
    v_accvgpr_read_b32 v147, a183
    v_accvgpr_read_b32 v148, a187
    v_accvgpr_read_b32 v149, a191
    v_cvt_pk_bf16_f32 v144, v144, v145
    v_mul_f32 v147, v147, v135
    v_mul_f32 v148, v148, v135
    v_mul_f32 v149, v149, v135
    v_cvt_pk_bf16_f32 v145, v146, v147
    v_cvt_pk_bf16_f32 v146, v148, v149
    buffer_store_dwordx3 v[144:146], v56, s[12:15], s42 offen offset:1344 sc0 sc1
L_fin:
L_done:
    s_endpgm
L_pollslow0:
    s_mov_b32 s59, 60
L_pollsm0:
    s_buffer_load_dwordx8 s[48:55], s[20:23], s44 glc
    s_waitcnt lgkmcnt(0)
    s_sub_u32 s48, s48, s92
    s_sub_u32 s49, s49, s92
    s_sub_u32 s50, s50, s92
    s_sub_u32 s51, s51, s92
    s_sub_u32 s52, s52, s92
    s_sub_u32 s53, s53, s92
    s_sub_u32 s54, s54, s92
    s_sub_u32 s55, s55, s92
    s_max_u32 s48, s48, s49
    s_max_u32 s48, s48, s50
    s_max_u32 s48, s48, s51
    s_max_u32 s48, s48, s52
    s_max_u32 s48, s48, s53
    s_max_u32 s48, s48, s54
    s_max_u32 s48, s48, s55
    s_cmp_lt_u32 s48, 16
    s_cbranch_scc1 L_pollok0
    s_sub_u32 s59, s59, 1
    s_cbranch_scc1 L_pollvec0
    s_sleep 1
    s_branch L_pollsm0
L_pollvec0:
    v_bfe_u32 v53, v4, 4, 6
    v_lshlrev_b32 v53, 2, v53
    s_sub_u32 s96, s96, 1
    s_cbranch_scc1 L_pollgiveup0
    s_sleep 2
    buffer_load_dword v52, v53, s[20:23], s44 offen sc1
    s_waitcnt vmcnt(0)
    s_bitcmp1_b32 s92, 9
    s_cbranch_scc1 L_nomix
    v_xor_b32 v53, s92, v52
    v_lshrrev_b32 v53, 5, v53
    v_add_u32 v53, -1, v53
    v_cmp_gt_u32 vcc, 31, v53
    s_nop 1
    s_and_b32 s59, vcc_lo, 0xff
    s_cbranch_scc0 L_nomix
    buffer_store_dwordx4 v[224:227], v11, s[4:7], s33 offen offset:0 sc1
    v_xor_b32 v55, 16, v11
    buffer_store_dwordx4 v[228:231], v55, s[4:7], s33 offen offset:768 sc1
    v_xor_b32 v54, 32, v11
    buffer_store_dwordx4 v[232:235], v54, s[4:7], s33 offen offset:1536 sc1
    v_xor_b32 v55, 48, v11
    buffer_store_dwordx4 v[236:239], v55, s[4:7], s33 offen offset:2304 sc1
    buffer_store_dwordx4 v[112:115], v15, s[4:7], s35 offen offset:0 sc1
    buffer_store_dwordx4 v[116:119], v15, s[4:7], s35 offen offset:1024 sc1
    buffer_store_dwordx4 v[120:123], v15, s[4:7], s35 offen offset:2048 sc1
    s_waitcnt vmcnt(0)
    s_barrier
    s_and_b32 s92, s92, 0xfffffc00
    s_add_u32 s92, s92, 512
    v_mov_b32 v0, s92
    s_add_u32 s92, s92, 1
    s_mov_b32 s44, 32
    v_add_u32 v0, 1, v0
    buffer_store_dword v0, v13, s[20:23], 0 offen offset:32 sc1
    s_branch L_pollvec0
L_nomix:
    v_subrev_u32 v52, s92, v52
    v_cmp_lt_u32 vcc, 15, v52
    s_nop 0
    s_and_b32 s59, vcc_lo, 0xff
    s_cbranch_scc1 L_pollvec0
    s_branch L_pollok0
L_pollgiveup0:
    s_mov_b32 s96, 0
    s_branch L_pollok0
L_pollslow1:
    s_mov_b32 s59, 200
L_pollsm1:
    s_buffer_load_dwordx8 s[48:55], s[20:23], s44 glc
    s_waitcnt lgkmcnt(0)
    s_sub_u32 s48, s48, s92
    s_sub_u32 s49, s49, s92
    s_sub_u32 s50, s50, s92
    s_sub_u32 s51, s51, s92
    s_sub_u32 s52, s52, s92
    s_sub_u32 s53, s53, s92
    s_sub_u32 s54, s54, s92
    s_sub_u32 s55, s55, s92
    s_max_u32 s48, s48, s49
    s_max_u32 s48, s48, s50
    s_max_u32 s48, s48, s51
    s_max_u32 s48, s48, s52
    s_max_u32 s48, s48, s53
    s_max_u32 s48, s48, s54
    s_max_u32 s48, s48, s55
    s_cmp_lt_u32 s48, 16
    s_cbranch_scc1 L_pollok1
    s_sub_u32 s59, s59, 1
    s_cbranch_scc1 L_pollvec1
    s_sleep 1
    s_branch L_pollsm1
L_pollvec1:
    v_bfe_u32 v53, v4, 4, 6
    v_lshlrev_b32 v53, 2, v53
    s_sub_u32 s96, s96, 1
    s_cbranch_scc1 L_pollgiveup1
    s_sleep 2
    buffer_load_dword v52, v53, s[20:23], s44 offen sc1
    s_waitcnt vmcnt(0)
    v_subrev_u32 v52, s92, v52
    v_cmp_lt_u32 vcc, 15, v52
    s_nop 0
    s_and_b32 s59, vcc_lo, 0xff
    s_cbranch_scc1 L_pollvec1
    s_branch L_pollok1
L_pollgiveup1:
    s_mov_b32 s96, 0
    s_branch L_pollok1
L_pollslow2:
    s_mov_b32 s59, 200
L_pollsm2:
    s_buffer_load_dwordx8 s[48:55], s[20:23], s44 glc
    s_waitcnt lgkmcnt(0)
    s_sub_u32 s48, s48, s92
    s_sub_u32 s49, s49, s92
    s_sub_u32 s50, s50, s92
    s_sub_u32 s51, s51, s92
    s_sub_u32 s52, s52, s92
    s_sub_u32 s53, s53, s92
    s_sub_u32 s54, s54, s92
    s_sub_u32 s55, s55, s92
    s_max_u32 s48, s48, s49
    s_max_u32 s48, s48, s50
    s_max_u32 s48, s48, s51
    s_max_u32 s48, s48, s52
    s_max_u32 s48, s48, s53
    s_max_u32 s48, s48, s54
    s_max_u32 s48, s48, s55
    s_cmp_lt_u32 s48, 16
    s_cbranch_scc1 L_pollok2
    s_sub_u32 s59, s59, 1
    s_cbranch_scc1 L_pollvec2
    s_sleep 1
    s_branch L_pollsm2
L_pollvec2:
    v_bfe_u32 v53, v4, 4, 6
    v_lshlrev_b32 v53, 2, v53
    s_sub_u32 s96, s96, 1
    s_cbranch_scc1 L_pollgiveup2
    s_sleep 2
    buffer_load_dword v52, v53, s[20:23], s44 offen sc1
    s_waitcnt vmcnt(0)
    v_subrev_u32 v52, s92, v52
    v_cmp_lt_u32 vcc, 15, v52
    s_nop 0
    s_and_b32 s59, vcc_lo, 0xff
    s_cbranch_scc1 L_pollvec2
    s_branch L_pollok2
L_pollgiveup2:
    s_mov_b32 s96, 0
    s_branch L_pollok2
L_pollslow3:
    s_mov_b32 s59, 200
L_pollsm3:
    s_buffer_load_dwordx8 s[48:55], s[20:23], s44 glc
    s_waitcnt lgkmcnt(0)
    s_sub_u32 s48, s48, s92
    s_sub_u32 s49, s49, s92
    s_sub_u32 s50, s50, s92
    s_sub_u32 s51, s51, s92
    s_sub_u32 s52, s52, s92
    s_sub_u32 s53, s53, s92
    s_sub_u32 s54, s54, s92
    s_sub_u32 s55, s55, s92
    s_max_u32 s48, s48, s49
    s_max_u32 s48, s48, s50
    s_max_u32 s48, s48, s51
    s_max_u32 s48, s48, s52
    s_max_u32 s48, s48, s53
    s_max_u32 s48, s48, s54
    s_max_u32 s48, s48, s55
    s_cmp_lt_u32 s48, 16
    s_cbranch_scc1 L_pollok3
    s_sub_u32 s59, s59, 1
    s_cbranch_scc1 L_pollvec3
    s_sleep 1
    s_branch L_pollsm3
L_pollvec3:
    v_bfe_u32 v53, v4, 4, 6
    v_lshlrev_b32 v53, 2, v53
    s_sub_u32 s96, s96, 1
    s_cbranch_scc1 L_pollgiveup3
    s_sleep 2
    buffer_load_dword v52, v53, s[20:23], s44 offen sc1
    s_waitcnt vmcnt(0)
    v_subrev_u32 v52, s92, v52
    v_cmp_lt_u32 vcc, 15, v52
    s_nop 0
    s_and_b32 s59, vcc_lo, 0xff
    s_cbranch_scc1 L_pollvec3
    s_branch L_pollok3
L_pollgiveup3:
    s_mov_b32 s96, 0
    s_branch L_pollok3
L_pollslow4:
    s_mov_b32 s59, 200
L_pollsm4:
    s_buffer_load_dwordx8 s[48:55], s[20:23], s44 glc
    s_waitcnt lgkmcnt(0)
    s_sub_u32 s48, s48, s92
    s_sub_u32 s49, s49, s92
    s_sub_u32 s50, s50, s92
    s_sub_u32 s51, s51, s92
    s_sub_u32 s52, s52, s92
    s_sub_u32 s53, s53, s92
    s_sub_u32 s54, s54, s92
    s_sub_u32 s55, s55, s92
    s_max_u32 s48, s48, s49
    s_max_u32 s48, s48, s50
    s_max_u32 s48, s48, s51
    s_max_u32 s48, s48, s52
    s_max_u32 s48, s48, s53
    s_max_u32 s48, s48, s54
    s_max_u32 s48, s48, s55
    s_cmp_lt_u32 s48, 16
    s_cbranch_scc1 L_pollok4
    s_sub_u32 s59, s59, 1
    s_cbranch_scc1 L_pollvec4
    s_sleep 1
    s_branch L_pollsm4
L_pollvec4:
    v_bfe_u32 v53, v4, 4, 6
    v_lshlrev_b32 v53, 2, v53
    s_sub_u32 s96, s96, 1
    s_cbranch_scc1 L_pollgiveup4
    s_sleep 2
    buffer_load_dword v52, v53, s[20:23], s44 offen sc1
    s_waitcnt vmcnt(0)
    v_subrev_u32 v52, s92, v52
    v_cmp_lt_u32 vcc, 15, v52
    s_nop 0
    s_and_b32 s59, vcc_lo, 0xff
    s_cbranch_scc1 L_pollvec4
    s_branch L_pollok4
L_pollgiveup4:
    s_mov_b32 s96, 0
    s_branch L_pollok4
L_tagslow:
    s_sub_u32 s96, s96, 1
    s_cbranch_scc1 L_taggiveup
    s_sleep 2
    buffer_load_dword v0, off, s[88:91], s93 sc1
    s_waitcnt vmcnt(0)
    v_readfirstlane_b32 s42, v0
    s_nop 0
    s_cmp_eq_u32 s42, s46
    s_cbranch_scc1 L_tagslow
    s_cmp_eq_u32 s42, 0
    s_cbranch_scc1 L_tagslow
    s_branch L_tagok
L_taggiveup:
    s_mov_b32 s96, 0
    s_branch L_tagok
L_slow:
    s_waitcnt vmcnt(0) lgkmcnt(0)
    s_nop 15
    v_accvgpr_write_b32 a0, 0
    v_accvgpr_write_b32 a1, 0
    v_accvgpr_write_b32 a2, 0
    v_accvgpr_write_b32 a3, 0
    v_accvgpr_write_b32 a4, 0
    v_accvgpr_write_b32 a5, 0
    v_accvgpr_write_b32 a6, 0
    v_accvgpr_write_b32 a7, 0
    v_accvgpr_write_b32 a8, 0
    v_accvgpr_write_b32 a9, 0
    v_accvgpr_write_b32 a10, 0
    v_accvgpr_write_b32 a11, 0
    v_accvgpr_write_b32 a12, 0
    v_accvgpr_write_b32 a13, 0
    v_accvgpr_write_b32 a14, 0
    v_accvgpr_write_b32 a15, 0
    v_accvgpr_write_b32 a16, 0
    v_accvgpr_write_b32 a17, 0
    v_accvgpr_write_b32 a18, 0
    v_accvgpr_write_b32 a19, 0
    v_accvgpr_write_b32 a20, 0
    v_accvgpr_write_b32 a21, 0
    v_accvgpr_write_b32 a22, 0
    v_accvgpr_write_b32 a23, 0
    v_accvgpr_write_b32 a24, 0
    v_accvgpr_write_b32 a25, 0
    v_accvgpr_write_b32 a26, 0
    v_accvgpr_write_b32 a27, 0
    v_accvgpr_write_b32 a28, 0
    v_accvgpr_write_b32 a29, 0
    v_accvgpr_write_b32 a30, 0
    v_accvgpr_write_b32 a31, 0
    v_accvgpr_write_b32 a32, 0
    v_accvgpr_write_b32 a33, 0
    v_accvgpr_write_b32 a34, 0
    v_accvgpr_write_b32 a35, 0
    v_accvgpr_write_b32 a36, 0
    v_accvgpr_write_b32 a37, 0
    v_accvgpr_write_b32 a38, 0
    v_accvgpr_write_b32 a39, 0
    v_accvgpr_write_b32 a40, 0
    v_accvgpr_write_b32 a41, 0
    v_accvgpr_write_b32 a42, 0
    v_accvgpr_write_b32 a43, 0
    v_accvgpr_write_b32 a44, 0
    v_accvgpr_write_b32 a45, 0
    v_accvgpr_write_b32 a46, 0
    v_accvgpr_write_b32 a47, 0
    v_accvgpr_write_b32 a48, 0
    v_accvgpr_write_b32 a49, 0
    v_accvgpr_write_b32 a50, 0
    v_accvgpr_write_b32 a51, 0
    v_accvgpr_write_b32 a52, 0
    v_accvgpr_write_b32 a53, 0
    v_accvgpr_write_b32 a54, 0
    v_accvgpr_write_b32 a55, 0
    v_accvgpr_write_b32 a56, 0
    v_accvgpr_write_b32 a57, 0
    v_accvgpr_write_b32 a58, 0
    v_accvgpr_write_b32 a59, 0
    v_accvgpr_write_b32 a60, 0
    v_accvgpr_write_b32 a61, 0
    v_accvgpr_write_b32 a62, 0
    v_accvgpr_write_b32 a63, 0
    v_accvgpr_write_b32 a64, 0
    v_accvgpr_write_b32 a65, 0
    v_accvgpr_write_b32 a66, 0
    v_accvgpr_write_b32 a67, 0
    v_accvgpr_write_b32 a68, 0
    v_accvgpr_write_b32 a69, 0
    v_accvgpr_write_b32 a70, 0
    v_accvgpr_write_b32 a71, 0
    v_accvgpr_write_b32 a72, 0
    v_accvgpr_write_b32 a73, 0
    v_accvgpr_write_b32 a74, 0
    v_accvgpr_write_b32 a75, 0
    v_accvgpr_write_b32 a76, 0
    v_accvgpr_write_b32 a77, 0
    v_accvgpr_write_b32 a78, 0
    v_accvgpr_write_b32 a79, 0
    v_accvgpr_write_b32 a80, 0
    v_accvgpr_write_b32 a81, 0
    v_accvgpr_write_b32 a82, 0
    v_accvgpr_write_b32 a83, 0
    v_accvgpr_write_b32 a84, 0
    v_accvgpr_write_b32 a85, 0
    v_accvgpr_write_b32 a86, 0
    v_accvgpr_write_b32 a87, 0
    v_accvgpr_write_b32 a88, 0
    v_accvgpr_write_b32 a89, 0
    v_accvgpr_write_b32 a90, 0
    v_accvgpr_write_b32 a91, 0
    v_accvgpr_write_b32 a92, 0
    v_accvgpr_write_b32 a93, 0
    v_accvgpr_write_b32 a94, 0
    v_accvgpr_write_b32 a95, 0
    v_accvgpr_write_b32 a96, 0
    v_accvgpr_write_b32 a97, 0
    v_accvgpr_write_b32 a98, 0
    v_accvgpr_write_b32 a99, 0
    v_accvgpr_write_b32 a100, 0
    v_accvgpr_write_b32 a101, 0
    v_accvgpr_write_b32 a102, 0
    v_accvgpr_write_b32 a103, 0
    v_accvgpr_write_b32 a104, 0
    v_accvgpr_write_b32 a105, 0
    v_accvgpr_write_b32 a106, 0
    v_accvgpr_write_b32 a107, 0
    v_accvgpr_write_b32 a108, 0
    v_accvgpr_write_b32 a109, 0
    v_accvgpr_write_b32 a110, 0
    v_accvgpr_write_b32 a111, 0
    v_accvgpr_write_b32 a112, 0
    v_accvgpr_write_b32 a113, 0
    v_accvgpr_write_b32 a114, 0
    v_accvgpr_write_b32 a115, 0
    v_accvgpr_write_b32 a116, 0
    v_accvgpr_write_b32 a117, 0
    v_accvgpr_write_b32 a118, 0
    v_accvgpr_write_b32 a119, 0
    v_accvgpr_write_b32 a120, 0
    v_accvgpr_write_b32 a121, 0
    v_accvgpr_write_b32 a122, 0
    v_accvgpr_write_b32 a123, 0
    v_accvgpr_write_b32 a124, 0
    v_accvgpr_write_b32 a125, 0
    v_accvgpr_write_b32 a126, 0
    v_accvgpr_write_b32 a127, 0
    v_accvgpr_write_b32 a128, 0
    v_accvgpr_write_b32 a129, 0
    v_accvgpr_write_b32 a130, 0
    v_accvgpr_write_b32 a131, 0
    v_accvgpr_write_b32 a132, 0
    v_accvgpr_write_b32 a133, 0
    v_accvgpr_write_b32 a134, 0
    v_accvgpr_write_b32 a135, 0
    v_accvgpr_write_b32 a136, 0
    v_accvgpr_write_b32 a137, 0
    v_accvgpr_write_b32 a138, 0
    v_accvgpr_write_b32 a139, 0
    v_accvgpr_write_b32 a140, 0
    v_accvgpr_write_b32 a141, 0
    v_accvgpr_write_b32 a142, 0
    v_accvgpr_write_b32 a143, 0
    v_accvgpr_write_b32 a144, 0
    v_accvgpr_write_b32 a145, 0
    v_accvgpr_write_b32 a146, 0
    v_accvgpr_write_b32 a147, 0
    v_accvgpr_write_b32 a148, 0
    v_accvgpr_write_b32 a149, 0
    v_accvgpr_write_b32 a150, 0
    v_accvgpr_write_b32 a151, 0
    v_accvgpr_write_b32 a152, 0
    v_accvgpr_write_b32 a153, 0
    v_accvgpr_write_b32 a154, 0
    v_accvgpr_write_b32 a155, 0
    v_accvgpr_write_b32 a156, 0
    v_accvgpr_write_b32 a157, 0
    v_accvgpr_write_b32 a158, 0
    v_accvgpr_write_b32 a159, 0
    v_accvgpr_write_b32 a160, 0
    v_accvgpr_write_b32 a161, 0
    v_accvgpr_write_b32 a162, 0
    v_accvgpr_write_b32 a163, 0
    v_accvgpr_write_b32 a164, 0
    v_accvgpr_write_b32 a165, 0
    v_accvgpr_write_b32 a166, 0
    v_accvgpr_write_b32 a167, 0
    v_accvgpr_write_b32 a168, 0
    v_accvgpr_write_b32 a169, 0
    v_accvgpr_write_b32 a170, 0
    v_accvgpr_write_b32 a171, 0
    v_accvgpr_write_b32 a172, 0
    v_accvgpr_write_b32 a173, 0
    v_accvgpr_write_b32 a174, 0
    v_accvgpr_write_b32 a175, 0
    v_accvgpr_write_b32 a176, 0
    v_accvgpr_write_b32 a177, 0
    v_accvgpr_write_b32 a178, 0
    v_accvgpr_write_b32 a179, 0
    v_accvgpr_write_b32 a180, 0
    v_accvgpr_write_b32 a181, 0
    v_accvgpr_write_b32 a182, 0
    v_accvgpr_write_b32 a183, 0
    v_accvgpr_write_b32 a184, 0
    v_accvgpr_write_b32 a185, 0
    v_accvgpr_write_b32 a186, 0
    v_accvgpr_write_b32 a187, 0
    v_accvgpr_write_b32 a188, 0
    v_accvgpr_write_b32 a189, 0
    v_accvgpr_write_b32 a190, 0
    v_accvgpr_write_b32 a191, 0
    v_mov_b32 v5, 0
    v_mov_b32 v240, 0xff7fffff
    v_mov_b32 v6, 0
    v_mov_b32 v241, 0xff7fffff
    v_mov_b32 v7, 0
    v_mov_b32 v242, 0xff7fffff
    v_mov_b32 v8, 0
    v_mov_b32 v243, 0xff7fffff
    v_subrev_u32 v244, 49152, v2
    v_subrev_u32 v245, 49152, v3
    v_subrev_u32 v246, 24576, v1
    s_mov_b32 s48, 0
L_slowloop:
    s_add_u32 s49, s48, 6144
    s_add_u32 s50, s48, 12288
    s_add_u32 s51, s48, 16384
    s_add_u32 s52, s48, 20480
    buffer_load_dwordx4 v[64:67], v244, s[4:7], s48 offen offset:0 sc1
    buffer_load_dwordx4 v[68:71], v245, s[4:7], s48 offen offset:0 sc1
    buffer_load_dwordx4 v[72:75], v244, s[4:7], s49 offen offset:0 sc1
    buffer_load_dwordx4 v[76:79], v245, s[4:7], s49 offen offset:0 sc1
    buffer_load_dwordx4 v[80:83], v244, s[4:7], s48 offen offset:128 sc1
    buffer_load_dwordx4 v[84:87], v245, s[4:7], s48 offen offset:128 sc1
    buffer_load_dwordx4 v[88:91], v244, s[4:7], s49 offen offset:128 sc1
    buffer_load_dwordx4 v[92:95], v245, s[4:7], s49 offen offset:128 sc1
    buffer_load_dwordx4 v[96:99], v244, s[4:7], s48 offen offset:256 sc1
    buffer_load_dwordx4 v[100:103], v245, s[4:7], s48 offen offset:256 sc1
    buffer_load_dwordx4 v[104:107], v244, s[4:7], s49 offen offset:256 sc1
    buffer_load_dwordx4 v[108:111], v245, s[4:7], s49 offen offset:256 sc1
    buffer_load_dwordx4 v[112:115], v246, s[4:7], s50 offen offset:0 sc1
    buffer_load_dwordx4 v[116:119], v246, s[4:7], s50 offen offset:1024 sc1
    buffer_load_dwordx4 v[120:123], v246, s[4:7], s50 offen offset:2048 sc1
    buffer_load_dwordx4 v[124:127], v246, s[4:7], s50 offen offset:3072 sc1
    buffer_load_dwordx4 v[128:131], v246, s[4:7], s51 offen offset:0 sc1
    buffer_load_dwordx4 v[132:135], v246, s[4:7], s51 offen offset:1024 sc1
    buffer_load_dwordx4 v[136:139], v246, s[4:7], s51 offen offset:2048 sc1
    buffer_load_dwordx4 v[140:143], v246, s[4:7], s51 offen offset:3072 sc1
    buffer_load_dwordx4 v[144:147], v246, s[4:7], s52 offen offset:0 sc1
    buffer_load_dwordx4 v[148:151], v246, s[4:7], s52 offen offset:1024 sc1
    buffer_load_dwordx4 v[152:155], v246, s[4:7], s52 offen offset:2048 sc1
    buffer_load_dwordx4 v[156:159], v246, s[4:7], s52 offen offset:3072 sc1
    s_waitcnt vmcnt(12)
    v_mfma_f32_16x16x32_bf16 v[160:163], v[64:67], a[192:195], 0
    v_mfma_f32_16x16x32_bf16 v[168:171], v[64:67], a[216:219], 0
    v_mfma_f32_16x16x32_bf16 v[176:179], v[64:67], a[240:243], 0
    v_mfma_f32_16x16x32_bf16 v[184:187], v[64:67], v[200:203], 0
    v_mfma_f32_16x16x32_bf16 v[160:163], v[68:71], a[196:199], v[160:163]
    v_mfma_f32_16x16x32_bf16 v[168:171], v[68:71], a[220:223], v[168:171]
    v_mfma_f32_16x16x32_bf16 v[176:179], v[68:71], a[244:247], v[176:179]
    v_mfma_f32_16x16x32_bf16 v[184:187], v[68:71], v[204:207], v[184:187]
    v_mfma_f32_16x16x32_bf16 v[164:167], v[72:75], a[192:195], 0
    v_mfma_f32_16x16x32_bf16 v[172:175], v[72:75], a[216:219], 0
    v_mfma_f32_16x16x32_bf16 v[180:183], v[72:75], a[240:243], 0
    v_mfma_f32_16x16x32_bf16 v[188:191], v[72:75], v[200:203], 0
    v_mfma_f32_16x16x32_bf16 v[164:167], v[76:79], a[196:199], v[164:167]
    v_mfma_f32_16x16x32_bf16 v[172:175], v[76:79], a[220:223], v[172:175]
    v_mfma_f32_16x16x32_bf16 v[180:183], v[76:79], a[244:247], v[180:183]
    v_mfma_f32_16x16x32_bf16 v[188:191], v[76:79], v[204:207], v[188:191]
    v_mfma_f32_16x16x32_bf16 v[160:163], v[80:83], a[200:203], v[160:163]
    v_mfma_f32_16x16x32_bf16 v[168:171], v[80:83], a[224:227], v[168:171]
    v_mfma_f32_16x16x32_bf16 v[176:179], v[80:83], a[248:251], v[176:179]
    v_mfma_f32_16x16x32_bf16 v[184:187], v[80:83], v[208:211], v[184:187]
    v_mfma_f32_16x16x32_bf16 v[160:163], v[84:87], a[204:207], v[160:163]
    v_mfma_f32_16x16x32_bf16 v[168:171], v[84:87], a[228:231], v[168:171]
    v_mfma_f32_16x16x32_bf16 v[176:179], v[84:87], a[252:255], v[176:179]
    v_mfma_f32_16x16x32_bf16 v[184:187], v[84:87], v[212:215], v[184:187]
    v_mfma_f32_16x16x32_bf16 v[164:167], v[88:91], a[200:203], v[164:167]
    v_mfma_f32_16x16x32_bf16 v[172:175], v[88:91], a[224:227], v[172:175]
    v_mfma_f32_16x16x32_bf16 v[180:183], v[88:91], a[248:251], v[180:183]
    v_mfma_f32_16x16x32_bf16 v[188:191], v[88:91], v[208:211], v[188:191]
    v_mfma_f32_16x16x32_bf16 v[164:167], v[92:95], a[204:207], v[164:167]
    v_mfma_f32_16x16x32_bf16 v[172:175], v[92:95], a[228:231], v[172:175]
    v_mfma_f32_16x16x32_bf16 v[180:183], v[92:95], a[252:255], v[180:183]
    v_mfma_f32_16x16x32_bf16 v[188:191], v[92:95], v[212:215], v[188:191]
    v_mfma_f32_16x16x32_bf16 v[160:163], v[96:99], a[208:211], v[160:163]
    v_mfma_f32_16x16x32_bf16 v[168:171], v[96:99], a[232:235], v[168:171]
    v_mfma_f32_16x16x32_bf16 v[176:179], v[96:99], v[192:195], v[176:179]
    v_mfma_f32_16x16x32_bf16 v[184:187], v[96:99], v[216:219], v[184:187]
    v_mfma_f32_16x16x32_bf16 v[160:163], v[100:103], a[212:215], v[160:163]
    v_mfma_f32_16x16x32_bf16 v[168:171], v[100:103], a[236:239], v[168:171]
    v_mfma_f32_16x16x32_bf16 v[176:179], v[100:103], v[196:199], v[176:179]
    v_mfma_f32_16x16x32_bf16 v[184:187], v[100:103], v[220:223], v[184:187]
    v_mfma_f32_16x16x32_bf16 v[164:167], v[104:107], a[208:211], v[164:167]
    v_mfma_f32_16x16x32_bf16 v[172:175], v[104:107], a[232:235], v[172:175]
    v_mfma_f32_16x16x32_bf16 v[180:183], v[104:107], v[192:195], v[180:183]
    v_mfma_f32_16x16x32_bf16 v[188:191], v[104:107], v[216:219], v[188:191]
    v_mfma_f32_16x16x32_bf16 v[164:167], v[108:111], a[212:215], v[164:167]
    v_mfma_f32_16x16x32_bf16 v[172:175], v[108:111], a[236:239], v[172:175]
    v_mfma_f32_16x16x32_bf16 v[180:183], v[108:111], v[196:199], v[180:183]
    v_mfma_f32_16x16x32_bf16 v[188:191], v[108:111], v[220:223], v[188:191]
    s_nop 9
    v_max3_f32 v16, v160, v161, v162
    v_max3_f32 v16, v16, v163, v164
    v_max3_f32 v16, v16, v165, v166
    v_max3_f32 v16, v16, v167, v240
    v_mov_b32 v17, v16
    s_nop 1
    v_permlane16_swap_b32 v16, v17
    s_nop 1
    v_max_f32 v16, v16, v17
    v_mov_b32 v17, v16
    s_nop 1
    v_permlane32_swap_b32 v16, v17
    s_nop 1
    v_max_f32 v16, v16, v17
    v_sub_f32 v17, v240, v16
    v_exp_f32 v17, v17
    v_mov_b32 v240, v16
    v_sub_f32 v160, v160, v16
    v_sub_f32 v161, v161, v16
    v_sub_f32 v162, v162, v16
    v_sub_f32 v163, v163, v16
    v_sub_f32 v164, v164, v16
    v_sub_f32 v165, v165, v16
    v_sub_f32 v166, v166, v16
    v_sub_f32 v167, v167, v16
    v_exp_f32 v160, v160
    v_exp_f32 v161, v161
    v_exp_f32 v162, v162
    v_exp_f32 v163, v163
    v_exp_f32 v164, v164
    v_exp_f32 v165, v165
    v_exp_f32 v166, v166
    v_exp_f32 v167, v167
    v_mul_f32 v5, v5, v17
    v_add_f32 v5, v5, v160
    v_add_f32 v5, v5, v161
    v_add_f32 v5, v5, v162
    v_add_f32 v5, v5, v163
    v_add_f32 v5, v5, v164
    v_add_f32 v5, v5, v165
    v_add_f32 v5, v5, v166
    v_add_f32 v5, v5, v167
    v_cvt_pk_bf16_f32 v224, v160, v161
    v_cvt_pk_bf16_f32 v225, v162, v163
    v_cvt_pk_bf16_f32 v226, v164, v165
    v_cvt_pk_bf16_f32 v227, v166, v167
    ds_bpermute_b32 v248, v58, v17 offset:0
    ds_bpermute_b32 v249, v58, v17 offset:4
    ds_bpermute_b32 v250, v58, v17 offset:8
    ds_bpermute_b32 v251, v58, v17 offset:12
    s_waitcnt lgkmcnt(0)
    v_accvgpr_read_b32 v18, a0
    v_mul_f32 v18, v18, v248
    v_accvgpr_write_b32 a0, v18
    v_accvgpr_read_b32 v19, a1
    v_mul_f32 v19, v19, v249
    v_accvgpr_write_b32 a1, v19
    v_accvgpr_read_b32 v18, a2
    v_mul_f32 v18, v18, v250
    v_accvgpr_write_b32 a2, v18
    v_accvgpr_read_b32 v19, a3
    v_mul_f32 v19, v19, v251
    v_accvgpr_write_b32 a3, v19
    v_accvgpr_read_b32 v18, a4
    v_mul_f32 v18, v18, v248
    v_accvgpr_write_b32 a4, v18
    v_accvgpr_read_b32 v19, a5
    v_mul_f32 v19, v19, v249
    v_accvgpr_write_b32 a5, v19
    v_accvgpr_read_b32 v18, a6
    v_mul_f32 v18, v18, v250
    v_accvgpr_write_b32 a6, v18
    v_accvgpr_read_b32 v19, a7
    v_mul_f32 v19, v19, v251
    v_accvgpr_write_b32 a7, v19
    v_accvgpr_read_b32 v18, a8
    v_mul_f32 v18, v18, v248
    v_accvgpr_write_b32 a8, v18
    v_accvgpr_read_b32 v19, a9
    v_mul_f32 v19, v19, v249
    v_accvgpr_write_b32 a9, v19
    v_accvgpr_read_b32 v18, a10
    v_mul_f32 v18, v18, v250
    v_accvgpr_write_b32 a10, v18
    v_accvgpr_read_b32 v19, a11
    v_mul_f32 v19, v19, v251
    v_accvgpr_write_b32 a11, v19
    v_accvgpr_read_b32 v18, a12
    v_mul_f32 v18, v18, v248
    v_accvgpr_write_b32 a12, v18
    v_accvgpr_read_b32 v19, a13
    v_mul_f32 v19, v19, v249
    v_accvgpr_write_b32 a13, v19
    v_accvgpr_read_b32 v18, a14
    v_mul_f32 v18, v18, v250
    v_accvgpr_write_b32 a14, v18
    v_accvgpr_read_b32 v19, a15
    v_mul_f32 v19, v19, v251
    v_accvgpr_write_b32 a15, v19
    v_accvgpr_read_b32 v18, a16
    v_mul_f32 v18, v18, v248
    v_accvgpr_write_b32 a16, v18
    v_accvgpr_read_b32 v19, a17
    v_mul_f32 v19, v19, v249
    v_accvgpr_write_b32 a17, v19
    v_accvgpr_read_b32 v18, a18
    v_mul_f32 v18, v18, v250
    v_accvgpr_write_b32 a18, v18
    v_accvgpr_read_b32 v19, a19
    v_mul_f32 v19, v19, v251
    v_accvgpr_write_b32 a19, v19
    v_accvgpr_read_b32 v18, a20
    v_mul_f32 v18, v18, v248
    v_accvgpr_write_b32 a20, v18
    v_accvgpr_read_b32 v19, a21
    v_mul_f32 v19, v19, v249
    v_accvgpr_write_b32 a21, v19
    v_accvgpr_read_b32 v18, a22
    v_mul_f32 v18, v18, v250
    v_accvgpr_write_b32 a22, v18
    v_accvgpr_read_b32 v19, a23
    v_mul_f32 v19, v19, v251
    v_accvgpr_write_b32 a23, v19
    v_accvgpr_read_b32 v18, a24
    v_mul_f32 v18, v18, v248
    v_accvgpr_write_b32 a24, v18
    v_accvgpr_read_b32 v19, a25
    v_mul_f32 v19, v19, v249
    v_accvgpr_write_b32 a25, v19
    v_accvgpr_read_b32 v18, a26
    v_mul_f32 v18, v18, v250
    v_accvgpr_write_b32 a26, v18
    v_accvgpr_read_b32 v19, a27
    v_mul_f32 v19, v19, v251
    v_accvgpr_write_b32 a27, v19
    v_accvgpr_read_b32 v18, a28
    v_mul_f32 v18, v18, v248
    v_accvgpr_write_b32 a28, v18
    v_accvgpr_read_b32 v19, a29
    v_mul_f32 v19, v19, v249
    v_accvgpr_write_b32 a29, v19
    v_accvgpr_read_b32 v18, a30
    v_mul_f32 v18, v18, v250
    v_accvgpr_write_b32 a30, v18
    v_accvgpr_read_b32 v19, a31
    v_mul_f32 v19, v19, v251
    v_accvgpr_write_b32 a31, v19
    v_accvgpr_read_b32 v18, a32
    v_mul_f32 v18, v18, v248
    v_accvgpr_write_b32 a32, v18
    v_accvgpr_read_b32 v19, a33
    v_mul_f32 v19, v19, v249
    v_accvgpr_write_b32 a33, v19
    v_accvgpr_read_b32 v18, a34
    v_mul_f32 v18, v18, v250
    v_accvgpr_write_b32 a34, v18
    v_accvgpr_read_b32 v19, a35
    v_mul_f32 v19, v19, v251
    v_accvgpr_write_b32 a35, v19
    v_accvgpr_read_b32 v18, a36
    v_mul_f32 v18, v18, v248
    v_accvgpr_write_b32 a36, v18
    v_accvgpr_read_b32 v19, a37
    v_mul_f32 v19, v19, v249
    v_accvgpr_write_b32 a37, v19
    v_accvgpr_read_b32 v18, a38
    v_mul_f32 v18, v18, v250
    v_accvgpr_write_b32 a38, v18
    v_accvgpr_read_b32 v19, a39
    v_mul_f32 v19, v19, v251
    v_accvgpr_write_b32 a39, v19
    v_accvgpr_read_b32 v18, a40
    v_mul_f32 v18, v18, v248
    v_accvgpr_write_b32 a40, v18
    v_accvgpr_read_b32 v19, a41
    v_mul_f32 v19, v19, v249
    v_accvgpr_write_b32 a41, v19
    v_accvgpr_read_b32 v18, a42
    v_mul_f32 v18, v18, v250
    v_accvgpr_write_b32 a42, v18
    v_accvgpr_read_b32 v19, a43
    v_mul_f32 v19, v19, v251
    v_accvgpr_write_b32 a43, v19
    v_accvgpr_read_b32 v18, a44
    v_mul_f32 v18, v18, v248
    v_accvgpr_write_b32 a44, v18
    v_accvgpr_read_b32 v19, a45
    v_mul_f32 v19, v19, v249
    v_accvgpr_write_b32 a45, v19
    v_accvgpr_read_b32 v18, a46
    v_mul_f32 v18, v18, v250
    v_accvgpr_write_b32 a46, v18
    v_accvgpr_read_b32 v19, a47
    v_mul_f32 v19, v19, v251
    v_accvgpr_write_b32 a47, v19
    v_max3_f32 v16, v168, v169, v170
    v_max3_f32 v16, v16, v171, v172
    v_max3_f32 v16, v16, v173, v174
    v_max3_f32 v16, v16, v175, v241
    v_mov_b32 v17, v16
    s_nop 1
    v_permlane16_swap_b32 v16, v17
    s_nop 1
    v_max_f32 v16, v16, v17
    v_mov_b32 v17, v16
    s_nop 1
    v_permlane32_swap_b32 v16, v17
    s_nop 1
    v_max_f32 v16, v16, v17
    v_sub_f32 v17, v241, v16
    v_exp_f32 v17, v17
    v_mov_b32 v241, v16
    v_sub_f32 v168, v168, v16
    v_sub_f32 v169, v169, v16
    v_sub_f32 v170, v170, v16
    v_sub_f32 v171, v171, v16
    v_sub_f32 v172, v172, v16
    v_sub_f32 v173, v173, v16
    v_sub_f32 v174, v174, v16
    v_sub_f32 v175, v175, v16
    v_exp_f32 v168, v168
    v_exp_f32 v169, v169
    v_exp_f32 v170, v170
    v_exp_f32 v171, v171
    v_exp_f32 v172, v172
    v_exp_f32 v173, v173
    v_exp_f32 v174, v174
    v_exp_f32 v175, v175
    v_mul_f32 v6, v6, v17
    v_add_f32 v6, v6, v168
    v_add_f32 v6, v6, v169
    v_add_f32 v6, v6, v170
    v_add_f32 v6, v6, v171
    v_add_f32 v6, v6, v172
    v_add_f32 v6, v6, v173
    v_add_f32 v6, v6, v174
    v_add_f32 v6, v6, v175
    v_cvt_pk_bf16_f32 v228, v168, v169
    v_cvt_pk_bf16_f32 v229, v170, v171
    v_cvt_pk_bf16_f32 v230, v172, v173
    v_cvt_pk_bf16_f32 v231, v174, v175
    ds_bpermute_b32 v248, v58, v17 offset:0
    ds_bpermute_b32 v249, v58, v17 offset:4
    ds_bpermute_b32 v250, v58, v17 offset:8
    ds_bpermute_b32 v251, v58, v17 offset:12
    s_waitcnt lgkmcnt(0)
    v_accvgpr_read_b32 v18, a48
    v_mul_f32 v18, v18, v248
    v_accvgpr_write_b32 a48, v18
    v_accvgpr_read_b32 v19, a49
    v_mul_f32 v19, v19, v249
    v_accvgpr_write_b32 a49, v19
    v_accvgpr_read_b32 v18, a50
    v_mul_f32 v18, v18, v250
    v_accvgpr_write_b32 a50, v18
    v_accvgpr_read_b32 v19, a51
    v_mul_f32 v19, v19, v251
    v_accvgpr_write_b32 a51, v19
    v_accvgpr_read_b32 v18, a52
    v_mul_f32 v18, v18, v248
    v_accvgpr_write_b32 a52, v18
    v_accvgpr_read_b32 v19, a53
    v_mul_f32 v19, v19, v249
    v_accvgpr_write_b32 a53, v19
    v_accvgpr_read_b32 v18, a54
    v_mul_f32 v18, v18, v250
    v_accvgpr_write_b32 a54, v18
    v_accvgpr_read_b32 v19, a55
    v_mul_f32 v19, v19, v251
    v_accvgpr_write_b32 a55, v19
    v_accvgpr_read_b32 v18, a56
    v_mul_f32 v18, v18, v248
    v_accvgpr_write_b32 a56, v18
    v_accvgpr_read_b32 v19, a57
    v_mul_f32 v19, v19, v249
    v_accvgpr_write_b32 a57, v19
    v_accvgpr_read_b32 v18, a58
    v_mul_f32 v18, v18, v250
    v_accvgpr_write_b32 a58, v18
    v_accvgpr_read_b32 v19, a59
    v_mul_f32 v19, v19, v251
    v_accvgpr_write_b32 a59, v19
    v_accvgpr_read_b32 v18, a60
    v_mul_f32 v18, v18, v248
    v_accvgpr_write_b32 a60, v18
    v_accvgpr_read_b32 v19, a61
    v_mul_f32 v19, v19, v249
    v_accvgpr_write_b32 a61, v19
    v_accvgpr_read_b32 v18, a62
    v_mul_f32 v18, v18, v250
    v_accvgpr_write_b32 a62, v18
    v_accvgpr_read_b32 v19, a63
    v_mul_f32 v19, v19, v251
    v_accvgpr_write_b32 a63, v19
    v_accvgpr_read_b32 v18, a64
    v_mul_f32 v18, v18, v248
    v_accvgpr_write_b32 a64, v18
    v_accvgpr_read_b32 v19, a65
    v_mul_f32 v19, v19, v249
    v_accvgpr_write_b32 a65, v19
    v_accvgpr_read_b32 v18, a66
    v_mul_f32 v18, v18, v250
    v_accvgpr_write_b32 a66, v18
    v_accvgpr_read_b32 v19, a67
    v_mul_f32 v19, v19, v251
    v_accvgpr_write_b32 a67, v19
    v_accvgpr_read_b32 v18, a68
    v_mul_f32 v18, v18, v248
    v_accvgpr_write_b32 a68, v18
    v_accvgpr_read_b32 v19, a69
    v_mul_f32 v19, v19, v249
    v_accvgpr_write_b32 a69, v19
    v_accvgpr_read_b32 v18, a70
    v_mul_f32 v18, v18, v250
    v_accvgpr_write_b32 a70, v18
    v_accvgpr_read_b32 v19, a71
    v_mul_f32 v19, v19, v251
    v_accvgpr_write_b32 a71, v19
    v_accvgpr_read_b32 v18, a72
    v_mul_f32 v18, v18, v248
    v_accvgpr_write_b32 a72, v18
    v_accvgpr_read_b32 v19, a73
    v_mul_f32 v19, v19, v249
    v_accvgpr_write_b32 a73, v19
    v_accvgpr_read_b32 v18, a74
    v_mul_f32 v18, v18, v250
    v_accvgpr_write_b32 a74, v18
    v_accvgpr_read_b32 v19, a75
    v_mul_f32 v19, v19, v251
    v_accvgpr_write_b32 a75, v19
    v_accvgpr_read_b32 v18, a76
    v_mul_f32 v18, v18, v248
    v_accvgpr_write_b32 a76, v18
    v_accvgpr_read_b32 v19, a77
    v_mul_f32 v19, v19, v249
    v_accvgpr_write_b32 a77, v19
    v_accvgpr_read_b32 v18, a78
    v_mul_f32 v18, v18, v250
    v_accvgpr_write_b32 a78, v18
    v_accvgpr_read_b32 v19, a79
    v_mul_f32 v19, v19, v251
    v_accvgpr_write_b32 a79, v19
    v_accvgpr_read_b32 v18, a80
    v_mul_f32 v18, v18, v248
    v_accvgpr_write_b32 a80, v18
    v_accvgpr_read_b32 v19, a81
    v_mul_f32 v19, v19, v249
    v_accvgpr_write_b32 a81, v19
    v_accvgpr_read_b32 v18, a82
    v_mul_f32 v18, v18, v250
    v_accvgpr_write_b32 a82, v18
    v_accvgpr_read_b32 v19, a83
    v_mul_f32 v19, v19, v251
    v_accvgpr_write_b32 a83, v19
    v_accvgpr_read_b32 v18, a84
    v_mul_f32 v18, v18, v248
    v_accvgpr_write_b32 a84, v18
    v_accvgpr_read_b32 v19, a85
    v_mul_f32 v19, v19, v249
    v_accvgpr_write_b32 a85, v19
    v_accvgpr_read_b32 v18, a86
    v_mul_f32 v18, v18, v250
    v_accvgpr_write_b32 a86, v18
    v_accvgpr_read_b32 v19, a87
    v_mul_f32 v19, v19, v251
    v_accvgpr_write_b32 a87, v19
    v_accvgpr_read_b32 v18, a88
    v_mul_f32 v18, v18, v248
    v_accvgpr_write_b32 a88, v18
    v_accvgpr_read_b32 v19, a89
    v_mul_f32 v19, v19, v249
    v_accvgpr_write_b32 a89, v19
    v_accvgpr_read_b32 v18, a90
    v_mul_f32 v18, v18, v250
    v_accvgpr_write_b32 a90, v18
    v_accvgpr_read_b32 v19, a91
    v_mul_f32 v19, v19, v251
    v_accvgpr_write_b32 a91, v19
    v_accvgpr_read_b32 v18, a92
    v_mul_f32 v18, v18, v248
    v_accvgpr_write_b32 a92, v18
    v_accvgpr_read_b32 v19, a93
    v_mul_f32 v19, v19, v249
    v_accvgpr_write_b32 a93, v19
    v_accvgpr_read_b32 v18, a94
    v_mul_f32 v18, v18, v250
    v_accvgpr_write_b32 a94, v18
    v_accvgpr_read_b32 v19, a95
    v_mul_f32 v19, v19, v251
    v_accvgpr_write_b32 a95, v19
    v_max3_f32 v16, v176, v177, v178
    v_max3_f32 v16, v16, v179, v180
    v_max3_f32 v16, v16, v181, v182
    v_max3_f32 v16, v16, v183, v242
    v_mov_b32 v17, v16
    s_nop 1
    v_permlane16_swap_b32 v16, v17
    s_nop 1
    v_max_f32 v16, v16, v17
    v_mov_b32 v17, v16
    s_nop 1
    v_permlane32_swap_b32 v16, v17
    s_nop 1
    v_max_f32 v16, v16, v17
    v_sub_f32 v17, v242, v16
    v_exp_f32 v17, v17
    v_mov_b32 v242, v16
    v_sub_f32 v176, v176, v16
    v_sub_f32 v177, v177, v16
    v_sub_f32 v178, v178, v16
    v_sub_f32 v179, v179, v16
    v_sub_f32 v180, v180, v16
    v_sub_f32 v181, v181, v16
    v_sub_f32 v182, v182, v16
    v_sub_f32 v183, v183, v16
    v_exp_f32 v176, v176
    v_exp_f32 v177, v177
    v_exp_f32 v178, v178
    v_exp_f32 v179, v179
    v_exp_f32 v180, v180
    v_exp_f32 v181, v181
    v_exp_f32 v182, v182
    v_exp_f32 v183, v183
    v_mul_f32 v7, v7, v17
    v_add_f32 v7, v7, v176
    v_add_f32 v7, v7, v177
    v_add_f32 v7, v7, v178
    v_add_f32 v7, v7, v179
    v_add_f32 v7, v7, v180
    v_add_f32 v7, v7, v181
    v_add_f32 v7, v7, v182
    v_add_f32 v7, v7, v183
    v_cvt_pk_bf16_f32 v232, v176, v177
    v_cvt_pk_bf16_f32 v233, v178, v179
    v_cvt_pk_bf16_f32 v234, v180, v181
    v_cvt_pk_bf16_f32 v235, v182, v183
    ds_bpermute_b32 v248, v58, v17 offset:0
    ds_bpermute_b32 v249, v58, v17 offset:4
    ds_bpermute_b32 v250, v58, v17 offset:8
    ds_bpermute_b32 v251, v58, v17 offset:12
    s_waitcnt lgkmcnt(0)
    v_accvgpr_read_b32 v18, a96
    v_mul_f32 v18, v18, v248
    v_accvgpr_write_b32 a96, v18
    v_accvgpr_read_b32 v19, a97
    v_mul_f32 v19, v19, v249
    v_accvgpr_write_b32 a97, v19
    v_accvgpr_read_b32 v18, a98
    v_mul_f32 v18, v18, v250
    v_accvgpr_write_b32 a98, v18
    v_accvgpr_read_b32 v19, a99
    v_mul_f32 v19, v19, v251
    v_accvgpr_write_b32 a99, v19
    v_accvgpr_read_b32 v18, a100
    v_mul_f32 v18, v18, v248
    v_accvgpr_write_b32 a100, v18
    v_accvgpr_read_b32 v19, a101
    v_mul_f32 v19, v19, v249
    v_accvgpr_write_b32 a101, v19
    v_accvgpr_read_b32 v18, a102
    v_mul_f32 v18, v18, v250
    v_accvgpr_write_b32 a102, v18
    v_accvgpr_read_b32 v19, a103
    v_mul_f32 v19, v19, v251
    v_accvgpr_write_b32 a103, v19
    v_accvgpr_read_b32 v18, a104
    v_mul_f32 v18, v18, v248
    v_accvgpr_write_b32 a104, v18
    v_accvgpr_read_b32 v19, a105
    v_mul_f32 v19, v19, v249
    v_accvgpr_write_b32 a105, v19
    v_accvgpr_read_b32 v18, a106
    v_mul_f32 v18, v18, v250
    v_accvgpr_write_b32 a106, v18
    v_accvgpr_read_b32 v19, a107
    v_mul_f32 v19, v19, v251
    v_accvgpr_write_b32 a107, v19
    v_accvgpr_read_b32 v18, a108
    v_mul_f32 v18, v18, v248
    v_accvgpr_write_b32 a108, v18
    v_accvgpr_read_b32 v19, a109
    v_mul_f32 v19, v19, v249
    v_accvgpr_write_b32 a109, v19
    v_accvgpr_read_b32 v18, a110
    v_mul_f32 v18, v18, v250
    v_accvgpr_write_b32 a110, v18
    v_accvgpr_read_b32 v19, a111
    v_mul_f32 v19, v19, v251
    v_accvgpr_write_b32 a111, v19
    v_accvgpr_read_b32 v18, a112
    v_mul_f32 v18, v18, v248
    v_accvgpr_write_b32 a112, v18
    v_accvgpr_read_b32 v19, a113
    v_mul_f32 v19, v19, v249
    v_accvgpr_write_b32 a113, v19
    v_accvgpr_read_b32 v18, a114
    v_mul_f32 v18, v18, v250
    v_accvgpr_write_b32 a114, v18
    v_accvgpr_read_b32 v19, a115
    v_mul_f32 v19, v19, v251
    v_accvgpr_write_b32 a115, v19
    v_accvgpr_read_b32 v18, a116
    v_mul_f32 v18, v18, v248
    v_accvgpr_write_b32 a116, v18
    v_accvgpr_read_b32 v19, a117
    v_mul_f32 v19, v19, v249
    v_accvgpr_write_b32 a117, v19
    v_accvgpr_read_b32 v18, a118
    v_mul_f32 v18, v18, v250
    v_accvgpr_write_b32 a118, v18
    v_accvgpr_read_b32 v19, a119
    v_mul_f32 v19, v19, v251
    v_accvgpr_write_b32 a119, v19
    v_accvgpr_read_b32 v18, a120
    v_mul_f32 v18, v18, v248
    v_accvgpr_write_b32 a120, v18
    v_accvgpr_read_b32 v19, a121
    v_mul_f32 v19, v19, v249
    v_accvgpr_write_b32 a121, v19
    v_accvgpr_read_b32 v18, a122
    v_mul_f32 v18, v18, v250
    v_accvgpr_write_b32 a122, v18
    v_accvgpr_read_b32 v19, a123
    v_mul_f32 v19, v19, v251
    v_accvgpr_write_b32 a123, v19
    v_accvgpr_read_b32 v18, a124
    v_mul_f32 v18, v18, v248
    v_accvgpr_write_b32 a124, v18
    v_accvgpr_read_b32 v19, a125
    v_mul_f32 v19, v19, v249
    v_accvgpr_write_b32 a125, v19
    v_accvgpr_read_b32 v18, a126
    v_mul_f32 v18, v18, v250
    v_accvgpr_write_b32 a126, v18
    v_accvgpr_read_b32 v19, a127
    v_mul_f32 v19, v19, v251
    v_accvgpr_write_b32 a127, v19
    v_accvgpr_read_b32 v18, a128
    v_mul_f32 v18, v18, v248
    v_accvgpr_write_b32 a128, v18
    v_accvgpr_read_b32 v19, a129
    v_mul_f32 v19, v19, v249
    v_accvgpr_write_b32 a129, v19
    v_accvgpr_read_b32 v18, a130
    v_mul_f32 v18, v18, v250
    v_accvgpr_write_b32 a130, v18
    v_accvgpr_read_b32 v19, a131
    v_mul_f32 v19, v19, v251
    v_accvgpr_write_b32 a131, v19
    v_accvgpr_read_b32 v18, a132
    v_mul_f32 v18, v18, v248
    v_accvgpr_write_b32 a132, v18
    v_accvgpr_read_b32 v19, a133
    v_mul_f32 v19, v19, v249
    v_accvgpr_write_b32 a133, v19
    v_accvgpr_read_b32 v18, a134
    v_mul_f32 v18, v18, v250
    v_accvgpr_write_b32 a134, v18
    v_accvgpr_read_b32 v19, a135
    v_mul_f32 v19, v19, v251
    v_accvgpr_write_b32 a135, v19
    v_accvgpr_read_b32 v18, a136
    v_mul_f32 v18, v18, v248
    v_accvgpr_write_b32 a136, v18
    v_accvgpr_read_b32 v19, a137
    v_mul_f32 v19, v19, v249
    v_accvgpr_write_b32 a137, v19
    v_accvgpr_read_b32 v18, a138
    v_mul_f32 v18, v18, v250
    v_accvgpr_write_b32 a138, v18
    v_accvgpr_read_b32 v19, a139
    v_mul_f32 v19, v19, v251
    v_accvgpr_write_b32 a139, v19
    v_accvgpr_read_b32 v18, a140
    v_mul_f32 v18, v18, v248
    v_accvgpr_write_b32 a140, v18
    v_accvgpr_read_b32 v19, a141
    v_mul_f32 v19, v19, v249
    v_accvgpr_write_b32 a141, v19
    v_accvgpr_read_b32 v18, a142
    v_mul_f32 v18, v18, v250
    v_accvgpr_write_b32 a142, v18
    v_accvgpr_read_b32 v19, a143
    v_mul_f32 v19, v19, v251
    v_accvgpr_write_b32 a143, v19
    v_max3_f32 v16, v184, v185, v186
    v_max3_f32 v16, v16, v187, v188
    v_max3_f32 v16, v16, v189, v190
    v_max3_f32 v16, v16, v191, v243
    v_mov_b32 v17, v16
    s_nop 1
    v_permlane16_swap_b32 v16, v17
    s_nop 1
    v_max_f32 v16, v16, v17
    v_mov_b32 v17, v16
    s_nop 1
    v_permlane32_swap_b32 v16, v17
    s_nop 1
    v_max_f32 v16, v16, v17
    v_sub_f32 v17, v243, v16
    v_exp_f32 v17, v17
    v_mov_b32 v243, v16
    v_sub_f32 v184, v184, v16
    v_sub_f32 v185, v185, v16
    v_sub_f32 v186, v186, v16
    v_sub_f32 v187, v187, v16
    v_sub_f32 v188, v188, v16
    v_sub_f32 v189, v189, v16
    v_sub_f32 v190, v190, v16
    v_sub_f32 v191, v191, v16
    v_exp_f32 v184, v184
    v_exp_f32 v185, v185
    v_exp_f32 v186, v186
    v_exp_f32 v187, v187
    v_exp_f32 v188, v188
    v_exp_f32 v189, v189
    v_exp_f32 v190, v190
    v_exp_f32 v191, v191
    v_mul_f32 v8, v8, v17
    v_add_f32 v8, v8, v184
    v_add_f32 v8, v8, v185
    v_add_f32 v8, v8, v186
    v_add_f32 v8, v8, v187
    v_add_f32 v8, v8, v188
    v_add_f32 v8, v8, v189
    v_add_f32 v8, v8, v190
    v_add_f32 v8, v8, v191
    v_cvt_pk_bf16_f32 v236, v184, v185
    v_cvt_pk_bf16_f32 v237, v186, v187
    v_cvt_pk_bf16_f32 v238, v188, v189
    v_cvt_pk_bf16_f32 v239, v190, v191
    ds_bpermute_b32 v248, v58, v17 offset:0
    ds_bpermute_b32 v249, v58, v17 offset:4
    ds_bpermute_b32 v250, v58, v17 offset:8
    ds_bpermute_b32 v251, v58, v17 offset:12
    s_waitcnt lgkmcnt(0)
    v_accvgpr_read_b32 v18, a144
    v_mul_f32 v18, v18, v248
    v_accvgpr_write_b32 a144, v18
    v_accvgpr_read_b32 v19, a145
    v_mul_f32 v19, v19, v249
    v_accvgpr_write_b32 a145, v19
    v_accvgpr_read_b32 v18, a146
    v_mul_f32 v18, v18, v250
    v_accvgpr_write_b32 a146, v18
    v_accvgpr_read_b32 v19, a147
    v_mul_f32 v19, v19, v251
    v_accvgpr_write_b32 a147, v19
    v_accvgpr_read_b32 v18, a148
    v_mul_f32 v18, v18, v248
    v_accvgpr_write_b32 a148, v18
    v_accvgpr_read_b32 v19, a149
    v_mul_f32 v19, v19, v249
    v_accvgpr_write_b32 a149, v19
    v_accvgpr_read_b32 v18, a150
    v_mul_f32 v18, v18, v250
    v_accvgpr_write_b32 a150, v18
    v_accvgpr_read_b32 v19, a151
    v_mul_f32 v19, v19, v251
    v_accvgpr_write_b32 a151, v19
    v_accvgpr_read_b32 v18, a152
    v_mul_f32 v18, v18, v248
    v_accvgpr_write_b32 a152, v18
    v_accvgpr_read_b32 v19, a153
    v_mul_f32 v19, v19, v249
    v_accvgpr_write_b32 a153, v19
    v_accvgpr_read_b32 v18, a154
    v_mul_f32 v18, v18, v250
    v_accvgpr_write_b32 a154, v18
    v_accvgpr_read_b32 v19, a155
    v_mul_f32 v19, v19, v251
    v_accvgpr_write_b32 a155, v19
    v_accvgpr_read_b32 v18, a156
    v_mul_f32 v18, v18, v248
    v_accvgpr_write_b32 a156, v18
    v_accvgpr_read_b32 v19, a157
    v_mul_f32 v19, v19, v249
    v_accvgpr_write_b32 a157, v19
    v_accvgpr_read_b32 v18, a158
    v_mul_f32 v18, v18, v250
    v_accvgpr_write_b32 a158, v18
    v_accvgpr_read_b32 v19, a159
    v_mul_f32 v19, v19, v251
    v_accvgpr_write_b32 a159, v19
    v_accvgpr_read_b32 v18, a160
    v_mul_f32 v18, v18, v248
    v_accvgpr_write_b32 a160, v18
    v_accvgpr_read_b32 v19, a161
    v_mul_f32 v19, v19, v249
    v_accvgpr_write_b32 a161, v19
    v_accvgpr_read_b32 v18, a162
    v_mul_f32 v18, v18, v250
    v_accvgpr_write_b32 a162, v18
    v_accvgpr_read_b32 v19, a163
    v_mul_f32 v19, v19, v251
    v_accvgpr_write_b32 a163, v19
    v_accvgpr_read_b32 v18, a164
    v_mul_f32 v18, v18, v248
    v_accvgpr_write_b32 a164, v18
    v_accvgpr_read_b32 v19, a165
    v_mul_f32 v19, v19, v249
    v_accvgpr_write_b32 a165, v19
    v_accvgpr_read_b32 v18, a166
    v_mul_f32 v18, v18, v250
    v_accvgpr_write_b32 a166, v18
    v_accvgpr_read_b32 v19, a167
    v_mul_f32 v19, v19, v251
    v_accvgpr_write_b32 a167, v19
    v_accvgpr_read_b32 v18, a168
    v_mul_f32 v18, v18, v248
    v_accvgpr_write_b32 a168, v18
    v_accvgpr_read_b32 v19, a169
    v_mul_f32 v19, v19, v249
    v_accvgpr_write_b32 a169, v19
    v_accvgpr_read_b32 v18, a170
    v_mul_f32 v18, v18, v250
    v_accvgpr_write_b32 a170, v18
    v_accvgpr_read_b32 v19, a171
    v_mul_f32 v19, v19, v251
    v_accvgpr_write_b32 a171, v19
    v_accvgpr_read_b32 v18, a172
    v_mul_f32 v18, v18, v248
    v_accvgpr_write_b32 a172, v18
    v_accvgpr_read_b32 v19, a173
    v_mul_f32 v19, v19, v249
    v_accvgpr_write_b32 a173, v19
    v_accvgpr_read_b32 v18, a174
    v_mul_f32 v18, v18, v250
    v_accvgpr_write_b32 a174, v18
    v_accvgpr_read_b32 v19, a175
    v_mul_f32 v19, v19, v251
    v_accvgpr_write_b32 a175, v19
    v_accvgpr_read_b32 v18, a176
    v_mul_f32 v18, v18, v248
    v_accvgpr_write_b32 a176, v18
    v_accvgpr_read_b32 v19, a177
    v_mul_f32 v19, v19, v249
    v_accvgpr_write_b32 a177, v19
    v_accvgpr_read_b32 v18, a178
    v_mul_f32 v18, v18, v250
    v_accvgpr_write_b32 a178, v18
    v_accvgpr_read_b32 v19, a179
    v_mul_f32 v19, v19, v251
    v_accvgpr_write_b32 a179, v19
    v_accvgpr_read_b32 v18, a180
    v_mul_f32 v18, v18, v248
    v_accvgpr_write_b32 a180, v18
    v_accvgpr_read_b32 v19, a181
    v_mul_f32 v19, v19, v249
    v_accvgpr_write_b32 a181, v19
    v_accvgpr_read_b32 v18, a182
    v_mul_f32 v18, v18, v250
    v_accvgpr_write_b32 a182, v18
    v_accvgpr_read_b32 v19, a183
    v_mul_f32 v19, v19, v251
    v_accvgpr_write_b32 a183, v19
    v_accvgpr_read_b32 v18, a184
    v_mul_f32 v18, v18, v248
    v_accvgpr_write_b32 a184, v18
    v_accvgpr_read_b32 v19, a185
    v_mul_f32 v19, v19, v249
    v_accvgpr_write_b32 a185, v19
    v_accvgpr_read_b32 v18, a186
    v_mul_f32 v18, v18, v250
    v_accvgpr_write_b32 a186, v18
    v_accvgpr_read_b32 v19, a187
    v_mul_f32 v19, v19, v251
    v_accvgpr_write_b32 a187, v19
    v_accvgpr_read_b32 v18, a188
    v_mul_f32 v18, v18, v248
    v_accvgpr_write_b32 a188, v18
    v_accvgpr_read_b32 v19, a189
    v_mul_f32 v19, v19, v249
    v_accvgpr_write_b32 a189, v19
    v_accvgpr_read_b32 v18, a190
    v_mul_f32 v18, v18, v250
    v_accvgpr_write_b32 a190, v18
    v_accvgpr_read_b32 v19, a191
    v_mul_f32 v19, v19, v251
    v_accvgpr_write_b32 a191, v19
    s_waitcnt vmcnt(0)
    s_nop 1
    v_mfma_f32_16x16x32_bf16 a[0:3], v[224:227], v[112:115], a[0:3]
    v_mfma_f32_16x16x32_bf16 a[48:51], v[228:231], v[112:115], a[48:51]
    v_mfma_f32_16x16x32_bf16 a[96:99], v[232:235], v[112:115], a[96:99]
    v_mfma_f32_16x16x32_bf16 a[144:147], v[236:239], v[112:115], a[144:147]
    v_mfma_f32_16x16x32_bf16 a[4:7], v[224:227], v[116:119], a[4:7]
    v_mfma_f32_16x16x32_bf16 a[52:55], v[228:231], v[116:119], a[52:55]
    v_mfma_f32_16x16x32_bf16 a[100:103], v[232:235], v[116:119], a[100:103]
    v_mfma_f32_16x16x32_bf16 a[148:151], v[236:239], v[116:119], a[148:151]
    v_mfma_f32_16x16x32_bf16 a[8:11], v[224:227], v[120:123], a[8:11]
    v_mfma_f32_16x16x32_bf16 a[56:59], v[228:231], v[120:123], a[56:59]
    v_mfma_f32_16x16x32_bf16 a[104:107], v[232:235], v[120:123], a[104:107]
    v_mfma_f32_16x16x32_bf16 a[152:155], v[236:239], v[120:123], a[152:155]
    v_mfma_f32_16x16x32_bf16 a[12:15], v[224:227], v[124:127], a[12:15]
    v_mfma_f32_16x16x32_bf16 a[60:63], v[228:231], v[124:127], a[60:63]
    v_mfma_f32_16x16x32_bf16 a[108:111], v[232:235], v[124:127], a[108:111]
    v_mfma_f32_16x16x32_bf16 a[156:159], v[236:239], v[124:127], a[156:159]
    v_mfma_f32_16x16x32_bf16 a[16:19], v[224:227], v[128:131], a[16:19]
    v_mfma_f32_16x16x32_bf16 a[64:67], v[228:231], v[128:131], a[64:67]
    v_mfma_f32_16x16x32_bf16 a[112:115], v[232:235], v[128:131], a[112:115]
    v_mfma_f32_16x16x32_bf16 a[160:163], v[236:239], v[128:131], a[160:163]
    v_mfma_f32_16x16x32_bf16 a[20:23], v[224:227], v[132:135], a[20:23]
    v_mfma_f32_16x16x32_bf16 a[68:71], v[228:231], v[132:135], a[68:71]
    v_mfma_f32_16x16x32_bf16 a[116:119], v[232:235], v[132:135], a[116:119]
    v_mfma_f32_16x16x32_bf16 a[164:167], v[236:239], v[132:135], a[164:167]
    v_mfma_f32_16x16x32_bf16 a[24:27], v[224:227], v[136:139], a[24:27]
    v_mfma_f32_16x16x32_bf16 a[72:75], v[228:231], v[136:139], a[72:75]
    v_mfma_f32_16x16x32_bf16 a[120:123], v[232:235], v[136:139], a[120:123]
    v_mfma_f32_16x16x32_bf16 a[168:171], v[236:239], v[136:139], a[168:171]
    v_mfma_f32_16x16x32_bf16 a[28:31], v[224:227], v[140:143], a[28:31]
    v_mfma_f32_16x16x32_bf16 a[76:79], v[228:231], v[140:143], a[76:79]
    v_mfma_f32_16x16x32_bf16 a[124:127], v[232:235], v[140:143], a[124:127]
    v_mfma_f32_16x16x32_bf16 a[172:175], v[236:239], v[140:143], a[172:175]
    v_mfma_f32_16x16x32_bf16 a[32:35], v[224:227], v[144:147], a[32:35]
    v_mfma_f32_16x16x32_bf16 a[80:83], v[228:231], v[144:147], a[80:83]
    v_mfma_f32_16x16x32_bf16 a[128:131], v[232:235], v[144:147], a[128:131]
    v_mfma_f32_16x16x32_bf16 a[176:179], v[236:239], v[144:147], a[176:179]
    v_mfma_f32_16x16x32_bf16 a[36:39], v[224:227], v[148:151], a[36:39]
    v_mfma_f32_16x16x32_bf16 a[84:87], v[228:231], v[148:151], a[84:87]
    v_mfma_f32_16x16x32_bf16 a[132:135], v[232:235], v[148:151], a[132:135]
    v_mfma_f32_16x16x32_bf16 a[180:183], v[236:239], v[148:151], a[180:183]
    v_mfma_f32_16x16x32_bf16 a[40:43], v[224:227], v[152:155], a[40:43]
    v_mfma_f32_16x16x32_bf16 a[88:91], v[228:231], v[152:155], a[88:91]
    v_mfma_f32_16x16x32_bf16 a[136:139], v[232:235], v[152:155], a[136:139]
    v_mfma_f32_16x16x32_bf16 a[184:187], v[236:239], v[152:155], a[184:187]
    v_mfma_f32_16x16x32_bf16 a[44:47], v[224:227], v[156:159], a[44:47]
    v_mfma_f32_16x16x32_bf16 a[92:95], v[228:231], v[156:159], a[92:95]
    v_mfma_f32_16x16x32_bf16 a[140:143], v[232:235], v[156:159], a[140:143]
    v_mfma_f32_16x16x32_bf16 a[188:191], v[236:239], v[156:159], a[188:191]
    s_add_u32 s48, s48, 24576
    s_cmp_lt_u32 s48, 1572864
    s_nop 7
    s_cbranch_scc1 L_slowloop
    s_nop 1
    v_mfma_f32_16x16x4_f32 v[48:51], v5, v57, 0
    v_mfma_f32_16x16x4_f32 v[52:55], v6, v57, 0
    s_nop 7
    s_nop 1
    v_rcp_f32 v48, v48
    v_rcp_f32 v49, v49
    v_rcp_f32 v50, v50
    v_rcp_f32 v51, v51
    v_rcp_f32 v52, v52
    v_rcp_f32 v53, v53
    v_rcp_f32 v54, v54
    v_rcp_f32 v55, v55
    v_mfma_f32_16x16x4_f32 v[128:131], v7, v57, 0
    v_mfma_f32_16x16x4_f32 v[132:135], v8, v57, 0
    s_nop 7
    s_nop 1
    v_rcp_f32 v128, v128
    v_rcp_f32 v129, v129
    v_rcp_f32 v130, v130
    v_rcp_f32 v131, v131
    v_rcp_f32 v132, v132
    v_rcp_f32 v133, v133
    v_rcp_f32 v134, v134
    v_rcp_f32 v135, v135
    s_nop 0
    v_accvgpr_read_b32 v64, a0
    v_accvgpr_read_b32 v65, a4
    v_accvgpr_read_b32 v66, a8
    v_accvgpr_read_b32 v67, a12
    v_accvgpr_read_b32 v68, a16
    v_accvgpr_read_b32 v69, a20
    v_pk_mul_f32 v[64:65], v[64:65], v[48:49] op_sel_hi:[1,0]
    v_pk_mul_f32 v[66:67], v[66:67], v[48:49] op_sel_hi:[1,0]
    v_pk_mul_f32 v[68:69], v[68:69], v[48:49] op_sel_hi:[1,0]
    v_cvt_pk_bf16_f32 v64, v64, v65
    v_cvt_pk_bf16_f32 v65, v66, v67
    v_cvt_pk_bf16_f32 v66, v68, v69
    v_accvgpr_read_b32 v70, a1
    v_accvgpr_read_b32 v71, a5
    v_accvgpr_read_b32 v72, a9
    v_accvgpr_read_b32 v73, a13
    v_accvgpr_read_b32 v74, a17
    v_accvgpr_read_b32 v75, a21
    v_pk_mul_f32 v[70:71], v[70:71], v[48:49] op_sel:[0,1] op_sel_hi:[1,1]
    v_pk_mul_f32 v[72:73], v[72:73], v[48:49] op_sel:[0,1] op_sel_hi:[1,1]
    v_pk_mul_f32 v[74:75], v[74:75], v[48:49] op_sel:[0,1] op_sel_hi:[1,1]
    v_cvt_pk_bf16_f32 v70, v70, v71
    v_cvt_pk_bf16_f32 v71, v72, v73
    v_cvt_pk_bf16_f32 v72, v74, v75
    buffer_store_dwordx3 v[64:66], v56, s[12:15], s24 offen offset:0 sc0 sc1
    v_accvgpr_read_b32 v76, a2
    v_accvgpr_read_b32 v77, a6
    v_accvgpr_read_b32 v78, a10
    v_accvgpr_read_b32 v79, a14
    v_accvgpr_read_b32 v80, a18
    v_accvgpr_read_b32 v81, a22
    v_pk_mul_f32 v[76:77], v[76:77], v[50:51] op_sel_hi:[1,0]
    v_pk_mul_f32 v[78:79], v[78:79], v[50:51] op_sel_hi:[1,0]
    v_pk_mul_f32 v[80:81], v[80:81], v[50:51] op_sel_hi:[1,0]
    v_cvt_pk_bf16_f32 v76, v76, v77
    v_cvt_pk_bf16_f32 v77, v78, v79
    v_cvt_pk_bf16_f32 v78, v80, v81
    buffer_store_dwordx3 v[70:72], v56, s[12:15], s24 offen offset:384 sc0 sc1
    v_accvgpr_read_b32 v82, a3
    v_accvgpr_read_b32 v83, a7
    v_accvgpr_read_b32 v84, a11
    v_accvgpr_read_b32 v85, a15
    v_accvgpr_read_b32 v86, a19
    v_accvgpr_read_b32 v87, a23
    v_pk_mul_f32 v[82:83], v[82:83], v[50:51] op_sel:[0,1] op_sel_hi:[1,1]
    v_pk_mul_f32 v[84:85], v[84:85], v[50:51] op_sel:[0,1] op_sel_hi:[1,1]
    v_pk_mul_f32 v[86:87], v[86:87], v[50:51] op_sel:[0,1] op_sel_hi:[1,1]
    v_cvt_pk_bf16_f32 v82, v82, v83
    v_cvt_pk_bf16_f32 v83, v84, v85
    v_cvt_pk_bf16_f32 v84, v86, v87
    buffer_store_dwordx3 v[76:78], v56, s[12:15], s24 offen offset:768 sc0 sc1
    v_accvgpr_read_b32 v88, a24
    v_accvgpr_read_b32 v89, a28
    v_accvgpr_read_b32 v90, a32
    v_accvgpr_read_b32 v91, a36
    v_accvgpr_read_b32 v92, a40
    v_accvgpr_read_b32 v93, a44
    v_pk_mul_f32 v[88:89], v[88:89], v[48:49] op_sel_hi:[1,0]
    v_pk_mul_f32 v[90:91], v[90:91], v[48:49] op_sel_hi:[1,0]
    v_pk_mul_f32 v[92:93], v[92:93], v[48:49] op_sel_hi:[1,0]
    v_cvt_pk_bf16_f32 v88, v88, v89
    v_cvt_pk_bf16_f32 v89, v90, v91
    v_cvt_pk_bf16_f32 v90, v92, v93
    buffer_store_dwordx3 v[82:84], v56, s[12:15], s24 offen offset:1152 sc0 sc1
    v_accvgpr_read_b32 v94, a25
    v_accvgpr_read_b32 v95, a29
    v_accvgpr_read_b32 v96, a33
    v_accvgpr_read_b32 v97, a37
    v_accvgpr_read_b32 v98, a41
    v_accvgpr_read_b32 v99, a45
    v_pk_mul_f32 v[94:95], v[94:95], v[48:49] op_sel:[0,1] op_sel_hi:[1,1]
    v_pk_mul_f32 v[96:97], v[96:97], v[48:49] op_sel:[0,1] op_sel_hi:[1,1]
    v_pk_mul_f32 v[98:99], v[98:99], v[48:49] op_sel:[0,1] op_sel_hi:[1,1]
    v_cvt_pk_bf16_f32 v94, v94, v95
    v_cvt_pk_bf16_f32 v95, v96, v97
    v_cvt_pk_bf16_f32 v96, v98, v99
    buffer_store_dwordx3 v[88:90], v56, s[12:15], s24 offen offset:192 sc0 sc1
    v_accvgpr_read_b32 v100, a26
    v_accvgpr_read_b32 v101, a30
    v_accvgpr_read_b32 v102, a34
    v_accvgpr_read_b32 v103, a38
    v_accvgpr_read_b32 v104, a42
    v_accvgpr_read_b32 v105, a46
    v_pk_mul_f32 v[100:101], v[100:101], v[50:51] op_sel_hi:[1,0]
    v_pk_mul_f32 v[102:103], v[102:103], v[50:51] op_sel_hi:[1,0]
    v_pk_mul_f32 v[104:105], v[104:105], v[50:51] op_sel_hi:[1,0]
    v_cvt_pk_bf16_f32 v100, v100, v101
    v_cvt_pk_bf16_f32 v101, v102, v103
    v_cvt_pk_bf16_f32 v102, v104, v105
    buffer_store_dwordx3 v[94:96], v56, s[12:15], s24 offen offset:576 sc0 sc1
    v_accvgpr_read_b32 v106, a27
    v_accvgpr_read_b32 v107, a31
    v_accvgpr_read_b32 v108, a35
    v_accvgpr_read_b32 v109, a39
    v_accvgpr_read_b32 v110, a43
    v_accvgpr_read_b32 v111, a47
    v_pk_mul_f32 v[106:107], v[106:107], v[50:51] op_sel:[0,1] op_sel_hi:[1,1]
    v_pk_mul_f32 v[108:109], v[108:109], v[50:51] op_sel:[0,1] op_sel_hi:[1,1]
    v_pk_mul_f32 v[110:111], v[110:111], v[50:51] op_sel:[0,1] op_sel_hi:[1,1]
    v_cvt_pk_bf16_f32 v106, v106, v107
    v_cvt_pk_bf16_f32 v107, v108, v109
    v_cvt_pk_bf16_f32 v108, v110, v111
    buffer_store_dwordx3 v[100:102], v56, s[12:15], s24 offen offset:960 sc0 sc1
    v_accvgpr_read_b32 v64, a48
    v_accvgpr_read_b32 v65, a52
    v_accvgpr_read_b32 v66, a56
    v_accvgpr_read_b32 v67, a60
    v_accvgpr_read_b32 v68, a64
    v_accvgpr_read_b32 v69, a68
    v_pk_mul_f32 v[64:65], v[64:65], v[52:53] op_sel_hi:[1,0]
    v_pk_mul_f32 v[66:67], v[66:67], v[52:53] op_sel_hi:[1,0]
    v_pk_mul_f32 v[68:69], v[68:69], v[52:53] op_sel_hi:[1,0]
    v_cvt_pk_bf16_f32 v64, v64, v65
    v_cvt_pk_bf16_f32 v65, v66, v67
    v_cvt_pk_bf16_f32 v66, v68, v69
    buffer_store_dwordx3 v[106:108], v56, s[12:15], s24 offen offset:1344 sc0 sc1
    v_accvgpr_read_b32 v70, a49
    v_accvgpr_read_b32 v71, a53
    v_accvgpr_read_b32 v72, a57
    v_accvgpr_read_b32 v73, a61
    v_accvgpr_read_b32 v74, a65
    v_accvgpr_read_b32 v75, a69
    v_pk_mul_f32 v[70:71], v[70:71], v[52:53] op_sel:[0,1] op_sel_hi:[1,1]
    v_pk_mul_f32 v[72:73], v[72:73], v[52:53] op_sel:[0,1] op_sel_hi:[1,1]
    v_pk_mul_f32 v[74:75], v[74:75], v[52:53] op_sel:[0,1] op_sel_hi:[1,1]
    v_cvt_pk_bf16_f32 v70, v70, v71
    v_cvt_pk_bf16_f32 v71, v72, v73
    v_cvt_pk_bf16_f32 v72, v74, v75
    buffer_store_dwordx3 v[64:66], v56, s[12:15], s40 offen offset:0 sc0 sc1
    v_accvgpr_read_b32 v76, a50
    v_accvgpr_read_b32 v77, a54
    v_accvgpr_read_b32 v78, a58
    v_accvgpr_read_b32 v79, a62
    v_accvgpr_read_b32 v80, a66
    v_accvgpr_read_b32 v81, a70
    v_pk_mul_f32 v[76:77], v[76:77], v[54:55] op_sel_hi:[1,0]
    v_pk_mul_f32 v[78:79], v[78:79], v[54:55] op_sel_hi:[1,0]
    v_pk_mul_f32 v[80:81], v[80:81], v[54:55] op_sel_hi:[1,0]
    v_cvt_pk_bf16_f32 v76, v76, v77
    v_cvt_pk_bf16_f32 v77, v78, v79
    v_cvt_pk_bf16_f32 v78, v80, v81
    buffer_store_dwordx3 v[70:72], v56, s[12:15], s40 offen offset:384 sc0 sc1
    v_accvgpr_read_b32 v82, a51
    v_accvgpr_read_b32 v83, a55
    v_accvgpr_read_b32 v84, a59
    v_accvgpr_read_b32 v85, a63
    v_accvgpr_read_b32 v86, a67
    v_accvgpr_read_b32 v87, a71
    v_pk_mul_f32 v[82:83], v[82:83], v[54:55] op_sel:[0,1] op_sel_hi:[1,1]
    v_pk_mul_f32 v[84:85], v[84:85], v[54:55] op_sel:[0,1] op_sel_hi:[1,1]
    v_pk_mul_f32 v[86:87], v[86:87], v[54:55] op_sel:[0,1] op_sel_hi:[1,1]
    v_cvt_pk_bf16_f32 v82, v82, v83
    v_cvt_pk_bf16_f32 v83, v84, v85
    v_cvt_pk_bf16_f32 v84, v86, v87
    buffer_store_dwordx3 v[76:78], v56, s[12:15], s40 offen offset:768 sc0 sc1
    v_accvgpr_read_b32 v88, a72
    v_accvgpr_read_b32 v89, a76
    v_accvgpr_read_b32 v90, a80
    v_accvgpr_read_b32 v91, a84
    v_accvgpr_read_b32 v92, a88
    v_accvgpr_read_b32 v93, a92
    v_pk_mul_f32 v[88:89], v[88:89], v[52:53] op_sel_hi:[1,0]
    v_pk_mul_f32 v[90:91], v[90:91], v[52:53] op_sel_hi:[1,0]
    v_pk_mul_f32 v[92:93], v[92:93], v[52:53] op_sel_hi:[1,0]
    v_cvt_pk_bf16_f32 v88, v88, v89
    v_cvt_pk_bf16_f32 v89, v90, v91
    v_cvt_pk_bf16_f32 v90, v92, v93
    buffer_store_dwordx3 v[82:84], v56, s[12:15], s40 offen offset:1152 sc0 sc1
    v_accvgpr_read_b32 v94, a73
    v_accvgpr_read_b32 v95, a77
    v_accvgpr_read_b32 v96, a81
    v_accvgpr_read_b32 v97, a85
    v_accvgpr_read_b32 v98, a89
    v_accvgpr_read_b32 v99, a93
    v_pk_mul_f32 v[94:95], v[94:95], v[52:53] op_sel:[0,1] op_sel_hi:[1,1]
    v_pk_mul_f32 v[96:97], v[96:97], v[52:53] op_sel:[0,1] op_sel_hi:[1,1]
    v_pk_mul_f32 v[98:99], v[98:99], v[52:53] op_sel:[0,1] op_sel_hi:[1,1]
    v_cvt_pk_bf16_f32 v94, v94, v95
    v_cvt_pk_bf16_f32 v95, v96, v97
    v_cvt_pk_bf16_f32 v96, v98, v99
    buffer_store_dwordx3 v[88:90], v56, s[12:15], s40 offen offset:192 sc0 sc1
    v_accvgpr_read_b32 v100, a74
    v_accvgpr_read_b32 v101, a78
    v_accvgpr_read_b32 v102, a82
    v_accvgpr_read_b32 v103, a86
    v_accvgpr_read_b32 v104, a90
    v_accvgpr_read_b32 v105, a94
    v_pk_mul_f32 v[100:101], v[100:101], v[54:55] op_sel_hi:[1,0]
    v_pk_mul_f32 v[102:103], v[102:103], v[54:55] op_sel_hi:[1,0]
    v_pk_mul_f32 v[104:105], v[104:105], v[54:55] op_sel_hi:[1,0]
    v_cvt_pk_bf16_f32 v100, v100, v101
    v_cvt_pk_bf16_f32 v101, v102, v103
    v_cvt_pk_bf16_f32 v102, v104, v105
    buffer_store_dwordx3 v[94:96], v56, s[12:15], s40 offen offset:576 sc0 sc1
    v_accvgpr_read_b32 v106, a75
    v_accvgpr_read_b32 v107, a79
    v_accvgpr_read_b32 v108, a83
    v_accvgpr_read_b32 v109, a87
    v_accvgpr_read_b32 v110, a91
    v_accvgpr_read_b32 v111, a95
    v_pk_mul_f32 v[106:107], v[106:107], v[54:55] op_sel:[0,1] op_sel_hi:[1,1]
    v_pk_mul_f32 v[108:109], v[108:109], v[54:55] op_sel:[0,1] op_sel_hi:[1,1]
    v_pk_mul_f32 v[110:111], v[110:111], v[54:55] op_sel:[0,1] op_sel_hi:[1,1]
    v_cvt_pk_bf16_f32 v106, v106, v107
    v_cvt_pk_bf16_f32 v107, v108, v109
    v_cvt_pk_bf16_f32 v108, v110, v111
    buffer_store_dwordx3 v[100:102], v56, s[12:15], s40 offen offset:960 sc0 sc1
    v_accvgpr_read_b32 v64, a96
    v_accvgpr_read_b32 v65, a100
    v_accvgpr_read_b32 v66, a104
    v_accvgpr_read_b32 v67, a108
    v_accvgpr_read_b32 v68, a112
    v_accvgpr_read_b32 v69, a116
    v_pk_mul_f32 v[64:65], v[64:65], v[128:129] op_sel_hi:[1,0]
    v_pk_mul_f32 v[66:67], v[66:67], v[128:129] op_sel_hi:[1,0]
    v_pk_mul_f32 v[68:69], v[68:69], v[128:129] op_sel_hi:[1,0]
    v_cvt_pk_bf16_f32 v64, v64, v65
    v_cvt_pk_bf16_f32 v65, v66, v67
    v_cvt_pk_bf16_f32 v66, v68, v69
    buffer_store_dwordx3 v[106:108], v56, s[12:15], s40 offen offset:1344 sc0 sc1
    v_accvgpr_read_b32 v70, a97
    v_accvgpr_read_b32 v71, a101
    v_accvgpr_read_b32 v72, a105
    v_accvgpr_read_b32 v73, a109
    v_accvgpr_read_b32 v74, a113
    v_accvgpr_read_b32 v75, a117
    v_pk_mul_f32 v[70:71], v[70:71], v[128:129] op_sel:[0,1] op_sel_hi:[1,1]
    v_pk_mul_f32 v[72:73], v[72:73], v[128:129] op_sel:[0,1] op_sel_hi:[1,1]
    v_pk_mul_f32 v[74:75], v[74:75], v[128:129] op_sel:[0,1] op_sel_hi:[1,1]
    v_cvt_pk_bf16_f32 v70, v70, v71
    v_cvt_pk_bf16_f32 v71, v72, v73
    v_cvt_pk_bf16_f32 v72, v74, v75
    buffer_store_dwordx3 v[64:66], v56, s[12:15], s41 offen offset:0 sc0 sc1
    v_accvgpr_read_b32 v76, a98
    v_accvgpr_read_b32 v77, a102
    v_accvgpr_read_b32 v78, a106
    v_accvgpr_read_b32 v79, a110
    v_accvgpr_read_b32 v80, a114
    v_accvgpr_read_b32 v81, a118
    v_pk_mul_f32 v[76:77], v[76:77], v[130:131] op_sel_hi:[1,0]
    v_pk_mul_f32 v[78:79], v[78:79], v[130:131] op_sel_hi:[1,0]
    v_pk_mul_f32 v[80:81], v[80:81], v[130:131] op_sel_hi:[1,0]
    v_cvt_pk_bf16_f32 v76, v76, v77
    v_cvt_pk_bf16_f32 v77, v78, v79
    v_cvt_pk_bf16_f32 v78, v80, v81
    buffer_store_dwordx3 v[70:72], v56, s[12:15], s41 offen offset:384 sc0 sc1
    v_accvgpr_read_b32 v82, a99
    v_accvgpr_read_b32 v83, a103
    v_accvgpr_read_b32 v84, a107
    v_accvgpr_read_b32 v85, a111
    v_accvgpr_read_b32 v86, a115
    v_accvgpr_read_b32 v87, a119
    v_pk_mul_f32 v[82:83], v[82:83], v[130:131] op_sel:[0,1] op_sel_hi:[1,1]
    v_pk_mul_f32 v[84:85], v[84:85], v[130:131] op_sel:[0,1] op_sel_hi:[1,1]
    v_pk_mul_f32 v[86:87], v[86:87], v[130:131] op_sel:[0,1] op_sel_hi:[1,1]
    v_cvt_pk_bf16_f32 v82, v82, v83
    v_cvt_pk_bf16_f32 v83, v84, v85
    v_cvt_pk_bf16_f32 v84, v86, v87
    buffer_store_dwordx3 v[76:78], v56, s[12:15], s41 offen offset:768 sc0 sc1
    v_accvgpr_read_b32 v88, a120
    v_accvgpr_read_b32 v89, a124
    v_accvgpr_read_b32 v90, a128
    v_accvgpr_read_b32 v91, a132
    v_accvgpr_read_b32 v92, a136
    v_accvgpr_read_b32 v93, a140
    v_pk_mul_f32 v[88:89], v[88:89], v[128:129] op_sel_hi:[1,0]
    v_pk_mul_f32 v[90:91], v[90:91], v[128:129] op_sel_hi:[1,0]
    v_pk_mul_f32 v[92:93], v[92:93], v[128:129] op_sel_hi:[1,0]
    v_cvt_pk_bf16_f32 v88, v88, v89
    v_cvt_pk_bf16_f32 v89, v90, v91
    v_cvt_pk_bf16_f32 v90, v92, v93
    buffer_store_dwordx3 v[82:84], v56, s[12:15], s41 offen offset:1152 sc0 sc1
    v_accvgpr_read_b32 v94, a121
    v_accvgpr_read_b32 v95, a125
    v_accvgpr_read_b32 v96, a129
    v_accvgpr_read_b32 v97, a133
    v_accvgpr_read_b32 v98, a137
    v_accvgpr_read_b32 v99, a141
    v_pk_mul_f32 v[94:95], v[94:95], v[128:129] op_sel:[0,1] op_sel_hi:[1,1]
    v_pk_mul_f32 v[96:97], v[96:97], v[128:129] op_sel:[0,1] op_sel_hi:[1,1]
    v_pk_mul_f32 v[98:99], v[98:99], v[128:129] op_sel:[0,1] op_sel_hi:[1,1]
    v_cvt_pk_bf16_f32 v94, v94, v95
    v_cvt_pk_bf16_f32 v95, v96, v97
    v_cvt_pk_bf16_f32 v96, v98, v99
    buffer_store_dwordx3 v[88:90], v56, s[12:15], s41 offen offset:192 sc0 sc1
    v_accvgpr_read_b32 v100, a122
    v_accvgpr_read_b32 v101, a126
    v_accvgpr_read_b32 v102, a130
    v_accvgpr_read_b32 v103, a134
    v_accvgpr_read_b32 v104, a138
    v_accvgpr_read_b32 v105, a142
    v_pk_mul_f32 v[100:101], v[100:101], v[130:131] op_sel_hi:[1,0]
    v_pk_mul_f32 v[102:103], v[102:103], v[130:131] op_sel_hi:[1,0]
    v_pk_mul_f32 v[104:105], v[104:105], v[130:131] op_sel_hi:[1,0]
    v_cvt_pk_bf16_f32 v100, v100, v101
    v_cvt_pk_bf16_f32 v101, v102, v103
    v_cvt_pk_bf16_f32 v102, v104, v105
    buffer_store_dwordx3 v[94:96], v56, s[12:15], s41 offen offset:576 sc0 sc1
    v_accvgpr_read_b32 v106, a123
    v_accvgpr_read_b32 v107, a127
    v_accvgpr_read_b32 v108, a131
    v_accvgpr_read_b32 v109, a135
    v_accvgpr_read_b32 v110, a139
    v_accvgpr_read_b32 v111, a143
    v_pk_mul_f32 v[106:107], v[106:107], v[130:131] op_sel:[0,1] op_sel_hi:[1,1]
    v_pk_mul_f32 v[108:109], v[108:109], v[130:131] op_sel:[0,1] op_sel_hi:[1,1]
    v_pk_mul_f32 v[110:111], v[110:111], v[130:131] op_sel:[0,1] op_sel_hi:[1,1]
    v_cvt_pk_bf16_f32 v106, v106, v107
    v_cvt_pk_bf16_f32 v107, v108, v109
    v_cvt_pk_bf16_f32 v108, v110, v111
    buffer_store_dwordx3 v[100:102], v56, s[12:15], s41 offen offset:960 sc0 sc1
    v_accvgpr_read_b32 v64, a144
    v_accvgpr_read_b32 v65, a148
    v_accvgpr_read_b32 v66, a152
    v_accvgpr_read_b32 v67, a156
    v_accvgpr_read_b32 v68, a160
    v_accvgpr_read_b32 v69, a164
    v_pk_mul_f32 v[64:65], v[64:65], v[132:133] op_sel_hi:[1,0]
    v_pk_mul_f32 v[66:67], v[66:67], v[132:133] op_sel_hi:[1,0]
    v_pk_mul_f32 v[68:69], v[68:69], v[132:133] op_sel_hi:[1,0]
    v_cvt_pk_bf16_f32 v64, v64, v65
    v_cvt_pk_bf16_f32 v65, v66, v67
    v_cvt_pk_bf16_f32 v66, v68, v69
    buffer_store_dwordx3 v[106:108], v56, s[12:15], s41 offen offset:1344 sc0 sc1
    v_accvgpr_read_b32 v70, a145
    v_accvgpr_read_b32 v71, a149
    v_accvgpr_read_b32 v72, a153
    v_accvgpr_read_b32 v73, a157
    v_accvgpr_read_b32 v74, a161
    v_accvgpr_read_b32 v75, a165
    v_pk_mul_f32 v[70:71], v[70:71], v[132:133] op_sel:[0,1] op_sel_hi:[1,1]
    v_pk_mul_f32 v[72:73], v[72:73], v[132:133] op_sel:[0,1] op_sel_hi:[1,1]
    v_pk_mul_f32 v[74:75], v[74:75], v[132:133] op_sel:[0,1] op_sel_hi:[1,1]
    v_cvt_pk_bf16_f32 v70, v70, v71
    v_cvt_pk_bf16_f32 v71, v72, v73
    v_cvt_pk_bf16_f32 v72, v74, v75
    buffer_store_dwordx3 v[64:66], v56, s[12:15], s42 offen offset:0 sc0 sc1
    v_accvgpr_read_b32 v76, a146
    v_accvgpr_read_b32 v77, a150
    v_accvgpr_read_b32 v78, a154
    v_accvgpr_read_b32 v79, a158
    v_accvgpr_read_b32 v80, a162
    v_accvgpr_read_b32 v81, a166
    v_pk_mul_f32 v[76:77], v[76:77], v[134:135] op_sel_hi:[1,0]
    v_pk_mul_f32 v[78:79], v[78:79], v[134:135] op_sel_hi:[1,0]
    v_pk_mul_f32 v[80:81], v[80:81], v[134:135] op_sel_hi:[1,0]
    v_cvt_pk_bf16_f32 v76, v76, v77
    v_cvt_pk_bf16_f32 v77, v78, v79
    v_cvt_pk_bf16_f32 v78, v80, v81
    buffer_store_dwordx3 v[70:72], v56, s[12:15], s42 offen offset:384 sc0 sc1
    v_accvgpr_read_b32 v82, a147
    v_accvgpr_read_b32 v83, a151
    v_accvgpr_read_b32 v84, a155
    v_accvgpr_read_b32 v85, a159
    v_accvgpr_read_b32 v86, a163
    v_accvgpr_read_b32 v87, a167
    v_pk_mul_f32 v[82:83], v[82:83], v[134:135] op_sel:[0,1] op_sel_hi:[1,1]
    v_pk_mul_f32 v[84:85], v[84:85], v[134:135] op_sel:[0,1] op_sel_hi:[1,1]
    v_pk_mul_f32 v[86:87], v[86:87], v[134:135] op_sel:[0,1] op_sel_hi:[1,1]
    v_cvt_pk_bf16_f32 v82, v82, v83
    v_cvt_pk_bf16_f32 v83, v84, v85
    v_cvt_pk_bf16_f32 v84, v86, v87
    buffer_store_dwordx3 v[76:78], v56, s[12:15], s42 offen offset:768 sc0 sc1
    v_accvgpr_read_b32 v88, a168
    v_accvgpr_read_b32 v89, a172
    v_accvgpr_read_b32 v90, a176
    v_accvgpr_read_b32 v91, a180
    v_accvgpr_read_b32 v92, a184
    v_accvgpr_read_b32 v93, a188
    v_pk_mul_f32 v[88:89], v[88:89], v[132:133] op_sel_hi:[1,0]
    v_pk_mul_f32 v[90:91], v[90:91], v[132:133] op_sel_hi:[1,0]
    v_pk_mul_f32 v[92:93], v[92:93], v[132:133] op_sel_hi:[1,0]
    v_cvt_pk_bf16_f32 v88, v88, v89
    v_cvt_pk_bf16_f32 v89, v90, v91
    v_cvt_pk_bf16_f32 v90, v92, v93
    buffer_store_dwordx3 v[82:84], v56, s[12:15], s42 offen offset:1152 sc0 sc1
    v_accvgpr_read_b32 v94, a169
    v_accvgpr_read_b32 v95, a173
    v_accvgpr_read_b32 v96, a177
    v_accvgpr_read_b32 v97, a181
    v_accvgpr_read_b32 v98, a185
    v_accvgpr_read_b32 v99, a189
    v_pk_mul_f32 v[94:95], v[94:95], v[132:133] op_sel:[0,1] op_sel_hi:[1,1]
    v_pk_mul_f32 v[96:97], v[96:97], v[132:133] op_sel:[0,1] op_sel_hi:[1,1]
    v_pk_mul_f32 v[98:99], v[98:99], v[132:133] op_sel:[0,1] op_sel_hi:[1,1]
    v_cvt_pk_bf16_f32 v94, v94, v95
    v_cvt_pk_bf16_f32 v95, v96, v97
    v_cvt_pk_bf16_f32 v96, v98, v99
    buffer_store_dwordx3 v[88:90], v56, s[12:15], s42 offen offset:192 sc0 sc1
    v_accvgpr_read_b32 v100, a170
    v_accvgpr_read_b32 v101, a174
    v_accvgpr_read_b32 v102, a178
    v_accvgpr_read_b32 v103, a182
    v_accvgpr_read_b32 v104, a186
    v_accvgpr_read_b32 v105, a190
    v_pk_mul_f32 v[100:101], v[100:101], v[134:135] op_sel_hi:[1,0]
    v_pk_mul_f32 v[102:103], v[102:103], v[134:135] op_sel_hi:[1,0]
    v_pk_mul_f32 v[104:105], v[104:105], v[134:135] op_sel_hi:[1,0]
    v_cvt_pk_bf16_f32 v100, v100, v101
    v_cvt_pk_bf16_f32 v101, v102, v103
    v_cvt_pk_bf16_f32 v102, v104, v105
    buffer_store_dwordx3 v[94:96], v56, s[12:15], s42 offen offset:576 sc0 sc1
    v_accvgpr_read_b32 v106, a171
    v_accvgpr_read_b32 v107, a175
    v_accvgpr_read_b32 v108, a179
    v_accvgpr_read_b32 v109, a183
    v_accvgpr_read_b32 v110, a187
    v_accvgpr_read_b32 v111, a191
    v_pk_mul_f32 v[106:107], v[106:107], v[134:135] op_sel:[0,1] op_sel_hi:[1,1]
    v_pk_mul_f32 v[108:109], v[108:109], v[134:135] op_sel:[0,1] op_sel_hi:[1,1]
    v_pk_mul_f32 v[110:111], v[110:111], v[134:135] op_sel:[0,1] op_sel_hi:[1,1]
    v_cvt_pk_bf16_f32 v106, v106, v107
    v_cvt_pk_bf16_f32 v107, v108, v109
    v_cvt_pk_bf16_f32 v108, v110, v111
    buffer_store_dwordx3 v[100:102], v56, s[12:15], s42 offen offset:960 sc0 sc1
    buffer_store_dwordx3 v[106:108], v56, s[12:15], s42 offen offset:1344 sc0 sc1
    s_branch L_fin
.section .rodata,"a"
.p2align 6
.amdhsa_kernel standalone__kv_cache_quant_int4_int2_kv_with_per_channel_or_per_token_scales__prompt_kernel
  .amdhsa_next_free_vgpr 512
  .amdhsa_next_free_sgpr 102
  .amdhsa_accum_offset 256
  .amdhsa_group_segment_fixed_size 0
  .amdhsa_kernarg_size 80
  .amdhsa_user_sgpr_count 2
  .amdhsa_user_sgpr_kernarg_segment_ptr 1
  .amdhsa_system_sgpr_workgroup_id_x 1
.end_amdhsa_kernel
```

```asm
; @launch grid=(256,1,1) block=(256,1,1) lds=147584
.amdgcn_target "amdgcn-amd-amdhsa--gfx950"
.text
.globl standalone__kv_cache_quant_int4_int2_kv_with_per_channel_or_per_token_scales__prompt_kernel
.p2align 8
.type standalone__kv_cache_quant_int4_int2_kv_with_per_channel_or_per_token_scales__prompt_kernel,@function
standalone__kv_cache_quant_int4_int2_kv_with_per_channel_or_per_token_scales__prompt_kernel:
    s_cmp_ge_u32 s2, 256
    s_cbranch_scc1 L_done
    s_load_dwordx16 s[40:55], s[0:1], 0
    s_load_dwordx4 s[16:19], s[0:1], 64
    s_and_b32 s94, s2, 7
    s_lshr_b32 s95, s2, 3
    s_lshr_b32 s24, s95, 3
    s_lshl_b32 s94, s94, 2
    s_add_u32 s94, s94, s24
    s_and_b32 s95, s95, 7
    s_getpc_b64 s[60:61]
L_pc:
    s_sub_u32 s60, s60, L_pc-standalone__kv_cache_quant_int4_int2_kv_with_per_channel_or_per_token_scales__prompt_kernel
    s_subb_u32 s61, s61, 0
    s_mov_b32 s62, L_slow-standalone__kv_cache_quant_int4_int2_kv_with_per_channel_or_per_token_scales__prompt_kernel
    s_mov_b32 s63, 0x20000
    s_lshr_b32 s22, s2, 3
    s_lshl_b32 s22, s22, 12
    v_lshlrev_b32 v30, 4, v0
    buffer_load_dwordx4 v[128:131], v30, s[60:63], s22 offen
    v_lshrrev_b32 v24, 6, v0
    v_and_b32 v25, 63, v0
    v_readfirstlane_b32 s25, v24
    v_lshlrev_b32 v1, 4, v25
    v_mul_u32_u24 v26, 43, v25
    v_lshrrev_b32 v26, 10, v26
    v_mul_u32_u24 v27, 24, v26
    v_sub_u32 v27, v25, v27
    v_lshrrev_b32 v28, 1, v24
    v_and_b32 v29, 1, v24
    v_lshlrev_b32 v30, 4, v29
    v_lshl_add_u32 v30, v28, 2, v30
    v_add_u32 v30, v30, v26
    v_mul_u32_u24 v30, 768, v30
    v_lshrrev_b32 v48, 1, v26
    v_lshlrev_b32 v48, 30, v48
    v_lshl_add_u32 v30, v27, 4, v30
    v_or_b32 v9, v30, v48
    v_lshl_or_b32 v10, v27, 3, v48
    v_mul_u32_u24 v30, 6144, v24
    v_mul_u32_u24 v31, 12, v25
    v_add_u32 v12, v30, v31
    s_mov_b32 s66, 1572864
    s_mov_b32 s67, 0x20000
    s_mov_b32 s70, 1572864
    s_mov_b32 s71, 0x20000
    s_mov_b32 s74, 12288
    s_mov_b32 s75, 0x20000
    s_mov_b32 s78, 12288
    s_mov_b32 s79, 0x20000
    s_mov_b32 s82, 4096
    s_mov_b32 s83, 0x20000
    s_mov_b32 s86, 4096
    s_mov_b32 s87, 0x20000
    s_mov_b32 s22, 64
    s_mov_b32 s23, 0x20000
    s_mul_i32 s33, s95, 24576
    s_add_u32 s34, s33, 6144
    s_mov_b32 s35, s33
    s_lshr_b32 s36, s95, 1
    s_mul_i32 s36, s36, 384
    s_lshl_b32 s37, s95, 6
    s_lshl_b32 s24, s25, 4
    s_add_u32 s37, s37, s24
    s_mul_i32 s24, s94, 1572864
    s_mul_i32 s56, s94, 12288
    s_lshl_b32 s57, s94, 12
    s_lshl_b32 s58, s94, 10
    s_add_u32 s58, s58, 51380320
    s_or_b32 s39, s95, s25
    s_waitcnt lgkmcnt(0)
    s_add_u32 s64, s42, s24
    s_addc_u32 s65, s43, 0
    s_add_u32 s72, s46, s56
    s_addc_u32 s73, s47, 0
    s_add_u32 s76, s48, s56
    s_addc_u32 s77, s49, 0
    buffer_load_dwordx4 v[224:227], v9, s[64:67], s33 offen offset:0 nt
    buffer_load_dwordx4 v[228:231], v9, s[64:67], s33 offen offset:1536 nt
    buffer_load_dwordx4 v[232:235], v9, s[64:67], s34 offen offset:0 nt
    buffer_load_dwordx4 v[236:239], v9, s[64:67], s34 offen offset:1536 nt
    buffer_load_dwordx2 v[32:33], v10, s[72:75], s36 offen offset:0
    buffer_load_dwordx2 v[34:35], v10, s[76:79], s36 offen offset:0
    buffer_load_dwordx2 v[36:37], v10, s[72:75], s36 offen offset:192
    buffer_load_dwordx2 v[38:39], v10, s[76:79], s36 offen offset:192
    s_add_u32 s20, s18, s58
    s_addc_u32 s21, s19, 0
    s_add_u32 s80, s50, s57
    s_addc_u32 s81, s51, 0
    s_add_u32 s84, s52, s57
    s_addc_u32 s85, s53, 0
    s_add_u32 s68, s44, s24
    s_addc_u32 s69, s45, 0
    s_mul_i32 s59, s94, 786432
    s_add_u32 s12, s54, s59
    s_addc_u32 s13, s55, 0
    s_add_u32 s8, s40, s59
    s_addc_u32 s9, s41, 0
    s_cmp_lg_u32 s39, 0
    s_cbranch_scc1 L_notleader0
    s_buffer_load_dwordx16 s[40:55], s[20:23], 0 glc
L_notleader0:
    buffer_load_dwordx4 v[240:243], v9, s[64:67], s33 offen offset:384 nt
    buffer_load_dwordx4 v[244:247], v9, s[64:67], s33 offen offset:1920 nt
    buffer_load_dwordx4 v[248:251], v9, s[64:67], s34 offen offset:384 nt
    buffer_load_dwordx4 v[252:255], v9, s[64:67], s34 offen offset:1920 nt
    s_add_u32 s4, s18, s24
    s_addc_u32 s5, s19, 0
    s_mov_b32 s6, 1572864
    s_mov_b32 s7, 0x20000
    s_mov_b32 s10, 786432
    s_mov_b32 s11, 0x20000
    s_mov_b32 s88, s16
    s_mov_b32 s89, s17
    s_add_u32 s16, s33, 3072
    s_add_u32 s17, s33, 6144
    s_mov_b32 s90, 256
    s_mov_b32 s91, 0x20000
    s_lshl_b32 s93, s94, 3
    s_cmp_lg_u32 s39, 0
    s_cbranch_scc1 L_notleader
    s_waitcnt lgkmcnt(0)
    s_mov_b32 s59, 1
    s_lshr_b32 s40, s40, 10
    s_min_u32 s40, s40, 31
    s_bitset1_b32 s59, s40
    s_lshr_b32 s41, s41, 10
    s_min_u32 s41, s41, 31
    s_bitset1_b32 s59, s41
    s_lshr_b32 s42, s42, 10
    s_min_u32 s42, s42, 31
    s_bitset1_b32 s59, s42
    s_lshr_b32 s43, s43, 10
    s_min_u32 s43, s43, 31
    s_bitset1_b32 s59, s43
    s_lshr_b32 s44, s44, 10
    s_min_u32 s44, s44, 31
    s_bitset1_b32 s59, s44
    s_lshr_b32 s45, s45, 10
    s_min_u32 s45, s45, 31
    s_bitset1_b32 s59, s45
    s_lshr_b32 s46, s46, 10
    s_min_u32 s46, s46, 31
    s_bitset1_b32 s59, s46
    s_lshr_b32 s47, s47, 10
    s_min_u32 s47, s47, 31
    s_bitset1_b32 s59, s47
    s_lshr_b32 s48, s48, 10
    s_min_u32 s48, s48, 31
    s_bitset1_b32 s59, s48
    s_lshr_b32 s49, s49, 10
    s_min_u32 s49, s49, 31
    s_bitset1_b32 s59, s49
    s_lshr_b32 s50, s50, 10
    s_min_u32 s50, s50, 31
    s_bitset1_b32 s59, s50
    s_lshr_b32 s51, s51, 10
    s_min_u32 s51, s51, 31
    s_bitset1_b32 s59, s51
    s_lshr_b32 s52, s52, 10
    s_min_u32 s52, s52, 31
    s_bitset1_b32 s59, s52
    s_lshr_b32 s53, s53, 10
    s_min_u32 s53, s53, 31
    s_bitset1_b32 s59, s53
    s_lshr_b32 s54, s54, 10
    s_min_u32 s54, s54, 31
    s_bitset1_b32 s59, s54
    s_lshr_b32 s55, s55, 10
    s_min_u32 s55, s55, 31
    s_bitset1_b32 s59, s55
    s_ff0_i32_b32 s59, s59
    s_lshl_b32 s59, s59, 10
    v_mov_b32 v52, s59
    s_mov_b64 exec, 1
    buffer_store_dword v52, off, s[88:91], s93 sc1
    s_mov_b64 exec, -1
L_notleader:
    s_lshl_b32 s24, s95, 2
    s_add_u32 s24, s24, 32
    s_buffer_load_dword s46, s[20:23], s24 glc
    s_getreg_b32 s45, hwreg(HW_REG_XCC_ID, 0, 4)
    s_lshl_b32 s45, s45, 5
    s_mov_b32 s44, 32
    buffer_load_dwordx3 v[112:114], v12, s[68:71], s35 offen offset:0 nt
    buffer_load_dwordx3 v[116:118], v12, s[68:71], s35 offen offset:768 nt
    buffer_load_dwordx3 v[120:122], v12, s[68:71], s35 offen offset:1536 nt
    buffer_load_dwordx3 v[124:126], v12, s[68:71], s35 offen offset:2304 nt
    buffer_load_dwordx2 v[40:41], off, s[80:83], s37 offset:0
    buffer_load_dwordx2 v[42:43], off, s[84:87], s37 offset:0
    buffer_load_dwordx2 v[44:45], off, s[80:83], s37 offset:8
    buffer_load_dwordx2 v[46:47], off, s[84:87], s37 offset:8
    s_mov_b32 s14, 786432
    s_mov_b32 s15, 0x20000
    s_lshl_b32 s24, s25, 8
    s_add_u32 s93, s93, s24
    v_mul_u32_u24 v30, 3072, v24
    v_add_u32 v4, v30, v1
    v_lshl_add_u32 v30, v24, 3, v26
    v_mul_u32_u24 v30, 384, v30
    v_lshlrev_b32 v31, 2, v29
    v_xor_b32 v31, v27, v31
    v_lshl_add_u32 v30, v31, 4, v30
    v_or_b32 v11, v30, v48
    v_lshlrev_b32 v30, 8, v24
    v_add_u32 v30, 12288, v30
    v_lshrrev_b32 v31, 5, v25
    v_mul_u32_u24 v31, 6144, v31
    v_add_u32 v30, v30, v31
    v_and_b32 v31, 1, v25
    v_mul_u32_u24 v31, 3072, v31
    v_add_u32 v30, v30, v31
    v_bfe_u32 v31, v25, 1, 4
    v_lshl_add_u32 v15, v31, 4, v30
    s_lshl_b32 s24, s95, 2
    v_lshl_add_u32 v13, v0, 2, s24
    v_cmp_lt_u32 vcc, 0, v0
    v_mov_b32 v30, 0x40000000
    s_nop 0
    v_cndmask_b32 v13, v13, v30, vcc
    s_mul_i32 s26, s25, 3072
    s_add_u32 s26, s26, 12288
    s_add_u32 s56, s26, 24576
    s_add_u32 s24, s95, 1
    s_and_b32 s24, s24, 7
    s_mul_i32 s32, s24, 24576
    s_add_u32 s27, s32, 12288
    s_mov_b32 s28, 98304
    s_mov_b32 s30, 73728
    v_add_u32 v1, 24576, v1
    s_mov_b32 s38, 0x3dd53b95
    s_mov_b32 s97, 0xffff0000
    s_and_b32 s24, s2, 7
    s_lshl_b32 s24, s24, 1
    s_lshr_b32 s100, 4369, s24
    s_mov_b32 s96, 100000
    v_and_b32 v26, 15, v25
    v_lshrrev_b32 v27, 4, v25
    v_bfe_u32 v28, v25, 1, 3
    v_xor_b32 v29, v27, v28
    v_mul_u32_u24 v30, 384, v26
    v_lshl_add_u32 v2, v29, 4, v30
    v_xor_b32 v3, 64, v2
    s_mul_i32 s40, s25, 6144
    s_add_u32 s40, s40, 73728
    v_lshrrev_b32 v29, 1, v27
    v_xor_b32 v29, v29, v28
    v_lshl_add_u32 v31, v29, 4, v30
    v_and_b32 v29, 1, v27
    v_lshl_add_u32 v31, v29, 3, v31
    v_xor_b32 v22, 0, v31
    v_add_u32 v22, s40, v22
    v_xor_b32 v23, 32, v31
    v_add_u32 v23, s40, v23
    v_xor_b32 v142, 64, v31
    v_add_u32 v142, s40, v142
    v_xor_b32 v143, 96, v31
    v_add_u32 v143, s40, v143
    s_lshl_b32 s24, s95, 2
    s_add_u32 s24, s24, s25
    s_mul_i32 s24, s24, 24576
    v_add_u32 v26, 0, v25
    v_mul_u32_u24 v27, 2731, v26
    v_lshrrev_b32 v27, 17, v27
    v_and_b32 v27, 7, v27
    v_xor_b32 v26, v26, v27
    v_lshlrev_b32 v136, 4, v26
    v_add_u32 v136, s24, v136
    v_add_u32 v26, 64, v25
    v_mul_u32_u24 v27, 2731, v26
    v_lshrrev_b32 v27, 17, v27
    v_and_b32 v27, 7, v27
    v_xor_b32 v26, v26, v27
    v_lshlrev_b32 v137, 4, v26
    v_add_u32 v137, s24, v137
    v_add_u32 v26, 128, v25
    v_mul_u32_u24 v27, 2731, v26
    v_lshrrev_b32 v27, 17, v27
    v_and_b32 v27, 7, v27
    v_xor_b32 v26, v26, v27
    v_lshlrev_b32 v138, 4, v26
    v_add_u32 v138, s24, v138
    v_add_u32 v26, 192, v25
    v_mul_u32_u24 v27, 2731, v26
    v_lshrrev_b32 v27, 17, v27
    v_and_b32 v27, 7, v27
    v_xor_b32 v26, v26, v27
    v_lshlrev_b32 v139, 4, v26
    v_add_u32 v139, s24, v139
    v_add_u32 v26, 256, v25
    v_mul_u32_u24 v27, 2731, v26
    v_lshrrev_b32 v27, 17, v27
    v_and_b32 v27, 7, v27
    v_xor_b32 v26, v26, v27
    v_lshlrev_b32 v140, 4, v26
    v_add_u32 v140, s24, v140
    v_add_u32 v26, 320, v25
    v_mul_u32_u24 v27, 2731, v26
    v_lshrrev_b32 v27, 17, v27
    v_and_b32 v27, 7, v27
    v_xor_b32 v26, v26, v27
    v_lshlrev_b32 v141, 4, v26
    v_add_u32 v141, s24, v141
    v_mov_b32 v5, 0
    v_mov_b32 v6, 0
    v_mov_b32 v7, 0
    v_mov_b32 v8, 0
    s_mov_b32 s62, -1
    s_mov_b32 s63, 0xffff
    s_waitcnt vmcnt(12)
    s_bitcmp0_b32 s100, 0
    s_cbranch_scc1 L_thr1
    s_waitcnt vmcnt(9)
L_thr1:
    buffer_load_dwordx3 v[80:82], v12, s[68:71], s16 offen offset:0 nt
    s_bitcmp0_b32 s100, 0
    s_cbranch_scc1 L_thr2
    s_waitcnt vmcnt(9)
L_thr2:
    buffer_load_dwordx3 v[84:86], v12, s[68:71], s16 offen offset:768 nt
    s_bitcmp0_b32 s100, 0
    s_cbranch_scc1 L_thr3
    s_waitcnt vmcnt(9)
L_thr3:
    buffer_load_dwordx3 v[88:90], v12, s[68:71], s16 offen offset:1536 nt
    s_bitcmp0_b32 s100, 0
    s_cbranch_scc1 L_thr4
    s_waitcnt vmcnt(9)
L_thr4:
    buffer_load_dwordx3 v[92:94], v12, s[68:71], s16 offen offset:2304 nt
    v_lshlrev_b32 v48, 16, v32
    v_and_b32 v49, s97, v32
    v_lshlrev_b32 v50, 16, v34
    v_and_b32 v51, s97, v34
    v_mul_f32 v48, s38, v48
    v_mul_f32 v49, s38, v49
    v_mul_f32_e64 v50, -v50, v48
    v_mul_f32_e64 v51, -v51, v49
    v_cvt_f32_i32 v224, v224
    v_cvt_f32_i32 v225, v225
    v_fma_f32 v224, v224, v48, v50
    v_fma_f32 v225, v225, v49, v51
    v_cvt_pk_bf16_f32 v224, v224, v225
    v_cvt_f32_i32 v228, v228
    v_cvt_f32_i32 v229, v229
    v_fma_f32 v228, v228, v48, v50
    v_fma_f32 v229, v229, v49, v51
    v_cvt_pk_bf16_f32 v228, v228, v229
    v_cvt_f32_i32 v232, v232
    v_cvt_f32_i32 v233, v233
    v_fma_f32 v232, v232, v48, v50
    v_fma_f32 v233, v233, v49, v51
    v_cvt_pk_bf16_f32 v232, v232, v233
    v_cvt_f32_i32 v236, v236
    v_cvt_f32_i32 v237, v237
    v_fma_f32 v236, v236, v48, v50
    v_fma_f32 v237, v237, v49, v51
    v_cvt_pk_bf16_f32 v236, v236, v237
    v_lshlrev_b32 v48, 16, v33
    v_and_b32 v49, s97, v33
    v_lshlrev_b32 v50, 16, v35
    v_and_b32 v51, s97, v35
    v_mul_f32 v48, s38, v48
    v_mul_f32 v49, s38, v49
    v_mul_f32_e64 v50, -v50, v48
    v_mul_f32_e64 v51, -v51, v49
    v_cvt_f32_i32 v226, v226
    v_cvt_f32_i32 v227, v227
    v_fma_f32 v226, v226, v48, v50
    v_fma_f32 v227, v227, v49, v51
    v_cvt_pk_bf16_f32 v225, v226, v227
    v_cvt_f32_i32 v230, v230
    v_cvt_f32_i32 v231, v231
    v_fma_f32 v230, v230, v48, v50
    v_fma_f32 v231, v231, v49, v51
    v_cvt_pk_bf16_f32 v229, v230, v231
    v_cvt_f32_i32 v234, v234
    v_cvt_f32_i32 v235, v235
    v_fma_f32 v234, v234, v48, v50
    v_fma_f32 v235, v235, v49, v51
    v_cvt_pk_bf16_f32 v233, v234, v235
    v_cvt_f32_i32 v238, v238
    v_cvt_f32_i32 v239, v239
    v_fma_f32 v238, v238, v48, v50
    v_fma_f32 v239, v239, v49, v51
    v_cvt_pk_bf16_f32 v237, v238, v239
    s_waitcnt vmcnt(12)
    v_lshlrev_b32 v48, 16, v36
    v_and_b32 v49, s97, v36
    v_lshlrev_b32 v50, 16, v38
    v_and_b32 v51, s97, v38
    v_mul_f32 v48, s38, v48
    v_mul_f32 v49, s38, v49
    v_mul_f32_e64 v50, -v50, v48
    v_mul_f32_e64 v51, -v51, v49
    v_cvt_f32_i32 v240, v240
    v_cvt_f32_i32 v241, v241
    v_fma_f32 v240, v240, v48, v50
    v_fma_f32 v241, v241, v49, v51
    v_cvt_pk_bf16_f32 v226, v240, v241
    v_cvt_f32_i32 v244, v244
    v_cvt_f32_i32 v245, v245
    v_fma_f32 v244, v244, v48, v50
    v_fma_f32 v245, v245, v49, v51
    v_cvt_pk_bf16_f32 v230, v244, v245
    v_cvt_f32_i32 v248, v248
    v_cvt_f32_i32 v249, v249
    v_fma_f32 v248, v248, v48, v50
    v_fma_f32 v249, v249, v49, v51
    v_cvt_pk_bf16_f32 v234, v248, v249
    v_cvt_f32_i32 v252, v252
    v_cvt_f32_i32 v253, v253
    v_fma_f32 v252, v252, v48, v50
    v_fma_f32 v253, v253, v49, v51
    v_cvt_pk_bf16_f32 v238, v252, v253
    v_lshlrev_b32 v48, 16, v37
    v_and_b32 v49, s97, v37
    v_lshlrev_b32 v50, 16, v39
    v_and_b32 v51, s97, v39
    v_mul_f32 v48, s38, v48
    v_mul_f32 v49, s38, v49
    v_mul_f32_e64 v50, -v50, v48
    v_mul_f32_e64 v51, -v51, v49
    v_cvt_f32_i32 v242, v242
    v_cvt_f32_i32 v243, v243
    v_fma_f32 v242, v242, v48, v50
    v_fma_f32 v243, v243, v49, v51
    v_cvt_pk_bf16_f32 v227, v242, v243
    v_cvt_f32_i32 v246, v246
    v_cvt_f32_i32 v247, v247
    v_fma_f32 v246, v246, v48, v50
    v_fma_f32 v247, v247, v49, v51
    v_cvt_pk_bf16_f32 v231, v246, v247
    v_cvt_f32_i32 v250, v250
    v_cvt_f32_i32 v251, v251
    v_fma_f32 v250, v250, v48, v50
    v_fma_f32 v251, v251, v49, v51
    v_cvt_pk_bf16_f32 v235, v250, v251
    v_cvt_f32_i32 v254, v254
    v_cvt_f32_i32 v255, v255
    v_fma_f32 v254, v254, v48, v50
    v_fma_f32 v255, v255, v49, v51
    v_cvt_pk_bf16_f32 v239, v254, v255
    buffer_store_dwordx4 v[224:227], v11, s[4:7], s33 offen offset:0
    s_mov_b64 exec, s[62:63]
    ds_write_b128 v11, v[224:227] offset:0
    s_mov_b64 exec, -1
    v_xor_b32 v55, 16, v11
    buffer_store_dwordx4 v[228:231], v55, s[4:7], s33 offen offset:768
    s_mov_b64 exec, s[62:63]
    ds_write_b128 v55, v[228:231] offset:768
    s_mov_b64 exec, -1
    v_xor_b32 v54, 32, v11
    buffer_store_dwordx4 v[232:235], v54, s[4:7], s33 offen offset:1536
    s_mov_b64 exec, s[62:63]
    ds_write_b128 v54, v[232:235] offset:1536
    s_mov_b64 exec, -1
    v_xor_b32 v55, 48, v11
    buffer_store_dwordx4 v[236:239], v55, s[4:7], s33 offen offset:2304
    s_mov_b64 exec, s[62:63]
    ds_write_b128 v55, v[236:239] offset:2304
    s_mov_b64 exec, -1
    s_mov_b32 s41, 0
    s_add_u32 m0, s40, 24576
    s_nop 0
    s_bitcmp0_b32 s100, 0
    s_cbranch_scc1 L_thr5
    s_waitcnt vmcnt(12)
L_thr5:
    buffer_load_dwordx4 v136, s[8:11], s41 offen nt lds
    s_add_u32 m0, s40, 25600
    s_nop 0
    s_bitcmp0_b32 s100, 0
    s_cbranch_scc1 L_thr6
    s_waitcnt vmcnt(9)
L_thr6:
    buffer_load_dwordx4 v137, s[8:11], s41 offen nt lds
    s_add_u32 m0, s40, 26624
    s_nop 0
    s_bitcmp0_b32 s100, 0
    s_cbranch_scc1 L_thr7
    s_waitcnt vmcnt(8)
L_thr7:
    buffer_load_dwordx4 v138, s[8:11], s41 offen nt lds
    s_add_u32 m0, s40, 27648
    s_nop 0
    s_bitcmp0_b32 s100, 0
    s_cbranch_scc1 L_thr8
    s_waitcnt vmcnt(8)
L_thr8:
    buffer_load_dwordx4 v139, s[8:11], s41 offen nt lds
    s_add_u32 m0, s40, 28672
    s_nop 0
    s_bitcmp0_b32 s100, 0
    s_cbranch_scc1 L_thr9
    s_waitcnt vmcnt(8)
L_thr9:
    buffer_load_dwordx4 v140, s[8:11], s41 offen nt lds
    s_add_u32 m0, s40, 29696
    s_waitcnt vmcnt(20)
    s_bitcmp0_b32 s100, 0
    s_cbranch_scc1 L_thr10
    s_waitcnt vmcnt(4)
L_thr10:
    buffer_load_dwordx4 v141, s[8:11], s41 offen nt lds
    s_waitcnt vmcnt(14)
    v_lshlrev_b32 v48, 16, v40
    v_and_b32 v49, s97, v40
    v_lshlrev_b32 v50, 16, v42
    v_and_b32 v51, s97, v42
    v_mul_f32_e64 v50, -v50, v48
    v_mul_f32_e64 v51, -v51, v49
    v_cvt_f32_i32 v112, v112
    v_cvt_f32_i32 v116, v116
    v_fma_f32 v112, v112, v48, v50
    v_fma_f32 v116, v116, v49, v51
    v_cvt_f32_i32 v113, v113
    v_cvt_f32_i32 v117, v117
    v_fma_f32 v113, v113, v48, v50
    v_fma_f32 v117, v117, v49, v51
    v_cvt_f32_i32 v114, v114
    v_cvt_f32_i32 v118, v118
    v_fma_f32 v114, v114, v48, v50
    v_fma_f32 v118, v118, v49, v51
    v_lshlrev_b32 v48, 16, v41
    v_and_b32 v49, s97, v41
    v_lshlrev_b32 v50, 16, v43
    v_and_b32 v51, s97, v43
    v_mul_f32_e64 v50, -v50, v48
    v_mul_f32_e64 v51, -v51, v49
    v_cvt_f32_i32 v120, v120
    v_cvt_f32_i32 v124, v124
    v_fma_f32 v120, v120, v48, v50
    v_fma_f32 v124, v124, v49, v51
    v_cvt_f32_i32 v121, v121
    v_cvt_f32_i32 v125, v125
    v_fma_f32 v121, v121, v48, v50
    v_fma_f32 v125, v125, v49, v51
    v_cvt_f32_i32 v122, v122
    v_cvt_f32_i32 v126, v126
    v_fma_f32 v122, v122, v48, v50
    v_fma_f32 v126, v126, v49, v51
    v_cvt_pk_bf16_f32 v112, v112, v116
    v_cvt_pk_bf16_f32 v116, v113, v117
    v_cvt_pk_bf16_f32 v113, v120, v124
    v_cvt_pk_bf16_f32 v117, v121, v125
    v_cvt_pk_bf16_f32 v120, v114, v118
    v_cvt_pk_bf16_f32 v121, v122, v126
    s_waitcnt vmcnt(10)
    v_lshlrev_b32 v48, 16, v44
    v_and_b32 v49, s97, v44
    v_lshlrev_b32 v50, 16, v46
    v_and_b32 v51, s97, v46
    v_mul_f32_e64 v50, -v50, v48
    v_mul_f32_e64 v51, -v51, v49
    v_cvt_f32_i32 v80, v80
    v_cvt_f32_i32 v84, v84
    v_fma_f32 v80, v80, v48, v50
    v_fma_f32 v84, v84, v49, v51
    v_cvt_f32_i32 v81, v81
    v_cvt_f32_i32 v85, v85
    v_fma_f32 v81, v81, v48, v50
    v_fma_f32 v85, v85, v49, v51
    v_cvt_f32_i32 v82, v82
    v_cvt_f32_i32 v86, v86
    v_fma_f32 v82, v82, v48, v50
    v_fma_f32 v86, v86, v49, v51
    v_lshlrev_b32 v48, 16, v45
    v_and_b32 v49, s97, v45
    v_lshlrev_b32 v50, 16, v47
    v_and_b32 v51, s97, v47
    v_mul_f32_e64 v50, -v50, v48
    v_mul_f32_e64 v51, -v51, v49
    v_cvt_f32_i32 v88, v88
    v_cvt_f32_i32 v92, v92
    v_fma_f32 v88, v88, v48, v50
    v_fma_f32 v92, v92, v49, v51
    v_cvt_f32_i32 v89, v89
    v_cvt_f32_i32 v93, v93
    v_fma_f32 v89, v89, v48, v50
    v_fma_f32 v93, v93, v49, v51
    v_cvt_f32_i32 v90, v90
    v_cvt_f32_i32 v94, v94
    v_fma_f32 v90, v90, v48, v50
    v_fma_f32 v94, v94, v49, v51
    v_cvt_pk_bf16_f32 v114, v80, v84
    v_cvt_pk_bf16_f32 v118, v81, v85
    v_cvt_pk_bf16_f32 v115, v88, v92
    v_cvt_pk_bf16_f32 v119, v89, v93
    v_cvt_pk_bf16_f32 v122, v82, v86
    v_cvt_pk_bf16_f32 v123, v90, v94
    buffer_store_dwordx4 v[112:115], v15, s[4:7], s35 offen offset:0
    buffer_store_dwordx4 v[116:119], v15, s[4:7], s35 offen offset:1024
    buffer_store_dwordx4 v[120:123], v15, s[4:7], s35 offen offset:2048
    ds_write_b128 v15, v[112:115] offset:12288
    ds_write_b128 v15, v[116:119] offset:13312
    ds_write_b128 v15, v[120:123] offset:14336
    s_bitcmp0_b32 s100, 0
    s_cbranch_scc1 L_thr11
    s_waitcnt vmcnt(7)
L_thr11:
    buffer_load_dword v0, off, s[88:91], s93 sc1
    s_mov_b32 s41, 6144
    s_add_u32 m0, s40, 0
    s_nop 0
    s_bitcmp0_b32 s100, 0
    s_cbranch_scc1 L_thr12
    s_waitcnt vmcnt(7)
L_thr12:
    buffer_load_dwordx4 v136, s[8:11], s41 offen nt lds
    s_add_u32 m0, s40, 1024
    s_nop 0
    s_bitcmp0_b32 s100, 0
    s_cbranch_scc1 L_thr13
    s_waitcnt vmcnt(7)
L_thr13:
    buffer_load_dwordx4 v137, s[8:11], s41 offen nt lds
    s_add_u32 m0, s40, 2048
    s_nop 0
    s_bitcmp0_b32 s100, 0
    s_cbranch_scc1 L_thr14
    s_waitcnt vmcnt(7)
L_thr14:
    buffer_load_dwordx4 v138, s[8:11], s41 offen nt lds
    s_add_u32 m0, s40, 3072
    s_nop 0
    s_bitcmp0_b32 s100, 0
    s_cbranch_scc1 L_thr15
    s_waitcnt vmcnt(7)
L_thr15:
    buffer_load_dwordx4 v139, s[8:11], s41 offen nt lds
    s_add_u32 m0, s40, 4096
    s_nop 0
    s_bitcmp0_b32 s100, 0
    s_cbranch_scc1 L_thr16
    s_waitcnt vmcnt(4)
L_thr16:
    buffer_load_dwordx4 v140, s[8:11], s41 offen nt lds
    s_add_u32 m0, s40, 5120
    s_waitcnt vmcnt(14)
    s_bitcmp0_b32 s100, 0
    s_cbranch_scc1 L_thr17
    s_waitcnt vmcnt(4)
L_thr17:
    buffer_load_dwordx4 v141, s[8:11], s41 offen nt lds
    s_mov_b32 s41, 12288
    s_add_u32 m0, s40, 49152
    s_waitcnt vmcnt(14)
    s_bitcmp0_b32 s100, 0
    s_cbranch_scc1 L_thr18
    s_waitcnt vmcnt(4)
L_thr18:
    buffer_load_dwordx4 v136, s[8:11], s41 offen nt lds
    s_add_u32 m0, s40, 50176
    s_waitcnt vmcnt(14)
    s_bitcmp0_b32 s100, 0
    s_cbranch_scc1 L_thr19
    s_waitcnt vmcnt(4)
L_thr19:
    buffer_load_dwordx4 v137, s[8:11], s41 offen nt lds
    s_add_u32 m0, s40, 51200
    s_waitcnt vmcnt(14)
    s_bitcmp0_b32 s100, 0
    s_cbranch_scc1 L_thr20
    s_waitcnt vmcnt(4)
L_thr20:
    buffer_load_dwordx4 v138, s[8:11], s41 offen nt lds
    s_mov_b64 exec, 0
    s_cmp_eq_u32 s25, 0
    s_cbranch_scc1 L_iw0
    s_cmp_eq_u32 s25, 1
    s_cbranch_scc1 L_iw1
    s_cmp_eq_u32 s25, 2
    s_cbranch_scc1 L_iw2
    s_branch L_iw3
L_iwret:
    s_mov_b64 exec, -1
    s_waitcnt vmcnt(9)
    s_cmp_lg_u32 s25, 0
    s_cbranch_scc1 L_tagdone
    v_readfirstlane_b32 s42, v0
    s_mov_b32 s39, 100
    s_waitcnt lgkmcnt(0)
    s_and_b32 s46, s46, 0xfffffc00
L_tagretry:
    s_cmp_eq_u32 s42, s46
    s_cselect_b32 s42, 0, s42
    s_cmp_lg_u32 s42, 0
    s_cbranch_scc1 L_tagok
    s_sub_u32 s39, s39, 1
    s_cbranch_scc1 L_tagslow
    s_sleep 4
    s_buffer_load_dword s42, s[88:91], s93 glc
    s_waitcnt lgkmcnt(0)
    s_branch L_tagretry
L_tagok:
    s_add_u32 s42, s42, s45
    v_mov_b32 v0, s42
    v_mov_b32 v16, 147456
    ds_write_b32 v16, v0
L_tagdone:
    s_waitcnt lgkmcnt(0)
    s_barrier
    v_add_u32 v0, 1, v0
    buffer_store_dword v0, v13, s[20:23], 0 offen offset:32 sc1
    v_mov_b32 v16, 147456
    ds_read_b32 v17, v16
    ds_read_b128 v[144:147], v2 offset:0
    ds_read_b128 v[148:151], v3 offset:0
    ds_read_b128 v[152:155], v2 offset:6144
    ds_read_b128 v[156:159], v3 offset:6144
    ds_read_b128 v[160:163], v2 offset:128
    ds_read_b128 v[164:167], v3 offset:128
    ds_read_b128 v[168:171], v2 offset:6272
    ds_read_b128 v[172:175], v3 offset:6272
    ds_read_b128 v[176:179], v2 offset:256
    ds_read_b128 v[180:183], v3 offset:256
    ds_read_b128 v[184:187], v2 offset:6400
    ds_read_b128 v[188:191], v3 offset:6400
    s_mov_b32 s41, 12288
    s_add_u32 m0, s40, 52224
    s_nop 0
    s_bitcmp0_b32 s100, 0
    s_cbranch_scc1 L_thr21
    s_waitcnt vmcnt(5)
L_thr21:
    buffer_load_dwordx4 v139, s[8:11], s41 offen nt lds
    s_add_u32 m0, s40, 53248
    s_nop 0
    s_bitcmp0_b32 s100, 0
    s_cbranch_scc1 L_thr22
    s_waitcnt vmcnt(5)
L_thr22:
    buffer_load_dwordx4 v140, s[8:11], s41 offen nt lds
    s_add_u32 m0, s40, 54272
    s_nop 0
    s_bitcmp0_b32 s100, 0
    s_cbranch_scc1 L_thr23
    s_waitcnt vmcnt(5)
L_thr23:
    buffer_load_dwordx4 v141, s[8:11], s41 offen nt lds
    s_waitcnt vmcnt(17)
    ds_read_b64 a[192:193], v22 offset:24576
    ds_read_b64 a[194:195], v142 offset:24704
    ds_read_b64 a[196:197], v23 offset:24576
    ds_read_b64 a[198:199], v143 offset:24704
    ds_read_b64 a[200:201], v142 offset:24576
    ds_read_b64 a[202:203], v22 offset:24832
    ds_read_b64 a[204:205], v143 offset:24576
    ds_read_b64 a[206:207], v23 offset:24832
    ds_read_b64 a[208:209], v22 offset:24704
    ds_read_b64 a[210:211], v142 offset:24832
    ds_read_b64 a[212:213], v23 offset:24704
    ds_read_b64 a[214:215], v143 offset:24832
    s_waitcnt lgkmcnt(15)
    v_readfirstlane_b32 s92, v17
    s_add_u32 s92, s92, 1
    s_waitcnt lgkmcnt(0)
    s_mov_b32 s41, 18432
    s_add_u32 m0, s40, 24576
    s_waitcnt vmcnt(12)
    s_bitcmp0_b32 s100, 0
    s_cbranch_scc1 L_thr24
    s_waitcnt vmcnt(5)
L_thr24:
    buffer_load_dwordx4 v136, s[8:11], s41 offen nt lds
    s_add_u32 m0, s40, 25600
    s_waitcnt vmcnt(12)
    s_bitcmp0_b32 s100, 0
    s_cbranch_scc1 L_thr25
    s_waitcnt vmcnt(5)
L_thr25:
    buffer_load_dwordx4 v137, s[8:11], s41 offen nt lds
    s_add_u32 m0, s40, 26624
    s_waitcnt vmcnt(12)
    s_bitcmp0_b32 s100, 0
    s_cbranch_scc1 L_thr26
    s_waitcnt vmcnt(4)
L_thr26:
    buffer_load_dwordx4 v138, s[8:11], s41 offen nt lds
    v_mfma_f32_16x16x32_bf16 v[64:67], v[144:147], a[192:195], 0
L_iw0:
L_pg0:
    s_cbranch_execz L_pg4
    v_mfma_f32_16x16x32_bf16 v[64:67], v[148:151], a[196:199], v[64:67]
    v_mfma_f32_16x16x32_bf16 v[64:67], v[160:163], a[200:203], v[64:67]
    v_mfma_f32_16x16x32_bf16 v[64:67], v[164:167], a[204:207], v[64:67]
    v_mfma_f32_16x16x32_bf16 v[64:67], v[176:179], a[208:211], v[64:67]
    v_mfma_f32_16x16x32_bf16 v[64:67], v[180:183], a[212:215], v[64:67]
    v_mfma_f32_16x16x32_bf16 v[96:99], v[152:155], a[192:195], 0
    v_mfma_f32_16x16x32_bf16 v[96:99], v[156:159], a[196:199], v[96:99]
    v_mfma_f32_16x16x32_bf16 v[96:99], v[168:171], a[200:203], v[96:99]
    v_mfma_f32_16x16x32_bf16 v[96:99], v[172:175], a[204:207], v[96:99]
    v_mfma_f32_16x16x32_bf16 v[96:99], v[184:187], a[208:211], v[96:99]
    v_mfma_f32_16x16x32_bf16 v[96:99], v[188:191], a[212:215], v[96:99]
    s_waitcnt vmcnt(10)
    ds_read_b64 a[216:217], v22 offset:0
    ds_read_b64 a[218:219], v142 offset:128
    ds_read_b64 a[220:221], v23 offset:0
    ds_read_b64 a[222:223], v143 offset:128
    ds_read_b64 a[224:225], v142 offset:0
    ds_read_b64 a[226:227], v22 offset:256
    ds_read_b64 a[228:229], v143 offset:0
    ds_read_b64 a[230:231], v23 offset:256
    ds_read_b64 a[232:233], v22 offset:128
    ds_read_b64 a[234:235], v142 offset:256
    ds_read_b64 a[236:237], v23 offset:128
    ds_read_b64 a[238:239], v143 offset:256
    s_mov_b32 s41, 18432
    s_add_u32 m0, s40, 27648
    s_nop 0
    s_bitcmp0_b32 s100, 0
    s_cbranch_scc1 L_thr27
    s_waitcnt vmcnt(4)
L_thr27:
    buffer_load_dwordx4 v139, s[8:11], s41 offen nt lds
    s_add_u32 m0, s40, 28672
    s_nop 0
    s_bitcmp0_b32 s100, 0
    s_cbranch_scc1 L_thr28
    s_waitcnt vmcnt(4)
L_thr28:
    buffer_load_dwordx4 v140, s[8:11], s41 offen nt lds
    s_add_u32 m0, s40, 29696
    s_nop 0
    s_bitcmp0_b32 s100, 0
    s_cbranch_scc1 L_thr29
    s_waitcnt vmcnt(4)
L_thr29:
    buffer_load_dwordx4 v141, s[8:11], s41 offen nt lds
    v_max3_f32 v48, v64, v65, v66
    v_max3_f32 v50, v67, v96, v97
    v_max3_f32 v48, v48, v98, v99
    v_max_f32 v48, v48, v50
    v_mov_b32 v49, v48
    s_nop 1
    v_permlane16_swap_b32 v48, v49
    s_nop 1
    v_max_f32 v48, v48, v49
    v_mov_b32 v49, v48
    s_nop 1
    v_permlane32_swap_b32 v48, v49
    s_nop 1
    v_max_f32 v48, v48, v49
    s_waitcnt lgkmcnt(0)
    v_mfma_f32_16x16x32_bf16 v[68:71], v[144:147], a[216:219], 0
    v_sub_f32 v64, v64, v48
    v_sub_f32 v65, v65, v48
    v_sub_f32 v66, v66, v48
    v_mfma_f32_16x16x32_bf16 v[68:71], v[148:151], a[220:223], v[68:71]
    v_sub_f32 v67, v67, v48
    v_sub_f32 v96, v96, v48
    v_sub_f32 v97, v97, v48
    v_mfma_f32_16x16x32_bf16 v[68:71], v[160:163], a[224:227], v[68:71]
    v_sub_f32 v98, v98, v48
    v_sub_f32 v99, v99, v48
    v_mfma_f32_16x16x32_bf16 v[68:71], v[164:167], a[228:231], v[68:71]
    v_exp_f32 v64, v64
    v_mfma_f32_16x16x32_bf16 v[68:71], v[176:179], a[232:235], v[68:71]
    v_exp_f32 v65, v65
    v_mfma_f32_16x16x32_bf16 v[68:71], v[180:183], a[236:239], v[68:71]
    v_exp_f32 v66, v66
    v_mfma_f32_16x16x32_bf16 v[100:103], v[152:155], a[216:219], 0
    v_exp_f32 v67, v67
    v_mfma_f32_16x16x32_bf16 v[100:103], v[156:159], a[220:223], v[100:103]
    v_exp_f32 v96, v96
    v_mfma_f32_16x16x32_bf16 v[100:103], v[168:171], a[224:227], v[100:103]
    v_exp_f32 v97, v97
    v_mfma_f32_16x16x32_bf16 v[100:103], v[172:175], a[228:231], v[100:103]
    v_exp_f32 v98, v98
    v_mfma_f32_16x16x32_bf16 v[100:103], v[184:187], a[232:235], v[100:103]
    v_exp_f32 v99, v99
    v_sub_f32 v128, 0, v48
    v_mfma_f32_16x16x32_bf16 v[100:103], v[188:191], a[236:239], v[100:103]
    v_sub_f32 v129, 0, v48
    v_sub_f32 v130, 0, v48
    v_sub_f32 v131, 0, v48
    v_add_f32 v5, v5, v64
    v_add_f32 v5, v5, v65
    v_add_f32 v5, v5, v66
    v_add_f32 v5, v5, v67
    v_add_f32 v5, v5, v96
    v_add_f32 v5, v5, v97
    v_add_f32 v5, v5, v98
    v_add_f32 v5, v5, v99
    v_cvt_pk_bf16_f32 v64, v64, v65
    v_cvt_pk_bf16_f32 v65, v66, v67
    v_cvt_pk_bf16_f32 v66, v96, v97
    v_cvt_pk_bf16_f32 v67, v98, v99
    s_waitcnt vmcnt(6)
    ds_read_b64 a[240:241], v22 offset:49152
    ds_read_b64 a[242:243], v142 offset:49280
    ds_read_b64 a[244:245], v23 offset:49152
    ds_read_b64 a[246:247], v143 offset:49280
    ds_read_b64 a[248:249], v142 offset:49152
    ds_read_b64 a[250:251], v22 offset:49408
    ds_read_b64 a[252:253], v143 offset:49152
    ds_read_b64 a[254:255], v23 offset:49408
    ds_read_b64 v[192:193], v22 offset:49280
    ds_read_b64 v[194:195], v142 offset:49408
    ds_read_b64 v[196:197], v23 offset:49280
    ds_read_b64 v[198:199], v143 offset:49408
    s_buffer_load_dwordx8 s[48:55], s[20:23], s44 glc
    v_max3_f32 v48, v68, v69, v70
    v_max3_f32 v50, v71, v100, v101
    v_max3_f32 v48, v48, v102, v103
    v_max_f32 v48, v48, v50
    v_mov_b32 v49, v48
    s_nop 1
    v_permlane16_swap_b32 v48, v49
    s_nop 1
    v_max_f32 v48, v48, v49
    v_mov_b32 v49, v48
    s_nop 1
    v_permlane32_swap_b32 v48, v49
    s_nop 1
    v_max_f32 v48, v48, v49
    s_waitcnt lgkmcnt(0)
    v_mfma_f32_16x16x32_bf16 v[72:75], v[144:147], a[240:243], 0
    v_sub_f32 v68, v68, v48
    v_sub_f32 v69, v69, v48
    v_sub_f32 v70, v70, v48
    v_mfma_f32_16x16x32_bf16 v[72:75], v[148:151], a[244:247], v[72:75]
    v_sub_f32 v71, v71, v48
    v_sub_f32 v100, v100, v48
    v_sub_f32 v101, v101, v48
    v_mfma_f32_16x16x32_bf16 v[72:75], v[160:163], a[248:251], v[72:75]
    v_sub_f32 v102, v102, v48
    v_sub_f32 v103, v103, v48
    v_mfma_f32_16x16x32_bf16 v[72:75], v[164:167], a[252:255], v[72:75]
    v_exp_f32 v68, v68
    v_mfma_f32_16x16x32_bf16 v[72:75], v[176:179], v[192:195], v[72:75]
    v_exp_f32 v69, v69
    v_mfma_f32_16x16x32_bf16 v[72:75], v[180:183], v[196:199], v[72:75]
    v_exp_f32 v70, v70
    v_mfma_f32_16x16x32_bf16 v[104:107], v[152:155], a[240:243], 0
    v_exp_f32 v71, v71
    v_mfma_f32_16x16x32_bf16 v[104:107], v[156:159], a[244:247], v[104:107]
    v_exp_f32 v100, v100
    v_mfma_f32_16x16x32_bf16 v[104:107], v[168:171], a[248:251], v[104:107]
    v_exp_f32 v101, v101
    v_mfma_f32_16x16x32_bf16 v[104:107], v[172:175], a[252:255], v[104:107]
    v_exp_f32 v102, v102
    v_mfma_f32_16x16x32_bf16 v[104:107], v[184:187], v[192:195], v[104:107]
    v_exp_f32 v103, v103
    v_sub_f32 v132, 0, v48
    v_mfma_f32_16x16x32_bf16 v[104:107], v[188:191], v[196:199], v[104:107]
    v_sub_f32 v133, 0, v48
    v_sub_f32 v134, 0, v48
    v_sub_f32 v135, 0, v48
    v_add_f32 v6, v6, v68
    v_add_f32 v6, v6, v69
    v_add_f32 v6, v6, v70
    v_add_f32 v6, v6, v71
    v_add_f32 v6, v6, v100
    v_add_f32 v6, v6, v101
    v_add_f32 v6, v6, v102
    v_add_f32 v6, v6, v103
    v_cvt_pk_bf16_f32 v68, v68, v69
    v_cvt_pk_bf16_f32 v69, v70, v71
    v_cvt_pk_bf16_f32 v70, v100, v101
    v_cvt_pk_bf16_f32 v71, v102, v103
    ds_read_b128 v[24:27], v1 offset:0
    ds_read_b128 v[28:31], v1 offset:1024
    ds_read_b128 v[32:35], v1 offset:2048
    ds_read_b128 v[36:39], v1 offset:3072
    s_waitcnt lgkmcnt(0)
    s_sub_u32 s48, s48, s92
    s_sub_u32 s49, s49, s92
    s_sub_u32 s50, s50, s92
    s_sub_u32 s51, s51, s92
    s_sub_u32 s52, s52, s92
    s_sub_u32 s53, s53, s92
    s_sub_u32 s54, s54, s92
    s_sub_u32 s55, s55, s92
    s_max_u32 s48, s48, s49
    s_max_u32 s48, s48, s50
    s_max_u32 s48, s48, s51
    s_max_u32 s48, s48, s52
    s_max_u32 s48, s48, s53
    s_max_u32 s48, s48, s54
    s_max_u32 s48, s48, s55
    s_cmp_ge_u32 s48, 16
    s_cbranch_scc1 L_pollslow0
L_pollok0:
    s_add_u32 s92, s92, 1
    s_mov_b32 m0, s26
    s_nop 0
    buffer_load_dwordx4 v4, s[4:7], s32 offen offset:0 sc1 lds
    buffer_load_dwordx4 v4, s[4:7], s32 offen offset:1024 sc1 lds
    buffer_load_dwordx4 v4, s[4:7], s32 offen offset:2048 sc1 lds
    s_add_u32 s32, s32, 24576
    s_sub_u32 s57, s32, 196608
    s_min_u32 s32, s32, s57
    s_add_u32 s26, s26, 36864
    s_sub_u32 s57, s26, 147456
    s_min_u32 s26, s26, s57
    s_mov_b32 m0, s26
    s_nop 0
    buffer_load_dwordx4 v4, s[4:7], s32 offen offset:0 sc1 lds
    buffer_load_dwordx4 v4, s[4:7], s32 offen offset:1024 sc1 lds
    buffer_load_dwordx4 v4, s[4:7], s32 offen offset:2048 sc1 lds
    s_add_u32 s32, s32, 24576
    s_sub_u32 s57, s32, 196608
    s_min_u32 s32, s32, s57
    s_add_u32 s26, s26, 12288
    s_mov_b32 m0, s26
    s_waitcnt vmcnt(11)
    buffer_load_dwordx4 v4, s[4:7], s32 offen offset:0 sc1 lds
    s_waitcnt vmcnt(11)
    buffer_load_dwordx4 v4, s[4:7], s32 offen offset:1024 sc1 lds
    s_waitcnt vmcnt(11)
    buffer_load_dwordx4 v4, s[4:7], s32 offen offset:2048 sc1 lds
    s_add_u32 s32, s32, 24576
    s_sub_u32 s57, s32, 196608
    s_min_u32 s32, s32, s57
    s_add_u32 s26, s26, 36864
    s_sub_u32 s57, s26, 147456
    s_min_u32 s26, s26, s57
    s_mov_b32 m0, s56
    s_waitcnt vmcnt(11)
    buffer_load_dwordx4 v4, s[4:7], s27 offen offset:0 sc1 lds
    s_waitcnt vmcnt(11)
    buffer_load_dwordx4 v4, s[4:7], s27 offen offset:1024 sc1 lds
    s_waitcnt vmcnt(11)
    buffer_load_dwordx4 v4, s[4:7], s27 offen offset:2048 sc1 lds
    s_add_u32 s27, s27, 24576
    s_sub_u32 s58, s27, 196608
    s_min_u32 s27, s27, s58
    s_add_u32 s56, s56, 36864
    s_sub_u32 s58, s56, 147456
    s_min_u32 s56, s56, s58
    s_add_u32 s33, s33, 196608
    s_add_u32 s34, s34, 196608
    s_add_u32 s36, s36, 1536
    s_add_u32 s35, s35, 196608
    s_add_u32 s16, s16, 196608
    s_add_u32 s17, s17, 196608
    s_add_u32 s37, s37, 512
    v_mfma_f32_16x16x32_bf16 a[0:3], v[64:67], v[24:27], 0
    ds_read_b128 v[40:43], v1 offset:4096
    v_max3_f32 v48, v72, v73, v74
    v_mfma_f32_16x16x32_bf16 a[4:7], v[64:67], v[28:31], 0
    v_max3_f32 v50, v75, v104, v105
    v_max3_f32 v48, v48, v106, v107
    v_mfma_f32_16x16x32_bf16 a[48:51], v[68:71], v[24:27], 0
    ds_read_b128 v[44:47], v1 offset:5120
    v_max_f32 v48, v48, v50
    v_mfma_f32_16x16x32_bf16 a[52:55], v[68:71], v[28:31], 0
    s_waitcnt lgkmcnt(2)
    v_mov_b32 v49, v48
    v_mfma_f32_16x16x32_bf16 a[8:11], v[64:67], v[32:35], 0
    s_nop 1
    ds_read_b128 v[24:27], v1 offset:6144
    v_mfma_f32_16x16x32_bf16 a[12:15], v[64:67], v[36:39], 0
    v_permlane16_swap_b32 v48, v49
    s_nop 1
    v_mfma_f32_16x16x32_bf16 a[56:59], v[68:71], v[32:35], 0
    ds_read_b128 v[28:31], v1 offset:7168
    v_max_f32 v48, v48, v49
    v_mfma_f32_16x16x32_bf16 a[60:63], v[68:71], v[36:39], 0
    s_waitcnt lgkmcnt(2)
    v_mov_b32 v49, v48
    s_nop 1
    v_mfma_f32_16x16x32_bf16 a[16:19], v[64:67], v[40:43], 0
    ds_read_b128 v[32:35], v1 offset:8192
    v_permlane32_swap_b32 v48, v49
    v_mfma_f32_16x16x32_bf16 a[20:23], v[64:67], v[44:47], 0
    s_nop 1
    v_max_f32 v48, v48, v49
    v_sub_f32 v72, v72, v48
    v_mfma_f32_16x16x32_bf16 a[64:67], v[68:71], v[40:43], 0
    ds_read_b128 v[36:39], v1 offset:9216
    v_sub_f32 v73, v73, v48
    v_mfma_f32_16x16x32_bf16 a[68:71], v[68:71], v[44:47], 0
    s_waitcnt lgkmcnt(2)
    v_sub_f32 v74, v74, v48
    v_sub_f32 v75, v75, v48
    v_sub_f32 v104, v104, v48
    v_mfma_f32_16x16x32_bf16 a[24:27], v[64:67], v[24:27], 0
    ds_read_b128 v[40:43], v1 offset:10240
    v_sub_f32 v105, v105, v48
    v_mfma_f32_16x16x32_bf16 a[28:31], v[64:67], v[28:31], 0
    v_sub_f32 v106, v106, v48
    v_sub_f32 v107, v107, v48
    v_mfma_f32_16x16x32_bf16 a[72:75], v[68:71], v[24:27], 0
    ds_read_b128 v[44:47], v1 offset:11264
    v_mfma_f32_16x16x32_bf16 a[76:79], v[68:71], v[28:31], 0
    s_waitcnt lgkmcnt(2)
    v_exp_f32 v72, v72
    v_mfma_f32_16x16x32_bf16 a[32:35], v[64:67], v[32:35], 0
    v_exp_f32 v73, v73
    v_mfma_f32_16x16x32_bf16 a[36:39], v[64:67], v[36:39], 0
    v_exp_f32 v74, v74
    v_mfma_f32_16x16x32_bf16 a[80:83], v[68:71], v[32:35], 0
    v_exp_f32 v75, v75
    v_mfma_f32_16x16x32_bf16 a[84:87], v[68:71], v[36:39], 0
    s_waitcnt lgkmcnt(0)
    v_exp_f32 v104, v104
    v_mfma_f32_16x16x32_bf16 a[40:43], v[64:67], v[40:43], 0
    v_exp_f32 v105, v105
    v_mfma_f32_16x16x32_bf16 a[44:47], v[64:67], v[44:47], 0
    v_exp_f32 v106, v106
    v_mfma_f32_16x16x32_bf16 a[88:91], v[68:71], v[40:43], 0
    v_exp_f32 v107, v107
    v_mfma_f32_16x16x32_bf16 a[92:95], v[68:71], v[44:47], 0
    v_sub_f32 v136, 0, v48
    v_sub_f32 v137, 0, v48
    v_sub_f32 v138, 0, v48
    v_sub_f32 v139, 0, v48
    v_add_f32 v7, v7, v72
    v_add_f32 v7, v7, v73
    v_add_f32 v7, v7, v74
    v_add_f32 v7, v7, v75
    v_add_f32 v7, v7, v104
    v_add_f32 v7, v7, v105
    v_add_f32 v7, v7, v106
    v_add_f32 v7, v7, v107
    v_cvt_pk_bf16_f32 v72, v72, v73
    v_cvt_pk_bf16_f32 v73, v74, v75
    v_cvt_pk_bf16_f32 v74, v104, v105
    v_cvt_pk_bf16_f32 v75, v106, v107
    s_waitcnt vmcnt(12)
    ds_read_b64 v[200:201], v22 offset:24576
    ds_read_b64 v[202:203], v142 offset:24704
    ds_read_b64 v[204:205], v23 offset:24576
    ds_read_b64 v[206:207], v143 offset:24704
    ds_read_b64 v[208:209], v142 offset:24576
    ds_read_b64 v[210:211], v22 offset:24832
    ds_read_b64 v[212:213], v143 offset:24576
    ds_read_b64 v[214:215], v23 offset:24832
    ds_read_b64 v[216:217], v22 offset:24704
    ds_read_b64 v[218:219], v142 offset:24832
    ds_read_b64 v[220:221], v23 offset:24704
    ds_read_b64 v[222:223], v143 offset:24832
    s_waitcnt lgkmcnt(0)
    v_mfma_f32_16x16x32_bf16 v[76:79], v[144:147], v[200:203], 0
    v_mfma_f32_16x16x32_bf16 v[76:79], v[148:151], v[204:207], v[76:79]
    v_mfma_f32_16x16x32_bf16 v[76:79], v[160:163], v[208:211], v[76:79]
    v_mfma_f32_16x16x32_bf16 v[76:79], v[164:167], v[212:215], v[76:79]
    v_mfma_f32_16x16x32_bf16 v[76:79], v[176:179], v[216:219], v[76:79]
    v_mfma_f32_16x16x32_bf16 v[76:79], v[180:183], v[220:223], v[76:79]
    v_mfma_f32_16x16x32_bf16 v[108:111], v[152:155], v[200:203], 0
    v_mfma_f32_16x16x32_bf16 v[108:111], v[156:159], v[204:207], v[108:111]
    v_mfma_f32_16x16x32_bf16 v[108:111], v[168:171], v[208:211], v[108:111]
    v_mfma_f32_16x16x32_bf16 v[108:111], v[172:175], v[212:215], v[108:111]
    v_mfma_f32_16x16x32_bf16 v[108:111], v[184:187], v[216:219], v[108:111]
    v_mfma_f32_16x16x32_bf16 v[108:111], v[188:191], v[220:223], v[108:111]
    s_nop 7
    v_max3_f32 v48, v76, v77, v78
    v_max3_f32 v50, v79, v108, v109
    v_max3_f32 v48, v48, v110, v111
    v_max_f32 v48, v48, v50
    v_mov_b32 v49, v48
    s_nop 1
    v_permlane16_swap_b32 v48, v49
    s_nop 1
    v_max_f32 v48, v48, v49
    v_mov_b32 v49, v48
    s_nop 1
    v_permlane32_swap_b32 v48, v49
    s_nop 1
    v_max_f32 v48, v48, v49
    v_sub_f32 v140, 0, v48
    v_sub_f32 v141, 0, v48
    v_sub_f32 v142, 0, v48
    v_sub_f32 v143, 0, v48
    s_waitcnt vmcnt(9)
    s_barrier
    ds_read_b128 v[24:27], v2 offset:12288
    ds_read_b128 v[28:31], v3 offset:12288
    ds_read_b128 v[32:35], v2 offset:18432
    ds_read_b128 v[36:39], v3 offset:18432
    s_waitcnt lgkmcnt(2)
    v_mfma_f32_16x16x32_bf16 v[80:83], v[24:27], a[192:195], v[128:131]
    ds_read_b128 v[40:43], v2 offset:12416
    v_sub_f32 v76, v76, v48
    v_mfma_f32_16x16x32_bf16 v[80:83], v[28:31], a[196:199], v[80:83]
    buffer_load_dwordx2 v[56:57], v10, s[72:75], s36 offen offset:0
    v_mfma_f32_16x16x32_bf16 v[84:87], v[28:31], a[220:223], v[132:135]
    v_sub_f32 v77, v77, v48
    v_sub_f32 v78, v78, v48
    v_mfma_f32_16x16x32_bf16 v[84:87], v[24:27], a[216:219], v[84:87]
    buffer_load_dwordx2 v[58:59], v10, s[76:79], s36 offen offset:0
    v_mfma_f32_16x16x32_bf16 v[88:91], v[24:27], a[240:243], v[136:139]
    ds_read_b128 v[44:47], v3 offset:12416
    v_sub_f32 v79, v79, v48
    v_mfma_f32_16x16x32_bf16 v[88:91], v[28:31], a[244:247], v[88:91]
    buffer_load_dwordx4 v[224:227], v9, s[64:67], s33 offen offset:0 nt
    v_mfma_f32_16x16x32_bf16 v[92:95], v[28:31], v[204:207], v[140:143]
    v_sub_f32 v108, v108, v48
    v_sub_f32 v109, v109, v48
    v_mfma_f32_16x16x32_bf16 v[92:95], v[24:27], v[200:203], v[92:95]
    s_waitcnt lgkmcnt(2)
    buffer_load_dwordx4 v[228:231], v9, s[64:67], s33 offen offset:1536 nt
    v_mfma_f32_16x16x32_bf16 v[112:115], v[32:35], a[192:195], v[128:131]
    ds_read_b128 v[24:27], v2 offset:18560
    v_sub_f32 v110, v110, v48
    v_mfma_f32_16x16x32_bf16 v[112:115], v[36:39], a[196:199], v[112:115]
    buffer_load_dwordx4 v[232:235], v9, s[64:67], s34 offen offset:0 nt
    v_mfma_f32_16x16x32_bf16 v[116:119], v[36:39], a[220:223], v[132:135]
    v_sub_f32 v111, v111, v48
    v_mfma_f32_16x16x32_bf16 v[116:119], v[32:35], a[216:219], v[116:119]
    s_waitcnt vmcnt(13)
    buffer_load_dwordx4 v[236:239], v9, s[64:67], s34 offen offset:1536 nt
    v_mfma_f32_16x16x32_bf16 v[120:123], v[32:35], a[240:243], v[136:139]
    ds_read_b128 v[28:31], v3 offset:18560
    v_mfma_f32_16x16x32_bf16 v[120:123], v[36:39], a[244:247], v[120:123]
    v_exp_f32 v76, v76
    v_mfma_f32_16x16x32_bf16 v[124:127], v[36:39], v[204:207], v[140:143]
    v_exp_f32 v77, v77
    v_mfma_f32_16x16x32_bf16 v[124:127], v[32:35], v[200:203], v[124:127]
    s_waitcnt lgkmcnt(2)
    s_waitcnt vmcnt(13)
    buffer_load_dwordx2 v[60:61], v10, s[72:75], s36 offen offset:192
    v_mfma_f32_16x16x32_bf16 v[80:83], v[40:43], a[200:203], v[80:83]
    ds_read_b128 v[32:35], v2 offset:12544
    v_mfma_f32_16x16x32_bf16 v[80:83], v[44:47], a[204:207], v[80:83]
    buffer_load_dwordx2 v[62:63], v10, s[76:79], s36 offen offset:192
    v_mfma_f32_16x16x32_bf16 v[84:87], v[44:47], a[228:231], v[84:87]
    v_exp_f32 v78, v78
    v_mfma_f32_16x16x32_bf16 v[84:87], v[40:43], a[224:227], v[84:87]
    s_waitcnt vmcnt(14)
    buffer_load_dwordx4 v[240:243], v9, s[64:67], s33 offen offset:384 nt
    v_mfma_f32_16x16x32_bf16 v[88:91], v[40:43], a[248:251], v[88:91]
    ds_read_b128 v[36:39], v3 offset:12544
    v_mfma_f32_16x16x32_bf16 v[88:91], v[44:47], a[252:255], v[88:91]
    buffer_load_dwordx4 v[244:247], v9, s[64:67], s33 offen offset:1920 nt
    v_mfma_f32_16x16x32_bf16 v[92:95], v[44:47], v[212:215], v[92:95]
    v_exp_f32 v79, v79
    v_mfma_f32_16x16x32_bf16 v[92:95], v[40:43], v[208:211], v[92:95]
    s_waitcnt lgkmcnt(2)
    v_exp_f32 v108, v108
    v_mfma_f32_16x16x32_bf16 v[112:115], v[24:27], a[200:203], v[112:115]
    ds_read_b128 v[40:43], v2 offset:18688
    v_mfma_f32_16x16x32_bf16 v[112:115], v[28:31], a[204:207], v[112:115]
    s_waitcnt vmcnt(15)
    buffer_load_dwordx4 v[248:251], v9, s[64:67], s34 offen offset:384 nt
    v_mfma_f32_16x16x32_bf16 v[116:119], v[28:31], a[228:231], v[116:119]
    v_exp_f32 v109, v109
    v_mfma_f32_16x16x32_bf16 v[116:119], v[24:27], a[224:227], v[116:119]
    s_waitcnt vmcnt(15)
    buffer_load_dwordx4 v[252:255], v9, s[64:67], s34 offen offset:1920 nt
    v_mfma_f32_16x16x32_bf16 v[120:123], v[24:27], a[248:251], v[120:123]
    ds_read_b128 v[44:47], v3 offset:18688
    v_mfma_f32_16x16x32_bf16 v[120:123], v[28:31], a[252:255], v[120:123]
    s_waitcnt lgkmcnt(2)
    v_exp_f32 v110, v110
    v_mfma_f32_16x16x32_bf16 v[124:127], v[28:31], v[212:215], v[124:127]
    s_waitcnt vmcnt(15)
    v_exp_f32 v111, v111
    v_mfma_f32_16x16x32_bf16 v[124:127], v[24:27], v[208:211], v[124:127]
    s_barrier
    v_add_u32 v2, 49152, v2
    v_add_u32 v3, 49152, v3
    v_mfma_f32_16x16x32_bf16 v[80:83], v[32:35], a[208:211], v[80:83]
    s_mov_b32 m0, s26
    ds_read_b128 v[24:27], v2 offset:0
    v_add_f32 v8, v8, v76
    v_mfma_f32_16x16x32_bf16 v[80:83], v[36:39], a[212:215], v[80:83]
    buffer_load_dwordx4 v4, s[4:7], s32 offen offset:0 sc1 lds
    v_add_f32 v8, v8, v77
    v_mfma_f32_16x16x32_bf16 v[84:87], v[36:39], a[236:239], v[84:87]
    v_add_f32 v8, v8, v78
    v_add_f32 v8, v8, v79
    v_mfma_f32_16x16x32_bf16 v[84:87], v[32:35], a[232:235], v[84:87]
    s_waitcnt vmcnt(15)
    buffer_load_dwordx4 v4, s[4:7], s32 offen offset:1024 sc1 lds
    v_add_f32 v8, v8, v108
    v_mfma_f32_16x16x32_bf16 v[88:91], v[32:35], v[192:195], v[88:91]
    ds_read_b128 v[28:31], v3 offset:0
    v_add_f32 v8, v8, v109
    v_mfma_f32_16x16x32_bf16 v[88:91], v[36:39], v[196:199], v[88:91]
    s_waitcnt vmcnt(15)
    buffer_load_dwordx4 v4, s[4:7], s32 offen offset:2048 sc1 lds
    v_add_f32 v8, v8, v110
    v_mfma_f32_16x16x32_bf16 v[92:95], v[36:39], v[220:223], v[92:95]
    s_add_u32 s32, s32, 24576
    v_add_f32 v8, v8, v111
    v_cvt_pk_bf16_f32 v76, v76, v77
    v_mfma_f32_16x16x32_bf16 v[92:95], v[32:35], v[216:219], v[92:95]
    s_waitcnt lgkmcnt(2)
    v_cvt_pk_bf16_f32 v77, v78, v79
    v_cvt_pk_bf16_f32 v78, v108, v109
    v_mfma_f32_16x16x32_bf16 v[112:115], v[40:43], a[208:211], v[112:115]
    ds_read_b128 v[32:35], v2 offset:6144
    v_cvt_pk_bf16_f32 v79, v110, v111
    v_bfe_u32 v20, v4, 4, 6
    v_lshlrev_b32 v20, 2, v20
    v_xor_b32 v21, 16, v11
    v_xor_b32 v22, 32, v11
    v_xor_b32 v23, 48, v11
    v_mfma_f32_16x16x32_bf16 v[112:115], v[44:47], a[212:215], v[112:115]
    s_sub_u32 s57, s32, 196608
    s_min_u32 s32, s32, s57
    v_mfma_f32_16x16x32_bf16 v[116:119], v[44:47], a[236:239], v[116:119]
    s_add_u32 s26, s26, 12288
    s_mov_b32 m0, s26
    v_mfma_f32_16x16x32_bf16 v[116:119], v[40:43], a[232:235], v[116:119]
    s_waitcnt vmcnt(15)
    buffer_load_dwordx4 v4, s[4:7], s32 offen offset:0 sc1 lds
    v_mfma_f32_16x16x32_bf16 v[120:123], v[40:43], v[192:195], v[120:123]
    ds_read_b128 v[36:39], v3 offset:6144
    v_mfma_f32_16x16x32_bf16 v[120:123], v[44:47], v[196:199], v[120:123]
    s_waitcnt vmcnt(14)
    buffer_load_dwordx4 v4, s[4:7], s32 offen offset:1024 sc1 lds
    v_mfma_f32_16x16x32_bf16 v[124:127], v[44:47], v[220:223], v[124:127]
    s_waitcnt vmcnt(14)
    buffer_load_dwordx4 v4, s[4:7], s32 offen offset:2048 sc1 lds
    v_mfma_f32_16x16x32_bf16 v[124:127], v[40:43], v[216:219], v[124:127]
    s_waitcnt lgkmcnt(2)
    s_add_u32 s32, s32, 24576
    s_sub_u32 s57, s32, 196608
    s_min_u32 s32, s32, s57
    s_add_u32 s26, s26, 36864
    s_sub_u32 s57, s26, 147456
    s_min_u32 s26, s26, s57
    v_mfma_f32_16x16x32_bf16 v[160:163], v[24:27], a[192:195], v[128:131]
    s_mov_b32 m0, s56
    ds_read_b128 v[40:43], v2 offset:128
    v_mfma_f32_16x16x32_bf16 v[160:163], v[28:31], a[196:199], v[160:163]
    s_waitcnt vmcnt(13)
    buffer_load_dwordx4 v4, s[4:7], s27 offen offset:0 sc1 lds
    v_mfma_f32_16x16x32_bf16 v[164:167], v[28:31], a[220:223], v[132:135]
    v_exp_f32 v16, v80
    v_mfma_f32_16x16x32_bf16 v[164:167], v[24:27], a[216:219], v[164:167]
    s_waitcnt vmcnt(13)
    buffer_load_dwordx4 v4, s[4:7], s27 offen offset:1024 sc1 lds
    v_exp_f32 v17, v81
    v_exp_f32 v18, v82
    v_add_f32 v5, v5, v16
    v_add_f32 v5, v5, v17
    v_mfma_f32_16x16x32_bf16 v[168:171], v[24:27], a[240:243], v[136:139]
    ds_read_b128 v[44:47], v3 offset:128
    v_mfma_f32_16x16x32_bf16 v[168:171], v[28:31], a[244:247], v[168:171]
    s_waitcnt vmcnt(12)
    buffer_load_dwordx4 v4, s[4:7], s27 offen offset:2048 sc1 lds
    v_exp_f32 v19, v83
    v_cvt_pk_bf16_f32 v80, v16, v17
    v_mfma_f32_16x16x32_bf16 v[172:175], v[28:31], v[204:207], v[140:143]
    s_add_u32 s27, s27, 24576
    v_exp_f32 v16, v112
    v_mfma_f32_16x16x32_bf16 v[172:175], v[24:27], v[200:203], v[172:175]
    s_waitcnt lgkmcnt(2)
    v_add_f32 v5, v5, v18
    v_add_f32 v5, v5, v19
    v_exp_f32 v17, v113
    v_cvt_pk_bf16_f32 v81, v18, v19
    s_sub_u32 s58, s27, 196608
    v_mfma_f32_16x16x32_bf16 v[96:99], v[32:35], a[192:195], v[128:131]
    s_min_u32 s27, s27, s58
    ds_read_b128 v[24:27], v2 offset:6272
    s_add_u32 s56, s56, 12288
    v_mfma_f32_16x16x32_bf16 v[96:99], v[36:39], a[196:199], v[96:99]
    s_mov_b32 m0, s56
    v_exp_f32 v18, v114
    v_add_f32 v5, v5, v16
    v_add_f32 v5, v5, v17
    v_mfma_f32_16x16x32_bf16 v[100:103], v[36:39], a[220:223], v[132:135]
    v_exp_f32 v19, v115
    v_mfma_f32_16x16x32_bf16 v[100:103], v[32:35], a[216:219], v[100:103]
    s_waitcnt vmcnt(11)
    buffer_load_dwordx4 v4, s[4:7], s27 offen offset:0 sc1 lds
    v_cvt_pk_bf16_f32 v82, v16, v17
    v_exp_f32 v16, v84
    v_add_f32 v5, v5, v18
    v_mfma_f32_16x16x32_bf16 v[104:107], v[32:35], a[240:243], v[136:139]
    ds_read_b128 v[28:31], v3 offset:6272
    v_add_f32 v5, v5, v19
    v_mfma_f32_16x16x32_bf16 v[104:107], v[36:39], a[244:247], v[104:107]
    s_waitcnt vmcnt(11)
    buffer_load_dwordx4 v4, s[4:7], s27 offen offset:1024 sc1 lds
    v_exp_f32 v17, v85
    v_cvt_pk_bf16_f32 v83, v18, v19
    v_mfma_f32_16x16x32_bf16 v[108:111], v[36:39], v[204:207], v[140:143]
    v_exp_f32 v18, v86
    v_mfma_f32_16x16x32_bf16 v[108:111], v[32:35], v[200:203], v[108:111]
    s_waitcnt lgkmcnt(2)
    s_waitcnt vmcnt(11)
    buffer_load_dwordx4 v4, s[4:7], s27 offen offset:2048 sc1 lds
    v_add_f32 v6, v6, v16
    v_add_f32 v6, v6, v17
    v_exp_f32 v19, v87
    v_mfma_f32_16x16x32_bf16 v[160:163], v[40:43], a[200:203], v[160:163]
    ds_read_b128 v[32:35], v2 offset:256
    v_cvt_pk_bf16_f32 v84, v16, v17
    v_mfma_f32_16x16x32_bf16 v[160:163], v[44:47], a[204:207], v[160:163]
    v_exp_f32 v16, v116
    v_add_f32 v6, v6, v18
    v_add_f32 v6, v6, v19
    v_mfma_f32_16x16x32_bf16 v[164:167], v[44:47], a[228:231], v[164:167]
    v_exp_f32 v17, v117
    v_mfma_f32_16x16x32_bf16 v[164:167], v[40:43], a[224:227], v[164:167]
    s_add_u32 s27, s27, 24576
    v_cvt_pk_bf16_f32 v85, v18, v19
    v_exp_f32 v18, v118
    v_add_f32 v6, v6, v16
    v_add_f32 v6, v6, v17
    s_sub_u32 s58, s27, 196608
    v_mfma_f32_16x16x32_bf16 v[168:171], v[40:43], a[248:251], v[168:171]
    s_waitcnt vmcnt(18)
    ds_read_b128 v[36:39], v3 offset:256
    v_lshlrev_b32 v48, 16, v56
    v_mfma_f32_16x16x32_bf16 v[168:171], v[44:47], a[252:255], v[168:171]
    s_waitcnt vmcnt(11)
    buffer_load_dwordx3 v[144:146], v12, s[68:71], s35 offen offset:0 nt
    v_exp_f32 v19, v119
    v_cvt_pk_bf16_f32 v86, v16, v17
    v_mfma_f32_16x16x32_bf16 v[172:175], v[44:47], v[212:215], v[172:175]
    s_min_u32 s27, s27, s58
    v_add_f32 v6, v6, v18
    v_add_f32 v6, v6, v19
    v_mfma_f32_16x16x32_bf16 v[172:175], v[40:43], v[208:211], v[172:175]
    s_waitcnt lgkmcnt(2)
    s_waitcnt vmcnt(11)
    buffer_load_dwordx3 v[148:150], v12, s[68:71], s35 offen offset:768 nt
    v_cvt_pk_bf16_f32 v87, v18, v19
    v_exp_f32 v16, v88
    v_and_b32 v49, s97, v56
    v_mfma_f32_16x16x32_bf16 v[96:99], v[24:27], a[200:203], v[96:99]
    s_add_u32 s56, s56, 36864
    ds_read_b128 v[40:43], v2 offset:6400
    v_lshlrev_b32 v50, 16, v58
    v_mfma_f32_16x16x32_bf16 v[96:99], v[28:31], a[204:207], v[96:99]
    s_waitcnt vmcnt(11)
    buffer_load_dwordx3 v[152:154], v12, s[68:71], s35 offen offset:1536 nt
    v_exp_f32 v17, v89
    v_and_b32 v51, s97, v58
    v_mfma_f32_16x16x32_bf16 v[100:103], v[28:31], a[228:231], v[100:103]
    s_sub_u32 s58, s56, 147456
    v_exp_f32 v18, v90
    v_mfma_f32_16x16x32_bf16 v[100:103], v[24:27], a[224:227], v[100:103]
    buffer_load_dwordx3 v[156:158], v12, s[68:71], s35 offen offset:2304 nt
    v_add_f32 v7, v7, v16
    v_add_f32 v7, v7, v17
    v_mul_f32 v48, s38, v48
    v_mfma_f32_16x16x32_bf16 v[104:107], v[24:27], a[248:251], v[104:107]
    s_min_u32 s56, s56, s58
    ds_read_b128 v[44:47], v3 offset:6400
    v_mul_f32 v49, s38, v49
    v_mfma_f32_16x16x32_bf16 v[104:107], v[28:31], a[252:255], v[104:107]
L_iw1:
L_pg1:
    s_cbranch_execz L_pg5
    v_exp_f32 v19, v91
    v_cvt_pk_bf16_f32 v88, v16, v17
    v_exp_f32 v16, v120
    v_mfma_f32_16x16x32_bf16 v[108:111], v[28:31], v[212:215], v[108:111]
    v_add_f32 v7, v7, v18
    v_add_f32 v7, v7, v19
    v_mfma_f32_16x16x32_bf16 v[108:111], v[24:27], v[208:211], v[108:111]
    s_waitcnt lgkmcnt(2)
    v_exp_f32 v17, v121
    v_mul_f32_e64 v50, -v50, v48
    v_mul_f32_e64 v51, -v51, v49
    v_cvt_pk_bf16_f32 v89, v18, v19
    v_cvt_f32_i32 v224, v224
    v_mfma_f32_16x16x32_bf16 v[160:163], v[32:35], a[208:211], v[160:163]
    ds_read_b128 v[24:27], v2 offset:12288
    v_cvt_f32_i32 v225, v225
    v_mfma_f32_16x16x32_bf16 v[160:163], v[36:39], a[212:215], v[160:163]
    v_exp_f32 v18, v122
    v_fma_f32 v224, v224, v48, v50
    v_add_f32 v7, v7, v16
    v_fma_f32 v225, v225, v49, v51
    v_mfma_f32_16x16x32_bf16 v[164:167], v[36:39], a[236:239], v[164:167]
    v_add_f32 v7, v7, v17
    v_cvt_pk_bf16_f32 v224, v224, v225
    v_mfma_f32_16x16x32_bf16 v[164:167], v[32:35], a[232:235], v[164:167]
    v_exp_f32 v19, v123
    v_cvt_f32_i32 v228, v228
    v_cvt_f32_i32 v229, v229
    v_cvt_pk_bf16_f32 v90, v16, v17
    v_mfma_f32_16x16x32_bf16 v[168:171], v[32:35], v[192:195], v[168:171]
    ds_read_b128 v[28:31], v3 offset:12288
    v_fma_f32 v228, v228, v48, v50
    v_mfma_f32_16x16x32_bf16 v[168:171], v[36:39], v[196:199], v[168:171]
    v_exp_f32 v16, v92
    v_fma_f32 v229, v229, v49, v51
    v_cvt_pk_bf16_f32 v228, v228, v229
    v_add_f32 v7, v7, v18
    v_mfma_f32_16x16x32_bf16 v[172:175], v[36:39], v[220:223], v[172:175]
    v_cvt_f32_i32 v232, v232
    v_add_f32 v7, v7, v19
    v_mfma_f32_16x16x32_bf16 v[172:175], v[32:35], v[216:219], v[172:175]
    s_waitcnt lgkmcnt(2)
    v_exp_f32 v17, v93
    v_cvt_f32_i32 v233, v233
    v_fma_f32 v232, v232, v48, v50
    v_fma_f32 v233, v233, v49, v51
    v_cvt_pk_bf16_f32 v91, v18, v19
    v_mfma_f32_16x16x32_bf16 v[96:99], v[40:43], a[208:211], v[96:99]
    ds_read_b128 v[32:35], v2 offset:18432
    v_cvt_pk_bf16_f32 v232, v232, v233
    v_mfma_f32_16x16x32_bf16 v[96:99], v[44:47], a[212:215], v[96:99]
    v_exp_f32 v18, v94
    v_cvt_f32_i32 v236, v236
    v_cvt_f32_i32 v237, v237
    v_add_f32 v8, v8, v16
    v_mfma_f32_16x16x32_bf16 v[100:103], v[44:47], a[236:239], v[100:103]
    v_fma_f32 v236, v236, v48, v50
    v_add_f32 v8, v8, v17
    v_mfma_f32_16x16x32_bf16 v[100:103], v[40:43], a[232:235], v[100:103]
    v_exp_f32 v19, v95
    v_fma_f32 v237, v237, v49, v51
    v_cvt_pk_bf16_f32 v236, v236, v237
    v_lshlrev_b32 v48, 16, v57
    v_mfma_f32_16x16x32_bf16 v[104:107], v[40:43], v[192:195], v[104:107]
    ds_read_b128 v[36:39], v3 offset:18432
    v_cvt_pk_bf16_f32 v92, v16, v17
    v_mfma_f32_16x16x32_bf16 v[104:107], v[44:47], v[196:199], v[104:107]
    v_exp_f32 v16, v124
    v_and_b32 v49, s97, v57
    v_lshlrev_b32 v50, 16, v59
    v_and_b32 v51, s97, v59
    v_mfma_f32_16x16x32_bf16 v[108:111], v[44:47], v[220:223], v[108:111]
    v_add_f32 v8, v8, v18
    v_mul_f32 v48, s38, v48
    v_mfma_f32_16x16x32_bf16 v[108:111], v[40:43], v[216:219], v[108:111]
    s_waitcnt lgkmcnt(2)
    v_add_f32 v8, v8, v19
    v_mul_f32 v49, s38, v49
    v_exp_f32 v17, v125
    v_mul_f32_e64 v50, -v50, v48
    v_mul_f32_e64 v51, -v51, v49
    v_mfma_f32_16x16x32_bf16 v[176:179], v[24:27], a[192:195], v[128:131]
    ds_read_b128 v[40:43], v2 offset:12416
    v_cvt_pk_bf16_f32 v93, v18, v19
    v_mfma_f32_16x16x32_bf16 v[176:179], v[28:31], a[196:199], v[176:179]
    v_exp_f32 v18, v126
    v_cvt_f32_i32 v226, v226
    v_cvt_f32_i32 v227, v227
    v_fma_f32 v226, v226, v48, v50
    v_mfma_f32_16x16x32_bf16 v[180:183], v[28:31], a[220:223], v[132:135]
    v_add_f32 v8, v8, v16
    v_fma_f32 v227, v227, v49, v51
    v_mfma_f32_16x16x32_bf16 v[180:183], v[24:27], a[216:219], v[180:183]
    v_add_f32 v8, v8, v17
    v_cvt_pk_bf16_f32 v225, v226, v227
    v_exp_f32 v19, v127
    v_cvt_f32_i32 v230, v230
    v_mfma_f32_16x16x32_bf16 v[184:187], v[24:27], a[240:243], v[136:139]
    ds_read_b128 v[44:47], v3 offset:12416
    v_cvt_f32_i32 v231, v231
    v_mfma_f32_16x16x32_bf16 v[184:187], v[28:31], a[244:247], v[184:187]
    v_cvt_pk_bf16_f32 v94, v16, v17
    v_fma_f32 v230, v230, v48, v50
    v_add_f32 v8, v8, v18
    v_fma_f32 v231, v231, v49, v51
    v_cvt_pk_bf16_f32 v229, v230, v231
    v_mfma_f32_16x16x32_bf16 v[188:191], v[28:31], v[204:207], v[140:143]
    v_add_f32 v8, v8, v19
    v_cvt_pk_bf16_f32 v95, v18, v19
    v_mfma_f32_16x16x32_bf16 v[188:191], v[24:27], v[200:203], v[188:191]
    s_waitcnt lgkmcnt(2)
    v_cvt_f32_i32 v234, v234
    v_cvt_f32_i32 v235, v235
    v_exp_f32 v16, v160
    v_fma_f32 v234, v234, v48, v50
    v_fma_f32 v235, v235, v49, v51
    v_mfma_f32_16x16x32_bf16 v[112:115], v[32:35], a[192:195], v[128:131]
    ds_read_b128 v[24:27], v2 offset:18560
    v_cvt_pk_bf16_f32 v233, v234, v235
    v_mfma_f32_16x16x32_bf16 v[112:115], v[36:39], a[196:199], v[112:115]
    v_exp_f32 v17, v161
    v_exp_f32 v18, v162
    v_add_f32 v5, v5, v16
    v_mfma_f32_16x16x32_bf16 v[116:119], v[36:39], a[220:223], v[132:135]
    v_cvt_f32_i32 v238, v238
    v_cvt_f32_i32 v239, v239
    v_mfma_f32_16x16x32_bf16 v[116:119], v[32:35], a[216:219], v[116:119]
    v_fma_f32 v238, v238, v48, v50
    v_add_f32 v5, v5, v17
    v_exp_f32 v19, v163
    v_cvt_pk_bf16_f32 v160, v16, v17
    v_mfma_f32_16x16x32_bf16 v[120:123], v[32:35], a[240:243], v[136:139]
    ds_read_b128 v[28:31], v3 offset:18560
    v_fma_f32 v239, v239, v49, v51
    v_cvt_pk_bf16_f32 v237, v238, v239
    v_mfma_f32_16x16x32_bf16 v[120:123], v[36:39], a[244:247], v[120:123]
    s_waitcnt vmcnt(16)
    v_lshlrev_b32 v48, 16, v60
    v_and_b32 v49, s97, v60
    v_lshlrev_b32 v50, 16, v62
    v_and_b32 v51, s97, v62
    v_mul_f32 v48, s38, v48
    v_mfma_f32_16x16x32_bf16 v[124:127], v[36:39], v[204:207], v[140:143]
    v_mul_f32 v49, s38, v49
    v_mul_f32_e64 v50, -v50, v48
    v_mfma_f32_16x16x32_bf16 v[124:127], v[32:35], v[200:203], v[124:127]
    s_waitcnt lgkmcnt(2)
    s_waitcnt vmcnt(12)
    buffer_load_dwordx2 v[56:57], off, s[80:83], s37 offset:0
    v_mul_f32_e64 v51, -v51, v49
    v_cvt_f32_i32 v240, v240
    v_cvt_f32_i32 v241, v241
    v_mfma_f32_16x16x32_bf16 v[176:179], v[40:43], a[200:203], v[176:179]
    ds_read_b128 v[32:35], v2 offset:12544
    v_fma_f32 v240, v240, v48, v50
    v_mfma_f32_16x16x32_bf16 v[176:179], v[44:47], a[204:207], v[176:179]
    buffer_load_dwordx2 v[58:59], off, s[84:87], s37 offset:0
    v_exp_f32 v16, v96
    v_fma_f32 v241, v241, v49, v51
    v_mfma_f32_16x16x32_bf16 v[180:183], v[44:47], a[228:231], v[180:183]
    v_cvt_pk_bf16_f32 v226, v240, v241
    v_add_f32 v5, v5, v18
    v_mfma_f32_16x16x32_bf16 v[180:183], v[40:43], a[224:227], v[180:183]
    v_cvt_f32_i32 v244, v244
    v_add_f32 v5, v5, v19
    v_cvt_f32_i32 v245, v245
    v_exp_f32 v17, v97
    v_fma_f32 v244, v244, v48, v50
    v_mfma_f32_16x16x32_bf16 v[184:187], v[40:43], a[248:251], v[184:187]
    ds_read_b128 v[36:39], v3 offset:12544
    v_fma_f32 v245, v245, v49, v51
    v_mfma_f32_16x16x32_bf16 v[184:187], v[44:47], a[252:255], v[184:187]
    v_cvt_pk_bf16_f32 v161, v18, v19
    v_cvt_pk_bf16_f32 v230, v244, v245
    v_exp_f32 v18, v98
    v_cvt_f32_i32 v248, v248
    v_mfma_f32_16x16x32_bf16 v[188:191], v[44:47], v[212:215], v[188:191]
    v_cvt_f32_i32 v249, v249
    v_add_f32 v5, v5, v16
    v_mfma_f32_16x16x32_bf16 v[188:191], v[40:43], v[208:211], v[188:191]
    s_waitcnt lgkmcnt(2)
    v_fma_f32 v248, v248, v48, v50
    v_add_f32 v5, v5, v17
    v_fma_f32 v249, v249, v49, v51
    v_exp_f32 v19, v99
    v_mfma_f32_16x16x32_bf16 v[112:115], v[24:27], a[200:203], v[112:115]
    ds_read_b128 v[40:43], v2 offset:18688
    v_cvt_pk_bf16_f32 v234, v248, v249
    v_mfma_f32_16x16x32_bf16 v[112:115], v[28:31], a[204:207], v[112:115]
    v_cvt_f32_i32 v252, v252
    v_cvt_pk_bf16_f32 v162, v16, v17
    v_cvt_f32_i32 v253, v253
    v_exp_f32 v16, v164
    v_mfma_f32_16x16x32_bf16 v[116:119], v[28:31], a[228:231], v[116:119]
    v_fma_f32 v252, v252, v48, v50
    v_fma_f32 v253, v253, v49, v51
    v_mfma_f32_16x16x32_bf16 v[116:119], v[24:27], a[224:227], v[116:119]
    v_add_f32 v5, v5, v18
    v_cvt_pk_bf16_f32 v238, v252, v253
    v_add_f32 v5, v5, v19
    v_lshlrev_b32 v48, 16, v61
    v_exp_f32 v17, v165
    v_mfma_f32_16x16x32_bf16 v[120:123], v[24:27], a[248:251], v[120:123]
    ds_read_b128 v[44:47], v3 offset:18688
    v_and_b32 v49, s97, v61
    v_mfma_f32_16x16x32_bf16 v[120:123], v[28:31], a[252:255], v[120:123]
    s_waitcnt lgkmcnt(2)
    v_lshlrev_b32 v50, 16, v63
    v_cvt_pk_bf16_f32 v163, v18, v19
    v_and_b32 v51, s97, v63
    v_exp_f32 v18, v166
    v_mfma_f32_16x16x32_bf16 v[124:127], v[28:31], v[212:215], v[124:127]
    s_waitcnt vmcnt(30)
    v_mul_f32 v48, s38, v48
    v_mul_f32 v49, s38, v49
    v_mfma_f32_16x16x32_bf16 v[124:127], v[24:27], v[208:211], v[124:127]
    s_barrier
    v_add_f32 v6, v6, v16
    v_mul_f32_e64 v50, -v50, v48
    v_add_f32 v6, v6, v17
    v_mul_f32_e64 v51, -v51, v49
    v_mfma_f32_16x16x32_bf16 v[176:179], v[32:35], a[208:211], v[176:179]
    ds_read_b128 v[24:27], v1 offset:0
    v_cvt_f32_i32 v242, v242
    v_mfma_f32_16x16x32_bf16 v[176:179], v[36:39], a[212:215], v[176:179]
    v_exp_f32 v19, v167
    v_cvt_f32_i32 v243, v243
    v_cvt_pk_bf16_f32 v164, v16, v17
    v_fma_f32 v242, v242, v48, v50
    v_mfma_f32_16x16x32_bf16 v[180:183], v[36:39], a[236:239], v[180:183]
    v_exp_f32 v16, v100
    v_mfma_f32_16x16x32_bf16 v[180:183], v[32:35], a[232:235], v[180:183]
    v_fma_f32 v243, v243, v49, v51
    v_cvt_pk_bf16_f32 v227, v242, v243
    v_add_f32 v6, v6, v18
    v_cvt_f32_i32 v246, v246
    v_add_f32 v6, v6, v19
    v_cvt_f32_i32 v247, v247
    v_mfma_f32_16x16x32_bf16 v[184:187], v[32:35], v[192:195], v[184:187]
    ds_read_b128 v[28:31], v1 offset:12288
    v_fma_f32 v246, v246, v48, v50
    v_mfma_f32_16x16x32_bf16 v[184:187], v[36:39], v[196:199], v[184:187]
    v_exp_f32 v17, v101
    v_fma_f32 v247, v247, v49, v51
    v_cvt_pk_bf16_f32 v165, v18, v19
    v_cvt_pk_bf16_f32 v231, v246, v247
    v_mfma_f32_16x16x32_bf16 v[188:191], v[36:39], v[220:223], v[188:191]
    v_exp_f32 v18, v102
    v_mfma_f32_16x16x32_bf16 v[188:191], v[32:35], v[216:219], v[188:191]
    s_waitcnt lgkmcnt(2)
    v_cvt_f32_i32 v250, v250
    v_cvt_f32_i32 v251, v251
    v_add_f32 v6, v6, v16
    v_fma_f32 v250, v250, v48, v50
    v_add_f32 v6, v6, v17
    v_mfma_f32_16x16x32_bf16 v[112:115], v[40:43], a[208:211], v[112:115]
    ds_read_b128 v[32:35], v1 offset:1024
    v_fma_f32 v251, v251, v49, v51
    v_mfma_f32_16x16x32_bf16 v[112:115], v[44:47], a[212:215], v[112:115]
    v_exp_f32 v19, v103
    v_cvt_pk_bf16_f32 v235, v250, v251
    v_cvt_f32_i32 v254, v254
    v_cvt_pk_bf16_f32 v166, v16, v17
    v_mfma_f32_16x16x32_bf16 v[116:119], v[44:47], a[236:239], v[116:119]
    v_cvt_f32_i32 v255, v255
    v_add_f32 v6, v6, v18
    v_mfma_f32_16x16x32_bf16 v[116:119], v[40:43], a[232:235], v[116:119]
    v_fma_f32 v254, v254, v48, v50
    v_add_f32 v6, v6, v19
    v_fma_f32 v255, v255, v49, v51
    v_cvt_pk_bf16_f32 v167, v18, v19
    v_cvt_pk_bf16_f32 v239, v254, v255
    v_mfma_f32_16x16x32_bf16 v[120:123], v[40:43], v[192:195], v[120:123]
    ds_read_b128 v[36:39], v1 offset:13312
    v_mfma_f32_16x16x32_bf16 v[120:123], v[44:47], v[196:199], v[120:123]
    v_mfma_f32_16x16x32_bf16 v[124:127], v[44:47], v[220:223], v[124:127]
    v_mfma_f32_16x16x32_bf16 v[124:127], v[40:43], v[216:219], v[124:127]
    s_waitcnt lgkmcnt(2)
    v_mfma_f32_16x16x32_bf16 a[144:147], v[76:79], v[24:27], 0
    ds_read_b128 v[40:43], v1 offset:2048
    v_mfma_f32_16x16x32_bf16 a[144:147], v[92:95], v[28:31], a[144:147]
    buffer_store_dwordx4 v[224:227], v11, s[4:7], s33 offen offset:0 sc1
    v_mfma_f32_16x16x32_bf16 a[96:99], v[72:75], v[24:27], 0
    v_exp_f32 v16, v168
    v_mfma_f32_16x16x32_bf16 a[96:99], v[88:91], v[28:31], a[96:99]
    ds_read_b128 v[44:47], v1 offset:14336
    v_mfma_f32_16x16x32_bf16 a[0:3], v[80:83], v[28:31], a[0:3]
    v_exp_f32 v17, v169
    v_mfma_f32_16x16x32_bf16 a[48:51], v[84:87], v[28:31], a[48:51]
    s_waitcnt lgkmcnt(2)
    v_exp_f32 v18, v170
    v_mfma_f32_16x16x32_bf16 a[148:151], v[76:79], v[32:35], 0
    ds_read_b128 v[24:27], v1 offset:3072
    v_add_f32 v7, v7, v16
    v_mfma_f32_16x16x32_bf16 a[148:151], v[92:95], v[36:39], a[148:151]
    v_add_f32 v7, v7, v17
    v_mfma_f32_16x16x32_bf16 a[100:103], v[72:75], v[32:35], 0
    v_exp_f32 v19, v171
    v_mfma_f32_16x16x32_bf16 a[100:103], v[88:91], v[36:39], a[100:103]
    ds_read_b128 v[28:31], v1 offset:15360
    v_cvt_pk_bf16_f32 v168, v16, v17
    v_mfma_f32_16x16x32_bf16 a[4:7], v[80:83], v[36:39], a[4:7]
    v_exp_f32 v16, v104
    v_mfma_f32_16x16x32_bf16 a[52:55], v[84:87], v[36:39], a[52:55]
    s_waitcnt lgkmcnt(2)
    v_add_f32 v7, v7, v18
    v_add_f32 v7, v7, v19
    v_mfma_f32_16x16x32_bf16 a[152:155], v[76:79], v[40:43], 0
    ds_read_b128 v[32:35], v1 offset:4096
    v_mfma_f32_16x16x32_bf16 a[152:155], v[92:95], v[44:47], a[152:155]
    buffer_store_dwordx4 v[228:231], v21, s[4:7], s33 offen offset:768 sc1
    v_mfma_f32_16x16x32_bf16 a[104:107], v[72:75], v[40:43], 0
    v_exp_f32 v17, v105
    v_mfma_f32_16x16x32_bf16 a[104:107], v[88:91], v[44:47], a[104:107]
    ds_read_b128 v[36:39], v1 offset:16384
    v_cvt_pk_bf16_f32 v169, v18, v19
    v_mfma_f32_16x16x32_bf16 a[8:11], v[80:83], v[44:47], a[8:11]
    v_exp_f32 v18, v106
    v_mfma_f32_16x16x32_bf16 a[56:59], v[84:87], v[44:47], a[56:59]
    s_waitcnt lgkmcnt(2)
    v_add_f32 v7, v7, v16
    v_add_f32 v7, v7, v17
    v_mfma_f32_16x16x32_bf16 a[156:159], v[76:79], v[24:27], 0
    ds_read_b128 v[40:43], v1 offset:5120
    v_mfma_f32_16x16x32_bf16 a[156:159], v[92:95], v[28:31], a[156:159]
    v_exp_f32 v19, v107
    v_cvt_pk_bf16_f32 v170, v16, v17
    v_mfma_f32_16x16x32_bf16 a[108:111], v[72:75], v[24:27], 0
    v_exp_f32 v16, v172
    v_mfma_f32_16x16x32_bf16 a[108:111], v[88:91], v[28:31], a[108:111]
    ds_read_b128 v[44:47], v1 offset:17408
    v_add_f32 v7, v7, v18
    v_add_f32 v7, v7, v19
    v_mfma_f32_16x16x32_bf16 a[12:15], v[80:83], v[28:31], a[12:15]
    v_exp_f32 v17, v173
    v_mfma_f32_16x16x32_bf16 a[60:63], v[84:87], v[28:31], a[60:63]
    s_waitcnt lgkmcnt(2)
    v_cvt_pk_bf16_f32 v171, v18, v19
    v_mfma_f32_16x16x32_bf16 a[160:163], v[76:79], v[32:35], 0
    ds_read_b128 v[24:27], v1 offset:6144
    v_mfma_f32_16x16x32_bf16 a[160:163], v[92:95], v[36:39], a[160:163]
    buffer_store_dwordx4 v[232:235], v22, s[4:7], s33 offen offset:1536 sc1
    v_mfma_f32_16x16x32_bf16 a[112:115], v[72:75], v[32:35], 0
    v_exp_f32 v18, v174
    v_mfma_f32_16x16x32_bf16 a[112:115], v[88:91], v[36:39], a[112:115]
    ds_read_b128 v[28:31], v1 offset:18432
    v_add_f32 v8, v8, v16
    v_add_f32 v8, v8, v17
    v_mfma_f32_16x16x32_bf16 a[16:19], v[80:83], v[36:39], a[16:19]
    v_exp_f32 v19, v175
    v_mfma_f32_16x16x32_bf16 a[64:67], v[84:87], v[36:39], a[64:67]
    s_waitcnt lgkmcnt(2)
    v_cvt_pk_bf16_f32 v172, v16, v17
    v_exp_f32 v16, v108
    v_mfma_f32_16x16x32_bf16 a[164:167], v[76:79], v[40:43], 0
    ds_read_b128 v[32:35], v1 offset:7168
    v_add_f32 v8, v8, v18
    v_mfma_f32_16x16x32_bf16 a[164:167], v[92:95], v[44:47], a[164:167]
    v_add_f32 v8, v8, v19
    v_exp_f32 v17, v109
    v_mfma_f32_16x16x32_bf16 a[116:119], v[72:75], v[40:43], 0
    v_cvt_pk_bf16_f32 v173, v18, v19
    v_mfma_f32_16x16x32_bf16 a[116:119], v[88:91], v[44:47], a[116:119]
    ds_read_b128 v[36:39], v1 offset:19456
    v_exp_f32 v18, v110
    v_mfma_f32_16x16x32_bf16 a[20:23], v[80:83], v[44:47], a[20:23]
    v_add_f32 v8, v8, v16
    v_add_f32 v8, v8, v17
    v_mfma_f32_16x16x32_bf16 a[68:71], v[84:87], v[44:47], a[68:71]
    s_waitcnt lgkmcnt(2)
    v_exp_f32 v19, v111
    v_mfma_f32_16x16x32_bf16 a[168:171], v[76:79], v[24:27], 0
    ds_read_b128 v[40:43], v1 offset:8192
    v_cvt_pk_bf16_f32 v174, v16, v17
    v_mfma_f32_16x16x32_bf16 a[168:171], v[92:95], v[28:31], a[168:171]
    buffer_store_dwordx4 v[236:239], v23, s[4:7], s33 offen offset:2304 sc1
    v_mfma_f32_16x16x32_bf16 a[120:123], v[72:75], v[24:27], 0
    v_add_f32 v8, v8, v18
    v_add_f32 v8, v8, v19
    v_mfma_f32_16x16x32_bf16 a[120:123], v[88:91], v[28:31], a[120:123]
    ds_read_b128 v[44:47], v1 offset:20480
    v_cvt_pk_bf16_f32 v175, v18, v19
    v_mfma_f32_16x16x32_bf16 a[24:27], v[80:83], v[28:31], a[24:27]
    v_exp_f32 v16, v176
    v_mfma_f32_16x16x32_bf16 a[72:75], v[84:87], v[28:31], a[72:75]
    s_waitcnt lgkmcnt(2)
    v_exp_f32 v17, v177
    v_mfma_f32_16x16x32_bf16 a[172:175], v[76:79], v[32:35], 0
    ds_read_b128 v[24:27], v1 offset:9216
    v_mfma_f32_16x16x32_bf16 a[172:175], v[92:95], v[36:39], a[172:175]
    v_exp_f32 v18, v178
    v_add_f32 v5, v5, v16
    v_mfma_f32_16x16x32_bf16 a[124:127], v[72:75], v[32:35], 0
    v_add_f32 v5, v5, v17
    v_mfma_f32_16x16x32_bf16 a[124:127], v[88:91], v[36:39], a[124:127]
    ds_read_b128 v[28:31], v1 offset:21504
    v_exp_f32 v19, v179
    v_mfma_f32_16x16x32_bf16 a[28:31], v[80:83], v[36:39], a[28:31]
    v_cvt_pk_bf16_f32 v176, v16, v17
    v_mfma_f32_16x16x32_bf16 a[76:79], v[84:87], v[36:39], a[76:79]
    s_waitcnt lgkmcnt(2)
    buffer_load_dwordx2 v[60:61], off, s[80:83], s37 offset:8
    v_mfma_f32_16x16x32_bf16 a[176:179], v[76:79], v[40:43], 0
    ds_read_b128 v[32:35], v1 offset:10240
    v_mfma_f32_16x16x32_bf16 a[176:179], v[92:95], v[44:47], a[176:179]
    buffer_load_dwordx2 v[62:63], off, s[84:87], s37 offset:8
    v_mfma_f32_16x16x32_bf16 a[128:131], v[72:75], v[40:43], 0
    v_exp_f32 v16, v112
    v_mfma_f32_16x16x32_bf16 a[128:131], v[88:91], v[44:47], a[128:131]
    ds_read_b128 v[36:39], v1 offset:22528
    v_add_f32 v5, v5, v18
    v_add_f32 v5, v5, v19
    v_mfma_f32_16x16x32_bf16 a[32:35], v[80:83], v[44:47], a[32:35]
    v_exp_f32 v17, v113
    v_mfma_f32_16x16x32_bf16 a[80:83], v[84:87], v[44:47], a[80:83]
    s_waitcnt lgkmcnt(2)
    s_waitcnt vmcnt(19)
    buffer_load_dwordx3 v[240:242], v12, s[68:71], s16 offen offset:0 nt
    v_cvt_pk_bf16_f32 v177, v18, v19
    v_mfma_f32_16x16x32_bf16 a[180:183], v[76:79], v[24:27], 0
    ds_read_b128 v[40:43], v1 offset:11264
    v_mfma_f32_16x16x32_bf16 a[180:183], v[92:95], v[28:31], a[180:183]
    buffer_load_dwordx3 v[244:246], v12, s[68:71], s16 offen offset:768 nt
    v_mfma_f32_16x16x32_bf16 a[132:135], v[72:75], v[24:27], 0
    v_exp_f32 v18, v114
    v_mfma_f32_16x16x32_bf16 a[132:135], v[88:91], v[28:31], a[132:135]
    s_waitcnt vmcnt(20)
    ds_read_b128 v[44:47], v1 offset:23552
    v_add_f32 v5, v5, v16
    v_add_f32 v5, v5, v17
    v_mfma_f32_16x16x32_bf16 a[36:39], v[80:83], v[28:31], a[36:39]
    v_exp_f32 v19, v115
    v_mfma_f32_16x16x32_bf16 a[84:87], v[84:87], v[28:31], a[84:87]
    s_waitcnt lgkmcnt(2)
    s_barrier
    v_add_u32 v2, 49152, v2
    v_add_u32 v3, 49152, v3
    v_mfma_f32_16x16x32_bf16 a[184:187], v[76:79], v[32:35], 0
    ds_read_b128 v[24:27], v2 offset:0
    v_cvt_pk_bf16_f32 v178, v16, v17
    v_mfma_f32_16x16x32_bf16 a[184:187], v[92:95], v[36:39], a[184:187]
    buffer_load_dwordx3 v[248:250], v12, s[68:71], s16 offen offset:1536 nt
    v_mfma_f32_16x16x32_bf16 a[136:139], v[72:75], v[32:35], 0
    v_exp_f32 v16, v180
    v_mfma_f32_16x16x32_bf16 a[136:139], v[88:91], v[36:39], a[136:139]
    ds_read_b128 v[28:31], v3 offset:0
    v_add_f32 v5, v5, v18
    v_add_f32 v5, v5, v19
    v_mfma_f32_16x16x32_bf16 a[40:43], v[80:83], v[36:39], a[40:43]
    v_exp_f32 v17, v181
    v_mfma_f32_16x16x32_bf16 a[88:91], v[84:87], v[36:39], a[88:91]
    s_waitcnt lgkmcnt(2)
    s_waitcnt vmcnt(20)
    buffer_load_dwordx3 v[252:254], v12, s[68:71], s16 offen offset:2304 nt
    v_cvt_pk_bf16_f32 v179, v18, v19
    v_mfma_f32_16x16x32_bf16 a[188:191], v[76:79], v[40:43], 0
    ds_read_b128 v[32:35], v2 offset:6144
    v_mfma_f32_16x16x32_bf16 a[188:191], v[92:95], v[44:47], a[188:191]
    v_exp_f32 v18, v182
    v_add_f32 v6, v6, v16
    v_mfma_f32_16x16x32_bf16 a[140:143], v[72:75], v[40:43], 0
    v_add_f32 v6, v6, v17
    v_mfma_f32_16x16x32_bf16 a[140:143], v[88:91], v[44:47], a[140:143]
    ds_read_b128 v[36:39], v3 offset:6144
    v_exp_f32 v19, v183
    v_mfma_f32_16x16x32_bf16 a[44:47], v[80:83], v[44:47], a[44:47]
    v_cvt_pk_bf16_f32 v180, v16, v17
    v_mfma_f32_16x16x32_bf16 a[92:95], v[84:87], v[44:47], a[92:95]
    s_waitcnt lgkmcnt(2)
    v_exp_f32 v16, v116
    v_add_f32 v6, v6, v18
    v_add_f32 v6, v6, v19
    v_exp_f32 v17, v117
    v_cvt_pk_bf16_f32 v181, v18, v19
    v_exp_f32 v18, v118
    v_add_f32 v6, v6, v16
    v_add_f32 v6, v6, v17
    v_exp_f32 v19, v119
    v_cvt_pk_bf16_f32 v182, v16, v17
    v_add_f32 v6, v6, v18
    v_add_f32 v6, v6, v19
    v_cvt_pk_bf16_f32 v183, v18, v19
    v_mfma_f32_16x16x32_bf16 v[64:67], v[24:27], a[192:195], v[128:131]
    s_waitcnt vmcnt(10)
    ds_read_b128 v[40:43], v2 offset:128
    v_lshlrev_b32 v48, 16, v56
    v_mfma_f32_16x16x32_bf16 v[64:67], v[28:31], a[196:199], v[64:67]
    v_exp_f32 v16, v184
    v_mfma_f32_16x16x32_bf16 v[68:71], v[28:31], a[220:223], v[132:135]
    v_exp_f32 v17, v185
    v_mfma_f32_16x16x32_bf16 v[68:71], v[24:27], a[216:219], v[68:71]
    v_exp_f32 v18, v186
    v_mfma_f32_16x16x32_bf16 v[72:75], v[24:27], a[240:243], v[136:139]
    ds_read_b128 v[44:47], v3 offset:128
    v_and_b32 v49, s97, v56
    v_mfma_f32_16x16x32_bf16 v[72:75], v[28:31], a[244:247], v[72:75]
    v_add_f32 v7, v7, v16
    v_add_f32 v7, v7, v17
    v_mfma_f32_16x16x32_bf16 v[76:79], v[28:31], v[204:207], v[140:143]
    v_exp_f32 v19, v187
    v_mfma_f32_16x16x32_bf16 v[76:79], v[24:27], v[200:203], v[76:79]
    s_waitcnt lgkmcnt(2)
    v_lshlrev_b32 v50, 16, v58
    v_and_b32 v51, s97, v58
    v_mfma_f32_16x16x32_bf16 v[96:99], v[32:35], a[192:195], v[128:131]
    ds_read_b128 v[24:27], v2 offset:6272
    v_cvt_pk_bf16_f32 v184, v16, v17
    v_mfma_f32_16x16x32_bf16 v[96:99], v[36:39], a[196:199], v[96:99]
    v_exp_f32 v16, v120
    v_mfma_f32_16x16x32_bf16 v[100:103], v[36:39], a[220:223], v[132:135]
    v_mul_f32_e64 v50, -v50, v48
    v_add_f32 v7, v7, v18
    v_mfma_f32_16x16x32_bf16 v[100:103], v[32:35], a[216:219], v[100:103]
    v_add_f32 v7, v7, v19
    v_mul_f32_e64 v51, -v51, v49
    v_mfma_f32_16x16x32_bf16 v[104:107], v[32:35], a[240:243], v[136:139]
    ds_read_b128 v[28:31], v3 offset:6272
    v_cvt_f32_i32 v144, v144
    v_mfma_f32_16x16x32_bf16 v[104:107], v[36:39], a[244:247], v[104:107]
    s_waitcnt lgkmcnt(2)
    v_exp_f32 v17, v121
    v_mfma_f32_16x16x32_bf16 v[108:111], v[36:39], v[204:207], v[140:143]
    s_waitcnt vmcnt(6)
    v_cvt_pk_bf16_f32 v185, v18, v19
    v_cvt_f32_i32 v148, v148
    v_mfma_f32_16x16x32_bf16 v[108:111], v[32:35], v[200:203], v[108:111]
    s_barrier
    v_mfma_f32_16x16x32_bf16 v[64:67], v[40:43], a[200:203], v[64:67]
    ds_read_b128 v[32:35], v2 offset:256
    v_add_u32 v0, 1, v0
    v_mfma_f32_16x16x32_bf16 v[64:67], v[44:47], a[204:207], v[64:67]
    buffer_store_dword v0, v13, s[20:23], 0 offen offset:32 sc1
    v_mfma_f32_16x16x32_bf16 v[68:71], v[44:47], a[228:231], v[68:71]
    s_mov_b32 m0, s26
    v_exp_f32 v18, v122
    v_mfma_f32_16x16x32_bf16 v[68:71], v[40:43], a[224:227], v[68:71]
    v_add_f32 v7, v7, v16
    v_add_f32 v7, v7, v17
    v_mfma_f32_16x16x32_bf16 v[72:75], v[40:43], a[248:251], v[72:75]
    ds_read_b128 v[36:39], v3 offset:256
    v_fma_f32 v144, v144, v48, v50
    v_mfma_f32_16x16x32_bf16 v[72:75], v[44:47], a[252:255], v[72:75]
    buffer_load_dwordx4 v4, s[4:7], s32 offen offset:0 sc1 lds
    v_mfma_f32_16x16x32_bf16 v[76:79], v[44:47], v[212:215], v[76:79]
    v_exp_f32 v19, v123
    v_mfma_f32_16x16x32_bf16 v[76:79], v[40:43], v[208:211], v[76:79]
    s_waitcnt lgkmcnt(2)
    v_cvt_pk_bf16_f32 v186, v16, v17
    v_fma_f32 v148, v148, v49, v51
    v_mfma_f32_16x16x32_bf16 v[96:99], v[24:27], a[200:203], v[96:99]
    ds_read_b128 v[40:43], v2 offset:6400
    v_cvt_f32_i32 v145, v145
    v_mfma_f32_16x16x32_bf16 v[96:99], v[28:31], a[204:207], v[96:99]
    buffer_load_dwordx4 v4, s[4:7], s32 offen offset:1024 sc1 lds
    v_mfma_f32_16x16x32_bf16 v[100:103], v[28:31], a[228:231], v[100:103]
    v_exp_f32 v16, v188
    v_mfma_f32_16x16x32_bf16 v[100:103], v[24:27], a[224:227], v[100:103]
    v_add_f32 v7, v7, v18
    v_add_f32 v7, v7, v19
    v_mfma_f32_16x16x32_bf16 v[104:107], v[24:27], a[248:251], v[104:107]
    ds_read_b128 v[44:47], v3 offset:6400
    v_cvt_f32_i32 v149, v149
    v_mfma_f32_16x16x32_bf16 v[104:107], v[28:31], a[252:255], v[104:107]
    buffer_load_dwordx4 v4, s[4:7], s32 offen offset:2048 sc1 lds
    v_mfma_f32_16x16x32_bf16 v[108:111], v[28:31], v[212:215], v[108:111]
    s_add_u32 s32, s32, 24576
    v_exp_f32 v17, v189
    v_mfma_f32_16x16x32_bf16 v[108:111], v[24:27], v[208:211], v[108:111]
    s_waitcnt lgkmcnt(2)
    v_cvt_pk_bf16_f32 v187, v18, v19
    v_fma_f32 v145, v145, v48, v50
    v_mfma_f32_16x16x32_bf16 v[64:67], v[32:35], a[208:211], v[64:67]
    s_sub_u32 s57, s32, 196608
    ds_read_b128 v[24:27], v2 offset:12288
    v_fma_f32 v149, v149, v49, v51
    v_mfma_f32_16x16x32_bf16 v[64:67], v[36:39], a[212:215], v[64:67]
    s_min_u32 s32, s32, s57
    v_exp_f32 v18, v190
    v_mfma_f32_16x16x32_bf16 v[68:71], v[36:39], a[236:239], v[68:71]
    s_add_u32 s26, s26, 12288
    v_add_f32 v8, v8, v16
    v_add_f32 v8, v8, v17
    v_mfma_f32_16x16x32_bf16 v[68:71], v[32:35], a[232:235], v[68:71]
    s_mov_b32 m0, s26
    v_exp_f32 v19, v191
    v_mfma_f32_16x16x32_bf16 v[72:75], v[32:35], v[192:195], v[72:75]
    ds_read_b128 v[28:31], v3 offset:12288
    v_cvt_pk_bf16_f32 v188, v16, v17
    v_mfma_f32_16x16x32_bf16 v[72:75], v[36:39], v[196:199], v[72:75]
    v_exp_f32 v16, v124
    v_mfma_f32_16x16x32_bf16 v[76:79], v[36:39], v[220:223], v[76:79]
    v_add_f32 v8, v8, v18
    v_add_f32 v8, v8, v19
    v_mfma_f32_16x16x32_bf16 v[76:79], v[32:35], v[216:219], v[76:79]
    s_waitcnt lgkmcnt(2)
    buffer_load_dwordx4 v4, s[4:7], s32 offen offset:0 sc1 lds
    v_mfma_f32_16x16x32_bf16 v[96:99], v[40:43], a[208:211], v[96:99]
    ds_read_b128 v[32:35], v2 offset:18432
    v_cvt_f32_i32 v146, v146
    v_mfma_f32_16x16x32_bf16 v[96:99], v[44:47], a[212:215], v[96:99]
    v_exp_f32 v17, v125
    v_mfma_f32_16x16x32_bf16 v[100:103], v[44:47], a[236:239], v[100:103]
    v_cvt_pk_bf16_f32 v189, v18, v19
    v_cvt_f32_i32 v150, v150
    v_mfma_f32_16x16x32_bf16 v[100:103], v[40:43], a[232:235], v[100:103]
    buffer_load_dwordx4 v4, s[4:7], s32 offen offset:1024 sc1 lds
    v_mfma_f32_16x16x32_bf16 v[104:107], v[40:43], v[192:195], v[104:107]
    ds_read_b128 v[36:39], v3 offset:18432
    v_fma_f32 v146, v146, v48, v50
    v_mfma_f32_16x16x32_bf16 v[104:107], v[44:47], v[196:199], v[104:107]
    v_exp_f32 v18, v126
    v_mfma_f32_16x16x32_bf16 v[108:111], v[44:47], v[220:223], v[108:111]
    v_add_f32 v8, v8, v16
    v_add_f32 v8, v8, v17
    v_mfma_f32_16x16x32_bf16 v[108:111], v[40:43], v[216:219], v[108:111]
    s_waitcnt lgkmcnt(2)
    buffer_load_dwordx4 v4, s[4:7], s32 offen offset:2048 sc1 lds
    v_mfma_f32_16x16x32_bf16 v[80:83], v[24:27], a[192:195], v[128:131]
    s_mov_b32 s32, 196608
    ds_read_b128 v[40:43], v2 offset:12416
    v_fma_f32 v150, v150, v49, v51
    v_mfma_f32_16x16x32_bf16 v[80:83], v[28:31], a[196:199], v[80:83]
    v_exp_f32 v19, v127
    v_cvt_pk_bf16_f32 v190, v16, v17
    v_mfma_f32_16x16x32_bf16 v[84:87], v[28:31], a[220:223], v[132:135]
    s_add_u32 s26, s26, 36864
    v_add_f32 v8, v8, v18
    v_add_f32 v8, v8, v19
    v_mfma_f32_16x16x32_bf16 v[84:87], v[24:27], a[216:219], v[84:87]
    s_sub_u32 s57, s26, 147456
    v_cvt_pk_bf16_f32 v191, v18, v19
    v_lshlrev_b32 v48, 16, v57
    v_mfma_f32_16x16x32_bf16 v[88:91], v[24:27], a[240:243], v[136:139]
    ds_read_b128 v[44:47], v3 offset:12416
    v_and_b32 v49, s97, v57
    v_mfma_f32_16x16x32_bf16 v[88:91], v[28:31], a[244:247], v[88:91]
    s_min_u32 s26, s26, s57
    v_exp_f32 v16, v64
    v_mfma_f32_16x16x32_bf16 v[92:95], v[28:31], v[204:207], v[140:143]
    v_exp_f32 v17, v65
    v_mfma_f32_16x16x32_bf16 v[92:95], v[24:27], v[200:203], v[92:95]
    s_waitcnt lgkmcnt(2)
    v_exp_f32 v18, v66
    v_mfma_f32_16x16x32_bf16 v[112:115], v[32:35], a[192:195], v[128:131]
L_iw2:
L_pg2:
    s_cbranch_execz L_pg6
    s_mov_b32 m0, s56
    ds_read_b128 v[24:27], v2 offset:18560
    v_lshlrev_b32 v50, 16, v59
    v_mfma_f32_16x16x32_bf16 v[112:115], v[36:39], a[196:199], v[112:115]
    v_add_f32 v5, v5, v16
    v_add_f32 v5, v5, v17
    v_mfma_f32_16x16x32_bf16 v[116:119], v[36:39], a[220:223], v[132:135]
    v_exp_f32 v19, v67
    v_mfma_f32_16x16x32_bf16 v[116:119], v[32:35], a[216:219], v[116:119]
    buffer_load_dwordx4 v4, s[4:7], s27 offen offset:0 sc1 lds
    v_mfma_f32_16x16x32_bf16 v[120:123], v[32:35], a[240:243], v[136:139]
    ds_read_b128 v[28:31], v3 offset:18560
    v_and_b32 v51, s97, v59
    v_mfma_f32_16x16x32_bf16 v[120:123], v[36:39], a[244:247], v[120:123]
    v_cvt_pk_bf16_f32 v64, v16, v17
    v_mul_f32_e64 v50, -v50, v48
    v_mfma_f32_16x16x32_bf16 v[124:127], v[36:39], v[204:207], v[140:143]
    v_exp_f32 v16, v96
    v_mfma_f32_16x16x32_bf16 v[124:127], v[32:35], v[200:203], v[124:127]
    s_waitcnt lgkmcnt(2)
    buffer_load_dwordx4 v4, s[4:7], s27 offen offset:1024 sc1 lds
    v_mfma_f32_16x16x32_bf16 v[80:83], v[40:43], a[200:203], v[80:83]
    ds_read_b128 v[32:35], v2 offset:12544
    v_add_f32 v5, v5, v18
    v_mfma_f32_16x16x32_bf16 v[80:83], v[44:47], a[204:207], v[80:83]
    v_add_f32 v5, v5, v19
    v_mul_f32_e64 v51, -v51, v49
    v_mfma_f32_16x16x32_bf16 v[84:87], v[44:47], a[228:231], v[84:87]
    v_exp_f32 v17, v97
    v_mfma_f32_16x16x32_bf16 v[84:87], v[40:43], a[224:227], v[84:87]
    s_waitcnt vmcnt(13)
    buffer_load_dwordx4 v4, s[4:7], s27 offen offset:2048 sc1 lds
    v_cvt_pk_bf16_f32 v65, v18, v19
    v_mfma_f32_16x16x32_bf16 v[88:91], v[40:43], a[248:251], v[88:91]
    s_add_u32 s27, s27, 24576
    ds_read_b128 v[36:39], v3 offset:12544
    v_cvt_f32_i32 v152, v152
    v_mfma_f32_16x16x32_bf16 v[88:91], v[44:47], a[252:255], v[88:91]
    v_exp_f32 v18, v98
    v_mfma_f32_16x16x32_bf16 v[92:95], v[44:47], v[212:215], v[92:95]
    s_sub_u32 s58, s27, 196608
    v_add_f32 v5, v5, v16
    v_add_f32 v5, v5, v17
    v_mfma_f32_16x16x32_bf16 v[92:95], v[40:43], v[208:211], v[92:95]
    s_waitcnt lgkmcnt(2)
    v_cvt_f32_i32 v156, v156
    v_fma_f32 v152, v152, v48, v50
    v_mfma_f32_16x16x32_bf16 v[112:115], v[24:27], a[200:203], v[112:115]
    s_min_u32 s27, s27, s58
    ds_read_b128 v[40:43], v2 offset:18688
    v_fma_f32 v156, v156, v49, v51
    v_mfma_f32_16x16x32_bf16 v[112:115], v[28:31], a[204:207], v[112:115]
    v_exp_f32 v19, v99
    v_cvt_pk_bf16_f32 v66, v16, v17
    v_mfma_f32_16x16x32_bf16 v[116:119], v[28:31], a[228:231], v[116:119]
    s_add_u32 s56, s56, 12288
    v_exp_f32 v16, v68
    v_mfma_f32_16x16x32_bf16 v[116:119], v[24:27], a[224:227], v[116:119]
    s_mov_b32 m0, s56
    v_add_f32 v5, v5, v18
    v_cvt_f32_i32 v153, v153
    v_mfma_f32_16x16x32_bf16 v[120:123], v[24:27], a[248:251], v[120:123]
    ds_read_b128 v[44:47], v3 offset:18688
    v_add_f32 v5, v5, v19
    v_mfma_f32_16x16x32_bf16 v[120:123], v[28:31], a[252:255], v[120:123]
    s_waitcnt lgkmcnt(2)
    v_exp_f32 v17, v69
    v_mfma_f32_16x16x32_bf16 v[124:127], v[28:31], v[212:215], v[124:127]
    s_waitcnt vmcnt(26)
    v_cvt_f32_i32 v157, v157
    v_cvt_pk_bf16_f32 v67, v18, v19
    v_mfma_f32_16x16x32_bf16 v[124:127], v[24:27], v[208:211], v[124:127]
    s_barrier
    v_add_u32 v1, 49152, v1
    v_mfma_f32_16x16x32_bf16 v[80:83], v[32:35], a[208:211], v[80:83]
    ds_read_b128 v[24:27], v1 offset:0
    v_fma_f32 v153, v153, v48, v50
    v_mfma_f32_16x16x32_bf16 v[80:83], v[36:39], a[212:215], v[80:83]
    s_waitcnt vmcnt(12)
    buffer_load_dwordx4 v4, s[4:7], s27 offen offset:0 sc1 lds
    v_mfma_f32_16x16x32_bf16 v[84:87], v[36:39], a[236:239], v[84:87]
    v_exp_f32 v18, v70
    v_mfma_f32_16x16x32_bf16 v[84:87], v[32:35], a[232:235], v[84:87]
    v_add_f32 v6, v6, v16
    v_add_f32 v6, v6, v17
    v_mfma_f32_16x16x32_bf16 v[88:91], v[32:35], v[192:195], v[88:91]
    ds_read_b128 v[28:31], v1 offset:12288
    v_fma_f32 v157, v157, v49, v51
    v_mfma_f32_16x16x32_bf16 v[88:91], v[36:39], v[196:199], v[88:91]
    s_waitcnt vmcnt(12)
    buffer_load_dwordx4 v4, s[4:7], s27 offen offset:1024 sc1 lds
    v_mfma_f32_16x16x32_bf16 v[92:95], v[36:39], v[220:223], v[92:95]
    v_exp_f32 v19, v71
    v_mfma_f32_16x16x32_bf16 v[92:95], v[32:35], v[216:219], v[92:95]
    s_waitcnt lgkmcnt(2)
    v_cvt_pk_bf16_f32 v68, v16, v17
    v_exp_f32 v16, v100
    v_mfma_f32_16x16x32_bf16 v[112:115], v[40:43], a[208:211], v[112:115]
    ds_read_b128 v[32:35], v1 offset:1024
    v_cvt_f32_i32 v154, v154
    v_mfma_f32_16x16x32_bf16 v[112:115], v[44:47], a[212:215], v[112:115]
    s_waitcnt vmcnt(12)
    buffer_load_dwordx4 v4, s[4:7], s27 offen offset:2048 sc1 lds
    v_add_f32 v6, v6, v18
    v_mfma_f32_16x16x32_bf16 v[116:119], v[44:47], a[236:239], v[116:119]
    v_add_f32 v6, v6, v19
    v_cvt_f32_i32 v158, v158
    v_mfma_f32_16x16x32_bf16 v[116:119], v[40:43], a[232:235], v[116:119]
    v_exp_f32 v17, v101
    v_cvt_pk_bf16_f32 v69, v18, v19
    v_mfma_f32_16x16x32_bf16 v[120:123], v[40:43], v[192:195], v[120:123]
    s_add_u32 s27, s27, 24576
    ds_read_b128 v[36:39], v1 offset:13312
    v_fma_f32 v154, v154, v48, v50
    v_mfma_f32_16x16x32_bf16 v[120:123], v[44:47], v[196:199], v[120:123]
    v_exp_f32 v18, v102
    v_fma_f32 v158, v158, v49, v51
    v_mfma_f32_16x16x32_bf16 v[124:127], v[44:47], v[220:223], v[124:127]
    s_sub_u32 s58, s27, 196608
    v_add_f32 v6, v6, v16
    v_add_f32 v6, v6, v17
    v_mfma_f32_16x16x32_bf16 v[124:127], v[40:43], v[216:219], v[124:127]
    s_waitcnt lgkmcnt(2)
    v_exp_f32 v19, v103
    v_cvt_pk_bf16_f32 v144, v144, v148
    v_cvt_pk_bf16_f32 v148, v145, v149
    v_cvt_pk_bf16_f32 v70, v16, v17
    s_min_u32 s27, s27, s58
    v_cvt_pk_bf16_f32 v145, v152, v156
    v_add_f32 v6, v6, v18
    s_add_u32 s56, s56, 36864
    v_cvt_pk_bf16_f32 v149, v153, v157
    v_add_f32 v6, v6, v19
    s_sub_u32 s58, s56, 147456
    v_cvt_pk_bf16_f32 v152, v146, v150
    v_cvt_pk_bf16_f32 v71, v18, v19
    s_min_u32 s56, s56, s58
    v_cvt_pk_bf16_f32 v153, v154, v158
    s_mov_b32 s31, 6
    v_mfma_f32_16x16x32_bf16 a[0:3], v[160:163], v[24:27], a[0:3]
    s_add_u32 s33, s33, 196608
    ds_read_b128 v[40:43], v1 offset:2048
    v_mfma_f32_16x16x32_bf16 a[0:3], v[176:179], v[28:31], a[0:3]
    s_add_u32 s34, s34, 196608
    v_exp_f32 v16, v72
    v_mfma_f32_16x16x32_bf16 a[48:51], v[180:183], v[28:31], a[48:51]
    s_add_u32 s36, s36, 1536
    v_exp_f32 v17, v73
    v_mfma_f32_16x16x32_bf16 a[48:51], v[164:167], v[24:27], a[48:51]
    v_exp_f32 v18, v74
    v_mfma_f32_16x16x32_bf16 a[96:99], v[168:171], v[24:27], a[96:99]
    ds_read_b128 v[44:47], v1 offset:14336
    v_add_f32 v7, v7, v16
    v_mfma_f32_16x16x32_bf16 a[96:99], v[184:187], v[28:31], a[96:99]
    s_waitcnt vmcnt(11)
    buffer_load_dwordx2 v[56:57], v10, s[72:75], s36 offen offset:0
    v_mfma_f32_16x16x32_bf16 a[144:147], v[188:191], v[28:31], a[144:147]
    v_add_f32 v7, v7, v17
    v_mfma_f32_16x16x32_bf16 a[144:147], v[172:175], v[24:27], a[144:147]
    s_waitcnt lgkmcnt(2)
    v_exp_f32 v19, v75
    v_mfma_f32_16x16x32_bf16 a[4:7], v[160:163], v[32:35], a[4:7]
    ds_read_b128 v[24:27], v1 offset:3072
    v_cvt_pk_bf16_f32 v72, v16, v17
    v_mfma_f32_16x16x32_bf16 a[4:7], v[176:179], v[36:39], a[4:7]
    buffer_load_dwordx2 v[58:59], v10, s[76:79], s36 offen offset:0
    v_mfma_f32_16x16x32_bf16 a[52:55], v[180:183], v[36:39], a[52:55]
    v_exp_f32 v16, v104
    v_mfma_f32_16x16x32_bf16 a[52:55], v[164:167], v[32:35], a[52:55]
    v_add_f32 v7, v7, v18
    v_add_f32 v7, v7, v19
    v_mfma_f32_16x16x32_bf16 a[100:103], v[168:171], v[32:35], a[100:103]
    ds_read_b128 v[28:31], v1 offset:15360
    v_mfma_f32_16x16x32_bf16 a[100:103], v[184:187], v[36:39], a[100:103]
    s_waitcnt vmcnt(12)
    buffer_load_dwordx4 v[224:227], v9, s[64:67], s33 offen offset:0 nt
    v_mfma_f32_16x16x32_bf16 a[148:151], v[188:191], v[36:39], a[148:151]
    v_exp_f32 v17, v105
    v_mfma_f32_16x16x32_bf16 a[148:151], v[172:175], v[32:35], a[148:151]
    s_waitcnt lgkmcnt(2)
    v_cvt_pk_bf16_f32 v73, v18, v19
    v_mfma_f32_16x16x32_bf16 a[8:11], v[160:163], v[40:43], a[8:11]
    ds_read_b128 v[32:35], v1 offset:4096
    v_mfma_f32_16x16x32_bf16 a[8:11], v[176:179], v[44:47], a[8:11]
    s_waitcnt vmcnt(12)
    buffer_load_dwordx4 v[228:231], v9, s[64:67], s33 offen offset:1536 nt
    v_mfma_f32_16x16x32_bf16 a[56:59], v[180:183], v[44:47], a[56:59]
    v_exp_f32 v18, v106
    v_mfma_f32_16x16x32_bf16 a[56:59], v[164:167], v[40:43], a[56:59]
    v_add_f32 v7, v7, v16
    v_add_f32 v7, v7, v17
    v_mfma_f32_16x16x32_bf16 a[104:107], v[168:171], v[40:43], a[104:107]
    s_waitcnt vmcnt(17)
    ds_read_b128 v[36:39], v1 offset:16384
    v_lshlrev_b32 v48, 16, v60
    v_mfma_f32_16x16x32_bf16 a[104:107], v[184:187], v[44:47], a[104:107]
    buffer_load_dwordx4 v[232:235], v9, s[64:67], s34 offen offset:0 nt
    v_mfma_f32_16x16x32_bf16 a[152:155], v[188:191], v[44:47], a[152:155]
    v_exp_f32 v19, v107
    v_mfma_f32_16x16x32_bf16 a[152:155], v[172:175], v[40:43], a[152:155]
    s_waitcnt lgkmcnt(2)
    v_cvt_pk_bf16_f32 v74, v16, v17
    v_and_b32 v49, s97, v60
    v_mfma_f32_16x16x32_bf16 a[12:15], v[160:163], v[24:27], a[12:15]
    ds_read_b128 v[40:43], v1 offset:5120
    v_lshlrev_b32 v50, 16, v62
    v_mfma_f32_16x16x32_bf16 a[12:15], v[176:179], v[28:31], a[12:15]
    s_waitcnt vmcnt(13)
    buffer_load_dwordx4 v[236:239], v9, s[64:67], s34 offen offset:1536 nt
    v_mfma_f32_16x16x32_bf16 a[60:63], v[180:183], v[28:31], a[60:63]
    v_exp_f32 v16, v76
    v_mfma_f32_16x16x32_bf16 a[60:63], v[164:167], v[24:27], a[60:63]
    v_add_f32 v7, v7, v18
    v_add_f32 v7, v7, v19
    v_mfma_f32_16x16x32_bf16 a[108:111], v[168:171], v[24:27], a[108:111]
    ds_read_b128 v[44:47], v1 offset:17408
    v_and_b32 v51, s97, v62
    v_mfma_f32_16x16x32_bf16 a[108:111], v[184:187], v[28:31], a[108:111]
    v_exp_f32 v17, v77
    v_mfma_f32_16x16x32_bf16 a[156:159], v[188:191], v[28:31], a[156:159]
    s_add_u32 s29, s28, 49152
    v_cvt_pk_bf16_f32 v75, v18, v19
    v_mul_f32_e64 v50, -v50, v48
    v_mfma_f32_16x16x32_bf16 a[156:159], v[172:175], v[24:27], a[156:159]
    s_waitcnt lgkmcnt(2)
    v_exp_f32 v18, v78
    v_mfma_f32_16x16x32_bf16 a[16:19], v[160:163], v[32:35], a[16:19]
    s_mov_b32 m0, s56
    ds_read_b128 v[24:27], v1 offset:6144
    v_add_f32 v8, v8, v16
    v_mfma_f32_16x16x32_bf16 a[16:19], v[176:179], v[36:39], a[16:19]
    s_sub_u32 s3, s29, 147456
    s_waitcnt vmcnt(13)
    buffer_load_dwordx4 v4, s[4:7], s27 offen offset:0 sc1 lds
    v_mfma_f32_16x16x32_bf16 a[64:67], v[180:183], v[36:39], a[64:67]
    s_min_u32 s29, s29, s3
    v_add_f32 v8, v8, v17
    v_mul_f32_e64 v51, -v51, v49
    v_mfma_f32_16x16x32_bf16 a[64:67], v[164:167], v[32:35], a[64:67]
    v_exp_f32 v19, v79
    v_mfma_f32_16x16x32_bf16 a[112:115], v[168:171], v[32:35], a[112:115]
    ds_read_b128 v[28:31], v1 offset:18432
    v_cvt_pk_bf16_f32 v76, v16, v17
    v_mfma_f32_16x16x32_bf16 a[112:115], v[184:187], v[36:39], a[112:115]
    s_waitcnt vmcnt(13)
    buffer_load_dwordx4 v4, s[4:7], s27 offen offset:1024 sc1 lds
    v_mfma_f32_16x16x32_bf16 a[160:163], v[188:191], v[36:39], a[160:163]
    s_sub_u32 s3, s29, s28
    v_exp_f32 v16, v108
    v_mfma_f32_16x16x32_bf16 a[160:163], v[172:175], v[32:35], a[160:163]
    s_waitcnt lgkmcnt(2)
    v_add_f32 v8, v8, v18
    v_add_f32 v8, v8, v19
    v_mfma_f32_16x16x32_bf16 a[20:23], v[160:163], v[40:43], a[20:23]
    ds_read_b128 v[32:35], v1 offset:7168
    v_cvt_f32_i32 v240, v240
    v_mfma_f32_16x16x32_bf16 a[20:23], v[176:179], v[44:47], a[20:23]
    buffer_load_dword v52, v20, s[20:23], s44 offen sc1
    v_mfma_f32_16x16x32_bf16 a[68:71], v[180:183], v[44:47], a[68:71]
    v_exp_f32 v17, v109
    v_mfma_f32_16x16x32_bf16 a[68:71], v[164:167], v[40:43], a[68:71]
    v_cvt_pk_bf16_f32 v77, v18, v19
    v_cvt_f32_i32 v244, v244
    v_mfma_f32_16x16x32_bf16 a[116:119], v[168:171], v[40:43], a[116:119]
    s_mov_b32 s28, s29
    ds_read_b128 v[36:39], v1 offset:19456
    v_fma_f32 v240, v240, v48, v50
    v_mfma_f32_16x16x32_bf16 a[116:119], v[184:187], v[44:47], a[116:119]
    s_waitcnt vmcnt(14)
    buffer_load_dwordx4 v4, s[4:7], s27 offen offset:2048 sc1 lds
    v_mfma_f32_16x16x32_bf16 a[164:167], v[188:191], v[44:47], a[164:167]
    s_add_u32 s27, s27, 24576
    v_exp_f32 v18, v110
    v_mfma_f32_16x16x32_bf16 a[164:167], v[172:175], v[40:43], a[164:167]
    s_waitcnt lgkmcnt(2)
    v_add_f32 v8, v8, v16
    v_add_f32 v8, v8, v17
    v_fma_f32 v244, v244, v49, v51
    v_mfma_f32_16x16x32_bf16 a[24:27], v[160:163], v[24:27], a[24:27]
    s_sub_u32 s58, s27, 196608
    ds_read_b128 v[40:43], v1 offset:8192
    v_cvt_f32_i32 v241, v241
    v_mfma_f32_16x16x32_bf16 a[24:27], v[176:179], v[28:31], a[24:27]
    v_exp_f32 v19, v111
    v_cvt_pk_bf16_f32 v78, v16, v17
    v_mfma_f32_16x16x32_bf16 a[72:75], v[180:183], v[28:31], a[72:75]
    s_min_u32 s27, s27, s58
    v_add_f32 v8, v8, v18
    v_add_f32 v8, v8, v19
    v_mfma_f32_16x16x32_bf16 a[72:75], v[164:167], v[24:27], a[72:75]
    v_cvt_f32_i32 v245, v245
    v_cvt_pk_bf16_f32 v79, v18, v19
    v_mfma_f32_16x16x32_bf16 a[120:123], v[168:171], v[24:27], a[120:123]
    s_add_u32 s56, s56, 12288
    ds_read_b128 v[44:47], v1 offset:20480
    v_fma_f32 v241, v241, v48, v50
    v_mfma_f32_16x16x32_bf16 a[120:123], v[184:187], v[28:31], a[120:123]
    v_exp_f32 v16, v80
    v_mfma_f32_16x16x32_bf16 a[168:171], v[188:191], v[28:31], a[168:171]
    s_mov_b32 m0, s56
    v_exp_f32 v17, v81
    v_mfma_f32_16x16x32_bf16 a[168:171], v[172:175], v[24:27], a[168:171]
    s_waitcnt lgkmcnt(2)
    v_fma_f32 v245, v245, v49, v51
    v_exp_f32 v18, v82
    v_mfma_f32_16x16x32_bf16 a[28:31], v[160:163], v[32:35], a[28:31]
    ds_read_b128 v[24:27], v1 offset:9216
    v_cvt_f32_i32 v242, v242
    v_mfma_f32_16x16x32_bf16 a[28:31], v[176:179], v[36:39], a[28:31]
    v_add_f32 v5, v5, v16
    v_cvt_f32_i32 v246, v246
    v_mfma_f32_16x16x32_bf16 a[76:79], v[180:183], v[36:39], a[76:79]
    v_add_f32 v5, v5, v17
    v_fma_f32 v242, v242, v48, v50
    v_mfma_f32_16x16x32_bf16 a[76:79], v[164:167], v[32:35], a[76:79]
    s_waitcnt vmcnt(14)
    buffer_load_dwordx4 v4, s[4:7], s27 offen offset:0 sc1 lds
    v_mfma_f32_16x16x32_bf16 a[124:127], v[168:171], v[32:35], a[124:127]
    ds_read_b128 v[28:31], v1 offset:21504
    v_fma_f32 v246, v246, v49, v51
    v_mfma_f32_16x16x32_bf16 a[124:127], v[184:187], v[36:39], a[124:127]
    v_exp_f32 v19, v83
    v_cvt_pk_bf16_f32 v80, v16, v17
    v_mfma_f32_16x16x32_bf16 a[172:175], v[188:191], v[36:39], a[172:175]
    v_exp_f32 v16, v112
    v_mfma_f32_16x16x32_bf16 a[172:175], v[172:175], v[32:35], a[172:175]
    s_waitcnt lgkmcnt(2)
    s_waitcnt vmcnt(14)
    buffer_load_dwordx4 v4, s[4:7], s27 offen offset:1024 sc1 lds
    v_add_f32 v5, v5, v18
    v_mfma_f32_16x16x32_bf16 a[32:35], v[160:163], v[40:43], a[32:35]
    ds_read_b128 v[32:35], v1 offset:10240
    v_lshlrev_b32 v48, 16, v61
    v_mfma_f32_16x16x32_bf16 a[32:35], v[176:179], v[44:47], a[32:35]
    v_add_f32 v5, v5, v19
    v_exp_f32 v17, v113
    v_mfma_f32_16x16x32_bf16 a[80:83], v[180:183], v[44:47], a[80:83]
    v_and_b32 v49, s97, v61
    v_cvt_pk_bf16_f32 v81, v18, v19
    v_mfma_f32_16x16x32_bf16 a[80:83], v[164:167], v[40:43], a[80:83]
    s_waitcnt vmcnt(14)
    buffer_load_dwordx4 v4, s[4:7], s27 offen offset:2048 sc1 lds
    v_lshlrev_b32 v50, 16, v63
    v_mfma_f32_16x16x32_bf16 a[128:131], v[168:171], v[40:43], a[128:131]
    ds_read_b128 v[36:39], v1 offset:22528
    v_and_b32 v51, s97, v63
    v_mfma_f32_16x16x32_bf16 a[128:131], v[184:187], v[44:47], a[128:131]
    v_exp_f32 v18, v114
    v_add_f32 v5, v5, v16
    v_mfma_f32_16x16x32_bf16 a[176:179], v[188:191], v[44:47], a[176:179]
    v_add_u32 v2, s3, v2
    v_add_u32 v3, s3, v3
    v_mfma_f32_16x16x32_bf16 a[176:179], v[172:175], v[40:43], a[176:179]
    s_waitcnt lgkmcnt(2)
    v_add_f32 v5, v5, v17
    v_exp_f32 v19, v115
    v_mfma_f32_16x16x32_bf16 a[36:39], v[160:163], v[24:27], a[36:39]
    ds_read_b128 v[40:43], v1 offset:11264
    v_mul_f32_e64 v50, -v50, v48
    v_mfma_f32_16x16x32_bf16 a[36:39], v[176:179], v[28:31], a[36:39]
    v_cvt_pk_bf16_f32 v82, v16, v17
    v_mul_f32_e64 v51, -v51, v49
    v_mfma_f32_16x16x32_bf16 a[84:87], v[180:183], v[28:31], a[84:87]
    v_exp_f32 v16, v84
    v_mfma_f32_16x16x32_bf16 a[84:87], v[164:167], v[24:27], a[84:87]
    v_cvt_f32_i32 v248, v248
    v_add_f32 v5, v5, v18
    v_cvt_f32_i32 v252, v252
    v_mfma_f32_16x16x32_bf16 a[132:135], v[168:171], v[24:27], a[132:135]
    s_mov_b32 s27, 208896
    ds_read_b128 v[44:47], v1 offset:23552
    v_add_f32 v5, v5, v19
    v_mfma_f32_16x16x32_bf16 a[132:135], v[184:187], v[28:31], a[132:135]
    s_waitcnt lgkmcnt(2)
    v_exp_f32 v17, v85
    v_fma_f32 v248, v248, v48, v50
    v_mfma_f32_16x16x32_bf16 a[180:183], v[188:191], v[28:31], a[180:183]
    s_waitcnt vmcnt(19)
    v_cvt_pk_bf16_f32 v83, v18, v19
    v_fma_f32 v252, v252, v49, v51
    v_mfma_f32_16x16x32_bf16 a[180:183], v[172:175], v[24:27], a[180:183]
    s_barrier
    v_mfma_f32_16x16x32_bf16 a[40:43], v[160:163], v[32:35], a[40:43]
    s_add_u32 s56, s56, 36864
    ds_read_b128 v[24:27], v2 offset:0
    v_cvt_f32_i32 v249, v249
    v_mfma_f32_16x16x32_bf16 a[40:43], v[176:179], v[36:39], a[40:43]
    v_exp_f32 v18, v86
    v_add_f32 v6, v6, v16
    v_mfma_f32_16x16x32_bf16 a[88:91], v[180:183], v[36:39], a[88:91]
    s_sub_u32 s58, s56, 147456
    v_add_f32 v6, v6, v17
    v_cvt_f32_i32 v253, v253
    v_mfma_f32_16x16x32_bf16 a[88:91], v[164:167], v[32:35], a[88:91]
    s_min_u32 s56, s56, s58
    v_exp_f32 v19, v87
    v_mfma_f32_16x16x32_bf16 a[136:139], v[168:171], v[32:35], a[136:139]
    ds_read_b128 v[28:31], v3 offset:0
    v_fma_f32 v249, v249, v48, v50
    v_mfma_f32_16x16x32_bf16 a[136:139], v[184:187], v[36:39], a[136:139]
    v_cvt_pk_bf16_f32 v84, v16, v17
    v_exp_f32 v16, v116
    v_mfma_f32_16x16x32_bf16 a[184:187], v[188:191], v[36:39], a[184:187]
    v_fma_f32 v253, v253, v49, v51
    v_add_f32 v6, v6, v18
    v_mfma_f32_16x16x32_bf16 a[184:187], v[172:175], v[32:35], a[184:187]
    s_waitcnt lgkmcnt(2)
    v_cvt_f32_i32 v250, v250
    v_add_f32 v6, v6, v19
    v_mfma_f32_16x16x32_bf16 a[44:47], v[160:163], v[40:43], a[44:47]
    ds_read_b128 v[32:35], v2 offset:6144
    v_cvt_f32_i32 v254, v254
    v_mfma_f32_16x16x32_bf16 a[44:47], v[176:179], v[44:47], a[44:47]
    v_exp_f32 v17, v117
    v_mfma_f32_16x16x32_bf16 a[92:95], v[180:183], v[44:47], a[92:95]
    v_cvt_pk_bf16_f32 v85, v18, v19
    v_fma_f32 v250, v250, v48, v50
    v_mfma_f32_16x16x32_bf16 a[92:95], v[164:167], v[40:43], a[92:95]
    v_exp_f32 v18, v118
    v_mfma_f32_16x16x32_bf16 a[140:143], v[168:171], v[40:43], a[140:143]
    s_nop 0
    ds_read_b128 v[36:39], v3 offset:6144
    v_fma_f32 v254, v254, v49, v51
    v_mfma_f32_16x16x32_bf16 a[140:143], v[184:187], v[44:47], a[140:143]
    v_add_f32 v6, v6, v16
    v_add_f32 v6, v6, v17
    v_mfma_f32_16x16x32_bf16 a[188:191], v[188:191], v[44:47], a[188:191]
    s_waitcnt lgkmcnt(2)
    v_exp_f32 v19, v119
    v_cvt_pk_bf16_f32 v146, v240, v244
    v_cvt_pk_bf16_f32 v150, v241, v245
    v_cvt_pk_bf16_f32 v86, v16, v17
    v_cvt_pk_bf16_f32 v147, v248, v252
    v_add_f32 v6, v6, v18
    v_cvt_pk_bf16_f32 v151, v249, v253
    v_add_f32 v6, v6, v19
    v_cvt_pk_bf16_f32 v154, v242, v246
    v_cvt_pk_bf16_f32 v87, v18, v19
    v_cvt_pk_bf16_f32 v155, v250, v254
    v_mfma_f32_16x16x32_bf16 a[188:191], v[172:175], v[40:43], a[188:191]
    s_branch L_join
.p2align 6
L_loop:
    v_mfma_f32_16x16x32_bf16 v[160:163], v[24:27], a[192:195], v[128:131]
    s_mov_b32 m0, s56
    ds_read_b128 v[40:43], v2 offset:128
    v_cvt_f32_i32 v247, v247
    v_mfma_f32_16x16x32_bf16 v[160:163], v[28:31], a[196:199], v[160:163]
    buffer_load_dwordx4 v4, s[4:7], s27 offen offset:0 sc1 lds
    v_mfma_f32_16x16x32_bf16 v[164:167], v[28:31], a[220:223], v[132:135]
    v_exp_f32 v16, v88
    v_mfma_f32_16x16x32_bf16 v[164:167], v[24:27], a[216:219], v[164:167]
    v_exp_f32 v17, v89
    v_mfma_f32_16x16x32_bf16 v[168:171], v[24:27], a[240:243], v[136:139]
    ds_read_b128 v[44:47], v3 offset:128
    v_fma_f32 v246, v246, v48, v50
    v_mfma_f32_16x16x32_bf16 v[168:171], v[28:31], a[244:247], v[168:171]
    v_exp_f32 v18, v90
    v_mfma_f32_16x16x32_bf16 v[172:175], v[28:31], v[204:207], v[140:143]
    v_fma_f32 v247, v247, v49, v51
    v_add_f32 v7, v7, v16
    v_mfma_f32_16x16x32_bf16 v[172:175], v[24:27], v[200:203], v[172:175]
    s_waitcnt lgkmcnt(2)
    v_add_f32 v7, v7, v17
    v_cvt_pk_bf16_f32 v231, v246, v247
    v_mfma_f32_16x16x32_bf16 v[96:99], v[32:35], a[192:195], v[128:131]
    ds_read_b128 v[24:27], v2 offset:6272
    v_cvt_f32_i32 v250, v250
    v_mfma_f32_16x16x32_bf16 v[96:99], v[36:39], a[196:199], v[96:99]
    buffer_load_dwordx4 v4, s[4:7], s27 offen offset:1024 sc1 lds
    v_mfma_f32_16x16x32_bf16 v[100:103], v[36:39], a[220:223], v[132:135]
    v_exp_f32 v19, v91
    v_mfma_f32_16x16x32_bf16 v[100:103], v[32:35], a[216:219], v[100:103]
    v_cvt_pk_bf16_f32 v88, v16, v17
    v_cvt_f32_i32 v251, v251
    v_mfma_f32_16x16x32_bf16 v[104:107], v[32:35], a[240:243], v[136:139]
    ds_read_b128 v[28:31], v3 offset:6272
    v_fma_f32 v250, v250, v48, v50
    v_mfma_f32_16x16x32_bf16 v[104:107], v[36:39], a[244:247], v[104:107]
    v_exp_f32 v16, v120
    v_mfma_f32_16x16x32_bf16 v[108:111], v[36:39], v[204:207], v[140:143]
    v_add_f32 v7, v7, v18
    v_add_f32 v7, v7, v19
    v_mfma_f32_16x16x32_bf16 v[108:111], v[32:35], v[200:203], v[108:111]
    s_waitcnt lgkmcnt(2)
    v_exp_f32 v17, v121
    v_mfma_f32_16x16x32_bf16 v[160:163], v[40:43], a[200:203], v[160:163]
    ds_read_b128 v[32:35], v2 offset:256
    v_cvt_pk_bf16_f32 v89, v18, v19
    v_mfma_f32_16x16x32_bf16 v[160:163], v[44:47], a[204:207], v[160:163]
    v_exp_f32 v18, v122
    v_mfma_f32_16x16x32_bf16 v[164:167], v[44:47], a[228:231], v[164:167]
    v_fma_f32 v251, v251, v49, v51
    v_add_f32 v7, v7, v16
    v_mfma_f32_16x16x32_bf16 v[164:167], v[40:43], a[224:227], v[164:167]
    buffer_load_dwordx4 v4, s[4:7], s27 offen offset:2048 sc1 lds
    v_mfma_f32_16x16x32_bf16 v[168:171], v[40:43], a[248:251], v[168:171]
    ds_read_b128 v[36:39], v3 offset:256
    v_cvt_pk_bf16_f32 v235, v250, v251
    v_mfma_f32_16x16x32_bf16 v[168:171], v[44:47], a[252:255], v[168:171]
    v_add_f32 v7, v7, v17
    v_cvt_f32_i32 v254, v254
    v_mfma_f32_16x16x32_bf16 v[172:175], v[44:47], v[212:215], v[172:175]
    v_exp_f32 v19, v123
    v_mfma_f32_16x16x32_bf16 v[172:175], v[40:43], v[208:211], v[172:175]
    s_waitcnt lgkmcnt(2)
    v_cvt_pk_bf16_f32 v90, v16, v17
    v_cvt_f32_i32 v255, v255
    v_mfma_f32_16x16x32_bf16 v[96:99], v[24:27], a[200:203], v[96:99]
    ds_read_b128 v[40:43], v2 offset:6400
    v_fma_f32 v254, v254, v48, v50
    v_mfma_f32_16x16x32_bf16 v[96:99], v[28:31], a[204:207], v[96:99]
    s_add_u32 s27, s27, 24576
    v_exp_f32 v16, v92
    v_mfma_f32_16x16x32_bf16 v[100:103], v[28:31], a[228:231], v[100:103]
    v_add_f32 v7, v7, v18
    v_add_f32 v7, v7, v19
    v_mfma_f32_16x16x32_bf16 v[100:103], v[24:27], a[224:227], v[100:103]
    v_exp_f32 v17, v93
    v_mfma_f32_16x16x32_bf16 v[104:107], v[24:27], a[248:251], v[104:107]
    ds_read_b128 v[44:47], v3 offset:6400
    v_fma_f32 v255, v255, v49, v51
    v_mfma_f32_16x16x32_bf16 v[104:107], v[28:31], a[252:255], v[104:107]
    v_cvt_pk_bf16_f32 v91, v18, v19
    v_cvt_pk_bf16_f32 v239, v254, v255
    v_mfma_f32_16x16x32_bf16 v[108:111], v[28:31], v[212:215], v[108:111]
    s_add_u32 s29, s30, 49152
    v_exp_f32 v18, v94
    v_mfma_f32_16x16x32_bf16 v[108:111], v[24:27], v[208:211], v[108:111]
    s_waitcnt lgkmcnt(2)
    v_add_f32 v8, v8, v16
    v_add_f32 v8, v8, v17
    v_mfma_f32_16x16x32_bf16 v[160:163], v[32:35], a[208:211], v[160:163]
    s_waitcnt vmcnt(11)
    ds_read_b128 v[24:27], v2 offset:12288
    v_lshlrev_b32 v48, 16, v56
    v_mfma_f32_16x16x32_bf16 v[160:163], v[36:39], a[212:215], v[160:163]
    s_sub_u32 s3, s29, 147456
    buffer_load_dwordx2 v[60:61], off, s[80:83], s37 offset:8
    v_mfma_f32_16x16x32_bf16 v[164:167], v[36:39], a[236:239], v[164:167]
    s_add_u32 s56, s56, 12288
    v_exp_f32 v19, v95
    v_mfma_f32_16x16x32_bf16 v[164:167], v[32:35], a[232:235], v[164:167]
    s_min_u32 s29, s29, s3
    v_cvt_pk_bf16_f32 v92, v16, v17
    v_and_b32 v49, s97, v56
    v_mfma_f32_16x16x32_bf16 v[168:171], v[32:35], v[192:195], v[168:171]
    s_mov_b32 m0, s56
    ds_read_b128 v[28:31], v3 offset:12288
    v_mfma_f32_16x16x32_bf16 v[168:171], v[36:39], v[196:199], v[168:171]
    buffer_load_dwordx2 v[62:63], off, s[84:87], s37 offset:8
    v_mfma_f32_16x16x32_bf16 v[172:175], v[36:39], v[220:223], v[172:175]
    v_exp_f32 v16, v124
    v_mfma_f32_16x16x32_bf16 v[172:175], v[32:35], v[216:219], v[172:175]
    s_waitcnt lgkmcnt(2)
    v_add_f32 v8, v8, v18
    v_add_f32 v8, v8, v19
    v_mfma_f32_16x16x32_bf16 v[96:99], v[40:43], a[208:211], v[96:99]
    ds_read_b128 v[32:35], v2 offset:18432
    v_lshlrev_b32 v50, 16, v58
    v_mfma_f32_16x16x32_bf16 v[96:99], v[44:47], a[212:215], v[96:99]
    s_sub_u32 s3, s29, s30
    v_exp_f32 v17, v125
    v_mfma_f32_16x16x32_bf16 v[100:103], v[44:47], a[236:239], v[100:103]
    v_cvt_pk_bf16_f32 v93, v18, v19
    v_mfma_f32_16x16x32_bf16 v[100:103], v[40:43], a[232:235], v[100:103]
    buffer_load_dwordx4 v4, s[4:7], s27 offen offset:0 sc1 lds
    v_mfma_f32_16x16x32_bf16 v[104:107], v[40:43], v[192:195], v[104:107]
    ds_read_b128 v[36:39], v3 offset:18432
    v_mfma_f32_16x16x32_bf16 v[104:107], v[44:47], v[196:199], v[104:107]
    v_exp_f32 v18, v126
    v_mfma_f32_16x16x32_bf16 v[108:111], v[44:47], v[220:223], v[108:111]
    v_add_f32 v8, v8, v16
    v_add_f32 v8, v8, v17
    v_mfma_f32_16x16x32_bf16 v[108:111], v[40:43], v[216:219], v[108:111]
    s_waitcnt lgkmcnt(2)
    buffer_load_dwordx3 v[240:242], v12, s[68:71], s16 offen offset:0 nt
    v_mfma_f32_16x16x32_bf16 v[176:179], v[24:27], a[192:195], v[128:131]
    ds_read_b128 v[40:43], v2 offset:12416
    v_and_b32 v51, s97, v58
    v_mfma_f32_16x16x32_bf16 v[176:179], v[28:31], a[196:199], v[176:179]
    v_exp_f32 v19, v127
    v_cvt_pk_bf16_f32 v94, v16, v17
    v_mfma_f32_16x16x32_bf16 v[180:183], v[28:31], a[220:223], v[132:135]
    s_mov_b32 s30, s29
    v_add_f32 v8, v8, v18
    v_add_f32 v8, v8, v19
    v_mfma_f32_16x16x32_bf16 v[180:183], v[24:27], a[216:219], v[180:183]
    buffer_load_dwordx4 v4, s[4:7], s27 offen offset:1024 sc1 lds
    v_mfma_f32_16x16x32_bf16 v[184:187], v[24:27], a[240:243], v[136:139]
    ds_read_b128 v[44:47], v3 offset:12416
    v_cvt_pk_bf16_f32 v95, v18, v19
    v_mfma_f32_16x16x32_bf16 v[184:187], v[28:31], a[244:247], v[184:187]
    v_exp_f32 v16, v160
    v_mfma_f32_16x16x32_bf16 v[188:191], v[28:31], v[204:207], v[140:143]
    v_exp_f32 v17, v161
    v_mfma_f32_16x16x32_bf16 v[188:191], v[24:27], v[200:203], v[188:191]
    s_waitcnt lgkmcnt(2)
    buffer_load_dwordx3 v[244:246], v12, s[68:71], s16 offen offset:768 nt
    v_mfma_f32_16x16x32_bf16 v[112:115], v[32:35], a[192:195], v[128:131]
    ds_read_b128 v[24:27], v2 offset:18560
    v_mul_f32_e64 v50, -v50, v48
    v_mfma_f32_16x16x32_bf16 v[112:115], v[36:39], a[196:199], v[112:115]
    v_exp_f32 v18, v162
    v_mfma_f32_16x16x32_bf16 v[116:119], v[36:39], a[220:223], v[132:135]
    v_add_f32 v5, v5, v16
    v_add_f32 v5, v5, v17
    v_mfma_f32_16x16x32_bf16 v[116:119], v[32:35], a[216:219], v[116:119]
    v_exp_f32 v19, v163
    v_mfma_f32_16x16x32_bf16 v[120:123], v[32:35], a[240:243], v[136:139]
    ds_read_b128 v[28:31], v3 offset:18560
    v_cvt_pk_bf16_f32 v160, v16, v17
    v_mfma_f32_16x16x32_bf16 v[120:123], v[36:39], a[244:247], v[120:123]
    buffer_load_dwordx3 v[248:250], v12, s[68:71], s16 offen offset:1536 nt
    v_mfma_f32_16x16x32_bf16 v[124:127], v[36:39], v[204:207], v[140:143]
    v_exp_f32 v16, v96
    v_mfma_f32_16x16x32_bf16 v[124:127], v[32:35], v[200:203], v[124:127]
    s_waitcnt lgkmcnt(2)
    v_add_f32 v5, v5, v18
    v_add_f32 v5, v5, v19
    v_mfma_f32_16x16x32_bf16 v[176:179], v[40:43], a[200:203], v[176:179]
    ds_read_b128 v[32:35], v2 offset:12544
    v_mul_f32_e64 v51, -v51, v49
    v_mfma_f32_16x16x32_bf16 v[176:179], v[44:47], a[204:207], v[176:179]
    buffer_load_dwordx4 v4, s[4:7], s27 offen offset:2048 sc1 lds
    v_mfma_f32_16x16x32_bf16 v[180:183], v[44:47], a[228:231], v[180:183]
    v_exp_f32 v17, v97
    v_mfma_f32_16x16x32_bf16 v[180:183], v[40:43], a[224:227], v[180:183]
L_iw3:
L_pg3:
    s_cbranch_execz L_pg7
    v_cvt_pk_bf16_f32 v161, v18, v19
    v_add_u32 v1, s3, v1
    v_mfma_f32_16x16x32_bf16 v[184:187], v[40:43], a[248:251], v[184:187]
    ds_read_b128 v[36:39], v3 offset:12544
    v_cvt_f32_i32 v144, v144
    v_mfma_f32_16x16x32_bf16 v[184:187], v[44:47], a[252:255], v[184:187]
    buffer_load_dwordx3 v[252:254], v12, s[68:71], s16 offen offset:2304 nt
    v_mfma_f32_16x16x32_bf16 v[188:191], v[44:47], v[212:215], v[188:191]
    v_exp_f32 v18, v98
    v_mfma_f32_16x16x32_bf16 v[188:191], v[40:43], v[208:211], v[188:191]
    s_waitcnt lgkmcnt(2)
    v_add_f32 v5, v5, v16
    v_add_f32 v5, v5, v17
    v_mfma_f32_16x16x32_bf16 v[112:115], v[24:27], a[200:203], v[112:115]
    ds_read_b128 v[40:43], v2 offset:18688
    v_cvt_f32_i32 v148, v148
    v_mfma_f32_16x16x32_bf16 v[112:115], v[28:31], a[204:207], v[112:115]
    v_exp_f32 v19, v99
    v_cvt_pk_bf16_f32 v162, v16, v17
    v_mfma_f32_16x16x32_bf16 v[116:119], v[28:31], a[228:231], v[116:119]
    v_exp_f32 v16, v164
    v_mfma_f32_16x16x32_bf16 v[116:119], v[24:27], a[224:227], v[116:119]
    s_add_u32 s27, s27, 24576
    v_add_f32 v5, v5, v18
    v_add_f32 v5, v5, v19
    v_mfma_f32_16x16x32_bf16 v[120:123], v[24:27], a[248:251], v[120:123]
    s_add_u32 s56, s56, 36864
    ds_read_b128 v[44:47], v3 offset:18688
    v_fma_f32 v144, v144, v48, v50
    v_mfma_f32_16x16x32_bf16 v[120:123], v[28:31], a[252:255], v[120:123]
    s_waitcnt lgkmcnt(2)
    v_exp_f32 v17, v165
    v_mfma_f32_16x16x32_bf16 v[124:127], v[28:31], v[212:215], v[124:127]
    s_waitcnt vmcnt(12)
    v_cvt_pk_bf16_f32 v163, v18, v19
    s_sub_u32 s58, s56, 147456
    v_mfma_f32_16x16x32_bf16 v[124:127], v[24:27], v[208:211], v[124:127]
    s_barrier
    v_mfma_f32_16x16x32_bf16 v[176:179], v[32:35], a[208:211], v[176:179]
    s_min_u32 s56, s56, s58
    ds_read_b128 v[24:27], v1 offset:0
    v_mfma_f32_16x16x32_bf16 v[176:179], v[36:39], a[212:215], v[176:179]
    v_exp_f32 v18, v166
    v_mfma_f32_16x16x32_bf16 v[180:183], v[36:39], a[236:239], v[180:183]
    v_add_f32 v6, v6, v16
    v_add_f32 v6, v6, v17
    v_mfma_f32_16x16x32_bf16 v[180:183], v[32:35], a[232:235], v[180:183]
    v_exp_f32 v19, v167
    v_mfma_f32_16x16x32_bf16 v[184:187], v[32:35], v[192:195], v[184:187]
    ds_read_b128 v[28:31], v1 offset:12288
    v_cvt_pk_bf16_f32 v164, v16, v17
    v_mfma_f32_16x16x32_bf16 v[184:187], v[36:39], v[196:199], v[184:187]
    v_exp_f32 v16, v100
    v_mfma_f32_16x16x32_bf16 v[188:191], v[36:39], v[220:223], v[188:191]
    v_add_f32 v6, v6, v18
    v_add_f32 v6, v6, v19
    v_mfma_f32_16x16x32_bf16 v[188:191], v[32:35], v[216:219], v[188:191]
    s_waitcnt lgkmcnt(2)
    v_exp_f32 v17, v101
    v_mfma_f32_16x16x32_bf16 v[112:115], v[40:43], a[208:211], v[112:115]
    ds_read_b128 v[32:35], v1 offset:1024
    v_cvt_pk_bf16_f32 v165, v18, v19
    v_mfma_f32_16x16x32_bf16 v[112:115], v[44:47], a[212:215], v[112:115]
    v_exp_f32 v18, v102
    v_mfma_f32_16x16x32_bf16 v[116:119], v[44:47], a[236:239], v[116:119]
    v_add_f32 v6, v6, v16
    v_add_f32 v6, v6, v17
    v_mfma_f32_16x16x32_bf16 v[116:119], v[40:43], a[232:235], v[116:119]
    v_exp_f32 v19, v103
    v_mfma_f32_16x16x32_bf16 v[120:123], v[40:43], v[192:195], v[120:123]
    ds_read_b128 v[36:39], v1 offset:13312
    v_cvt_pk_bf16_f32 v166, v16, v17
    v_mfma_f32_16x16x32_bf16 v[120:123], v[44:47], v[196:199], v[120:123]
    v_add_f32 v6, v6, v18
    v_fma_f32 v148, v148, v49, v51
    v_mfma_f32_16x16x32_bf16 v[124:127], v[44:47], v[220:223], v[124:127]
    v_add_f32 v6, v6, v19
    v_cvt_pk_bf16_f32 v167, v18, v19
    v_mfma_f32_16x16x32_bf16 v[124:127], v[40:43], v[216:219], v[124:127]
    s_waitcnt lgkmcnt(2)
    v_mfma_f32_16x16x32_bf16 a[0:3], v[64:67], v[24:27], a[0:3]
    ds_read_b128 v[40:43], v1 offset:2048
    v_cvt_f32_i32 v145, v145
    v_mfma_f32_16x16x32_bf16 a[0:3], v[80:83], v[28:31], a[0:3]
    buffer_store_dwordx4 v[224:227], v11, s[4:7], s33 offen offset:0 sc1
    v_mfma_f32_16x16x32_bf16 a[48:51], v[84:87], v[28:31], a[48:51]
    v_exp_f32 v16, v168
    v_mfma_f32_16x16x32_bf16 a[48:51], v[68:71], v[24:27], a[48:51]
    v_exp_f32 v17, v169
    v_mfma_f32_16x16x32_bf16 a[96:99], v[72:75], v[24:27], a[96:99]
    ds_read_b128 v[44:47], v1 offset:14336
    v_cvt_f32_i32 v149, v149
    v_mfma_f32_16x16x32_bf16 a[96:99], v[88:91], v[28:31], a[96:99]
    v_exp_f32 v18, v170
    v_mfma_f32_16x16x32_bf16 a[144:147], v[92:95], v[28:31], a[144:147]
    v_add_f32 v7, v7, v16
    v_add_f32 v7, v7, v17
    v_mfma_f32_16x16x32_bf16 a[144:147], v[76:79], v[24:27], a[144:147]
    s_waitcnt lgkmcnt(2)
    v_exp_f32 v19, v171
    v_mfma_f32_16x16x32_bf16 a[4:7], v[64:67], v[32:35], a[4:7]
    ds_read_b128 v[24:27], v1 offset:3072
    v_cvt_pk_bf16_f32 v168, v16, v17
    v_mfma_f32_16x16x32_bf16 a[4:7], v[80:83], v[36:39], a[4:7]
    buffer_store_dwordx4 v[228:231], v21, s[4:7], s33 offen offset:768 sc1
    v_mfma_f32_16x16x32_bf16 a[52:55], v[84:87], v[36:39], a[52:55]
    v_exp_f32 v16, v104
    v_mfma_f32_16x16x32_bf16 a[52:55], v[68:71], v[32:35], a[52:55]
    v_add_f32 v7, v7, v18
    v_fma_f32 v145, v145, v48, v50
    v_mfma_f32_16x16x32_bf16 a[100:103], v[72:75], v[32:35], a[100:103]
    ds_read_b128 v[28:31], v1 offset:15360
    v_add_f32 v7, v7, v19
    v_mfma_f32_16x16x32_bf16 a[100:103], v[88:91], v[36:39], a[100:103]
    v_exp_f32 v17, v105
    v_mfma_f32_16x16x32_bf16 a[148:151], v[92:95], v[36:39], a[148:151]
    v_cvt_pk_bf16_f32 v169, v18, v19
    v_fma_f32 v149, v149, v49, v51
    v_mfma_f32_16x16x32_bf16 a[148:151], v[76:79], v[32:35], a[148:151]
    s_waitcnt lgkmcnt(2)
    v_exp_f32 v18, v106
    v_mfma_f32_16x16x32_bf16 a[8:11], v[64:67], v[40:43], a[8:11]
    ds_read_b128 v[32:35], v1 offset:4096
    v_add_f32 v7, v7, v16
    v_mfma_f32_16x16x32_bf16 a[8:11], v[80:83], v[44:47], a[8:11]
    buffer_store_dwordx4 v[232:235], v22, s[4:7], s33 offen offset:1536 sc1
    v_mfma_f32_16x16x32_bf16 a[56:59], v[84:87], v[44:47], a[56:59]
    v_add_f32 v7, v7, v17
    v_cvt_f32_i32 v146, v146
    v_mfma_f32_16x16x32_bf16 a[56:59], v[68:71], v[40:43], a[56:59]
    v_exp_f32 v19, v107
    v_mfma_f32_16x16x32_bf16 a[104:107], v[72:75], v[40:43], a[104:107]
    ds_read_b128 v[36:39], v1 offset:16384
    v_cvt_pk_bf16_f32 v170, v16, v17
    v_mfma_f32_16x16x32_bf16 a[104:107], v[88:91], v[44:47], a[104:107]
    v_exp_f32 v16, v172
    v_mfma_f32_16x16x32_bf16 a[152:155], v[92:95], v[44:47], a[152:155]
    v_add_f32 v7, v7, v18
    v_cvt_f32_i32 v150, v150
    v_mfma_f32_16x16x32_bf16 a[152:155], v[76:79], v[40:43], a[152:155]
    s_waitcnt lgkmcnt(2)
    v_add_f32 v7, v7, v19
    v_fma_f32 v146, v146, v48, v50
    v_mfma_f32_16x16x32_bf16 a[12:15], v[64:67], v[24:27], a[12:15]
    ds_read_b128 v[40:43], v1 offset:5120
    v_mfma_f32_16x16x32_bf16 a[12:15], v[80:83], v[28:31], a[12:15]
    buffer_store_dwordx4 v[236:239], v23, s[4:7], s33 offen offset:2304 sc1
    v_mfma_f32_16x16x32_bf16 a[60:63], v[84:87], v[28:31], a[60:63]
    v_exp_f32 v17, v173
    v_mfma_f32_16x16x32_bf16 a[60:63], v[68:71], v[24:27], a[60:63]
    v_cvt_pk_bf16_f32 v171, v18, v19
    v_fma_f32 v150, v150, v49, v51
    v_mfma_f32_16x16x32_bf16 a[108:111], v[72:75], v[24:27], a[108:111]
    ds_read_b128 v[44:47], v1 offset:17408
    v_mfma_f32_16x16x32_bf16 a[108:111], v[88:91], v[28:31], a[108:111]
    v_exp_f32 v18, v174
    v_mfma_f32_16x16x32_bf16 a[156:159], v[92:95], v[28:31], a[156:159]
    s_add_u32 s29, s28, 49152
    v_add_f32 v8, v8, v16
    v_add_f32 v8, v8, v17
    v_mfma_f32_16x16x32_bf16 a[156:159], v[76:79], v[24:27], a[156:159]
    s_waitcnt lgkmcnt(2)
    v_exp_f32 v19, v175
    v_mfma_f32_16x16x32_bf16 a[16:19], v[64:67], v[32:35], a[16:19]
    s_sub_u32 s3, s29, 147456
    ds_read_b128 v[24:27], v1 offset:6144
    v_cvt_pk_bf16_f32 v172, v16, v17
    v_mfma_f32_16x16x32_bf16 a[16:19], v[80:83], v[36:39], a[16:19]
    s_mov_b32 m0, s26
    v_exp_f32 v16, v108
    v_mfma_f32_16x16x32_bf16 a[64:67], v[84:87], v[36:39], a[64:67]
    s_min_u32 s29, s29, s3
    v_add_f32 v8, v8, v18
    v_lshlrev_b32 v48, 16, v57
    v_mfma_f32_16x16x32_bf16 a[64:67], v[68:71], v[32:35], a[64:67]
    buffer_load_dwordx4 v4, s[4:7], s32 offen offset:0 sc1 lds
    v_mfma_f32_16x16x32_bf16 a[112:115], v[72:75], v[32:35], a[112:115]
    ds_read_b128 v[28:31], v1 offset:18432
    v_add_f32 v8, v8, v19
    v_mfma_f32_16x16x32_bf16 a[112:115], v[88:91], v[36:39], a[112:115]
    v_exp_f32 v17, v109
    v_mfma_f32_16x16x32_bf16 a[160:163], v[92:95], v[36:39], a[160:163]
    v_cvt_pk_bf16_f32 v173, v18, v19
    v_and_b32 v49, s97, v57
    v_mfma_f32_16x16x32_bf16 a[160:163], v[76:79], v[32:35], a[160:163]
    s_waitcnt lgkmcnt(2)
    buffer_load_dwordx4 v4, s[4:7], s32 offen offset:1024 sc1 lds
    v_mfma_f32_16x16x32_bf16 a[20:23], v[64:67], v[40:43], a[20:23]
    s_sub_u32 s3, s29, s28
    ds_read_b128 v[32:35], v1 offset:7168
    v_lshlrev_b32 v50, 16, v59
    v_mfma_f32_16x16x32_bf16 a[20:23], v[80:83], v[44:47], a[20:23]
    v_exp_f32 v18, v110
    v_mfma_f32_16x16x32_bf16 a[68:71], v[84:87], v[44:47], a[68:71]
    v_add_f32 v8, v8, v16
    v_add_f32 v8, v8, v17
    v_mfma_f32_16x16x32_bf16 a[68:71], v[68:71], v[40:43], a[68:71]
    buffer_load_dwordx4 v4, s[4:7], s32 offen offset:2048 sc1 lds
    v_mfma_f32_16x16x32_bf16 a[116:119], v[72:75], v[40:43], a[116:119]
    ds_read_b128 v[36:39], v1 offset:19456
    v_mfma_f32_16x16x32_bf16 a[116:119], v[88:91], v[44:47], a[116:119]
    v_exp_f32 v19, v111
    v_mfma_f32_16x16x32_bf16 a[164:167], v[92:95], v[44:47], a[164:167]
    s_mov_b32 s28, s29
    v_cvt_pk_bf16_f32 v174, v16, v17
    v_add_f32 v8, v8, v18
    v_mfma_f32_16x16x32_bf16 a[164:167], v[76:79], v[40:43], a[164:167]
    s_waitcnt lgkmcnt(2)
    v_add_f32 v8, v8, v19
    v_cvt_pk_bf16_f32 v175, v18, v19
    v_mfma_f32_16x16x32_bf16 a[24:27], v[64:67], v[24:27], a[24:27]
    s_add_u32 s32, s32, 24576
    ds_read_b128 v[40:43], v1 offset:8192
    v_and_b32 v51, s97, v59
    v_mfma_f32_16x16x32_bf16 a[24:27], v[80:83], v[28:31], a[24:27]
    v_exp_f32 v16, v176
    v_mfma_f32_16x16x32_bf16 a[72:75], v[84:87], v[28:31], a[72:75]
    s_add_u32 s26, s26, 12288
    v_exp_f32 v17, v177
    v_mfma_f32_16x16x32_bf16 a[72:75], v[68:71], v[24:27], a[72:75]
    v_exp_f32 v18, v178
    v_mfma_f32_16x16x32_bf16 a[120:123], v[72:75], v[24:27], a[120:123]
    s_mov_b32 m0, s26
    ds_read_b128 v[44:47], v1 offset:20480
    v_add_f32 v5, v5, v16
    v_mfma_f32_16x16x32_bf16 a[120:123], v[88:91], v[28:31], a[120:123]
    v_add_f32 v5, v5, v17
    v_mul_f32_e64 v50, -v50, v48
    v_mfma_f32_16x16x32_bf16 a[168:171], v[92:95], v[28:31], a[168:171]
    v_exp_f32 v19, v179
    v_mfma_f32_16x16x32_bf16 a[168:171], v[76:79], v[24:27], a[168:171]
    s_waitcnt lgkmcnt(2)
    v_cvt_pk_bf16_f32 v176, v16, v17
    v_mul_f32_e64 v51, -v51, v49
    v_mfma_f32_16x16x32_bf16 a[28:31], v[64:67], v[32:35], a[28:31]
    ds_read_b128 v[24:27], v1 offset:9216
    v_add_u32 v2, s3, v2
    v_mfma_f32_16x16x32_bf16 a[28:31], v[80:83], v[36:39], a[28:31]
    buffer_load_dwordx4 v4, s[4:7], s32 offen offset:0 sc1 lds
    v_mfma_f32_16x16x32_bf16 a[76:79], v[84:87], v[36:39], a[76:79]
    v_exp_f32 v16, v112
    v_mfma_f32_16x16x32_bf16 a[76:79], v[68:71], v[32:35], a[76:79]
    v_add_f32 v5, v5, v18
    v_add_f32 v5, v5, v19
    v_mfma_f32_16x16x32_bf16 a[124:127], v[72:75], v[32:35], a[124:127]
    ds_read_b128 v[28:31], v1 offset:21504
    v_cvt_f32_i32 v152, v152
    v_mfma_f32_16x16x32_bf16 a[124:127], v[88:91], v[36:39], a[124:127]
    buffer_load_dwordx4 v4, s[4:7], s32 offen offset:1024 sc1 lds
    v_mfma_f32_16x16x32_bf16 a[172:175], v[92:95], v[36:39], a[172:175]
    v_exp_f32 v17, v113
    v_mfma_f32_16x16x32_bf16 a[172:175], v[76:79], v[32:35], a[172:175]
    s_waitcnt lgkmcnt(2)
    v_cvt_pk_bf16_f32 v177, v18, v19
    v_add_u32 v3, s3, v3
    v_mfma_f32_16x16x32_bf16 a[32:35], v[64:67], v[40:43], a[32:35]
    ds_read_b128 v[32:35], v1 offset:10240
    v_cvt_f32_i32 v156, v156
    v_mfma_f32_16x16x32_bf16 a[32:35], v[80:83], v[44:47], a[32:35]
    v_exp_f32 v18, v114
    v_mfma_f32_16x16x32_bf16 a[80:83], v[84:87], v[44:47], a[80:83]
    v_add_f32 v5, v5, v16
    v_add_f32 v5, v5, v17
    v_mfma_f32_16x16x32_bf16 a[80:83], v[68:71], v[40:43], a[80:83]
    buffer_load_dwordx4 v4, s[4:7], s32 offen offset:2048 sc1 lds
    v_mfma_f32_16x16x32_bf16 a[128:131], v[72:75], v[40:43], a[128:131]
    ds_read_b128 v[36:39], v1 offset:22528
    v_mfma_f32_16x16x32_bf16 a[128:131], v[88:91], v[44:47], a[128:131]
    v_exp_f32 v19, v115
    v_mfma_f32_16x16x32_bf16 a[176:179], v[92:95], v[44:47], a[176:179]
    v_cvt_pk_bf16_f32 v178, v16, v17
    v_fma_f32 v152, v152, v48, v50
    v_mfma_f32_16x16x32_bf16 a[176:179], v[76:79], v[40:43], a[176:179]
    s_waitcnt lgkmcnt(2)
    v_exp_f32 v16, v180
    v_mfma_f32_16x16x32_bf16 a[36:39], v[64:67], v[24:27], a[36:39]
    ds_read_b128 v[40:43], v1 offset:11264
    v_add_f32 v5, v5, v18
    v_mfma_f32_16x16x32_bf16 a[36:39], v[80:83], v[28:31], a[36:39]
    v_add_f32 v5, v5, v19
    v_mfma_f32_16x16x32_bf16 a[84:87], v[84:87], v[28:31], a[84:87]
    v_exp_f32 v17, v181
    v_mfma_f32_16x16x32_bf16 a[84:87], v[68:71], v[24:27], a[84:87]
    s_add_u32 s32, s32, 24576
    v_cvt_pk_bf16_f32 v179, v18, v19
    s_add_u32 s26, s26, 36864
    v_mfma_f32_16x16x32_bf16 a[132:135], v[72:75], v[24:27], a[132:135]
    s_sub_u32 s57, s26, 147456
    ds_read_b128 v[44:47], v1 offset:23552
    v_fma_f32 v156, v156, v49, v51
    v_mfma_f32_16x16x32_bf16 a[132:135], v[88:91], v[28:31], a[132:135]
    s_waitcnt lgkmcnt(2)
    v_exp_f32 v18, v182
    v_mfma_f32_16x16x32_bf16 a[180:183], v[92:95], v[28:31], a[180:183]
    s_waitcnt vmcnt(6)
    v_add_f32 v6, v6, v16
    v_add_f32 v6, v6, v17
    v_mfma_f32_16x16x32_bf16 a[180:183], v[76:79], v[24:27], a[180:183]
    s_barrier
    v_mfma_f32_16x16x32_bf16 a[40:43], v[64:67], v[32:35], a[40:43]
    s_min_u32 s26, s26, s57
    ds_read_b128 v[24:27], v2 offset:0
    v_add_u32 v0, 1, v0
    v_mfma_f32_16x16x32_bf16 a[40:43], v[80:83], v[36:39], a[40:43]
    buffer_store_dword v0, v13, s[20:23], 0 offen offset:32 sc1
    v_mfma_f32_16x16x32_bf16 a[88:91], v[84:87], v[36:39], a[88:91]
    v_exp_f32 v19, v183
    v_mfma_f32_16x16x32_bf16 a[88:91], v[68:71], v[32:35], a[88:91]
    v_cvt_pk_bf16_f32 v180, v16, v17
    v_cvt_f32_i32 v153, v153
    v_mfma_f32_16x16x32_bf16 a[136:139], v[72:75], v[32:35], a[136:139]
    ds_read_b128 v[28:31], v3 offset:0
    v_cvt_f32_i32 v157, v157
    v_mfma_f32_16x16x32_bf16 a[136:139], v[88:91], v[36:39], a[136:139]
    v_exp_f32 v16, v116
    v_mfma_f32_16x16x32_bf16 a[184:187], v[92:95], v[36:39], a[184:187]
    v_add_f32 v6, v6, v18
    v_add_f32 v6, v6, v19
    v_mfma_f32_16x16x32_bf16 a[184:187], v[76:79], v[32:35], a[184:187]
    s_waitcnt lgkmcnt(2)
    v_exp_f32 v17, v117
    v_mfma_f32_16x16x32_bf16 a[44:47], v[64:67], v[40:43], a[44:47]
    ds_read_b128 v[32:35], v2 offset:6144
    v_cvt_pk_bf16_f32 v181, v18, v19
    v_mfma_f32_16x16x32_bf16 a[44:47], v[80:83], v[44:47], a[44:47]
    v_exp_f32 v18, v118
    v_mfma_f32_16x16x32_bf16 a[92:95], v[84:87], v[44:47], a[92:95]
    v_add_f32 v6, v6, v16
    v_add_f32 v6, v6, v17
    v_mfma_f32_16x16x32_bf16 a[92:95], v[68:71], v[40:43], a[92:95]
    v_exp_f32 v19, v119
    v_mfma_f32_16x16x32_bf16 a[140:143], v[72:75], v[40:43], a[140:143]
    ds_read_b128 v[36:39], v3 offset:6144
    v_cvt_pk_bf16_f32 v182, v16, v17
    v_mfma_f32_16x16x32_bf16 a[140:143], v[88:91], v[44:47], a[140:143]
    v_add_f32 v6, v6, v18
    v_add_f32 v6, v6, v19
    v_mfma_f32_16x16x32_bf16 a[188:191], v[92:95], v[44:47], a[188:191]
    v_cvt_pk_bf16_f32 v183, v18, v19
    v_mfma_f32_16x16x32_bf16 a[188:191], v[76:79], v[40:43], a[188:191]
    s_waitcnt lgkmcnt(2)
    v_mfma_f32_16x16x32_bf16 v[64:67], v[24:27], a[192:195], v[128:131]
    s_add_u32 s33, s33, 196608
    ds_read_b128 v[40:43], v2 offset:128
    v_fma_f32 v153, v153, v48, v50
    v_mfma_f32_16x16x32_bf16 v[64:67], v[28:31], a[196:199], v[64:67]
    s_mov_b32 m0, s56
    v_exp_f32 v16, v184
    v_mfma_f32_16x16x32_bf16 v[68:71], v[28:31], a[220:223], v[132:135]
    s_add_u32 s34, s34, 196608
    v_exp_f32 v17, v185
    v_mfma_f32_16x16x32_bf16 v[68:71], v[24:27], a[216:219], v[68:71]
    s_add_u32 s36, s36, 1536
    buffer_load_dwordx4 v4, s[4:7], s27 offen offset:0 sc1 lds
    v_mfma_f32_16x16x32_bf16 v[72:75], v[24:27], a[240:243], v[136:139]
    ds_read_b128 v[44:47], v3 offset:128
    v_fma_f32 v157, v157, v49, v51
    v_mfma_f32_16x16x32_bf16 v[72:75], v[28:31], a[244:247], v[72:75]
    v_exp_f32 v18, v186
    v_mfma_f32_16x16x32_bf16 v[76:79], v[28:31], v[204:207], v[140:143]
    v_add_f32 v7, v7, v16
    v_add_f32 v7, v7, v17
    v_mfma_f32_16x16x32_bf16 v[76:79], v[24:27], v[200:203], v[76:79]
    s_waitcnt lgkmcnt(2)
    buffer_load_dwordx2 v[56:57], v10, s[72:75], s36 offen offset:0
    v_mfma_f32_16x16x32_bf16 v[96:99], v[32:35], a[192:195], v[128:131]
    ds_read_b128 v[24:27], v2 offset:6272
    v_cvt_f32_i32 v154, v154
    v_mfma_f32_16x16x32_bf16 v[96:99], v[36:39], a[196:199], v[96:99]
    v_exp_f32 v19, v187
    v_mfma_f32_16x16x32_bf16 v[100:103], v[36:39], a[220:223], v[132:135]
    v_cvt_pk_bf16_f32 v184, v16, v17
    v_cvt_f32_i32 v158, v158
    v_mfma_f32_16x16x32_bf16 v[100:103], v[32:35], a[216:219], v[100:103]
    buffer_load_dwordx4 v4, s[4:7], s27 offen offset:1024 sc1 lds
    v_mfma_f32_16x16x32_bf16 v[104:107], v[32:35], a[240:243], v[136:139]
    ds_read_b128 v[28:31], v3 offset:6272
    v_fma_f32 v154, v154, v48, v50
    v_mfma_f32_16x16x32_bf16 v[104:107], v[36:39], a[244:247], v[104:107]
    v_exp_f32 v16, v120
    v_mfma_f32_16x16x32_bf16 v[108:111], v[36:39], v[204:207], v[140:143]
    v_add_f32 v7, v7, v18
    v_add_f32 v7, v7, v19
    v_mfma_f32_16x16x32_bf16 v[108:111], v[32:35], v[200:203], v[108:111]
    s_waitcnt lgkmcnt(2)
    buffer_load_dwordx2 v[58:59], v10, s[76:79], s36 offen offset:0
    v_mfma_f32_16x16x32_bf16 v[64:67], v[40:43], a[200:203], v[64:67]
    ds_read_b128 v[32:35], v2 offset:256
    v_fma_f32 v158, v158, v49, v51
    v_mfma_f32_16x16x32_bf16 v[64:67], v[44:47], a[204:207], v[64:67]
    v_exp_f32 v17, v121
    v_mfma_f32_16x16x32_bf16 v[68:71], v[44:47], a[228:231], v[68:71]
    v_cvt_pk_bf16_f32 v185, v18, v19
    v_mfma_f32_16x16x32_bf16 v[68:71], v[40:43], a[224:227], v[68:71]
    buffer_load_dwordx4 v[224:227], v9, s[64:67], s33 offen offset:0 nt
    v_mfma_f32_16x16x32_bf16 v[72:75], v[40:43], a[248:251], v[72:75]
    ds_read_b128 v[36:39], v3 offset:256
    v_cvt_pk_bf16_f32 v144, v144, v148
    v_mfma_f32_16x16x32_bf16 v[72:75], v[44:47], a[252:255], v[72:75]
    v_exp_f32 v18, v122
    v_mfma_f32_16x16x32_bf16 v[76:79], v[44:47], v[212:215], v[76:79]
    v_add_f32 v7, v7, v16
    v_add_f32 v7, v7, v17
    v_mfma_f32_16x16x32_bf16 v[76:79], v[40:43], v[208:211], v[76:79]
    s_waitcnt lgkmcnt(2)
    buffer_load_dwordx4 v4, s[4:7], s27 offen offset:2048 sc1 lds
    v_mfma_f32_16x16x32_bf16 v[96:99], v[24:27], a[200:203], v[96:99]
    ds_read_b128 v[40:43], v2 offset:6400
    v_cvt_pk_bf16_f32 v148, v145, v149
    v_mfma_f32_16x16x32_bf16 v[96:99], v[28:31], a[204:207], v[96:99]
    v_exp_f32 v19, v123
    v_cvt_pk_bf16_f32 v186, v16, v17
    v_mfma_f32_16x16x32_bf16 v[100:103], v[28:31], a[228:231], v[100:103]
    v_exp_f32 v16, v188
    v_mfma_f32_16x16x32_bf16 v[100:103], v[24:27], a[224:227], v[100:103]
    buffer_load_dwordx4 v[228:231], v9, s[64:67], s33 offen offset:1536 nt
    v_mfma_f32_16x16x32_bf16 v[104:107], v[24:27], a[248:251], v[104:107]
    ds_read_b128 v[44:47], v3 offset:6400
    v_add_f32 v7, v7, v18
    v_mfma_f32_16x16x32_bf16 v[104:107], v[28:31], a[252:255], v[104:107]
    v_add_f32 v7, v7, v19
    v_cvt_pk_bf16_f32 v145, v152, v156
    v_mfma_f32_16x16x32_bf16 v[108:111], v[28:31], v[212:215], v[108:111]
    s_add_u32 s29, s30, 49152
    v_exp_f32 v17, v189
    v_mfma_f32_16x16x32_bf16 v[108:111], v[24:27], v[208:211], v[108:111]
    s_waitcnt lgkmcnt(2)
    buffer_load_dwordx4 v[232:235], v9, s[64:67], s34 offen offset:0 nt
    v_cvt_pk_bf16_f32 v187, v18, v19
    v_mfma_f32_16x16x32_bf16 v[64:67], v[32:35], a[208:211], v[64:67]
    s_sub_u32 s3, s29, 147456
    ds_read_b128 v[24:27], v2 offset:12288
    s_add_u32 s27, s27, 24576
    v_mfma_f32_16x16x32_bf16 v[64:67], v[36:39], a[212:215], v[64:67]
    s_min_u32 s29, s29, s3
    v_exp_f32 v18, v190
    v_mfma_f32_16x16x32_bf16 v[68:71], v[36:39], a[236:239], v[68:71]
    v_add_f32 v8, v8, v16
    v_add_f32 v8, v8, v17
    v_mfma_f32_16x16x32_bf16 v[68:71], v[32:35], a[232:235], v[68:71]
    buffer_load_dwordx4 v[236:239], v9, s[64:67], s34 offen offset:1536 nt
    v_mfma_f32_16x16x32_bf16 v[72:75], v[32:35], v[192:195], v[72:75]
    s_add_u32 s56, s56, 12288
    ds_read_b128 v[28:31], v3 offset:12288
    v_cvt_pk_bf16_f32 v149, v153, v157
    v_mfma_f32_16x16x32_bf16 v[72:75], v[36:39], v[196:199], v[72:75]
    v_exp_f32 v19, v191
    v_cvt_pk_bf16_f32 v188, v16, v17
    v_mfma_f32_16x16x32_bf16 v[76:79], v[36:39], v[220:223], v[76:79]
    v_exp_f32 v16, v124
    v_mfma_f32_16x16x32_bf16 v[76:79], v[32:35], v[216:219], v[76:79]
    s_waitcnt lgkmcnt(2)
    v_add_f32 v8, v8, v18
    v_add_f32 v8, v8, v19
    v_mfma_f32_16x16x32_bf16 v[96:99], v[40:43], a[208:211], v[96:99]
    ds_read_b128 v[32:35], v2 offset:18432
    v_cvt_pk_bf16_f32 v152, v146, v150
    v_mfma_f32_16x16x32_bf16 v[96:99], v[44:47], a[212:215], v[96:99]
    s_sub_u32 s3, s29, s30
    v_exp_f32 v17, v125
    v_mfma_f32_16x16x32_bf16 v[100:103], v[44:47], a[236:239], v[100:103]
    s_mov_b32 m0, s56
    v_cvt_pk_bf16_f32 v189, v18, v19
    v_cvt_pk_bf16_f32 v153, v154, v158
    v_mfma_f32_16x16x32_bf16 v[100:103], v[40:43], a[232:235], v[100:103]
    v_exp_f32 v18, v126
    v_mfma_f32_16x16x32_bf16 v[104:107], v[40:43], v[192:195], v[104:107]
    ds_read_b128 v[36:39], v3 offset:18432
    v_add_f32 v8, v8, v16
    v_mfma_f32_16x16x32_bf16 v[104:107], v[44:47], v[196:199], v[104:107]
    v_add_f32 v8, v8, v17
    v_mfma_f32_16x16x32_bf16 v[108:111], v[44:47], v[220:223], v[108:111]
    v_exp_f32 v19, v127
    v_mfma_f32_16x16x32_bf16 v[108:111], v[40:43], v[216:219], v[108:111]
    s_waitcnt lgkmcnt(2)
    v_cvt_pk_bf16_f32 v190, v16, v17
    v_add_f32 v8, v8, v18
    v_mfma_f32_16x16x32_bf16 v[80:83], v[24:27], a[192:195], v[128:131]
    ds_read_b128 v[40:43], v2 offset:12416
    v_add_f32 v8, v8, v19
    v_mfma_f32_16x16x32_bf16 v[80:83], v[28:31], a[196:199], v[80:83]
    s_mov_b32 s30, s29
    v_cvt_pk_bf16_f32 v191, v18, v19
    v_mfma_f32_16x16x32_bf16 v[84:87], v[28:31], a[220:223], v[132:135]
    v_exp_f32 v16, v64
    v_mfma_f32_16x16x32_bf16 v[84:87], v[24:27], a[216:219], v[84:87]
    s_waitcnt vmcnt(20)
    buffer_load_dwordx4 v4, s[4:7], s27 offen offset:0 sc1 lds
    v_mfma_f32_16x16x32_bf16 v[88:91], v[24:27], a[240:243], v[136:139]
    ds_read_b128 v[44:47], v3 offset:12416
    v_lshlrev_b32 v48, 16, v60
    v_mfma_f32_16x16x32_bf16 v[88:91], v[28:31], a[244:247], v[88:91]
    v_exp_f32 v17, v65
    v_mfma_f32_16x16x32_bf16 v[92:95], v[28:31], v[204:207], v[140:143]
    v_exp_f32 v18, v66
    v_mfma_f32_16x16x32_bf16 v[92:95], v[24:27], v[200:203], v[92:95]
    s_waitcnt lgkmcnt(2)
    v_add_f32 v5, v5, v16
    v_add_f32 v5, v5, v17
    v_mfma_f32_16x16x32_bf16 v[112:115], v[32:35], a[192:195], v[128:131]
    ds_read_b128 v[24:27], v2 offset:18560
    v_and_b32 v49, s97, v60
    v_mfma_f32_16x16x32_bf16 v[112:115], v[36:39], a[196:199], v[112:115]
    v_exp_f32 v19, v67
    v_mfma_f32_16x16x32_bf16 v[116:119], v[36:39], a[220:223], v[132:135]
    v_cvt_pk_bf16_f32 v64, v16, v17
    v_lshlrev_b32 v50, 16, v62
    v_mfma_f32_16x16x32_bf16 v[116:119], v[32:35], a[216:219], v[116:119]
    v_exp_f32 v16, v96
    v_mfma_f32_16x16x32_bf16 v[120:123], v[32:35], a[240:243], v[136:139]
    ds_read_b128 v[28:31], v3 offset:18560
    v_add_f32 v5, v5, v18
    v_mfma_f32_16x16x32_bf16 v[120:123], v[36:39], a[244:247], v[120:123]
    v_add_f32 v5, v5, v19
    v_and_b32 v51, s97, v62
    v_mfma_f32_16x16x32_bf16 v[124:127], v[36:39], v[204:207], v[140:143]
    v_exp_f32 v17, v97
    v_mfma_f32_16x16x32_bf16 v[124:127], v[32:35], v[200:203], v[124:127]
    s_waitcnt lgkmcnt(2)
    buffer_load_dwordx4 v4, s[4:7], s27 offen offset:1024 sc1 lds
    v_mfma_f32_16x16x32_bf16 v[80:83], v[40:43], a[200:203], v[80:83]
    ds_read_b128 v[32:35], v2 offset:12544
    v_cvt_pk_bf16_f32 v65, v18, v19
    v_mfma_f32_16x16x32_bf16 v[80:83], v[44:47], a[204:207], v[80:83]
    v_exp_f32 v18, v98
    v_mfma_f32_16x16x32_bf16 v[84:87], v[44:47], a[228:231], v[84:87]
    v_add_f32 v5, v5, v16
    v_add_f32 v5, v5, v17
    v_mfma_f32_16x16x32_bf16 v[84:87], v[40:43], a[224:227], v[84:87]
    v_exp_f32 v19, v99
    v_mfma_f32_16x16x32_bf16 v[88:91], v[40:43], a[248:251], v[88:91]
    ds_read_b128 v[36:39], v3 offset:12544
    v_cvt_pk_bf16_f32 v66, v16, v17
    v_mfma_f32_16x16x32_bf16 v[88:91], v[44:47], a[252:255], v[88:91]
    v_exp_f32 v16, v68
    v_mfma_f32_16x16x32_bf16 v[92:95], v[44:47], v[212:215], v[92:95]
    v_add_u32 v1, s3, v1
    v_mul_f32_e64 v50, -v50, v48
    v_mfma_f32_16x16x32_bf16 v[92:95], v[40:43], v[208:211], v[92:95]
    s_waitcnt lgkmcnt(2)
    v_add_f32 v5, v5, v18
    v_add_f32 v5, v5, v19
    v_mfma_f32_16x16x32_bf16 v[112:115], v[24:27], a[200:203], v[112:115]
    ds_read_b128 v[40:43], v2 offset:18688
    v_mul_f32_e64 v51, -v51, v49
    v_mfma_f32_16x16x32_bf16 v[112:115], v[28:31], a[204:207], v[112:115]
    buffer_load_dwordx4 v4, s[4:7], s27 offen offset:2048 sc1 lds
    v_mfma_f32_16x16x32_bf16 v[116:119], v[28:31], a[228:231], v[116:119]
    v_exp_f32 v17, v69
    v_mfma_f32_16x16x32_bf16 v[116:119], v[24:27], a[224:227], v[116:119]
    v_cvt_pk_bf16_f32 v67, v18, v19
    v_cvt_f32_i32 v240, v240
    v_mfma_f32_16x16x32_bf16 v[120:123], v[24:27], a[248:251], v[120:123]
    ds_read_b128 v[44:47], v3 offset:18688
    v_mfma_f32_16x16x32_bf16 v[120:123], v[28:31], a[252:255], v[120:123]
    s_waitcnt lgkmcnt(2)
    v_exp_f32 v18, v70
    v_mfma_f32_16x16x32_bf16 v[124:127], v[28:31], v[212:215], v[124:127]
    s_waitcnt vmcnt(13)
    v_add_f32 v6, v6, v16
    v_add_f32 v6, v6, v17
    v_mfma_f32_16x16x32_bf16 v[124:127], v[24:27], v[208:211], v[124:127]
    s_barrier
    v_mfma_f32_16x16x32_bf16 v[80:83], v[32:35], a[208:211], v[80:83]
    ds_read_b128 v[24:27], v1 offset:0
    v_cvt_f32_i32 v244, v244
    v_mfma_f32_16x16x32_bf16 v[80:83], v[36:39], a[212:215], v[80:83]
    v_exp_f32 v19, v71
    v_mfma_f32_16x16x32_bf16 v[84:87], v[36:39], a[236:239], v[84:87]
    v_cvt_pk_bf16_f32 v68, v16, v17
    v_fma_f32 v240, v240, v48, v50
    v_mfma_f32_16x16x32_bf16 v[84:87], v[32:35], a[232:235], v[84:87]
    v_exp_f32 v16, v100
    v_mfma_f32_16x16x32_bf16 v[88:91], v[32:35], v[192:195], v[88:91]
    ds_read_b128 v[28:31], v1 offset:12288
    v_add_f32 v6, v6, v18
    v_mfma_f32_16x16x32_bf16 v[88:91], v[36:39], v[196:199], v[88:91]
    v_add_f32 v6, v6, v19
    v_fma_f32 v244, v244, v49, v51
    v_mfma_f32_16x16x32_bf16 v[92:95], v[36:39], v[220:223], v[92:95]
    v_exp_f32 v17, v101
    v_mfma_f32_16x16x32_bf16 v[92:95], v[32:35], v[216:219], v[92:95]
    s_waitcnt lgkmcnt(2)
    v_cvt_pk_bf16_f32 v69, v18, v19
    v_mfma_f32_16x16x32_bf16 v[112:115], v[40:43], a[208:211], v[112:115]
    ds_read_b128 v[32:35], v1 offset:1024
    v_mfma_f32_16x16x32_bf16 v[112:115], v[44:47], a[212:215], v[112:115]
    v_exp_f32 v18, v102
    v_mfma_f32_16x16x32_bf16 v[116:119], v[44:47], a[236:239], v[116:119]
    v_add_f32 v6, v6, v16
    v_add_f32 v6, v6, v17
    v_mfma_f32_16x16x32_bf16 v[116:119], v[40:43], a[232:235], v[116:119]
    s_add_u32 s27, s27, 24576
    v_exp_f32 v19, v103
    v_mfma_f32_16x16x32_bf16 v[120:123], v[40:43], v[192:195], v[120:123]
    s_add_u32 s56, s56, 36864
    ds_read_b128 v[36:39], v1 offset:13312
    v_cvt_pk_bf16_f32 v70, v16, v17
    v_mfma_f32_16x16x32_bf16 v[120:123], v[44:47], v[196:199], v[120:123]
    s_sub_u32 s58, s56, 147456
    v_add_f32 v6, v6, v18
    v_add_f32 v6, v6, v19
    v_mfma_f32_16x16x32_bf16 v[124:127], v[44:47], v[220:223], v[124:127]
    s_min_u32 s56, s56, s58
    v_cvt_pk_bf16_f32 v71, v18, v19
    v_mfma_f32_16x16x32_bf16 v[124:127], v[40:43], v[216:219], v[124:127]
    s_waitcnt lgkmcnt(2)
    v_mfma_f32_16x16x32_bf16 a[0:3], v[160:163], v[24:27], a[0:3]
    s_mov_b32 m0, s56
    ds_read_b128 v[40:43], v1 offset:2048
    v_cvt_f32_i32 v241, v241
    v_mfma_f32_16x16x32_bf16 a[0:3], v[176:179], v[28:31], a[0:3]
    buffer_load_dwordx4 v4, s[4:7], s27 offen offset:0 sc1 lds
    v_mfma_f32_16x16x32_bf16 a[48:51], v[180:183], v[28:31], a[48:51]
    v_exp_f32 v16, v72
    v_mfma_f32_16x16x32_bf16 a[48:51], v[164:167], v[24:27], a[48:51]
    v_exp_f32 v17, v73
    v_mfma_f32_16x16x32_bf16 a[96:99], v[168:171], v[24:27], a[96:99]
    ds_read_b128 v[44:47], v1 offset:14336
    v_cvt_f32_i32 v245, v245
    v_mfma_f32_16x16x32_bf16 a[96:99], v[184:187], v[28:31], a[96:99]
    v_exp_f32 v18, v74
    v_mfma_f32_16x16x32_bf16 a[144:147], v[188:191], v[28:31], a[144:147]
    v_add_f32 v7, v7, v16
    v_add_f32 v7, v7, v17
    v_mfma_f32_16x16x32_bf16 a[144:147], v[172:175], v[24:27], a[144:147]
    s_waitcnt lgkmcnt(2)
    v_exp_f32 v19, v75
    v_mfma_f32_16x16x32_bf16 a[4:7], v[160:163], v[32:35], a[4:7]
L_pg4:
    s_cbranch_execz L_pg8
    ds_read_b128 v[24:27], v1 offset:3072
    v_fma_f32 v241, v241, v48, v50
    v_mfma_f32_16x16x32_bf16 a[4:7], v[176:179], v[36:39], a[4:7]
    buffer_load_dwordx4 v4, s[4:7], s27 offen offset:1024 sc1 lds
    v_mfma_f32_16x16x32_bf16 a[52:55], v[180:183], v[36:39], a[52:55]
    v_cvt_pk_bf16_f32 v72, v16, v17
    v_fma_f32 v245, v245, v49, v51
    v_mfma_f32_16x16x32_bf16 a[52:55], v[164:167], v[32:35], a[52:55]
    v_exp_f32 v16, v104
    v_mfma_f32_16x16x32_bf16 a[100:103], v[168:171], v[32:35], a[100:103]
    ds_read_b128 v[28:31], v1 offset:15360
    v_add_f32 v7, v7, v18
    v_mfma_f32_16x16x32_bf16 a[100:103], v[184:187], v[36:39], a[100:103]
    buffer_load_dword v52, v20, s[20:23], s44 offen sc1
    v_mfma_f32_16x16x32_bf16 a[148:151], v[188:191], v[36:39], a[148:151]
    v_add_f32 v7, v7, v19
    v_cvt_f32_i32 v242, v242
    v_mfma_f32_16x16x32_bf16 a[148:151], v[172:175], v[32:35], a[148:151]
    s_waitcnt lgkmcnt(2)
    v_exp_f32 v17, v105
    v_mfma_f32_16x16x32_bf16 a[8:11], v[160:163], v[40:43], a[8:11]
    ds_read_b128 v[32:35], v1 offset:4096
    v_cvt_pk_bf16_f32 v73, v18, v19
    v_mfma_f32_16x16x32_bf16 a[8:11], v[176:179], v[44:47], a[8:11]
    v_exp_f32 v18, v106
    v_mfma_f32_16x16x32_bf16 a[56:59], v[180:183], v[44:47], a[56:59]
    v_add_f32 v7, v7, v16
    v_cvt_f32_i32 v246, v246
    v_mfma_f32_16x16x32_bf16 a[56:59], v[164:167], v[40:43], a[56:59]
    buffer_load_dwordx4 v4, s[4:7], s27 offen offset:2048 sc1 lds
    v_mfma_f32_16x16x32_bf16 a[104:107], v[168:171], v[40:43], a[104:107]
    ds_read_b128 v[36:39], v1 offset:16384
    v_add_f32 v7, v7, v17
    v_mfma_f32_16x16x32_bf16 a[104:107], v[184:187], v[44:47], a[104:107]
    v_exp_f32 v19, v107
    v_mfma_f32_16x16x32_bf16 a[152:155], v[188:191], v[44:47], a[152:155]
    v_cvt_pk_bf16_f32 v74, v16, v17
    v_fma_f32 v242, v242, v48, v50
    v_mfma_f32_16x16x32_bf16 a[152:155], v[172:175], v[40:43], a[152:155]
    s_waitcnt lgkmcnt(2)
    v_exp_f32 v16, v76
    v_mfma_f32_16x16x32_bf16 a[12:15], v[160:163], v[24:27], a[12:15]
    ds_read_b128 v[40:43], v1 offset:5120
    v_add_f32 v7, v7, v18
    v_mfma_f32_16x16x32_bf16 a[12:15], v[176:179], v[28:31], a[12:15]
    s_add_u32 s27, s27, 24576
    v_add_f32 v7, v7, v19
    v_fma_f32 v246, v246, v49, v51
    v_mfma_f32_16x16x32_bf16 a[60:63], v[180:183], v[28:31], a[60:63]
    v_exp_f32 v17, v77
    v_mfma_f32_16x16x32_bf16 a[60:63], v[164:167], v[24:27], a[60:63]
    v_cvt_pk_bf16_f32 v75, v18, v19
    v_lshlrev_b32 v48, 16, v61
    v_mfma_f32_16x16x32_bf16 a[108:111], v[168:171], v[24:27], a[108:111]
    ds_read_b128 v[44:47], v1 offset:17408
    v_and_b32 v49, s97, v61
    v_mfma_f32_16x16x32_bf16 a[108:111], v[184:187], v[28:31], a[108:111]
    v_exp_f32 v18, v78
    v_mfma_f32_16x16x32_bf16 a[156:159], v[188:191], v[28:31], a[156:159]
    s_add_u32 s29, s28, 49152
    v_add_f32 v8, v8, v16
    v_add_f32 v8, v8, v17
    v_mfma_f32_16x16x32_bf16 a[156:159], v[172:175], v[24:27], a[156:159]
    s_waitcnt lgkmcnt(2)
    v_exp_f32 v19, v79
    v_mfma_f32_16x16x32_bf16 a[16:19], v[160:163], v[32:35], a[16:19]
    s_sub_u32 s3, s29, 147456
    ds_read_b128 v[24:27], v1 offset:6144
    v_lshlrev_b32 v50, 16, v63
    v_mfma_f32_16x16x32_bf16 a[16:19], v[176:179], v[36:39], a[16:19]
    s_add_u32 s56, s56, 12288
    v_cvt_pk_bf16_f32 v76, v16, v17
    v_and_b32 v51, s97, v63
    v_mfma_f32_16x16x32_bf16 a[64:67], v[180:183], v[36:39], a[64:67]
    s_min_u32 s29, s29, s3
    v_exp_f32 v16, v108
    v_mfma_f32_16x16x32_bf16 a[64:67], v[164:167], v[32:35], a[64:67]
    s_mov_b32 m0, s56
    v_add_f32 v8, v8, v18
    v_add_f32 v8, v8, v19
    v_mfma_f32_16x16x32_bf16 a[112:115], v[168:171], v[32:35], a[112:115]
    ds_read_b128 v[28:31], v1 offset:18432
    v_mul_f32_e64 v50, -v50, v48
    v_mfma_f32_16x16x32_bf16 a[112:115], v[184:187], v[36:39], a[112:115]
    v_exp_f32 v17, v109
    v_mfma_f32_16x16x32_bf16 a[160:163], v[188:191], v[36:39], a[160:163]
    v_cvt_pk_bf16_f32 v77, v18, v19
    v_mul_f32_e64 v51, -v51, v49
    v_mfma_f32_16x16x32_bf16 a[160:163], v[172:175], v[32:35], a[160:163]
    s_waitcnt lgkmcnt(2)
    v_exp_f32 v18, v110
    v_mfma_f32_16x16x32_bf16 a[20:23], v[160:163], v[40:43], a[20:23]
    s_sub_u32 s3, s29, s28
    ds_read_b128 v[32:35], v1 offset:7168
    v_add_f32 v8, v8, v16
    v_mfma_f32_16x16x32_bf16 a[20:23], v[176:179], v[44:47], a[20:23]
    v_add_f32 v8, v8, v17
    v_cvt_f32_i32 v248, v248
    v_mfma_f32_16x16x32_bf16 a[68:71], v[180:183], v[44:47], a[68:71]
    v_exp_f32 v19, v111
    v_mfma_f32_16x16x32_bf16 a[68:71], v[164:167], v[40:43], a[68:71]
    buffer_load_dwordx4 v4, s[4:7], s27 offen offset:0 sc1 lds
    v_mfma_f32_16x16x32_bf16 a[116:119], v[168:171], v[40:43], a[116:119]
    ds_read_b128 v[36:39], v1 offset:19456
    v_cvt_pk_bf16_f32 v78, v16, v17
    v_mfma_f32_16x16x32_bf16 a[116:119], v[184:187], v[44:47], a[116:119]
    v_add_f32 v8, v8, v18
    v_cvt_f32_i32 v252, v252
    v_mfma_f32_16x16x32_bf16 a[164:167], v[188:191], v[44:47], a[164:167]
    s_mov_b32 s28, s29
    v_add_f32 v8, v8, v19
    v_cvt_pk_bf16_f32 v79, v18, v19
    v_mfma_f32_16x16x32_bf16 a[164:167], v[172:175], v[40:43], a[164:167]
    s_waitcnt lgkmcnt(2)
    v_exp_f32 v16, v80
    v_mfma_f32_16x16x32_bf16 a[24:27], v[160:163], v[24:27], a[24:27]
    ds_read_b128 v[40:43], v1 offset:8192
    v_fma_f32 v248, v248, v48, v50
    v_mfma_f32_16x16x32_bf16 a[24:27], v[176:179], v[28:31], a[24:27]
    v_exp_f32 v17, v81
    v_mfma_f32_16x16x32_bf16 a[72:75], v[180:183], v[28:31], a[72:75]
    v_fma_f32 v252, v252, v49, v51
    v_cvt_f32_i32 v249, v249
    v_mfma_f32_16x16x32_bf16 a[72:75], v[164:167], v[24:27], a[72:75]
    buffer_load_dwordx4 v4, s[4:7], s27 offen offset:1024 sc1 lds
    v_mfma_f32_16x16x32_bf16 a[120:123], v[168:171], v[24:27], a[120:123]
    ds_read_b128 v[44:47], v1 offset:20480
    v_cvt_f32_i32 v253, v253
    v_mfma_f32_16x16x32_bf16 a[120:123], v[184:187], v[28:31], a[120:123]
    v_exp_f32 v18, v82
    v_mfma_f32_16x16x32_bf16 a[168:171], v[188:191], v[28:31], a[168:171]
    v_add_f32 v5, v5, v16
    v_add_f32 v5, v5, v17
    v_mfma_f32_16x16x32_bf16 a[168:171], v[172:175], v[24:27], a[168:171]
    s_waitcnt lgkmcnt(2)
    v_exp_f32 v19, v83
    v_mfma_f32_16x16x32_bf16 a[28:31], v[160:163], v[32:35], a[28:31]
    ds_read_b128 v[24:27], v1 offset:9216
    v_cvt_pk_bf16_f32 v80, v16, v17
    v_mfma_f32_16x16x32_bf16 a[28:31], v[176:179], v[36:39], a[28:31]
    v_exp_f32 v16, v112
    v_mfma_f32_16x16x32_bf16 a[76:79], v[180:183], v[36:39], a[76:79]
    v_add_f32 v5, v5, v18
    v_fma_f32 v249, v249, v48, v50
    v_mfma_f32_16x16x32_bf16 a[76:79], v[164:167], v[32:35], a[76:79]
    v_add_f32 v5, v5, v19
    v_add_u32 v2, s3, v2
    v_mfma_f32_16x16x32_bf16 a[124:127], v[168:171], v[32:35], a[124:127]
    ds_read_b128 v[28:31], v1 offset:21504
    v_fma_f32 v253, v253, v49, v51
    v_mfma_f32_16x16x32_bf16 a[124:127], v[184:187], v[36:39], a[124:127]
    buffer_load_dwordx4 v4, s[4:7], s27 offen offset:2048 sc1 lds
    v_mfma_f32_16x16x32_bf16 a[172:175], v[188:191], v[36:39], a[172:175]
    v_exp_f32 v17, v113
    v_mfma_f32_16x16x32_bf16 a[172:175], v[172:175], v[32:35], a[172:175]
    s_waitcnt lgkmcnt(2)
    v_cvt_pk_bf16_f32 v81, v18, v19
    v_cvt_f32_i32 v250, v250
    v_mfma_f32_16x16x32_bf16 a[32:35], v[160:163], v[40:43], a[32:35]
    ds_read_b128 v[32:35], v1 offset:10240
    v_add_u32 v3, s3, v3
    v_mfma_f32_16x16x32_bf16 a[32:35], v[176:179], v[44:47], a[32:35]
    v_exp_f32 v18, v114
    v_mfma_f32_16x16x32_bf16 a[80:83], v[180:183], v[44:47], a[80:83]
    v_add_f32 v5, v5, v16
    v_add_f32 v5, v5, v17
    v_mfma_f32_16x16x32_bf16 a[80:83], v[164:167], v[40:43], a[80:83]
    v_exp_f32 v19, v115
    v_mfma_f32_16x16x32_bf16 a[128:131], v[168:171], v[40:43], a[128:131]
    ds_read_b128 v[36:39], v1 offset:22528
    v_cvt_pk_bf16_f32 v82, v16, v17
    v_mfma_f32_16x16x32_bf16 a[128:131], v[184:187], v[44:47], a[128:131]
    v_exp_f32 v16, v84
    v_mfma_f32_16x16x32_bf16 a[176:179], v[188:191], v[44:47], a[176:179]
    v_cvt_f32_i32 v254, v254
    v_add_f32 v5, v5, v18
    v_mfma_f32_16x16x32_bf16 a[176:179], v[172:175], v[40:43], a[176:179]
    s_waitcnt lgkmcnt(2)
    v_add_f32 v5, v5, v19
    v_fma_f32 v250, v250, v48, v50
    v_mfma_f32_16x16x32_bf16 a[36:39], v[160:163], v[24:27], a[36:39]
    ds_read_b128 v[40:43], v1 offset:11264
    v_fma_f32 v254, v254, v49, v51
    v_mfma_f32_16x16x32_bf16 a[36:39], v[176:179], v[28:31], a[36:39]
    v_exp_f32 v17, v85
    v_mfma_f32_16x16x32_bf16 a[84:87], v[180:183], v[28:31], a[84:87]
    v_cvt_pk_bf16_f32 v83, v18, v19
    v_cvt_pk_bf16_f32 v146, v240, v244
    v_mfma_f32_16x16x32_bf16 a[84:87], v[164:167], v[24:27], a[84:87]
    s_add_u32 s27, s27, 24576
    v_exp_f32 v18, v86
    v_mfma_f32_16x16x32_bf16 a[132:135], v[168:171], v[24:27], a[132:135]
    s_add_u32 s56, s56, 36864
    ds_read_b128 v[44:47], v1 offset:23552
    v_add_f32 v6, v6, v16
    v_mfma_f32_16x16x32_bf16 a[132:135], v[184:187], v[28:31], a[132:135]
    s_sub_u32 s58, s56, 147456
    v_add_f32 v6, v6, v17
    v_cvt_pk_bf16_f32 v150, v241, v245
    v_mfma_f32_16x16x32_bf16 a[180:183], v[188:191], v[28:31], a[180:183]
    v_exp_f32 v19, v87
    v_mfma_f32_16x16x32_bf16 a[180:183], v[172:175], v[24:27], a[180:183]
    s_waitcnt lgkmcnt(2)
    v_cvt_pk_bf16_f32 v84, v16, v17
    v_cvt_pk_bf16_f32 v147, v248, v252
    v_mfma_f32_16x16x32_bf16 a[40:43], v[160:163], v[32:35], a[40:43]
    s_min_u32 s56, s56, s58
    ds_read_b128 v[24:27], v2 offset:0
    v_mfma_f32_16x16x32_bf16 a[40:43], v[176:179], v[36:39], a[40:43]
    v_exp_f32 v16, v116
    v_mfma_f32_16x16x32_bf16 a[88:91], v[180:183], v[36:39], a[88:91]
    v_add_f32 v6, v6, v18
    v_add_f32 v6, v6, v19
    v_mfma_f32_16x16x32_bf16 a[88:91], v[164:167], v[32:35], a[88:91]
    v_exp_f32 v17, v117
    v_mfma_f32_16x16x32_bf16 a[136:139], v[168:171], v[32:35], a[136:139]
    ds_read_b128 v[28:31], v3 offset:0
    v_cvt_pk_bf16_f32 v151, v249, v253
    v_mfma_f32_16x16x32_bf16 a[136:139], v[184:187], v[36:39], a[136:139]
    v_cvt_pk_bf16_f32 v85, v18, v19
    v_cvt_pk_bf16_f32 v154, v242, v246
    v_mfma_f32_16x16x32_bf16 a[184:187], v[188:191], v[36:39], a[184:187]
    v_exp_f32 v18, v118
    v_mfma_f32_16x16x32_bf16 a[184:187], v[172:175], v[32:35], a[184:187]
    s_waitcnt lgkmcnt(2)
    v_add_f32 v6, v6, v16
    v_mfma_f32_16x16x32_bf16 a[44:47], v[160:163], v[40:43], a[44:47]
    ds_read_b128 v[32:35], v2 offset:6144
    v_add_f32 v6, v6, v17
    v_mfma_f32_16x16x32_bf16 a[44:47], v[176:179], v[44:47], a[44:47]
    v_exp_f32 v19, v119
    v_mfma_f32_16x16x32_bf16 a[92:95], v[180:183], v[44:47], a[92:95]
    v_cvt_pk_bf16_f32 v155, v250, v254
    v_mfma_f32_16x16x32_bf16 a[92:95], v[164:167], v[40:43], a[92:95]
    v_cvt_pk_bf16_f32 v86, v16, v17
    v_mfma_f32_16x16x32_bf16 a[140:143], v[168:171], v[40:43], a[140:143]
    ds_read_b128 v[36:39], v3 offset:6144
    v_add_f32 v6, v6, v18
    v_mfma_f32_16x16x32_bf16 a[140:143], v[184:187], v[44:47], a[140:143]
    v_add_f32 v6, v6, v19
    v_cvt_pk_bf16_f32 v87, v18, v19
    v_mfma_f32_16x16x32_bf16 a[188:191], v[188:191], v[44:47], a[188:191]
    v_mfma_f32_16x16x32_bf16 a[188:191], v[172:175], v[40:43], a[188:191]
    s_waitcnt lgkmcnt(2)
L_join:
    v_mfma_f32_16x16x32_bf16 v[160:163], v[24:27], a[192:195], v[128:131]
L_pg5:
    s_cbranch_execz L_pg9
    ds_read_b128 v[40:43], v2 offset:128
    v_mfma_f32_16x16x32_bf16 v[160:163], v[28:31], a[196:199], v[160:163]
    s_waitcnt vmcnt(4)
    v_subrev_u32 v52, s92, v52
    v_cmp_lt_u32 vcc, 15, v52
    v_mfma_f32_16x16x32_bf16 v[164:167], v[28:31], a[220:223], v[132:135]
    v_exp_f32 v16, v88
    v_mfma_f32_16x16x32_bf16 v[164:167], v[24:27], a[216:219], v[164:167]
    v_exp_f32 v17, v89
    v_mfma_f32_16x16x32_bf16 v[168:171], v[24:27], a[240:243], v[136:139]
    s_and_b32 s59, vcc_lo, 0xff
    ds_read_b128 v[44:47], v3 offset:128
    v_mfma_f32_16x16x32_bf16 v[168:171], v[28:31], a[244:247], v[168:171]
    s_cbranch_scc1 L_pollslow1
L_pollok1:
    v_mfma_f32_16x16x32_bf16 v[172:175], v[28:31], v[204:207], v[140:143]
    s_add_u32 s92, s92, 1
    v_exp_f32 v18, v90
    v_mfma_f32_16x16x32_bf16 v[172:175], v[24:27], v[200:203], v[172:175]
    s_waitcnt lgkmcnt(2)
    v_add_f32 v7, v7, v16
    v_add_f32 v7, v7, v17
    v_mfma_f32_16x16x32_bf16 v[96:99], v[32:35], a[192:195], v[128:131]
    ds_read_b128 v[24:27], v2 offset:6272
    v_mfma_f32_16x16x32_bf16 v[96:99], v[36:39], a[196:199], v[96:99]
    buffer_store_dwordx4 v[144:147], v15, s[4:7], s35 offen offset:0 sc1
    v_mfma_f32_16x16x32_bf16 v[100:103], v[36:39], a[220:223], v[132:135]
    v_exp_f32 v19, v91
    v_mfma_f32_16x16x32_bf16 v[100:103], v[32:35], a[216:219], v[100:103]
    v_cvt_pk_bf16_f32 v88, v16, v17
    v_mfma_f32_16x16x32_bf16 v[104:107], v[32:35], a[240:243], v[136:139]
    ds_read_b128 v[28:31], v3 offset:6272
    v_mfma_f32_16x16x32_bf16 v[104:107], v[36:39], a[244:247], v[104:107]
    v_exp_f32 v16, v120
    v_mfma_f32_16x16x32_bf16 v[108:111], v[36:39], v[204:207], v[140:143]
    v_add_f32 v7, v7, v18
    v_add_f32 v7, v7, v19
    v_mfma_f32_16x16x32_bf16 v[108:111], v[32:35], v[200:203], v[108:111]
    s_waitcnt lgkmcnt(2)
    v_exp_f32 v17, v121
    v_mfma_f32_16x16x32_bf16 v[160:163], v[40:43], a[200:203], v[160:163]
    ds_read_b128 v[32:35], v2 offset:256
    v_cvt_pk_bf16_f32 v89, v18, v19
    v_mfma_f32_16x16x32_bf16 v[160:163], v[44:47], a[204:207], v[160:163]
    buffer_store_dwordx4 v[148:151], v15, s[4:7], s35 offen offset:1024 sc1
    v_mfma_f32_16x16x32_bf16 v[164:167], v[44:47], a[228:231], v[164:167]
    v_exp_f32 v18, v122
    v_mfma_f32_16x16x32_bf16 v[164:167], v[40:43], a[224:227], v[164:167]
    v_add_f32 v7, v7, v16
    v_add_f32 v7, v7, v17
    v_mfma_f32_16x16x32_bf16 v[168:171], v[40:43], a[248:251], v[168:171]
    ds_read_b128 v[36:39], v3 offset:256
    v_mfma_f32_16x16x32_bf16 v[168:171], v[44:47], a[252:255], v[168:171]
    v_exp_f32 v19, v123
    v_mfma_f32_16x16x32_bf16 v[172:175], v[44:47], v[212:215], v[172:175]
    v_cvt_pk_bf16_f32 v90, v16, v17
    v_mfma_f32_16x16x32_bf16 v[172:175], v[40:43], v[208:211], v[172:175]
    s_waitcnt lgkmcnt(2)
    v_exp_f32 v16, v92
    v_mfma_f32_16x16x32_bf16 v[96:99], v[24:27], a[200:203], v[96:99]
    ds_read_b128 v[40:43], v2 offset:6400
    v_add_f32 v7, v7, v18
    v_mfma_f32_16x16x32_bf16 v[96:99], v[28:31], a[204:207], v[96:99]
    buffer_store_dwordx4 v[152:155], v15, s[4:7], s35 offen offset:2048 sc1
    v_mfma_f32_16x16x32_bf16 v[100:103], v[28:31], a[228:231], v[100:103]
    v_add_f32 v7, v7, v19
    v_mfma_f32_16x16x32_bf16 v[100:103], v[24:27], a[224:227], v[100:103]
    v_exp_f32 v17, v93
    v_mfma_f32_16x16x32_bf16 v[104:107], v[24:27], a[248:251], v[104:107]
    ds_read_b128 v[44:47], v3 offset:6400
    v_cvt_pk_bf16_f32 v91, v18, v19
    v_mfma_f32_16x16x32_bf16 v[104:107], v[28:31], a[252:255], v[104:107]
    v_exp_f32 v18, v94
    v_mfma_f32_16x16x32_bf16 v[108:111], v[28:31], v[212:215], v[108:111]
    s_add_u32 s29, s30, 49152
    v_add_f32 v8, v8, v16
    v_add_f32 v8, v8, v17
    v_mfma_f32_16x16x32_bf16 v[108:111], v[24:27], v[208:211], v[108:111]
    s_waitcnt lgkmcnt(2)
    v_exp_f32 v19, v95
    v_mfma_f32_16x16x32_bf16 v[160:163], v[32:35], a[208:211], v[160:163]
    s_sub_u32 s3, s29, 147456
    ds_read_b128 v[24:27], v2 offset:12288
    v_cvt_pk_bf16_f32 v92, v16, v17
    v_mfma_f32_16x16x32_bf16 v[160:163], v[36:39], a[212:215], v[160:163]
    s_min_u32 s29, s29, s3
    v_exp_f32 v16, v124
    v_mfma_f32_16x16x32_bf16 v[164:167], v[36:39], a[236:239], v[164:167]
    v_add_f32 v8, v8, v18
    v_add_f32 v8, v8, v19
    v_mfma_f32_16x16x32_bf16 v[164:167], v[32:35], a[232:235], v[164:167]
    v_exp_f32 v17, v125
    v_mfma_f32_16x16x32_bf16 v[168:171], v[32:35], v[192:195], v[168:171]
    ds_read_b128 v[28:31], v3 offset:12288
    v_mfma_f32_16x16x32_bf16 v[168:171], v[36:39], v[196:199], v[168:171]
    v_cvt_pk_bf16_f32 v93, v18, v19
    v_mfma_f32_16x16x32_bf16 v[172:175], v[36:39], v[220:223], v[172:175]
    v_exp_f32 v18, v126
    v_mfma_f32_16x16x32_bf16 v[172:175], v[32:35], v[216:219], v[172:175]
    s_waitcnt lgkmcnt(2)
    v_add_f32 v8, v8, v16
    v_mfma_f32_16x16x32_bf16 v[96:99], v[40:43], a[208:211], v[96:99]
    s_waitcnt vmcnt(10)
    ds_read_b128 v[32:35], v2 offset:18432
    v_lshlrev_b32 v48, 16, v56
    v_mfma_f32_16x16x32_bf16 v[96:99], v[44:47], a[212:215], v[96:99]
    s_mov_b32 m0, s26
    v_add_f32 v8, v8, v17
    v_and_b32 v49, s97, v56
    v_mfma_f32_16x16x32_bf16 v[100:103], v[44:47], a[236:239], v[100:103]
    s_sub_u32 s3, s29, s30
    v_exp_f32 v19, v127
    v_mfma_f32_16x16x32_bf16 v[100:103], v[40:43], a[232:235], v[100:103]
    buffer_load_dwordx4 v4, s[4:7], s32 offen offset:0 sc1 lds
    v_mfma_f32_16x16x32_bf16 v[104:107], v[40:43], v[192:195], v[104:107]
    ds_read_b128 v[36:39], v3 offset:18432
    v_cvt_pk_bf16_f32 v94, v16, v17
    v_mfma_f32_16x16x32_bf16 v[104:107], v[44:47], v[196:199], v[104:107]
    v_add_f32 v8, v8, v18
    v_add_f32 v8, v8, v19
    v_mfma_f32_16x16x32_bf16 v[108:111], v[44:47], v[220:223], v[108:111]
    v_lshlrev_b32 v50, 16, v58
    v_cvt_pk_bf16_f32 v95, v18, v19
    v_mfma_f32_16x16x32_bf16 v[108:111], v[40:43], v[216:219], v[108:111]
    s_waitcnt lgkmcnt(2)
    buffer_load_dwordx4 v4, s[4:7], s32 offen offset:1024 sc1 lds
    v_mfma_f32_16x16x32_bf16 v[176:179], v[24:27], a[192:195], v[128:131]
    ds_read_b128 v[40:43], v2 offset:12416
    v_and_b32 v51, s97, v58
    v_mfma_f32_16x16x32_bf16 v[176:179], v[28:31], a[196:199], v[176:179]
    s_mov_b32 s30, s29
    v_exp_f32 v16, v160
    v_mfma_f32_16x16x32_bf16 v[180:183], v[28:31], a[220:223], v[132:135]
    v_exp_f32 v17, v161
    v_mfma_f32_16x16x32_bf16 v[180:183], v[24:27], a[216:219], v[180:183]
    buffer_load_dwordx4 v4, s[4:7], s32 offen offset:2048 sc1 lds
    v_mfma_f32_16x16x32_bf16 v[184:187], v[24:27], a[240:243], v[136:139]
    s_add_u32 s32, s32, 24576
    ds_read_b128 v[44:47], v3 offset:12416
    v_mul_f32 v48, s38, v48
    v_mfma_f32_16x16x32_bf16 v[184:187], v[28:31], a[244:247], v[184:187]
    v_exp_f32 v18, v162
    v_mfma_f32_16x16x32_bf16 v[188:191], v[28:31], v[204:207], v[140:143]
    s_add_u32 s26, s26, 12288
    v_add_f32 v5, v5, v16
    v_add_f32 v5, v5, v17
    v_mfma_f32_16x16x32_bf16 v[188:191], v[24:27], v[200:203], v[188:191]
    s_waitcnt lgkmcnt(2)
    v_exp_f32 v19, v163
    v_mfma_f32_16x16x32_bf16 v[112:115], v[32:35], a[192:195], v[128:131]
    s_mov_b32 m0, s26
    ds_read_b128 v[24:27], v2 offset:18560
    v_mul_f32 v49, s38, v49
    v_mfma_f32_16x16x32_bf16 v[112:115], v[36:39], a[196:199], v[112:115]
    v_cvt_pk_bf16_f32 v160, v16, v17
    v_mul_f32_e64 v50, -v50, v48
    v_mfma_f32_16x16x32_bf16 v[116:119], v[36:39], a[220:223], v[132:135]
    v_exp_f32 v16, v96
    v_mfma_f32_16x16x32_bf16 v[116:119], v[32:35], a[216:219], v[116:119]
    v_add_f32 v5, v5, v18
    v_mul_f32_e64 v51, -v51, v49
    v_mfma_f32_16x16x32_bf16 v[120:123], v[32:35], a[240:243], v[136:139]
    ds_read_b128 v[28:31], v3 offset:18560
    v_add_f32 v5, v5, v19
    v_mfma_f32_16x16x32_bf16 v[120:123], v[36:39], a[244:247], v[120:123]
    buffer_load_dwordx4 v4, s[4:7], s32 offen offset:0 sc1 lds
    v_mfma_f32_16x16x32_bf16 v[124:127], v[36:39], v[204:207], v[140:143]
    v_exp_f32 v17, v97
    v_mfma_f32_16x16x32_bf16 v[124:127], v[32:35], v[200:203], v[124:127]
    s_waitcnt lgkmcnt(2)
    v_cvt_pk_bf16_f32 v161, v18, v19
    v_cvt_f32_i32 v224, v224
    v_mfma_f32_16x16x32_bf16 v[176:179], v[40:43], a[200:203], v[176:179]
    ds_read_b128 v[32:35], v2 offset:12544
    v_cvt_f32_i32 v225, v225
    v_mfma_f32_16x16x32_bf16 v[176:179], v[44:47], a[204:207], v[176:179]
    buffer_load_dwordx4 v4, s[4:7], s32 offen offset:1024 sc1 lds
    v_mfma_f32_16x16x32_bf16 v[180:183], v[44:47], a[228:231], v[180:183]
    v_exp_f32 v18, v98
    v_mfma_f32_16x16x32_bf16 v[180:183], v[40:43], a[224:227], v[180:183]
    v_add_f32 v5, v5, v16
    v_add_f32 v5, v5, v17
    v_mfma_f32_16x16x32_bf16 v[184:187], v[40:43], a[248:251], v[184:187]
    ds_read_b128 v[36:39], v3 offset:12544
    v_fma_f32 v224, v224, v48, v50
    v_mfma_f32_16x16x32_bf16 v[184:187], v[44:47], a[252:255], v[184:187]
    buffer_load_dwordx4 v4, s[4:7], s32 offen offset:2048 sc1 lds
    v_mfma_f32_16x16x32_bf16 v[188:191], v[44:47], v[212:215], v[188:191]
    v_exp_f32 v19, v99
    v_mfma_f32_16x16x32_bf16 v[188:191], v[40:43], v[208:211], v[188:191]
    s_waitcnt lgkmcnt(2)
    v_cvt_pk_bf16_f32 v162, v16, v17
    v_fma_f32 v225, v225, v49, v51
    v_mfma_f32_16x16x32_bf16 v[112:115], v[24:27], a[200:203], v[112:115]
    ds_read_b128 v[40:43], v2 offset:18688
    v_add_u32 v1, s3, v1
    v_mfma_f32_16x16x32_bf16 v[112:115], v[28:31], a[204:207], v[112:115]
    v_exp_f32 v16, v164
    v_mfma_f32_16x16x32_bf16 v[116:119], v[28:31], a[228:231], v[116:119]
    v_add_f32 v5, v5, v18
    v_add_f32 v5, v5, v19
    v_mfma_f32_16x16x32_bf16 v[116:119], v[24:27], a[224:227], v[116:119]
    s_add_u32 s32, s32, 24576
    v_exp_f32 v17, v165
    v_mfma_f32_16x16x32_bf16 v[120:123], v[24:27], a[248:251], v[120:123]
    s_add_u32 s26, s26, 36864
    ds_read_b128 v[44:47], v3 offset:18688
    v_cvt_pk_bf16_f32 v163, v18, v19
    v_mfma_f32_16x16x32_bf16 v[120:123], v[28:31], a[252:255], v[120:123]
    s_waitcnt lgkmcnt(2)
    v_exp_f32 v18, v166
    v_mfma_f32_16x16x32_bf16 v[124:127], v[28:31], v[212:215], v[124:127]
    s_waitcnt vmcnt(6)
    v_cvt_pk_bf16_f32 v224, v224, v225
    v_add_f32 v6, v6, v16
    v_mfma_f32_16x16x32_bf16 v[124:127], v[24:27], v[208:211], v[124:127]
    s_barrier
    v_mfma_f32_16x16x32_bf16 v[176:179], v[32:35], a[208:211], v[176:179]
    s_sub_u32 s57, s26, 147456
    ds_read_b128 v[24:27], v1 offset:0
    v_add_f32 v6, v6, v17
    v_mfma_f32_16x16x32_bf16 v[176:179], v[36:39], a[212:215], v[176:179]
    s_min_u32 s26, s26, s57
    v_exp_f32 v19, v167
    v_mfma_f32_16x16x32_bf16 v[180:183], v[36:39], a[236:239], v[180:183]
    v_cvt_f32_i32 v228, v228
    v_cvt_pk_bf16_f32 v164, v16, v17
    v_mfma_f32_16x16x32_bf16 v[180:183], v[32:35], a[232:235], v[180:183]
    v_cvt_f32_i32 v229, v229
    v_fma_f32 v228, v228, v48, v50
    v_mfma_f32_16x16x32_bf16 v[184:187], v[32:35], v[192:195], v[184:187]
    ds_read_b128 v[28:31], v1 offset:12288
    v_fma_f32 v229, v229, v49, v51
    v_mfma_f32_16x16x32_bf16 v[184:187], v[36:39], v[196:199], v[184:187]
    v_exp_f32 v16, v100
    v_mfma_f32_16x16x32_bf16 v[188:191], v[36:39], v[220:223], v[188:191]
    v_add_f32 v6, v6, v18
    v_add_f32 v6, v6, v19
    v_mfma_f32_16x16x32_bf16 v[188:191], v[32:35], v[216:219], v[188:191]
    s_waitcnt lgkmcnt(2)
    v_exp_f32 v17, v101
    v_mfma_f32_16x16x32_bf16 v[112:115], v[40:43], a[208:211], v[112:115]
    ds_read_b128 v[32:35], v1 offset:1024
    v_cvt_pk_bf16_f32 v165, v18, v19
    v_mfma_f32_16x16x32_bf16 v[112:115], v[44:47], a[212:215], v[112:115]
    v_exp_f32 v18, v102
    v_mfma_f32_16x16x32_bf16 v[116:119], v[44:47], a[236:239], v[116:119]
    v_cvt_pk_bf16_f32 v228, v228, v229
    v_add_u32 v0, 1, v0
    v_mfma_f32_16x16x32_bf16 v[116:119], v[40:43], a[232:235], v[116:119]
    buffer_store_dword v0, v13, s[20:23], 0 offen offset:32 sc1
    v_mfma_f32_16x16x32_bf16 v[120:123], v[40:43], v[192:195], v[120:123]
    ds_read_b128 v[36:39], v1 offset:13312
    v_add_f32 v6, v6, v16
    v_mfma_f32_16x16x32_bf16 v[120:123], v[44:47], v[196:199], v[120:123]
    v_add_f32 v6, v6, v17
    v_cvt_f32_i32 v232, v232
    v_mfma_f32_16x16x32_bf16 v[124:127], v[44:47], v[220:223], v[124:127]
    v_exp_f32 v19, v103
    v_mfma_f32_16x16x32_bf16 v[124:127], v[40:43], v[216:219], v[124:127]
    s_waitcnt lgkmcnt(2)
    v_cvt_pk_bf16_f32 v166, v16, v17
    v_add_f32 v6, v6, v18
    v_cvt_f32_i32 v233, v233
    v_add_f32 v6, v6, v19
    v_fma_f32 v232, v232, v48, v50
    v_cvt_pk_bf16_f32 v167, v18, v19
    v_fma_f32 v233, v233, v49, v51
    v_mfma_f32_16x16x32_bf16 a[0:3], v[64:67], v[24:27], a[0:3]
    s_mov_b32 m0, s26
    ds_read_b128 v[40:43], v1 offset:2048
    v_cvt_pk_bf16_f32 v232, v232, v233
    v_mfma_f32_16x16x32_bf16 a[0:3], v[80:83], v[28:31], a[0:3]
    buffer_load_dwordx2 v[60:61], v10, s[72:75], s36 offen offset:192
    v_mfma_f32_16x16x32_bf16 a[48:51], v[84:87], v[28:31], a[48:51]
    v_exp_f32 v16, v168
    v_mfma_f32_16x16x32_bf16 a[48:51], v[68:71], v[24:27], a[48:51]
    v_exp_f32 v17, v169
    v_mfma_f32_16x16x32_bf16 a[96:99], v[72:75], v[24:27], a[96:99]
    ds_read_b128 v[44:47], v1 offset:14336
    v_cvt_f32_i32 v236, v236
    v_mfma_f32_16x16x32_bf16 a[96:99], v[88:91], v[28:31], a[96:99]
    buffer_load_dwordx4 v4, s[4:7], s32 offen offset:0 sc1 lds
    v_mfma_f32_16x16x32_bf16 a[144:147], v[92:95], v[28:31], a[144:147]
    v_exp_f32 v18, v170
    v_mfma_f32_16x16x32_bf16 a[144:147], v[76:79], v[24:27], a[144:147]
    s_waitcnt lgkmcnt(2)
    v_add_f32 v7, v7, v16
    v_add_f32 v7, v7, v17
    v_mfma_f32_16x16x32_bf16 a[4:7], v[64:67], v[32:35], a[4:7]
    ds_read_b128 v[24:27], v1 offset:3072
    v_cvt_f32_i32 v237, v237
    v_mfma_f32_16x16x32_bf16 a[4:7], v[80:83], v[36:39], a[4:7]
    buffer_load_dwordx2 v[62:63], v10, s[76:79], s36 offen offset:192
    v_mfma_f32_16x16x32_bf16 a[52:55], v[84:87], v[36:39], a[52:55]
    v_exp_f32 v19, v171
    v_mfma_f32_16x16x32_bf16 a[52:55], v[68:71], v[32:35], a[52:55]
    v_cvt_pk_bf16_f32 v168, v16, v17
    v_fma_f32 v236, v236, v48, v50
    v_mfma_f32_16x16x32_bf16 a[100:103], v[72:75], v[32:35], a[100:103]
    ds_read_b128 v[28:31], v1 offset:15360
    v_fma_f32 v237, v237, v49, v51
    v_mfma_f32_16x16x32_bf16 a[100:103], v[88:91], v[36:39], a[100:103]
    buffer_load_dwordx4 v[240:243], v9, s[64:67], s33 offen offset:384 nt
    v_mfma_f32_16x16x32_bf16 a[148:151], v[92:95], v[36:39], a[148:151]
    v_exp_f32 v16, v104
    v_mfma_f32_16x16x32_bf16 a[148:151], v[76:79], v[32:35], a[148:151]
    s_waitcnt lgkmcnt(2)
    v_add_f32 v7, v7, v18
    v_add_f32 v7, v7, v19
    v_mfma_f32_16x16x32_bf16 a[8:11], v[64:67], v[40:43], a[8:11]
    ds_read_b128 v[32:35], v1 offset:4096
    v_cvt_pk_bf16_f32 v236, v236, v237
    v_mfma_f32_16x16x32_bf16 a[8:11], v[80:83], v[44:47], a[8:11]
    buffer_load_dwordx4 v4, s[4:7], s32 offen offset:1024 sc1 lds
    v_mfma_f32_16x16x32_bf16 a[56:59], v[84:87], v[44:47], a[56:59]
    v_exp_f32 v17, v105
    v_mfma_f32_16x16x32_bf16 a[56:59], v[68:71], v[40:43], a[56:59]
    v_cvt_pk_bf16_f32 v169, v18, v19
    v_lshlrev_b32 v48, 16, v57
    v_mfma_f32_16x16x32_bf16 a[104:107], v[72:75], v[40:43], a[104:107]
    ds_read_b128 v[36:39], v1 offset:16384
    v_mfma_f32_16x16x32_bf16 a[104:107], v[88:91], v[44:47], a[104:107]
    buffer_load_dwordx4 v[244:247], v9, s[64:67], s33 offen offset:1920 nt
    v_mfma_f32_16x16x32_bf16 a[152:155], v[92:95], v[44:47], a[152:155]
    v_exp_f32 v18, v106
    v_mfma_f32_16x16x32_bf16 a[152:155], v[76:79], v[40:43], a[152:155]
    s_waitcnt lgkmcnt(2)
    v_add_f32 v7, v7, v16
    v_add_f32 v7, v7, v17
    v_mfma_f32_16x16x32_bf16 a[12:15], v[64:67], v[24:27], a[12:15]
    ds_read_b128 v[40:43], v1 offset:5120
    v_and_b32 v49, s97, v57
    v_mfma_f32_16x16x32_bf16 a[12:15], v[80:83], v[28:31], a[12:15]
    buffer_load_dwordx4 v4, s[4:7], s32 offen offset:2048 sc1 lds
    v_mfma_f32_16x16x32_bf16 a[60:63], v[84:87], v[28:31], a[60:63]
    v_exp_f32 v19, v107
    v_mfma_f32_16x16x32_bf16 a[60:63], v[68:71], v[24:27], a[60:63]
    v_cvt_pk_bf16_f32 v170, v16, v17
    v_exp_f32 v16, v172
    v_mfma_f32_16x16x32_bf16 a[108:111], v[72:75], v[24:27], a[108:111]
    ds_read_b128 v[44:47], v1 offset:17408
    v_add_f32 v7, v7, v18
    v_mfma_f32_16x16x32_bf16 a[108:111], v[88:91], v[28:31], a[108:111]
    buffer_load_dwordx4 v[248:251], v9, s[64:67], s34 offen offset:384 nt
    v_add_f32 v7, v7, v19
    v_mfma_f32_16x16x32_bf16 a[156:159], v[92:95], v[28:31], a[156:159]
    s_add_u32 s29, s28, 49152
    v_exp_f32 v17, v173
    v_mfma_f32_16x16x32_bf16 a[156:159], v[76:79], v[24:27], a[156:159]
    s_waitcnt lgkmcnt(2)
    v_cvt_pk_bf16_f32 v171, v18, v19
    v_lshlrev_b32 v50, 16, v59
    v_mfma_f32_16x16x32_bf16 a[16:19], v[64:67], v[32:35], a[16:19]
    s_sub_u32 s3, s29, 147456
    ds_read_b128 v[24:27], v1 offset:6144
    v_and_b32 v51, s97, v59
    v_mfma_f32_16x16x32_bf16 a[16:19], v[80:83], v[36:39], a[16:19]
    s_add_u32 s32, s32, 24576
    buffer_load_dwordx4 v[252:255], v9, s[64:67], s34 offen offset:1920 nt
    v_mfma_f32_16x16x32_bf16 a[64:67], v[84:87], v[36:39], a[64:67]
    s_min_u32 s29, s29, s3
    v_exp_f32 v18, v174
    v_mfma_f32_16x16x32_bf16 a[64:67], v[68:71], v[32:35], a[64:67]
    v_add_f32 v8, v8, v16
    v_add_f32 v8, v8, v17
    v_mfma_f32_16x16x32_bf16 a[112:115], v[72:75], v[32:35], a[112:115]
    s_add_u32 s26, s26, 12288
    ds_read_b128 v[28:31], v1 offset:18432
    v_mul_f32 v48, s38, v48
    v_mfma_f32_16x16x32_bf16 a[112:115], v[88:91], v[36:39], a[112:115]
    v_exp_f32 v19, v175
    v_cvt_pk_bf16_f32 v172, v16, v17
    v_mfma_f32_16x16x32_bf16 a[160:163], v[92:95], v[36:39], a[160:163]
    v_exp_f32 v16, v108
    v_mfma_f32_16x16x32_bf16 a[160:163], v[76:79], v[32:35], a[160:163]
    s_waitcnt lgkmcnt(2)
    v_add_f32 v8, v8, v18
    v_add_f32 v8, v8, v19
    v_mfma_f32_16x16x32_bf16 a[20:23], v[64:67], v[40:43], a[20:23]
    s_sub_u32 s3, s29, s28
    ds_read_b128 v[32:35], v1 offset:7168
    v_mul_f32 v49, s38, v49
    v_mfma_f32_16x16x32_bf16 a[20:23], v[80:83], v[44:47], a[20:23]
L_pg6:
    s_cbranch_execz L_pg10
    v_exp_f32 v17, v109
    v_mfma_f32_16x16x32_bf16 a[68:71], v[84:87], v[44:47], a[68:71]
    s_mov_b32 m0, s26
    v_cvt_pk_bf16_f32 v173, v18, v19
    v_mul_f32_e64 v50, -v50, v48
    v_mfma_f32_16x16x32_bf16 a[68:71], v[68:71], v[40:43], a[68:71]
    v_exp_f32 v18, v110
    v_mfma_f32_16x16x32_bf16 a[116:119], v[72:75], v[40:43], a[116:119]
    ds_read_b128 v[36:39], v1 offset:19456
    v_add_f32 v8, v8, v16
    v_mfma_f32_16x16x32_bf16 a[116:119], v[88:91], v[44:47], a[116:119]
    v_add_f32 v8, v8, v17
    v_mul_f32_e64 v51, -v51, v49
    v_mfma_f32_16x16x32_bf16 a[164:167], v[92:95], v[44:47], a[164:167]
    s_mov_b32 s28, s29
    v_exp_f32 v19, v111
    v_mfma_f32_16x16x32_bf16 a[164:167], v[76:79], v[40:43], a[164:167]
    s_waitcnt lgkmcnt(2)
    v_cvt_pk_bf16_f32 v174, v16, v17
    v_add_f32 v8, v8, v18
    v_mfma_f32_16x16x32_bf16 a[24:27], v[64:67], v[24:27], a[24:27]
    ds_read_b128 v[40:43], v1 offset:8192
    v_add_f32 v8, v8, v19
    v_mfma_f32_16x16x32_bf16 a[24:27], v[80:83], v[28:31], a[24:27]
    v_cvt_pk_bf16_f32 v175, v18, v19
    v_cvt_f32_i32 v226, v226
    v_mfma_f32_16x16x32_bf16 a[72:75], v[84:87], v[28:31], a[72:75]
    v_exp_f32 v16, v176
    v_mfma_f32_16x16x32_bf16 a[72:75], v[68:71], v[24:27], a[72:75]
    buffer_load_dwordx4 v4, s[4:7], s32 offen offset:0 sc1 lds
    v_mfma_f32_16x16x32_bf16 a[120:123], v[72:75], v[24:27], a[120:123]
    ds_read_b128 v[44:47], v1 offset:20480
    v_mfma_f32_16x16x32_bf16 a[120:123], v[88:91], v[28:31], a[120:123]
    v_exp_f32 v17, v177
    v_mfma_f32_16x16x32_bf16 a[168:171], v[92:95], v[28:31], a[168:171]
    v_exp_f32 v18, v178
    v_mfma_f32_16x16x32_bf16 a[168:171], v[76:79], v[24:27], a[168:171]
    s_waitcnt lgkmcnt(2)
    v_add_f32 v5, v5, v16
    v_add_f32 v5, v5, v17
    v_mfma_f32_16x16x32_bf16 a[28:31], v[64:67], v[32:35], a[28:31]
    ds_read_b128 v[24:27], v1 offset:9216
    v_cvt_f32_i32 v227, v227
    v_mfma_f32_16x16x32_bf16 a[28:31], v[80:83], v[36:39], a[28:31]
    v_exp_f32 v19, v179
    v_mfma_f32_16x16x32_bf16 a[76:79], v[84:87], v[36:39], a[76:79]
    v_cvt_pk_bf16_f32 v176, v16, v17
    v_add_u32 v2, s3, v2
    v_mfma_f32_16x16x32_bf16 a[76:79], v[68:71], v[32:35], a[76:79]
    v_exp_f32 v16, v112
    v_mfma_f32_16x16x32_bf16 a[124:127], v[72:75], v[32:35], a[124:127]
    ds_read_b128 v[28:31], v1 offset:21504
    v_add_f32 v5, v5, v18
    v_mfma_f32_16x16x32_bf16 a[124:127], v[88:91], v[36:39], a[124:127]
    v_add_f32 v5, v5, v19
    v_fma_f32 v226, v226, v48, v50
    v_mfma_f32_16x16x32_bf16 a[172:175], v[92:95], v[36:39], a[172:175]
    v_exp_f32 v17, v113
    v_mfma_f32_16x16x32_bf16 a[172:175], v[76:79], v[32:35], a[172:175]
    s_waitcnt lgkmcnt(2)
    buffer_load_dwordx4 v4, s[4:7], s32 offen offset:1024 sc1 lds
    v_mfma_f32_16x16x32_bf16 a[32:35], v[64:67], v[40:43], a[32:35]
    ds_read_b128 v[32:35], v1 offset:10240
    v_cvt_pk_bf16_f32 v177, v18, v19
    v_mfma_f32_16x16x32_bf16 a[32:35], v[80:83], v[44:47], a[32:35]
    v_exp_f32 v18, v114
    v_mfma_f32_16x16x32_bf16 a[80:83], v[84:87], v[44:47], a[80:83]
    v_add_f32 v5, v5, v16
    v_add_f32 v5, v5, v17
    v_mfma_f32_16x16x32_bf16 a[80:83], v[68:71], v[40:43], a[80:83]
    v_exp_f32 v19, v115
    v_mfma_f32_16x16x32_bf16 a[128:131], v[72:75], v[40:43], a[128:131]
    ds_read_b128 v[36:39], v1 offset:22528
    v_cvt_pk_bf16_f32 v178, v16, v17
    v_mfma_f32_16x16x32_bf16 a[128:131], v[88:91], v[44:47], a[128:131]
    v_exp_f32 v16, v180
    v_mfma_f32_16x16x32_bf16 a[176:179], v[92:95], v[44:47], a[176:179]
    v_fma_f32 v227, v227, v49, v51
    v_add_u32 v3, s3, v3
    v_mfma_f32_16x16x32_bf16 a[176:179], v[76:79], v[40:43], a[176:179]
    s_waitcnt lgkmcnt(2)
    v_add_f32 v5, v5, v18
    v_add_f32 v5, v5, v19
    v_mfma_f32_16x16x32_bf16 a[36:39], v[64:67], v[24:27], a[36:39]
    ds_read_b128 v[40:43], v1 offset:11264
    v_cvt_pk_bf16_f32 v225, v226, v227
    v_mfma_f32_16x16x32_bf16 a[36:39], v[80:83], v[28:31], a[36:39]
    buffer_load_dwordx4 v4, s[4:7], s32 offen offset:2048 sc1 lds
    v_mfma_f32_16x16x32_bf16 a[84:87], v[84:87], v[28:31], a[84:87]
    v_exp_f32 v17, v181
    v_mfma_f32_16x16x32_bf16 a[84:87], v[68:71], v[24:27], a[84:87]
    v_cvt_pk_bf16_f32 v179, v18, v19
    v_cvt_f32_i32 v230, v230
    v_mfma_f32_16x16x32_bf16 a[132:135], v[72:75], v[24:27], a[132:135]
    ds_read_b128 v[44:47], v1 offset:23552
    v_cvt_f32_i32 v231, v231
    v_mfma_f32_16x16x32_bf16 a[132:135], v[88:91], v[28:31], a[132:135]
    s_waitcnt lgkmcnt(2)
    v_exp_f32 v18, v182
    v_mfma_f32_16x16x32_bf16 a[180:183], v[92:95], v[28:31], a[180:183]
    s_waitcnt vmcnt(13)
    v_add_f32 v6, v6, v16
    v_add_f32 v6, v6, v17
    v_mfma_f32_16x16x32_bf16 a[180:183], v[76:79], v[24:27], a[180:183]
    s_barrier
    v_mfma_f32_16x16x32_bf16 a[40:43], v[64:67], v[32:35], a[40:43]
    ds_read_b128 v[24:27], v2 offset:0
    v_fma_f32 v230, v230, v48, v50
    v_mfma_f32_16x16x32_bf16 a[40:43], v[80:83], v[36:39], a[40:43]
    v_exp_f32 v19, v183
    v_mfma_f32_16x16x32_bf16 a[88:91], v[84:87], v[36:39], a[88:91]
    v_cvt_pk_bf16_f32 v180, v16, v17
    v_fma_f32 v231, v231, v49, v51
    v_mfma_f32_16x16x32_bf16 a[88:91], v[68:71], v[32:35], a[88:91]
    v_exp_f32 v16, v116
    v_mfma_f32_16x16x32_bf16 a[136:139], v[72:75], v[32:35], a[136:139]
    ds_read_b128 v[28:31], v3 offset:0
    v_add_f32 v6, v6, v18
    v_mfma_f32_16x16x32_bf16 a[136:139], v[88:91], v[36:39], a[136:139]
    v_add_f32 v6, v6, v19
    v_cvt_pk_bf16_f32 v229, v230, v231
    v_mfma_f32_16x16x32_bf16 a[184:187], v[92:95], v[36:39], a[184:187]
    v_exp_f32 v17, v117
    v_mfma_f32_16x16x32_bf16 a[184:187], v[76:79], v[32:35], a[184:187]
    s_waitcnt lgkmcnt(2)
    v_cvt_pk_bf16_f32 v181, v18, v19
    v_mfma_f32_16x16x32_bf16 a[44:47], v[64:67], v[40:43], a[44:47]
    ds_read_b128 v[32:35], v2 offset:6144
    v_mfma_f32_16x16x32_bf16 a[44:47], v[80:83], v[44:47], a[44:47]
    v_exp_f32 v18, v118
    v_mfma_f32_16x16x32_bf16 a[92:95], v[84:87], v[44:47], a[92:95]
    v_add_f32 v6, v6, v16
    v_add_f32 v6, v6, v17
    v_mfma_f32_16x16x32_bf16 a[92:95], v[68:71], v[40:43], a[92:95]
    s_add_u32 s32, s32, 24576
    v_exp_f32 v19, v119
    v_mfma_f32_16x16x32_bf16 a[140:143], v[72:75], v[40:43], a[140:143]
    s_add_u32 s26, s26, 36864
    ds_read_b128 v[36:39], v3 offset:6144
    v_cvt_pk_bf16_f32 v182, v16, v17
    v_mfma_f32_16x16x32_bf16 a[140:143], v[88:91], v[44:47], a[140:143]
    s_sub_u32 s57, s26, 147456
    v_add_f32 v6, v6, v18
    v_add_f32 v6, v6, v19
    v_mfma_f32_16x16x32_bf16 a[188:191], v[92:95], v[44:47], a[188:191]
    s_min_u32 s26, s26, s57
    v_cvt_pk_bf16_f32 v183, v18, v19
    v_mfma_f32_16x16x32_bf16 a[188:191], v[76:79], v[40:43], a[188:191]
    s_waitcnt lgkmcnt(2)
    v_mfma_f32_16x16x32_bf16 v[64:67], v[24:27], a[192:195], v[128:131]
    ds_read_b128 v[40:43], v2 offset:128
    v_cvt_f32_i32 v234, v234
    v_mfma_f32_16x16x32_bf16 v[64:67], v[28:31], a[196:199], v[64:67]
    v_exp_f32 v16, v184
    v_mfma_f32_16x16x32_bf16 v[68:71], v[28:31], a[220:223], v[132:135]
    v_exp_f32 v17, v185
    v_mfma_f32_16x16x32_bf16 v[68:71], v[24:27], a[216:219], v[68:71]
    buffer_load_dword v52, v20, s[20:23], s44 offen sc1
    v_mfma_f32_16x16x32_bf16 v[72:75], v[24:27], a[240:243], v[136:139]
    ds_read_b128 v[44:47], v3 offset:128
    v_cvt_f32_i32 v235, v235
    v_mfma_f32_16x16x32_bf16 v[72:75], v[28:31], a[244:247], v[72:75]
    v_exp_f32 v18, v186
    v_mfma_f32_16x16x32_bf16 v[76:79], v[28:31], v[204:207], v[140:143]
    v_add_f32 v7, v7, v16
    v_add_f32 v7, v7, v17
    v_mfma_f32_16x16x32_bf16 v[76:79], v[24:27], v[200:203], v[76:79]
    s_waitcnt lgkmcnt(2)
    v_exp_f32 v19, v187
    v_mfma_f32_16x16x32_bf16 v[96:99], v[32:35], a[192:195], v[128:131]
    ds_read_b128 v[24:27], v2 offset:6272
    v_cvt_pk_bf16_f32 v184, v16, v17
    v_mfma_f32_16x16x32_bf16 v[96:99], v[36:39], a[196:199], v[96:99]
    v_exp_f32 v16, v120
    v_mfma_f32_16x16x32_bf16 v[100:103], v[36:39], a[220:223], v[132:135]
    v_add_f32 v7, v7, v18
    v_fma_f32 v234, v234, v48, v50
    v_mfma_f32_16x16x32_bf16 v[100:103], v[32:35], a[216:219], v[100:103]
    s_add_u32 s35, s35, 196608
    s_mov_b32 m0, s26
    v_add_f32 v7, v7, v19
    v_mfma_f32_16x16x32_bf16 v[104:107], v[32:35], a[240:243], v[136:139]
    s_add_u32 s16, s16, 196608
    ds_read_b128 v[28:31], v3 offset:6272
    v_fma_f32 v235, v235, v49, v51
    v_mfma_f32_16x16x32_bf16 v[104:107], v[36:39], a[244:247], v[104:107]
    s_add_u32 s17, s17, 196608
    buffer_load_dwordx4 v4, s[4:7], s32 offen offset:0 sc1 lds
    v_mfma_f32_16x16x32_bf16 v[108:111], v[36:39], v[204:207], v[140:143]
    v_exp_f32 v17, v121
    v_mfma_f32_16x16x32_bf16 v[108:111], v[32:35], v[200:203], v[108:111]
    s_waitcnt lgkmcnt(2)
    v_cvt_pk_bf16_f32 v185, v18, v19
    v_cvt_pk_bf16_f32 v233, v234, v235
    v_mfma_f32_16x16x32_bf16 v[64:67], v[40:43], a[200:203], v[64:67]
    s_add_u32 s37, s37, 512
    ds_read_b128 v[32:35], v2 offset:256
    v_mfma_f32_16x16x32_bf16 v[64:67], v[44:47], a[204:207], v[64:67]
    v_exp_f32 v18, v122
    v_mfma_f32_16x16x32_bf16 v[68:71], v[44:47], a[228:231], v[68:71]
    v_add_f32 v7, v7, v16
    v_add_f32 v7, v7, v17
    v_mfma_f32_16x16x32_bf16 v[68:71], v[40:43], a[224:227], v[68:71]
    v_exp_f32 v19, v123
    v_mfma_f32_16x16x32_bf16 v[72:75], v[40:43], a[248:251], v[72:75]
    ds_read_b128 v[36:39], v3 offset:256
    v_cvt_pk_bf16_f32 v186, v16, v17
    v_mfma_f32_16x16x32_bf16 v[72:75], v[44:47], a[252:255], v[72:75]
    buffer_load_dwordx4 v4, s[4:7], s32 offen offset:1024 sc1 lds
    v_mfma_f32_16x16x32_bf16 v[76:79], v[44:47], v[212:215], v[76:79]
    v_exp_f32 v16, v188
    v_mfma_f32_16x16x32_bf16 v[76:79], v[40:43], v[208:211], v[76:79]
    s_waitcnt lgkmcnt(2)
    v_add_f32 v7, v7, v18
    v_add_f32 v7, v7, v19
    v_mfma_f32_16x16x32_bf16 v[96:99], v[24:27], a[200:203], v[96:99]
    ds_read_b128 v[40:43], v2 offset:6400
    v_cvt_f32_i32 v238, v238
    v_mfma_f32_16x16x32_bf16 v[96:99], v[28:31], a[204:207], v[96:99]
    buffer_load_dwordx2 v[56:57], off, s[80:83], s37 offset:0
    v_mfma_f32_16x16x32_bf16 v[100:103], v[28:31], a[228:231], v[100:103]
    v_exp_f32 v17, v189
    v_mfma_f32_16x16x32_bf16 v[100:103], v[24:27], a[224:227], v[100:103]
    v_cvt_pk_bf16_f32 v187, v18, v19
    v_cvt_f32_i32 v239, v239
    v_mfma_f32_16x16x32_bf16 v[104:107], v[24:27], a[248:251], v[104:107]
    ds_read_b128 v[44:47], v3 offset:6400
    v_mfma_f32_16x16x32_bf16 v[104:107], v[28:31], a[252:255], v[104:107]
    buffer_load_dwordx2 v[58:59], off, s[84:87], s37 offset:0
    v_mfma_f32_16x16x32_bf16 v[108:111], v[28:31], v[212:215], v[108:111]
    s_add_u32 s29, s30, 49152
    v_exp_f32 v18, v190
    v_mfma_f32_16x16x32_bf16 v[108:111], v[24:27], v[208:211], v[108:111]
    s_waitcnt lgkmcnt(2)
    v_add_f32 v8, v8, v16
    v_add_f32 v8, v8, v17
    v_mfma_f32_16x16x32_bf16 v[64:67], v[32:35], a[208:211], v[64:67]
    s_sub_u32 s3, s29, 147456
    ds_read_b128 v[24:27], v2 offset:12288
    v_mfma_f32_16x16x32_bf16 v[64:67], v[36:39], a[212:215], v[64:67]
    s_min_u32 s29, s29, s3
    buffer_load_dwordx4 v4, s[4:7], s32 offen offset:2048 sc1 lds
    v_mfma_f32_16x16x32_bf16 v[68:71], v[36:39], a[236:239], v[68:71]
    v_exp_f32 v19, v191
    v_mfma_f32_16x16x32_bf16 v[68:71], v[32:35], a[232:235], v[68:71]
    v_cvt_pk_bf16_f32 v188, v16, v17
    v_fma_f32 v238, v238, v48, v50
    v_mfma_f32_16x16x32_bf16 v[72:75], v[32:35], v[192:195], v[72:75]
    ds_read_b128 v[28:31], v3 offset:12288
    v_mfma_f32_16x16x32_bf16 v[72:75], v[36:39], v[196:199], v[72:75]
    buffer_load_dwordx3 v[144:146], v12, s[68:71], s35 offen offset:0 nt
    v_mfma_f32_16x16x32_bf16 v[76:79], v[36:39], v[220:223], v[76:79]
    v_exp_f32 v16, v124
    v_mfma_f32_16x16x32_bf16 v[76:79], v[32:35], v[216:219], v[76:79]
    s_waitcnt lgkmcnt(2)
    v_add_f32 v8, v8, v18
    v_add_f32 v8, v8, v19
    v_mfma_f32_16x16x32_bf16 v[96:99], v[40:43], a[208:211], v[96:99]
    s_add_u32 s32, s32, 24576
    ds_read_b128 v[32:35], v2 offset:18432
    v_fma_f32 v239, v239, v49, v51
    v_mfma_f32_16x16x32_bf16 v[96:99], v[44:47], a[212:215], v[96:99]
    s_sub_u32 s3, s29, s30
    v_exp_f32 v17, v125
    v_mfma_f32_16x16x32_bf16 v[100:103], v[44:47], a[236:239], v[100:103]
    v_cvt_pk_bf16_f32 v189, v18, v19
    v_mfma_f32_16x16x32_bf16 v[100:103], v[40:43], a[232:235], v[100:103]
    v_exp_f32 v18, v126
    v_mfma_f32_16x16x32_bf16 v[104:107], v[40:43], v[192:195], v[104:107]
    s_add_u32 s26, s26, 12288
    ds_read_b128 v[36:39], v3 offset:18432
    v_add_f32 v8, v8, v16
    v_mfma_f32_16x16x32_bf16 v[104:107], v[44:47], v[196:199], v[104:107]
    buffer_load_dwordx3 v[148:150], v12, s[68:71], s35 offen offset:768 nt
    v_mfma_f32_16x16x32_bf16 v[108:111], v[44:47], v[220:223], v[108:111]
    v_add_f32 v8, v8, v17
    v_cvt_pk_bf16_f32 v237, v238, v239
    v_mfma_f32_16x16x32_bf16 v[108:111], v[40:43], v[216:219], v[108:111]
    s_waitcnt lgkmcnt(2)
    v_exp_f32 v19, v127
    v_mfma_f32_16x16x32_bf16 v[80:83], v[24:27], a[192:195], v[128:131]
    ds_read_b128 v[40:43], v2 offset:12416
    v_cvt_pk_bf16_f32 v190, v16, v17
    v_mfma_f32_16x16x32_bf16 v[80:83], v[28:31], a[196:199], v[80:83]
    s_mov_b32 m0, s26
    v_add_f32 v8, v8, v18
    v_add_f32 v8, v8, v19
    v_mfma_f32_16x16x32_bf16 v[84:87], v[28:31], a[220:223], v[132:135]
    s_mov_b32 s30, s29
    v_cvt_pk_bf16_f32 v191, v18, v19
    v_mfma_f32_16x16x32_bf16 v[84:87], v[24:27], a[216:219], v[84:87]
    v_exp_f32 v16, v64
    v_mfma_f32_16x16x32_bf16 v[88:91], v[24:27], a[240:243], v[136:139]
    ds_read_b128 v[44:47], v3 offset:12416
    v_mfma_f32_16x16x32_bf16 v[88:91], v[28:31], a[244:247], v[88:91]
    buffer_load_dwordx3 v[152:154], v12, s[68:71], s35 offen offset:1536 nt
    v_mfma_f32_16x16x32_bf16 v[92:95], v[28:31], v[204:207], v[140:143]
    v_exp_f32 v17, v65
    v_mfma_f32_16x16x32_bf16 v[92:95], v[24:27], v[200:203], v[92:95]
    s_waitcnt lgkmcnt(2)
    v_exp_f32 v18, v66
    v_mfma_f32_16x16x32_bf16 v[112:115], v[32:35], a[192:195], v[128:131]
    ds_read_b128 v[24:27], v2 offset:18560
    v_add_f32 v5, v5, v16
    v_mfma_f32_16x16x32_bf16 v[112:115], v[36:39], a[196:199], v[112:115]
    buffer_load_dwordx4 v4, s[4:7], s32 offen offset:0 sc1 lds
    v_mfma_f32_16x16x32_bf16 v[116:119], v[36:39], a[220:223], v[132:135]
    v_add_f32 v5, v5, v17
    v_add_u32 v1, s3, v1
    v_mfma_f32_16x16x32_bf16 v[116:119], v[32:35], a[216:219], v[116:119]
    v_exp_f32 v19, v67
    v_mfma_f32_16x16x32_bf16 v[120:123], v[32:35], a[240:243], v[136:139]
    ds_read_b128 v[28:31], v3 offset:18560
    v_cvt_pk_bf16_f32 v64, v16, v17
    v_mfma_f32_16x16x32_bf16 v[120:123], v[36:39], a[244:247], v[120:123]
    s_waitcnt vmcnt(13)
    buffer_load_dwordx3 v[156:158], v12, s[68:71], s35 offen offset:2304 nt
    v_mfma_f32_16x16x32_bf16 v[124:127], v[36:39], v[204:207], v[140:143]
    v_exp_f32 v16, v96
    v_mfma_f32_16x16x32_bf16 v[124:127], v[32:35], v[200:203], v[124:127]
    s_waitcnt lgkmcnt(2)
    v_add_f32 v5, v5, v18
    v_add_f32 v5, v5, v19
    v_mfma_f32_16x16x32_bf16 v[80:83], v[40:43], a[200:203], v[80:83]
    ds_read_b128 v[32:35], v2 offset:12544
    v_lshlrev_b32 v48, 16, v60
    v_mfma_f32_16x16x32_bf16 v[80:83], v[44:47], a[204:207], v[80:83]
    v_exp_f32 v17, v97
    v_mfma_f32_16x16x32_bf16 v[84:87], v[44:47], a[228:231], v[84:87]
    v_cvt_pk_bf16_f32 v65, v18, v19
    v_and_b32 v49, s97, v60
    v_mfma_f32_16x16x32_bf16 v[84:87], v[40:43], a[224:227], v[84:87]
    buffer_load_dwordx4 v4, s[4:7], s32 offen offset:1024 sc1 lds
    v_mfma_f32_16x16x32_bf16 v[88:91], v[40:43], a[248:251], v[88:91]
    ds_read_b128 v[36:39], v3 offset:12544
    v_lshlrev_b32 v50, 16, v62
    v_mfma_f32_16x16x32_bf16 v[88:91], v[44:47], a[252:255], v[88:91]
    v_exp_f32 v18, v98
    v_mfma_f32_16x16x32_bf16 v[92:95], v[44:47], v[212:215], v[92:95]
    v_add_f32 v5, v5, v16
    v_add_f32 v5, v5, v17
    v_mfma_f32_16x16x32_bf16 v[92:95], v[40:43], v[208:211], v[92:95]
    s_waitcnt lgkmcnt(2)
    v_exp_f32 v19, v99
    v_mfma_f32_16x16x32_bf16 v[112:115], v[24:27], a[200:203], v[112:115]
    ds_read_b128 v[40:43], v2 offset:18688
    v_cvt_pk_bf16_f32 v66, v16, v17
    v_mfma_f32_16x16x32_bf16 v[112:115], v[28:31], a[204:207], v[112:115]
    v_exp_f32 v16, v68
    v_mfma_f32_16x16x32_bf16 v[116:119], v[28:31], a[228:231], v[116:119]
    v_add_f32 v5, v5, v18
    v_add_f32 v5, v5, v19
    v_mfma_f32_16x16x32_bf16 v[116:119], v[24:27], a[224:227], v[116:119]
    v_exp_f32 v17, v69
    v_mfma_f32_16x16x32_bf16 v[120:123], v[24:27], a[248:251], v[120:123]
    ds_read_b128 v[44:47], v3 offset:18688
    v_cvt_pk_bf16_f32 v67, v18, v19
    v_mfma_f32_16x16x32_bf16 v[120:123], v[28:31], a[252:255], v[120:123]
    s_waitcnt lgkmcnt(2)
    buffer_load_dwordx4 v4, s[4:7], s32 offen offset:2048 sc1 lds
    v_mfma_f32_16x16x32_bf16 v[124:127], v[28:31], v[212:215], v[124:127]
    s_waitcnt vmcnt(13)
    v_exp_f32 v18, v70
    v_mfma_f32_16x16x32_bf16 v[124:127], v[24:27], v[208:211], v[124:127]
    s_barrier
    v_mfma_f32_16x16x32_bf16 v[80:83], v[32:35], a[208:211], v[80:83]
    ds_read_b128 v[24:27], v1 offset:0
    v_add_f32 v6, v6, v16
    v_mfma_f32_16x16x32_bf16 v[80:83], v[36:39], a[212:215], v[80:83]
    v_add_f32 v6, v6, v17
    v_and_b32 v51, s97, v62
    v_mfma_f32_16x16x32_bf16 v[84:87], v[36:39], a[236:239], v[84:87]
    v_exp_f32 v19, v71
    v_mfma_f32_16x16x32_bf16 v[84:87], v[32:35], a[232:235], v[84:87]
    v_cvt_pk_bf16_f32 v68, v16, v17
    v_mul_f32 v48, s38, v48
    v_mfma_f32_16x16x32_bf16 v[88:91], v[32:35], v[192:195], v[88:91]
    ds_read_b128 v[28:31], v1 offset:12288
    v_mul_f32 v49, s38, v49
    v_mfma_f32_16x16x32_bf16 v[88:91], v[36:39], v[196:199], v[88:91]
    v_exp_f32 v16, v100
    v_mfma_f32_16x16x32_bf16 v[92:95], v[36:39], v[220:223], v[92:95]
    v_add_f32 v6, v6, v18
    v_add_f32 v6, v6, v19
    v_mfma_f32_16x16x32_bf16 v[92:95], v[32:35], v[216:219], v[92:95]
    s_waitcnt lgkmcnt(2)
    v_exp_f32 v17, v101
    v_mfma_f32_16x16x32_bf16 v[112:115], v[40:43], a[208:211], v[112:115]
    ds_read_b128 v[32:35], v1 offset:1024
    v_cvt_pk_bf16_f32 v69, v18, v19
    v_mfma_f32_16x16x32_bf16 v[112:115], v[44:47], a[212:215], v[112:115]
    v_exp_f32 v18, v102
    v_mfma_f32_16x16x32_bf16 v[116:119], v[44:47], a[236:239], v[116:119]
    v_add_f32 v6, v6, v16
    v_add_f32 v6, v6, v17
    v_mfma_f32_16x16x32_bf16 v[116:119], v[40:43], a[232:235], v[116:119]
    v_exp_f32 v19, v103
    v_mfma_f32_16x16x32_bf16 v[120:123], v[40:43], v[192:195], v[120:123]
    ds_read_b128 v[36:39], v1 offset:13312
    v_cvt_pk_bf16_f32 v70, v16, v17
    v_mfma_f32_16x16x32_bf16 v[120:123], v[44:47], v[196:199], v[120:123]
    s_add_u32 s32, s32, 24576
    v_add_f32 v6, v6, v18
    s_add_u32 s26, s26, 36864
    v_mfma_f32_16x16x32_bf16 v[124:127], v[44:47], v[220:223], v[124:127]
    s_sub_u32 s57, s26, 147456
    v_add_f32 v6, v6, v19
    v_cvt_pk_bf16_f32 v71, v18, v19
    v_mfma_f32_16x16x32_bf16 v[124:127], v[40:43], v[216:219], v[124:127]
    s_waitcnt lgkmcnt(2)
    s_min_u32 s26, s26, s57
    v_mfma_f32_16x16x32_bf16 a[0:3], v[160:163], v[24:27], a[0:3]
    ds_read_b128 v[40:43], v1 offset:2048
    v_mul_f32_e64 v50, -v50, v48
    v_mfma_f32_16x16x32_bf16 a[0:3], v[176:179], v[28:31], a[0:3]
    s_waitcnt vmcnt(12)
    v_subrev_u32 v52, s92, v52
    v_cmp_lt_u32 vcc, 15, v52
    v_mfma_f32_16x16x32_bf16 a[48:51], v[180:183], v[28:31], a[48:51]
    v_exp_f32 v16, v72
    v_mfma_f32_16x16x32_bf16 a[48:51], v[164:167], v[24:27], a[48:51]
    v_exp_f32 v17, v73
    v_mfma_f32_16x16x32_bf16 a[96:99], v[168:171], v[24:27], a[96:99]
    s_and_b32 s59, vcc_lo, 0xff
    ds_read_b128 v[44:47], v1 offset:14336
    v_mul_f32_e64 v51, -v51, v49
    v_mfma_f32_16x16x32_bf16 a[96:99], v[184:187], v[28:31], a[96:99]
    s_cbranch_scc1 L_pollslow2
L_pollok2:
    v_mfma_f32_16x16x32_bf16 a[144:147], v[188:191], v[28:31], a[144:147]
    s_add_u32 s92, s92, 1
    v_exp_f32 v18, v74
    v_mfma_f32_16x16x32_bf16 a[144:147], v[172:175], v[24:27], a[144:147]
    s_waitcnt lgkmcnt(2)
    v_add_f32 v7, v7, v16
    v_add_f32 v7, v7, v17
    v_mfma_f32_16x16x32_bf16 a[4:7], v[160:163], v[32:35], a[4:7]
    s_mov_b32 m0, s56
    ds_read_b128 v[24:27], v1 offset:3072
    v_cvt_f32_i32 v240, v240
    v_mfma_f32_16x16x32_bf16 a[4:7], v[176:179], v[36:39], a[4:7]
    buffer_load_dwordx4 v4, s[4:7], s27 offen offset:0 sc1 lds
    v_mfma_f32_16x16x32_bf16 a[52:55], v[180:183], v[36:39], a[52:55]
    v_exp_f32 v19, v75
    v_mfma_f32_16x16x32_bf16 a[52:55], v[164:167], v[32:35], a[52:55]
    v_cvt_pk_bf16_f32 v72, v16, v17
    v_cvt_f32_i32 v241, v241
    v_mfma_f32_16x16x32_bf16 a[100:103], v[168:171], v[32:35], a[100:103]
    ds_read_b128 v[28:31], v1 offset:15360
    v_fma_f32 v240, v240, v48, v50
    v_mfma_f32_16x16x32_bf16 a[100:103], v[184:187], v[36:39], a[100:103]
    v_exp_f32 v16, v104
    v_mfma_f32_16x16x32_bf16 a[148:151], v[188:191], v[36:39], a[148:151]
    v_add_f32 v7, v7, v18
    v_add_f32 v7, v7, v19
    v_mfma_f32_16x16x32_bf16 a[148:151], v[172:175], v[32:35], a[148:151]
    s_waitcnt lgkmcnt(2)
    v_exp_f32 v17, v105
    v_mfma_f32_16x16x32_bf16 a[8:11], v[160:163], v[40:43], a[8:11]
    ds_read_b128 v[32:35], v1 offset:4096
    v_cvt_pk_bf16_f32 v73, v18, v19
    v_mfma_f32_16x16x32_bf16 a[8:11], v[176:179], v[44:47], a[8:11]
    buffer_load_dwordx4 v4, s[4:7], s27 offen offset:1024 sc1 lds
    v_mfma_f32_16x16x32_bf16 a[56:59], v[180:183], v[44:47], a[56:59]
    v_exp_f32 v18, v106
    v_mfma_f32_16x16x32_bf16 a[56:59], v[164:167], v[40:43], a[56:59]
    v_add_f32 v7, v7, v16
    v_fma_f32 v241, v241, v49, v51
    v_mfma_f32_16x16x32_bf16 a[104:107], v[168:171], v[40:43], a[104:107]
    ds_read_b128 v[36:39], v1 offset:16384
    v_add_f32 v7, v7, v17
    v_mfma_f32_16x16x32_bf16 a[104:107], v[184:187], v[44:47], a[104:107]
    v_exp_f32 v19, v107
    v_mfma_f32_16x16x32_bf16 a[152:155], v[188:191], v[44:47], a[152:155]
    v_cvt_pk_bf16_f32 v74, v16, v17
    v_cvt_pk_bf16_f32 v226, v240, v241
    v_mfma_f32_16x16x32_bf16 a[152:155], v[172:175], v[40:43], a[152:155]
    s_waitcnt lgkmcnt(2)
    v_exp_f32 v16, v76
    v_mfma_f32_16x16x32_bf16 a[12:15], v[160:163], v[24:27], a[12:15]
    ds_read_b128 v[40:43], v1 offset:5120
    v_add_f32 v7, v7, v18
    v_mfma_f32_16x16x32_bf16 a[12:15], v[176:179], v[28:31], a[12:15]
    buffer_load_dwordx4 v4, s[4:7], s27 offen offset:2048 sc1 lds
    v_mfma_f32_16x16x32_bf16 a[60:63], v[180:183], v[28:31], a[60:63]
    v_add_f32 v7, v7, v19
    v_cvt_f32_i32 v244, v244
    v_mfma_f32_16x16x32_bf16 a[60:63], v[164:167], v[24:27], a[60:63]
    v_exp_f32 v17, v77
    v_mfma_f32_16x16x32_bf16 a[108:111], v[168:171], v[24:27], a[108:111]
    ds_read_b128 v[44:47], v1 offset:17408
    v_cvt_pk_bf16_f32 v75, v18, v19
    v_mfma_f32_16x16x32_bf16 a[108:111], v[184:187], v[28:31], a[108:111]
    v_exp_f32 v18, v78
    v_mfma_f32_16x16x32_bf16 a[156:159], v[188:191], v[28:31], a[156:159]
    s_add_u32 s29, s28, 49152
    v_cvt_f32_i32 v245, v245
    v_fma_f32 v244, v244, v48, v50
    v_mfma_f32_16x16x32_bf16 a[156:159], v[172:175], v[24:27], a[156:159]
    s_waitcnt lgkmcnt(2)
    v_add_f32 v8, v8, v16
    v_add_f32 v8, v8, v17
    v_mfma_f32_16x16x32_bf16 a[16:19], v[160:163], v[32:35], a[16:19]
    s_sub_u32 s3, s29, 147456
    ds_read_b128 v[24:27], v1 offset:6144
    v_fma_f32 v245, v245, v49, v51
    v_mfma_f32_16x16x32_bf16 a[16:19], v[176:179], v[36:39], a[16:19]
    s_add_u32 s27, s27, 24576
    v_exp_f32 v19, v79
    v_mfma_f32_16x16x32_bf16 a[64:67], v[180:183], v[36:39], a[64:67]
    s_min_u32 s29, s29, s3
    v_cvt_pk_bf16_f32 v76, v16, v17
    v_cvt_pk_bf16_f32 v230, v244, v245
    v_mfma_f32_16x16x32_bf16 a[64:67], v[164:167], v[32:35], a[64:67]
    s_add_u32 s56, s56, 12288
    v_exp_f32 v16, v108
    v_mfma_f32_16x16x32_bf16 a[112:115], v[168:171], v[32:35], a[112:115]
    ds_read_b128 v[28:31], v1 offset:18432
    v_add_f32 v8, v8, v18
    v_mfma_f32_16x16x32_bf16 a[112:115], v[184:187], v[36:39], a[112:115]
    v_add_f32 v8, v8, v19
    v_cvt_f32_i32 v248, v248
    v_mfma_f32_16x16x32_bf16 a[160:163], v[188:191], v[36:39], a[160:163]
    v_exp_f32 v17, v109
    v_mfma_f32_16x16x32_bf16 a[160:163], v[172:175], v[32:35], a[160:163]
    s_waitcnt lgkmcnt(2)
    v_cvt_f32_i32 v249, v249
    v_cvt_pk_bf16_f32 v77, v18, v19
    v_mfma_f32_16x16x32_bf16 a[20:23], v[160:163], v[40:43], a[20:23]
    s_mov_b32 m0, s56
    ds_read_b128 v[32:35], v1 offset:7168
    v_fma_f32 v248, v248, v48, v50
    v_mfma_f32_16x16x32_bf16 a[20:23], v[176:179], v[44:47], a[20:23]
    s_sub_u32 s3, s29, s28
    v_exp_f32 v18, v110
    v_mfma_f32_16x16x32_bf16 a[68:71], v[180:183], v[44:47], a[68:71]
    v_add_f32 v8, v8, v16
    v_add_f32 v8, v8, v17
    v_mfma_f32_16x16x32_bf16 a[68:71], v[164:167], v[40:43], a[68:71]
    v_exp_f32 v19, v111
    v_mfma_f32_16x16x32_bf16 a[116:119], v[168:171], v[40:43], a[116:119]
    ds_read_b128 v[36:39], v1 offset:19456
    v_fma_f32 v249, v249, v49, v51
    v_mfma_f32_16x16x32_bf16 a[116:119], v[184:187], v[44:47], a[116:119]
    buffer_load_dwordx4 v4, s[4:7], s27 offen offset:0 sc1 lds
    v_mfma_f32_16x16x32_bf16 a[164:167], v[188:191], v[44:47], a[164:167]
    s_mov_b32 s28, s29
    v_cvt_pk_bf16_f32 v78, v16, v17
    v_add_f32 v8, v8, v18
    v_mfma_f32_16x16x32_bf16 a[164:167], v[172:175], v[40:43], a[164:167]
    s_waitcnt lgkmcnt(2)
    v_add_f32 v8, v8, v19
    v_cvt_pk_bf16_f32 v234, v248, v249
    v_mfma_f32_16x16x32_bf16 a[24:27], v[160:163], v[24:27], a[24:27]
    ds_read_b128 v[40:43], v1 offset:8192
    v_cvt_pk_bf16_f32 v79, v18, v19
    v_mfma_f32_16x16x32_bf16 a[24:27], v[176:179], v[28:31], a[24:27]
    v_exp_f32 v16, v80
    v_mfma_f32_16x16x32_bf16 a[72:75], v[180:183], v[28:31], a[72:75]
    v_cvt_f32_i32 v252, v252
    v_cvt_f32_i32 v253, v253
    v_mfma_f32_16x16x32_bf16 a[72:75], v[164:167], v[24:27], a[72:75]
    v_exp_f32 v17, v81
    v_mfma_f32_16x16x32_bf16 a[120:123], v[168:171], v[24:27], a[120:123]
    ds_read_b128 v[44:47], v1 offset:20480
    v_fma_f32 v252, v252, v48, v50
    v_mfma_f32_16x16x32_bf16 a[120:123], v[184:187], v[28:31], a[120:123]
    v_exp_f32 v18, v82
    v_mfma_f32_16x16x32_bf16 a[168:171], v[188:191], v[28:31], a[168:171]
    v_add_f32 v5, v5, v16
    v_add_f32 v5, v5, v17
    v_mfma_f32_16x16x32_bf16 a[168:171], v[172:175], v[24:27], a[168:171]
    s_waitcnt lgkmcnt(2)
    buffer_load_dwordx4 v4, s[4:7], s27 offen offset:1024 sc1 lds
    v_mfma_f32_16x16x32_bf16 a[28:31], v[160:163], v[32:35], a[28:31]
    ds_read_b128 v[24:27], v1 offset:9216
    v_fma_f32 v253, v253, v49, v51
    v_mfma_f32_16x16x32_bf16 a[28:31], v[176:179], v[36:39], a[28:31]
    v_exp_f32 v19, v83
    v_mfma_f32_16x16x32_bf16 a[76:79], v[180:183], v[36:39], a[76:79]
    v_cvt_pk_bf16_f32 v80, v16, v17
    v_cvt_pk_bf16_f32 v238, v252, v253
    v_mfma_f32_16x16x32_bf16 a[76:79], v[164:167], v[32:35], a[76:79]
    v_exp_f32 v16, v112
    v_mfma_f32_16x16x32_bf16 a[124:127], v[168:171], v[32:35], a[124:127]
    ds_read_b128 v[28:31], v1 offset:21504
    v_add_f32 v5, v5, v18
    v_mfma_f32_16x16x32_bf16 a[124:127], v[184:187], v[36:39], a[124:127]
    v_add_f32 v5, v5, v19
    v_lshlrev_b32 v48, 16, v61
    v_mfma_f32_16x16x32_bf16 a[172:175], v[188:191], v[36:39], a[172:175]
    v_exp_f32 v17, v113
    v_mfma_f32_16x16x32_bf16 a[172:175], v[172:175], v[32:35], a[172:175]
    s_waitcnt lgkmcnt(2)
    buffer_load_dwordx4 v4, s[4:7], s27 offen offset:2048 sc1 lds
    v_mfma_f32_16x16x32_bf16 a[32:35], v[160:163], v[40:43], a[32:35]
    ds_read_b128 v[32:35], v1 offset:10240
    v_cvt_pk_bf16_f32 v81, v18, v19
    v_mfma_f32_16x16x32_bf16 a[32:35], v[176:179], v[44:47], a[32:35]
    v_exp_f32 v18, v114
    v_mfma_f32_16x16x32_bf16 a[80:83], v[180:183], v[44:47], a[80:83]
    v_add_f32 v5, v5, v16
    v_and_b32 v49, s97, v61
    v_mfma_f32_16x16x32_bf16 a[80:83], v[164:167], v[40:43], a[80:83]
    v_add_f32 v5, v5, v17
    v_lshlrev_b32 v50, 16, v63
    v_mfma_f32_16x16x32_bf16 a[128:131], v[168:171], v[40:43], a[128:131]
    ds_read_b128 v[36:39], v1 offset:22528
    v_add_u32 v2, s3, v2
    v_mfma_f32_16x16x32_bf16 a[128:131], v[184:187], v[44:47], a[128:131]
    v_exp_f32 v19, v115
    v_mfma_f32_16x16x32_bf16 a[176:179], v[188:191], v[44:47], a[176:179]
    v_cvt_pk_bf16_f32 v82, v16, v17
    v_and_b32 v51, s97, v63
    v_mfma_f32_16x16x32_bf16 a[176:179], v[172:175], v[40:43], a[176:179]
    s_waitcnt lgkmcnt(2)
    v_exp_f32 v16, v84
    v_mfma_f32_16x16x32_bf16 a[36:39], v[160:163], v[24:27], a[36:39]
    ds_read_b128 v[40:43], v1 offset:11264
    v_add_f32 v5, v5, v18
    v_mfma_f32_16x16x32_bf16 a[36:39], v[176:179], v[28:31], a[36:39]
    v_add_f32 v5, v5, v19
    v_mul_f32 v48, s38, v48
    v_mfma_f32_16x16x32_bf16 a[84:87], v[180:183], v[28:31], a[84:87]
    v_exp_f32 v17, v85
    v_mfma_f32_16x16x32_bf16 a[84:87], v[164:167], v[24:27], a[84:87]
    s_add_u32 s27, s27, 24576
    v_add_u32 v3, s3, v3
    v_cvt_pk_bf16_f32 v83, v18, v19
    v_mfma_f32_16x16x32_bf16 a[132:135], v[168:171], v[24:27], a[132:135]
L_pg7:
    s_cbranch_execz L_pg11
    s_add_u32 s56, s56, 36864
    ds_read_b128 v[44:47], v1 offset:23552
    v_mul_f32 v49, s38, v49
    v_mfma_f32_16x16x32_bf16 a[132:135], v[184:187], v[28:31], a[132:135]
    s_sub_u32 s58, s56, 147456
    v_exp_f32 v18, v86
    v_mfma_f32_16x16x32_bf16 a[180:183], v[188:191], v[28:31], a[180:183]
    v_add_f32 v6, v6, v16
    v_add_f32 v6, v6, v17
    v_mfma_f32_16x16x32_bf16 a[180:183], v[172:175], v[24:27], a[180:183]
    s_waitcnt lgkmcnt(2)
    v_mul_f32_e64 v50, -v50, v48
    v_mul_f32_e64 v51, -v51, v49
    v_mfma_f32_16x16x32_bf16 a[40:43], v[160:163], v[32:35], a[40:43]
    s_min_u32 s56, s56, s58
    ds_read_b128 v[24:27], v2 offset:0
    v_cvt_f32_i32 v242, v242
    v_mfma_f32_16x16x32_bf16 a[40:43], v[176:179], v[36:39], a[40:43]
    v_exp_f32 v19, v87
    v_mfma_f32_16x16x32_bf16 a[88:91], v[180:183], v[36:39], a[88:91]
    v_cvt_pk_bf16_f32 v84, v16, v17
    v_cvt_f32_i32 v243, v243
    v_mfma_f32_16x16x32_bf16 a[88:91], v[164:167], v[32:35], a[88:91]
    v_exp_f32 v16, v116
    v_mfma_f32_16x16x32_bf16 a[136:139], v[168:171], v[32:35], a[136:139]
    ds_read_b128 v[28:31], v3 offset:0
    v_add_f32 v6, v6, v18
    v_mfma_f32_16x16x32_bf16 a[136:139], v[184:187], v[36:39], a[136:139]
    v_add_f32 v6, v6, v19
    v_fma_f32 v242, v242, v48, v50
    v_mfma_f32_16x16x32_bf16 a[184:187], v[188:191], v[36:39], a[184:187]
    v_exp_f32 v17, v117
    v_mfma_f32_16x16x32_bf16 a[184:187], v[172:175], v[32:35], a[184:187]
    s_waitcnt lgkmcnt(2)
    v_cvt_pk_bf16_f32 v85, v18, v19
    v_fma_f32 v243, v243, v49, v51
    v_mfma_f32_16x16x32_bf16 a[44:47], v[160:163], v[40:43], a[44:47]
    ds_read_b128 v[32:35], v2 offset:6144
    v_cvt_pk_bf16_f32 v227, v242, v243
    v_mfma_f32_16x16x32_bf16 a[44:47], v[176:179], v[44:47], a[44:47]
    v_exp_f32 v18, v118
    v_mfma_f32_16x16x32_bf16 a[92:95], v[180:183], v[44:47], a[92:95]
    v_add_f32 v6, v6, v16
    v_add_f32 v6, v6, v17
    v_mfma_f32_16x16x32_bf16 a[92:95], v[164:167], v[40:43], a[92:95]
    v_exp_f32 v19, v119
    v_mfma_f32_16x16x32_bf16 a[140:143], v[168:171], v[40:43], a[140:143]
    s_sub_u32 s31, s31, 1
    ds_read_b128 v[36:39], v3 offset:6144
    v_cvt_pk_bf16_f32 v86, v16, v17
    v_mfma_f32_16x16x32_bf16 a[140:143], v[184:187], v[44:47], a[140:143]
    v_add_f32 v6, v6, v18
    v_add_f32 v6, v6, v19
    v_mfma_f32_16x16x32_bf16 a[188:191], v[188:191], v[44:47], a[188:191]
    s_waitcnt lgkmcnt(2)
    s_cmp_lg_u32 s31, 0
    v_cvt_pk_bf16_f32 v87, v18, v19
    v_cvt_f32_i32 v246, v246
    v_mfma_f32_16x16x32_bf16 a[188:191], v[172:175], v[40:43], a[188:191]
    s_cbranch_scc1 L_loop
    v_mfma_f32_16x16x32_bf16 v[160:163], v[24:27], a[192:195], v[128:131]
    s_mov_b32 m0, s56
    ds_read_b128 v[40:43], v2 offset:128
    v_cvt_f32_i32 v247, v247
    v_mfma_f32_16x16x32_bf16 v[160:163], v[28:31], a[196:199], v[160:163]
    buffer_load_dwordx4 v4, s[4:7], s27 offen offset:0 sc1 lds
    v_mfma_f32_16x16x32_bf16 v[164:167], v[28:31], a[220:223], v[132:135]
    v_exp_f32 v16, v88
    v_mfma_f32_16x16x32_bf16 v[164:167], v[24:27], a[216:219], v[164:167]
    v_exp_f32 v17, v89
    v_mfma_f32_16x16x32_bf16 v[168:171], v[24:27], a[240:243], v[136:139]
    ds_read_b128 v[44:47], v3 offset:128
    v_fma_f32 v246, v246, v48, v50
    v_mfma_f32_16x16x32_bf16 v[168:171], v[28:31], a[244:247], v[168:171]
    v_exp_f32 v18, v90
    v_mfma_f32_16x16x32_bf16 v[172:175], v[28:31], v[204:207], v[140:143]
    v_fma_f32 v247, v247, v49, v51
    v_add_f32 v7, v7, v16
    v_mfma_f32_16x16x32_bf16 v[172:175], v[24:27], v[200:203], v[172:175]
    s_waitcnt lgkmcnt(2)
    v_add_f32 v7, v7, v17
    v_cvt_pk_bf16_f32 v231, v246, v247
    v_mfma_f32_16x16x32_bf16 v[96:99], v[32:35], a[192:195], v[128:131]
    ds_read_b128 v[24:27], v2 offset:6272
    v_cvt_f32_i32 v250, v250
    v_mfma_f32_16x16x32_bf16 v[96:99], v[36:39], a[196:199], v[96:99]
    buffer_load_dwordx4 v4, s[4:7], s27 offen offset:1024 sc1 lds
    v_mfma_f32_16x16x32_bf16 v[100:103], v[36:39], a[220:223], v[132:135]
    v_exp_f32 v19, v91
    v_mfma_f32_16x16x32_bf16 v[100:103], v[32:35], a[216:219], v[100:103]
    v_cvt_pk_bf16_f32 v88, v16, v17
    v_cvt_f32_i32 v251, v251
    v_mfma_f32_16x16x32_bf16 v[104:107], v[32:35], a[240:243], v[136:139]
    ds_read_b128 v[28:31], v3 offset:6272
    v_fma_f32 v250, v250, v48, v50
    v_mfma_f32_16x16x32_bf16 v[104:107], v[36:39], a[244:247], v[104:107]
    v_exp_f32 v16, v120
    v_mfma_f32_16x16x32_bf16 v[108:111], v[36:39], v[204:207], v[140:143]
    v_add_f32 v7, v7, v18
    v_add_f32 v7, v7, v19
    v_mfma_f32_16x16x32_bf16 v[108:111], v[32:35], v[200:203], v[108:111]
    s_waitcnt lgkmcnt(2)
    v_exp_f32 v17, v121
    v_mfma_f32_16x16x32_bf16 v[160:163], v[40:43], a[200:203], v[160:163]
    ds_read_b128 v[32:35], v2 offset:256
    v_cvt_pk_bf16_f32 v89, v18, v19
    v_mfma_f32_16x16x32_bf16 v[160:163], v[44:47], a[204:207], v[160:163]
    v_exp_f32 v18, v122
    v_mfma_f32_16x16x32_bf16 v[164:167], v[44:47], a[228:231], v[164:167]
    v_fma_f32 v251, v251, v49, v51
    v_add_f32 v7, v7, v16
    v_mfma_f32_16x16x32_bf16 v[164:167], v[40:43], a[224:227], v[164:167]
    buffer_load_dwordx4 v4, s[4:7], s27 offen offset:2048 sc1 lds
    v_mfma_f32_16x16x32_bf16 v[168:171], v[40:43], a[248:251], v[168:171]
    ds_read_b128 v[36:39], v3 offset:256
    v_cvt_pk_bf16_f32 v235, v250, v251
    v_mfma_f32_16x16x32_bf16 v[168:171], v[44:47], a[252:255], v[168:171]
    v_add_f32 v7, v7, v17
    v_cvt_f32_i32 v254, v254
    v_mfma_f32_16x16x32_bf16 v[172:175], v[44:47], v[212:215], v[172:175]
    v_exp_f32 v19, v123
    v_mfma_f32_16x16x32_bf16 v[172:175], v[40:43], v[208:211], v[172:175]
    s_waitcnt lgkmcnt(2)
    v_cvt_pk_bf16_f32 v90, v16, v17
    v_cvt_f32_i32 v255, v255
    v_mfma_f32_16x16x32_bf16 v[96:99], v[24:27], a[200:203], v[96:99]
    ds_read_b128 v[40:43], v2 offset:6400
    v_fma_f32 v254, v254, v48, v50
    v_mfma_f32_16x16x32_bf16 v[96:99], v[28:31], a[204:207], v[96:99]
    s_add_u32 s27, s27, 24576
    v_exp_f32 v16, v92
    v_mfma_f32_16x16x32_bf16 v[100:103], v[28:31], a[228:231], v[100:103]
    v_add_f32 v7, v7, v18
    v_add_f32 v7, v7, v19
    v_mfma_f32_16x16x32_bf16 v[100:103], v[24:27], a[224:227], v[100:103]
    v_exp_f32 v17, v93
    v_mfma_f32_16x16x32_bf16 v[104:107], v[24:27], a[248:251], v[104:107]
    ds_read_b128 v[44:47], v3 offset:6400
    v_fma_f32 v255, v255, v49, v51
    v_mfma_f32_16x16x32_bf16 v[104:107], v[28:31], a[252:255], v[104:107]
    v_cvt_pk_bf16_f32 v91, v18, v19
    v_cvt_pk_bf16_f32 v239, v254, v255
    v_mfma_f32_16x16x32_bf16 v[108:111], v[28:31], v[212:215], v[108:111]
    s_add_u32 s29, s30, 49152
    v_exp_f32 v18, v94
    v_mfma_f32_16x16x32_bf16 v[108:111], v[24:27], v[208:211], v[108:111]
    s_waitcnt lgkmcnt(2)
    v_add_f32 v8, v8, v16
    v_add_f32 v8, v8, v17
    v_mfma_f32_16x16x32_bf16 v[160:163], v[32:35], a[208:211], v[160:163]
    s_waitcnt vmcnt(11)
    ds_read_b128 v[24:27], v2 offset:12288
    v_lshlrev_b32 v48, 16, v56
    v_mfma_f32_16x16x32_bf16 v[160:163], v[36:39], a[212:215], v[160:163]
    s_sub_u32 s3, s29, 147456
    buffer_load_dwordx2 v[60:61], off, s[80:83], s37 offset:8
    v_mfma_f32_16x16x32_bf16 v[164:167], v[36:39], a[236:239], v[164:167]
    s_add_u32 s56, s56, 12288
    v_exp_f32 v19, v95
    v_mfma_f32_16x16x32_bf16 v[164:167], v[32:35], a[232:235], v[164:167]
    s_min_u32 s29, s29, s3
    v_cvt_pk_bf16_f32 v92, v16, v17
    v_and_b32 v49, s97, v56
    v_mfma_f32_16x16x32_bf16 v[168:171], v[32:35], v[192:195], v[168:171]
    s_mov_b32 m0, s56
    ds_read_b128 v[28:31], v3 offset:12288
    v_mfma_f32_16x16x32_bf16 v[168:171], v[36:39], v[196:199], v[168:171]
    buffer_load_dwordx2 v[62:63], off, s[84:87], s37 offset:8
    v_mfma_f32_16x16x32_bf16 v[172:175], v[36:39], v[220:223], v[172:175]
    v_exp_f32 v16, v124
    v_mfma_f32_16x16x32_bf16 v[172:175], v[32:35], v[216:219], v[172:175]
    s_waitcnt lgkmcnt(2)
    v_add_f32 v8, v8, v18
    v_add_f32 v8, v8, v19
    v_mfma_f32_16x16x32_bf16 v[96:99], v[40:43], a[208:211], v[96:99]
    ds_read_b128 v[32:35], v2 offset:18432
    v_lshlrev_b32 v50, 16, v58
    v_mfma_f32_16x16x32_bf16 v[96:99], v[44:47], a[212:215], v[96:99]
    s_sub_u32 s3, s29, s30
    v_exp_f32 v17, v125
    v_mfma_f32_16x16x32_bf16 v[100:103], v[44:47], a[236:239], v[100:103]
    v_cvt_pk_bf16_f32 v93, v18, v19
    v_mfma_f32_16x16x32_bf16 v[100:103], v[40:43], a[232:235], v[100:103]
    buffer_load_dwordx4 v4, s[4:7], s27 offen offset:0 sc1 lds
    v_mfma_f32_16x16x32_bf16 v[104:107], v[40:43], v[192:195], v[104:107]
    ds_read_b128 v[36:39], v3 offset:18432
    v_mfma_f32_16x16x32_bf16 v[104:107], v[44:47], v[196:199], v[104:107]
    v_exp_f32 v18, v126
    v_mfma_f32_16x16x32_bf16 v[108:111], v[44:47], v[220:223], v[108:111]
    v_add_f32 v8, v8, v16
    v_add_f32 v8, v8, v17
    v_mfma_f32_16x16x32_bf16 v[108:111], v[40:43], v[216:219], v[108:111]
    s_waitcnt lgkmcnt(2)
    buffer_load_dwordx3 v[240:242], v12, s[68:71], s16 offen offset:0 nt
    v_mfma_f32_16x16x32_bf16 v[176:179], v[24:27], a[192:195], v[128:131]
    ds_read_b128 v[40:43], v2 offset:12416
    v_and_b32 v51, s97, v58
    v_mfma_f32_16x16x32_bf16 v[176:179], v[28:31], a[196:199], v[176:179]
    v_exp_f32 v19, v127
    v_cvt_pk_bf16_f32 v94, v16, v17
    v_mfma_f32_16x16x32_bf16 v[180:183], v[28:31], a[220:223], v[132:135]
    s_mov_b32 s30, s29
    v_add_f32 v8, v8, v18
    v_add_f32 v8, v8, v19
    v_mfma_f32_16x16x32_bf16 v[180:183], v[24:27], a[216:219], v[180:183]
    buffer_load_dwordx4 v4, s[4:7], s27 offen offset:1024 sc1 lds
    v_mfma_f32_16x16x32_bf16 v[184:187], v[24:27], a[240:243], v[136:139]
    ds_read_b128 v[44:47], v3 offset:12416
    v_cvt_pk_bf16_f32 v95, v18, v19
    v_mfma_f32_16x16x32_bf16 v[184:187], v[28:31], a[244:247], v[184:187]
    v_exp_f32 v16, v160
    v_mfma_f32_16x16x32_bf16 v[188:191], v[28:31], v[204:207], v[140:143]
    v_exp_f32 v17, v161
    v_mfma_f32_16x16x32_bf16 v[188:191], v[24:27], v[200:203], v[188:191]
    s_waitcnt lgkmcnt(2)
    buffer_load_dwordx3 v[244:246], v12, s[68:71], s16 offen offset:768 nt
    v_mfma_f32_16x16x32_bf16 v[112:115], v[32:35], a[192:195], v[128:131]
    ds_read_b128 v[24:27], v2 offset:18560
    v_mul_f32_e64 v50, -v50, v48
    v_mfma_f32_16x16x32_bf16 v[112:115], v[36:39], a[196:199], v[112:115]
    v_exp_f32 v18, v162
    v_mfma_f32_16x16x32_bf16 v[116:119], v[36:39], a[220:223], v[132:135]
    v_add_f32 v5, v5, v16
    v_add_f32 v5, v5, v17
    v_mfma_f32_16x16x32_bf16 v[116:119], v[32:35], a[216:219], v[116:119]
    v_exp_f32 v19, v163
    v_mfma_f32_16x16x32_bf16 v[120:123], v[32:35], a[240:243], v[136:139]
    ds_read_b128 v[28:31], v3 offset:18560
    v_cvt_pk_bf16_f32 v160, v16, v17
    v_mfma_f32_16x16x32_bf16 v[120:123], v[36:39], a[244:247], v[120:123]
    buffer_load_dwordx3 v[248:250], v12, s[68:71], s16 offen offset:1536 nt
    v_mfma_f32_16x16x32_bf16 v[124:127], v[36:39], v[204:207], v[140:143]
    v_exp_f32 v16, v96
    v_mfma_f32_16x16x32_bf16 v[124:127], v[32:35], v[200:203], v[124:127]
    s_waitcnt lgkmcnt(2)
    v_add_f32 v5, v5, v18
    v_add_f32 v5, v5, v19
    v_mfma_f32_16x16x32_bf16 v[176:179], v[40:43], a[200:203], v[176:179]
    ds_read_b128 v[32:35], v2 offset:12544
    v_mul_f32_e64 v51, -v51, v49
    v_mfma_f32_16x16x32_bf16 v[176:179], v[44:47], a[204:207], v[176:179]
    buffer_load_dwordx4 v4, s[4:7], s27 offen offset:2048 sc1 lds
    v_mfma_f32_16x16x32_bf16 v[180:183], v[44:47], a[228:231], v[180:183]
    v_exp_f32 v17, v97
    v_mfma_f32_16x16x32_bf16 v[180:183], v[40:43], a[224:227], v[180:183]
    v_cvt_pk_bf16_f32 v161, v18, v19
    v_add_u32 v1, s3, v1
    v_mfma_f32_16x16x32_bf16 v[184:187], v[40:43], a[248:251], v[184:187]
    ds_read_b128 v[36:39], v3 offset:12544
    v_cvt_f32_i32 v144, v144
    v_mfma_f32_16x16x32_bf16 v[184:187], v[44:47], a[252:255], v[184:187]
    buffer_load_dwordx3 v[252:254], v12, s[68:71], s16 offen offset:2304 nt
    v_mfma_f32_16x16x32_bf16 v[188:191], v[44:47], v[212:215], v[188:191]
    v_exp_f32 v18, v98
    v_mfma_f32_16x16x32_bf16 v[188:191], v[40:43], v[208:211], v[188:191]
    s_waitcnt lgkmcnt(2)
    v_add_f32 v5, v5, v16
    v_add_f32 v5, v5, v17
    v_mfma_f32_16x16x32_bf16 v[112:115], v[24:27], a[200:203], v[112:115]
    ds_read_b128 v[40:43], v2 offset:18688
    v_cvt_f32_i32 v148, v148
    v_mfma_f32_16x16x32_bf16 v[112:115], v[28:31], a[204:207], v[112:115]
    v_exp_f32 v19, v99
    v_cvt_pk_bf16_f32 v162, v16, v17
    v_mfma_f32_16x16x32_bf16 v[116:119], v[28:31], a[228:231], v[116:119]
    v_exp_f32 v16, v164
    v_mfma_f32_16x16x32_bf16 v[116:119], v[24:27], a[224:227], v[116:119]
    s_add_u32 s27, s27, 24576
    v_add_f32 v5, v5, v18
    v_add_f32 v5, v5, v19
    v_mfma_f32_16x16x32_bf16 v[120:123], v[24:27], a[248:251], v[120:123]
    s_add_u32 s56, s56, 36864
    ds_read_b128 v[44:47], v3 offset:18688
    v_fma_f32 v144, v144, v48, v50
    v_mfma_f32_16x16x32_bf16 v[120:123], v[28:31], a[252:255], v[120:123]
    s_waitcnt lgkmcnt(2)
    v_exp_f32 v17, v165
    v_mfma_f32_16x16x32_bf16 v[124:127], v[28:31], v[212:215], v[124:127]
    s_waitcnt vmcnt(12)
    v_cvt_pk_bf16_f32 v163, v18, v19
    s_sub_u32 s58, s56, 147456
    v_mfma_f32_16x16x32_bf16 v[124:127], v[24:27], v[208:211], v[124:127]
    s_barrier
    v_mfma_f32_16x16x32_bf16 v[176:179], v[32:35], a[208:211], v[176:179]
    s_min_u32 s56, s56, s58
    ds_read_b128 v[24:27], v1 offset:0
    v_mfma_f32_16x16x32_bf16 v[176:179], v[36:39], a[212:215], v[176:179]
    v_exp_f32 v18, v166
    v_mfma_f32_16x16x32_bf16 v[180:183], v[36:39], a[236:239], v[180:183]
    v_add_f32 v6, v6, v16
    v_add_f32 v6, v6, v17
    v_mfma_f32_16x16x32_bf16 v[180:183], v[32:35], a[232:235], v[180:183]
    v_exp_f32 v19, v167
    v_mfma_f32_16x16x32_bf16 v[184:187], v[32:35], v[192:195], v[184:187]
    ds_read_b128 v[28:31], v1 offset:12288
    v_cvt_pk_bf16_f32 v164, v16, v17
    v_mfma_f32_16x16x32_bf16 v[184:187], v[36:39], v[196:199], v[184:187]
    v_exp_f32 v16, v100
    v_mfma_f32_16x16x32_bf16 v[188:191], v[36:39], v[220:223], v[188:191]
    v_add_f32 v6, v6, v18
    v_add_f32 v6, v6, v19
    v_mfma_f32_16x16x32_bf16 v[188:191], v[32:35], v[216:219], v[188:191]
    s_waitcnt lgkmcnt(2)
    v_exp_f32 v17, v101
    v_mfma_f32_16x16x32_bf16 v[112:115], v[40:43], a[208:211], v[112:115]
    ds_read_b128 v[32:35], v1 offset:1024
    v_cvt_pk_bf16_f32 v165, v18, v19
    v_mfma_f32_16x16x32_bf16 v[112:115], v[44:47], a[212:215], v[112:115]
    v_exp_f32 v18, v102
    v_mfma_f32_16x16x32_bf16 v[116:119], v[44:47], a[236:239], v[116:119]
    v_add_f32 v6, v6, v16
    v_add_f32 v6, v6, v17
    v_mfma_f32_16x16x32_bf16 v[116:119], v[40:43], a[232:235], v[116:119]
    v_exp_f32 v19, v103
    v_mfma_f32_16x16x32_bf16 v[120:123], v[40:43], v[192:195], v[120:123]
    ds_read_b128 v[36:39], v1 offset:13312
    v_cvt_pk_bf16_f32 v166, v16, v17
    v_mfma_f32_16x16x32_bf16 v[120:123], v[44:47], v[196:199], v[120:123]
    v_add_f32 v6, v6, v18
    v_fma_f32 v148, v148, v49, v51
    v_mfma_f32_16x16x32_bf16 v[124:127], v[44:47], v[220:223], v[124:127]
    v_add_f32 v6, v6, v19
    v_cvt_pk_bf16_f32 v167, v18, v19
    v_mfma_f32_16x16x32_bf16 v[124:127], v[40:43], v[216:219], v[124:127]
    s_waitcnt lgkmcnt(2)
    v_mfma_f32_16x16x32_bf16 a[0:3], v[64:67], v[24:27], a[0:3]
    ds_read_b128 v[40:43], v1 offset:2048
    v_cvt_f32_i32 v145, v145
    v_mfma_f32_16x16x32_bf16 a[0:3], v[80:83], v[28:31], a[0:3]
    buffer_store_dwordx4 v[224:227], v11, s[4:7], s33 offen offset:0 sc1
    v_mfma_f32_16x16x32_bf16 a[48:51], v[84:87], v[28:31], a[48:51]
    v_exp_f32 v16, v168
    v_mfma_f32_16x16x32_bf16 a[48:51], v[68:71], v[24:27], a[48:51]
    v_exp_f32 v17, v169
    v_mfma_f32_16x16x32_bf16 a[96:99], v[72:75], v[24:27], a[96:99]
    ds_read_b128 v[44:47], v1 offset:14336
    v_cvt_f32_i32 v149, v149
    v_mfma_f32_16x16x32_bf16 a[96:99], v[88:91], v[28:31], a[96:99]
    v_exp_f32 v18, v170
    v_mfma_f32_16x16x32_bf16 a[144:147], v[92:95], v[28:31], a[144:147]
    v_add_f32 v7, v7, v16
    v_add_f32 v7, v7, v17
    v_mfma_f32_16x16x32_bf16 a[144:147], v[76:79], v[24:27], a[144:147]
    s_waitcnt lgkmcnt(2)
    v_exp_f32 v19, v171
    v_mfma_f32_16x16x32_bf16 a[4:7], v[64:67], v[32:35], a[4:7]
    ds_read_b128 v[24:27], v1 offset:3072
    v_cvt_pk_bf16_f32 v168, v16, v17
    v_mfma_f32_16x16x32_bf16 a[4:7], v[80:83], v[36:39], a[4:7]
    buffer_store_dwordx4 v[228:231], v21, s[4:7], s33 offen offset:768 sc1
    v_mfma_f32_16x16x32_bf16 a[52:55], v[84:87], v[36:39], a[52:55]
    v_exp_f32 v16, v104
    v_mfma_f32_16x16x32_bf16 a[52:55], v[68:71], v[32:35], a[52:55]
    v_add_f32 v7, v7, v18
    v_fma_f32 v145, v145, v48, v50
    v_mfma_f32_16x16x32_bf16 a[100:103], v[72:75], v[32:35], a[100:103]
    ds_read_b128 v[28:31], v1 offset:15360
    v_add_f32 v7, v7, v19
    v_mfma_f32_16x16x32_bf16 a[100:103], v[88:91], v[36:39], a[100:103]
    v_exp_f32 v17, v105
    v_mfma_f32_16x16x32_bf16 a[148:151], v[92:95], v[36:39], a[148:151]
    v_cvt_pk_bf16_f32 v169, v18, v19
    v_fma_f32 v149, v149, v49, v51
    v_mfma_f32_16x16x32_bf16 a[148:151], v[76:79], v[32:35], a[148:151]
    s_waitcnt lgkmcnt(2)
    v_exp_f32 v18, v106
    v_mfma_f32_16x16x32_bf16 a[8:11], v[64:67], v[40:43], a[8:11]
    ds_read_b128 v[32:35], v1 offset:4096
    v_add_f32 v7, v7, v16
    v_mfma_f32_16x16x32_bf16 a[8:11], v[80:83], v[44:47], a[8:11]
    buffer_store_dwordx4 v[232:235], v22, s[4:7], s33 offen offset:1536 sc1
    v_mfma_f32_16x16x32_bf16 a[56:59], v[84:87], v[44:47], a[56:59]
    v_add_f32 v7, v7, v17
    v_cvt_f32_i32 v146, v146
    v_mfma_f32_16x16x32_bf16 a[56:59], v[68:71], v[40:43], a[56:59]
    v_exp_f32 v19, v107
    v_mfma_f32_16x16x32_bf16 a[104:107], v[72:75], v[40:43], a[104:107]
    ds_read_b128 v[36:39], v1 offset:16384
    v_cvt_pk_bf16_f32 v170, v16, v17
    v_mfma_f32_16x16x32_bf16 a[104:107], v[88:91], v[44:47], a[104:107]
    v_exp_f32 v16, v172
    v_mfma_f32_16x16x32_bf16 a[152:155], v[92:95], v[44:47], a[152:155]
    v_add_f32 v7, v7, v18
    v_cvt_f32_i32 v150, v150
    v_mfma_f32_16x16x32_bf16 a[152:155], v[76:79], v[40:43], a[152:155]
    s_waitcnt lgkmcnt(2)
    v_add_f32 v7, v7, v19
    v_fma_f32 v146, v146, v48, v50
    v_mfma_f32_16x16x32_bf16 a[12:15], v[64:67], v[24:27], a[12:15]
    ds_read_b128 v[40:43], v1 offset:5120
    v_mfma_f32_16x16x32_bf16 a[12:15], v[80:83], v[28:31], a[12:15]
    buffer_store_dwordx4 v[236:239], v23, s[4:7], s33 offen offset:2304 sc1
    v_mfma_f32_16x16x32_bf16 a[60:63], v[84:87], v[28:31], a[60:63]
    v_exp_f32 v17, v173
    v_mfma_f32_16x16x32_bf16 a[60:63], v[68:71], v[24:27], a[60:63]
    v_cvt_pk_bf16_f32 v171, v18, v19
    v_fma_f32 v150, v150, v49, v51
    v_mfma_f32_16x16x32_bf16 a[108:111], v[72:75], v[24:27], a[108:111]
    ds_read_b128 v[44:47], v1 offset:17408
    v_mfma_f32_16x16x32_bf16 a[108:111], v[88:91], v[28:31], a[108:111]
    v_exp_f32 v18, v174
    v_mfma_f32_16x16x32_bf16 a[156:159], v[92:95], v[28:31], a[156:159]
    s_add_u32 s29, s28, 49152
    v_add_f32 v8, v8, v16
    v_add_f32 v8, v8, v17
    v_mfma_f32_16x16x32_bf16 a[156:159], v[76:79], v[24:27], a[156:159]
    s_waitcnt lgkmcnt(2)
    v_exp_f32 v19, v175
    v_mfma_f32_16x16x32_bf16 a[16:19], v[64:67], v[32:35], a[16:19]
    s_sub_u32 s3, s29, 147456
    ds_read_b128 v[24:27], v1 offset:6144
    v_cvt_pk_bf16_f32 v172, v16, v17
    v_mfma_f32_16x16x32_bf16 a[16:19], v[80:83], v[36:39], a[16:19]
    s_mov_b32 m0, s26
    v_exp_f32 v16, v108
    v_mfma_f32_16x16x32_bf16 a[64:67], v[84:87], v[36:39], a[64:67]
    s_min_u32 s29, s29, s3
    v_add_f32 v8, v8, v18
    v_lshlrev_b32 v48, 16, v57
    v_mfma_f32_16x16x32_bf16 a[64:67], v[68:71], v[32:35], a[64:67]
    buffer_load_dwordx4 v4, s[4:7], s32 offen offset:0 sc1 lds
    v_mfma_f32_16x16x32_bf16 a[112:115], v[72:75], v[32:35], a[112:115]
    ds_read_b128 v[28:31], v1 offset:18432
    v_add_f32 v8, v8, v19
    v_mfma_f32_16x16x32_bf16 a[112:115], v[88:91], v[36:39], a[112:115]
    v_exp_f32 v17, v109
    v_mfma_f32_16x16x32_bf16 a[160:163], v[92:95], v[36:39], a[160:163]
    v_cvt_pk_bf16_f32 v173, v18, v19
    v_and_b32 v49, s97, v57
    v_mfma_f32_16x16x32_bf16 a[160:163], v[76:79], v[32:35], a[160:163]
    s_waitcnt lgkmcnt(2)
    buffer_load_dwordx4 v4, s[4:7], s32 offen offset:1024 sc1 lds
    v_mfma_f32_16x16x32_bf16 a[20:23], v[64:67], v[40:43], a[20:23]
    s_sub_u32 s3, s29, s28
    ds_read_b128 v[32:35], v1 offset:7168
    v_lshlrev_b32 v50, 16, v59
    v_mfma_f32_16x16x32_bf16 a[20:23], v[80:83], v[44:47], a[20:23]
    v_exp_f32 v18, v110
    v_mfma_f32_16x16x32_bf16 a[68:71], v[84:87], v[44:47], a[68:71]
    v_add_f32 v8, v8, v16
    v_add_f32 v8, v8, v17
    v_mfma_f32_16x16x32_bf16 a[68:71], v[68:71], v[40:43], a[68:71]
    buffer_load_dwordx4 v4, s[4:7], s32 offen offset:2048 sc1 lds
    v_mfma_f32_16x16x32_bf16 a[116:119], v[72:75], v[40:43], a[116:119]
    ds_read_b128 v[36:39], v1 offset:19456
    v_mfma_f32_16x16x32_bf16 a[116:119], v[88:91], v[44:47], a[116:119]
    v_exp_f32 v19, v111
    v_mfma_f32_16x16x32_bf16 a[164:167], v[92:95], v[44:47], a[164:167]
    s_mov_b32 s28, s29
    v_cvt_pk_bf16_f32 v174, v16, v17
    v_add_f32 v8, v8, v18
    v_mfma_f32_16x16x32_bf16 a[164:167], v[76:79], v[40:43], a[164:167]
    s_waitcnt lgkmcnt(2)
    v_add_f32 v8, v8, v19
    v_cvt_pk_bf16_f32 v175, v18, v19
    v_mfma_f32_16x16x32_bf16 a[24:27], v[64:67], v[24:27], a[24:27]
    s_add_u32 s32, s32, 24576
    ds_read_b128 v[40:43], v1 offset:8192
    v_and_b32 v51, s97, v59
    v_mfma_f32_16x16x32_bf16 a[24:27], v[80:83], v[28:31], a[24:27]
    v_exp_f32 v16, v176
    v_mfma_f32_16x16x32_bf16 a[72:75], v[84:87], v[28:31], a[72:75]
    s_add_u32 s26, s26, 12288
    v_exp_f32 v17, v177
    v_mfma_f32_16x16x32_bf16 a[72:75], v[68:71], v[24:27], a[72:75]
    v_exp_f32 v18, v178
    v_mfma_f32_16x16x32_bf16 a[120:123], v[72:75], v[24:27], a[120:123]
    s_mov_b32 m0, s26
    ds_read_b128 v[44:47], v1 offset:20480
    v_add_f32 v5, v5, v16
    v_mfma_f32_16x16x32_bf16 a[120:123], v[88:91], v[28:31], a[120:123]
    v_add_f32 v5, v5, v17
    v_mul_f32_e64 v50, -v50, v48
    v_mfma_f32_16x16x32_bf16 a[168:171], v[92:95], v[28:31], a[168:171]
    v_exp_f32 v19, v179
    v_mfma_f32_16x16x32_bf16 a[168:171], v[76:79], v[24:27], a[168:171]
    s_waitcnt lgkmcnt(2)
    v_cvt_pk_bf16_f32 v176, v16, v17
    v_mul_f32_e64 v51, -v51, v49
    v_mfma_f32_16x16x32_bf16 a[28:31], v[64:67], v[32:35], a[28:31]
    ds_read_b128 v[24:27], v1 offset:9216
    v_add_u32 v2, s3, v2
    v_mfma_f32_16x16x32_bf16 a[28:31], v[80:83], v[36:39], a[28:31]
    buffer_load_dwordx4 v4, s[4:7], s32 offen offset:0 sc1 lds
    v_mfma_f32_16x16x32_bf16 a[76:79], v[84:87], v[36:39], a[76:79]
    v_exp_f32 v16, v112
    v_mfma_f32_16x16x32_bf16 a[76:79], v[68:71], v[32:35], a[76:79]
    v_add_f32 v5, v5, v18
    v_add_f32 v5, v5, v19
    v_mfma_f32_16x16x32_bf16 a[124:127], v[72:75], v[32:35], a[124:127]
    ds_read_b128 v[28:31], v1 offset:21504
    v_cvt_f32_i32 v152, v152
    v_mfma_f32_16x16x32_bf16 a[124:127], v[88:91], v[36:39], a[124:127]
    buffer_load_dwordx4 v4, s[4:7], s32 offen offset:1024 sc1 lds
    v_mfma_f32_16x16x32_bf16 a[172:175], v[92:95], v[36:39], a[172:175]
    v_exp_f32 v17, v113
    v_mfma_f32_16x16x32_bf16 a[172:175], v[76:79], v[32:35], a[172:175]
    s_waitcnt lgkmcnt(2)
    v_cvt_pk_bf16_f32 v177, v18, v19
    v_add_u32 v3, s3, v3
    v_mfma_f32_16x16x32_bf16 a[32:35], v[64:67], v[40:43], a[32:35]
    ds_read_b128 v[32:35], v1 offset:10240
    v_cvt_f32_i32 v156, v156
    v_mfma_f32_16x16x32_bf16 a[32:35], v[80:83], v[44:47], a[32:35]
    v_exp_f32 v18, v114
    v_mfma_f32_16x16x32_bf16 a[80:83], v[84:87], v[44:47], a[80:83]
    v_add_f32 v5, v5, v16
    v_add_f32 v5, v5, v17
    v_mfma_f32_16x16x32_bf16 a[80:83], v[68:71], v[40:43], a[80:83]
    buffer_load_dwordx4 v4, s[4:7], s32 offen offset:2048 sc1 lds
    v_mfma_f32_16x16x32_bf16 a[128:131], v[72:75], v[40:43], a[128:131]
    ds_read_b128 v[36:39], v1 offset:22528
    v_mfma_f32_16x16x32_bf16 a[128:131], v[88:91], v[44:47], a[128:131]
    v_exp_f32 v19, v115
    v_mfma_f32_16x16x32_bf16 a[176:179], v[92:95], v[44:47], a[176:179]
    v_cvt_pk_bf16_f32 v178, v16, v17
    v_fma_f32 v152, v152, v48, v50
    v_mfma_f32_16x16x32_bf16 a[176:179], v[76:79], v[40:43], a[176:179]
    s_waitcnt lgkmcnt(2)
    v_exp_f32 v16, v180
    v_mfma_f32_16x16x32_bf16 a[36:39], v[64:67], v[24:27], a[36:39]
    ds_read_b128 v[40:43], v1 offset:11264
    v_add_f32 v5, v5, v18
    v_mfma_f32_16x16x32_bf16 a[36:39], v[80:83], v[28:31], a[36:39]
    v_add_f32 v5, v5, v19
    v_mfma_f32_16x16x32_bf16 a[84:87], v[84:87], v[28:31], a[84:87]
    v_exp_f32 v17, v181
    v_mfma_f32_16x16x32_bf16 a[84:87], v[68:71], v[24:27], a[84:87]
    s_add_u32 s32, s32, 24576
    v_cvt_pk_bf16_f32 v179, v18, v19
    s_add_u32 s26, s26, 36864
    v_mfma_f32_16x16x32_bf16 a[132:135], v[72:75], v[24:27], a[132:135]
    s_sub_u32 s57, s26, 147456
    ds_read_b128 v[44:47], v1 offset:23552
    v_fma_f32 v156, v156, v49, v51
    v_mfma_f32_16x16x32_bf16 a[132:135], v[88:91], v[28:31], a[132:135]
    s_waitcnt lgkmcnt(2)
    v_exp_f32 v18, v182
    v_mfma_f32_16x16x32_bf16 a[180:183], v[92:95], v[28:31], a[180:183]
    s_waitcnt vmcnt(6)
    v_add_f32 v6, v6, v16
    v_add_f32 v6, v6, v17
    v_mfma_f32_16x16x32_bf16 a[180:183], v[76:79], v[24:27], a[180:183]
    s_barrier
    v_mfma_f32_16x16x32_bf16 a[40:43], v[64:67], v[32:35], a[40:43]
    s_min_u32 s26, s26, s57
    ds_read_b128 v[24:27], v2 offset:0
    v_add_u32 v0, 1, v0
    v_mfma_f32_16x16x32_bf16 a[40:43], v[80:83], v[36:39], a[40:43]
    buffer_store_dword v0, v13, s[20:23], 0 offen offset:32 sc1
    v_mfma_f32_16x16x32_bf16 a[88:91], v[84:87], v[36:39], a[88:91]
    v_exp_f32 v19, v183
    v_mfma_f32_16x16x32_bf16 a[88:91], v[68:71], v[32:35], a[88:91]
    v_cvt_pk_bf16_f32 v180, v16, v17
    v_cvt_f32_i32 v153, v153
    v_mfma_f32_16x16x32_bf16 a[136:139], v[72:75], v[32:35], a[136:139]
    ds_read_b128 v[28:31], v3 offset:0
    v_cvt_f32_i32 v157, v157
    v_mfma_f32_16x16x32_bf16 a[136:139], v[88:91], v[36:39], a[136:139]
    v_exp_f32 v16, v116
    v_mfma_f32_16x16x32_bf16 a[184:187], v[92:95], v[36:39], a[184:187]
    v_add_f32 v6, v6, v18
    v_add_f32 v6, v6, v19
    v_mfma_f32_16x16x32_bf16 a[184:187], v[76:79], v[32:35], a[184:187]
    s_waitcnt lgkmcnt(2)
    v_exp_f32 v17, v117
    v_mfma_f32_16x16x32_bf16 a[44:47], v[64:67], v[40:43], a[44:47]
    ds_read_b128 v[32:35], v2 offset:6144
    v_cvt_pk_bf16_f32 v181, v18, v19
    v_mfma_f32_16x16x32_bf16 a[44:47], v[80:83], v[44:47], a[44:47]
    v_exp_f32 v18, v118
    v_mfma_f32_16x16x32_bf16 a[92:95], v[84:87], v[44:47], a[92:95]
    v_add_f32 v6, v6, v16
    v_add_f32 v6, v6, v17
    v_mfma_f32_16x16x32_bf16 a[92:95], v[68:71], v[40:43], a[92:95]
    v_exp_f32 v19, v119
    v_mfma_f32_16x16x32_bf16 a[140:143], v[72:75], v[40:43], a[140:143]
    ds_read_b128 v[36:39], v3 offset:6144
    v_cvt_pk_bf16_f32 v182, v16, v17
    v_mfma_f32_16x16x32_bf16 a[140:143], v[88:91], v[44:47], a[140:143]
    v_add_f32 v6, v6, v18
    v_add_f32 v6, v6, v19
    v_mfma_f32_16x16x32_bf16 a[188:191], v[92:95], v[44:47], a[188:191]
    v_cvt_pk_bf16_f32 v183, v18, v19
    v_mfma_f32_16x16x32_bf16 a[188:191], v[76:79], v[40:43], a[188:191]
    s_waitcnt lgkmcnt(2)
    v_mfma_f32_16x16x32_bf16 v[64:67], v[24:27], a[192:195], v[128:131]
    s_mov_b32 m0, s56
    ds_read_b128 v[40:43], v2 offset:128
    v_fma_f32 v153, v153, v48, v50
    v_mfma_f32_16x16x32_bf16 v[64:67], v[28:31], a[196:199], v[64:67]
    buffer_load_dwordx4 v4, s[4:7], s27 offen offset:0 sc1 lds
    v_mfma_f32_16x16x32_bf16 v[68:71], v[28:31], a[220:223], v[132:135]
    v_exp_f32 v16, v184
    v_mfma_f32_16x16x32_bf16 v[68:71], v[24:27], a[216:219], v[68:71]
    v_exp_f32 v17, v185
    v_mfma_f32_16x16x32_bf16 v[72:75], v[24:27], a[240:243], v[136:139]
    ds_read_b128 v[44:47], v3 offset:128
    v_fma_f32 v157, v157, v49, v51
    v_mfma_f32_16x16x32_bf16 v[72:75], v[28:31], a[244:247], v[72:75]
    v_exp_f32 v18, v186
    v_mfma_f32_16x16x32_bf16 v[76:79], v[28:31], v[204:207], v[140:143]
    v_add_f32 v7, v7, v16
    v_add_f32 v7, v7, v17
    v_mfma_f32_16x16x32_bf16 v[76:79], v[24:27], v[200:203], v[76:79]
    s_waitcnt lgkmcnt(2)
    v_exp_f32 v19, v187
    v_mfma_f32_16x16x32_bf16 v[96:99], v[32:35], a[192:195], v[128:131]
    ds_read_b128 v[24:27], v2 offset:6272
    v_cvt_pk_bf16_f32 v184, v16, v17
    v_mfma_f32_16x16x32_bf16 v[96:99], v[36:39], a[196:199], v[96:99]
    v_exp_f32 v16, v120
    v_mfma_f32_16x16x32_bf16 v[100:103], v[36:39], a[220:223], v[132:135]
    v_cvt_f32_i32 v154, v154
    v_add_f32 v7, v7, v18
    v_mfma_f32_16x16x32_bf16 v[100:103], v[32:35], a[216:219], v[100:103]
    buffer_load_dwordx4 v4, s[4:7], s27 offen offset:1024 sc1 lds
    v_mfma_f32_16x16x32_bf16 v[104:107], v[32:35], a[240:243], v[136:139]
    ds_read_b128 v[28:31], v3 offset:6272
    v_add_f32 v7, v7, v19
    v_mfma_f32_16x16x32_bf16 v[104:107], v[36:39], a[244:247], v[104:107]
    v_exp_f32 v17, v121
    v_mfma_f32_16x16x32_bf16 v[108:111], v[36:39], v[204:207], v[140:143]
    v_cvt_f32_i32 v158, v158
    v_cvt_pk_bf16_f32 v185, v18, v19
    v_mfma_f32_16x16x32_bf16 v[108:111], v[32:35], v[200:203], v[108:111]
    s_waitcnt lgkmcnt(2)
    v_exp_f32 v18, v122
    v_mfma_f32_16x16x32_bf16 v[64:67], v[40:43], a[200:203], v[64:67]
    ds_read_b128 v[32:35], v2 offset:256
    v_fma_f32 v154, v154, v48, v50
    v_mfma_f32_16x16x32_bf16 v[64:67], v[44:47], a[204:207], v[64:67]
L_pg8:
    s_cbranch_execz L_pg12
    v_add_f32 v7, v7, v16
    v_add_f32 v7, v7, v17
    v_mfma_f32_16x16x32_bf16 v[68:71], v[44:47], a[228:231], v[68:71]
    v_exp_f32 v19, v123
    v_mfma_f32_16x16x32_bf16 v[68:71], v[40:43], a[224:227], v[68:71]
    v_fma_f32 v158, v158, v49, v51
    v_cvt_pk_bf16_f32 v186, v16, v17
    v_mfma_f32_16x16x32_bf16 v[72:75], v[40:43], a[248:251], v[72:75]
    ds_read_b128 v[36:39], v3 offset:256
    v_cvt_pk_bf16_f32 v144, v144, v148
    v_mfma_f32_16x16x32_bf16 v[72:75], v[44:47], a[252:255], v[72:75]
    v_exp_f32 v16, v188
    v_mfma_f32_16x16x32_bf16 v[76:79], v[44:47], v[212:215], v[76:79]
    v_add_f32 v7, v7, v18
    v_add_f32 v7, v7, v19
    v_mfma_f32_16x16x32_bf16 v[76:79], v[40:43], v[208:211], v[76:79]
    s_waitcnt lgkmcnt(2)
    buffer_load_dwordx4 v4, s[4:7], s27 offen offset:2048 sc1 lds
    v_mfma_f32_16x16x32_bf16 v[96:99], v[24:27], a[200:203], v[96:99]
    ds_read_b128 v[40:43], v2 offset:6400
    v_cvt_pk_bf16_f32 v148, v145, v149
    v_mfma_f32_16x16x32_bf16 v[96:99], v[28:31], a[204:207], v[96:99]
    v_exp_f32 v17, v189
    v_mfma_f32_16x16x32_bf16 v[100:103], v[28:31], a[228:231], v[100:103]
    v_cvt_pk_bf16_f32 v187, v18, v19
    v_mfma_f32_16x16x32_bf16 v[100:103], v[24:27], a[224:227], v[100:103]
    v_exp_f32 v18, v190
    v_mfma_f32_16x16x32_bf16 v[104:107], v[24:27], a[248:251], v[104:107]
    ds_read_b128 v[44:47], v3 offset:6400
    v_add_f32 v8, v8, v16
    v_mfma_f32_16x16x32_bf16 v[104:107], v[28:31], a[252:255], v[104:107]
    v_add_f32 v8, v8, v17
    v_cvt_pk_bf16_f32 v145, v152, v156
    v_mfma_f32_16x16x32_bf16 v[108:111], v[28:31], v[212:215], v[108:111]
    s_add_u32 s29, s30, 49152
    v_exp_f32 v19, v191
    v_mfma_f32_16x16x32_bf16 v[108:111], v[24:27], v[208:211], v[108:111]
    s_waitcnt lgkmcnt(2)
    v_cvt_pk_bf16_f32 v188, v16, v17
    s_sub_u32 s3, s29, 147456
    v_mfma_f32_16x16x32_bf16 v[64:67], v[32:35], a[208:211], v[64:67]
    s_add_u32 s27, s27, 24576
    ds_read_b128 v[24:27], v2 offset:12288
    v_cvt_pk_bf16_f32 v149, v153, v157
    v_mfma_f32_16x16x32_bf16 v[64:67], v[36:39], a[212:215], v[64:67]
    s_min_u32 s29, s29, s3
    v_exp_f32 v16, v124
    v_mfma_f32_16x16x32_bf16 v[68:71], v[36:39], a[236:239], v[68:71]
    v_add_f32 v8, v8, v18
    v_add_f32 v8, v8, v19
    v_mfma_f32_16x16x32_bf16 v[68:71], v[32:35], a[232:235], v[68:71]
    v_exp_f32 v17, v125
    v_mfma_f32_16x16x32_bf16 v[72:75], v[32:35], v[192:195], v[72:75]
    s_add_u32 s56, s56, 12288
    ds_read_b128 v[28:31], v3 offset:12288
    v_cvt_pk_bf16_f32 v152, v146, v150
    v_mfma_f32_16x16x32_bf16 v[72:75], v[36:39], v[196:199], v[72:75]
    v_cvt_pk_bf16_f32 v189, v18, v19
    v_mfma_f32_16x16x32_bf16 v[76:79], v[36:39], v[220:223], v[76:79]
    v_exp_f32 v18, v126
    v_mfma_f32_16x16x32_bf16 v[76:79], v[32:35], v[216:219], v[76:79]
    s_waitcnt lgkmcnt(2)
    v_add_f32 v8, v8, v16
    v_mfma_f32_16x16x32_bf16 v[96:99], v[40:43], a[208:211], v[96:99]
    ds_read_b128 v[32:35], v2 offset:18432
    v_add_f32 v8, v8, v17
    v_mfma_f32_16x16x32_bf16 v[96:99], v[44:47], a[212:215], v[96:99]
    s_sub_u32 s3, s29, s30
    v_exp_f32 v19, v127
    v_mfma_f32_16x16x32_bf16 v[100:103], v[44:47], a[236:239], v[100:103]
    s_mov_b32 m0, s56
    v_cvt_pk_bf16_f32 v153, v154, v158
    v_mfma_f32_16x16x32_bf16 v[100:103], v[40:43], a[232:235], v[100:103]
    v_cvt_pk_bf16_f32 v190, v16, v17
    v_mfma_f32_16x16x32_bf16 v[104:107], v[40:43], v[192:195], v[104:107]
    ds_read_b128 v[36:39], v3 offset:18432
    v_add_f32 v8, v8, v18
    v_mfma_f32_16x16x32_bf16 v[104:107], v[44:47], v[196:199], v[104:107]
    v_add_f32 v8, v8, v19
    v_cvt_pk_bf16_f32 v191, v18, v19
    v_mfma_f32_16x16x32_bf16 v[108:111], v[44:47], v[220:223], v[108:111]
    v_mfma_f32_16x16x32_bf16 v[108:111], v[40:43], v[216:219], v[108:111]
    s_waitcnt lgkmcnt(2)
    v_exp_f32 v16, v64
    v_mfma_f32_16x16x32_bf16 v[80:83], v[24:27], a[192:195], v[128:131]
    ds_read_b128 v[40:43], v2 offset:12416
    v_mfma_f32_16x16x32_bf16 v[80:83], v[28:31], a[196:199], v[80:83]
    s_mov_b32 s30, s29
    v_exp_f32 v17, v65
    v_mfma_f32_16x16x32_bf16 v[84:87], v[28:31], a[220:223], v[132:135]
    v_exp_f32 v18, v66
    v_mfma_f32_16x16x32_bf16 v[84:87], v[24:27], a[216:219], v[84:87]
    s_waitcnt vmcnt(14)
    buffer_load_dwordx4 v4, s[4:7], s27 offen offset:0 sc1 lds
    v_mfma_f32_16x16x32_bf16 v[88:91], v[24:27], a[240:243], v[136:139]
    ds_read_b128 v[44:47], v3 offset:12416
    v_add_f32 v5, v5, v16
    v_mfma_f32_16x16x32_bf16 v[88:91], v[28:31], a[244:247], v[88:91]
    v_add_f32 v5, v5, v17
    v_lshlrev_b32 v48, 16, v60
    v_mfma_f32_16x16x32_bf16 v[92:95], v[28:31], v[204:207], v[140:143]
    v_exp_f32 v19, v67
    v_mfma_f32_16x16x32_bf16 v[92:95], v[24:27], v[200:203], v[92:95]
    s_waitcnt lgkmcnt(2)
    v_cvt_pk_bf16_f32 v64, v16, v17
    v_and_b32 v49, s97, v60
    v_mfma_f32_16x16x32_bf16 v[112:115], v[32:35], a[192:195], v[128:131]
    ds_read_b128 v[24:27], v2 offset:18560
    v_mfma_f32_16x16x32_bf16 v[112:115], v[36:39], a[196:199], v[112:115]
    v_exp_f32 v16, v96
    v_mfma_f32_16x16x32_bf16 v[116:119], v[36:39], a[220:223], v[132:135]
    v_add_f32 v5, v5, v18
    v_lshlrev_b32 v50, 16, v62
    v_mfma_f32_16x16x32_bf16 v[116:119], v[32:35], a[216:219], v[116:119]
    v_add_f32 v5, v5, v19
    v_add_u32 v1, s3, v1
    v_mfma_f32_16x16x32_bf16 v[120:123], v[32:35], a[240:243], v[136:139]
    ds_read_b128 v[28:31], v3 offset:18560
    v_mfma_f32_16x16x32_bf16 v[120:123], v[36:39], a[244:247], v[120:123]
    v_exp_f32 v17, v97
    v_mfma_f32_16x16x32_bf16 v[124:127], v[36:39], v[204:207], v[140:143]
    v_cvt_pk_bf16_f32 v65, v18, v19
    v_and_b32 v51, s97, v62
    v_mfma_f32_16x16x32_bf16 v[124:127], v[32:35], v[200:203], v[124:127]
    s_waitcnt lgkmcnt(2)
    buffer_load_dwordx4 v4, s[4:7], s27 offen offset:1024 sc1 lds
    v_mfma_f32_16x16x32_bf16 v[80:83], v[40:43], a[200:203], v[80:83]
    ds_read_b128 v[32:35], v2 offset:12544
    v_mfma_f32_16x16x32_bf16 v[80:83], v[44:47], a[204:207], v[80:83]
    v_exp_f32 v18, v98
    v_mfma_f32_16x16x32_bf16 v[84:87], v[44:47], a[228:231], v[84:87]
    v_add_f32 v5, v5, v16
    v_add_f32 v5, v5, v17
    v_mfma_f32_16x16x32_bf16 v[84:87], v[40:43], a[224:227], v[84:87]
    v_exp_f32 v19, v99
    v_mfma_f32_16x16x32_bf16 v[88:91], v[40:43], a[248:251], v[88:91]
    ds_read_b128 v[36:39], v3 offset:12544
    v_cvt_pk_bf16_f32 v66, v16, v17
    v_mfma_f32_16x16x32_bf16 v[88:91], v[44:47], a[252:255], v[88:91]
    v_exp_f32 v16, v68
    v_mfma_f32_16x16x32_bf16 v[92:95], v[44:47], v[212:215], v[92:95]
    v_mul_f32_e64 v50, -v50, v48
    v_add_f32 v5, v5, v18
    v_mfma_f32_16x16x32_bf16 v[92:95], v[40:43], v[208:211], v[92:95]
    s_waitcnt lgkmcnt(2)
    v_add_f32 v5, v5, v19
    v_mul_f32_e64 v51, -v51, v49
    v_mfma_f32_16x16x32_bf16 v[112:115], v[24:27], a[200:203], v[112:115]
    ds_read_b128 v[40:43], v2 offset:18688
    v_mfma_f32_16x16x32_bf16 v[112:115], v[28:31], a[204:207], v[112:115]
    buffer_load_dwordx4 v4, s[4:7], s27 offen offset:2048 sc1 lds
    v_mfma_f32_16x16x32_bf16 v[116:119], v[28:31], a[228:231], v[116:119]
    v_exp_f32 v17, v69
    v_mfma_f32_16x16x32_bf16 v[116:119], v[24:27], a[224:227], v[116:119]
    v_cvt_pk_bf16_f32 v67, v18, v19
    v_cvt_f32_i32 v240, v240
    v_mfma_f32_16x16x32_bf16 v[120:123], v[24:27], a[248:251], v[120:123]
    ds_read_b128 v[44:47], v3 offset:18688
    v_mfma_f32_16x16x32_bf16 v[120:123], v[28:31], a[252:255], v[120:123]
    s_waitcnt lgkmcnt(2)
    v_exp_f32 v18, v70
    v_mfma_f32_16x16x32_bf16 v[124:127], v[28:31], v[212:215], v[124:127]
    s_waitcnt vmcnt(7)
    v_add_f32 v6, v6, v16
    v_add_f32 v6, v6, v17
    v_mfma_f32_16x16x32_bf16 v[124:127], v[24:27], v[208:211], v[124:127]
    s_barrier
    v_mfma_f32_16x16x32_bf16 v[80:83], v[32:35], a[208:211], v[80:83]
    ds_read_b128 v[24:27], v1 offset:0
    v_cvt_f32_i32 v244, v244
    v_mfma_f32_16x16x32_bf16 v[80:83], v[36:39], a[212:215], v[80:83]
    v_exp_f32 v19, v71
    v_mfma_f32_16x16x32_bf16 v[84:87], v[36:39], a[236:239], v[84:87]
    v_cvt_pk_bf16_f32 v68, v16, v17
    v_fma_f32 v240, v240, v48, v50
    v_mfma_f32_16x16x32_bf16 v[84:87], v[32:35], a[232:235], v[84:87]
    v_exp_f32 v16, v100
    v_mfma_f32_16x16x32_bf16 v[88:91], v[32:35], v[192:195], v[88:91]
    ds_read_b128 v[28:31], v1 offset:12288
    v_add_f32 v6, v6, v18
    v_mfma_f32_16x16x32_bf16 v[88:91], v[36:39], v[196:199], v[88:91]
    v_add_f32 v6, v6, v19
    v_fma_f32 v244, v244, v49, v51
    v_mfma_f32_16x16x32_bf16 v[92:95], v[36:39], v[220:223], v[92:95]
    v_exp_f32 v17, v101
    v_mfma_f32_16x16x32_bf16 v[92:95], v[32:35], v[216:219], v[92:95]
    s_waitcnt lgkmcnt(2)
    v_cvt_pk_bf16_f32 v69, v18, v19
    v_mfma_f32_16x16x32_bf16 v[112:115], v[40:43], a[208:211], v[112:115]
    ds_read_b128 v[32:35], v1 offset:1024
    v_mfma_f32_16x16x32_bf16 v[112:115], v[44:47], a[212:215], v[112:115]
    v_exp_f32 v18, v102
    v_mfma_f32_16x16x32_bf16 v[116:119], v[44:47], a[236:239], v[116:119]
    v_add_f32 v6, v6, v16
    v_add_f32 v6, v6, v17
    v_mfma_f32_16x16x32_bf16 v[116:119], v[40:43], a[232:235], v[116:119]
    s_add_u32 s27, s27, 24576
    v_exp_f32 v19, v103
    v_mfma_f32_16x16x32_bf16 v[120:123], v[40:43], v[192:195], v[120:123]
    s_add_u32 s56, s56, 36864
    ds_read_b128 v[36:39], v1 offset:13312
    v_cvt_pk_bf16_f32 v70, v16, v17
    v_mfma_f32_16x16x32_bf16 v[120:123], v[44:47], v[196:199], v[120:123]
    s_sub_u32 s58, s56, 147456
    v_add_f32 v6, v6, v18
    v_add_f32 v6, v6, v19
    v_mfma_f32_16x16x32_bf16 v[124:127], v[44:47], v[220:223], v[124:127]
    s_min_u32 s56, s56, s58
    v_cvt_pk_bf16_f32 v71, v18, v19
    v_mfma_f32_16x16x32_bf16 v[124:127], v[40:43], v[216:219], v[124:127]
    s_waitcnt lgkmcnt(2)
    v_mfma_f32_16x16x32_bf16 a[0:3], v[160:163], v[24:27], a[0:3]
    s_mov_b32 m0, s56
    ds_read_b128 v[40:43], v1 offset:2048
    v_cvt_f32_i32 v241, v241
    v_mfma_f32_16x16x32_bf16 a[0:3], v[176:179], v[28:31], a[0:3]
    buffer_load_dwordx4 v4, s[4:7], s27 offen offset:0 sc1 lds
    v_mfma_f32_16x16x32_bf16 a[48:51], v[180:183], v[28:31], a[48:51]
    v_exp_f32 v16, v72
    v_mfma_f32_16x16x32_bf16 a[48:51], v[164:167], v[24:27], a[48:51]
    v_exp_f32 v17, v73
    v_mfma_f32_16x16x32_bf16 a[96:99], v[168:171], v[24:27], a[96:99]
    ds_read_b128 v[44:47], v1 offset:14336
    v_cvt_f32_i32 v245, v245
    v_mfma_f32_16x16x32_bf16 a[96:99], v[184:187], v[28:31], a[96:99]
    v_exp_f32 v18, v74
    v_mfma_f32_16x16x32_bf16 a[144:147], v[188:191], v[28:31], a[144:147]
    v_add_f32 v7, v7, v16
    v_add_f32 v7, v7, v17
    v_mfma_f32_16x16x32_bf16 a[144:147], v[172:175], v[24:27], a[144:147]
    s_waitcnt lgkmcnt(2)
    v_exp_f32 v19, v75
    v_mfma_f32_16x16x32_bf16 a[4:7], v[160:163], v[32:35], a[4:7]
    ds_read_b128 v[24:27], v1 offset:3072
    v_fma_f32 v241, v241, v48, v50
    v_mfma_f32_16x16x32_bf16 a[4:7], v[176:179], v[36:39], a[4:7]
    buffer_load_dwordx4 v4, s[4:7], s27 offen offset:1024 sc1 lds
    v_mfma_f32_16x16x32_bf16 a[52:55], v[180:183], v[36:39], a[52:55]
    v_cvt_pk_bf16_f32 v72, v16, v17
    v_fma_f32 v245, v245, v49, v51
    v_mfma_f32_16x16x32_bf16 a[52:55], v[164:167], v[32:35], a[52:55]
    v_exp_f32 v16, v104
    v_mfma_f32_16x16x32_bf16 a[100:103], v[168:171], v[32:35], a[100:103]
    ds_read_b128 v[28:31], v1 offset:15360
    v_add_f32 v7, v7, v18
    v_mfma_f32_16x16x32_bf16 a[100:103], v[184:187], v[36:39], a[100:103]
    buffer_load_dword v52, v20, s[20:23], s44 offen sc1
    v_mfma_f32_16x16x32_bf16 a[148:151], v[188:191], v[36:39], a[148:151]
    v_add_f32 v7, v7, v19
    v_cvt_f32_i32 v242, v242
    v_mfma_f32_16x16x32_bf16 a[148:151], v[172:175], v[32:35], a[148:151]
    s_waitcnt lgkmcnt(2)
    v_exp_f32 v17, v105
    v_mfma_f32_16x16x32_bf16 a[8:11], v[160:163], v[40:43], a[8:11]
    ds_read_b128 v[32:35], v1 offset:4096
    v_cvt_pk_bf16_f32 v73, v18, v19
    v_mfma_f32_16x16x32_bf16 a[8:11], v[176:179], v[44:47], a[8:11]
    v_exp_f32 v18, v106
    v_mfma_f32_16x16x32_bf16 a[56:59], v[180:183], v[44:47], a[56:59]
    v_add_f32 v7, v7, v16
    v_cvt_f32_i32 v246, v246
    v_mfma_f32_16x16x32_bf16 a[56:59], v[164:167], v[40:43], a[56:59]
    buffer_load_dwordx4 v4, s[4:7], s27 offen offset:2048 sc1 lds
    v_mfma_f32_16x16x32_bf16 a[104:107], v[168:171], v[40:43], a[104:107]
    ds_read_b128 v[36:39], v1 offset:16384
    v_add_f32 v7, v7, v17
    v_mfma_f32_16x16x32_bf16 a[104:107], v[184:187], v[44:47], a[104:107]
    v_exp_f32 v19, v107
    v_mfma_f32_16x16x32_bf16 a[152:155], v[188:191], v[44:47], a[152:155]
    v_cvt_pk_bf16_f32 v74, v16, v17
    v_fma_f32 v242, v242, v48, v50
    v_mfma_f32_16x16x32_bf16 a[152:155], v[172:175], v[40:43], a[152:155]
    s_waitcnt lgkmcnt(2)
    v_exp_f32 v16, v76
    v_mfma_f32_16x16x32_bf16 a[12:15], v[160:163], v[24:27], a[12:15]
    ds_read_b128 v[40:43], v1 offset:5120
    v_add_f32 v7, v7, v18
    v_mfma_f32_16x16x32_bf16 a[12:15], v[176:179], v[28:31], a[12:15]
    s_add_u32 s27, s27, 24576
    v_add_f32 v7, v7, v19
    v_fma_f32 v246, v246, v49, v51
    v_mfma_f32_16x16x32_bf16 a[60:63], v[180:183], v[28:31], a[60:63]
    v_exp_f32 v17, v77
    v_mfma_f32_16x16x32_bf16 a[60:63], v[164:167], v[24:27], a[60:63]
    v_cvt_pk_bf16_f32 v75, v18, v19
    v_lshlrev_b32 v48, 16, v61
    v_mfma_f32_16x16x32_bf16 a[108:111], v[168:171], v[24:27], a[108:111]
    ds_read_b128 v[44:47], v1 offset:17408
    v_and_b32 v49, s97, v61
    v_mfma_f32_16x16x32_bf16 a[108:111], v[184:187], v[28:31], a[108:111]
    v_exp_f32 v18, v78
    v_mfma_f32_16x16x32_bf16 a[156:159], v[188:191], v[28:31], a[156:159]
    s_add_u32 s29, s28, 49152
    v_add_f32 v8, v8, v16
    v_add_f32 v8, v8, v17
    v_mfma_f32_16x16x32_bf16 a[156:159], v[172:175], v[24:27], a[156:159]
    s_waitcnt lgkmcnt(2)
    v_exp_f32 v19, v79
    v_mfma_f32_16x16x32_bf16 a[16:19], v[160:163], v[32:35], a[16:19]
    s_sub_u32 s3, s29, 147456
    ds_read_b128 v[24:27], v1 offset:6144
    v_lshlrev_b32 v50, 16, v63
    v_mfma_f32_16x16x32_bf16 a[16:19], v[176:179], v[36:39], a[16:19]
    s_add_u32 s56, s56, 12288
    v_cvt_pk_bf16_f32 v76, v16, v17
    v_and_b32 v51, s97, v63
    v_mfma_f32_16x16x32_bf16 a[64:67], v[180:183], v[36:39], a[64:67]
    s_min_u32 s29, s29, s3
    v_exp_f32 v16, v108
    v_mfma_f32_16x16x32_bf16 a[64:67], v[164:167], v[32:35], a[64:67]
    s_mov_b32 m0, s56
    v_add_f32 v8, v8, v18
    v_add_f32 v8, v8, v19
    v_mfma_f32_16x16x32_bf16 a[112:115], v[168:171], v[32:35], a[112:115]
    ds_read_b128 v[28:31], v1 offset:18432
    v_mul_f32_e64 v50, -v50, v48
    v_mfma_f32_16x16x32_bf16 a[112:115], v[184:187], v[36:39], a[112:115]
    v_exp_f32 v17, v109
    v_mfma_f32_16x16x32_bf16 a[160:163], v[188:191], v[36:39], a[160:163]
    v_cvt_pk_bf16_f32 v77, v18, v19
    v_mul_f32_e64 v51, -v51, v49
    v_mfma_f32_16x16x32_bf16 a[160:163], v[172:175], v[32:35], a[160:163]
    s_waitcnt lgkmcnt(2)
    v_exp_f32 v18, v110
    v_mfma_f32_16x16x32_bf16 a[20:23], v[160:163], v[40:43], a[20:23]
    s_sub_u32 s3, s29, s28
    ds_read_b128 v[32:35], v1 offset:7168
    v_add_f32 v8, v8, v16
    v_mfma_f32_16x16x32_bf16 a[20:23], v[176:179], v[44:47], a[20:23]
    v_add_f32 v8, v8, v17
    v_cvt_f32_i32 v248, v248
    v_mfma_f32_16x16x32_bf16 a[68:71], v[180:183], v[44:47], a[68:71]
    v_exp_f32 v19, v111
    v_mfma_f32_16x16x32_bf16 a[68:71], v[164:167], v[40:43], a[68:71]
    buffer_load_dwordx4 v4, s[4:7], s27 offen offset:0 sc1 lds
    v_mfma_f32_16x16x32_bf16 a[116:119], v[168:171], v[40:43], a[116:119]
    ds_read_b128 v[36:39], v1 offset:19456
    v_cvt_pk_bf16_f32 v78, v16, v17
    v_mfma_f32_16x16x32_bf16 a[116:119], v[184:187], v[44:47], a[116:119]
    v_add_f32 v8, v8, v18
    v_cvt_f32_i32 v252, v252
    v_mfma_f32_16x16x32_bf16 a[164:167], v[188:191], v[44:47], a[164:167]
    s_mov_b32 s28, s29
    v_add_f32 v8, v8, v19
    v_cvt_pk_bf16_f32 v79, v18, v19
    v_mfma_f32_16x16x32_bf16 a[164:167], v[172:175], v[40:43], a[164:167]
    s_waitcnt lgkmcnt(2)
    v_exp_f32 v16, v80
    v_mfma_f32_16x16x32_bf16 a[24:27], v[160:163], v[24:27], a[24:27]
    ds_read_b128 v[40:43], v1 offset:8192
    v_fma_f32 v248, v248, v48, v50
    v_mfma_f32_16x16x32_bf16 a[24:27], v[176:179], v[28:31], a[24:27]
    v_exp_f32 v17, v81
    v_mfma_f32_16x16x32_bf16 a[72:75], v[180:183], v[28:31], a[72:75]
    v_fma_f32 v252, v252, v49, v51
    v_cvt_f32_i32 v249, v249
    v_mfma_f32_16x16x32_bf16 a[72:75], v[164:167], v[24:27], a[72:75]
    buffer_load_dwordx4 v4, s[4:7], s27 offen offset:1024 sc1 lds
    v_mfma_f32_16x16x32_bf16 a[120:123], v[168:171], v[24:27], a[120:123]
    ds_read_b128 v[44:47], v1 offset:20480
    v_cvt_f32_i32 v253, v253
    v_mfma_f32_16x16x32_bf16 a[120:123], v[184:187], v[28:31], a[120:123]
    v_exp_f32 v18, v82
    v_mfma_f32_16x16x32_bf16 a[168:171], v[188:191], v[28:31], a[168:171]
    v_add_f32 v5, v5, v16
    v_add_f32 v5, v5, v17
    v_mfma_f32_16x16x32_bf16 a[168:171], v[172:175], v[24:27], a[168:171]
    s_waitcnt lgkmcnt(2)
    v_exp_f32 v19, v83
    v_mfma_f32_16x16x32_bf16 a[28:31], v[160:163], v[32:35], a[28:31]
    ds_read_b128 v[24:27], v1 offset:9216
    v_cvt_pk_bf16_f32 v80, v16, v17
    v_mfma_f32_16x16x32_bf16 a[28:31], v[176:179], v[36:39], a[28:31]
    v_exp_f32 v16, v112
    v_mfma_f32_16x16x32_bf16 a[76:79], v[180:183], v[36:39], a[76:79]
    v_add_f32 v5, v5, v18
    v_fma_f32 v249, v249, v48, v50
    v_mfma_f32_16x16x32_bf16 a[76:79], v[164:167], v[32:35], a[76:79]
    v_add_f32 v5, v5, v19
    v_add_u32 v2, s3, v2
    v_mfma_f32_16x16x32_bf16 a[124:127], v[168:171], v[32:35], a[124:127]
    ds_read_b128 v[28:31], v1 offset:21504
    v_fma_f32 v253, v253, v49, v51
    v_mfma_f32_16x16x32_bf16 a[124:127], v[184:187], v[36:39], a[124:127]
    buffer_load_dwordx4 v4, s[4:7], s27 offen offset:2048 sc1 lds
    v_mfma_f32_16x16x32_bf16 a[172:175], v[188:191], v[36:39], a[172:175]
    v_exp_f32 v17, v113
    v_mfma_f32_16x16x32_bf16 a[172:175], v[172:175], v[32:35], a[172:175]
    s_waitcnt lgkmcnt(2)
    v_cvt_pk_bf16_f32 v81, v18, v19
    v_cvt_f32_i32 v250, v250
    v_mfma_f32_16x16x32_bf16 a[32:35], v[160:163], v[40:43], a[32:35]
    ds_read_b128 v[32:35], v1 offset:10240
    v_add_u32 v3, s3, v3
    v_mfma_f32_16x16x32_bf16 a[32:35], v[176:179], v[44:47], a[32:35]
    v_exp_f32 v18, v114
    v_mfma_f32_16x16x32_bf16 a[80:83], v[180:183], v[44:47], a[80:83]
    v_add_f32 v5, v5, v16
    v_add_f32 v5, v5, v17
    v_mfma_f32_16x16x32_bf16 a[80:83], v[164:167], v[40:43], a[80:83]
    v_exp_f32 v19, v115
    v_mfma_f32_16x16x32_bf16 a[128:131], v[168:171], v[40:43], a[128:131]
    ds_read_b128 v[36:39], v1 offset:22528
    v_cvt_pk_bf16_f32 v82, v16, v17
    v_mfma_f32_16x16x32_bf16 a[128:131], v[184:187], v[44:47], a[128:131]
    v_exp_f32 v16, v84
    v_mfma_f32_16x16x32_bf16 a[176:179], v[188:191], v[44:47], a[176:179]
    v_cvt_f32_i32 v254, v254
    v_add_f32 v5, v5, v18
    v_mfma_f32_16x16x32_bf16 a[176:179], v[172:175], v[40:43], a[176:179]
    s_waitcnt lgkmcnt(2)
    v_add_f32 v5, v5, v19
    v_fma_f32 v250, v250, v48, v50
    v_mfma_f32_16x16x32_bf16 a[36:39], v[160:163], v[24:27], a[36:39]
    ds_read_b128 v[40:43], v1 offset:11264
    v_fma_f32 v254, v254, v49, v51
    v_mfma_f32_16x16x32_bf16 a[36:39], v[176:179], v[28:31], a[36:39]
    v_exp_f32 v17, v85
    v_mfma_f32_16x16x32_bf16 a[84:87], v[180:183], v[28:31], a[84:87]
    v_cvt_pk_bf16_f32 v83, v18, v19
    v_cvt_pk_bf16_f32 v146, v240, v244
    v_mfma_f32_16x16x32_bf16 a[84:87], v[164:167], v[24:27], a[84:87]
    s_add_u32 s27, s27, 24576
    v_exp_f32 v18, v86
    v_mfma_f32_16x16x32_bf16 a[132:135], v[168:171], v[24:27], a[132:135]
    s_add_u32 s56, s56, 36864
    ds_read_b128 v[44:47], v1 offset:23552
    v_add_f32 v6, v6, v16
    v_mfma_f32_16x16x32_bf16 a[132:135], v[184:187], v[28:31], a[132:135]
    s_sub_u32 s58, s56, 147456
    v_add_f32 v6, v6, v17
    v_cvt_pk_bf16_f32 v150, v241, v245
    v_mfma_f32_16x16x32_bf16 a[180:183], v[188:191], v[28:31], a[180:183]
    v_exp_f32 v19, v87
    v_mfma_f32_16x16x32_bf16 a[180:183], v[172:175], v[24:27], a[180:183]
    s_waitcnt lgkmcnt(2)
    v_cvt_pk_bf16_f32 v84, v16, v17
    v_cvt_pk_bf16_f32 v147, v248, v252
    v_mfma_f32_16x16x32_bf16 a[40:43], v[160:163], v[32:35], a[40:43]
    s_min_u32 s56, s56, s58
    ds_read_b128 v[24:27], v2 offset:0
    v_mfma_f32_16x16x32_bf16 a[40:43], v[176:179], v[36:39], a[40:43]
    v_exp_f32 v16, v116
    v_mfma_f32_16x16x32_bf16 a[88:91], v[180:183], v[36:39], a[88:91]
    v_add_f32 v6, v6, v18
    v_add_f32 v6, v6, v19
    v_mfma_f32_16x16x32_bf16 a[88:91], v[164:167], v[32:35], a[88:91]
    v_exp_f32 v17, v117
    v_mfma_f32_16x16x32_bf16 a[136:139], v[168:171], v[32:35], a[136:139]
    ds_read_b128 v[28:31], v3 offset:0
    v_cvt_pk_bf16_f32 v151, v249, v253
    v_mfma_f32_16x16x32_bf16 a[136:139], v[184:187], v[36:39], a[136:139]
    v_cvt_pk_bf16_f32 v85, v18, v19
    v_cvt_pk_bf16_f32 v154, v242, v246
    v_mfma_f32_16x16x32_bf16 a[184:187], v[188:191], v[36:39], a[184:187]
    v_exp_f32 v18, v118
    v_mfma_f32_16x16x32_bf16 a[184:187], v[172:175], v[32:35], a[184:187]
    s_waitcnt lgkmcnt(2)
    v_add_f32 v6, v6, v16
    v_mfma_f32_16x16x32_bf16 a[44:47], v[160:163], v[40:43], a[44:47]
    ds_read_b128 v[32:35], v2 offset:6144
    v_add_f32 v6, v6, v17
    v_mfma_f32_16x16x32_bf16 a[44:47], v[176:179], v[44:47], a[44:47]
    v_exp_f32 v19, v119
    v_mfma_f32_16x16x32_bf16 a[92:95], v[180:183], v[44:47], a[92:95]
    v_cvt_pk_bf16_f32 v155, v250, v254
    v_mfma_f32_16x16x32_bf16 a[92:95], v[164:167], v[40:43], a[92:95]
    v_cvt_pk_bf16_f32 v86, v16, v17
    v_mfma_f32_16x16x32_bf16 a[140:143], v[168:171], v[40:43], a[140:143]
    ds_read_b128 v[36:39], v3 offset:6144
    v_add_f32 v6, v6, v18
    v_mfma_f32_16x16x32_bf16 a[140:143], v[184:187], v[44:47], a[140:143]
    v_add_f32 v6, v6, v19
    v_cvt_pk_bf16_f32 v87, v18, v19
    v_mfma_f32_16x16x32_bf16 a[188:191], v[188:191], v[44:47], a[188:191]
    v_mfma_f32_16x16x32_bf16 a[188:191], v[172:175], v[40:43], a[188:191]
    s_waitcnt lgkmcnt(2)
    v_mfma_f32_16x16x32_bf16 v[160:163], v[24:27], a[192:195], v[128:131]
    ds_read_b128 v[40:43], v2 offset:128
    v_mfma_f32_16x16x32_bf16 v[160:163], v[28:31], a[196:199], v[160:163]
    s_waitcnt vmcnt(4)
    v_subrev_u32 v52, s92, v52
    v_cmp_lt_u32 vcc, 15, v52
    v_mfma_f32_16x16x32_bf16 v[164:167], v[28:31], a[220:223], v[132:135]
    v_exp_f32 v16, v88
    v_mfma_f32_16x16x32_bf16 v[164:167], v[24:27], a[216:219], v[164:167]
    v_exp_f32 v17, v89
    v_mfma_f32_16x16x32_bf16 v[168:171], v[24:27], a[240:243], v[136:139]
    s_and_b32 s59, vcc_lo, 0xff
    ds_read_b128 v[44:47], v3 offset:128
    v_mfma_f32_16x16x32_bf16 v[168:171], v[28:31], a[244:247], v[168:171]
    s_cbranch_scc1 L_pollslow3
L_pollok3:
    v_mfma_f32_16x16x32_bf16 v[172:175], v[28:31], v[204:207], v[140:143]
    s_add_u32 s92, s92, 1
    v_exp_f32 v18, v90
    v_mfma_f32_16x16x32_bf16 v[172:175], v[24:27], v[200:203], v[172:175]
    s_waitcnt lgkmcnt(2)
    v_add_f32 v7, v7, v16
    v_add_f32 v7, v7, v17
    v_mfma_f32_16x16x32_bf16 v[96:99], v[32:35], a[192:195], v[128:131]
    ds_read_b128 v[24:27], v2 offset:6272
    v_mfma_f32_16x16x32_bf16 v[96:99], v[36:39], a[196:199], v[96:99]
    buffer_store_dwordx4 v[144:147], v15, s[4:7], s35 offen offset:0 sc1
    v_mfma_f32_16x16x32_bf16 v[100:103], v[36:39], a[220:223], v[132:135]
    v_exp_f32 v19, v91
    v_mfma_f32_16x16x32_bf16 v[100:103], v[32:35], a[216:219], v[100:103]
    v_cvt_pk_bf16_f32 v88, v16, v17
    v_mfma_f32_16x16x32_bf16 v[104:107], v[32:35], a[240:243], v[136:139]
    ds_read_b128 v[28:31], v3 offset:6272
    v_mfma_f32_16x16x32_bf16 v[104:107], v[36:39], a[244:247], v[104:107]
    v_exp_f32 v16, v120
    v_mfma_f32_16x16x32_bf16 v[108:111], v[36:39], v[204:207], v[140:143]
    v_add_f32 v7, v7, v18
    v_add_f32 v7, v7, v19
    v_mfma_f32_16x16x32_bf16 v[108:111], v[32:35], v[200:203], v[108:111]
    s_waitcnt lgkmcnt(2)
    v_exp_f32 v17, v121
    v_mfma_f32_16x16x32_bf16 v[160:163], v[40:43], a[200:203], v[160:163]
    ds_read_b128 v[32:35], v2 offset:256
    v_cvt_pk_bf16_f32 v89, v18, v19
    v_mfma_f32_16x16x32_bf16 v[160:163], v[44:47], a[204:207], v[160:163]
    buffer_store_dwordx4 v[148:151], v15, s[4:7], s35 offen offset:1024 sc1
    v_mfma_f32_16x16x32_bf16 v[164:167], v[44:47], a[228:231], v[164:167]
    v_exp_f32 v18, v122
    v_mfma_f32_16x16x32_bf16 v[164:167], v[40:43], a[224:227], v[164:167]
    v_add_f32 v7, v7, v16
    v_add_f32 v7, v7, v17
    v_mfma_f32_16x16x32_bf16 v[168:171], v[40:43], a[248:251], v[168:171]
    ds_read_b128 v[36:39], v3 offset:256
    v_mfma_f32_16x16x32_bf16 v[168:171], v[44:47], a[252:255], v[168:171]
    v_exp_f32 v19, v123
    v_mfma_f32_16x16x32_bf16 v[172:175], v[44:47], v[212:215], v[172:175]
    v_cvt_pk_bf16_f32 v90, v16, v17
    v_mfma_f32_16x16x32_bf16 v[172:175], v[40:43], v[208:211], v[172:175]
    s_waitcnt lgkmcnt(2)
    v_exp_f32 v16, v92
    v_mfma_f32_16x16x32_bf16 v[96:99], v[24:27], a[200:203], v[96:99]
    ds_read_b128 v[40:43], v2 offset:6400
    v_add_f32 v7, v7, v18
    v_mfma_f32_16x16x32_bf16 v[96:99], v[28:31], a[204:207], v[96:99]
    buffer_store_dwordx4 v[152:155], v15, s[4:7], s35 offen offset:2048 sc1
    v_mfma_f32_16x16x32_bf16 v[100:103], v[28:31], a[228:231], v[100:103]
    v_add_f32 v7, v7, v19
    v_mfma_f32_16x16x32_bf16 v[100:103], v[24:27], a[224:227], v[100:103]
    v_exp_f32 v17, v93
    v_mfma_f32_16x16x32_bf16 v[104:107], v[24:27], a[248:251], v[104:107]
    ds_read_b128 v[44:47], v3 offset:6400
    v_cvt_pk_bf16_f32 v91, v18, v19
    v_mfma_f32_16x16x32_bf16 v[104:107], v[28:31], a[252:255], v[104:107]
    v_exp_f32 v18, v94
    v_mfma_f32_16x16x32_bf16 v[108:111], v[28:31], v[212:215], v[108:111]
    s_add_u32 s29, s30, 49152
    v_add_f32 v8, v8, v16
    v_add_f32 v8, v8, v17
    v_mfma_f32_16x16x32_bf16 v[108:111], v[24:27], v[208:211], v[108:111]
    s_waitcnt lgkmcnt(2)
    v_exp_f32 v19, v95
    v_mfma_f32_16x16x32_bf16 v[160:163], v[32:35], a[208:211], v[160:163]
    s_sub_u32 s3, s29, 147456
    ds_read_b128 v[24:27], v2 offset:12288
    v_cvt_pk_bf16_f32 v92, v16, v17
    v_mfma_f32_16x16x32_bf16 v[160:163], v[36:39], a[212:215], v[160:163]
    s_min_u32 s29, s29, s3
    v_exp_f32 v16, v124
    v_mfma_f32_16x16x32_bf16 v[164:167], v[36:39], a[236:239], v[164:167]
    v_add_f32 v8, v8, v18
    v_add_f32 v8, v8, v19
    v_mfma_f32_16x16x32_bf16 v[164:167], v[32:35], a[232:235], v[164:167]
    v_exp_f32 v17, v125
    v_mfma_f32_16x16x32_bf16 v[168:171], v[32:35], v[192:195], v[168:171]
    ds_read_b128 v[28:31], v3 offset:12288
    v_mfma_f32_16x16x32_bf16 v[168:171], v[36:39], v[196:199], v[168:171]
    v_cvt_pk_bf16_f32 v93, v18, v19
    v_mfma_f32_16x16x32_bf16 v[172:175], v[36:39], v[220:223], v[172:175]
    v_exp_f32 v18, v126
    v_mfma_f32_16x16x32_bf16 v[172:175], v[32:35], v[216:219], v[172:175]
    s_waitcnt lgkmcnt(2)
    v_add_f32 v8, v8, v16
    v_mfma_f32_16x16x32_bf16 v[96:99], v[40:43], a[208:211], v[96:99]
    ds_read_b128 v[32:35], v2 offset:18432
    v_add_f32 v8, v8, v17
    v_mfma_f32_16x16x32_bf16 v[96:99], v[44:47], a[212:215], v[96:99]
    s_mov_b32 m0, s26
    v_exp_f32 v19, v127
    v_mfma_f32_16x16x32_bf16 v[100:103], v[44:47], a[236:239], v[100:103]
    s_sub_u32 s3, s29, s30
    v_mfma_f32_16x16x32_bf16 v[100:103], v[40:43], a[232:235], v[100:103]
    buffer_load_dwordx4 v4, s[4:7], s32 offen offset:0 sc1 lds
    v_mfma_f32_16x16x32_bf16 v[104:107], v[40:43], v[192:195], v[104:107]
    ds_read_b128 v[36:39], v3 offset:18432
    v_cvt_pk_bf16_f32 v94, v16, v17
    v_mfma_f32_16x16x32_bf16 v[104:107], v[44:47], v[196:199], v[104:107]
    v_add_f32 v8, v8, v18
    v_add_f32 v8, v8, v19
    v_mfma_f32_16x16x32_bf16 v[108:111], v[44:47], v[220:223], v[108:111]
    v_cvt_pk_bf16_f32 v95, v18, v19
    v_mfma_f32_16x16x32_bf16 v[108:111], v[40:43], v[216:219], v[108:111]
    s_waitcnt lgkmcnt(2)
    buffer_load_dwordx4 v4, s[4:7], s32 offen offset:1024 sc1 lds
    v_mfma_f32_16x16x32_bf16 v[176:179], v[24:27], a[192:195], v[128:131]
    ds_read_b128 v[40:43], v2 offset:12416
    v_mfma_f32_16x16x32_bf16 v[176:179], v[28:31], a[196:199], v[176:179]
    s_mov_b32 s30, s29
    v_exp_f32 v16, v160
    v_mfma_f32_16x16x32_bf16 v[180:183], v[28:31], a[220:223], v[132:135]
    v_exp_f32 v17, v161
    v_mfma_f32_16x16x32_bf16 v[180:183], v[24:27], a[216:219], v[180:183]
    buffer_load_dwordx4 v4, s[4:7], s32 offen offset:2048 sc1 lds
    v_mfma_f32_16x16x32_bf16 v[184:187], v[24:27], a[240:243], v[136:139]
    s_add_u32 s32, s32, 24576
    ds_read_b128 v[44:47], v3 offset:12416
    v_mfma_f32_16x16x32_bf16 v[184:187], v[28:31], a[244:247], v[184:187]
    v_exp_f32 v18, v162
    v_mfma_f32_16x16x32_bf16 v[188:191], v[28:31], v[204:207], v[140:143]
    s_add_u32 s26, s26, 12288
    v_add_f32 v5, v5, v16
    v_add_f32 v5, v5, v17
    v_mfma_f32_16x16x32_bf16 v[188:191], v[24:27], v[200:203], v[188:191]
    s_waitcnt lgkmcnt(2)
    v_exp_f32 v19, v163
    v_mfma_f32_16x16x32_bf16 v[112:115], v[32:35], a[192:195], v[128:131]
    s_mov_b32 m0, s26
    ds_read_b128 v[24:27], v2 offset:18560
    v_cvt_pk_bf16_f32 v160, v16, v17
    v_mfma_f32_16x16x32_bf16 v[112:115], v[36:39], a[196:199], v[112:115]
L_pg9:
    s_cbranch_execz L_pg13
    v_exp_f32 v16, v96
    v_mfma_f32_16x16x32_bf16 v[116:119], v[36:39], a[220:223], v[132:135]
    v_add_f32 v5, v5, v18
    v_add_f32 v5, v5, v19
    v_mfma_f32_16x16x32_bf16 v[116:119], v[32:35], a[216:219], v[116:119]
    v_exp_f32 v17, v97
    v_mfma_f32_16x16x32_bf16 v[120:123], v[32:35], a[240:243], v[136:139]
    ds_read_b128 v[28:31], v3 offset:18560
    v_add_u32 v1, s3, v1
    v_mfma_f32_16x16x32_bf16 v[120:123], v[36:39], a[244:247], v[120:123]
    buffer_load_dwordx4 v4, s[4:7], s32 offen offset:0 sc1 lds
    v_mfma_f32_16x16x32_bf16 v[124:127], v[36:39], v[204:207], v[140:143]
    v_cvt_pk_bf16_f32 v161, v18, v19
    v_mfma_f32_16x16x32_bf16 v[124:127], v[32:35], v[200:203], v[124:127]
    s_waitcnt lgkmcnt(2)
    v_exp_f32 v18, v98
    v_mfma_f32_16x16x32_bf16 v[176:179], v[40:43], a[200:203], v[176:179]
    ds_read_b128 v[32:35], v2 offset:12544
    v_add_f32 v5, v5, v16
    v_mfma_f32_16x16x32_bf16 v[176:179], v[44:47], a[204:207], v[176:179]
    buffer_load_dwordx4 v4, s[4:7], s32 offen offset:1024 sc1 lds
    v_mfma_f32_16x16x32_bf16 v[180:183], v[44:47], a[228:231], v[180:183]
    v_add_f32 v5, v5, v17
    v_mfma_f32_16x16x32_bf16 v[180:183], v[40:43], a[224:227], v[180:183]
    v_exp_f32 v19, v99
    v_mfma_f32_16x16x32_bf16 v[184:187], v[40:43], a[248:251], v[184:187]
    ds_read_b128 v[36:39], v3 offset:12544
    v_cvt_pk_bf16_f32 v162, v16, v17
    v_mfma_f32_16x16x32_bf16 v[184:187], v[44:47], a[252:255], v[184:187]
    buffer_load_dwordx4 v4, s[4:7], s32 offen offset:2048 sc1 lds
    v_mfma_f32_16x16x32_bf16 v[188:191], v[44:47], v[212:215], v[188:191]
    v_exp_f32 v16, v164
    v_mfma_f32_16x16x32_bf16 v[188:191], v[40:43], v[208:211], v[188:191]
    s_waitcnt lgkmcnt(2)
    v_add_f32 v5, v5, v18
    v_add_f32 v5, v5, v19
    v_mfma_f32_16x16x32_bf16 v[112:115], v[24:27], a[200:203], v[112:115]
    ds_read_b128 v[40:43], v2 offset:18688
    v_mfma_f32_16x16x32_bf16 v[112:115], v[28:31], a[204:207], v[112:115]
    v_exp_f32 v17, v165
    v_mfma_f32_16x16x32_bf16 v[116:119], v[28:31], a[228:231], v[116:119]
    v_cvt_pk_bf16_f32 v163, v18, v19
    v_mfma_f32_16x16x32_bf16 v[116:119], v[24:27], a[224:227], v[116:119]
    s_add_u32 s32, s32, 24576
    v_exp_f32 v18, v166
    v_mfma_f32_16x16x32_bf16 v[120:123], v[24:27], a[248:251], v[120:123]
    s_add_u32 s26, s26, 36864
    ds_read_b128 v[44:47], v3 offset:18688
    v_add_f32 v6, v6, v16
    v_mfma_f32_16x16x32_bf16 v[120:123], v[28:31], a[252:255], v[120:123]
    s_waitcnt lgkmcnt(2)
    v_add_f32 v6, v6, v17
    s_sub_u32 s57, s26, 147456
    v_mfma_f32_16x16x32_bf16 v[124:127], v[28:31], v[212:215], v[124:127]
    s_waitcnt vmcnt(6)
    v_exp_f32 v19, v167
    v_mfma_f32_16x16x32_bf16 v[124:127], v[24:27], v[208:211], v[124:127]
    s_barrier
    v_mfma_f32_16x16x32_bf16 v[176:179], v[32:35], a[208:211], v[176:179]
    s_min_u32 s26, s26, s57
    ds_read_b128 v[24:27], v1 offset:0
    v_cvt_pk_bf16_f32 v164, v16, v17
    v_mfma_f32_16x16x32_bf16 v[176:179], v[36:39], a[212:215], v[176:179]
    v_exp_f32 v16, v100
    v_mfma_f32_16x16x32_bf16 v[180:183], v[36:39], a[236:239], v[180:183]
    v_add_u32 v0, 1, v0
    v_add_f32 v6, v6, v18
    v_mfma_f32_16x16x32_bf16 v[180:183], v[32:35], a[232:235], v[180:183]
    buffer_store_dword v0, v13, s[20:23], 0 offen offset:32 sc1
    v_mfma_f32_16x16x32_bf16 v[184:187], v[32:35], v[192:195], v[184:187]
    ds_read_b128 v[28:31], v1 offset:12288
    v_add_f32 v6, v6, v19
    v_mfma_f32_16x16x32_bf16 v[184:187], v[36:39], v[196:199], v[184:187]
    v_exp_f32 v17, v101
    v_mfma_f32_16x16x32_bf16 v[188:191], v[36:39], v[220:223], v[188:191]
    v_cvt_pk_bf16_f32 v165, v18, v19
    v_mfma_f32_16x16x32_bf16 v[188:191], v[32:35], v[216:219], v[188:191]
    s_waitcnt lgkmcnt(2)
    v_exp_f32 v18, v102
    v_mfma_f32_16x16x32_bf16 v[112:115], v[40:43], a[208:211], v[112:115]
    ds_read_b128 v[32:35], v1 offset:1024
    v_add_f32 v6, v6, v16
    v_mfma_f32_16x16x32_bf16 v[112:115], v[44:47], a[212:215], v[112:115]
    v_add_f32 v6, v6, v17
    v_mfma_f32_16x16x32_bf16 v[116:119], v[44:47], a[236:239], v[116:119]
    v_exp_f32 v19, v103
    v_mfma_f32_16x16x32_bf16 v[116:119], v[40:43], a[232:235], v[116:119]
    v_cvt_pk_bf16_f32 v166, v16, v17
    v_mfma_f32_16x16x32_bf16 v[120:123], v[40:43], v[192:195], v[120:123]
    ds_read_b128 v[36:39], v1 offset:13312
    v_add_f32 v6, v6, v18
    v_mfma_f32_16x16x32_bf16 v[120:123], v[44:47], v[196:199], v[120:123]
    v_add_f32 v6, v6, v19
    v_cvt_pk_bf16_f32 v167, v18, v19
    v_mfma_f32_16x16x32_bf16 v[124:127], v[44:47], v[220:223], v[124:127]
    v_mfma_f32_16x16x32_bf16 v[124:127], v[40:43], v[216:219], v[124:127]
    s_waitcnt lgkmcnt(2)
    v_mfma_f32_16x16x32_bf16 a[0:3], v[64:67], v[24:27], a[0:3]
    s_mov_b32 m0, s26
    ds_read_b128 v[40:43], v1 offset:2048
    v_mfma_f32_16x16x32_bf16 a[0:3], v[80:83], v[28:31], a[0:3]
    buffer_load_dwordx4 v4, s[4:7], s32 offen offset:0 sc1 lds
    v_mfma_f32_16x16x32_bf16 a[48:51], v[84:87], v[28:31], a[48:51]
    v_exp_f32 v16, v168
    v_mfma_f32_16x16x32_bf16 a[48:51], v[68:71], v[24:27], a[48:51]
    v_exp_f32 v17, v169
    v_mfma_f32_16x16x32_bf16 a[96:99], v[72:75], v[24:27], a[96:99]
    ds_read_b128 v[44:47], v1 offset:14336
    v_mfma_f32_16x16x32_bf16 a[96:99], v[88:91], v[28:31], a[96:99]
    v_exp_f32 v18, v170
    v_mfma_f32_16x16x32_bf16 a[144:147], v[92:95], v[28:31], a[144:147]
    v_add_f32 v7, v7, v16
    v_add_f32 v7, v7, v17
    v_mfma_f32_16x16x32_bf16 a[144:147], v[76:79], v[24:27], a[144:147]
    s_waitcnt lgkmcnt(2)
    v_exp_f32 v19, v171
    v_mfma_f32_16x16x32_bf16 a[4:7], v[64:67], v[32:35], a[4:7]
    ds_read_b128 v[24:27], v1 offset:3072
    v_cvt_pk_bf16_f32 v168, v16, v17
    v_mfma_f32_16x16x32_bf16 a[4:7], v[80:83], v[36:39], a[4:7]
    v_exp_f32 v16, v104
    v_mfma_f32_16x16x32_bf16 a[52:55], v[84:87], v[36:39], a[52:55]
    v_add_f32 v7, v7, v18
    v_add_f32 v7, v7, v19
    v_mfma_f32_16x16x32_bf16 a[52:55], v[68:71], v[32:35], a[52:55]
    buffer_load_dwordx4 v4, s[4:7], s32 offen offset:1024 sc1 lds
    v_mfma_f32_16x16x32_bf16 a[100:103], v[72:75], v[32:35], a[100:103]
    ds_read_b128 v[28:31], v1 offset:15360
    v_mfma_f32_16x16x32_bf16 a[100:103], v[88:91], v[36:39], a[100:103]
    v_exp_f32 v17, v105
    v_mfma_f32_16x16x32_bf16 a[148:151], v[92:95], v[36:39], a[148:151]
    v_cvt_pk_bf16_f32 v169, v18, v19
    v_mfma_f32_16x16x32_bf16 a[148:151], v[76:79], v[32:35], a[148:151]
    s_waitcnt lgkmcnt(2)
    v_exp_f32 v18, v106
    v_mfma_f32_16x16x32_bf16 a[8:11], v[64:67], v[40:43], a[8:11]
    ds_read_b128 v[32:35], v1 offset:4096
    v_add_f32 v7, v7, v16
    v_mfma_f32_16x16x32_bf16 a[8:11], v[80:83], v[44:47], a[8:11]
    v_add_f32 v7, v7, v17
    v_mfma_f32_16x16x32_bf16 a[56:59], v[84:87], v[44:47], a[56:59]
    v_exp_f32 v19, v107
    v_mfma_f32_16x16x32_bf16 a[56:59], v[68:71], v[40:43], a[56:59]
    v_cvt_pk_bf16_f32 v170, v16, v17
    v_mfma_f32_16x16x32_bf16 a[104:107], v[72:75], v[40:43], a[104:107]
    ds_read_b128 v[36:39], v1 offset:16384
    v_mfma_f32_16x16x32_bf16 a[104:107], v[88:91], v[44:47], a[104:107]
    v_exp_f32 v16, v172
    v_mfma_f32_16x16x32_bf16 a[152:155], v[92:95], v[44:47], a[152:155]
    v_add_f32 v7, v7, v18
    v_add_f32 v7, v7, v19
    v_mfma_f32_16x16x32_bf16 a[152:155], v[76:79], v[40:43], a[152:155]
    s_waitcnt lgkmcnt(2)
    buffer_load_dwordx4 v4, s[4:7], s32 offen offset:2048 sc1 lds
    v_mfma_f32_16x16x32_bf16 a[12:15], v[64:67], v[24:27], a[12:15]
    ds_read_b128 v[40:43], v1 offset:5120
    v_mfma_f32_16x16x32_bf16 a[12:15], v[80:83], v[28:31], a[12:15]
    v_exp_f32 v17, v173
    v_mfma_f32_16x16x32_bf16 a[60:63], v[84:87], v[28:31], a[60:63]
    v_cvt_pk_bf16_f32 v171, v18, v19
    v_mfma_f32_16x16x32_bf16 a[60:63], v[68:71], v[24:27], a[60:63]
    v_exp_f32 v18, v174
    v_mfma_f32_16x16x32_bf16 a[108:111], v[72:75], v[24:27], a[108:111]
    ds_read_b128 v[44:47], v1 offset:17408
    v_add_f32 v8, v8, v16
    v_mfma_f32_16x16x32_bf16 a[108:111], v[88:91], v[28:31], a[108:111]
    v_add_f32 v8, v8, v17
    v_mfma_f32_16x16x32_bf16 a[156:159], v[92:95], v[28:31], a[156:159]
    s_add_u32 s29, s28, 49152
    v_exp_f32 v19, v175
    v_mfma_f32_16x16x32_bf16 a[156:159], v[76:79], v[24:27], a[156:159]
    s_waitcnt lgkmcnt(2)
    v_cvt_pk_bf16_f32 v172, v16, v17
    s_sub_u32 s3, s29, 147456
    v_mfma_f32_16x16x32_bf16 a[16:19], v[64:67], v[32:35], a[16:19]
    s_add_u32 s32, s32, 24576
    ds_read_b128 v[24:27], v1 offset:6144
    v_mfma_f32_16x16x32_bf16 a[16:19], v[80:83], v[36:39], a[16:19]
    s_min_u32 s29, s29, s3
    v_exp_f32 v16, v108
    v_mfma_f32_16x16x32_bf16 a[64:67], v[84:87], v[36:39], a[64:67]
    v_add_f32 v8, v8, v18
    v_add_f32 v8, v8, v19
    v_mfma_f32_16x16x32_bf16 a[64:67], v[68:71], v[32:35], a[64:67]
    v_exp_f32 v17, v109
    v_mfma_f32_16x16x32_bf16 a[112:115], v[72:75], v[32:35], a[112:115]
    s_add_u32 s26, s26, 12288
    ds_read_b128 v[28:31], v1 offset:18432
    v_mfma_f32_16x16x32_bf16 a[112:115], v[88:91], v[36:39], a[112:115]
    v_cvt_pk_bf16_f32 v173, v18, v19
    v_mfma_f32_16x16x32_bf16 a[160:163], v[92:95], v[36:39], a[160:163]
    v_exp_f32 v18, v110
    v_mfma_f32_16x16x32_bf16 a[160:163], v[76:79], v[32:35], a[160:163]
    s_waitcnt lgkmcnt(2)
    v_add_f32 v8, v8, v16
    v_mfma_f32_16x16x32_bf16 a[20:23], v[64:67], v[40:43], a[20:23]
    s_sub_u32 s3, s29, s28
    ds_read_b128 v[32:35], v1 offset:7168
    v_add_f32 v8, v8, v17
    v_mfma_f32_16x16x32_bf16 a[20:23], v[80:83], v[44:47], a[20:23]
    v_exp_f32 v19, v111
    v_mfma_f32_16x16x32_bf16 a[68:71], v[84:87], v[44:47], a[68:71]
    s_mov_b32 m0, s26
    v_mfma_f32_16x16x32_bf16 a[68:71], v[68:71], v[40:43], a[68:71]
    v_cvt_pk_bf16_f32 v174, v16, v17
    v_mfma_f32_16x16x32_bf16 a[116:119], v[72:75], v[40:43], a[116:119]
    ds_read_b128 v[36:39], v1 offset:19456
    v_add_f32 v8, v8, v18
    v_mfma_f32_16x16x32_bf16 a[116:119], v[88:91], v[44:47], a[116:119]
    v_add_f32 v8, v8, v19
    v_cvt_pk_bf16_f32 v175, v18, v19
    v_mfma_f32_16x16x32_bf16 a[164:167], v[92:95], v[44:47], a[164:167]
    s_mov_b32 s28, s29
    v_mfma_f32_16x16x32_bf16 a[164:167], v[76:79], v[40:43], a[164:167]
    s_waitcnt lgkmcnt(2)
    v_exp_f32 v16, v176
    v_mfma_f32_16x16x32_bf16 a[24:27], v[64:67], v[24:27], a[24:27]
    ds_read_b128 v[40:43], v1 offset:8192
    v_mfma_f32_16x16x32_bf16 a[24:27], v[80:83], v[28:31], a[24:27]
    v_exp_f32 v17, v177
    v_mfma_f32_16x16x32_bf16 a[72:75], v[84:87], v[28:31], a[72:75]
    v_exp_f32 v18, v178
    v_mfma_f32_16x16x32_bf16 a[72:75], v[68:71], v[24:27], a[72:75]
    buffer_load_dwordx4 v4, s[4:7], s32 offen offset:0 sc1 lds
    v_mfma_f32_16x16x32_bf16 a[120:123], v[72:75], v[24:27], a[120:123]
    ds_read_b128 v[44:47], v1 offset:20480
    v_add_f32 v5, v5, v16
    v_mfma_f32_16x16x32_bf16 a[120:123], v[88:91], v[28:31], a[120:123]
    v_add_f32 v5, v5, v17
    v_add_u32 v2, s3, v2
    v_mfma_f32_16x16x32_bf16 a[168:171], v[92:95], v[28:31], a[168:171]
    v_exp_f32 v19, v179
    v_mfma_f32_16x16x32_bf16 a[168:171], v[76:79], v[24:27], a[168:171]
    s_waitcnt lgkmcnt(2)
    v_cvt_pk_bf16_f32 v176, v16, v17
    v_mfma_f32_16x16x32_bf16 a[28:31], v[64:67], v[32:35], a[28:31]
    ds_read_b128 v[24:27], v1 offset:9216
    v_mfma_f32_16x16x32_bf16 a[28:31], v[80:83], v[36:39], a[28:31]
    v_exp_f32 v16, v112
    v_mfma_f32_16x16x32_bf16 a[76:79], v[84:87], v[36:39], a[76:79]
    v_add_f32 v5, v5, v18
    v_add_f32 v5, v5, v19
    v_mfma_f32_16x16x32_bf16 a[76:79], v[68:71], v[32:35], a[76:79]
    v_exp_f32 v17, v113
    v_mfma_f32_16x16x32_bf16 a[124:127], v[72:75], v[32:35], a[124:127]
    ds_read_b128 v[28:31], v1 offset:21504
    v_add_u32 v3, s3, v3
    v_mfma_f32_16x16x32_bf16 a[124:127], v[88:91], v[36:39], a[124:127]
    v_cvt_pk_bf16_f32 v177, v18, v19
    v_mfma_f32_16x16x32_bf16 a[172:175], v[92:95], v[36:39], a[172:175]
    v_exp_f32 v18, v114
    v_mfma_f32_16x16x32_bf16 a[172:175], v[76:79], v[32:35], a[172:175]
    s_waitcnt lgkmcnt(2)
    buffer_load_dwordx4 v4, s[4:7], s32 offen offset:1024 sc1 lds
    v_mfma_f32_16x16x32_bf16 a[32:35], v[64:67], v[40:43], a[32:35]
    ds_read_b128 v[32:35], v1 offset:10240
    v_add_f32 v5, v5, v16
    v_mfma_f32_16x16x32_bf16 a[32:35], v[80:83], v[44:47], a[32:35]
    v_add_f32 v5, v5, v17
    v_mfma_f32_16x16x32_bf16 a[80:83], v[84:87], v[44:47], a[80:83]
    v_exp_f32 v19, v115
    v_mfma_f32_16x16x32_bf16 a[80:83], v[68:71], v[40:43], a[80:83]
    v_cvt_pk_bf16_f32 v178, v16, v17
    v_mfma_f32_16x16x32_bf16 a[128:131], v[72:75], v[40:43], a[128:131]
    ds_read_b128 v[36:39], v1 offset:22528
    v_mfma_f32_16x16x32_bf16 a[128:131], v[88:91], v[44:47], a[128:131]
    v_exp_f32 v16, v180
    v_mfma_f32_16x16x32_bf16 a[176:179], v[92:95], v[44:47], a[176:179]
    v_add_f32 v5, v5, v18
    v_add_f32 v5, v5, v19
    v_mfma_f32_16x16x32_bf16 a[176:179], v[76:79], v[40:43], a[176:179]
    s_waitcnt lgkmcnt(2)
    v_exp_f32 v17, v181
    v_mfma_f32_16x16x32_bf16 a[36:39], v[64:67], v[24:27], a[36:39]
    ds_read_b128 v[40:43], v1 offset:11264
    v_mfma_f32_16x16x32_bf16 a[36:39], v[80:83], v[28:31], a[36:39]
    buffer_load_dwordx4 v4, s[4:7], s32 offen offset:2048 sc1 lds
    v_mfma_f32_16x16x32_bf16 a[84:87], v[84:87], v[28:31], a[84:87]
    v_cvt_pk_bf16_f32 v179, v18, v19
    v_mfma_f32_16x16x32_bf16 a[84:87], v[68:71], v[24:27], a[84:87]
    v_exp_f32 v18, v182
    v_mfma_f32_16x16x32_bf16 a[132:135], v[72:75], v[24:27], a[132:135]
    ds_read_b128 v[44:47], v1 offset:23552
    v_add_f32 v6, v6, v16
    v_mfma_f32_16x16x32_bf16 a[132:135], v[88:91], v[28:31], a[132:135]
    s_waitcnt lgkmcnt(2)
    v_add_f32 v6, v6, v17
    v_mfma_f32_16x16x32_bf16 a[180:183], v[92:95], v[28:31], a[180:183]
    s_waitcnt vmcnt(7)
    v_exp_f32 v19, v183
    v_mfma_f32_16x16x32_bf16 a[180:183], v[76:79], v[24:27], a[180:183]
    s_barrier
    v_mfma_f32_16x16x32_bf16 a[40:43], v[64:67], v[32:35], a[40:43]
    ds_read_b128 v[24:27], v2 offset:0
    v_cvt_pk_bf16_f32 v180, v16, v17
    v_mfma_f32_16x16x32_bf16 a[40:43], v[80:83], v[36:39], a[40:43]
    v_exp_f32 v16, v116
    v_mfma_f32_16x16x32_bf16 a[88:91], v[84:87], v[36:39], a[88:91]
    v_add_f32 v6, v6, v18
    v_add_f32 v6, v6, v19
    v_mfma_f32_16x16x32_bf16 a[88:91], v[68:71], v[32:35], a[88:91]
    v_exp_f32 v17, v117
    v_mfma_f32_16x16x32_bf16 a[136:139], v[72:75], v[32:35], a[136:139]
    ds_read_b128 v[28:31], v3 offset:0
    v_mfma_f32_16x16x32_bf16 a[136:139], v[88:91], v[36:39], a[136:139]
    v_cvt_pk_bf16_f32 v181, v18, v19
    v_mfma_f32_16x16x32_bf16 a[184:187], v[92:95], v[36:39], a[184:187]
    v_exp_f32 v18, v118
    v_mfma_f32_16x16x32_bf16 a[184:187], v[76:79], v[32:35], a[184:187]
    s_waitcnt lgkmcnt(2)
    v_add_f32 v6, v6, v16
    v_mfma_f32_16x16x32_bf16 a[44:47], v[64:67], v[40:43], a[44:47]
    ds_read_b128 v[32:35], v2 offset:6144
    v_add_f32 v6, v6, v17
    v_mfma_f32_16x16x32_bf16 a[44:47], v[80:83], v[44:47], a[44:47]
    v_exp_f32 v19, v119
    v_mfma_f32_16x16x32_bf16 a[92:95], v[84:87], v[44:47], a[92:95]
    v_mfma_f32_16x16x32_bf16 a[92:95], v[68:71], v[40:43], a[92:95]
    s_add_u32 s32, s32, 24576
    s_add_u32 s26, s26, 36864
    v_cvt_pk_bf16_f32 v182, v16, v17
    v_mfma_f32_16x16x32_bf16 a[140:143], v[72:75], v[40:43], a[140:143]
    s_sub_u32 s57, s26, 147456
    ds_read_b128 v[36:39], v3 offset:6144
    v_add_f32 v6, v6, v18
    v_mfma_f32_16x16x32_bf16 a[140:143], v[88:91], v[44:47], a[140:143]
    s_min_u32 s26, s26, s57
    v_add_f32 v6, v6, v19
    v_cvt_pk_bf16_f32 v183, v18, v19
    v_mfma_f32_16x16x32_bf16 a[188:191], v[92:95], v[44:47], a[188:191]
    v_mfma_f32_16x16x32_bf16 a[188:191], v[76:79], v[40:43], a[188:191]
    s_waitcnt lgkmcnt(2)
    v_mfma_f32_16x16x32_bf16 v[64:67], v[24:27], a[192:195], v[128:131]
    ds_read_b128 v[40:43], v2 offset:128
    v_mfma_f32_16x16x32_bf16 v[64:67], v[28:31], a[196:199], v[64:67]
    v_exp_f32 v16, v184
    v_mfma_f32_16x16x32_bf16 v[68:71], v[28:31], a[220:223], v[132:135]
    v_exp_f32 v17, v185
    v_mfma_f32_16x16x32_bf16 v[68:71], v[24:27], a[216:219], v[68:71]
    buffer_load_dword v52, v20, s[20:23], s44 offen sc1
    v_mfma_f32_16x16x32_bf16 v[72:75], v[24:27], a[240:243], v[136:139]
    ds_read_b128 v[44:47], v3 offset:128
    v_mfma_f32_16x16x32_bf16 v[72:75], v[28:31], a[244:247], v[72:75]
    v_exp_f32 v18, v186
    v_mfma_f32_16x16x32_bf16 v[76:79], v[28:31], v[204:207], v[140:143]
    v_add_f32 v7, v7, v16
    v_add_f32 v7, v7, v17
    v_mfma_f32_16x16x32_bf16 v[76:79], v[24:27], v[200:203], v[76:79]
    s_waitcnt lgkmcnt(2)
    v_exp_f32 v19, v187
    v_mfma_f32_16x16x32_bf16 v[96:99], v[32:35], a[192:195], v[128:131]
    ds_read_b128 v[24:27], v2 offset:6272
    v_cvt_pk_bf16_f32 v184, v16, v17
    v_mfma_f32_16x16x32_bf16 v[96:99], v[36:39], a[196:199], v[96:99]
    v_exp_f32 v16, v120
    v_mfma_f32_16x16x32_bf16 v[100:103], v[36:39], a[220:223], v[132:135]
    v_add_f32 v7, v7, v18
    v_add_f32 v7, v7, v19
    v_mfma_f32_16x16x32_bf16 v[100:103], v[32:35], a[216:219], v[100:103]
    s_mov_b32 m0, s26
    v_exp_f32 v17, v121
    v_mfma_f32_16x16x32_bf16 v[104:107], v[32:35], a[240:243], v[136:139]
    ds_read_b128 v[28:31], v3 offset:6272
    v_mfma_f32_16x16x32_bf16 v[104:107], v[36:39], a[244:247], v[104:107]
    buffer_load_dwordx4 v4, s[4:7], s32 offen offset:0 sc1 lds
    v_mfma_f32_16x16x32_bf16 v[108:111], v[36:39], v[204:207], v[140:143]
    v_cvt_pk_bf16_f32 v185, v18, v19
    v_mfma_f32_16x16x32_bf16 v[108:111], v[32:35], v[200:203], v[108:111]
    s_waitcnt lgkmcnt(2)
    v_exp_f32 v18, v122
    v_mfma_f32_16x16x32_bf16 v[64:67], v[40:43], a[200:203], v[64:67]
    ds_read_b128 v[32:35], v2 offset:256
    v_add_f32 v7, v7, v16
    v_mfma_f32_16x16x32_bf16 v[64:67], v[44:47], a[204:207], v[64:67]
    v_add_f32 v7, v7, v17
    v_mfma_f32_16x16x32_bf16 v[68:71], v[44:47], a[228:231], v[68:71]
    v_exp_f32 v19, v123
    v_mfma_f32_16x16x32_bf16 v[68:71], v[40:43], a[224:227], v[68:71]
    v_cvt_pk_bf16_f32 v186, v16, v17
    v_mfma_f32_16x16x32_bf16 v[72:75], v[40:43], a[248:251], v[72:75]
    ds_read_b128 v[36:39], v3 offset:256
    v_mfma_f32_16x16x32_bf16 v[72:75], v[44:47], a[252:255], v[72:75]
    buffer_load_dwordx4 v4, s[4:7], s32 offen offset:1024 sc1 lds
    v_mfma_f32_16x16x32_bf16 v[76:79], v[44:47], v[212:215], v[76:79]
    v_exp_f32 v16, v188
    v_mfma_f32_16x16x32_bf16 v[76:79], v[40:43], v[208:211], v[76:79]
    s_waitcnt lgkmcnt(2)
    v_add_f32 v7, v7, v18
    v_add_f32 v7, v7, v19
    v_mfma_f32_16x16x32_bf16 v[96:99], v[24:27], a[200:203], v[96:99]
    ds_read_b128 v[40:43], v2 offset:6400
    v_mfma_f32_16x16x32_bf16 v[96:99], v[28:31], a[204:207], v[96:99]
    v_exp_f32 v17, v189
    v_mfma_f32_16x16x32_bf16 v[100:103], v[28:31], a[228:231], v[100:103]
    v_cvt_pk_bf16_f32 v187, v18, v19
    v_mfma_f32_16x16x32_bf16 v[100:103], v[24:27], a[224:227], v[100:103]
    v_exp_f32 v18, v190
    v_mfma_f32_16x16x32_bf16 v[104:107], v[24:27], a[248:251], v[104:107]
    ds_read_b128 v[44:47], v3 offset:6400
    v_add_f32 v8, v8, v16
    v_mfma_f32_16x16x32_bf16 v[104:107], v[28:31], a[252:255], v[104:107]
    v_add_f32 v8, v8, v17
    v_mfma_f32_16x16x32_bf16 v[108:111], v[28:31], v[212:215], v[108:111]
    s_add_u32 s29, s30, 49152
    v_exp_f32 v19, v191
    v_mfma_f32_16x16x32_bf16 v[108:111], v[24:27], v[208:211], v[108:111]
    s_waitcnt lgkmcnt(2)
    buffer_load_dwordx4 v4, s[4:7], s32 offen offset:2048 sc1 lds
    v_mfma_f32_16x16x32_bf16 v[64:67], v[32:35], a[208:211], v[64:67]
    s_sub_u32 s3, s29, 147456
    ds_read_b128 v[24:27], v2 offset:12288
    v_cvt_pk_bf16_f32 v188, v16, v17
    v_mfma_f32_16x16x32_bf16 v[64:67], v[36:39], a[212:215], v[64:67]
    s_min_u32 s29, s29, s3
    v_exp_f32 v16, v124
    v_mfma_f32_16x16x32_bf16 v[68:71], v[36:39], a[236:239], v[68:71]
    v_add_f32 v8, v8, v18
    v_add_f32 v8, v8, v19
    v_mfma_f32_16x16x32_bf16 v[68:71], v[32:35], a[232:235], v[68:71]
    v_exp_f32 v17, v125
    v_mfma_f32_16x16x32_bf16 v[72:75], v[32:35], v[192:195], v[72:75]
    ds_read_b128 v[28:31], v3 offset:12288
    v_mfma_f32_16x16x32_bf16 v[72:75], v[36:39], v[196:199], v[72:75]
    v_cvt_pk_bf16_f32 v189, v18, v19
    v_mfma_f32_16x16x32_bf16 v[76:79], v[36:39], v[220:223], v[76:79]
    v_exp_f32 v18, v126
    v_mfma_f32_16x16x32_bf16 v[76:79], v[32:35], v[216:219], v[76:79]
    s_waitcnt lgkmcnt(2)
    v_add_f32 v8, v8, v16
    s_add_u32 s32, s32, 24576
    v_mfma_f32_16x16x32_bf16 v[96:99], v[40:43], a[208:211], v[96:99]
    ds_read_b128 v[32:35], v2 offset:18432
    v_add_f32 v8, v8, v17
    v_mfma_f32_16x16x32_bf16 v[96:99], v[44:47], a[212:215], v[96:99]
    s_sub_u32 s3, s29, s30
    v_exp_f32 v19, v127
    v_mfma_f32_16x16x32_bf16 v[100:103], v[44:47], a[236:239], v[100:103]
    v_mfma_f32_16x16x32_bf16 v[100:103], v[40:43], a[232:235], v[100:103]
    v_cvt_pk_bf16_f32 v190, v16, v17
    v_mfma_f32_16x16x32_bf16 v[104:107], v[40:43], v[192:195], v[104:107]
    s_add_u32 s26, s26, 12288
    ds_read_b128 v[36:39], v3 offset:18432
    v_add_f32 v8, v8, v18
    v_mfma_f32_16x16x32_bf16 v[104:107], v[44:47], v[196:199], v[104:107]
    v_add_f32 v8, v8, v19
    v_cvt_pk_bf16_f32 v191, v18, v19
    v_mfma_f32_16x16x32_bf16 v[108:111], v[44:47], v[220:223], v[108:111]
    v_mfma_f32_16x16x32_bf16 v[108:111], v[40:43], v[216:219], v[108:111]
    s_waitcnt lgkmcnt(2)
    v_exp_f32 v16, v64
    v_mfma_f32_16x16x32_bf16 v[80:83], v[24:27], a[192:195], v[128:131]
    ds_read_b128 v[40:43], v2 offset:12416
    v_mfma_f32_16x16x32_bf16 v[80:83], v[28:31], a[196:199], v[80:83]
    s_mov_b32 m0, s26
    v_exp_f32 v17, v65
    v_mfma_f32_16x16x32_bf16 v[84:87], v[28:31], a[220:223], v[132:135]
    s_mov_b32 s30, s29
    v_exp_f32 v18, v66
    v_mfma_f32_16x16x32_bf16 v[84:87], v[24:27], a[216:219], v[84:87]
    v_add_f32 v5, v5, v16
    v_mfma_f32_16x16x32_bf16 v[88:91], v[24:27], a[240:243], v[136:139]
    ds_read_b128 v[44:47], v3 offset:12416
    v_add_f32 v5, v5, v17
    v_mfma_f32_16x16x32_bf16 v[88:91], v[28:31], a[244:247], v[88:91]
    v_exp_f32 v19, v67
    v_mfma_f32_16x16x32_bf16 v[92:95], v[28:31], v[204:207], v[140:143]
    v_mfma_f32_16x16x32_bf16 v[92:95], v[24:27], v[200:203], v[92:95]
    s_waitcnt lgkmcnt(2)
    v_cvt_pk_bf16_f32 v64, v16, v17
    v_mfma_f32_16x16x32_bf16 v[112:115], v[32:35], a[192:195], v[128:131]
    ds_read_b128 v[24:27], v2 offset:18560
    v_mfma_f32_16x16x32_bf16 v[112:115], v[36:39], a[196:199], v[112:115]
    buffer_load_dwordx4 v4, s[4:7], s32 offen offset:0 sc1 lds
    v_mfma_f32_16x16x32_bf16 v[116:119], v[36:39], a[220:223], v[132:135]
    v_exp_f32 v16, v96
    v_mfma_f32_16x16x32_bf16 v[116:119], v[32:35], a[216:219], v[116:119]
    v_add_f32 v5, v5, v18
    v_add_f32 v5, v5, v19
    v_mfma_f32_16x16x32_bf16 v[120:123], v[32:35], a[240:243], v[136:139]
    ds_read_b128 v[28:31], v3 offset:18560
    v_add_u32 v1, s3, v1
    v_mfma_f32_16x16x32_bf16 v[120:123], v[36:39], a[244:247], v[120:123]
    v_exp_f32 v17, v97
    v_mfma_f32_16x16x32_bf16 v[124:127], v[36:39], v[204:207], v[140:143]
    v_cvt_pk_bf16_f32 v65, v18, v19
    v_mfma_f32_16x16x32_bf16 v[124:127], v[32:35], v[200:203], v[124:127]
    s_waitcnt lgkmcnt(2)
    v_exp_f32 v18, v98
    v_mfma_f32_16x16x32_bf16 v[80:83], v[40:43], a[200:203], v[80:83]
    ds_read_b128 v[32:35], v2 offset:12544
    v_add_f32 v5, v5, v16
    v_mfma_f32_16x16x32_bf16 v[80:83], v[44:47], a[204:207], v[80:83]
    v_add_f32 v5, v5, v17
    v_mfma_f32_16x16x32_bf16 v[84:87], v[44:47], a[228:231], v[84:87]
    v_exp_f32 v19, v99
    v_mfma_f32_16x16x32_bf16 v[84:87], v[40:43], a[224:227], v[84:87]
    buffer_load_dwordx4 v4, s[4:7], s32 offen offset:1024 sc1 lds
    v_mfma_f32_16x16x32_bf16 v[88:91], v[40:43], a[248:251], v[88:91]
    ds_read_b128 v[36:39], v3 offset:12544
    v_cvt_pk_bf16_f32 v66, v16, v17
    v_mfma_f32_16x16x32_bf16 v[88:91], v[44:47], a[252:255], v[88:91]
    v_exp_f32 v16, v68
    v_mfma_f32_16x16x32_bf16 v[92:95], v[44:47], v[212:215], v[92:95]
    v_add_f32 v5, v5, v18
    v_add_f32 v5, v5, v19
    v_mfma_f32_16x16x32_bf16 v[92:95], v[40:43], v[208:211], v[92:95]
    s_waitcnt lgkmcnt(2)
    v_exp_f32 v17, v69
    v_mfma_f32_16x16x32_bf16 v[112:115], v[24:27], a[200:203], v[112:115]
    ds_read_b128 v[40:43], v2 offset:18688
    v_mfma_f32_16x16x32_bf16 v[112:115], v[28:31], a[204:207], v[112:115]
    v_cvt_pk_bf16_f32 v67, v18, v19
    v_mfma_f32_16x16x32_bf16 v[116:119], v[28:31], a[228:231], v[116:119]
    v_exp_f32 v18, v70
    v_mfma_f32_16x16x32_bf16 v[116:119], v[24:27], a[224:227], v[116:119]
    v_add_f32 v6, v6, v16
    v_mfma_f32_16x16x32_bf16 v[120:123], v[24:27], a[248:251], v[120:123]
    ds_read_b128 v[44:47], v3 offset:18688
    v_add_f32 v6, v6, v17
    v_mfma_f32_16x16x32_bf16 v[120:123], v[28:31], a[252:255], v[120:123]
    s_waitcnt lgkmcnt(2)
    buffer_load_dwordx4 v4, s[4:7], s32 offen offset:2048 sc1 lds
    v_mfma_f32_16x16x32_bf16 v[124:127], v[28:31], v[212:215], v[124:127]
    s_waitcnt vmcnt(7)
    v_exp_f32 v19, v71
    v_mfma_f32_16x16x32_bf16 v[124:127], v[24:27], v[208:211], v[124:127]
    s_barrier
    v_mfma_f32_16x16x32_bf16 v[80:83], v[32:35], a[208:211], v[80:83]
    ds_read_b128 v[24:27], v1 offset:0
    v_cvt_pk_bf16_f32 v68, v16, v17
    v_mfma_f32_16x16x32_bf16 v[80:83], v[36:39], a[212:215], v[80:83]
    v_exp_f32 v16, v100
    v_mfma_f32_16x16x32_bf16 v[84:87], v[36:39], a[236:239], v[84:87]
    v_add_f32 v6, v6, v18
    v_add_f32 v6, v6, v19
    v_mfma_f32_16x16x32_bf16 v[84:87], v[32:35], a[232:235], v[84:87]
    v_exp_f32 v17, v101
    v_mfma_f32_16x16x32_bf16 v[88:91], v[32:35], v[192:195], v[88:91]
    ds_read_b128 v[28:31], v1 offset:12288
    v_mfma_f32_16x16x32_bf16 v[88:91], v[36:39], v[196:199], v[88:91]
    v_cvt_pk_bf16_f32 v69, v18, v19
    v_mfma_f32_16x16x32_bf16 v[92:95], v[36:39], v[220:223], v[92:95]
    v_exp_f32 v18, v102
    v_mfma_f32_16x16x32_bf16 v[92:95], v[32:35], v[216:219], v[92:95]
    s_waitcnt lgkmcnt(2)
    v_add_f32 v6, v6, v16
    v_mfma_f32_16x16x32_bf16 v[112:115], v[40:43], a[208:211], v[112:115]
    ds_read_b128 v[32:35], v1 offset:1024
    v_add_f32 v6, v6, v17
    v_mfma_f32_16x16x32_bf16 v[112:115], v[44:47], a[212:215], v[112:115]
    v_exp_f32 v19, v103
    v_mfma_f32_16x16x32_bf16 v[116:119], v[44:47], a[236:239], v[116:119]
    v_mfma_f32_16x16x32_bf16 v[116:119], v[40:43], a[232:235], v[116:119]
    v_cvt_pk_bf16_f32 v70, v16, v17
    v_mfma_f32_16x16x32_bf16 v[120:123], v[40:43], v[192:195], v[120:123]
    ds_read_b128 v[36:39], v1 offset:13312
    v_add_f32 v6, v6, v18
    v_mfma_f32_16x16x32_bf16 v[120:123], v[44:47], v[196:199], v[120:123]
    s_add_u32 s32, s32, 24576
    s_add_u32 s26, s26, 36864
    v_add_f32 v6, v6, v19
    v_mfma_f32_16x16x32_bf16 v[124:127], v[44:47], v[220:223], v[124:127]
    s_sub_u32 s57, s26, 147456
    v_cvt_pk_bf16_f32 v71, v18, v19
    s_min_u32 s26, s26, s57
    v_mfma_f32_16x16x32_bf16 v[124:127], v[40:43], v[216:219], v[124:127]
    s_waitcnt lgkmcnt(2)
    v_mfma_f32_16x16x32_bf16 a[0:3], v[160:163], v[24:27], a[0:3]
    ds_read_b128 v[40:43], v1 offset:2048
    v_mfma_f32_16x16x32_bf16 a[0:3], v[176:179], v[28:31], a[0:3]
    s_waitcnt vmcnt(6)
    v_subrev_u32 v52, s92, v52
    v_cmp_lt_u32 vcc, 15, v52
    v_mfma_f32_16x16x32_bf16 a[48:51], v[180:183], v[28:31], a[48:51]
    v_exp_f32 v16, v72
    v_mfma_f32_16x16x32_bf16 a[48:51], v[164:167], v[24:27], a[48:51]
    v_exp_f32 v17, v73
    v_mfma_f32_16x16x32_bf16 a[96:99], v[168:171], v[24:27], a[96:99]
    s_and_b32 s59, vcc_lo, 0xff
    ds_read_b128 v[44:47], v1 offset:14336
    v_mfma_f32_16x16x32_bf16 a[96:99], v[184:187], v[28:31], a[96:99]
    s_cbranch_scc1 L_pollslow4
L_pollok4:
    v_mfma_f32_16x16x32_bf16 a[144:147], v[188:191], v[28:31], a[144:147]
    s_add_u32 s92, s92, 1
    v_exp_f32 v18, v74
    v_mfma_f32_16x16x32_bf16 a[144:147], v[172:175], v[24:27], a[144:147]
    s_waitcnt lgkmcnt(2)
    v_add_f32 v7, v7, v16
    v_add_f32 v7, v7, v17
    v_mfma_f32_16x16x32_bf16 a[4:7], v[160:163], v[32:35], a[4:7]
    ds_read_b128 v[24:27], v1 offset:3072
    v_mfma_f32_16x16x32_bf16 a[4:7], v[176:179], v[36:39], a[4:7]
    v_exp_f32 v19, v75
    v_mfma_f32_16x16x32_bf16 a[52:55], v[180:183], v[36:39], a[52:55]
    v_cvt_pk_bf16_f32 v72, v16, v17
    v_mfma_f32_16x16x32_bf16 a[52:55], v[164:167], v[32:35], a[52:55]
    v_exp_f32 v16, v104
    v_mfma_f32_16x16x32_bf16 a[100:103], v[168:171], v[32:35], a[100:103]
    ds_read_b128 v[28:31], v1 offset:15360
    v_add_f32 v7, v7, v18
    v_mfma_f32_16x16x32_bf16 a[100:103], v[184:187], v[36:39], a[100:103]
    s_waitcnt lgkmcnt(2)
    v_add_f32 v7, v7, v19
    v_mfma_f32_16x16x32_bf16 a[148:151], v[188:191], v[36:39], a[148:151]
    s_waitcnt vmcnt(0)
    v_exp_f32 v17, v105
    v_mfma_f32_16x16x32_bf16 a[148:151], v[172:175], v[32:35], a[148:151]
    s_barrier
    v_mfma_f32_16x16x32_bf16 a[8:11], v[160:163], v[40:43], a[8:11]
    s_mov_b32 m0, s56
    ds_read_b128 v[32:35], v1 offset:4096
    v_cvt_pk_bf16_f32 v73, v18, v19
    v_mfma_f32_16x16x32_bf16 a[8:11], v[176:179], v[44:47], a[8:11]
    buffer_load_dwordx4 v4, s[4:7], s27 offen offset:0 sc1 lds
    v_mfma_f32_16x16x32_bf16 a[56:59], v[180:183], v[44:47], a[56:59]
    v_exp_f32 v18, v106
    v_mfma_f32_16x16x32_bf16 a[56:59], v[164:167], v[40:43], a[56:59]
    v_add_f32 v7, v7, v16
    v_add_f32 v7, v7, v17
    v_mfma_f32_16x16x32_bf16 a[104:107], v[168:171], v[40:43], a[104:107]
    ds_read_b128 v[36:39], v1 offset:16384
    v_mfma_f32_16x16x32_bf16 a[104:107], v[184:187], v[44:47], a[104:107]
    buffer_load_dwordx4 v4, s[4:7], s27 offen offset:1024 sc1 lds
    v_mfma_f32_16x16x32_bf16 a[152:155], v[188:191], v[44:47], a[152:155]
    v_exp_f32 v19, v107
    v_mfma_f32_16x16x32_bf16 a[152:155], v[172:175], v[40:43], a[152:155]
    s_waitcnt lgkmcnt(2)
    v_cvt_pk_bf16_f32 v74, v16, v17
    v_mfma_f32_16x16x32_bf16 a[12:15], v[160:163], v[24:27], a[12:15]
L_pg10:
    s_cbranch_execz L_iwret
    ds_read_b128 v[40:43], v1 offset:5120
    v_mfma_f32_16x16x32_bf16 a[12:15], v[176:179], v[28:31], a[12:15]
    buffer_load_dwordx4 v4, s[4:7], s27 offen offset:2048 sc1 lds
    v_mfma_f32_16x16x32_bf16 a[60:63], v[180:183], v[28:31], a[60:63]
    v_exp_f32 v16, v76
    v_mfma_f32_16x16x32_bf16 a[60:63], v[164:167], v[24:27], a[60:63]
    s_add_u32 s27, s27, 24576
    v_add_f32 v7, v7, v18
    v_add_f32 v7, v7, v19
    v_mfma_f32_16x16x32_bf16 a[108:111], v[168:171], v[24:27], a[108:111]
    ds_read_b128 v[44:47], v1 offset:17408
    v_mfma_f32_16x16x32_bf16 a[108:111], v[184:187], v[28:31], a[108:111]
    s_add_u32 s56, s56, 12288
    v_exp_f32 v17, v77
    v_mfma_f32_16x16x32_bf16 a[156:159], v[188:191], v[28:31], a[156:159]
    s_add_u32 s29, s28, 49152
    v_cvt_pk_bf16_f32 v75, v18, v19
    v_mfma_f32_16x16x32_bf16 a[156:159], v[172:175], v[24:27], a[156:159]
    s_waitcnt lgkmcnt(2)
    v_exp_f32 v18, v78
    v_mfma_f32_16x16x32_bf16 a[16:19], v[160:163], v[32:35], a[16:19]
    s_sub_u32 s3, s29, 147456
    ds_read_b128 v[24:27], v1 offset:6144
    v_add_f32 v8, v8, v16
    v_mfma_f32_16x16x32_bf16 a[16:19], v[176:179], v[36:39], a[16:19]
    s_mov_b32 m0, s56
    v_add_f32 v8, v8, v17
    s_min_u32 s29, s29, s3
    v_mfma_f32_16x16x32_bf16 a[64:67], v[180:183], v[36:39], a[64:67]
    v_exp_f32 v19, v79
    v_mfma_f32_16x16x32_bf16 a[64:67], v[164:167], v[32:35], a[64:67]
    buffer_load_dwordx4 v4, s[4:7], s27 offen offset:0 sc1 lds
    v_mfma_f32_16x16x32_bf16 a[112:115], v[168:171], v[32:35], a[112:115]
    ds_read_b128 v[28:31], v1 offset:18432
    v_cvt_pk_bf16_f32 v76, v16, v17
    v_mfma_f32_16x16x32_bf16 a[112:115], v[184:187], v[36:39], a[112:115]
    v_exp_f32 v16, v108
    v_mfma_f32_16x16x32_bf16 a[160:163], v[188:191], v[36:39], a[160:163]
    v_add_f32 v8, v8, v18
    v_add_f32 v8, v8, v19
    v_mfma_f32_16x16x32_bf16 a[160:163], v[172:175], v[32:35], a[160:163]
    s_waitcnt lgkmcnt(2)
    buffer_load_dwordx4 v4, s[4:7], s27 offen offset:1024 sc1 lds
    v_mfma_f32_16x16x32_bf16 a[20:23], v[160:163], v[40:43], a[20:23]
    s_sub_u32 s3, s29, s28
    ds_read_b128 v[32:35], v1 offset:7168
    v_mfma_f32_16x16x32_bf16 a[20:23], v[176:179], v[44:47], a[20:23]
    v_exp_f32 v17, v109
    v_mfma_f32_16x16x32_bf16 a[68:71], v[180:183], v[44:47], a[68:71]
    v_cvt_pk_bf16_f32 v77, v18, v19
    v_mfma_f32_16x16x32_bf16 a[68:71], v[164:167], v[40:43], a[68:71]
    buffer_load_dwordx4 v4, s[4:7], s27 offen offset:2048 sc1 lds
    v_mfma_f32_16x16x32_bf16 a[116:119], v[168:171], v[40:43], a[116:119]
    ds_read_b128 v[36:39], v1 offset:19456
    v_mfma_f32_16x16x32_bf16 a[116:119], v[184:187], v[44:47], a[116:119]
    v_exp_f32 v18, v110
    v_mfma_f32_16x16x32_bf16 a[164:167], v[188:191], v[44:47], a[164:167]
    s_add_u32 s27, s27, 24576
    v_add_f32 v8, v8, v16
    v_add_f32 v8, v8, v17
    v_mfma_f32_16x16x32_bf16 a[164:167], v[172:175], v[40:43], a[164:167]
    s_waitcnt lgkmcnt(2)
    v_exp_f32 v19, v111
    v_mfma_f32_16x16x32_bf16 a[24:27], v[160:163], v[24:27], a[24:27]
    s_add_u32 s56, s56, 36864
    ds_read_b128 v[40:43], v1 offset:8192
    v_cvt_pk_bf16_f32 v78, v16, v17
    v_mfma_f32_16x16x32_bf16 a[24:27], v[176:179], v[28:31], a[24:27]
    s_mov_b32 s28, s29
    v_add_f32 v8, v8, v18
    v_add_f32 v8, v8, v19
    v_mfma_f32_16x16x32_bf16 a[72:75], v[180:183], v[28:31], a[72:75]
    s_sub_u32 s58, s56, 147456
    v_cvt_pk_bf16_f32 v79, v18, v19
    v_mfma_f32_16x16x32_bf16 a[72:75], v[164:167], v[24:27], a[72:75]
    v_exp_f32 v16, v80
    v_mfma_f32_16x16x32_bf16 a[120:123], v[168:171], v[24:27], a[120:123]
    s_min_u32 s56, s56, s58
    ds_read_b128 v[44:47], v1 offset:20480
    v_mfma_f32_16x16x32_bf16 a[120:123], v[184:187], v[28:31], a[120:123]
    v_exp_f32 v17, v81
    v_mfma_f32_16x16x32_bf16 a[168:171], v[188:191], v[28:31], a[168:171]
    s_mov_b32 m0, s26
    v_exp_f32 v18, v82
    v_mfma_f32_16x16x32_bf16 a[168:171], v[172:175], v[24:27], a[168:171]
    s_waitcnt lgkmcnt(2)
    v_add_f32 v5, v5, v16
    v_add_f32 v5, v5, v17
    v_mfma_f32_16x16x32_bf16 a[28:31], v[160:163], v[32:35], a[28:31]
    ds_read_b128 v[24:27], v1 offset:9216
    v_add_u32 v2, s3, v2
    v_mfma_f32_16x16x32_bf16 a[28:31], v[176:179], v[36:39], a[28:31]
    buffer_load_dwordx4 v4, s[4:7], s32 offen offset:0 sc1 lds
    v_mfma_f32_16x16x32_bf16 a[76:79], v[180:183], v[36:39], a[76:79]
    v_exp_f32 v19, v83
    v_mfma_f32_16x16x32_bf16 a[76:79], v[164:167], v[32:35], a[76:79]
    v_cvt_pk_bf16_f32 v80, v16, v17
    v_mfma_f32_16x16x32_bf16 a[124:127], v[168:171], v[32:35], a[124:127]
    ds_read_b128 v[28:31], v1 offset:21504
    v_add_u32 v3, s3, v3
    v_mfma_f32_16x16x32_bf16 a[124:127], v[184:187], v[36:39], a[124:127]
    buffer_load_dwordx4 v4, s[4:7], s32 offen offset:1024 sc1 lds
    v_mfma_f32_16x16x32_bf16 a[172:175], v[188:191], v[36:39], a[172:175]
    v_exp_f32 v16, v112
    v_mfma_f32_16x16x32_bf16 a[172:175], v[172:175], v[32:35], a[172:175]
    s_waitcnt lgkmcnt(2)
    v_add_f32 v5, v5, v18
    v_add_f32 v5, v5, v19
    v_mfma_f32_16x16x32_bf16 a[32:35], v[160:163], v[40:43], a[32:35]
    ds_read_b128 v[32:35], v1 offset:10240
    v_mfma_f32_16x16x32_bf16 a[32:35], v[176:179], v[44:47], a[32:35]
    buffer_load_dwordx4 v4, s[4:7], s32 offen offset:2048 sc1 lds
    v_mfma_f32_16x16x32_bf16 a[80:83], v[180:183], v[44:47], a[80:83]
    v_exp_f32 v17, v113
    v_mfma_f32_16x16x32_bf16 a[80:83], v[164:167], v[40:43], a[80:83]
    v_cvt_pk_bf16_f32 v81, v18, v19
    v_mfma_f32_16x16x32_bf16 a[128:131], v[168:171], v[40:43], a[128:131]
    ds_read_b128 v[36:39], v1 offset:22528
    v_mfma_f32_16x16x32_bf16 a[128:131], v[184:187], v[44:47], a[128:131]
    s_add_u32 s32, s32, 24576
    v_exp_f32 v18, v114
    v_mfma_f32_16x16x32_bf16 a[176:179], v[188:191], v[44:47], a[176:179]
    v_add_f32 v5, v5, v16
    v_add_f32 v5, v5, v17
    v_mfma_f32_16x16x32_bf16 a[176:179], v[172:175], v[40:43], a[176:179]
    s_waitcnt lgkmcnt(2)
    v_exp_f32 v19, v115
    v_mfma_f32_16x16x32_bf16 a[36:39], v[160:163], v[24:27], a[36:39]
    s_add_u32 s26, s26, 12288
    ds_read_b128 v[40:43], v1 offset:11264
    v_cvt_pk_bf16_f32 v82, v16, v17
    v_mfma_f32_16x16x32_bf16 a[36:39], v[176:179], v[28:31], a[36:39]
    s_mov_b32 m0, s26
    v_exp_f32 v16, v84
    v_mfma_f32_16x16x32_bf16 a[84:87], v[180:183], v[28:31], a[84:87]
    v_add_f32 v5, v5, v18
    v_add_f32 v5, v5, v19
    v_mfma_f32_16x16x32_bf16 a[84:87], v[164:167], v[24:27], a[84:87]
    v_exp_f32 v17, v85
    v_mfma_f32_16x16x32_bf16 a[132:135], v[168:171], v[24:27], a[132:135]
    ds_read_b128 v[44:47], v1 offset:23552
    v_cvt_pk_bf16_f32 v83, v18, v19
    v_mfma_f32_16x16x32_bf16 a[132:135], v[184:187], v[28:31], a[132:135]
    buffer_load_dwordx4 v4, s[4:7], s32 offen offset:0 sc1 lds
    v_mfma_f32_16x16x32_bf16 a[180:183], v[188:191], v[28:31], a[180:183]
    v_exp_f32 v18, v86
    v_mfma_f32_16x16x32_bf16 a[180:183], v[172:175], v[24:27], a[180:183]
    s_waitcnt lgkmcnt(2)
    v_add_f32 v6, v6, v16
    v_add_f32 v6, v6, v17
    v_mfma_f32_16x16x32_bf16 a[40:43], v[160:163], v[32:35], a[40:43]
    ds_read_b128 v[24:27], v2 offset:0
    v_mfma_f32_16x16x32_bf16 a[40:43], v[176:179], v[36:39], a[40:43]
    buffer_load_dwordx4 v4, s[4:7], s32 offen offset:1024 sc1 lds
    v_mfma_f32_16x16x32_bf16 a[88:91], v[180:183], v[36:39], a[88:91]
    v_exp_f32 v19, v87
    v_mfma_f32_16x16x32_bf16 a[88:91], v[164:167], v[32:35], a[88:91]
    v_cvt_pk_bf16_f32 v84, v16, v17
    v_mfma_f32_16x16x32_bf16 a[136:139], v[168:171], v[32:35], a[136:139]
    ds_read_b128 v[28:31], v3 offset:0
    v_mfma_f32_16x16x32_bf16 a[136:139], v[184:187], v[36:39], a[136:139]
    buffer_load_dwordx4 v4, s[4:7], s32 offen offset:2048 sc1 lds
    v_mfma_f32_16x16x32_bf16 a[184:187], v[188:191], v[36:39], a[184:187]
    v_exp_f32 v16, v116
    v_mfma_f32_16x16x32_bf16 a[184:187], v[172:175], v[32:35], a[184:187]
    s_waitcnt lgkmcnt(2)
    v_add_f32 v6, v6, v18
    v_add_f32 v6, v6, v19
    v_mfma_f32_16x16x32_bf16 a[44:47], v[160:163], v[40:43], a[44:47]
    ds_read_b128 v[32:35], v2 offset:6144
    v_mfma_f32_16x16x32_bf16 a[44:47], v[176:179], v[44:47], a[44:47]
    v_exp_f32 v17, v117
    v_mfma_f32_16x16x32_bf16 a[92:95], v[180:183], v[44:47], a[92:95]
    v_cvt_pk_bf16_f32 v85, v18, v19
    v_mfma_f32_16x16x32_bf16 a[92:95], v[164:167], v[40:43], a[92:95]
    s_add_u32 s32, s32, 24576
    v_exp_f32 v18, v118
    v_mfma_f32_16x16x32_bf16 a[140:143], v[168:171], v[40:43], a[140:143]
    s_add_u32 s26, s26, 36864
    ds_read_b128 v[36:39], v3 offset:6144
    v_add_f32 v6, v6, v16
    v_mfma_f32_16x16x32_bf16 a[140:143], v[184:187], v[44:47], a[140:143]
    s_sub_u32 s57, s26, 147456
    v_add_f32 v6, v6, v17
    s_min_u32 s26, s26, s57
    v_mfma_f32_16x16x32_bf16 a[188:191], v[188:191], v[44:47], a[188:191]
    v_exp_f32 v19, v119
    v_mfma_f32_16x16x32_bf16 a[188:191], v[172:175], v[40:43], a[188:191]
    s_waitcnt lgkmcnt(2)
    v_cvt_pk_bf16_f32 v86, v16, v17
    v_add_f32 v6, v6, v18
    v_add_f32 v6, v6, v19
    v_cvt_pk_bf16_f32 v87, v18, v19
    v_mfma_f32_16x16x32_bf16 v[160:163], v[24:27], a[192:195], v[128:131]
    ds_read_b128 v[40:43], v2 offset:128
    v_mfma_f32_16x16x32_bf16 v[160:163], v[28:31], a[196:199], v[160:163]
    v_exp_f32 v16, v88
    v_mfma_f32_16x16x32_bf16 v[164:167], v[28:31], a[220:223], v[132:135]
    ds_read_b128 v[44:47], v3 offset:128
    v_mfma_f32_16x16x32_bf16 v[164:167], v[24:27], a[216:219], v[164:167]
    s_waitcnt lgkmcnt(2)
    v_exp_f32 v17, v89
    v_mfma_f32_16x16x32_bf16 v[96:99], v[32:35], a[192:195], v[128:131]
    ds_read_b128 v[24:27], v2 offset:6272
    v_mfma_f32_16x16x32_bf16 v[96:99], v[36:39], a[196:199], v[96:99]
    v_exp_f32 v18, v90
    v_mfma_f32_16x16x32_bf16 v[100:103], v[36:39], a[220:223], v[132:135]
    ds_read_b128 v[28:31], v3 offset:6272
    v_add_f32 v7, v7, v16
    v_mfma_f32_16x16x32_bf16 v[100:103], v[32:35], a[216:219], v[100:103]
    s_waitcnt lgkmcnt(2)
    v_add_f32 v7, v7, v17
    v_mfma_f32_16x16x32_bf16 v[160:163], v[40:43], a[200:203], v[160:163]
    ds_read_b128 v[32:35], v2 offset:256
    v_mfma_f32_16x16x32_bf16 v[160:163], v[44:47], a[204:207], v[160:163]
    v_exp_f32 v19, v91
    v_mfma_f32_16x16x32_bf16 v[164:167], v[44:47], a[228:231], v[164:167]
    ds_read_b128 v[36:39], v3 offset:256
    v_cvt_pk_bf16_f32 v88, v16, v17
    v_mfma_f32_16x16x32_bf16 v[164:167], v[40:43], a[224:227], v[164:167]
    s_waitcnt lgkmcnt(2)
    v_exp_f32 v16, v120
    v_mfma_f32_16x16x32_bf16 v[96:99], v[24:27], a[200:203], v[96:99]
    ds_read_b128 v[40:43], v2 offset:6400
    v_add_f32 v7, v7, v18
    v_mfma_f32_16x16x32_bf16 v[96:99], v[28:31], a[204:207], v[96:99]
    v_add_f32 v7, v7, v19
    v_mfma_f32_16x16x32_bf16 v[100:103], v[28:31], a[228:231], v[100:103]
    ds_read_b128 v[44:47], v3 offset:6400
    v_mfma_f32_16x16x32_bf16 v[100:103], v[24:27], a[224:227], v[100:103]
    s_waitcnt lgkmcnt(2)
    v_exp_f32 v17, v121
    v_mfma_f32_16x16x32_bf16 v[160:163], v[32:35], a[208:211], v[160:163]
    ds_read_b128 v[24:27], v2 offset:12288
    v_cvt_pk_bf16_f32 v89, v18, v19
    v_mfma_f32_16x16x32_bf16 v[160:163], v[36:39], a[212:215], v[160:163]
    v_exp_f32 v18, v122
    v_mfma_f32_16x16x32_bf16 v[164:167], v[36:39], a[236:239], v[164:167]
    ds_read_b128 v[28:31], v3 offset:12288
    v_add_f32 v7, v7, v16
    v_mfma_f32_16x16x32_bf16 v[164:167], v[32:35], a[232:235], v[164:167]
    s_waitcnt lgkmcnt(2)
    v_add_f32 v7, v7, v17
    v_mfma_f32_16x16x32_bf16 v[96:99], v[40:43], a[208:211], v[96:99]
    ds_read_b128 v[32:35], v2 offset:18432
    v_mfma_f32_16x16x32_bf16 v[96:99], v[44:47], a[212:215], v[96:99]
    v_exp_f32 v19, v123
    v_mfma_f32_16x16x32_bf16 v[100:103], v[44:47], a[236:239], v[100:103]
    ds_read_b128 v[36:39], v3 offset:18432
    v_cvt_pk_bf16_f32 v90, v16, v17
    v_mfma_f32_16x16x32_bf16 v[100:103], v[40:43], a[232:235], v[100:103]
    s_waitcnt lgkmcnt(2)
    v_exp_f32 v16, v92
    v_mfma_f32_16x16x32_bf16 v[168:171], v[24:27], a[192:195], v[128:131]
    ds_read_b128 v[40:43], v2 offset:12416
    v_add_f32 v7, v7, v18
    v_mfma_f32_16x16x32_bf16 v[168:171], v[28:31], a[196:199], v[168:171]
    v_add_f32 v7, v7, v19
    v_mfma_f32_16x16x32_bf16 v[172:175], v[28:31], a[220:223], v[132:135]
    ds_read_b128 v[44:47], v3 offset:12416
    v_mfma_f32_16x16x32_bf16 v[172:175], v[24:27], a[216:219], v[172:175]
    s_waitcnt lgkmcnt(2)
    v_exp_f32 v17, v93
    v_mfma_f32_16x16x32_bf16 v[104:107], v[32:35], a[192:195], v[128:131]
    ds_read_b128 v[24:27], v2 offset:18560
    v_cvt_pk_bf16_f32 v91, v18, v19
    v_mfma_f32_16x16x32_bf16 v[104:107], v[36:39], a[196:199], v[104:107]
    v_exp_f32 v18, v94
    v_mfma_f32_16x16x32_bf16 v[108:111], v[36:39], a[220:223], v[132:135]
    s_add_u32 s29, s30, 49152
    ds_read_b128 v[28:31], v3 offset:18560
    v_add_f32 v8, v8, v16
    v_mfma_f32_16x16x32_bf16 v[108:111], v[32:35], a[216:219], v[108:111]
    s_waitcnt lgkmcnt(2)
    v_add_f32 v8, v8, v17
    s_sub_u32 s3, s29, 147456
    v_mfma_f32_16x16x32_bf16 v[168:171], v[40:43], a[200:203], v[168:171]
    ds_read_b128 v[32:35], v2 offset:12544
    v_mfma_f32_16x16x32_bf16 v[168:171], v[44:47], a[204:207], v[168:171]
    s_min_u32 s29, s29, s3
    v_exp_f32 v19, v95
    v_mfma_f32_16x16x32_bf16 v[172:175], v[44:47], a[228:231], v[172:175]
    ds_read_b128 v[36:39], v3 offset:12544
    v_cvt_pk_bf16_f32 v92, v16, v17
    v_mfma_f32_16x16x32_bf16 v[172:175], v[40:43], a[224:227], v[172:175]
    s_waitcnt lgkmcnt(2)
    v_exp_f32 v16, v124
    v_mfma_f32_16x16x32_bf16 v[104:107], v[24:27], a[200:203], v[104:107]
    ds_read_b128 v[40:43], v2 offset:18688
    v_add_f32 v8, v8, v18
    v_mfma_f32_16x16x32_bf16 v[104:107], v[28:31], a[204:207], v[104:107]
    v_add_f32 v8, v8, v19
    v_mfma_f32_16x16x32_bf16 v[108:111], v[28:31], a[228:231], v[108:111]
    ds_read_b128 v[44:47], v3 offset:18688
    v_mfma_f32_16x16x32_bf16 v[108:111], v[24:27], a[224:227], v[108:111]
    s_waitcnt lgkmcnt(2)
    v_subrev_u32 v2, 98304, v2
    v_subrev_u32 v3, 98304, v3
    v_mfma_f32_16x16x32_bf16 v[168:171], v[32:35], a[208:211], v[168:171]
    ds_read_b128 v[24:27], v2 offset:0
    v_mfma_f32_16x16x32_bf16 v[168:171], v[36:39], a[212:215], v[168:171]
    s_sub_u32 s3, s29, s30
    v_exp_f32 v17, v125
    v_mfma_f32_16x16x32_bf16 v[172:175], v[36:39], a[236:239], v[172:175]
    ds_read_b128 v[28:31], v3 offset:0
    v_cvt_pk_bf16_f32 v93, v18, v19
    v_mfma_f32_16x16x32_bf16 v[172:175], v[32:35], a[232:235], v[172:175]
    s_waitcnt lgkmcnt(2)
    v_exp_f32 v18, v126
    v_mfma_f32_16x16x32_bf16 v[104:107], v[40:43], a[208:211], v[104:107]
    ds_read_b128 v[32:35], v2 offset:6144
    v_add_f32 v8, v8, v16
    v_mfma_f32_16x16x32_bf16 v[104:107], v[44:47], a[212:215], v[104:107]
    v_add_f32 v8, v8, v17
    v_mfma_f32_16x16x32_bf16 v[108:111], v[44:47], a[236:239], v[108:111]
    ds_read_b128 v[36:39], v3 offset:6144
    v_mfma_f32_16x16x32_bf16 v[108:111], v[40:43], a[232:235], v[108:111]
    s_waitcnt lgkmcnt(2)
    v_exp_f32 v19, v127
    v_mfma_f32_16x16x32_bf16 v[176:179], v[24:27], a[192:195], v[128:131]
    ds_read_b128 v[40:43], v2 offset:128
    v_cvt_pk_bf16_f32 v94, v16, v17
    v_mfma_f32_16x16x32_bf16 v[176:179], v[28:31], a[196:199], v[176:179]
    s_mov_b32 s30, s29
    v_add_f32 v8, v8, v18
    v_add_f32 v8, v8, v19
    v_mfma_f32_16x16x32_bf16 v[180:183], v[28:31], a[220:223], v[132:135]
    ds_read_b128 v[44:47], v3 offset:128
    v_cvt_pk_bf16_f32 v95, v18, v19
    v_mfma_f32_16x16x32_bf16 v[180:183], v[24:27], a[216:219], v[180:183]
    s_waitcnt lgkmcnt(2)
    v_exp_f32 v16, v160
    v_mfma_f32_16x16x32_bf16 v[112:115], v[32:35], a[192:195], v[128:131]
    ds_read_b128 v[24:27], v2 offset:6272
    v_mfma_f32_16x16x32_bf16 v[112:115], v[36:39], a[196:199], v[112:115]
    v_exp_f32 v17, v161
    v_mfma_f32_16x16x32_bf16 v[116:119], v[36:39], a[220:223], v[132:135]
    ds_read_b128 v[28:31], v3 offset:6272
    v_mfma_f32_16x16x32_bf16 v[116:119], v[32:35], a[216:219], v[116:119]
    s_waitcnt lgkmcnt(2)
    v_exp_f32 v18, v162
    v_mfma_f32_16x16x32_bf16 v[176:179], v[40:43], a[200:203], v[176:179]
    ds_read_b128 v[32:35], v2 offset:256
    v_add_f32 v5, v5, v16
    v_mfma_f32_16x16x32_bf16 v[176:179], v[44:47], a[204:207], v[176:179]
    v_add_f32 v5, v5, v17
    v_add_u32 v1, s3, v1
    v_mfma_f32_16x16x32_bf16 v[180:183], v[44:47], a[228:231], v[180:183]
    ds_read_b128 v[36:39], v3 offset:256
    v_mfma_f32_16x16x32_bf16 v[180:183], v[40:43], a[224:227], v[180:183]
    s_waitcnt lgkmcnt(2)
    v_exp_f32 v19, v163
    v_mfma_f32_16x16x32_bf16 v[112:115], v[24:27], a[200:203], v[112:115]
    ds_read_b128 v[40:43], v2 offset:6400
    v_cvt_pk_bf16_f32 v160, v16, v17
    v_mfma_f32_16x16x32_bf16 v[112:115], v[28:31], a[204:207], v[112:115]
    v_exp_f32 v16, v96
    v_mfma_f32_16x16x32_bf16 v[116:119], v[28:31], a[228:231], v[116:119]
    ds_read_b128 v[44:47], v3 offset:6400
    v_add_f32 v5, v5, v18
    v_mfma_f32_16x16x32_bf16 v[116:119], v[24:27], a[224:227], v[116:119]
    s_waitcnt lgkmcnt(2)
    v_add_f32 v5, v5, v19
    v_mfma_f32_16x16x32_bf16 v[176:179], v[32:35], a[208:211], v[176:179]
    ds_read_b128 v[24:27], v2 offset:12288
    v_mfma_f32_16x16x32_bf16 v[176:179], v[36:39], a[212:215], v[176:179]
    v_exp_f32 v17, v97
    v_mfma_f32_16x16x32_bf16 v[180:183], v[36:39], a[236:239], v[180:183]
    ds_read_b128 v[28:31], v3 offset:12288
    v_cvt_pk_bf16_f32 v161, v18, v19
    v_mfma_f32_16x16x32_bf16 v[180:183], v[32:35], a[232:235], v[180:183]
    s_waitcnt lgkmcnt(2)
    v_exp_f32 v18, v98
    v_mfma_f32_16x16x32_bf16 v[112:115], v[40:43], a[208:211], v[112:115]
    ds_read_b128 v[32:35], v2 offset:18432
    v_add_f32 v5, v5, v16
    v_mfma_f32_16x16x32_bf16 v[112:115], v[44:47], a[212:215], v[112:115]
    v_add_f32 v5, v5, v17
    v_mfma_f32_16x16x32_bf16 v[116:119], v[44:47], a[236:239], v[116:119]
    ds_read_b128 v[36:39], v3 offset:18432
    v_mfma_f32_16x16x32_bf16 v[116:119], v[40:43], a[232:235], v[116:119]
    s_waitcnt lgkmcnt(2)
    v_exp_f32 v19, v99
    v_mfma_f32_16x16x32_bf16 v[184:187], v[24:27], a[192:195], v[128:131]
    ds_read_b128 v[40:43], v2 offset:12416
    v_cvt_pk_bf16_f32 v162, v16, v17
    v_mfma_f32_16x16x32_bf16 v[184:187], v[28:31], a[196:199], v[184:187]
    v_exp_f32 v16, v164
    v_mfma_f32_16x16x32_bf16 v[188:191], v[28:31], a[220:223], v[132:135]
    ds_read_b128 v[44:47], v3 offset:12416
    v_add_f32 v5, v5, v18
    v_mfma_f32_16x16x32_bf16 v[188:191], v[24:27], a[216:219], v[188:191]
    s_waitcnt lgkmcnt(2)
    v_add_f32 v5, v5, v19
    v_mfma_f32_16x16x32_bf16 v[120:123], v[32:35], a[192:195], v[128:131]
    ds_read_b128 v[24:27], v2 offset:18560
    v_mfma_f32_16x16x32_bf16 v[120:123], v[36:39], a[196:199], v[120:123]
    s_waitcnt vmcnt(6)
    v_exp_f32 v17, v165
    v_mfma_f32_16x16x32_bf16 v[124:127], v[36:39], a[220:223], v[132:135]
    ds_read_b128 v[28:31], v3 offset:18560
    v_cvt_pk_bf16_f32 v163, v18, v19
    v_mfma_f32_16x16x32_bf16 v[124:127], v[32:35], a[216:219], v[124:127]
    s_waitcnt lgkmcnt(2)
    s_barrier
    v_mfma_f32_16x16x32_bf16 v[184:187], v[40:43], a[200:203], v[184:187]
    ds_read_b128 v[32:35], v2 offset:12544
    v_mfma_f32_16x16x32_bf16 v[184:187], v[44:47], a[204:207], v[184:187]
    v_exp_f32 v18, v166
    v_mfma_f32_16x16x32_bf16 v[188:191], v[44:47], a[228:231], v[188:191]
    ds_read_b128 v[36:39], v3 offset:12544
    v_add_f32 v6, v6, v16
    v_mfma_f32_16x16x32_bf16 v[188:191], v[40:43], a[224:227], v[188:191]
    s_waitcnt lgkmcnt(2)
    v_add_f32 v6, v6, v17
    v_mfma_f32_16x16x32_bf16 v[120:123], v[24:27], a[200:203], v[120:123]
    ds_read_b128 v[40:43], v2 offset:18688
    v_mfma_f32_16x16x32_bf16 v[120:123], v[28:31], a[204:207], v[120:123]
    v_exp_f32 v19, v167
    v_cvt_pk_bf16_f32 v164, v16, v17
    v_mfma_f32_16x16x32_bf16 v[124:127], v[28:31], a[228:231], v[124:127]
    ds_read_b128 v[44:47], v3 offset:18688
    v_mfma_f32_16x16x32_bf16 v[124:127], v[24:27], a[224:227], v[124:127]
    s_waitcnt lgkmcnt(2)
    v_exp_f32 v16, v100
    v_mfma_f32_16x16x32_bf16 v[184:187], v[32:35], a[208:211], v[184:187]
    ds_read_b128 v[24:27], v1 offset:0
    v_add_f32 v6, v6, v18
    v_mfma_f32_16x16x32_bf16 v[184:187], v[36:39], a[212:215], v[184:187]
    v_add_f32 v6, v6, v19
    v_mfma_f32_16x16x32_bf16 v[188:191], v[36:39], a[236:239], v[188:191]
    ds_read_b128 v[28:31], v1 offset:12288
    v_mfma_f32_16x16x32_bf16 v[188:191], v[32:35], a[232:235], v[188:191]
    s_waitcnt lgkmcnt(2)
    v_exp_f32 v17, v101
    v_cvt_pk_bf16_f32 v165, v18, v19
    v_mfma_f32_16x16x32_bf16 v[120:123], v[40:43], a[208:211], v[120:123]
    ds_read_b128 v[32:35], v1 offset:1024
    v_mfma_f32_16x16x32_bf16 v[120:123], v[44:47], a[212:215], v[120:123]
    v_exp_f32 v18, v102
    v_mfma_f32_16x16x32_bf16 v[124:127], v[44:47], a[236:239], v[124:127]
    ds_read_b128 v[36:39], v1 offset:13312
    v_add_f32 v6, v6, v16
    v_mfma_f32_16x16x32_bf16 v[124:127], v[40:43], a[232:235], v[124:127]
    s_waitcnt lgkmcnt(2)
    v_add_f32 v6, v6, v17
    v_exp_f32 v19, v103
    v_cvt_pk_bf16_f32 v166, v16, v17
    v_add_f32 v6, v6, v18
    v_add_f32 v6, v6, v19
    v_cvt_pk_bf16_f32 v167, v18, v19
    v_mfma_f32_16x16x32_bf16 a[0:3], v[64:67], v[24:27], a[0:3]
    s_mov_b32 m0, s56
    ds_read_b128 v[40:43], v1 offset:2048
    v_bfe_u32 v57, v4, 8, 2
    v_mfma_f32_16x16x32_bf16 a[0:3], v[80:83], v[28:31], a[0:3]
    buffer_load_dwordx4 v4, s[4:7], s27 offen offset:0 sc1 lds
    v_mfma_f32_16x16x32_bf16 a[48:51], v[84:87], v[28:31], a[48:51]
    v_exp_f32 v16, v168
    v_mfma_f32_16x16x32_bf16 a[48:51], v[68:71], v[24:27], a[48:51]
    v_exp_f32 v17, v169
    v_mfma_f32_16x16x32_bf16 a[96:99], v[72:75], v[24:27], a[96:99]
    ds_read_b128 v[44:47], v1 offset:14336
    v_mul_u32_u24 v56, 1536, v57
    v_mfma_f32_16x16x32_bf16 a[96:99], v[88:91], v[28:31], a[96:99]
    buffer_load_dwordx4 v4, s[4:7], s27 offen offset:1024 sc1 lds
    v_mfma_f32_16x16x32_bf16 a[144:147], v[92:95], v[28:31], a[144:147]
    v_exp_f32 v18, v170
    v_mfma_f32_16x16x32_bf16 a[144:147], v[76:79], v[24:27], a[144:147]
    s_waitcnt lgkmcnt(2)
    v_add_f32 v5, v5, v16
    v_add_f32 v5, v5, v17
    v_mfma_f32_16x16x32_bf16 a[4:7], v[64:67], v[32:35], a[4:7]
    ds_read_b128 v[24:27], v1 offset:3072
    v_lshlrev_b32 v58, 4, v57
    v_mfma_f32_16x16x32_bf16 a[4:7], v[80:83], v[36:39], a[4:7]
    buffer_load_dwordx4 v4, s[4:7], s27 offen offset:2048 sc1 lds
    v_mfma_f32_16x16x32_bf16 a[52:55], v[84:87], v[36:39], a[52:55]
    v_exp_f32 v19, v171
    v_mfma_f32_16x16x32_bf16 a[52:55], v[68:71], v[32:35], a[52:55]
    s_add_u32 s27, s27, 24576
    v_cvt_pk_bf16_f32 v168, v16, v17
    v_bfe_u32 v57, v4, 4, 4
    v_mfma_f32_16x16x32_bf16 a[100:103], v[72:75], v[32:35], a[100:103]
    ds_read_b128 v[28:31], v1 offset:15360
    v_mfma_f32_16x16x32_bf16 a[100:103], v[88:91], v[36:39], a[100:103]
    s_add_u32 s56, s56, 12288
    v_exp_f32 v16, v104
    v_mfma_f32_16x16x32_bf16 a[148:151], v[92:95], v[36:39], a[148:151]
    v_add_f32 v5, v5, v18
    v_add_f32 v5, v5, v19
    v_mfma_f32_16x16x32_bf16 a[148:151], v[76:79], v[32:35], a[148:151]
    s_waitcnt lgkmcnt(2)
    v_exp_f32 v17, v105
    v_mfma_f32_16x16x32_bf16 a[8:11], v[64:67], v[40:43], a[8:11]
    s_mov_b32 m0, s56
    ds_read_b128 v[32:35], v1 offset:4096
    v_cvt_pk_bf16_f32 v169, v18, v19
    v_mfma_f32_16x16x32_bf16 a[8:11], v[80:83], v[44:47], a[8:11]
    v_exp_f32 v18, v106
    v_mfma_f32_16x16x32_bf16 a[56:59], v[84:87], v[44:47], a[56:59]
    v_add_f32 v5, v5, v16
    v_add_f32 v5, v5, v17
    v_mfma_f32_16x16x32_bf16 a[56:59], v[68:71], v[40:43], a[56:59]
    buffer_load_dwordx4 v4, s[4:7], s27 offen offset:0 sc1 lds
    v_mfma_f32_16x16x32_bf16 a[104:107], v[72:75], v[40:43], a[104:107]
    ds_read_b128 v[36:39], v1 offset:16384
    v_mul_u32_u24 v57, 12, v57
    v_mfma_f32_16x16x32_bf16 a[104:107], v[88:91], v[44:47], a[104:107]
    v_exp_f32 v19, v107
    v_mfma_f32_16x16x32_bf16 a[152:155], v[92:95], v[44:47], a[152:155]
    v_cvt_pk_bf16_f32 v170, v16, v17
    v_add_u32 v56, v56, v57
    v_mfma_f32_16x16x32_bf16 a[152:155], v[76:79], v[40:43], a[152:155]
    s_waitcnt lgkmcnt(2)
    buffer_load_dwordx4 v4, s[4:7], s27 offen offset:1024 sc1 lds
    v_mfma_f32_16x16x32_bf16 a[12:15], v[64:67], v[24:27], a[12:15]
    ds_read_b128 v[40:43], v1 offset:5120
    v_mfma_f32_16x16x32_bf16 a[12:15], v[80:83], v[28:31], a[12:15]
    v_exp_f32 v16, v172
    v_mfma_f32_16x16x32_bf16 a[60:63], v[84:87], v[28:31], a[60:63]
    v_add_f32 v5, v5, v18
    v_add_f32 v5, v5, v19
    v_mfma_f32_16x16x32_bf16 a[60:63], v[68:71], v[24:27], a[60:63]
    buffer_load_dwordx4 v4, s[4:7], s27 offen offset:2048 sc1 lds
    v_mfma_f32_16x16x32_bf16 a[108:111], v[72:75], v[24:27], a[108:111]
    ds_read_b128 v[44:47], v1 offset:17408
    v_mov_b32 v57, 1.0
    v_mfma_f32_16x16x32_bf16 a[108:111], v[88:91], v[28:31], a[108:111]
    v_exp_f32 v17, v173
    v_mfma_f32_16x16x32_bf16 a[156:159], v[92:95], v[28:31], a[156:159]
    s_add_u32 s27, s27, 24576
    v_cvt_pk_bf16_f32 v171, v18, v19
    v_mfma_f32_16x16x32_bf16 a[156:159], v[76:79], v[24:27], a[156:159]
    s_waitcnt lgkmcnt(2)
    v_exp_f32 v18, v174
    v_mfma_f32_16x16x32_bf16 a[16:19], v[64:67], v[32:35], a[16:19]
    s_add_u32 s56, s56, 36864
    ds_read_b128 v[24:27], v1 offset:6144
    v_add_f32 v6, v6, v16
    v_mfma_f32_16x16x32_bf16 a[16:19], v[80:83], v[36:39], a[16:19]
    v_add_f32 v6, v6, v17
    v_mov_b32 v20, 0x3f803f80
    v_mfma_f32_16x16x32_bf16 a[64:67], v[84:87], v[36:39], a[64:67]
    s_sub_u32 s58, s56, 147456
    v_exp_f32 v19, v175
    v_mfma_f32_16x16x32_bf16 a[64:67], v[68:71], v[32:35], a[64:67]
    v_cvt_pk_bf16_f32 v172, v16, v17
    v_mfma_f32_16x16x32_bf16 a[112:115], v[72:75], v[32:35], a[112:115]
    s_min_u32 s56, s56, s58
    ds_read_b128 v[28:31], v1 offset:18432
    v_mov_b32 v21, 0x3f803f80
    v_mfma_f32_16x16x32_bf16 a[112:115], v[88:91], v[36:39], a[112:115]
    v_exp_f32 v16, v108
    v_mfma_f32_16x16x32_bf16 a[160:163], v[92:95], v[36:39], a[160:163]
    s_mov_b32 m0, s56
    v_add_f32 v6, v6, v18
    v_add_f32 v6, v6, v19
    v_mfma_f32_16x16x32_bf16 a[160:163], v[76:79], v[32:35], a[160:163]
    s_waitcnt lgkmcnt(2)
    v_exp_f32 v17, v109
    v_mfma_f32_16x16x32_bf16 a[20:23], v[64:67], v[40:43], a[20:23]
    ds_read_b128 v[32:35], v1 offset:7168
    v_cvt_pk_bf16_f32 v173, v18, v19
    v_mfma_f32_16x16x32_bf16 a[20:23], v[80:83], v[44:47], a[20:23]
    buffer_load_dwordx4 v4, s[4:7], s27 offen offset:0 sc1 lds
    v_mfma_f32_16x16x32_bf16 a[68:71], v[84:87], v[44:47], a[68:71]
    v_exp_f32 v18, v110
    v_mfma_f32_16x16x32_bf16 a[68:71], v[68:71], v[40:43], a[68:71]
    v_add_f32 v6, v6, v16
    v_add_f32 v6, v6, v17
    v_mfma_f32_16x16x32_bf16 a[116:119], v[72:75], v[40:43], a[116:119]
    ds_read_b128 v[36:39], v1 offset:19456
    v_mov_b32 v22, 0x3f803f80
    v_mfma_f32_16x16x32_bf16 a[116:119], v[88:91], v[44:47], a[116:119]
    buffer_load_dwordx4 v4, s[4:7], s27 offen offset:1024 sc1 lds
    v_mfma_f32_16x16x32_bf16 a[164:167], v[92:95], v[44:47], a[164:167]
    v_exp_f32 v19, v111
    v_mfma_f32_16x16x32_bf16 a[164:167], v[76:79], v[40:43], a[164:167]
    s_waitcnt lgkmcnt(2)
    v_cvt_pk_bf16_f32 v174, v16, v17
    v_add_f32 v6, v6, v18
    v_mfma_f32_16x16x32_bf16 a[24:27], v[64:67], v[24:27], a[24:27]
    ds_read_b128 v[40:43], v1 offset:8192
    v_add_f32 v6, v6, v19
    v_mfma_f32_16x16x32_bf16 a[24:27], v[80:83], v[28:31], a[24:27]
    buffer_load_dwordx4 v4, s[4:7], s27 offen offset:2048 sc1 lds
    v_mfma_f32_16x16x32_bf16 a[72:75], v[84:87], v[28:31], a[72:75]
    v_cvt_pk_bf16_f32 v175, v18, v19
    v_mov_b32 v23, 0x3f803f80
    v_mfma_f32_16x16x32_bf16 a[72:75], v[68:71], v[24:27], a[72:75]
    v_exp_f32 v16, v176
    v_mfma_f32_16x16x32_bf16 a[120:123], v[72:75], v[24:27], a[120:123]
    ds_read_b128 v[44:47], v1 offset:20480
    v_mfma_f32_16x16x32_bf16 a[120:123], v[88:91], v[28:31], a[120:123]
    s_lshl_b32 s24, s95, 2
    v_exp_f32 v17, v177
    v_mfma_f32_16x16x32_bf16 a[168:171], v[92:95], v[28:31], a[168:171]
    s_add_u32 s27, s27, 24576
    v_exp_f32 v18, v178
    v_mfma_f32_16x16x32_bf16 a[168:171], v[76:79], v[24:27], a[168:171]
    s_waitcnt lgkmcnt(2)
    v_add_f32 v5, v5, v16
    v_add_f32 v5, v5, v17
    v_mfma_f32_16x16x32_bf16 a[28:31], v[64:67], v[32:35], a[28:31]
    s_add_u32 s56, s56, 12288
    ds_read_b128 v[24:27], v1 offset:9216
    v_mfma_f32_16x16x32_bf16 a[28:31], v[80:83], v[36:39], a[28:31]
    s_mov_b32 m0, s56
    v_exp_f32 v19, v179
    v_mfma_f32_16x16x32_bf16 a[76:79], v[84:87], v[36:39], a[76:79]
    v_cvt_pk_bf16_f32 v176, v16, v17
    v_mfma_f32_16x16x32_bf16 a[76:79], v[68:71], v[32:35], a[76:79]
    s_add_u32 s24, s24, s25
    v_exp_f32 v16, v112
    v_mfma_f32_16x16x32_bf16 a[124:127], v[72:75], v[32:35], a[124:127]
    ds_read_b128 v[28:31], v1 offset:21504
    v_add_f32 v5, v5, v18
    v_mfma_f32_16x16x32_bf16 a[124:127], v[88:91], v[36:39], a[124:127]
    buffer_load_dwordx4 v4, s[4:7], s27 offen offset:0 sc1 lds
    v_mfma_f32_16x16x32_bf16 a[172:175], v[92:95], v[36:39], a[172:175]
L_pg11:
    s_cbranch_execz L_iwret
    v_add_f32 v5, v5, v19
    v_mfma_f32_16x16x32_bf16 a[172:175], v[76:79], v[32:35], a[172:175]
    s_waitcnt lgkmcnt(2)
    v_exp_f32 v17, v113
    v_mfma_f32_16x16x32_bf16 a[32:35], v[64:67], v[40:43], a[32:35]
    s_mul_i32 s24, s24, 24576
    ds_read_b128 v[32:35], v1 offset:10240
    v_cvt_pk_bf16_f32 v177, v18, v19
    v_mfma_f32_16x16x32_bf16 a[32:35], v[80:83], v[44:47], a[32:35]
    buffer_load_dwordx4 v4, s[4:7], s27 offen offset:1024 sc1 lds
    v_mfma_f32_16x16x32_bf16 a[80:83], v[84:87], v[44:47], a[80:83]
    v_exp_f32 v18, v114
    v_mfma_f32_16x16x32_bf16 a[80:83], v[68:71], v[40:43], a[80:83]
    v_add_f32 v5, v5, v16
    v_add_f32 v5, v5, v17
    v_mfma_f32_16x16x32_bf16 a[128:131], v[72:75], v[40:43], a[128:131]
    ds_read_b128 v[36:39], v1 offset:22528
    v_mfma_f32_16x16x32_bf16 a[128:131], v[88:91], v[44:47], a[128:131]
    buffer_load_dwordx4 v4, s[4:7], s27 offen offset:2048 sc1 lds
    v_mfma_f32_16x16x32_bf16 a[176:179], v[92:95], v[44:47], a[176:179]
    s_add_u32 s40, s24, 6144
    v_exp_f32 v19, v115
    v_mfma_f32_16x16x32_bf16 a[176:179], v[76:79], v[40:43], a[176:179]
    s_waitcnt lgkmcnt(2)
    v_cvt_pk_bf16_f32 v178, v16, v17
    v_mfma_f32_16x16x32_bf16 a[36:39], v[64:67], v[24:27], a[36:39]
    ds_read_b128 v[40:43], v1 offset:11264
    v_mfma_f32_16x16x32_bf16 a[36:39], v[80:83], v[28:31], a[36:39]
    v_exp_f32 v16, v180
    v_mfma_f32_16x16x32_bf16 a[84:87], v[84:87], v[28:31], a[84:87]
    v_add_f32 v5, v5, v18
    v_add_f32 v5, v5, v19
    v_mfma_f32_16x16x32_bf16 a[84:87], v[68:71], v[24:27], a[84:87]
    s_add_u32 s27, s27, 24576
    v_exp_f32 v17, v181
    v_mfma_f32_16x16x32_bf16 a[132:135], v[72:75], v[24:27], a[132:135]
    s_add_u32 s56, s56, 36864
    ds_read_b128 v[44:47], v1 offset:23552
    v_cvt_pk_bf16_f32 v179, v18, v19
    v_mfma_f32_16x16x32_bf16 a[132:135], v[88:91], v[28:31], a[132:135]
    s_waitcnt lgkmcnt(2)
    v_exp_f32 v18, v182
    v_mfma_f32_16x16x32_bf16 a[180:183], v[92:95], v[28:31], a[180:183]
    s_waitcnt vmcnt(12)
    v_add_f32 v6, v6, v16
    v_add_f32 v6, v6, v17
    v_mfma_f32_16x16x32_bf16 a[180:183], v[76:79], v[24:27], a[180:183]
    s_barrier
    v_add_u32 v2, 49152, v2
    v_add_u32 v3, 49152, v3
    v_mfma_f32_16x16x32_bf16 a[40:43], v[64:67], v[32:35], a[40:43]
    s_sub_u32 s58, s56, 147456
    ds_read_b128 v[24:27], v2 offset:0
    s_add_u32 s41, s24, 12288
    v_mfma_f32_16x16x32_bf16 a[40:43], v[80:83], v[36:39], a[40:43]
    s_min_u32 s56, s56, s58
    v_exp_f32 v19, v183
    v_mfma_f32_16x16x32_bf16 a[88:91], v[84:87], v[36:39], a[88:91]
    s_add_u32 s42, s24, 18432
    v_cvt_pk_bf16_f32 v180, v16, v17
    v_mfma_f32_16x16x32_bf16 a[88:91], v[68:71], v[32:35], a[88:91]
    v_exp_f32 v16, v116
    v_mfma_f32_16x16x32_bf16 a[136:139], v[72:75], v[32:35], a[136:139]
    ds_read_b128 v[28:31], v3 offset:0
    v_add_f32 v6, v6, v18
    v_mfma_f32_16x16x32_bf16 a[136:139], v[88:91], v[36:39], a[136:139]
    v_add_f32 v6, v6, v19
    v_mfma_f32_16x16x32_bf16 a[184:187], v[92:95], v[36:39], a[184:187]
    v_exp_f32 v17, v117
    v_mfma_f32_16x16x32_bf16 a[184:187], v[76:79], v[32:35], a[184:187]
    s_waitcnt lgkmcnt(2)
    v_cvt_pk_bf16_f32 v181, v18, v19
    v_mfma_f32_16x16x32_bf16 a[44:47], v[64:67], v[40:43], a[44:47]
    ds_read_b128 v[32:35], v2 offset:6144
    v_mfma_f32_16x16x32_bf16 a[44:47], v[80:83], v[44:47], a[44:47]
    v_exp_f32 v18, v118
    v_mfma_f32_16x16x32_bf16 a[92:95], v[84:87], v[44:47], a[92:95]
    v_add_f32 v6, v6, v16
    v_add_f32 v6, v6, v17
    v_mfma_f32_16x16x32_bf16 a[92:95], v[68:71], v[40:43], a[92:95]
    v_exp_f32 v19, v119
    v_mfma_f32_16x16x32_bf16 a[140:143], v[72:75], v[40:43], a[140:143]
    ds_read_b128 v[36:39], v3 offset:6144
    v_cvt_pk_bf16_f32 v182, v16, v17
    v_mfma_f32_16x16x32_bf16 a[140:143], v[88:91], v[44:47], a[140:143]
    v_add_f32 v6, v6, v18
    v_add_f32 v6, v6, v19
    v_mfma_f32_16x16x32_bf16 a[188:191], v[92:95], v[44:47], a[188:191]
    v_cvt_pk_bf16_f32 v183, v18, v19
    v_mfma_f32_16x16x32_bf16 a[188:191], v[76:79], v[40:43], a[188:191]
    s_waitcnt lgkmcnt(2)
    v_mfma_f32_16x16x32_bf16 v[64:67], v[24:27], a[192:195], v[128:131]
    ds_read_b128 v[40:43], v2 offset:128
    v_mfma_f32_16x16x32_bf16 v[64:67], v[28:31], a[196:199], v[64:67]
    v_exp_f32 v16, v184
    v_mfma_f32_16x16x32_bf16 v[68:71], v[28:31], a[220:223], v[132:135]
    ds_read_b128 v[44:47], v3 offset:128
    v_mfma_f32_16x16x32_bf16 v[68:71], v[24:27], a[216:219], v[68:71]
    s_waitcnt lgkmcnt(2)
    v_exp_f32 v17, v185
    v_mfma_f32_16x16x32_bf16 v[96:99], v[32:35], a[192:195], v[128:131]
    ds_read_b128 v[24:27], v2 offset:6272
    v_mfma_f32_16x16x32_bf16 v[96:99], v[36:39], a[196:199], v[96:99]
    v_exp_f32 v18, v186
    v_mfma_f32_16x16x32_bf16 v[100:103], v[36:39], a[220:223], v[132:135]
    ds_read_b128 v[28:31], v3 offset:6272
    v_add_f32 v5, v5, v16
    v_mfma_f32_16x16x32_bf16 v[100:103], v[32:35], a[216:219], v[100:103]
    s_waitcnt lgkmcnt(2)
    v_add_f32 v5, v5, v17
    v_mfma_f32_16x16x32_bf16 v[64:67], v[40:43], a[200:203], v[64:67]
    ds_read_b128 v[32:35], v2 offset:256
    v_mfma_f32_16x16x32_bf16 v[64:67], v[44:47], a[204:207], v[64:67]
    v_exp_f32 v19, v187
    v_mfma_f32_16x16x32_bf16 v[68:71], v[44:47], a[228:231], v[68:71]
    ds_read_b128 v[36:39], v3 offset:256
    v_cvt_pk_bf16_f32 v184, v16, v17
    v_mfma_f32_16x16x32_bf16 v[68:71], v[40:43], a[224:227], v[68:71]
    s_waitcnt lgkmcnt(2)
    v_exp_f32 v16, v120
    v_mfma_f32_16x16x32_bf16 v[96:99], v[24:27], a[200:203], v[96:99]
    ds_read_b128 v[40:43], v2 offset:6400
    v_add_f32 v5, v5, v18
    v_mfma_f32_16x16x32_bf16 v[96:99], v[28:31], a[204:207], v[96:99]
    s_waitcnt vmcnt(0)
    v_add_f32 v5, v5, v19
    v_mfma_f32_16x16x32_bf16 v[100:103], v[28:31], a[228:231], v[100:103]
    ds_read_b128 v[44:47], v3 offset:6400
    v_mfma_f32_16x16x32_bf16 v[100:103], v[24:27], a[224:227], v[100:103]
    s_waitcnt lgkmcnt(2)
    s_barrier
    v_mfma_f32_16x16x32_bf16 v[64:67], v[32:35], a[208:211], v[64:67]
    s_mov_b32 m0, s56
    ds_read_b128 v[24:27], v2 offset:12288
    v_mfma_f32_16x16x32_bf16 v[64:67], v[36:39], a[212:215], v[64:67]
    buffer_load_dwordx4 v4, s[4:7], s27 offen offset:0 sc1 lds
    v_mfma_f32_16x16x32_bf16 v[68:71], v[36:39], a[236:239], v[68:71]
    ds_read_b128 v[28:31], v3 offset:12288
    v_mfma_f32_16x16x32_bf16 v[68:71], v[32:35], a[232:235], v[68:71]
    s_waitcnt lgkmcnt(2)
    v_exp_f32 v17, v121
    v_cvt_pk_bf16_f32 v185, v18, v19
    v_mfma_f32_16x16x32_bf16 v[96:99], v[40:43], a[208:211], v[96:99]
    ds_read_b128 v[32:35], v2 offset:18432
    v_mfma_f32_16x16x32_bf16 v[96:99], v[44:47], a[212:215], v[96:99]
    buffer_load_dwordx4 v4, s[4:7], s27 offen offset:1024 sc1 lds
    v_mfma_f32_16x16x32_bf16 v[100:103], v[44:47], a[236:239], v[100:103]
    ds_read_b128 v[36:39], v3 offset:18432
    v_mfma_f32_16x16x32_bf16 v[100:103], v[40:43], a[232:235], v[100:103]
    s_waitcnt lgkmcnt(2)
    v_exp_f32 v18, v122
    v_add_f32 v5, v5, v16
    v_mfma_f32_16x16x32_bf16 v[72:75], v[24:27], a[192:195], v[128:131]
    ds_read_b128 v[40:43], v2 offset:12416
    v_add_f32 v5, v5, v17
    v_mfma_f32_16x16x32_bf16 v[72:75], v[28:31], a[196:199], v[72:75]
    v_exp_f32 v19, v123
    v_cvt_pk_bf16_f32 v186, v16, v17
    v_mfma_f32_16x16x32_bf16 v[76:79], v[28:31], a[220:223], v[132:135]
    ds_read_b128 v[44:47], v3 offset:12416
    v_mfma_f32_16x16x32_bf16 v[76:79], v[24:27], a[216:219], v[76:79]
    s_waitcnt lgkmcnt(2)
    buffer_load_dwordx4 v4, s[4:7], s27 offen offset:2048 sc1 lds
    v_mfma_f32_16x16x32_bf16 v[104:107], v[32:35], a[192:195], v[128:131]
    ds_read_b128 v[24:27], v2 offset:18560
    v_mfma_f32_16x16x32_bf16 v[104:107], v[36:39], a[196:199], v[104:107]
    v_exp_f32 v16, v188
    v_add_f32 v5, v5, v18
    v_mfma_f32_16x16x32_bf16 v[108:111], v[36:39], a[220:223], v[132:135]
    ds_read_b128 v[28:31], v3 offset:18560
    v_add_f32 v5, v5, v19
    v_mfma_f32_16x16x32_bf16 v[108:111], v[32:35], a[216:219], v[108:111]
    s_waitcnt lgkmcnt(2)
    v_exp_f32 v17, v189
    v_cvt_pk_bf16_f32 v187, v18, v19
    v_mfma_f32_16x16x32_bf16 v[72:75], v[40:43], a[200:203], v[72:75]
    s_add_u32 s27, s27, 24576
    ds_read_b128 v[32:35], v2 offset:12544
    v_mfma_f32_16x16x32_bf16 v[72:75], v[44:47], a[204:207], v[72:75]
    v_exp_f32 v18, v190
    v_mfma_f32_16x16x32_bf16 v[76:79], v[44:47], a[228:231], v[76:79]
    s_add_u32 s56, s56, 12288
    ds_read_b128 v[36:39], v3 offset:12544
    v_add_f32 v6, v6, v16
    v_mfma_f32_16x16x32_bf16 v[76:79], v[40:43], a[224:227], v[76:79]
    s_waitcnt lgkmcnt(2)
    v_add_f32 v6, v6, v17
    v_mfma_f32_16x16x32_bf16 v[104:107], v[24:27], a[200:203], v[104:107]
    ds_read_b128 v[40:43], v2 offset:18688
    v_mfma_f32_16x16x32_bf16 v[104:107], v[28:31], a[204:207], v[104:107]
    v_exp_f32 v19, v191
    v_cvt_pk_bf16_f32 v188, v16, v17
    v_mfma_f32_16x16x32_bf16 v[108:111], v[28:31], a[228:231], v[108:111]
    s_mov_b32 m0, s56
    ds_read_b128 v[44:47], v3 offset:18688
    v_mfma_f32_16x16x32_bf16 v[108:111], v[24:27], a[224:227], v[108:111]
    s_waitcnt lgkmcnt(2)
    v_add_u32 v2, 49152, v2
    v_add_u32 v3, 49152, v3
    v_mfma_f32_16x16x32_bf16 v[72:75], v[32:35], a[208:211], v[72:75]
    ds_read_b128 v[24:27], v2 offset:0
    v_mfma_f32_16x16x32_bf16 v[72:75], v[36:39], a[212:215], v[72:75]
    buffer_load_dwordx4 v4, s[4:7], s27 offen offset:0 sc1 lds
    v_mfma_f32_16x16x32_bf16 v[76:79], v[36:39], a[236:239], v[76:79]
    ds_read_b128 v[28:31], v3 offset:0
    v_mfma_f32_16x16x32_bf16 v[76:79], v[32:35], a[232:235], v[76:79]
    s_waitcnt lgkmcnt(2)
    v_exp_f32 v16, v124
    v_add_f32 v6, v6, v18
    v_mfma_f32_16x16x32_bf16 v[104:107], v[40:43], a[208:211], v[104:107]
    ds_read_b128 v[32:35], v2 offset:6144
    v_add_f32 v6, v6, v19
    v_mfma_f32_16x16x32_bf16 v[104:107], v[44:47], a[212:215], v[104:107]
    v_exp_f32 v17, v125
    v_cvt_pk_bf16_f32 v189, v18, v19
    v_mfma_f32_16x16x32_bf16 v[108:111], v[44:47], a[236:239], v[108:111]
    ds_read_b128 v[36:39], v3 offset:6144
    v_mfma_f32_16x16x32_bf16 v[108:111], v[40:43], a[232:235], v[108:111]
    s_waitcnt lgkmcnt(2)
    buffer_load_dwordx4 v4, s[4:7], s27 offen offset:1024 sc1 lds
    v_mfma_f32_16x16x32_bf16 v[80:83], v[24:27], a[240:243], v[136:139]
    ds_read_b128 v[40:43], v2 offset:128
    v_mfma_f32_16x16x32_bf16 v[80:83], v[28:31], a[244:247], v[80:83]
    v_exp_f32 v18, v126
    v_add_f32 v6, v6, v16
    v_mfma_f32_16x16x32_bf16 v[84:87], v[28:31], v[204:207], v[140:143]
    ds_read_b128 v[44:47], v3 offset:128
    v_add_f32 v6, v6, v17
    v_exp_f32 v19, v127
    v_cvt_pk_bf16_f32 v190, v16, v17
    v_add_f32 v6, v6, v18
    v_add_f32 v6, v6, v19
    v_cvt_pk_bf16_f32 v191, v18, v19
    v_mfma_f32_16x16x32_bf16 v[84:87], v[24:27], v[200:203], v[84:87]
    s_waitcnt lgkmcnt(2)
    v_exp_f32 v16, v64
    v_mfma_f32_16x16x32_bf16 v[112:115], v[32:35], a[240:243], v[136:139]
    ds_read_b128 v[24:27], v2 offset:6272
    v_mfma_f32_16x16x32_bf16 v[112:115], v[36:39], a[244:247], v[112:115]
    buffer_load_dwordx4 v4, s[4:7], s27 offen offset:2048 sc1 lds
    v_mfma_f32_16x16x32_bf16 v[116:119], v[36:39], v[204:207], v[140:143]
    ds_read_b128 v[28:31], v3 offset:6272
    v_mfma_f32_16x16x32_bf16 v[116:119], v[32:35], v[200:203], v[116:119]
    s_waitcnt lgkmcnt(2)
    v_exp_f32 v17, v65
    v_mfma_f32_16x16x32_bf16 v[80:83], v[40:43], a[248:251], v[80:83]
    ds_read_b128 v[32:35], v2 offset:256
    v_mfma_f32_16x16x32_bf16 v[80:83], v[44:47], a[252:255], v[80:83]
    v_exp_f32 v18, v66
    v_mfma_f32_16x16x32_bf16 v[84:87], v[44:47], v[212:215], v[84:87]
    ds_read_b128 v[36:39], v3 offset:256
    v_add_f32 v5, v5, v16
    v_mfma_f32_16x16x32_bf16 v[84:87], v[40:43], v[208:211], v[84:87]
    s_waitcnt lgkmcnt(2)
    v_add_f32 v5, v5, v17
    v_mfma_f32_16x16x32_bf16 v[112:115], v[24:27], a[248:251], v[112:115]
    ds_read_b128 v[40:43], v2 offset:6400
    v_mfma_f32_16x16x32_bf16 v[112:115], v[28:31], a[252:255], v[112:115]
    v_exp_f32 v19, v67
    v_cvt_pk_bf16_f32 v64, v16, v17
    v_mfma_f32_16x16x32_bf16 v[116:119], v[28:31], v[212:215], v[116:119]
    s_add_u32 s27, s27, 24576
    ds_read_b128 v[44:47], v3 offset:6400
    s_add_u32 s56, s56, 36864
    v_mfma_f32_16x16x32_bf16 v[116:119], v[24:27], v[208:211], v[116:119]
    s_waitcnt lgkmcnt(2)
    v_exp_f32 v16, v96
    v_mfma_f32_16x16x32_bf16 v[80:83], v[32:35], v[192:195], v[80:83]
    s_sub_u32 s58, s56, 147456
    ds_read_b128 v[24:27], v2 offset:12288
    v_add_f32 v5, v5, v18
    v_mfma_f32_16x16x32_bf16 v[80:83], v[36:39], v[196:199], v[80:83]
    s_min_u32 s56, s56, s58
    v_add_f32 v5, v5, v19
    v_mfma_f32_16x16x32_bf16 v[84:87], v[36:39], v[220:223], v[84:87]
    ds_read_b128 v[28:31], v3 offset:12288
    v_mfma_f32_16x16x32_bf16 v[84:87], v[32:35], v[216:219], v[84:87]
    s_waitcnt lgkmcnt(2)
    v_exp_f32 v17, v97
    v_cvt_pk_bf16_f32 v65, v18, v19
    v_mfma_f32_16x16x32_bf16 v[112:115], v[40:43], v[192:195], v[112:115]
    ds_read_b128 v[32:35], v2 offset:18432
    v_mfma_f32_16x16x32_bf16 v[112:115], v[44:47], v[196:199], v[112:115]
    v_exp_f32 v18, v98
    v_mfma_f32_16x16x32_bf16 v[116:119], v[44:47], v[220:223], v[116:119]
    ds_read_b128 v[36:39], v3 offset:18432
    v_add_f32 v5, v5, v16
    v_mfma_f32_16x16x32_bf16 v[116:119], v[40:43], v[216:219], v[116:119]
    s_waitcnt lgkmcnt(2)
    v_add_f32 v5, v5, v17
    v_mfma_f32_16x16x32_bf16 v[88:91], v[24:27], a[240:243], v[136:139]
    ds_read_b128 v[40:43], v2 offset:12416
    v_mfma_f32_16x16x32_bf16 v[88:91], v[28:31], a[244:247], v[88:91]
    v_exp_f32 v19, v99
    v_cvt_pk_bf16_f32 v66, v16, v17
    v_mfma_f32_16x16x32_bf16 v[92:95], v[28:31], v[204:207], v[140:143]
    ds_read_b128 v[44:47], v3 offset:12416
    v_mfma_f32_16x16x32_bf16 v[92:95], v[24:27], v[200:203], v[92:95]
    s_waitcnt lgkmcnt(2)
    v_exp_f32 v16, v68
    v_mfma_f32_16x16x32_bf16 v[120:123], v[32:35], a[240:243], v[136:139]
    ds_read_b128 v[24:27], v2 offset:18560
    v_add_f32 v5, v5, v18
    v_mfma_f32_16x16x32_bf16 v[120:123], v[36:39], a[244:247], v[120:123]
    v_add_f32 v5, v5, v19
    v_mfma_f32_16x16x32_bf16 v[124:127], v[36:39], v[204:207], v[140:143]
    ds_read_b128 v[28:31], v3 offset:18560
    v_mfma_f32_16x16x32_bf16 v[124:127], v[32:35], v[200:203], v[124:127]
    s_waitcnt lgkmcnt(2)
    v_exp_f32 v17, v69
    v_cvt_pk_bf16_f32 v67, v18, v19
    v_mfma_f32_16x16x32_bf16 v[88:91], v[40:43], a[248:251], v[88:91]
    ds_read_b128 v[32:35], v2 offset:12544
    v_mfma_f32_16x16x32_bf16 v[88:91], v[44:47], a[252:255], v[88:91]
    v_exp_f32 v18, v70
    v_mfma_f32_16x16x32_bf16 v[92:95], v[44:47], v[212:215], v[92:95]
    ds_read_b128 v[36:39], v3 offset:12544
    v_add_f32 v6, v6, v16
    v_mfma_f32_16x16x32_bf16 v[92:95], v[40:43], v[208:211], v[92:95]
    s_waitcnt lgkmcnt(2)
    v_add_f32 v6, v6, v17
    v_mfma_f32_16x16x32_bf16 v[120:123], v[24:27], a[248:251], v[120:123]
    ds_read_b128 v[40:43], v2 offset:18688
    v_mfma_f32_16x16x32_bf16 v[120:123], v[28:31], a[252:255], v[120:123]
    v_exp_f32 v19, v71
    v_cvt_pk_bf16_f32 v68, v16, v17
    v_mfma_f32_16x16x32_bf16 v[124:127], v[28:31], v[212:215], v[124:127]
    ds_read_b128 v[44:47], v3 offset:18688
    v_mfma_f32_16x16x32_bf16 v[124:127], v[24:27], v[208:211], v[124:127]
    s_waitcnt lgkmcnt(2)
    v_add_u32 v1, 49152, v1
    v_exp_f32 v16, v100
    v_mfma_f32_16x16x32_bf16 v[88:91], v[32:35], v[192:195], v[88:91]
    ds_read_b128 v[24:27], v1 offset:0
    v_add_f32 v6, v6, v18
    v_mfma_f32_16x16x32_bf16 v[88:91], v[36:39], v[196:199], v[88:91]
    v_add_f32 v6, v6, v19
    v_mfma_f32_16x16x32_bf16 v[92:95], v[36:39], v[220:223], v[92:95]
    ds_read_b128 v[28:31], v1 offset:12288
    v_mfma_f32_16x16x32_bf16 v[92:95], v[32:35], v[216:219], v[92:95]
    s_waitcnt lgkmcnt(2)
    v_exp_f32 v17, v101
    v_cvt_pk_bf16_f32 v69, v18, v19
    v_mfma_f32_16x16x32_bf16 v[120:123], v[40:43], v[192:195], v[120:123]
    ds_read_b128 v[32:35], v1 offset:1024
    v_mfma_f32_16x16x32_bf16 v[120:123], v[44:47], v[196:199], v[120:123]
    v_exp_f32 v18, v102
    v_mfma_f32_16x16x32_bf16 v[124:127], v[44:47], v[220:223], v[124:127]
    ds_read_b128 v[36:39], v1 offset:13312
    v_add_f32 v6, v6, v16
    v_mfma_f32_16x16x32_bf16 v[124:127], v[40:43], v[216:219], v[124:127]
    s_waitcnt lgkmcnt(2)
    v_add_f32 v6, v6, v17
    v_exp_f32 v19, v103
    v_cvt_pk_bf16_f32 v70, v16, v17
    v_add_f32 v6, v6, v18
    v_add_f32 v6, v6, v19
    v_cvt_pk_bf16_f32 v71, v18, v19
    v_mfma_f32_16x16x32_bf16 a[0:3], v[160:163], v[24:27], a[0:3]
    ds_read_b128 v[40:43], v1 offset:2048
    v_mfma_f32_16x16x32_bf16 a[0:3], v[168:171], v[28:31], a[0:3]
    v_exp_f32 v16, v72
    v_mfma_f32_16x16x32_bf16 a[48:51], v[172:175], v[28:31], a[48:51]
    ds_read_b128 v[44:47], v1 offset:14336
    v_mfma_f32_16x16x32_bf16 a[48:51], v[164:167], v[24:27], a[48:51]
    s_waitcnt lgkmcnt(2)
    v_exp_f32 v17, v73
    v_mfma_f32_16x16x32_bf16 a[4:7], v[160:163], v[32:35], a[4:7]
    ds_read_b128 v[24:27], v1 offset:3072
    v_mfma_f32_16x16x32_bf16 a[4:7], v[168:171], v[36:39], a[4:7]
    v_exp_f32 v18, v74
    v_mfma_f32_16x16x32_bf16 a[52:55], v[172:175], v[36:39], a[52:55]
    ds_read_b128 v[28:31], v1 offset:15360
    v_add_f32 v5, v5, v16
    v_mfma_f32_16x16x32_bf16 a[52:55], v[164:167], v[32:35], a[52:55]
    s_waitcnt lgkmcnt(2)
    v_add_f32 v5, v5, v17
    v_mfma_f32_16x16x32_bf16 a[8:11], v[160:163], v[40:43], a[8:11]
    ds_read_b128 v[32:35], v1 offset:4096
    v_mfma_f32_16x16x32_bf16 a[8:11], v[168:171], v[44:47], a[8:11]
    v_exp_f32 v19, v75
    v_mfma_f32_16x16x32_bf16 a[56:59], v[172:175], v[44:47], a[56:59]
    ds_read_b128 v[36:39], v1 offset:16384
    v_cvt_pk_bf16_f32 v72, v16, v17
    v_mfma_f32_16x16x32_bf16 a[56:59], v[164:167], v[40:43], a[56:59]
    s_waitcnt lgkmcnt(2)
    v_exp_f32 v16, v104
    v_mfma_f32_16x16x32_bf16 a[12:15], v[160:163], v[24:27], a[12:15]
    ds_read_b128 v[40:43], v1 offset:5120
    v_add_f32 v5, v5, v18
    v_mfma_f32_16x16x32_bf16 a[12:15], v[168:171], v[28:31], a[12:15]
    v_add_f32 v5, v5, v19
    v_mfma_f32_16x16x32_bf16 a[60:63], v[172:175], v[28:31], a[60:63]
    ds_read_b128 v[44:47], v1 offset:17408
    v_mfma_f32_16x16x32_bf16 a[60:63], v[164:167], v[24:27], a[60:63]
    s_waitcnt lgkmcnt(2)
    v_exp_f32 v17, v105
    v_mfma_f32_16x16x32_bf16 a[16:19], v[160:163], v[32:35], a[16:19]
    ds_read_b128 v[24:27], v1 offset:6144
    v_cvt_pk_bf16_f32 v73, v18, v19
    v_mfma_f32_16x16x32_bf16 a[16:19], v[168:171], v[36:39], a[16:19]
    v_exp_f32 v18, v106
    v_mfma_f32_16x16x32_bf16 a[64:67], v[172:175], v[36:39], a[64:67]
    ds_read_b128 v[28:31], v1 offset:18432
    v_add_f32 v5, v5, v16
    v_mfma_f32_16x16x32_bf16 a[64:67], v[164:167], v[32:35], a[64:67]
    s_waitcnt lgkmcnt(2)
    v_add_f32 v5, v5, v17
    v_mfma_f32_16x16x32_bf16 a[20:23], v[160:163], v[40:43], a[20:23]
    ds_read_b128 v[32:35], v1 offset:7168
    v_mfma_f32_16x16x32_bf16 a[20:23], v[168:171], v[44:47], a[20:23]
    v_exp_f32 v19, v107
    v_mfma_f32_16x16x32_bf16 a[68:71], v[172:175], v[44:47], a[68:71]
    ds_read_b128 v[36:39], v1 offset:19456
    v_cvt_pk_bf16_f32 v74, v16, v17
    v_mfma_f32_16x16x32_bf16 a[68:71], v[164:167], v[40:43], a[68:71]
    s_waitcnt lgkmcnt(2)
    v_exp_f32 v16, v76
    v_mfma_f32_16x16x32_bf16 a[24:27], v[160:163], v[24:27], a[24:27]
    ds_read_b128 v[40:43], v1 offset:8192
    v_add_f32 v5, v5, v18
    v_mfma_f32_16x16x32_bf16 a[24:27], v[168:171], v[28:31], a[24:27]
    v_add_f32 v5, v5, v19
    v_mfma_f32_16x16x32_bf16 a[72:75], v[172:175], v[28:31], a[72:75]
    ds_read_b128 v[44:47], v1 offset:20480
    v_mfma_f32_16x16x32_bf16 a[72:75], v[164:167], v[24:27], a[72:75]
    s_waitcnt lgkmcnt(2)
    v_exp_f32 v17, v77
    v_mfma_f32_16x16x32_bf16 a[28:31], v[160:163], v[32:35], a[28:31]
    ds_read_b128 v[24:27], v1 offset:9216
    v_cvt_pk_bf16_f32 v75, v18, v19
    v_mfma_f32_16x16x32_bf16 a[28:31], v[168:171], v[36:39], a[28:31]
    v_exp_f32 v18, v78
    v_mfma_f32_16x16x32_bf16 a[76:79], v[172:175], v[36:39], a[76:79]
    ds_read_b128 v[28:31], v1 offset:21504
    v_add_f32 v6, v6, v16
    v_mfma_f32_16x16x32_bf16 a[76:79], v[164:167], v[32:35], a[76:79]
    s_waitcnt lgkmcnt(2)
    v_add_f32 v6, v6, v17
    v_mfma_f32_16x16x32_bf16 a[32:35], v[160:163], v[40:43], a[32:35]
    ds_read_b128 v[32:35], v1 offset:10240
    v_mfma_f32_16x16x32_bf16 a[32:35], v[168:171], v[44:47], a[32:35]
    v_exp_f32 v19, v79
    v_mfma_f32_16x16x32_bf16 a[80:83], v[172:175], v[44:47], a[80:83]
    ds_read_b128 v[36:39], v1 offset:22528
    v_cvt_pk_bf16_f32 v76, v16, v17
    v_mfma_f32_16x16x32_bf16 a[80:83], v[164:167], v[40:43], a[80:83]
    s_waitcnt lgkmcnt(2)
    v_exp_f32 v16, v108
    v_mfma_f32_16x16x32_bf16 a[36:39], v[160:163], v[24:27], a[36:39]
    ds_read_b128 v[40:43], v1 offset:11264
    v_add_f32 v6, v6, v18
    v_mfma_f32_16x16x32_bf16 a[36:39], v[168:171], v[28:31], a[36:39]
    v_add_f32 v6, v6, v19
    v_mfma_f32_16x16x32_bf16 a[84:87], v[172:175], v[28:31], a[84:87]
    ds_read_b128 v[44:47], v1 offset:23552
    v_mfma_f32_16x16x32_bf16 a[84:87], v[164:167], v[24:27], a[84:87]
    s_waitcnt lgkmcnt(2)
    v_subrev_u32 v1, 98304, v1
    v_mfma_f32_16x16x32_bf16 a[40:43], v[160:163], v[32:35], a[40:43]
    ds_read_b128 v[24:27], v1 offset:0
    v_mfma_f32_16x16x32_bf16 a[40:43], v[168:171], v[36:39], a[40:43]
    v_exp_f32 v17, v109
    v_mfma_f32_16x16x32_bf16 a[88:91], v[172:175], v[36:39], a[88:91]
    ds_read_b128 v[28:31], v1 offset:12288
    v_cvt_pk_bf16_f32 v77, v18, v19
    v_mfma_f32_16x16x32_bf16 a[88:91], v[164:167], v[32:35], a[88:91]
    s_waitcnt lgkmcnt(2)
    v_exp_f32 v18, v110
    v_mfma_f32_16x16x32_bf16 a[44:47], v[160:163], v[40:43], a[44:47]
    ds_read_b128 v[32:35], v1 offset:1024
    v_add_f32 v6, v6, v16
    v_mfma_f32_16x16x32_bf16 a[44:47], v[168:171], v[44:47], a[44:47]
    v_add_f32 v6, v6, v17
    v_mfma_f32_16x16x32_bf16 a[92:95], v[172:175], v[44:47], a[92:95]
    ds_read_b128 v[36:39], v1 offset:13312
    v_mfma_f32_16x16x32_bf16 a[92:95], v[164:167], v[40:43], a[92:95]
    s_waitcnt lgkmcnt(2)
    v_exp_f32 v19, v111
    v_mfma_f32_16x16x32_bf16 a[0:3], v[176:179], v[24:27], a[0:3]
    ds_read_b128 v[40:43], v1 offset:2048
    v_cvt_pk_bf16_f32 v78, v16, v17
    v_mfma_f32_16x16x32_bf16 a[0:3], v[184:187], v[28:31], a[0:3]
    v_add_f32 v6, v6, v18
    v_add_f32 v6, v6, v19
    v_mfma_f32_16x16x32_bf16 a[48:51], v[188:191], v[28:31], a[48:51]
    ds_read_b128 v[44:47], v1 offset:14336
    v_cvt_pk_bf16_f32 v79, v18, v19
    v_mfma_f32_16x16x32_bf16 a[48:51], v[180:183], v[24:27], a[48:51]
    s_waitcnt lgkmcnt(2)
    v_exp_f32 v16, v80
    v_mfma_f32_16x16x32_bf16 a[4:7], v[176:179], v[32:35], a[4:7]
    ds_read_b128 v[24:27], v1 offset:3072
    v_mfma_f32_16x16x32_bf16 a[4:7], v[184:187], v[36:39], a[4:7]
    v_exp_f32 v17, v81
    v_mfma_f32_16x16x32_bf16 a[52:55], v[188:191], v[36:39], a[52:55]
    ds_read_b128 v[28:31], v1 offset:15360
    v_mfma_f32_16x16x32_bf16 a[52:55], v[180:183], v[32:35], a[52:55]
    s_waitcnt lgkmcnt(2)
    v_exp_f32 v18, v82
    v_mfma_f32_16x16x32_bf16 a[8:11], v[176:179], v[40:43], a[8:11]
    ds_read_b128 v[32:35], v1 offset:4096
    v_add_f32 v7, v7, v16
    v_mfma_f32_16x16x32_bf16 a[8:11], v[184:187], v[44:47], a[8:11]
    v_add_f32 v7, v7, v17
    v_mfma_f32_16x16x32_bf16 a[56:59], v[188:191], v[44:47], a[56:59]
    ds_read_b128 v[36:39], v1 offset:16384
    v_mfma_f32_16x16x32_bf16 a[56:59], v[180:183], v[40:43], a[56:59]
    s_waitcnt lgkmcnt(2)
    v_exp_f32 v19, v83
    v_mfma_f32_16x16x32_bf16 a[12:15], v[176:179], v[24:27], a[12:15]
    ds_read_b128 v[40:43], v1 offset:5120
    v_cvt_pk_bf16_f32 v80, v16, v17
    v_mfma_f32_16x16x32_bf16 a[12:15], v[184:187], v[28:31], a[12:15]
    v_exp_f32 v16, v112
    v_mfma_f32_16x16x32_bf16 a[60:63], v[188:191], v[28:31], a[60:63]
    ds_read_b128 v[44:47], v1 offset:17408
    v_add_f32 v7, v7, v18
    v_mfma_f32_16x16x32_bf16 a[60:63], v[180:183], v[24:27], a[60:63]
    s_waitcnt lgkmcnt(2)
    v_add_f32 v7, v7, v19
    v_mfma_f32_16x16x32_bf16 a[16:19], v[176:179], v[32:35], a[16:19]
    ds_read_b128 v[24:27], v1 offset:6144
    v_mfma_f32_16x16x32_bf16 a[16:19], v[184:187], v[36:39], a[16:19]
    v_exp_f32 v17, v113
    v_mfma_f32_16x16x32_bf16 a[64:67], v[188:191], v[36:39], a[64:67]
    ds_read_b128 v[28:31], v1 offset:18432
    v_cvt_pk_bf16_f32 v81, v18, v19
    v_mfma_f32_16x16x32_bf16 a[64:67], v[180:183], v[32:35], a[64:67]
    s_waitcnt lgkmcnt(2)
    v_exp_f32 v18, v114
    v_mfma_f32_16x16x32_bf16 a[20:23], v[176:179], v[40:43], a[20:23]
    ds_read_b128 v[32:35], v1 offset:7168
    v_add_f32 v7, v7, v16
    v_mfma_f32_16x16x32_bf16 a[20:23], v[184:187], v[44:47], a[20:23]
    v_add_f32 v7, v7, v17
    v_mfma_f32_16x16x32_bf16 a[68:71], v[188:191], v[44:47], a[68:71]
    ds_read_b128 v[36:39], v1 offset:19456
    v_mfma_f32_16x16x32_bf16 a[68:71], v[180:183], v[40:43], a[68:71]
    s_waitcnt lgkmcnt(2)
    v_exp_f32 v19, v115
    v_mfma_f32_16x16x32_bf16 a[24:27], v[176:179], v[24:27], a[24:27]
    ds_read_b128 v[40:43], v1 offset:8192
    v_cvt_pk_bf16_f32 v82, v16, v17
    v_mfma_f32_16x16x32_bf16 a[24:27], v[184:187], v[28:31], a[24:27]
    v_exp_f32 v16, v84
    v_mfma_f32_16x16x32_bf16 a[72:75], v[188:191], v[28:31], a[72:75]
    ds_read_b128 v[44:47], v1 offset:20480
    v_add_f32 v7, v7, v18
    v_mfma_f32_16x16x32_bf16 a[72:75], v[180:183], v[24:27], a[72:75]
    s_waitcnt lgkmcnt(2)
    v_add_f32 v7, v7, v19
    v_mfma_f32_16x16x32_bf16 a[28:31], v[176:179], v[32:35], a[28:31]
    ds_read_b128 v[24:27], v1 offset:9216
    v_mfma_f32_16x16x32_bf16 a[28:31], v[184:187], v[36:39], a[28:31]
    s_waitcnt vmcnt(0)
    v_exp_f32 v17, v85
    v_mfma_f32_16x16x32_bf16 a[76:79], v[188:191], v[36:39], a[76:79]
    ds_read_b128 v[28:31], v1 offset:21504
    v_cvt_pk_bf16_f32 v83, v18, v19
    v_mfma_f32_16x16x32_bf16 a[76:79], v[180:183], v[32:35], a[76:79]
    s_waitcnt lgkmcnt(2)
    s_barrier
    v_mfma_f32_16x16x32_bf16 a[32:35], v[176:179], v[40:43], a[32:35]
    ds_read_b128 v[32:35], v1 offset:10240
    v_mfma_f32_16x16x32_bf16 a[32:35], v[184:187], v[44:47], a[32:35]
    v_exp_f32 v18, v86
    v_mfma_f32_16x16x32_bf16 a[80:83], v[188:191], v[44:47], a[80:83]
    ds_read_b128 v[36:39], v1 offset:22528
    v_add_f32 v8, v8, v16
    v_mfma_f32_16x16x32_bf16 a[80:83], v[180:183], v[40:43], a[80:83]
    s_waitcnt lgkmcnt(2)
    v_add_f32 v8, v8, v17
    v_mfma_f32_16x16x32_bf16 a[36:39], v[176:179], v[24:27], a[36:39]
    ds_read_b128 v[40:43], v1 offset:11264
    v_mfma_f32_16x16x32_bf16 a[36:39], v[184:187], v[28:31], a[36:39]
    v_exp_f32 v19, v87
    v_cvt_pk_bf16_f32 v84, v16, v17
    v_mfma_f32_16x16x32_bf16 a[84:87], v[188:191], v[28:31], a[84:87]
    ds_read_b128 v[44:47], v1 offset:23552
    v_mfma_f32_16x16x32_bf16 a[84:87], v[180:183], v[24:27], a[84:87]
    s_waitcnt lgkmcnt(2)
    v_add_u32 v1, 49152, v1
    v_exp_f32 v16, v116
    v_mfma_f32_16x16x32_bf16 a[40:43], v[176:179], v[32:35], a[40:43]
    ds_read_b128 v[24:27], v1 offset:0
    v_add_f32 v8, v8, v18
    v_mfma_f32_16x16x32_bf16 a[40:43], v[184:187], v[36:39], a[40:43]
    v_add_f32 v8, v8, v19
    v_mfma_f32_16x16x32_bf16 a[88:91], v[188:191], v[36:39], a[88:91]
    ds_read_b128 v[28:31], v1 offset:12288
    v_mfma_f32_16x16x32_bf16 a[88:91], v[180:183], v[32:35], a[88:91]
    s_waitcnt lgkmcnt(2)
    v_exp_f32 v17, v117
    v_cvt_pk_bf16_f32 v85, v18, v19
    v_mfma_f32_16x16x32_bf16 a[44:47], v[176:179], v[40:43], a[44:47]
    ds_read_b128 v[32:35], v1 offset:1024
    v_mfma_f32_16x16x32_bf16 a[44:47], v[184:187], v[44:47], a[44:47]
    v_exp_f32 v18, v118
    v_mfma_f32_16x16x32_bf16 a[92:95], v[188:191], v[44:47], a[92:95]
    ds_read_b128 v[36:39], v1 offset:13312
    v_add_f32 v8, v8, v16
    v_mfma_f32_16x16x32_bf16 a[92:95], v[180:183], v[40:43], a[92:95]
    s_waitcnt lgkmcnt(2)
    v_add_f32 v8, v8, v17
    v_exp_f32 v19, v119
    v_cvt_pk_bf16_f32 v86, v16, v17
    v_add_f32 v8, v8, v18
    v_add_f32 v8, v8, v19
    v_cvt_pk_bf16_f32 v87, v18, v19
    v_mfma_f32_16x16x32_bf16 a[0:3], v[64:67], v[24:27], a[0:3]
    ds_read_b128 v[40:43], v1 offset:2048
    v_mfma_f32_16x16x32_bf16 a[0:3], v[72:75], v[28:31], a[0:3]
    v_exp_f32 v16, v88
    v_exp_f32 v17, v89
    v_exp_f32 v18, v90
    v_mfma_f32_16x16x4_f32 v[48:51], v5, v57, 0
    v_mfma_f32_16x16x32_bf16 a[48:51], v[76:79], v[28:31], a[48:51]
    ds_read_b128 v[44:47], v1 offset:14336
    v_mfma_f32_16x16x32_bf16 a[48:51], v[68:71], v[24:27], a[48:51]
L_pg12:
    s_cbranch_execz L_iwret
    s_waitcnt lgkmcnt(2)
    v_exp_f32 v19, v91
    v_cvt_pk_bf16_f32 v88, v16, v17
    v_exp_f32 v16, v120
    v_mfma_f32_16x16x4_f32 v[52:55], v6, v57, 0
    v_mfma_f32_16x16x32_bf16 a[4:7], v[64:67], v[32:35], a[4:7]
    ds_read_b128 v[24:27], v1 offset:3072
    v_mfma_f32_16x16x32_bf16 a[4:7], v[72:75], v[36:39], a[4:7]
    v_exp_f32 v17, v121
    v_cvt_pk_bf16_f32 v89, v18, v19
    v_mfma_f32_16x16x32_bf16 a[52:55], v[76:79], v[36:39], a[52:55]
    ds_read_b128 v[28:31], v1 offset:15360
    v_mfma_f32_16x16x32_bf16 a[52:55], v[68:71], v[32:35], a[52:55]
    s_waitcnt lgkmcnt(2)
    v_exp_f32 v18, v122
    v_mfma_f32_16x16x32_bf16 a[8:11], v[64:67], v[40:43], a[8:11]
    ds_read_b128 v[32:35], v1 offset:4096
    v_mfma_f32_16x16x32_bf16 a[8:11], v[72:75], v[44:47], a[8:11]
    v_exp_f32 v19, v123
    v_mfma_f32_16x16x32_bf16 a[56:59], v[76:79], v[44:47], a[56:59]
    ds_read_b128 v[36:39], v1 offset:16384
    v_cvt_pk_bf16_f32 v90, v16, v17
    v_mfma_f32_16x16x32_bf16 a[56:59], v[68:71], v[40:43], a[56:59]
    s_waitcnt lgkmcnt(2)
    v_exp_f32 v16, v92
    v_mfma_f32_16x16x32_bf16 a[12:15], v[64:67], v[24:27], a[12:15]
    ds_read_b128 v[40:43], v1 offset:5120
    v_mfma_f32_16x16x32_bf16 a[12:15], v[72:75], v[28:31], a[12:15]
    v_exp_f32 v17, v93
    v_mfma_f32_16x16x32_bf16 a[60:63], v[76:79], v[28:31], a[60:63]
    ds_read_b128 v[44:47], v1 offset:17408
    v_cvt_pk_bf16_f32 v91, v18, v19
    v_mfma_f32_16x16x32_bf16 a[60:63], v[68:71], v[24:27], a[60:63]
    s_waitcnt lgkmcnt(2)
    v_exp_f32 v18, v94
    v_mfma_f32_16x16x32_bf16 a[16:19], v[64:67], v[32:35], a[16:19]
    ds_read_b128 v[24:27], v1 offset:6144
    v_mfma_f32_16x16x32_bf16 a[16:19], v[72:75], v[36:39], a[16:19]
    v_exp_f32 v19, v95
    v_mfma_f32_16x16x32_bf16 a[64:67], v[76:79], v[36:39], a[64:67]
    ds_read_b128 v[28:31], v1 offset:18432
    v_mfma_f32_16x16x32_bf16 a[64:67], v[68:71], v[32:35], a[64:67]
    s_waitcnt lgkmcnt(2)
    v_mfma_f32_16x16x32_bf16 v[128:131], v[88:91], v[20:23], 0
    v_mfma_f32_16x16x32_bf16 a[20:23], v[64:67], v[40:43], a[20:23]
    ds_read_b128 v[32:35], v1 offset:7168
    v_cvt_pk_bf16_f32 v92, v16, v17
    v_mfma_f32_16x16x32_bf16 a[20:23], v[72:75], v[44:47], a[20:23]
    v_exp_f32 v16, v124
    v_mfma_f32_16x16x32_bf16 a[68:71], v[76:79], v[44:47], a[68:71]
    ds_read_b128 v[36:39], v1 offset:19456
    v_mfma_f32_16x16x32_bf16 a[68:71], v[68:71], v[40:43], a[68:71]
    s_waitcnt lgkmcnt(2)
    v_exp_f32 v17, v125
    v_mfma_f32_16x16x32_bf16 a[24:27], v[64:67], v[24:27], a[24:27]
    ds_read_b128 v[40:43], v1 offset:8192
    v_cvt_pk_bf16_f32 v93, v18, v19
    v_mfma_f32_16x16x32_bf16 a[24:27], v[72:75], v[28:31], a[24:27]
    v_exp_f32 v18, v126
    v_mfma_f32_16x16x32_bf16 a[72:75], v[76:79], v[28:31], a[72:75]
    ds_read_b128 v[44:47], v1 offset:20480
    v_mfma_f32_16x16x32_bf16 a[72:75], v[68:71], v[24:27], a[72:75]
    s_waitcnt lgkmcnt(2)
    v_exp_f32 v19, v127
    v_mfma_f32_16x16x32_bf16 a[28:31], v[64:67], v[32:35], a[28:31]
    ds_read_b128 v[24:27], v1 offset:9216
    v_cvt_pk_bf16_f32 v94, v16, v17
    v_mfma_f32_16x16x32_bf16 a[28:31], v[72:75], v[36:39], a[28:31]
    v_cvt_pk_bf16_f32 v95, v18, v19
    s_nop 1
    v_mfma_f32_16x16x32_bf16 a[76:79], v[76:79], v[36:39], a[76:79]
    ds_read_b128 v[28:31], v1 offset:21504
    v_mfma_f32_16x16x32_bf16 a[76:79], v[68:71], v[32:35], a[76:79]
    s_waitcnt lgkmcnt(2)
    v_mfma_f32_16x16x32_bf16 v[132:135], v[92:95], v[20:23], 0
    v_mfma_f32_16x16x32_bf16 a[32:35], v[64:67], v[40:43], a[32:35]
    ds_read_b128 v[32:35], v1 offset:10240
    v_mfma_f32_16x16x32_bf16 a[32:35], v[72:75], v[44:47], a[32:35]
    v_rcp_f32 v48, v48
    v_mfma_f32_16x16x32_bf16 a[80:83], v[76:79], v[44:47], a[80:83]
    ds_read_b128 v[36:39], v1 offset:22528
    v_mfma_f32_16x16x32_bf16 a[80:83], v[68:71], v[40:43], a[80:83]
    s_waitcnt lgkmcnt(2)
    v_rcp_f32 v49, v49
    v_mfma_f32_16x16x32_bf16 a[36:39], v[64:67], v[24:27], a[36:39]
    ds_read_b128 v[40:43], v1 offset:11264
    v_mfma_f32_16x16x32_bf16 a[36:39], v[72:75], v[28:31], a[36:39]
    v_rcp_f32 v50, v50
    v_mfma_f32_16x16x32_bf16 a[84:87], v[76:79], v[28:31], a[84:87]
    ds_read_b128 v[44:47], v1 offset:23552
    v_mfma_f32_16x16x32_bf16 a[84:87], v[68:71], v[24:27], a[84:87]
    s_waitcnt lgkmcnt(2)
    v_subrev_u32 v2, 98304, v2
    v_subrev_u32 v3, 98304, v3
    v_mfma_f32_16x16x32_bf16 a[40:43], v[64:67], v[32:35], a[40:43]
    ds_read_b128 v[24:27], v2 offset:0
    v_mfma_f32_16x16x32_bf16 a[40:43], v[72:75], v[36:39], a[40:43]
    v_rcp_f32 v51, v51
    v_mfma_f32_16x16x32_bf16 a[88:91], v[76:79], v[36:39], a[88:91]
    ds_read_b128 v[28:31], v3 offset:0
    v_mfma_f32_16x16x32_bf16 a[88:91], v[68:71], v[32:35], a[88:91]
    s_waitcnt lgkmcnt(2)
    v_rcp_f32 v52, v52
    v_mfma_f32_16x16x32_bf16 a[44:47], v[64:67], v[40:43], a[44:47]
    ds_read_b128 v[32:35], v2 offset:6144
    v_mfma_f32_16x16x32_bf16 a[44:47], v[72:75], v[44:47], a[44:47]
    v_rcp_f32 v53, v53
    v_mfma_f32_16x16x32_bf16 a[92:95], v[76:79], v[44:47], a[92:95]
    ds_read_b128 v[36:39], v3 offset:6144
    v_mfma_f32_16x16x32_bf16 a[92:95], v[68:71], v[40:43], a[92:95]
    s_waitcnt lgkmcnt(2)
    v_rcp_f32 v54, v54
    v_mfma_f32_16x16x32_bf16 v[160:163], v[24:27], a[240:243], v[136:139]
    ds_read_b128 v[40:43], v2 offset:128
    v_mfma_f32_16x16x32_bf16 v[160:163], v[28:31], a[244:247], v[160:163]
    v_rcp_f32 v55, v55
    v_mfma_f32_16x16x32_bf16 v[164:167], v[28:31], v[204:207], v[140:143]
    ds_read_b128 v[44:47], v3 offset:128
    v_mfma_f32_16x16x32_bf16 v[164:167], v[24:27], v[200:203], v[164:167]
    s_waitcnt lgkmcnt(2)
    v_mfma_f32_16x16x32_bf16 v[96:99], v[32:35], a[240:243], v[136:139]
    ds_read_b128 v[24:27], v2 offset:6272
    v_accvgpr_read_b32 v224, a0
    v_mfma_f32_16x16x32_bf16 v[96:99], v[36:39], a[244:247], v[96:99]
    v_accvgpr_read_b32 v225, a4
    v_accvgpr_read_b32 v226, a8
    v_accvgpr_read_b32 v227, a12
    v_accvgpr_read_b32 v228, a16
    v_accvgpr_read_b32 v229, a20
    v_mfma_f32_16x16x32_bf16 v[100:103], v[36:39], v[204:207], v[140:143]
    ds_read_b128 v[28:31], v3 offset:6272
    v_mul_f32 v224, v224, v48
    v_mfma_f32_16x16x32_bf16 v[100:103], v[32:35], v[200:203], v[100:103]
    s_waitcnt lgkmcnt(2)
    v_mul_f32 v225, v225, v48
    v_mul_f32 v226, v226, v48
    v_mul_f32 v227, v227, v48
    v_mul_f32 v228, v228, v48
    v_mul_f32 v229, v229, v48
    v_mfma_f32_16x16x32_bf16 v[160:163], v[40:43], a[248:251], v[160:163]
    ds_read_b128 v[32:35], v2 offset:256
    v_cvt_pk_bf16_f32 v224, v224, v225
    v_mfma_f32_16x16x32_bf16 v[160:163], v[44:47], a[252:255], v[160:163]
    v_cvt_pk_bf16_f32 v225, v226, v227
    v_cvt_pk_bf16_f32 v226, v228, v229
    v_accvgpr_read_b32 v230, a1
    v_accvgpr_read_b32 v231, a5
    v_accvgpr_read_b32 v232, a9
    v_mfma_f32_16x16x32_bf16 v[164:167], v[44:47], v[212:215], v[164:167]
    ds_read_b128 v[36:39], v3 offset:256
    v_accvgpr_read_b32 v233, a13
    v_mfma_f32_16x16x32_bf16 v[164:167], v[40:43], v[208:211], v[164:167]
    s_waitcnt lgkmcnt(2)
    buffer_store_dwordx3 v[224:226], v56, s[12:15], s24 offen offset:0 sc0 sc1
    v_accvgpr_read_b32 v234, a17
    v_accvgpr_read_b32 v235, a21
    v_mfma_f32_16x16x32_bf16 v[96:99], v[24:27], a[248:251], v[96:99]
    ds_read_b128 v[40:43], v2 offset:6400
    v_mul_f32 v230, v230, v49
    v_mfma_f32_16x16x32_bf16 v[96:99], v[28:31], a[252:255], v[96:99]
    v_mul_f32 v231, v231, v49
    v_mul_f32 v232, v232, v49
    v_mul_f32 v233, v233, v49
    v_mul_f32 v234, v234, v49
    v_mul_f32 v235, v235, v49
    v_mfma_f32_16x16x32_bf16 v[100:103], v[28:31], v[212:215], v[100:103]
    ds_read_b128 v[44:47], v3 offset:6400
    v_cvt_pk_bf16_f32 v230, v230, v231
    v_mfma_f32_16x16x32_bf16 v[100:103], v[24:27], v[208:211], v[100:103]
    s_waitcnt lgkmcnt(2)
    v_cvt_pk_bf16_f32 v231, v232, v233
    v_cvt_pk_bf16_f32 v232, v234, v235
    v_accvgpr_read_b32 v236, a2
    v_accvgpr_read_b32 v237, a6
    v_accvgpr_read_b32 v238, a10
    v_mfma_f32_16x16x32_bf16 v[160:163], v[32:35], v[192:195], v[160:163]
    ds_read_b128 v[24:27], v2 offset:12288
    v_accvgpr_read_b32 v239, a14
    v_mfma_f32_16x16x32_bf16 v[160:163], v[36:39], v[196:199], v[160:163]
    buffer_store_dwordx3 v[230:232], v56, s[12:15], s24 offen offset:384 sc0 sc1
    v_accvgpr_read_b32 v240, a18
    v_accvgpr_read_b32 v241, a22
    v_mfma_f32_16x16x32_bf16 v[164:167], v[36:39], v[220:223], v[164:167]
    ds_read_b128 v[28:31], v3 offset:12288
    v_mul_f32 v236, v236, v50
    v_mfma_f32_16x16x32_bf16 v[164:167], v[32:35], v[216:219], v[164:167]
    s_waitcnt lgkmcnt(2)
    v_mul_f32 v237, v237, v50
    v_mul_f32 v238, v238, v50
    v_mul_f32 v239, v239, v50
    v_mul_f32 v240, v240, v50
    v_mul_f32 v241, v241, v50
    v_mfma_f32_16x16x32_bf16 v[96:99], v[40:43], v[192:195], v[96:99]
    ds_read_b128 v[32:35], v2 offset:18432
    v_cvt_pk_bf16_f32 v236, v236, v237
    v_mfma_f32_16x16x32_bf16 v[96:99], v[44:47], v[196:199], v[96:99]
    v_cvt_pk_bf16_f32 v237, v238, v239
    v_cvt_pk_bf16_f32 v238, v240, v241
    v_accvgpr_read_b32 v242, a3
    v_accvgpr_read_b32 v243, a7
    v_accvgpr_read_b32 v244, a11
    v_mfma_f32_16x16x32_bf16 v[100:103], v[44:47], v[220:223], v[100:103]
    ds_read_b128 v[36:39], v3 offset:18432
    v_accvgpr_read_b32 v245, a15
    v_mfma_f32_16x16x32_bf16 v[100:103], v[40:43], v[216:219], v[100:103]
    s_waitcnt lgkmcnt(2)
    buffer_store_dwordx3 v[236:238], v56, s[12:15], s24 offen offset:768 sc0 sc1
    v_accvgpr_read_b32 v246, a19
    v_accvgpr_read_b32 v247, a23
    v_mfma_f32_16x16x32_bf16 v[168:171], v[24:27], a[240:243], v[136:139]
    ds_read_b128 v[40:43], v2 offset:12416
    v_mul_f32 v242, v242, v51
    v_mfma_f32_16x16x32_bf16 v[168:171], v[28:31], a[244:247], v[168:171]
    v_mul_f32 v243, v243, v51
    v_mul_f32 v244, v244, v51
    v_mul_f32 v245, v245, v51
    v_mul_f32 v246, v246, v51
    v_mul_f32 v247, v247, v51
    v_mfma_f32_16x16x32_bf16 v[172:175], v[28:31], v[204:207], v[140:143]
    ds_read_b128 v[44:47], v3 offset:12416
    v_cvt_pk_bf16_f32 v242, v242, v243
    v_mfma_f32_16x16x32_bf16 v[172:175], v[24:27], v[200:203], v[172:175]
    s_waitcnt lgkmcnt(2)
    v_cvt_pk_bf16_f32 v243, v244, v245
    v_cvt_pk_bf16_f32 v244, v246, v247
    v_accvgpr_read_b32 v248, a24
    v_accvgpr_read_b32 v249, a28
    v_accvgpr_read_b32 v250, a32
    v_mfma_f32_16x16x32_bf16 v[104:107], v[32:35], a[240:243], v[136:139]
    ds_read_b128 v[24:27], v2 offset:18560
    v_accvgpr_read_b32 v251, a36
    v_mfma_f32_16x16x32_bf16 v[104:107], v[36:39], a[244:247], v[104:107]
    buffer_store_dwordx3 v[242:244], v56, s[12:15], s24 offen offset:1152 sc0 sc1
    v_accvgpr_read_b32 v252, a40
    v_accvgpr_read_b32 v253, a44
    v_mfma_f32_16x16x32_bf16 v[108:111], v[36:39], v[204:207], v[140:143]
    ds_read_b128 v[28:31], v3 offset:18560
    v_mul_f32 v248, v248, v48
    v_mfma_f32_16x16x32_bf16 v[108:111], v[32:35], v[200:203], v[108:111]
    s_waitcnt lgkmcnt(2)
    v_mul_f32 v249, v249, v48
    v_mul_f32 v250, v250, v48
    v_mul_f32 v251, v251, v48
    v_mul_f32 v252, v252, v48
    v_mul_f32 v253, v253, v48
    v_mfma_f32_16x16x32_bf16 v[168:171], v[40:43], a[248:251], v[168:171]
    ds_read_b128 v[32:35], v2 offset:12544
    v_cvt_pk_bf16_f32 v248, v248, v249
    v_mfma_f32_16x16x32_bf16 v[168:171], v[44:47], a[252:255], v[168:171]
    v_cvt_pk_bf16_f32 v249, v250, v251
    v_cvt_pk_bf16_f32 v250, v252, v253
    v_accvgpr_read_b32 v224, a25
    v_accvgpr_read_b32 v225, a29
    v_accvgpr_read_b32 v226, a33
    v_mfma_f32_16x16x32_bf16 v[172:175], v[44:47], v[212:215], v[172:175]
    ds_read_b128 v[36:39], v3 offset:12544
    v_accvgpr_read_b32 v227, a37
    v_mfma_f32_16x16x32_bf16 v[172:175], v[40:43], v[208:211], v[172:175]
    s_waitcnt lgkmcnt(2)
    buffer_store_dwordx3 v[248:250], v56, s[12:15], s24 offen offset:192 sc0 sc1
    v_accvgpr_read_b32 v228, a41
    v_mfma_f32_16x16x32_bf16 v[104:107], v[24:27], a[248:251], v[104:107]
    ds_read_b128 v[40:43], v2 offset:18688
    v_accvgpr_read_b32 v229, a45
    v_mfma_f32_16x16x32_bf16 v[104:107], v[28:31], a[252:255], v[104:107]
    v_mul_f32 v224, v224, v49
    v_mul_f32 v225, v225, v49
    v_mul_f32 v226, v226, v49
    v_mul_f32 v227, v227, v49
    v_mul_f32 v228, v228, v49
    v_mul_f32 v229, v229, v49
    v_mfma_f32_16x16x32_bf16 v[108:111], v[28:31], v[212:215], v[108:111]
    ds_read_b128 v[44:47], v3 offset:18688
    v_cvt_pk_bf16_f32 v224, v224, v225
    v_mfma_f32_16x16x32_bf16 v[108:111], v[24:27], v[208:211], v[108:111]
    s_waitcnt lgkmcnt(2)
    v_add_u32 v2, 49152, v2
    v_add_u32 v3, 49152, v3
    v_exp_f32 v16, v160
    v_cvt_pk_bf16_f32 v225, v226, v227
    v_mfma_f32_16x16x32_bf16 v[168:171], v[32:35], v[192:195], v[168:171]
    ds_read_b128 v[24:27], v2 offset:0
    v_cvt_pk_bf16_f32 v226, v228, v229
    v_mfma_f32_16x16x32_bf16 v[168:171], v[36:39], v[196:199], v[168:171]
    buffer_store_dwordx3 v[224:226], v56, s[12:15], s24 offen offset:576 sc0 sc1
    v_accvgpr_read_b32 v230, a26
    v_mfma_f32_16x16x32_bf16 v[172:175], v[36:39], v[220:223], v[172:175]
    ds_read_b128 v[28:31], v3 offset:0
    v_accvgpr_read_b32 v231, a30
    v_mfma_f32_16x16x32_bf16 v[172:175], v[32:35], v[216:219], v[172:175]
    s_waitcnt lgkmcnt(2)
    v_exp_f32 v17, v161
    v_exp_f32 v18, v162
    v_exp_f32 v19, v163
    v_mfma_f32_16x16x32_bf16 v[104:107], v[40:43], v[192:195], v[104:107]
    ds_read_b128 v[32:35], v2 offset:6144
    v_accvgpr_read_b32 v232, a34
    v_mfma_f32_16x16x32_bf16 v[104:107], v[44:47], v[196:199], v[104:107]
    v_cvt_pk_bf16_f32 v160, v16, v17
    v_accvgpr_read_b32 v233, a38
    v_accvgpr_read_b32 v234, a42
    v_exp_f32 v16, v96
    v_mfma_f32_16x16x32_bf16 v[108:111], v[44:47], v[220:223], v[108:111]
    ds_read_b128 v[36:39], v3 offset:6144
    v_accvgpr_read_b32 v235, a46
    v_mfma_f32_16x16x32_bf16 v[108:111], v[40:43], v[216:219], v[108:111]
    s_waitcnt lgkmcnt(2)
    v_mul_f32 v230, v230, v50
    v_exp_f32 v17, v97
    v_mul_f32 v231, v231, v50
    v_mul_f32 v232, v232, v50
    v_mfma_f32_16x16x32_bf16 v[176:179], v[24:27], a[240:243], v[136:139]
    ds_read_b128 v[40:43], v2 offset:128
    v_cvt_pk_bf16_f32 v161, v18, v19
    v_mfma_f32_16x16x32_bf16 v[176:179], v[28:31], a[244:247], v[176:179]
    v_mul_f32 v233, v233, v50
    v_exp_f32 v18, v98
    v_mul_f32 v234, v234, v50
    v_mul_f32 v235, v235, v50
    v_cvt_pk_bf16_f32 v230, v230, v231
    v_mfma_f32_16x16x32_bf16 v[180:183], v[28:31], v[204:207], v[140:143]
    ds_read_b128 v[44:47], v3 offset:128
    v_cvt_pk_bf16_f32 v231, v232, v233
    v_mfma_f32_16x16x32_bf16 v[180:183], v[24:27], v[200:203], v[180:183]
    s_waitcnt lgkmcnt(2)
    v_exp_f32 v19, v99
    v_cvt_pk_bf16_f32 v232, v234, v235
    v_accvgpr_read_b32 v236, a27
    v_cvt_pk_bf16_f32 v162, v16, v17
    v_mfma_f32_16x16x32_bf16 v[112:115], v[32:35], a[240:243], v[136:139]
    ds_read_b128 v[24:27], v2 offset:6272
    v_accvgpr_read_b32 v237, a31
    v_mfma_f32_16x16x32_bf16 v[112:115], v[36:39], a[244:247], v[112:115]
    buffer_store_dwordx3 v[230:232], v56, s[12:15], s24 offen offset:960 sc0 sc1
    v_accvgpr_read_b32 v238, a35
    v_mfma_f32_16x16x32_bf16 v[116:119], v[36:39], v[204:207], v[140:143]
    ds_read_b128 v[28:31], v3 offset:6272
    v_accvgpr_read_b32 v239, a39
    v_mfma_f32_16x16x32_bf16 v[116:119], v[32:35], v[200:203], v[116:119]
    s_waitcnt lgkmcnt(2)
    v_exp_f32 v16, v164
    v_exp_f32 v17, v165
    v_accvgpr_read_b32 v240, a43
    v_accvgpr_read_b32 v241, a47
    v_mfma_f32_16x16x32_bf16 v[176:179], v[40:43], a[248:251], v[176:179]
    ds_read_b128 v[32:35], v2 offset:256
    v_cvt_pk_bf16_f32 v163, v18, v19
    v_mfma_f32_16x16x32_bf16 v[176:179], v[44:47], a[252:255], v[176:179]
    v_exp_f32 v18, v166
    v_mul_f32 v236, v236, v51
    v_mul_f32 v237, v237, v51
    v_mul_f32 v238, v238, v51
    v_mfma_f32_16x16x32_bf16 v[180:183], v[44:47], v[212:215], v[180:183]
    ds_read_b128 v[36:39], v3 offset:256
    v_mul_f32 v239, v239, v51
    v_mfma_f32_16x16x32_bf16 v[180:183], v[40:43], v[208:211], v[180:183]
    s_waitcnt lgkmcnt(2)
    v_exp_f32 v19, v167
    v_mul_f32 v240, v240, v51
    v_mul_f32 v241, v241, v51
    v_cvt_pk_bf16_f32 v236, v236, v237
    v_mfma_f32_16x16x32_bf16 v[112:115], v[24:27], a[248:251], v[112:115]
    ds_read_b128 v[40:43], v2 offset:6400
    v_cvt_pk_bf16_f32 v237, v238, v239
    v_mfma_f32_16x16x32_bf16 v[112:115], v[28:31], a[252:255], v[112:115]
    v_mfma_f32_16x16x32_bf16 v[128:131], v[160:163], v[20:23], v[128:131]
    v_cvt_pk_bf16_f32 v164, v16, v17
    v_cvt_pk_bf16_f32 v238, v240, v241
    v_accvgpr_read_b32 v242, a48
    v_mfma_f32_16x16x32_bf16 v[116:119], v[28:31], v[212:215], v[116:119]
    ds_read_b128 v[44:47], v3 offset:6400
    v_accvgpr_read_b32 v243, a52
    v_mfma_f32_16x16x32_bf16 v[116:119], v[24:27], v[208:211], v[116:119]
    s_waitcnt lgkmcnt(2)
    buffer_store_dwordx3 v[236:238], v56, s[12:15], s24 offen offset:1344 sc0 sc1
    v_exp_f32 v16, v100
    v_mfma_f32_16x16x32_bf16 v[176:179], v[32:35], v[192:195], v[176:179]
    ds_read_b128 v[24:27], v2 offset:12288
    v_accvgpr_read_b32 v244, a56
    v_mfma_f32_16x16x32_bf16 v[176:179], v[36:39], v[196:199], v[176:179]
    v_exp_f32 v17, v101
    v_accvgpr_read_b32 v245, a60
    v_cvt_pk_bf16_f32 v165, v18, v19
    v_accvgpr_read_b32 v246, a64
    v_mfma_f32_16x16x32_bf16 v[180:183], v[36:39], v[220:223], v[180:183]
    ds_read_b128 v[28:31], v3 offset:12288
    v_accvgpr_read_b32 v247, a68
    v_mfma_f32_16x16x32_bf16 v[180:183], v[32:35], v[216:219], v[180:183]
    s_waitcnt lgkmcnt(2)
    v_exp_f32 v18, v102
    v_mul_f32 v242, v242, v52
    v_mul_f32 v243, v243, v52
    v_mul_f32 v244, v244, v52
    v_mfma_f32_16x16x32_bf16 v[112:115], v[40:43], v[192:195], v[112:115]
    ds_read_b128 v[32:35], v2 offset:18432
    v_mul_f32 v245, v245, v52
    v_mfma_f32_16x16x32_bf16 v[112:115], v[44:47], v[196:199], v[112:115]
    v_exp_f32 v19, v103
    v_cvt_pk_bf16_f32 v166, v16, v17
    v_mul_f32 v246, v246, v52
    v_mul_f32 v247, v247, v52
    v_cvt_pk_bf16_f32 v167, v18, v19
    v_mfma_f32_16x16x32_bf16 v[116:119], v[44:47], v[220:223], v[116:119]
    ds_read_b128 v[36:39], v3 offset:18432
    v_cvt_pk_bf16_f32 v242, v242, v243
    v_mfma_f32_16x16x32_bf16 v[116:119], v[40:43], v[216:219], v[116:119]
    s_waitcnt lgkmcnt(2)
    s_nop 1
    v_cvt_pk_bf16_f32 v243, v244, v245
    v_cvt_pk_bf16_f32 v244, v246, v247
    v_accvgpr_read_b32 v248, a49
    v_mfma_f32_16x16x32_bf16 v[184:187], v[24:27], a[240:243], v[136:139]
    ds_read_b128 v[40:43], v2 offset:12416
    v_accvgpr_read_b32 v249, a53
    v_mfma_f32_16x16x32_bf16 v[184:187], v[28:31], a[244:247], v[184:187]
    buffer_store_dwordx3 v[242:244], v56, s[12:15], s40 offen offset:0 sc0 sc1
    v_accvgpr_read_b32 v250, a57
    v_mfma_f32_16x16x32_bf16 v[188:191], v[28:31], v[204:207], v[140:143]
    ds_read_b128 v[44:47], v3 offset:12416
    v_accvgpr_read_b32 v251, a61
    v_mfma_f32_16x16x32_bf16 v[188:191], v[24:27], v[200:203], v[188:191]
    s_waitcnt lgkmcnt(2)
    v_mfma_f32_16x16x32_bf16 v[132:135], v[164:167], v[20:23], v[132:135]
    v_exp_f32 v16, v168
    v_accvgpr_read_b32 v252, a65
    v_accvgpr_read_b32 v253, a69
    v_mfma_f32_16x16x32_bf16 v[120:123], v[32:35], a[240:243], v[136:139]
    ds_read_b128 v[24:27], v2 offset:18560
    v_mul_f32 v248, v248, v53
    v_mfma_f32_16x16x32_bf16 v[120:123], v[36:39], a[244:247], v[120:123]
    v_exp_f32 v17, v169
    v_exp_f32 v18, v170
    v_mul_f32 v249, v249, v53
    v_mfma_f32_16x16x32_bf16 v[124:127], v[36:39], v[204:207], v[140:143]
    ds_read_b128 v[28:31], v3 offset:18560
    v_mul_f32 v250, v250, v53
    v_mfma_f32_16x16x32_bf16 v[124:127], v[32:35], v[200:203], v[124:127]
    s_waitcnt lgkmcnt(2)
    v_exp_f32 v19, v171
    v_mul_f32 v251, v251, v53
    v_mul_f32 v252, v252, v53
    v_mul_f32 v253, v253, v53
    v_mfma_f32_16x16x32_bf16 v[184:187], v[40:43], a[248:251], v[184:187]
    ds_read_b128 v[32:35], v2 offset:12544
    v_cvt_pk_bf16_f32 v168, v16, v17
    v_mfma_f32_16x16x32_bf16 v[184:187], v[44:47], a[252:255], v[184:187]
    v_cvt_pk_bf16_f32 v248, v248, v249
    v_exp_f32 v16, v104
    v_cvt_pk_bf16_f32 v249, v250, v251
    v_cvt_pk_bf16_f32 v250, v252, v253
    v_accvgpr_read_b32 v224, a50
    v_mfma_f32_16x16x32_bf16 v[188:191], v[44:47], v[212:215], v[188:191]
    ds_read_b128 v[36:39], v3 offset:12544
    v_accvgpr_read_b32 v225, a54
    v_mfma_f32_16x16x32_bf16 v[188:191], v[40:43], v[208:211], v[188:191]
    s_waitcnt lgkmcnt(2)
    buffer_store_dwordx3 v[248:250], v56, s[12:15], s40 offen offset:384 sc0 sc1
    v_accvgpr_read_b32 v226, a58
    v_mfma_f32_16x16x32_bf16 v[120:123], v[24:27], a[248:251], v[120:123]
    ds_read_b128 v[40:43], v2 offset:18688
    v_accvgpr_read_b32 v227, a62
    v_mfma_f32_16x16x32_bf16 v[120:123], v[28:31], a[252:255], v[120:123]
    v_exp_f32 v17, v105
    v_cvt_pk_bf16_f32 v169, v18, v19
    v_accvgpr_read_b32 v228, a66
    v_accvgpr_read_b32 v229, a70
    v_mfma_f32_16x16x32_bf16 v[124:127], v[28:31], v[212:215], v[124:127]
    ds_read_b128 v[44:47], v3 offset:18688
    v_mul_f32 v224, v224, v54
    v_mfma_f32_16x16x32_bf16 v[124:127], v[24:27], v[208:211], v[124:127]
    s_waitcnt lgkmcnt(2)
    v_add_u32 v60, 49152, v1
    v_mov_b32 v59, v1
    v_subrev_u32 v1, 49152, v1
    v_exp_f32 v18, v106
    v_mfma_f32_16x16x32_bf16 v[184:187], v[32:35], v[192:195], v[184:187]
    ds_read_b128 v[24:27], v60 offset:0
    v_mul_f32 v225, v225, v54
    v_mfma_f32_16x16x32_bf16 v[184:187], v[36:39], v[196:199], v[184:187]
    v_exp_f32 v19, v107
    v_mul_f32 v226, v226, v54
    v_cvt_pk_bf16_f32 v170, v16, v17
    v_mul_f32 v227, v227, v54
    v_mul_f32 v228, v228, v54
    v_mfma_f32_16x16x32_bf16 v[188:191], v[36:39], v[220:223], v[188:191]
    ds_read_b128 v[28:31], v60 offset:12288
    v_mul_f32 v229, v229, v54
    v_mfma_f32_16x16x32_bf16 v[188:191], v[32:35], v[216:219], v[188:191]
    s_waitcnt lgkmcnt(2)
    v_exp_f32 v16, v172
    v_cvt_pk_bf16_f32 v224, v224, v225
    v_cvt_pk_bf16_f32 v225, v226, v227
    v_cvt_pk_bf16_f32 v226, v228, v229
    v_mfma_f32_16x16x32_bf16 v[120:123], v[40:43], v[192:195], v[120:123]
    ds_read_b128 v[32:35], v60 offset:1024
    v_accvgpr_read_b32 v230, a51
    v_mfma_f32_16x16x32_bf16 v[120:123], v[44:47], v[196:199], v[120:123]
    buffer_store_dwordx3 v[224:226], v56, s[12:15], s40 offen offset:768 sc0 sc1
    v_accvgpr_read_b32 v231, a55
    v_mfma_f32_16x16x32_bf16 v[124:127], v[44:47], v[220:223], v[124:127]
    ds_read_b128 v[36:39], v60 offset:13312
    v_accvgpr_read_b32 v232, a59
    v_mfma_f32_16x16x32_bf16 v[124:127], v[40:43], v[216:219], v[124:127]
    s_waitcnt lgkmcnt(2)
    v_exp_f32 v17, v173
    v_cvt_pk_bf16_f32 v171, v18, v19
    v_exp_f32 v18, v174
    v_accvgpr_read_b32 v233, a63
    v_mfma_f32_16x16x32_bf16 a[96:99], v[80:83], v[24:27], a[96:99]
    ds_read_b128 v[40:43], v60 offset:2048
    v_accvgpr_read_b32 v234, a67
    v_mfma_f32_16x16x32_bf16 a[96:99], v[88:91], v[28:31], a[96:99]
    v_exp_f32 v19, v175
    v_accvgpr_read_b32 v235, a71
    v_mul_f32 v230, v230, v55
    v_mul_f32 v231, v231, v55
    v_mfma_f32_16x16x32_bf16 a[144:147], v[92:95], v[28:31], a[144:147]
    ds_read_b128 v[44:47], v60 offset:14336
    v_mul_f32 v232, v232, v55
    v_mfma_f32_16x16x32_bf16 a[144:147], v[84:87], v[24:27], a[144:147]
    s_waitcnt lgkmcnt(2)
    v_mfma_f32_16x16x32_bf16 v[128:131], v[168:171], v[20:23], v[128:131]
    v_mul_f32 v233, v233, v55
    v_mul_f32 v234, v234, v55
    v_mul_f32 v235, v235, v55
    v_mfma_f32_16x16x32_bf16 a[100:103], v[80:83], v[32:35], a[100:103]
    ds_read_b128 v[24:27], v60 offset:3072
    v_cvt_pk_bf16_f32 v172, v16, v17
    v_mfma_f32_16x16x32_bf16 a[100:103], v[88:91], v[36:39], a[100:103]
    v_exp_f32 v16, v108
    v_cvt_pk_bf16_f32 v230, v230, v231
    v_cvt_pk_bf16_f32 v231, v232, v233
    v_cvt_pk_bf16_f32 v232, v234, v235
    v_accvgpr_read_b32 v236, a72
    v_mfma_f32_16x16x32_bf16 a[148:151], v[92:95], v[36:39], a[148:151]
    ds_read_b128 v[28:31], v60 offset:15360
    v_accvgpr_read_b32 v237, a76
    v_mfma_f32_16x16x32_bf16 a[148:151], v[84:87], v[32:35], a[148:151]
    s_waitcnt lgkmcnt(2)
    buffer_store_dwordx3 v[230:232], v56, s[12:15], s40 offen offset:1152 sc0 sc1
    v_accvgpr_read_b32 v238, a80
    v_mfma_f32_16x16x32_bf16 a[104:107], v[80:83], v[40:43], a[104:107]
    ds_read_b128 v[32:35], v60 offset:4096
    v_accvgpr_read_b32 v239, a84
    v_mfma_f32_16x16x32_bf16 a[104:107], v[88:91], v[44:47], a[104:107]
    v_exp_f32 v17, v109
    v_cvt_pk_bf16_f32 v173, v18, v19
    v_accvgpr_read_b32 v240, a88
    v_accvgpr_read_b32 v241, a92
    v_mfma_f32_16x16x32_bf16 a[152:155], v[92:95], v[44:47], a[152:155]
    ds_read_b128 v[36:39], v60 offset:16384
    v_mul_f32 v236, v236, v52
    v_mfma_f32_16x16x32_bf16 a[152:155], v[84:87], v[40:43], a[152:155]
    s_waitcnt lgkmcnt(2)
    v_exp_f32 v18, v110
    v_mul_f32 v237, v237, v52
    v_mul_f32 v238, v238, v52
    v_mul_f32 v239, v239, v52
    v_mul_f32 v240, v240, v52
    v_mfma_f32_16x16x32_bf16 a[108:111], v[80:83], v[24:27], a[108:111]
    ds_read_b128 v[40:43], v60 offset:5120
    v_mul_f32 v241, v241, v52
    v_mfma_f32_16x16x32_bf16 a[108:111], v[88:91], v[28:31], a[108:111]
    v_exp_f32 v19, v111
    v_cvt_pk_bf16_f32 v236, v236, v237
    v_cvt_pk_bf16_f32 v237, v238, v239
    v_cvt_pk_bf16_f32 v238, v240, v241
    v_mfma_f32_16x16x32_bf16 a[156:159], v[92:95], v[28:31], a[156:159]
    ds_read_b128 v[44:47], v60 offset:17408
    v_cvt_pk_bf16_f32 v174, v16, v17
    v_mfma_f32_16x16x32_bf16 a[156:159], v[84:87], v[24:27], a[156:159]
    s_waitcnt lgkmcnt(2)
    buffer_store_dwordx3 v[236:238], v56, s[12:15], s40 offen offset:192 sc0 sc1
    v_accvgpr_read_b32 v242, a73
    v_mfma_f32_16x16x32_bf16 a[112:115], v[80:83], v[32:35], a[112:115]
    ds_read_b128 v[24:27], v1 offset:0
    v_cvt_pk_bf16_f32 v175, v18, v19
    v_mfma_f32_16x16x32_bf16 a[112:115], v[88:91], v[36:39], a[112:115]
    s_nop 1
    v_accvgpr_read_b32 v243, a77
    v_accvgpr_read_b32 v244, a81
    v_accvgpr_read_b32 v245, a85
    v_accvgpr_read_b32 v246, a89
    v_mfma_f32_16x16x32_bf16 a[160:163], v[92:95], v[36:39], a[160:163]
    ds_read_b128 v[28:31], v1 offset:12288
    v_accvgpr_read_b32 v247, a93
    v_mfma_f32_16x16x32_bf16 a[160:163], v[84:87], v[32:35], a[160:163]
    s_waitcnt lgkmcnt(2)
    v_mul_f32 v242, v242, v53
    v_mfma_f32_16x16x32_bf16 v[132:135], v[172:175], v[20:23], v[132:135]
    v_exp_f32 v16, v176
    v_mul_f32 v243, v243, v53
    v_mfma_f32_16x16x32_bf16 a[116:119], v[80:83], v[40:43], a[116:119]
    ds_read_b128 v[32:35], v1 offset:1024
    v_mul_f32 v244, v244, v53
    v_mfma_f32_16x16x32_bf16 a[116:119], v[88:91], v[44:47], a[116:119]
    v_exp_f32 v17, v177
    v_exp_f32 v18, v178
    v_mul_f32 v245, v245, v53
    v_mfma_f32_16x16x32_bf16 a[164:167], v[92:95], v[44:47], a[164:167]
    ds_read_b128 v[36:39], v1 offset:13312
    v_mul_f32 v246, v246, v53
    v_mfma_f32_16x16x32_bf16 a[164:167], v[84:87], v[40:43], a[164:167]
    s_waitcnt lgkmcnt(2)
    v_exp_f32 v19, v179
    v_cvt_pk_bf16_f32 v176, v16, v17
    v_exp_f32 v16, v112
    v_mfma_f32_16x16x32_bf16 a[96:99], v[160:163], v[24:27], a[96:99]
L_pg13:
    s_cbranch_execz L_iwret
    ds_read_b128 v[40:43], v1 offset:2048
    v_mul_f32 v247, v247, v53
    v_mfma_f32_16x16x32_bf16 a[96:99], v[168:171], v[28:31], a[96:99]
    v_exp_f32 v17, v113
    v_cvt_pk_bf16_f32 v177, v18, v19
    v_exp_f32 v18, v114
    v_cvt_pk_bf16_f32 v242, v242, v243
    v_mfma_f32_16x16x32_bf16 a[144:147], v[172:175], v[28:31], a[144:147]
    ds_read_b128 v[44:47], v1 offset:14336
    v_cvt_pk_bf16_f32 v243, v244, v245
    v_mfma_f32_16x16x32_bf16 a[144:147], v[164:167], v[24:27], a[144:147]
    s_waitcnt lgkmcnt(2)
    v_exp_f32 v19, v115
    v_cvt_pk_bf16_f32 v178, v16, v17
    v_exp_f32 v16, v180
    v_mfma_f32_16x16x32_bf16 a[100:103], v[160:163], v[32:35], a[100:103]
    ds_read_b128 v[24:27], v1 offset:3072
    v_cvt_pk_bf16_f32 v244, v246, v247
    v_mfma_f32_16x16x32_bf16 a[100:103], v[168:171], v[36:39], a[100:103]
    buffer_store_dwordx3 v[242:244], v56, s[12:15], s40 offen offset:576 sc0 sc1
    v_accvgpr_read_b32 v248, a74
    v_mfma_f32_16x16x32_bf16 a[148:151], v[172:175], v[36:39], a[148:151]
    ds_read_b128 v[28:31], v1 offset:15360
    v_accvgpr_read_b32 v249, a78
    v_mfma_f32_16x16x32_bf16 a[148:151], v[164:167], v[32:35], a[148:151]
    s_waitcnt lgkmcnt(2)
    v_exp_f32 v17, v181
    v_cvt_pk_bf16_f32 v179, v18, v19
    v_exp_f32 v18, v182
    v_accvgpr_read_b32 v250, a82
    v_mfma_f32_16x16x32_bf16 a[104:107], v[160:163], v[40:43], a[104:107]
    ds_read_b128 v[32:35], v1 offset:4096
    v_accvgpr_read_b32 v251, a86
    v_mfma_f32_16x16x32_bf16 a[104:107], v[168:171], v[44:47], a[104:107]
    v_exp_f32 v19, v183
    v_mfma_f32_16x16x32_bf16 v[128:131], v[176:179], v[20:23], v[128:131]
    v_cvt_pk_bf16_f32 v180, v16, v17
    v_mfma_f32_16x16x32_bf16 a[152:155], v[172:175], v[44:47], a[152:155]
    ds_read_b128 v[36:39], v1 offset:16384
    v_accvgpr_read_b32 v252, a90
    v_mfma_f32_16x16x32_bf16 a[152:155], v[164:167], v[40:43], a[152:155]
    s_waitcnt lgkmcnt(2)
    v_exp_f32 v16, v116
    v_exp_f32 v17, v117
    v_cvt_pk_bf16_f32 v181, v18, v19
    v_mfma_f32_16x16x32_bf16 a[108:111], v[160:163], v[24:27], a[108:111]
    ds_read_b128 v[40:43], v1 offset:5120
    v_accvgpr_read_b32 v253, a94
    v_mfma_f32_16x16x32_bf16 a[108:111], v[168:171], v[28:31], a[108:111]
    v_exp_f32 v18, v118
    v_exp_f32 v19, v119
    v_cvt_pk_bf16_f32 v182, v16, v17
    v_cvt_pk_bf16_f32 v183, v18, v19
    v_mfma_f32_16x16x32_bf16 a[156:159], v[172:175], v[28:31], a[156:159]
    s_nop 1
    ds_read_b128 v[44:47], v1 offset:17408
    v_mfma_f32_16x16x32_bf16 a[156:159], v[164:167], v[24:27], a[156:159]
    s_waitcnt lgkmcnt(2)
    v_mfma_f32_16x16x32_bf16 v[132:135], v[180:183], v[20:23], v[132:135]
    v_exp_f32 v16, v184
    v_mul_f32 v248, v248, v54
    v_mfma_f32_16x16x32_bf16 a[112:115], v[160:163], v[32:35], a[112:115]
    ds_read_b128 v[24:27], v59 offset:0
    v_mul_f32 v249, v249, v54
    v_mfma_f32_16x16x32_bf16 a[112:115], v[168:171], v[36:39], a[112:115]
    v_exp_f32 v17, v185
    v_exp_f32 v18, v186
    v_mul_f32 v250, v250, v54
    v_mfma_f32_16x16x32_bf16 a[160:163], v[172:175], v[36:39], a[160:163]
    ds_read_b128 v[28:31], v59 offset:12288
    v_mul_f32 v251, v251, v54
    v_mfma_f32_16x16x32_bf16 a[160:163], v[164:167], v[32:35], a[160:163]
    s_waitcnt lgkmcnt(2)
    v_exp_f32 v19, v187
    v_cvt_pk_bf16_f32 v184, v16, v17
    v_exp_f32 v16, v120
    v_exp_f32 v17, v121
    v_cvt_pk_bf16_f32 v185, v18, v19
    v_exp_f32 v18, v122
    v_exp_f32 v19, v123
    v_cvt_pk_bf16_f32 v186, v16, v17
    v_exp_f32 v16, v188
    v_exp_f32 v17, v189
    v_cvt_pk_bf16_f32 v187, v18, v19
    v_exp_f32 v18, v190
    v_exp_f32 v19, v191
    v_mfma_f32_16x16x32_bf16 v[128:131], v[184:187], v[20:23], v[128:131]
    v_cvt_pk_bf16_f32 v188, v16, v17
    v_exp_f32 v16, v124
    v_exp_f32 v17, v125
    v_cvt_pk_bf16_f32 v189, v18, v19
    v_exp_f32 v18, v126
    v_exp_f32 v19, v127
    v_cvt_pk_bf16_f32 v190, v16, v17
    v_cvt_pk_bf16_f32 v191, v18, v19
    s_nop 1
    v_mfma_f32_16x16x32_bf16 v[132:135], v[188:191], v[20:23], v[132:135]
    v_mfma_f32_16x16x32_bf16 a[116:119], v[160:163], v[40:43], a[116:119]
    ds_read_b128 v[32:35], v59 offset:1024
    v_mul_f32 v252, v252, v54
    v_mfma_f32_16x16x32_bf16 a[116:119], v[168:171], v[44:47], a[116:119]
    v_mul_f32 v253, v253, v54
    v_cvt_pk_bf16_f32 v248, v248, v249
    v_cvt_pk_bf16_f32 v249, v250, v251
    v_cvt_pk_bf16_f32 v250, v252, v253
    v_accvgpr_read_b32 v224, a75
    v_mfma_f32_16x16x32_bf16 a[164:167], v[172:175], v[44:47], a[164:167]
    ds_read_b128 v[36:39], v59 offset:13312
    v_accvgpr_read_b32 v225, a79
    v_mfma_f32_16x16x32_bf16 a[164:167], v[164:167], v[40:43], a[164:167]
    s_waitcnt lgkmcnt(2)
    buffer_store_dwordx3 v[248:250], v56, s[12:15], s40 offen offset:960 sc0 sc1
    v_accvgpr_read_b32 v226, a83
    v_accvgpr_read_b32 v227, a87
    v_mfma_f32_16x16x4_f32 v[128:131], v7, v57, v[128:131]
    v_mfma_f32_16x16x32_bf16 a[96:99], v[176:179], v[24:27], a[96:99]
    ds_read_b128 v[40:43], v59 offset:2048
    v_accvgpr_read_b32 v228, a91
    v_mfma_f32_16x16x32_bf16 a[96:99], v[184:187], v[28:31], a[96:99]
    v_accvgpr_read_b32 v229, a95
    v_mul_f32 v224, v224, v55
    v_mul_f32 v225, v225, v55
    v_mul_f32 v226, v226, v55
    v_mul_f32 v227, v227, v55
    v_mul_f32 v228, v228, v55
    v_mfma_f32_16x16x4_f32 v[132:135], v8, v57, v[132:135]
    v_mfma_f32_16x16x32_bf16 a[144:147], v[188:191], v[28:31], a[144:147]
    ds_read_b128 v[44:47], v59 offset:14336
    v_mul_f32 v229, v229, v55
    v_mfma_f32_16x16x32_bf16 a[144:147], v[180:183], v[24:27], a[144:147]
    s_waitcnt lgkmcnt(2)
    v_cvt_pk_bf16_f32 v224, v224, v225
    v_cvt_pk_bf16_f32 v225, v226, v227
    v_cvt_pk_bf16_f32 v226, v228, v229
    v_mfma_f32_16x16x32_bf16 a[100:103], v[176:179], v[32:35], a[100:103]
    ds_read_b128 v[24:27], v59 offset:3072
    v_mfma_f32_16x16x32_bf16 a[100:103], v[184:187], v[36:39], a[100:103]
    buffer_store_dwordx3 v[224:226], v56, s[12:15], s40 offen offset:1344 sc0 sc1
    v_mfma_f32_16x16x32_bf16 a[148:151], v[188:191], v[36:39], a[148:151]
    ds_read_b128 v[28:31], v59 offset:15360
    v_max3_f32 v18, v5, v6, v128
    v_mfma_f32_16x16x32_bf16 a[148:151], v[180:183], v[32:35], a[148:151]
    s_waitcnt lgkmcnt(2)
    v_max3_f32 v18, v18, v129, v130
    v_max3_f32 v18, v18, v131, v132
    v_max3_f32 v18, v18, v133, v134
    v_max_f32 v18, v18, v135
    s_mov_b32 s29, 0x5f800000
    v_cmp_lt_f32 s[48:49], s29, v18
    v_rcp_f32 v128, v128
    v_mfma_f32_16x16x32_bf16 a[104:107], v[176:179], v[40:43], a[104:107]
    ds_read_b128 v[32:35], v59 offset:4096
    v_mfma_f32_16x16x32_bf16 a[104:107], v[184:187], v[44:47], a[104:107]
    v_rcp_f32 v129, v129
    v_rcp_f32 v130, v130
    v_rcp_f32 v131, v131
    v_mfma_f32_16x16x32_bf16 a[152:155], v[188:191], v[44:47], a[152:155]
    ds_read_b128 v[36:39], v59 offset:16384
    v_mfma_f32_16x16x32_bf16 a[152:155], v[180:183], v[40:43], a[152:155]
    s_waitcnt lgkmcnt(2)
    v_rcp_f32 v132, v132
    v_rcp_f32 v133, v133
    v_mfma_f32_16x16x32_bf16 a[108:111], v[176:179], v[24:27], a[108:111]
    ds_read_b128 v[40:43], v59 offset:5120
    v_mfma_f32_16x16x32_bf16 a[108:111], v[184:187], v[28:31], a[108:111]
    v_rcp_f32 v134, v134
    v_rcp_f32 v135, v135
    v_mfma_f32_16x16x32_bf16 a[156:159], v[188:191], v[28:31], a[156:159]
    ds_read_b128 v[44:47], v59 offset:17408
    v_mfma_f32_16x16x32_bf16 a[156:159], v[180:183], v[24:27], a[156:159]
    s_waitcnt lgkmcnt(2)
    v_mfma_f32_16x16x32_bf16 a[112:115], v[176:179], v[32:35], a[112:115]
    ds_read_b128 v[24:27], v60 offset:6144
    v_mfma_f32_16x16x32_bf16 a[112:115], v[184:187], v[36:39], a[112:115]
    v_mfma_f32_16x16x32_bf16 a[160:163], v[188:191], v[36:39], a[160:163]
    ds_read_b128 v[28:31], v60 offset:18432
    v_mfma_f32_16x16x32_bf16 a[160:163], v[180:183], v[32:35], a[160:163]
    s_waitcnt lgkmcnt(2)
    s_cmp_lg_u64 s[48:49], 0
    s_cbranch_scc1 L_slow
    v_mfma_f32_16x16x32_bf16 a[116:119], v[176:179], v[40:43], a[116:119]
    ds_read_b128 v[32:35], v60 offset:7168
    v_mfma_f32_16x16x32_bf16 a[116:119], v[184:187], v[44:47], a[116:119]
    v_mfma_f32_16x16x32_bf16 a[164:167], v[188:191], v[44:47], a[164:167]
    ds_read_b128 v[36:39], v60 offset:19456
    v_mfma_f32_16x16x32_bf16 a[164:167], v[180:183], v[40:43], a[164:167]
    s_waitcnt lgkmcnt(2)
    v_mfma_f32_16x16x32_bf16 a[120:123], v[80:83], v[24:27], a[120:123]
    ds_read_b128 v[40:43], v60 offset:8192
    v_mfma_f32_16x16x32_bf16 a[120:123], v[88:91], v[28:31], a[120:123]
    v_mfma_f32_16x16x32_bf16 a[168:171], v[92:95], v[28:31], a[168:171]
    ds_read_b128 v[44:47], v60 offset:20480
    v_mfma_f32_16x16x32_bf16 a[168:171], v[84:87], v[24:27], a[168:171]
    s_waitcnt lgkmcnt(2)
    v_mfma_f32_16x16x32_bf16 a[124:127], v[80:83], v[32:35], a[124:127]
    ds_read_b128 v[24:27], v1 offset:6144
    v_accvgpr_read_b32 v230, a96
    v_mfma_f32_16x16x32_bf16 a[124:127], v[88:91], v[36:39], a[124:127]
    v_accvgpr_read_b32 v231, a100
    v_accvgpr_read_b32 v232, a104
    v_accvgpr_read_b32 v233, a108
    v_accvgpr_read_b32 v234, a112
    v_accvgpr_read_b32 v235, a116
    v_mul_f32 v230, v230, v128
    v_mul_f32 v231, v231, v128
    v_mul_f32 v232, v232, v128
    v_mul_f32 v233, v233, v128
    v_mul_f32 v234, v234, v128
    v_mul_f32 v235, v235, v128
    v_cvt_pk_bf16_f32 v230, v230, v231
    v_cvt_pk_bf16_f32 v231, v232, v233
    v_cvt_pk_bf16_f32 v232, v234, v235
    v_accvgpr_read_b32 v236, a97
    v_accvgpr_read_b32 v237, a101
    v_accvgpr_read_b32 v238, a105
    v_accvgpr_read_b32 v239, a109
    v_accvgpr_read_b32 v240, a113
    v_accvgpr_read_b32 v241, a117
    v_mul_f32 v236, v236, v129
    v_mul_f32 v237, v237, v129
    v_mul_f32 v238, v238, v129
    v_mul_f32 v239, v239, v129
    v_mul_f32 v240, v240, v129
    v_mul_f32 v241, v241, v129
    v_cvt_pk_bf16_f32 v236, v236, v237
    v_cvt_pk_bf16_f32 v237, v238, v239
    v_cvt_pk_bf16_f32 v238, v240, v241
    v_accvgpr_read_b32 v242, a98
    v_mfma_f32_16x16x32_bf16 a[172:175], v[92:95], v[36:39], a[172:175]
    ds_read_b128 v[28:31], v1 offset:18432
    v_accvgpr_read_b32 v243, a102
    v_mfma_f32_16x16x32_bf16 a[172:175], v[84:87], v[32:35], a[172:175]
    s_waitcnt lgkmcnt(2)
    buffer_store_dwordx3 v[230:232], v56, s[12:15], s41 offen offset:0 sc0 sc1
    v_accvgpr_read_b32 v244, a106
    v_mfma_f32_16x16x32_bf16 a[128:131], v[80:83], v[40:43], a[128:131]
    ds_read_b128 v[32:35], v1 offset:7168
    v_accvgpr_read_b32 v245, a110
    v_mfma_f32_16x16x32_bf16 a[128:131], v[88:91], v[44:47], a[128:131]
    buffer_store_dwordx3 v[236:238], v56, s[12:15], s41 offen offset:384 sc0 sc1
    v_accvgpr_read_b32 v246, a114
    v_mfma_f32_16x16x32_bf16 a[176:179], v[92:95], v[44:47], a[176:179]
    ds_read_b128 v[36:39], v1 offset:19456
    v_accvgpr_read_b32 v247, a118
    v_mfma_f32_16x16x32_bf16 a[176:179], v[84:87], v[40:43], a[176:179]
    s_waitcnt lgkmcnt(2)
    v_mul_f32 v242, v242, v130
    v_mul_f32 v243, v243, v130
    v_mul_f32 v244, v244, v130
    v_mul_f32 v245, v245, v130
    v_mul_f32 v246, v246, v130
    v_mul_f32 v247, v247, v130
    v_mfma_f32_16x16x32_bf16 a[120:123], v[160:163], v[24:27], a[120:123]
    ds_read_b128 v[40:43], v1 offset:8192
    v_cvt_pk_bf16_f32 v242, v242, v243
    v_mfma_f32_16x16x32_bf16 a[120:123], v[168:171], v[28:31], a[120:123]
    v_cvt_pk_bf16_f32 v243, v244, v245
    v_cvt_pk_bf16_f32 v244, v246, v247
    v_accvgpr_read_b32 v248, a99
    v_accvgpr_read_b32 v249, a103
    v_accvgpr_read_b32 v250, a107
    v_mfma_f32_16x16x32_bf16 a[168:171], v[172:175], v[28:31], a[168:171]
    ds_read_b128 v[44:47], v1 offset:20480
    v_accvgpr_read_b32 v251, a111
    v_mfma_f32_16x16x32_bf16 a[168:171], v[164:167], v[24:27], a[168:171]
    s_waitcnt lgkmcnt(2)
    buffer_store_dwordx3 v[242:244], v56, s[12:15], s41 offen offset:768 sc0 sc1
    v_accvgpr_read_b32 v252, a115
    v_mfma_f32_16x16x32_bf16 a[124:127], v[160:163], v[32:35], a[124:127]
    ds_read_b128 v[24:27], v59 offset:6144
    v_accvgpr_read_b32 v253, a119
    v_mfma_f32_16x16x32_bf16 a[124:127], v[168:171], v[36:39], a[124:127]
    v_mul_f32 v248, v248, v131
    v_mul_f32 v249, v249, v131
    v_mul_f32 v250, v250, v131
    v_mul_f32 v251, v251, v131
    v_mul_f32 v252, v252, v131
    v_mul_f32 v253, v253, v131
    v_mfma_f32_16x16x32_bf16 a[172:175], v[172:175], v[36:39], a[172:175]
    ds_read_b128 v[28:31], v59 offset:18432
    v_cvt_pk_bf16_f32 v248, v248, v249
    v_mfma_f32_16x16x32_bf16 a[172:175], v[164:167], v[32:35], a[172:175]
    s_waitcnt lgkmcnt(2)
    v_cvt_pk_bf16_f32 v249, v250, v251
    v_cvt_pk_bf16_f32 v250, v252, v253
    v_accvgpr_read_b32 v224, a144
    v_accvgpr_read_b32 v225, a148
    v_accvgpr_read_b32 v226, a152
    v_mfma_f32_16x16x32_bf16 a[128:131], v[160:163], v[40:43], a[128:131]
    ds_read_b128 v[32:35], v59 offset:7168
    v_accvgpr_read_b32 v227, a156
    v_mfma_f32_16x16x32_bf16 a[128:131], v[168:171], v[44:47], a[128:131]
    buffer_store_dwordx3 v[248:250], v56, s[12:15], s41 offen offset:1152 sc0 sc1
    v_accvgpr_read_b32 v228, a160
    v_mfma_f32_16x16x32_bf16 a[176:179], v[172:175], v[44:47], a[176:179]
    ds_read_b128 v[36:39], v59 offset:19456
    v_accvgpr_read_b32 v229, a164
    v_mfma_f32_16x16x32_bf16 a[176:179], v[164:167], v[40:43], a[176:179]
    s_waitcnt lgkmcnt(2)
    v_mul_f32 v224, v224, v132
    v_mul_f32 v225, v225, v132
    v_mul_f32 v226, v226, v132
    v_mul_f32 v227, v227, v132
    v_mul_f32 v228, v228, v132
    v_mul_f32 v229, v229, v132
    v_mfma_f32_16x16x32_bf16 a[120:123], v[176:179], v[24:27], a[120:123]
    ds_read_b128 v[40:43], v59 offset:8192
    v_cvt_pk_bf16_f32 v224, v224, v225
    v_mfma_f32_16x16x32_bf16 a[120:123], v[184:187], v[28:31], a[120:123]
    v_cvt_pk_bf16_f32 v225, v226, v227
    v_cvt_pk_bf16_f32 v226, v228, v229
    v_accvgpr_read_b32 v230, a145
    v_accvgpr_read_b32 v231, a149
    v_accvgpr_read_b32 v232, a153
    v_mfma_f32_16x16x32_bf16 a[168:171], v[188:191], v[28:31], a[168:171]
    ds_read_b128 v[44:47], v59 offset:20480
    v_accvgpr_read_b32 v233, a157
    v_mfma_f32_16x16x32_bf16 a[168:171], v[180:183], v[24:27], a[168:171]
    s_waitcnt lgkmcnt(2)
    buffer_store_dwordx3 v[224:226], v56, s[12:15], s42 offen offset:0 sc0 sc1
    v_accvgpr_read_b32 v234, a161
    v_mfma_f32_16x16x32_bf16 a[124:127], v[176:179], v[32:35], a[124:127]
    ds_read_b128 v[24:27], v60 offset:9216
    v_accvgpr_read_b32 v235, a165
    v_mfma_f32_16x16x32_bf16 a[124:127], v[184:187], v[36:39], a[124:127]
    v_mul_f32 v230, v230, v133
    v_mul_f32 v231, v231, v133
    v_mul_f32 v232, v232, v133
    v_mul_f32 v233, v233, v133
    v_mul_f32 v234, v234, v133
    v_mul_f32 v235, v235, v133
    v_mfma_f32_16x16x32_bf16 a[172:175], v[188:191], v[36:39], a[172:175]
    ds_read_b128 v[28:31], v60 offset:21504
    v_cvt_pk_bf16_f32 v230, v230, v231
    v_mfma_f32_16x16x32_bf16 a[172:175], v[180:183], v[32:35], a[172:175]
    s_waitcnt lgkmcnt(2)
    v_cvt_pk_bf16_f32 v231, v232, v233
    v_cvt_pk_bf16_f32 v232, v234, v235
    v_accvgpr_read_b32 v236, a146
    v_accvgpr_read_b32 v237, a150
    v_accvgpr_read_b32 v238, a154
    v_mfma_f32_16x16x32_bf16 a[128:131], v[176:179], v[40:43], a[128:131]
    ds_read_b128 v[32:35], v60 offset:10240
    v_accvgpr_read_b32 v239, a158
    v_mfma_f32_16x16x32_bf16 a[128:131], v[184:187], v[44:47], a[128:131]
    buffer_store_dwordx3 v[230:232], v56, s[12:15], s42 offen offset:384 sc0 sc1
    v_accvgpr_read_b32 v240, a162
    v_mfma_f32_16x16x32_bf16 a[176:179], v[188:191], v[44:47], a[176:179]
    ds_read_b128 v[36:39], v60 offset:22528
    v_accvgpr_read_b32 v241, a166
    v_mfma_f32_16x16x32_bf16 a[176:179], v[180:183], v[40:43], a[176:179]
    s_waitcnt lgkmcnt(2)
    v_mul_f32 v236, v236, v134
    v_mul_f32 v237, v237, v134
    v_mul_f32 v238, v238, v134
    v_mul_f32 v239, v239, v134
    v_mul_f32 v240, v240, v134
    v_mfma_f32_16x16x32_bf16 a[132:135], v[80:83], v[24:27], a[132:135]
    ds_read_b128 v[40:43], v60 offset:11264
    v_mul_f32 v241, v241, v134
    v_mfma_f32_16x16x32_bf16 a[132:135], v[88:91], v[28:31], a[132:135]
    v_cvt_pk_bf16_f32 v236, v236, v237
    v_cvt_pk_bf16_f32 v237, v238, v239
    v_cvt_pk_bf16_f32 v238, v240, v241
    v_accvgpr_read_b32 v242, a147
    v_accvgpr_read_b32 v243, a151
    v_accvgpr_read_b32 v244, a155
    v_mfma_f32_16x16x32_bf16 a[180:183], v[92:95], v[28:31], a[180:183]
    ds_read_b128 v[44:47], v60 offset:23552
    v_accvgpr_read_b32 v245, a159
    v_mfma_f32_16x16x32_bf16 a[180:183], v[84:87], v[24:27], a[180:183]
    s_waitcnt lgkmcnt(2)
    buffer_store_dwordx3 v[236:238], v56, s[12:15], s42 offen offset:768 sc0 sc1
    v_accvgpr_read_b32 v246, a163
    v_mfma_f32_16x16x32_bf16 a[136:139], v[80:83], v[32:35], a[136:139]
    ds_read_b128 v[24:27], v1 offset:9216
    v_accvgpr_read_b32 v96, a120
    v_mfma_f32_16x16x32_bf16 a[136:139], v[88:91], v[36:39], a[136:139]
    v_accvgpr_read_b32 v97, a124
    v_accvgpr_read_b32 v98, a128
    v_mul_f32 v96, v96, v128
    v_mul_f32 v97, v97, v128
    v_mul_f32 v98, v98, v128
    v_mfma_f32_16x16x32_bf16 a[184:187], v[92:95], v[36:39], a[184:187]
    ds_read_b128 v[28:31], v1 offset:21504
    v_accvgpr_read_b32 v102, a121
    v_mfma_f32_16x16x32_bf16 a[184:187], v[84:87], v[32:35], a[184:187]
    s_waitcnt lgkmcnt(2)
    v_accvgpr_read_b32 v103, a125
    v_accvgpr_read_b32 v104, a129
    v_mul_f32 v102, v102, v129
    v_mul_f32 v103, v103, v129
    v_mul_f32 v104, v104, v129
    v_accvgpr_read_b32 v108, a122
    v_mfma_f32_16x16x32_bf16 a[140:143], v[80:83], v[40:43], a[140:143]
    ds_read_b128 v[32:35], v1 offset:10240
    v_accvgpr_read_b32 v109, a126
    v_mfma_f32_16x16x32_bf16 a[140:143], v[88:91], v[44:47], a[140:143]
    v_accvgpr_read_b32 v110, a130
    v_mul_f32 v108, v108, v130
    v_mul_f32 v109, v109, v130
    v_mul_f32 v110, v110, v130
    v_accvgpr_read_b32 v114, a123
    v_mfma_f32_16x16x32_bf16 a[188:191], v[92:95], v[44:47], a[188:191]
    ds_read_b128 v[36:39], v1 offset:22528
    v_accvgpr_read_b32 v115, a127
    v_mfma_f32_16x16x32_bf16 a[188:191], v[84:87], v[40:43], a[188:191]
    s_waitcnt lgkmcnt(2)
    v_accvgpr_read_b32 v116, a131
    v_mul_f32 v114, v114, v131
    v_mul_f32 v115, v115, v131
    v_mul_f32 v116, v116, v131
    v_accvgpr_read_b32 v120, a168
    v_mfma_f32_16x16x32_bf16 a[132:135], v[160:163], v[24:27], a[132:135]
    ds_read_b128 v[40:43], v1 offset:11264
    v_accvgpr_read_b32 v121, a172
    v_mfma_f32_16x16x32_bf16 a[132:135], v[168:171], v[28:31], a[132:135]
    v_accvgpr_read_b32 v122, a176
    v_mul_f32 v120, v120, v132
    v_mul_f32 v121, v121, v132
    v_mul_f32 v122, v122, v132
    v_accvgpr_read_b32 v64, a169
    v_accvgpr_read_b32 v65, a173
    v_mfma_f32_16x16x32_bf16 a[180:183], v[172:175], v[28:31], a[180:183]
    ds_read_b128 v[44:47], v1 offset:23552
    v_accvgpr_read_b32 v66, a177
    v_mfma_f32_16x16x32_bf16 a[180:183], v[164:167], v[24:27], a[180:183]
    s_waitcnt lgkmcnt(2)
    v_mul_f32 v64, v64, v133
    v_mul_f32 v65, v65, v133
    v_mul_f32 v66, v66, v133
    v_accvgpr_read_b32 v70, a170
    v_accvgpr_read_b32 v71, a174
    v_mfma_f32_16x16x32_bf16 a[136:139], v[160:163], v[32:35], a[136:139]
    ds_read_b128 v[24:27], v59 offset:9216
    v_accvgpr_read_b32 v247, a167
    v_mfma_f32_16x16x32_bf16 a[136:139], v[168:171], v[36:39], a[136:139]
    v_accvgpr_read_b32 v72, a178
    v_mul_f32 v242, v242, v135
    v_mul_f32 v70, v70, v134
    v_mul_f32 v243, v243, v135
    v_mul_f32 v71, v71, v134
    v_mfma_f32_16x16x32_bf16 a[184:187], v[172:175], v[36:39], a[184:187]
    ds_read_b128 v[28:31], v59 offset:21504
    v_mul_f32 v244, v244, v135
    v_mfma_f32_16x16x32_bf16 a[184:187], v[164:167], v[32:35], a[184:187]
    s_waitcnt lgkmcnt(2)
    v_mul_f32 v72, v72, v134
    v_mul_f32 v245, v245, v135
    v_accvgpr_read_b32 v144, a171
    v_mul_f32 v246, v246, v135
    v_accvgpr_read_b32 v145, a175
    v_mul_f32 v247, v247, v135
    v_mfma_f32_16x16x32_bf16 a[140:143], v[160:163], v[40:43], a[140:143]
    ds_read_b128 v[32:35], v59 offset:10240
    v_accvgpr_read_b32 v146, a179
    v_mfma_f32_16x16x32_bf16 a[140:143], v[168:171], v[44:47], a[140:143]
    v_cvt_pk_bf16_f32 v242, v242, v243
    v_mul_f32 v144, v144, v135
    v_cvt_pk_bf16_f32 v243, v244, v245
    v_mul_f32 v145, v145, v135
    v_cvt_pk_bf16_f32 v244, v246, v247
    v_mfma_f32_16x16x32_bf16 a[188:191], v[172:175], v[44:47], a[188:191]
    ds_read_b128 v[36:39], v59 offset:22528
    v_mul_f32 v146, v146, v135
    v_mfma_f32_16x16x32_bf16 a[188:191], v[164:167], v[40:43], a[188:191]
    s_waitcnt lgkmcnt(2)
    buffer_store_dwordx3 v[242:244], v56, s[12:15], s42 offen offset:1152 sc0 sc1
    v_mfma_f32_16x16x32_bf16 a[132:135], v[176:179], v[24:27], a[132:135]
    ds_read_b128 v[40:43], v59 offset:11264
    v_mfma_f32_16x16x32_bf16 a[132:135], v[184:187], v[28:31], a[132:135]
    v_mfma_f32_16x16x32_bf16 a[180:183], v[188:191], v[28:31], a[180:183]
    ds_read_b128 v[44:47], v59 offset:23552
    v_mfma_f32_16x16x32_bf16 a[180:183], v[180:183], v[24:27], a[180:183]
    s_waitcnt lgkmcnt(2)
    v_mfma_f32_16x16x32_bf16 a[136:139], v[176:179], v[32:35], a[136:139]
    v_mfma_f32_16x16x32_bf16 a[136:139], v[184:187], v[36:39], a[136:139]
    v_mfma_f32_16x16x32_bf16 a[184:187], v[188:191], v[36:39], a[184:187]
    v_mfma_f32_16x16x32_bf16 a[184:187], v[180:183], v[32:35], a[184:187]
    s_waitcnt lgkmcnt(0)
    v_mfma_f32_16x16x32_bf16 a[140:143], v[176:179], v[40:43], a[140:143]
    v_mfma_f32_16x16x32_bf16 a[140:143], v[184:187], v[44:47], a[140:143]
    v_mfma_f32_16x16x32_bf16 a[188:191], v[188:191], v[44:47], a[188:191]
    v_mfma_f32_16x16x32_bf16 a[188:191], v[180:183], v[40:43], a[188:191]
    s_nop 7
    v_accvgpr_read_b32 v99, a132
    v_accvgpr_read_b32 v100, a136
    v_accvgpr_read_b32 v101, a140
    v_cvt_pk_bf16_f32 v96, v96, v97
    v_mul_f32 v99, v99, v128
    v_mul_f32 v100, v100, v128
    v_mul_f32 v101, v101, v128
    v_cvt_pk_bf16_f32 v97, v98, v99
    v_cvt_pk_bf16_f32 v98, v100, v101
    buffer_store_dwordx3 v[96:98], v56, s[12:15], s41 offen offset:192 sc0 sc1
    v_accvgpr_read_b32 v105, a133
    v_accvgpr_read_b32 v106, a137
    v_accvgpr_read_b32 v107, a141
    v_cvt_pk_bf16_f32 v102, v102, v103
    v_mul_f32 v105, v105, v129
    v_mul_f32 v106, v106, v129
    v_mul_f32 v107, v107, v129
    v_cvt_pk_bf16_f32 v103, v104, v105
    v_cvt_pk_bf16_f32 v104, v106, v107
    buffer_store_dwordx3 v[102:104], v56, s[12:15], s41 offen offset:576 sc0 sc1
    v_accvgpr_read_b32 v111, a134
    v_accvgpr_read_b32 v112, a138
    v_accvgpr_read_b32 v113, a142
    v_cvt_pk_bf16_f32 v108, v108, v109
    v_mul_f32 v111, v111, v130
    v_mul_f32 v112, v112, v130
    v_mul_f32 v113, v113, v130
    v_cvt_pk_bf16_f32 v109, v110, v111
    v_cvt_pk_bf16_f32 v110, v112, v113
    buffer_store_dwordx3 v[108:110], v56, s[12:15], s41 offen offset:960 sc0 sc1
    v_accvgpr_read_b32 v117, a135
    v_accvgpr_read_b32 v118, a139
    v_accvgpr_read_b32 v119, a143
    v_cvt_pk_bf16_f32 v114, v114, v115
    v_mul_f32 v117, v117, v131
    v_mul_f32 v118, v118, v131
    v_mul_f32 v119, v119, v131
    v_cvt_pk_bf16_f32 v115, v116, v117
    v_cvt_pk_bf16_f32 v116, v118, v119
    buffer_store_dwordx3 v[114:116], v56, s[12:15], s41 offen offset:1344 sc0 sc1
    v_accvgpr_read_b32 v123, a180
    v_accvgpr_read_b32 v124, a184
    v_accvgpr_read_b32 v125, a188
    v_cvt_pk_bf16_f32 v120, v120, v121
    v_mul_f32 v123, v123, v132
    v_mul_f32 v124, v124, v132
    v_mul_f32 v125, v125, v132
    v_cvt_pk_bf16_f32 v121, v122, v123
    v_cvt_pk_bf16_f32 v122, v124, v125
    buffer_store_dwordx3 v[120:122], v56, s[12:15], s42 offen offset:192 sc0 sc1
    v_accvgpr_read_b32 v67, a181
    v_accvgpr_read_b32 v68, a185
    v_accvgpr_read_b32 v69, a189
    v_cvt_pk_bf16_f32 v64, v64, v65
    v_mul_f32 v67, v67, v133
    v_mul_f32 v68, v68, v133
    v_mul_f32 v69, v69, v133
    v_cvt_pk_bf16_f32 v65, v66, v67
    v_cvt_pk_bf16_f32 v66, v68, v69
    buffer_store_dwordx3 v[64:66], v56, s[12:15], s42 offen offset:576 sc0 sc1
    v_accvgpr_read_b32 v73, a182
    v_accvgpr_read_b32 v74, a186
    v_accvgpr_read_b32 v75, a190
    v_cvt_pk_bf16_f32 v70, v70, v71
    v_mul_f32 v73, v73, v134
    v_mul_f32 v74, v74, v134
    v_mul_f32 v75, v75, v134
    v_cvt_pk_bf16_f32 v71, v72, v73
    v_cvt_pk_bf16_f32 v72, v74, v75
    buffer_store_dwordx3 v[70:72], v56, s[12:15], s42 offen offset:960 sc0 sc1
    v_accvgpr_read_b32 v147, a183
    v_accvgpr_read_b32 v148, a187
    v_accvgpr_read_b32 v149, a191
    v_cvt_pk_bf16_f32 v144, v144, v145
    v_mul_f32 v147, v147, v135
    v_mul_f32 v148, v148, v135
    v_mul_f32 v149, v149, v135
    v_cvt_pk_bf16_f32 v145, v146, v147
    v_cvt_pk_bf16_f32 v146, v148, v149
    buffer_store_dwordx3 v[144:146], v56, s[12:15], s42 offen offset:1344 sc0 sc1
L_fin:
L_done:
    s_endpgm
L_pollslow0:
    s_mov_b32 s59, 60
L_pollsm0:
    s_buffer_load_dwordx8 s[48:55], s[20:23], s44 glc
    s_waitcnt lgkmcnt(0)
    s_sub_u32 s48, s48, s92
    s_sub_u32 s49, s49, s92
    s_sub_u32 s50, s50, s92
    s_sub_u32 s51, s51, s92
    s_sub_u32 s52, s52, s92
    s_sub_u32 s53, s53, s92
    s_sub_u32 s54, s54, s92
    s_sub_u32 s55, s55, s92
    s_max_u32 s48, s48, s49
    s_max_u32 s48, s48, s50
    s_max_u32 s48, s48, s51
    s_max_u32 s48, s48, s52
    s_max_u32 s48, s48, s53
    s_max_u32 s48, s48, s54
    s_max_u32 s48, s48, s55
    s_cmp_lt_u32 s48, 16
    s_cbranch_scc1 L_pollok0
    s_sub_u32 s59, s59, 1
    s_cbranch_scc1 L_pollvec0
    s_sleep 1
    s_branch L_pollsm0
L_pollvec0:
    v_bfe_u32 v53, v4, 4, 6
    v_lshlrev_b32 v53, 2, v53
    s_sub_u32 s96, s96, 1
    s_cbranch_scc1 L_pollgiveup0
    s_sleep 2
    buffer_load_dword v52, v53, s[20:23], s44 offen sc1
    s_waitcnt vmcnt(0)
    s_bitcmp1_b32 s92, 9
    s_cbranch_scc1 L_nomix
    v_xor_b32 v53, s92, v52
    v_lshrrev_b32 v53, 5, v53
    v_add_u32 v53, -1, v53
    v_cmp_gt_u32 vcc, 31, v53
    s_nop 1
    s_and_b32 s59, vcc_lo, 0xff
    s_cbranch_scc0 L_nomix
    buffer_store_dwordx4 v[224:227], v11, s[4:7], s33 offen offset:0 sc1
    v_xor_b32 v55, 16, v11
    buffer_store_dwordx4 v[228:231], v55, s[4:7], s33 offen offset:768 sc1
    v_xor_b32 v54, 32, v11
    buffer_store_dwordx4 v[232:235], v54, s[4:7], s33 offen offset:1536 sc1
    v_xor_b32 v55, 48, v11
    buffer_store_dwordx4 v[236:239], v55, s[4:7], s33 offen offset:2304 sc1
    buffer_store_dwordx4 v[112:115], v15, s[4:7], s35 offen offset:0 sc1
    buffer_store_dwordx4 v[116:119], v15, s[4:7], s35 offen offset:1024 sc1
    buffer_store_dwordx4 v[120:123], v15, s[4:7], s35 offen offset:2048 sc1
    s_waitcnt vmcnt(0)
    s_barrier
    s_and_b32 s92, s92, 0xfffffc00
    s_add_u32 s92, s92, 512
    v_mov_b32 v0, s92
    s_add_u32 s92, s92, 1
    s_mov_b32 s44, 32
    v_add_u32 v0, 1, v0
    buffer_store_dword v0, v13, s[20:23], 0 offen offset:32 sc1
    s_branch L_pollvec0
L_nomix:
    v_subrev_u32 v52, s92, v52
    v_cmp_lt_u32 vcc, 15, v52
    s_nop 0
    s_and_b32 s59, vcc_lo, 0xff
    s_cbranch_scc1 L_pollvec0
    s_branch L_pollok0
L_pollgiveup0:
    s_mov_b32 s96, 0
    s_branch L_pollok0
L_pollslow1:
    s_mov_b32 s59, 200
L_pollsm1:
    s_buffer_load_dwordx8 s[48:55], s[20:23], s44 glc
    s_waitcnt lgkmcnt(0)
    s_sub_u32 s48, s48, s92
    s_sub_u32 s49, s49, s92
    s_sub_u32 s50, s50, s92
    s_sub_u32 s51, s51, s92
    s_sub_u32 s52, s52, s92
    s_sub_u32 s53, s53, s92
    s_sub_u32 s54, s54, s92
    s_sub_u32 s55, s55, s92
    s_max_u32 s48, s48, s49
    s_max_u32 s48, s48, s50
    s_max_u32 s48, s48, s51
    s_max_u32 s48, s48, s52
    s_max_u32 s48, s48, s53
    s_max_u32 s48, s48, s54
    s_max_u32 s48, s48, s55
    s_cmp_lt_u32 s48, 16
    s_cbranch_scc1 L_pollok1
    s_sub_u32 s59, s59, 1
    s_cbranch_scc1 L_pollvec1
    s_sleep 1
    s_branch L_pollsm1
L_pollvec1:
    v_bfe_u32 v53, v4, 4, 6
    v_lshlrev_b32 v53, 2, v53
    s_sub_u32 s96, s96, 1
    s_cbranch_scc1 L_pollgiveup1
    s_sleep 2
    buffer_load_dword v52, v53, s[20:23], s44 offen sc1
    s_waitcnt vmcnt(0)
    v_subrev_u32 v52, s92, v52
    v_cmp_lt_u32 vcc, 15, v52
    s_nop 0
    s_and_b32 s59, vcc_lo, 0xff
    s_cbranch_scc1 L_pollvec1
    s_branch L_pollok1
L_pollgiveup1:
    s_mov_b32 s96, 0
    s_branch L_pollok1
L_pollslow2:
    s_mov_b32 s59, 200
L_pollsm2:
    s_buffer_load_dwordx8 s[48:55], s[20:23], s44 glc
    s_waitcnt lgkmcnt(0)
    s_sub_u32 s48, s48, s92
    s_sub_u32 s49, s49, s92
    s_sub_u32 s50, s50, s92
    s_sub_u32 s51, s51, s92
    s_sub_u32 s52, s52, s92
    s_sub_u32 s53, s53, s92
    s_sub_u32 s54, s54, s92
    s_sub_u32 s55, s55, s92
    s_max_u32 s48, s48, s49
    s_max_u32 s48, s48, s50
    s_max_u32 s48, s48, s51
    s_max_u32 s48, s48, s52
    s_max_u32 s48, s48, s53
    s_max_u32 s48, s48, s54
    s_max_u32 s48, s48, s55
    s_cmp_lt_u32 s48, 16
    s_cbranch_scc1 L_pollok2
    s_sub_u32 s59, s59, 1
    s_cbranch_scc1 L_pollvec2
    s_sleep 1
    s_branch L_pollsm2
L_pollvec2:
    v_bfe_u32 v53, v4, 4, 6
    v_lshlrev_b32 v53, 2, v53
    s_sub_u32 s96, s96, 1
    s_cbranch_scc1 L_pollgiveup2
    s_sleep 2
    buffer_load_dword v52, v53, s[20:23], s44 offen sc1
    s_waitcnt vmcnt(0)
    v_subrev_u32 v52, s92, v52
    v_cmp_lt_u32 vcc, 15, v52
    s_nop 0
    s_and_b32 s59, vcc_lo, 0xff
    s_cbranch_scc1 L_pollvec2
    s_branch L_pollok2
L_pollgiveup2:
    s_mov_b32 s96, 0
    s_branch L_pollok2
L_pollslow3:
    s_mov_b32 s59, 200
L_pollsm3:
    s_buffer_load_dwordx8 s[48:55], s[20:23], s44 glc
    s_waitcnt lgkmcnt(0)
    s_sub_u32 s48, s48, s92
    s_sub_u32 s49, s49, s92
    s_sub_u32 s50, s50, s92
    s_sub_u32 s51, s51, s92
    s_sub_u32 s52, s52, s92
    s_sub_u32 s53, s53, s92
    s_sub_u32 s54, s54, s92
    s_sub_u32 s55, s55, s92
    s_max_u32 s48, s48, s49
    s_max_u32 s48, s48, s50
    s_max_u32 s48, s48, s51
    s_max_u32 s48, s48, s52
    s_max_u32 s48, s48, s53
    s_max_u32 s48, s48, s54
    s_max_u32 s48, s48, s55
    s_cmp_lt_u32 s48, 16
    s_cbranch_scc1 L_pollok3
    s_sub_u32 s59, s59, 1
    s_cbranch_scc1 L_pollvec3
    s_sleep 1
    s_branch L_pollsm3
L_pollvec3:
    v_bfe_u32 v53, v4, 4, 6
    v_lshlrev_b32 v53, 2, v53
    s_sub_u32 s96, s96, 1
    s_cbranch_scc1 L_pollgiveup3
    s_sleep 2
    buffer_load_dword v52, v53, s[20:23], s44 offen sc1
    s_waitcnt vmcnt(0)
    v_subrev_u32 v52, s92, v52
    v_cmp_lt_u32 vcc, 15, v52
    s_nop 0
    s_and_b32 s59, vcc_lo, 0xff
    s_cbranch_scc1 L_pollvec3
    s_branch L_pollok3
L_pollgiveup3:
    s_mov_b32 s96, 0
    s_branch L_pollok3
L_pollslow4:
    s_mov_b32 s59, 200
L_pollsm4:
    s_buffer_load_dwordx8 s[48:55], s[20:23], s44 glc
    s_waitcnt lgkmcnt(0)
    s_sub_u32 s48, s48, s92
    s_sub_u32 s49, s49, s92
    s_sub_u32 s50, s50, s92
    s_sub_u32 s51, s51, s92
    s_sub_u32 s52, s52, s92
    s_sub_u32 s53, s53, s92
    s_sub_u32 s54, s54, s92
    s_sub_u32 s55, s55, s92
    s_max_u32 s48, s48, s49
    s_max_u32 s48, s48, s50
    s_max_u32 s48, s48, s51
    s_max_u32 s48, s48, s52
    s_max_u32 s48, s48, s53
    s_max_u32 s48, s48, s54
    s_max_u32 s48, s48, s55
    s_cmp_lt_u32 s48, 16
    s_cbranch_scc1 L_pollok4
    s_sub_u32 s59, s59, 1
    s_cbranch_scc1 L_pollvec4
    s_sleep 1
    s_branch L_pollsm4
L_pollvec4:
    v_bfe_u32 v53, v4, 4, 6
    v_lshlrev_b32 v53, 2, v53
    s_sub_u32 s96, s96, 1
    s_cbranch_scc1 L_pollgiveup4
    s_sleep 2
    buffer_load_dword v52, v53, s[20:23], s44 offen sc1
    s_waitcnt vmcnt(0)
    v_subrev_u32 v52, s92, v52
    v_cmp_lt_u32 vcc, 15, v52
    s_nop 0
    s_and_b32 s59, vcc_lo, 0xff
    s_cbranch_scc1 L_pollvec4
    s_branch L_pollok4
L_pollgiveup4:
    s_mov_b32 s96, 0
    s_branch L_pollok4
L_tagslow:
    s_sub_u32 s96, s96, 1
    s_cbranch_scc1 L_taggiveup
    s_sleep 2
    buffer_load_dword v0, off, s[88:91], s93 sc1
    s_waitcnt vmcnt(0)
    v_readfirstlane_b32 s42, v0
    s_nop 0
    s_cmp_eq_u32 s42, s46
    s_cbranch_scc1 L_tagslow
    s_cmp_eq_u32 s42, 0
    s_cbranch_scc1 L_tagslow
    s_branch L_tagok
L_taggiveup:
    s_mov_b32 s96, 0
    s_branch L_tagok
L_slow:
    s_waitcnt vmcnt(0) lgkmcnt(0)
    s_nop 15
    v_accvgpr_write_b32 a0, 0
    v_accvgpr_write_b32 a1, 0
    v_accvgpr_write_b32 a2, 0
    v_accvgpr_write_b32 a3, 0
    v_accvgpr_write_b32 a4, 0
    v_accvgpr_write_b32 a5, 0
    v_accvgpr_write_b32 a6, 0
    v_accvgpr_write_b32 a7, 0
    v_accvgpr_write_b32 a8, 0
    v_accvgpr_write_b32 a9, 0
    v_accvgpr_write_b32 a10, 0
    v_accvgpr_write_b32 a11, 0
    v_accvgpr_write_b32 a12, 0
    v_accvgpr_write_b32 a13, 0
    v_accvgpr_write_b32 a14, 0
    v_accvgpr_write_b32 a15, 0
    v_accvgpr_write_b32 a16, 0
    v_accvgpr_write_b32 a17, 0
    v_accvgpr_write_b32 a18, 0
    v_accvgpr_write_b32 a19, 0
    v_accvgpr_write_b32 a20, 0
    v_accvgpr_write_b32 a21, 0
    v_accvgpr_write_b32 a22, 0
    v_accvgpr_write_b32 a23, 0
    v_accvgpr_write_b32 a24, 0
    v_accvgpr_write_b32 a25, 0
    v_accvgpr_write_b32 a26, 0
    v_accvgpr_write_b32 a27, 0
    v_accvgpr_write_b32 a28, 0
    v_accvgpr_write_b32 a29, 0
    v_accvgpr_write_b32 a30, 0
    v_accvgpr_write_b32 a31, 0
    v_accvgpr_write_b32 a32, 0
    v_accvgpr_write_b32 a33, 0
    v_accvgpr_write_b32 a34, 0
    v_accvgpr_write_b32 a35, 0
    v_accvgpr_write_b32 a36, 0
    v_accvgpr_write_b32 a37, 0
    v_accvgpr_write_b32 a38, 0
    v_accvgpr_write_b32 a39, 0
    v_accvgpr_write_b32 a40, 0
    v_accvgpr_write_b32 a41, 0
    v_accvgpr_write_b32 a42, 0
    v_accvgpr_write_b32 a43, 0
    v_accvgpr_write_b32 a44, 0
    v_accvgpr_write_b32 a45, 0
    v_accvgpr_write_b32 a46, 0
    v_accvgpr_write_b32 a47, 0
    v_accvgpr_write_b32 a48, 0
    v_accvgpr_write_b32 a49, 0
    v_accvgpr_write_b32 a50, 0
    v_accvgpr_write_b32 a51, 0
    v_accvgpr_write_b32 a52, 0
    v_accvgpr_write_b32 a53, 0
    v_accvgpr_write_b32 a54, 0
    v_accvgpr_write_b32 a55, 0
    v_accvgpr_write_b32 a56, 0
    v_accvgpr_write_b32 a57, 0
    v_accvgpr_write_b32 a58, 0
    v_accvgpr_write_b32 a59, 0
    v_accvgpr_write_b32 a60, 0
    v_accvgpr_write_b32 a61, 0
    v_accvgpr_write_b32 a62, 0
    v_accvgpr_write_b32 a63, 0
    v_accvgpr_write_b32 a64, 0
    v_accvgpr_write_b32 a65, 0
    v_accvgpr_write_b32 a66, 0
    v_accvgpr_write_b32 a67, 0
    v_accvgpr_write_b32 a68, 0
    v_accvgpr_write_b32 a69, 0
    v_accvgpr_write_b32 a70, 0
    v_accvgpr_write_b32 a71, 0
    v_accvgpr_write_b32 a72, 0
    v_accvgpr_write_b32 a73, 0
    v_accvgpr_write_b32 a74, 0
    v_accvgpr_write_b32 a75, 0
    v_accvgpr_write_b32 a76, 0
    v_accvgpr_write_b32 a77, 0
    v_accvgpr_write_b32 a78, 0
    v_accvgpr_write_b32 a79, 0
    v_accvgpr_write_b32 a80, 0
    v_accvgpr_write_b32 a81, 0
    v_accvgpr_write_b32 a82, 0
    v_accvgpr_write_b32 a83, 0
    v_accvgpr_write_b32 a84, 0
    v_accvgpr_write_b32 a85, 0
    v_accvgpr_write_b32 a86, 0
    v_accvgpr_write_b32 a87, 0
    v_accvgpr_write_b32 a88, 0
    v_accvgpr_write_b32 a89, 0
    v_accvgpr_write_b32 a90, 0
    v_accvgpr_write_b32 a91, 0
    v_accvgpr_write_b32 a92, 0
    v_accvgpr_write_b32 a93, 0
    v_accvgpr_write_b32 a94, 0
    v_accvgpr_write_b32 a95, 0
    v_accvgpr_write_b32 a96, 0
    v_accvgpr_write_b32 a97, 0
    v_accvgpr_write_b32 a98, 0
    v_accvgpr_write_b32 a99, 0
    v_accvgpr_write_b32 a100, 0
    v_accvgpr_write_b32 a101, 0
    v_accvgpr_write_b32 a102, 0
    v_accvgpr_write_b32 a103, 0
    v_accvgpr_write_b32 a104, 0
    v_accvgpr_write_b32 a105, 0
    v_accvgpr_write_b32 a106, 0
    v_accvgpr_write_b32 a107, 0
    v_accvgpr_write_b32 a108, 0
    v_accvgpr_write_b32 a109, 0
    v_accvgpr_write_b32 a110, 0
    v_accvgpr_write_b32 a111, 0
    v_accvgpr_write_b32 a112, 0
    v_accvgpr_write_b32 a113, 0
    v_accvgpr_write_b32 a114, 0
    v_accvgpr_write_b32 a115, 0
    v_accvgpr_write_b32 a116, 0
    v_accvgpr_write_b32 a117, 0
    v_accvgpr_write_b32 a118, 0
    v_accvgpr_write_b32 a119, 0
    v_accvgpr_write_b32 a120, 0
    v_accvgpr_write_b32 a121, 0
    v_accvgpr_write_b32 a122, 0
    v_accvgpr_write_b32 a123, 0
    v_accvgpr_write_b32 a124, 0
    v_accvgpr_write_b32 a125, 0
    v_accvgpr_write_b32 a126, 0
    v_accvgpr_write_b32 a127, 0
    v_accvgpr_write_b32 a128, 0
    v_accvgpr_write_b32 a129, 0
    v_accvgpr_write_b32 a130, 0
    v_accvgpr_write_b32 a131, 0
    v_accvgpr_write_b32 a132, 0
    v_accvgpr_write_b32 a133, 0
    v_accvgpr_write_b32 a134, 0
    v_accvgpr_write_b32 a135, 0
    v_accvgpr_write_b32 a136, 0
    v_accvgpr_write_b32 a137, 0
    v_accvgpr_write_b32 a138, 0
    v_accvgpr_write_b32 a139, 0
    v_accvgpr_write_b32 a140, 0
    v_accvgpr_write_b32 a141, 0
    v_accvgpr_write_b32 a142, 0
    v_accvgpr_write_b32 a143, 0
    v_accvgpr_write_b32 a144, 0
    v_accvgpr_write_b32 a145, 0
    v_accvgpr_write_b32 a146, 0
    v_accvgpr_write_b32 a147, 0
    v_accvgpr_write_b32 a148, 0
    v_accvgpr_write_b32 a149, 0
    v_accvgpr_write_b32 a150, 0
    v_accvgpr_write_b32 a151, 0
    v_accvgpr_write_b32 a152, 0
    v_accvgpr_write_b32 a153, 0
    v_accvgpr_write_b32 a154, 0
    v_accvgpr_write_b32 a155, 0
    v_accvgpr_write_b32 a156, 0
    v_accvgpr_write_b32 a157, 0
    v_accvgpr_write_b32 a158, 0
    v_accvgpr_write_b32 a159, 0
    v_accvgpr_write_b32 a160, 0
    v_accvgpr_write_b32 a161, 0
    v_accvgpr_write_b32 a162, 0
    v_accvgpr_write_b32 a163, 0
    v_accvgpr_write_b32 a164, 0
    v_accvgpr_write_b32 a165, 0
    v_accvgpr_write_b32 a166, 0
    v_accvgpr_write_b32 a167, 0
    v_accvgpr_write_b32 a168, 0
    v_accvgpr_write_b32 a169, 0
    v_accvgpr_write_b32 a170, 0
    v_accvgpr_write_b32 a171, 0
    v_accvgpr_write_b32 a172, 0
    v_accvgpr_write_b32 a173, 0
    v_accvgpr_write_b32 a174, 0
    v_accvgpr_write_b32 a175, 0
    v_accvgpr_write_b32 a176, 0
    v_accvgpr_write_b32 a177, 0
    v_accvgpr_write_b32 a178, 0
    v_accvgpr_write_b32 a179, 0
    v_accvgpr_write_b32 a180, 0
    v_accvgpr_write_b32 a181, 0
    v_accvgpr_write_b32 a182, 0
    v_accvgpr_write_b32 a183, 0
    v_accvgpr_write_b32 a184, 0
    v_accvgpr_write_b32 a185, 0
    v_accvgpr_write_b32 a186, 0
    v_accvgpr_write_b32 a187, 0
    v_accvgpr_write_b32 a188, 0
    v_accvgpr_write_b32 a189, 0
    v_accvgpr_write_b32 a190, 0
    v_accvgpr_write_b32 a191, 0
    v_mov_b32 v5, 0
    v_mov_b32 v240, 0xff7fffff
    v_mov_b32 v6, 0
    v_mov_b32 v241, 0xff7fffff
    v_mov_b32 v7, 0
    v_mov_b32 v242, 0xff7fffff
    v_mov_b32 v8, 0
    v_mov_b32 v243, 0xff7fffff
    v_subrev_u32 v244, 49152, v2
    v_subrev_u32 v245, 49152, v3
    v_subrev_u32 v246, 24576, v1
    s_mov_b32 s48, 0
L_slowloop:
    s_add_u32 s49, s48, 6144
    s_add_u32 s50, s48, 12288
    s_add_u32 s51, s48, 16384
    s_add_u32 s52, s48, 20480
    buffer_load_dwordx4 v[64:67], v244, s[4:7], s48 offen offset:0 sc1
    buffer_load_dwordx4 v[68:71], v245, s[4:7], s48 offen offset:0 sc1
    buffer_load_dwordx4 v[72:75], v244, s[4:7], s49 offen offset:0 sc1
    buffer_load_dwordx4 v[76:79], v245, s[4:7], s49 offen offset:0 sc1
    buffer_load_dwordx4 v[80:83], v244, s[4:7], s48 offen offset:128 sc1
    buffer_load_dwordx4 v[84:87], v245, s[4:7], s48 offen offset:128 sc1
    buffer_load_dwordx4 v[88:91], v244, s[4:7], s49 offen offset:128 sc1
    buffer_load_dwordx4 v[92:95], v245, s[4:7], s49 offen offset:128 sc1
    buffer_load_dwordx4 v[96:99], v244, s[4:7], s48 offen offset:256 sc1
    buffer_load_dwordx4 v[100:103], v245, s[4:7], s48 offen offset:256 sc1
    buffer_load_dwordx4 v[104:107], v244, s[4:7], s49 offen offset:256 sc1
    buffer_load_dwordx4 v[108:111], v245, s[4:7], s49 offen offset:256 sc1
    buffer_load_dwordx4 v[112:115], v246, s[4:7], s50 offen offset:0 sc1
    buffer_load_dwordx4 v[116:119], v246, s[4:7], s50 offen offset:1024 sc1
    buffer_load_dwordx4 v[120:123], v246, s[4:7], s50 offen offset:2048 sc1
    buffer_load_dwordx4 v[124:127], v246, s[4:7], s50 offen offset:3072 sc1
    buffer_load_dwordx4 v[128:131], v246, s[4:7], s51 offen offset:0 sc1
    buffer_load_dwordx4 v[132:135], v246, s[4:7], s51 offen offset:1024 sc1
    buffer_load_dwordx4 v[136:139], v246, s[4:7], s51 offen offset:2048 sc1
    buffer_load_dwordx4 v[140:143], v246, s[4:7], s51 offen offset:3072 sc1
    buffer_load_dwordx4 v[144:147], v246, s[4:7], s52 offen offset:0 sc1
    buffer_load_dwordx4 v[148:151], v246, s[4:7], s52 offen offset:1024 sc1
    buffer_load_dwordx4 v[152:155], v246, s[4:7], s52 offen offset:2048 sc1
    buffer_load_dwordx4 v[156:159], v246, s[4:7], s52 offen offset:3072 sc1
    s_waitcnt vmcnt(12)
    v_mfma_f32_16x16x32_bf16 v[160:163], v[64:67], a[192:195], 0
    v_mfma_f32_16x16x32_bf16 v[168:171], v[64:67], a[216:219], 0
    v_mfma_f32_16x16x32_bf16 v[176:179], v[64:67], a[240:243], 0
    v_mfma_f32_16x16x32_bf16 v[184:187], v[64:67], v[200:203], 0
    v_mfma_f32_16x16x32_bf16 v[160:163], v[68:71], a[196:199], v[160:163]
    v_mfma_f32_16x16x32_bf16 v[168:171], v[68:71], a[220:223], v[168:171]
    v_mfma_f32_16x16x32_bf16 v[176:179], v[68:71], a[244:247], v[176:179]
    v_mfma_f32_16x16x32_bf16 v[184:187], v[68:71], v[204:207], v[184:187]
    v_mfma_f32_16x16x32_bf16 v[164:167], v[72:75], a[192:195], 0
    v_mfma_f32_16x16x32_bf16 v[172:175], v[72:75], a[216:219], 0
    v_mfma_f32_16x16x32_bf16 v[180:183], v[72:75], a[240:243], 0
    v_mfma_f32_16x16x32_bf16 v[188:191], v[72:75], v[200:203], 0
    v_mfma_f32_16x16x32_bf16 v[164:167], v[76:79], a[196:199], v[164:167]
    v_mfma_f32_16x16x32_bf16 v[172:175], v[76:79], a[220:223], v[172:175]
    v_mfma_f32_16x16x32_bf16 v[180:183], v[76:79], a[244:247], v[180:183]
    v_mfma_f32_16x16x32_bf16 v[188:191], v[76:79], v[204:207], v[188:191]
    v_mfma_f32_16x16x32_bf16 v[160:163], v[80:83], a[200:203], v[160:163]
    v_mfma_f32_16x16x32_bf16 v[168:171], v[80:83], a[224:227], v[168:171]
    v_mfma_f32_16x16x32_bf16 v[176:179], v[80:83], a[248:251], v[176:179]
    v_mfma_f32_16x16x32_bf16 v[184:187], v[80:83], v[208:211], v[184:187]
    v_mfma_f32_16x16x32_bf16 v[160:163], v[84:87], a[204:207], v[160:163]
    v_mfma_f32_16x16x32_bf16 v[168:171], v[84:87], a[228:231], v[168:171]
    v_mfma_f32_16x16x32_bf16 v[176:179], v[84:87], a[252:255], v[176:179]
    v_mfma_f32_16x16x32_bf16 v[184:187], v[84:87], v[212:215], v[184:187]
    v_mfma_f32_16x16x32_bf16 v[164:167], v[88:91], a[200:203], v[164:167]
    v_mfma_f32_16x16x32_bf16 v[172:175], v[88:91], a[224:227], v[172:175]
    v_mfma_f32_16x16x32_bf16 v[180:183], v[88:91], a[248:251], v[180:183]
    v_mfma_f32_16x16x32_bf16 v[188:191], v[88:91], v[208:211], v[188:191]
    v_mfma_f32_16x16x32_bf16 v[164:167], v[92:95], a[204:207], v[164:167]
    v_mfma_f32_16x16x32_bf16 v[172:175], v[92:95], a[228:231], v[172:175]
    v_mfma_f32_16x16x32_bf16 v[180:183], v[92:95], a[252:255], v[180:183]
    v_mfma_f32_16x16x32_bf16 v[188:191], v[92:95], v[212:215], v[188:191]
    v_mfma_f32_16x16x32_bf16 v[160:163], v[96:99], a[208:211], v[160:163]
    v_mfma_f32_16x16x32_bf16 v[168:171], v[96:99], a[232:235], v[168:171]
    v_mfma_f32_16x16x32_bf16 v[176:179], v[96:99], v[192:195], v[176:179]
    v_mfma_f32_16x16x32_bf16 v[184:187], v[96:99], v[216:219], v[184:187]
    v_mfma_f32_16x16x32_bf16 v[160:163], v[100:103], a[212:215], v[160:163]
    v_mfma_f32_16x16x32_bf16 v[168:171], v[100:103], a[236:239], v[168:171]
    v_mfma_f32_16x16x32_bf16 v[176:179], v[100:103], v[196:199], v[176:179]
    v_mfma_f32_16x16x32_bf16 v[184:187], v[100:103], v[220:223], v[184:187]
    v_mfma_f32_16x16x32_bf16 v[164:167], v[104:107], a[208:211], v[164:167]
    v_mfma_f32_16x16x32_bf16 v[172:175], v[104:107], a[232:235], v[172:175]
    v_mfma_f32_16x16x32_bf16 v[180:183], v[104:107], v[192:195], v[180:183]
    v_mfma_f32_16x16x32_bf16 v[188:191], v[104:107], v[216:219], v[188:191]
    v_mfma_f32_16x16x32_bf16 v[164:167], v[108:111], a[212:215], v[164:167]
    v_mfma_f32_16x16x32_bf16 v[172:175], v[108:111], a[236:239], v[172:175]
    v_mfma_f32_16x16x32_bf16 v[180:183], v[108:111], v[196:199], v[180:183]
    v_mfma_f32_16x16x32_bf16 v[188:191], v[108:111], v[220:223], v[188:191]
    s_nop 9
    v_max3_f32 v16, v160, v161, v162
    v_max3_f32 v16, v16, v163, v164
    v_max3_f32 v16, v16, v165, v166
    v_max3_f32 v16, v16, v167, v240
    v_mov_b32 v17, v16
    s_nop 1
    v_permlane16_swap_b32 v16, v17
    s_nop 1
    v_max_f32 v16, v16, v17
    v_mov_b32 v17, v16
    s_nop 1
    v_permlane32_swap_b32 v16, v17
    s_nop 1
    v_max_f32 v16, v16, v17
    v_sub_f32 v17, v240, v16
    v_exp_f32 v17, v17
    v_mov_b32 v240, v16
    v_sub_f32 v160, v160, v16
    v_sub_f32 v161, v161, v16
    v_sub_f32 v162, v162, v16
    v_sub_f32 v163, v163, v16
    v_sub_f32 v164, v164, v16
    v_sub_f32 v165, v165, v16
    v_sub_f32 v166, v166, v16
    v_sub_f32 v167, v167, v16
    v_exp_f32 v160, v160
    v_exp_f32 v161, v161
    v_exp_f32 v162, v162
    v_exp_f32 v163, v163
    v_exp_f32 v164, v164
    v_exp_f32 v165, v165
    v_exp_f32 v166, v166
    v_exp_f32 v167, v167
    v_mul_f32 v5, v5, v17
    v_add_f32 v5, v5, v160
    v_add_f32 v5, v5, v161
    v_add_f32 v5, v5, v162
    v_add_f32 v5, v5, v163
    v_add_f32 v5, v5, v164
    v_add_f32 v5, v5, v165
    v_add_f32 v5, v5, v166
    v_add_f32 v5, v5, v167
    v_cvt_pk_bf16_f32 v224, v160, v161
    v_cvt_pk_bf16_f32 v225, v162, v163
    v_cvt_pk_bf16_f32 v226, v164, v165
    v_cvt_pk_bf16_f32 v227, v166, v167
    ds_bpermute_b32 v248, v58, v17 offset:0
    ds_bpermute_b32 v249, v58, v17 offset:4
    ds_bpermute_b32 v250, v58, v17 offset:8
    ds_bpermute_b32 v251, v58, v17 offset:12
    s_waitcnt lgkmcnt(0)
    v_accvgpr_read_b32 v18, a0
    v_mul_f32 v18, v18, v248
    v_accvgpr_write_b32 a0, v18
    v_accvgpr_read_b32 v19, a1
    v_mul_f32 v19, v19, v249
    v_accvgpr_write_b32 a1, v19
    v_accvgpr_read_b32 v18, a2
    v_mul_f32 v18, v18, v250
    v_accvgpr_write_b32 a2, v18
    v_accvgpr_read_b32 v19, a3
    v_mul_f32 v19, v19, v251
    v_accvgpr_write_b32 a3, v19
    v_accvgpr_read_b32 v18, a4
    v_mul_f32 v18, v18, v248
    v_accvgpr_write_b32 a4, v18
    v_accvgpr_read_b32 v19, a5
    v_mul_f32 v19, v19, v249
    v_accvgpr_write_b32 a5, v19
    v_accvgpr_read_b32 v18, a6
    v_mul_f32 v18, v18, v250
    v_accvgpr_write_b32 a6, v18
    v_accvgpr_read_b32 v19, a7
    v_mul_f32 v19, v19, v251
    v_accvgpr_write_b32 a7, v19
    v_accvgpr_read_b32 v18, a8
    v_mul_f32 v18, v18, v248
    v_accvgpr_write_b32 a8, v18
    v_accvgpr_read_b32 v19, a9
    v_mul_f32 v19, v19, v249
    v_accvgpr_write_b32 a9, v19
    v_accvgpr_read_b32 v18, a10
    v_mul_f32 v18, v18, v250
    v_accvgpr_write_b32 a10, v18
    v_accvgpr_read_b32 v19, a11
    v_mul_f32 v19, v19, v251
    v_accvgpr_write_b32 a11, v19
    v_accvgpr_read_b32 v18, a12
    v_mul_f32 v18, v18, v248
    v_accvgpr_write_b32 a12, v18
    v_accvgpr_read_b32 v19, a13
    v_mul_f32 v19, v19, v249
    v_accvgpr_write_b32 a13, v19
    v_accvgpr_read_b32 v18, a14
    v_mul_f32 v18, v18, v250
    v_accvgpr_write_b32 a14, v18
    v_accvgpr_read_b32 v19, a15
    v_mul_f32 v19, v19, v251
    v_accvgpr_write_b32 a15, v19
    v_accvgpr_read_b32 v18, a16
    v_mul_f32 v18, v18, v248
    v_accvgpr_write_b32 a16, v18
    v_accvgpr_read_b32 v19, a17
    v_mul_f32 v19, v19, v249
    v_accvgpr_write_b32 a17, v19
    v_accvgpr_read_b32 v18, a18
    v_mul_f32 v18, v18, v250
    v_accvgpr_write_b32 a18, v18
    v_accvgpr_read_b32 v19, a19
    v_mul_f32 v19, v19, v251
    v_accvgpr_write_b32 a19, v19
    v_accvgpr_read_b32 v18, a20
    v_mul_f32 v18, v18, v248
    v_accvgpr_write_b32 a20, v18
    v_accvgpr_read_b32 v19, a21
    v_mul_f32 v19, v19, v249
    v_accvgpr_write_b32 a21, v19
    v_accvgpr_read_b32 v18, a22
    v_mul_f32 v18, v18, v250
    v_accvgpr_write_b32 a22, v18
    v_accvgpr_read_b32 v19, a23
    v_mul_f32 v19, v19, v251
    v_accvgpr_write_b32 a23, v19
    v_accvgpr_read_b32 v18, a24
    v_mul_f32 v18, v18, v248
    v_accvgpr_write_b32 a24, v18
    v_accvgpr_read_b32 v19, a25
    v_mul_f32 v19, v19, v249
    v_accvgpr_write_b32 a25, v19
    v_accvgpr_read_b32 v18, a26
    v_mul_f32 v18, v18, v250
    v_accvgpr_write_b32 a26, v18
    v_accvgpr_read_b32 v19, a27
    v_mul_f32 v19, v19, v251
    v_accvgpr_write_b32 a27, v19
    v_accvgpr_read_b32 v18, a28
    v_mul_f32 v18, v18, v248
    v_accvgpr_write_b32 a28, v18
    v_accvgpr_read_b32 v19, a29
    v_mul_f32 v19, v19, v249
    v_accvgpr_write_b32 a29, v19
    v_accvgpr_read_b32 v18, a30
    v_mul_f32 v18, v18, v250
    v_accvgpr_write_b32 a30, v18
    v_accvgpr_read_b32 v19, a31
    v_mul_f32 v19, v19, v251
    v_accvgpr_write_b32 a31, v19
    v_accvgpr_read_b32 v18, a32
    v_mul_f32 v18, v18, v248
    v_accvgpr_write_b32 a32, v18
    v_accvgpr_read_b32 v19, a33
    v_mul_f32 v19, v19, v249
    v_accvgpr_write_b32 a33, v19
    v_accvgpr_read_b32 v18, a34
    v_mul_f32 v18, v18, v250
    v_accvgpr_write_b32 a34, v18
    v_accvgpr_read_b32 v19, a35
    v_mul_f32 v19, v19, v251
    v_accvgpr_write_b32 a35, v19
    v_accvgpr_read_b32 v18, a36
    v_mul_f32 v18, v18, v248
    v_accvgpr_write_b32 a36, v18
    v_accvgpr_read_b32 v19, a37
    v_mul_f32 v19, v19, v249
    v_accvgpr_write_b32 a37, v19
    v_accvgpr_read_b32 v18, a38
    v_mul_f32 v18, v18, v250
    v_accvgpr_write_b32 a38, v18
    v_accvgpr_read_b32 v19, a39
    v_mul_f32 v19, v19, v251
    v_accvgpr_write_b32 a39, v19
    v_accvgpr_read_b32 v18, a40
    v_mul_f32 v18, v18, v248
    v_accvgpr_write_b32 a40, v18
    v_accvgpr_read_b32 v19, a41
    v_mul_f32 v19, v19, v249
    v_accvgpr_write_b32 a41, v19
    v_accvgpr_read_b32 v18, a42
    v_mul_f32 v18, v18, v250
    v_accvgpr_write_b32 a42, v18
    v_accvgpr_read_b32 v19, a43
    v_mul_f32 v19, v19, v251
    v_accvgpr_write_b32 a43, v19
    v_accvgpr_read_b32 v18, a44
    v_mul_f32 v18, v18, v248
    v_accvgpr_write_b32 a44, v18
    v_accvgpr_read_b32 v19, a45
    v_mul_f32 v19, v19, v249
    v_accvgpr_write_b32 a45, v19
    v_accvgpr_read_b32 v18, a46
    v_mul_f32 v18, v18, v250
    v_accvgpr_write_b32 a46, v18
    v_accvgpr_read_b32 v19, a47
    v_mul_f32 v19, v19, v251
    v_accvgpr_write_b32 a47, v19
    v_max3_f32 v16, v168, v169, v170
    v_max3_f32 v16, v16, v171, v172
    v_max3_f32 v16, v16, v173, v174
    v_max3_f32 v16, v16, v175, v241
    v_mov_b32 v17, v16
    s_nop 1
    v_permlane16_swap_b32 v16, v17
    s_nop 1
    v_max_f32 v16, v16, v17
    v_mov_b32 v17, v16
    s_nop 1
    v_permlane32_swap_b32 v16, v17
    s_nop 1
    v_max_f32 v16, v16, v17
    v_sub_f32 v17, v241, v16
    v_exp_f32 v17, v17
    v_mov_b32 v241, v16
    v_sub_f32 v168, v168, v16
    v_sub_f32 v169, v169, v16
    v_sub_f32 v170, v170, v16
    v_sub_f32 v171, v171, v16
    v_sub_f32 v172, v172, v16
    v_sub_f32 v173, v173, v16
    v_sub_f32 v174, v174, v16
    v_sub_f32 v175, v175, v16
    v_exp_f32 v168, v168
    v_exp_f32 v169, v169
    v_exp_f32 v170, v170
    v_exp_f32 v171, v171
    v_exp_f32 v172, v172
    v_exp_f32 v173, v173
    v_exp_f32 v174, v174
    v_exp_f32 v175, v175
    v_mul_f32 v6, v6, v17
    v_add_f32 v6, v6, v168
    v_add_f32 v6, v6, v169
    v_add_f32 v6, v6, v170
    v_add_f32 v6, v6, v171
    v_add_f32 v6, v6, v172
    v_add_f32 v6, v6, v173
    v_add_f32 v6, v6, v174
    v_add_f32 v6, v6, v175
    v_cvt_pk_bf16_f32 v228, v168, v169
    v_cvt_pk_bf16_f32 v229, v170, v171
    v_cvt_pk_bf16_f32 v230, v172, v173
    v_cvt_pk_bf16_f32 v231, v174, v175
    ds_bpermute_b32 v248, v58, v17 offset:0
    ds_bpermute_b32 v249, v58, v17 offset:4
    ds_bpermute_b32 v250, v58, v17 offset:8
    ds_bpermute_b32 v251, v58, v17 offset:12
    s_waitcnt lgkmcnt(0)
    v_accvgpr_read_b32 v18, a48
    v_mul_f32 v18, v18, v248
    v_accvgpr_write_b32 a48, v18
    v_accvgpr_read_b32 v19, a49
    v_mul_f32 v19, v19, v249
    v_accvgpr_write_b32 a49, v19
    v_accvgpr_read_b32 v18, a50
    v_mul_f32 v18, v18, v250
    v_accvgpr_write_b32 a50, v18
    v_accvgpr_read_b32 v19, a51
    v_mul_f32 v19, v19, v251
    v_accvgpr_write_b32 a51, v19
    v_accvgpr_read_b32 v18, a52
    v_mul_f32 v18, v18, v248
    v_accvgpr_write_b32 a52, v18
    v_accvgpr_read_b32 v19, a53
    v_mul_f32 v19, v19, v249
    v_accvgpr_write_b32 a53, v19
    v_accvgpr_read_b32 v18, a54
    v_mul_f32 v18, v18, v250
    v_accvgpr_write_b32 a54, v18
    v_accvgpr_read_b32 v19, a55
    v_mul_f32 v19, v19, v251
    v_accvgpr_write_b32 a55, v19
    v_accvgpr_read_b32 v18, a56
    v_mul_f32 v18, v18, v248
    v_accvgpr_write_b32 a56, v18
    v_accvgpr_read_b32 v19, a57
    v_mul_f32 v19, v19, v249
    v_accvgpr_write_b32 a57, v19
    v_accvgpr_read_b32 v18, a58
    v_mul_f32 v18, v18, v250
    v_accvgpr_write_b32 a58, v18
    v_accvgpr_read_b32 v19, a59
    v_mul_f32 v19, v19, v251
    v_accvgpr_write_b32 a59, v19
    v_accvgpr_read_b32 v18, a60
    v_mul_f32 v18, v18, v248
    v_accvgpr_write_b32 a60, v18
    v_accvgpr_read_b32 v19, a61
    v_mul_f32 v19, v19, v249
    v_accvgpr_write_b32 a61, v19
    v_accvgpr_read_b32 v18, a62
    v_mul_f32 v18, v18, v250
    v_accvgpr_write_b32 a62, v18
    v_accvgpr_read_b32 v19, a63
    v_mul_f32 v19, v19, v251
    v_accvgpr_write_b32 a63, v19
    v_accvgpr_read_b32 v18, a64
    v_mul_f32 v18, v18, v248
    v_accvgpr_write_b32 a64, v18
    v_accvgpr_read_b32 v19, a65
    v_mul_f32 v19, v19, v249
    v_accvgpr_write_b32 a65, v19
    v_accvgpr_read_b32 v18, a66
    v_mul_f32 v18, v18, v250
    v_accvgpr_write_b32 a66, v18
    v_accvgpr_read_b32 v19, a67
    v_mul_f32 v19, v19, v251
    v_accvgpr_write_b32 a67, v19
    v_accvgpr_read_b32 v18, a68
    v_mul_f32 v18, v18, v248
    v_accvgpr_write_b32 a68, v18
    v_accvgpr_read_b32 v19, a69
    v_mul_f32 v19, v19, v249
    v_accvgpr_write_b32 a69, v19
    v_accvgpr_read_b32 v18, a70
    v_mul_f32 v18, v18, v250
    v_accvgpr_write_b32 a70, v18
    v_accvgpr_read_b32 v19, a71
    v_mul_f32 v19, v19, v251
    v_accvgpr_write_b32 a71, v19
    v_accvgpr_read_b32 v18, a72
    v_mul_f32 v18, v18, v248
    v_accvgpr_write_b32 a72, v18
    v_accvgpr_read_b32 v19, a73
    v_mul_f32 v19, v19, v249
    v_accvgpr_write_b32 a73, v19
    v_accvgpr_read_b32 v18, a74
    v_mul_f32 v18, v18, v250
    v_accvgpr_write_b32 a74, v18
    v_accvgpr_read_b32 v19, a75
    v_mul_f32 v19, v19, v251
    v_accvgpr_write_b32 a75, v19
    v_accvgpr_read_b32 v18, a76
    v_mul_f32 v18, v18, v248
    v_accvgpr_write_b32 a76, v18
    v_accvgpr_read_b32 v19, a77
    v_mul_f32 v19, v19, v249
    v_accvgpr_write_b32 a77, v19
    v_accvgpr_read_b32 v18, a78
    v_mul_f32 v18, v18, v250
    v_accvgpr_write_b32 a78, v18
    v_accvgpr_read_b32 v19, a79
    v_mul_f32 v19, v19, v251
    v_accvgpr_write_b32 a79, v19
    v_accvgpr_read_b32 v18, a80
    v_mul_f32 v18, v18, v248
    v_accvgpr_write_b32 a80, v18
    v_accvgpr_read_b32 v19, a81
    v_mul_f32 v19, v19, v249
    v_accvgpr_write_b32 a81, v19
    v_accvgpr_read_b32 v18, a82
    v_mul_f32 v18, v18, v250
    v_accvgpr_write_b32 a82, v18
    v_accvgpr_read_b32 v19, a83
    v_mul_f32 v19, v19, v251
    v_accvgpr_write_b32 a83, v19
    v_accvgpr_read_b32 v18, a84
    v_mul_f32 v18, v18, v248
    v_accvgpr_write_b32 a84, v18
    v_accvgpr_read_b32 v19, a85
    v_mul_f32 v19, v19, v249
    v_accvgpr_write_b32 a85, v19
    v_accvgpr_read_b32 v18, a86
    v_mul_f32 v18, v18, v250
    v_accvgpr_write_b32 a86, v18
    v_accvgpr_read_b32 v19, a87
    v_mul_f32 v19, v19, v251
    v_accvgpr_write_b32 a87, v19
    v_accvgpr_read_b32 v18, a88
    v_mul_f32 v18, v18, v248
    v_accvgpr_write_b32 a88, v18
    v_accvgpr_read_b32 v19, a89
    v_mul_f32 v19, v19, v249
    v_accvgpr_write_b32 a89, v19
    v_accvgpr_read_b32 v18, a90
    v_mul_f32 v18, v18, v250
    v_accvgpr_write_b32 a90, v18
    v_accvgpr_read_b32 v19, a91
    v_mul_f32 v19, v19, v251
    v_accvgpr_write_b32 a91, v19
    v_accvgpr_read_b32 v18, a92
    v_mul_f32 v18, v18, v248
    v_accvgpr_write_b32 a92, v18
    v_accvgpr_read_b32 v19, a93
    v_mul_f32 v19, v19, v249
    v_accvgpr_write_b32 a93, v19
    v_accvgpr_read_b32 v18, a94
    v_mul_f32 v18, v18, v250
    v_accvgpr_write_b32 a94, v18
    v_accvgpr_read_b32 v19, a95
    v_mul_f32 v19, v19, v251
    v_accvgpr_write_b32 a95, v19
    v_max3_f32 v16, v176, v177, v178
    v_max3_f32 v16, v16, v179, v180
    v_max3_f32 v16, v16, v181, v182
    v_max3_f32 v16, v16, v183, v242
    v_mov_b32 v17, v16
    s_nop 1
    v_permlane16_swap_b32 v16, v17
    s_nop 1
    v_max_f32 v16, v16, v17
    v_mov_b32 v17, v16
    s_nop 1
    v_permlane32_swap_b32 v16, v17
    s_nop 1
    v_max_f32 v16, v16, v17
    v_sub_f32 v17, v242, v16
    v_exp_f32 v17, v17
    v_mov_b32 v242, v16
    v_sub_f32 v176, v176, v16
    v_sub_f32 v177, v177, v16
    v_sub_f32 v178, v178, v16
    v_sub_f32 v179, v179, v16
    v_sub_f32 v180, v180, v16
    v_sub_f32 v181, v181, v16
    v_sub_f32 v182, v182, v16
    v_sub_f32 v183, v183, v16
    v_exp_f32 v176, v176
    v_exp_f32 v177, v177
    v_exp_f32 v178, v178
    v_exp_f32 v179, v179
    v_exp_f32 v180, v180
    v_exp_f32 v181, v181
    v_exp_f32 v182, v182
    v_exp_f32 v183, v183
    v_mul_f32 v7, v7, v17
    v_add_f32 v7, v7, v176
    v_add_f32 v7, v7, v177
    v_add_f32 v7, v7, v178
    v_add_f32 v7, v7, v179
    v_add_f32 v7, v7, v180
    v_add_f32 v7, v7, v181
    v_add_f32 v7, v7, v182
    v_add_f32 v7, v7, v183
    v_cvt_pk_bf16_f32 v232, v176, v177
    v_cvt_pk_bf16_f32 v233, v178, v179
    v_cvt_pk_bf16_f32 v234, v180, v181
    v_cvt_pk_bf16_f32 v235, v182, v183
    ds_bpermute_b32 v248, v58, v17 offset:0
    ds_bpermute_b32 v249, v58, v17 offset:4
    ds_bpermute_b32 v250, v58, v17 offset:8
    ds_bpermute_b32 v251, v58, v17 offset:12
    s_waitcnt lgkmcnt(0)
    v_accvgpr_read_b32 v18, a96
    v_mul_f32 v18, v18, v248
    v_accvgpr_write_b32 a96, v18
    v_accvgpr_read_b32 v19, a97
    v_mul_f32 v19, v19, v249
    v_accvgpr_write_b32 a97, v19
    v_accvgpr_read_b32 v18, a98
    v_mul_f32 v18, v18, v250
    v_accvgpr_write_b32 a98, v18
    v_accvgpr_read_b32 v19, a99
    v_mul_f32 v19, v19, v251
    v_accvgpr_write_b32 a99, v19
    v_accvgpr_read_b32 v18, a100
    v_mul_f32 v18, v18, v248
    v_accvgpr_write_b32 a100, v18
    v_accvgpr_read_b32 v19, a101
    v_mul_f32 v19, v19, v249
    v_accvgpr_write_b32 a101, v19
    v_accvgpr_read_b32 v18, a102
    v_mul_f32 v18, v18, v250
    v_accvgpr_write_b32 a102, v18
    v_accvgpr_read_b32 v19, a103
    v_mul_f32 v19, v19, v251
    v_accvgpr_write_b32 a103, v19
    v_accvgpr_read_b32 v18, a104
    v_mul_f32 v18, v18, v248
    v_accvgpr_write_b32 a104, v18
    v_accvgpr_read_b32 v19, a105
    v_mul_f32 v19, v19, v249
    v_accvgpr_write_b32 a105, v19
    v_accvgpr_read_b32 v18, a106
    v_mul_f32 v18, v18, v250
    v_accvgpr_write_b32 a106, v18
    v_accvgpr_read_b32 v19, a107
    v_mul_f32 v19, v19, v251
    v_accvgpr_write_b32 a107, v19
    v_accvgpr_read_b32 v18, a108
    v_mul_f32 v18, v18, v248
    v_accvgpr_write_b32 a108, v18
    v_accvgpr_read_b32 v19, a109
    v_mul_f32 v19, v19, v249
    v_accvgpr_write_b32 a109, v19
    v_accvgpr_read_b32 v18, a110
    v_mul_f32 v18, v18, v250
    v_accvgpr_write_b32 a110, v18
    v_accvgpr_read_b32 v19, a111
    v_mul_f32 v19, v19, v251
    v_accvgpr_write_b32 a111, v19
    v_accvgpr_read_b32 v18, a112
    v_mul_f32 v18, v18, v248
    v_accvgpr_write_b32 a112, v18
    v_accvgpr_read_b32 v19, a113
    v_mul_f32 v19, v19, v249
    v_accvgpr_write_b32 a113, v19
    v_accvgpr_read_b32 v18, a114
    v_mul_f32 v18, v18, v250
    v_accvgpr_write_b32 a114, v18
    v_accvgpr_read_b32 v19, a115
    v_mul_f32 v19, v19, v251
    v_accvgpr_write_b32 a115, v19
    v_accvgpr_read_b32 v18, a116
    v_mul_f32 v18, v18, v248
    v_accvgpr_write_b32 a116, v18
    v_accvgpr_read_b32 v19, a117
    v_mul_f32 v19, v19, v249
    v_accvgpr_write_b32 a117, v19
    v_accvgpr_read_b32 v18, a118
    v_mul_f32 v18, v18, v250
    v_accvgpr_write_b32 a118, v18
    v_accvgpr_read_b32 v19, a119
    v_mul_f32 v19, v19, v251
    v_accvgpr_write_b32 a119, v19
    v_accvgpr_read_b32 v18, a120
    v_mul_f32 v18, v18, v248
    v_accvgpr_write_b32 a120, v18
    v_accvgpr_read_b32 v19, a121
    v_mul_f32 v19, v19, v249
    v_accvgpr_write_b32 a121, v19
    v_accvgpr_read_b32 v18, a122
    v_mul_f32 v18, v18, v250
    v_accvgpr_write_b32 a122, v18
    v_accvgpr_read_b32 v19, a123
    v_mul_f32 v19, v19, v251
    v_accvgpr_write_b32 a123, v19
    v_accvgpr_read_b32 v18, a124
    v_mul_f32 v18, v18, v248
    v_accvgpr_write_b32 a124, v18
    v_accvgpr_read_b32 v19, a125
    v_mul_f32 v19, v19, v249
    v_accvgpr_write_b32 a125, v19
    v_accvgpr_read_b32 v18, a126
    v_mul_f32 v18, v18, v250
    v_accvgpr_write_b32 a126, v18
    v_accvgpr_read_b32 v19, a127
    v_mul_f32 v19, v19, v251
    v_accvgpr_write_b32 a127, v19
    v_accvgpr_read_b32 v18, a128
    v_mul_f32 v18, v18, v248
    v_accvgpr_write_b32 a128, v18
    v_accvgpr_read_b32 v19, a129
    v_mul_f32 v19, v19, v249
    v_accvgpr_write_b32 a129, v19
    v_accvgpr_read_b32 v18, a130
    v_mul_f32 v18, v18, v250
    v_accvgpr_write_b32 a130, v18
    v_accvgpr_read_b32 v19, a131
    v_mul_f32 v19, v19, v251
    v_accvgpr_write_b32 a131, v19
    v_accvgpr_read_b32 v18, a132
    v_mul_f32 v18, v18, v248
    v_accvgpr_write_b32 a132, v18
    v_accvgpr_read_b32 v19, a133
    v_mul_f32 v19, v19, v249
    v_accvgpr_write_b32 a133, v19
    v_accvgpr_read_b32 v18, a134
    v_mul_f32 v18, v18, v250
    v_accvgpr_write_b32 a134, v18
    v_accvgpr_read_b32 v19, a135
    v_mul_f32 v19, v19, v251
    v_accvgpr_write_b32 a135, v19
    v_accvgpr_read_b32 v18, a136
    v_mul_f32 v18, v18, v248
    v_accvgpr_write_b32 a136, v18
    v_accvgpr_read_b32 v19, a137
    v_mul_f32 v19, v19, v249
    v_accvgpr_write_b32 a137, v19
    v_accvgpr_read_b32 v18, a138
    v_mul_f32 v18, v18, v250
    v_accvgpr_write_b32 a138, v18
    v_accvgpr_read_b32 v19, a139
    v_mul_f32 v19, v19, v251
    v_accvgpr_write_b32 a139, v19
    v_accvgpr_read_b32 v18, a140
    v_mul_f32 v18, v18, v248
    v_accvgpr_write_b32 a140, v18
    v_accvgpr_read_b32 v19, a141
    v_mul_f32 v19, v19, v249
    v_accvgpr_write_b32 a141, v19
    v_accvgpr_read_b32 v18, a142
    v_mul_f32 v18, v18, v250
    v_accvgpr_write_b32 a142, v18
    v_accvgpr_read_b32 v19, a143
    v_mul_f32 v19, v19, v251
    v_accvgpr_write_b32 a143, v19
    v_max3_f32 v16, v184, v185, v186
    v_max3_f32 v16, v16, v187, v188
    v_max3_f32 v16, v16, v189, v190
    v_max3_f32 v16, v16, v191, v243
    v_mov_b32 v17, v16
    s_nop 1
    v_permlane16_swap_b32 v16, v17
    s_nop 1
    v_max_f32 v16, v16, v17
    v_mov_b32 v17, v16
    s_nop 1
    v_permlane32_swap_b32 v16, v17
    s_nop 1
    v_max_f32 v16, v16, v17
    v_sub_f32 v17, v243, v16
    v_exp_f32 v17, v17
    v_mov_b32 v243, v16
    v_sub_f32 v184, v184, v16
    v_sub_f32 v185, v185, v16
    v_sub_f32 v186, v186, v16
    v_sub_f32 v187, v187, v16
    v_sub_f32 v188, v188, v16
    v_sub_f32 v189, v189, v16
    v_sub_f32 v190, v190, v16
    v_sub_f32 v191, v191, v16
    v_exp_f32 v184, v184
    v_exp_f32 v185, v185
    v_exp_f32 v186, v186
    v_exp_f32 v187, v187
    v_exp_f32 v188, v188
    v_exp_f32 v189, v189
    v_exp_f32 v190, v190
    v_exp_f32 v191, v191
    v_mul_f32 v8, v8, v17
    v_add_f32 v8, v8, v184
    v_add_f32 v8, v8, v185
    v_add_f32 v8, v8, v186
    v_add_f32 v8, v8, v187
    v_add_f32 v8, v8, v188
    v_add_f32 v8, v8, v189
    v_add_f32 v8, v8, v190
    v_add_f32 v8, v8, v191
    v_cvt_pk_bf16_f32 v236, v184, v185
    v_cvt_pk_bf16_f32 v237, v186, v187
    v_cvt_pk_bf16_f32 v238, v188, v189
    v_cvt_pk_bf16_f32 v239, v190, v191
    ds_bpermute_b32 v248, v58, v17 offset:0
    ds_bpermute_b32 v249, v58, v17 offset:4
    ds_bpermute_b32 v250, v58, v17 offset:8
    ds_bpermute_b32 v251, v58, v17 offset:12
    s_waitcnt lgkmcnt(0)
    v_accvgpr_read_b32 v18, a144
    v_mul_f32 v18, v18, v248
    v_accvgpr_write_b32 a144, v18
    v_accvgpr_read_b32 v19, a145
    v_mul_f32 v19, v19, v249
    v_accvgpr_write_b32 a145, v19
    v_accvgpr_read_b32 v18, a146
    v_mul_f32 v18, v18, v250
    v_accvgpr_write_b32 a146, v18
    v_accvgpr_read_b32 v19, a147
    v_mul_f32 v19, v19, v251
    v_accvgpr_write_b32 a147, v19
    v_accvgpr_read_b32 v18, a148
    v_mul_f32 v18, v18, v248
    v_accvgpr_write_b32 a148, v18
    v_accvgpr_read_b32 v19, a149
    v_mul_f32 v19, v19, v249
    v_accvgpr_write_b32 a149, v19
    v_accvgpr_read_b32 v18, a150
    v_mul_f32 v18, v18, v250
    v_accvgpr_write_b32 a150, v18
    v_accvgpr_read_b32 v19, a151
    v_mul_f32 v19, v19, v251
    v_accvgpr_write_b32 a151, v19
    v_accvgpr_read_b32 v18, a152
    v_mul_f32 v18, v18, v248
    v_accvgpr_write_b32 a152, v18
    v_accvgpr_read_b32 v19, a153
    v_mul_f32 v19, v19, v249
    v_accvgpr_write_b32 a153, v19
    v_accvgpr_read_b32 v18, a154
    v_mul_f32 v18, v18, v250
    v_accvgpr_write_b32 a154, v18
    v_accvgpr_read_b32 v19, a155
    v_mul_f32 v19, v19, v251
    v_accvgpr_write_b32 a155, v19
    v_accvgpr_read_b32 v18, a156
    v_mul_f32 v18, v18, v248
    v_accvgpr_write_b32 a156, v18
    v_accvgpr_read_b32 v19, a157
    v_mul_f32 v19, v19, v249
    v_accvgpr_write_b32 a157, v19
    v_accvgpr_read_b32 v18, a158
    v_mul_f32 v18, v18, v250
    v_accvgpr_write_b32 a158, v18
    v_accvgpr_read_b32 v19, a159
    v_mul_f32 v19, v19, v251
    v_accvgpr_write_b32 a159, v19
    v_accvgpr_read_b32 v18, a160
    v_mul_f32 v18, v18, v248
    v_accvgpr_write_b32 a160, v18
    v_accvgpr_read_b32 v19, a161
    v_mul_f32 v19, v19, v249
    v_accvgpr_write_b32 a161, v19
    v_accvgpr_read_b32 v18, a162
    v_mul_f32 v18, v18, v250
    v_accvgpr_write_b32 a162, v18
    v_accvgpr_read_b32 v19, a163
    v_mul_f32 v19, v19, v251
    v_accvgpr_write_b32 a163, v19
    v_accvgpr_read_b32 v18, a164
    v_mul_f32 v18, v18, v248
    v_accvgpr_write_b32 a164, v18
    v_accvgpr_read_b32 v19, a165
    v_mul_f32 v19, v19, v249
    v_accvgpr_write_b32 a165, v19
    v_accvgpr_read_b32 v18, a166
    v_mul_f32 v18, v18, v250
    v_accvgpr_write_b32 a166, v18
    v_accvgpr_read_b32 v19, a167
    v_mul_f32 v19, v19, v251
    v_accvgpr_write_b32 a167, v19
    v_accvgpr_read_b32 v18, a168
    v_mul_f32 v18, v18, v248
    v_accvgpr_write_b32 a168, v18
    v_accvgpr_read_b32 v19, a169
    v_mul_f32 v19, v19, v249
    v_accvgpr_write_b32 a169, v19
    v_accvgpr_read_b32 v18, a170
    v_mul_f32 v18, v18, v250
    v_accvgpr_write_b32 a170, v18
    v_accvgpr_read_b32 v19, a171
    v_mul_f32 v19, v19, v251
    v_accvgpr_write_b32 a171, v19
    v_accvgpr_read_b32 v18, a172
    v_mul_f32 v18, v18, v248
    v_accvgpr_write_b32 a172, v18
    v_accvgpr_read_b32 v19, a173
    v_mul_f32 v19, v19, v249
    v_accvgpr_write_b32 a173, v19
    v_accvgpr_read_b32 v18, a174
    v_mul_f32 v18, v18, v250
    v_accvgpr_write_b32 a174, v18
    v_accvgpr_read_b32 v19, a175
    v_mul_f32 v19, v19, v251
    v_accvgpr_write_b32 a175, v19
    v_accvgpr_read_b32 v18, a176
    v_mul_f32 v18, v18, v248
    v_accvgpr_write_b32 a176, v18
    v_accvgpr_read_b32 v19, a177
    v_mul_f32 v19, v19, v249
    v_accvgpr_write_b32 a177, v19
    v_accvgpr_read_b32 v18, a178
    v_mul_f32 v18, v18, v250
    v_accvgpr_write_b32 a178, v18
    v_accvgpr_read_b32 v19, a179
    v_mul_f32 v19, v19, v251
    v_accvgpr_write_b32 a179, v19
    v_accvgpr_read_b32 v18, a180
    v_mul_f32 v18, v18, v248
    v_accvgpr_write_b32 a180, v18
    v_accvgpr_read_b32 v19, a181
    v_mul_f32 v19, v19, v249
    v_accvgpr_write_b32 a181, v19
    v_accvgpr_read_b32 v18, a182
    v_mul_f32 v18, v18, v250
    v_accvgpr_write_b32 a182, v18
    v_accvgpr_read_b32 v19, a183
    v_mul_f32 v19, v19, v251
    v_accvgpr_write_b32 a183, v19
    v_accvgpr_read_b32 v18, a184
    v_mul_f32 v18, v18, v248
    v_accvgpr_write_b32 a184, v18
    v_accvgpr_read_b32 v19, a185
    v_mul_f32 v19, v19, v249
    v_accvgpr_write_b32 a185, v19
    v_accvgpr_read_b32 v18, a186
    v_mul_f32 v18, v18, v250
    v_accvgpr_write_b32 a186, v18
    v_accvgpr_read_b32 v19, a187
    v_mul_f32 v19, v19, v251
    v_accvgpr_write_b32 a187, v19
    v_accvgpr_read_b32 v18, a188
    v_mul_f32 v18, v18, v248
    v_accvgpr_write_b32 a188, v18
    v_accvgpr_read_b32 v19, a189
    v_mul_f32 v19, v19, v249
    v_accvgpr_write_b32 a189, v19
    v_accvgpr_read_b32 v18, a190
    v_mul_f32 v18, v18, v250
    v_accvgpr_write_b32 a190, v18
    v_accvgpr_read_b32 v19, a191
    v_mul_f32 v19, v19, v251
    v_accvgpr_write_b32 a191, v19
    s_waitcnt vmcnt(0)
    s_nop 1
    v_mfma_f32_16x16x32_bf16 a[0:3], v[224:227], v[112:115], a[0:3]
    v_mfma_f32_16x16x32_bf16 a[48:51], v[228:231], v[112:115], a[48:51]
    v_mfma_f32_16x16x32_bf16 a[96:99], v[232:235], v[112:115], a[96:99]
    v_mfma_f32_16x16x32_bf16 a[144:147], v[236:239], v[112:115], a[144:147]
    v_mfma_f32_16x16x32_bf16 a[4:7], v[224:227], v[116:119], a[4:7]
    v_mfma_f32_16x16x32_bf16 a[52:55], v[228:231], v[116:119], a[52:55]
    v_mfma_f32_16x16x32_bf16 a[100:103], v[232:235], v[116:119], a[100:103]
    v_mfma_f32_16x16x32_bf16 a[148:151], v[236:239], v[116:119], a[148:151]
    v_mfma_f32_16x16x32_bf16 a[8:11], v[224:227], v[120:123], a[8:11]
    v_mfma_f32_16x16x32_bf16 a[56:59], v[228:231], v[120:123], a[56:59]
    v_mfma_f32_16x16x32_bf16 a[104:107], v[232:235], v[120:123], a[104:107]
    v_mfma_f32_16x16x32_bf16 a[152:155], v[236:239], v[120:123], a[152:155]
    v_mfma_f32_16x16x32_bf16 a[12:15], v[224:227], v[124:127], a[12:15]
    v_mfma_f32_16x16x32_bf16 a[60:63], v[228:231], v[124:127], a[60:63]
    v_mfma_f32_16x16x32_bf16 a[108:111], v[232:235], v[124:127], a[108:111]
    v_mfma_f32_16x16x32_bf16 a[156:159], v[236:239], v[124:127], a[156:159]
    v_mfma_f32_16x16x32_bf16 a[16:19], v[224:227], v[128:131], a[16:19]
    v_mfma_f32_16x16x32_bf16 a[64:67], v[228:231], v[128:131], a[64:67]
    v_mfma_f32_16x16x32_bf16 a[112:115], v[232:235], v[128:131], a[112:115]
    v_mfma_f32_16x16x32_bf16 a[160:163], v[236:239], v[128:131], a[160:163]
    v_mfma_f32_16x16x32_bf16 a[20:23], v[224:227], v[132:135], a[20:23]
    v_mfma_f32_16x16x32_bf16 a[68:71], v[228:231], v[132:135], a[68:71]
    v_mfma_f32_16x16x32_bf16 a[116:119], v[232:235], v[132:135], a[116:119]
    v_mfma_f32_16x16x32_bf16 a[164:167], v[236:239], v[132:135], a[164:167]
    v_mfma_f32_16x16x32_bf16 a[24:27], v[224:227], v[136:139], a[24:27]
    v_mfma_f32_16x16x32_bf16 a[72:75], v[228:231], v[136:139], a[72:75]
    v_mfma_f32_16x16x32_bf16 a[120:123], v[232:235], v[136:139], a[120:123]
    v_mfma_f32_16x16x32_bf16 a[168:171], v[236:239], v[136:139], a[168:171]
    v_mfma_f32_16x16x32_bf16 a[28:31], v[224:227], v[140:143], a[28:31]
    v_mfma_f32_16x16x32_bf16 a[76:79], v[228:231], v[140:143], a[76:79]
    v_mfma_f32_16x16x32_bf16 a[124:127], v[232:235], v[140:143], a[124:127]
    v_mfma_f32_16x16x32_bf16 a[172:175], v[236:239], v[140:143], a[172:175]
    v_mfma_f32_16x16x32_bf16 a[32:35], v[224:227], v[144:147], a[32:35]
    v_mfma_f32_16x16x32_bf16 a[80:83], v[228:231], v[144:147], a[80:83]
    v_mfma_f32_16x16x32_bf16 a[128:131], v[232:235], v[144:147], a[128:131]
    v_mfma_f32_16x16x32_bf16 a[176:179], v[236:239], v[144:147], a[176:179]
    v_mfma_f32_16x16x32_bf16 a[36:39], v[224:227], v[148:151], a[36:39]
    v_mfma_f32_16x16x32_bf16 a[84:87], v[228:231], v[148:151], a[84:87]
    v_mfma_f32_16x16x32_bf16 a[132:135], v[232:235], v[148:151], a[132:135]
    v_mfma_f32_16x16x32_bf16 a[180:183], v[236:239], v[148:151], a[180:183]
    v_mfma_f32_16x16x32_bf16 a[40:43], v[224:227], v[152:155], a[40:43]
    v_mfma_f32_16x16x32_bf16 a[88:91], v[228:231], v[152:155], a[88:91]
    v_mfma_f32_16x16x32_bf16 a[136:139], v[232:235], v[152:155], a[136:139]
    v_mfma_f32_16x16x32_bf16 a[184:187], v[236:239], v[152:155], a[184:187]
    v_mfma_f32_16x16x32_bf16 a[44:47], v[224:227], v[156:159], a[44:47]
    v_mfma_f32_16x16x32_bf16 a[92:95], v[228:231], v[156:159], a[92:95]
    v_mfma_f32_16x16x32_bf16 a[140:143], v[232:235], v[156:159], a[140:143]
    v_mfma_f32_16x16x32_bf16 a[188:191], v[236:239], v[156:159], a[188:191]
    s_add_u32 s48, s48, 24576
    s_cmp_lt_u32 s48, 1572864
    s_nop 7
    s_cbranch_scc1 L_slowloop
    s_nop 1
    v_mfma_f32_16x16x4_f32 v[48:51], v5, v57, 0
    v_mfma_f32_16x16x4_f32 v[52:55], v6, v57, 0
    s_nop 7
    s_nop 1
    v_rcp_f32 v48, v48
    v_rcp_f32 v49, v49
    v_rcp_f32 v50, v50
    v_rcp_f32 v51, v51
    v_rcp_f32 v52, v52
    v_rcp_f32 v53, v53
    v_rcp_f32 v54, v54
    v_rcp_f32 v55, v55
    v_mfma_f32_16x16x4_f32 v[128:131], v7, v57, 0
    v_mfma_f32_16x16x4_f32 v[132:135], v8, v57, 0
    s_nop 7
    s_nop 1
    v_rcp_f32 v128, v128
    v_rcp_f32 v129, v129
    v_rcp_f32 v130, v130
    v_rcp_f32 v131, v131
    v_rcp_f32 v132, v132
    v_rcp_f32 v133, v133
    v_rcp_f32 v134, v134
    v_rcp_f32 v135, v135
    s_nop 0
    v_accvgpr_read_b32 v64, a0
    v_accvgpr_read_b32 v65, a4
    v_accvgpr_read_b32 v66, a8
    v_accvgpr_read_b32 v67, a12
    v_accvgpr_read_b32 v68, a16
    v_accvgpr_read_b32 v69, a20
    v_pk_mul_f32 v[64:65], v[64:65], v[48:49] op_sel_hi:[1,0]
    v_pk_mul_f32 v[66:67], v[66:67], v[48:49] op_sel_hi:[1,0]
    v_pk_mul_f32 v[68:69], v[68:69], v[48:49] op_sel_hi:[1,0]
    v_cvt_pk_bf16_f32 v64, v64, v65
    v_cvt_pk_bf16_f32 v65, v66, v67
    v_cvt_pk_bf16_f32 v66, v68, v69
    v_accvgpr_read_b32 v70, a1
    v_accvgpr_read_b32 v71, a5
    v_accvgpr_read_b32 v72, a9
    v_accvgpr_read_b32 v73, a13
    v_accvgpr_read_b32 v74, a17
    v_accvgpr_read_b32 v75, a21
    v_pk_mul_f32 v[70:71], v[70:71], v[48:49] op_sel:[0,1] op_sel_hi:[1,1]
    v_pk_mul_f32 v[72:73], v[72:73], v[48:49] op_sel:[0,1] op_sel_hi:[1,1]
    v_pk_mul_f32 v[74:75], v[74:75], v[48:49] op_sel:[0,1] op_sel_hi:[1,1]
    v_cvt_pk_bf16_f32 v70, v70, v71
    v_cvt_pk_bf16_f32 v71, v72, v73
    v_cvt_pk_bf16_f32 v72, v74, v75
    buffer_store_dwordx3 v[64:66], v56, s[12:15], s24 offen offset:0 sc0 sc1
    v_accvgpr_read_b32 v76, a2
    v_accvgpr_read_b32 v77, a6
    v_accvgpr_read_b32 v78, a10
    v_accvgpr_read_b32 v79, a14
    v_accvgpr_read_b32 v80, a18
    v_accvgpr_read_b32 v81, a22
    v_pk_mul_f32 v[76:77], v[76:77], v[50:51] op_sel_hi:[1,0]
    v_pk_mul_f32 v[78:79], v[78:79], v[50:51] op_sel_hi:[1,0]
    v_pk_mul_f32 v[80:81], v[80:81], v[50:51] op_sel_hi:[1,0]
    v_cvt_pk_bf16_f32 v76, v76, v77
    v_cvt_pk_bf16_f32 v77, v78, v79
    v_cvt_pk_bf16_f32 v78, v80, v81
    buffer_store_dwordx3 v[70:72], v56, s[12:15], s24 offen offset:384 sc0 sc1
    v_accvgpr_read_b32 v82, a3
    v_accvgpr_read_b32 v83, a7
    v_accvgpr_read_b32 v84, a11
    v_accvgpr_read_b32 v85, a15
    v_accvgpr_read_b32 v86, a19
    v_accvgpr_read_b32 v87, a23
    v_pk_mul_f32 v[82:83], v[82:83], v[50:51] op_sel:[0,1] op_sel_hi:[1,1]
    v_pk_mul_f32 v[84:85], v[84:85], v[50:51] op_sel:[0,1] op_sel_hi:[1,1]
    v_pk_mul_f32 v[86:87], v[86:87], v[50:51] op_sel:[0,1] op_sel_hi:[1,1]
    v_cvt_pk_bf16_f32 v82, v82, v83
    v_cvt_pk_bf16_f32 v83, v84, v85
    v_cvt_pk_bf16_f32 v84, v86, v87
    buffer_store_dwordx3 v[76:78], v56, s[12:15], s24 offen offset:768 sc0 sc1
    v_accvgpr_read_b32 v88, a24
    v_accvgpr_read_b32 v89, a28
    v_accvgpr_read_b32 v90, a32
    v_accvgpr_read_b32 v91, a36
    v_accvgpr_read_b32 v92, a40
    v_accvgpr_read_b32 v93, a44
    v_pk_mul_f32 v[88:89], v[88:89], v[48:49] op_sel_hi:[1,0]
    v_pk_mul_f32 v[90:91], v[90:91], v[48:49] op_sel_hi:[1,0]
    v_pk_mul_f32 v[92:93], v[92:93], v[48:49] op_sel_hi:[1,0]
    v_cvt_pk_bf16_f32 v88, v88, v89
    v_cvt_pk_bf16_f32 v89, v90, v91
    v_cvt_pk_bf16_f32 v90, v92, v93
    buffer_store_dwordx3 v[82:84], v56, s[12:15], s24 offen offset:1152 sc0 sc1
    v_accvgpr_read_b32 v94, a25
    v_accvgpr_read_b32 v95, a29
    v_accvgpr_read_b32 v96, a33
    v_accvgpr_read_b32 v97, a37
    v_accvgpr_read_b32 v98, a41
    v_accvgpr_read_b32 v99, a45
    v_pk_mul_f32 v[94:95], v[94:95], v[48:49] op_sel:[0,1] op_sel_hi:[1,1]
    v_pk_mul_f32 v[96:97], v[96:97], v[48:49] op_sel:[0,1] op_sel_hi:[1,1]
    v_pk_mul_f32 v[98:99], v[98:99], v[48:49] op_sel:[0,1] op_sel_hi:[1,1]
    v_cvt_pk_bf16_f32 v94, v94, v95
    v_cvt_pk_bf16_f32 v95, v96, v97
    v_cvt_pk_bf16_f32 v96, v98, v99
    buffer_store_dwordx3 v[88:90], v56, s[12:15], s24 offen offset:192 sc0 sc1
    v_accvgpr_read_b32 v100, a26
    v_accvgpr_read_b32 v101, a30
    v_accvgpr_read_b32 v102, a34
    v_accvgpr_read_b32 v103, a38
    v_accvgpr_read_b32 v104, a42
    v_accvgpr_read_b32 v105, a46
    v_pk_mul_f32 v[100:101], v[100:101], v[50:51] op_sel_hi:[1,0]
    v_pk_mul_f32 v[102:103], v[102:103], v[50:51] op_sel_hi:[1,0]
    v_pk_mul_f32 v[104:105], v[104:105], v[50:51] op_sel_hi:[1,0]
    v_cvt_pk_bf16_f32 v100, v100, v101
    v_cvt_pk_bf16_f32 v101, v102, v103
    v_cvt_pk_bf16_f32 v102, v104, v105
    buffer_store_dwordx3 v[94:96], v56, s[12:15], s24 offen offset:576 sc0 sc1
    v_accvgpr_read_b32 v106, a27
    v_accvgpr_read_b32 v107, a31
    v_accvgpr_read_b32 v108, a35
    v_accvgpr_read_b32 v109, a39
    v_accvgpr_read_b32 v110, a43
    v_accvgpr_read_b32 v111, a47
    v_pk_mul_f32 v[106:107], v[106:107], v[50:51] op_sel:[0,1] op_sel_hi:[1,1]
    v_pk_mul_f32 v[108:109], v[108:109], v[50:51] op_sel:[0,1] op_sel_hi:[1,1]
    v_pk_mul_f32 v[110:111], v[110:111], v[50:51] op_sel:[0,1] op_sel_hi:[1,1]
    v_cvt_pk_bf16_f32 v106, v106, v107
    v_cvt_pk_bf16_f32 v107, v108, v109
    v_cvt_pk_bf16_f32 v108, v110, v111
    buffer_store_dwordx3 v[100:102], v56, s[12:15], s24 offen offset:960 sc0 sc1
    v_accvgpr_read_b32 v64, a48
    v_accvgpr_read_b32 v65, a52
    v_accvgpr_read_b32 v66, a56
    v_accvgpr_read_b32 v67, a60
    v_accvgpr_read_b32 v68, a64
    v_accvgpr_read_b32 v69, a68
    v_pk_mul_f32 v[64:65], v[64:65], v[52:53] op_sel_hi:[1,0]
    v_pk_mul_f32 v[66:67], v[66:67], v[52:53] op_sel_hi:[1,0]
    v_pk_mul_f32 v[68:69], v[68:69], v[52:53] op_sel_hi:[1,0]
    v_cvt_pk_bf16_f32 v64, v64, v65
    v_cvt_pk_bf16_f32 v65, v66, v67
    v_cvt_pk_bf16_f32 v66, v68, v69
    buffer_store_dwordx3 v[106:108], v56, s[12:15], s24 offen offset:1344 sc0 sc1
    v_accvgpr_read_b32 v70, a49
    v_accvgpr_read_b32 v71, a53
    v_accvgpr_read_b32 v72, a57
    v_accvgpr_read_b32 v73, a61
    v_accvgpr_read_b32 v74, a65
    v_accvgpr_read_b32 v75, a69
    v_pk_mul_f32 v[70:71], v[70:71], v[52:53] op_sel:[0,1] op_sel_hi:[1,1]
    v_pk_mul_f32 v[72:73], v[72:73], v[52:53] op_sel:[0,1] op_sel_hi:[1,1]
    v_pk_mul_f32 v[74:75], v[74:75], v[52:53] op_sel:[0,1] op_sel_hi:[1,1]
    v_cvt_pk_bf16_f32 v70, v70, v71
    v_cvt_pk_bf16_f32 v71, v72, v73
    v_cvt_pk_bf16_f32 v72, v74, v75
    buffer_store_dwordx3 v[64:66], v56, s[12:15], s40 offen offset:0 sc0 sc1
    v_accvgpr_read_b32 v76, a50
    v_accvgpr_read_b32 v77, a54
    v_accvgpr_read_b32 v78, a58
    v_accvgpr_read_b32 v79, a62
    v_accvgpr_read_b32 v80, a66
    v_accvgpr_read_b32 v81, a70
    v_pk_mul_f32 v[76:77], v[76:77], v[54:55] op_sel_hi:[1,0]
    v_pk_mul_f32 v[78:79], v[78:79], v[54:55] op_sel_hi:[1,0]
    v_pk_mul_f32 v[80:81], v[80:81], v[54:55] op_sel_hi:[1,0]
    v_cvt_pk_bf16_f32 v76, v76, v77
    v_cvt_pk_bf16_f32 v77, v78, v79
    v_cvt_pk_bf16_f32 v78, v80, v81
    buffer_store_dwordx3 v[70:72], v56, s[12:15], s40 offen offset:384 sc0 sc1
    v_accvgpr_read_b32 v82, a51
    v_accvgpr_read_b32 v83, a55
    v_accvgpr_read_b32 v84, a59
    v_accvgpr_read_b32 v85, a63
    v_accvgpr_read_b32 v86, a67
    v_accvgpr_read_b32 v87, a71
    v_pk_mul_f32 v[82:83], v[82:83], v[54:55] op_sel:[0,1] op_sel_hi:[1,1]
    v_pk_mul_f32 v[84:85], v[84:85], v[54:55] op_sel:[0,1] op_sel_hi:[1,1]
    v_pk_mul_f32 v[86:87], v[86:87], v[54:55] op_sel:[0,1] op_sel_hi:[1,1]
    v_cvt_pk_bf16_f32 v82, v82, v83
    v_cvt_pk_bf16_f32 v83, v84, v85
    v_cvt_pk_bf16_f32 v84, v86, v87
    buffer_store_dwordx3 v[76:78], v56, s[12:15], s40 offen offset:768 sc0 sc1
    v_accvgpr_read_b32 v88, a72
    v_accvgpr_read_b32 v89, a76
    v_accvgpr_read_b32 v90, a80
    v_accvgpr_read_b32 v91, a84
    v_accvgpr_read_b32 v92, a88
    v_accvgpr_read_b32 v93, a92
    v_pk_mul_f32 v[88:89], v[88:89], v[52:53] op_sel_hi:[1,0]
    v_pk_mul_f32 v[90:91], v[90:91], v[52:53] op_sel_hi:[1,0]
    v_pk_mul_f32 v[92:93], v[92:93], v[52:53] op_sel_hi:[1,0]
    v_cvt_pk_bf16_f32 v88, v88, v89
    v_cvt_pk_bf16_f32 v89, v90, v91
    v_cvt_pk_bf16_f32 v90, v92, v93
    buffer_store_dwordx3 v[82:84], v56, s[12:15], s40 offen offset:1152 sc0 sc1
    v_accvgpr_read_b32 v94, a73
    v_accvgpr_read_b32 v95, a77
    v_accvgpr_read_b32 v96, a81
    v_accvgpr_read_b32 v97, a85
    v_accvgpr_read_b32 v98, a89
    v_accvgpr_read_b32 v99, a93
    v_pk_mul_f32 v[94:95], v[94:95], v[52:53] op_sel:[0,1] op_sel_hi:[1,1]
    v_pk_mul_f32 v[96:97], v[96:97], v[52:53] op_sel:[0,1] op_sel_hi:[1,1]
    v_pk_mul_f32 v[98:99], v[98:99], v[52:53] op_sel:[0,1] op_sel_hi:[1,1]
    v_cvt_pk_bf16_f32 v94, v94, v95
    v_cvt_pk_bf16_f32 v95, v96, v97
    v_cvt_pk_bf16_f32 v96, v98, v99
    buffer_store_dwordx3 v[88:90], v56, s[12:15], s40 offen offset:192 sc0 sc1
    v_accvgpr_read_b32 v100, a74
    v_accvgpr_read_b32 v101, a78
    v_accvgpr_read_b32 v102, a82
    v_accvgpr_read_b32 v103, a86
    v_accvgpr_read_b32 v104, a90
    v_accvgpr_read_b32 v105, a94
    v_pk_mul_f32 v[100:101], v[100:101], v[54:55] op_sel_hi:[1,0]
    v_pk_mul_f32 v[102:103], v[102:103], v[54:55] op_sel_hi:[1,0]
    v_pk_mul_f32 v[104:105], v[104:105], v[54:55] op_sel_hi:[1,0]
    v_cvt_pk_bf16_f32 v100, v100, v101
    v_cvt_pk_bf16_f32 v101, v102, v103
    v_cvt_pk_bf16_f32 v102, v104, v105
    buffer_store_dwordx3 v[94:96], v56, s[12:15], s40 offen offset:576 sc0 sc1
    v_accvgpr_read_b32 v106, a75
    v_accvgpr_read_b32 v107, a79
    v_accvgpr_read_b32 v108, a83
    v_accvgpr_read_b32 v109, a87
    v_accvgpr_read_b32 v110, a91
    v_accvgpr_read_b32 v111, a95
    v_pk_mul_f32 v[106:107], v[106:107], v[54:55] op_sel:[0,1] op_sel_hi:[1,1]
    v_pk_mul_f32 v[108:109], v[108:109], v[54:55] op_sel:[0,1] op_sel_hi:[1,1]
    v_pk_mul_f32 v[110:111], v[110:111], v[54:55] op_sel:[0,1] op_sel_hi:[1,1]
    v_cvt_pk_bf16_f32 v106, v106, v107
    v_cvt_pk_bf16_f32 v107, v108, v109
    v_cvt_pk_bf16_f32 v108, v110, v111
    buffer_store_dwordx3 v[100:102], v56, s[12:15], s40 offen offset:960 sc0 sc1
    v_accvgpr_read_b32 v64, a96
    v_accvgpr_read_b32 v65, a100
    v_accvgpr_read_b32 v66, a104
    v_accvgpr_read_b32 v67, a108
    v_accvgpr_read_b32 v68, a112
    v_accvgpr_read_b32 v69, a116
    v_pk_mul_f32 v[64:65], v[64:65], v[128:129] op_sel_hi:[1,0]
    v_pk_mul_f32 v[66:67], v[66:67], v[128:129] op_sel_hi:[1,0]
    v_pk_mul_f32 v[68:69], v[68:69], v[128:129] op_sel_hi:[1,0]
    v_cvt_pk_bf16_f32 v64, v64, v65
    v_cvt_pk_bf16_f32 v65, v66, v67
    v_cvt_pk_bf16_f32 v66, v68, v69
    buffer_store_dwordx3 v[106:108], v56, s[12:15], s40 offen offset:1344 sc0 sc1
    v_accvgpr_read_b32 v70, a97
    v_accvgpr_read_b32 v71, a101
    v_accvgpr_read_b32 v72, a105
    v_accvgpr_read_b32 v73, a109
    v_accvgpr_read_b32 v74, a113
    v_accvgpr_read_b32 v75, a117
    v_pk_mul_f32 v[70:71], v[70:71], v[128:129] op_sel:[0,1] op_sel_hi:[1,1]
    v_pk_mul_f32 v[72:73], v[72:73], v[128:129] op_sel:[0,1] op_sel_hi:[1,1]
    v_pk_mul_f32 v[74:75], v[74:75], v[128:129] op_sel:[0,1] op_sel_hi:[1,1]
    v_cvt_pk_bf16_f32 v70, v70, v71
    v_cvt_pk_bf16_f32 v71, v72, v73
    v_cvt_pk_bf16_f32 v72, v74, v75
    buffer_store_dwordx3 v[64:66], v56, s[12:15], s41 offen offset:0 sc0 sc1
    v_accvgpr_read_b32 v76, a98
    v_accvgpr_read_b32 v77, a102
    v_accvgpr_read_b32 v78, a106
    v_accvgpr_read_b32 v79, a110
    v_accvgpr_read_b32 v80, a114
    v_accvgpr_read_b32 v81, a118
    v_pk_mul_f32 v[76:77], v[76:77], v[130:131] op_sel_hi:[1,0]
    v_pk_mul_f32 v[78:79], v[78:79], v[130:131] op_sel_hi:[1,0]
    v_pk_mul_f32 v[80:81], v[80:81], v[130:131] op_sel_hi:[1,0]
    v_cvt_pk_bf16_f32 v76, v76, v77
    v_cvt_pk_bf16_f32 v77, v78, v79
    v_cvt_pk_bf16_f32 v78, v80, v81
    buffer_store_dwordx3 v[70:72], v56, s[12:15], s41 offen offset:384 sc0 sc1
    v_accvgpr_read_b32 v82, a99
    v_accvgpr_read_b32 v83, a103
    v_accvgpr_read_b32 v84, a107
    v_accvgpr_read_b32 v85, a111
    v_accvgpr_read_b32 v86, a115
    v_accvgpr_read_b32 v87, a119
    v_pk_mul_f32 v[82:83], v[82:83], v[130:131] op_sel:[0,1] op_sel_hi:[1,1]
    v_pk_mul_f32 v[84:85], v[84:85], v[130:131] op_sel:[0,1] op_sel_hi:[1,1]
    v_pk_mul_f32 v[86:87], v[86:87], v[130:131] op_sel:[0,1] op_sel_hi:[1,1]
    v_cvt_pk_bf16_f32 v82, v82, v83
    v_cvt_pk_bf16_f32 v83, v84, v85
    v_cvt_pk_bf16_f32 v84, v86, v87
    buffer_store_dwordx3 v[76:78], v56, s[12:15], s41 offen offset:768 sc0 sc1
    v_accvgpr_read_b32 v88, a120
    v_accvgpr_read_b32 v89, a124
    v_accvgpr_read_b32 v90, a128
    v_accvgpr_read_b32 v91, a132
    v_accvgpr_read_b32 v92, a136
    v_accvgpr_read_b32 v93, a140
    v_pk_mul_f32 v[88:89], v[88:89], v[128:129] op_sel_hi:[1,0]
    v_pk_mul_f32 v[90:91], v[90:91], v[128:129] op_sel_hi:[1,0]
    v_pk_mul_f32 v[92:93], v[92:93], v[128:129] op_sel_hi:[1,0]
    v_cvt_pk_bf16_f32 v88, v88, v89
    v_cvt_pk_bf16_f32 v89, v90, v91
    v_cvt_pk_bf16_f32 v90, v92, v93
    buffer_store_dwordx3 v[82:84], v56, s[12:15], s41 offen offset:1152 sc0 sc1
    v_accvgpr_read_b32 v94, a121
    v_accvgpr_read_b32 v95, a125
    v_accvgpr_read_b32 v96, a129
    v_accvgpr_read_b32 v97, a133
    v_accvgpr_read_b32 v98, a137
    v_accvgpr_read_b32 v99, a141
    v_pk_mul_f32 v[94:95], v[94:95], v[128:129] op_sel:[0,1] op_sel_hi:[1,1]
    v_pk_mul_f32 v[96:97], v[96:97], v[128:129] op_sel:[0,1] op_sel_hi:[1,1]
    v_pk_mul_f32 v[98:99], v[98:99], v[128:129] op_sel:[0,1] op_sel_hi:[1,1]
    v_cvt_pk_bf16_f32 v94, v94, v95
    v_cvt_pk_bf16_f32 v95, v96, v97
    v_cvt_pk_bf16_f32 v96, v98, v99
    buffer_store_dwordx3 v[88:90], v56, s[12:15], s41 offen offset:192 sc0 sc1
    v_accvgpr_read_b32 v100, a122
    v_accvgpr_read_b32 v101, a126
    v_accvgpr_read_b32 v102, a130
    v_accvgpr_read_b32 v103, a134
    v_accvgpr_read_b32 v104, a138
    v_accvgpr_read_b32 v105, a142
    v_pk_mul_f32 v[100:101], v[100:101], v[130:131] op_sel_hi:[1,0]
    v_pk_mul_f32 v[102:103], v[102:103], v[130:131] op_sel_hi:[1,0]
    v_pk_mul_f32 v[104:105], v[104:105], v[130:131] op_sel_hi:[1,0]
    v_cvt_pk_bf16_f32 v100, v100, v101
    v_cvt_pk_bf16_f32 v101, v102, v103
    v_cvt_pk_bf16_f32 v102, v104, v105
    buffer_store_dwordx3 v[94:96], v56, s[12:15], s41 offen offset:576 sc0 sc1
    v_accvgpr_read_b32 v106, a123
    v_accvgpr_read_b32 v107, a127
    v_accvgpr_read_b32 v108, a131
    v_accvgpr_read_b32 v109, a135
    v_accvgpr_read_b32 v110, a139
    v_accvgpr_read_b32 v111, a143
    v_pk_mul_f32 v[106:107], v[106:107], v[130:131] op_sel:[0,1] op_sel_hi:[1,1]
    v_pk_mul_f32 v[108:109], v[108:109], v[130:131] op_sel:[0,1] op_sel_hi:[1,1]
    v_pk_mul_f32 v[110:111], v[110:111], v[130:131] op_sel:[0,1] op_sel_hi:[1,1]
    v_cvt_pk_bf16_f32 v106, v106, v107
    v_cvt_pk_bf16_f32 v107, v108, v109
    v_cvt_pk_bf16_f32 v108, v110, v111
    buffer_store_dwordx3 v[100:102], v56, s[12:15], s41 offen offset:960 sc0 sc1
    v_accvgpr_read_b32 v64, a144
    v_accvgpr_read_b32 v65, a148
    v_accvgpr_read_b32 v66, a152
    v_accvgpr_read_b32 v67, a156
    v_accvgpr_read_b32 v68, a160
    v_accvgpr_read_b32 v69, a164
    v_pk_mul_f32 v[64:65], v[64:65], v[132:133] op_sel_hi:[1,0]
    v_pk_mul_f32 v[66:67], v[66:67], v[132:133] op_sel_hi:[1,0]
    v_pk_mul_f32 v[68:69], v[68:69], v[132:133] op_sel_hi:[1,0]
    v_cvt_pk_bf16_f32 v64, v64, v65
    v_cvt_pk_bf16_f32 v65, v66, v67
    v_cvt_pk_bf16_f32 v66, v68, v69
    buffer_store_dwordx3 v[106:108], v56, s[12:15], s41 offen offset:1344 sc0 sc1
    v_accvgpr_read_b32 v70, a145
    v_accvgpr_read_b32 v71, a149
    v_accvgpr_read_b32 v72, a153
    v_accvgpr_read_b32 v73, a157
    v_accvgpr_read_b32 v74, a161
    v_accvgpr_read_b32 v75, a165
    v_pk_mul_f32 v[70:71], v[70:71], v[132:133] op_sel:[0,1] op_sel_hi:[1,1]
    v_pk_mul_f32 v[72:73], v[72:73], v[132:133] op_sel:[0,1] op_sel_hi:[1,1]
    v_pk_mul_f32 v[74:75], v[74:75], v[132:133] op_sel:[0,1] op_sel_hi:[1,1]
    v_cvt_pk_bf16_f32 v70, v70, v71
    v_cvt_pk_bf16_f32 v71, v72, v73
    v_cvt_pk_bf16_f32 v72, v74, v75
    buffer_store_dwordx3 v[64:66], v56, s[12:15], s42 offen offset:0 sc0 sc1
    v_accvgpr_read_b32 v76, a146
    v_accvgpr_read_b32 v77, a150
    v_accvgpr_read_b32 v78, a154
    v_accvgpr_read_b32 v79, a158
    v_accvgpr_read_b32 v80, a162
    v_accvgpr_read_b32 v81, a166
    v_pk_mul_f32 v[76:77], v[76:77], v[134:135] op_sel_hi:[1,0]
    v_pk_mul_f32 v[78:79], v[78:79], v[134:135] op_sel_hi:[1,0]
    v_pk_mul_f32 v[80:81], v[80:81], v[134:135] op_sel_hi:[1,0]
    v_cvt_pk_bf16_f32 v76, v76, v77
    v_cvt_pk_bf16_f32 v77, v78, v79
    v_cvt_pk_bf16_f32 v78, v80, v81
    buffer_store_dwordx3 v[70:72], v56, s[12:15], s42 offen offset:384 sc0 sc1
    v_accvgpr_read_b32 v82, a147
    v_accvgpr_read_b32 v83, a151
    v_accvgpr_read_b32 v84, a155
    v_accvgpr_read_b32 v85, a159
    v_accvgpr_read_b32 v86, a163
    v_accvgpr_read_b32 v87, a167
    v_pk_mul_f32 v[82:83], v[82:83], v[134:135] op_sel:[0,1] op_sel_hi:[1,1]
    v_pk_mul_f32 v[84:85], v[84:85], v[134:135] op_sel:[0,1] op_sel_hi:[1,1]
    v_pk_mul_f32 v[86:87], v[86:87], v[134:135] op_sel:[0,1] op_sel_hi:[1,1]
    v_cvt_pk_bf16_f32 v82, v82, v83
    v_cvt_pk_bf16_f32 v83, v84, v85
    v_cvt_pk_bf16_f32 v84, v86, v87
    buffer_store_dwordx3 v[76:78], v56, s[12:15], s42 offen offset:768 sc0 sc1
    v_accvgpr_read_b32 v88, a168
    v_accvgpr_read_b32 v89, a172
    v_accvgpr_read_b32 v90, a176
    v_accvgpr_read_b32 v91, a180
    v_accvgpr_read_b32 v92, a184
    v_accvgpr_read_b32 v93, a188
    v_pk_mul_f32 v[88:89], v[88:89], v[132:133] op_sel_hi:[1,0]
    v_pk_mul_f32 v[90:91], v[90:91], v[132:133] op_sel_hi:[1,0]
    v_pk_mul_f32 v[92:93], v[92:93], v[132:133] op_sel_hi:[1,0]
    v_cvt_pk_bf16_f32 v88, v88, v89
    v_cvt_pk_bf16_f32 v89, v90, v91
    v_cvt_pk_bf16_f32 v90, v92, v93
    buffer_store_dwordx3 v[82:84], v56, s[12:15], s42 offen offset:1152 sc0 sc1
    v_accvgpr_read_b32 v94, a169
    v_accvgpr_read_b32 v95, a173
    v_accvgpr_read_b32 v96, a177
    v_accvgpr_read_b32 v97, a181
    v_accvgpr_read_b32 v98, a185
    v_accvgpr_read_b32 v99, a189
    v_pk_mul_f32 v[94:95], v[94:95], v[132:133] op_sel:[0,1] op_sel_hi:[1,1]
    v_pk_mul_f32 v[96:97], v[96:97], v[132:133] op_sel:[0,1] op_sel_hi:[1,1]
    v_pk_mul_f32 v[98:99], v[98:99], v[132:133] op_sel:[0,1] op_sel_hi:[1,1]
    v_cvt_pk_bf16_f32 v94, v94, v95
    v_cvt_pk_bf16_f32 v95, v96, v97
    v_cvt_pk_bf16_f32 v96, v98, v99
    buffer_store_dwordx3 v[88:90], v56, s[12:15], s42 offen offset:192 sc0 sc1
    v_accvgpr_read_b32 v100, a170
    v_accvgpr_read_b32 v101, a174
    v_accvgpr_read_b32 v102, a178
    v_accvgpr_read_b32 v103, a182
    v_accvgpr_read_b32 v104, a186
    v_accvgpr_read_b32 v105, a190
    v_pk_mul_f32 v[100:101], v[100:101], v[134:135] op_sel_hi:[1,0]
    v_pk_mul_f32 v[102:103], v[102:103], v[134:135] op_sel_hi:[1,0]
    v_pk_mul_f32 v[104:105], v[104:105], v[134:135] op_sel_hi:[1,0]
    v_cvt_pk_bf16_f32 v100, v100, v101
    v_cvt_pk_bf16_f32 v101, v102, v103
    v_cvt_pk_bf16_f32 v102, v104, v105
    buffer_store_dwordx3 v[94:96], v56, s[12:15], s42 offen offset:576 sc0 sc1
    v_accvgpr_read_b32 v106, a171
    v_accvgpr_read_b32 v107, a175
    v_accvgpr_read_b32 v108, a179
    v_accvgpr_read_b32 v109, a183
    v_accvgpr_read_b32 v110, a187
    v_accvgpr_read_b32 v111, a191
    v_pk_mul_f32 v[106:107], v[106:107], v[134:135] op_sel:[0,1] op_sel_hi:[1,1]
    v_pk_mul_f32 v[108:109], v[108:109], v[134:135] op_sel:[0,1] op_sel_hi:[1,1]
    v_pk_mul_f32 v[110:111], v[110:111], v[134:135] op_sel:[0,1] op_sel_hi:[1,1]
    v_cvt_pk_bf16_f32 v106, v106, v107
    v_cvt_pk_bf16_f32 v107, v108, v109
    v_cvt_pk_bf16_f32 v108, v110, v111
    buffer_store_dwordx3 v[100:102], v56, s[12:15], s42 offen offset:960 sc0 sc1
    buffer_store_dwordx3 v[106:108], v56, s[12:15], s42 offen offset:1344 sc0 sc1
    s_branch L_fin
.section .rodata,"a"
.p2align 6
.amdhsa_kernel standalone__kv_cache_quant_int4_int2_kv_with_per_channel_or_per_token_scales__prompt_kernel
  .amdhsa_next_free_vgpr 512
  .amdhsa_next_free_sgpr 102
  .amdhsa_accum_offset 256
  .amdhsa_group_segment_fixed_size 0
  .amdhsa_kernarg_size 80
  .amdhsa_user_sgpr_count 2
  .amdhsa_user_sgpr_kernarg_segment_ptr 1
  .amdhsa_system_sgpr_workgroup_id_x 1
.end_amdhsa_kernel
```
